```python
import torch

def _softmax(x, axis=-1):
    return torch.softmax(x, dim=axis)
def _gelu(x):
    return torch.nn.functional.gelu(x, approximate="tanh")
def _silu(x):
    return torch.nn.functional.silu(x)
def _sigmoid(x):
    return torch.sigmoid(x)
def _layernorm(x, axis=-1, eps=1e-5):
    m = x.mean(dim=axis, keepdim=True)
    v = x.var(dim=axis, keepdim=True, unbiased=False)
    return (x - m) / torch.sqrt(v + eps)
def _scatter_add(tgt, idx, src, axis=0):
    return tgt.clone().index_add_(axis, idx, src)
def _segment_sum(src, seg, n):
    out = torch.zeros((n,) + src.shape[1:], dtype=src.dtype)
    return out.index_add_(0, seg, src)
def _pad(x, pw):
    flat = tuple(v for pair in reversed(pw) for v in pair)
    return torch.nn.functional.pad(x, flat)

kernel_name = 'interleave_layers__sliding_local_dilated__softmax_full_mha__prompt'

def setup_inputs():

    _w = (lambda a: (lambda t: t.to(torch.bfloat16) if t.is_floating_point() else t)(torch.as_tensor(a)))
    def _A_setup():
        B, S, D = 1, 2048, 1024
        return {
            "x": _w((lambda *s: torch.randn(*s, dtype=torch.bfloat16) * 0.05)(B, S, D)),
            "wqkv": _w((lambda *s: torch.randn(*s, dtype=torch.bfloat16) * 0.05)(D, 3 * D)),
            "wo": _w((lambda *s: torch.randn(*s, dtype=torch.bfloat16) * 0.05)(D, D)),
        }
    _A_in = _A_setup()

    def _B_setup():
        B, S, D = 1, 2048, 1024
        return {
            "x": _w((lambda *s: torch.randn(*s, dtype=torch.bfloat16) * 0.05)(B, S, D)),
            "wqkv": _w((lambda *s: torch.randn(*s, dtype=torch.bfloat16) * 0.05)(D, 3 * D)),
            "wo": _w((lambda *s: torch.randn(*s, dtype=torch.bfloat16) * 0.05)(D, D)),
        }
    _B_in = _B_setup()

    return {
        "A_x": _A_in["x"],
        "A_wqkv": _A_in["wqkv"],
        "A_wo": _A_in["wo"],
        "B_x": _B_in["x"],
        "B_wqkv": _B_in["wqkv"],
        "B_wo": _B_in["wo"],
    }

def reference(A_x, A_wqkv, A_wo, B_x, B_wqkv, B_wo):
    def _A_ref(x, wqkv, wo):
        B, S, D = x.shape
        H = 32; Dh = D // H
        W, dil = 8, 2
        qkv = (lambda x, *d: x.permute(*d))((x @ wqkv).reshape(B, S, 3, H, Dh), 2, 0, 3, 1, 4)
        q, k, v = qkv[0], qkv[1], qkv[2]
        scale = Dh ** -0.5
        pos = torch.arange(S)
        off = torch.arange(W) * dil
        idx = pos[:, None] - off[None, :]
        mask = idx >= 0
        idx_c = torch.where(mask, idx, 0).reshape(-1)
        kg = k[:, :, idx_c, :].reshape(B, H, S, W, Dh)
        vg = v[:, :, idx_c, :].reshape(B, H, S, W, Dh)
        logits = torch.einsum("bhsd,bhswd->bhsw", q, kg) * scale
        logits = torch.where(mask[None, None, :, :], logits, -1e9)
        attn = _softmax(logits, axis=-1)
        o = torch.einsum("bhsw,bhswd->bhsd", attn, vg)
        return (lambda x, *d: x.permute(*d))(o, 0, 2, 1, 3).reshape(B, S, D) @ wo

    def _B_ref(x, wqkv, wo):
        B, S, D = x.shape
        H = 32; Dh = D // H
        qkv = (lambda x, *d: x.permute(*d))((x @ wqkv).reshape(B, S, 3, H, Dh), 2, 0, 3, 1, 4)
        q, k, v = qkv[0], qkv[1], qkv[2]
        scale = Dh ** -0.5
        scores = torch.einsum("bhqd,bhkd->bhqk", q, k) * scale
        p = _softmax(scores, axis=-1)
        o = torch.einsum("bhqk,bhkd->bhqd", p, v)
        return (lambda x, *d: x.permute(*d))(o, 0, 2, 1, 3).reshape(B, S, D) @ wo

    x = A_x
    x = x + _A_ref(_layernorm(x, axis=-1), A_wqkv, A_wo)
    x = x + _B_ref(_layernorm(x, axis=-1), B_wqkv, B_wo)
    x = x + _A_ref(_layernorm(x, axis=-1), A_wqkv, A_wo)
    x = x + _B_ref(_layernorm(x, axis=-1), B_wqkv, B_wo)
    return x
```

```asm
; @launch grid=(256,1,1) block=(512,1,1) lds=158720
.amdgcn_target "amdgcn-amd-amdhsa--gfx950"
.text
.globl interleave_layers__sliding_local_dilated__softmax_full_mha__prompt_kernel
.type interleave_layers__sliding_local_dilated__softmax_full_mha__prompt_kernel,@function
.p2align 8
interleave_layers__sliding_local_dilated__softmax_full_mha__prompt_kernel:
    s_mov_b32 s96, 0
    s_mov_b32 s98, 10
    s_mov_b32 s100, 0
    s_mov_b32 s101, 0
    s_cmp_ge_u32 s2, 256
    s_cbranch_scc1 mega_exit
    s_branch prep_body
mega_next:
    s_add_u32 s96, s96, 1
    s_waitcnt lgkmcnt(0)
    s_branch mega_next3
mega_next2:
    s_add_u32 s96, s96, 1
mega_next3:
    s_barrier
    s_mov_b32 s99, 0
    s_cmp_ge_u32 s96, 3
    s_addc_u32 s99, s99, 0
    s_cmp_ge_u32 s96, 6
    s_addc_u32 s99, s99, 0
    s_cmp_ge_u32 s96, 8
    s_addc_u32 s99, s99, 0
    s_cmp_eq_u32 s96, 1
    s_cbranch_scc1 qkvA_body
    s_cmp_eq_u32 s96, 2
    s_cbranch_scc1 wo_body
    s_cmp_eq_u32 s96, 3
    s_cbranch_scc1 qkvB_body
    s_cmp_eq_u32 s96, 4
    s_cbranch_scc1 attn_body
    s_cmp_eq_u32 s96, 5
    s_cbranch_scc1 wo_body
    s_cmp_eq_u32 s96, 6
    s_cbranch_scc1 qkvA_body
    s_cmp_eq_u32 s96, 7
    s_cbranch_scc1 wo_body
    s_cmp_eq_u32 s96, 8
    s_cbranch_scc1 qkvB_body
    s_cmp_eq_u32 s96, 9
    s_cbranch_scc1 attn_body
    s_cmp_eq_u32 s96, 10
    s_cbranch_scc1 woF_body
mega_exit:
    s_endpgm
.p2align 6
prep_body:
    s_load_dwordx2 s[4:5], s[0:1], 0
    s_load_dwordx2 s[6:7], s[0:1], 8
    s_load_dwordx2 s[8:9], s[0:1], 32
    s_load_dwordx4 s[40:43], s[0:1], 56
    s_load_dwordx2 s[44:45], s[0:1], 16
    s_load_dwordx2 s[46:47], s[0:1], 40
    s_memrealtime s[60:61]
    v_and_b32 v1, 63, v0
    v_lshrrev_b32 v2, 6, v0
    s_nop 0
    v_readfirstlane_b32 s30, v2
    v_mov_b32 v210, 0
    s_waitcnt lgkmcnt(0)
    s_mov_b32 s16, s42
    s_mov_b32 s17, s43
    s_mov_b32 s18, 75497472
    s_mov_b32 s19, 0x00020000
    s_mov_b32 s32, s40
    s_mov_b32 s33, s41
    s_mov_b32 s34, 256
    s_mov_b32 s35, 0x00020000
    s_lshl_b32 s3, s2, 3
    s_add_u32 s3, s3, s30
    s_cmp_lg_u32 s3, 7
    s_cbranch_scc1 prep_nonon
    v_lshrrev_b32 v211, 3, v1
    v_lshlrev_b32 v211, 8, v211
    v_and_b32 v212, 7, v1
    v_lshl_add_u32 v211, v212, 4, v211
    v_mov_b32 v212, 0
    v_mov_b32 v213, 0
    v_mov_b32 v214, 0
    v_mov_b32 v215, 0
    s_mov_b32 s3, 71303168
    buffer_store_dwordx4 v[212:215], v211, s[16:19], s3 offen sc1
    s_add_u32 s3, s3, 2048
    buffer_store_dwordx4 v[212:215], v211, s[16:19], s3 offen sc1
    s_add_u32 s3, s3, 2048
    buffer_store_dwordx4 v[212:215], v211, s[16:19], s3 offen sc1
    s_add_u32 s3, s3, 2048
    buffer_store_dwordx4 v[212:215], v211, s[16:19], s3 offen sc1
    s_add_u32 s3, s3, 2048
    buffer_store_dwordx4 v[212:215], v211, s[16:19], s3 offen sc1
    s_add_u32 s3, s3, 2048
    buffer_store_dwordx4 v[212:215], v211, s[16:19], s3 offen sc1
    s_add_u32 s3, s3, 2048
    buffer_store_dwordx4 v[212:215], v211, s[16:19], s3 offen sc1
    s_add_u32 s3, s3, 2048
    buffer_store_dwordx4 v[212:215], v211, s[16:19], s3 offen sc1
    s_add_u32 s3, s3, 2048
    s_or_b32 s60, s60, 1
    v_mov_b32 v208, s60
    v_mov_b32 v209, s61
    s_waitcnt vmcnt(0)
    buffer_store_dwordx2 v[208:209], v210, s[32:35], 0 offen sc1
    v_lshlrev_b32 v211, 8, v1
    s_mov_b32 s3, 71335936
    buffer_store_dword v210, v211, s[16:19], s3 offen sc1
    s_add_u32 s3, s3, 16384
    buffer_store_dword v210, v211, s[16:19], s3 offen sc1
    s_add_u32 s3, s3, 16384
    buffer_store_dword v210, v211, s[16:19], s3 offen sc1
    s_add_u32 s3, s3, 16384
    buffer_store_dword v210, v211, s[16:19], s3 offen sc1
    s_add_u32 s3, s3, 16384
    buffer_store_dword v210, v211, s[16:19], s3 offen sc1
    s_add_u32 s3, s3, 16384
    buffer_store_dword v210, v211, s[16:19], s3 offen sc1
    s_add_u32 s3, s3, 16384
    buffer_store_dword v210, v211, s[16:19], s3 offen sc1
    s_add_u32 s3, s3, 16384
    buffer_store_dword v210, v211, s[16:19], s3 offen sc1
    s_add_u32 s3, s3, 16384
    buffer_store_dword v210, v211, s[16:19], s3 offen sc1
    s_add_u32 s3, s3, 16384
    buffer_store_dword v210, v211, s[16:19], s3 offen sc1
    s_add_u32 s3, s3, 16384
    buffer_store_dword v210, v211, s[16:19], s3 offen sc1
    s_add_u32 s3, s3, 16384
    buffer_store_dword v210, v211, s[16:19], s3 offen sc1
    s_add_u32 s3, s3, 16384
    buffer_store_dword v210, v211, s[16:19], s3 offen sc1
    s_add_u32 s3, s3, 16384
    buffer_store_dword v210, v211, s[16:19], s3 offen sc1
    s_add_u32 s3, s3, 16384
    buffer_store_dword v210, v211, s[16:19], s3 offen sc1
    s_add_u32 s3, s3, 16384
    buffer_store_dword v210, v211, s[16:19], s3 offen sc1
    s_add_u32 s3, s3, 16384
    buffer_store_dword v210, v211, s[16:19], s3 offen sc1
    s_add_u32 s3, s3, 16384
    buffer_store_dword v210, v211, s[16:19], s3 offen sc1
    s_add_u32 s3, s3, 16384
    buffer_store_dword v210, v211, s[16:19], s3 offen sc1
    s_add_u32 s3, s3, 16384
    buffer_store_dword v210, v211, s[16:19], s3 offen sc1
    s_add_u32 s3, s3, 16384
    s_mov_b32 s3, 68730880
    s_waitcnt vmcnt(0)
    buffer_store_dwordx2 v[208:209], v210, s[16:19], s3 offen sc1
prep_nonon:
    s_cmp_ge_u32 s30, 4
    s_cbranch_scc1 prep_side
    s_mov_b32 s12, s4
    s_mov_b32 s13, s5
    s_mov_b32 s14, 4194304
    s_mov_b32 s15, 0x00020000
    s_lshr_b32 s21, s2, 2
    s_and_b32 s22, s2, 3
    s_lshl_b32 s22, s22, 2
    s_add_u32 s22, s22, s30
    v_lshrrev_b32 v3, 3, v1
    v_and_b32 v4, 7, v1
    v_lshlrev_b32 v5, 11, v3
    v_lshl_add_u32 v5, v4, 4, v5
    s_lshl_b32 s3, s21, 16
    s_lshl_b32 s23, s22, 7
    s_add_u32 s3, s3, s23
    buffer_load_dwordx4 v[8:11], v5, s[12:15], s3 offen
    s_add_u32 s3, s3, 16384
    buffer_load_dwordx4 v[12:15], v5, s[12:15], s3 offen
    s_add_u32 s3, s3, 16384
    buffer_load_dwordx4 v[16:19], v5, s[12:15], s3 offen
    s_add_u32 s3, s3, 16384
    buffer_load_dwordx4 v[20:23], v5, s[12:15], s3 offen
    s_add_u32 s3, s3, 16384
    v_lshrrev_b32 v6, 1, v4
    v_lshl_add_u32 v6, v2, 2, v6
    v_lshlrev_b32 v6, 10, v6
    v_lshl_add_u32 v6, v3, 4, v6
    v_and_b32 v7, 1, v4
    v_lshl_add_u32 v6, v7, 3, v6
    v_lshlrev_b32 v24, 4, v3
    s_lshl_b32 s24, s21, 12
    s_bfe_u32 s23, s22, 0x20001
    s_lshl_b32 s23, s23, 10
    s_add_u32 s24, s24, s23
    s_lshr_b32 s23, s22, 3
    s_lshl_b32 s23, s23, 9
    s_add_u32 s24, s24, s23
    s_and_b32 s23, s22, 1
    s_lshl_b32 s23, s23, 3
    s_add_u32 s24, s24, s23
    s_add_u32 s24, s24, 58720256
    v_mov_b32 v25, 0x3f803f80
    s_waitcnt vmcnt(3)
    ds_write_b64 v6, v[8:9] offset:0
    ds_write_b64 v6, v[10:11] offset:512
    v_mov_b32 v28, 0
    v_mov_b32 v29, 0
    v_dot2_f32_bf16 v28, v8, v25, v28
    v_dot2_f32_bf16 v29, v8, v8, v29
    v_dot2_f32_bf16 v28, v9, v25, v28
    v_dot2_f32_bf16 v29, v9, v9, v29
    v_dot2_f32_bf16 v28, v10, v25, v28
    v_dot2_f32_bf16 v29, v10, v10, v29
    v_dot2_f32_bf16 v28, v11, v25, v28
    v_dot2_f32_bf16 v29, v11, v11, v29
    s_nop 2
    v_add_f32_dpp v28, v28, v28 quad_perm:[1,0,3,2] row_mask:0xf bank_mask:0xf
    v_add_f32_dpp v29, v29, v29 quad_perm:[1,0,3,2] row_mask:0xf bank_mask:0xf
    s_nop 0
    v_add_f32_dpp v28, v28, v28 quad_perm:[2,3,0,1] row_mask:0xf bank_mask:0xf
    v_add_f32_dpp v29, v29, v29 quad_perm:[2,3,0,1] row_mask:0xf bank_mask:0xf
    s_nop 0
    v_add_f32_dpp v28, v28, v28 row_half_mirror row_mask:0xf bank_mask:0xf
    v_add_f32_dpp v29, v29, v29 row_half_mirror row_mask:0xf bank_mask:0xf
    buffer_store_dwordx2 v[28:29], v24, s[16:19], s24 offen offset:0 sc1
    s_waitcnt vmcnt(3)
    ds_write_b64 v6, v[12:13] offset:128
    ds_write_b64 v6, v[14:15] offset:640
    v_mov_b32 v30, 0
    v_mov_b32 v31, 0
    v_dot2_f32_bf16 v30, v12, v25, v30
    v_dot2_f32_bf16 v31, v12, v12, v31
    v_dot2_f32_bf16 v30, v13, v25, v30
    v_dot2_f32_bf16 v31, v13, v13, v31
    v_dot2_f32_bf16 v30, v14, v25, v30
    v_dot2_f32_bf16 v31, v14, v14, v31
    v_dot2_f32_bf16 v30, v15, v25, v30
    v_dot2_f32_bf16 v31, v15, v15, v31
    s_nop 2
    v_add_f32_dpp v30, v30, v30 quad_perm:[1,0,3,2] row_mask:0xf bank_mask:0xf
    v_add_f32_dpp v31, v31, v31 quad_perm:[1,0,3,2] row_mask:0xf bank_mask:0xf
    s_nop 0
    v_add_f32_dpp v30, v30, v30 quad_perm:[2,3,0,1] row_mask:0xf bank_mask:0xf
    v_add_f32_dpp v31, v31, v31 quad_perm:[2,3,0,1] row_mask:0xf bank_mask:0xf
    s_nop 0
    v_add_f32_dpp v30, v30, v30 row_half_mirror row_mask:0xf bank_mask:0xf
    v_add_f32_dpp v31, v31, v31 row_half_mirror row_mask:0xf bank_mask:0xf
    buffer_store_dwordx2 v[30:31], v24, s[16:19], s24 offen offset:128 sc1
    s_waitcnt vmcnt(3)
    ds_write_b64 v6, v[16:17] offset:256
    ds_write_b64 v6, v[18:19] offset:768
    v_mov_b32 v32, 0
    v_mov_b32 v33, 0
    v_dot2_f32_bf16 v32, v16, v25, v32
    v_dot2_f32_bf16 v33, v16, v16, v33
    v_dot2_f32_bf16 v32, v17, v25, v32
    v_dot2_f32_bf16 v33, v17, v17, v33
    v_dot2_f32_bf16 v32, v18, v25, v32
    v_dot2_f32_bf16 v33, v18, v18, v33
    v_dot2_f32_bf16 v32, v19, v25, v32
    v_dot2_f32_bf16 v33, v19, v19, v33
    s_nop 2
    v_add_f32_dpp v32, v32, v32 quad_perm:[1,0,3,2] row_mask:0xf bank_mask:0xf
    v_add_f32_dpp v33, v33, v33 quad_perm:[1,0,3,2] row_mask:0xf bank_mask:0xf
    s_nop 0
    v_add_f32_dpp v32, v32, v32 quad_perm:[2,3,0,1] row_mask:0xf bank_mask:0xf
    v_add_f32_dpp v33, v33, v33 quad_perm:[2,3,0,1] row_mask:0xf bank_mask:0xf
    s_nop 0
    v_add_f32_dpp v32, v32, v32 row_half_mirror row_mask:0xf bank_mask:0xf
    v_add_f32_dpp v33, v33, v33 row_half_mirror row_mask:0xf bank_mask:0xf
    buffer_store_dwordx2 v[32:33], v24, s[16:19], s24 offen offset:256 sc1
    s_waitcnt vmcnt(3)
    ds_write_b64 v6, v[20:21] offset:384
    ds_write_b64 v6, v[22:23] offset:896
    v_mov_b32 v34, 0
    v_mov_b32 v35, 0
    v_dot2_f32_bf16 v34, v20, v25, v34
    v_dot2_f32_bf16 v35, v20, v20, v35
    v_dot2_f32_bf16 v34, v21, v25, v34
    v_dot2_f32_bf16 v35, v21, v21, v35
    v_dot2_f32_bf16 v34, v22, v25, v34
    v_dot2_f32_bf16 v35, v22, v22, v35
    v_dot2_f32_bf16 v34, v23, v25, v34
    v_dot2_f32_bf16 v35, v23, v23, v35
    s_nop 2
    v_add_f32_dpp v34, v34, v34 quad_perm:[1,0,3,2] row_mask:0xf bank_mask:0xf
    v_add_f32_dpp v35, v35, v35 quad_perm:[1,0,3,2] row_mask:0xf bank_mask:0xf
    s_nop 0
    v_add_f32_dpp v34, v34, v34 quad_perm:[2,3,0,1] row_mask:0xf bank_mask:0xf
    v_add_f32_dpp v35, v35, v35 quad_perm:[2,3,0,1] row_mask:0xf bank_mask:0xf
    s_nop 0
    v_add_f32_dpp v34, v34, v34 row_half_mirror row_mask:0xf bank_mask:0xf
    v_add_f32_dpp v35, v35, v35 row_half_mirror row_mask:0xf bank_mask:0xf
    buffer_store_dwordx2 v[34:35], v24, s[16:19], s24 offen offset:384 sc1
    v_lshlrev_b32 v5, 4, v1
    v_lshl_add_u32 v7, v2, 12, v5
    s_waitcnt lgkmcnt(0)
    ds_read_b128 v[8:11], v7 offset:0
    ds_read_b128 v[12:15], v7 offset:1024
    ds_read_b128 v[16:19], v7 offset:2048
    ds_read_b128 v[20:23], v7 offset:3072
    buffer_load_dwordx2 v[208:209], v210, s[32:35], 0 offen sc1
    s_lshl_b32 s3, s21, 16
    s_lshl_b32 s23, s22, 12
    s_add_u32 s3, s3, s23
    s_waitcnt lgkmcnt(3)
    buffer_store_dwordx4 v[8:11], v5, s[16:19], s3 offen offset:0 sc1
    s_waitcnt lgkmcnt(2)
    buffer_store_dwordx4 v[12:15], v5, s[16:19], s3 offen offset:1024 sc1
    s_waitcnt lgkmcnt(1)
    buffer_store_dwordx4 v[16:19], v5, s[16:19], s3 offen offset:2048 sc1
    s_waitcnt lgkmcnt(0)
    buffer_store_dwordx4 v[20:23], v5, s[16:19], s3 offen offset:3072 sc1
    s_mov_b32 s37, 0x40000
    s_branch prep_n1_w
prep_n1:
    buffer_load_dwordx2 v[208:209], v210, s[32:35], 0 offen sc1
prep_n1_w:
    s_waitcnt vmcnt(0)
    v_readfirstlane_b32 s60, v208
    v_readfirstlane_b32 s61, v209
    s_sub_u32 s37, s37, 1
    s_cmp_eq_u32 s37, 0
    s_cbranch_scc1 prep_n1_ok
    s_cmp_eq_u32 s60, 0
    s_cbranch_scc1 prep_n1
prep_n1_ok:
    s_cmp_eq_u32 s96, s98
    s_cbranch_scc1 mega_exit
    s_lshl_b32 s36, s96, 15
    s_lshl_b32 s37, s21, 8
    s_add_u32 s36, s36, s37
    s_add_u32 s36, s36, 71303168
    s_add_u32 s54, s16, s36
    s_addc_u32 s55, s17, 0
    s_mov_b32 s59, 1
    s_waitcnt vmcnt(0)
    s_atomic_add s59, s[54:55], 0
    s_branch mega_next2
prep_side:
    s_cmp_eq_u32 s30, 7
    s_cbranch_scc1 prep_pf
    s_sub_u32 s3, s30, 4
    s_lshl_b32 s3, s3, 8
    s_add_u32 s27, s3, s2
    s_cmp_ge_u32 s27, 384
    s_cselect_b32 s12, s8, s6
    s_cselect_b32 s13, s9, s7
    s_cselect_b32 s21, 1, 0
    s_cselect_b32 s22, 384, 0
    s_sub_u32 s3, s27, s22
    s_mov_b32 s14, 6291456
    s_mov_b32 s15, 0x00020000
    s_and_b32 s22, s3, 15
    s_lshr_b32 s23, s3, 4
    v_lshrrev_b32 v3, 4, v1
    v_mul_u32_u24 v3, 6144, v3
    v_and_b32 v4, 15, v1
    v_lshl_add_u32 v3, v4, 4, v3
    s_mul_i32 s24, s22, 393216
    s_lshl_b32 s25, s23, 8
    s_add_u32 s24, s24, s25
    buffer_load_dwordx4 v[16:19], v3, s[12:15], s24 offen
    s_add_u32 s24, s24, 24576
    buffer_load_dwordx4 v[20:23], v3, s[12:15], s24 offen
    s_add_u32 s24, s24, 24576
    buffer_load_dwordx4 v[24:27], v3, s[12:15], s24 offen
    s_add_u32 s24, s24, 24576
    buffer_load_dwordx4 v[28:31], v3, s[12:15], s24 offen
    s_add_u32 s24, s24, 24576
    buffer_load_dwordx4 v[32:35], v3, s[12:15], s24 offen
    s_add_u32 s24, s24, 24576
    buffer_load_dwordx4 v[36:39], v3, s[12:15], s24 offen
    s_add_u32 s24, s24, 24576
    buffer_load_dwordx4 v[40:43], v3, s[12:15], s24 offen
    s_add_u32 s24, s24, 24576
    buffer_load_dwordx4 v[44:47], v3, s[12:15], s24 offen
    s_add_u32 s24, s24, 24576
    buffer_load_dwordx4 v[48:51], v3, s[12:15], s24 offen
    s_add_u32 s24, s24, 24576
    buffer_load_dwordx4 v[52:55], v3, s[12:15], s24 offen
    s_add_u32 s24, s24, 24576
    buffer_load_dwordx4 v[56:59], v3, s[12:15], s24 offen
    s_add_u32 s24, s24, 24576
    buffer_load_dwordx4 v[60:63], v3, s[12:15], s24 offen
    s_add_u32 s24, s24, 24576
    buffer_load_dwordx4 v[64:67], v3, s[12:15], s24 offen
    s_add_u32 s24, s24, 24576
    buffer_load_dwordx4 v[68:71], v3, s[12:15], s24 offen
    s_add_u32 s24, s24, 24576
    buffer_load_dwordx4 v[72:75], v3, s[12:15], s24 offen
    s_add_u32 s24, s24, 24576
    buffer_load_dwordx4 v[76:79], v3, s[12:15], s24 offen
    s_add_u32 s24, s24, 24576
    v_mov_b32 v8, 0
    v_mov_b32 v9, 0
    v_mov_b32 v10, 0
    v_mov_b32 v11, 0
    v_mov_b32 v12, 0
    v_mov_b32 v13, 0
    v_mov_b32 v14, 0
    v_mov_b32 v15, 0
    s_mov_b32 s20, 0xffff0000
    s_waitcnt vmcnt(15)
    v_lshlrev_b32 v6, 16, v16
    v_and_b32 v7, s20, v16
    v_pk_add_f32 v[8:9], v[8:9], v[6:7]
    v_lshlrev_b32 v6, 16, v17
    v_and_b32 v7, s20, v17
    v_pk_add_f32 v[10:11], v[10:11], v[6:7]
    v_lshlrev_b32 v6, 16, v18
    v_and_b32 v7, s20, v18
    v_pk_add_f32 v[12:13], v[12:13], v[6:7]
    v_lshlrev_b32 v6, 16, v19
    v_and_b32 v7, s20, v19
    v_pk_add_f32 v[14:15], v[14:15], v[6:7]
    s_waitcnt vmcnt(14)
    v_lshlrev_b32 v6, 16, v20
    v_and_b32 v7, s20, v20
    v_pk_add_f32 v[8:9], v[8:9], v[6:7]
    v_lshlrev_b32 v6, 16, v21
    v_and_b32 v7, s20, v21
    v_pk_add_f32 v[10:11], v[10:11], v[6:7]
    v_lshlrev_b32 v6, 16, v22
    v_and_b32 v7, s20, v22
    v_pk_add_f32 v[12:13], v[12:13], v[6:7]
    v_lshlrev_b32 v6, 16, v23
    v_and_b32 v7, s20, v23
    v_pk_add_f32 v[14:15], v[14:15], v[6:7]
    s_waitcnt vmcnt(13)
    v_lshlrev_b32 v6, 16, v24
    v_and_b32 v7, s20, v24
    v_pk_add_f32 v[8:9], v[8:9], v[6:7]
    v_lshlrev_b32 v6, 16, v25
    v_and_b32 v7, s20, v25
    v_pk_add_f32 v[10:11], v[10:11], v[6:7]
    v_lshlrev_b32 v6, 16, v26
    v_and_b32 v7, s20, v26
    v_pk_add_f32 v[12:13], v[12:13], v[6:7]
    v_lshlrev_b32 v6, 16, v27
    v_and_b32 v7, s20, v27
    v_pk_add_f32 v[14:15], v[14:15], v[6:7]
    s_waitcnt vmcnt(12)
    v_lshlrev_b32 v6, 16, v28
    v_and_b32 v7, s20, v28
    v_pk_add_f32 v[8:9], v[8:9], v[6:7]
    v_lshlrev_b32 v6, 16, v29
    v_and_b32 v7, s20, v29
    v_pk_add_f32 v[10:11], v[10:11], v[6:7]
    v_lshlrev_b32 v6, 16, v30
    v_and_b32 v7, s20, v30
    v_pk_add_f32 v[12:13], v[12:13], v[6:7]
    v_lshlrev_b32 v6, 16, v31
    v_and_b32 v7, s20, v31
    v_pk_add_f32 v[14:15], v[14:15], v[6:7]
    s_waitcnt vmcnt(11)
    v_lshlrev_b32 v6, 16, v32
    v_and_b32 v7, s20, v32
    v_pk_add_f32 v[8:9], v[8:9], v[6:7]
    v_lshlrev_b32 v6, 16, v33
    v_and_b32 v7, s20, v33
    v_pk_add_f32 v[10:11], v[10:11], v[6:7]
    v_lshlrev_b32 v6, 16, v34
    v_and_b32 v7, s20, v34
    v_pk_add_f32 v[12:13], v[12:13], v[6:7]
    v_lshlrev_b32 v6, 16, v35
    v_and_b32 v7, s20, v35
    v_pk_add_f32 v[14:15], v[14:15], v[6:7]
    s_waitcnt vmcnt(10)
    v_lshlrev_b32 v6, 16, v36
    v_and_b32 v7, s20, v36
    v_pk_add_f32 v[8:9], v[8:9], v[6:7]
    v_lshlrev_b32 v6, 16, v37
    v_and_b32 v7, s20, v37
    v_pk_add_f32 v[10:11], v[10:11], v[6:7]
    v_lshlrev_b32 v6, 16, v38
    v_and_b32 v7, s20, v38
    v_pk_add_f32 v[12:13], v[12:13], v[6:7]
    v_lshlrev_b32 v6, 16, v39
    v_and_b32 v7, s20, v39
    v_pk_add_f32 v[14:15], v[14:15], v[6:7]
    s_waitcnt vmcnt(9)
    v_lshlrev_b32 v6, 16, v40
    v_and_b32 v7, s20, v40
    v_pk_add_f32 v[8:9], v[8:9], v[6:7]
    v_lshlrev_b32 v6, 16, v41
    v_and_b32 v7, s20, v41
    v_pk_add_f32 v[10:11], v[10:11], v[6:7]
    v_lshlrev_b32 v6, 16, v42
    v_and_b32 v7, s20, v42
    v_pk_add_f32 v[12:13], v[12:13], v[6:7]
    v_lshlrev_b32 v6, 16, v43
    v_and_b32 v7, s20, v43
    v_pk_add_f32 v[14:15], v[14:15], v[6:7]
    s_waitcnt vmcnt(8)
    v_lshlrev_b32 v6, 16, v44
    v_and_b32 v7, s20, v44
    v_pk_add_f32 v[8:9], v[8:9], v[6:7]
    v_lshlrev_b32 v6, 16, v45
    v_and_b32 v7, s20, v45
    v_pk_add_f32 v[10:11], v[10:11], v[6:7]
    v_lshlrev_b32 v6, 16, v46
    v_and_b32 v7, s20, v46
    v_pk_add_f32 v[12:13], v[12:13], v[6:7]
    v_lshlrev_b32 v6, 16, v47
    v_and_b32 v7, s20, v47
    v_pk_add_f32 v[14:15], v[14:15], v[6:7]
    s_waitcnt vmcnt(7)
    v_lshlrev_b32 v6, 16, v48
    v_and_b32 v7, s20, v48
    v_pk_add_f32 v[8:9], v[8:9], v[6:7]
    v_lshlrev_b32 v6, 16, v49
    v_and_b32 v7, s20, v49
    v_pk_add_f32 v[10:11], v[10:11], v[6:7]
    v_lshlrev_b32 v6, 16, v50
    v_and_b32 v7, s20, v50
    v_pk_add_f32 v[12:13], v[12:13], v[6:7]
    v_lshlrev_b32 v6, 16, v51
    v_and_b32 v7, s20, v51
    v_pk_add_f32 v[14:15], v[14:15], v[6:7]
    s_waitcnt vmcnt(6)
    v_lshlrev_b32 v6, 16, v52
    v_and_b32 v7, s20, v52
    v_pk_add_f32 v[8:9], v[8:9], v[6:7]
    v_lshlrev_b32 v6, 16, v53
    v_and_b32 v7, s20, v53
    v_pk_add_f32 v[10:11], v[10:11], v[6:7]
    v_lshlrev_b32 v6, 16, v54
    v_and_b32 v7, s20, v54
    v_pk_add_f32 v[12:13], v[12:13], v[6:7]
    v_lshlrev_b32 v6, 16, v55
    v_and_b32 v7, s20, v55
    v_pk_add_f32 v[14:15], v[14:15], v[6:7]
    s_waitcnt vmcnt(5)
    v_lshlrev_b32 v6, 16, v56
    v_and_b32 v7, s20, v56
    v_pk_add_f32 v[8:9], v[8:9], v[6:7]
    v_lshlrev_b32 v6, 16, v57
    v_and_b32 v7, s20, v57
    v_pk_add_f32 v[10:11], v[10:11], v[6:7]
    v_lshlrev_b32 v6, 16, v58
    v_and_b32 v7, s20, v58
    v_pk_add_f32 v[12:13], v[12:13], v[6:7]
    v_lshlrev_b32 v6, 16, v59
    v_and_b32 v7, s20, v59
    v_pk_add_f32 v[14:15], v[14:15], v[6:7]
    s_waitcnt vmcnt(4)
    v_lshlrev_b32 v6, 16, v60
    v_and_b32 v7, s20, v60
    v_pk_add_f32 v[8:9], v[8:9], v[6:7]
    v_lshlrev_b32 v6, 16, v61
    v_and_b32 v7, s20, v61
    v_pk_add_f32 v[10:11], v[10:11], v[6:7]
    v_lshlrev_b32 v6, 16, v62
    v_and_b32 v7, s20, v62
    v_pk_add_f32 v[12:13], v[12:13], v[6:7]
    v_lshlrev_b32 v6, 16, v63
    v_and_b32 v7, s20, v63
    v_pk_add_f32 v[14:15], v[14:15], v[6:7]
    s_waitcnt vmcnt(3)
    v_lshlrev_b32 v6, 16, v64
    v_and_b32 v7, s20, v64
    v_pk_add_f32 v[8:9], v[8:9], v[6:7]
    v_lshlrev_b32 v6, 16, v65
    v_and_b32 v7, s20, v65
    v_pk_add_f32 v[10:11], v[10:11], v[6:7]
    v_lshlrev_b32 v6, 16, v66
    v_and_b32 v7, s20, v66
    v_pk_add_f32 v[12:13], v[12:13], v[6:7]
    v_lshlrev_b32 v6, 16, v67
    v_and_b32 v7, s20, v67
    v_pk_add_f32 v[14:15], v[14:15], v[6:7]
    s_waitcnt vmcnt(2)
    v_lshlrev_b32 v6, 16, v68
    v_and_b32 v7, s20, v68
    v_pk_add_f32 v[8:9], v[8:9], v[6:7]
    v_lshlrev_b32 v6, 16, v69
    v_and_b32 v7, s20, v69
    v_pk_add_f32 v[10:11], v[10:11], v[6:7]
    v_lshlrev_b32 v6, 16, v70
    v_and_b32 v7, s20, v70
    v_pk_add_f32 v[12:13], v[12:13], v[6:7]
    v_lshlrev_b32 v6, 16, v71
    v_and_b32 v7, s20, v71
    v_pk_add_f32 v[14:15], v[14:15], v[6:7]
    s_waitcnt vmcnt(1)
    v_lshlrev_b32 v6, 16, v72
    v_and_b32 v7, s20, v72
    v_pk_add_f32 v[8:9], v[8:9], v[6:7]
    v_lshlrev_b32 v6, 16, v73
    v_and_b32 v7, s20, v73
    v_pk_add_f32 v[10:11], v[10:11], v[6:7]
    v_lshlrev_b32 v6, 16, v74
    v_and_b32 v7, s20, v74
    v_pk_add_f32 v[12:13], v[12:13], v[6:7]
    v_lshlrev_b32 v6, 16, v75
    v_and_b32 v7, s20, v75
    v_pk_add_f32 v[14:15], v[14:15], v[6:7]
    s_waitcnt vmcnt(0)
    v_lshlrev_b32 v6, 16, v76
    v_and_b32 v7, s20, v76
    v_pk_add_f32 v[8:9], v[8:9], v[6:7]
    v_lshlrev_b32 v6, 16, v77
    v_and_b32 v7, s20, v77
    v_pk_add_f32 v[10:11], v[10:11], v[6:7]
    v_lshlrev_b32 v6, 16, v78
    v_and_b32 v7, s20, v78
    v_pk_add_f32 v[12:13], v[12:13], v[6:7]
    v_lshlrev_b32 v6, 16, v79
    v_and_b32 v7, s20, v79
    v_pk_add_f32 v[14:15], v[14:15], v[6:7]
    buffer_load_dwordx2 v[208:209], v210, s[32:35], 0 offen sc1
    v_mov_b32 v16, v8
    v_mov_b32 v17, v9
    v_mov_b32 v18, v10
    v_mov_b32 v19, v11
    v_mov_b32 v20, v12
    v_mov_b32 v21, v13
    v_mov_b32 v22, v14
    v_mov_b32 v23, v15
    v_permlane32_swap_b32 v8, v16
    v_permlane32_swap_b32 v9, v17
    v_permlane32_swap_b32 v10, v18
    v_permlane32_swap_b32 v11, v19
    v_permlane32_swap_b32 v12, v20
    v_permlane32_swap_b32 v13, v21
    v_permlane32_swap_b32 v14, v22
    v_permlane32_swap_b32 v15, v23
    v_add_f32 v8, v8, v16
    v_add_f32 v9, v9, v17
    v_add_f32 v10, v10, v18
    v_add_f32 v11, v11, v19
    v_add_f32 v12, v12, v20
    v_add_f32 v13, v13, v21
    v_add_f32 v14, v14, v22
    v_add_f32 v15, v15, v23
    v_mov_b32 v16, v8
    v_mov_b32 v17, v9
    v_mov_b32 v18, v10
    v_mov_b32 v19, v11
    v_mov_b32 v20, v12
    v_mov_b32 v21, v13
    v_mov_b32 v22, v14
    v_mov_b32 v23, v15
    v_permlane16_swap_b32 v8, v16
    v_permlane16_swap_b32 v9, v17
    v_permlane16_swap_b32 v10, v18
    v_permlane16_swap_b32 v11, v19
    v_permlane16_swap_b32 v12, v20
    v_permlane16_swap_b32 v13, v21
    v_permlane16_swap_b32 v14, v22
    v_permlane16_swap_b32 v15, v23
    v_add_f32 v8, v8, v16
    v_add_f32 v9, v9, v17
    v_add_f32 v10, v10, v18
    v_add_f32 v11, v11, v19
    v_add_f32 v12, v12, v20
    v_add_f32 v13, v13, v21
    v_add_f32 v14, v14, v22
    v_add_f32 v15, v15, v23
    s_lshl_b32 s24, s21, 2
    s_lshr_b32 s25, s22, 2
    s_add_u32 s24, s24, s25
    s_mul_i32 s24, s24, 49152
    s_lshl_b32 s25, s23, 11
    s_add_u32 s24, s24, s25
    s_and_b32 s25, s22, 3
    s_lshl_b32 s25, s25, 2
    s_add_u32 s24, s24, s25
    s_add_u32 s24, s24, 59768832
    v_lshrrev_b32 v5, 4, v1
    v_cmp_eq_u32 vcc, 1, v5
    s_nop 1
    v_cndmask_b32 v8, v8, v10, vcc
    v_cndmask_b32 v9, v9, v11, vcc
    v_cmp_eq_u32 vcc, 2, v5
    s_nop 1
    v_cndmask_b32 v8, v8, v12, vcc
    v_cndmask_b32 v9, v9, v13, vcc
    v_cmp_eq_u32 vcc, 3, v5
    s_nop 1
    v_cndmask_b32 v8, v8, v14, vcc
    v_cndmask_b32 v9, v9, v15, vcc
    v_lshlrev_b32 v5, 5, v5
    v_lshl_add_u32 v5, v4, 7, v5
    buffer_store_dword v8, v5, s[16:19], s24 offen sc1
    buffer_store_dword v9, v5, s[16:19], s24 offen offset:16 sc1
    s_mov_b32 s37, 0x40000
    s_branch prep_n2_w
prep_n2:
    buffer_load_dwordx2 v[208:209], v210, s[32:35], 0 offen sc1
prep_n2_w:
    s_waitcnt vmcnt(0)
    v_readfirstlane_b32 s60, v208
    v_readfirstlane_b32 s61, v209
    s_sub_u32 s37, s37, 1
    s_cmp_eq_u32 s37, 0
    s_cbranch_scc1 prep_n2_ok
    s_cmp_eq_u32 s60, 0
    s_cbranch_scc1 prep_n2
prep_n2_ok:
    s_lshl_b32 s24, s27, 6
    s_add_u32 s24, s24, 68681728
    buffer_store_dwordx2 v[208:209], v210, s[16:19], s24 offen sc1
    s_branch mega_next
prep_pf:
    s_mov_b32 s37, 0x40000
prep_n3:
    buffer_load_dwordx2 v[208:209], v210, s[32:35], 0 offen sc1
prep_n3_w:
    s_waitcnt vmcnt(0)
    v_readfirstlane_b32 s60, v208
    v_readfirstlane_b32 s61, v209
    s_sub_u32 s37, s37, 1
    s_cmp_eq_u32 s37, 0
    s_cbranch_scc1 prep_n3_ok
    s_cmp_eq_u32 s60, 0
    s_cbranch_scc1 prep_n3
prep_n3_ok:
    s_branch mega_next
.p2align 6
qkvA_body:
    s_lshl_b32 s20, s99, 22
    s_lshl_b32 s21, s99, 18
    s_add_u32 s21, s21, 58720256
    s_load_dwordx2 s[4:5], s[0:1], 8
    s_load_dwordx2 s[6:7], s[0:1], 64
    v_and_b32 v1, 63, v0
    v_lshrrev_b32 v2, 6, v0
    v_lshlrev_b32 v5, 4, v1
    v_readfirstlane_b32 s8, v2
    s_and_b32 s3, s2, 1
    s_lshl_b32 s3, s3, 3
    s_bfe_u32 s11, s2, 0x30003
    s_add_u32 s9, s3, s11
    s_bfe_u32 s3, s2, 0x20001
    s_lshl_b32 s3, s3, 2
    s_lshr_b32 s11, s2, 6
    s_add_u32 s10, s3, s11
    s_lshl_b32 s3, s9, 2
    s_add_u32 s11, s3, s8
    s_lshl_b32 s22, s11, 16
    s_add_u32 s22, s22, s20
    s_sub_u32 s44, s3, 1
    s_max_i32 s44, s44, 0
    s_lshl_b32 s23, s44, 16
    s_add_u32 s23, s23, s20
    v_lshrrev_b32 v3, 5, v1
    v_and_b32 v4, 15, v0
    v_bfe_u32 v19, v1, 4, 1
    v_lshl_add_u32 v6, v19, 5, v4
    v_lshlrev_b32 v6, 4, v6
    v_lshl_add_u32 v6, v3, 10, v6
    s_waitcnt lgkmcnt(0)
    s_mov_b32 s24, s4
    s_mov_b32 s25, s5
    s_mov_b32 s26, 6291456
    s_mov_b32 s27, 0x00020000
    s_add_u32 s12, s6, s22
    s_addc_u32 s13, s7, 0
    s_mov_b32 s14, 65536
    s_mov_b32 s15, 0x00020000
    s_add_u32 s16, s6, s23
    s_addc_u32 s17, s7, 0
    s_mov_b32 s18, 65536
    s_mov_b32 s19, 0x00020000
    s_mov_b32 s28, s6
    s_mov_b32 s29, s7
    s_mov_b32 s30, 75497472
    s_mov_b32 s31, 0x00020000
    s_cmp_eq_u32 s8, 4
    s_cbranch_scc1 qkvA_helper
    s_cmp_gt_u32 s8, 4
    s_cbranch_scc1 qkvA_loader
    s_movk_i32 s40, 4096
    v_lshrrev_b32 v23, 2, v4
    v_lshl_add_u32 v23, v19, 2, v23
    v_lshlrev_b32 v23, 7, v23
    v_and_b32 v22, 3, v4
    v_lshl_add_u32 v23, v22, 3, v23
    v_mul_u32_u24 v22, 6144, v3
    v_add_u32 v23, v23, v22
    v_lshrrev_b32 v22, 3, v4
    v_lshl_add_u32 v22, v22, 1, v19
    v_xor_b32 v24, 0, v22
    v_lshl_add_u32 v11, v24, 5, v23
    v_mov_b32 v7, v11
    v_xor_b32 v24, 1, v22
    v_lshl_add_u32 v12, v24, 5, v23
    v_mov_b32 v8, v12
    v_xor_b32 v24, 2, v22
    v_lshl_add_u32 v13, v24, 5, v23
    v_mov_b32 v9, v13
    v_xor_b32 v24, 3, v22
    v_lshl_add_u32 v14, v24, 5, v23
    v_mov_b32 v10, v14
    v_xor_b32 v24, v2, v22
    v_lshl_add_u32 v16, v24, 5, v23
    v_mov_b32 v15, v16
    v_cmp_eq_u32 vcc, 1, v19
    v_mov_b32 v31, 0x7ffffff0
    s_nop 0
    v_cndmask_b32 v31, v31, v5, vcc
    v_add_u32 v18, 256, v6
    v_mov_b32 v17, v18
    v_mov_b32 v32, 0
    v_mov_b32 v33, 0
    v_mov_b32 v34, 0
    v_mov_b32 v35, 0
    v_mov_b32 v36, 0
    v_mov_b32 v37, 0
    v_mov_b32 v38, 0
    v_mov_b32 v39, 0
    v_mov_b32 v40, 0
    v_mov_b32 v41, 0
    v_mov_b32 v42, 0
    v_mov_b32 v43, 0
    v_mov_b32 v44, 0
    v_mov_b32 v45, 0
    v_mov_b32 v46, 0
    v_mov_b32 v47, 0
    v_mov_b32 v48, 0
    v_mov_b32 v49, 0
    v_mov_b32 v50, 0
    v_mov_b32 v51, 0
    v_mov_b32 v52, 0
    v_mov_b32 v53, 0
    v_mov_b32 v54, 0
    v_mov_b32 v55, 0
    v_mov_b32 v56, 0
    v_mov_b32 v57, 0
    v_mov_b32 v58, 0
    v_mov_b32 v59, 0
    v_mov_b32 v60, 0
    v_mov_b32 v61, 0
    v_mov_b32 v62, 0
    v_mov_b32 v63, 0
    v_mov_b32 v64, 0
    v_mov_b32 v65, 0
    v_mov_b32 v66, 0
    v_mov_b32 v67, 0
    v_mov_b32 v68, 0
    v_mov_b32 v69, 0
    v_mov_b32 v70, 0
    v_mov_b32 v71, 0
    v_mov_b32 v72, 0
    v_mov_b32 v73, 0
    v_mov_b32 v74, 0
    v_mov_b32 v75, 0
    v_mov_b32 v76, 0
    v_mov_b32 v77, 0
    v_mov_b32 v78, 0
    v_mov_b32 v79, 0
    v_mov_b32 v80, 0
    v_mov_b32 v81, 0
    v_mov_b32 v82, 0
    v_mov_b32 v83, 0
    v_mov_b32 v84, 0
    v_mov_b32 v85, 0
    v_mov_b32 v86, 0
    v_mov_b32 v87, 0
    v_mov_b32 v88, 0
    v_mov_b32 v89, 0
    v_mov_b32 v90, 0
    v_mov_b32 v91, 0
    v_mov_b32 v92, 0
    v_mov_b32 v93, 0
    v_mov_b32 v94, 0
    v_mov_b32 v95, 0
    v_mov_b32 v96, 0
    v_mov_b32 v97, 0
    v_mov_b32 v98, 0
    v_mov_b32 v99, 0
    v_mov_b32 v100, 0
    v_mov_b32 v101, 0
    v_mov_b32 v102, 0
    v_mov_b32 v103, 0
    v_mov_b32 v104, 0
    v_mov_b32 v105, 0
    v_mov_b32 v106, 0
    v_mov_b32 v107, 0
    v_mov_b32 v108, 0
    v_mov_b32 v109, 0
    v_mov_b32 v110, 0
    v_mov_b32 v111, 0
    v_mov_b32 v112, 0
    v_mov_b32 v113, 0
    v_mov_b32 v114, 0
    v_mov_b32 v115, 0
    v_mov_b32 v116, 0
    v_mov_b32 v117, 0
    v_mov_b32 v118, 0
    v_mov_b32 v119, 0
    v_mov_b32 v120, 0
    v_mov_b32 v121, 0
    v_mov_b32 v122, 0
    v_mov_b32 v123, 0
    v_mov_b32 v124, 0
    v_mov_b32 v125, 0
    v_mov_b32 v126, 0
    v_mov_b32 v127, 0
    v_mov_b32 v128, 0
    v_mov_b32 v129, 0
    v_mov_b32 v130, 0
    v_mov_b32 v131, 0
    v_mov_b32 v132, 0
    v_mov_b32 v133, 0
    v_mov_b32 v134, 0
    v_mov_b32 v135, 0
    v_mov_b32 v184, 0
    v_mov_b32 v185, 0
    v_mov_b32 v186, 0
    v_mov_b32 v187, 0
    v_mov_b32 v188, 0
    v_mov_b32 v189, 0
    v_mov_b32 v190, 0
    v_mov_b32 v191, 0
    v_mov_b32 v192, 0
    v_mov_b32 v193, 0
    v_mov_b32 v194, 0
    v_mov_b32 v195, 0
    v_mov_b32 v196, 0
    v_mov_b32 v197, 0
    v_mov_b32 v198, 0
    v_mov_b32 v199, 0
    s_lshl_b32 s47, s96, 15
    s_add_u32 s47, s47, 71270400
    s_add_u32 s54, s28, s47
    s_addc_u32 s55, s29, 0
    s_mov_b32 s56, 0x40000
    s_lshl_b32 s57, s11, 8
    s_lshl_b32 s58, s44, 8
qkvA_poll:
    s_mov_b32 s70, 0
    s_mov_b32 s71, 0
    s_atomic_add s70, s[54:55], s57 offset:0 glc
    s_atomic_add s71, s[54:55], s58 offset:0 glc
    s_waitcnt lgkmcnt(0)
    s_and_b32 s70, s70, s71
    s_cmp_eq_u32 s70, 16
    s_cbranch_scc1 qkvA_ready
    s_sub_u32 s56, s56, 1
    s_cmp_lg_u32 s56, 0
    s_cbranch_scc1 qkvA_poll
qkvA_ready:
    s_lshl_b32 s43, s8, 10
    s_add_u32 s45, s43, 24576
    s_mov_b32 m0, s45
    s_nop 0
    buffer_load_dwordx4 v31, s[16:19], s43 offen sc1 lds
    s_add_u32 m0, s45, 28672
    s_add_u32 s43, s43, 4096
    buffer_load_dwordx4 v31, s[16:19], s43 offen sc1 lds
    buffer_load_dwordx4 a[0:3], v6, s[12:15], 0 offen offset:0 sc1
    buffer_load_dwordx4 a[4:7], v6, s[12:15], 0 offen offset:256 sc1
    buffer_load_dwordx4 a[8:11], v6, s[12:15], 0 offen offset:2048 sc1
    buffer_load_dwordx4 a[12:15], v6, s[12:15], 0 offen offset:2304 sc1
    s_add_u32 m0, s45, 57344
    s_add_u32 s43, s43, 4096
    buffer_load_dwordx4 v31, s[16:19], s43 offen sc1 lds
    buffer_load_dwordx4 a[16:19], v6, s[12:15], s40 offen offset:0 sc1
    buffer_load_dwordx4 a[20:23], v6, s[12:15], s40 offen offset:256 sc1
    s_add_u32 s43, s43, 4096
    s_mov_b32 s32, 6144
    s_mov_b32 s33, 10240
    s_mov_b32 s38, 0
    s_mov_b32 s40, 8
    s_waitcnt vmcnt(8)
    s_barrier
    ds_read_b64_tr_b16 v[136:137], v7 offset:0
    ds_read_b64_tr_b16 v[138:139], v7 offset:3072
    ds_read_b64_tr_b16 v[140:141], v8 offset:0
    ds_read_b64_tr_b16 v[142:143], v8 offset:3072
    ds_read_b64_tr_b16 v[144:145], v9 offset:0
    ds_read_b64_tr_b16 v[146:147], v9 offset:3072
    ds_read_b64_tr_b16 v[148:149], v10 offset:0
    ds_read_b64_tr_b16 v[150:151], v10 offset:3072
    ds_read_b64_tr_b16 v[152:153], v7 offset:1024
    ds_read_b64_tr_b16 v[154:155], v7 offset:4096
    ds_read_b64_tr_b16 v[156:157], v8 offset:1024
    ds_read_b64_tr_b16 v[158:159], v8 offset:4096
    ds_read_b64_tr_b16 v[160:161], v9 offset:1024
    ds_read_b64_tr_b16 v[162:163], v9 offset:4096
    ds_read_b64_tr_b16 v[164:165], v10 offset:1024
    ds_read_b64_tr_b16 v[166:167], v10 offset:4096
    ds_read_b64_tr_b16 v[168:169], v7 offset:2048
    ds_read_b64_tr_b16 v[170:171], v7 offset:5120
    ds_read_b64_tr_b16 v[172:173], v8 offset:2048
    ds_read_b64_tr_b16 v[174:175], v8 offset:5120
    ds_read_b64_tr_b16 v[176:177], v9 offset:2048
    ds_read_b64_tr_b16 v[178:179], v9 offset:5120
qkvA_loop:
    s_waitcnt vmcnt(5) lgkmcnt(10)
    v_mfma_f32_16x16x32_bf16 v[128:131], v[184:187], v[196:199], v[128:131]
    v_mfma_f32_16x16x32_bf16 v[132:135], v[196:199], v[188:191], v[132:135]
    v_mfma_f32_16x16x32_bf16 v[32:35], v[136:139], a[0:3], v[32:35]
    ds_read_b64_tr_b16 v[180:181], v10 offset:2048
    v_mfma_f32_16x16x32_bf16 v[36:39], v[136:139], a[4:7], v[36:39]
    ds_read_b64_tr_b16 v[182:183], v10 offset:5120
    v_mfma_f32_16x16x32_bf16 v[40:43], v[140:143], a[0:3], v[40:43]
    ds_read_b64_tr_b16 v[136:137], v7 offset:12288
    buffer_load_dwordx4 a[24:27], v6, s[12:15], s32 offen offset:0 sc1
    v_mfma_f32_16x16x32_bf16 v[44:47], v[140:143], a[4:7], v[44:47]
    ds_read_b64_tr_b16 v[138:139], v7 offset:15360
    v_mfma_f32_16x16x32_bf16 v[48:51], v[144:147], a[0:3], v[48:51]
    ds_read_b64_tr_b16 v[140:141], v8 offset:12288
    v_mfma_f32_16x16x32_bf16 v[52:55], v[144:147], a[4:7], v[52:55]
    ds_read_b64_tr_b16 v[142:143], v8 offset:15360
    ds_read_b64_tr_b16 v[184:185], v15 offset:1024
    ds_read_b64_tr_b16 v[186:187], v15 offset:4096
    v_mfma_f32_16x16x32_bf16 v[56:59], v[148:151], a[0:3], v[56:59]
    ds_read_b64_tr_b16 v[144:145], v9 offset:12288
    buffer_load_dwordx4 a[28:31], v6, s[12:15], s32 offen offset:256 sc1
    v_mfma_f32_16x16x32_bf16 v[60:63], v[148:151], a[4:7], v[60:63]
    ds_read_b64_tr_b16 v[146:147], v9 offset:15360
    v_mfma_f32_16x16x32_bf16 v[64:67], v[152:155], a[0:3], v[64:67]
    ds_read_b64_tr_b16 v[148:149], v10 offset:12288
    v_mfma_f32_16x16x32_bf16 v[68:71], v[152:155], a[4:7], v[68:71]
    ds_read_b64_tr_b16 v[150:151], v10 offset:15360
    ds_read_b64_tr_b16 v[188:189], v15 offset:2048
    ds_read_b64_tr_b16 v[190:191], v15 offset:5120
    v_mfma_f32_16x16x32_bf16 v[72:75], v[156:159], a[0:3], v[72:75]
    ds_read_b64_tr_b16 v[152:153], v7 offset:13312
    v_mfma_f32_16x16x32_bf16 v[76:79], v[156:159], a[4:7], v[76:79]
    ds_read_b64_tr_b16 v[154:155], v7 offset:16384
    v_mfma_f32_16x16x32_bf16 v[80:83], v[160:163], a[0:3], v[80:83]
    ds_read_b64_tr_b16 v[156:157], v8 offset:13312
    v_mfma_f32_16x16x32_bf16 v[84:87], v[160:163], a[4:7], v[84:87]
    ds_read_b64_tr_b16 v[158:159], v8 offset:16384
    ds_read_b128 v[192:195], v17 offset:24576
    v_mfma_f32_16x16x32_bf16 v[88:91], v[164:167], a[0:3], v[88:91]
    ds_read_b64_tr_b16 v[160:161], v9 offset:13312
    v_mfma_f32_16x16x32_bf16 v[92:95], v[164:167], a[4:7], v[92:95]
    ds_read_b64_tr_b16 v[162:163], v9 offset:16384
    v_mfma_f32_16x16x32_bf16 v[96:99], a[0:3], v[168:171], v[96:99]
    ds_read_b64_tr_b16 v[164:165], v10 offset:13312
    v_mfma_f32_16x16x32_bf16 v[100:103], a[4:7], v[168:171], v[100:103]
    ds_read_b64_tr_b16 v[166:167], v10 offset:16384
    v_mfma_f32_16x16x32_bf16 v[104:107], a[0:3], v[172:175], v[104:107]
    ds_read_b64_tr_b16 v[168:169], v7 offset:14336
    v_mfma_f32_16x16x32_bf16 v[108:111], a[4:7], v[172:175], v[108:111]
    ds_read_b64_tr_b16 v[170:171], v7 offset:17408
    v_mfma_f32_16x16x32_bf16 v[112:115], a[0:3], v[176:179], v[112:115]
    ds_read_b64_tr_b16 v[172:173], v8 offset:14336
    v_mfma_f32_16x16x32_bf16 v[116:119], a[4:7], v[176:179], v[116:119]
    ds_read_b64_tr_b16 v[174:175], v8 offset:17408
    v_mfma_f32_16x16x32_bf16 v[120:123], a[0:3], v[180:183], v[120:123]
    ds_read_b64_tr_b16 v[176:177], v9 offset:14336
    v_mfma_f32_16x16x32_bf16 v[124:127], a[4:7], v[180:183], v[124:127]
    ds_read_b64_tr_b16 v[178:179], v9 offset:17408
    s_waitcnt vmcnt(5) lgkmcnt(10)
    v_mfma_f32_16x16x32_bf16 v[128:131], v[184:187], v[192:195], v[128:131]
    v_mfma_f32_16x16x32_bf16 v[132:135], v[192:195], v[188:191], v[132:135]
    v_mfma_f32_16x16x32_bf16 v[32:35], v[136:139], a[8:11], v[32:35]
    ds_read_b64_tr_b16 v[180:181], v10 offset:14336
    v_mfma_f32_16x16x32_bf16 v[36:39], v[136:139], a[12:15], v[36:39]
    ds_read_b64_tr_b16 v[182:183], v10 offset:17408
    s_waitcnt vmcnt(9)
    s_barrier
    s_xor_b32 s39, s38, 57344
    s_add_u32 s39, s39, 28672
    s_cmp_le_u32 s40, 1
    s_cselect_b32 s39, 163840, s39
    s_add_u32 m0, s39, s45
    s_nop 0
    buffer_load_dwordx4 v31, s[16:19], s43 offen sc1 lds
    s_add_u32 s43, s43, 4096
    v_mfma_f32_16x16x32_bf16 v[40:43], v[140:143], a[8:11], v[40:43]
    ds_read_b64_tr_b16 v[136:137], v7 offset:28672
    buffer_load_dwordx4 a[0:3], v6, s[12:15], s32 offen offset:2048 sc1
    v_mfma_f32_16x16x32_bf16 v[44:47], v[140:143], a[12:15], v[44:47]
    ds_read_b64_tr_b16 v[138:139], v7 offset:31744
    v_mfma_f32_16x16x32_bf16 v[48:51], v[144:147], a[8:11], v[48:51]
    ds_read_b64_tr_b16 v[140:141], v8 offset:28672
    v_mfma_f32_16x16x32_bf16 v[52:55], v[144:147], a[12:15], v[52:55]
    ds_read_b64_tr_b16 v[142:143], v8 offset:31744
    ds_read_b64_tr_b16 v[184:185], v15 offset:13312
    ds_read_b64_tr_b16 v[186:187], v15 offset:16384
    v_mfma_f32_16x16x32_bf16 v[56:59], v[148:151], a[8:11], v[56:59]
    ds_read_b64_tr_b16 v[144:145], v9 offset:28672
    buffer_load_dwordx4 a[4:7], v6, s[12:15], s32 offen offset:2304 sc1
    v_mfma_f32_16x16x32_bf16 v[60:63], v[148:151], a[12:15], v[60:63]
    ds_read_b64_tr_b16 v[146:147], v9 offset:31744
    v_mfma_f32_16x16x32_bf16 v[64:67], v[152:155], a[8:11], v[64:67]
    ds_read_b64_tr_b16 v[148:149], v10 offset:28672
    v_mfma_f32_16x16x32_bf16 v[68:71], v[152:155], a[12:15], v[68:71]
    ds_read_b64_tr_b16 v[150:151], v10 offset:31744
    ds_read_b64_tr_b16 v[188:189], v15 offset:14336
    ds_read_b64_tr_b16 v[190:191], v15 offset:17408
    v_mfma_f32_16x16x32_bf16 v[72:75], v[156:159], a[8:11], v[72:75]
    ds_read_b64_tr_b16 v[152:153], v7 offset:29696
    v_mfma_f32_16x16x32_bf16 v[76:79], v[156:159], a[12:15], v[76:79]
    ds_read_b64_tr_b16 v[154:155], v7 offset:32768
    v_mfma_f32_16x16x32_bf16 v[80:83], v[160:163], a[8:11], v[80:83]
    ds_read_b64_tr_b16 v[156:157], v8 offset:29696
    v_mfma_f32_16x16x32_bf16 v[84:87], v[160:163], a[12:15], v[84:87]
    ds_read_b64_tr_b16 v[158:159], v8 offset:32768
    ds_read_b128 v[196:199], v17 offset:26624
    v_mfma_f32_16x16x32_bf16 v[88:91], v[164:167], a[8:11], v[88:91]
    ds_read_b64_tr_b16 v[160:161], v9 offset:29696
    v_mfma_f32_16x16x32_bf16 v[92:95], v[164:167], a[12:15], v[92:95]
    ds_read_b64_tr_b16 v[162:163], v9 offset:32768
    v_mfma_f32_16x16x32_bf16 v[96:99], a[8:11], v[168:171], v[96:99]
    ds_read_b64_tr_b16 v[164:165], v10 offset:29696
    v_mfma_f32_16x16x32_bf16 v[100:103], a[12:15], v[168:171], v[100:103]
    ds_read_b64_tr_b16 v[166:167], v10 offset:32768
    v_mfma_f32_16x16x32_bf16 v[104:107], a[8:11], v[172:175], v[104:107]
    ds_read_b64_tr_b16 v[168:169], v7 offset:30720
    v_mfma_f32_16x16x32_bf16 v[108:111], a[12:15], v[172:175], v[108:111]
    ds_read_b64_tr_b16 v[170:171], v7 offset:33792
    v_mfma_f32_16x16x32_bf16 v[112:115], a[8:11], v[176:179], v[112:115]
    ds_read_b64_tr_b16 v[172:173], v8 offset:30720
    v_mfma_f32_16x16x32_bf16 v[116:119], a[12:15], v[176:179], v[116:119]
    ds_read_b64_tr_b16 v[174:175], v8 offset:33792
    v_mfma_f32_16x16x32_bf16 v[120:123], a[8:11], v[180:183], v[120:123]
    ds_read_b64_tr_b16 v[176:177], v9 offset:30720
    v_mfma_f32_16x16x32_bf16 v[124:127], a[12:15], v[180:183], v[124:127]
    ds_read_b64_tr_b16 v[178:179], v9 offset:33792
    s_waitcnt vmcnt(5) lgkmcnt(10)
    v_mfma_f32_16x16x32_bf16 v[128:131], v[184:187], v[196:199], v[128:131]
    v_mfma_f32_16x16x32_bf16 v[132:135], v[196:199], v[188:191], v[132:135]
    v_mfma_f32_16x16x32_bf16 v[32:35], v[136:139], a[16:19], v[32:35]
    ds_read_b64_tr_b16 v[180:181], v10 offset:30720
    v_mfma_f32_16x16x32_bf16 v[36:39], v[136:139], a[20:23], v[36:39]
    ds_read_b64_tr_b16 v[182:183], v10 offset:33792
    v_mfma_f32_16x16x32_bf16 v[40:43], v[140:143], a[16:19], v[40:43]
    ds_read_b64_tr_b16 v[136:137], v7 offset:40960
    buffer_load_dwordx4 a[8:11], v6, s[12:15], s33 offen offset:0 sc1
    v_mfma_f32_16x16x32_bf16 v[44:47], v[140:143], a[20:23], v[44:47]
    ds_read_b64_tr_b16 v[138:139], v7 offset:44032
    v_mfma_f32_16x16x32_bf16 v[48:51], v[144:147], a[16:19], v[48:51]
    ds_read_b64_tr_b16 v[140:141], v8 offset:40960
    v_mfma_f32_16x16x32_bf16 v[52:55], v[144:147], a[20:23], v[52:55]
    ds_read_b64_tr_b16 v[142:143], v8 offset:44032
    ds_read_b64_tr_b16 v[184:185], v15 offset:29696
    ds_read_b64_tr_b16 v[186:187], v15 offset:32768
    v_mfma_f32_16x16x32_bf16 v[56:59], v[148:151], a[16:19], v[56:59]
    ds_read_b64_tr_b16 v[144:145], v9 offset:40960
    buffer_load_dwordx4 a[12:15], v6, s[12:15], s33 offen offset:256 sc1
    v_mfma_f32_16x16x32_bf16 v[60:63], v[148:151], a[20:23], v[60:63]
    ds_read_b64_tr_b16 v[146:147], v9 offset:44032
    v_mfma_f32_16x16x32_bf16 v[64:67], v[152:155], a[16:19], v[64:67]
    ds_read_b64_tr_b16 v[148:149], v10 offset:40960
    v_mfma_f32_16x16x32_bf16 v[68:71], v[152:155], a[20:23], v[68:71]
    ds_read_b64_tr_b16 v[150:151], v10 offset:44032
    ds_read_b64_tr_b16 v[188:189], v15 offset:30720
    ds_read_b64_tr_b16 v[190:191], v15 offset:33792
    v_mfma_f32_16x16x32_bf16 v[72:75], v[156:159], a[16:19], v[72:75]
    ds_read_b64_tr_b16 v[152:153], v7 offset:41984
    v_mfma_f32_16x16x32_bf16 v[76:79], v[156:159], a[20:23], v[76:79]
    ds_read_b64_tr_b16 v[154:155], v7 offset:45056
    v_mfma_f32_16x16x32_bf16 v[80:83], v[160:163], a[16:19], v[80:83]
    ds_read_b64_tr_b16 v[156:157], v8 offset:41984
    v_mfma_f32_16x16x32_bf16 v[84:87], v[160:163], a[20:23], v[84:87]
    ds_read_b64_tr_b16 v[158:159], v8 offset:45056
    ds_read_b128 v[192:195], v17 offset:53248
    v_mfma_f32_16x16x32_bf16 v[88:91], v[164:167], a[16:19], v[88:91]
    ds_read_b64_tr_b16 v[160:161], v9 offset:41984
    v_mfma_f32_16x16x32_bf16 v[92:95], v[164:167], a[20:23], v[92:95]
    ds_read_b64_tr_b16 v[162:163], v9 offset:45056
    v_mfma_f32_16x16x32_bf16 v[96:99], a[16:19], v[168:171], v[96:99]
    ds_read_b64_tr_b16 v[164:165], v10 offset:41984
    v_mfma_f32_16x16x32_bf16 v[100:103], a[20:23], v[168:171], v[100:103]
    ds_read_b64_tr_b16 v[166:167], v10 offset:45056
    v_mfma_f32_16x16x32_bf16 v[104:107], a[16:19], v[172:175], v[104:107]
    ds_read_b64_tr_b16 v[168:169], v7 offset:43008
    v_mfma_f32_16x16x32_bf16 v[108:111], a[20:23], v[172:175], v[108:111]
    ds_read_b64_tr_b16 v[170:171], v7 offset:46080
    v_mfma_f32_16x16x32_bf16 v[112:115], a[16:19], v[176:179], v[112:115]
    ds_read_b64_tr_b16 v[172:173], v8 offset:43008
    v_mfma_f32_16x16x32_bf16 v[116:119], a[20:23], v[176:179], v[116:119]
    ds_read_b64_tr_b16 v[174:175], v8 offset:46080
    v_mfma_f32_16x16x32_bf16 v[120:123], a[16:19], v[180:183], v[120:123]
    ds_read_b64_tr_b16 v[176:177], v9 offset:43008
    v_mfma_f32_16x16x32_bf16 v[124:127], a[20:23], v[180:183], v[124:127]
    ds_read_b64_tr_b16 v[178:179], v9 offset:46080
    s_waitcnt vmcnt(5) lgkmcnt(10)
    v_mfma_f32_16x16x32_bf16 v[128:131], v[184:187], v[192:195], v[128:131]
    v_mfma_f32_16x16x32_bf16 v[132:135], v[192:195], v[188:191], v[132:135]
    v_mfma_f32_16x16x32_bf16 v[32:35], v[136:139], a[24:27], v[32:35]
    ds_read_b64_tr_b16 v[180:181], v10 offset:43008
    v_mfma_f32_16x16x32_bf16 v[36:39], v[136:139], a[28:31], v[36:39]
    ds_read_b64_tr_b16 v[182:183], v10 offset:46080
    s_waitcnt vmcnt(9)
    s_barrier
    s_xor_b32 s38, s38, 57344
    v_add_u32 v7, s38, v11
    v_add_u32 v8, s38, v12
    v_add_u32 v9, s38, v13
    v_add_u32 v10, s38, v14
    s_xor_b32 s39, s38, 57344
    s_cmp_le_u32 s40, 2
    s_cselect_b32 s39, 163840, s39
    s_add_u32 m0, s39, s45
    s_nop 0
    buffer_load_dwordx4 v31, s[16:19], s43 offen sc1 lds
    s_add_u32 s43, s43, 4096
    v_mfma_f32_16x16x32_bf16 v[40:43], v[140:143], a[24:27], v[40:43]
    ds_read_b64_tr_b16 v[136:137], v7 offset:0
    buffer_load_dwordx4 a[16:19], v6, s[12:15], s33 offen offset:2048 sc1
    v_mfma_f32_16x16x32_bf16 v[44:47], v[140:143], a[28:31], v[44:47]
    ds_read_b64_tr_b16 v[138:139], v7 offset:3072
    v_mfma_f32_16x16x32_bf16 v[48:51], v[144:147], a[24:27], v[48:51]
    ds_read_b64_tr_b16 v[140:141], v8 offset:0
    v_mfma_f32_16x16x32_bf16 v[52:55], v[144:147], a[28:31], v[52:55]
    ds_read_b64_tr_b16 v[142:143], v8 offset:3072
    ds_read_b64_tr_b16 v[184:185], v15 offset:41984
    ds_read_b64_tr_b16 v[186:187], v15 offset:45056
    v_mfma_f32_16x16x32_bf16 v[56:59], v[148:151], a[24:27], v[56:59]
    ds_read_b64_tr_b16 v[144:145], v9 offset:0
    buffer_load_dwordx4 a[20:23], v6, s[12:15], s33 offen offset:2304 sc1
    v_mfma_f32_16x16x32_bf16 v[60:63], v[148:151], a[28:31], v[60:63]
    ds_read_b64_tr_b16 v[146:147], v9 offset:3072
    v_mfma_f32_16x16x32_bf16 v[64:67], v[152:155], a[24:27], v[64:67]
    ds_read_b64_tr_b16 v[148:149], v10 offset:0
    v_mfma_f32_16x16x32_bf16 v[68:71], v[152:155], a[28:31], v[68:71]
    ds_read_b64_tr_b16 v[150:151], v10 offset:3072
    ds_read_b64_tr_b16 v[188:189], v15 offset:43008
    ds_read_b64_tr_b16 v[190:191], v15 offset:46080
    v_mfma_f32_16x16x32_bf16 v[72:75], v[156:159], a[24:27], v[72:75]
    ds_read_b64_tr_b16 v[152:153], v7 offset:1024
    v_mfma_f32_16x16x32_bf16 v[76:79], v[156:159], a[28:31], v[76:79]
    ds_read_b64_tr_b16 v[154:155], v7 offset:4096
    v_mfma_f32_16x16x32_bf16 v[80:83], v[160:163], a[24:27], v[80:83]
    ds_read_b64_tr_b16 v[156:157], v8 offset:1024
    v_mfma_f32_16x16x32_bf16 v[84:87], v[160:163], a[28:31], v[84:87]
    ds_read_b64_tr_b16 v[158:159], v8 offset:4096
    ds_read_b128 v[196:199], v17 offset:55296
    v_mfma_f32_16x16x32_bf16 v[88:91], v[164:167], a[24:27], v[88:91]
    ds_read_b64_tr_b16 v[160:161], v9 offset:1024
    v_mfma_f32_16x16x32_bf16 v[92:95], v[164:167], a[28:31], v[92:95]
    ds_read_b64_tr_b16 v[162:163], v9 offset:4096
    v_mfma_f32_16x16x32_bf16 v[96:99], a[24:27], v[168:171], v[96:99]
    ds_read_b64_tr_b16 v[164:165], v10 offset:1024
    v_mfma_f32_16x16x32_bf16 v[100:103], a[28:31], v[168:171], v[100:103]
    ds_read_b64_tr_b16 v[166:167], v10 offset:4096
    v_mfma_f32_16x16x32_bf16 v[104:107], a[24:27], v[172:175], v[104:107]
    ds_read_b64_tr_b16 v[168:169], v7 offset:2048
    v_mfma_f32_16x16x32_bf16 v[108:111], a[28:31], v[172:175], v[108:111]
    ds_read_b64_tr_b16 v[170:171], v7 offset:5120
    v_mfma_f32_16x16x32_bf16 v[112:115], a[24:27], v[176:179], v[112:115]
    ds_read_b64_tr_b16 v[172:173], v8 offset:2048
    v_mfma_f32_16x16x32_bf16 v[116:119], a[28:31], v[176:179], v[116:119]
    ds_read_b64_tr_b16 v[174:175], v8 offset:5120
    v_mfma_f32_16x16x32_bf16 v[120:123], a[24:27], v[180:183], v[120:123]
    ds_read_b64_tr_b16 v[176:177], v9 offset:2048
    v_mfma_f32_16x16x32_bf16 v[124:127], a[28:31], v[180:183], v[124:127]
    ds_read_b64_tr_b16 v[178:179], v9 offset:5120
    v_add_u32 v15, s38, v16
    v_add_u32 v17, s38, v18
    s_add_u32 s32, s32, 8192
    s_add_u32 s33, s33, 8192
    s_sub_u32 s40, s40, 1
    s_cmp_lg_u32 s40, 0
    s_cbranch_scc1 qkvA_loop
    s_waitcnt lgkmcnt(0)
    v_mfma_f32_16x16x32_bf16 v[128:131], v[184:187], v[196:199], v[128:131]
    v_mfma_f32_16x16x32_bf16 v[132:135], v[196:199], v[188:191], v[132:135]
    s_cmp_eq_u32 s96, s98
    s_cselect_b32 s100, 0, 112
    v_lshrrev_b32 v7, 4, v1
    v_lshlrev_b32 v7, 4, v7
    v_add_u32 v7, 114688, v7
    v_lshlrev_b32 v8, 2, v4
    v_add_u32 v8, 114688, v8
    v_lshl_add_u32 v9, v2, 7, v8
    v_lshl_add_u32 v10, v2, 7, v7
    ds_read_b32 v20, v9 offset:1024
    ds_read_b32 v24, v9 offset:1664
    ds_read_b32 v22, v9 offset:1088
    ds_read_b32 v26, v9 offset:1728
    ds_read_b128 v[152:155], v7 offset:256
    ds_read_b128 v[156:159], v7 offset:320
    ds_read_b128 v[160:163], v7 offset:384
    ds_read_b128 v[164:167], v7 offset:448
    ds_read_b128 v[136:139], v7 offset:0
    ds_read_b128 v[140:143], v7 offset:64
    ds_read_b128 v[144:147], v7 offset:128
    ds_read_b128 v[148:151], v7 offset:192
    s_waitcnt lgkmcnt(8)
    ds_read_b128 v[168:171], v10 offset:1024
    ds_read_b128 v[176:179], v10 offset:1664
    v_mul_f32 v28, 0x3e8293ee, v24
    ds_read_b128 v[172:175], v10 offset:1088
    ds_read_b128 v[180:183], v10 offset:1728
    v_mul_f32 v30, 0x3e8293ee, v26
    ds_read_b32 v200, v8 offset:512
    ds_read_b32 v202, v8 offset:576
    ds_read_b32 v204, v8 offset:640
    ds_read_b32 v206, v8 offset:704
    v_lshl_add_u32 v11, v2, 12, v5
    v_add_u32 v11, 117248, v11
    s_waitcnt lgkmcnt(14)
    v_pk_fma_f32 v[64:65], v[20:21], v[152:153], v[64:65] op_sel_hi:[0,1,1] neg_lo:[1,0,0] neg_hi:[1,0,0]
    v_pk_fma_f32 v[66:67], v[20:21], v[154:155], v[66:67] op_sel_hi:[0,1,1] neg_lo:[1,0,0] neg_hi:[1,0,0]
    v_pk_mul_f32 v[64:65], v[24:25], v[64:65] op_sel_hi:[0,1]
    v_pk_mul_f32 v[66:67], v[24:25], v[66:67] op_sel_hi:[0,1]
    v_pk_fma_f32 v[72:73], v[20:21], v[156:157], v[72:73] op_sel_hi:[0,1,1] neg_lo:[1,0,0] neg_hi:[1,0,0]
    v_pk_fma_f32 v[74:75], v[20:21], v[158:159], v[74:75] op_sel_hi:[0,1,1] neg_lo:[1,0,0] neg_hi:[1,0,0]
    v_pk_mul_f32 v[72:73], v[24:25], v[72:73] op_sel_hi:[0,1]
    v_pk_mul_f32 v[74:75], v[24:25], v[74:75] op_sel_hi:[0,1]
    v_pk_fma_f32 v[68:69], v[22:23], v[152:153], v[68:69] op_sel_hi:[0,1,1] neg_lo:[1,0,0] neg_hi:[1,0,0]
    v_pk_fma_f32 v[70:71], v[22:23], v[154:155], v[70:71] op_sel_hi:[0,1,1] neg_lo:[1,0,0] neg_hi:[1,0,0]
    v_pk_mul_f32 v[68:69], v[26:27], v[68:69] op_sel_hi:[0,1]
    v_pk_mul_f32 v[70:71], v[26:27], v[70:71] op_sel_hi:[0,1]
    v_pk_fma_f32 v[76:77], v[22:23], v[156:157], v[76:77] op_sel_hi:[0,1,1] neg_lo:[1,0,0] neg_hi:[1,0,0]
    v_pk_fma_f32 v[78:79], v[22:23], v[158:159], v[78:79] op_sel_hi:[0,1,1] neg_lo:[1,0,0] neg_hi:[1,0,0]
    v_pk_mul_f32 v[76:77], v[26:27], v[76:77] op_sel_hi:[0,1]
    v_pk_mul_f32 v[78:79], v[26:27], v[78:79] op_sel_hi:[0,1]
    v_cvt_pk_bf16_f32 v64, v64, v65
    v_cvt_pk_bf16_f32 v65, v66, v67
    v_cvt_pk_bf16_f32 v66, v72, v73
    v_cvt_pk_bf16_f32 v67, v74, v75
    v_cvt_pk_bf16_f32 v68, v68, v69
    v_cvt_pk_bf16_f32 v69, v70, v71
    v_cvt_pk_bf16_f32 v70, v76, v77
    v_cvt_pk_bf16_f32 v71, v78, v79
    ds_write_b128 v11, v[68:71] offset:4096
    s_waitcnt lgkmcnt(13)
    v_pk_fma_f32 v[80:81], v[20:21], v[160:161], v[80:81] op_sel_hi:[0,1,1] neg_lo:[1,0,0] neg_hi:[1,0,0]
    v_pk_fma_f32 v[82:83], v[20:21], v[162:163], v[82:83] op_sel_hi:[0,1,1] neg_lo:[1,0,0] neg_hi:[1,0,0]
    v_pk_mul_f32 v[80:81], v[24:25], v[80:81] op_sel_hi:[0,1]
    v_pk_mul_f32 v[82:83], v[24:25], v[82:83] op_sel_hi:[0,1]
    v_pk_fma_f32 v[88:89], v[20:21], v[164:165], v[88:89] op_sel_hi:[0,1,1] neg_lo:[1,0,0] neg_hi:[1,0,0]
    v_pk_fma_f32 v[90:91], v[20:21], v[166:167], v[90:91] op_sel_hi:[0,1,1] neg_lo:[1,0,0] neg_hi:[1,0,0]
    v_pk_mul_f32 v[88:89], v[24:25], v[88:89] op_sel_hi:[0,1]
    v_pk_mul_f32 v[90:91], v[24:25], v[90:91] op_sel_hi:[0,1]
    v_pk_fma_f32 v[84:85], v[22:23], v[160:161], v[84:85] op_sel_hi:[0,1,1] neg_lo:[1,0,0] neg_hi:[1,0,0]
    v_pk_fma_f32 v[86:87], v[22:23], v[162:163], v[86:87] op_sel_hi:[0,1,1] neg_lo:[1,0,0] neg_hi:[1,0,0]
    v_pk_mul_f32 v[84:85], v[26:27], v[84:85] op_sel_hi:[0,1]
    v_pk_mul_f32 v[86:87], v[26:27], v[86:87] op_sel_hi:[0,1]
    v_pk_fma_f32 v[92:93], v[22:23], v[164:165], v[92:93] op_sel_hi:[0,1,1] neg_lo:[1,0,0] neg_hi:[1,0,0]
    v_pk_fma_f32 v[94:95], v[22:23], v[166:167], v[94:95] op_sel_hi:[0,1,1] neg_lo:[1,0,0] neg_hi:[1,0,0]
    v_pk_mul_f32 v[92:93], v[26:27], v[92:93] op_sel_hi:[0,1]
    v_pk_mul_f32 v[94:95], v[26:27], v[94:95] op_sel_hi:[0,1]
    v_cvt_pk_bf16_f32 v80, v80, v81
    v_cvt_pk_bf16_f32 v81, v82, v83
    v_cvt_pk_bf16_f32 v82, v88, v89
    v_cvt_pk_bf16_f32 v83, v90, v91
    v_cvt_pk_bf16_f32 v84, v84, v85
    v_cvt_pk_bf16_f32 v85, v86, v87
    v_cvt_pk_bf16_f32 v86, v92, v93
    v_cvt_pk_bf16_f32 v87, v94, v95
    ds_write_b128 v11, v[84:87] offset:5120
    v_lshl_add_u32 v12, v2, 6, v7
    v_lshl_add_u32 v13, v2, 6, v8
    ds_read_b128 v[208:211], v12 offset:256
    ds_read_b128 v[212:215], v7 offset:1600
    ds_read_b128 v[216:219], v7 offset:2240
    ds_read_b32 v220, v8 offset:1600
    ds_read_b32 v222, v8 offset:2240
    ds_read_b32 v184, v13 offset:512
    s_waitcnt lgkmcnt(8)
    v_pk_fma_f32 v[96:97], v[168:169], v[200:201], v[96:97] op_sel_hi:[1,0,1] neg_lo:[1,0,0] neg_hi:[1,0,0]
    v_pk_fma_f32 v[98:99], v[170:171], v[200:201], v[98:99] op_sel_hi:[1,0,1] neg_lo:[1,0,0] neg_hi:[1,0,0]
    v_pk_mul_f32 v[96:97], v[176:177], v[96:97]
    v_pk_mul_f32 v[98:99], v[178:179], v[98:99]
    v_pk_fma_f32 v[100:101], v[172:173], v[200:201], v[100:101] op_sel_hi:[1,0,1] neg_lo:[1,0,0] neg_hi:[1,0,0]
    v_pk_fma_f32 v[102:103], v[174:175], v[200:201], v[102:103] op_sel_hi:[1,0,1] neg_lo:[1,0,0] neg_hi:[1,0,0]
    v_pk_mul_f32 v[100:101], v[180:181], v[100:101]
    v_pk_mul_f32 v[102:103], v[182:183], v[102:103]
    v_cvt_pk_bf16_f32 v98, v98, v99
    v_cvt_pk_bf16_f32 v99, v96, v97
    v_swap_b32 v98, v99
    v_cvt_pk_bf16_f32 v100, v100, v101
    v_cvt_pk_bf16_f32 v101, v102, v103
    ds_write_b64 v11, v[100:101] offset:6144
    v_pk_fma_f32 v[104:105], v[168:169], v[202:203], v[104:105] op_sel_hi:[1,0,1] neg_lo:[1,0,0] neg_hi:[1,0,0]
    v_pk_fma_f32 v[106:107], v[170:171], v[202:203], v[106:107] op_sel_hi:[1,0,1] neg_lo:[1,0,0] neg_hi:[1,0,0]
    v_pk_mul_f32 v[104:105], v[176:177], v[104:105]
    v_pk_mul_f32 v[106:107], v[178:179], v[106:107]
    v_pk_fma_f32 v[108:109], v[172:173], v[202:203], v[108:109] op_sel_hi:[1,0,1] neg_lo:[1,0,0] neg_hi:[1,0,0]
    v_pk_fma_f32 v[110:111], v[174:175], v[202:203], v[110:111] op_sel_hi:[1,0,1] neg_lo:[1,0,0] neg_hi:[1,0,0]
    v_pk_mul_f32 v[108:109], v[180:181], v[108:109]
    v_pk_mul_f32 v[110:111], v[182:183], v[110:111]
    v_cvt_pk_bf16_f32 v106, v106, v107
    v_cvt_pk_bf16_f32 v107, v104, v105
    v_swap_b32 v106, v107
    v_cvt_pk_bf16_f32 v108, v108, v109
    v_cvt_pk_bf16_f32 v109, v110, v111
    ds_write_b64 v11, v[108:109] offset:6152
    v_pk_fma_f32 v[112:113], v[168:169], v[204:205], v[112:113] op_sel_hi:[1,0,1] neg_lo:[1,0,0] neg_hi:[1,0,0]
    v_pk_fma_f32 v[114:115], v[170:171], v[204:205], v[114:115] op_sel_hi:[1,0,1] neg_lo:[1,0,0] neg_hi:[1,0,0]
    v_pk_mul_f32 v[112:113], v[176:177], v[112:113]
    v_pk_mul_f32 v[114:115], v[178:179], v[114:115]
    v_pk_fma_f32 v[116:117], v[172:173], v[204:205], v[116:117] op_sel_hi:[1,0,1] neg_lo:[1,0,0] neg_hi:[1,0,0]
    v_pk_fma_f32 v[118:119], v[174:175], v[204:205], v[118:119] op_sel_hi:[1,0,1] neg_lo:[1,0,0] neg_hi:[1,0,0]
    v_pk_mul_f32 v[116:117], v[180:181], v[116:117]
    v_pk_mul_f32 v[118:119], v[182:183], v[118:119]
    v_cvt_pk_bf16_f32 v114, v114, v115
    v_cvt_pk_bf16_f32 v115, v112, v113
    v_swap_b32 v114, v115
    v_cvt_pk_bf16_f32 v116, v116, v117
    v_cvt_pk_bf16_f32 v117, v118, v119
    ds_write_b64 v11, v[116:117] offset:7168
    v_pk_fma_f32 v[120:121], v[168:169], v[206:207], v[120:121] op_sel_hi:[1,0,1] neg_lo:[1,0,0] neg_hi:[1,0,0]
    v_pk_fma_f32 v[122:123], v[170:171], v[206:207], v[122:123] op_sel_hi:[1,0,1] neg_lo:[1,0,0] neg_hi:[1,0,0]
    v_pk_mul_f32 v[120:121], v[176:177], v[120:121]
    v_pk_mul_f32 v[122:123], v[178:179], v[122:123]
    v_pk_fma_f32 v[124:125], v[172:173], v[206:207], v[124:125] op_sel_hi:[1,0,1] neg_lo:[1,0,0] neg_hi:[1,0,0]
    v_pk_fma_f32 v[126:127], v[174:175], v[206:207], v[126:127] op_sel_hi:[1,0,1] neg_lo:[1,0,0] neg_hi:[1,0,0]
    v_pk_mul_f32 v[124:125], v[180:181], v[124:125]
    v_pk_mul_f32 v[126:127], v[182:183], v[126:127]
    v_cvt_pk_bf16_f32 v122, v122, v123
    v_cvt_pk_bf16_f32 v123, v120, v121
    v_swap_b32 v122, v123
    v_cvt_pk_bf16_f32 v124, v124, v125
    v_cvt_pk_bf16_f32 v125, v126, v127
    ds_write_b64 v11, v[124:125] offset:7176
    s_waitcnt lgkmcnt(4)
    v_pk_fma_f32 v[128:129], v[220:221], v[208:209], v[128:129] op_sel_hi:[0,1,1] neg_lo:[1,0,0] neg_hi:[1,0,0]
    v_pk_fma_f32 v[130:131], v[220:221], v[210:211], v[130:131] op_sel_hi:[0,1,1] neg_lo:[1,0,0] neg_hi:[1,0,0]
    v_pk_mul_f32 v[128:129], v[222:223], v[128:129] op_sel_hi:[0,1]
    v_pk_mul_f32 v[130:131], v[222:223], v[130:131] op_sel_hi:[0,1]
    v_pk_fma_f32 v[132:133], v[212:213], v[184:185], v[132:133] op_sel_hi:[1,0,1] neg_lo:[1,0,0] neg_hi:[1,0,0]
    v_pk_fma_f32 v[134:135], v[214:215], v[184:185], v[134:135] op_sel_hi:[1,0,1] neg_lo:[1,0,0] neg_hi:[1,0,0]
    v_pk_mul_f32 v[132:133], v[216:217], v[132:133]
    v_pk_mul_f32 v[134:135], v[218:219], v[134:135]
    v_cvt_pk_bf16_f32 v128, v128, v129
    v_cvt_pk_bf16_f32 v129, v130, v131
    v_cvt_pk_bf16_f32 v130, v132, v133
    v_cvt_pk_bf16_f32 v131, v134, v135
    s_lshr_b32 s3, s8, 1
    s_lshl_b32 s3, s3, 10
    s_and_b32 s22, s8, 1
    s_lshl_b32 s22, s22, 3
    s_add_u32 s3, s3, s22
    s_add_u32 s3, s3, 117248
    v_add_u32 v12, s3, v5
    ds_write_b64 v12, v[128:129]
    ds_write_b64 v12, v[130:131] offset:2048
    v_pk_fma_f32 v[32:33], v[20:21], v[136:137], v[32:33] op_sel_hi:[0,1,1] neg_lo:[1,0,0] neg_hi:[1,0,0]
    v_pk_fma_f32 v[34:35], v[20:21], v[138:139], v[34:35] op_sel_hi:[0,1,1] neg_lo:[1,0,0] neg_hi:[1,0,0]
    v_pk_mul_f32 v[32:33], v[28:29], v[32:33] op_sel_hi:[0,1]
    v_pk_mul_f32 v[34:35], v[28:29], v[34:35] op_sel_hi:[0,1]
    v_pk_fma_f32 v[40:41], v[20:21], v[140:141], v[40:41] op_sel_hi:[0,1,1] neg_lo:[1,0,0] neg_hi:[1,0,0]
    v_pk_fma_f32 v[42:43], v[20:21], v[142:143], v[42:43] op_sel_hi:[0,1,1] neg_lo:[1,0,0] neg_hi:[1,0,0]
    v_pk_mul_f32 v[40:41], v[28:29], v[40:41] op_sel_hi:[0,1]
    v_pk_mul_f32 v[42:43], v[28:29], v[42:43] op_sel_hi:[0,1]
    v_pk_fma_f32 v[36:37], v[22:23], v[136:137], v[36:37] op_sel_hi:[0,1,1] neg_lo:[1,0,0] neg_hi:[1,0,0]
    v_pk_fma_f32 v[38:39], v[22:23], v[138:139], v[38:39] op_sel_hi:[0,1,1] neg_lo:[1,0,0] neg_hi:[1,0,0]
    v_pk_mul_f32 v[36:37], v[30:31], v[36:37] op_sel_hi:[0,1]
    v_pk_mul_f32 v[38:39], v[30:31], v[38:39] op_sel_hi:[0,1]
    v_pk_fma_f32 v[44:45], v[22:23], v[140:141], v[44:45] op_sel_hi:[0,1,1] neg_lo:[1,0,0] neg_hi:[1,0,0]
    v_pk_fma_f32 v[46:47], v[22:23], v[142:143], v[46:47] op_sel_hi:[0,1,1] neg_lo:[1,0,0] neg_hi:[1,0,0]
    v_pk_mul_f32 v[44:45], v[30:31], v[44:45] op_sel_hi:[0,1]
    v_pk_mul_f32 v[46:47], v[30:31], v[46:47] op_sel_hi:[0,1]
    v_cvt_pk_bf16_f32 v32, v32, v33
    v_cvt_pk_bf16_f32 v33, v34, v35
    v_cvt_pk_bf16_f32 v34, v40, v41
    v_cvt_pk_bf16_f32 v35, v42, v43
    v_cvt_pk_bf16_f32 v36, v36, v37
    v_cvt_pk_bf16_f32 v37, v38, v39
    v_cvt_pk_bf16_f32 v38, v44, v45
    v_cvt_pk_bf16_f32 v39, v46, v47
    v_pk_fma_f32 v[48:49], v[20:21], v[144:145], v[48:49] op_sel_hi:[0,1,1] neg_lo:[1,0,0] neg_hi:[1,0,0]
    v_pk_fma_f32 v[50:51], v[20:21], v[146:147], v[50:51] op_sel_hi:[0,1,1] neg_lo:[1,0,0] neg_hi:[1,0,0]
    v_pk_mul_f32 v[48:49], v[28:29], v[48:49] op_sel_hi:[0,1]
    v_pk_mul_f32 v[50:51], v[28:29], v[50:51] op_sel_hi:[0,1]
    v_pk_fma_f32 v[56:57], v[20:21], v[148:149], v[56:57] op_sel_hi:[0,1,1] neg_lo:[1,0,0] neg_hi:[1,0,0]
    v_pk_fma_f32 v[58:59], v[20:21], v[150:151], v[58:59] op_sel_hi:[0,1,1] neg_lo:[1,0,0] neg_hi:[1,0,0]
    v_pk_mul_f32 v[56:57], v[28:29], v[56:57] op_sel_hi:[0,1]
    v_pk_mul_f32 v[58:59], v[28:29], v[58:59] op_sel_hi:[0,1]
    v_pk_fma_f32 v[52:53], v[22:23], v[144:145], v[52:53] op_sel_hi:[0,1,1] neg_lo:[1,0,0] neg_hi:[1,0,0]
    v_pk_fma_f32 v[54:55], v[22:23], v[146:147], v[54:55] op_sel_hi:[0,1,1] neg_lo:[1,0,0] neg_hi:[1,0,0]
    v_pk_mul_f32 v[52:53], v[30:31], v[52:53] op_sel_hi:[0,1]
    v_pk_mul_f32 v[54:55], v[30:31], v[54:55] op_sel_hi:[0,1]
    v_pk_fma_f32 v[60:61], v[22:23], v[148:149], v[60:61] op_sel_hi:[0,1,1] neg_lo:[1,0,0] neg_hi:[1,0,0]
    v_pk_fma_f32 v[62:63], v[22:23], v[150:151], v[62:63] op_sel_hi:[0,1,1] neg_lo:[1,0,0] neg_hi:[1,0,0]
    v_pk_mul_f32 v[60:61], v[30:31], v[60:61] op_sel_hi:[0,1]
    v_pk_mul_f32 v[62:63], v[30:31], v[62:63] op_sel_hi:[0,1]
    v_cvt_pk_bf16_f32 v48, v48, v49
    v_cvt_pk_bf16_f32 v49, v50, v51
    v_cvt_pk_bf16_f32 v50, v56, v57
    v_cvt_pk_bf16_f32 v51, v58, v59
    v_cvt_pk_bf16_f32 v52, v52, v53
    v_cvt_pk_bf16_f32 v53, v54, v55
    v_cvt_pk_bf16_f32 v54, v60, v61
    v_cvt_pk_bf16_f32 v55, v62, v63
    v_lshrrev_b32 v13, 4, v1
    v_lshlrev_b32 v13, 2, v13
    v_sub_u32 v13, v4, v13
    v_mov_b32 v14, 0xf149f2ca
    v_add_u32 v9, 0x0, v13
    v_and_b32 v9, 0xfffffff1, v9
    v_cmp_eq_u32 vcc, 0, v9
    s_nop 1
    v_cndmask_b32 v216, v14, 0, vcc
    v_add_u32 v9, 0xffffffff, v13
    v_and_b32 v9, 0xfffffff1, v9
    v_cmp_eq_u32 vcc, 0, v9
    s_nop 1
    v_cndmask_b32 v217, v14, 0, vcc
    v_add_u32 v9, 0xfffffffe, v13
    v_and_b32 v9, 0xfffffff1, v9
    v_cmp_eq_u32 vcc, 0, v9
    s_nop 1
    v_cndmask_b32 v218, v14, 0, vcc
    v_add_u32 v9, 0xfffffffd, v13
    v_and_b32 v9, 0xfffffff1, v9
    v_cmp_eq_u32 vcc, 0, v9
    s_nop 1
    v_cndmask_b32 v219, v14, 0, vcc
    v_add_u32 v9, 0x10, v13
    v_and_b32 v9, 0xfffffff1, v9
    v_cmp_eq_u32 vcc, 0, v9
    s_nop 1
    v_cndmask_b32 v220, v14, 0, vcc
    v_add_u32 v9, 0xf, v13
    v_and_b32 v9, 0xfffffff1, v9
    v_cmp_eq_u32 vcc, 0, v9
    s_nop 1
    v_cndmask_b32 v221, v14, 0, vcc
    v_add_u32 v9, 0xe, v13
    v_and_b32 v9, 0xfffffff1, v9
    v_cmp_eq_u32 vcc, 0, v9
    s_nop 1
    v_cndmask_b32 v222, v14, 0, vcc
    v_add_u32 v9, 0xd, v13
    v_and_b32 v9, 0xfffffff1, v9
    v_cmp_eq_u32 vcc, 0, v9
    s_nop 1
    v_cndmask_b32 v223, v14, 0, vcc
    v_mfma_f32_16x16x32_bf16 v[140:143], v[64:67], v[32:35], v[216:219]
    v_mfma_f32_16x16x32_bf16 v[148:151], v[68:71], v[36:39], v[216:219]
    v_mfma_f32_16x16x32_bf16 v[144:147], v[64:67], v[36:39], v[220:223]
    v_mfma_f32_16x16x32_bf16 v[156:159], v[80:83], v[48:51], v[216:219]
    v_mfma_f32_16x16x32_bf16 v[164:167], v[84:87], v[52:55], v[216:219]
    v_mfma_f32_16x16x32_bf16 v[160:163], v[80:83], v[52:55], v[220:223]
    s_waitcnt lgkmcnt(0)
    s_barrier
    ds_read_b128 v[168:171], v11 offset:0
    ds_read_b128 v[172:175], v11 offset:1024
    ds_read_b64 v[96:97], v11 offset:2048
    ds_read_b64 v[104:105], v11 offset:2056
    ds_read_b64 v[112:113], v11 offset:3072
    ds_read_b64 v[120:121], v11 offset:3080
    s_cmp_lg_u32 s11, 0
    s_cbranch_scc1 qkvA_hasprev
    v_mov_b32 v220, 0xf149f2ca
    v_mov_b32 v221, 0xf149f2ca
    v_mov_b32 v222, 0xf149f2ca
    v_mov_b32 v223, 0xf149f2ca
qkvA_hasprev:
    s_lshl_b32 s3, s11, 16
    s_lshl_b32 s22, s10, 12
    s_add_u32 s3, s3, s22
    s_add_u32 s3, s3, s20
    s_add_u32 s3, s3, 41943040
    s_waitcnt lgkmcnt(4)
    v_mfma_f32_16x16x32_bf16 v[136:139], v[168:171], v[32:35], v[220:223]
    v_mfma_f32_16x16x32_bf16 v[152:155], v[172:175], v[48:51], v[220:223]
    v_max3_f32 v20, v144, v145, v146
    v_max3_f32 v20, v20, v147, v148
    v_max3_f32 v20, v20, v149, v150
    v_max_f32 v20, v20, v151
    v_max3_f32 v22, v160, v161, v162
    v_max3_f32 v22, v22, v163, v164
    v_max3_f32 v22, v22, v165, v166
    v_max_f32 v22, v22, v167
    v_max3_f32 v24, v136, v137, v138
    v_max3_f32 v24, v24, v139, v140
    v_max3_f32 v24, v24, v141, v142
    v_max_f32 v24, v24, v143
    v_max3_f32 v26, v152, v153, v154
    v_max3_f32 v26, v26, v155, v156
    v_max3_f32 v26, v26, v157, v158
    v_max_f32 v26, v26, v159
    v_mov_b32 v21, v20
    v_mov_b32 v23, v22
    v_mov_b32 v25, v24
    v_mov_b32 v27, v26
    v_permlane32_swap_b32 v20, v21
    v_permlane32_swap_b32 v22, v23
    v_permlane32_swap_b32 v24, v25
    v_permlane32_swap_b32 v26, v27
    v_max_f32 v20, v20, v21
    v_max_f32 v22, v22, v23
    v_max_f32 v24, v24, v25
    v_max_f32 v26, v26, v27
    v_mov_b32 v21, v20
    v_mov_b32 v23, v22
    v_mov_b32 v25, v24
    v_mov_b32 v27, v26
    v_permlane16_swap_b32 v20, v21
    v_permlane16_swap_b32 v22, v23
    v_permlane16_swap_b32 v24, v25
    v_permlane16_swap_b32 v26, v27
    v_max_f32 v20, v20, v21
    v_max_f32 v22, v22, v23
    v_max_f32 v24, v24, v25
    v_max_f32 v26, v26, v27
    s_waitcnt lgkmcnt(0)
    v_pk_add_f32 v[144:145], v[144:145], v[20:21] op_sel_hi:[1,0] neg_lo:[0,1] neg_hi:[0,1]
    v_pk_add_f32 v[146:147], v[146:147], v[20:21] op_sel_hi:[1,0] neg_lo:[0,1] neg_hi:[0,1]
    v_pk_add_f32 v[148:149], v[148:149], v[20:21] op_sel_hi:[1,0] neg_lo:[0,1] neg_hi:[0,1]
    v_pk_add_f32 v[150:151], v[150:151], v[20:21] op_sel_hi:[1,0] neg_lo:[0,1] neg_hi:[0,1]
    v_exp_f32 v144, v144
    v_exp_f32 v145, v145
    v_exp_f32 v146, v146
    v_exp_f32 v147, v147
    v_exp_f32 v148, v148
    v_exp_f32 v149, v149
    v_exp_f32 v150, v150
    v_exp_f32 v151, v151
    v_cvt_pk_bf16_f32 v168, v144, v145
    v_cvt_pk_bf16_f32 v169, v146, v147
    v_cvt_pk_bf16_f32 v170, v148, v149
    v_cvt_pk_bf16_f32 v171, v150, v151
    s_nop 1
    v_mfma_f32_16x16x32_bf16 v[56:59], v[98:101], v[168:171], 0
    v_mfma_f32_16x16x32_bf16 v[60:63], v[106:109], v[168:171], 0
    v_pk_add_f32 v[200:201], v[144:145], v[146:147]
    v_pk_add_f32 v[200:201], v[200:201], v[148:149]
    v_pk_add_f32 v[200:201], v[200:201], v[150:151]
    v_add_f32 v200, v200, v201
    v_pk_add_f32 v[160:161], v[160:161], v[22:23] op_sel_hi:[1,0] neg_lo:[0,1] neg_hi:[0,1]
    v_pk_add_f32 v[162:163], v[162:163], v[22:23] op_sel_hi:[1,0] neg_lo:[0,1] neg_hi:[0,1]
    v_pk_add_f32 v[164:165], v[164:165], v[22:23] op_sel_hi:[1,0] neg_lo:[0,1] neg_hi:[0,1]
    v_pk_add_f32 v[166:167], v[166:167], v[22:23] op_sel_hi:[1,0] neg_lo:[0,1] neg_hi:[0,1]
    v_exp_f32 v160, v160
    v_exp_f32 v161, v161
    v_exp_f32 v162, v162
    v_exp_f32 v163, v163
    v_exp_f32 v164, v164
    v_exp_f32 v165, v165
    v_exp_f32 v166, v166
    v_exp_f32 v167, v167
    v_cvt_pk_bf16_f32 v172, v160, v161
    v_cvt_pk_bf16_f32 v173, v162, v163
    v_cvt_pk_bf16_f32 v174, v164, v165
    v_cvt_pk_bf16_f32 v175, v166, v167
    s_nop 1
    v_mfma_f32_16x16x32_bf16 v[88:91], v[114:117], v[172:175], 0
    v_mfma_f32_16x16x32_bf16 v[92:95], v[122:125], v[172:175], 0
    v_pk_add_f32 v[202:203], v[160:161], v[162:163]
    v_pk_add_f32 v[202:203], v[202:203], v[164:165]
    v_pk_add_f32 v[202:203], v[202:203], v[166:167]
    v_add_f32 v202, v202, v203
    v_pk_add_f32 v[136:137], v[136:137], v[24:25] op_sel_hi:[1,0] neg_lo:[0,1] neg_hi:[0,1]
    v_pk_add_f32 v[138:139], v[138:139], v[24:25] op_sel_hi:[1,0] neg_lo:[0,1] neg_hi:[0,1]
    v_pk_add_f32 v[140:141], v[140:141], v[24:25] op_sel_hi:[1,0] neg_lo:[0,1] neg_hi:[0,1]
    v_pk_add_f32 v[142:143], v[142:143], v[24:25] op_sel_hi:[1,0] neg_lo:[0,1] neg_hi:[0,1]
    v_exp_f32 v136, v136
    v_exp_f32 v137, v137
    v_exp_f32 v138, v138
    v_exp_f32 v139, v139
    v_exp_f32 v140, v140
    v_exp_f32 v141, v141
    v_exp_f32 v142, v142
    v_exp_f32 v143, v143
    v_cvt_pk_bf16_f32 v176, v136, v137
    v_cvt_pk_bf16_f32 v177, v138, v139
    v_cvt_pk_bf16_f32 v178, v140, v141
    v_cvt_pk_bf16_f32 v179, v142, v143
    s_nop 1
    v_mfma_f32_16x16x32_bf16 v[40:43], v[96:99], v[176:179], 0
    v_mfma_f32_16x16x32_bf16 v[44:47], v[104:107], v[176:179], 0
    v_pk_add_f32 v[204:205], v[136:137], v[138:139]
    v_pk_add_f32 v[204:205], v[204:205], v[140:141]
    v_pk_add_f32 v[204:205], v[204:205], v[142:143]
    v_add_f32 v204, v204, v205
    v_pk_add_f32 v[152:153], v[152:153], v[26:27] op_sel_hi:[1,0] neg_lo:[0,1] neg_hi:[0,1]
    v_pk_add_f32 v[154:155], v[154:155], v[26:27] op_sel_hi:[1,0] neg_lo:[0,1] neg_hi:[0,1]
    v_pk_add_f32 v[156:157], v[156:157], v[26:27] op_sel_hi:[1,0] neg_lo:[0,1] neg_hi:[0,1]
    v_pk_add_f32 v[158:159], v[158:159], v[26:27] op_sel_hi:[1,0] neg_lo:[0,1] neg_hi:[0,1]
    v_exp_f32 v152, v152
    v_exp_f32 v153, v153
    v_exp_f32 v154, v154
    v_exp_f32 v155, v155
    v_exp_f32 v156, v156
    v_exp_f32 v157, v157
    v_exp_f32 v158, v158
    v_exp_f32 v159, v159
    v_cvt_pk_bf16_f32 v180, v152, v153
    v_cvt_pk_bf16_f32 v181, v154, v155
    v_cvt_pk_bf16_f32 v182, v156, v157
    v_cvt_pk_bf16_f32 v183, v158, v159
    s_nop 1
    v_mfma_f32_16x16x32_bf16 v[72:75], v[112:115], v[180:183], 0
    v_mfma_f32_16x16x32_bf16 v[76:79], v[120:123], v[180:183], 0
    v_pk_add_f32 v[206:207], v[152:153], v[154:155]
    v_pk_add_f32 v[206:207], v[206:207], v[156:157]
    v_pk_add_f32 v[206:207], v[206:207], v[158:159]
    v_add_f32 v206, v206, v207
    v_mov_b32 v201, v200
    v_mov_b32 v203, v202
    v_mov_b32 v205, v204
    v_mov_b32 v207, v206
    v_permlane32_swap_b32 v200, v201
    v_permlane32_swap_b32 v202, v203
    v_permlane32_swap_b32 v204, v205
    v_permlane32_swap_b32 v206, v207
    v_add_f32 v200, v200, v201
    v_add_f32 v202, v202, v203
    v_add_f32 v204, v204, v205
    v_add_f32 v206, v206, v207
    v_mov_b32 v201, v200
    v_mov_b32 v203, v202
    v_mov_b32 v205, v204
    v_mov_b32 v207, v206
    v_permlane16_swap_b32 v200, v201
    v_permlane16_swap_b32 v202, v203
    v_permlane16_swap_b32 v204, v205
    v_permlane16_swap_b32 v206, v207
    v_add_f32 v200, v200, v201
    v_add_f32 v202, v202, v203
    v_add_f32 v204, v204, v205
    v_add_f32 v206, v206, v207
    v_rcp_f32 v200, v200
    v_rcp_f32 v202, v202
    v_rcp_f32 v204, v204
    v_rcp_f32 v206, v206
    v_pk_mul_f32 v[56:57], v[200:201], v[56:57] op_sel_hi:[0,1]
    v_pk_mul_f32 v[58:59], v[200:201], v[58:59] op_sel_hi:[0,1]
    v_pk_mul_f32 v[60:61], v[200:201], v[60:61] op_sel_hi:[0,1]
    v_pk_mul_f32 v[62:63], v[200:201], v[62:63] op_sel_hi:[0,1]
    v_cvt_pk_bf16_f32 v56, v56, v57
    v_cvt_pk_bf16_f32 v57, v58, v59
    v_cvt_pk_bf16_f32 v58, v60, v61
    v_cvt_pk_bf16_f32 v59, v62, v63
    s_nop 0
    v_permlane32_swap_b32 v56, v58
    v_permlane32_swap_b32 v57, v59
    buffer_store_dwordx4 v[56:59], v6, s[28:31], s3 offen offset:256 sc1
    v_pk_mul_f32 v[88:89], v[202:203], v[88:89] op_sel_hi:[0,1]
    v_pk_mul_f32 v[90:91], v[202:203], v[90:91] op_sel_hi:[0,1]
    v_pk_mul_f32 v[92:93], v[202:203], v[92:93] op_sel_hi:[0,1]
    v_pk_mul_f32 v[94:95], v[202:203], v[94:95] op_sel_hi:[0,1]
    v_cvt_pk_bf16_f32 v88, v88, v89
    v_cvt_pk_bf16_f32 v89, v90, v91
    v_cvt_pk_bf16_f32 v90, v92, v93
    v_cvt_pk_bf16_f32 v91, v94, v95
    s_nop 0
    v_permlane32_swap_b32 v88, v90
    v_permlane32_swap_b32 v89, v91
    buffer_store_dwordx4 v[88:91], v6, s[28:31], s3 offen offset:2304 sc1
    v_pk_mul_f32 v[40:41], v[204:205], v[40:41] op_sel_hi:[0,1]
    v_pk_mul_f32 v[42:43], v[204:205], v[42:43] op_sel_hi:[0,1]
    v_pk_mul_f32 v[44:45], v[204:205], v[44:45] op_sel_hi:[0,1]
    v_pk_mul_f32 v[46:47], v[204:205], v[46:47] op_sel_hi:[0,1]
    v_cvt_pk_bf16_f32 v40, v40, v41
    v_cvt_pk_bf16_f32 v41, v42, v43
    v_cvt_pk_bf16_f32 v42, v44, v45
    v_cvt_pk_bf16_f32 v43, v46, v47
    s_nop 0
    v_permlane32_swap_b32 v40, v42
    v_permlane32_swap_b32 v41, v43
    buffer_store_dwordx4 v[40:43], v6, s[28:31], s3 offen offset:0 sc1
    v_pk_mul_f32 v[72:73], v[206:207], v[72:73] op_sel_hi:[0,1]
    v_pk_mul_f32 v[74:75], v[206:207], v[74:75] op_sel_hi:[0,1]
    v_pk_mul_f32 v[76:77], v[206:207], v[76:77] op_sel_hi:[0,1]
    v_pk_mul_f32 v[78:79], v[206:207], v[78:79] op_sel_hi:[0,1]
    v_cvt_pk_bf16_f32 v72, v72, v73
    v_cvt_pk_bf16_f32 v73, v74, v75
    v_cvt_pk_bf16_f32 v74, v76, v77
    v_cvt_pk_bf16_f32 v75, v78, v79
    s_nop 0
    v_permlane32_swap_b32 v72, v74
    v_permlane32_swap_b32 v73, v75
    buffer_store_dwordx4 v[72:75], v6, s[28:31], s3 offen offset:2048 sc1
    s_cmp_eq_u32 s96, s98
    s_cbranch_scc1 mega_exit
    s_lshl_b32 s47, s96, 15
    s_lshl_b32 s48, s11, 8
    s_add_u32 s47, s47, s48
    s_add_u32 s47, s47, 71303168
    s_add_u32 s54, s28, s47
    s_addc_u32 s55, s29, 0
    s_mov_b32 s59, 1
    s_waitcnt vmcnt(0)
    s_atomic_add s59, s[54:55], 0
    s_branch mega_next2
qkvA_loader:
    v_lshrrev_b32 v20, 3, v1
    v_mul_u32_u24 v21, 6144, v20
    v_and_b32 v22, 2, v20
    v_lshrrev_b32 v23, 2, v20
    v_or_b32 v22, v22, v23
    v_bfe_u32 v23, v1, 1, 2
    v_xor_b32 v22, v22, v23
    v_lshl_add_u32 v21, v22, 5, v21
    v_and_b32 v22, 1, v1
    v_lshl_add_u32 v21, v22, 4, v21
    s_sub_u32 s3, s8, 5
    s_lshl_b32 s41, s3, 10
    s_lshl_b32 s3, s3, 11
    s_lshl_b32 s22, s10, 7
    s_add_u32 s3, s3, s22
    v_add_u32 v7, s3, v21
    s_mov_b32 s42, 0
    s_add_u32 m0, s41, 0
    s_nop 0
    buffer_load_dwordx4 v7, s[24:27], s42 offen lds
    s_add_u32 s42, s42, 49152
    s_add_u32 m0, s41, 3072
    s_nop 0
    buffer_load_dwordx4 v7, s[24:27], s42 offen lds
    s_add_u32 s42, s42, 49152
    s_add_u32 m0, s41, 6144
    s_nop 0
    buffer_load_dwordx4 v7, s[24:27], s42 offen lds
    s_add_u32 s42, s42, 49152
    s_add_u32 m0, s41, 9216
    s_nop 0
    buffer_load_dwordx4 v7, s[24:27], s42 offen lds
    s_add_u32 s42, s42, 49152
    s_add_u32 m0, s41, 12288
    s_nop 0
    buffer_load_dwordx4 v7, s[24:27], s42 offen lds
    s_add_u32 s42, s42, 49152
    s_add_u32 m0, s41, 15360
    s_nop 0
    buffer_load_dwordx4 v7, s[24:27], s42 offen lds
    s_add_u32 s42, s42, 49152
    s_add_u32 m0, s41, 18432
    s_nop 0
    buffer_load_dwordx4 v7, s[24:27], s42 offen lds
    s_add_u32 s42, s42, 49152
    s_add_u32 m0, s41, 21504
    s_nop 0
    buffer_load_dwordx4 v7, s[24:27], s42 offen lds
    s_add_u32 s42, s42, 49152
    s_add_u32 m0, s41, 28672
    s_nop 0
    buffer_load_dwordx4 v7, s[24:27], s42 offen lds
    s_add_u32 s42, s42, 49152
    s_add_u32 m0, s41, 31744
    s_nop 0
    buffer_load_dwordx4 v7, s[24:27], s42 offen lds
    s_add_u32 s42, s42, 49152
    s_add_u32 m0, s41, 34816
    s_nop 0
    buffer_load_dwordx4 v7, s[24:27], s42 offen lds
    s_add_u32 s42, s42, 49152
    s_add_u32 m0, s41, 37888
    s_nop 0
    buffer_load_dwordx4 v7, s[24:27], s42 offen lds
    s_add_u32 s42, s42, 49152
    s_add_u32 m0, s41, 40960
    s_nop 0
    buffer_load_dwordx4 v7, s[24:27], s42 offen lds
    s_add_u32 s42, s42, 49152
    s_add_u32 m0, s41, 44032
    s_nop 0
    buffer_load_dwordx4 v7, s[24:27], s42 offen lds
    s_add_u32 s42, s42, 49152
    s_add_u32 m0, s41, 47104
    s_nop 0
    buffer_load_dwordx4 v7, s[24:27], s42 offen lds
    s_add_u32 s42, s42, 49152
    s_add_u32 m0, s41, 50176
    s_nop 0
    buffer_load_dwordx4 v7, s[24:27], s42 offen lds
    s_add_u32 s42, s42, 49152
    s_add_u32 m0, s41, 57344
    s_nop 0
    buffer_load_dwordx4 v7, s[24:27], s42 offen lds
    s_add_u32 s42, s42, 49152
    s_add_u32 m0, s41, 60416
    s_nop 0
    buffer_load_dwordx4 v7, s[24:27], s42 offen lds
    s_add_u32 s42, s42, 49152
    s_add_u32 m0, s41, 63488
    s_nop 0
    buffer_load_dwordx4 v7, s[24:27], s42 offen lds
    s_add_u32 s42, s42, 49152
    s_add_u32 m0, s41, 66560
    s_nop 0
    buffer_load_dwordx4 v7, s[24:27], s42 offen lds
    s_add_u32 s42, s42, 49152
    s_add_u32 m0, s41, 69632
    s_nop 0
    buffer_load_dwordx4 v7, s[24:27], s42 offen lds
    s_add_u32 s42, s42, 49152
    s_add_u32 m0, s41, 72704
    s_nop 0
    buffer_load_dwordx4 v7, s[24:27], s42 offen lds
    s_add_u32 s42, s42, 49152
    s_add_u32 m0, s41, 75776
    s_nop 0
    buffer_load_dwordx4 v7, s[24:27], s42 offen lds
    s_add_u32 s42, s42, 49152
    s_add_u32 m0, s41, 78848
    s_nop 0
    buffer_load_dwordx4 v7, s[24:27], s42 offen lds
    s_add_u32 s42, s42, 49152
    s_waitcnt vmcnt(16)
    s_barrier
    s_mov_b32 s40, 3
qkvA_lloop:
    s_waitcnt vmcnt(8)
    s_barrier
    s_add_u32 m0, s41, 86016
    s_nop 0
    buffer_load_dwordx4 v7, s[24:27], s42 offen lds
    s_add_u32 s42, s42, 49152
    s_add_u32 m0, s41, 89088
    s_nop 0
    buffer_load_dwordx4 v7, s[24:27], s42 offen lds
    s_add_u32 s42, s42, 49152
    s_add_u32 m0, s41, 92160
    s_nop 0
    buffer_load_dwordx4 v7, s[24:27], s42 offen lds
    s_add_u32 s42, s42, 49152
    s_add_u32 m0, s41, 95232
    s_nop 0
    buffer_load_dwordx4 v7, s[24:27], s42 offen lds
    s_add_u32 s42, s42, 49152
    s_add_u32 m0, s41, 98304
    s_nop 0
    buffer_load_dwordx4 v7, s[24:27], s42 offen lds
    s_add_u32 s42, s42, 49152
    s_add_u32 m0, s41, 101376
    s_nop 0
    buffer_load_dwordx4 v7, s[24:27], s42 offen lds
    s_add_u32 s42, s42, 49152
    s_add_u32 m0, s41, 104448
    s_nop 0
    buffer_load_dwordx4 v7, s[24:27], s42 offen lds
    s_add_u32 s42, s42, 49152
    s_add_u32 m0, s41, 107520
    s_nop 0
    buffer_load_dwordx4 v7, s[24:27], s42 offen lds
    s_add_u32 s42, s42, 49152
    s_waitcnt vmcnt(8)
    s_barrier
    s_add_u32 m0, s41, 0
    s_nop 0
    buffer_load_dwordx4 v7, s[24:27], s42 offen lds
    s_add_u32 s42, s42, 49152
    s_add_u32 m0, s41, 3072
    s_nop 0
    buffer_load_dwordx4 v7, s[24:27], s42 offen lds
    s_add_u32 s42, s42, 49152
    s_add_u32 m0, s41, 6144
    s_nop 0
    buffer_load_dwordx4 v7, s[24:27], s42 offen lds
    s_add_u32 s42, s42, 49152
    s_add_u32 m0, s41, 9216
    s_nop 0
    buffer_load_dwordx4 v7, s[24:27], s42 offen lds
    s_add_u32 s42, s42, 49152
    s_add_u32 m0, s41, 12288
    s_nop 0
    buffer_load_dwordx4 v7, s[24:27], s42 offen lds
    s_add_u32 s42, s42, 49152
    s_add_u32 m0, s41, 15360
    s_nop 0
    buffer_load_dwordx4 v7, s[24:27], s42 offen lds
    s_add_u32 s42, s42, 49152
    s_add_u32 m0, s41, 18432
    s_nop 0
    buffer_load_dwordx4 v7, s[24:27], s42 offen lds
    s_add_u32 s42, s42, 49152
    s_add_u32 m0, s41, 21504
    s_nop 0
    buffer_load_dwordx4 v7, s[24:27], s42 offen lds
    s_add_u32 s42, s42, 49152
    s_waitcnt vmcnt(8)
    s_barrier
    s_add_u32 m0, s41, 28672
    s_nop 0
    buffer_load_dwordx4 v7, s[24:27], s42 offen lds
    s_add_u32 s42, s42, 49152
    s_add_u32 m0, s41, 31744
    s_nop 0
    buffer_load_dwordx4 v7, s[24:27], s42 offen lds
    s_add_u32 s42, s42, 49152
    s_add_u32 m0, s41, 34816
    s_nop 0
    buffer_load_dwordx4 v7, s[24:27], s42 offen lds
    s_add_u32 s42, s42, 49152
    s_add_u32 m0, s41, 37888
    s_nop 0
    buffer_load_dwordx4 v7, s[24:27], s42 offen lds
    s_add_u32 s42, s42, 49152
    s_add_u32 m0, s41, 40960
    s_nop 0
    buffer_load_dwordx4 v7, s[24:27], s42 offen lds
    s_add_u32 s42, s42, 49152
    s_add_u32 m0, s41, 44032
    s_nop 0
    buffer_load_dwordx4 v7, s[24:27], s42 offen lds
    s_add_u32 s42, s42, 49152
    s_add_u32 m0, s41, 47104
    s_nop 0
    buffer_load_dwordx4 v7, s[24:27], s42 offen lds
    s_add_u32 s42, s42, 49152
    s_add_u32 m0, s41, 50176
    s_nop 0
    buffer_load_dwordx4 v7, s[24:27], s42 offen lds
    s_add_u32 s42, s42, 49152
    s_waitcnt vmcnt(8)
    s_barrier
    s_add_u32 m0, s41, 57344
    s_nop 0
    buffer_load_dwordx4 v7, s[24:27], s42 offen lds
    s_add_u32 s42, s42, 49152
    s_add_u32 m0, s41, 60416
    s_nop 0
    buffer_load_dwordx4 v7, s[24:27], s42 offen lds
    s_add_u32 s42, s42, 49152
    s_add_u32 m0, s41, 63488
    s_nop 0
    buffer_load_dwordx4 v7, s[24:27], s42 offen lds
    s_add_u32 s42, s42, 49152
    s_add_u32 m0, s41, 66560
    s_nop 0
    buffer_load_dwordx4 v7, s[24:27], s42 offen lds
    s_add_u32 s42, s42, 49152
    s_add_u32 m0, s41, 69632
    s_nop 0
    buffer_load_dwordx4 v7, s[24:27], s42 offen lds
    s_add_u32 s42, s42, 49152
    s_add_u32 m0, s41, 72704
    s_nop 0
    buffer_load_dwordx4 v7, s[24:27], s42 offen lds
    s_add_u32 s42, s42, 49152
    s_add_u32 m0, s41, 75776
    s_nop 0
    buffer_load_dwordx4 v7, s[24:27], s42 offen lds
    s_add_u32 s42, s42, 49152
    s_add_u32 m0, s41, 78848
    s_nop 0
    buffer_load_dwordx4 v7, s[24:27], s42 offen lds
    s_add_u32 s42, s42, 49152
    s_sub_u32 s40, s40, 1
    s_cmp_lg_u32 s40, 0
    s_cbranch_scc1 qkvA_lloop
    s_waitcnt vmcnt(8)
    s_barrier
    s_add_u32 m0, s41, 86016
    s_nop 0
    buffer_load_dwordx4 v7, s[24:27], s42 offen lds
    s_add_u32 s42, s42, 49152
    s_add_u32 m0, s41, 89088
    s_nop 0
    buffer_load_dwordx4 v7, s[24:27], s42 offen lds
    s_add_u32 s42, s42, 49152
    s_add_u32 m0, s41, 92160
    s_nop 0
    buffer_load_dwordx4 v7, s[24:27], s42 offen lds
    s_add_u32 s42, s42, 49152
    s_add_u32 m0, s41, 95232
    s_nop 0
    buffer_load_dwordx4 v7, s[24:27], s42 offen lds
    s_add_u32 s42, s42, 49152
    s_add_u32 m0, s41, 98304
    s_nop 0
    buffer_load_dwordx4 v7, s[24:27], s42 offen lds
    s_add_u32 s42, s42, 49152
    s_add_u32 m0, s41, 101376
    s_nop 0
    buffer_load_dwordx4 v7, s[24:27], s42 offen lds
    s_add_u32 s42, s42, 49152
    s_add_u32 m0, s41, 104448
    s_nop 0
    buffer_load_dwordx4 v7, s[24:27], s42 offen lds
    s_add_u32 s42, s42, 49152
    s_add_u32 m0, s41, 107520
    s_nop 0
    buffer_load_dwordx4 v7, s[24:27], s42 offen lds
    s_add_u32 s42, s42, 49152
qkvA_tail:
    s_load_dwordx2 s[4:5], s[0:1], 16
    s_bfe_u32 s47, s2, 0x10002
    s_lshl_b32 s47, s47, 3
    s_lshr_b32 s48, s2, 5
    s_add_u32 s47, s47, s48
    s_lshl_b32 s47, s47, 7
    v_lshrrev_b32 v20, 3, v1
    v_lshlrev_b32 v21, 11, v20
    v_lshrrev_b32 v22, 2, v1
    v_lshrrev_b32 v23, 4, v1
    v_xor_b32 v22, v22, v23
    v_and_b32 v22, 1, v22
    v_lshl_add_u32 v21, v22, 6, v21
    v_and_b32 v22, 3, v1
    v_lshl_add_u32 v21, v22, 4, v21
    v_add_u32 v11, s47, v21
    v_add_u32 v12, 15360, v11
    v_add_u32 v13, 30720, v11
    v_add_u32 v14, 46080, v11
    s_and_b32 s41, s8, 3
    s_waitcnt lgkmcnt(0)
    s_mov_b32 s12, s4
    s_mov_b32 s13, s5
    s_mov_b32 s14, 2097152
    s_mov_b32 s15, 0x00020000
    s_cmp_eq_u32 s96, s98
    s_cselect_b32 s100, 0, 112
    s_cselect_b32 s42, 8, 0
    s_waitcnt vmcnt(8)
    s_barrier
qkvA_ld0:
    s_cmp_ge_u32 s42, 1
    s_cbranch_scc1 qkvA_ld0_end
    s_lshl_b32 s47, s42, 14
    s_add_u32 s47, s47, s101
    s_sub_u32 s48, s47, 147456
    s_cmp_ge_u32 s47, 147456
    s_cselect_b32 s47, s48, s47
    s_lshl_b32 s48, s41, 12
    s_add_u32 m0, s47, s48
    s_lshl_b32 s47, s42, 18
    s_lshl_b32 s48, s41, 16
    s_add_u32 s47, s47, s48
    buffer_load_dwordx4 v11, s[12:15], s47 offen offset:0 lds
    buffer_load_dwordx4 v12, s[12:15], s47 offen offset:1024 lds
    buffer_load_dwordx4 v13, s[12:15], s47 offen offset:2048 lds
    buffer_load_dwordx4 v14, s[12:15], s47 offen offset:3072 lds
    s_add_u32 s42, s42, 1
    s_branch qkvA_ld0
qkvA_ld0_end:
    s_waitcnt vmcnt(4)
    s_barrier
qkvA_ld1:
    s_cmp_ge_u32 s42, 3
    s_cbranch_scc1 qkvA_ld1_end
    s_lshl_b32 s47, s42, 14
    s_add_u32 s47, s47, s101
    s_sub_u32 s48, s47, 147456
    s_cmp_ge_u32 s47, 147456
    s_cselect_b32 s47, s48, s47
    s_lshl_b32 s48, s41, 12
    s_add_u32 m0, s47, s48
    s_lshl_b32 s47, s42, 18
    s_lshl_b32 s48, s41, 16
    s_add_u32 s47, s47, s48
    buffer_load_dwordx4 v11, s[12:15], s47 offen offset:0 lds
    buffer_load_dwordx4 v12, s[12:15], s47 offen offset:1024 lds
    buffer_load_dwordx4 v13, s[12:15], s47 offen offset:2048 lds
    buffer_load_dwordx4 v14, s[12:15], s47 offen offset:3072 lds
    s_add_u32 s42, s42, 1
    s_branch qkvA_ld1
qkvA_ld1_end:
    s_barrier
qkvA_ld2:
    s_cmp_ge_u32 s42, 5
    s_cbranch_scc1 qkvA_ld2_end
    s_lshl_b32 s47, s42, 14
    s_add_u32 s47, s47, s101
    s_sub_u32 s48, s47, 147456
    s_cmp_ge_u32 s47, 147456
    s_cselect_b32 s47, s48, s47
    s_lshl_b32 s48, s41, 12
    s_add_u32 m0, s47, s48
    s_lshl_b32 s47, s42, 18
    s_lshl_b32 s48, s41, 16
    s_add_u32 s47, s47, s48
    buffer_load_dwordx4 v11, s[12:15], s47 offen offset:0 lds
    buffer_load_dwordx4 v12, s[12:15], s47 offen offset:1024 lds
    buffer_load_dwordx4 v13, s[12:15], s47 offen offset:2048 lds
    buffer_load_dwordx4 v14, s[12:15], s47 offen offset:3072 lds
    s_add_u32 s42, s42, 1
    s_branch qkvA_ld2
qkvA_ld2_end:
    s_barrier
qkvA_ld3:
    s_cmp_ge_u32 s42, 7
    s_cbranch_scc1 qkvA_ld3_end
    s_lshl_b32 s47, s42, 14
    s_add_u32 s47, s47, s101
    s_sub_u32 s48, s47, 147456
    s_cmp_ge_u32 s47, 147456
    s_cselect_b32 s47, s48, s47
    s_lshl_b32 s48, s41, 12
    s_add_u32 m0, s47, s48
    s_lshl_b32 s47, s42, 18
    s_lshl_b32 s48, s41, 16
    s_add_u32 s47, s47, s48
    buffer_load_dwordx4 v11, s[12:15], s47 offen offset:0 lds
    buffer_load_dwordx4 v12, s[12:15], s47 offen offset:1024 lds
    buffer_load_dwordx4 v13, s[12:15], s47 offen offset:2048 lds
    buffer_load_dwordx4 v14, s[12:15], s47 offen offset:3072 lds
    s_add_u32 s42, s42, 1
    s_branch qkvA_ld3
qkvA_ld3_end:
    s_waitcnt vmcnt(0)
    s_cmp_eq_u32 s96, s98
    s_cbranch_scc1 mega_exit
    s_branch mega_next
qkvA_helper:
    s_barrier
    s_lshl_b32 s23, s9, 14
    s_add_u32 s23, s23, s21
    buffer_load_dwordx4 v[32:35], v5, s[28:31], s23 offen offset:0 sc1
    buffer_load_dwordx4 v[36:39], v5, s[28:31], s23 offen offset:1024 sc1
    buffer_load_dwordx4 v[40:43], v5, s[28:31], s23 offen offset:2048 sc1
    buffer_load_dwordx4 v[44:47], v5, s[28:31], s23 offen offset:3072 sc1
    s_add_u32 s23, s23, 4096
    buffer_load_dwordx4 v[48:51], v5, s[28:31], s23 offen offset:0 sc1
    buffer_load_dwordx4 v[52:55], v5, s[28:31], s23 offen offset:1024 sc1
    buffer_load_dwordx4 v[56:59], v5, s[28:31], s23 offen offset:2048 sc1
    buffer_load_dwordx4 v[60:63], v5, s[28:31], s23 offen offset:3072 sc1
    s_add_u32 s23, s23, 4096
    s_barrier
    buffer_load_dwordx4 v[64:67], v5, s[28:31], s23 offen offset:0 sc1
    buffer_load_dwordx4 v[68:71], v5, s[28:31], s23 offen offset:1024 sc1
    buffer_load_dwordx4 v[72:75], v5, s[28:31], s23 offen offset:2048 sc1
    buffer_load_dwordx4 v[76:79], v5, s[28:31], s23 offen offset:3072 sc1
    s_add_u32 s23, s23, 4096
    buffer_load_dwordx4 v[80:83], v5, s[28:31], s23 offen offset:0 sc1
    buffer_load_dwordx4 v[84:87], v5, s[28:31], s23 offen offset:1024 sc1
    buffer_load_dwordx4 v[88:91], v5, s[28:31], s23 offen offset:2048 sc1
    buffer_load_dwordx4 v[92:95], v5, s[28:31], s23 offen offset:3072 sc1
    s_barrier
    s_lshl_b32 s23, s44, 12
    s_add_u32 s23, s23, s21
    buffer_load_dwordx4 v[96:99], v5, s[28:31], s23 offen offset:0 sc1
    buffer_load_dwordx4 v[100:103], v5, s[28:31], s23 offen offset:1024 sc1
    buffer_load_dwordx4 v[104:107], v5, s[28:31], s23 offen offset:2048 sc1
    buffer_load_dwordx4 v[108:111], v5, s[28:31], s23 offen offset:3072 sc1
    v_lshrrev_b32 v20, 4, v1
    v_min_u32 v20, 2, v20
    v_lshlrev_b32 v20, 7, v20
    v_add_u32 v20, v20, v4
    s_lshr_b32 s22, s10, 1
    s_lshl_b32 s22, s22, 4
    v_add_u32 v20, s22, v20
    v_lshlrev_b32 v20, 6, v20
    v_mov_b32 v21, 49152
    v_cmp_lt_u32 vcc, 47, v1
    s_nop 1
    v_cndmask_b32 v20, v20, v21, vcc
    s_mov_b32 s47, 68681728
    s_mov_b32 s48, 0x40000
qkvA_h2_poll:
    buffer_load_dwordx2 v[208:209], v20, s[28:31], s47 offen sc1
    s_waitcnt vmcnt(0)
    v_cmp_ne_u64 vcc, s[60:61], v[208:209]
    s_nop 4
    s_cbranch_vccz qkvA_h2_ready
    s_sub_u32 s48, s48, 1
    s_cmp_lg_u32 s48, 0
    s_cbranch_scc1 qkvA_h2_poll
qkvA_h2_ready:
    s_lshl_b32 s22, s10, 10
    s_add_u32 s23, s22, 59768832
    buffer_load_dwordx4 v[112:115], v5, s[28:31], s23 offen sc1
    s_add_u32 s23, s22, 59817984
    buffer_load_dwordx4 v[116:119], v5, s[28:31], s23 offen sc1
    s_add_u32 s23, s22, 59867136
    buffer_load_dwordx4 v[120:123], v5, s[28:31], s23 offen sc1
    s_add_u32 s23, s22, 59916288
    buffer_load_dwordx4 v[124:127], v5, s[28:31], s23 offen sc1
    s_barrier
    s_add_u32 s23, s22, 59785216
    buffer_load_dwordx4 v[128:131], v5, s[28:31], s23 offen sc1
    s_add_u32 s23, s22, 59834368
    buffer_load_dwordx4 v[132:135], v5, s[28:31], s23 offen sc1
    s_add_u32 s23, s22, 59883520
    buffer_load_dwordx4 v[136:139], v5, s[28:31], s23 offen sc1
    s_add_u32 s23, s22, 59932672
    buffer_load_dwordx4 v[140:143], v5, s[28:31], s23 offen sc1
    s_add_u32 s23, s22, 59801600
    buffer_load_dwordx4 v[144:147], v5, s[28:31], s23 offen sc1
    s_add_u32 s23, s22, 59850752
    buffer_load_dwordx4 v[148:151], v5, s[28:31], s23 offen sc1
    s_add_u32 s23, s22, 59899904
    buffer_load_dwordx4 v[152:155], v5, s[28:31], s23 offen sc1
    s_add_u32 s23, s22, 59949056
    buffer_load_dwordx4 v[156:159], v5, s[28:31], s23 offen sc1
    s_barrier
    v_and_b32 v24, 31, v1
    v_lshlrev_b32 v24, 2, v24
    v_add_u32 v24, 114688, v24
    v_pk_add_f32 v[20:21], v[32:33], v[34:35]
    v_pk_add_f32 v[20:21], v[20:21], v[36:37]
    v_pk_add_f32 v[20:21], v[20:21], v[38:39]
    v_pk_add_f32 v[20:21], v[20:21], v[40:41]
    v_pk_add_f32 v[20:21], v[20:21], v[42:43]
    v_pk_add_f32 v[20:21], v[20:21], v[44:45]
    v_pk_add_f32 v[20:21], v[20:21], v[46:47]
    v_mov_b32 v22, v20
    v_mov_b32 v23, v21
    s_nop 0
    v_permlane32_swap_b32 v20, v22
    v_permlane32_swap_b32 v21, v23
    v_pk_add_f32 v[20:21], v[20:21], v[22:23]
    v_mul_f32 v32, 0x3a800000, v20
    v_mul_f32 v21, 0x3a800000, v21
    v_fma_f32 v21, -v32, v32, v21
    v_max_f32 v21, 0, v21
    v_add_f32 v21, 0x3727c5ac, v21
    v_rsq_f32 v33, v21
    ds_write_b32 v24, v32 offset:1024
    ds_write_b32 v24, v33 offset:1664
    v_pk_add_f32 v[20:21], v[48:49], v[50:51]
    v_pk_add_f32 v[20:21], v[20:21], v[52:53]
    v_pk_add_f32 v[20:21], v[20:21], v[54:55]
    v_pk_add_f32 v[20:21], v[20:21], v[56:57]
    v_pk_add_f32 v[20:21], v[20:21], v[58:59]
    v_pk_add_f32 v[20:21], v[20:21], v[60:61]
    v_pk_add_f32 v[20:21], v[20:21], v[62:63]
    v_mov_b32 v22, v20
    v_mov_b32 v23, v21
    s_nop 0
    v_permlane32_swap_b32 v20, v22
    v_permlane32_swap_b32 v21, v23
    v_pk_add_f32 v[20:21], v[20:21], v[22:23]
    v_mul_f32 v48, 0x3a800000, v20
    v_mul_f32 v21, 0x3a800000, v21
    v_fma_f32 v21, -v48, v48, v21
    v_max_f32 v21, 0, v21
    v_add_f32 v21, 0x3727c5ac, v21
    v_rsq_f32 v49, v21
    ds_write_b32 v24, v48 offset:1152
    ds_write_b32 v24, v49 offset:1792
    s_barrier
    v_pk_add_f32 v[20:21], v[64:65], v[66:67]
    v_pk_add_f32 v[20:21], v[20:21], v[68:69]
    v_pk_add_f32 v[20:21], v[20:21], v[70:71]
    v_pk_add_f32 v[20:21], v[20:21], v[72:73]
    v_pk_add_f32 v[20:21], v[20:21], v[74:75]
    v_pk_add_f32 v[20:21], v[20:21], v[76:77]
    v_pk_add_f32 v[20:21], v[20:21], v[78:79]
    v_mov_b32 v22, v20
    v_mov_b32 v23, v21
    s_nop 0
    v_permlane32_swap_b32 v20, v22
    v_permlane32_swap_b32 v21, v23
    v_pk_add_f32 v[20:21], v[20:21], v[22:23]
    v_mul_f32 v64, 0x3a800000, v20
    v_mul_f32 v21, 0x3a800000, v21
    v_fma_f32 v21, -v64, v64, v21
    v_max_f32 v21, 0, v21
    v_add_f32 v21, 0x3727c5ac, v21
    v_rsq_f32 v65, v21
    ds_write_b32 v24, v64 offset:1280
    ds_write_b32 v24, v65 offset:1920
    v_pk_add_f32 v[20:21], v[80:81], v[82:83]
    v_pk_add_f32 v[20:21], v[20:21], v[84:85]
    v_pk_add_f32 v[20:21], v[20:21], v[86:87]
    v_pk_add_f32 v[20:21], v[20:21], v[88:89]
    v_pk_add_f32 v[20:21], v[20:21], v[90:91]
    v_pk_add_f32 v[20:21], v[20:21], v[92:93]
    v_pk_add_f32 v[20:21], v[20:21], v[94:95]
    v_mov_b32 v22, v20
    v_mov_b32 v23, v21
    s_nop 0
    v_permlane32_swap_b32 v20, v22
    v_permlane32_swap_b32 v21, v23
    v_pk_add_f32 v[20:21], v[20:21], v[22:23]
    v_mul_f32 v80, 0x3a800000, v20
    v_mul_f32 v21, 0x3a800000, v21
    v_fma_f32 v21, -v80, v80, v21
    v_max_f32 v21, 0, v21
    v_add_f32 v21, 0x3727c5ac, v21
    v_rsq_f32 v81, v21
    ds_write_b32 v24, v80 offset:1408
    ds_write_b32 v24, v81 offset:2048
    s_barrier
    v_pk_add_f32 v[20:21], v[96:97], v[98:99]
    v_pk_add_f32 v[20:21], v[20:21], v[100:101]
    v_pk_add_f32 v[20:21], v[20:21], v[102:103]
    v_pk_add_f32 v[20:21], v[20:21], v[104:105]
    v_pk_add_f32 v[20:21], v[20:21], v[106:107]
    v_pk_add_f32 v[20:21], v[20:21], v[108:109]
    v_pk_add_f32 v[20:21], v[20:21], v[110:111]
    v_mov_b32 v22, v20
    v_mov_b32 v23, v21
    s_nop 0
    v_permlane32_swap_b32 v20, v22
    v_permlane32_swap_b32 v21, v23
    v_pk_add_f32 v[20:21], v[20:21], v[22:23]
    v_mul_f32 v96, 0x3a800000, v20
    v_mul_f32 v21, 0x3a800000, v21
    v_fma_f32 v21, -v96, v96, v21
    v_max_f32 v21, 0, v21
    v_add_f32 v21, 0x3727c5ac, v21
    v_rsq_f32 v97, v21
    ds_write_b32 v24, v96 offset:1536
    ds_write_b32 v24, v97 offset:2176
    s_barrier
    v_lshlrev_b32 v24, 2, v1
    v_add_u32 v24, 114688, v24
    s_waitcnt vmcnt(8)
    v_pk_add_f32 v[112:113], v[112:113], v[114:115]
    v_pk_add_f32 v[112:113], v[112:113], v[116:117]
    v_pk_add_f32 v[112:113], v[112:113], v[118:119]
    v_pk_add_f32 v[112:113], v[112:113], v[120:121]
    v_pk_add_f32 v[112:113], v[112:113], v[122:123]
    v_pk_add_f32 v[112:113], v[112:113], v[124:125]
    v_pk_add_f32 v[112:113], v[112:113], v[126:127]
    v_add_f32 v112, v112, v113
    ds_write_b32 v24, v112 offset:0
    s_waitcnt vmcnt(4)
    v_pk_add_f32 v[128:129], v[128:129], v[130:131]
    v_pk_add_f32 v[128:129], v[128:129], v[132:133]
    v_pk_add_f32 v[128:129], v[128:129], v[134:135]
    v_pk_add_f32 v[128:129], v[128:129], v[136:137]
    v_pk_add_f32 v[128:129], v[128:129], v[138:139]
    v_pk_add_f32 v[128:129], v[128:129], v[140:141]
    v_pk_add_f32 v[128:129], v[128:129], v[142:143]
    v_add_f32 v128, v128, v129
    ds_write_b32 v24, v128 offset:256
    s_waitcnt vmcnt(0)
    v_pk_add_f32 v[144:145], v[144:145], v[146:147]
    v_pk_add_f32 v[144:145], v[144:145], v[148:149]
    v_pk_add_f32 v[144:145], v[144:145], v[150:151]
    v_pk_add_f32 v[144:145], v[144:145], v[152:153]
    v_pk_add_f32 v[144:145], v[144:145], v[154:155]
    v_pk_add_f32 v[144:145], v[144:145], v[156:157]
    v_pk_add_f32 v[144:145], v[144:145], v[158:159]
    v_add_f32 v144, v144, v145
    ds_write_b32 v24, v144 offset:512
    s_waitcnt lgkmcnt(0)
    s_barrier
    s_barrier
    s_barrier
    s_barrier
    s_barrier
    s_barrier
    s_branch qkvA_tail
.p2align 6
wo_body:
    s_lshl_b32 s20, s99, 22
    s_add_u32 s21, s20, 4194304
    s_lshl_b32 s22, s99, 18
    s_add_u32 s22, s22, 58982400
    s_bitcmp1_b32 s99, 0
    s_cselect_b32 s23, 40, 16
    s_load_dwordx2 s[4:5], s[0:1], s23
    s_load_dwordx2 s[6:7], s[0:1], 64
    v_and_b32 v1, 63, v0
    v_lshrrev_b32 v2, 6, v0
    v_lshlrev_b32 v5, 4, v1
    v_readfirstlane_b32 s8, v2
    s_and_b32 s3, s2, 3
    s_lshl_b32 s3, s3, 2
    s_bfe_u32 s11, s2, 0x20003
    s_add_u32 s9, s3, s11
    s_bfe_u32 s3, s2, 0x10002
    s_lshl_b32 s3, s3, 3
    s_lshr_b32 s11, s2, 5
    s_add_u32 s10, s3, s11
    v_lshrrev_b32 v16, 3, v1
    v_lshlrev_b32 v17, 11, v16
    v_lshrrev_b32 v18, 2, v1
    v_lshrrev_b32 v19, 4, v1
    v_xor_b32 v18, v18, v19
    v_and_b32 v18, 1, v18
    v_lshl_add_u32 v17, v18, 6, v17
    v_and_b32 v18, 3, v1
    v_lshl_add_u32 v17, v18, 4, v17
    s_lshl_b32 s3, s10, 7
    v_add_u32 v6, s3, v17
    v_add_u32 v7, 15360, v6
    v_add_u32 v8, 30720, v6
    v_add_u32 v9, 46080, v6
    s_and_b32 s3, s8, 3
    s_lshl_b32 s41, s3, 12
    s_lshl_b32 s47, s3, 16
    s_lshl_b32 s3, s9, 2
    s_add_u32 s11, s3, s8
    s_lshl_b32 s42, s11, 16
    s_add_u32 s43, s42, 41943040
    s_add_u32 s43, s43, s20
    s_waitcnt lgkmcnt(0)
    s_mov_b32 s24, s4
    s_mov_b32 s25, s5
    s_mov_b32 s26, 2097152
    s_mov_b32 s27, 0x00020000
    s_cmp_gt_u32 s8, 3
    s_cbranch_scc1 wo_idle
    s_add_u32 s12, s6, s43
    s_addc_u32 s13, s7, 0
    s_mov_b32 s14, 65536
    s_mov_b32 s15, 0x00020000
    s_mov_b32 s28, s6
    s_mov_b32 s29, s7
    s_mov_b32 s30, 75497472
    s_mov_b32 s31, 0x00020000
    s_bitcmp1_b32 s99, 0
    s_cselect_b32 s53, 32, 16
    s_lshl_b32 s50, s96, 15
    s_add_u32 s50, s50, 71270400
    s_add_u32 s54, s28, s50
    s_addc_u32 s55, s29, 0
    s_mov_b32 s56, 0x40000
    s_lshl_b32 s57, s11, 8
wo_poll:
    s_mov_b32 s70, 0
    s_atomic_add s70, s[54:55], s57 offset:0 glc
    s_waitcnt lgkmcnt(0)
    s_cmp_eq_u32 s70, s53
    s_cbranch_scc1 wo_ready
    s_sub_u32 s56, s56, 1
    s_cmp_lg_u32 s56, 0
    s_cbranch_scc1 wo_poll
wo_ready:
    s_mov_b32 s40, 0
    buffer_load_dwordx4 v[112:115], v5, s[12:15], s40 offen offset:0 sc1
    buffer_load_dwordx4 v[116:119], v5, s[12:15], s40 offen offset:1024 sc1
    buffer_load_dwordx4 v[120:123], v5, s[12:15], s40 offen offset:2048 sc1
    buffer_load_dwordx4 v[124:127], v5, s[12:15], s40 offen offset:3072 sc1
    s_mov_b32 s40, 4096
    buffer_load_dwordx4 v[128:131], v5, s[12:15], s40 offen offset:0 sc1
    buffer_load_dwordx4 v[132:135], v5, s[12:15], s40 offen offset:1024 sc1
    v_lshrrev_b32 v3, 5, v1
    v_and_b32 v4, 15, v0
    v_lshrrev_b32 v16, 2, v4
    v_lshl_add_u32 v16, v3, 2, v16
    v_lshlrev_b32 v16, 7, v16
    v_bfe_u32 v17, v1, 4, 1
    v_lshl_add_u32 v16, v17, 5, v16
    v_and_b32 v17, 3, v4
    v_lshl_add_u32 v16, v17, 3, v16
    v_lshrrev_b32 v17, 3, v4
    v_lshlrev_b32 v18, 6, v17
    v_add_u32 v10, v16, v18
    v_sub_u32 v11, v16, v18
    s_add_u32 s52, s101, 16384
    v_add_u32 v12, s101, v10
    v_add_u32 v14, s52, v10
    v_add_u32 v13, s101, v11
    v_add_u32 v15, s52, v11
    s_mov_b32 s100, 0
    s_mov_b32 s101, 0
    v_mov_b32 v32, 0
    v_mov_b32 v33, 0
    v_mov_b32 v34, 0
    v_mov_b32 v35, 0
    v_mov_b32 v36, 0
    v_mov_b32 v37, 0
    v_mov_b32 v38, 0
    v_mov_b32 v39, 0
    v_mov_b32 v40, 0
    v_mov_b32 v41, 0
    v_mov_b32 v42, 0
    v_mov_b32 v43, 0
    v_mov_b32 v44, 0
    v_mov_b32 v45, 0
    v_mov_b32 v46, 0
    v_mov_b32 v47, 0
    v_mov_b32 v48, 0
    v_mov_b32 v49, 0
    v_mov_b32 v50, 0
    v_mov_b32 v51, 0
    v_mov_b32 v52, 0
    v_mov_b32 v53, 0
    v_mov_b32 v54, 0
    v_mov_b32 v55, 0
    v_mov_b32 v56, 0
    v_mov_b32 v57, 0
    v_mov_b32 v58, 0
    v_mov_b32 v59, 0
    v_mov_b32 v60, 0
    v_mov_b32 v61, 0
    v_mov_b32 v62, 0
    v_mov_b32 v63, 0
    buffer_load_dwordx4 v[136:139], v5, s[12:15], s40 offen offset:2048 sc1
    buffer_load_dwordx4 v[140:143], v5, s[12:15], s40 offen offset:3072 sc1
    s_mov_b32 s40, 8192
    buffer_load_dwordx4 v[144:147], v5, s[12:15], s40 offen offset:0 sc1
    buffer_load_dwordx4 v[148:151], v5, s[12:15], s40 offen offset:1024 sc1
    buffer_load_dwordx4 v[152:155], v5, s[12:15], s40 offen offset:2048 sc1
    buffer_load_dwordx4 v[156:159], v5, s[12:15], s40 offen offset:3072 sc1
    s_mov_b32 s40, 12288
    buffer_load_dwordx4 v[160:163], v5, s[12:15], s40 offen offset:0 sc1
    buffer_load_dwordx4 v[164:167], v5, s[12:15], s40 offen offset:1024 sc1
    buffer_load_dwordx4 v[168:171], v5, s[12:15], s40 offen offset:2048 sc1
    s_lshl_b32 s3, s10, 12
    s_add_u32 s48, s3, s42
    s_add_u32 s43, s48, s20
    buffer_load_dwordx4 v[96:99], v5, s[28:31], s43 offen offset:0 sc1
    buffer_load_dwordx4 v[100:103], v5, s[28:31], s43 offen offset:1024 sc1
    buffer_load_dwordx4 v[104:107], v5, s[28:31], s43 offen offset:2048 sc1
    buffer_load_dwordx4 v[108:111], v5, s[28:31], s43 offen offset:3072 sc1
    s_mov_b32 s32, 15360
    s_mov_b32 s33, 19456
    s_mov_b32 s34, 23552
    s_mov_b32 s35, 27648
    s_mov_b32 s40, 4
    s_barrier
    ds_read_b64_tr_b16 v[64:65], v12 offset:0
    ds_read_b64_tr_b16 v[66:67], v12 offset:1024
    ds_read_b64_tr_b16 v[68:69], v13 offset:64
    ds_read_b64_tr_b16 v[70:71], v13 offset:1088
    ds_read_b64_tr_b16 v[72:73], v12 offset:2048
    ds_read_b64_tr_b16 v[74:75], v12 offset:3072
    ds_read_b64_tr_b16 v[76:77], v13 offset:2112
    ds_read_b64_tr_b16 v[78:79], v13 offset:3136
    ds_read_b64_tr_b16 v[80:81], v12 offset:4096
    ds_read_b64_tr_b16 v[82:83], v12 offset:5120
    ds_read_b64_tr_b16 v[84:85], v13 offset:4160
    ds_read_b64_tr_b16 v[86:87], v13 offset:5184
wo_loop:
    s_waitcnt vmcnt(14) lgkmcnt(8)
    v_mfma_f32_32x32x16_bf16 v[32:47], v[64:67], v[112:115], v[32:47]
    ds_read_b64_tr_b16 v[88:89], v12 offset:6144
    ds_read_b64_tr_b16 v[90:91], v12 offset:7168
    buffer_load_dwordx4 v[172:175], v5, s[12:15], s32 offen offset:0 sc1
    v_mfma_f32_32x32x16_bf16 v[48:63], v[68:71], v[112:115], v[48:63]
    ds_read_b64_tr_b16 v[92:93], v13 offset:6208
    ds_read_b64_tr_b16 v[94:95], v13 offset:7232
    s_waitcnt vmcnt(14) lgkmcnt(8)
    v_mfma_f32_32x32x16_bf16 v[32:47], v[72:75], v[116:119], v[32:47]
    ds_read_b64_tr_b16 v[64:65], v12 offset:8192
    ds_read_b64_tr_b16 v[66:67], v12 offset:9216
    buffer_load_dwordx4 v[112:115], v5, s[12:15], s32 offen offset:1024 sc1
    v_mfma_f32_32x32x16_bf16 v[48:63], v[76:79], v[116:119], v[48:63]
    ds_read_b64_tr_b16 v[68:69], v13 offset:8256
    ds_read_b64_tr_b16 v[70:71], v13 offset:9280
    s_waitcnt vmcnt(14) lgkmcnt(8)
    v_mfma_f32_32x32x16_bf16 v[32:47], v[80:83], v[120:123], v[32:47]
    ds_read_b64_tr_b16 v[72:73], v12 offset:10240
    ds_read_b64_tr_b16 v[74:75], v12 offset:11264
    buffer_load_dwordx4 v[116:119], v5, s[12:15], s32 offen offset:2048 sc1
    v_mfma_f32_32x32x16_bf16 v[48:63], v[84:87], v[120:123], v[48:63]
    ds_read_b64_tr_b16 v[76:77], v13 offset:10304
    ds_read_b64_tr_b16 v[78:79], v13 offset:11328
    s_waitcnt vmcnt(14) lgkmcnt(8)
    v_mfma_f32_32x32x16_bf16 v[32:47], v[88:91], v[124:127], v[32:47]
    ds_read_b64_tr_b16 v[80:81], v12 offset:12288
    ds_read_b64_tr_b16 v[82:83], v12 offset:13312
    buffer_load_dwordx4 v[120:123], v5, s[12:15], s32 offen offset:3072 sc1
    v_mfma_f32_32x32x16_bf16 v[48:63], v[92:95], v[124:127], v[48:63]
    ds_read_b64_tr_b16 v[84:85], v13 offset:12352
    ds_read_b64_tr_b16 v[86:87], v13 offset:13376
    s_waitcnt vmcnt(14) lgkmcnt(8)
    v_mfma_f32_32x32x16_bf16 v[32:47], v[64:67], v[128:131], v[32:47]
    ds_read_b64_tr_b16 v[88:89], v12 offset:14336
    ds_read_b64_tr_b16 v[90:91], v12 offset:15360
    buffer_load_dwordx4 v[124:127], v5, s[12:15], s33 offen offset:0 sc1
    v_mfma_f32_32x32x16_bf16 v[48:63], v[68:71], v[128:131], v[48:63]
    ds_read_b64_tr_b16 v[92:93], v13 offset:14400
    ds_read_b64_tr_b16 v[94:95], v13 offset:15424
    s_add_u32 s52, s52, 16384
    s_sub_u32 s3, s52, 147456
    s_cmp_ge_u32 s52, 147456
    s_cselect_b32 s52, s3, s52
    v_add_u32 v12, s52, v10
    v_add_u32 v13, s52, v11
    s_barrier
    s_waitcnt vmcnt(14) lgkmcnt(8)
    v_mfma_f32_32x32x16_bf16 v[32:47], v[72:75], v[132:135], v[32:47]
    ds_read_b64_tr_b16 v[64:65], v14 offset:0
    ds_read_b64_tr_b16 v[66:67], v14 offset:1024
    buffer_load_dwordx4 v[128:131], v5, s[12:15], s33 offen offset:1024 sc1
    v_mfma_f32_32x32x16_bf16 v[48:63], v[76:79], v[132:135], v[48:63]
    ds_read_b64_tr_b16 v[68:69], v15 offset:64
    ds_read_b64_tr_b16 v[70:71], v15 offset:1088
    s_waitcnt vmcnt(14) lgkmcnt(8)
    v_mfma_f32_32x32x16_bf16 v[32:47], v[80:83], v[136:139], v[32:47]
    ds_read_b64_tr_b16 v[72:73], v14 offset:2048
    ds_read_b64_tr_b16 v[74:75], v14 offset:3072
    buffer_load_dwordx4 v[132:135], v5, s[12:15], s33 offen offset:2048 sc1
    v_mfma_f32_32x32x16_bf16 v[48:63], v[84:87], v[136:139], v[48:63]
    ds_read_b64_tr_b16 v[76:77], v15 offset:2112
    ds_read_b64_tr_b16 v[78:79], v15 offset:3136
    s_waitcnt vmcnt(14) lgkmcnt(8)
    v_mfma_f32_32x32x16_bf16 v[32:47], v[88:91], v[140:143], v[32:47]
    ds_read_b64_tr_b16 v[80:81], v14 offset:4096
    ds_read_b64_tr_b16 v[82:83], v14 offset:5120
    buffer_load_dwordx4 v[136:139], v5, s[12:15], s33 offen offset:3072 sc1
    v_mfma_f32_32x32x16_bf16 v[48:63], v[92:95], v[140:143], v[48:63]
    ds_read_b64_tr_b16 v[84:85], v15 offset:4160
    ds_read_b64_tr_b16 v[86:87], v15 offset:5184
    s_waitcnt vmcnt(14) lgkmcnt(8)
    v_mfma_f32_32x32x16_bf16 v[32:47], v[64:67], v[144:147], v[32:47]
    ds_read_b64_tr_b16 v[88:89], v14 offset:6144
    ds_read_b64_tr_b16 v[90:91], v14 offset:7168
    buffer_load_dwordx4 v[140:143], v5, s[12:15], s34 offen offset:0 sc1
    v_mfma_f32_32x32x16_bf16 v[48:63], v[68:71], v[144:147], v[48:63]
    ds_read_b64_tr_b16 v[92:93], v15 offset:6208
    ds_read_b64_tr_b16 v[94:95], v15 offset:7232
    s_waitcnt vmcnt(14) lgkmcnt(8)
    v_mfma_f32_32x32x16_bf16 v[32:47], v[72:75], v[148:151], v[32:47]
    ds_read_b64_tr_b16 v[64:65], v14 offset:8192
    ds_read_b64_tr_b16 v[66:67], v14 offset:9216
    buffer_load_dwordx4 v[144:147], v5, s[12:15], s34 offen offset:1024 sc1
    v_mfma_f32_32x32x16_bf16 v[48:63], v[76:79], v[148:151], v[48:63]
    ds_read_b64_tr_b16 v[68:69], v15 offset:8256
    ds_read_b64_tr_b16 v[70:71], v15 offset:9280
    s_waitcnt vmcnt(14) lgkmcnt(8)
    v_mfma_f32_32x32x16_bf16 v[32:47], v[80:83], v[152:155], v[32:47]
    ds_read_b64_tr_b16 v[72:73], v14 offset:10240
    ds_read_b64_tr_b16 v[74:75], v14 offset:11264
    buffer_load_dwordx4 v[148:151], v5, s[12:15], s34 offen offset:2048 sc1
    v_mfma_f32_32x32x16_bf16 v[48:63], v[84:87], v[152:155], v[48:63]
    ds_read_b64_tr_b16 v[76:77], v15 offset:10304
    ds_read_b64_tr_b16 v[78:79], v15 offset:11328
    s_waitcnt vmcnt(14) lgkmcnt(8)
    v_mfma_f32_32x32x16_bf16 v[32:47], v[88:91], v[156:159], v[32:47]
    ds_read_b64_tr_b16 v[80:81], v14 offset:12288
    ds_read_b64_tr_b16 v[82:83], v14 offset:13312
    buffer_load_dwordx4 v[152:155], v5, s[12:15], s34 offen offset:3072 sc1
    v_mfma_f32_32x32x16_bf16 v[48:63], v[92:95], v[156:159], v[48:63]
    ds_read_b64_tr_b16 v[84:85], v15 offset:12352
    ds_read_b64_tr_b16 v[86:87], v15 offset:13376
    s_waitcnt vmcnt(14) lgkmcnt(8)
    v_mfma_f32_32x32x16_bf16 v[32:47], v[64:67], v[160:163], v[32:47]
    ds_read_b64_tr_b16 v[88:89], v14 offset:14336
    ds_read_b64_tr_b16 v[90:91], v14 offset:15360
    buffer_load_dwordx4 v[156:159], v5, s[12:15], s35 offen offset:0 sc1
    v_mfma_f32_32x32x16_bf16 v[48:63], v[68:71], v[160:163], v[48:63]
    ds_read_b64_tr_b16 v[92:93], v15 offset:14400
    ds_read_b64_tr_b16 v[94:95], v15 offset:15424
    s_add_u32 s52, s52, 16384
    s_sub_u32 s3, s52, 147456
    s_cmp_ge_u32 s52, 147456
    s_cselect_b32 s52, s3, s52
    v_add_u32 v14, s52, v10
    v_add_u32 v15, s52, v11
    s_barrier
    s_waitcnt vmcnt(14) lgkmcnt(8)
    v_mfma_f32_32x32x16_bf16 v[32:47], v[72:75], v[164:167], v[32:47]
    ds_read_b64_tr_b16 v[64:65], v12 offset:0
    ds_read_b64_tr_b16 v[66:67], v12 offset:1024
    buffer_load_dwordx4 v[160:163], v5, s[12:15], s35 offen offset:1024 sc1
    v_mfma_f32_32x32x16_bf16 v[48:63], v[76:79], v[164:167], v[48:63]
    ds_read_b64_tr_b16 v[68:69], v13 offset:64
    ds_read_b64_tr_b16 v[70:71], v13 offset:1088
    s_waitcnt vmcnt(14) lgkmcnt(8)
    v_mfma_f32_32x32x16_bf16 v[32:47], v[80:83], v[168:171], v[32:47]
    ds_read_b64_tr_b16 v[72:73], v12 offset:2048
    ds_read_b64_tr_b16 v[74:75], v12 offset:3072
    buffer_load_dwordx4 v[164:167], v5, s[12:15], s35 offen offset:2048 sc1
    v_mfma_f32_32x32x16_bf16 v[48:63], v[84:87], v[168:171], v[48:63]
    ds_read_b64_tr_b16 v[76:77], v13 offset:2112
    ds_read_b64_tr_b16 v[78:79], v13 offset:3136
    s_waitcnt vmcnt(14) lgkmcnt(8)
    v_mfma_f32_32x32x16_bf16 v[32:47], v[88:91], v[172:175], v[32:47]
    ds_read_b64_tr_b16 v[80:81], v12 offset:4096
    ds_read_b64_tr_b16 v[82:83], v12 offset:5120
    buffer_load_dwordx4 v[168:171], v5, s[12:15], s35 offen offset:3072 sc1
    v_mfma_f32_32x32x16_bf16 v[48:63], v[92:95], v[172:175], v[48:63]
    ds_read_b64_tr_b16 v[84:85], v13 offset:4160
    ds_read_b64_tr_b16 v[86:87], v13 offset:5184
    s_add_u32 s32, s32, 16384
    s_add_u32 s33, s33, 16384
    s_add_u32 s34, s34, 16384
    s_add_u32 s35, s35, 16384
    s_sub_u32 s40, s40, 1
    s_cmp_lg_u32 s40, 0
    s_cbranch_scc1 wo_loop
    s_mov_b32 s46, 0xffff0000
    v_lshlrev_b32 v64, 16, v96
    v_and_b32 v65, s46, v96
    v_lshlrev_b32 v66, 16, v97
    v_and_b32 v67, s46, v97
    v_lshlrev_b32 v68, 16, v98
    v_and_b32 v69, s46, v98
    v_lshlrev_b32 v70, 16, v99
    v_and_b32 v71, s46, v99
    v_lshlrev_b32 v72, 16, v100
    v_and_b32 v73, s46, v100
    v_lshlrev_b32 v74, 16, v101
    v_and_b32 v75, s46, v101
    v_lshlrev_b32 v76, 16, v102
    v_and_b32 v77, s46, v102
    v_lshlrev_b32 v78, 16, v103
    v_and_b32 v79, s46, v103
    v_lshlrev_b32 v80, 16, v104
    v_and_b32 v81, s46, v104
    v_lshlrev_b32 v82, 16, v105
    v_and_b32 v83, s46, v105
    v_lshlrev_b32 v84, 16, v106
    v_and_b32 v85, s46, v106
    v_lshlrev_b32 v86, 16, v107
    v_and_b32 v87, s46, v107
    v_lshlrev_b32 v88, 16, v108
    v_and_b32 v89, s46, v108
    v_lshlrev_b32 v90, 16, v109
    v_and_b32 v91, s46, v109
    v_lshlrev_b32 v92, 16, v110
    v_and_b32 v93, s46, v110
    v_lshlrev_b32 v94, 16, v111
    v_and_b32 v95, s46, v111
    v_pk_add_f32 v[32:33], v[32:33], v[64:65]
    v_pk_add_f32 v[34:35], v[34:35], v[66:67]
    v_pk_add_f32 v[36:37], v[36:37], v[68:69]
    v_pk_add_f32 v[38:39], v[38:39], v[70:71]
    v_pk_add_f32 v[40:41], v[40:41], v[72:73]
    v_pk_add_f32 v[42:43], v[42:43], v[74:75]
    v_pk_add_f32 v[44:45], v[44:45], v[76:77]
    v_pk_add_f32 v[46:47], v[46:47], v[78:79]
    v_pk_add_f32 v[48:49], v[48:49], v[80:81]
    v_pk_add_f32 v[50:51], v[50:51], v[82:83]
    v_pk_add_f32 v[52:53], v[52:53], v[84:85]
    v_pk_add_f32 v[54:55], v[54:55], v[86:87]
    v_pk_add_f32 v[56:57], v[56:57], v[88:89]
    v_pk_add_f32 v[58:59], v[58:59], v[90:91]
    v_pk_add_f32 v[60:61], v[60:61], v[92:93]
    v_pk_add_f32 v[62:63], v[62:63], v[94:95]
    v_cvt_pk_bf16_f32 v96, v32, v33
    v_cvt_pk_bf16_f32 v97, v34, v35
    v_cvt_pk_bf16_f32 v98, v36, v37
    v_cvt_pk_bf16_f32 v99, v38, v39
    v_cvt_pk_bf16_f32 v100, v40, v41
    v_cvt_pk_bf16_f32 v101, v42, v43
    v_cvt_pk_bf16_f32 v102, v44, v45
    v_cvt_pk_bf16_f32 v103, v46, v47
    v_cvt_pk_bf16_f32 v104, v48, v49
    v_cvt_pk_bf16_f32 v105, v50, v51
    v_cvt_pk_bf16_f32 v106, v52, v53
    v_cvt_pk_bf16_f32 v107, v54, v55
    v_cvt_pk_bf16_f32 v108, v56, v57
    v_cvt_pk_bf16_f32 v109, v58, v59
    v_cvt_pk_bf16_f32 v110, v60, v61
    v_cvt_pk_bf16_f32 v111, v62, v63
    s_add_u32 s43, s48, s21
    buffer_store_dwordx4 v[96:99], v5, s[28:31], s43 offen offset:0 sc1
    buffer_store_dwordx4 v[100:103], v5, s[28:31], s43 offen offset:1024 sc1
    buffer_store_dwordx4 v[104:107], v5, s[28:31], s43 offen offset:2048 sc1
    buffer_store_dwordx4 v[108:111], v5, s[28:31], s43 offen offset:3072 sc1
    v_mov_b32 v22, 0x3f803f80
    v_mov_b32 v18, 0
    v_mov_b32 v19, 0
    v_dot2_f32_bf16 v18, v96, v22, v18
    v_dot2_f32_bf16 v19, v96, v96, v19
    v_dot2_f32_bf16 v18, v97, v22, v18
    v_dot2_f32_bf16 v19, v97, v97, v19
    v_dot2_f32_bf16 v18, v98, v22, v18
    v_dot2_f32_bf16 v19, v98, v98, v19
    v_dot2_f32_bf16 v18, v99, v22, v18
    v_dot2_f32_bf16 v19, v99, v99, v19
    v_dot2_f32_bf16 v18, v100, v22, v18
    v_dot2_f32_bf16 v19, v100, v100, v19
    v_dot2_f32_bf16 v18, v101, v22, v18
    v_dot2_f32_bf16 v19, v101, v101, v19
    v_dot2_f32_bf16 v18, v102, v22, v18
    v_dot2_f32_bf16 v19, v102, v102, v19
    v_dot2_f32_bf16 v18, v103, v22, v18
    v_dot2_f32_bf16 v19, v103, v103, v19
    v_dot2_f32_bf16 v18, v104, v22, v18
    v_dot2_f32_bf16 v19, v104, v104, v19
    v_dot2_f32_bf16 v18, v105, v22, v18
    v_dot2_f32_bf16 v19, v105, v105, v19
    v_dot2_f32_bf16 v18, v106, v22, v18
    v_dot2_f32_bf16 v19, v106, v106, v19
    v_dot2_f32_bf16 v18, v107, v22, v18
    v_dot2_f32_bf16 v19, v107, v107, v19
    v_dot2_f32_bf16 v18, v108, v22, v18
    v_dot2_f32_bf16 v19, v108, v108, v19
    v_dot2_f32_bf16 v18, v109, v22, v18
    v_dot2_f32_bf16 v19, v109, v109, v19
    v_dot2_f32_bf16 v18, v110, v22, v18
    v_dot2_f32_bf16 v19, v110, v110, v19
    v_dot2_f32_bf16 v18, v111, v22, v18
    v_dot2_f32_bf16 v19, v111, v111, v19
    s_nop 2
    v_mov_b32 v20, v18
    v_mov_b32 v21, v19
    s_nop 0
    v_permlane32_swap_b32 v18, v20
    v_permlane32_swap_b32 v19, v21
    v_pk_add_f32 v[18:19], v[18:19], v[20:21]
    v_and_b32 v16, 31, v1
    v_lshlrev_b32 v16, 4, v16
    s_lshl_b32 s3, s11, 12
    s_bfe_u32 s43, s10, 0x20001
    s_lshl_b32 s43, s43, 10
    s_add_u32 s3, s3, s43
    s_lshr_b32 s43, s10, 3
    s_lshl_b32 s43, s43, 9
    s_add_u32 s3, s3, s43
    s_and_b32 s43, s10, 1
    s_lshl_b32 s43, s43, 3
    s_add_u32 s3, s3, s43
    s_add_u32 s3, s3, s22
    buffer_store_dwordx2 v[18:19], v16, s[28:31], s3 offen sc1
    s_cmp_eq_u32 s96, s98
    s_cbranch_scc1 mega_exit
    s_lshl_b32 s50, s96, 15
    s_lshl_b32 s51, s11, 8
    s_add_u32 s50, s50, s51
    s_add_u32 s50, s50, 71303168
    s_add_u32 s54, s28, s50
    s_addc_u32 s55, s29, 0
    s_mov_b32 s59, 1
    s_waitcnt vmcnt(0)
    s_atomic_add s59, s[54:55], 0
    s_branch mega_next2
wo_idle:
    s_and_b32 s41, s8, 3
    s_lshr_b32 s47, s100, 4
wo_ld:
    s_cmp_ge_u32 s47, 8
    s_cbranch_scc1 wo_ld_end
    s_lshl_b32 s50, s47, 14
    s_add_u32 s50, s50, s101
    s_sub_u32 s51, s50, 147456
    s_cmp_ge_u32 s50, 147456
    s_cselect_b32 s50, s51, s50
    s_lshl_b32 s51, s41, 12
    s_add_u32 m0, s50, s51
    s_lshl_b32 s50, s47, 18
    s_lshl_b32 s51, s41, 16
    s_add_u32 s50, s50, s51
    buffer_load_dwordx4 v6, s[24:27], s50 offen offset:0 lds
    buffer_load_dwordx4 v7, s[24:27], s50 offen offset:1024 lds
    buffer_load_dwordx4 v8, s[24:27], s50 offen offset:2048 lds
    buffer_load_dwordx4 v9, s[24:27], s50 offen offset:3072 lds
    s_add_u32 s47, s47, 1
    s_branch wo_ld
wo_ld_end:
    s_mov_b32 s100, 0
    s_mov_b32 s101, 0
    s_waitcnt vmcnt(28)
    s_barrier
    s_waitcnt vmcnt(24)
    s_barrier
    s_waitcnt vmcnt(20)
    s_barrier
    s_waitcnt vmcnt(16)
    s_barrier
    s_waitcnt vmcnt(12)
    s_barrier
    s_waitcnt vmcnt(8)
    s_barrier
    s_waitcnt vmcnt(4)
    s_barrier
    s_waitcnt vmcnt(0)
    s_barrier
    s_barrier
    s_cmp_eq_u32 s96, s98
    s_cbranch_scc1 mega_exit
    s_branch mega_next
.p2align 6
qkvB_body:
    s_lshl_b32 s20, s99, 22
    s_lshl_b32 s21, s99, 18
    s_add_u32 s21, s21, 58720256
    s_load_dwordx2 s[4:5], s[0:1], 32
    s_load_dwordx2 s[6:7], s[0:1], 64
    v_and_b32 v1, 63, v0
    v_lshrrev_b32 v2, 6, v0
    v_lshlrev_b32 v5, 4, v1
    v_readfirstlane_b32 s8, v2
    s_and_b32 s3, s2, 1
    s_lshl_b32 s3, s3, 3
    s_bfe_u32 s11, s2, 0x30003
    s_add_u32 s9, s3, s11
    s_bfe_u32 s3, s2, 0x20001
    s_lshl_b32 s3, s3, 2
    s_lshr_b32 s11, s2, 6
    s_add_u32 s10, s3, s11
    s_lshl_b32 s3, s9, 2
    s_add_u32 s11, s3, s8
    s_lshl_b32 s22, s11, 16
    s_add_u32 s22, s22, s20
    s_sub_u32 s44, s3, 1
    s_max_i32 s44, s44, 0
    s_lshl_b32 s23, s44, 16
    s_add_u32 s23, s23, s20
    v_lshrrev_b32 v3, 5, v1
    v_and_b32 v4, 15, v0
    v_bfe_u32 v19, v1, 4, 1
    v_lshl_add_u32 v6, v19, 5, v4
    v_lshlrev_b32 v6, 4, v6
    v_lshl_add_u32 v6, v3, 10, v6
    s_waitcnt lgkmcnt(0)
    s_mov_b32 s24, s4
    s_mov_b32 s25, s5
    s_mov_b32 s26, 6291456
    s_mov_b32 s27, 0x00020000
    s_add_u32 s12, s6, s22
    s_addc_u32 s13, s7, 0
    s_mov_b32 s14, 65536
    s_mov_b32 s15, 0x00020000
    s_mov_b32 s28, s6
    s_mov_b32 s29, s7
    s_mov_b32 s30, 75497472
    s_mov_b32 s31, 0x00020000
    s_cmp_eq_u32 s8, 4
    s_cbranch_scc1 qkvB_helper
    s_cmp_gt_u32 s8, 4
    s_cbranch_scc1 qkvB_loader
    s_movk_i32 s40, 4096
    v_lshrrev_b32 v23, 2, v4
    v_lshl_add_u32 v23, v19, 2, v23
    v_lshlrev_b32 v23, 7, v23
    v_and_b32 v22, 3, v4
    v_lshl_add_u32 v23, v22, 3, v23
    v_mul_u32_u24 v22, 6144, v3
    v_add_u32 v23, v23, v22
    v_lshrrev_b32 v22, 3, v4
    v_lshl_add_u32 v22, v22, 1, v19
    v_xor_b32 v24, 0, v22
    v_lshl_add_u32 v11, v24, 5, v23
    v_mov_b32 v7, v11
    v_xor_b32 v24, 1, v22
    v_lshl_add_u32 v12, v24, 5, v23
    v_mov_b32 v8, v12
    v_xor_b32 v24, 2, v22
    v_lshl_add_u32 v13, v24, 5, v23
    v_mov_b32 v9, v13
    v_xor_b32 v24, 3, v22
    v_lshl_add_u32 v14, v24, 5, v23
    v_mov_b32 v10, v14
    v_mov_b32 v32, 0
    v_mov_b32 v33, 0
    v_mov_b32 v34, 0
    v_mov_b32 v35, 0
    v_mov_b32 v36, 0
    v_mov_b32 v37, 0
    v_mov_b32 v38, 0
    v_mov_b32 v39, 0
    v_mov_b32 v40, 0
    v_mov_b32 v41, 0
    v_mov_b32 v42, 0
    v_mov_b32 v43, 0
    v_mov_b32 v44, 0
    v_mov_b32 v45, 0
    v_mov_b32 v46, 0
    v_mov_b32 v47, 0
    v_mov_b32 v48, 0
    v_mov_b32 v49, 0
    v_mov_b32 v50, 0
    v_mov_b32 v51, 0
    v_mov_b32 v52, 0
    v_mov_b32 v53, 0
    v_mov_b32 v54, 0
    v_mov_b32 v55, 0
    v_mov_b32 v56, 0
    v_mov_b32 v57, 0
    v_mov_b32 v58, 0
    v_mov_b32 v59, 0
    v_mov_b32 v60, 0
    v_mov_b32 v61, 0
    v_mov_b32 v62, 0
    v_mov_b32 v63, 0
    v_mov_b32 v64, 0
    v_mov_b32 v65, 0
    v_mov_b32 v66, 0
    v_mov_b32 v67, 0
    v_mov_b32 v68, 0
    v_mov_b32 v69, 0
    v_mov_b32 v70, 0
    v_mov_b32 v71, 0
    v_mov_b32 v72, 0
    v_mov_b32 v73, 0
    v_mov_b32 v74, 0
    v_mov_b32 v75, 0
    v_mov_b32 v76, 0
    v_mov_b32 v77, 0
    v_mov_b32 v78, 0
    v_mov_b32 v79, 0
    v_mov_b32 v80, 0
    v_mov_b32 v81, 0
    v_mov_b32 v82, 0
    v_mov_b32 v83, 0
    v_mov_b32 v84, 0
    v_mov_b32 v85, 0
    v_mov_b32 v86, 0
    v_mov_b32 v87, 0
    v_mov_b32 v88, 0
    v_mov_b32 v89, 0
    v_mov_b32 v90, 0
    v_mov_b32 v91, 0
    v_mov_b32 v92, 0
    v_mov_b32 v93, 0
    v_mov_b32 v94, 0
    v_mov_b32 v95, 0
    v_mov_b32 v96, 0
    v_mov_b32 v97, 0
    v_mov_b32 v98, 0
    v_mov_b32 v99, 0
    v_mov_b32 v100, 0
    v_mov_b32 v101, 0
    v_mov_b32 v102, 0
    v_mov_b32 v103, 0
    v_mov_b32 v104, 0
    v_mov_b32 v105, 0
    v_mov_b32 v106, 0
    v_mov_b32 v107, 0
    v_mov_b32 v108, 0
    v_mov_b32 v109, 0
    v_mov_b32 v110, 0
    v_mov_b32 v111, 0
    v_mov_b32 v112, 0
    v_mov_b32 v113, 0
    v_mov_b32 v114, 0
    v_mov_b32 v115, 0
    v_mov_b32 v116, 0
    v_mov_b32 v117, 0
    v_mov_b32 v118, 0
    v_mov_b32 v119, 0
    v_mov_b32 v120, 0
    v_mov_b32 v121, 0
    v_mov_b32 v122, 0
    v_mov_b32 v123, 0
    v_mov_b32 v124, 0
    v_mov_b32 v125, 0
    v_mov_b32 v126, 0
    v_mov_b32 v127, 0
    s_lshl_b32 s47, s96, 15
    s_add_u32 s47, s47, 71270400
    s_add_u32 s54, s28, s47
    s_addc_u32 s55, s29, 0
    s_mov_b32 s56, 0x40000
    s_lshl_b32 s57, s11, 8
qkvB_poll:
    s_mov_b32 s70, 0
    s_atomic_add s70, s[54:55], s57 offset:0 glc
    s_waitcnt lgkmcnt(0)
    s_cmp_eq_u32 s70, 16
    s_cbranch_scc1 qkvB_ready
    s_sub_u32 s56, s56, 1
    s_cmp_lg_u32 s56, 0
    s_cbranch_scc1 qkvB_poll
qkvB_ready:
    buffer_load_dwordx4 a[0:3], v6, s[12:15], 0 offen offset:0 sc1
    buffer_load_dwordx4 a[4:7], v6, s[12:15], 0 offen offset:256 sc1
    buffer_load_dwordx4 a[8:11], v6, s[12:15], 0 offen offset:2048 sc1
    buffer_load_dwordx4 a[12:15], v6, s[12:15], 0 offen offset:2304 sc1
    buffer_load_dwordx4 a[16:19], v6, s[12:15], s40 offen offset:0 sc1
    buffer_load_dwordx4 a[20:23], v6, s[12:15], s40 offen offset:256 sc1
    s_mov_b32 s32, 6144
    s_mov_b32 s33, 10240
    s_mov_b32 s38, 0
    s_mov_b32 s40, 8
    s_barrier
    ds_read_b64_tr_b16 v[136:137], v7 offset:0
    ds_read_b64_tr_b16 v[138:139], v7 offset:3072
    ds_read_b64_tr_b16 v[140:141], v8 offset:0
    ds_read_b64_tr_b16 v[142:143], v8 offset:3072
    ds_read_b64_tr_b16 v[144:145], v9 offset:0
    ds_read_b64_tr_b16 v[146:147], v9 offset:3072
    ds_read_b64_tr_b16 v[148:149], v10 offset:0
    ds_read_b64_tr_b16 v[150:151], v10 offset:3072
    ds_read_b64_tr_b16 v[152:153], v7 offset:1024
    ds_read_b64_tr_b16 v[154:155], v7 offset:4096
    ds_read_b64_tr_b16 v[156:157], v8 offset:1024
    ds_read_b64_tr_b16 v[158:159], v8 offset:4096
    ds_read_b64_tr_b16 v[160:161], v9 offset:1024
    ds_read_b64_tr_b16 v[162:163], v9 offset:4096
    ds_read_b64_tr_b16 v[164:165], v10 offset:1024
    ds_read_b64_tr_b16 v[166:167], v10 offset:4096
    ds_read_b64_tr_b16 v[168:169], v7 offset:2048
    ds_read_b64_tr_b16 v[170:171], v7 offset:5120
    ds_read_b64_tr_b16 v[172:173], v8 offset:2048
    ds_read_b64_tr_b16 v[174:175], v8 offset:5120
    ds_read_b64_tr_b16 v[176:177], v9 offset:2048
    ds_read_b64_tr_b16 v[178:179], v9 offset:5120
qkvB_loop:
    s_waitcnt vmcnt(4)
    v_mfma_f32_16x16x32_bf16 v[32:35], v[136:139], a[0:3], v[32:35]
    ds_read_b64_tr_b16 v[180:181], v10 offset:2048
    v_mfma_f32_16x16x32_bf16 v[36:39], v[136:139], a[4:7], v[36:39]
    ds_read_b64_tr_b16 v[182:183], v10 offset:5120
    v_mfma_f32_16x16x32_bf16 v[40:43], v[140:143], a[0:3], v[40:43]
    ds_read_b64_tr_b16 v[136:137], v7 offset:12288
    buffer_load_dwordx4 a[24:27], v6, s[12:15], s32 offen offset:0 sc1
    v_mfma_f32_16x16x32_bf16 v[44:47], v[140:143], a[4:7], v[44:47]
    ds_read_b64_tr_b16 v[138:139], v7 offset:15360
    v_mfma_f32_16x16x32_bf16 v[48:51], v[144:147], a[0:3], v[48:51]
    ds_read_b64_tr_b16 v[140:141], v8 offset:12288
    v_mfma_f32_16x16x32_bf16 v[52:55], v[144:147], a[4:7], v[52:55]
    ds_read_b64_tr_b16 v[142:143], v8 offset:15360
    v_mfma_f32_16x16x32_bf16 v[56:59], v[148:151], a[0:3], v[56:59]
    ds_read_b64_tr_b16 v[144:145], v9 offset:12288
    buffer_load_dwordx4 a[28:31], v6, s[12:15], s32 offen offset:256 sc1
    v_mfma_f32_16x16x32_bf16 v[60:63], v[148:151], a[4:7], v[60:63]
    ds_read_b64_tr_b16 v[146:147], v9 offset:15360
    v_mfma_f32_16x16x32_bf16 v[64:67], v[152:155], a[0:3], v[64:67]
    ds_read_b64_tr_b16 v[148:149], v10 offset:12288
    v_mfma_f32_16x16x32_bf16 v[68:71], v[152:155], a[4:7], v[68:71]
    ds_read_b64_tr_b16 v[150:151], v10 offset:15360
    v_mfma_f32_16x16x32_bf16 v[72:75], v[156:159], a[0:3], v[72:75]
    ds_read_b64_tr_b16 v[152:153], v7 offset:13312
    v_mfma_f32_16x16x32_bf16 v[76:79], v[156:159], a[4:7], v[76:79]
    ds_read_b64_tr_b16 v[154:155], v7 offset:16384
    v_mfma_f32_16x16x32_bf16 v[80:83], v[160:163], a[0:3], v[80:83]
    ds_read_b64_tr_b16 v[156:157], v8 offset:13312
    v_mfma_f32_16x16x32_bf16 v[84:87], v[160:163], a[4:7], v[84:87]
    ds_read_b64_tr_b16 v[158:159], v8 offset:16384
    v_mfma_f32_16x16x32_bf16 v[88:91], v[164:167], a[0:3], v[88:91]
    ds_read_b64_tr_b16 v[160:161], v9 offset:13312
    v_mfma_f32_16x16x32_bf16 v[92:95], v[164:167], a[4:7], v[92:95]
    ds_read_b64_tr_b16 v[162:163], v9 offset:16384
    v_mfma_f32_16x16x32_bf16 v[96:99], a[0:3], v[168:171], v[96:99]
    ds_read_b64_tr_b16 v[164:165], v10 offset:13312
    v_mfma_f32_16x16x32_bf16 v[100:103], a[4:7], v[168:171], v[100:103]
    ds_read_b64_tr_b16 v[166:167], v10 offset:16384
    v_mfma_f32_16x16x32_bf16 v[104:107], a[0:3], v[172:175], v[104:107]
    ds_read_b64_tr_b16 v[168:169], v7 offset:14336
    v_mfma_f32_16x16x32_bf16 v[108:111], a[4:7], v[172:175], v[108:111]
    ds_read_b64_tr_b16 v[170:171], v7 offset:17408
    v_mfma_f32_16x16x32_bf16 v[112:115], a[0:3], v[176:179], v[112:115]
    ds_read_b64_tr_b16 v[172:173], v8 offset:14336
    v_mfma_f32_16x16x32_bf16 v[116:119], a[4:7], v[176:179], v[116:119]
    ds_read_b64_tr_b16 v[174:175], v8 offset:17408
    v_mfma_f32_16x16x32_bf16 v[120:123], a[0:3], v[180:183], v[120:123]
    ds_read_b64_tr_b16 v[176:177], v9 offset:14336
    v_mfma_f32_16x16x32_bf16 v[124:127], a[4:7], v[180:183], v[124:127]
    ds_read_b64_tr_b16 v[178:179], v9 offset:17408
    s_waitcnt vmcnt(4)
    v_mfma_f32_16x16x32_bf16 v[32:35], v[136:139], a[8:11], v[32:35]
    ds_read_b64_tr_b16 v[180:181], v10 offset:14336
    v_mfma_f32_16x16x32_bf16 v[36:39], v[136:139], a[12:15], v[36:39]
    ds_read_b64_tr_b16 v[182:183], v10 offset:17408
    s_barrier
    v_mfma_f32_16x16x32_bf16 v[40:43], v[140:143], a[8:11], v[40:43]
    ds_read_b64_tr_b16 v[136:137], v7 offset:24576
    buffer_load_dwordx4 a[0:3], v6, s[12:15], s32 offen offset:2048 sc1
    v_mfma_f32_16x16x32_bf16 v[44:47], v[140:143], a[12:15], v[44:47]
    ds_read_b64_tr_b16 v[138:139], v7 offset:27648
    v_mfma_f32_16x16x32_bf16 v[48:51], v[144:147], a[8:11], v[48:51]
    ds_read_b64_tr_b16 v[140:141], v8 offset:24576
    v_mfma_f32_16x16x32_bf16 v[52:55], v[144:147], a[12:15], v[52:55]
    ds_read_b64_tr_b16 v[142:143], v8 offset:27648
    v_mfma_f32_16x16x32_bf16 v[56:59], v[148:151], a[8:11], v[56:59]
    ds_read_b64_tr_b16 v[144:145], v9 offset:24576
    buffer_load_dwordx4 a[4:7], v6, s[12:15], s32 offen offset:2304 sc1
    v_mfma_f32_16x16x32_bf16 v[60:63], v[148:151], a[12:15], v[60:63]
    ds_read_b64_tr_b16 v[146:147], v9 offset:27648
    v_mfma_f32_16x16x32_bf16 v[64:67], v[152:155], a[8:11], v[64:67]
    ds_read_b64_tr_b16 v[148:149], v10 offset:24576
    v_mfma_f32_16x16x32_bf16 v[68:71], v[152:155], a[12:15], v[68:71]
    ds_read_b64_tr_b16 v[150:151], v10 offset:27648
    v_mfma_f32_16x16x32_bf16 v[72:75], v[156:159], a[8:11], v[72:75]
    ds_read_b64_tr_b16 v[152:153], v7 offset:25600
    v_mfma_f32_16x16x32_bf16 v[76:79], v[156:159], a[12:15], v[76:79]
    ds_read_b64_tr_b16 v[154:155], v7 offset:28672
    v_mfma_f32_16x16x32_bf16 v[80:83], v[160:163], a[8:11], v[80:83]
    ds_read_b64_tr_b16 v[156:157], v8 offset:25600
    v_mfma_f32_16x16x32_bf16 v[84:87], v[160:163], a[12:15], v[84:87]
    ds_read_b64_tr_b16 v[158:159], v8 offset:28672
    v_mfma_f32_16x16x32_bf16 v[88:91], v[164:167], a[8:11], v[88:91]
    ds_read_b64_tr_b16 v[160:161], v9 offset:25600
    v_mfma_f32_16x16x32_bf16 v[92:95], v[164:167], a[12:15], v[92:95]
    ds_read_b64_tr_b16 v[162:163], v9 offset:28672
    v_mfma_f32_16x16x32_bf16 v[96:99], a[8:11], v[168:171], v[96:99]
    ds_read_b64_tr_b16 v[164:165], v10 offset:25600
    v_mfma_f32_16x16x32_bf16 v[100:103], a[12:15], v[168:171], v[100:103]
    ds_read_b64_tr_b16 v[166:167], v10 offset:28672
    v_mfma_f32_16x16x32_bf16 v[104:107], a[8:11], v[172:175], v[104:107]
    ds_read_b64_tr_b16 v[168:169], v7 offset:26624
    v_mfma_f32_16x16x32_bf16 v[108:111], a[12:15], v[172:175], v[108:111]
    ds_read_b64_tr_b16 v[170:171], v7 offset:29696
    v_mfma_f32_16x16x32_bf16 v[112:115], a[8:11], v[176:179], v[112:115]
    ds_read_b64_tr_b16 v[172:173], v8 offset:26624
    v_mfma_f32_16x16x32_bf16 v[116:119], a[12:15], v[176:179], v[116:119]
    ds_read_b64_tr_b16 v[174:175], v8 offset:29696
    v_mfma_f32_16x16x32_bf16 v[120:123], a[8:11], v[180:183], v[120:123]
    ds_read_b64_tr_b16 v[176:177], v9 offset:26624
    v_mfma_f32_16x16x32_bf16 v[124:127], a[12:15], v[180:183], v[124:127]
    ds_read_b64_tr_b16 v[178:179], v9 offset:29696
    s_waitcnt vmcnt(4)
    v_mfma_f32_16x16x32_bf16 v[32:35], v[136:139], a[16:19], v[32:35]
    ds_read_b64_tr_b16 v[180:181], v10 offset:26624
    v_mfma_f32_16x16x32_bf16 v[36:39], v[136:139], a[20:23], v[36:39]
    ds_read_b64_tr_b16 v[182:183], v10 offset:29696
    v_mfma_f32_16x16x32_bf16 v[40:43], v[140:143], a[16:19], v[40:43]
    ds_read_b64_tr_b16 v[136:137], v7 offset:36864
    buffer_load_dwordx4 a[8:11], v6, s[12:15], s33 offen offset:0 sc1
    v_mfma_f32_16x16x32_bf16 v[44:47], v[140:143], a[20:23], v[44:47]
    ds_read_b64_tr_b16 v[138:139], v7 offset:39936
    v_mfma_f32_16x16x32_bf16 v[48:51], v[144:147], a[16:19], v[48:51]
    ds_read_b64_tr_b16 v[140:141], v8 offset:36864
    v_mfma_f32_16x16x32_bf16 v[52:55], v[144:147], a[20:23], v[52:55]
    ds_read_b64_tr_b16 v[142:143], v8 offset:39936
    v_mfma_f32_16x16x32_bf16 v[56:59], v[148:151], a[16:19], v[56:59]
    ds_read_b64_tr_b16 v[144:145], v9 offset:36864
    buffer_load_dwordx4 a[12:15], v6, s[12:15], s33 offen offset:256 sc1
    v_mfma_f32_16x16x32_bf16 v[60:63], v[148:151], a[20:23], v[60:63]
    ds_read_b64_tr_b16 v[146:147], v9 offset:39936
    v_mfma_f32_16x16x32_bf16 v[64:67], v[152:155], a[16:19], v[64:67]
    ds_read_b64_tr_b16 v[148:149], v10 offset:36864
    v_mfma_f32_16x16x32_bf16 v[68:71], v[152:155], a[20:23], v[68:71]
    ds_read_b64_tr_b16 v[150:151], v10 offset:39936
    v_mfma_f32_16x16x32_bf16 v[72:75], v[156:159], a[16:19], v[72:75]
    ds_read_b64_tr_b16 v[152:153], v7 offset:37888
    v_mfma_f32_16x16x32_bf16 v[76:79], v[156:159], a[20:23], v[76:79]
    ds_read_b64_tr_b16 v[154:155], v7 offset:40960
    v_mfma_f32_16x16x32_bf16 v[80:83], v[160:163], a[16:19], v[80:83]
    ds_read_b64_tr_b16 v[156:157], v8 offset:37888
    v_mfma_f32_16x16x32_bf16 v[84:87], v[160:163], a[20:23], v[84:87]
    ds_read_b64_tr_b16 v[158:159], v8 offset:40960
    v_mfma_f32_16x16x32_bf16 v[88:91], v[164:167], a[16:19], v[88:91]
    ds_read_b64_tr_b16 v[160:161], v9 offset:37888
    v_mfma_f32_16x16x32_bf16 v[92:95], v[164:167], a[20:23], v[92:95]
    ds_read_b64_tr_b16 v[162:163], v9 offset:40960
    v_mfma_f32_16x16x32_bf16 v[96:99], a[16:19], v[168:171], v[96:99]
    ds_read_b64_tr_b16 v[164:165], v10 offset:37888
    v_mfma_f32_16x16x32_bf16 v[100:103], a[20:23], v[168:171], v[100:103]
    ds_read_b64_tr_b16 v[166:167], v10 offset:40960
    v_mfma_f32_16x16x32_bf16 v[104:107], a[16:19], v[172:175], v[104:107]
    ds_read_b64_tr_b16 v[168:169], v7 offset:38912
    v_mfma_f32_16x16x32_bf16 v[108:111], a[20:23], v[172:175], v[108:111]
    ds_read_b64_tr_b16 v[170:171], v7 offset:41984
    v_mfma_f32_16x16x32_bf16 v[112:115], a[16:19], v[176:179], v[112:115]
    ds_read_b64_tr_b16 v[172:173], v8 offset:38912
    v_mfma_f32_16x16x32_bf16 v[116:119], a[20:23], v[176:179], v[116:119]
    ds_read_b64_tr_b16 v[174:175], v8 offset:41984
    v_mfma_f32_16x16x32_bf16 v[120:123], a[16:19], v[180:183], v[120:123]
    ds_read_b64_tr_b16 v[176:177], v9 offset:38912
    v_mfma_f32_16x16x32_bf16 v[124:127], a[20:23], v[180:183], v[124:127]
    ds_read_b64_tr_b16 v[178:179], v9 offset:41984
    s_waitcnt vmcnt(4)
    v_mfma_f32_16x16x32_bf16 v[32:35], v[136:139], a[24:27], v[32:35]
    ds_read_b64_tr_b16 v[180:181], v10 offset:38912
    v_mfma_f32_16x16x32_bf16 v[36:39], v[136:139], a[28:31], v[36:39]
    ds_read_b64_tr_b16 v[182:183], v10 offset:41984
    s_barrier
    s_xor_b32 s38, s38, 49152
    v_add_u32 v7, s38, v11
    v_add_u32 v8, s38, v12
    v_add_u32 v9, s38, v13
    v_add_u32 v10, s38, v14
    v_mfma_f32_16x16x32_bf16 v[40:43], v[140:143], a[24:27], v[40:43]
    ds_read_b64_tr_b16 v[136:137], v7 offset:0
    buffer_load_dwordx4 a[16:19], v6, s[12:15], s33 offen offset:2048 sc1
    v_mfma_f32_16x16x32_bf16 v[44:47], v[140:143], a[28:31], v[44:47]
    ds_read_b64_tr_b16 v[138:139], v7 offset:3072
    v_mfma_f32_16x16x32_bf16 v[48:51], v[144:147], a[24:27], v[48:51]
    ds_read_b64_tr_b16 v[140:141], v8 offset:0
    v_mfma_f32_16x16x32_bf16 v[52:55], v[144:147], a[28:31], v[52:55]
    ds_read_b64_tr_b16 v[142:143], v8 offset:3072
    v_mfma_f32_16x16x32_bf16 v[56:59], v[148:151], a[24:27], v[56:59]
    ds_read_b64_tr_b16 v[144:145], v9 offset:0
    buffer_load_dwordx4 a[20:23], v6, s[12:15], s33 offen offset:2304 sc1
    v_mfma_f32_16x16x32_bf16 v[60:63], v[148:151], a[28:31], v[60:63]
    ds_read_b64_tr_b16 v[146:147], v9 offset:3072
    v_mfma_f32_16x16x32_bf16 v[64:67], v[152:155], a[24:27], v[64:67]
    ds_read_b64_tr_b16 v[148:149], v10 offset:0
    v_mfma_f32_16x16x32_bf16 v[68:71], v[152:155], a[28:31], v[68:71]
    ds_read_b64_tr_b16 v[150:151], v10 offset:3072
    v_mfma_f32_16x16x32_bf16 v[72:75], v[156:159], a[24:27], v[72:75]
    ds_read_b64_tr_b16 v[152:153], v7 offset:1024
    v_mfma_f32_16x16x32_bf16 v[76:79], v[156:159], a[28:31], v[76:79]
    ds_read_b64_tr_b16 v[154:155], v7 offset:4096
    v_mfma_f32_16x16x32_bf16 v[80:83], v[160:163], a[24:27], v[80:83]
    ds_read_b64_tr_b16 v[156:157], v8 offset:1024
    v_mfma_f32_16x16x32_bf16 v[84:87], v[160:163], a[28:31], v[84:87]
    ds_read_b64_tr_b16 v[158:159], v8 offset:4096
    v_mfma_f32_16x16x32_bf16 v[88:91], v[164:167], a[24:27], v[88:91]
    ds_read_b64_tr_b16 v[160:161], v9 offset:1024
    v_mfma_f32_16x16x32_bf16 v[92:95], v[164:167], a[28:31], v[92:95]
    ds_read_b64_tr_b16 v[162:163], v9 offset:4096
    v_mfma_f32_16x16x32_bf16 v[96:99], a[24:27], v[168:171], v[96:99]
    ds_read_b64_tr_b16 v[164:165], v10 offset:1024
    v_mfma_f32_16x16x32_bf16 v[100:103], a[28:31], v[168:171], v[100:103]
    ds_read_b64_tr_b16 v[166:167], v10 offset:4096
    v_mfma_f32_16x16x32_bf16 v[104:107], a[24:27], v[172:175], v[104:107]
    ds_read_b64_tr_b16 v[168:169], v7 offset:2048
    v_mfma_f32_16x16x32_bf16 v[108:111], a[28:31], v[172:175], v[108:111]
    ds_read_b64_tr_b16 v[170:171], v7 offset:5120
    v_mfma_f32_16x16x32_bf16 v[112:115], a[24:27], v[176:179], v[112:115]
    ds_read_b64_tr_b16 v[172:173], v8 offset:2048
    v_mfma_f32_16x16x32_bf16 v[116:119], a[28:31], v[176:179], v[116:119]
    ds_read_b64_tr_b16 v[174:175], v8 offset:5120
    v_mfma_f32_16x16x32_bf16 v[120:123], a[24:27], v[180:183], v[120:123]
    ds_read_b64_tr_b16 v[176:177], v9 offset:2048
    v_mfma_f32_16x16x32_bf16 v[124:127], a[28:31], v[180:183], v[124:127]
    ds_read_b64_tr_b16 v[178:179], v9 offset:5120
    s_add_u32 s32, s32, 8192
    s_add_u32 s33, s33, 8192
    s_sub_u32 s40, s40, 1
    s_cmp_lg_u32 s40, 0
    s_cbranch_scc1 qkvB_loop
    s_waitcnt lgkmcnt(0)
    v_lshrrev_b32 v7, 4, v1
    v_lshlrev_b32 v7, 4, v7
    v_add_u32 v7, 98304, v7
    v_lshlrev_b32 v8, 2, v4
    v_add_u32 v8, 98304, v8
    v_lshl_add_u32 v9, v2, 7, v8
    v_lshl_add_u32 v10, v2, 7, v7
    ds_read_b32 v20, v9 offset:1024
    ds_read_b32 v24, v9 offset:1664
    ds_read_b32 v22, v9 offset:1088
    ds_read_b32 v26, v9 offset:1728
    ds_read_b128 v[136:139], v7 offset:0
    ds_read_b128 v[140:143], v7 offset:64
    ds_read_b128 v[144:147], v7 offset:128
    ds_read_b128 v[148:151], v7 offset:192
    ds_read_b128 v[152:155], v7 offset:256
    ds_read_b128 v[156:159], v7 offset:320
    ds_read_b128 v[160:163], v7 offset:384
    ds_read_b128 v[164:167], v7 offset:448
    s_waitcnt lgkmcnt(8)
    ds_read_b128 v[168:171], v10 offset:1024
    ds_read_b128 v[176:179], v10 offset:1664
    v_mul_f32 v28, 0x3e8293ee, v24
    ds_read_b128 v[172:175], v10 offset:1088
    ds_read_b128 v[180:183], v10 offset:1728
    v_mul_f32 v30, 0x3e8293ee, v26
    s_lshl_b32 s3, s10, 18
    s_lshl_b32 s22, s11, 11
    s_add_u32 s3, s3, s22
    s_lshr_b32 s22, s99, 1
    s_mul_i32 s22, s22, 12582912
    s_add_u32 s3, s3, s22
    ds_read_b32 v200, v8 offset:512
    ds_read_b32 v202, v8 offset:576
    ds_read_b32 v204, v8 offset:640
    ds_read_b32 v206, v8 offset:704
    s_waitcnt lgkmcnt(14)
    v_pk_fma_f32 v[32:33], v[20:21], v[136:137], v[32:33] op_sel_hi:[0,1,1] neg_lo:[1,0,0] neg_hi:[1,0,0]
    v_pk_fma_f32 v[34:35], v[20:21], v[138:139], v[34:35] op_sel_hi:[0,1,1] neg_lo:[1,0,0] neg_hi:[1,0,0]
    v_pk_mul_f32 v[32:33], v[28:29], v[32:33] op_sel_hi:[0,1]
    v_pk_mul_f32 v[34:35], v[28:29], v[34:35] op_sel_hi:[0,1]
    v_pk_fma_f32 v[40:41], v[20:21], v[140:141], v[40:41] op_sel_hi:[0,1,1] neg_lo:[1,0,0] neg_hi:[1,0,0]
    v_pk_fma_f32 v[42:43], v[20:21], v[142:143], v[42:43] op_sel_hi:[0,1,1] neg_lo:[1,0,0] neg_hi:[1,0,0]
    v_pk_mul_f32 v[40:41], v[28:29], v[40:41] op_sel_hi:[0,1]
    v_pk_mul_f32 v[42:43], v[28:29], v[42:43] op_sel_hi:[0,1]
    v_pk_fma_f32 v[36:37], v[22:23], v[136:137], v[36:37] op_sel_hi:[0,1,1] neg_lo:[1,0,0] neg_hi:[1,0,0]
    v_pk_fma_f32 v[38:39], v[22:23], v[138:139], v[38:39] op_sel_hi:[0,1,1] neg_lo:[1,0,0] neg_hi:[1,0,0]
    v_pk_mul_f32 v[36:37], v[30:31], v[36:37] op_sel_hi:[0,1]
    v_pk_mul_f32 v[38:39], v[30:31], v[38:39] op_sel_hi:[0,1]
    v_pk_fma_f32 v[44:45], v[22:23], v[140:141], v[44:45] op_sel_hi:[0,1,1] neg_lo:[1,0,0] neg_hi:[1,0,0]
    v_pk_fma_f32 v[46:47], v[22:23], v[142:143], v[46:47] op_sel_hi:[0,1,1] neg_lo:[1,0,0] neg_hi:[1,0,0]
    v_pk_mul_f32 v[44:45], v[30:31], v[44:45] op_sel_hi:[0,1]
    v_pk_mul_f32 v[46:47], v[30:31], v[46:47] op_sel_hi:[0,1]
    v_cvt_pk_bf16_f32 v32, v32, v33
    v_cvt_pk_bf16_f32 v33, v34, v35
    v_cvt_pk_bf16_f32 v34, v40, v41
    v_cvt_pk_bf16_f32 v35, v42, v43
    v_cvt_pk_bf16_f32 v36, v36, v37
    v_cvt_pk_bf16_f32 v37, v38, v39
    v_cvt_pk_bf16_f32 v38, v44, v45
    v_cvt_pk_bf16_f32 v39, v46, v47
    s_add_u32 s22, s3, 16777216
    buffer_store_dwordx4 v[32:35], v6, s[28:31], s22 offen offset:0 sc1
    buffer_store_dwordx4 v[36:39], v6, s[28:31], s22 offen offset:256 sc1
    s_waitcnt lgkmcnt(12)
    v_pk_fma_f32 v[48:49], v[20:21], v[144:145], v[48:49] op_sel_hi:[0,1,1] neg_lo:[1,0,0] neg_hi:[1,0,0]
    v_pk_fma_f32 v[50:51], v[20:21], v[146:147], v[50:51] op_sel_hi:[0,1,1] neg_lo:[1,0,0] neg_hi:[1,0,0]
    v_pk_mul_f32 v[48:49], v[28:29], v[48:49] op_sel_hi:[0,1]
    v_pk_mul_f32 v[50:51], v[28:29], v[50:51] op_sel_hi:[0,1]
    v_pk_fma_f32 v[56:57], v[20:21], v[148:149], v[56:57] op_sel_hi:[0,1,1] neg_lo:[1,0,0] neg_hi:[1,0,0]
    v_pk_fma_f32 v[58:59], v[20:21], v[150:151], v[58:59] op_sel_hi:[0,1,1] neg_lo:[1,0,0] neg_hi:[1,0,0]
    v_pk_mul_f32 v[56:57], v[28:29], v[56:57] op_sel_hi:[0,1]
    v_pk_mul_f32 v[58:59], v[28:29], v[58:59] op_sel_hi:[0,1]
    v_pk_fma_f32 v[52:53], v[22:23], v[144:145], v[52:53] op_sel_hi:[0,1,1] neg_lo:[1,0,0] neg_hi:[1,0,0]
    v_pk_fma_f32 v[54:55], v[22:23], v[146:147], v[54:55] op_sel_hi:[0,1,1] neg_lo:[1,0,0] neg_hi:[1,0,0]
    v_pk_mul_f32 v[52:53], v[30:31], v[52:53] op_sel_hi:[0,1]
    v_pk_mul_f32 v[54:55], v[30:31], v[54:55] op_sel_hi:[0,1]
    v_pk_fma_f32 v[60:61], v[22:23], v[148:149], v[60:61] op_sel_hi:[0,1,1] neg_lo:[1,0,0] neg_hi:[1,0,0]
    v_pk_fma_f32 v[62:63], v[22:23], v[150:151], v[62:63] op_sel_hi:[0,1,1] neg_lo:[1,0,0] neg_hi:[1,0,0]
    v_pk_mul_f32 v[60:61], v[30:31], v[60:61] op_sel_hi:[0,1]
    v_pk_mul_f32 v[62:63], v[30:31], v[62:63] op_sel_hi:[0,1]
    v_cvt_pk_bf16_f32 v48, v48, v49
    v_cvt_pk_bf16_f32 v49, v50, v51
    v_cvt_pk_bf16_f32 v50, v56, v57
    v_cvt_pk_bf16_f32 v51, v58, v59
    v_cvt_pk_bf16_f32 v52, v52, v53
    v_cvt_pk_bf16_f32 v53, v54, v55
    v_cvt_pk_bf16_f32 v54, v60, v61
    v_cvt_pk_bf16_f32 v55, v62, v63
    s_add_u32 s22, s3, 16908288
    buffer_store_dwordx4 v[48:51], v6, s[28:31], s22 offen offset:0 sc1
    buffer_store_dwordx4 v[52:55], v6, s[28:31], s22 offen offset:256 sc1
    s_waitcnt lgkmcnt(10)
    v_pk_fma_f32 v[64:65], v[20:21], v[152:153], v[64:65] op_sel_hi:[0,1,1] neg_lo:[1,0,0] neg_hi:[1,0,0]
    v_pk_fma_f32 v[66:67], v[20:21], v[154:155], v[66:67] op_sel_hi:[0,1,1] neg_lo:[1,0,0] neg_hi:[1,0,0]
    v_pk_mul_f32 v[64:65], v[24:25], v[64:65] op_sel_hi:[0,1]
    v_pk_mul_f32 v[66:67], v[24:25], v[66:67] op_sel_hi:[0,1]
    v_pk_fma_f32 v[72:73], v[20:21], v[156:157], v[72:73] op_sel_hi:[0,1,1] neg_lo:[1,0,0] neg_hi:[1,0,0]
    v_pk_fma_f32 v[74:75], v[20:21], v[158:159], v[74:75] op_sel_hi:[0,1,1] neg_lo:[1,0,0] neg_hi:[1,0,0]
    v_pk_mul_f32 v[72:73], v[24:25], v[72:73] op_sel_hi:[0,1]
    v_pk_mul_f32 v[74:75], v[24:25], v[74:75] op_sel_hi:[0,1]
    v_pk_fma_f32 v[68:69], v[22:23], v[152:153], v[68:69] op_sel_hi:[0,1,1] neg_lo:[1,0,0] neg_hi:[1,0,0]
    v_pk_fma_f32 v[70:71], v[22:23], v[154:155], v[70:71] op_sel_hi:[0,1,1] neg_lo:[1,0,0] neg_hi:[1,0,0]
    v_pk_mul_f32 v[68:69], v[26:27], v[68:69] op_sel_hi:[0,1]
    v_pk_mul_f32 v[70:71], v[26:27], v[70:71] op_sel_hi:[0,1]
    v_pk_fma_f32 v[76:77], v[22:23], v[156:157], v[76:77] op_sel_hi:[0,1,1] neg_lo:[1,0,0] neg_hi:[1,0,0]
    v_pk_fma_f32 v[78:79], v[22:23], v[158:159], v[78:79] op_sel_hi:[0,1,1] neg_lo:[1,0,0] neg_hi:[1,0,0]
    v_pk_mul_f32 v[76:77], v[26:27], v[76:77] op_sel_hi:[0,1]
    v_pk_mul_f32 v[78:79], v[26:27], v[78:79] op_sel_hi:[0,1]
    v_cvt_pk_bf16_f32 v64, v64, v65
    v_cvt_pk_bf16_f32 v65, v66, v67
    v_cvt_pk_bf16_f32 v66, v72, v73
    v_cvt_pk_bf16_f32 v67, v74, v75
    v_cvt_pk_bf16_f32 v68, v68, v69
    v_cvt_pk_bf16_f32 v69, v70, v71
    v_cvt_pk_bf16_f32 v70, v76, v77
    v_cvt_pk_bf16_f32 v71, v78, v79
    s_add_u32 s22, s3, 20971520
    buffer_store_dwordx4 v[64:67], v6, s[28:31], s22 offen offset:0 sc1
    buffer_store_dwordx4 v[68:71], v6, s[28:31], s22 offen offset:256 sc1
    s_waitcnt lgkmcnt(8)
    v_pk_fma_f32 v[80:81], v[20:21], v[160:161], v[80:81] op_sel_hi:[0,1,1] neg_lo:[1,0,0] neg_hi:[1,0,0]
    v_pk_fma_f32 v[82:83], v[20:21], v[162:163], v[82:83] op_sel_hi:[0,1,1] neg_lo:[1,0,0] neg_hi:[1,0,0]
    v_pk_mul_f32 v[80:81], v[24:25], v[80:81] op_sel_hi:[0,1]
    v_pk_mul_f32 v[82:83], v[24:25], v[82:83] op_sel_hi:[0,1]
    v_pk_fma_f32 v[88:89], v[20:21], v[164:165], v[88:89] op_sel_hi:[0,1,1] neg_lo:[1,0,0] neg_hi:[1,0,0]
    v_pk_fma_f32 v[90:91], v[20:21], v[166:167], v[90:91] op_sel_hi:[0,1,1] neg_lo:[1,0,0] neg_hi:[1,0,0]
    v_pk_mul_f32 v[88:89], v[24:25], v[88:89] op_sel_hi:[0,1]
    v_pk_mul_f32 v[90:91], v[24:25], v[90:91] op_sel_hi:[0,1]
    v_pk_fma_f32 v[84:85], v[22:23], v[160:161], v[84:85] op_sel_hi:[0,1,1] neg_lo:[1,0,0] neg_hi:[1,0,0]
    v_pk_fma_f32 v[86:87], v[22:23], v[162:163], v[86:87] op_sel_hi:[0,1,1] neg_lo:[1,0,0] neg_hi:[1,0,0]
    v_pk_mul_f32 v[84:85], v[26:27], v[84:85] op_sel_hi:[0,1]
    v_pk_mul_f32 v[86:87], v[26:27], v[86:87] op_sel_hi:[0,1]
    v_pk_fma_f32 v[92:93], v[22:23], v[164:165], v[92:93] op_sel_hi:[0,1,1] neg_lo:[1,0,0] neg_hi:[1,0,0]
    v_pk_fma_f32 v[94:95], v[22:23], v[166:167], v[94:95] op_sel_hi:[0,1,1] neg_lo:[1,0,0] neg_hi:[1,0,0]
    v_pk_mul_f32 v[92:93], v[26:27], v[92:93] op_sel_hi:[0,1]
    v_pk_mul_f32 v[94:95], v[26:27], v[94:95] op_sel_hi:[0,1]
    v_cvt_pk_bf16_f32 v80, v80, v81
    v_cvt_pk_bf16_f32 v81, v82, v83
    v_cvt_pk_bf16_f32 v82, v88, v89
    v_cvt_pk_bf16_f32 v83, v90, v91
    v_cvt_pk_bf16_f32 v84, v84, v85
    v_cvt_pk_bf16_f32 v85, v86, v87
    v_cvt_pk_bf16_f32 v86, v92, v93
    v_cvt_pk_bf16_f32 v87, v94, v95
    s_add_u32 s22, s3, 21102592
    buffer_store_dwordx4 v[80:83], v6, s[28:31], s22 offen offset:0 sc1
    buffer_store_dwordx4 v[84:87], v6, s[28:31], s22 offen offset:256 sc1
    v_lshl_add_u32 v11, v3, 4, v4
    v_lshl_add_u32 v11, v19, 5, v11
    v_lshlrev_b32 v11, 4, v11
    s_waitcnt lgkmcnt(0)
    v_pk_fma_f32 v[96:97], v[168:169], v[200:201], v[96:97] op_sel_hi:[1,0,1] neg_lo:[1,0,0] neg_hi:[1,0,0]
    v_pk_fma_f32 v[98:99], v[170:171], v[200:201], v[98:99] op_sel_hi:[1,0,1] neg_lo:[1,0,0] neg_hi:[1,0,0]
    v_pk_mul_f32 v[96:97], v[176:177], v[96:97]
    v_pk_mul_f32 v[98:99], v[178:179], v[98:99]
    v_pk_fma_f32 v[104:105], v[168:169], v[202:203], v[104:105] op_sel_hi:[1,0,1] neg_lo:[1,0,0] neg_hi:[1,0,0]
    v_pk_fma_f32 v[106:107], v[170:171], v[202:203], v[106:107] op_sel_hi:[1,0,1] neg_lo:[1,0,0] neg_hi:[1,0,0]
    v_pk_mul_f32 v[104:105], v[176:177], v[104:105]
    v_pk_mul_f32 v[106:107], v[178:179], v[106:107]
    v_pk_fma_f32 v[100:101], v[172:173], v[200:201], v[100:101] op_sel_hi:[1,0,1] neg_lo:[1,0,0] neg_hi:[1,0,0]
    v_pk_fma_f32 v[102:103], v[174:175], v[200:201], v[102:103] op_sel_hi:[1,0,1] neg_lo:[1,0,0] neg_hi:[1,0,0]
    v_pk_mul_f32 v[100:101], v[180:181], v[100:101]
    v_pk_mul_f32 v[102:103], v[182:183], v[102:103]
    v_pk_fma_f32 v[108:109], v[172:173], v[202:203], v[108:109] op_sel_hi:[1,0,1] neg_lo:[1,0,0] neg_hi:[1,0,0]
    v_pk_fma_f32 v[110:111], v[174:175], v[202:203], v[110:111] op_sel_hi:[1,0,1] neg_lo:[1,0,0] neg_hi:[1,0,0]
    v_pk_mul_f32 v[108:109], v[180:181], v[108:109]
    v_pk_mul_f32 v[110:111], v[182:183], v[110:111]
    s_add_u32 s22, s3, 25165824
    v_cvt_pk_bf16_f32 v96, v96, v97
    v_cvt_pk_bf16_f32 v97, v98, v99
    v_cvt_pk_bf16_f32 v98, v104, v105
    v_cvt_pk_bf16_f32 v99, v106, v107
    s_nop 0
    v_permlane32_swap_b32 v96, v98
    v_permlane32_swap_b32 v97, v99
    buffer_store_dwordx4 v[96:99], v11, s[28:31], s22 offen offset:0 sc1
    v_cvt_pk_bf16_f32 v100, v100, v101
    v_cvt_pk_bf16_f32 v101, v102, v103
    v_cvt_pk_bf16_f32 v102, v108, v109
    v_cvt_pk_bf16_f32 v103, v110, v111
    s_nop 0
    v_permlane32_swap_b32 v100, v102
    v_permlane32_swap_b32 v101, v103
    buffer_store_dwordx4 v[100:103], v11, s[28:31], s22 offen offset:1024 sc1
    v_pk_fma_f32 v[112:113], v[168:169], v[204:205], v[112:113] op_sel_hi:[1,0,1] neg_lo:[1,0,0] neg_hi:[1,0,0]
    v_pk_fma_f32 v[114:115], v[170:171], v[204:205], v[114:115] op_sel_hi:[1,0,1] neg_lo:[1,0,0] neg_hi:[1,0,0]
    v_pk_mul_f32 v[112:113], v[176:177], v[112:113]
    v_pk_mul_f32 v[114:115], v[178:179], v[114:115]
    v_pk_fma_f32 v[120:121], v[168:169], v[206:207], v[120:121] op_sel_hi:[1,0,1] neg_lo:[1,0,0] neg_hi:[1,0,0]
    v_pk_fma_f32 v[122:123], v[170:171], v[206:207], v[122:123] op_sel_hi:[1,0,1] neg_lo:[1,0,0] neg_hi:[1,0,0]
    v_pk_mul_f32 v[120:121], v[176:177], v[120:121]
    v_pk_mul_f32 v[122:123], v[178:179], v[122:123]
    v_pk_fma_f32 v[116:117], v[172:173], v[204:205], v[116:117] op_sel_hi:[1,0,1] neg_lo:[1,0,0] neg_hi:[1,0,0]
    v_pk_fma_f32 v[118:119], v[174:175], v[204:205], v[118:119] op_sel_hi:[1,0,1] neg_lo:[1,0,0] neg_hi:[1,0,0]
    v_pk_mul_f32 v[116:117], v[180:181], v[116:117]
    v_pk_mul_f32 v[118:119], v[182:183], v[118:119]
    v_pk_fma_f32 v[124:125], v[172:173], v[206:207], v[124:125] op_sel_hi:[1,0,1] neg_lo:[1,0,0] neg_hi:[1,0,0]
    v_pk_fma_f32 v[126:127], v[174:175], v[206:207], v[126:127] op_sel_hi:[1,0,1] neg_lo:[1,0,0] neg_hi:[1,0,0]
    v_pk_mul_f32 v[124:125], v[180:181], v[124:125]
    v_pk_mul_f32 v[126:127], v[182:183], v[126:127]
    s_add_u32 s22, s3, 25296896
    v_cvt_pk_bf16_f32 v112, v112, v113
    v_cvt_pk_bf16_f32 v113, v114, v115
    v_cvt_pk_bf16_f32 v114, v120, v121
    v_cvt_pk_bf16_f32 v115, v122, v123
    s_nop 0
    v_permlane32_swap_b32 v112, v114
    v_permlane32_swap_b32 v113, v115
    buffer_store_dwordx4 v[112:115], v11, s[28:31], s22 offen offset:0 sc1
    v_cvt_pk_bf16_f32 v116, v116, v117
    v_cvt_pk_bf16_f32 v117, v118, v119
    v_cvt_pk_bf16_f32 v118, v124, v125
    v_cvt_pk_bf16_f32 v119, v126, v127
    s_nop 0
    v_permlane32_swap_b32 v116, v118
    v_permlane32_swap_b32 v117, v119
    buffer_store_dwordx4 v[116:119], v11, s[28:31], s22 offen offset:1024 sc1
    s_lshl_b32 s3, s10, 3
    s_lshr_b32 s22, s11, 3
    s_add_u32 s22, s22, s3
    s_cmp_eq_u32 s96, s98
    s_cbranch_scc1 mega_exit
    s_lshl_b32 s47, s96, 15
    s_lshl_b32 s48, s22, 8
    s_add_u32 s47, s47, s48
    s_add_u32 s47, s47, 71303168
    s_add_u32 s54, s28, s47
    s_addc_u32 s55, s29, 0
    s_mov_b32 s59, 1
    s_waitcnt vmcnt(0)
    s_atomic_add s59, s[54:55], 0
    s_branch mega_next2
qkvB_loader:
    v_lshrrev_b32 v20, 3, v1
    v_mul_u32_u24 v21, 6144, v20
    v_and_b32 v22, 2, v20
    v_lshrrev_b32 v23, 2, v20
    v_or_b32 v22, v22, v23
    v_bfe_u32 v23, v1, 1, 2
    v_xor_b32 v22, v22, v23
    v_lshl_add_u32 v21, v22, 5, v21
    v_and_b32 v22, 1, v1
    v_lshl_add_u32 v21, v22, 4, v21
    s_sub_u32 s3, s8, 5
    s_lshl_b32 s41, s3, 10
    s_lshl_b32 s3, s3, 11
    s_lshl_b32 s22, s10, 7
    s_add_u32 s3, s3, s22
    v_add_u32 v7, s3, v21
    s_mov_b32 s42, 0
    s_add_u32 m0, s41, 0
    s_nop 0
    buffer_load_dwordx4 v7, s[24:27], s42 offen lds
    s_add_u32 s42, s42, 49152
    s_add_u32 m0, s41, 3072
    s_nop 0
    buffer_load_dwordx4 v7, s[24:27], s42 offen lds
    s_add_u32 s42, s42, 49152
    s_add_u32 m0, s41, 6144
    s_nop 0
    buffer_load_dwordx4 v7, s[24:27], s42 offen lds
    s_add_u32 s42, s42, 49152
    s_add_u32 m0, s41, 9216
    s_nop 0
    buffer_load_dwordx4 v7, s[24:27], s42 offen lds
    s_add_u32 s42, s42, 49152
    s_add_u32 m0, s41, 12288
    s_nop 0
    buffer_load_dwordx4 v7, s[24:27], s42 offen lds
    s_add_u32 s42, s42, 49152
    s_add_u32 m0, s41, 15360
    s_nop 0
    buffer_load_dwordx4 v7, s[24:27], s42 offen lds
    s_add_u32 s42, s42, 49152
    s_add_u32 m0, s41, 18432
    s_nop 0
    buffer_load_dwordx4 v7, s[24:27], s42 offen lds
    s_add_u32 s42, s42, 49152
    s_add_u32 m0, s41, 21504
    s_nop 0
    buffer_load_dwordx4 v7, s[24:27], s42 offen lds
    s_add_u32 s42, s42, 49152
    s_add_u32 m0, s41, 24576
    s_nop 0
    buffer_load_dwordx4 v7, s[24:27], s42 offen lds
    s_add_u32 s42, s42, 49152
    s_add_u32 m0, s41, 27648
    s_nop 0
    buffer_load_dwordx4 v7, s[24:27], s42 offen lds
    s_add_u32 s42, s42, 49152
    s_add_u32 m0, s41, 30720
    s_nop 0
    buffer_load_dwordx4 v7, s[24:27], s42 offen lds
    s_add_u32 s42, s42, 49152
    s_add_u32 m0, s41, 33792
    s_nop 0
    buffer_load_dwordx4 v7, s[24:27], s42 offen lds
    s_add_u32 s42, s42, 49152
    s_add_u32 m0, s41, 36864
    s_nop 0
    buffer_load_dwordx4 v7, s[24:27], s42 offen lds
    s_add_u32 s42, s42, 49152
    s_add_u32 m0, s41, 39936
    s_nop 0
    buffer_load_dwordx4 v7, s[24:27], s42 offen lds
    s_add_u32 s42, s42, 49152
    s_add_u32 m0, s41, 43008
    s_nop 0
    buffer_load_dwordx4 v7, s[24:27], s42 offen lds
    s_add_u32 s42, s42, 49152
    s_add_u32 m0, s41, 46080
    s_nop 0
    buffer_load_dwordx4 v7, s[24:27], s42 offen lds
    s_add_u32 s42, s42, 49152
    s_add_u32 m0, s41, 49152
    s_nop 0
    buffer_load_dwordx4 v7, s[24:27], s42 offen lds
    s_add_u32 s42, s42, 49152
    s_add_u32 m0, s41, 52224
    s_nop 0
    buffer_load_dwordx4 v7, s[24:27], s42 offen lds
    s_add_u32 s42, s42, 49152
    s_add_u32 m0, s41, 55296
    s_nop 0
    buffer_load_dwordx4 v7, s[24:27], s42 offen lds
    s_add_u32 s42, s42, 49152
    s_add_u32 m0, s41, 58368
    s_nop 0
    buffer_load_dwordx4 v7, s[24:27], s42 offen lds
    s_add_u32 s42, s42, 49152
    s_add_u32 m0, s41, 61440
    s_nop 0
    buffer_load_dwordx4 v7, s[24:27], s42 offen lds
    s_add_u32 s42, s42, 49152
    s_add_u32 m0, s41, 64512
    s_nop 0
    buffer_load_dwordx4 v7, s[24:27], s42 offen lds
    s_add_u32 s42, s42, 49152
    s_add_u32 m0, s41, 67584
    s_nop 0
    buffer_load_dwordx4 v7, s[24:27], s42 offen lds
    s_add_u32 s42, s42, 49152
    s_add_u32 m0, s41, 70656
    s_nop 0
    buffer_load_dwordx4 v7, s[24:27], s42 offen lds
    s_add_u32 s42, s42, 49152
    s_waitcnt vmcnt(16)
    s_barrier
    s_mov_b32 s40, 3
qkvB_lloop:
    s_waitcnt vmcnt(8)
    s_barrier
    s_add_u32 m0, s41, 73728
    s_nop 0
    buffer_load_dwordx4 v7, s[24:27], s42 offen lds
    s_add_u32 s42, s42, 49152
    s_add_u32 m0, s41, 76800
    s_nop 0
    buffer_load_dwordx4 v7, s[24:27], s42 offen lds
    s_add_u32 s42, s42, 49152
    s_add_u32 m0, s41, 79872
    s_nop 0
    buffer_load_dwordx4 v7, s[24:27], s42 offen lds
    s_add_u32 s42, s42, 49152
    s_add_u32 m0, s41, 82944
    s_nop 0
    buffer_load_dwordx4 v7, s[24:27], s42 offen lds
    s_add_u32 s42, s42, 49152
    s_add_u32 m0, s41, 86016
    s_nop 0
    buffer_load_dwordx4 v7, s[24:27], s42 offen lds
    s_add_u32 s42, s42, 49152
    s_add_u32 m0, s41, 89088
    s_nop 0
    buffer_load_dwordx4 v7, s[24:27], s42 offen lds
    s_add_u32 s42, s42, 49152
    s_add_u32 m0, s41, 92160
    s_nop 0
    buffer_load_dwordx4 v7, s[24:27], s42 offen lds
    s_add_u32 s42, s42, 49152
    s_add_u32 m0, s41, 95232
    s_nop 0
    buffer_load_dwordx4 v7, s[24:27], s42 offen lds
    s_add_u32 s42, s42, 49152
    s_waitcnt vmcnt(8)
    s_barrier
    s_add_u32 m0, s41, 0
    s_nop 0
    buffer_load_dwordx4 v7, s[24:27], s42 offen lds
    s_add_u32 s42, s42, 49152
    s_add_u32 m0, s41, 3072
    s_nop 0
    buffer_load_dwordx4 v7, s[24:27], s42 offen lds
    s_add_u32 s42, s42, 49152
    s_add_u32 m0, s41, 6144
    s_nop 0
    buffer_load_dwordx4 v7, s[24:27], s42 offen lds
    s_add_u32 s42, s42, 49152
    s_add_u32 m0, s41, 9216
    s_nop 0
    buffer_load_dwordx4 v7, s[24:27], s42 offen lds
    s_add_u32 s42, s42, 49152
    s_add_u32 m0, s41, 12288
    s_nop 0
    buffer_load_dwordx4 v7, s[24:27], s42 offen lds
    s_add_u32 s42, s42, 49152
    s_add_u32 m0, s41, 15360
    s_nop 0
    buffer_load_dwordx4 v7, s[24:27], s42 offen lds
    s_add_u32 s42, s42, 49152
    s_add_u32 m0, s41, 18432
    s_nop 0
    buffer_load_dwordx4 v7, s[24:27], s42 offen lds
    s_add_u32 s42, s42, 49152
    s_add_u32 m0, s41, 21504
    s_nop 0
    buffer_load_dwordx4 v7, s[24:27], s42 offen lds
    s_add_u32 s42, s42, 49152
    s_waitcnt vmcnt(8)
    s_barrier
    s_add_u32 m0, s41, 24576
    s_nop 0
    buffer_load_dwordx4 v7, s[24:27], s42 offen lds
    s_add_u32 s42, s42, 49152
    s_add_u32 m0, s41, 27648
    s_nop 0
    buffer_load_dwordx4 v7, s[24:27], s42 offen lds
    s_add_u32 s42, s42, 49152
    s_add_u32 m0, s41, 30720
    s_nop 0
    buffer_load_dwordx4 v7, s[24:27], s42 offen lds
    s_add_u32 s42, s42, 49152
    s_add_u32 m0, s41, 33792
    s_nop 0
    buffer_load_dwordx4 v7, s[24:27], s42 offen lds
    s_add_u32 s42, s42, 49152
    s_add_u32 m0, s41, 36864
    s_nop 0
    buffer_load_dwordx4 v7, s[24:27], s42 offen lds
    s_add_u32 s42, s42, 49152
    s_add_u32 m0, s41, 39936
    s_nop 0
    buffer_load_dwordx4 v7, s[24:27], s42 offen lds
    s_add_u32 s42, s42, 49152
    s_add_u32 m0, s41, 43008
    s_nop 0
    buffer_load_dwordx4 v7, s[24:27], s42 offen lds
    s_add_u32 s42, s42, 49152
    s_add_u32 m0, s41, 46080
    s_nop 0
    buffer_load_dwordx4 v7, s[24:27], s42 offen lds
    s_add_u32 s42, s42, 49152
    s_waitcnt vmcnt(8)
    s_barrier
    s_add_u32 m0, s41, 49152
    s_nop 0
    buffer_load_dwordx4 v7, s[24:27], s42 offen lds
    s_add_u32 s42, s42, 49152
    s_add_u32 m0, s41, 52224
    s_nop 0
    buffer_load_dwordx4 v7, s[24:27], s42 offen lds
    s_add_u32 s42, s42, 49152
    s_add_u32 m0, s41, 55296
    s_nop 0
    buffer_load_dwordx4 v7, s[24:27], s42 offen lds
    s_add_u32 s42, s42, 49152
    s_add_u32 m0, s41, 58368
    s_nop 0
    buffer_load_dwordx4 v7, s[24:27], s42 offen lds
    s_add_u32 s42, s42, 49152
    s_add_u32 m0, s41, 61440
    s_nop 0
    buffer_load_dwordx4 v7, s[24:27], s42 offen lds
    s_add_u32 s42, s42, 49152
    s_add_u32 m0, s41, 64512
    s_nop 0
    buffer_load_dwordx4 v7, s[24:27], s42 offen lds
    s_add_u32 s42, s42, 49152
    s_add_u32 m0, s41, 67584
    s_nop 0
    buffer_load_dwordx4 v7, s[24:27], s42 offen lds
    s_add_u32 s42, s42, 49152
    s_add_u32 m0, s41, 70656
    s_nop 0
    buffer_load_dwordx4 v7, s[24:27], s42 offen lds
    s_add_u32 s42, s42, 49152
    s_sub_u32 s40, s40, 1
    s_cmp_lg_u32 s40, 0
    s_cbranch_scc1 qkvB_lloop
    s_waitcnt vmcnt(8)
    s_barrier
    s_add_u32 m0, s41, 73728
    s_nop 0
    buffer_load_dwordx4 v7, s[24:27], s42 offen lds
    s_add_u32 s42, s42, 49152
    s_add_u32 m0, s41, 76800
    s_nop 0
    buffer_load_dwordx4 v7, s[24:27], s42 offen lds
    s_add_u32 s42, s42, 49152
    s_add_u32 m0, s41, 79872
    s_nop 0
    buffer_load_dwordx4 v7, s[24:27], s42 offen lds
    s_add_u32 s42, s42, 49152
    s_add_u32 m0, s41, 82944
    s_nop 0
    buffer_load_dwordx4 v7, s[24:27], s42 offen lds
    s_add_u32 s42, s42, 49152
    s_add_u32 m0, s41, 86016
    s_nop 0
    buffer_load_dwordx4 v7, s[24:27], s42 offen lds
    s_add_u32 s42, s42, 49152
    s_add_u32 m0, s41, 89088
    s_nop 0
    buffer_load_dwordx4 v7, s[24:27], s42 offen lds
    s_add_u32 s42, s42, 49152
    s_add_u32 m0, s41, 92160
    s_nop 0
    buffer_load_dwordx4 v7, s[24:27], s42 offen lds
    s_add_u32 s42, s42, 49152
    s_add_u32 m0, s41, 95232
    s_nop 0
    buffer_load_dwordx4 v7, s[24:27], s42 offen lds
    s_add_u32 s42, s42, 49152
qkvB_tail:
    s_waitcnt vmcnt(8)
    s_barrier
    s_waitcnt vmcnt(0)
    s_barrier
    s_barrier
    s_cmp_eq_u32 s96, s98
    s_cbranch_scc1 mega_exit
    s_branch mega_next
qkvB_helper:
    s_barrier
    s_lshl_b32 s23, s9, 14
    s_add_u32 s23, s23, s21
    buffer_load_dwordx4 v[32:35], v5, s[28:31], s23 offen offset:0 sc1
    buffer_load_dwordx4 v[36:39], v5, s[28:31], s23 offen offset:1024 sc1
    buffer_load_dwordx4 v[40:43], v5, s[28:31], s23 offen offset:2048 sc1
    buffer_load_dwordx4 v[44:47], v5, s[28:31], s23 offen offset:3072 sc1
    s_add_u32 s23, s23, 4096
    buffer_load_dwordx4 v[48:51], v5, s[28:31], s23 offen offset:0 sc1
    buffer_load_dwordx4 v[52:55], v5, s[28:31], s23 offen offset:1024 sc1
    buffer_load_dwordx4 v[56:59], v5, s[28:31], s23 offen offset:2048 sc1
    buffer_load_dwordx4 v[60:63], v5, s[28:31], s23 offen offset:3072 sc1
    s_add_u32 s23, s23, 4096
    s_barrier
    buffer_load_dwordx4 v[64:67], v5, s[28:31], s23 offen offset:0 sc1
    buffer_load_dwordx4 v[68:71], v5, s[28:31], s23 offen offset:1024 sc1
    buffer_load_dwordx4 v[72:75], v5, s[28:31], s23 offen offset:2048 sc1
    buffer_load_dwordx4 v[76:79], v5, s[28:31], s23 offen offset:3072 sc1
    s_add_u32 s23, s23, 4096
    buffer_load_dwordx4 v[80:83], v5, s[28:31], s23 offen offset:0 sc1
    buffer_load_dwordx4 v[84:87], v5, s[28:31], s23 offen offset:1024 sc1
    buffer_load_dwordx4 v[88:91], v5, s[28:31], s23 offen offset:2048 sc1
    buffer_load_dwordx4 v[92:95], v5, s[28:31], s23 offen offset:3072 sc1
    s_barrier
    v_lshrrev_b32 v20, 4, v1
    v_min_u32 v20, 2, v20
    v_lshlrev_b32 v20, 7, v20
    v_add_u32 v20, v20, v4
    s_lshr_b32 s22, s10, 1
    s_lshl_b32 s22, s22, 4
    v_add_u32 v20, s22, v20
    v_lshlrev_b32 v20, 6, v20
    v_mov_b32 v21, 24576
    v_cmp_lt_u32 vcc, 47, v1
    s_nop 1
    v_cndmask_b32 v20, v20, v21, vcc
    s_mov_b32 s47, 68706304
    s_mov_b32 s48, 0x40000
qkvB_h2_poll:
    buffer_load_dwordx2 v[208:209], v20, s[28:31], s47 offen sc1
    s_waitcnt vmcnt(0)
    v_cmp_ne_u64 vcc, s[60:61], v[208:209]
    s_nop 4
    s_cbranch_vccz qkvB_h2_ready
    s_sub_u32 s48, s48, 1
    s_cmp_lg_u32 s48, 0
    s_cbranch_scc1 qkvB_h2_poll
qkvB_h2_ready:
    s_lshl_b32 s22, s10, 10
    s_add_u32 s23, s22, 59965440
    buffer_load_dwordx4 v[112:115], v5, s[28:31], s23 offen sc1
    s_add_u32 s23, s22, 60014592
    buffer_load_dwordx4 v[116:119], v5, s[28:31], s23 offen sc1
    s_add_u32 s23, s22, 60063744
    buffer_load_dwordx4 v[120:123], v5, s[28:31], s23 offen sc1
    s_add_u32 s23, s22, 60112896
    buffer_load_dwordx4 v[124:127], v5, s[28:31], s23 offen sc1
    s_barrier
    s_add_u32 s23, s22, 59981824
    buffer_load_dwordx4 v[128:131], v5, s[28:31], s23 offen sc1
    s_add_u32 s23, s22, 60030976
    buffer_load_dwordx4 v[132:135], v5, s[28:31], s23 offen sc1
    s_add_u32 s23, s22, 60080128
    buffer_load_dwordx4 v[136:139], v5, s[28:31], s23 offen sc1
    s_add_u32 s23, s22, 60129280
    buffer_load_dwordx4 v[140:143], v5, s[28:31], s23 offen sc1
    s_add_u32 s23, s22, 59998208
    buffer_load_dwordx4 v[144:147], v5, s[28:31], s23 offen sc1
    s_add_u32 s23, s22, 60047360
    buffer_load_dwordx4 v[148:151], v5, s[28:31], s23 offen sc1
    s_add_u32 s23, s22, 60096512
    buffer_load_dwordx4 v[152:155], v5, s[28:31], s23 offen sc1
    s_add_u32 s23, s22, 60145664
    buffer_load_dwordx4 v[156:159], v5, s[28:31], s23 offen sc1
    s_barrier
    v_and_b32 v24, 31, v1
    v_lshlrev_b32 v24, 2, v24
    v_add_u32 v24, 98304, v24
    v_pk_add_f32 v[20:21], v[32:33], v[34:35]
    v_pk_add_f32 v[20:21], v[20:21], v[36:37]
    v_pk_add_f32 v[20:21], v[20:21], v[38:39]
    v_pk_add_f32 v[20:21], v[20:21], v[40:41]
    v_pk_add_f32 v[20:21], v[20:21], v[42:43]
    v_pk_add_f32 v[20:21], v[20:21], v[44:45]
    v_pk_add_f32 v[20:21], v[20:21], v[46:47]
    v_mov_b32 v22, v20
    v_mov_b32 v23, v21
    s_nop 0
    v_permlane32_swap_b32 v20, v22
    v_permlane32_swap_b32 v21, v23
    v_pk_add_f32 v[20:21], v[20:21], v[22:23]
    v_mul_f32 v32, 0x3a800000, v20
    v_mul_f32 v21, 0x3a800000, v21
    v_fma_f32 v21, -v32, v32, v21
    v_max_f32 v21, 0, v21
    v_add_f32 v21, 0x3727c5ac, v21
    v_rsq_f32 v33, v21
    ds_write_b32 v24, v32 offset:1024
    ds_write_b32 v24, v33 offset:1664
    v_pk_add_f32 v[20:21], v[48:49], v[50:51]
    v_pk_add_f32 v[20:21], v[20:21], v[52:53]
    v_pk_add_f32 v[20:21], v[20:21], v[54:55]
    v_pk_add_f32 v[20:21], v[20:21], v[56:57]
    v_pk_add_f32 v[20:21], v[20:21], v[58:59]
    v_pk_add_f32 v[20:21], v[20:21], v[60:61]
    v_pk_add_f32 v[20:21], v[20:21], v[62:63]
    v_mov_b32 v22, v20
    v_mov_b32 v23, v21
    s_nop 0
    v_permlane32_swap_b32 v20, v22
    v_permlane32_swap_b32 v21, v23
    v_pk_add_f32 v[20:21], v[20:21], v[22:23]
    v_mul_f32 v48, 0x3a800000, v20
    v_mul_f32 v21, 0x3a800000, v21
    v_fma_f32 v21, -v48, v48, v21
    v_max_f32 v21, 0, v21
    v_add_f32 v21, 0x3727c5ac, v21
    v_rsq_f32 v49, v21
    ds_write_b32 v24, v48 offset:1152
    ds_write_b32 v24, v49 offset:1792
    s_barrier
    v_pk_add_f32 v[20:21], v[64:65], v[66:67]
    v_pk_add_f32 v[20:21], v[20:21], v[68:69]
    v_pk_add_f32 v[20:21], v[20:21], v[70:71]
    v_pk_add_f32 v[20:21], v[20:21], v[72:73]
    v_pk_add_f32 v[20:21], v[20:21], v[74:75]
    v_pk_add_f32 v[20:21], v[20:21], v[76:77]
    v_pk_add_f32 v[20:21], v[20:21], v[78:79]
    v_mov_b32 v22, v20
    v_mov_b32 v23, v21
    s_nop 0
    v_permlane32_swap_b32 v20, v22
    v_permlane32_swap_b32 v21, v23
    v_pk_add_f32 v[20:21], v[20:21], v[22:23]
    v_mul_f32 v64, 0x3a800000, v20
    v_mul_f32 v21, 0x3a800000, v21
    v_fma_f32 v21, -v64, v64, v21
    v_max_f32 v21, 0, v21
    v_add_f32 v21, 0x3727c5ac, v21
    v_rsq_f32 v65, v21
    ds_write_b32 v24, v64 offset:1280
    ds_write_b32 v24, v65 offset:1920
    v_pk_add_f32 v[20:21], v[80:81], v[82:83]
    v_pk_add_f32 v[20:21], v[20:21], v[84:85]
    v_pk_add_f32 v[20:21], v[20:21], v[86:87]
    v_pk_add_f32 v[20:21], v[20:21], v[88:89]
    v_pk_add_f32 v[20:21], v[20:21], v[90:91]
    v_pk_add_f32 v[20:21], v[20:21], v[92:93]
    v_pk_add_f32 v[20:21], v[20:21], v[94:95]
    v_mov_b32 v22, v20
    v_mov_b32 v23, v21
    s_nop 0
    v_permlane32_swap_b32 v20, v22
    v_permlane32_swap_b32 v21, v23
    v_pk_add_f32 v[20:21], v[20:21], v[22:23]
    v_mul_f32 v80, 0x3a800000, v20
    v_mul_f32 v21, 0x3a800000, v21
    v_fma_f32 v21, -v80, v80, v21
    v_max_f32 v21, 0, v21
    v_add_f32 v21, 0x3727c5ac, v21
    v_rsq_f32 v81, v21
    ds_write_b32 v24, v80 offset:1408
    ds_write_b32 v24, v81 offset:2048
    s_barrier
    v_lshlrev_b32 v24, 2, v1
    v_add_u32 v24, 98304, v24
    s_waitcnt vmcnt(8)
    v_pk_add_f32 v[112:113], v[112:113], v[114:115]
    v_pk_add_f32 v[112:113], v[112:113], v[116:117]
    v_pk_add_f32 v[112:113], v[112:113], v[118:119]
    v_pk_add_f32 v[112:113], v[112:113], v[120:121]
    v_pk_add_f32 v[112:113], v[112:113], v[122:123]
    v_pk_add_f32 v[112:113], v[112:113], v[124:125]
    v_pk_add_f32 v[112:113], v[112:113], v[126:127]
    v_add_f32 v112, v112, v113
    ds_write_b32 v24, v112 offset:0
    s_waitcnt vmcnt(4)
    v_pk_add_f32 v[128:129], v[128:129], v[130:131]
    v_pk_add_f32 v[128:129], v[128:129], v[132:133]
    v_pk_add_f32 v[128:129], v[128:129], v[134:135]
    v_pk_add_f32 v[128:129], v[128:129], v[136:137]
    v_pk_add_f32 v[128:129], v[128:129], v[138:139]
    v_pk_add_f32 v[128:129], v[128:129], v[140:141]
    v_pk_add_f32 v[128:129], v[128:129], v[142:143]
    v_add_f32 v128, v128, v129
    ds_write_b32 v24, v128 offset:256
    s_waitcnt vmcnt(0)
    v_pk_add_f32 v[144:145], v[144:145], v[146:147]
    v_pk_add_f32 v[144:145], v[144:145], v[148:149]
    v_pk_add_f32 v[144:145], v[144:145], v[150:151]
    v_pk_add_f32 v[144:145], v[144:145], v[152:153]
    v_pk_add_f32 v[144:145], v[144:145], v[154:155]
    v_pk_add_f32 v[144:145], v[144:145], v[156:157]
    v_pk_add_f32 v[144:145], v[144:145], v[158:159]
    v_add_f32 v144, v144, v145
    ds_write_b32 v24, v144 offset:512
    s_waitcnt lgkmcnt(0)
    s_barrier
    s_barrier
    s_barrier
    s_barrier
    s_barrier
    s_barrier
    s_barrier
    s_branch qkvB_tail
.p2align 6
attn_body:
    s_load_dwordx2 s[6:7], s[0:1], 64
    v_and_b32 v1, 63, v0
    v_lshrrev_b32 v2, 6, v0
    v_lshlrev_b32 v4, 4, v1
    v_readfirstlane_b32 s8, v2
    s_and_b32 s3, s2, 7
    s_lshl_b32 s3, s3, 2
    s_bfe_u32 s4, s2, 0x20003
    s_add_u32 s9, s3, s4
    s_lshr_b32 s10, s2, 5
    s_lshl_b32 s3, s10, 3
    s_and_b32 s4, s8, 3
    s_lshl_b32 s4, s4, 1
    s_add_u32 s11, s3, s4
    s_lshr_b32 s37, s8, 2
    v_lshl_add_u32 v6, v2, 10, v4
    s_lshl_b32 s35, s8, 10
    s_load_dwordx2 s[44:45], s[0:1], 40
    s_bfe_u32 s40, s2, 0x10002
    s_lshl_b32 s40, s40, 3
    s_lshr_b32 s41, s2, 5
    s_add_u32 s40, s40, s41
    s_lshl_b32 s40, s40, 7
    v_lshrrev_b32 v8, 3, v1
    v_lshlrev_b32 v9, 11, v8
    v_lshrrev_b32 v10, 2, v1
    v_lshrrev_b32 v11, 4, v1
    v_xor_b32 v10, v10, v11
    v_and_b32 v10, 1, v10
    v_lshl_add_u32 v9, v10, 6, v9
    v_and_b32 v10, 3, v1
    v_lshl_add_u32 v9, v10, 4, v9
    v_add_u32 v3, s40, v9
    s_lshl_b32 s3, s9, 17
    s_lshr_b32 s4, s99, 1
    s_mul_i32 s4, s4, 12582912
    s_add_u32 s3, s3, s4
    s_add_u32 s4, s3, 20971520
    s_add_u32 s5, s3, 25165824
    s_lshl_b32 s20, s10, 14
    s_add_u32 s20, s20, s3
    s_add_u32 s20, s20, 16777216
    s_mov_b32 s36, 0
    s_lshl_b32 s3, s37, 12
    v_add_u32 v5, s3, v4
    s_waitcnt lgkmcnt(0)
    s_mov_b32 s24, s44
    s_mov_b32 s25, s45
    s_mov_b32 s26, 2097152
    s_mov_b32 s27, 0x00020000
    s_add_u32 s12, s6, s4
    s_addc_u32 s13, s7, 0
    s_mov_b32 s14, 131072
    s_mov_b32 s15, 0x00020000
    s_add_u32 s16, s6, s5
    s_addc_u32 s17, s7, 0
    s_mov_b32 s18, 131072
    s_mov_b32 s19, 0x00020000
    s_mov_b32 s28, s6
    s_mov_b32 s29, s7
    s_mov_b32 s30, 75497472
    s_mov_b32 s31, 0x00020000
    s_lshr_b32 s49, s9, 1
    s_lshl_b32 s49, s49, 3
    s_add_u32 s3, s49, s10
    s_lshl_b32 s38, s96, 15
    s_add_u32 s38, s38, 71270400
    s_add_u32 s54, s28, s38
    s_addc_u32 s55, s29, 0
    s_mov_b32 s56, 0x40000
    s_lshl_b32 s57, s3, 8
attn_poll:
    s_mov_b32 s70, 0
    s_atomic_add s70, s[54:55], s57 offset:0 glc
    s_waitcnt lgkmcnt(0)
    s_cmp_eq_u32 s70, 8
    s_cbranch_scc1 attn_ready
    s_sub_u32 s56, s56, 1
    s_cmp_lg_u32 s56, 0
    s_cbranch_scc1 attn_poll
attn_ready:
    s_mov_b32 s46, s8
    s_lshl_b32 s48, s10, 14
attn_restart:
    s_mov_b32 m0, s35
    s_nop 0
    buffer_load_dwordx4 v6, s[12:15], s48 offen sc1 lds
    s_add_u32 m0, s35, 49152
    s_nop 0
    buffer_load_dwordx4 v6, s[28:31], s20 offen sc1 lds
    s_add_u32 m0, s35, 57344
    s_add_u32 s3, s20, 8192
    buffer_load_dwordx4 v6, s[28:31], s3 offen sc1 lds
    s_add_u32 m0, s35, 8192
    s_nop 0
    buffer_load_dwordx4 v6, s[16:19], s48 offen sc1 lds
    s_add_u32 s32, s48, 8192
    s_add_u32 m0, s35, 16384
    s_nop 0
    buffer_load_dwordx4 v6, s[12:15], s32 offen sc1 lds
    s_add_u32 m0, m0, 8192
    s_nop 0
    buffer_load_dwordx4 v6, s[16:19], s32 offen sc1 lds
    s_lshl_b32 s42, s8, 14
    s_add_u32 s43, s35, 65536
    s_cmp_eq_u32 s96, s98
    s_cselect_b32 s43, 163840, s43
    s_cselect_b32 s100, 0, 80
    s_cselect_b32 s101, 0, 65536
    v_and_b32 v8, 15, v1
    v_bfe_u32 v9, v1, 4, 1
    v_cmp_eq_u32 vcc, v8, v9
    v_mov_b32 v10, 0x3f803f80
    s_nop 0
    v_cndmask_b32 v184, 0, v10, vcc
    v_cndmask_b32 v185, 0, v10, vcc
    v_cndmask_b32 v186, 0, v10, vcc
    v_cndmask_b32 v187, 0, v10, vcc
    v_mov_b32 v144, 0
    v_mov_b32 v145, 0
    v_mov_b32 v146, 0
    v_mov_b32 v147, 0
    v_mov_b32 v148, 0
    v_mov_b32 v149, 0
    v_mov_b32 v150, 0
    v_mov_b32 v151, 0
    v_mov_b32 v152, 0
    v_mov_b32 v153, 0
    v_mov_b32 v154, 0
    v_mov_b32 v155, 0
    v_mov_b32 v156, 0
    v_mov_b32 v157, 0
    v_mov_b32 v158, 0
    v_mov_b32 v159, 0
    v_mov_b32 v176, 0
    v_mov_b32 v177, 0
    v_mov_b32 v178, 0
    v_mov_b32 v179, 0
    v_mov_b32 v160, 0
    v_mov_b32 v161, 0
    v_mov_b32 v162, 0
    v_mov_b32 v163, 0
    v_mov_b32 v164, 0
    v_mov_b32 v165, 0
    v_mov_b32 v166, 0
    v_mov_b32 v167, 0
    v_mov_b32 v168, 0
    v_mov_b32 v169, 0
    v_mov_b32 v170, 0
    v_mov_b32 v171, 0
    v_mov_b32 v172, 0
    v_mov_b32 v173, 0
    v_mov_b32 v174, 0
    v_mov_b32 v175, 0
    v_mov_b32 v180, 0
    v_mov_b32 v181, 0
    v_mov_b32 v182, 0
    v_mov_b32 v183, 0
    v_mov_b32 v104, 0
    v_mov_b32 v105, 0
    v_mov_b32 v106, 0
    v_mov_b32 v107, 0
    v_mov_b32 v108, 0
    v_mov_b32 v109, 0
    v_mov_b32 v110, 0
    v_mov_b32 v111, 0
    v_mov_b32 v136, 0
    v_mov_b32 v137, 0
    v_mov_b32 v138, 0
    v_mov_b32 v139, 0
    v_mov_b32 v140, 0
    v_mov_b32 v141, 0
    v_mov_b32 v142, 0
    v_mov_b32 v143, 0
    s_waitcnt vmcnt(2)
    s_barrier
    v_and_b32 v8, 3, v2
    v_lshl_add_u32 v8, v8, 12, v4
    v_add_u32 v8, 49152, v8
    ds_read_b128 v[16:19], v8 offset:0
    ds_read_b128 v[20:23], v8 offset:1024
    ds_read_b128 v[24:27], v8 offset:2048
    ds_read_b128 v[28:31], v8 offset:3072
    s_cmp_lg_u32 s36, 0
    s_cbranch_scc1 attn_havemax
    ds_read_b128 v[120:123], v4 offset:0
    ds_read_b128 v[124:127], v4 offset:1024
    s_waitcnt lgkmcnt(0)
    v_mfma_f32_32x32x16_bf16 v[64:79], v[120:123], v[16:19], 0
    v_mfma_f32_32x32x16_bf16 v[80:95], v[120:123], v[24:27], 0
    v_mfma_f32_32x32x16_bf16 v[64:79], v[124:127], v[20:23], v[64:79]
    v_mfma_f32_32x32x16_bf16 v[80:95], v[124:127], v[28:31], v[80:95]
    s_nop 10
    v_max_f32 v8, v64, v65
    v_max3_f32 v8, v8, v66, v67
    v_max3_f32 v8, v8, v68, v69
    v_max3_f32 v8, v8, v70, v71
    v_max3_f32 v8, v8, v72, v73
    v_max3_f32 v8, v8, v74, v75
    v_max3_f32 v8, v8, v76, v77
    v_max3_f32 v8, v8, v78, v79
    v_mov_b32 v9, v8
    s_nop 1
    v_permlane32_swap_b32 v8, v9
    v_max_f32 v8, v8, v9
    v_sub_f32 v32, 0, v8
    v_sub_f32 v33, 0, v8
    v_sub_f32 v34, 0, v8
    v_sub_f32 v35, 0, v8
    v_sub_f32 v36, 0, v8
    v_sub_f32 v37, 0, v8
    v_sub_f32 v38, 0, v8
    v_sub_f32 v39, 0, v8
    v_sub_f32 v40, 0, v8
    v_sub_f32 v41, 0, v8
    v_sub_f32 v42, 0, v8
    v_sub_f32 v43, 0, v8
    v_sub_f32 v44, 0, v8
    v_sub_f32 v45, 0, v8
    v_sub_f32 v46, 0, v8
    v_sub_f32 v47, 0, v8
    v_max_f32 v10, v80, v81
    v_max3_f32 v10, v10, v82, v83
    v_max3_f32 v10, v10, v84, v85
    v_max3_f32 v10, v10, v86, v87
    v_max3_f32 v10, v10, v88, v89
    v_max3_f32 v10, v10, v90, v91
    v_max3_f32 v10, v10, v92, v93
    v_max3_f32 v10, v10, v94, v95
    v_mov_b32 v11, v10
    s_nop 1
    v_permlane32_swap_b32 v10, v11
    v_max_f32 v10, v10, v11
    v_sub_f32 v48, 0, v10
    v_sub_f32 v49, 0, v10
    v_sub_f32 v50, 0, v10
    v_sub_f32 v51, 0, v10
    v_sub_f32 v52, 0, v10
    v_sub_f32 v53, 0, v10
    v_sub_f32 v54, 0, v10
    v_sub_f32 v55, 0, v10
    v_sub_f32 v56, 0, v10
    v_sub_f32 v57, 0, v10
    v_sub_f32 v58, 0, v10
    v_sub_f32 v59, 0, v10
    v_sub_f32 v60, 0, v10
    v_sub_f32 v61, 0, v10
    v_sub_f32 v62, 0, v10
    v_sub_f32 v63, 0, v10
attn_havemax:
    ds_read_b128 v[112:115], v5 offset:0
    ds_read_b128 v[116:119], v5 offset:1024
    s_waitcnt lgkmcnt(0)
    v_mfma_f32_32x32x16_bf16 v[64:79], v[112:115], v[16:19], v[32:47]
    v_mfma_f32_32x32x16_bf16 v[64:79], v[116:119], v[20:23], v[64:79]
    s_add_u32 s32, s48, 16384
    s_and_b32 s32, s32, 0x1ffff
    s_mov_b32 s47, 2
    s_mov_b32 s34, 4
    s_nop 9
attn_loop:
    v_mfma_f32_32x32x16_bf16 v[80:95], v[112:115], v[24:27], v[48:63]
    v_exp_f32 v64, v64
    ds_read_b128 v[120:123], v5 offset:2048
    v_exp_f32 v65, v65
    ds_read_b128 v[124:127], v5 offset:3072
    v_exp_f32 v66, v66
    v_mfma_f32_32x32x16_bf16 v[80:95], v[116:119], v[28:31], v[80:95]
    v_exp_f32 v67, v67
    ds_read_b128 v[128:131], v5 offset:8192
    v_exp_f32 v68, v68
    ds_read_b128 v[132:135], v5 offset:9216
    v_exp_f32 v69, v69
    v_mfma_f32_32x32x16_bf16 v[160:175], v[136:139], v[104:107], v[160:175]
    v_exp_f32 v70, v70
    v_exp_f32 v71, v71
    v_exp_f32 v72, v72
    v_mfma_f32_16x16x32_bf16 v[180:183], v[184:187], v[104:107], v[180:183]
    v_exp_f32 v73, v73
    v_cvt_pk_bf16_f32 v96, v64, v65
    v_cvt_pk_bf16_f32 v97, v66, v67
    v_mfma_f32_32x32x16_bf16 v[160:175], v[140:143], v[108:111], v[160:175]
    v_exp_f32 v74, v74
    v_exp_f32 v75, v75
    v_exp_f32 v76, v76
    v_mfma_f32_16x16x32_bf16 v[180:183], v[184:187], v[108:111], v[180:183]
    v_exp_f32 v77, v77
    v_cvt_pk_bf16_f32 v98, v68, v69
    v_cvt_pk_bf16_f32 v99, v70, v71
    v_exp_f32 v78, v78
    v_exp_f32 v79, v79
    v_cvt_pk_bf16_f32 v100, v72, v73
    v_cvt_pk_bf16_f32 v101, v74, v75
    v_cvt_pk_bf16_f32 v102, v76, v77
    v_cvt_pk_bf16_f32 v103, v78, v79
    s_waitcnt lgkmcnt(0)
    v_mfma_f32_32x32x16_bf16 v[64:79], v[120:123], v[16:19], v[32:47]
    v_exp_f32 v80, v80
    v_exp_f32 v81, v81
    v_exp_f32 v82, v82
    v_mfma_f32_32x32x16_bf16 v[64:79], v[124:127], v[20:23], v[64:79]
    v_exp_f32 v83, v83
    v_exp_f32 v84, v84
    v_exp_f32 v85, v85
    v_mfma_f32_32x32x16_bf16 v[144:159], v[128:131], v[96:99], v[144:159]
    v_exp_f32 v86, v86
    v_exp_f32 v87, v87
    v_exp_f32 v88, v88
    v_mfma_f32_16x16x32_bf16 v[176:179], v[184:187], v[96:99], v[176:179]
    v_exp_f32 v89, v89
    v_cvt_pk_bf16_f32 v104, v80, v81
    v_cvt_pk_bf16_f32 v105, v82, v83
    v_mfma_f32_32x32x16_bf16 v[144:159], v[132:135], v[100:103], v[144:159]
    v_exp_f32 v90, v90
    v_exp_f32 v91, v91
    v_exp_f32 v92, v92
    v_mfma_f32_16x16x32_bf16 v[176:179], v[184:187], v[100:103], v[176:179]
    v_exp_f32 v93, v93
    v_cvt_pk_bf16_f32 v106, v84, v85
    v_cvt_pk_bf16_f32 v107, v86, v87
    v_exp_f32 v94, v94
    v_exp_f32 v95, v95
    v_cvt_pk_bf16_f32 v108, v88, v89
    v_cvt_pk_bf16_f32 v109, v90, v91
    v_cvt_pk_bf16_f32 v110, v92, v93
    v_cvt_pk_bf16_f32 v111, v94, v95
    v_mfma_f32_32x32x16_bf16 v[80:95], v[120:123], v[24:27], v[48:63]
    s_cmp_lg_u32 s46, 0
    s_cbranch_scc1 attn2_skip
    s_lshl_b32 s38, s96, 15
    s_add_u32 s38, s38, 71270400
    s_add_u32 s54, s28, s38
    s_addc_u32 s55, s29, 0
    s_mov_b32 s56, 0x40000
    s_lshl_b32 s57, s49, 8
attn2_poll:
    s_mov_b32 s70, 0
    s_mov_b32 s71, 0
    s_mov_b32 s72, 0
    s_mov_b32 s73, 0
    s_mov_b32 s74, 0
    s_mov_b32 s75, 0
    s_mov_b32 s76, 0
    s_mov_b32 s77, 0
    s_atomic_add s70, s[54:55], s57 offset:0 glc
    s_atomic_add s71, s[54:55], s57 offset:256 glc
    s_atomic_add s72, s[54:55], s57 offset:512 glc
    s_atomic_add s73, s[54:55], s57 offset:768 glc
    s_atomic_add s74, s[54:55], s57 offset:1024 glc
    s_atomic_add s75, s[54:55], s57 offset:1280 glc
    s_atomic_add s76, s[54:55], s57 offset:1536 glc
    s_atomic_add s77, s[54:55], s57 offset:1792 glc
    s_waitcnt lgkmcnt(0)
    s_and_b32 s70, s70, s71
    s_and_b32 s70, s70, s72
    s_and_b32 s70, s70, s73
    s_and_b32 s70, s70, s74
    s_and_b32 s70, s70, s75
    s_and_b32 s70, s70, s76
    s_and_b32 s70, s70, s77
    s_cmp_eq_u32 s70, 8
    s_cbranch_scc1 attn2_ready
    s_sub_u32 s56, s56, 1
    s_cmp_lg_u32 s56, 0
    s_cbranch_scc1 attn2_poll
attn2_ready:
    s_mov_b32 s46, 1
attn2_skip:
    s_waitcnt vmcnt(0)
    s_barrier
    v_exp_f32 v64, v64
    ds_read_b128 v[112:115], v5 offset:16384
    v_exp_f32 v65, v65
    ds_read_b128 v[116:119], v5 offset:17408
    v_exp_f32 v66, v66
    v_mfma_f32_32x32x16_bf16 v[80:95], v[124:127], v[28:31], v[80:95]
    v_exp_f32 v67, v67
    ds_read_b128 v[136:139], v5 offset:10240
    v_exp_f32 v68, v68
    ds_read_b128 v[140:143], v5 offset:11264
    v_exp_f32 v69, v69
    v_mfma_f32_32x32x16_bf16 v[160:175], v[128:131], v[104:107], v[160:175]
    v_exp_f32 v70, v70
    v_exp_f32 v71, v71
    v_exp_f32 v72, v72
    v_mfma_f32_16x16x32_bf16 v[180:183], v[184:187], v[104:107], v[180:183]
    v_exp_f32 v73, v73
    v_cvt_pk_bf16_f32 v96, v64, v65
    v_cvt_pk_bf16_f32 v97, v66, v67
    v_mfma_f32_32x32x16_bf16 v[160:175], v[132:135], v[108:111], v[160:175]
    v_exp_f32 v74, v74
    v_exp_f32 v75, v75
    v_exp_f32 v76, v76
    v_mfma_f32_16x16x32_bf16 v[180:183], v[184:187], v[108:111], v[180:183]
    v_exp_f32 v77, v77
    v_cvt_pk_bf16_f32 v98, v68, v69
    v_cvt_pk_bf16_f32 v99, v70, v71
    v_exp_f32 v78, v78
    v_exp_f32 v79, v79
    v_cvt_pk_bf16_f32 v100, v72, v73
    v_cvt_pk_bf16_f32 v101, v74, v75
    v_cvt_pk_bf16_f32 v102, v76, v77
    v_cvt_pk_bf16_f32 v103, v78, v79
    s_waitcnt lgkmcnt(0)
    v_mfma_f32_32x32x16_bf16 v[64:79], v[112:115], v[16:19], v[32:47]
    v_exp_f32 v80, v80
    v_exp_f32 v81, v81
    v_exp_f32 v82, v82
    v_mfma_f32_32x32x16_bf16 v[64:79], v[116:119], v[20:23], v[64:79]
    v_exp_f32 v83, v83
    v_exp_f32 v84, v84
    v_exp_f32 v85, v85
    v_mfma_f32_32x32x16_bf16 v[144:159], v[136:139], v[96:99], v[144:159]
    v_exp_f32 v86, v86
    s_cmp_lt_u32 s47, 16
    s_cselect_b32 s3, s35, 163840
    s_cselect_b32 s4, s32, 1048576
    s_add_u32 m0, s3, 32768
    s_nop 0
    buffer_load_dwordx4 v6, s[12:15], s4 offen sc1 lds
    s_add_u32 m0, m0, 8192
    s_nop 0
    buffer_load_dwordx4 v6, s[16:19], s4 offen sc1 lds
    s_add_u32 s32, s32, 8192
    s_and_b32 s32, s32, 0x1ffff
    s_add_u32 s47, s47, 1
    s_cmp_lt_u32 s43, 147456
    s_cselect_b32 m0, s43, 163840
    s_cselect_b32 s3, s42, 4194304
    buffer_load_dwordx4 v3, s[24:27], s3 offen lds
    s_add_u32 s42, s42, 131072
    s_add_u32 s43, s43, 8192
    v_exp_f32 v87, v87
    v_exp_f32 v88, v88
    v_mfma_f32_16x16x32_bf16 v[176:179], v[184:187], v[96:99], v[176:179]
    v_exp_f32 v89, v89
    v_cvt_pk_bf16_f32 v104, v80, v81
    v_cvt_pk_bf16_f32 v105, v82, v83
    v_mfma_f32_32x32x16_bf16 v[144:159], v[140:143], v[100:103], v[144:159]
    v_exp_f32 v90, v90
    v_exp_f32 v91, v91
    v_exp_f32 v92, v92
    v_mfma_f32_16x16x32_bf16 v[176:179], v[184:187], v[100:103], v[176:179]
    v_exp_f32 v93, v93
    v_cvt_pk_bf16_f32 v106, v84, v85
    v_cvt_pk_bf16_f32 v107, v86, v87
    v_exp_f32 v94, v94
    v_exp_f32 v95, v95
    v_cvt_pk_bf16_f32 v108, v88, v89
    v_cvt_pk_bf16_f32 v109, v90, v91
    v_cvt_pk_bf16_f32 v110, v92, v93
    v_cvt_pk_bf16_f32 v111, v94, v95
    v_mfma_f32_32x32x16_bf16 v[80:95], v[112:115], v[24:27], v[48:63]
    v_exp_f32 v64, v64
    ds_read_b128 v[120:123], v5 offset:18432
    v_exp_f32 v65, v65
    ds_read_b128 v[124:127], v5 offset:19456
    v_exp_f32 v66, v66
    v_mfma_f32_32x32x16_bf16 v[80:95], v[116:119], v[28:31], v[80:95]
    v_exp_f32 v67, v67
    ds_read_b128 v[128:131], v5 offset:24576
    v_exp_f32 v68, v68
    ds_read_b128 v[132:135], v5 offset:25600
    v_exp_f32 v69, v69
    v_mfma_f32_32x32x16_bf16 v[160:175], v[136:139], v[104:107], v[160:175]
    v_exp_f32 v70, v70
    v_exp_f32 v71, v71
    v_exp_f32 v72, v72
    v_mfma_f32_16x16x32_bf16 v[180:183], v[184:187], v[104:107], v[180:183]
    v_exp_f32 v73, v73
    v_cvt_pk_bf16_f32 v96, v64, v65
    v_cvt_pk_bf16_f32 v97, v66, v67
    v_mfma_f32_32x32x16_bf16 v[160:175], v[140:143], v[108:111], v[160:175]
    v_exp_f32 v74, v74
    v_exp_f32 v75, v75
    v_exp_f32 v76, v76
    v_mfma_f32_16x16x32_bf16 v[180:183], v[184:187], v[108:111], v[180:183]
    v_exp_f32 v77, v77
    v_cvt_pk_bf16_f32 v98, v68, v69
    v_cvt_pk_bf16_f32 v99, v70, v71
    v_exp_f32 v78, v78
    v_exp_f32 v79, v79
    v_cvt_pk_bf16_f32 v100, v72, v73
    v_cvt_pk_bf16_f32 v101, v74, v75
    v_cvt_pk_bf16_f32 v102, v76, v77
    v_cvt_pk_bf16_f32 v103, v78, v79
    s_waitcnt lgkmcnt(0)
    v_mfma_f32_32x32x16_bf16 v[64:79], v[120:123], v[16:19], v[32:47]
    v_exp_f32 v80, v80
    v_exp_f32 v81, v81
    v_exp_f32 v82, v82
    v_mfma_f32_32x32x16_bf16 v[64:79], v[124:127], v[20:23], v[64:79]
    v_exp_f32 v83, v83
    v_exp_f32 v84, v84
    v_exp_f32 v85, v85
    v_mfma_f32_32x32x16_bf16 v[144:159], v[128:131], v[96:99], v[144:159]
    v_exp_f32 v86, v86
    v_exp_f32 v87, v87
    v_exp_f32 v88, v88
    v_mfma_f32_16x16x32_bf16 v[176:179], v[184:187], v[96:99], v[176:179]
    v_exp_f32 v89, v89
    v_cvt_pk_bf16_f32 v104, v80, v81
    v_cvt_pk_bf16_f32 v105, v82, v83
    v_mfma_f32_32x32x16_bf16 v[144:159], v[132:135], v[100:103], v[144:159]
    v_exp_f32 v90, v90
    v_exp_f32 v91, v91
    v_exp_f32 v92, v92
    v_mfma_f32_16x16x32_bf16 v[176:179], v[184:187], v[100:103], v[176:179]
    v_exp_f32 v93, v93
    v_cvt_pk_bf16_f32 v106, v84, v85
    v_cvt_pk_bf16_f32 v107, v86, v87
    v_exp_f32 v94, v94
    v_exp_f32 v95, v95
    v_cvt_pk_bf16_f32 v108, v88, v89
    v_cvt_pk_bf16_f32 v109, v90, v91
    v_cvt_pk_bf16_f32 v110, v92, v93
    v_cvt_pk_bf16_f32 v111, v94, v95
    v_mfma_f32_32x32x16_bf16 v[80:95], v[120:123], v[24:27], v[48:63]
    s_waitcnt vmcnt(1)
    s_barrier
    v_exp_f32 v64, v64
    ds_read_b128 v[112:115], v5 offset:32768
    v_exp_f32 v65, v65
    ds_read_b128 v[116:119], v5 offset:33792
    v_exp_f32 v66, v66
    v_mfma_f32_32x32x16_bf16 v[80:95], v[124:127], v[28:31], v[80:95]
    v_exp_f32 v67, v67
    ds_read_b128 v[136:139], v5 offset:26624
    v_exp_f32 v68, v68
    ds_read_b128 v[140:143], v5 offset:27648
    v_exp_f32 v69, v69
    v_mfma_f32_32x32x16_bf16 v[160:175], v[128:131], v[104:107], v[160:175]
    v_exp_f32 v70, v70
    v_exp_f32 v71, v71
    v_exp_f32 v72, v72
    v_mfma_f32_16x16x32_bf16 v[180:183], v[184:187], v[104:107], v[180:183]
    v_exp_f32 v73, v73
    v_cvt_pk_bf16_f32 v96, v64, v65
    v_cvt_pk_bf16_f32 v97, v66, v67
    v_mfma_f32_32x32x16_bf16 v[160:175], v[132:135], v[108:111], v[160:175]
    v_exp_f32 v74, v74
    v_exp_f32 v75, v75
    v_exp_f32 v76, v76
    v_mfma_f32_16x16x32_bf16 v[180:183], v[184:187], v[108:111], v[180:183]
    v_exp_f32 v77, v77
    v_cvt_pk_bf16_f32 v98, v68, v69
    v_cvt_pk_bf16_f32 v99, v70, v71
    v_exp_f32 v78, v78
    v_exp_f32 v79, v79
    v_cvt_pk_bf16_f32 v100, v72, v73
    v_cvt_pk_bf16_f32 v101, v74, v75
    v_cvt_pk_bf16_f32 v102, v76, v77
    v_cvt_pk_bf16_f32 v103, v78, v79
    s_waitcnt lgkmcnt(0)
    v_mfma_f32_32x32x16_bf16 v[64:79], v[112:115], v[16:19], v[32:47]
    v_exp_f32 v80, v80
    v_exp_f32 v81, v81
    v_exp_f32 v82, v82
    v_mfma_f32_32x32x16_bf16 v[64:79], v[116:119], v[20:23], v[64:79]
    v_exp_f32 v83, v83
    v_exp_f32 v84, v84
    v_exp_f32 v85, v85
    v_mfma_f32_32x32x16_bf16 v[144:159], v[136:139], v[96:99], v[144:159]
    v_exp_f32 v86, v86
    s_cmp_lt_u32 s47, 16
    s_cselect_b32 s3, s35, 163840
    s_cselect_b32 s4, s32, 1048576
    s_add_u32 m0, s3, 49152
    s_nop 0
    buffer_load_dwordx4 v6, s[12:15], s4 offen sc1 lds
    s_add_u32 m0, m0, 8192
    s_nop 0
    buffer_load_dwordx4 v6, s[16:19], s4 offen sc1 lds
    s_add_u32 s32, s32, 8192
    s_and_b32 s32, s32, 0x1ffff
    s_add_u32 s47, s47, 1
    s_cmp_lt_u32 s43, 147456
    s_cselect_b32 m0, s43, 163840
    s_cselect_b32 s3, s42, 4194304
    buffer_load_dwordx4 v3, s[24:27], s3 offen lds
    s_add_u32 s42, s42, 131072
    s_add_u32 s43, s43, 8192
    v_exp_f32 v87, v87
    v_exp_f32 v88, v88
    v_mfma_f32_16x16x32_bf16 v[176:179], v[184:187], v[96:99], v[176:179]
    v_exp_f32 v89, v89
    v_cvt_pk_bf16_f32 v104, v80, v81
    v_cvt_pk_bf16_f32 v105, v82, v83
    v_mfma_f32_32x32x16_bf16 v[144:159], v[140:143], v[100:103], v[144:159]
    v_exp_f32 v90, v90
    v_exp_f32 v91, v91
    v_exp_f32 v92, v92
    v_mfma_f32_16x16x32_bf16 v[176:179], v[184:187], v[100:103], v[176:179]
    v_exp_f32 v93, v93
    v_cvt_pk_bf16_f32 v106, v84, v85
    v_cvt_pk_bf16_f32 v107, v86, v87
    v_exp_f32 v94, v94
    v_exp_f32 v95, v95
    v_cvt_pk_bf16_f32 v108, v88, v89
    v_cvt_pk_bf16_f32 v109, v90, v91
    v_cvt_pk_bf16_f32 v110, v92, v93
    v_cvt_pk_bf16_f32 v111, v94, v95
    v_mfma_f32_32x32x16_bf16 v[80:95], v[112:115], v[24:27], v[48:63]
    v_exp_f32 v64, v64
    ds_read_b128 v[120:123], v5 offset:34816
    v_exp_f32 v65, v65
    ds_read_b128 v[124:127], v5 offset:35840
    v_exp_f32 v66, v66
    v_mfma_f32_32x32x16_bf16 v[80:95], v[116:119], v[28:31], v[80:95]
    v_exp_f32 v67, v67
    ds_read_b128 v[128:131], v5 offset:40960
    v_exp_f32 v68, v68
    ds_read_b128 v[132:135], v5 offset:41984
    v_exp_f32 v69, v69
    v_mfma_f32_32x32x16_bf16 v[160:175], v[136:139], v[104:107], v[160:175]
    v_exp_f32 v70, v70
    v_exp_f32 v71, v71
    v_exp_f32 v72, v72
    v_mfma_f32_16x16x32_bf16 v[180:183], v[184:187], v[104:107], v[180:183]
    v_exp_f32 v73, v73
    v_cvt_pk_bf16_f32 v96, v64, v65
    v_cvt_pk_bf16_f32 v97, v66, v67
    v_mfma_f32_32x32x16_bf16 v[160:175], v[140:143], v[108:111], v[160:175]
    v_exp_f32 v74, v74
    v_exp_f32 v75, v75
    v_exp_f32 v76, v76
    v_mfma_f32_16x16x32_bf16 v[180:183], v[184:187], v[108:111], v[180:183]
    v_exp_f32 v77, v77
    v_cvt_pk_bf16_f32 v98, v68, v69
    v_cvt_pk_bf16_f32 v99, v70, v71
    v_exp_f32 v78, v78
    v_exp_f32 v79, v79
    v_cvt_pk_bf16_f32 v100, v72, v73
    v_cvt_pk_bf16_f32 v101, v74, v75
    v_cvt_pk_bf16_f32 v102, v76, v77
    v_cvt_pk_bf16_f32 v103, v78, v79
    s_waitcnt lgkmcnt(0)
    v_mfma_f32_32x32x16_bf16 v[64:79], v[120:123], v[16:19], v[32:47]
    v_exp_f32 v80, v80
    v_exp_f32 v81, v81
    v_exp_f32 v82, v82
    v_mfma_f32_32x32x16_bf16 v[64:79], v[124:127], v[20:23], v[64:79]
    v_exp_f32 v83, v83
    v_exp_f32 v84, v84
    v_exp_f32 v85, v85
    v_mfma_f32_32x32x16_bf16 v[144:159], v[128:131], v[96:99], v[144:159]
    v_exp_f32 v86, v86
    v_exp_f32 v87, v87
    v_exp_f32 v88, v88
    v_mfma_f32_16x16x32_bf16 v[176:179], v[184:187], v[96:99], v[176:179]
    v_exp_f32 v89, v89
    v_cvt_pk_bf16_f32 v104, v80, v81
    v_cvt_pk_bf16_f32 v105, v82, v83
    v_mfma_f32_32x32x16_bf16 v[144:159], v[132:135], v[100:103], v[144:159]
    v_exp_f32 v90, v90
    v_exp_f32 v91, v91
    v_exp_f32 v92, v92
    v_mfma_f32_16x16x32_bf16 v[176:179], v[184:187], v[100:103], v[176:179]
    v_exp_f32 v93, v93
    v_cvt_pk_bf16_f32 v106, v84, v85
    v_cvt_pk_bf16_f32 v107, v86, v87
    v_exp_f32 v94, v94
    v_exp_f32 v95, v95
    v_cvt_pk_bf16_f32 v108, v88, v89
    v_cvt_pk_bf16_f32 v109, v90, v91
    v_cvt_pk_bf16_f32 v110, v92, v93
    v_cvt_pk_bf16_f32 v111, v94, v95
    v_mfma_f32_32x32x16_bf16 v[80:95], v[120:123], v[24:27], v[48:63]
    s_waitcnt vmcnt(1)
    s_barrier
    v_exp_f32 v64, v64
    ds_read_b128 v[112:115], v5 offset:49152
    v_exp_f32 v65, v65
    ds_read_b128 v[116:119], v5 offset:50176
    v_exp_f32 v66, v66
    v_mfma_f32_32x32x16_bf16 v[80:95], v[124:127], v[28:31], v[80:95]
    v_exp_f32 v67, v67
    ds_read_b128 v[136:139], v5 offset:43008
    v_exp_f32 v68, v68
    ds_read_b128 v[140:143], v5 offset:44032
    v_exp_f32 v69, v69
    v_mfma_f32_32x32x16_bf16 v[160:175], v[128:131], v[104:107], v[160:175]
    v_exp_f32 v70, v70
    v_exp_f32 v71, v71
    v_exp_f32 v72, v72
    v_mfma_f32_16x16x32_bf16 v[180:183], v[184:187], v[104:107], v[180:183]
    v_exp_f32 v73, v73
    v_cvt_pk_bf16_f32 v96, v64, v65
    v_cvt_pk_bf16_f32 v97, v66, v67
    v_mfma_f32_32x32x16_bf16 v[160:175], v[132:135], v[108:111], v[160:175]
    v_exp_f32 v74, v74
    v_exp_f32 v75, v75
    v_exp_f32 v76, v76
    v_mfma_f32_16x16x32_bf16 v[180:183], v[184:187], v[108:111], v[180:183]
    v_exp_f32 v77, v77
    v_cvt_pk_bf16_f32 v98, v68, v69
    v_cvt_pk_bf16_f32 v99, v70, v71
    v_exp_f32 v78, v78
    v_exp_f32 v79, v79
    v_cvt_pk_bf16_f32 v100, v72, v73
    v_cvt_pk_bf16_f32 v101, v74, v75
    v_cvt_pk_bf16_f32 v102, v76, v77
    v_cvt_pk_bf16_f32 v103, v78, v79
    s_waitcnt lgkmcnt(0)
    v_mfma_f32_32x32x16_bf16 v[64:79], v[112:115], v[16:19], v[32:47]
    v_exp_f32 v80, v80
    v_exp_f32 v81, v81
    v_exp_f32 v82, v82
    v_mfma_f32_32x32x16_bf16 v[64:79], v[116:119], v[20:23], v[64:79]
    v_exp_f32 v83, v83
    v_exp_f32 v84, v84
    v_exp_f32 v85, v85
    v_mfma_f32_32x32x16_bf16 v[144:159], v[136:139], v[96:99], v[144:159]
    v_exp_f32 v86, v86
    s_cmp_lt_u32 s47, 16
    s_cselect_b32 s3, s35, 163840
    s_cselect_b32 s4, s32, 1048576
    s_add_u32 m0, s3, 0
    s_nop 0
    buffer_load_dwordx4 v6, s[12:15], s4 offen sc1 lds
    s_add_u32 m0, m0, 8192
    s_nop 0
    buffer_load_dwordx4 v6, s[16:19], s4 offen sc1 lds
    s_add_u32 s32, s32, 8192
    s_and_b32 s32, s32, 0x1ffff
    s_add_u32 s47, s47, 1
    s_cmp_lt_u32 s43, 147456
    s_cselect_b32 m0, s43, 163840
    s_cselect_b32 s3, s42, 4194304
    buffer_load_dwordx4 v3, s[24:27], s3 offen lds
    s_add_u32 s42, s42, 131072
    s_add_u32 s43, s43, 8192
    v_exp_f32 v87, v87
    v_exp_f32 v88, v88
    v_mfma_f32_16x16x32_bf16 v[176:179], v[184:187], v[96:99], v[176:179]
    v_exp_f32 v89, v89
    v_cvt_pk_bf16_f32 v104, v80, v81
    v_cvt_pk_bf16_f32 v105, v82, v83
    v_mfma_f32_32x32x16_bf16 v[144:159], v[140:143], v[100:103], v[144:159]
    v_exp_f32 v90, v90
    v_exp_f32 v91, v91
    v_exp_f32 v92, v92
    v_mfma_f32_16x16x32_bf16 v[176:179], v[184:187], v[100:103], v[176:179]
    v_exp_f32 v93, v93
    v_cvt_pk_bf16_f32 v106, v84, v85
    v_cvt_pk_bf16_f32 v107, v86, v87
    v_exp_f32 v94, v94
    v_exp_f32 v95, v95
    v_cvt_pk_bf16_f32 v108, v88, v89
    v_cvt_pk_bf16_f32 v109, v90, v91
    v_cvt_pk_bf16_f32 v110, v92, v93
    v_cvt_pk_bf16_f32 v111, v94, v95
    v_mfma_f32_32x32x16_bf16 v[80:95], v[112:115], v[24:27], v[48:63]
    v_exp_f32 v64, v64
    ds_read_b128 v[120:123], v5 offset:51200
    v_exp_f32 v65, v65
    ds_read_b128 v[124:127], v5 offset:52224
    v_exp_f32 v66, v66
    v_mfma_f32_32x32x16_bf16 v[80:95], v[116:119], v[28:31], v[80:95]
    v_exp_f32 v67, v67
    ds_read_b128 v[128:131], v5 offset:57344
    v_exp_f32 v68, v68
    ds_read_b128 v[132:135], v5 offset:58368
    v_exp_f32 v69, v69
    v_mfma_f32_32x32x16_bf16 v[160:175], v[136:139], v[104:107], v[160:175]
    v_exp_f32 v70, v70
    v_exp_f32 v71, v71
    v_exp_f32 v72, v72
    v_mfma_f32_16x16x32_bf16 v[180:183], v[184:187], v[104:107], v[180:183]
    v_exp_f32 v73, v73
    v_cvt_pk_bf16_f32 v96, v64, v65
    v_cvt_pk_bf16_f32 v97, v66, v67
    v_mfma_f32_32x32x16_bf16 v[160:175], v[140:143], v[108:111], v[160:175]
    v_exp_f32 v74, v74
    v_exp_f32 v75, v75
    v_exp_f32 v76, v76
    v_mfma_f32_16x16x32_bf16 v[180:183], v[184:187], v[108:111], v[180:183]
    v_exp_f32 v77, v77
    v_cvt_pk_bf16_f32 v98, v68, v69
    v_cvt_pk_bf16_f32 v99, v70, v71
    v_exp_f32 v78, v78
    v_exp_f32 v79, v79
    v_cvt_pk_bf16_f32 v100, v72, v73
    v_cvt_pk_bf16_f32 v101, v74, v75
    v_cvt_pk_bf16_f32 v102, v76, v77
    v_cvt_pk_bf16_f32 v103, v78, v79
    s_waitcnt lgkmcnt(0)
    v_mfma_f32_32x32x16_bf16 v[64:79], v[120:123], v[16:19], v[32:47]
    v_exp_f32 v80, v80
    v_exp_f32 v81, v81
    v_exp_f32 v82, v82
    v_mfma_f32_32x32x16_bf16 v[64:79], v[124:127], v[20:23], v[64:79]
    v_exp_f32 v83, v83
    v_exp_f32 v84, v84
    v_exp_f32 v85, v85
    v_mfma_f32_32x32x16_bf16 v[144:159], v[128:131], v[96:99], v[144:159]
    v_exp_f32 v86, v86
    v_exp_f32 v87, v87
    v_exp_f32 v88, v88
    v_mfma_f32_16x16x32_bf16 v[176:179], v[184:187], v[96:99], v[176:179]
    v_exp_f32 v89, v89
    v_cvt_pk_bf16_f32 v104, v80, v81
    v_cvt_pk_bf16_f32 v105, v82, v83
    v_mfma_f32_32x32x16_bf16 v[144:159], v[132:135], v[100:103], v[144:159]
    v_exp_f32 v90, v90
    v_exp_f32 v91, v91
    v_exp_f32 v92, v92
    v_mfma_f32_16x16x32_bf16 v[176:179], v[184:187], v[100:103], v[176:179]
    v_exp_f32 v93, v93
    v_cvt_pk_bf16_f32 v106, v84, v85
    v_cvt_pk_bf16_f32 v107, v86, v87
    v_exp_f32 v94, v94
    v_exp_f32 v95, v95
    v_cvt_pk_bf16_f32 v108, v88, v89
    v_cvt_pk_bf16_f32 v109, v90, v91
    v_cvt_pk_bf16_f32 v110, v92, v93
    v_cvt_pk_bf16_f32 v111, v94, v95
    v_mfma_f32_32x32x16_bf16 v[80:95], v[120:123], v[24:27], v[48:63]
    s_waitcnt vmcnt(1)
    s_barrier
    v_exp_f32 v64, v64
    ds_read_b128 v[112:115], v5 offset:0
    v_exp_f32 v65, v65
    ds_read_b128 v[116:119], v5 offset:1024
    v_exp_f32 v66, v66
    v_mfma_f32_32x32x16_bf16 v[80:95], v[124:127], v[28:31], v[80:95]
    v_exp_f32 v67, v67
    ds_read_b128 v[136:139], v5 offset:59392
    v_exp_f32 v68, v68
    ds_read_b128 v[140:143], v5 offset:60416
    v_exp_f32 v69, v69
    v_mfma_f32_32x32x16_bf16 v[160:175], v[128:131], v[104:107], v[160:175]
    v_exp_f32 v70, v70
    v_exp_f32 v71, v71
    v_exp_f32 v72, v72
    v_mfma_f32_16x16x32_bf16 v[180:183], v[184:187], v[104:107], v[180:183]
    v_exp_f32 v73, v73
    v_cvt_pk_bf16_f32 v96, v64, v65
    v_cvt_pk_bf16_f32 v97, v66, v67
    v_mfma_f32_32x32x16_bf16 v[160:175], v[132:135], v[108:111], v[160:175]
    v_exp_f32 v74, v74
    v_exp_f32 v75, v75
    v_exp_f32 v76, v76
    v_mfma_f32_16x16x32_bf16 v[180:183], v[184:187], v[108:111], v[180:183]
    v_exp_f32 v77, v77
    v_cvt_pk_bf16_f32 v98, v68, v69
    v_cvt_pk_bf16_f32 v99, v70, v71
    v_exp_f32 v78, v78
    v_exp_f32 v79, v79
    v_cvt_pk_bf16_f32 v100, v72, v73
    v_cvt_pk_bf16_f32 v101, v74, v75
    v_cvt_pk_bf16_f32 v102, v76, v77
    v_cvt_pk_bf16_f32 v103, v78, v79
    s_waitcnt lgkmcnt(0)
    v_mfma_f32_32x32x16_bf16 v[64:79], v[112:115], v[16:19], v[32:47]
    v_exp_f32 v80, v80
    v_exp_f32 v81, v81
    v_exp_f32 v82, v82
    v_mfma_f32_32x32x16_bf16 v[64:79], v[116:119], v[20:23], v[64:79]
    v_exp_f32 v83, v83
    v_exp_f32 v84, v84
    v_exp_f32 v85, v85
    v_mfma_f32_32x32x16_bf16 v[144:159], v[136:139], v[96:99], v[144:159]
    v_exp_f32 v86, v86
    s_cmp_lt_u32 s47, 16
    s_cselect_b32 s3, s35, 163840
    s_cselect_b32 s4, s32, 1048576
    s_add_u32 m0, s3, 16384
    s_nop 0
    buffer_load_dwordx4 v6, s[12:15], s4 offen sc1 lds
    s_add_u32 m0, m0, 8192
    s_nop 0
    buffer_load_dwordx4 v6, s[16:19], s4 offen sc1 lds
    s_add_u32 s32, s32, 8192
    s_and_b32 s32, s32, 0x1ffff
    s_add_u32 s47, s47, 1
    s_cmp_lt_u32 s43, 147456
    s_cselect_b32 m0, s43, 163840
    s_cselect_b32 s3, s42, 4194304
    buffer_load_dwordx4 v3, s[24:27], s3 offen lds
    s_add_u32 s42, s42, 131072
    s_add_u32 s43, s43, 8192
    v_exp_f32 v87, v87
    v_exp_f32 v88, v88
    v_mfma_f32_16x16x32_bf16 v[176:179], v[184:187], v[96:99], v[176:179]
    v_exp_f32 v89, v89
    v_cvt_pk_bf16_f32 v104, v80, v81
    v_cvt_pk_bf16_f32 v105, v82, v83
    v_mfma_f32_32x32x16_bf16 v[144:159], v[140:143], v[100:103], v[144:159]
    v_exp_f32 v90, v90
    v_exp_f32 v91, v91
    v_exp_f32 v92, v92
    v_mfma_f32_16x16x32_bf16 v[176:179], v[184:187], v[100:103], v[176:179]
    v_exp_f32 v93, v93
    v_cvt_pk_bf16_f32 v106, v84, v85
    v_cvt_pk_bf16_f32 v107, v86, v87
    v_exp_f32 v94, v94
    v_exp_f32 v95, v95
    v_cvt_pk_bf16_f32 v108, v88, v89
    v_cvt_pk_bf16_f32 v109, v90, v91
    v_cvt_pk_bf16_f32 v110, v92, v93
    v_cvt_pk_bf16_f32 v111, v94, v95
    s_sub_u32 s34, s34, 1
    s_cmp_lg_u32 s34, 0
    s_cbranch_scc1 attn_loop
    v_mfma_f32_32x32x16_bf16 v[160:175], v[136:139], v[104:107], v[160:175]
    v_mfma_f32_16x16x32_bf16 v[180:183], v[184:187], v[104:107], v[180:183]
    v_mfma_f32_32x32x16_bf16 v[160:175], v[140:143], v[108:111], v[160:175]
    v_mfma_f32_16x16x32_bf16 v[180:183], v[184:187], v[108:111], v[180:183]
    s_xor_b32 s3, s8, 0
    s_mul_i32 s4, s3, 5120
    s_cmp_ge_u32 s3, 6
    s_cselect_b32 s3, 116736, 0
    s_add_u32 s4, s4, s3
    v_add_u32 v8, s4, v4
    s_xor_b32 s3, s8, 4
    s_mul_i32 s4, s3, 5120
    s_cmp_ge_u32 s3, 6
    s_cselect_b32 s3, 116736, 0
    s_add_u32 s4, s4, s3
    v_add_u32 v9, s4, v4
    v_mov_b32 v14, 0x5f000000
    v_lshlrev_b32 v15, 2, v2
    v_add_u32 v15, 157696, v15
    v_add_f32 v12, v176, v177
    v_add_f32 v13, v180, v181
    v_add_f32 v12, v12, v13
    v_cmp_nlt_f32 vcc, v12, v14
    s_cmp_lg_u64 vcc, 0
    s_cselect_b32 s3, 1, 0
    v_mov_b32 v14, s3
    ds_write_b32 v15, v14
    s_cmp_eq_u32 s37, 0
    s_cbranch_scc1 attn_g0
    ds_write_b128 v8, v[144:147] offset:0
    ds_write_b128 v8, v[148:151] offset:1024
    ds_write_b128 v8, v[152:155] offset:2048
    ds_write_b128 v8, v[156:159] offset:3072
    ds_write_b64 v8, v[176:177] offset:4096
    s_nop 1
    v_mov_b32 v144, v160
    v_mov_b32 v145, v161
    v_mov_b32 v146, v162
    v_mov_b32 v147, v163
    v_mov_b32 v148, v164
    v_mov_b32 v149, v165
    v_mov_b32 v150, v166
    v_mov_b32 v151, v167
    v_mov_b32 v152, v168
    v_mov_b32 v153, v169
    v_mov_b32 v154, v170
    v_mov_b32 v155, v171
    v_mov_b32 v156, v172
    v_mov_b32 v157, v173
    v_mov_b32 v158, v174
    v_mov_b32 v159, v175
    v_mov_b32 v176, v180
    v_mov_b32 v177, v181
    s_branch attn_xch
attn_g0:
    ds_write_b128 v8, v[160:163] offset:0
    ds_write_b128 v8, v[164:167] offset:1024
    ds_write_b128 v8, v[168:171] offset:2048
    ds_write_b128 v8, v[172:175] offset:3072
    ds_write_b64 v8, v[180:181] offset:4096
attn_xch:
    v_mov_b32 v15, 157696
    s_waitcnt lgkmcnt(0)
    s_barrier
    ds_read_b64 v[80:81], v9 offset:4096
    ds_read_b128 v[84:87], v15
    ds_read_b128 v[88:91], v15 offset:16
    ds_read_b128 v[64:67], v9 offset:0
    ds_read_b128 v[68:71], v9 offset:1024
    ds_read_b128 v[72:75], v9 offset:2048
    ds_read_b128 v[76:79], v9 offset:3072
    v_and_b32 v8, 15, v1
    v_lshlrev_b32 v8, 2, v8
    v_bfe_u32 v9, v1, 4, 1
    v_cmp_eq_u32 vcc, 0, v9
    s_waitcnt lgkmcnt(4)
    v_pk_add_f32 v[176:177], v[176:177], v[80:81]
    ds_bpermute_b32 v10, v8, v176
    ds_bpermute_b32 v11, v8, v177
    v_or3_b32 v14, v84, v85, v86
    v_or3_b32 v14, v14, v87, v88
    v_or3_b32 v14, v14, v89, v90
    v_or_b32 v14, v14, v91
    s_nop 0
    v_readfirstlane_b32 s3, v14
    s_waitcnt lgkmcnt(2)
    v_pk_add_f32 v[144:145], v[144:145], v[64:65]
    v_pk_add_f32 v[146:147], v[146:147], v[66:67]
    v_pk_add_f32 v[148:149], v[148:149], v[68:69]
    v_pk_add_f32 v[150:151], v[150:151], v[70:71]
    v_pk_add_f32 v[152:153], v[152:153], v[72:73]
    v_pk_add_f32 v[154:155], v[154:155], v[74:75]
    v_pk_add_f32 v[156:157], v[156:157], v[76:77]
    v_pk_add_f32 v[158:159], v[158:159], v[78:79]
    s_waitcnt lgkmcnt(0)
    v_cndmask_b32 v10, v11, v10, vcc
    s_andn2_b32 s3, s3, s36
    s_cmp_lg_u32 s3, 0
    s_cbranch_scc1 attn_slow
attn_fin:
    v_rcp_f32 v10, v10
    s_add_u32 s21, s11, s37
    s_lshl_b32 s3, s21, 16
    s_lshl_b32 s4, s9, 11
    s_add_u32 s3, s3, s4
    s_lshl_b32 s4, s99, 22
    s_add_u32 s3, s3, s4
    s_add_u32 s3, s3, 41943040
    v_pk_mul_f32 v[144:145], v[10:11], v[144:145] op_sel_hi:[0,1]
    v_pk_mul_f32 v[146:147], v[10:11], v[146:147] op_sel_hi:[0,1]
    v_pk_mul_f32 v[148:149], v[10:11], v[148:149] op_sel_hi:[0,1]
    v_pk_mul_f32 v[150:151], v[10:11], v[150:151] op_sel_hi:[0,1]
    v_pk_mul_f32 v[152:153], v[10:11], v[152:153] op_sel_hi:[0,1]
    v_pk_mul_f32 v[154:155], v[10:11], v[154:155] op_sel_hi:[0,1]
    v_pk_mul_f32 v[156:157], v[10:11], v[156:157] op_sel_hi:[0,1]
    v_pk_mul_f32 v[158:159], v[10:11], v[158:159] op_sel_hi:[0,1]
    v_cvt_pk_bf16_f32 v144, v144, v145
    v_cvt_pk_bf16_f32 v145, v146, v147
    v_cvt_pk_bf16_f32 v146, v148, v149
    v_cvt_pk_bf16_f32 v147, v150, v151
    v_cvt_pk_bf16_f32 v148, v152, v153
    v_cvt_pk_bf16_f32 v149, v154, v155
    v_cvt_pk_bf16_f32 v150, v156, v157
    v_cvt_pk_bf16_f32 v151, v158, v159
    buffer_store_dwordx4 v[144:147], v4, s[28:31], s3 offen offset:0 sc1
    buffer_store_dwordx4 v[148:151], v4, s[28:31], s3 offen offset:1024 sc1
    s_cmp_eq_u32 s96, s98
    s_cbranch_scc1 mega_exit
    s_lshl_b32 s38, s96, 15
    s_lshl_b32 s39, s21, 8
    s_add_u32 s38, s38, s39
    s_add_u32 s38, s38, 71303168
    s_add_u32 s54, s28, s38
    s_addc_u32 s55, s29, 0
    s_mov_b32 s59, 1
    s_waitcnt vmcnt(0)
    s_atomic_add s59, s[54:55], 0
    s_branch mega_next2
attn_slow:
    s_waitcnt vmcnt(0)
    s_barrier
    s_mov_b32 s36, 1
    s_mov_b32 s32, 0
    v_mov_b32 v8, 0xff800000
    v_mov_b32 v10, 0xff800000
attn_slow_loop:
    buffer_load_dwordx4 v[112:115], v4, s[12:15], s32 offen offset:0 sc1
    buffer_load_dwordx4 v[116:119], v4, s[12:15], s32 offen offset:1024 sc1
    s_waitcnt vmcnt(0)
    v_mfma_f32_32x32x16_bf16 v[64:79], v[112:115], v[16:19], 0
    v_mfma_f32_32x32x16_bf16 v[80:95], v[112:115], v[24:27], 0
    v_mfma_f32_32x32x16_bf16 v[64:79], v[116:119], v[20:23], v[64:79]
    v_mfma_f32_32x32x16_bf16 v[80:95], v[116:119], v[28:31], v[80:95]
    s_nop 10
    v_max3_f32 v8, v8, v64, v65
    v_max3_f32 v8, v8, v66, v67
    v_max3_f32 v8, v8, v68, v69
    v_max3_f32 v8, v8, v70, v71
    v_max3_f32 v8, v8, v72, v73
    v_max3_f32 v8, v8, v74, v75
    v_max3_f32 v8, v8, v76, v77
    v_max3_f32 v8, v8, v78, v79
    v_max3_f32 v10, v10, v80, v81
    v_max3_f32 v10, v10, v82, v83
    v_max3_f32 v10, v10, v84, v85
    v_max3_f32 v10, v10, v86, v87
    v_max3_f32 v10, v10, v88, v89
    v_max3_f32 v10, v10, v90, v91
    v_max3_f32 v10, v10, v92, v93
    v_max3_f32 v10, v10, v94, v95
    s_add_u32 s32, s32, 2048
    s_cmp_lt_u32 s32, 131072
    s_cbranch_scc1 attn_slow_loop
    v_mov_b32 v9, v8
    s_nop 1
    v_permlane32_swap_b32 v8, v9
    v_max_f32 v8, v8, v9
    v_sub_f32 v32, 0, v8
    v_sub_f32 v33, 0, v8
    v_sub_f32 v34, 0, v8
    v_sub_f32 v35, 0, v8
    v_sub_f32 v36, 0, v8
    v_sub_f32 v37, 0, v8
    v_sub_f32 v38, 0, v8
    v_sub_f32 v39, 0, v8
    v_sub_f32 v40, 0, v8
    v_sub_f32 v41, 0, v8
    v_sub_f32 v42, 0, v8
    v_sub_f32 v43, 0, v8
    v_sub_f32 v44, 0, v8
    v_sub_f32 v45, 0, v8
    v_sub_f32 v46, 0, v8
    v_sub_f32 v47, 0, v8
    v_mov_b32 v11, v10
    s_nop 1
    v_permlane32_swap_b32 v10, v11
    v_max_f32 v10, v10, v11
    v_sub_f32 v48, 0, v10
    v_sub_f32 v49, 0, v10
    v_sub_f32 v50, 0, v10
    v_sub_f32 v51, 0, v10
    v_sub_f32 v52, 0, v10
    v_sub_f32 v53, 0, v10
    v_sub_f32 v54, 0, v10
    v_sub_f32 v55, 0, v10
    v_sub_f32 v56, 0, v10
    v_sub_f32 v57, 0, v10
    v_sub_f32 v58, 0, v10
    v_sub_f32 v59, 0, v10
    v_sub_f32 v60, 0, v10
    v_sub_f32 v61, 0, v10
    v_sub_f32 v62, 0, v10
    v_sub_f32 v63, 0, v10
    s_branch attn_restart
.p2align 6
woF_body:
    s_lshl_b32 s20, s99, 22
    s_add_u32 s21, s20, 4194304
    s_lshl_b32 s22, s99, 18
    s_add_u32 s22, s22, 58982400
    s_bitcmp1_b32 s99, 0
    s_cselect_b32 s23, 40, 16
    s_load_dwordx2 s[4:5], s[0:1], s23
    s_load_dwordx2 s[6:7], s[0:1], 64
    s_load_dwordx2 s[44:45], s[0:1], 48
    v_and_b32 v1, 63, v0
    v_lshrrev_b32 v2, 6, v0
    v_lshlrev_b32 v5, 4, v1
    v_readfirstlane_b32 s8, v2
    s_and_b32 s3, s2, 3
    s_lshl_b32 s3, s3, 2
    s_bfe_u32 s11, s2, 0x20003
    s_add_u32 s9, s3, s11
    s_bfe_u32 s3, s2, 0x10002
    s_lshl_b32 s3, s3, 3
    s_lshr_b32 s11, s2, 5
    s_add_u32 s10, s3, s11
    v_lshrrev_b32 v16, 3, v1
    v_lshlrev_b32 v17, 11, v16
    v_lshrrev_b32 v18, 2, v1
    v_lshrrev_b32 v19, 4, v1
    v_xor_b32 v18, v18, v19
    v_and_b32 v18, 1, v18
    v_lshl_add_u32 v17, v18, 6, v17
    v_and_b32 v18, 3, v1
    v_lshl_add_u32 v17, v18, 4, v17
    s_lshl_b32 s3, s10, 7
    v_add_u32 v6, s3, v17
    v_add_u32 v7, 15360, v6
    v_add_u32 v8, 30720, v6
    v_add_u32 v9, 46080, v6
    s_and_b32 s3, s8, 3
    s_lshl_b32 s41, s3, 12
    s_lshl_b32 s47, s3, 16
    s_lshl_b32 s3, s9, 2
    s_add_u32 s11, s3, s8
    s_lshl_b32 s42, s11, 16
    s_add_u32 s43, s42, 41943040
    s_add_u32 s43, s43, s20
    s_waitcnt lgkmcnt(0)
    s_mov_b32 s24, s4
    s_mov_b32 s25, s5
    s_mov_b32 s26, 2097152
    s_mov_b32 s27, 0x00020000
    s_cmp_gt_u32 s8, 3
    s_cbranch_scc1 woF_idle
    s_add_u32 s12, s6, s43
    s_addc_u32 s13, s7, 0
    s_mov_b32 s14, 65536
    s_mov_b32 s15, 0x00020000
    s_mov_b32 s28, s6
    s_mov_b32 s29, s7
    s_mov_b32 s30, 75497472
    s_mov_b32 s31, 0x00020000
    s_bitcmp1_b32 s99, 0
    s_cselect_b32 s53, 32, 16
    s_lshl_b32 s50, s96, 15
    s_add_u32 s50, s50, 71270400
    s_add_u32 s54, s28, s50
    s_addc_u32 s55, s29, 0
    s_mov_b32 s56, 0x40000
    s_lshl_b32 s57, s11, 8
woF_poll:
    s_mov_b32 s70, 0
    s_atomic_add s70, s[54:55], s57 offset:0 glc
    s_waitcnt lgkmcnt(0)
    s_cmp_eq_u32 s70, s53
    s_cbranch_scc1 woF_ready
    s_sub_u32 s56, s56, 1
    s_cmp_lg_u32 s56, 0
    s_cbranch_scc1 woF_poll
woF_ready:
    s_mov_b32 s40, 0
    buffer_load_dwordx4 v[112:115], v5, s[12:15], s40 offen offset:0 sc1
    buffer_load_dwordx4 v[116:119], v5, s[12:15], s40 offen offset:1024 sc1
    buffer_load_dwordx4 v[120:123], v5, s[12:15], s40 offen offset:2048 sc1
    buffer_load_dwordx4 v[124:127], v5, s[12:15], s40 offen offset:3072 sc1
    s_mov_b32 s40, 4096
    buffer_load_dwordx4 v[128:131], v5, s[12:15], s40 offen offset:0 sc1
    buffer_load_dwordx4 v[132:135], v5, s[12:15], s40 offen offset:1024 sc1
    v_lshrrev_b32 v3, 5, v1
    v_and_b32 v4, 15, v0
    v_lshrrev_b32 v16, 2, v4
    v_lshl_add_u32 v16, v3, 2, v16
    v_lshlrev_b32 v16, 7, v16
    v_bfe_u32 v17, v1, 4, 1
    v_lshl_add_u32 v16, v17, 5, v16
    v_and_b32 v17, 3, v4
    v_lshl_add_u32 v16, v17, 3, v16
    v_lshrrev_b32 v17, 3, v4
    v_lshlrev_b32 v18, 6, v17
    v_add_u32 v10, v16, v18
    v_sub_u32 v11, v16, v18
    s_add_u32 s52, s101, 16384
    v_add_u32 v12, s101, v10
    v_add_u32 v14, s52, v10
    v_add_u32 v13, s101, v11
    v_add_u32 v15, s52, v11
    s_mov_b32 s100, 0
    s_mov_b32 s101, 0
    v_mov_b32 v32, 0
    v_mov_b32 v33, 0
    v_mov_b32 v34, 0
    v_mov_b32 v35, 0
    v_mov_b32 v36, 0
    v_mov_b32 v37, 0
    v_mov_b32 v38, 0
    v_mov_b32 v39, 0
    v_mov_b32 v40, 0
    v_mov_b32 v41, 0
    v_mov_b32 v42, 0
    v_mov_b32 v43, 0
    v_mov_b32 v44, 0
    v_mov_b32 v45, 0
    v_mov_b32 v46, 0
    v_mov_b32 v47, 0
    v_mov_b32 v48, 0
    v_mov_b32 v49, 0
    v_mov_b32 v50, 0
    v_mov_b32 v51, 0
    v_mov_b32 v52, 0
    v_mov_b32 v53, 0
    v_mov_b32 v54, 0
    v_mov_b32 v55, 0
    v_mov_b32 v56, 0
    v_mov_b32 v57, 0
    v_mov_b32 v58, 0
    v_mov_b32 v59, 0
    v_mov_b32 v60, 0
    v_mov_b32 v61, 0
    v_mov_b32 v62, 0
    v_mov_b32 v63, 0
    buffer_load_dwordx4 v[136:139], v5, s[12:15], s40 offen offset:2048 sc1
    buffer_load_dwordx4 v[140:143], v5, s[12:15], s40 offen offset:3072 sc1
    s_mov_b32 s40, 8192
    buffer_load_dwordx4 v[144:147], v5, s[12:15], s40 offen offset:0 sc1
    buffer_load_dwordx4 v[148:151], v5, s[12:15], s40 offen offset:1024 sc1
    buffer_load_dwordx4 v[152:155], v5, s[12:15], s40 offen offset:2048 sc1
    buffer_load_dwordx4 v[156:159], v5, s[12:15], s40 offen offset:3072 sc1
    s_mov_b32 s40, 12288
    buffer_load_dwordx4 v[160:163], v5, s[12:15], s40 offen offset:0 sc1
    buffer_load_dwordx4 v[164:167], v5, s[12:15], s40 offen offset:1024 sc1
    buffer_load_dwordx4 v[168:171], v5, s[12:15], s40 offen offset:2048 sc1
    s_lshl_b32 s3, s10, 12
    s_add_u32 s48, s3, s42
    s_add_u32 s43, s48, s20
    buffer_load_dwordx4 v[96:99], v5, s[28:31], s43 offen offset:0 sc1
    buffer_load_dwordx4 v[100:103], v5, s[28:31], s43 offen offset:1024 sc1
    buffer_load_dwordx4 v[104:107], v5, s[28:31], s43 offen offset:2048 sc1
    buffer_load_dwordx4 v[108:111], v5, s[28:31], s43 offen offset:3072 sc1
    s_mov_b32 s32, 15360
    s_mov_b32 s33, 19456
    s_mov_b32 s34, 23552
    s_mov_b32 s35, 27648
    s_mov_b32 s40, 4
    s_barrier
    ds_read_b64_tr_b16 v[64:65], v12 offset:0
    ds_read_b64_tr_b16 v[66:67], v12 offset:1024
    ds_read_b64_tr_b16 v[68:69], v13 offset:64
    ds_read_b64_tr_b16 v[70:71], v13 offset:1088
    ds_read_b64_tr_b16 v[72:73], v12 offset:2048
    ds_read_b64_tr_b16 v[74:75], v12 offset:3072
    ds_read_b64_tr_b16 v[76:77], v13 offset:2112
    ds_read_b64_tr_b16 v[78:79], v13 offset:3136
    ds_read_b64_tr_b16 v[80:81], v12 offset:4096
    ds_read_b64_tr_b16 v[82:83], v12 offset:5120
    ds_read_b64_tr_b16 v[84:85], v13 offset:4160
    ds_read_b64_tr_b16 v[86:87], v13 offset:5184
woF_loop:
    s_waitcnt vmcnt(14) lgkmcnt(8)
    v_mfma_f32_32x32x16_bf16 v[32:47], v[64:67], v[112:115], v[32:47]
    ds_read_b64_tr_b16 v[88:89], v12 offset:6144
    ds_read_b64_tr_b16 v[90:91], v12 offset:7168
    buffer_load_dwordx4 v[172:175], v5, s[12:15], s32 offen offset:0 sc1
    v_mfma_f32_32x32x16_bf16 v[48:63], v[68:71], v[112:115], v[48:63]
    ds_read_b64_tr_b16 v[92:93], v13 offset:6208
    ds_read_b64_tr_b16 v[94:95], v13 offset:7232
    s_waitcnt vmcnt(14) lgkmcnt(8)
    v_mfma_f32_32x32x16_bf16 v[32:47], v[72:75], v[116:119], v[32:47]
    ds_read_b64_tr_b16 v[64:65], v12 offset:8192
    ds_read_b64_tr_b16 v[66:67], v12 offset:9216
    buffer_load_dwordx4 v[112:115], v5, s[12:15], s32 offen offset:1024 sc1
    v_mfma_f32_32x32x16_bf16 v[48:63], v[76:79], v[116:119], v[48:63]
    ds_read_b64_tr_b16 v[68:69], v13 offset:8256
    ds_read_b64_tr_b16 v[70:71], v13 offset:9280
    s_waitcnt vmcnt(14) lgkmcnt(8)
    v_mfma_f32_32x32x16_bf16 v[32:47], v[80:83], v[120:123], v[32:47]
    ds_read_b64_tr_b16 v[72:73], v12 offset:10240
    ds_read_b64_tr_b16 v[74:75], v12 offset:11264
    buffer_load_dwordx4 v[116:119], v5, s[12:15], s32 offen offset:2048 sc1
    v_mfma_f32_32x32x16_bf16 v[48:63], v[84:87], v[120:123], v[48:63]
    ds_read_b64_tr_b16 v[76:77], v13 offset:10304
    ds_read_b64_tr_b16 v[78:79], v13 offset:11328
    s_waitcnt vmcnt(14) lgkmcnt(8)
    v_mfma_f32_32x32x16_bf16 v[32:47], v[88:91], v[124:127], v[32:47]
    ds_read_b64_tr_b16 v[80:81], v12 offset:12288
    ds_read_b64_tr_b16 v[82:83], v12 offset:13312
    buffer_load_dwordx4 v[120:123], v5, s[12:15], s32 offen offset:3072 sc1
    v_mfma_f32_32x32x16_bf16 v[48:63], v[92:95], v[124:127], v[48:63]
    ds_read_b64_tr_b16 v[84:85], v13 offset:12352
    ds_read_b64_tr_b16 v[86:87], v13 offset:13376
    s_waitcnt vmcnt(14) lgkmcnt(8)
    v_mfma_f32_32x32x16_bf16 v[32:47], v[64:67], v[128:131], v[32:47]
    ds_read_b64_tr_b16 v[88:89], v12 offset:14336
    ds_read_b64_tr_b16 v[90:91], v12 offset:15360
    buffer_load_dwordx4 v[124:127], v5, s[12:15], s33 offen offset:0 sc1
    v_mfma_f32_32x32x16_bf16 v[48:63], v[68:71], v[128:131], v[48:63]
    ds_read_b64_tr_b16 v[92:93], v13 offset:14400
    ds_read_b64_tr_b16 v[94:95], v13 offset:15424
    s_add_u32 s52, s52, 16384
    s_sub_u32 s3, s52, 147456
    s_cmp_ge_u32 s52, 147456
    s_cselect_b32 s52, s3, s52
    v_add_u32 v12, s52, v10
    v_add_u32 v13, s52, v11
    s_barrier
    s_waitcnt vmcnt(14) lgkmcnt(8)
    v_mfma_f32_32x32x16_bf16 v[32:47], v[72:75], v[132:135], v[32:47]
    ds_read_b64_tr_b16 v[64:65], v14 offset:0
    ds_read_b64_tr_b16 v[66:67], v14 offset:1024
    buffer_load_dwordx4 v[128:131], v5, s[12:15], s33 offen offset:1024 sc1
    v_mfma_f32_32x32x16_bf16 v[48:63], v[76:79], v[132:135], v[48:63]
    ds_read_b64_tr_b16 v[68:69], v15 offset:64
    ds_read_b64_tr_b16 v[70:71], v15 offset:1088
    s_waitcnt vmcnt(14) lgkmcnt(8)
    v_mfma_f32_32x32x16_bf16 v[32:47], v[80:83], v[136:139], v[32:47]
    ds_read_b64_tr_b16 v[72:73], v14 offset:2048
    ds_read_b64_tr_b16 v[74:75], v14 offset:3072
    buffer_load_dwordx4 v[132:135], v5, s[12:15], s33 offen offset:2048 sc1
    v_mfma_f32_32x32x16_bf16 v[48:63], v[84:87], v[136:139], v[48:63]
    ds_read_b64_tr_b16 v[76:77], v15 offset:2112
    ds_read_b64_tr_b16 v[78:79], v15 offset:3136
    s_waitcnt vmcnt(14) lgkmcnt(8)
    v_mfma_f32_32x32x16_bf16 v[32:47], v[88:91], v[140:143], v[32:47]
    ds_read_b64_tr_b16 v[80:81], v14 offset:4096
    ds_read_b64_tr_b16 v[82:83], v14 offset:5120
    buffer_load_dwordx4 v[136:139], v5, s[12:15], s33 offen offset:3072 sc1
    v_mfma_f32_32x32x16_bf16 v[48:63], v[92:95], v[140:143], v[48:63]
    ds_read_b64_tr_b16 v[84:85], v15 offset:4160
    ds_read_b64_tr_b16 v[86:87], v15 offset:5184
    s_waitcnt vmcnt(14) lgkmcnt(8)
    v_mfma_f32_32x32x16_bf16 v[32:47], v[64:67], v[144:147], v[32:47]
    ds_read_b64_tr_b16 v[88:89], v14 offset:6144
    ds_read_b64_tr_b16 v[90:91], v14 offset:7168
    buffer_load_dwordx4 v[140:143], v5, s[12:15], s34 offen offset:0 sc1
    v_mfma_f32_32x32x16_bf16 v[48:63], v[68:71], v[144:147], v[48:63]
    ds_read_b64_tr_b16 v[92:93], v15 offset:6208
    ds_read_b64_tr_b16 v[94:95], v15 offset:7232
    s_waitcnt vmcnt(14) lgkmcnt(8)
    v_mfma_f32_32x32x16_bf16 v[32:47], v[72:75], v[148:151], v[32:47]
    ds_read_b64_tr_b16 v[64:65], v14 offset:8192
    ds_read_b64_tr_b16 v[66:67], v14 offset:9216
    buffer_load_dwordx4 v[144:147], v5, s[12:15], s34 offen offset:1024 sc1
    v_mfma_f32_32x32x16_bf16 v[48:63], v[76:79], v[148:151], v[48:63]
    ds_read_b64_tr_b16 v[68:69], v15 offset:8256
    ds_read_b64_tr_b16 v[70:71], v15 offset:9280
    s_waitcnt vmcnt(14) lgkmcnt(8)
    v_mfma_f32_32x32x16_bf16 v[32:47], v[80:83], v[152:155], v[32:47]
    ds_read_b64_tr_b16 v[72:73], v14 offset:10240
    ds_read_b64_tr_b16 v[74:75], v14 offset:11264
    buffer_load_dwordx4 v[148:151], v5, s[12:15], s34 offen offset:2048 sc1
    v_mfma_f32_32x32x16_bf16 v[48:63], v[84:87], v[152:155], v[48:63]
    ds_read_b64_tr_b16 v[76:77], v15 offset:10304
    ds_read_b64_tr_b16 v[78:79], v15 offset:11328
    s_waitcnt vmcnt(14) lgkmcnt(8)
    v_mfma_f32_32x32x16_bf16 v[32:47], v[88:91], v[156:159], v[32:47]
    ds_read_b64_tr_b16 v[80:81], v14 offset:12288
    ds_read_b64_tr_b16 v[82:83], v14 offset:13312
    buffer_load_dwordx4 v[152:155], v5, s[12:15], s34 offen offset:3072 sc1
    v_mfma_f32_32x32x16_bf16 v[48:63], v[92:95], v[156:159], v[48:63]
    ds_read_b64_tr_b16 v[84:85], v15 offset:12352
    ds_read_b64_tr_b16 v[86:87], v15 offset:13376
    s_waitcnt vmcnt(14) lgkmcnt(8)
    v_mfma_f32_32x32x16_bf16 v[32:47], v[64:67], v[160:163], v[32:47]
    ds_read_b64_tr_b16 v[88:89], v14 offset:14336
    ds_read_b64_tr_b16 v[90:91], v14 offset:15360
    buffer_load_dwordx4 v[156:159], v5, s[12:15], s35 offen offset:0 sc1
    v_mfma_f32_32x32x16_bf16 v[48:63], v[68:71], v[160:163], v[48:63]
    ds_read_b64_tr_b16 v[92:93], v15 offset:14400
    ds_read_b64_tr_b16 v[94:95], v15 offset:15424
    s_add_u32 s52, s52, 16384
    s_sub_u32 s3, s52, 147456
    s_cmp_ge_u32 s52, 147456
    s_cselect_b32 s52, s3, s52
    v_add_u32 v14, s52, v10
    v_add_u32 v15, s52, v11
    s_barrier
    s_waitcnt vmcnt(14) lgkmcnt(8)
    v_mfma_f32_32x32x16_bf16 v[32:47], v[72:75], v[164:167], v[32:47]
    ds_read_b64_tr_b16 v[64:65], v12 offset:0
    ds_read_b64_tr_b16 v[66:67], v12 offset:1024
    buffer_load_dwordx4 v[160:163], v5, s[12:15], s35 offen offset:1024 sc1
    v_mfma_f32_32x32x16_bf16 v[48:63], v[76:79], v[164:167], v[48:63]
    ds_read_b64_tr_b16 v[68:69], v13 offset:64
    ds_read_b64_tr_b16 v[70:71], v13 offset:1088
    s_waitcnt vmcnt(14) lgkmcnt(8)
    v_mfma_f32_32x32x16_bf16 v[32:47], v[80:83], v[168:171], v[32:47]
    ds_read_b64_tr_b16 v[72:73], v12 offset:2048
    ds_read_b64_tr_b16 v[74:75], v12 offset:3072
    buffer_load_dwordx4 v[164:167], v5, s[12:15], s35 offen offset:2048 sc1
    v_mfma_f32_32x32x16_bf16 v[48:63], v[84:87], v[168:171], v[48:63]
    ds_read_b64_tr_b16 v[76:77], v13 offset:2112
    ds_read_b64_tr_b16 v[78:79], v13 offset:3136
    s_waitcnt vmcnt(14) lgkmcnt(8)
    v_mfma_f32_32x32x16_bf16 v[32:47], v[88:91], v[172:175], v[32:47]
    ds_read_b64_tr_b16 v[80:81], v12 offset:4096
    ds_read_b64_tr_b16 v[82:83], v12 offset:5120
    buffer_load_dwordx4 v[168:171], v5, s[12:15], s35 offen offset:3072 sc1
    v_mfma_f32_32x32x16_bf16 v[48:63], v[92:95], v[172:175], v[48:63]
    ds_read_b64_tr_b16 v[84:85], v13 offset:4160
    ds_read_b64_tr_b16 v[86:87], v13 offset:5184
    s_add_u32 s32, s32, 16384
    s_add_u32 s33, s33, 16384
    s_add_u32 s34, s34, 16384
    s_add_u32 s35, s35, 16384
    s_sub_u32 s40, s40, 1
    s_cmp_lg_u32 s40, 0
    s_cbranch_scc1 woF_loop
    s_mov_b32 s46, 0xffff0000
    v_lshlrev_b32 v64, 16, v96
    v_and_b32 v65, s46, v96
    v_lshlrev_b32 v66, 16, v97
    v_and_b32 v67, s46, v97
    v_lshlrev_b32 v68, 16, v98
    v_and_b32 v69, s46, v98
    v_lshlrev_b32 v70, 16, v99
    v_and_b32 v71, s46, v99
    v_lshlrev_b32 v72, 16, v100
    v_and_b32 v73, s46, v100
    v_lshlrev_b32 v74, 16, v101
    v_and_b32 v75, s46, v101
    v_lshlrev_b32 v76, 16, v102
    v_and_b32 v77, s46, v102
    v_lshlrev_b32 v78, 16, v103
    v_and_b32 v79, s46, v103
    v_lshlrev_b32 v80, 16, v104
    v_and_b32 v81, s46, v104
    v_lshlrev_b32 v82, 16, v105
    v_and_b32 v83, s46, v105
    v_lshlrev_b32 v84, 16, v106
    v_and_b32 v85, s46, v106
    v_lshlrev_b32 v86, 16, v107
    v_and_b32 v87, s46, v107
    v_lshlrev_b32 v88, 16, v108
    v_and_b32 v89, s46, v108
    v_lshlrev_b32 v90, 16, v109
    v_and_b32 v91, s46, v109
    v_lshlrev_b32 v92, 16, v110
    v_and_b32 v93, s46, v110
    v_lshlrev_b32 v94, 16, v111
    v_and_b32 v95, s46, v111
    v_pk_add_f32 v[32:33], v[32:33], v[64:65]
    v_pk_add_f32 v[34:35], v[34:35], v[66:67]
    v_pk_add_f32 v[36:37], v[36:37], v[68:69]
    v_pk_add_f32 v[38:39], v[38:39], v[70:71]
    v_pk_add_f32 v[40:41], v[40:41], v[72:73]
    v_pk_add_f32 v[42:43], v[42:43], v[74:75]
    v_pk_add_f32 v[44:45], v[44:45], v[76:77]
    v_pk_add_f32 v[46:47], v[46:47], v[78:79]
    v_pk_add_f32 v[48:49], v[48:49], v[80:81]
    v_pk_add_f32 v[50:51], v[50:51], v[82:83]
    v_pk_add_f32 v[52:53], v[52:53], v[84:85]
    v_pk_add_f32 v[54:55], v[54:55], v[86:87]
    v_pk_add_f32 v[56:57], v[56:57], v[88:89]
    v_pk_add_f32 v[58:59], v[58:59], v[90:91]
    v_pk_add_f32 v[60:61], v[60:61], v[92:93]
    v_pk_add_f32 v[62:63], v[62:63], v[94:95]
    v_cvt_pk_bf16_f32 v96, v32, v33
    v_cvt_pk_bf16_f32 v97, v34, v35
    v_cvt_pk_bf16_f32 v98, v36, v37
    v_cvt_pk_bf16_f32 v99, v38, v39
    v_cvt_pk_bf16_f32 v100, v40, v41
    v_cvt_pk_bf16_f32 v101, v42, v43
    v_cvt_pk_bf16_f32 v102, v44, v45
    v_cvt_pk_bf16_f32 v103, v46, v47
    v_cvt_pk_bf16_f32 v104, v48, v49
    v_cvt_pk_bf16_f32 v105, v50, v51
    v_cvt_pk_bf16_f32 v106, v52, v53
    v_cvt_pk_bf16_f32 v107, v54, v55
    v_cvt_pk_bf16_f32 v108, v56, v57
    v_cvt_pk_bf16_f32 v109, v58, v59
    v_cvt_pk_bf16_f32 v110, v60, v61
    v_cvt_pk_bf16_f32 v111, v62, v63
    s_mov_b32 s12, s44
    s_mov_b32 s13, s45
    s_mov_b32 s14, 4194304
    s_mov_b32 s15, 0x00020000
    s_barrier
    v_and_b32 v16, 31, v1
    v_mul_u32_u24 v16, 144, v16
    v_lshl_add_u32 v16, v3, 3, v16
    v_mul_u32_u24 v17, 4608, v2
    v_add_u32 v16, v16, v17
    ds_write_b64 v16, v[96:97] offset:0
    ds_write_b64 v16, v[98:99] offset:16
    ds_write_b64 v16, v[100:101] offset:32
    ds_write_b64 v16, v[102:103] offset:48
    ds_write_b64 v16, v[104:105] offset:64
    ds_write_b64 v16, v[106:107] offset:80
    ds_write_b64 v16, v[108:109] offset:96
    ds_write_b64 v16, v[110:111] offset:112
    v_lshrrev_b32 v18, 3, v1
    v_and_b32 v19, 7, v1
    v_mul_u32_u24 v20, 144, v18
    v_lshl_add_u32 v20, v19, 4, v20
    v_add_u32 v20, v20, v17
    v_lshlrev_b32 v21, 11, v18
    v_lshl_add_u32 v21, v19, 4, v21
    s_lshl_b32 s3, s11, 16
    s_lshl_b32 s43, s10, 7
    s_add_u32 s3, s3, s43
    s_waitcnt lgkmcnt(0)
    ds_read_b128 v[32:35], v20 offset:0
    ds_read_b128 v[36:39], v20 offset:1152
    ds_read_b128 v[40:43], v20 offset:2304
    ds_read_b128 v[44:47], v20 offset:3456
    s_waitcnt lgkmcnt(3)
    buffer_store_dwordx4 v[32:35], v21, s[12:15], s3 offen sc1
    s_add_u32 s3, s3, 16384
    s_waitcnt lgkmcnt(2)
    buffer_store_dwordx4 v[36:39], v21, s[12:15], s3 offen sc1
    s_add_u32 s3, s3, 16384
    s_waitcnt lgkmcnt(1)
    buffer_store_dwordx4 v[40:43], v21, s[12:15], s3 offen sc1
    s_add_u32 s3, s3, 16384
    s_waitcnt lgkmcnt(0)
    buffer_store_dwordx4 v[44:47], v21, s[12:15], s3 offen sc1
    s_add_u32 s3, s3, 16384
    s_cmp_eq_u32 s96, s98
    s_cbranch_scc1 mega_exit
    s_lshl_b32 s50, s96, 15
    s_lshl_b32 s51, s11, 8
    s_add_u32 s50, s50, s51
    s_add_u32 s50, s50, 71303168
    s_add_u32 s54, s28, s50
    s_addc_u32 s55, s29, 0
    s_mov_b32 s59, 1
    s_waitcnt vmcnt(0)
    s_atomic_add s59, s[54:55], 0
    s_branch mega_next2
woF_idle:
    s_and_b32 s41, s8, 3
    s_lshr_b32 s47, s100, 4
woF_ld:
    s_cmp_ge_u32 s47, 8
    s_cbranch_scc1 woF_ld_end
    s_lshl_b32 s50, s47, 14
    s_add_u32 s50, s50, s101
    s_sub_u32 s51, s50, 147456
    s_cmp_ge_u32 s50, 147456
    s_cselect_b32 s50, s51, s50
    s_lshl_b32 s51, s41, 12
    s_add_u32 m0, s50, s51
    s_lshl_b32 s50, s47, 18
    s_lshl_b32 s51, s41, 16
    s_add_u32 s50, s50, s51
    buffer_load_dwordx4 v6, s[24:27], s50 offen offset:0 lds
    buffer_load_dwordx4 v7, s[24:27], s50 offen offset:1024 lds
    buffer_load_dwordx4 v8, s[24:27], s50 offen offset:2048 lds
    buffer_load_dwordx4 v9, s[24:27], s50 offen offset:3072 lds
    s_add_u32 s47, s47, 1
    s_branch woF_ld
woF_ld_end:
    s_mov_b32 s100, 0
    s_mov_b32 s101, 0
    s_waitcnt vmcnt(28)
    s_barrier
    s_waitcnt vmcnt(24)
    s_barrier
    s_waitcnt vmcnt(20)
    s_barrier
    s_waitcnt vmcnt(16)
    s_barrier
    s_waitcnt vmcnt(12)
    s_barrier
    s_waitcnt vmcnt(8)
    s_barrier
    s_waitcnt vmcnt(4)
    s_barrier
    s_waitcnt vmcnt(0)
    s_barrier
    s_barrier
    s_barrier
    s_cmp_eq_u32 s96, s98
    s_cbranch_scc1 mega_exit
    s_branch mega_next
    s_endpgm
.section .rodata,"a"
.p2align 6
.amdhsa_kernel interleave_layers__sliding_local_dilated__softmax_full_mha__prompt_kernel
  .amdhsa_next_free_vgpr 256
  .amdhsa_next_free_sgpr 102
  .amdhsa_accum_offset 224
  .amdhsa_group_segment_fixed_size 0
  .amdhsa_kernarg_size 72
  .amdhsa_user_sgpr_count 2
  .amdhsa_user_sgpr_kernarg_segment_ptr 1
  .amdhsa_system_sgpr_workgroup_id_x 1
.end_amdhsa_kernel
```

```asm
; @launch grid=(256,1,1) block=(512,1,1) lds=156736
.amdgcn_target "amdgcn-amd-amdhsa--gfx950"
.text
.globl interleave_layers__sliding_local_dilated__softmax_full_mha__prompt_kernel
.type interleave_layers__sliding_local_dilated__softmax_full_mha__prompt_kernel,@function
.p2align 8
interleave_layers__sliding_local_dilated__softmax_full_mha__prompt_kernel:
    s_cmp_ge_u32 s2, 256
    s_cbranch_scc1 k_exit
    s_load_dwordx2 s[36:37], s[0:1], 0
    s_load_dwordx4 s[24:27], s[0:1], 8
    s_load_dwordx8 s[28:35], s[0:1], 32
    s_load_dwordx2 s[44:45], s[0:1], 64
    v_lshrrev_b32 v2, 6, v0
    v_and_b32 v0, 63, v0
    v_readfirstlane_b32 s16, v2
    v_lshlrev_b32 v1, 4, v0
    s_mov_b32 s21, 0
    s_mov_b32 s40, 1
    s_and_b32 s3, s2, 1
    s_lshl_b32 s3, s3, 3
    s_bfe_u32 s17, s2, 0x30003
    s_add_u32 s17, s17, s3
    s_bfe_u32 s3, s2, 0x20001
    s_lshl_b32 s3, s3, 2
    s_lshr_b32 s18, s2, 6
    s_add_u32 s18, s18, s3
    s_and_b32 s3, s2, 3
    s_lshl_b32 s3, s3, 2
    s_bfe_u32 s19, s2, 0x20003
    s_add_u32 s19, s19, s3
    s_bfe_u32 s3, s2, 0x10002
    s_lshl_b32 s3, s3, 3
    s_lshr_b32 s20, s2, 5
    s_add_u32 s20, s20, s3
    s_and_b32 s3, s16, 3
    s_lshl_b32 s38, s17, 2
    s_add_u32 s38, s38, s3
    s_lshl_b32 s39, s19, 2
    s_add_u32 s39, s39, s3
    v_mov_b32 v12, 0
    v_mov_b32 v13, 0
    v_mov_b32 v14, 0
    v_mov_b32 v15, 0
    s_mov_b32 s41, 0
    s_mov_b32 s42, 0
    s_mov_b32 s43, 0
    s_mov_b32 s62, 0
    s_waitcnt lgkmcnt(0)
    s_mov_b32 s4, s44
    s_mov_b32 s5, s45
    s_mov_b32 s6, 67108864
    s_mov_b32 s7, 0x00020000
    s_add_u32 s22, s44, 58720256
    s_addc_u32 s23, s45, 0
    s_load_dword s100, s[22:23], 217088
    s_cmp_eq_u32 s16, 4
    s_cbranch_scc1 h_start
    s_cmp_eq_u32 s16, 7
    s_cbranch_scc1 z_start
    s_cmp_gt_u32 s16, 4
    s_cbranch_scc1 l_start
    s_mov_b32 s8, s36
    s_mov_b32 s9, s37
    s_mov_b32 s10, 4194304
    s_mov_b32 s11, 0x00020000
    v_lshrrev_b32 v8, 4, v1
    v_lshrrev_b32 v32, 3, v8
    v_and_b32 v33, 7, v8
    v_lshlrev_b32 v34, 11, v32
    v_lshl_add_u32 v34, v33, 4, v34
    s_lshl_b32 s44, s39, 16
    s_lshl_b32 s45, s20, 7
    s_add_u32 s46, s44, s45
    buffer_load_dwordx4 v[40:43], v34, s[8:11], s46 offen
    s_add_u32 s46, s46, 16384
    buffer_load_dwordx4 v[44:47], v34, s[8:11], s46 offen
    s_add_u32 s46, s46, 16384
    buffer_load_dwordx4 v[48:51], v34, s[8:11], s46 offen
    s_add_u32 s46, s46, 16384
    buffer_load_dwordx4 v[52:55], v34, s[8:11], s46 offen
    v_lshrrev_b32 v12, 4, v1
    v_and_b32 v13, 15, v12
    v_bfe_u32 v14, v12, 4, 1
    v_lshrrev_b32 v12, 5, v12
    v_lshl_add_u32 v2, v14, 5, v13
    v_lshlrev_b32 v2, 4, v2
    v_lshl_add_u32 v2, v12, 10, v2
    v_lshrrev_b32 v15, 2, v13
    v_lshl_add_u32 v15, v14, 2, v15
    v_lshlrev_b32 v3, 7, v15
    v_lshl_add_u32 v3, v12, 11, v3
    v_and_b32 v15, 3, v13
    v_lshl_add_u32 v3, v15, 3, v3
    v_lshrrev_b32 v15, 3, v13
    v_lshl_add_u32 v15, v15, 1, v14
    v_lshl_add_u32 v3, v15, 5, v3
    v_xor_b32 v4, 32, v3
    v_xor_b32 v5, 64, v3
    v_xor_b32 v6, 96, v3
    s_lshl_b32 s45, s16, 12
    s_add_u32 s45, s45, 131072
    v_lshrrev_b32 v35, 1, v33
    v_lshlrev_b32 v35, 10, v35
    v_lshl_add_u32 v35, v32, 4, v35
    v_and_b32 v36, 1, v33
    v_lshl_add_u32 v35, v36, 3, v35
    v_add_u32 v35, s45, v35
    v_add_u32 v36, s45, v1
    v_mov_b32 v37, 0x3f803f80
    v_and_b32 v38, 3, v8
    v_lshl_add_u32 v39, v38, 3, v32
    v_lshlrev_b32 v39, 3, v39
    v_mov_b32 v56, 0
    v_mov_b32 v57, 0
    v_mov_b32 v58, 0
    v_mov_b32 v59, 0
    v_mov_b32 v60, 0
    v_mov_b32 v61, 0
    v_mov_b32 v62, 0
    v_mov_b32 v63, 0
    s_waitcnt vmcnt(3)
    ds_write_b64 v35, v[40:41] offset:0
    ds_write_b64 v35, v[42:43] offset:512
    s_waitcnt vmcnt(2)
    ds_write_b64 v35, v[44:45] offset:128
    ds_write_b64 v35, v[46:47] offset:640
    s_waitcnt vmcnt(1)
    ds_write_b64 v35, v[48:49] offset:256
    ds_write_b64 v35, v[50:51] offset:768
    s_waitcnt vmcnt(0)
    ds_write_b64 v35, v[52:53] offset:384
    ds_write_b64 v35, v[54:55] offset:896
    ds_read_b128 v[64:67], v36 offset:0
    ds_read_b128 v[68:71], v36 offset:1024
    ds_read_b128 v[72:75], v36 offset:2048
    ds_read_b128 v[76:79], v36 offset:3072
    s_lshl_b32 s45, s20, 12
    s_add_u32 s46, s44, s45
    s_waitcnt lgkmcnt(3)
    buffer_store_dwordx4 v[64:67], v1, s[4:7], s46 offen offset:0 sc1
    s_waitcnt lgkmcnt(2)
    buffer_store_dwordx4 v[68:71], v1, s[4:7], s46 offen offset:1024 sc1
    s_waitcnt lgkmcnt(1)
    buffer_store_dwordx4 v[72:75], v1, s[4:7], s46 offen offset:2048 sc1
    s_waitcnt lgkmcnt(0)
    buffer_store_dwordx4 v[76:79], v1, s[4:7], s46 offen offset:3072 sc1
    v_dot2_f32_bf16 v56, v40, v37, v56
    v_dot2_f32_bf16 v57, v40, v40, v57
    v_dot2_f32_bf16 v58, v44, v37, v58
    v_dot2_f32_bf16 v59, v44, v44, v59
    v_dot2_f32_bf16 v60, v48, v37, v60
    v_dot2_f32_bf16 v61, v48, v48, v61
    v_dot2_f32_bf16 v62, v52, v37, v62
    v_dot2_f32_bf16 v63, v52, v52, v63
    v_dot2_f32_bf16 v56, v41, v37, v56
    v_dot2_f32_bf16 v57, v41, v41, v57
    v_dot2_f32_bf16 v58, v45, v37, v58
    v_dot2_f32_bf16 v59, v45, v45, v59
    v_dot2_f32_bf16 v60, v49, v37, v60
    v_dot2_f32_bf16 v61, v49, v49, v61
    v_dot2_f32_bf16 v62, v53, v37, v62
    v_dot2_f32_bf16 v63, v53, v53, v63
    v_dot2_f32_bf16 v56, v42, v37, v56
    v_dot2_f32_bf16 v57, v42, v42, v57
    v_dot2_f32_bf16 v58, v46, v37, v58
    v_dot2_f32_bf16 v59, v46, v46, v59
    v_dot2_f32_bf16 v60, v50, v37, v60
    v_dot2_f32_bf16 v61, v50, v50, v61
    v_dot2_f32_bf16 v62, v54, v37, v62
    v_dot2_f32_bf16 v63, v54, v54, v63
    v_dot2_f32_bf16 v56, v43, v37, v56
    v_dot2_f32_bf16 v57, v43, v43, v57
    v_dot2_f32_bf16 v58, v47, v37, v58
    v_dot2_f32_bf16 v59, v47, v47, v59
    v_dot2_f32_bf16 v60, v51, v37, v60
    v_dot2_f32_bf16 v61, v51, v51, v61
    v_dot2_f32_bf16 v62, v55, v37, v62
    v_dot2_f32_bf16 v63, v55, v55, v63
    s_nop 2
    v_add_f32_dpp v56, v56, v56 quad_perm:[1,0,3,2] row_mask:0xf bank_mask:0xf
    v_add_f32_dpp v57, v57, v57 quad_perm:[1,0,3,2] row_mask:0xf bank_mask:0xf
    v_add_f32_dpp v58, v58, v58 quad_perm:[1,0,3,2] row_mask:0xf bank_mask:0xf
    v_add_f32_dpp v59, v59, v59 quad_perm:[1,0,3,2] row_mask:0xf bank_mask:0xf
    v_add_f32_dpp v60, v60, v60 quad_perm:[1,0,3,2] row_mask:0xf bank_mask:0xf
    v_add_f32_dpp v61, v61, v61 quad_perm:[1,0,3,2] row_mask:0xf bank_mask:0xf
    v_add_f32_dpp v62, v62, v62 quad_perm:[1,0,3,2] row_mask:0xf bank_mask:0xf
    v_add_f32_dpp v63, v63, v63 quad_perm:[1,0,3,2] row_mask:0xf bank_mask:0xf
    v_add_f32_dpp v56, v56, v56 quad_perm:[2,3,0,1] row_mask:0xf bank_mask:0xf
    v_add_f32_dpp v57, v57, v57 quad_perm:[2,3,0,1] row_mask:0xf bank_mask:0xf
    v_add_f32_dpp v58, v58, v58 quad_perm:[2,3,0,1] row_mask:0xf bank_mask:0xf
    v_add_f32_dpp v59, v59, v59 quad_perm:[2,3,0,1] row_mask:0xf bank_mask:0xf
    v_add_f32_dpp v60, v60, v60 quad_perm:[2,3,0,1] row_mask:0xf bank_mask:0xf
    v_add_f32_dpp v61, v61, v61 quad_perm:[2,3,0,1] row_mask:0xf bank_mask:0xf
    v_add_f32_dpp v62, v62, v62 quad_perm:[2,3,0,1] row_mask:0xf bank_mask:0xf
    v_add_f32_dpp v63, v63, v63 quad_perm:[2,3,0,1] row_mask:0xf bank_mask:0xf
    v_add_f32_dpp v56, v56, v56 row_half_mirror row_mask:0xf bank_mask:0xf
    v_add_f32_dpp v57, v57, v57 row_half_mirror row_mask:0xf bank_mask:0xf
    v_add_f32_dpp v58, v58, v58 row_half_mirror row_mask:0xf bank_mask:0xf
    v_add_f32_dpp v59, v59, v59 row_half_mirror row_mask:0xf bank_mask:0xf
    v_add_f32_dpp v60, v60, v60 row_half_mirror row_mask:0xf bank_mask:0xf
    v_add_f32_dpp v61, v61, v61 row_half_mirror row_mask:0xf bank_mask:0xf
    v_add_f32_dpp v62, v62, v62 row_half_mirror row_mask:0xf bank_mask:0xf
    v_add_f32_dpp v63, v63, v63 row_half_mirror row_mask:0xf bank_mask:0xf
    v_cmp_eq_u32 vcc, 1, v38
    s_nop 1
    v_cndmask_b32 v56, v56, v58, vcc
    v_cndmask_b32 v57, v57, v59, vcc
    v_cmp_eq_u32 vcc, 2, v38
    s_nop 1
    v_cndmask_b32 v56, v56, v60, vcc
    v_cndmask_b32 v57, v57, v61, vcc
    v_cmp_eq_u32 vcc, 3, v38
    s_nop 1
    v_cndmask_b32 v56, v56, v62, vcc
    v_cndmask_b32 v57, v57, v63, vcc
    s_lshl_b32 s44, s21, 18
    s_lshl_b32 s45, s39, 12
    s_add_u32 s44, s44, s45
    s_lshl_b32 s45, s20, 8
    s_add_u32 s44, s44, s45
    s_add_u32 s44, s44, 50331648
    buffer_store_dwordx2 v[56:57], v39, s[4:7], s44 offen sc1
    s_lshl_b32 s46, s21, 14
    s_lshl_b32 s67, s39, 7
    s_add_u32 s46, s46, s67
    s_add_u32 s46, s46, 4096
    s_add_u32 s47, s46, 8192
    s_barrier
    s_waitcnt vmcnt(1)
    s_load_dword s68, s[34:35], 0
    s_mov_b32 s8, s34
    s_mov_b32 s9, s35
    s_mov_b32 s10, 256
    s_mov_b32 s11, 0x00020000
    s_mov_b32 s66, 0x10000
    v_mov_b32 v16, 0
    s_waitcnt lgkmcnt(0)
c_f0:
    s_cmp_eq_u32 s68, 1
    s_cbranch_scc1 c_f0_ok
    buffer_load_dword v17, v16, s[8:11], 0 offen offset:0 sc1
    s_waitcnt vmcnt(0)
    v_readfirstlane_b32 s68, v17
    s_sub_u32 s66, s66, 1
    s_cmp_lg_u32 s66, 0
    s_cbranch_scc1 c_f0
c_f0_ok:
    s_atomic_add s40, s[22:23], s46
c_layer:
    s_lshl_b32 s48, s21, 22
    s_lshl_b32 s49, s38, 16
    s_add_u32 s41, s48, s49
    s_lshl_b32 s48, s21, 14
    s_lshl_b32 s67, s38, 7
    s_add_u32 s48, s48, s67
    s_add_u32 s48, s48, 4096
    v_lshrrev_b32 v16, 4, v1
    v_and_b32 v17, 15, v16
    v_lshrrev_b32 v16, 4, v16
    s_lshl_b32 s49, s16, 7
    s_add_u32 s50, s49, 151552
    s_and_b32 s49, s21, 1
    s_lshl_b32 s49, s49, 10
    s_add_u32 s49, s49, 151552
    v_lshlrev_b32 v11, 4, v16
    v_add_u32 v13, s50, v11
    v_add_u32 v11, s49, v11
    v_lshlrev_b32 v15, 2, v17
    v_add_u32 v9, s50, v15
    v_add_u32 v15, s49, v15
    s_mov_b32 s66, 0x10000
c_x_poll:
    s_mov_b32 s68, 0
    s_atomic_add s68, s[22:23], s48 offset:0 glc
    s_waitcnt lgkmcnt(0)
    s_cmp_eq_u32 s68, 16
    s_cbranch_scc1 c_x_ok
    s_sub_u32 s66, s66, 1
    s_cmp_lg_u32 s66, 0
    s_cbranch_scc1 c_x_poll
c_x_ok:
    s_waitcnt vmcnt(0)
    s_atomic_add s40, s[22:23], s47
    s_add_u32 s42, s41, 0
    buffer_load_dwordx4 v[160:163], v2, s[4:7], s42 offen offset:0 sc1
    buffer_load_dwordx4 v[164:167], v2, s[4:7], s42 offen offset:256 sc1
    buffer_load_dwordx4 v[168:171], v2, s[4:7], s42 offen offset:2048 sc1
    buffer_load_dwordx4 v[172:175], v2, s[4:7], s42 offen offset:2304 sc1
    s_add_u32 s42, s41, 4096
    buffer_load_dwordx4 v[176:179], v2, s[4:7], s42 offen offset:0 sc1
    buffer_load_dwordx4 v[180:183], v2, s[4:7], s42 offen offset:256 sc1
    buffer_load_dwordx4 v[184:187], v2, s[4:7], s42 offen offset:2048 sc1
    buffer_load_dwordx4 v[188:191], v2, s[4:7], s42 offen offset:2304 sc1
    s_barrier
    ds_read_b64_tr_b16 v[32:33], v3 offset:0
    ds_read_b64_tr_b16 v[34:35], v3 offset:1024
    ds_read_b64_tr_b16 v[36:37], v4 offset:0
    ds_read_b64_tr_b16 v[38:39], v4 offset:1024
    ds_read_b64_tr_b16 v[40:41], v5 offset:0
    ds_read_b64_tr_b16 v[42:43], v5 offset:1024
    ds_read_b64_tr_b16 v[44:45], v6 offset:0
    ds_read_b64_tr_b16 v[46:47], v6 offset:1024
    ds_read_b64_tr_b16 v[48:49], v3 offset:4096
    ds_read_b64_tr_b16 v[50:51], v3 offset:5120
    ds_read_b64_tr_b16 v[52:53], v4 offset:4096
    ds_read_b64_tr_b16 v[54:55], v4 offset:5120
    ds_read_b64_tr_b16 v[56:57], v5 offset:4096
    ds_read_b64_tr_b16 v[58:59], v5 offset:5120
    s_waitcnt vmcnt(6) lgkmcnt(10)
    v_mfma_f32_16x16x32_bf16 v[64:67], v[32:35], v[160:163], 0
    ds_read_b64_tr_b16 v[60:61], v6 offset:4096
    s_add_u32 s42, s41, 8192
    buffer_load_dwordx4 v[192:195], v2, s[4:7], s42 offen offset:0 sc1
    v_mfma_f32_16x16x32_bf16 v[68:71], v[32:35], v[164:167], 0
    ds_read_b64_tr_b16 v[62:63], v6 offset:5120
    v_mfma_f32_16x16x32_bf16 v[72:75], v[36:39], v[160:163], 0
    ds_read_b64_tr_b16 v[32:33], v3 offset:8192
    buffer_load_dwordx4 v[196:199], v2, s[4:7], s42 offen offset:256 sc1
    v_mfma_f32_16x16x32_bf16 v[76:79], v[36:39], v[164:167], 0
    ds_read_b64_tr_b16 v[34:35], v3 offset:9216
    s_waitcnt lgkmcnt(10)
    v_mfma_f32_16x16x32_bf16 v[80:83], v[40:43], v[160:163], 0
    ds_read_b64_tr_b16 v[36:37], v4 offset:8192
    buffer_load_dwordx4 v[200:203], v2, s[4:7], s42 offen offset:2048 sc1
    v_mfma_f32_16x16x32_bf16 v[84:87], v[40:43], v[164:167], 0
    ds_read_b64_tr_b16 v[38:39], v4 offset:9216
    v_mfma_f32_16x16x32_bf16 v[88:91], v[44:47], v[160:163], 0
    ds_read_b64_tr_b16 v[40:41], v5 offset:8192
    buffer_load_dwordx4 v[204:207], v2, s[4:7], s42 offen offset:2304 sc1
    v_mfma_f32_16x16x32_bf16 v[92:95], v[44:47], v[164:167], 0
    ds_read_b64_tr_b16 v[42:43], v5 offset:9216
    s_waitcnt lgkmcnt(10)
    v_mfma_f32_16x16x32_bf16 v[96:99], v[160:163], v[48:51], 0
    ds_read_b64_tr_b16 v[44:45], v6 offset:8192
    s_add_u32 s42, s41, 12288
    buffer_load_dwordx4 v[208:211], v2, s[4:7], s42 offen offset:0 sc1
    v_mfma_f32_16x16x32_bf16 v[100:103], v[164:167], v[48:51], 0
    ds_read_b64_tr_b16 v[46:47], v6 offset:9216
    v_mfma_f32_16x16x32_bf16 v[104:107], v[160:163], v[52:55], 0
    ds_read_b64_tr_b16 v[48:49], v3 offset:12288
    v_mfma_f32_16x16x32_bf16 v[108:111], v[164:167], v[52:55], 0
    ds_read_b64_tr_b16 v[50:51], v3 offset:13312
    s_waitcnt lgkmcnt(10)
    v_mfma_f32_16x16x32_bf16 v[112:115], v[160:163], v[56:59], 0
    ds_read_b64_tr_b16 v[52:53], v4 offset:12288
    v_mfma_f32_16x16x32_bf16 v[116:119], v[164:167], v[56:59], 0
    ds_read_b64_tr_b16 v[54:55], v4 offset:13312
    v_mfma_f32_16x16x32_bf16 v[120:123], v[160:163], v[60:63], 0
    ds_read_b64_tr_b16 v[56:57], v5 offset:12288
    v_mfma_f32_16x16x32_bf16 v[124:127], v[164:167], v[60:63], 0
    ds_read_b64_tr_b16 v[58:59], v5 offset:13312
    s_waitcnt lgkmcnt(10)
    v_mfma_f32_16x16x32_bf16 v[128:131], v[32:35], v[160:163], 0
    ds_read_b64_tr_b16 v[60:61], v6 offset:12288
    v_mfma_f32_16x16x32_bf16 v[132:135], v[32:35], v[164:167], 0
    ds_read_b64_tr_b16 v[62:63], v6 offset:13312
    v_mfma_f32_16x16x32_bf16 v[136:139], v[36:39], v[160:163], 0
    ds_read_b64_tr_b16 v[32:33], v3 offset:16384
    buffer_load_dwordx4 v[212:215], v2, s[4:7], s42 offen offset:256 sc1
    v_mfma_f32_16x16x32_bf16 v[140:143], v[36:39], v[164:167], 0
    ds_read_b64_tr_b16 v[34:35], v3 offset:17408
    s_waitcnt lgkmcnt(10)
    v_mfma_f32_16x16x32_bf16 v[144:147], v[40:43], v[160:163], 0
    ds_read_b64_tr_b16 v[36:37], v4 offset:16384
    v_mfma_f32_16x16x32_bf16 v[148:151], v[40:43], v[164:167], 0
    ds_read_b64_tr_b16 v[38:39], v4 offset:17408
    v_mfma_f32_16x16x32_bf16 v[152:155], v[44:47], v[160:163], 0
    ds_read_b64_tr_b16 v[40:41], v5 offset:16384
    v_mfma_f32_16x16x32_bf16 v[156:159], v[44:47], v[164:167], 0
    ds_read_b64_tr_b16 v[42:43], v5 offset:17408
    s_waitcnt vmcnt(10) lgkmcnt(10)
    v_mfma_f32_16x16x32_bf16 v[64:67], v[48:51], v[168:171], v[64:67]
    ds_read_b64_tr_b16 v[44:45], v6 offset:16384
    v_mfma_f32_16x16x32_bf16 v[68:71], v[48:51], v[172:175], v[68:71]
    ds_read_b64_tr_b16 v[46:47], v6 offset:17408
    v_mfma_f32_16x16x32_bf16 v[72:75], v[52:55], v[168:171], v[72:75]
    ds_read_b64_tr_b16 v[48:49], v3 offset:20480
    v_mfma_f32_16x16x32_bf16 v[76:79], v[52:55], v[172:175], v[76:79]
    ds_read_b64_tr_b16 v[50:51], v3 offset:21504
    s_waitcnt lgkmcnt(10)
    v_mfma_f32_16x16x32_bf16 v[80:83], v[56:59], v[168:171], v[80:83]
    ds_read_b64_tr_b16 v[52:53], v4 offset:20480
    buffer_load_dwordx4 v[216:219], v2, s[4:7], s42 offen offset:2048 sc1
    v_mfma_f32_16x16x32_bf16 v[84:87], v[56:59], v[172:175], v[84:87]
    ds_read_b64_tr_b16 v[54:55], v4 offset:21504
    v_mfma_f32_16x16x32_bf16 v[88:91], v[60:63], v[168:171], v[88:91]
    ds_read_b64_tr_b16 v[56:57], v5 offset:20480
    v_mfma_f32_16x16x32_bf16 v[92:95], v[60:63], v[172:175], v[92:95]
    ds_read_b64_tr_b16 v[58:59], v5 offset:21504
    s_waitcnt lgkmcnt(10)
    v_mfma_f32_16x16x32_bf16 v[96:99], v[168:171], v[32:35], v[96:99]
    ds_read_b64_tr_b16 v[60:61], v6 offset:20480
    v_mfma_f32_16x16x32_bf16 v[100:103], v[172:175], v[32:35], v[100:103]
    ds_read_b64_tr_b16 v[62:63], v6 offset:21504
    v_mfma_f32_16x16x32_bf16 v[104:107], v[168:171], v[36:39], v[104:107]
    ds_read_b64_tr_b16 v[32:33], v3 offset:24576
    v_mfma_f32_16x16x32_bf16 v[108:111], v[172:175], v[36:39], v[108:111]
    ds_read_b64_tr_b16 v[34:35], v3 offset:25600
    s_waitcnt lgkmcnt(10)
    v_mfma_f32_16x16x32_bf16 v[112:115], v[168:171], v[40:43], v[112:115]
    ds_read_b64_tr_b16 v[36:37], v4 offset:24576
    v_mfma_f32_16x16x32_bf16 v[116:119], v[172:175], v[40:43], v[116:119]
    ds_read_b64_tr_b16 v[38:39], v4 offset:25600
    v_mfma_f32_16x16x32_bf16 v[120:123], v[168:171], v[44:47], v[120:123]
    ds_read_b64_tr_b16 v[40:41], v5 offset:24576
    buffer_load_dwordx4 v[220:223], v2, s[4:7], s42 offen offset:2304 sc1
    v_mfma_f32_16x16x32_bf16 v[124:127], v[172:175], v[44:47], v[124:127]
    ds_read_b64_tr_b16 v[42:43], v5 offset:25600
    s_waitcnt lgkmcnt(10)
    v_mfma_f32_16x16x32_bf16 v[128:131], v[48:51], v[168:171], v[128:131]
    ds_read_b64_tr_b16 v[44:45], v6 offset:24576
    v_mfma_f32_16x16x32_bf16 v[132:135], v[48:51], v[172:175], v[132:135]
    ds_read_b64_tr_b16 v[46:47], v6 offset:25600
    v_mfma_f32_16x16x32_bf16 v[136:139], v[52:55], v[168:171], v[136:139]
    ds_read_b64_tr_b16 v[48:49], v3 offset:28672
    v_mfma_f32_16x16x32_bf16 v[140:143], v[52:55], v[172:175], v[140:143]
    ds_read_b64_tr_b16 v[50:51], v3 offset:29696
    s_waitcnt lgkmcnt(10)
    v_mfma_f32_16x16x32_bf16 v[144:147], v[56:59], v[168:171], v[144:147]
    ds_read_b64_tr_b16 v[52:53], v4 offset:28672
    v_mfma_f32_16x16x32_bf16 v[148:151], v[56:59], v[172:175], v[148:151]
    ds_read_b64_tr_b16 v[54:55], v4 offset:29696
    v_mfma_f32_16x16x32_bf16 v[152:155], v[60:63], v[168:171], v[152:155]
    ds_read_b64_tr_b16 v[56:57], v5 offset:28672
    v_mfma_f32_16x16x32_bf16 v[156:159], v[60:63], v[172:175], v[156:159]
    ds_read_b64_tr_b16 v[58:59], v5 offset:29696
    s_waitcnt vmcnt(10) lgkmcnt(10)
    v_mfma_f32_16x16x32_bf16 v[64:67], v[32:35], v[176:179], v[64:67]
    ds_read_b64_tr_b16 v[60:61], v6 offset:28672
    v_mfma_f32_16x16x32_bf16 v[68:71], v[32:35], v[180:183], v[68:71]
    ds_read_b64_tr_b16 v[62:63], v6 offset:29696
    s_barrier
    v_mfma_f32_16x16x32_bf16 v[72:75], v[36:39], v[176:179], v[72:75]
    ds_read_b64_tr_b16 v[32:33], v3 offset:32768
    v_mfma_f32_16x16x32_bf16 v[76:79], v[36:39], v[180:183], v[76:79]
    ds_read_b64_tr_b16 v[34:35], v3 offset:33792
    s_waitcnt lgkmcnt(10)
    v_mfma_f32_16x16x32_bf16 v[80:83], v[40:43], v[176:179], v[80:83]
    ds_read_b64_tr_b16 v[36:37], v4 offset:32768
    v_mfma_f32_16x16x32_bf16 v[84:87], v[40:43], v[180:183], v[84:87]
    ds_read_b64_tr_b16 v[38:39], v4 offset:33792
    v_mfma_f32_16x16x32_bf16 v[88:91], v[44:47], v[176:179], v[88:91]
    ds_read_b64_tr_b16 v[40:41], v5 offset:32768
    v_mfma_f32_16x16x32_bf16 v[92:95], v[44:47], v[180:183], v[92:95]
    ds_read_b64_tr_b16 v[42:43], v5 offset:33792
    s_waitcnt lgkmcnt(10)
    v_mfma_f32_16x16x32_bf16 v[96:99], v[176:179], v[48:51], v[96:99]
    ds_read_b64_tr_b16 v[44:45], v6 offset:32768
    v_mfma_f32_16x16x32_bf16 v[100:103], v[180:183], v[48:51], v[100:103]
    ds_read_b64_tr_b16 v[46:47], v6 offset:33792
    v_mfma_f32_16x16x32_bf16 v[104:107], v[176:179], v[52:55], v[104:107]
    ds_read_b64_tr_b16 v[48:49], v3 offset:36864
    v_mfma_f32_16x16x32_bf16 v[108:111], v[180:183], v[52:55], v[108:111]
    ds_read_b64_tr_b16 v[50:51], v3 offset:37888
    s_waitcnt lgkmcnt(10)
    v_mfma_f32_16x16x32_bf16 v[112:115], v[176:179], v[56:59], v[112:115]
    ds_read_b64_tr_b16 v[52:53], v4 offset:36864
    v_mfma_f32_16x16x32_bf16 v[116:119], v[180:183], v[56:59], v[116:119]
    ds_read_b64_tr_b16 v[54:55], v4 offset:37888
    v_mfma_f32_16x16x32_bf16 v[120:123], v[176:179], v[60:63], v[120:123]
    ds_read_b64_tr_b16 v[56:57], v5 offset:36864
    v_mfma_f32_16x16x32_bf16 v[124:127], v[180:183], v[60:63], v[124:127]
    ds_read_b64_tr_b16 v[58:59], v5 offset:37888
    s_waitcnt lgkmcnt(10)
    v_mfma_f32_16x16x32_bf16 v[128:131], v[32:35], v[176:179], v[128:131]
    ds_read_b64_tr_b16 v[60:61], v6 offset:36864
    v_mfma_f32_16x16x32_bf16 v[132:135], v[32:35], v[180:183], v[132:135]
    ds_read_b64_tr_b16 v[62:63], v6 offset:37888
    v_mfma_f32_16x16x32_bf16 v[136:139], v[36:39], v[176:179], v[136:139]
    ds_read_b64_tr_b16 v[32:33], v3 offset:40960
    v_mfma_f32_16x16x32_bf16 v[140:143], v[36:39], v[180:183], v[140:143]
    ds_read_b64_tr_b16 v[34:35], v3 offset:41984
    s_waitcnt lgkmcnt(10)
    v_mfma_f32_16x16x32_bf16 v[144:147], v[40:43], v[176:179], v[144:147]
    ds_read_b64_tr_b16 v[36:37], v4 offset:40960
    v_mfma_f32_16x16x32_bf16 v[148:151], v[40:43], v[180:183], v[148:151]
    ds_read_b64_tr_b16 v[38:39], v4 offset:41984
    v_mfma_f32_16x16x32_bf16 v[152:155], v[44:47], v[176:179], v[152:155]
    ds_read_b64_tr_b16 v[40:41], v5 offset:40960
    v_mfma_f32_16x16x32_bf16 v[156:159], v[44:47], v[180:183], v[156:159]
    ds_read_b64_tr_b16 v[42:43], v5 offset:41984
    s_waitcnt vmcnt(8) lgkmcnt(10)
    v_mfma_f32_16x16x32_bf16 v[64:67], v[48:51], v[184:187], v[64:67]
    ds_read_b64_tr_b16 v[44:45], v6 offset:40960
    v_mfma_f32_16x16x32_bf16 v[68:71], v[48:51], v[188:191], v[68:71]
    ds_read_b64_tr_b16 v[46:47], v6 offset:41984
    v_mfma_f32_16x16x32_bf16 v[72:75], v[52:55], v[184:187], v[72:75]
    ds_read_b64_tr_b16 v[48:49], v3 offset:45056
    v_mfma_f32_16x16x32_bf16 v[76:79], v[52:55], v[188:191], v[76:79]
    ds_read_b64_tr_b16 v[50:51], v3 offset:46080
    s_waitcnt lgkmcnt(10)
    v_mfma_f32_16x16x32_bf16 v[80:83], v[56:59], v[184:187], v[80:83]
    ds_read_b64_tr_b16 v[52:53], v4 offset:45056
    v_mfma_f32_16x16x32_bf16 v[84:87], v[56:59], v[188:191], v[84:87]
    ds_read_b64_tr_b16 v[54:55], v4 offset:46080
    v_mfma_f32_16x16x32_bf16 v[88:91], v[60:63], v[184:187], v[88:91]
    ds_read_b64_tr_b16 v[56:57], v5 offset:45056
    v_mfma_f32_16x16x32_bf16 v[92:95], v[60:63], v[188:191], v[92:95]
    ds_read_b64_tr_b16 v[58:59], v5 offset:46080
    s_waitcnt lgkmcnt(10)
    v_mfma_f32_16x16x32_bf16 v[96:99], v[184:187], v[32:35], v[96:99]
    ds_read_b64_tr_b16 v[60:61], v6 offset:45056
    v_mfma_f32_16x16x32_bf16 v[100:103], v[188:191], v[32:35], v[100:103]
    ds_read_b64_tr_b16 v[62:63], v6 offset:46080
    v_mfma_f32_16x16x32_bf16 v[104:107], v[184:187], v[36:39], v[104:107]
    ds_read_b64_tr_b16 v[32:33], v3 offset:49152
    v_mfma_f32_16x16x32_bf16 v[108:111], v[188:191], v[36:39], v[108:111]
    ds_read_b64_tr_b16 v[34:35], v3 offset:50176
    s_waitcnt lgkmcnt(10)
    v_mfma_f32_16x16x32_bf16 v[112:115], v[184:187], v[40:43], v[112:115]
    ds_read_b64_tr_b16 v[36:37], v4 offset:49152
    v_mfma_f32_16x16x32_bf16 v[116:119], v[188:191], v[40:43], v[116:119]
    ds_read_b64_tr_b16 v[38:39], v4 offset:50176
    v_mfma_f32_16x16x32_bf16 v[120:123], v[184:187], v[44:47], v[120:123]
    ds_read_b64_tr_b16 v[40:41], v5 offset:49152
    v_mfma_f32_16x16x32_bf16 v[124:127], v[188:191], v[44:47], v[124:127]
    ds_read_b64_tr_b16 v[42:43], v5 offset:50176
    s_waitcnt lgkmcnt(10)
    v_mfma_f32_16x16x32_bf16 v[128:131], v[48:51], v[184:187], v[128:131]
    ds_read_b64_tr_b16 v[44:45], v6 offset:49152
    s_add_u32 s42, s41, 16384
    buffer_load_dwordx4 v[224:227], v2, s[4:7], s42 offen offset:0 sc1
    v_mfma_f32_16x16x32_bf16 v[132:135], v[48:51], v[188:191], v[132:135]
    ds_read_b64_tr_b16 v[46:47], v6 offset:50176
    v_mfma_f32_16x16x32_bf16 v[136:139], v[52:55], v[184:187], v[136:139]
    ds_read_b64_tr_b16 v[48:49], v3 offset:53248
    buffer_load_dwordx4 v[228:231], v2, s[4:7], s42 offen offset:256 sc1
    v_mfma_f32_16x16x32_bf16 v[140:143], v[52:55], v[188:191], v[140:143]
    ds_read_b64_tr_b16 v[50:51], v3 offset:54272
    s_waitcnt lgkmcnt(10)
    v_mfma_f32_16x16x32_bf16 v[144:147], v[56:59], v[184:187], v[144:147]
    ds_read_b64_tr_b16 v[52:53], v4 offset:53248
    buffer_load_dwordx4 v[232:235], v2, s[4:7], s42 offen offset:2048 sc1
    v_mfma_f32_16x16x32_bf16 v[148:151], v[56:59], v[188:191], v[148:151]
    ds_read_b64_tr_b16 v[54:55], v4 offset:54272
    v_mfma_f32_16x16x32_bf16 v[152:155], v[60:63], v[184:187], v[152:155]
    ds_read_b64_tr_b16 v[56:57], v5 offset:53248
    buffer_load_dwordx4 v[236:239], v2, s[4:7], s42 offen offset:2304 sc1
    v_mfma_f32_16x16x32_bf16 v[156:159], v[60:63], v[188:191], v[156:159]
    ds_read_b64_tr_b16 v[58:59], v5 offset:54272
    s_waitcnt vmcnt(10) lgkmcnt(10)
    v_mfma_f32_16x16x32_bf16 v[64:67], v[32:35], v[192:195], v[64:67]
    ds_read_b64_tr_b16 v[60:61], v6 offset:53248
    s_add_u32 s42, s41, 20480
    buffer_load_dwordx4 v[240:243], v2, s[4:7], s42 offen offset:0 sc1
    v_mfma_f32_16x16x32_bf16 v[68:71], v[32:35], v[196:199], v[68:71]
    ds_read_b64_tr_b16 v[62:63], v6 offset:54272
    v_mfma_f32_16x16x32_bf16 v[72:75], v[36:39], v[192:195], v[72:75]
    ds_read_b64_tr_b16 v[32:33], v3 offset:57344
    buffer_load_dwordx4 v[244:247], v2, s[4:7], s42 offen offset:256 sc1
    v_mfma_f32_16x16x32_bf16 v[76:79], v[36:39], v[196:199], v[76:79]
    ds_read_b64_tr_b16 v[34:35], v3 offset:58368
    s_waitcnt lgkmcnt(10)
    v_mfma_f32_16x16x32_bf16 v[80:83], v[40:43], v[192:195], v[80:83]
    ds_read_b64_tr_b16 v[36:37], v4 offset:57344
    v_mfma_f32_16x16x32_bf16 v[84:87], v[40:43], v[196:199], v[84:87]
    ds_read_b64_tr_b16 v[38:39], v4 offset:58368
    v_mfma_f32_16x16x32_bf16 v[88:91], v[44:47], v[192:195], v[88:91]
    ds_read_b64_tr_b16 v[40:41], v5 offset:57344
    v_mfma_f32_16x16x32_bf16 v[92:95], v[44:47], v[196:199], v[92:95]
    ds_read_b64_tr_b16 v[42:43], v5 offset:58368
    s_waitcnt lgkmcnt(10)
    v_mfma_f32_16x16x32_bf16 v[96:99], v[192:195], v[48:51], v[96:99]
    ds_read_b64_tr_b16 v[44:45], v6 offset:57344
    buffer_load_dwordx4 v[248:251], v2, s[4:7], s42 offen offset:2048 sc1
    v_mfma_f32_16x16x32_bf16 v[100:103], v[196:199], v[48:51], v[100:103]
    ds_read_b64_tr_b16 v[46:47], v6 offset:58368
    v_mfma_f32_16x16x32_bf16 v[104:107], v[192:195], v[52:55], v[104:107]
    ds_read_b64_tr_b16 v[48:49], v3 offset:61440
    v_mfma_f32_16x16x32_bf16 v[108:111], v[196:199], v[52:55], v[108:111]
    ds_read_b64_tr_b16 v[50:51], v3 offset:62464
    s_waitcnt lgkmcnt(10)
    v_mfma_f32_16x16x32_bf16 v[112:115], v[192:195], v[56:59], v[112:115]
    ds_read_b64_tr_b16 v[52:53], v4 offset:61440
    v_mfma_f32_16x16x32_bf16 v[116:119], v[196:199], v[56:59], v[116:119]
    ds_read_b64_tr_b16 v[54:55], v4 offset:62464
    v_mfma_f32_16x16x32_bf16 v[120:123], v[192:195], v[60:63], v[120:123]
    ds_read_b64_tr_b16 v[56:57], v5 offset:61440
    v_mfma_f32_16x16x32_bf16 v[124:127], v[196:199], v[60:63], v[124:127]
    ds_read_b64_tr_b16 v[58:59], v5 offset:62464
    s_waitcnt lgkmcnt(10)
    v_mfma_f32_16x16x32_bf16 v[128:131], v[32:35], v[192:195], v[128:131]
    ds_read_b64_tr_b16 v[60:61], v6 offset:61440
    v_mfma_f32_16x16x32_bf16 v[132:135], v[32:35], v[196:199], v[132:135]
    ds_read_b64_tr_b16 v[62:63], v6 offset:62464
    s_barrier
    v_xor_b32 v3, 0x10000, v3
    v_xor_b32 v4, 0x10000, v4
    v_xor_b32 v5, 0x10000, v5
    v_xor_b32 v6, 0x10000, v6
    v_mfma_f32_16x16x32_bf16 v[136:139], v[36:39], v[192:195], v[136:139]
    ds_read_b64_tr_b16 v[32:33], v3 offset:0
    v_mfma_f32_16x16x32_bf16 v[140:143], v[36:39], v[196:199], v[140:143]
    ds_read_b64_tr_b16 v[34:35], v3 offset:1024
    s_waitcnt lgkmcnt(10)
    v_mfma_f32_16x16x32_bf16 v[144:147], v[40:43], v[192:195], v[144:147]
    ds_read_b64_tr_b16 v[36:37], v4 offset:0
    v_mfma_f32_16x16x32_bf16 v[148:151], v[40:43], v[196:199], v[148:151]
    ds_read_b64_tr_b16 v[38:39], v4 offset:1024
    v_mfma_f32_16x16x32_bf16 v[152:155], v[44:47], v[192:195], v[152:155]
    ds_read_b64_tr_b16 v[40:41], v5 offset:0
    v_mfma_f32_16x16x32_bf16 v[156:159], v[44:47], v[196:199], v[156:159]
    ds_read_b64_tr_b16 v[42:43], v5 offset:1024
    s_waitcnt vmcnt(11) lgkmcnt(10)
    v_mfma_f32_16x16x32_bf16 v[64:67], v[48:51], v[200:203], v[64:67]
    ds_read_b64_tr_b16 v[44:45], v6 offset:0
    v_mfma_f32_16x16x32_bf16 v[68:71], v[48:51], v[204:207], v[68:71]
    ds_read_b64_tr_b16 v[46:47], v6 offset:1024
    v_mfma_f32_16x16x32_bf16 v[72:75], v[52:55], v[200:203], v[72:75]
    ds_read_b64_tr_b16 v[48:49], v3 offset:4096
    v_mfma_f32_16x16x32_bf16 v[76:79], v[52:55], v[204:207], v[76:79]
    ds_read_b64_tr_b16 v[50:51], v3 offset:5120
    s_waitcnt lgkmcnt(10)
    v_mfma_f32_16x16x32_bf16 v[80:83], v[56:59], v[200:203], v[80:83]
    ds_read_b64_tr_b16 v[52:53], v4 offset:4096
    v_mfma_f32_16x16x32_bf16 v[84:87], v[56:59], v[204:207], v[84:87]
    ds_read_b64_tr_b16 v[54:55], v4 offset:5120
    v_mfma_f32_16x16x32_bf16 v[88:91], v[60:63], v[200:203], v[88:91]
    ds_read_b64_tr_b16 v[56:57], v5 offset:4096
    v_mfma_f32_16x16x32_bf16 v[92:95], v[60:63], v[204:207], v[92:95]
    ds_read_b64_tr_b16 v[58:59], v5 offset:5120
    s_waitcnt lgkmcnt(10)
    v_mfma_f32_16x16x32_bf16 v[96:99], v[200:203], v[32:35], v[96:99]
    ds_read_b64_tr_b16 v[60:61], v6 offset:4096
    v_mfma_f32_16x16x32_bf16 v[100:103], v[204:207], v[32:35], v[100:103]
    ds_read_b64_tr_b16 v[62:63], v6 offset:5120
    v_mfma_f32_16x16x32_bf16 v[104:107], v[200:203], v[36:39], v[104:107]
    ds_read_b64_tr_b16 v[32:33], v3 offset:8192
    v_mfma_f32_16x16x32_bf16 v[108:111], v[204:207], v[36:39], v[108:111]
    ds_read_b64_tr_b16 v[34:35], v3 offset:9216
    s_waitcnt lgkmcnt(10)
    v_mfma_f32_16x16x32_bf16 v[112:115], v[200:203], v[40:43], v[112:115]
    ds_read_b64_tr_b16 v[36:37], v4 offset:8192
    v_mfma_f32_16x16x32_bf16 v[116:119], v[204:207], v[40:43], v[116:119]
    ds_read_b64_tr_b16 v[38:39], v4 offset:9216
    v_mfma_f32_16x16x32_bf16 v[120:123], v[200:203], v[44:47], v[120:123]
    ds_read_b64_tr_b16 v[40:41], v5 offset:8192
    v_mfma_f32_16x16x32_bf16 v[124:127], v[204:207], v[44:47], v[124:127]
    ds_read_b64_tr_b16 v[42:43], v5 offset:9216
    s_waitcnt lgkmcnt(10)
    v_mfma_f32_16x16x32_bf16 v[128:131], v[48:51], v[200:203], v[128:131]
    ds_read_b64_tr_b16 v[44:45], v6 offset:8192
    v_mfma_f32_16x16x32_bf16 v[132:135], v[48:51], v[204:207], v[132:135]
    ds_read_b64_tr_b16 v[46:47], v6 offset:9216
    v_mfma_f32_16x16x32_bf16 v[136:139], v[52:55], v[200:203], v[136:139]
    ds_read_b64_tr_b16 v[48:49], v3 offset:12288
    v_mfma_f32_16x16x32_bf16 v[140:143], v[52:55], v[204:207], v[140:143]
    ds_read_b64_tr_b16 v[50:51], v3 offset:13312
    s_waitcnt lgkmcnt(10)
    v_mfma_f32_16x16x32_bf16 v[144:147], v[56:59], v[200:203], v[144:147]
    ds_read_b64_tr_b16 v[52:53], v4 offset:12288
    v_mfma_f32_16x16x32_bf16 v[148:151], v[56:59], v[204:207], v[148:151]
    ds_read_b64_tr_b16 v[54:55], v4 offset:13312
    v_mfma_f32_16x16x32_bf16 v[152:155], v[60:63], v[200:203], v[152:155]
    ds_read_b64_tr_b16 v[56:57], v5 offset:12288
    v_mfma_f32_16x16x32_bf16 v[156:159], v[60:63], v[204:207], v[156:159]
    ds_read_b64_tr_b16 v[58:59], v5 offset:13312
    s_waitcnt vmcnt(9) lgkmcnt(10)
    v_mfma_f32_16x16x32_bf16 v[64:67], v[32:35], v[208:211], v[64:67]
    ds_read_b64_tr_b16 v[60:61], v6 offset:12288
    v_mfma_f32_16x16x32_bf16 v[68:71], v[32:35], v[212:215], v[68:71]
    ds_read_b64_tr_b16 v[62:63], v6 offset:13312
    v_mfma_f32_16x16x32_bf16 v[72:75], v[36:39], v[208:211], v[72:75]
    ds_read_b64_tr_b16 v[32:33], v3 offset:16384
    v_mfma_f32_16x16x32_bf16 v[76:79], v[36:39], v[212:215], v[76:79]
    ds_read_b64_tr_b16 v[34:35], v3 offset:17408
    s_waitcnt lgkmcnt(10)
    v_mfma_f32_16x16x32_bf16 v[80:83], v[40:43], v[208:211], v[80:83]
    ds_read_b64_tr_b16 v[36:37], v4 offset:16384
    v_mfma_f32_16x16x32_bf16 v[84:87], v[40:43], v[212:215], v[84:87]
    ds_read_b64_tr_b16 v[38:39], v4 offset:17408
    v_mfma_f32_16x16x32_bf16 v[88:91], v[44:47], v[208:211], v[88:91]
    ds_read_b64_tr_b16 v[40:41], v5 offset:16384
    v_mfma_f32_16x16x32_bf16 v[92:95], v[44:47], v[212:215], v[92:95]
    ds_read_b64_tr_b16 v[42:43], v5 offset:17408
    s_waitcnt lgkmcnt(10)
    v_mfma_f32_16x16x32_bf16 v[96:99], v[208:211], v[48:51], v[96:99]
    ds_read_b64_tr_b16 v[44:45], v6 offset:16384
    buffer_load_dwordx4 v[252:255], v2, s[4:7], s42 offen offset:2304 sc1
    v_mfma_f32_16x16x32_bf16 v[100:103], v[212:215], v[48:51], v[100:103]
    ds_read_b64_tr_b16 v[46:47], v6 offset:17408
    v_mfma_f32_16x16x32_bf16 v[104:107], v[208:211], v[52:55], v[104:107]
    ds_read_b64_tr_b16 v[48:49], v3 offset:20480
    s_add_u32 s42, s41, 24576
    buffer_load_dwordx4 v[160:163], v2, s[4:7], s42 offen offset:0 sc1
    v_mfma_f32_16x16x32_bf16 v[108:111], v[212:215], v[52:55], v[108:111]
    ds_read_b64_tr_b16 v[50:51], v3 offset:21504
    s_waitcnt lgkmcnt(10)
    v_mfma_f32_16x16x32_bf16 v[112:115], v[208:211], v[56:59], v[112:115]
    ds_read_b64_tr_b16 v[52:53], v4 offset:20480
    buffer_load_dwordx4 v[164:167], v2, s[4:7], s42 offen offset:256 sc1
    v_mfma_f32_16x16x32_bf16 v[116:119], v[212:215], v[56:59], v[116:119]
    ds_read_b64_tr_b16 v[54:55], v4 offset:21504
    v_mfma_f32_16x16x32_bf16 v[120:123], v[208:211], v[60:63], v[120:123]
    ds_read_b64_tr_b16 v[56:57], v5 offset:20480
    buffer_load_dwordx4 v[168:171], v2, s[4:7], s42 offen offset:2048 sc1
    v_mfma_f32_16x16x32_bf16 v[124:127], v[212:215], v[60:63], v[124:127]
    ds_read_b64_tr_b16 v[58:59], v5 offset:21504
    s_waitcnt lgkmcnt(10)
    v_mfma_f32_16x16x32_bf16 v[128:131], v[32:35], v[208:211], v[128:131]
    ds_read_b64_tr_b16 v[60:61], v6 offset:20480
    buffer_load_dwordx4 v[172:175], v2, s[4:7], s42 offen offset:2304 sc1
    v_mfma_f32_16x16x32_bf16 v[132:135], v[32:35], v[212:215], v[132:135]
    ds_read_b64_tr_b16 v[62:63], v6 offset:21504
    v_mfma_f32_16x16x32_bf16 v[136:139], v[36:39], v[208:211], v[136:139]
    ds_read_b64_tr_b16 v[32:33], v3 offset:24576
    s_add_u32 s42, s41, 28672
    buffer_load_dwordx4 v[176:179], v2, s[4:7], s42 offen offset:0 sc1
    v_mfma_f32_16x16x32_bf16 v[140:143], v[36:39], v[212:215], v[140:143]
    ds_read_b64_tr_b16 v[34:35], v3 offset:25600
    s_waitcnt lgkmcnt(10)
    v_mfma_f32_16x16x32_bf16 v[144:147], v[40:43], v[208:211], v[144:147]
    ds_read_b64_tr_b16 v[36:37], v4 offset:24576
    v_mfma_f32_16x16x32_bf16 v[148:151], v[40:43], v[212:215], v[148:151]
    ds_read_b64_tr_b16 v[38:39], v4 offset:25600
    v_mfma_f32_16x16x32_bf16 v[152:155], v[44:47], v[208:211], v[152:155]
    ds_read_b64_tr_b16 v[40:41], v5 offset:24576
    v_mfma_f32_16x16x32_bf16 v[156:159], v[44:47], v[212:215], v[156:159]
    ds_read_b64_tr_b16 v[42:43], v5 offset:25600
    s_waitcnt vmcnt(13) lgkmcnt(10)
    v_mfma_f32_16x16x32_bf16 v[64:67], v[48:51], v[216:219], v[64:67]
    ds_read_b64_tr_b16 v[44:45], v6 offset:24576
    v_mfma_f32_16x16x32_bf16 v[68:71], v[48:51], v[220:223], v[68:71]
    ds_read_b64_tr_b16 v[46:47], v6 offset:25600
    v_mfma_f32_16x16x32_bf16 v[72:75], v[52:55], v[216:219], v[72:75]
    ds_read_b64_tr_b16 v[48:49], v3 offset:28672
    v_mfma_f32_16x16x32_bf16 v[76:79], v[52:55], v[220:223], v[76:79]
    ds_read_b64_tr_b16 v[50:51], v3 offset:29696
    s_waitcnt lgkmcnt(10)
    v_mfma_f32_16x16x32_bf16 v[80:83], v[56:59], v[216:219], v[80:83]
    ds_read_b64_tr_b16 v[52:53], v4 offset:28672
    buffer_load_dwordx4 v[180:183], v2, s[4:7], s42 offen offset:256 sc1
    v_mfma_f32_16x16x32_bf16 v[84:87], v[56:59], v[220:223], v[84:87]
    ds_read_b64_tr_b16 v[54:55], v4 offset:29696
    v_mfma_f32_16x16x32_bf16 v[88:91], v[60:63], v[216:219], v[88:91]
    ds_read_b64_tr_b16 v[56:57], v5 offset:28672
    v_mfma_f32_16x16x32_bf16 v[92:95], v[60:63], v[220:223], v[92:95]
    ds_read_b64_tr_b16 v[58:59], v5 offset:29696
    s_waitcnt lgkmcnt(10)
    v_mfma_f32_16x16x32_bf16 v[96:99], v[216:219], v[32:35], v[96:99]
    ds_read_b64_tr_b16 v[60:61], v6 offset:28672
    v_mfma_f32_16x16x32_bf16 v[100:103], v[220:223], v[32:35], v[100:103]
    ds_read_b64_tr_b16 v[62:63], v6 offset:29696
    s_barrier
    v_mfma_f32_16x16x32_bf16 v[104:107], v[216:219], v[36:39], v[104:107]
    ds_read_b64_tr_b16 v[32:33], v3 offset:32768
    v_mfma_f32_16x16x32_bf16 v[108:111], v[220:223], v[36:39], v[108:111]
    ds_read_b64_tr_b16 v[34:35], v3 offset:33792
    s_waitcnt lgkmcnt(10)
    v_mfma_f32_16x16x32_bf16 v[112:115], v[216:219], v[40:43], v[112:115]
    ds_read_b64_tr_b16 v[36:37], v4 offset:32768
    v_mfma_f32_16x16x32_bf16 v[116:119], v[220:223], v[40:43], v[116:119]
    ds_read_b64_tr_b16 v[38:39], v4 offset:33792
    v_mfma_f32_16x16x32_bf16 v[120:123], v[216:219], v[44:47], v[120:123]
    ds_read_b64_tr_b16 v[40:41], v5 offset:32768
    v_mfma_f32_16x16x32_bf16 v[124:127], v[220:223], v[44:47], v[124:127]
    ds_read_b64_tr_b16 v[42:43], v5 offset:33792
    s_waitcnt lgkmcnt(10)
    v_mfma_f32_16x16x32_bf16 v[128:131], v[48:51], v[216:219], v[128:131]
    ds_read_b64_tr_b16 v[44:45], v6 offset:32768
    v_mfma_f32_16x16x32_bf16 v[132:135], v[48:51], v[220:223], v[132:135]
    ds_read_b64_tr_b16 v[46:47], v6 offset:33792
    v_mfma_f32_16x16x32_bf16 v[136:139], v[52:55], v[216:219], v[136:139]
    ds_read_b64_tr_b16 v[48:49], v3 offset:36864
    v_mfma_f32_16x16x32_bf16 v[140:143], v[52:55], v[220:223], v[140:143]
    ds_read_b64_tr_b16 v[50:51], v3 offset:37888
    s_waitcnt lgkmcnt(10)
    v_mfma_f32_16x16x32_bf16 v[144:147], v[56:59], v[216:219], v[144:147]
    ds_read_b64_tr_b16 v[52:53], v4 offset:36864
    v_mfma_f32_16x16x32_bf16 v[148:151], v[56:59], v[220:223], v[148:151]
    ds_read_b64_tr_b16 v[54:55], v4 offset:37888
    v_mfma_f32_16x16x32_bf16 v[152:155], v[60:63], v[216:219], v[152:155]
    ds_read_b64_tr_b16 v[56:57], v5 offset:36864
    v_mfma_f32_16x16x32_bf16 v[156:159], v[60:63], v[220:223], v[156:159]
    ds_read_b64_tr_b16 v[58:59], v5 offset:37888
    s_waitcnt vmcnt(12) lgkmcnt(10)
    v_mfma_f32_16x16x32_bf16 v[64:67], v[32:35], v[224:227], v[64:67]
    ds_read_b64_tr_b16 v[60:61], v6 offset:36864
    v_mfma_f32_16x16x32_bf16 v[68:71], v[32:35], v[228:231], v[68:71]
    ds_read_b64_tr_b16 v[62:63], v6 offset:37888
    v_mfma_f32_16x16x32_bf16 v[72:75], v[36:39], v[224:227], v[72:75]
    ds_read_b64_tr_b16 v[32:33], v3 offset:40960
    v_mfma_f32_16x16x32_bf16 v[76:79], v[36:39], v[228:231], v[76:79]
    ds_read_b64_tr_b16 v[34:35], v3 offset:41984
    s_waitcnt lgkmcnt(10)
    v_mfma_f32_16x16x32_bf16 v[80:83], v[40:43], v[224:227], v[80:83]
    ds_read_b64_tr_b16 v[36:37], v4 offset:40960
    v_mfma_f32_16x16x32_bf16 v[84:87], v[40:43], v[228:231], v[84:87]
    ds_read_b64_tr_b16 v[38:39], v4 offset:41984
    v_mfma_f32_16x16x32_bf16 v[88:91], v[44:47], v[224:227], v[88:91]
    ds_read_b64_tr_b16 v[40:41], v5 offset:40960
    v_mfma_f32_16x16x32_bf16 v[92:95], v[44:47], v[228:231], v[92:95]
    ds_read_b64_tr_b16 v[42:43], v5 offset:41984
    s_waitcnt lgkmcnt(10)
    v_mfma_f32_16x16x32_bf16 v[96:99], v[224:227], v[48:51], v[96:99]
    ds_read_b64_tr_b16 v[44:45], v6 offset:40960
    v_mfma_f32_16x16x32_bf16 v[100:103], v[228:231], v[48:51], v[100:103]
    ds_read_b64_tr_b16 v[46:47], v6 offset:41984
    v_mfma_f32_16x16x32_bf16 v[104:107], v[224:227], v[52:55], v[104:107]
    ds_read_b64_tr_b16 v[48:49], v3 offset:45056
    v_mfma_f32_16x16x32_bf16 v[108:111], v[228:231], v[52:55], v[108:111]
    ds_read_b64_tr_b16 v[50:51], v3 offset:46080
    s_waitcnt lgkmcnt(10)
    v_mfma_f32_16x16x32_bf16 v[112:115], v[224:227], v[56:59], v[112:115]
    ds_read_b64_tr_b16 v[52:53], v4 offset:45056
    v_mfma_f32_16x16x32_bf16 v[116:119], v[228:231], v[56:59], v[116:119]
    ds_read_b64_tr_b16 v[54:55], v4 offset:46080
    v_mfma_f32_16x16x32_bf16 v[120:123], v[224:227], v[60:63], v[120:123]
    ds_read_b64_tr_b16 v[56:57], v5 offset:45056
    v_mfma_f32_16x16x32_bf16 v[124:127], v[228:231], v[60:63], v[124:127]
    ds_read_b64_tr_b16 v[58:59], v5 offset:46080
    s_waitcnt lgkmcnt(10)
    v_mfma_f32_16x16x32_bf16 v[128:131], v[32:35], v[224:227], v[128:131]
    ds_read_b64_tr_b16 v[60:61], v6 offset:45056
    v_mfma_f32_16x16x32_bf16 v[132:135], v[32:35], v[228:231], v[132:135]
    ds_read_b64_tr_b16 v[62:63], v6 offset:46080
    v_mfma_f32_16x16x32_bf16 v[136:139], v[36:39], v[224:227], v[136:139]
    ds_read_b64_tr_b16 v[32:33], v3 offset:49152
    v_mfma_f32_16x16x32_bf16 v[140:143], v[36:39], v[228:231], v[140:143]
    ds_read_b64_tr_b16 v[34:35], v3 offset:50176
    s_waitcnt lgkmcnt(10)
    v_mfma_f32_16x16x32_bf16 v[144:147], v[40:43], v[224:227], v[144:147]
    ds_read_b64_tr_b16 v[36:37], v4 offset:49152
    v_mfma_f32_16x16x32_bf16 v[148:151], v[40:43], v[228:231], v[148:151]
    ds_read_b64_tr_b16 v[38:39], v4 offset:50176
    v_mfma_f32_16x16x32_bf16 v[152:155], v[44:47], v[224:227], v[152:155]
    ds_read_b64_tr_b16 v[40:41], v5 offset:49152
    v_mfma_f32_16x16x32_bf16 v[156:159], v[44:47], v[228:231], v[156:159]
    ds_read_b64_tr_b16 v[42:43], v5 offset:50176
    s_waitcnt vmcnt(10) lgkmcnt(10)
    v_mfma_f32_16x16x32_bf16 v[64:67], v[48:51], v[232:235], v[64:67]
    ds_read_b64_tr_b16 v[44:45], v6 offset:49152
    buffer_load_dwordx4 v[184:187], v2, s[4:7], s42 offen offset:2048 sc1
    v_mfma_f32_16x16x32_bf16 v[68:71], v[48:51], v[236:239], v[68:71]
    ds_read_b64_tr_b16 v[46:47], v6 offset:50176
    v_mfma_f32_16x16x32_bf16 v[72:75], v[52:55], v[232:235], v[72:75]
    ds_read_b64_tr_b16 v[48:49], v3 offset:53248
    buffer_load_dwordx4 v[188:191], v2, s[4:7], s42 offen offset:2304 sc1
    v_mfma_f32_16x16x32_bf16 v[76:79], v[52:55], v[236:239], v[76:79]
    ds_read_b64_tr_b16 v[50:51], v3 offset:54272
    s_waitcnt lgkmcnt(10)
    v_mfma_f32_16x16x32_bf16 v[80:83], v[56:59], v[232:235], v[80:83]
    ds_read_b64_tr_b16 v[52:53], v4 offset:53248
    s_add_u32 s42, s41, 32768
    buffer_load_dwordx4 v[192:195], v2, s[4:7], s42 offen offset:0 sc1
    v_mfma_f32_16x16x32_bf16 v[84:87], v[56:59], v[236:239], v[84:87]
    ds_read_b64_tr_b16 v[54:55], v4 offset:54272
    v_mfma_f32_16x16x32_bf16 v[88:91], v[60:63], v[232:235], v[88:91]
    ds_read_b64_tr_b16 v[56:57], v5 offset:53248
    buffer_load_dwordx4 v[196:199], v2, s[4:7], s42 offen offset:256 sc1
    v_mfma_f32_16x16x32_bf16 v[92:95], v[60:63], v[236:239], v[92:95]
    ds_read_b64_tr_b16 v[58:59], v5 offset:54272
    s_waitcnt lgkmcnt(10)
    v_mfma_f32_16x16x32_bf16 v[96:99], v[232:235], v[32:35], v[96:99]
    ds_read_b64_tr_b16 v[60:61], v6 offset:53248
    buffer_load_dwordx4 v[200:203], v2, s[4:7], s42 offen offset:2048 sc1
    v_mfma_f32_16x16x32_bf16 v[100:103], v[236:239], v[32:35], v[100:103]
    ds_read_b64_tr_b16 v[62:63], v6 offset:54272
    v_mfma_f32_16x16x32_bf16 v[104:107], v[232:235], v[36:39], v[104:107]
    ds_read_b64_tr_b16 v[32:33], v3 offset:57344
    v_mfma_f32_16x16x32_bf16 v[108:111], v[236:239], v[36:39], v[108:111]
    ds_read_b64_tr_b16 v[34:35], v3 offset:58368
    s_waitcnt lgkmcnt(10)
    v_mfma_f32_16x16x32_bf16 v[112:115], v[232:235], v[40:43], v[112:115]
    ds_read_b64_tr_b16 v[36:37], v4 offset:57344
    v_mfma_f32_16x16x32_bf16 v[116:119], v[236:239], v[40:43], v[116:119]
    ds_read_b64_tr_b16 v[38:39], v4 offset:58368
    v_mfma_f32_16x16x32_bf16 v[120:123], v[232:235], v[44:47], v[120:123]
    ds_read_b64_tr_b16 v[40:41], v5 offset:57344
    buffer_load_dwordx4 v[204:207], v2, s[4:7], s42 offen offset:2304 sc1
    v_mfma_f32_16x16x32_bf16 v[124:127], v[236:239], v[44:47], v[124:127]
    ds_read_b64_tr_b16 v[42:43], v5 offset:58368
    s_waitcnt lgkmcnt(10)
    v_mfma_f32_16x16x32_bf16 v[128:131], v[48:51], v[232:235], v[128:131]
    ds_read_b64_tr_b16 v[44:45], v6 offset:57344
    v_mfma_f32_16x16x32_bf16 v[132:135], v[48:51], v[236:239], v[132:135]
    ds_read_b64_tr_b16 v[46:47], v6 offset:58368
    v_mfma_f32_16x16x32_bf16 v[136:139], v[52:55], v[232:235], v[136:139]
    ds_read_b64_tr_b16 v[48:49], v3 offset:61440
    v_mfma_f32_16x16x32_bf16 v[140:143], v[52:55], v[236:239], v[140:143]
    ds_read_b64_tr_b16 v[50:51], v3 offset:62464
    s_waitcnt lgkmcnt(10)
    v_mfma_f32_16x16x32_bf16 v[144:147], v[56:59], v[232:235], v[144:147]
    ds_read_b64_tr_b16 v[52:53], v4 offset:61440
    v_mfma_f32_16x16x32_bf16 v[148:151], v[56:59], v[236:239], v[148:151]
    ds_read_b64_tr_b16 v[54:55], v4 offset:62464
    v_mfma_f32_16x16x32_bf16 v[152:155], v[60:63], v[232:235], v[152:155]
    ds_read_b64_tr_b16 v[56:57], v5 offset:61440
    v_mfma_f32_16x16x32_bf16 v[156:159], v[60:63], v[236:239], v[156:159]
    ds_read_b64_tr_b16 v[58:59], v5 offset:62464
    s_waitcnt vmcnt(14) lgkmcnt(10)
    v_mfma_f32_16x16x32_bf16 v[64:67], v[32:35], v[240:243], v[64:67]
    ds_read_b64_tr_b16 v[60:61], v6 offset:61440
    v_mfma_f32_16x16x32_bf16 v[68:71], v[32:35], v[244:247], v[68:71]
    ds_read_b64_tr_b16 v[62:63], v6 offset:62464
    s_barrier
    v_xor_b32 v3, 0x10000, v3
    v_xor_b32 v4, 0x10000, v4
    v_xor_b32 v5, 0x10000, v5
    v_xor_b32 v6, 0x10000, v6
    v_mfma_f32_16x16x32_bf16 v[72:75], v[36:39], v[240:243], v[72:75]
    ds_read_b64_tr_b16 v[32:33], v3 offset:0
    v_mfma_f32_16x16x32_bf16 v[76:79], v[36:39], v[244:247], v[76:79]
    ds_read_b64_tr_b16 v[34:35], v3 offset:1024
    s_waitcnt lgkmcnt(10)
    v_mfma_f32_16x16x32_bf16 v[80:83], v[40:43], v[240:243], v[80:83]
    ds_read_b64_tr_b16 v[36:37], v4 offset:0
    v_mfma_f32_16x16x32_bf16 v[84:87], v[40:43], v[244:247], v[84:87]
    ds_read_b64_tr_b16 v[38:39], v4 offset:1024
    v_mfma_f32_16x16x32_bf16 v[88:91], v[44:47], v[240:243], v[88:91]
    ds_read_b64_tr_b16 v[40:41], v5 offset:0
    v_mfma_f32_16x16x32_bf16 v[92:95], v[44:47], v[244:247], v[92:95]
    ds_read_b64_tr_b16 v[42:43], v5 offset:1024
    s_waitcnt lgkmcnt(10)
    v_mfma_f32_16x16x32_bf16 v[96:99], v[240:243], v[48:51], v[96:99]
    ds_read_b64_tr_b16 v[44:45], v6 offset:0
    v_mfma_f32_16x16x32_bf16 v[100:103], v[244:247], v[48:51], v[100:103]
    ds_read_b64_tr_b16 v[46:47], v6 offset:1024
    v_mfma_f32_16x16x32_bf16 v[104:107], v[240:243], v[52:55], v[104:107]
    ds_read_b64_tr_b16 v[48:49], v3 offset:4096
    v_mfma_f32_16x16x32_bf16 v[108:111], v[244:247], v[52:55], v[108:111]
    ds_read_b64_tr_b16 v[50:51], v3 offset:5120
    s_waitcnt lgkmcnt(10)
    v_mfma_f32_16x16x32_bf16 v[112:115], v[240:243], v[56:59], v[112:115]
    ds_read_b64_tr_b16 v[52:53], v4 offset:4096
    v_mfma_f32_16x16x32_bf16 v[116:119], v[244:247], v[56:59], v[116:119]
    ds_read_b64_tr_b16 v[54:55], v4 offset:5120
    v_mfma_f32_16x16x32_bf16 v[120:123], v[240:243], v[60:63], v[120:123]
    ds_read_b64_tr_b16 v[56:57], v5 offset:4096
    v_mfma_f32_16x16x32_bf16 v[124:127], v[244:247], v[60:63], v[124:127]
    ds_read_b64_tr_b16 v[58:59], v5 offset:5120
    s_waitcnt lgkmcnt(10)
    v_mfma_f32_16x16x32_bf16 v[128:131], v[32:35], v[240:243], v[128:131]
    ds_read_b64_tr_b16 v[60:61], v6 offset:4096
    v_mfma_f32_16x16x32_bf16 v[132:135], v[32:35], v[244:247], v[132:135]
    ds_read_b64_tr_b16 v[62:63], v6 offset:5120
    v_mfma_f32_16x16x32_bf16 v[136:139], v[36:39], v[240:243], v[136:139]
    ds_read_b64_tr_b16 v[32:33], v3 offset:8192
    v_mfma_f32_16x16x32_bf16 v[140:143], v[36:39], v[244:247], v[140:143]
    ds_read_b64_tr_b16 v[34:35], v3 offset:9216
    s_waitcnt lgkmcnt(10)
    v_mfma_f32_16x16x32_bf16 v[144:147], v[40:43], v[240:243], v[144:147]
    ds_read_b64_tr_b16 v[36:37], v4 offset:8192
    v_mfma_f32_16x16x32_bf16 v[148:151], v[40:43], v[244:247], v[148:151]
    ds_read_b64_tr_b16 v[38:39], v4 offset:9216
    v_mfma_f32_16x16x32_bf16 v[152:155], v[44:47], v[240:243], v[152:155]
    ds_read_b64_tr_b16 v[40:41], v5 offset:8192
    v_mfma_f32_16x16x32_bf16 v[156:159], v[44:47], v[244:247], v[156:159]
    ds_read_b64_tr_b16 v[42:43], v5 offset:9216
    s_waitcnt vmcnt(12) lgkmcnt(10)
    v_mfma_f32_16x16x32_bf16 v[64:67], v[48:51], v[248:251], v[64:67]
    ds_read_b64_tr_b16 v[44:45], v6 offset:8192
    v_mfma_f32_16x16x32_bf16 v[68:71], v[48:51], v[252:255], v[68:71]
    ds_read_b64_tr_b16 v[46:47], v6 offset:9216
    v_mfma_f32_16x16x32_bf16 v[72:75], v[52:55], v[248:251], v[72:75]
    ds_read_b64_tr_b16 v[48:49], v3 offset:12288
    v_mfma_f32_16x16x32_bf16 v[76:79], v[52:55], v[252:255], v[76:79]
    ds_read_b64_tr_b16 v[50:51], v3 offset:13312
    s_waitcnt lgkmcnt(10)
    v_mfma_f32_16x16x32_bf16 v[80:83], v[56:59], v[248:251], v[80:83]
    ds_read_b64_tr_b16 v[52:53], v4 offset:12288
    v_mfma_f32_16x16x32_bf16 v[84:87], v[56:59], v[252:255], v[84:87]
    ds_read_b64_tr_b16 v[54:55], v4 offset:13312
    v_mfma_f32_16x16x32_bf16 v[88:91], v[60:63], v[248:251], v[88:91]
    ds_read_b64_tr_b16 v[56:57], v5 offset:12288
    v_mfma_f32_16x16x32_bf16 v[92:95], v[60:63], v[252:255], v[92:95]
    ds_read_b64_tr_b16 v[58:59], v5 offset:13312
    s_waitcnt lgkmcnt(10)
    v_mfma_f32_16x16x32_bf16 v[96:99], v[248:251], v[32:35], v[96:99]
    ds_read_b64_tr_b16 v[60:61], v6 offset:12288
    v_mfma_f32_16x16x32_bf16 v[100:103], v[252:255], v[32:35], v[100:103]
    ds_read_b64_tr_b16 v[62:63], v6 offset:13312
    v_mfma_f32_16x16x32_bf16 v[104:107], v[248:251], v[36:39], v[104:107]
    ds_read_b64_tr_b16 v[32:33], v3 offset:16384
    v_mfma_f32_16x16x32_bf16 v[108:111], v[252:255], v[36:39], v[108:111]
    ds_read_b64_tr_b16 v[34:35], v3 offset:17408
    s_waitcnt lgkmcnt(10)
    v_mfma_f32_16x16x32_bf16 v[112:115], v[248:251], v[40:43], v[112:115]
    ds_read_b64_tr_b16 v[36:37], v4 offset:16384
    v_mfma_f32_16x16x32_bf16 v[116:119], v[252:255], v[40:43], v[116:119]
    ds_read_b64_tr_b16 v[38:39], v4 offset:17408
    v_mfma_f32_16x16x32_bf16 v[120:123], v[248:251], v[44:47], v[120:123]
    ds_read_b64_tr_b16 v[40:41], v5 offset:16384
    v_mfma_f32_16x16x32_bf16 v[124:127], v[252:255], v[44:47], v[124:127]
    ds_read_b64_tr_b16 v[42:43], v5 offset:17408
    s_waitcnt lgkmcnt(10)
    v_mfma_f32_16x16x32_bf16 v[128:131], v[48:51], v[248:251], v[128:131]
    ds_read_b64_tr_b16 v[44:45], v6 offset:16384
    s_add_u32 s42, s41, 36864
    buffer_load_dwordx4 v[208:211], v2, s[4:7], s42 offen offset:0 sc1
    v_mfma_f32_16x16x32_bf16 v[132:135], v[48:51], v[252:255], v[132:135]
    ds_read_b64_tr_b16 v[46:47], v6 offset:17408
    v_mfma_f32_16x16x32_bf16 v[136:139], v[52:55], v[248:251], v[136:139]
    ds_read_b64_tr_b16 v[48:49], v3 offset:20480
    buffer_load_dwordx4 v[212:215], v2, s[4:7], s42 offen offset:256 sc1
    v_mfma_f32_16x16x32_bf16 v[140:143], v[52:55], v[252:255], v[140:143]
    ds_read_b64_tr_b16 v[50:51], v3 offset:21504
    s_waitcnt lgkmcnt(10)
    v_mfma_f32_16x16x32_bf16 v[144:147], v[56:59], v[248:251], v[144:147]
    ds_read_b64_tr_b16 v[52:53], v4 offset:20480
    buffer_load_dwordx4 v[216:219], v2, s[4:7], s42 offen offset:2048 sc1
    v_mfma_f32_16x16x32_bf16 v[148:151], v[56:59], v[252:255], v[148:151]
    ds_read_b64_tr_b16 v[54:55], v4 offset:21504
    v_mfma_f32_16x16x32_bf16 v[152:155], v[60:63], v[248:251], v[152:155]
    ds_read_b64_tr_b16 v[56:57], v5 offset:20480
    buffer_load_dwordx4 v[220:223], v2, s[4:7], s42 offen offset:2304 sc1
    v_mfma_f32_16x16x32_bf16 v[156:159], v[60:63], v[252:255], v[156:159]
    ds_read_b64_tr_b16 v[58:59], v5 offset:21504
    s_waitcnt vmcnt(14) lgkmcnt(10)
    v_mfma_f32_16x16x32_bf16 v[64:67], v[32:35], v[160:163], v[64:67]
    ds_read_b64_tr_b16 v[60:61], v6 offset:20480
    s_add_u32 s42, s41, 40960
    buffer_load_dwordx4 v[224:227], v2, s[4:7], s42 offen offset:0 sc1
    v_mfma_f32_16x16x32_bf16 v[68:71], v[32:35], v[164:167], v[68:71]
    ds_read_b64_tr_b16 v[62:63], v6 offset:21504
    v_mfma_f32_16x16x32_bf16 v[72:75], v[36:39], v[160:163], v[72:75]
    ds_read_b64_tr_b16 v[32:33], v3 offset:24576
    buffer_load_dwordx4 v[228:231], v2, s[4:7], s42 offen offset:256 sc1
    v_mfma_f32_16x16x32_bf16 v[76:79], v[36:39], v[164:167], v[76:79]
    ds_read_b64_tr_b16 v[34:35], v3 offset:25600
    s_waitcnt lgkmcnt(10)
    v_mfma_f32_16x16x32_bf16 v[80:83], v[40:43], v[160:163], v[80:83]
    ds_read_b64_tr_b16 v[36:37], v4 offset:24576
    v_mfma_f32_16x16x32_bf16 v[84:87], v[40:43], v[164:167], v[84:87]
    ds_read_b64_tr_b16 v[38:39], v4 offset:25600
    v_mfma_f32_16x16x32_bf16 v[88:91], v[44:47], v[160:163], v[88:91]
    ds_read_b64_tr_b16 v[40:41], v5 offset:24576
    v_mfma_f32_16x16x32_bf16 v[92:95], v[44:47], v[164:167], v[92:95]
    ds_read_b64_tr_b16 v[42:43], v5 offset:25600
    s_waitcnt lgkmcnt(10)
    v_mfma_f32_16x16x32_bf16 v[96:99], v[160:163], v[48:51], v[96:99]
    ds_read_b64_tr_b16 v[44:45], v6 offset:24576
    buffer_load_dwordx4 v[232:235], v2, s[4:7], s42 offen offset:2048 sc1
    v_mfma_f32_16x16x32_bf16 v[100:103], v[164:167], v[48:51], v[100:103]
    ds_read_b64_tr_b16 v[46:47], v6 offset:25600
    v_mfma_f32_16x16x32_bf16 v[104:107], v[160:163], v[52:55], v[104:107]
    ds_read_b64_tr_b16 v[48:49], v3 offset:28672
    v_mfma_f32_16x16x32_bf16 v[108:111], v[164:167], v[52:55], v[108:111]
    ds_read_b64_tr_b16 v[50:51], v3 offset:29696
    s_waitcnt lgkmcnt(10)
    v_mfma_f32_16x16x32_bf16 v[112:115], v[160:163], v[56:59], v[112:115]
    ds_read_b64_tr_b16 v[52:53], v4 offset:28672
    v_mfma_f32_16x16x32_bf16 v[116:119], v[164:167], v[56:59], v[116:119]
    ds_read_b64_tr_b16 v[54:55], v4 offset:29696
    v_mfma_f32_16x16x32_bf16 v[120:123], v[160:163], v[60:63], v[120:123]
    ds_read_b64_tr_b16 v[56:57], v5 offset:28672
    v_mfma_f32_16x16x32_bf16 v[124:127], v[164:167], v[60:63], v[124:127]
    ds_read_b64_tr_b16 v[58:59], v5 offset:29696
    s_waitcnt lgkmcnt(10)
    v_mfma_f32_16x16x32_bf16 v[128:131], v[32:35], v[160:163], v[128:131]
    ds_read_b64_tr_b16 v[60:61], v6 offset:28672
    v_mfma_f32_16x16x32_bf16 v[132:135], v[32:35], v[164:167], v[132:135]
    ds_read_b64_tr_b16 v[62:63], v6 offset:29696
    s_barrier
    v_mfma_f32_16x16x32_bf16 v[136:139], v[36:39], v[160:163], v[136:139]
    ds_read_b64_tr_b16 v[32:33], v3 offset:32768
    v_mfma_f32_16x16x32_bf16 v[140:143], v[36:39], v[164:167], v[140:143]
    ds_read_b64_tr_b16 v[34:35], v3 offset:33792
    s_waitcnt lgkmcnt(10)
    v_mfma_f32_16x16x32_bf16 v[144:147], v[40:43], v[160:163], v[144:147]
    ds_read_b64_tr_b16 v[36:37], v4 offset:32768
    v_mfma_f32_16x16x32_bf16 v[148:151], v[40:43], v[164:167], v[148:151]
    ds_read_b64_tr_b16 v[38:39], v4 offset:33792
    v_mfma_f32_16x16x32_bf16 v[152:155], v[44:47], v[160:163], v[152:155]
    ds_read_b64_tr_b16 v[40:41], v5 offset:32768
    v_mfma_f32_16x16x32_bf16 v[156:159], v[44:47], v[164:167], v[156:159]
    ds_read_b64_tr_b16 v[42:43], v5 offset:33792
    s_waitcnt vmcnt(15) lgkmcnt(10)
    v_mfma_f32_16x16x32_bf16 v[64:67], v[48:51], v[168:171], v[64:67]
    ds_read_b64_tr_b16 v[44:45], v6 offset:32768
    v_mfma_f32_16x16x32_bf16 v[68:71], v[48:51], v[172:175], v[68:71]
    ds_read_b64_tr_b16 v[46:47], v6 offset:33792
    v_mfma_f32_16x16x32_bf16 v[72:75], v[52:55], v[168:171], v[72:75]
    ds_read_b64_tr_b16 v[48:49], v3 offset:36864
    v_mfma_f32_16x16x32_bf16 v[76:79], v[52:55], v[172:175], v[76:79]
    ds_read_b64_tr_b16 v[50:51], v3 offset:37888
    s_waitcnt lgkmcnt(10)
    v_mfma_f32_16x16x32_bf16 v[80:83], v[56:59], v[168:171], v[80:83]
    ds_read_b64_tr_b16 v[52:53], v4 offset:36864
    v_mfma_f32_16x16x32_bf16 v[84:87], v[56:59], v[172:175], v[84:87]
    ds_read_b64_tr_b16 v[54:55], v4 offset:37888
    v_mfma_f32_16x16x32_bf16 v[88:91], v[60:63], v[168:171], v[88:91]
    ds_read_b64_tr_b16 v[56:57], v5 offset:36864
    v_mfma_f32_16x16x32_bf16 v[92:95], v[60:63], v[172:175], v[92:95]
    ds_read_b64_tr_b16 v[58:59], v5 offset:37888
    s_waitcnt lgkmcnt(10)
    v_mfma_f32_16x16x32_bf16 v[96:99], v[168:171], v[32:35], v[96:99]
    ds_read_b64_tr_b16 v[60:61], v6 offset:36864
    v_mfma_f32_16x16x32_bf16 v[100:103], v[172:175], v[32:35], v[100:103]
    ds_read_b64_tr_b16 v[62:63], v6 offset:37888
    v_mfma_f32_16x16x32_bf16 v[104:107], v[168:171], v[36:39], v[104:107]
    ds_read_b64_tr_b16 v[32:33], v3 offset:40960
    v_mfma_f32_16x16x32_bf16 v[108:111], v[172:175], v[36:39], v[108:111]
    ds_read_b64_tr_b16 v[34:35], v3 offset:41984
    s_waitcnt lgkmcnt(10)
    v_mfma_f32_16x16x32_bf16 v[112:115], v[168:171], v[40:43], v[112:115]
    ds_read_b64_tr_b16 v[36:37], v4 offset:40960
    v_mfma_f32_16x16x32_bf16 v[116:119], v[172:175], v[40:43], v[116:119]
    ds_read_b64_tr_b16 v[38:39], v4 offset:41984
    v_mfma_f32_16x16x32_bf16 v[120:123], v[168:171], v[44:47], v[120:123]
    ds_read_b64_tr_b16 v[40:41], v5 offset:40960
    v_mfma_f32_16x16x32_bf16 v[124:127], v[172:175], v[44:47], v[124:127]
    ds_read_b64_tr_b16 v[42:43], v5 offset:41984
    s_waitcnt lgkmcnt(10)
    v_mfma_f32_16x16x32_bf16 v[128:131], v[48:51], v[168:171], v[128:131]
    ds_read_b64_tr_b16 v[44:45], v6 offset:40960
    v_mfma_f32_16x16x32_bf16 v[132:135], v[48:51], v[172:175], v[132:135]
    ds_read_b64_tr_b16 v[46:47], v6 offset:41984
    v_mfma_f32_16x16x32_bf16 v[136:139], v[52:55], v[168:171], v[136:139]
    ds_read_b64_tr_b16 v[48:49], v3 offset:45056
    v_mfma_f32_16x16x32_bf16 v[140:143], v[52:55], v[172:175], v[140:143]
    ds_read_b64_tr_b16 v[50:51], v3 offset:46080
    s_waitcnt lgkmcnt(10)
    v_mfma_f32_16x16x32_bf16 v[144:147], v[56:59], v[168:171], v[144:147]
    ds_read_b64_tr_b16 v[52:53], v4 offset:45056
    v_mfma_f32_16x16x32_bf16 v[148:151], v[56:59], v[172:175], v[148:151]
    ds_read_b64_tr_b16 v[54:55], v4 offset:46080
    v_mfma_f32_16x16x32_bf16 v[152:155], v[60:63], v[168:171], v[152:155]
    ds_read_b64_tr_b16 v[56:57], v5 offset:45056
    v_mfma_f32_16x16x32_bf16 v[156:159], v[60:63], v[172:175], v[156:159]
    ds_read_b64_tr_b16 v[58:59], v5 offset:46080
    s_waitcnt vmcnt(13) lgkmcnt(10)
    v_mfma_f32_16x16x32_bf16 v[64:67], v[32:35], v[176:179], v[64:67]
    ds_read_b64_tr_b16 v[60:61], v6 offset:45056
    v_mfma_f32_16x16x32_bf16 v[68:71], v[32:35], v[180:183], v[68:71]
    ds_read_b64_tr_b16 v[62:63], v6 offset:46080
    v_mfma_f32_16x16x32_bf16 v[72:75], v[36:39], v[176:179], v[72:75]
    ds_read_b64_tr_b16 v[32:33], v3 offset:49152
    v_mfma_f32_16x16x32_bf16 v[76:79], v[36:39], v[180:183], v[76:79]
    ds_read_b64_tr_b16 v[34:35], v3 offset:50176
    s_waitcnt lgkmcnt(10)
    v_mfma_f32_16x16x32_bf16 v[80:83], v[40:43], v[176:179], v[80:83]
    ds_read_b64_tr_b16 v[36:37], v4 offset:49152
    v_mfma_f32_16x16x32_bf16 v[84:87], v[40:43], v[180:183], v[84:87]
    ds_read_b64_tr_b16 v[38:39], v4 offset:50176
    v_mfma_f32_16x16x32_bf16 v[88:91], v[44:47], v[176:179], v[88:91]
    ds_read_b64_tr_b16 v[40:41], v5 offset:49152
    v_mfma_f32_16x16x32_bf16 v[92:95], v[44:47], v[180:183], v[92:95]
    ds_read_b64_tr_b16 v[42:43], v5 offset:50176
    s_waitcnt lgkmcnt(10)
    v_mfma_f32_16x16x32_bf16 v[96:99], v[176:179], v[48:51], v[96:99]
    ds_read_b64_tr_b16 v[44:45], v6 offset:49152
    buffer_load_dwordx4 v[236:239], v2, s[4:7], s42 offen offset:2304 sc1
    v_mfma_f32_16x16x32_bf16 v[100:103], v[180:183], v[48:51], v[100:103]
    ds_read_b64_tr_b16 v[46:47], v6 offset:50176
    v_mfma_f32_16x16x32_bf16 v[104:107], v[176:179], v[52:55], v[104:107]
    ds_read_b64_tr_b16 v[48:49], v3 offset:53248
    s_add_u32 s42, s41, 45056
    buffer_load_dwordx4 v[240:243], v2, s[4:7], s42 offen offset:0 sc1
    v_mfma_f32_16x16x32_bf16 v[108:111], v[180:183], v[52:55], v[108:111]
    ds_read_b64_tr_b16 v[50:51], v3 offset:54272
    s_waitcnt lgkmcnt(10)
    v_mfma_f32_16x16x32_bf16 v[112:115], v[176:179], v[56:59], v[112:115]
    ds_read_b64_tr_b16 v[52:53], v4 offset:53248
    buffer_load_dwordx4 v[244:247], v2, s[4:7], s42 offen offset:256 sc1
    v_mfma_f32_16x16x32_bf16 v[116:119], v[180:183], v[56:59], v[116:119]
    ds_read_b64_tr_b16 v[54:55], v4 offset:54272
    v_mfma_f32_16x16x32_bf16 v[120:123], v[176:179], v[60:63], v[120:123]
    ds_read_b64_tr_b16 v[56:57], v5 offset:53248
    buffer_load_dwordx4 v[248:251], v2, s[4:7], s42 offen offset:2048 sc1
    v_mfma_f32_16x16x32_bf16 v[124:127], v[180:183], v[60:63], v[124:127]
    ds_read_b64_tr_b16 v[58:59], v5 offset:54272
    s_waitcnt lgkmcnt(10)
    v_mfma_f32_16x16x32_bf16 v[128:131], v[32:35], v[176:179], v[128:131]
    ds_read_b64_tr_b16 v[60:61], v6 offset:53248
    buffer_load_dwordx4 v[252:255], v2, s[4:7], s42 offen offset:2304 sc1
    v_mfma_f32_16x16x32_bf16 v[132:135], v[32:35], v[180:183], v[132:135]
    ds_read_b64_tr_b16 v[62:63], v6 offset:54272
    v_mfma_f32_16x16x32_bf16 v[136:139], v[36:39], v[176:179], v[136:139]
    ds_read_b64_tr_b16 v[32:33], v3 offset:57344
    s_add_u32 s42, s41, 49152
    buffer_load_dwordx4 v[160:163], v2, s[4:7], s42 offen offset:0 sc1
    v_mfma_f32_16x16x32_bf16 v[140:143], v[36:39], v[180:183], v[140:143]
    ds_read_b64_tr_b16 v[34:35], v3 offset:58368
    s_waitcnt lgkmcnt(10)
    v_mfma_f32_16x16x32_bf16 v[144:147], v[40:43], v[176:179], v[144:147]
    ds_read_b64_tr_b16 v[36:37], v4 offset:57344
    v_mfma_f32_16x16x32_bf16 v[148:151], v[40:43], v[180:183], v[148:151]
    ds_read_b64_tr_b16 v[38:39], v4 offset:58368
    v_mfma_f32_16x16x32_bf16 v[152:155], v[44:47], v[176:179], v[152:155]
    ds_read_b64_tr_b16 v[40:41], v5 offset:57344
    v_mfma_f32_16x16x32_bf16 v[156:159], v[44:47], v[180:183], v[156:159]
    ds_read_b64_tr_b16 v[42:43], v5 offset:58368
    s_waitcnt vmcnt(17) lgkmcnt(10)
    v_mfma_f32_16x16x32_bf16 v[64:67], v[48:51], v[184:187], v[64:67]
    ds_read_b64_tr_b16 v[44:45], v6 offset:57344
    v_mfma_f32_16x16x32_bf16 v[68:71], v[48:51], v[188:191], v[68:71]
    ds_read_b64_tr_b16 v[46:47], v6 offset:58368
    v_mfma_f32_16x16x32_bf16 v[72:75], v[52:55], v[184:187], v[72:75]
    ds_read_b64_tr_b16 v[48:49], v3 offset:61440
    v_mfma_f32_16x16x32_bf16 v[76:79], v[52:55], v[188:191], v[76:79]
    ds_read_b64_tr_b16 v[50:51], v3 offset:62464
    s_waitcnt lgkmcnt(10)
    v_mfma_f32_16x16x32_bf16 v[80:83], v[56:59], v[184:187], v[80:83]
    ds_read_b64_tr_b16 v[52:53], v4 offset:61440
    buffer_load_dwordx4 v[164:167], v2, s[4:7], s42 offen offset:256 sc1
    v_mfma_f32_16x16x32_bf16 v[84:87], v[56:59], v[188:191], v[84:87]
    ds_read_b64_tr_b16 v[54:55], v4 offset:62464
    v_mfma_f32_16x16x32_bf16 v[88:91], v[60:63], v[184:187], v[88:91]
    ds_read_b64_tr_b16 v[56:57], v5 offset:61440
    v_mfma_f32_16x16x32_bf16 v[92:95], v[60:63], v[188:191], v[92:95]
    ds_read_b64_tr_b16 v[58:59], v5 offset:62464
    s_waitcnt lgkmcnt(10)
    v_mfma_f32_16x16x32_bf16 v[96:99], v[184:187], v[32:35], v[96:99]
    ds_read_b64_tr_b16 v[60:61], v6 offset:61440
    v_mfma_f32_16x16x32_bf16 v[100:103], v[188:191], v[32:35], v[100:103]
    ds_read_b64_tr_b16 v[62:63], v6 offset:62464
    s_barrier
    v_xor_b32 v3, 0x10000, v3
    v_xor_b32 v4, 0x10000, v4
    v_xor_b32 v5, 0x10000, v5
    v_xor_b32 v6, 0x10000, v6
    v_mfma_f32_16x16x32_bf16 v[104:107], v[184:187], v[36:39], v[104:107]
    ds_read_b64_tr_b16 v[32:33], v3 offset:0
    v_mfma_f32_16x16x32_bf16 v[108:111], v[188:191], v[36:39], v[108:111]
    ds_read_b64_tr_b16 v[34:35], v3 offset:1024
    s_waitcnt lgkmcnt(10)
    v_mfma_f32_16x16x32_bf16 v[112:115], v[184:187], v[40:43], v[112:115]
    ds_read_b64_tr_b16 v[36:37], v4 offset:0
    v_mfma_f32_16x16x32_bf16 v[116:119], v[188:191], v[40:43], v[116:119]
    ds_read_b64_tr_b16 v[38:39], v4 offset:1024
    v_mfma_f32_16x16x32_bf16 v[120:123], v[184:187], v[44:47], v[120:123]
    ds_read_b64_tr_b16 v[40:41], v5 offset:0
    v_mfma_f32_16x16x32_bf16 v[124:127], v[188:191], v[44:47], v[124:127]
    ds_read_b64_tr_b16 v[42:43], v5 offset:1024
    s_waitcnt lgkmcnt(10)
    v_mfma_f32_16x16x32_bf16 v[128:131], v[48:51], v[184:187], v[128:131]
    ds_read_b64_tr_b16 v[44:45], v6 offset:0
    v_mfma_f32_16x16x32_bf16 v[132:135], v[48:51], v[188:191], v[132:135]
    ds_read_b64_tr_b16 v[46:47], v6 offset:1024
    v_mfma_f32_16x16x32_bf16 v[136:139], v[52:55], v[184:187], v[136:139]
    ds_read_b64_tr_b16 v[48:49], v3 offset:4096
    v_mfma_f32_16x16x32_bf16 v[140:143], v[52:55], v[188:191], v[140:143]
    ds_read_b64_tr_b16 v[50:51], v3 offset:5120
    s_waitcnt lgkmcnt(10)
    v_mfma_f32_16x16x32_bf16 v[144:147], v[56:59], v[184:187], v[144:147]
    ds_read_b64_tr_b16 v[52:53], v4 offset:4096
    v_mfma_f32_16x16x32_bf16 v[148:151], v[56:59], v[188:191], v[148:151]
    ds_read_b64_tr_b16 v[54:55], v4 offset:5120
    v_mfma_f32_16x16x32_bf16 v[152:155], v[60:63], v[184:187], v[152:155]
    ds_read_b64_tr_b16 v[56:57], v5 offset:4096
    v_mfma_f32_16x16x32_bf16 v[156:159], v[60:63], v[188:191], v[156:159]
    ds_read_b64_tr_b16 v[58:59], v5 offset:5120
    s_waitcnt vmcnt(16) lgkmcnt(10)
    v_mfma_f32_16x16x32_bf16 v[64:67], v[32:35], v[192:195], v[64:67]
    ds_read_b64_tr_b16 v[60:61], v6 offset:4096
    v_mfma_f32_16x16x32_bf16 v[68:71], v[32:35], v[196:199], v[68:71]
    ds_read_b64_tr_b16 v[62:63], v6 offset:5120
    v_mfma_f32_16x16x32_bf16 v[72:75], v[36:39], v[192:195], v[72:75]
    ds_read_b64_tr_b16 v[32:33], v3 offset:8192
    v_mfma_f32_16x16x32_bf16 v[76:79], v[36:39], v[196:199], v[76:79]
    ds_read_b64_tr_b16 v[34:35], v3 offset:9216
    s_waitcnt lgkmcnt(10)
    v_mfma_f32_16x16x32_bf16 v[80:83], v[40:43], v[192:195], v[80:83]
    ds_read_b64_tr_b16 v[36:37], v4 offset:8192
    v_mfma_f32_16x16x32_bf16 v[84:87], v[40:43], v[196:199], v[84:87]
    ds_read_b64_tr_b16 v[38:39], v4 offset:9216
    v_mfma_f32_16x16x32_bf16 v[88:91], v[44:47], v[192:195], v[88:91]
    ds_read_b64_tr_b16 v[40:41], v5 offset:8192
    v_mfma_f32_16x16x32_bf16 v[92:95], v[44:47], v[196:199], v[92:95]
    ds_read_b64_tr_b16 v[42:43], v5 offset:9216
    s_waitcnt lgkmcnt(10)
    v_mfma_f32_16x16x32_bf16 v[96:99], v[192:195], v[48:51], v[96:99]
    ds_read_b64_tr_b16 v[44:45], v6 offset:8192
    v_mfma_f32_16x16x32_bf16 v[100:103], v[196:199], v[48:51], v[100:103]
    ds_read_b64_tr_b16 v[46:47], v6 offset:9216
    v_mfma_f32_16x16x32_bf16 v[104:107], v[192:195], v[52:55], v[104:107]
    ds_read_b64_tr_b16 v[48:49], v3 offset:12288
    v_mfma_f32_16x16x32_bf16 v[108:111], v[196:199], v[52:55], v[108:111]
    ds_read_b64_tr_b16 v[50:51], v3 offset:13312
    s_waitcnt lgkmcnt(10)
    v_mfma_f32_16x16x32_bf16 v[112:115], v[192:195], v[56:59], v[112:115]
    ds_read_b64_tr_b16 v[52:53], v4 offset:12288
    v_mfma_f32_16x16x32_bf16 v[116:119], v[196:199], v[56:59], v[116:119]
    ds_read_b64_tr_b16 v[54:55], v4 offset:13312
    v_mfma_f32_16x16x32_bf16 v[120:123], v[192:195], v[60:63], v[120:123]
    ds_read_b64_tr_b16 v[56:57], v5 offset:12288
    v_mfma_f32_16x16x32_bf16 v[124:127], v[196:199], v[60:63], v[124:127]
    ds_read_b64_tr_b16 v[58:59], v5 offset:13312
    s_waitcnt lgkmcnt(10)
    v_mfma_f32_16x16x32_bf16 v[128:131], v[32:35], v[192:195], v[128:131]
    ds_read_b64_tr_b16 v[60:61], v6 offset:12288
    v_mfma_f32_16x16x32_bf16 v[132:135], v[32:35], v[196:199], v[132:135]
    ds_read_b64_tr_b16 v[62:63], v6 offset:13312
    v_mfma_f32_16x16x32_bf16 v[136:139], v[36:39], v[192:195], v[136:139]
    ds_read_b64_tr_b16 v[32:33], v3 offset:16384
    v_mfma_f32_16x16x32_bf16 v[140:143], v[36:39], v[196:199], v[140:143]
    ds_read_b64_tr_b16 v[34:35], v3 offset:17408
    s_waitcnt lgkmcnt(10)
    v_mfma_f32_16x16x32_bf16 v[144:147], v[40:43], v[192:195], v[144:147]
    ds_read_b64_tr_b16 v[36:37], v4 offset:16384
    v_mfma_f32_16x16x32_bf16 v[148:151], v[40:43], v[196:199], v[148:151]
    ds_read_b64_tr_b16 v[38:39], v4 offset:17408
    v_mfma_f32_16x16x32_bf16 v[152:155], v[44:47], v[192:195], v[152:155]
    ds_read_b64_tr_b16 v[40:41], v5 offset:16384
    v_mfma_f32_16x16x32_bf16 v[156:159], v[44:47], v[196:199], v[156:159]
    ds_read_b64_tr_b16 v[42:43], v5 offset:17408
    s_waitcnt vmcnt(14) lgkmcnt(10)
    v_mfma_f32_16x16x32_bf16 v[64:67], v[48:51], v[200:203], v[64:67]
    ds_read_b64_tr_b16 v[44:45], v6 offset:16384
    buffer_load_dwordx4 v[168:171], v2, s[4:7], s42 offen offset:2048 sc1
    v_mfma_f32_16x16x32_bf16 v[68:71], v[48:51], v[204:207], v[68:71]
    ds_read_b64_tr_b16 v[46:47], v6 offset:17408
    v_mfma_f32_16x16x32_bf16 v[72:75], v[52:55], v[200:203], v[72:75]
    ds_read_b64_tr_b16 v[48:49], v3 offset:20480
    buffer_load_dwordx4 v[172:175], v2, s[4:7], s42 offen offset:2304 sc1
    v_mfma_f32_16x16x32_bf16 v[76:79], v[52:55], v[204:207], v[76:79]
    ds_read_b64_tr_b16 v[50:51], v3 offset:21504
    s_waitcnt lgkmcnt(10)
    v_mfma_f32_16x16x32_bf16 v[80:83], v[56:59], v[200:203], v[80:83]
    ds_read_b64_tr_b16 v[52:53], v4 offset:20480
    s_add_u32 s42, s41, 53248
    buffer_load_dwordx4 v[176:179], v2, s[4:7], s42 offen offset:0 sc1
    v_mfma_f32_16x16x32_bf16 v[84:87], v[56:59], v[204:207], v[84:87]
    ds_read_b64_tr_b16 v[54:55], v4 offset:21504
    v_mfma_f32_16x16x32_bf16 v[88:91], v[60:63], v[200:203], v[88:91]
    ds_read_b64_tr_b16 v[56:57], v5 offset:20480
    buffer_load_dwordx4 v[180:183], v2, s[4:7], s42 offen offset:256 sc1
    v_mfma_f32_16x16x32_bf16 v[92:95], v[60:63], v[204:207], v[92:95]
    ds_read_b64_tr_b16 v[58:59], v5 offset:21504
    s_waitcnt lgkmcnt(10)
    v_mfma_f32_16x16x32_bf16 v[96:99], v[200:203], v[32:35], v[96:99]
    ds_read_b64_tr_b16 v[60:61], v6 offset:20480
    buffer_load_dwordx4 v[184:187], v2, s[4:7], s42 offen offset:2048 sc1
    v_mfma_f32_16x16x32_bf16 v[100:103], v[204:207], v[32:35], v[100:103]
    ds_read_b64_tr_b16 v[62:63], v6 offset:21504
    v_mfma_f32_16x16x32_bf16 v[104:107], v[200:203], v[36:39], v[104:107]
    ds_read_b64_tr_b16 v[32:33], v3 offset:24576
    v_mfma_f32_16x16x32_bf16 v[108:111], v[204:207], v[36:39], v[108:111]
    ds_read_b64_tr_b16 v[34:35], v3 offset:25600
    s_waitcnt lgkmcnt(10)
    v_mfma_f32_16x16x32_bf16 v[112:115], v[200:203], v[40:43], v[112:115]
    ds_read_b64_tr_b16 v[36:37], v4 offset:24576
    v_mfma_f32_16x16x32_bf16 v[116:119], v[204:207], v[40:43], v[116:119]
    ds_read_b64_tr_b16 v[38:39], v4 offset:25600
    v_mfma_f32_16x16x32_bf16 v[120:123], v[200:203], v[44:47], v[120:123]
    ds_read_b64_tr_b16 v[40:41], v5 offset:24576
    buffer_load_dwordx4 v[188:191], v2, s[4:7], s42 offen offset:2304 sc1
    v_mfma_f32_16x16x32_bf16 v[124:127], v[204:207], v[44:47], v[124:127]
    ds_read_b64_tr_b16 v[42:43], v5 offset:25600
    s_waitcnt lgkmcnt(10)
    v_mfma_f32_16x16x32_bf16 v[128:131], v[48:51], v[200:203], v[128:131]
    ds_read_b64_tr_b16 v[44:45], v6 offset:24576
    v_mfma_f32_16x16x32_bf16 v[132:135], v[48:51], v[204:207], v[132:135]
    ds_read_b64_tr_b16 v[46:47], v6 offset:25600
    v_mfma_f32_16x16x32_bf16 v[136:139], v[52:55], v[200:203], v[136:139]
    ds_read_b64_tr_b16 v[48:49], v3 offset:28672
    v_mfma_f32_16x16x32_bf16 v[140:143], v[52:55], v[204:207], v[140:143]
    ds_read_b64_tr_b16 v[50:51], v3 offset:29696
    s_waitcnt lgkmcnt(10)
    v_mfma_f32_16x16x32_bf16 v[144:147], v[56:59], v[200:203], v[144:147]
    ds_read_b64_tr_b16 v[52:53], v4 offset:28672
    v_mfma_f32_16x16x32_bf16 v[148:151], v[56:59], v[204:207], v[148:151]
    ds_read_b64_tr_b16 v[54:55], v4 offset:29696
    v_mfma_f32_16x16x32_bf16 v[152:155], v[60:63], v[200:203], v[152:155]
    ds_read_b64_tr_b16 v[56:57], v5 offset:28672
    v_mfma_f32_16x16x32_bf16 v[156:159], v[60:63], v[204:207], v[156:159]
    ds_read_b64_tr_b16 v[58:59], v5 offset:29696
    s_waitcnt vmcnt(18) lgkmcnt(10)
    v_mfma_f32_16x16x32_bf16 v[64:67], v[32:35], v[208:211], v[64:67]
    ds_read_b64_tr_b16 v[60:61], v6 offset:28672
    v_mfma_f32_16x16x32_bf16 v[68:71], v[32:35], v[212:215], v[68:71]
    ds_read_b64_tr_b16 v[62:63], v6 offset:29696
    s_barrier
    v_mfma_f32_16x16x32_bf16 v[72:75], v[36:39], v[208:211], v[72:75]
    ds_read_b64_tr_b16 v[32:33], v3 offset:32768
    v_mfma_f32_16x16x32_bf16 v[76:79], v[36:39], v[212:215], v[76:79]
    ds_read_b64_tr_b16 v[34:35], v3 offset:33792
    s_waitcnt lgkmcnt(10)
    v_mfma_f32_16x16x32_bf16 v[80:83], v[40:43], v[208:211], v[80:83]
    ds_read_b64_tr_b16 v[36:37], v4 offset:32768
    v_mfma_f32_16x16x32_bf16 v[84:87], v[40:43], v[212:215], v[84:87]
    ds_read_b64_tr_b16 v[38:39], v4 offset:33792
    v_mfma_f32_16x16x32_bf16 v[88:91], v[44:47], v[208:211], v[88:91]
    ds_read_b64_tr_b16 v[40:41], v5 offset:32768
    v_mfma_f32_16x16x32_bf16 v[92:95], v[44:47], v[212:215], v[92:95]
    ds_read_b64_tr_b16 v[42:43], v5 offset:33792
    s_waitcnt lgkmcnt(10)
    v_mfma_f32_16x16x32_bf16 v[96:99], v[208:211], v[48:51], v[96:99]
    ds_read_b64_tr_b16 v[44:45], v6 offset:32768
    v_mfma_f32_16x16x32_bf16 v[100:103], v[212:215], v[48:51], v[100:103]
    ds_read_b64_tr_b16 v[46:47], v6 offset:33792
    v_mfma_f32_16x16x32_bf16 v[104:107], v[208:211], v[52:55], v[104:107]
    ds_read_b64_tr_b16 v[48:49], v3 offset:36864
    v_mfma_f32_16x16x32_bf16 v[108:111], v[212:215], v[52:55], v[108:111]
    ds_read_b64_tr_b16 v[50:51], v3 offset:37888
    s_waitcnt lgkmcnt(10)
    v_mfma_f32_16x16x32_bf16 v[112:115], v[208:211], v[56:59], v[112:115]
    ds_read_b64_tr_b16 v[52:53], v4 offset:36864
    v_mfma_f32_16x16x32_bf16 v[116:119], v[212:215], v[56:59], v[116:119]
    ds_read_b64_tr_b16 v[54:55], v4 offset:37888
    v_mfma_f32_16x16x32_bf16 v[120:123], v[208:211], v[60:63], v[120:123]
    ds_read_b64_tr_b16 v[56:57], v5 offset:36864
    v_mfma_f32_16x16x32_bf16 v[124:127], v[212:215], v[60:63], v[124:127]
    ds_read_b64_tr_b16 v[58:59], v5 offset:37888
    s_waitcnt lgkmcnt(10)
    v_mfma_f32_16x16x32_bf16 v[128:131], v[32:35], v[208:211], v[128:131]
    ds_read_b64_tr_b16 v[60:61], v6 offset:36864
    v_mfma_f32_16x16x32_bf16 v[132:135], v[32:35], v[212:215], v[132:135]
    ds_read_b64_tr_b16 v[62:63], v6 offset:37888
    v_mfma_f32_16x16x32_bf16 v[136:139], v[36:39], v[208:211], v[136:139]
    ds_read_b64_tr_b16 v[32:33], v3 offset:40960
    v_mfma_f32_16x16x32_bf16 v[140:143], v[36:39], v[212:215], v[140:143]
    ds_read_b64_tr_b16 v[34:35], v3 offset:41984
    s_waitcnt lgkmcnt(10)
    v_mfma_f32_16x16x32_bf16 v[144:147], v[40:43], v[208:211], v[144:147]
    ds_read_b64_tr_b16 v[36:37], v4 offset:40960
    v_mfma_f32_16x16x32_bf16 v[148:151], v[40:43], v[212:215], v[148:151]
    ds_read_b64_tr_b16 v[38:39], v4 offset:41984
    v_mfma_f32_16x16x32_bf16 v[152:155], v[44:47], v[208:211], v[152:155]
    ds_read_b64_tr_b16 v[40:41], v5 offset:40960
    v_mfma_f32_16x16x32_bf16 v[156:159], v[44:47], v[212:215], v[156:159]
    ds_read_b64_tr_b16 v[42:43], v5 offset:41984
    s_waitcnt vmcnt(16) lgkmcnt(10)
    v_mfma_f32_16x16x32_bf16 v[64:67], v[48:51], v[216:219], v[64:67]
    ds_read_b64_tr_b16 v[44:45], v6 offset:40960
    v_mfma_f32_16x16x32_bf16 v[68:71], v[48:51], v[220:223], v[68:71]
    ds_read_b64_tr_b16 v[46:47], v6 offset:41984
    v_mfma_f32_16x16x32_bf16 v[72:75], v[52:55], v[216:219], v[72:75]
    ds_read_b64_tr_b16 v[48:49], v3 offset:45056
    v_mfma_f32_16x16x32_bf16 v[76:79], v[52:55], v[220:223], v[76:79]
    ds_read_b64_tr_b16 v[50:51], v3 offset:46080
    s_waitcnt lgkmcnt(10)
    v_mfma_f32_16x16x32_bf16 v[80:83], v[56:59], v[216:219], v[80:83]
    ds_read_b64_tr_b16 v[52:53], v4 offset:45056
    v_mfma_f32_16x16x32_bf16 v[84:87], v[56:59], v[220:223], v[84:87]
    ds_read_b64_tr_b16 v[54:55], v4 offset:46080
    v_mfma_f32_16x16x32_bf16 v[88:91], v[60:63], v[216:219], v[88:91]
    ds_read_b64_tr_b16 v[56:57], v5 offset:45056
    v_mfma_f32_16x16x32_bf16 v[92:95], v[60:63], v[220:223], v[92:95]
    ds_read_b64_tr_b16 v[58:59], v5 offset:46080
    s_waitcnt lgkmcnt(10)
    v_mfma_f32_16x16x32_bf16 v[96:99], v[216:219], v[32:35], v[96:99]
    ds_read_b64_tr_b16 v[60:61], v6 offset:45056
    v_mfma_f32_16x16x32_bf16 v[100:103], v[220:223], v[32:35], v[100:103]
    ds_read_b64_tr_b16 v[62:63], v6 offset:46080
    v_mfma_f32_16x16x32_bf16 v[104:107], v[216:219], v[36:39], v[104:107]
    ds_read_b64_tr_b16 v[32:33], v3 offset:49152
    v_mfma_f32_16x16x32_bf16 v[108:111], v[220:223], v[36:39], v[108:111]
    ds_read_b64_tr_b16 v[34:35], v3 offset:50176
    s_waitcnt lgkmcnt(10)
    v_mfma_f32_16x16x32_bf16 v[112:115], v[216:219], v[40:43], v[112:115]
    ds_read_b64_tr_b16 v[36:37], v4 offset:49152
    v_mfma_f32_16x16x32_bf16 v[116:119], v[220:223], v[40:43], v[116:119]
    ds_read_b64_tr_b16 v[38:39], v4 offset:50176
    v_mfma_f32_16x16x32_bf16 v[120:123], v[216:219], v[44:47], v[120:123]
    ds_read_b64_tr_b16 v[40:41], v5 offset:49152
    v_mfma_f32_16x16x32_bf16 v[124:127], v[220:223], v[44:47], v[124:127]
    ds_read_b64_tr_b16 v[42:43], v5 offset:50176
    s_waitcnt lgkmcnt(10)
    v_mfma_f32_16x16x32_bf16 v[128:131], v[48:51], v[216:219], v[128:131]
    ds_read_b64_tr_b16 v[44:45], v6 offset:49152
    s_add_u32 s42, s41, 57344
    buffer_load_dwordx4 v[192:195], v2, s[4:7], s42 offen offset:0 sc1
    v_mfma_f32_16x16x32_bf16 v[132:135], v[48:51], v[220:223], v[132:135]
    ds_read_b64_tr_b16 v[46:47], v6 offset:50176
    v_mfma_f32_16x16x32_bf16 v[136:139], v[52:55], v[216:219], v[136:139]
    ds_read_b64_tr_b16 v[48:49], v3 offset:53248
    buffer_load_dwordx4 v[196:199], v2, s[4:7], s42 offen offset:256 sc1
    v_mfma_f32_16x16x32_bf16 v[140:143], v[52:55], v[220:223], v[140:143]
    ds_read_b64_tr_b16 v[50:51], v3 offset:54272
    s_waitcnt lgkmcnt(10)
    v_mfma_f32_16x16x32_bf16 v[144:147], v[56:59], v[216:219], v[144:147]
    ds_read_b64_tr_b16 v[52:53], v4 offset:53248
    buffer_load_dwordx4 v[200:203], v2, s[4:7], s42 offen offset:2048 sc1
    v_mfma_f32_16x16x32_bf16 v[148:151], v[56:59], v[220:223], v[148:151]
    ds_read_b64_tr_b16 v[54:55], v4 offset:54272
    v_mfma_f32_16x16x32_bf16 v[152:155], v[60:63], v[216:219], v[152:155]
    ds_read_b64_tr_b16 v[56:57], v5 offset:53248
    buffer_load_dwordx4 v[204:207], v2, s[4:7], s42 offen offset:2304 sc1
    v_mfma_f32_16x16x32_bf16 v[156:159], v[60:63], v[220:223], v[156:159]
    ds_read_b64_tr_b16 v[58:59], v5 offset:54272
    s_waitcnt vmcnt(18) lgkmcnt(10)
    v_mfma_f32_16x16x32_bf16 v[64:67], v[32:35], v[224:227], v[64:67]
    ds_read_b64_tr_b16 v[60:61], v6 offset:53248
    s_add_u32 s42, s41, 61440
    buffer_load_dwordx4 v[208:211], v2, s[4:7], s42 offen offset:0 sc1
    v_mfma_f32_16x16x32_bf16 v[68:71], v[32:35], v[228:231], v[68:71]
    ds_read_b64_tr_b16 v[62:63], v6 offset:54272
    v_mfma_f32_16x16x32_bf16 v[72:75], v[36:39], v[224:227], v[72:75]
    ds_read_b64_tr_b16 v[32:33], v3 offset:57344
    buffer_load_dwordx4 v[212:215], v2, s[4:7], s42 offen offset:256 sc1
    v_mfma_f32_16x16x32_bf16 v[76:79], v[36:39], v[228:231], v[76:79]
    ds_read_b64_tr_b16 v[34:35], v3 offset:58368
    s_waitcnt lgkmcnt(10)
    v_mfma_f32_16x16x32_bf16 v[80:83], v[40:43], v[224:227], v[80:83]
    ds_read_b64_tr_b16 v[36:37], v4 offset:57344
    v_mfma_f32_16x16x32_bf16 v[84:87], v[40:43], v[228:231], v[84:87]
    ds_read_b64_tr_b16 v[38:39], v4 offset:58368
    v_mfma_f32_16x16x32_bf16 v[88:91], v[44:47], v[224:227], v[88:91]
    ds_read_b64_tr_b16 v[40:41], v5 offset:57344
    v_mfma_f32_16x16x32_bf16 v[92:95], v[44:47], v[228:231], v[92:95]
    ds_read_b64_tr_b16 v[42:43], v5 offset:58368
    s_waitcnt lgkmcnt(10)
    v_mfma_f32_16x16x32_bf16 v[96:99], v[224:227], v[48:51], v[96:99]
    ds_read_b64_tr_b16 v[44:45], v6 offset:57344
    buffer_load_dwordx4 v[216:219], v2, s[4:7], s42 offen offset:2048 sc1
    v_mfma_f32_16x16x32_bf16 v[100:103], v[228:231], v[48:51], v[100:103]
    ds_read_b64_tr_b16 v[46:47], v6 offset:58368
    v_mfma_f32_16x16x32_bf16 v[104:107], v[224:227], v[52:55], v[104:107]
    ds_read_b64_tr_b16 v[48:49], v3 offset:61440
    v_mfma_f32_16x16x32_bf16 v[108:111], v[228:231], v[52:55], v[108:111]
    ds_read_b64_tr_b16 v[50:51], v3 offset:62464
    s_waitcnt lgkmcnt(10)
    v_mfma_f32_16x16x32_bf16 v[112:115], v[224:227], v[56:59], v[112:115]
    ds_read_b64_tr_b16 v[52:53], v4 offset:61440
    v_mfma_f32_16x16x32_bf16 v[116:119], v[228:231], v[56:59], v[116:119]
    ds_read_b64_tr_b16 v[54:55], v4 offset:62464
    v_mfma_f32_16x16x32_bf16 v[120:123], v[224:227], v[60:63], v[120:123]
    ds_read_b64_tr_b16 v[56:57], v5 offset:61440
    v_mfma_f32_16x16x32_bf16 v[124:127], v[228:231], v[60:63], v[124:127]
    ds_read_b64_tr_b16 v[58:59], v5 offset:62464
    s_waitcnt vmcnt(19) lgkmcnt(10)
    v_mfma_f32_16x16x32_bf16 v[64:67], v[32:35], v[232:235], v[64:67]
    ds_read_b64_tr_b16 v[60:61], v6 offset:61440
    v_mfma_f32_16x16x32_bf16 v[68:71], v[32:35], v[236:239], v[68:71]
    ds_read_b64_tr_b16 v[62:63], v6 offset:62464
    s_barrier
    v_xor_b32 v3, 0x10000, v3
    v_xor_b32 v4, 0x10000, v4
    v_xor_b32 v5, 0x10000, v5
    v_xor_b32 v6, 0x10000, v6
    v_mfma_f32_16x16x32_bf16 v[72:75], v[36:39], v[232:235], v[72:75]
    ds_read_b64_tr_b16 v[32:33], v3 offset:0
    v_mfma_f32_16x16x32_bf16 v[76:79], v[36:39], v[236:239], v[76:79]
    ds_read_b64_tr_b16 v[34:35], v3 offset:1024
    s_waitcnt lgkmcnt(10)
    v_mfma_f32_16x16x32_bf16 v[80:83], v[40:43], v[232:235], v[80:83]
    ds_read_b64_tr_b16 v[36:37], v4 offset:0
    v_mfma_f32_16x16x32_bf16 v[84:87], v[40:43], v[236:239], v[84:87]
    ds_read_b64_tr_b16 v[38:39], v4 offset:1024
    v_mfma_f32_16x16x32_bf16 v[88:91], v[44:47], v[232:235], v[88:91]
    ds_read_b64_tr_b16 v[40:41], v5 offset:0
    v_mfma_f32_16x16x32_bf16 v[92:95], v[44:47], v[236:239], v[92:95]
    ds_read_b64_tr_b16 v[42:43], v5 offset:1024
    s_waitcnt lgkmcnt(10)
    v_mfma_f32_16x16x32_bf16 v[96:99], v[232:235], v[48:51], v[96:99]
    ds_read_b64_tr_b16 v[44:45], v6 offset:0
    v_mfma_f32_16x16x32_bf16 v[100:103], v[236:239], v[48:51], v[100:103]
    ds_read_b64_tr_b16 v[46:47], v6 offset:1024
    v_mfma_f32_16x16x32_bf16 v[104:107], v[232:235], v[52:55], v[104:107]
    ds_read_b64_tr_b16 v[48:49], v3 offset:4096
    v_mfma_f32_16x16x32_bf16 v[108:111], v[236:239], v[52:55], v[108:111]
    ds_read_b64_tr_b16 v[50:51], v3 offset:5120
    s_waitcnt lgkmcnt(10)
    v_mfma_f32_16x16x32_bf16 v[112:115], v[232:235], v[56:59], v[112:115]
    ds_read_b64_tr_b16 v[52:53], v4 offset:4096
    v_mfma_f32_16x16x32_bf16 v[116:119], v[236:239], v[56:59], v[116:119]
    ds_read_b64_tr_b16 v[54:55], v4 offset:5120
    v_mfma_f32_16x16x32_bf16 v[120:123], v[232:235], v[60:63], v[120:123]
    ds_read_b64_tr_b16 v[56:57], v5 offset:4096
    v_mfma_f32_16x16x32_bf16 v[124:127], v[236:239], v[60:63], v[124:127]
    ds_read_b64_tr_b16 v[58:59], v5 offset:5120
    s_waitcnt vmcnt(17) lgkmcnt(10)
    v_mfma_f32_16x16x32_bf16 v[64:67], v[32:35], v[240:243], v[64:67]
    ds_read_b64_tr_b16 v[60:61], v6 offset:4096
    v_mfma_f32_16x16x32_bf16 v[68:71], v[32:35], v[244:247], v[68:71]
    ds_read_b64_tr_b16 v[62:63], v6 offset:5120
    v_mfma_f32_16x16x32_bf16 v[72:75], v[36:39], v[240:243], v[72:75]
    ds_read_b64_tr_b16 v[32:33], v3 offset:8192
    v_mfma_f32_16x16x32_bf16 v[76:79], v[36:39], v[244:247], v[76:79]
    ds_read_b64_tr_b16 v[34:35], v3 offset:9216
    s_waitcnt lgkmcnt(10)
    v_mfma_f32_16x16x32_bf16 v[80:83], v[40:43], v[240:243], v[80:83]
    ds_read_b64_tr_b16 v[36:37], v4 offset:8192
    v_mfma_f32_16x16x32_bf16 v[84:87], v[40:43], v[244:247], v[84:87]
    ds_read_b64_tr_b16 v[38:39], v4 offset:9216
    v_mfma_f32_16x16x32_bf16 v[88:91], v[44:47], v[240:243], v[88:91]
    ds_read_b64_tr_b16 v[40:41], v5 offset:8192
    v_mfma_f32_16x16x32_bf16 v[92:95], v[44:47], v[244:247], v[92:95]
    ds_read_b64_tr_b16 v[42:43], v5 offset:9216
    s_waitcnt lgkmcnt(10)
    v_mfma_f32_16x16x32_bf16 v[96:99], v[240:243], v[48:51], v[96:99]
    ds_read_b64_tr_b16 v[44:45], v6 offset:8192
    v_mfma_f32_16x16x32_bf16 v[100:103], v[244:247], v[48:51], v[100:103]
    ds_read_b64_tr_b16 v[46:47], v6 offset:9216
    v_mfma_f32_16x16x32_bf16 v[104:107], v[240:243], v[52:55], v[104:107]
    ds_read_b64_tr_b16 v[48:49], v3 offset:12288
    v_mfma_f32_16x16x32_bf16 v[108:111], v[244:247], v[52:55], v[108:111]
    ds_read_b64_tr_b16 v[50:51], v3 offset:13312
    s_waitcnt lgkmcnt(10)
    v_mfma_f32_16x16x32_bf16 v[112:115], v[240:243], v[56:59], v[112:115]
    ds_read_b64_tr_b16 v[52:53], v4 offset:12288
    v_mfma_f32_16x16x32_bf16 v[116:119], v[244:247], v[56:59], v[116:119]
    ds_read_b64_tr_b16 v[54:55], v4 offset:13312
    v_mfma_f32_16x16x32_bf16 v[120:123], v[240:243], v[60:63], v[120:123]
    ds_read_b64_tr_b16 v[56:57], v5 offset:12288
    v_mfma_f32_16x16x32_bf16 v[124:127], v[244:247], v[60:63], v[124:127]
    ds_read_b64_tr_b16 v[58:59], v5 offset:13312
    s_waitcnt vmcnt(15) lgkmcnt(10)
    v_mfma_f32_16x16x32_bf16 v[64:67], v[32:35], v[248:251], v[64:67]
    ds_read_b64_tr_b16 v[60:61], v6 offset:12288
    v_mfma_f32_16x16x32_bf16 v[68:71], v[32:35], v[252:255], v[68:71]
    ds_read_b64_tr_b16 v[62:63], v6 offset:13312
    v_mfma_f32_16x16x32_bf16 v[72:75], v[36:39], v[248:251], v[72:75]
    ds_read_b64_tr_b16 v[32:33], v3 offset:16384
    v_mfma_f32_16x16x32_bf16 v[76:79], v[36:39], v[252:255], v[76:79]
    ds_read_b64_tr_b16 v[34:35], v3 offset:17408
    s_waitcnt lgkmcnt(10)
    v_mfma_f32_16x16x32_bf16 v[80:83], v[40:43], v[248:251], v[80:83]
    ds_read_b64_tr_b16 v[36:37], v4 offset:16384
    v_mfma_f32_16x16x32_bf16 v[84:87], v[40:43], v[252:255], v[84:87]
    ds_read_b64_tr_b16 v[38:39], v4 offset:17408
    v_mfma_f32_16x16x32_bf16 v[88:91], v[44:47], v[248:251], v[88:91]
    ds_read_b64_tr_b16 v[40:41], v5 offset:16384
    v_mfma_f32_16x16x32_bf16 v[92:95], v[44:47], v[252:255], v[92:95]
    ds_read_b64_tr_b16 v[42:43], v5 offset:17408
    s_waitcnt lgkmcnt(10)
    v_mfma_f32_16x16x32_bf16 v[96:99], v[248:251], v[48:51], v[96:99]
    ds_read_b64_tr_b16 v[44:45], v6 offset:16384
    buffer_load_dwordx4 v[220:223], v2, s[4:7], s42 offen offset:2304 sc1
    v_mfma_f32_16x16x32_bf16 v[100:103], v[252:255], v[48:51], v[100:103]
    ds_read_b64_tr_b16 v[46:47], v6 offset:17408
    v_mfma_f32_16x16x32_bf16 v[104:107], v[248:251], v[52:55], v[104:107]
    ds_read_b64_tr_b16 v[48:49], v3 offset:20480
    v_mfma_f32_16x16x32_bf16 v[108:111], v[252:255], v[52:55], v[108:111]
    ds_read_b64_tr_b16 v[50:51], v3 offset:21504
    s_waitcnt lgkmcnt(10)
    v_mfma_f32_16x16x32_bf16 v[112:115], v[248:251], v[56:59], v[112:115]
    ds_read_b64_tr_b16 v[52:53], v4 offset:20480
    v_mfma_f32_16x16x32_bf16 v[116:119], v[252:255], v[56:59], v[116:119]
    ds_read_b64_tr_b16 v[54:55], v4 offset:21504
    v_mfma_f32_16x16x32_bf16 v[120:123], v[248:251], v[60:63], v[120:123]
    ds_read_b64_tr_b16 v[56:57], v5 offset:20480
    v_mfma_f32_16x16x32_bf16 v[124:127], v[252:255], v[60:63], v[124:127]
    ds_read_b64_tr_b16 v[58:59], v5 offset:21504
    s_waitcnt vmcnt(14) lgkmcnt(10)
    v_mfma_f32_16x16x32_bf16 v[64:67], v[32:35], v[160:163], v[64:67]
    ds_read_b64_tr_b16 v[60:61], v6 offset:20480
    v_mfma_f32_16x16x32_bf16 v[68:71], v[32:35], v[164:167], v[68:71]
    ds_read_b64_tr_b16 v[62:63], v6 offset:21504
    v_mfma_f32_16x16x32_bf16 v[72:75], v[36:39], v[160:163], v[72:75]
    ds_read_b64_tr_b16 v[32:33], v3 offset:24576
    v_mfma_f32_16x16x32_bf16 v[76:79], v[36:39], v[164:167], v[76:79]
    ds_read_b64_tr_b16 v[34:35], v3 offset:25600
    s_waitcnt lgkmcnt(10)
    v_mfma_f32_16x16x32_bf16 v[80:83], v[40:43], v[160:163], v[80:83]
    ds_read_b64_tr_b16 v[36:37], v4 offset:24576
    v_mfma_f32_16x16x32_bf16 v[84:87], v[40:43], v[164:167], v[84:87]
    ds_read_b64_tr_b16 v[38:39], v4 offset:25600
    v_mfma_f32_16x16x32_bf16 v[88:91], v[44:47], v[160:163], v[88:91]
    ds_read_b64_tr_b16 v[40:41], v5 offset:24576
    v_mfma_f32_16x16x32_bf16 v[92:95], v[44:47], v[164:167], v[92:95]
    ds_read_b64_tr_b16 v[42:43], v5 offset:25600
    s_waitcnt lgkmcnt(10)
    v_mfma_f32_16x16x32_bf16 v[96:99], v[160:163], v[48:51], v[96:99]
    ds_read_b64_tr_b16 v[44:45], v6 offset:24576
    v_mfma_f32_16x16x32_bf16 v[100:103], v[164:167], v[48:51], v[100:103]
    ds_read_b64_tr_b16 v[46:47], v6 offset:25600
    v_mfma_f32_16x16x32_bf16 v[104:107], v[160:163], v[52:55], v[104:107]
    ds_read_b64_tr_b16 v[48:49], v3 offset:28672
    v_mfma_f32_16x16x32_bf16 v[108:111], v[164:167], v[52:55], v[108:111]
    ds_read_b64_tr_b16 v[50:51], v3 offset:29696
    s_waitcnt lgkmcnt(10)
    v_mfma_f32_16x16x32_bf16 v[112:115], v[160:163], v[56:59], v[112:115]
    ds_read_b64_tr_b16 v[52:53], v4 offset:28672
    v_mfma_f32_16x16x32_bf16 v[116:119], v[164:167], v[56:59], v[116:119]
    ds_read_b64_tr_b16 v[54:55], v4 offset:29696
    v_mfma_f32_16x16x32_bf16 v[120:123], v[160:163], v[60:63], v[120:123]
    ds_read_b64_tr_b16 v[56:57], v5 offset:28672
    v_mfma_f32_16x16x32_bf16 v[124:127], v[164:167], v[60:63], v[124:127]
    ds_read_b64_tr_b16 v[58:59], v5 offset:29696
    s_waitcnt vmcnt(12) lgkmcnt(10)
    v_mfma_f32_16x16x32_bf16 v[64:67], v[32:35], v[168:171], v[64:67]
    ds_read_b64_tr_b16 v[60:61], v6 offset:28672
    v_mfma_f32_16x16x32_bf16 v[68:71], v[32:35], v[172:175], v[68:71]
    ds_read_b64_tr_b16 v[62:63], v6 offset:29696
    s_barrier
    v_mfma_f32_16x16x32_bf16 v[72:75], v[36:39], v[168:171], v[72:75]
    ds_read_b64_tr_b16 v[32:33], v3 offset:32768
    v_mfma_f32_16x16x32_bf16 v[76:79], v[36:39], v[172:175], v[76:79]
    ds_read_b64_tr_b16 v[34:35], v3 offset:33792
    s_waitcnt lgkmcnt(10)
    v_mfma_f32_16x16x32_bf16 v[80:83], v[40:43], v[168:171], v[80:83]
    ds_read_b64_tr_b16 v[36:37], v4 offset:32768
    v_mfma_f32_16x16x32_bf16 v[84:87], v[40:43], v[172:175], v[84:87]
    ds_read_b64_tr_b16 v[38:39], v4 offset:33792
    v_mfma_f32_16x16x32_bf16 v[88:91], v[44:47], v[168:171], v[88:91]
    ds_read_b64_tr_b16 v[40:41], v5 offset:32768
    v_mfma_f32_16x16x32_bf16 v[92:95], v[44:47], v[172:175], v[92:95]
    ds_read_b64_tr_b16 v[42:43], v5 offset:33792
    s_waitcnt lgkmcnt(10)
    v_mfma_f32_16x16x32_bf16 v[96:99], v[168:171], v[48:51], v[96:99]
    ds_read_b64_tr_b16 v[44:45], v6 offset:32768
    v_mfma_f32_16x16x32_bf16 v[100:103], v[172:175], v[48:51], v[100:103]
    ds_read_b64_tr_b16 v[46:47], v6 offset:33792
    v_mfma_f32_16x16x32_bf16 v[104:107], v[168:171], v[52:55], v[104:107]
    ds_read_b64_tr_b16 v[48:49], v3 offset:36864
    v_mfma_f32_16x16x32_bf16 v[108:111], v[172:175], v[52:55], v[108:111]
    ds_read_b64_tr_b16 v[50:51], v3 offset:37888
    s_waitcnt lgkmcnt(10)
    v_mfma_f32_16x16x32_bf16 v[112:115], v[168:171], v[56:59], v[112:115]
    ds_read_b64_tr_b16 v[52:53], v4 offset:36864
    v_mfma_f32_16x16x32_bf16 v[116:119], v[172:175], v[56:59], v[116:119]
    ds_read_b64_tr_b16 v[54:55], v4 offset:37888
    v_mfma_f32_16x16x32_bf16 v[120:123], v[168:171], v[60:63], v[120:123]
    ds_read_b64_tr_b16 v[56:57], v5 offset:36864
    v_mfma_f32_16x16x32_bf16 v[124:127], v[172:175], v[60:63], v[124:127]
    ds_read_b64_tr_b16 v[58:59], v5 offset:37888
    s_waitcnt vmcnt(10) lgkmcnt(10)
    v_mfma_f32_16x16x32_bf16 v[64:67], v[32:35], v[176:179], v[64:67]
    ds_read_b64_tr_b16 v[60:61], v6 offset:36864
    v_mfma_f32_16x16x32_bf16 v[68:71], v[32:35], v[180:183], v[68:71]
    ds_read_b64_tr_b16 v[62:63], v6 offset:37888
    v_mfma_f32_16x16x32_bf16 v[72:75], v[36:39], v[176:179], v[72:75]
    ds_read_b64_tr_b16 v[32:33], v3 offset:40960
    v_mfma_f32_16x16x32_bf16 v[76:79], v[36:39], v[180:183], v[76:79]
    ds_read_b64_tr_b16 v[34:35], v3 offset:41984
    s_waitcnt lgkmcnt(10)
    v_mfma_f32_16x16x32_bf16 v[80:83], v[40:43], v[176:179], v[80:83]
    ds_read_b64_tr_b16 v[36:37], v4 offset:40960
    v_mfma_f32_16x16x32_bf16 v[84:87], v[40:43], v[180:183], v[84:87]
    ds_read_b64_tr_b16 v[38:39], v4 offset:41984
    v_mfma_f32_16x16x32_bf16 v[88:91], v[44:47], v[176:179], v[88:91]
    ds_read_b64_tr_b16 v[40:41], v5 offset:40960
    v_mfma_f32_16x16x32_bf16 v[92:95], v[44:47], v[180:183], v[92:95]
    ds_read_b64_tr_b16 v[42:43], v5 offset:41984
    s_waitcnt lgkmcnt(10)
    v_mfma_f32_16x16x32_bf16 v[96:99], v[176:179], v[48:51], v[96:99]
    ds_read_b64_tr_b16 v[44:45], v6 offset:40960
    v_mfma_f32_16x16x32_bf16 v[100:103], v[180:183], v[48:51], v[100:103]
    ds_read_b64_tr_b16 v[46:47], v6 offset:41984
    v_mfma_f32_16x16x32_bf16 v[104:107], v[176:179], v[52:55], v[104:107]
    ds_read_b64_tr_b16 v[48:49], v3 offset:45056
    v_mfma_f32_16x16x32_bf16 v[108:111], v[180:183], v[52:55], v[108:111]
    ds_read_b64_tr_b16 v[50:51], v3 offset:46080
    s_waitcnt lgkmcnt(10)
    v_mfma_f32_16x16x32_bf16 v[112:115], v[176:179], v[56:59], v[112:115]
    ds_read_b64_tr_b16 v[52:53], v4 offset:45056
    v_mfma_f32_16x16x32_bf16 v[116:119], v[180:183], v[56:59], v[116:119]
    ds_read_b64_tr_b16 v[54:55], v4 offset:46080
    v_mfma_f32_16x16x32_bf16 v[120:123], v[176:179], v[60:63], v[120:123]
    ds_read_b64_tr_b16 v[56:57], v5 offset:45056
    v_mfma_f32_16x16x32_bf16 v[124:127], v[180:183], v[60:63], v[124:127]
    ds_read_b64_tr_b16 v[58:59], v5 offset:46080
    s_waitcnt vmcnt(8) lgkmcnt(10)
    v_mfma_f32_16x16x32_bf16 v[64:67], v[32:35], v[184:187], v[64:67]
    ds_read_b64_tr_b16 v[60:61], v6 offset:45056
    v_mfma_f32_16x16x32_bf16 v[68:71], v[32:35], v[188:191], v[68:71]
    ds_read_b64_tr_b16 v[62:63], v6 offset:46080
    v_mfma_f32_16x16x32_bf16 v[72:75], v[36:39], v[184:187], v[72:75]
    ds_read_b64_tr_b16 v[32:33], v3 offset:49152
    v_mfma_f32_16x16x32_bf16 v[76:79], v[36:39], v[188:191], v[76:79]
    ds_read_b64_tr_b16 v[34:35], v3 offset:50176
    s_waitcnt lgkmcnt(10)
    v_mfma_f32_16x16x32_bf16 v[80:83], v[40:43], v[184:187], v[80:83]
    ds_read_b64_tr_b16 v[36:37], v4 offset:49152
    v_mfma_f32_16x16x32_bf16 v[84:87], v[40:43], v[188:191], v[84:87]
    ds_read_b64_tr_b16 v[38:39], v4 offset:50176
    v_mfma_f32_16x16x32_bf16 v[88:91], v[44:47], v[184:187], v[88:91]
    ds_read_b64_tr_b16 v[40:41], v5 offset:49152
    v_mfma_f32_16x16x32_bf16 v[92:95], v[44:47], v[188:191], v[92:95]
    ds_read_b64_tr_b16 v[42:43], v5 offset:50176
    s_waitcnt lgkmcnt(10)
    v_mfma_f32_16x16x32_bf16 v[96:99], v[184:187], v[48:51], v[96:99]
    ds_read_b64_tr_b16 v[44:45], v6 offset:49152
    v_mfma_f32_16x16x32_bf16 v[100:103], v[188:191], v[48:51], v[100:103]
    ds_read_b64_tr_b16 v[46:47], v6 offset:50176
    v_mfma_f32_16x16x32_bf16 v[104:107], v[184:187], v[52:55], v[104:107]
    ds_read_b64_tr_b16 v[48:49], v3 offset:53248
    v_mfma_f32_16x16x32_bf16 v[108:111], v[188:191], v[52:55], v[108:111]
    ds_read_b64_tr_b16 v[50:51], v3 offset:54272
    s_waitcnt lgkmcnt(10)
    v_mfma_f32_16x16x32_bf16 v[112:115], v[184:187], v[56:59], v[112:115]
    ds_read_b64_tr_b16 v[52:53], v4 offset:53248
    v_mfma_f32_16x16x32_bf16 v[116:119], v[188:191], v[56:59], v[116:119]
    ds_read_b64_tr_b16 v[54:55], v4 offset:54272
    v_mfma_f32_16x16x32_bf16 v[120:123], v[184:187], v[60:63], v[120:123]
    ds_read_b64_tr_b16 v[56:57], v5 offset:53248
    v_mfma_f32_16x16x32_bf16 v[124:127], v[188:191], v[60:63], v[124:127]
    ds_read_b64_tr_b16 v[58:59], v5 offset:54272
    s_waitcnt vmcnt(6) lgkmcnt(10)
    v_mfma_f32_16x16x32_bf16 v[64:67], v[32:35], v[192:195], v[64:67]
    ds_read_b64_tr_b16 v[60:61], v6 offset:53248
    v_mfma_f32_16x16x32_bf16 v[68:71], v[32:35], v[196:199], v[68:71]
    ds_read_b64_tr_b16 v[62:63], v6 offset:54272
    v_mfma_f32_16x16x32_bf16 v[72:75], v[36:39], v[192:195], v[72:75]
    ds_read_b64_tr_b16 v[32:33], v3 offset:57344
    v_mfma_f32_16x16x32_bf16 v[76:79], v[36:39], v[196:199], v[76:79]
    ds_read_b64_tr_b16 v[34:35], v3 offset:58368
    s_waitcnt lgkmcnt(10)
    v_mfma_f32_16x16x32_bf16 v[80:83], v[40:43], v[192:195], v[80:83]
    ds_read_b64_tr_b16 v[36:37], v4 offset:57344
    v_mfma_f32_16x16x32_bf16 v[84:87], v[40:43], v[196:199], v[84:87]
    ds_read_b64_tr_b16 v[38:39], v4 offset:58368
    v_mfma_f32_16x16x32_bf16 v[88:91], v[44:47], v[192:195], v[88:91]
    ds_read_b64_tr_b16 v[40:41], v5 offset:57344
    v_mfma_f32_16x16x32_bf16 v[92:95], v[44:47], v[196:199], v[92:95]
    ds_read_b64_tr_b16 v[42:43], v5 offset:58368
    s_waitcnt lgkmcnt(10)
    v_mfma_f32_16x16x32_bf16 v[96:99], v[192:195], v[48:51], v[96:99]
    ds_read_b64_tr_b16 v[44:45], v6 offset:57344
    v_mfma_f32_16x16x32_bf16 v[100:103], v[196:199], v[48:51], v[100:103]
    ds_read_b64_tr_b16 v[46:47], v6 offset:58368
    v_mfma_f32_16x16x32_bf16 v[104:107], v[192:195], v[52:55], v[104:107]
    ds_read_b64_tr_b16 v[48:49], v3 offset:61440
    v_mfma_f32_16x16x32_bf16 v[108:111], v[196:199], v[52:55], v[108:111]
    ds_read_b64_tr_b16 v[50:51], v3 offset:62464
    s_waitcnt lgkmcnt(10)
    v_mfma_f32_16x16x32_bf16 v[112:115], v[192:195], v[56:59], v[112:115]
    ds_read_b64_tr_b16 v[52:53], v4 offset:61440
    v_mfma_f32_16x16x32_bf16 v[116:119], v[196:199], v[56:59], v[116:119]
    ds_read_b64_tr_b16 v[54:55], v4 offset:62464
    v_mfma_f32_16x16x32_bf16 v[120:123], v[192:195], v[60:63], v[120:123]
    ds_read_b64_tr_b16 v[56:57], v5 offset:61440
    v_mfma_f32_16x16x32_bf16 v[124:127], v[196:199], v[60:63], v[124:127]
    ds_read_b64_tr_b16 v[58:59], v5 offset:62464
    s_waitcnt vmcnt(4) lgkmcnt(10)
    v_mfma_f32_16x16x32_bf16 v[64:67], v[32:35], v[200:203], v[64:67]
    ds_read_b64_tr_b16 v[60:61], v6 offset:61440
    v_mfma_f32_16x16x32_bf16 v[68:71], v[32:35], v[204:207], v[68:71]
    ds_read_b64_tr_b16 v[62:63], v6 offset:62464
    s_barrier
    v_xor_b32 v3, 0x10000, v3
    v_xor_b32 v4, 0x10000, v4
    v_xor_b32 v5, 0x10000, v5
    v_xor_b32 v6, 0x10000, v6
    v_mfma_f32_16x16x32_bf16 v[72:75], v[36:39], v[200:203], v[72:75]
    ds_read_b64_tr_b16 v[32:33], v3 offset:0
    v_mfma_f32_16x16x32_bf16 v[76:79], v[36:39], v[204:207], v[76:79]
    ds_read_b64_tr_b16 v[34:35], v3 offset:1024
    s_waitcnt lgkmcnt(10)
    v_mfma_f32_16x16x32_bf16 v[80:83], v[40:43], v[200:203], v[80:83]
    ds_read_b64_tr_b16 v[36:37], v4 offset:0
    v_mfma_f32_16x16x32_bf16 v[84:87], v[40:43], v[204:207], v[84:87]
    ds_read_b64_tr_b16 v[38:39], v4 offset:1024
    v_mfma_f32_16x16x32_bf16 v[88:91], v[44:47], v[200:203], v[88:91]
    ds_read_b64_tr_b16 v[40:41], v5 offset:0
    v_mfma_f32_16x16x32_bf16 v[92:95], v[44:47], v[204:207], v[92:95]
    ds_read_b64_tr_b16 v[42:43], v5 offset:1024
    s_waitcnt lgkmcnt(10)
    v_mfma_f32_16x16x32_bf16 v[96:99], v[200:203], v[48:51], v[96:99]
    ds_read_b64_tr_b16 v[44:45], v6 offset:0
    v_mfma_f32_16x16x32_bf16 v[100:103], v[204:207], v[48:51], v[100:103]
    ds_read_b64_tr_b16 v[46:47], v6 offset:1024
    v_mfma_f32_16x16x32_bf16 v[104:107], v[200:203], v[52:55], v[104:107]
    ds_read_b64_tr_b16 v[48:49], v3 offset:4096
    v_mfma_f32_16x16x32_bf16 v[108:111], v[204:207], v[52:55], v[108:111]
    ds_read_b64_tr_b16 v[50:51], v3 offset:5120
    s_waitcnt lgkmcnt(10)
    v_mfma_f32_16x16x32_bf16 v[112:115], v[200:203], v[56:59], v[112:115]
    ds_read_b64_tr_b16 v[52:53], v4 offset:4096
    v_mfma_f32_16x16x32_bf16 v[116:119], v[204:207], v[56:59], v[116:119]
    ds_read_b64_tr_b16 v[54:55], v4 offset:5120
    v_mfma_f32_16x16x32_bf16 v[120:123], v[200:203], v[60:63], v[120:123]
    ds_read_b64_tr_b16 v[56:57], v5 offset:4096
    v_mfma_f32_16x16x32_bf16 v[124:127], v[204:207], v[60:63], v[124:127]
    ds_read_b64_tr_b16 v[58:59], v5 offset:5120
    s_waitcnt vmcnt(2) lgkmcnt(10)
    v_mfma_f32_16x16x32_bf16 v[64:67], v[32:35], v[208:211], v[64:67]
    ds_read_b64_tr_b16 v[60:61], v6 offset:4096
    v_mfma_f32_16x16x32_bf16 v[68:71], v[32:35], v[212:215], v[68:71]
    ds_read_b64_tr_b16 v[62:63], v6 offset:5120
    v_mfma_f32_16x16x32_bf16 v[72:75], v[36:39], v[208:211], v[72:75]
    ds_read_b64_tr_b16 v[32:33], v3 offset:8192
    v_mfma_f32_16x16x32_bf16 v[76:79], v[36:39], v[212:215], v[76:79]
    ds_read_b64_tr_b16 v[34:35], v3 offset:9216
    s_waitcnt lgkmcnt(10)
    v_mfma_f32_16x16x32_bf16 v[80:83], v[40:43], v[208:211], v[80:83]
    ds_read_b64_tr_b16 v[36:37], v4 offset:8192
    v_mfma_f32_16x16x32_bf16 v[84:87], v[40:43], v[212:215], v[84:87]
    ds_read_b64_tr_b16 v[38:39], v4 offset:9216
    v_mfma_f32_16x16x32_bf16 v[88:91], v[44:47], v[208:211], v[88:91]
    ds_read_b64_tr_b16 v[40:41], v5 offset:8192
    v_mfma_f32_16x16x32_bf16 v[92:95], v[44:47], v[212:215], v[92:95]
    ds_read_b64_tr_b16 v[42:43], v5 offset:9216
    s_waitcnt lgkmcnt(10)
    v_mfma_f32_16x16x32_bf16 v[96:99], v[208:211], v[48:51], v[96:99]
    ds_read_b64_tr_b16 v[44:45], v6 offset:8192
    v_mfma_f32_16x16x32_bf16 v[100:103], v[212:215], v[48:51], v[100:103]
    ds_read_b64_tr_b16 v[46:47], v6 offset:9216
    v_mfma_f32_16x16x32_bf16 v[104:107], v[208:211], v[52:55], v[104:107]
    ds_read_b64_tr_b16 v[48:49], v3 offset:12288
    v_mfma_f32_16x16x32_bf16 v[108:111], v[212:215], v[52:55], v[108:111]
    ds_read_b64_tr_b16 v[50:51], v3 offset:13312
    s_waitcnt lgkmcnt(10)
    v_mfma_f32_16x16x32_bf16 v[112:115], v[208:211], v[56:59], v[112:115]
    ds_read_b64_tr_b16 v[52:53], v4 offset:12288
    v_mfma_f32_16x16x32_bf16 v[116:119], v[212:215], v[56:59], v[116:119]
    ds_read_b64_tr_b16 v[54:55], v4 offset:13312
    v_mfma_f32_16x16x32_bf16 v[120:123], v[208:211], v[60:63], v[120:123]
    ds_read_b64_tr_b16 v[56:57], v5 offset:12288
    v_mfma_f32_16x16x32_bf16 v[124:127], v[212:215], v[60:63], v[124:127]
    ds_read_b64_tr_b16 v[58:59], v5 offset:13312
    s_waitcnt vmcnt(0) lgkmcnt(10)
    v_mfma_f32_16x16x32_bf16 v[64:67], v[32:35], v[216:219], v[64:67]
    ds_read_b64_tr_b16 v[60:61], v6 offset:12288
    v_mfma_f32_16x16x32_bf16 v[68:71], v[32:35], v[220:223], v[68:71]
    ds_read_b64_tr_b16 v[62:63], v6 offset:13312
    v_mfma_f32_16x16x32_bf16 v[72:75], v[36:39], v[216:219], v[72:75]
    ds_read_b64_tr_b16 v[32:33], v3 offset:16384
    ds_read_b32 v8, v9 offset:4096
    v_mfma_f32_16x16x32_bf16 v[76:79], v[36:39], v[220:223], v[76:79]
    ds_read_b64_tr_b16 v[34:35], v3 offset:17408
    ds_read_b32 v10, v9 offset:4608
    s_waitcnt lgkmcnt(12)
    v_mfma_f32_16x16x32_bf16 v[80:83], v[40:43], v[216:219], v[80:83]
    ds_read_b64_tr_b16 v[36:37], v4 offset:16384
    ds_read_b32 v12, v9 offset:4160
    v_mfma_f32_16x16x32_bf16 v[84:87], v[40:43], v[220:223], v[84:87]
    ds_read_b64_tr_b16 v[38:39], v4 offset:17408
    ds_read_b32 v14, v9 offset:4672
    v_mfma_f32_16x16x32_bf16 v[88:91], v[44:47], v[216:219], v[88:91]
    ds_read_b64_tr_b16 v[40:41], v5 offset:16384
    ds_read_b128 v[16:19], v11 offset:256
    v_mfma_f32_16x16x32_bf16 v[92:95], v[44:47], v[220:223], v[92:95]
    ds_read_b64_tr_b16 v[42:43], v5 offset:17408
    ds_read_b128 v[20:23], v11 offset:320
    s_waitcnt lgkmcnt(15)
    v_mfma_f32_16x16x32_bf16 v[96:99], v[216:219], v[48:51], v[96:99]
    ds_read_b64_tr_b16 v[44:45], v6 offset:16384
    ds_read_b128 v[24:27], v11 offset:384
    v_mfma_f32_16x16x32_bf16 v[100:103], v[220:223], v[48:51], v[100:103]
    ds_read_b64_tr_b16 v[46:47], v6 offset:17408
    ds_read_b128 v[28:31], v11 offset:448
    v_mfma_f32_16x16x32_bf16 v[104:107], v[216:219], v[52:55], v[104:107]
    ds_read_b64_tr_b16 v[48:49], v3 offset:20480
    v_mfma_f32_16x16x32_bf16 v[108:111], v[220:223], v[52:55], v[108:111]
    ds_read_b64_tr_b16 v[50:51], v3 offset:21504
    s_waitcnt lgkmcnt(15)
    v_mfma_f32_16x16x32_bf16 v[112:115], v[216:219], v[56:59], v[112:115]
    ds_read_b64_tr_b16 v[52:53], v4 offset:20480
    v_mfma_f32_16x16x32_bf16 v[116:119], v[220:223], v[56:59], v[116:119]
    ds_read_b64_tr_b16 v[54:55], v4 offset:21504
    v_mfma_f32_16x16x32_bf16 v[120:123], v[216:219], v[60:63], v[120:123]
    ds_read_b64_tr_b16 v[56:57], v5 offset:20480
    v_mfma_f32_16x16x32_bf16 v[124:127], v[220:223], v[60:63], v[124:127]
    ds_read_b64_tr_b16 v[58:59], v5 offset:21504
    s_waitcnt lgkmcnt(6)
    v_pk_fma_f32 v[68:69], v[12:13], v[16:17], v[68:69] op_sel_hi:[0,1,1] neg_lo:[1,0,0] neg_hi:[1,0,0]
    v_pk_fma_f32 v[70:71], v[12:13], v[18:19], v[70:71] op_sel_hi:[0,1,1] neg_lo:[1,0,0] neg_hi:[1,0,0]
    v_pk_fma_f32 v[76:77], v[12:13], v[20:21], v[76:77] op_sel_hi:[0,1,1] neg_lo:[1,0,0] neg_hi:[1,0,0]
    v_pk_fma_f32 v[78:79], v[12:13], v[22:23], v[78:79] op_sel_hi:[0,1,1] neg_lo:[1,0,0] neg_hi:[1,0,0]
    v_pk_fma_f32 v[84:85], v[12:13], v[24:25], v[84:85] op_sel_hi:[0,1,1] neg_lo:[1,0,0] neg_hi:[1,0,0]
    v_pk_fma_f32 v[86:87], v[12:13], v[26:27], v[86:87] op_sel_hi:[0,1,1] neg_lo:[1,0,0] neg_hi:[1,0,0]
    v_pk_fma_f32 v[92:93], v[12:13], v[28:29], v[92:93] op_sel_hi:[0,1,1] neg_lo:[1,0,0] neg_hi:[1,0,0]
    v_pk_fma_f32 v[94:95], v[12:13], v[30:31], v[94:95] op_sel_hi:[0,1,1] neg_lo:[1,0,0] neg_hi:[1,0,0]
    v_pk_mul_f32 v[68:69], v[14:15], v[68:69] op_sel_hi:[0,1]
    v_pk_mul_f32 v[70:71], v[14:15], v[70:71] op_sel_hi:[0,1]
    v_pk_mul_f32 v[76:77], v[14:15], v[76:77] op_sel_hi:[0,1]
    v_pk_mul_f32 v[78:79], v[14:15], v[78:79] op_sel_hi:[0,1]
    v_pk_mul_f32 v[84:85], v[14:15], v[84:85] op_sel_hi:[0,1]
    v_pk_mul_f32 v[86:87], v[14:15], v[86:87] op_sel_hi:[0,1]
    v_pk_mul_f32 v[92:93], v[14:15], v[92:93] op_sel_hi:[0,1]
    v_pk_mul_f32 v[94:95], v[14:15], v[94:95] op_sel_hi:[0,1]
    v_pk_fma_f32 v[64:65], v[8:9], v[16:17], v[64:65] op_sel_hi:[0,1,1] neg_lo:[1,0,0] neg_hi:[1,0,0]
    v_pk_fma_f32 v[66:67], v[8:9], v[18:19], v[66:67] op_sel_hi:[0,1,1] neg_lo:[1,0,0] neg_hi:[1,0,0]
    v_pk_fma_f32 v[72:73], v[8:9], v[20:21], v[72:73] op_sel_hi:[0,1,1] neg_lo:[1,0,0] neg_hi:[1,0,0]
    v_pk_fma_f32 v[74:75], v[8:9], v[22:23], v[74:75] op_sel_hi:[0,1,1] neg_lo:[1,0,0] neg_hi:[1,0,0]
    v_pk_fma_f32 v[80:81], v[8:9], v[24:25], v[80:81] op_sel_hi:[0,1,1] neg_lo:[1,0,0] neg_hi:[1,0,0]
    v_pk_fma_f32 v[82:83], v[8:9], v[26:27], v[82:83] op_sel_hi:[0,1,1] neg_lo:[1,0,0] neg_hi:[1,0,0]
    v_pk_fma_f32 v[88:89], v[8:9], v[28:29], v[88:89] op_sel_hi:[0,1,1] neg_lo:[1,0,0] neg_hi:[1,0,0]
    v_pk_fma_f32 v[90:91], v[8:9], v[30:31], v[90:91] op_sel_hi:[0,1,1] neg_lo:[1,0,0] neg_hi:[1,0,0]
    v_pk_mul_f32 v[64:65], v[10:11], v[64:65] op_sel_hi:[0,1]
    v_pk_mul_f32 v[66:67], v[10:11], v[66:67] op_sel_hi:[0,1]
    v_pk_mul_f32 v[72:73], v[10:11], v[72:73] op_sel_hi:[0,1]
    v_pk_mul_f32 v[74:75], v[10:11], v[74:75] op_sel_hi:[0,1]
    v_pk_mul_f32 v[80:81], v[10:11], v[80:81] op_sel_hi:[0,1]
    v_pk_mul_f32 v[82:83], v[10:11], v[82:83] op_sel_hi:[0,1]
    v_pk_mul_f32 v[88:89], v[10:11], v[88:89] op_sel_hi:[0,1]
    v_pk_mul_f32 v[90:91], v[10:11], v[90:91] op_sel_hi:[0,1]
    ds_read_b128 v[16:19], v13 offset:4096
    ds_read_b128 v[24:27], v13 offset:4608
    ds_read_b128 v[20:23], v13 offset:4160
    ds_read_b128 v[28:31], v13 offset:4672
    ds_read_b32 v8, v15 offset:512
    ds_read_b32 v10, v15 offset:576
    ds_read_b32 v12, v15 offset:640
    ds_read_b32 v14, v15 offset:704
    s_bitcmp1_b32 s21, 0
    s_cbranch_scc1 c_B
    s_lshr_b32 s44, s21, 1
    s_lshl_b32 s44, s44, 8
    s_lshl_b32 s45, s17, 4
    s_add_u32 s44, s44, s45
    s_add_u32 s44, s44, s18
    s_lshl_b32 s52, s44, 12
    s_add_u32 s52, s52, 54525952
    s_cmp_eq_u32 s16, 3
    s_cselect_b32 s52, s52, 2146435072
    s_lshl_b32 s53, s44, 7
    s_add_u32 s53, s53, 151552
    s_lshl_b32 s44, s16, 12
    s_add_u32 s44, s44, 131072
    v_add_u32 v15, s44, v1
    v_cvt_pk_bf16_f32 v68, v68, v69
    v_cvt_pk_bf16_f32 v69, v70, v71
    v_cvt_pk_bf16_f32 v70, v76, v77
    v_cvt_pk_bf16_f32 v71, v78, v79
    buffer_store_dwordx4 v[68:71], v1, s[4:7], s52 offen offset:0 sc1
    ds_write_b128 v15, v[68:71] offset:4096
    v_cvt_pk_bf16_f32 v84, v84, v85
    v_cvt_pk_bf16_f32 v85, v86, v87
    v_cvt_pk_bf16_f32 v86, v92, v93
    v_cvt_pk_bf16_f32 v87, v94, v95
    buffer_store_dwordx4 v[84:87], v1, s[4:7], s52 offen offset:1024 sc1
    ds_write_b128 v15, v[84:87] offset:5120
    v_cvt_pk_bf16_f32 v64, v64, v65
    v_cvt_pk_bf16_f32 v65, v66, v67
    v_cvt_pk_bf16_f32 v66, v72, v73
    v_cvt_pk_bf16_f32 v67, v74, v75
    v_cvt_pk_bf16_f32 v80, v80, v81
    v_cvt_pk_bf16_f32 v81, v82, v83
    v_cvt_pk_bf16_f32 v82, v88, v89
    v_cvt_pk_bf16_f32 v83, v90, v91
    s_waitcnt lgkmcnt(2)
    v_pk_fma_f32 v[100:101], v[8:9], v[20:21], v[100:101] op_sel_hi:[0,1,1] neg_lo:[1,0,0] neg_hi:[1,0,0]
    v_pk_fma_f32 v[102:103], v[8:9], v[22:23], v[102:103] op_sel_hi:[0,1,1] neg_lo:[1,0,0] neg_hi:[1,0,0]
    v_pk_mul_f32 v[100:101], v[28:29], v[100:101]
    v_pk_mul_f32 v[102:103], v[30:31], v[102:103]
    v_pk_fma_f32 v[108:109], v[10:11], v[20:21], v[108:109] op_sel_hi:[0,1,1] neg_lo:[1,0,0] neg_hi:[1,0,0]
    v_pk_fma_f32 v[110:111], v[10:11], v[22:23], v[110:111] op_sel_hi:[0,1,1] neg_lo:[1,0,0] neg_hi:[1,0,0]
    v_pk_mul_f32 v[108:109], v[28:29], v[108:109]
    v_pk_mul_f32 v[110:111], v[30:31], v[110:111]
    v_cvt_pk_bf16_f32 v74, v100, v101
    v_cvt_pk_bf16_f32 v75, v102, v103
    v_cvt_pk_bf16_f32 v78, v108, v109
    v_cvt_pk_bf16_f32 v79, v110, v111
    v_cvt_pk_bf16_f32 v100, v100, v101
    v_cvt_pk_bf16_f32 v101, v102, v103
    v_cvt_pk_bf16_f32 v102, v108, v109
    v_cvt_pk_bf16_f32 v103, v110, v111
    buffer_store_dwordx4 v[100:103], v1, s[4:7], s52 offen offset:2048 sc1
    ds_write_b128 v15, v[100:103] offset:6144
    v_pk_fma_f32 v[116:117], v[12:13], v[20:21], v[116:117] op_sel_hi:[0,1,1] neg_lo:[1,0,0] neg_hi:[1,0,0]
    v_pk_fma_f32 v[118:119], v[12:13], v[22:23], v[118:119] op_sel_hi:[0,1,1] neg_lo:[1,0,0] neg_hi:[1,0,0]
    v_pk_mul_f32 v[116:117], v[28:29], v[116:117]
    v_pk_mul_f32 v[118:119], v[30:31], v[118:119]
    v_pk_fma_f32 v[124:125], v[14:15], v[20:21], v[124:125] op_sel_hi:[0,1,1] neg_lo:[1,0,0] neg_hi:[1,0,0]
    v_pk_fma_f32 v[126:127], v[14:15], v[22:23], v[126:127] op_sel_hi:[0,1,1] neg_lo:[1,0,0] neg_hi:[1,0,0]
    v_pk_mul_f32 v[124:125], v[28:29], v[124:125]
    v_pk_mul_f32 v[126:127], v[30:31], v[126:127]
    v_cvt_pk_bf16_f32 v90, v116, v117
    v_cvt_pk_bf16_f32 v91, v118, v119
    v_cvt_pk_bf16_f32 v94, v124, v125
    v_cvt_pk_bf16_f32 v95, v126, v127
    v_cvt_pk_bf16_f32 v116, v116, v117
    v_cvt_pk_bf16_f32 v117, v118, v119
    v_cvt_pk_bf16_f32 v118, v124, v125
    v_cvt_pk_bf16_f32 v119, v126, v127
    buffer_store_dwordx4 v[116:119], v1, s[4:7], s52 offen offset:3072 sc1
    ds_write_b128 v15, v[116:119] offset:7168
    v_pk_fma_f32 v[96:97], v[8:9], v[16:17], v[96:97] op_sel_hi:[0,1,1] neg_lo:[1,0,0] neg_hi:[1,0,0]
    v_pk_fma_f32 v[98:99], v[8:9], v[18:19], v[98:99] op_sel_hi:[0,1,1] neg_lo:[1,0,0] neg_hi:[1,0,0]
    v_pk_mul_f32 v[96:97], v[24:25], v[96:97]
    v_pk_mul_f32 v[98:99], v[26:27], v[98:99]
    v_cvt_pk_bf16_f32 v72, v96, v97
    v_cvt_pk_bf16_f32 v73, v98, v99
    v_pk_fma_f32 v[104:105], v[10:11], v[16:17], v[104:105] op_sel_hi:[0,1,1] neg_lo:[1,0,0] neg_hi:[1,0,0]
    v_pk_fma_f32 v[106:107], v[10:11], v[18:19], v[106:107] op_sel_hi:[0,1,1] neg_lo:[1,0,0] neg_hi:[1,0,0]
    v_pk_mul_f32 v[104:105], v[24:25], v[104:105]
    v_pk_mul_f32 v[106:107], v[26:27], v[106:107]
    v_cvt_pk_bf16_f32 v76, v104, v105
    v_cvt_pk_bf16_f32 v77, v106, v107
    v_pk_fma_f32 v[112:113], v[12:13], v[16:17], v[112:113] op_sel_hi:[0,1,1] neg_lo:[1,0,0] neg_hi:[1,0,0]
    v_pk_fma_f32 v[114:115], v[12:13], v[18:19], v[114:115] op_sel_hi:[0,1,1] neg_lo:[1,0,0] neg_hi:[1,0,0]
    v_pk_mul_f32 v[112:113], v[24:25], v[112:113]
    v_pk_mul_f32 v[114:115], v[26:27], v[114:115]
    v_cvt_pk_bf16_f32 v88, v112, v113
    v_cvt_pk_bf16_f32 v89, v114, v115
    v_pk_fma_f32 v[120:121], v[14:15], v[16:17], v[120:121] op_sel_hi:[0,1,1] neg_lo:[1,0,0] neg_hi:[1,0,0]
    v_pk_fma_f32 v[122:123], v[14:15], v[18:19], v[122:123] op_sel_hi:[0,1,1] neg_lo:[1,0,0] neg_hi:[1,0,0]
    v_pk_mul_f32 v[120:121], v[24:25], v[120:121]
    v_pk_mul_f32 v[122:123], v[26:27], v[122:123]
    v_cvt_pk_bf16_f32 v92, v120, v121
    v_cvt_pk_bf16_f32 v93, v122, v123
    v_mfma_f32_16x16x32_bf16 v[128:131], v[32:35], v[224:227], v[128:131]
    ds_read_b64_tr_b16 v[60:61], v6 offset:20480
    v_mfma_f32_16x16x32_bf16 v[132:135], v[32:35], v[228:231], v[132:135]
    ds_read_b64_tr_b16 v[62:63], v6 offset:21504
    v_mfma_f32_16x16x32_bf16 v[136:139], v[36:39], v[224:227], v[136:139]
    ds_read_b64_tr_b16 v[32:33], v3 offset:24576
    v_mfma_f32_16x16x32_bf16 v[140:143], v[36:39], v[228:231], v[140:143]
    ds_read_b64_tr_b16 v[34:35], v3 offset:25600
    v_mfma_f32_16x16x32_bf16 v[144:147], v[40:43], v[224:227], v[144:147]
    ds_read_b64_tr_b16 v[36:37], v4 offset:24576
    v_mfma_f32_16x16x32_bf16 v[148:151], v[40:43], v[228:231], v[148:151]
    ds_read_b64_tr_b16 v[38:39], v4 offset:25600
    v_mfma_f32_16x16x32_bf16 v[152:155], v[44:47], v[224:227], v[152:155]
    ds_read_b64_tr_b16 v[40:41], v5 offset:24576
    v_mfma_f32_16x16x32_bf16 v[156:159], v[44:47], v[228:231], v[156:159]
    ds_read_b64_tr_b16 v[42:43], v5 offset:25600
    v_mfma_f32_16x16x32_bf16 v[128:131], v[48:51], v[232:235], v[128:131]
    ds_read_b64_tr_b16 v[44:45], v6 offset:24576
    v_mfma_f32_16x16x32_bf16 v[132:135], v[48:51], v[236:239], v[132:135]
    ds_read_b64_tr_b16 v[46:47], v6 offset:25600
    v_mfma_f32_16x16x32_bf16 v[136:139], v[52:55], v[232:235], v[136:139]
    ds_read_b64_tr_b16 v[48:49], v3 offset:28672
    v_mfma_f32_16x16x32_bf16 v[140:143], v[52:55], v[236:239], v[140:143]
    ds_read_b64_tr_b16 v[50:51], v3 offset:29696
    s_waitcnt lgkmcnt(10)
    v_mfma_f32_16x16x32_bf16 v[144:147], v[56:59], v[232:235], v[144:147]
    ds_read_b64_tr_b16 v[52:53], v4 offset:28672
    v_mfma_f32_16x16x32_bf16 v[148:151], v[56:59], v[236:239], v[148:151]
    ds_read_b64_tr_b16 v[54:55], v4 offset:29696
    v_mfma_f32_16x16x32_bf16 v[152:155], v[60:63], v[232:235], v[152:155]
    ds_read_b64_tr_b16 v[56:57], v5 offset:28672
    v_mfma_f32_16x16x32_bf16 v[156:159], v[60:63], v[236:239], v[156:159]
    ds_read_b64_tr_b16 v[58:59], v5 offset:29696
    s_waitcnt lgkmcnt(10)
    v_mfma_f32_16x16x32_bf16 v[128:131], v[32:35], v[240:243], v[128:131]
    ds_read_b64_tr_b16 v[60:61], v6 offset:28672
    v_mfma_f32_16x16x32_bf16 v[132:135], v[32:35], v[244:247], v[132:135]
    ds_read_b64_tr_b16 v[62:63], v6 offset:29696
    s_barrier
    v_mfma_f32_16x16x32_bf16 v[136:139], v[36:39], v[240:243], v[136:139]
    ds_read_b64_tr_b16 v[32:33], v3 offset:32768
    v_mfma_f32_16x16x32_bf16 v[140:143], v[36:39], v[244:247], v[140:143]
    ds_read_b64_tr_b16 v[34:35], v3 offset:33792
    s_waitcnt lgkmcnt(10)
    v_mfma_f32_16x16x32_bf16 v[144:147], v[40:43], v[240:243], v[144:147]
    ds_read_b64_tr_b16 v[36:37], v4 offset:32768
    v_mfma_f32_16x16x32_bf16 v[148:151], v[40:43], v[244:247], v[148:151]
    ds_read_b64_tr_b16 v[38:39], v4 offset:33792
    v_mfma_f32_16x16x32_bf16 v[152:155], v[44:47], v[240:243], v[152:155]
    ds_read_b64_tr_b16 v[40:41], v5 offset:32768
    v_mfma_f32_16x16x32_bf16 v[156:159], v[44:47], v[244:247], v[156:159]
    ds_read_b64_tr_b16 v[42:43], v5 offset:33792
    s_waitcnt lgkmcnt(10)
    v_mfma_f32_16x16x32_bf16 v[128:131], v[48:51], v[248:251], v[128:131]
    ds_read_b64_tr_b16 v[44:45], v6 offset:32768
    v_mfma_f32_16x16x32_bf16 v[132:135], v[48:51], v[252:255], v[132:135]
    ds_read_b64_tr_b16 v[46:47], v6 offset:33792
    v_mfma_f32_16x16x32_bf16 v[136:139], v[52:55], v[248:251], v[136:139]
    ds_read_b64_tr_b16 v[48:49], v3 offset:36864
    v_mfma_f32_16x16x32_bf16 v[140:143], v[52:55], v[252:255], v[140:143]
    ds_read_b64_tr_b16 v[50:51], v3 offset:37888
    s_waitcnt lgkmcnt(10)
    v_mfma_f32_16x16x32_bf16 v[144:147], v[56:59], v[248:251], v[144:147]
    ds_read_b64_tr_b16 v[52:53], v4 offset:36864
    v_mfma_f32_16x16x32_bf16 v[148:151], v[56:59], v[252:255], v[148:151]
    ds_read_b64_tr_b16 v[54:55], v4 offset:37888
    v_mfma_f32_16x16x32_bf16 v[152:155], v[60:63], v[248:251], v[152:155]
    ds_read_b64_tr_b16 v[56:57], v5 offset:36864
    v_mfma_f32_16x16x32_bf16 v[156:159], v[60:63], v[252:255], v[156:159]
    ds_read_b64_tr_b16 v[58:59], v5 offset:37888
    s_waitcnt lgkmcnt(10)
    v_mfma_f32_16x16x32_bf16 v[128:131], v[32:35], v[160:163], v[128:131]
    ds_read_b64_tr_b16 v[60:61], v6 offset:36864
    v_mfma_f32_16x16x32_bf16 v[132:135], v[32:35], v[164:167], v[132:135]
    ds_read_b64_tr_b16 v[62:63], v6 offset:37888
    v_mfma_f32_16x16x32_bf16 v[136:139], v[36:39], v[160:163], v[136:139]
    ds_read_b64_tr_b16 v[32:33], v3 offset:40960
    v_mfma_f32_16x16x32_bf16 v[140:143], v[36:39], v[164:167], v[140:143]
    ds_read_b64_tr_b16 v[34:35], v3 offset:41984
    s_waitcnt lgkmcnt(10)
    v_mfma_f32_16x16x32_bf16 v[144:147], v[40:43], v[160:163], v[144:147]
    ds_read_b64_tr_b16 v[36:37], v4 offset:40960
    v_mfma_f32_16x16x32_bf16 v[148:151], v[40:43], v[164:167], v[148:151]
    ds_read_b64_tr_b16 v[38:39], v4 offset:41984
    v_mfma_f32_16x16x32_bf16 v[152:155], v[44:47], v[160:163], v[152:155]
    ds_read_b64_tr_b16 v[40:41], v5 offset:40960
    v_mfma_f32_16x16x32_bf16 v[156:159], v[44:47], v[164:167], v[156:159]
    ds_read_b64_tr_b16 v[42:43], v5 offset:41984
    s_waitcnt lgkmcnt(10)
    v_mfma_f32_16x16x32_bf16 v[128:131], v[48:51], v[168:171], v[128:131]
    ds_read_b64_tr_b16 v[44:45], v6 offset:40960
    v_mfma_f32_16x16x32_bf16 v[132:135], v[48:51], v[172:175], v[132:135]
    ds_read_b64_tr_b16 v[46:47], v6 offset:41984
    v_mfma_f32_16x16x32_bf16 v[136:139], v[52:55], v[168:171], v[136:139]
    ds_read_b64_tr_b16 v[48:49], v3 offset:45056
    v_mfma_f32_16x16x32_bf16 v[140:143], v[52:55], v[172:175], v[140:143]
    ds_read_b64_tr_b16 v[50:51], v3 offset:46080
    s_waitcnt lgkmcnt(10)
    v_mfma_f32_16x16x32_bf16 v[144:147], v[56:59], v[168:171], v[144:147]
    ds_read_b64_tr_b16 v[52:53], v4 offset:45056
    v_mfma_f32_16x16x32_bf16 v[148:151], v[56:59], v[172:175], v[148:151]
    ds_read_b64_tr_b16 v[54:55], v4 offset:46080
    v_mfma_f32_16x16x32_bf16 v[152:155], v[60:63], v[168:171], v[152:155]
    ds_read_b64_tr_b16 v[56:57], v5 offset:45056
    v_mfma_f32_16x16x32_bf16 v[156:159], v[60:63], v[172:175], v[156:159]
    ds_read_b64_tr_b16 v[58:59], v5 offset:46080
    s_waitcnt lgkmcnt(10)
    v_mfma_f32_16x16x32_bf16 v[128:131], v[32:35], v[176:179], v[128:131]
    ds_read_b64_tr_b16 v[60:61], v6 offset:45056
    v_mfma_f32_16x16x32_bf16 v[132:135], v[32:35], v[180:183], v[132:135]
    ds_read_b64_tr_b16 v[62:63], v6 offset:46080
    v_mfma_f32_16x16x32_bf16 v[136:139], v[36:39], v[176:179], v[136:139]
    ds_read_b64_tr_b16 v[32:33], v3 offset:49152
    v_mfma_f32_16x16x32_bf16 v[140:143], v[36:39], v[180:183], v[140:143]
    ds_read_b64_tr_b16 v[34:35], v3 offset:50176
    s_waitcnt lgkmcnt(10)
    v_mfma_f32_16x16x32_bf16 v[144:147], v[40:43], v[176:179], v[144:147]
    ds_read_b64_tr_b16 v[36:37], v4 offset:49152
    v_mfma_f32_16x16x32_bf16 v[148:151], v[40:43], v[180:183], v[148:151]
    ds_read_b64_tr_b16 v[38:39], v4 offset:50176
    v_mfma_f32_16x16x32_bf16 v[152:155], v[44:47], v[176:179], v[152:155]
    ds_read_b64_tr_b16 v[40:41], v5 offset:49152
    v_mfma_f32_16x16x32_bf16 v[156:159], v[44:47], v[180:183], v[156:159]
    ds_read_b64_tr_b16 v[42:43], v5 offset:50176
    s_waitcnt lgkmcnt(10)
    v_mfma_f32_16x16x32_bf16 v[128:131], v[48:51], v[184:187], v[128:131]
    ds_read_b64_tr_b16 v[44:45], v6 offset:49152
    s_waitcnt vmcnt(0)
    s_cmp_lg_u32 s16, 3
    s_cbranch_scc1 a_nopub
    s_atomic_add s40, s[22:23], s53
a_nopub:
    ds_read_b32 v8, v9 offset:4096
    v_mfma_f32_16x16x32_bf16 v[132:135], v[48:51], v[188:191], v[132:135]
    ds_read_b64_tr_b16 v[46:47], v6 offset:50176
    ds_read_b32 v10, v9 offset:4608
    v_mfma_f32_16x16x32_bf16 v[136:139], v[52:55], v[184:187], v[136:139]
    ds_read_b64_tr_b16 v[48:49], v3 offset:53248
    ds_read_b32 v12, v9 offset:4160
    v_mfma_f32_16x16x32_bf16 v[140:143], v[52:55], v[188:191], v[140:143]
    ds_read_b64_tr_b16 v[50:51], v3 offset:54272
    ds_read_b32 v14, v9 offset:4672
    s_waitcnt lgkmcnt(14)
    v_mfma_f32_16x16x32_bf16 v[144:147], v[56:59], v[184:187], v[144:147]
    ds_read_b64_tr_b16 v[52:53], v4 offset:53248
    ds_read_b128 v[16:19], v11 offset:0
    v_mfma_f32_16x16x32_bf16 v[148:151], v[56:59], v[188:191], v[148:151]
    ds_read_b64_tr_b16 v[54:55], v4 offset:54272
    ds_read_b128 v[20:23], v11 offset:64
    v_mfma_f32_16x16x32_bf16 v[152:155], v[60:63], v[184:187], v[152:155]
    ds_read_b64_tr_b16 v[56:57], v5 offset:53248
    ds_read_b128 v[24:27], v11 offset:128
    v_mfma_f32_16x16x32_bf16 v[156:159], v[60:63], v[188:191], v[156:159]
    ds_read_b64_tr_b16 v[58:59], v5 offset:54272
    ds_read_b128 v[28:31], v11 offset:192
    s_waitcnt lgkmcnt(15)
    v_mfma_f32_16x16x32_bf16 v[128:131], v[32:35], v[192:195], v[128:131]
    ds_read_b64_tr_b16 v[60:61], v6 offset:53248
    v_add_u32 v13, 153600, v1
    v_mfma_f32_16x16x32_bf16 v[132:135], v[32:35], v[196:199], v[132:135]
    ds_read_b64_tr_b16 v[62:63], v6 offset:54272
    v_mfma_f32_16x16x32_bf16 v[136:139], v[36:39], v[192:195], v[136:139]
    ds_read_b64_tr_b16 v[32:33], v3 offset:57344
    v_mfma_f32_16x16x32_bf16 v[140:143], v[36:39], v[196:199], v[140:143]
    ds_read_b64_tr_b16 v[34:35], v3 offset:58368
    s_waitcnt lgkmcnt(15)
    v_mfma_f32_16x16x32_bf16 v[144:147], v[40:43], v[192:195], v[144:147]
    ds_read_b64_tr_b16 v[36:37], v4 offset:57344
    v_mfma_f32_16x16x32_bf16 v[148:151], v[40:43], v[196:199], v[148:151]
    ds_read_b64_tr_b16 v[38:39], v4 offset:58368
    v_mfma_f32_16x16x32_bf16 v[152:155], v[44:47], v[192:195], v[152:155]
    ds_read_b64_tr_b16 v[40:41], v5 offset:57344
    v_mfma_f32_16x16x32_bf16 v[156:159], v[44:47], v[196:199], v[156:159]
    ds_read_b64_tr_b16 v[42:43], v5 offset:58368
    s_waitcnt lgkmcnt(13)
    v_mfma_f32_16x16x32_bf16 v[128:131], v[48:51], v[200:203], v[128:131]
    ds_read_b64_tr_b16 v[44:45], v6 offset:57344
    s_waitcnt lgkmcnt(9)
    v_mfma_f32_16x16x32_bf16 v[132:135], v[48:51], v[204:207], v[132:135]
    ds_read_b64_tr_b16 v[46:47], v6 offset:58368
    v_mul_f32 v10, 0x3e8293ee, v10
    v_mfma_f32_16x16x32_bf16 v[136:139], v[52:55], v[200:203], v[136:139]
    ds_read_b64_tr_b16 v[48:49], v3 offset:61440
    v_mul_f32 v14, 0x3e8293ee, v14
    v_mfma_f32_16x16x32_bf16 v[140:143], v[52:55], v[204:207], v[140:143]
    ds_read_b64_tr_b16 v[50:51], v3 offset:62464
    ds_read_b128 v[120:123], v13 offset:0
    s_waitcnt lgkmcnt(11)
    v_mfma_f32_16x16x32_bf16 v[144:147], v[56:59], v[200:203], v[144:147]
    ds_read_b64_tr_b16 v[52:53], v4 offset:61440
    ds_read_b128 v[124:127], v13 offset:1024
    v_mfma_f32_16x16x32_bf16 v[148:151], v[56:59], v[204:207], v[148:151]
    ds_read_b64_tr_b16 v[54:55], v4 offset:62464
    v_mfma_f32_16x16x32_bf16 v[152:155], v[60:63], v[200:203], v[152:155]
    ds_read_b64_tr_b16 v[56:57], v5 offset:61440
    v_mfma_f32_16x16x32_bf16 v[156:159], v[60:63], v[204:207], v[156:159]
    ds_read_b64_tr_b16 v[58:59], v5 offset:62464
    s_waitcnt lgkmcnt(12)
    v_mfma_f32_16x16x32_bf16 v[128:131], v[32:35], v[208:211], v[128:131]
    ds_read_b64_tr_b16 v[60:61], v6 offset:61440
    v_mfma_f32_16x16x32_bf16 v[132:135], v[32:35], v[212:215], v[132:135]
    ds_read_b64_tr_b16 v[62:63], v6 offset:62464
    v_xor_b32 v3, 0x10000, v3
    v_xor_b32 v4, 0x10000, v4
    v_xor_b32 v5, 0x10000, v5
    v_xor_b32 v6, 0x10000, v6
    v_mfma_f32_16x16x32_bf16 v[136:139], v[36:39], v[208:211], v[136:139]
    v_mfma_f32_16x16x32_bf16 v[140:143], v[36:39], v[212:215], v[140:143]
    s_waitcnt lgkmcnt(10)
    v_mfma_f32_16x16x32_bf16 v[144:147], v[40:43], v[208:211], v[144:147]
    v_mfma_f32_16x16x32_bf16 v[148:151], v[40:43], v[212:215], v[148:151]
    v_mfma_f32_16x16x32_bf16 v[152:155], v[44:47], v[208:211], v[152:155]
    v_mfma_f32_16x16x32_bf16 v[156:159], v[44:47], v[212:215], v[156:159]
    s_waitcnt lgkmcnt(4)
    v_mfma_f32_16x16x32_bf16 v[128:131], v[48:51], v[216:219], v[128:131]
    v_mfma_f32_16x16x32_bf16 v[132:135], v[48:51], v[220:223], v[132:135]
    v_mfma_f32_16x16x32_bf16 v[136:139], v[52:55], v[216:219], v[136:139]
    v_mfma_f32_16x16x32_bf16 v[140:143], v[52:55], v[220:223], v[140:143]
    s_waitcnt lgkmcnt(0)
    v_mfma_f32_16x16x32_bf16 v[144:147], v[56:59], v[216:219], v[144:147]
    v_mfma_f32_16x16x32_bf16 v[148:151], v[56:59], v[220:223], v[148:151]
    v_mfma_f32_16x16x32_bf16 v[152:155], v[60:63], v[216:219], v[152:155]
    v_mfma_f32_16x16x32_bf16 v[156:159], v[60:63], v[220:223], v[156:159]
    s_lshl_b32 s44, s21, 22
    s_lshl_b32 s45, s38, 16
    s_add_u32 s44, s44, s45
    s_lshl_b32 s45, s18, 12
    s_add_u32 s44, s44, s45
    s_add_u32 s52, s44, 16777216
    v_pk_fma_f32 v[132:133], v[12:13], v[16:17], v[132:133] op_sel_hi:[0,1,1] neg_lo:[1,0,0] neg_hi:[1,0,0]
    v_pk_fma_f32 v[134:135], v[12:13], v[18:19], v[134:135] op_sel_hi:[0,1,1] neg_lo:[1,0,0] neg_hi:[1,0,0]
    v_pk_fma_f32 v[140:141], v[12:13], v[20:21], v[140:141] op_sel_hi:[0,1,1] neg_lo:[1,0,0] neg_hi:[1,0,0]
    v_pk_fma_f32 v[142:143], v[12:13], v[22:23], v[142:143] op_sel_hi:[0,1,1] neg_lo:[1,0,0] neg_hi:[1,0,0]
    v_pk_fma_f32 v[148:149], v[12:13], v[24:25], v[148:149] op_sel_hi:[0,1,1] neg_lo:[1,0,0] neg_hi:[1,0,0]
    v_pk_fma_f32 v[150:151], v[12:13], v[26:27], v[150:151] op_sel_hi:[0,1,1] neg_lo:[1,0,0] neg_hi:[1,0,0]
    v_pk_fma_f32 v[156:157], v[12:13], v[28:29], v[156:157] op_sel_hi:[0,1,1] neg_lo:[1,0,0] neg_hi:[1,0,0]
    v_pk_fma_f32 v[158:159], v[12:13], v[30:31], v[158:159] op_sel_hi:[0,1,1] neg_lo:[1,0,0] neg_hi:[1,0,0]
    v_pk_mul_f32 v[132:133], v[14:15], v[132:133] op_sel_hi:[0,1]
    v_pk_mul_f32 v[134:135], v[14:15], v[134:135] op_sel_hi:[0,1]
    v_pk_mul_f32 v[140:141], v[14:15], v[140:141] op_sel_hi:[0,1]
    v_pk_mul_f32 v[142:143], v[14:15], v[142:143] op_sel_hi:[0,1]
    v_pk_mul_f32 v[148:149], v[14:15], v[148:149] op_sel_hi:[0,1]
    v_pk_mul_f32 v[150:151], v[14:15], v[150:151] op_sel_hi:[0,1]
    v_pk_mul_f32 v[156:157], v[14:15], v[156:157] op_sel_hi:[0,1]
    v_pk_mul_f32 v[158:159], v[14:15], v[158:159] op_sel_hi:[0,1]
    v_cvt_pk_bf16_f32 v132, v132, v133
    v_cvt_pk_bf16_f32 v133, v134, v135
    v_cvt_pk_bf16_f32 v134, v140, v141
    v_cvt_pk_bf16_f32 v135, v142, v143
    v_cvt_pk_bf16_f32 v148, v148, v149
    v_cvt_pk_bf16_f32 v149, v150, v151
    v_cvt_pk_bf16_f32 v150, v156, v157
    v_cvt_pk_bf16_f32 v151, v158, v159
    v_mfma_f32_16x16x32_bf16 v[172:175], v[68:71], v[132:135], v[120:123]
    v_mfma_f32_16x16x32_bf16 v[168:171], v[64:67], v[132:135], v[124:127]
    v_mfma_f32_16x16x32_bf16 v[188:191], v[84:87], v[148:151], v[120:123]
    v_mfma_f32_16x16x32_bf16 v[184:187], v[80:83], v[148:151], v[124:127]
    v_pk_fma_f32 v[128:129], v[8:9], v[16:17], v[128:129] op_sel_hi:[0,1,1] neg_lo:[1,0,0] neg_hi:[1,0,0]
    v_pk_fma_f32 v[130:131], v[8:9], v[18:19], v[130:131] op_sel_hi:[0,1,1] neg_lo:[1,0,0] neg_hi:[1,0,0]
    v_pk_fma_f32 v[136:137], v[8:9], v[20:21], v[136:137] op_sel_hi:[0,1,1] neg_lo:[1,0,0] neg_hi:[1,0,0]
    v_pk_fma_f32 v[138:139], v[8:9], v[22:23], v[138:139] op_sel_hi:[0,1,1] neg_lo:[1,0,0] neg_hi:[1,0,0]
    v_pk_fma_f32 v[144:145], v[8:9], v[24:25], v[144:145] op_sel_hi:[0,1,1] neg_lo:[1,0,0] neg_hi:[1,0,0]
    v_pk_fma_f32 v[146:147], v[8:9], v[26:27], v[146:147] op_sel_hi:[0,1,1] neg_lo:[1,0,0] neg_hi:[1,0,0]
    v_pk_fma_f32 v[152:153], v[8:9], v[28:29], v[152:153] op_sel_hi:[0,1,1] neg_lo:[1,0,0] neg_hi:[1,0,0]
    v_pk_fma_f32 v[154:155], v[8:9], v[30:31], v[154:155] op_sel_hi:[0,1,1] neg_lo:[1,0,0] neg_hi:[1,0,0]
    v_pk_mul_f32 v[128:129], v[10:11], v[128:129] op_sel_hi:[0,1]
    v_pk_mul_f32 v[130:131], v[10:11], v[130:131] op_sel_hi:[0,1]
    v_pk_mul_f32 v[136:137], v[10:11], v[136:137] op_sel_hi:[0,1]
    v_pk_mul_f32 v[138:139], v[10:11], v[138:139] op_sel_hi:[0,1]
    v_pk_mul_f32 v[144:145], v[10:11], v[144:145] op_sel_hi:[0,1]
    v_pk_mul_f32 v[146:147], v[10:11], v[146:147] op_sel_hi:[0,1]
    v_pk_mul_f32 v[152:153], v[10:11], v[152:153] op_sel_hi:[0,1]
    v_pk_mul_f32 v[154:155], v[10:11], v[154:155] op_sel_hi:[0,1]
    v_cvt_pk_bf16_f32 v128, v128, v129
    v_cvt_pk_bf16_f32 v129, v130, v131
    v_cvt_pk_bf16_f32 v130, v136, v137
    v_cvt_pk_bf16_f32 v131, v138, v139
    v_cvt_pk_bf16_f32 v144, v144, v145
    v_cvt_pk_bf16_f32 v145, v146, v147
    v_cvt_pk_bf16_f32 v146, v152, v153
    v_cvt_pk_bf16_f32 v147, v154, v155
    v_mfma_f32_16x16x32_bf16 v[164:167], v[64:67], v[128:131], v[120:123]
    s_nop 0
    v_mfma_f32_16x16x32_bf16 v[180:183], v[80:83], v[144:147], v[120:123]
    v_max3_f32 v16, v168, v169, v170
    v_max3_f32 v16, v16, v171, v172
    v_max3_f32 v16, v16, v173, v174
    v_max_f32 v16, v16, v175
    v_max3_f32 v18, v184, v185, v186
    v_max3_f32 v18, v18, v187, v188
    v_max3_f32 v18, v18, v189, v190
    v_max_f32 v18, v18, v191
    v_mov_b32 v17, v16
    v_mov_b32 v19, v18
    s_nop 0
    v_permlane32_swap_b32 v16, v17
    v_permlane32_swap_b32 v18, v19
    v_max_f32 v16, v16, v17
    v_max_f32 v18, v18, v19
    v_mov_b32 v17, v16
    v_mov_b32 v19, v18
    s_nop 0
    v_permlane16_swap_b32 v16, v17
    v_permlane16_swap_b32 v18, v19
    v_max_f32 v16, v16, v17
    v_max_f32 v18, v18, v19
    v_pk_add_f32 v[168:169], v[168:169], v[16:17] op_sel_hi:[1,0] neg_lo:[0,1] neg_hi:[0,1]
    v_pk_add_f32 v[170:171], v[170:171], v[16:17] op_sel_hi:[1,0] neg_lo:[0,1] neg_hi:[0,1]
    v_pk_add_f32 v[172:173], v[172:173], v[16:17] op_sel_hi:[1,0] neg_lo:[0,1] neg_hi:[0,1]
    v_pk_add_f32 v[174:175], v[174:175], v[16:17] op_sel_hi:[1,0] neg_lo:[0,1] neg_hi:[0,1]
    v_exp_f32 v168, v168
    v_exp_f32 v169, v169
    v_exp_f32 v170, v170
    v_exp_f32 v171, v171
    v_exp_f32 v172, v172
    v_exp_f32 v173, v173
    v_exp_f32 v174, v174
    v_exp_f32 v175, v175
    v_cvt_pk_bf16_f32 v200, v168, v169
    v_cvt_pk_bf16_f32 v201, v170, v171
    v_cvt_pk_bf16_f32 v202, v172, v173
    v_cvt_pk_bf16_f32 v203, v174, v175
    v_pk_add_f32 v[24:25], v[168:169], v[170:171]
    v_pk_add_f32 v[24:25], v[24:25], v[172:173]
    v_mfma_f32_16x16x32_bf16 v[40:43], v[72:75], v[200:203], 0
    v_mfma_f32_16x16x32_bf16 v[44:47], v[76:79], v[200:203], 0
    v_pk_add_f32 v[24:25], v[24:25], v[174:175]
    v_add_f32 v24, v24, v25
    v_pk_add_f32 v[184:185], v[184:185], v[18:19] op_sel_hi:[1,0] neg_lo:[0,1] neg_hi:[0,1]
    v_pk_add_f32 v[186:187], v[186:187], v[18:19] op_sel_hi:[1,0] neg_lo:[0,1] neg_hi:[0,1]
    v_pk_add_f32 v[188:189], v[188:189], v[18:19] op_sel_hi:[1,0] neg_lo:[0,1] neg_hi:[0,1]
    v_pk_add_f32 v[190:191], v[190:191], v[18:19] op_sel_hi:[1,0] neg_lo:[0,1] neg_hi:[0,1]
    v_exp_f32 v184, v184
    v_exp_f32 v185, v185
    v_exp_f32 v186, v186
    v_exp_f32 v187, v187
    v_exp_f32 v188, v188
    v_exp_f32 v189, v189
    v_exp_f32 v190, v190
    v_exp_f32 v191, v191
    v_cvt_pk_bf16_f32 v204, v184, v185
    v_cvt_pk_bf16_f32 v205, v186, v187
    v_cvt_pk_bf16_f32 v206, v188, v189
    v_cvt_pk_bf16_f32 v207, v190, v191
    v_pk_add_f32 v[26:27], v[184:185], v[186:187]
    v_pk_add_f32 v[26:27], v[26:27], v[188:189]
    v_mfma_f32_16x16x32_bf16 v[56:59], v[88:91], v[204:207], 0
    v_mfma_f32_16x16x32_bf16 v[60:63], v[92:95], v[204:207], 0
    v_pk_add_f32 v[26:27], v[26:27], v[190:191]
    v_add_f32 v26, v26, v27
    v_mov_b32 v25, v24
    v_mov_b32 v27, v26
    s_nop 0
    v_permlane32_swap_b32 v24, v25
    v_permlane32_swap_b32 v26, v27
    v_add_f32 v24, v24, v25
    v_add_f32 v26, v26, v27
    v_mov_b32 v25, v24
    v_mov_b32 v27, v26
    s_nop 0
    v_permlane16_swap_b32 v24, v25
    v_permlane16_swap_b32 v26, v27
    v_add_f32 v24, v24, v25
    v_add_f32 v26, v26, v27
    v_rcp_f32 v24, v24
    v_rcp_f32 v26, v26
    v_pk_mul_f32 v[40:41], v[24:25], v[40:41] op_sel_hi:[0,1]
    v_pk_mul_f32 v[42:43], v[24:25], v[42:43] op_sel_hi:[0,1]
    v_pk_mul_f32 v[44:45], v[24:25], v[44:45] op_sel_hi:[0,1]
    v_pk_mul_f32 v[46:47], v[24:25], v[46:47] op_sel_hi:[0,1]
    v_cvt_pk_bf16_f32 v40, v40, v41
    v_cvt_pk_bf16_f32 v41, v42, v43
    v_cvt_pk_bf16_f32 v42, v44, v45
    v_cvt_pk_bf16_f32 v43, v46, v47
    s_nop 0
    v_permlane32_swap_b32 v40, v42
    v_permlane32_swap_b32 v41, v43
    buffer_store_dwordx4 v[40:43], v2, s[4:7], s52 offen offset:256 sc1
    v_pk_mul_f32 v[56:57], v[26:27], v[56:57] op_sel_hi:[0,1]
    v_pk_mul_f32 v[58:59], v[26:27], v[58:59] op_sel_hi:[0,1]
    v_pk_mul_f32 v[60:61], v[26:27], v[60:61] op_sel_hi:[0,1]
    v_pk_mul_f32 v[62:63], v[26:27], v[62:63] op_sel_hi:[0,1]
    v_cvt_pk_bf16_f32 v56, v56, v57
    v_cvt_pk_bf16_f32 v57, v58, v59
    v_cvt_pk_bf16_f32 v58, v60, v61
    v_cvt_pk_bf16_f32 v59, v62, v63
    s_nop 0
    v_permlane32_swap_b32 v56, v58
    v_permlane32_swap_b32 v57, v59
    buffer_store_dwordx4 v[56:59], v2, s[4:7], s52 offen offset:2304 sc1
    v_mov_b32 v218, v72
    v_mov_b32 v219, v73
    v_mov_b32 v222, v76
    v_mov_b32 v223, v77
    v_mov_b32 v226, v88
    v_mov_b32 v227, v89
    v_mov_b32 v230, v92
    v_mov_b32 v231, v93
    s_cmp_lg_u32 s38, 0
    s_cbranch_scc1 a_hasprev
    v_mov_b32 v124, 0xf149f2ca
    v_mov_b32 v125, 0xf149f2ca
    v_mov_b32 v126, 0xf149f2ca
    v_mov_b32 v127, 0xf149f2ca
a_hasprev:
    s_waitcnt lgkmcnt(0)
    s_barrier
    ds_read_b128 v[192:195], v15 offset:0
    ds_read_b128 v[196:199], v15 offset:1024
    ds_read_b64 v[216:217], v15 offset:2048
    ds_read_b64 v[220:221], v15 offset:2056
    ds_read_b64 v[224:225], v15 offset:3072
    ds_read_b64 v[228:229], v15 offset:3080
    s_waitcnt lgkmcnt(4)
    v_mfma_f32_16x16x32_bf16 v[160:163], v[192:195], v[128:131], v[124:127]
    v_mfma_f32_16x16x32_bf16 v[176:179], v[196:199], v[144:147], v[124:127]
    s_waitcnt lgkmcnt(0)
    s_nop 5
    v_max3_f32 v20, v160, v161, v162
    v_max3_f32 v20, v20, v163, v164
    v_max3_f32 v20, v20, v165, v166
    v_max_f32 v20, v20, v167
    v_max3_f32 v22, v176, v177, v178
    v_max3_f32 v22, v22, v179, v180
    v_max3_f32 v22, v22, v181, v182
    v_max_f32 v22, v22, v183
    v_mov_b32 v21, v20
    v_mov_b32 v23, v22
    s_nop 0
    v_permlane32_swap_b32 v20, v21
    v_permlane32_swap_b32 v22, v23
    v_max_f32 v20, v20, v21
    v_max_f32 v22, v22, v23
    v_mov_b32 v21, v20
    v_mov_b32 v23, v22
    s_nop 0
    v_permlane16_swap_b32 v20, v21
    v_permlane16_swap_b32 v22, v23
    v_max_f32 v20, v20, v21
    v_max_f32 v22, v22, v23
    v_pk_add_f32 v[160:161], v[160:161], v[20:21] op_sel_hi:[1,0] neg_lo:[0,1] neg_hi:[0,1]
    v_pk_add_f32 v[162:163], v[162:163], v[20:21] op_sel_hi:[1,0] neg_lo:[0,1] neg_hi:[0,1]
    v_pk_add_f32 v[164:165], v[164:165], v[20:21] op_sel_hi:[1,0] neg_lo:[0,1] neg_hi:[0,1]
    v_pk_add_f32 v[166:167], v[166:167], v[20:21] op_sel_hi:[1,0] neg_lo:[0,1] neg_hi:[0,1]
    v_exp_f32 v160, v160
    v_exp_f32 v161, v161
    v_exp_f32 v162, v162
    v_exp_f32 v163, v163
    v_exp_f32 v164, v164
    v_exp_f32 v165, v165
    v_exp_f32 v166, v166
    v_exp_f32 v167, v167
    v_cvt_pk_bf16_f32 v208, v160, v161
    v_cvt_pk_bf16_f32 v209, v162, v163
    v_cvt_pk_bf16_f32 v210, v164, v165
    v_cvt_pk_bf16_f32 v211, v166, v167
    v_pk_add_f32 v[28:29], v[160:161], v[162:163]
    v_pk_add_f32 v[28:29], v[28:29], v[164:165]
    v_mfma_f32_16x16x32_bf16 v[32:35], v[216:219], v[208:211], 0
    v_mfma_f32_16x16x32_bf16 v[36:39], v[220:223], v[208:211], 0
    v_pk_add_f32 v[28:29], v[28:29], v[166:167]
    v_add_f32 v28, v28, v29
    v_pk_add_f32 v[176:177], v[176:177], v[22:23] op_sel_hi:[1,0] neg_lo:[0,1] neg_hi:[0,1]
    v_pk_add_f32 v[178:179], v[178:179], v[22:23] op_sel_hi:[1,0] neg_lo:[0,1] neg_hi:[0,1]
    v_pk_add_f32 v[180:181], v[180:181], v[22:23] op_sel_hi:[1,0] neg_lo:[0,1] neg_hi:[0,1]
    v_pk_add_f32 v[182:183], v[182:183], v[22:23] op_sel_hi:[1,0] neg_lo:[0,1] neg_hi:[0,1]
    v_exp_f32 v176, v176
    v_exp_f32 v177, v177
    v_exp_f32 v178, v178
    v_exp_f32 v179, v179
    v_exp_f32 v180, v180
    v_exp_f32 v181, v181
    v_exp_f32 v182, v182
    v_exp_f32 v183, v183
    v_cvt_pk_bf16_f32 v212, v176, v177
    v_cvt_pk_bf16_f32 v213, v178, v179
    v_cvt_pk_bf16_f32 v214, v180, v181
    v_cvt_pk_bf16_f32 v215, v182, v183
    v_pk_add_f32 v[30:31], v[176:177], v[178:179]
    v_pk_add_f32 v[30:31], v[30:31], v[180:181]
    v_mfma_f32_16x16x32_bf16 v[48:51], v[224:227], v[212:215], 0
    v_mfma_f32_16x16x32_bf16 v[52:55], v[228:231], v[212:215], 0
    v_pk_add_f32 v[30:31], v[30:31], v[182:183]
    v_add_f32 v30, v30, v31
    v_mov_b32 v29, v28
    v_mov_b32 v31, v30
    s_nop 0
    v_permlane32_swap_b32 v28, v29
    v_permlane32_swap_b32 v30, v31
    v_add_f32 v28, v28, v29
    v_add_f32 v30, v30, v31
    v_mov_b32 v29, v28
    v_mov_b32 v31, v30
    s_nop 0
    v_permlane16_swap_b32 v28, v29
    v_permlane16_swap_b32 v30, v31
    v_add_f32 v28, v28, v29
    v_add_f32 v30, v30, v31
    v_rcp_f32 v28, v28
    v_rcp_f32 v30, v30
    v_pk_mul_f32 v[32:33], v[28:29], v[32:33] op_sel_hi:[0,1]
    v_pk_mul_f32 v[34:35], v[28:29], v[34:35] op_sel_hi:[0,1]
    v_pk_mul_f32 v[36:37], v[28:29], v[36:37] op_sel_hi:[0,1]
    v_pk_mul_f32 v[38:39], v[28:29], v[38:39] op_sel_hi:[0,1]
    v_cvt_pk_bf16_f32 v32, v32, v33
    v_cvt_pk_bf16_f32 v33, v34, v35
    v_cvt_pk_bf16_f32 v34, v36, v37
    v_cvt_pk_bf16_f32 v35, v38, v39
    s_nop 0
    v_permlane32_swap_b32 v32, v34
    v_permlane32_swap_b32 v33, v35
    buffer_store_dwordx4 v[32:35], v2, s[4:7], s52 offen offset:0 sc1
    v_pk_mul_f32 v[48:49], v[30:31], v[48:49] op_sel_hi:[0,1]
    v_pk_mul_f32 v[50:51], v[30:31], v[50:51] op_sel_hi:[0,1]
    v_pk_mul_f32 v[52:53], v[30:31], v[52:53] op_sel_hi:[0,1]
    v_pk_mul_f32 v[54:55], v[30:31], v[54:55] op_sel_hi:[0,1]
    v_cvt_pk_bf16_f32 v48, v48, v49
    v_cvt_pk_bf16_f32 v49, v50, v51
    v_cvt_pk_bf16_f32 v50, v52, v53
    v_cvt_pk_bf16_f32 v51, v54, v55
    s_nop 0
    v_permlane32_swap_b32 v48, v50
    v_permlane32_swap_b32 v49, v51
    buffer_store_dwordx4 v[48:51], v2, s[4:7], s52 offen offset:2048 sc1
    s_lshl_b32 s44, s21, 22
    s_lshl_b32 s45, s39, 16
    s_add_u32 s41, s44, s45
    s_lshl_b32 s45, s20, 12
    s_add_u32 s43, s41, s45
    s_add_u32 s41, s41, 16777216
    buffer_load_dwordx4 v[224:227], v2, s[4:7], s43 offen offset:0 sc1
    buffer_load_dwordx4 v[228:231], v2, s[4:7], s43 offen offset:256 sc1
    buffer_load_dwordx4 v[232:235], v2, s[4:7], s43 offen offset:2048 sc1
    buffer_load_dwordx4 v[236:239], v2, s[4:7], s43 offen offset:2304 sc1
    s_lshl_b32 s46, s21, 14
    s_lshl_b32 s67, s38, 8
    s_add_u32 s46, s46, s67
    s_add_u32 s46, s46, 86144
    s_lshl_b32 s47, s21, 14
    s_lshl_b32 s67, s39, 8
    s_add_u32 s47, s47, s67
    s_add_u32 s47, s47, 86144
    s_waitcnt vmcnt(4)
    s_atomic_add s40, s[22:23], s46
    s_barrier
    s_mov_b32 s66, 0x10000
c_o_poll:
    s_mov_b32 s68, 0
    s_atomic_add s68, s[22:23], s47 offset:0 glc
    s_waitcnt lgkmcnt(0)
    s_cmp_eq_u32 s68, 16
    s_cbranch_scc1 c_o_ok
    s_sub_u32 s66, s66, 1
    s_cmp_lg_u32 s66, 0
    s_cbranch_scc1 c_o_poll
c_o_ok:
    s_branch c_wo
c_B:
    s_lshr_b32 s44, s21, 1
    s_lshl_b32 s53, s44, 23
    s_lshl_b32 s45, s18, 18
    s_add_u32 s53, s53, s45
    s_add_u32 s53, s53, 33554432
    s_lshl_b32 s54, s38, 11
    s_add_u32 s52, s53, s54
    s_add_u32 s55, s52, 0
    v_cvt_pk_bf16_f32 v64, v64, v65
    v_cvt_pk_bf16_f32 v65, v66, v67
    v_cvt_pk_bf16_f32 v66, v72, v73
    v_cvt_pk_bf16_f32 v67, v74, v75
    buffer_store_dwordx4 v[64:67], v2, s[4:7], s55 offen offset:0 sc1
    v_cvt_pk_bf16_f32 v68, v68, v69
    v_cvt_pk_bf16_f32 v69, v70, v71
    v_cvt_pk_bf16_f32 v70, v76, v77
    v_cvt_pk_bf16_f32 v71, v78, v79
    buffer_store_dwordx4 v[68:71], v2, s[4:7], s55 offen offset:256 sc1
    s_add_u32 s55, s52, 131072
    v_cvt_pk_bf16_f32 v80, v80, v81
    v_cvt_pk_bf16_f32 v81, v82, v83
    v_cvt_pk_bf16_f32 v82, v88, v89
    v_cvt_pk_bf16_f32 v83, v90, v91
    buffer_store_dwordx4 v[80:83], v2, s[4:7], s55 offen offset:0 sc1
    v_cvt_pk_bf16_f32 v84, v84, v85
    v_cvt_pk_bf16_f32 v85, v86, v87
    v_cvt_pk_bf16_f32 v86, v92, v93
    v_cvt_pk_bf16_f32 v87, v94, v95
    buffer_store_dwordx4 v[84:87], v2, s[4:7], s55 offen offset:256 sc1
    s_waitcnt lgkmcnt(0)
    s_add_u32 s56, s52, 4194304
    v_pk_fma_f32 v[96:97], v[8:9], v[16:17], v[96:97] op_sel_hi:[0,1,1] neg_lo:[1,0,0] neg_hi:[1,0,0]
    v_pk_fma_f32 v[98:99], v[8:9], v[18:19], v[98:99] op_sel_hi:[0,1,1] neg_lo:[1,0,0] neg_hi:[1,0,0]
    v_pk_fma_f32 v[104:105], v[10:11], v[16:17], v[104:105] op_sel_hi:[0,1,1] neg_lo:[1,0,0] neg_hi:[1,0,0]
    v_pk_fma_f32 v[106:107], v[10:11], v[18:19], v[106:107] op_sel_hi:[0,1,1] neg_lo:[1,0,0] neg_hi:[1,0,0]
    v_pk_fma_f32 v[100:101], v[8:9], v[20:21], v[100:101] op_sel_hi:[0,1,1] neg_lo:[1,0,0] neg_hi:[1,0,0]
    v_pk_fma_f32 v[102:103], v[8:9], v[22:23], v[102:103] op_sel_hi:[0,1,1] neg_lo:[1,0,0] neg_hi:[1,0,0]
    v_pk_fma_f32 v[108:109], v[10:11], v[20:21], v[108:109] op_sel_hi:[0,1,1] neg_lo:[1,0,0] neg_hi:[1,0,0]
    v_pk_fma_f32 v[110:111], v[10:11], v[22:23], v[110:111] op_sel_hi:[0,1,1] neg_lo:[1,0,0] neg_hi:[1,0,0]
    v_pk_mul_f32 v[96:97], v[24:25], v[96:97]
    v_pk_mul_f32 v[98:99], v[26:27], v[98:99]
    v_pk_mul_f32 v[104:105], v[24:25], v[104:105]
    v_pk_mul_f32 v[106:107], v[26:27], v[106:107]
    v_pk_mul_f32 v[100:101], v[28:29], v[100:101]
    v_pk_mul_f32 v[102:103], v[30:31], v[102:103]
    v_pk_mul_f32 v[108:109], v[28:29], v[108:109]
    v_pk_mul_f32 v[110:111], v[30:31], v[110:111]
    v_cvt_pk_bf16_f32 v72, v96, v97
    v_cvt_pk_bf16_f32 v73, v98, v99
    v_cvt_pk_bf16_f32 v74, v104, v105
    v_cvt_pk_bf16_f32 v75, v106, v107
    v_cvt_pk_bf16_f32 v76, v100, v101
    v_cvt_pk_bf16_f32 v77, v102, v103
    v_cvt_pk_bf16_f32 v78, v108, v109
    v_cvt_pk_bf16_f32 v79, v110, v111
    v_permlane16_swap_b32 v72, v74
    v_permlane16_swap_b32 v73, v75
    buffer_store_dwordx4 v[72:75], v1, s[4:7], s56 offen offset:0 sc1
    v_permlane16_swap_b32 v76, v78
    v_permlane16_swap_b32 v77, v79
    buffer_store_dwordx4 v[76:79], v1, s[4:7], s56 offen offset:1024 sc1
    s_add_u32 s56, s52, 4325376
    v_pk_fma_f32 v[112:113], v[12:13], v[16:17], v[112:113] op_sel_hi:[0,1,1] neg_lo:[1,0,0] neg_hi:[1,0,0]
    v_pk_fma_f32 v[114:115], v[12:13], v[18:19], v[114:115] op_sel_hi:[0,1,1] neg_lo:[1,0,0] neg_hi:[1,0,0]
    v_pk_fma_f32 v[120:121], v[14:15], v[16:17], v[120:121] op_sel_hi:[0,1,1] neg_lo:[1,0,0] neg_hi:[1,0,0]
    v_pk_fma_f32 v[122:123], v[14:15], v[18:19], v[122:123] op_sel_hi:[0,1,1] neg_lo:[1,0,0] neg_hi:[1,0,0]
    v_pk_fma_f32 v[116:117], v[12:13], v[20:21], v[116:117] op_sel_hi:[0,1,1] neg_lo:[1,0,0] neg_hi:[1,0,0]
    v_pk_fma_f32 v[118:119], v[12:13], v[22:23], v[118:119] op_sel_hi:[0,1,1] neg_lo:[1,0,0] neg_hi:[1,0,0]
    v_pk_fma_f32 v[124:125], v[14:15], v[20:21], v[124:125] op_sel_hi:[0,1,1] neg_lo:[1,0,0] neg_hi:[1,0,0]
    v_pk_fma_f32 v[126:127], v[14:15], v[22:23], v[126:127] op_sel_hi:[0,1,1] neg_lo:[1,0,0] neg_hi:[1,0,0]
    v_pk_mul_f32 v[112:113], v[24:25], v[112:113]
    v_pk_mul_f32 v[114:115], v[26:27], v[114:115]
    v_pk_mul_f32 v[120:121], v[24:25], v[120:121]
    v_pk_mul_f32 v[122:123], v[26:27], v[122:123]
    v_pk_mul_f32 v[116:117], v[28:29], v[116:117]
    v_pk_mul_f32 v[118:119], v[30:31], v[118:119]
    v_pk_mul_f32 v[124:125], v[28:29], v[124:125]
    v_pk_mul_f32 v[126:127], v[30:31], v[126:127]
    v_cvt_pk_bf16_f32 v88, v112, v113
    v_cvt_pk_bf16_f32 v89, v114, v115
    v_cvt_pk_bf16_f32 v90, v120, v121
    v_cvt_pk_bf16_f32 v91, v122, v123
    v_cvt_pk_bf16_f32 v92, v116, v117
    v_cvt_pk_bf16_f32 v93, v118, v119
    v_cvt_pk_bf16_f32 v94, v124, v125
    v_cvt_pk_bf16_f32 v95, v126, v127
    v_permlane16_swap_b32 v88, v90
    v_permlane16_swap_b32 v89, v91
    buffer_store_dwordx4 v[88:91], v1, s[4:7], s56 offen offset:0 sc1
    v_permlane16_swap_b32 v92, v94
    v_permlane16_swap_b32 v93, v95
    buffer_store_dwordx4 v[92:95], v1, s[4:7], s56 offen offset:1024 sc1
    s_lshl_b32 s46, s44, 13
    s_lshl_b32 s67, s18, 9
    s_add_u32 s46, s46, s67
    s_lshl_b32 s67, s16, 7
    s_add_u32 s46, s46, s67
    s_add_u32 s46, s46, 69632
    v_mfma_f32_16x16x32_bf16 v[128:131], v[32:35], v[224:227], v[128:131]
    ds_read_b64_tr_b16 v[60:61], v6 offset:20480
    v_mfma_f32_16x16x32_bf16 v[132:135], v[32:35], v[228:231], v[132:135]
    ds_read_b64_tr_b16 v[62:63], v6 offset:21504
    v_mfma_f32_16x16x32_bf16 v[136:139], v[36:39], v[224:227], v[136:139]
    ds_read_b64_tr_b16 v[32:33], v3 offset:24576
    v_mfma_f32_16x16x32_bf16 v[140:143], v[36:39], v[228:231], v[140:143]
    ds_read_b64_tr_b16 v[34:35], v3 offset:25600
    v_mfma_f32_16x16x32_bf16 v[144:147], v[40:43], v[224:227], v[144:147]
    ds_read_b64_tr_b16 v[36:37], v4 offset:24576
    v_mfma_f32_16x16x32_bf16 v[148:151], v[40:43], v[228:231], v[148:151]
    ds_read_b64_tr_b16 v[38:39], v4 offset:25600
    v_mfma_f32_16x16x32_bf16 v[152:155], v[44:47], v[224:227], v[152:155]
    ds_read_b64_tr_b16 v[40:41], v5 offset:24576
    v_mfma_f32_16x16x32_bf16 v[156:159], v[44:47], v[228:231], v[156:159]
    ds_read_b64_tr_b16 v[42:43], v5 offset:25600
    v_mfma_f32_16x16x32_bf16 v[128:131], v[48:51], v[232:235], v[128:131]
    ds_read_b64_tr_b16 v[44:45], v6 offset:24576
    v_mfma_f32_16x16x32_bf16 v[132:135], v[48:51], v[236:239], v[132:135]
    ds_read_b64_tr_b16 v[46:47], v6 offset:25600
    v_mfma_f32_16x16x32_bf16 v[136:139], v[52:55], v[232:235], v[136:139]
    ds_read_b64_tr_b16 v[48:49], v3 offset:28672
    v_mfma_f32_16x16x32_bf16 v[140:143], v[52:55], v[236:239], v[140:143]
    ds_read_b64_tr_b16 v[50:51], v3 offset:29696
    s_waitcnt lgkmcnt(10)
    v_mfma_f32_16x16x32_bf16 v[144:147], v[56:59], v[232:235], v[144:147]
    ds_read_b64_tr_b16 v[52:53], v4 offset:28672
    v_mfma_f32_16x16x32_bf16 v[148:151], v[56:59], v[236:239], v[148:151]
    ds_read_b64_tr_b16 v[54:55], v4 offset:29696
    v_mfma_f32_16x16x32_bf16 v[152:155], v[60:63], v[232:235], v[152:155]
    ds_read_b64_tr_b16 v[56:57], v5 offset:28672
    v_mfma_f32_16x16x32_bf16 v[156:159], v[60:63], v[236:239], v[156:159]
    ds_read_b64_tr_b16 v[58:59], v5 offset:29696
    s_waitcnt lgkmcnt(10)
    v_mfma_f32_16x16x32_bf16 v[128:131], v[32:35], v[240:243], v[128:131]
    ds_read_b64_tr_b16 v[60:61], v6 offset:28672
    v_mfma_f32_16x16x32_bf16 v[132:135], v[32:35], v[244:247], v[132:135]
    ds_read_b64_tr_b16 v[62:63], v6 offset:29696
    s_barrier
    v_mfma_f32_16x16x32_bf16 v[136:139], v[36:39], v[240:243], v[136:139]
    ds_read_b64_tr_b16 v[32:33], v3 offset:32768
    v_mfma_f32_16x16x32_bf16 v[140:143], v[36:39], v[244:247], v[140:143]
    ds_read_b64_tr_b16 v[34:35], v3 offset:33792
    s_waitcnt lgkmcnt(10)
    v_mfma_f32_16x16x32_bf16 v[144:147], v[40:43], v[240:243], v[144:147]
    ds_read_b64_tr_b16 v[36:37], v4 offset:32768
    v_mfma_f32_16x16x32_bf16 v[148:151], v[40:43], v[244:247], v[148:151]
    ds_read_b64_tr_b16 v[38:39], v4 offset:33792
    v_mfma_f32_16x16x32_bf16 v[152:155], v[44:47], v[240:243], v[152:155]
    ds_read_b64_tr_b16 v[40:41], v5 offset:32768
    v_mfma_f32_16x16x32_bf16 v[156:159], v[44:47], v[244:247], v[156:159]
    ds_read_b64_tr_b16 v[42:43], v5 offset:33792
    s_waitcnt lgkmcnt(10)
    v_mfma_f32_16x16x32_bf16 v[128:131], v[48:51], v[248:251], v[128:131]
    ds_read_b64_tr_b16 v[44:45], v6 offset:32768
    v_mfma_f32_16x16x32_bf16 v[132:135], v[48:51], v[252:255], v[132:135]
    ds_read_b64_tr_b16 v[46:47], v6 offset:33792
    v_mfma_f32_16x16x32_bf16 v[136:139], v[52:55], v[248:251], v[136:139]
    ds_read_b64_tr_b16 v[48:49], v3 offset:36864
    v_mfma_f32_16x16x32_bf16 v[140:143], v[52:55], v[252:255], v[140:143]
    ds_read_b64_tr_b16 v[50:51], v3 offset:37888
    s_waitcnt lgkmcnt(10)
    v_mfma_f32_16x16x32_bf16 v[144:147], v[56:59], v[248:251], v[144:147]
    ds_read_b64_tr_b16 v[52:53], v4 offset:36864
    v_mfma_f32_16x16x32_bf16 v[148:151], v[56:59], v[252:255], v[148:151]
    ds_read_b64_tr_b16 v[54:55], v4 offset:37888
    v_mfma_f32_16x16x32_bf16 v[152:155], v[60:63], v[248:251], v[152:155]
    ds_read_b64_tr_b16 v[56:57], v5 offset:36864
    v_mfma_f32_16x16x32_bf16 v[156:159], v[60:63], v[252:255], v[156:159]
    ds_read_b64_tr_b16 v[58:59], v5 offset:37888
    s_waitcnt lgkmcnt(10)
    v_mfma_f32_16x16x32_bf16 v[128:131], v[32:35], v[160:163], v[128:131]
    ds_read_b64_tr_b16 v[60:61], v6 offset:36864
    v_mfma_f32_16x16x32_bf16 v[132:135], v[32:35], v[164:167], v[132:135]
    ds_read_b64_tr_b16 v[62:63], v6 offset:37888
    v_mfma_f32_16x16x32_bf16 v[136:139], v[36:39], v[160:163], v[136:139]
    ds_read_b64_tr_b16 v[32:33], v3 offset:40960
    v_mfma_f32_16x16x32_bf16 v[140:143], v[36:39], v[164:167], v[140:143]
    ds_read_b64_tr_b16 v[34:35], v3 offset:41984
    s_waitcnt lgkmcnt(10)
    v_mfma_f32_16x16x32_bf16 v[144:147], v[40:43], v[160:163], v[144:147]
    ds_read_b64_tr_b16 v[36:37], v4 offset:40960
    v_mfma_f32_16x16x32_bf16 v[148:151], v[40:43], v[164:167], v[148:151]
    ds_read_b64_tr_b16 v[38:39], v4 offset:41984
    v_mfma_f32_16x16x32_bf16 v[152:155], v[44:47], v[160:163], v[152:155]
    ds_read_b64_tr_b16 v[40:41], v5 offset:40960
    v_mfma_f32_16x16x32_bf16 v[156:159], v[44:47], v[164:167], v[156:159]
    ds_read_b64_tr_b16 v[42:43], v5 offset:41984
    s_waitcnt lgkmcnt(10)
    v_mfma_f32_16x16x32_bf16 v[128:131], v[48:51], v[168:171], v[128:131]
    ds_read_b64_tr_b16 v[44:45], v6 offset:40960
    v_mfma_f32_16x16x32_bf16 v[132:135], v[48:51], v[172:175], v[132:135]
    ds_read_b64_tr_b16 v[46:47], v6 offset:41984
    v_mfma_f32_16x16x32_bf16 v[136:139], v[52:55], v[168:171], v[136:139]
    ds_read_b64_tr_b16 v[48:49], v3 offset:45056
    v_mfma_f32_16x16x32_bf16 v[140:143], v[52:55], v[172:175], v[140:143]
    ds_read_b64_tr_b16 v[50:51], v3 offset:46080
    s_waitcnt lgkmcnt(10)
    v_mfma_f32_16x16x32_bf16 v[144:147], v[56:59], v[168:171], v[144:147]
    ds_read_b64_tr_b16 v[52:53], v4 offset:45056
    v_mfma_f32_16x16x32_bf16 v[148:151], v[56:59], v[172:175], v[148:151]
    ds_read_b64_tr_b16 v[54:55], v4 offset:46080
    v_mfma_f32_16x16x32_bf16 v[152:155], v[60:63], v[168:171], v[152:155]
    ds_read_b64_tr_b16 v[56:57], v5 offset:45056
    v_mfma_f32_16x16x32_bf16 v[156:159], v[60:63], v[172:175], v[156:159]
    ds_read_b64_tr_b16 v[58:59], v5 offset:46080
    s_waitcnt lgkmcnt(10)
    v_mfma_f32_16x16x32_bf16 v[128:131], v[32:35], v[176:179], v[128:131]
    ds_read_b64_tr_b16 v[60:61], v6 offset:45056
    v_mfma_f32_16x16x32_bf16 v[132:135], v[32:35], v[180:183], v[132:135]
    ds_read_b64_tr_b16 v[62:63], v6 offset:46080
    v_mfma_f32_16x16x32_bf16 v[136:139], v[36:39], v[176:179], v[136:139]
    ds_read_b64_tr_b16 v[32:33], v3 offset:49152
    v_mfma_f32_16x16x32_bf16 v[140:143], v[36:39], v[180:183], v[140:143]
    ds_read_b64_tr_b16 v[34:35], v3 offset:50176
    s_waitcnt lgkmcnt(10)
    v_mfma_f32_16x16x32_bf16 v[144:147], v[40:43], v[176:179], v[144:147]
    ds_read_b64_tr_b16 v[36:37], v4 offset:49152
    v_mfma_f32_16x16x32_bf16 v[148:151], v[40:43], v[180:183], v[148:151]
    ds_read_b64_tr_b16 v[38:39], v4 offset:50176
    v_mfma_f32_16x16x32_bf16 v[152:155], v[44:47], v[176:179], v[152:155]
    ds_read_b64_tr_b16 v[40:41], v5 offset:49152
    v_mfma_f32_16x16x32_bf16 v[156:159], v[44:47], v[180:183], v[156:159]
    ds_read_b64_tr_b16 v[42:43], v5 offset:50176
    s_waitcnt lgkmcnt(10)
    v_mfma_f32_16x16x32_bf16 v[128:131], v[48:51], v[184:187], v[128:131]
    ds_read_b64_tr_b16 v[44:45], v6 offset:49152
    s_waitcnt vmcnt(0)
    s_atomic_add s40, s[22:23], s46
    s_mov_b32 s55, s52
    s_add_u32 s56, s52, 4194304
    ds_read_b32 v8, v9 offset:4096
    v_mfma_f32_16x16x32_bf16 v[132:135], v[48:51], v[188:191], v[132:135]
    ds_read_b64_tr_b16 v[46:47], v6 offset:50176
    buffer_load_dwordx4 v[64:67], v1, s[4:7], s55 offen offset:0 sc1
    ds_read_b32 v10, v9 offset:4608
    v_mfma_f32_16x16x32_bf16 v[136:139], v[52:55], v[184:187], v[136:139]
    ds_read_b64_tr_b16 v[48:49], v3 offset:53248
    buffer_load_dwordx4 v[68:71], v1, s[4:7], s55 offen offset:1024 sc1
    ds_read_b32 v12, v9 offset:4160
    v_mfma_f32_16x16x32_bf16 v[140:143], v[52:55], v[188:191], v[140:143]
    ds_read_b64_tr_b16 v[50:51], v3 offset:54272
    buffer_load_dwordx4 v[72:75], v1, s[4:7], s56 offen offset:0 sc1
    ds_read_b32 v14, v9 offset:4672
    s_waitcnt lgkmcnt(14)
    v_mfma_f32_16x16x32_bf16 v[144:147], v[56:59], v[184:187], v[144:147]
    ds_read_b64_tr_b16 v[52:53], v4 offset:53248
    buffer_load_dwordx4 v[76:79], v1, s[4:7], s56 offen offset:1024 sc1
    ds_read_b128 v[16:19], v11 offset:0
    v_mfma_f32_16x16x32_bf16 v[148:151], v[56:59], v[188:191], v[148:151]
    ds_read_b64_tr_b16 v[54:55], v4 offset:54272
    ds_read_b128 v[20:23], v11 offset:64
    v_mfma_f32_16x16x32_bf16 v[152:155], v[60:63], v[184:187], v[152:155]
    ds_read_b64_tr_b16 v[56:57], v5 offset:53248
    ds_read_b128 v[24:27], v11 offset:128
    v_mfma_f32_16x16x32_bf16 v[156:159], v[60:63], v[188:191], v[156:159]
    ds_read_b64_tr_b16 v[58:59], v5 offset:54272
    ds_read_b128 v[28:31], v11 offset:192
    s_waitcnt lgkmcnt(15)
    v_mfma_f32_16x16x32_bf16 v[128:131], v[32:35], v[192:195], v[128:131]
    ds_read_b64_tr_b16 v[60:61], v6 offset:53248
    v_mfma_f32_16x16x32_bf16 v[132:135], v[32:35], v[196:199], v[132:135]
    ds_read_b64_tr_b16 v[62:63], v6 offset:54272
    v_mfma_f32_16x16x32_bf16 v[136:139], v[36:39], v[192:195], v[136:139]
    ds_read_b64_tr_b16 v[32:33], v3 offset:57344
    v_mfma_f32_16x16x32_bf16 v[140:143], v[36:39], v[196:199], v[140:143]
    ds_read_b64_tr_b16 v[34:35], v3 offset:58368
    s_waitcnt lgkmcnt(15)
    v_mfma_f32_16x16x32_bf16 v[144:147], v[40:43], v[192:195], v[144:147]
    ds_read_b64_tr_b16 v[36:37], v4 offset:57344
    v_mfma_f32_16x16x32_bf16 v[148:151], v[40:43], v[196:199], v[148:151]
    ds_read_b64_tr_b16 v[38:39], v4 offset:58368
    v_mfma_f32_16x16x32_bf16 v[152:155], v[44:47], v[192:195], v[152:155]
    ds_read_b64_tr_b16 v[40:41], v5 offset:57344
    v_mfma_f32_16x16x32_bf16 v[156:159], v[44:47], v[196:199], v[156:159]
    ds_read_b64_tr_b16 v[42:43], v5 offset:58368
    s_waitcnt lgkmcnt(13)
    v_mfma_f32_16x16x32_bf16 v[128:131], v[48:51], v[200:203], v[128:131]
    ds_read_b64_tr_b16 v[44:45], v6 offset:57344
    s_waitcnt lgkmcnt(9)
    v_mfma_f32_16x16x32_bf16 v[132:135], v[48:51], v[204:207], v[132:135]
    ds_read_b64_tr_b16 v[46:47], v6 offset:58368
    v_mul_f32 v10, 0x3e8293ee, v10
    v_mfma_f32_16x16x32_bf16 v[136:139], v[52:55], v[200:203], v[136:139]
    ds_read_b64_tr_b16 v[48:49], v3 offset:61440
    v_mul_f32 v14, 0x3e8293ee, v14
    v_mfma_f32_16x16x32_bf16 v[140:143], v[52:55], v[204:207], v[140:143]
    ds_read_b64_tr_b16 v[50:51], v3 offset:62464
    s_lshl_b32 s44, s16, 11
    s_waitcnt lgkmcnt(10)
    v_mfma_f32_16x16x32_bf16 v[144:147], v[56:59], v[200:203], v[144:147]
    ds_read_b64_tr_b16 v[52:53], v4 offset:61440
    s_add_u32 s44, s44, 131072
    v_mfma_f32_16x16x32_bf16 v[148:151], v[56:59], v[204:207], v[148:151]
    ds_read_b64_tr_b16 v[54:55], v4 offset:62464
    v_add_u32 v13, s44, v2
    v_mfma_f32_16x16x32_bf16 v[152:155], v[60:63], v[200:203], v[152:155]
    ds_read_b64_tr_b16 v[56:57], v5 offset:61440
    v_mfma_f32_16x16x32_bf16 v[156:159], v[60:63], v[204:207], v[156:159]
    ds_read_b64_tr_b16 v[58:59], v5 offset:62464
    s_waitcnt lgkmcnt(10)
    v_mfma_f32_16x16x32_bf16 v[128:131], v[32:35], v[208:211], v[128:131]
    ds_read_b64_tr_b16 v[60:61], v6 offset:61440
    v_mfma_f32_16x16x32_bf16 v[132:135], v[32:35], v[212:215], v[132:135]
    ds_read_b64_tr_b16 v[62:63], v6 offset:62464
    v_xor_b32 v3, 0x10000, v3
    v_xor_b32 v4, 0x10000, v4
    v_xor_b32 v5, 0x10000, v5
    v_xor_b32 v6, 0x10000, v6
    v_mfma_f32_16x16x32_bf16 v[136:139], v[36:39], v[208:211], v[136:139]
    v_mfma_f32_16x16x32_bf16 v[140:143], v[36:39], v[212:215], v[140:143]
    s_waitcnt lgkmcnt(8)
    v_mfma_f32_16x16x32_bf16 v[144:147], v[40:43], v[208:211], v[144:147]
    v_mfma_f32_16x16x32_bf16 v[148:151], v[40:43], v[212:215], v[148:151]
    v_mfma_f32_16x16x32_bf16 v[152:155], v[44:47], v[208:211], v[152:155]
    v_mfma_f32_16x16x32_bf16 v[156:159], v[44:47], v[212:215], v[156:159]
    s_waitcnt lgkmcnt(4)
    v_mfma_f32_16x16x32_bf16 v[128:131], v[48:51], v[216:219], v[128:131]
    v_mfma_f32_16x16x32_bf16 v[132:135], v[48:51], v[220:223], v[132:135]
    v_mfma_f32_16x16x32_bf16 v[136:139], v[52:55], v[216:219], v[136:139]
    v_mfma_f32_16x16x32_bf16 v[140:143], v[52:55], v[220:223], v[140:143]
    s_waitcnt lgkmcnt(0)
    v_mfma_f32_16x16x32_bf16 v[144:147], v[56:59], v[216:219], v[144:147]
    v_mfma_f32_16x16x32_bf16 v[148:151], v[56:59], v[220:223], v[148:151]
    v_mfma_f32_16x16x32_bf16 v[152:155], v[60:63], v[216:219], v[152:155]
    v_mfma_f32_16x16x32_bf16 v[156:159], v[60:63], v[220:223], v[156:159]
    v_pk_fma_f32 v[128:129], v[8:9], v[16:17], v[128:129] op_sel_hi:[0,1,1] neg_lo:[1,0,0] neg_hi:[1,0,0]
    v_pk_fma_f32 v[130:131], v[8:9], v[18:19], v[130:131] op_sel_hi:[0,1,1] neg_lo:[1,0,0] neg_hi:[1,0,0]
    v_pk_mul_f32 v[128:129], v[10:11], v[128:129] op_sel_hi:[0,1]
    v_pk_mul_f32 v[130:131], v[10:11], v[130:131] op_sel_hi:[0,1]
    v_pk_fma_f32 v[136:137], v[8:9], v[20:21], v[136:137] op_sel_hi:[0,1,1] neg_lo:[1,0,0] neg_hi:[1,0,0]
    v_pk_fma_f32 v[138:139], v[8:9], v[22:23], v[138:139] op_sel_hi:[0,1,1] neg_lo:[1,0,0] neg_hi:[1,0,0]
    v_pk_mul_f32 v[136:137], v[10:11], v[136:137] op_sel_hi:[0,1]
    v_pk_mul_f32 v[138:139], v[10:11], v[138:139] op_sel_hi:[0,1]
    v_cvt_pk_bf16_f32 v128, v128, v129
    v_cvt_pk_bf16_f32 v129, v130, v131
    v_cvt_pk_bf16_f32 v130, v136, v137
    v_cvt_pk_bf16_f32 v131, v138, v139
    ds_write_b128 v13, v[128:131] offset:0
    v_pk_fma_f32 v[132:133], v[12:13], v[16:17], v[132:133] op_sel_hi:[0,1,1] neg_lo:[1,0,0] neg_hi:[1,0,0]
    v_pk_fma_f32 v[134:135], v[12:13], v[18:19], v[134:135] op_sel_hi:[0,1,1] neg_lo:[1,0,0] neg_hi:[1,0,0]
    v_pk_mul_f32 v[132:133], v[14:15], v[132:133] op_sel_hi:[0,1]
    v_pk_mul_f32 v[134:135], v[14:15], v[134:135] op_sel_hi:[0,1]
    v_pk_fma_f32 v[140:141], v[12:13], v[20:21], v[140:141] op_sel_hi:[0,1,1] neg_lo:[1,0,0] neg_hi:[1,0,0]
    v_pk_fma_f32 v[142:143], v[12:13], v[22:23], v[142:143] op_sel_hi:[0,1,1] neg_lo:[1,0,0] neg_hi:[1,0,0]
    v_pk_mul_f32 v[140:141], v[14:15], v[140:141] op_sel_hi:[0,1]
    v_pk_mul_f32 v[142:143], v[14:15], v[142:143] op_sel_hi:[0,1]
    v_cvt_pk_bf16_f32 v132, v132, v133
    v_cvt_pk_bf16_f32 v133, v134, v135
    v_cvt_pk_bf16_f32 v134, v140, v141
    v_cvt_pk_bf16_f32 v135, v142, v143
    ds_write_b128 v13, v[132:135] offset:256
    v_pk_fma_f32 v[144:145], v[8:9], v[24:25], v[144:145] op_sel_hi:[0,1,1] neg_lo:[1,0,0] neg_hi:[1,0,0]
    v_pk_fma_f32 v[146:147], v[8:9], v[26:27], v[146:147] op_sel_hi:[0,1,1] neg_lo:[1,0,0] neg_hi:[1,0,0]
    v_pk_mul_f32 v[144:145], v[10:11], v[144:145] op_sel_hi:[0,1]
    v_pk_mul_f32 v[146:147], v[10:11], v[146:147] op_sel_hi:[0,1]
    v_pk_fma_f32 v[152:153], v[8:9], v[28:29], v[152:153] op_sel_hi:[0,1,1] neg_lo:[1,0,0] neg_hi:[1,0,0]
    v_pk_fma_f32 v[154:155], v[8:9], v[30:31], v[154:155] op_sel_hi:[0,1,1] neg_lo:[1,0,0] neg_hi:[1,0,0]
    v_pk_mul_f32 v[152:153], v[10:11], v[152:153] op_sel_hi:[0,1]
    v_pk_mul_f32 v[154:155], v[10:11], v[154:155] op_sel_hi:[0,1]
    v_cvt_pk_bf16_f32 v144, v144, v145
    v_cvt_pk_bf16_f32 v145, v146, v147
    v_cvt_pk_bf16_f32 v146, v152, v153
    v_cvt_pk_bf16_f32 v147, v154, v155
    ds_write_b128 v13, v[144:147] offset:8192
    v_pk_fma_f32 v[148:149], v[12:13], v[24:25], v[148:149] op_sel_hi:[0,1,1] neg_lo:[1,0,0] neg_hi:[1,0,0]
    v_pk_fma_f32 v[150:151], v[12:13], v[26:27], v[150:151] op_sel_hi:[0,1,1] neg_lo:[1,0,0] neg_hi:[1,0,0]
    v_pk_mul_f32 v[148:149], v[14:15], v[148:149] op_sel_hi:[0,1]
    v_pk_mul_f32 v[150:151], v[14:15], v[150:151] op_sel_hi:[0,1]
    v_pk_fma_f32 v[156:157], v[12:13], v[28:29], v[156:157] op_sel_hi:[0,1,1] neg_lo:[1,0,0] neg_hi:[1,0,0]
    v_pk_fma_f32 v[158:159], v[12:13], v[30:31], v[158:159] op_sel_hi:[0,1,1] neg_lo:[1,0,0] neg_hi:[1,0,0]
    v_pk_mul_f32 v[156:157], v[14:15], v[156:157] op_sel_hi:[0,1]
    v_pk_mul_f32 v[158:159], v[14:15], v[158:159] op_sel_hi:[0,1]
    v_cvt_pk_bf16_f32 v148, v148, v149
    v_cvt_pk_bf16_f32 v149, v150, v151
    v_cvt_pk_bf16_f32 v150, v156, v157
    v_cvt_pk_bf16_f32 v151, v158, v159
    ds_write_b128 v13, v[148:151] offset:8448
    v_add_u32 v4, 131072, v1
    s_lshl_b32 s44, s16, 12
    s_add_u32 s44, s44, 65536
    v_add_u32 v5, s44, v1
    s_lshl_b32 s44, s16, 8
    s_add_u32 s44, s44, 147456
    v_lshrrev_b32 v6, 2, v1
    v_add_u32 v6, s44, v6
    v_mov_b32 v8, 156672
    v_mov_b32 v9, 0xdddddddd
    v_bfe_u32 v10, v1, 4, 3
    v_mov_b32 v11, 0x3f803f80
    v_cmp_eq_u32 vcc, 0, v10
    s_nop 1
    v_cndmask_b32 v28, 0, v11, vcc
    v_cndmask_b32 v29, 0, v11, vcc
    v_cmp_eq_u32 vcc, 4, v10
    s_nop 1
    v_cndmask_b32 v30, 0, v11, vcc
    v_cndmask_b32 v31, 0, v11, vcc
    v_mov_b32 v10, 0
    v_mov_b32 v11, 0
    v_mov_b32 v13, 0
    v_mov_b32 v14, 0
    v_mov_b32 v15, 0
    v_mov_b32 v17, 0
    v_mov_b32 v18, 0
    v_mov_b32 v19, 0
    v_mov_b32 v21, 0
    v_mov_b32 v22, 0
    v_mov_b32 v23, 0
    v_mov_b32 v25, 0
    v_mov_b32 v26, 0
    v_mov_b32 v27, 0
    v_mfma_f32_32x32x8_bf16 v[160:175], v[10:11], v[10:11], 0
    v_mov_b32 v20, 0
    v_mfma_f32_32x32x8_bf16 v[176:191], v[10:11], v[10:11], 0
    v_mov_b32 v24, 0
    s_waitcnt lgkmcnt(0)
    v_mfma_f32_32x32x8_bf16 v[128:143], v[10:11], v[10:11], 0
    v_mov_b32 v12, 0
    v_mfma_f32_32x32x8_bf16 v[144:159], v[10:11], v[10:11], 0
    v_mov_b32 v16, 0
    s_barrier
    ds_read_b128 v[32:35], v4 offset:0
    ds_read_b128 v[36:39], v4 offset:1024
    ds_read_b128 v[40:43], v4 offset:2048
    ds_read_b128 v[44:47], v4 offset:3072
    s_add_u32 s54, s54, 8192
    s_and_b32 s54, s54, 0x1ffff
    s_add_u32 s55, s53, s54
    s_add_u32 s56, s55, 4194304
    buffer_load_dwordx4 v[80:83], v1, s[4:7], s55 offen offset:0 sc1
    buffer_load_dwordx4 v[84:87], v1, s[4:7], s55 offen offset:1024 sc1
    buffer_load_dwordx4 v[88:91], v1, s[4:7], s56 offen offset:0 sc1
    buffer_load_dwordx4 v[92:95], v1, s[4:7], s56 offen offset:1024 sc1
    s_add_u32 s54, s54, 8192
    s_and_b32 s54, s54, 0x1ffff
    s_add_u32 s55, s53, s54
    s_add_u32 s56, s55, 4194304
    buffer_load_dwordx4 v[96:99], v1, s[4:7], s55 offen offset:0 sc1
    buffer_load_dwordx4 v[100:103], v1, s[4:7], s55 offen offset:1024 sc1
    buffer_load_dwordx4 v[104:107], v1, s[4:7], s56 offen offset:0 sc1
    buffer_load_dwordx4 v[108:111], v1, s[4:7], s56 offen offset:1024 sc1
    ds_read_b128 v[48:51], v4 offset:4096
    ds_read_b128 v[52:55], v4 offset:5120
    ds_read_b128 v[56:59], v4 offset:6144
    ds_read_b128 v[60:63], v4 offset:7168
    s_mov_b32 s57, 0
    s_waitcnt vmcnt(8) lgkmcnt(6)
    v_mfma_f32_32x32x16_bf16 v[192:207], v[64:67], v[32:35], 0
    v_mfma_f32_32x32x16_bf16 v[192:207], v[68:71], v[36:39], v[192:207]
    s_waitcnt lgkmcnt(4)
    v_mfma_f32_32x32x16_bf16 v[208:223], v[64:67], v[40:43], 0
    s_add_u32 s54, s54, 8192
    s_and_b32 s54, s54, 0x1ffff
    s_add_u32 s55, s53, s54
    s_add_u32 s56, s55, 4194304
    buffer_load_dwordx4 v[112:115], v1, s[4:7], s55 offen offset:0 sc1
    s_nop 4
    v_exp_f32 v192, v192
    v_exp_f32 v193, v193
    v_exp_f32 v194, v194
    v_exp_f32 v195, v195
    v_exp_f32 v196, v196
    v_exp_f32 v197, v197
    v_mfma_f32_32x32x16_bf16 v[208:223], v[68:71], v[44:47], v[208:223]
    v_exp_f32 v198, v198
    v_exp_f32 v199, v199
    v_exp_f32 v200, v200
    v_exp_f32 v201, v201
    v_exp_f32 v202, v202
    v_exp_f32 v203, v203
    v_exp_f32 v204, v204
    v_exp_f32 v205, v205
    v_exp_f32 v206, v206
    v_exp_f32 v207, v207
    s_waitcnt lgkmcnt(0)
    v_mfma_f32_32x32x16_bf16 v[224:239], v[64:67], v[48:51], 0
    buffer_load_dwordx4 v[116:119], v1, s[4:7], s55 offen offset:1024 sc1
    v_exp_f32 v208, v208
    v_exp_f32 v209, v209
    v_exp_f32 v210, v210
    v_smfmac_f32_32x32x32_bf16 v[128:143], v[72:75], v[192:199], v9
    v_exp_f32 v211, v211
    v_exp_f32 v212, v212
    v_exp_f32 v213, v213
    v_mfma_f32_32x32x16_bf16 v[224:239], v[68:71], v[52:55], v[224:239]
    v_exp_f32 v214, v214
    v_exp_f32 v215, v215
    v_exp_f32 v216, v216
    v_smfmac_f32_16x16x64_bf16 v[12:15], v[28:31], v[192:199], v9
    v_exp_f32 v217, v217
    v_smfmac_f32_32x32x32_bf16 v[128:143], v[76:79], v[200:207], v9
    v_exp_f32 v218, v218
    v_exp_f32 v219, v219
    v_exp_f32 v220, v220
    v_smfmac_f32_16x16x64_bf16 v[12:15], v[28:31], v[200:207], v9
    v_exp_f32 v221, v221
    v_exp_f32 v222, v222
    v_exp_f32 v223, v223
b_head:
    s_mov_b32 s58, 3
b_loop:
    v_mfma_f32_32x32x16_bf16 v[240:255], v[64:67], v[56:59], 0
    buffer_load_dwordx4 v[120:123], v1, s[4:7], s56 offen offset:0 sc1
    v_exp_f32 v224, v224
    v_exp_f32 v225, v225
    v_exp_f32 v226, v226
    v_smfmac_f32_32x32x32_bf16 v[144:159], v[72:75], v[208:215], v9
    v_exp_f32 v227, v227
    v_exp_f32 v228, v228
    v_exp_f32 v229, v229
    v_mfma_f32_32x32x16_bf16 v[240:255], v[68:71], v[60:63], v[240:255]
    v_exp_f32 v230, v230
    v_exp_f32 v231, v231
    v_exp_f32 v232, v232
    v_smfmac_f32_16x16x64_bf16 v[16:19], v[28:31], v[208:215], v9
    v_exp_f32 v233, v233
    v_smfmac_f32_32x32x32_bf16 v[144:159], v[76:79], v[216:223], v9
    v_exp_f32 v234, v234
    v_exp_f32 v235, v235
    v_exp_f32 v236, v236
    v_smfmac_f32_16x16x64_bf16 v[16:19], v[28:31], v[216:223], v9
    v_exp_f32 v237, v237
    v_exp_f32 v238, v238
    v_exp_f32 v239, v239
    s_waitcnt vmcnt(7)
    v_mfma_f32_32x32x16_bf16 v[192:207], v[80:83], v[32:35], 0
    buffer_load_dwordx4 v[124:127], v1, s[4:7], s56 offen offset:1024 sc1
    v_exp_f32 v240, v240
    v_exp_f32 v241, v241
    v_exp_f32 v242, v242
    v_smfmac_f32_32x32x32_bf16 v[160:175], v[72:75], v[224:231], v9
    v_exp_f32 v243, v243
    v_exp_f32 v244, v244
    v_exp_f32 v245, v245
    v_mfma_f32_32x32x16_bf16 v[192:207], v[84:87], v[36:39], v[192:207]
    v_exp_f32 v246, v246
    v_exp_f32 v247, v247
    v_exp_f32 v248, v248
    v_smfmac_f32_16x16x64_bf16 v[20:23], v[28:31], v[224:231], v9
    v_exp_f32 v249, v249
    v_smfmac_f32_32x32x32_bf16 v[160:175], v[76:79], v[232:239], v9
    v_exp_f32 v250, v250
    v_exp_f32 v251, v251
    v_exp_f32 v252, v252
    v_smfmac_f32_16x16x64_bf16 v[20:23], v[28:31], v[232:239], v9
    v_exp_f32 v253, v253
    v_exp_f32 v254, v254
    v_exp_f32 v255, v255
    v_mfma_f32_32x32x16_bf16 v[208:223], v[80:83], v[40:43], 0
    s_add_u32 s54, s54, 8192
    s_and_b32 s54, s54, 0x1ffff
    s_add_u32 s55, s53, s54
    s_add_u32 s56, s55, 4194304
    buffer_load_dwordx4 v[64:67], v1, s[4:7], s55 offen offset:0 sc1
    v_exp_f32 v192, v192
    v_exp_f32 v193, v193
    v_exp_f32 v194, v194
    v_smfmac_f32_32x32x32_bf16 v[176:191], v[72:75], v[240:247], v9
    v_exp_f32 v195, v195
    v_exp_f32 v196, v196
    v_exp_f32 v197, v197
    v_mfma_f32_32x32x16_bf16 v[208:223], v[84:87], v[44:47], v[208:223]
    v_exp_f32 v198, v198
    v_exp_f32 v199, v199
    v_exp_f32 v200, v200
    v_smfmac_f32_16x16x64_bf16 v[24:27], v[28:31], v[240:247], v9
    v_exp_f32 v201, v201
    v_smfmac_f32_32x32x32_bf16 v[176:191], v[76:79], v[248:255], v9
    v_exp_f32 v202, v202
    v_exp_f32 v203, v203
    v_exp_f32 v204, v204
    v_smfmac_f32_16x16x64_bf16 v[24:27], v[28:31], v[248:255], v9
    v_exp_f32 v205, v205
    v_exp_f32 v206, v206
    v_exp_f32 v207, v207
    v_mfma_f32_32x32x16_bf16 v[224:239], v[80:83], v[48:51], 0
    buffer_load_dwordx4 v[68:71], v1, s[4:7], s55 offen offset:1024 sc1
    v_exp_f32 v208, v208
    v_exp_f32 v209, v209
    v_exp_f32 v210, v210
    v_smfmac_f32_32x32x32_bf16 v[128:143], v[88:91], v[192:199], v9
    v_exp_f32 v211, v211
    v_exp_f32 v212, v212
    v_exp_f32 v213, v213
    v_mfma_f32_32x32x16_bf16 v[224:239], v[84:87], v[52:55], v[224:239]
    v_exp_f32 v214, v214
    v_exp_f32 v215, v215
    v_exp_f32 v216, v216
    v_smfmac_f32_16x16x64_bf16 v[12:15], v[28:31], v[192:199], v9
    v_exp_f32 v217, v217
    v_smfmac_f32_32x32x32_bf16 v[128:143], v[92:95], v[200:207], v9
    v_exp_f32 v218, v218
    v_exp_f32 v219, v219
    v_exp_f32 v220, v220
    v_smfmac_f32_16x16x64_bf16 v[12:15], v[28:31], v[200:207], v9
    v_exp_f32 v221, v221
    v_exp_f32 v222, v222
    v_exp_f32 v223, v223
    v_mfma_f32_32x32x16_bf16 v[240:255], v[80:83], v[56:59], 0
    buffer_load_dwordx4 v[72:75], v1, s[4:7], s56 offen offset:0 sc1
    v_exp_f32 v224, v224
    v_exp_f32 v225, v225
    v_exp_f32 v226, v226
    v_smfmac_f32_32x32x32_bf16 v[144:159], v[88:91], v[208:215], v9
    v_exp_f32 v227, v227
    v_exp_f32 v228, v228
    v_exp_f32 v229, v229
    v_mfma_f32_32x32x16_bf16 v[240:255], v[84:87], v[60:63], v[240:255]
    v_exp_f32 v230, v230
    v_exp_f32 v231, v231
    v_exp_f32 v232, v232
    v_smfmac_f32_16x16x64_bf16 v[16:19], v[28:31], v[208:215], v9
    v_exp_f32 v233, v233
    v_smfmac_f32_32x32x32_bf16 v[144:159], v[92:95], v[216:223], v9
    v_exp_f32 v234, v234
    v_exp_f32 v235, v235
    v_exp_f32 v236, v236
    v_smfmac_f32_16x16x64_bf16 v[16:19], v[28:31], v[216:223], v9
    v_exp_f32 v237, v237
    v_exp_f32 v238, v238
    v_exp_f32 v239, v239
    s_waitcnt vmcnt(7)
    v_mfma_f32_32x32x16_bf16 v[192:207], v[96:99], v[32:35], 0
    buffer_load_dwordx4 v[76:79], v1, s[4:7], s56 offen offset:1024 sc1
    v_exp_f32 v240, v240
    v_exp_f32 v241, v241
    v_exp_f32 v242, v242
    v_smfmac_f32_32x32x32_bf16 v[160:175], v[88:91], v[224:231], v9
    v_exp_f32 v243, v243
    v_exp_f32 v244, v244
    v_exp_f32 v245, v245
    v_mfma_f32_32x32x16_bf16 v[192:207], v[100:103], v[36:39], v[192:207]
    v_exp_f32 v246, v246
    v_exp_f32 v247, v247
    v_exp_f32 v248, v248
    v_smfmac_f32_16x16x64_bf16 v[20:23], v[28:31], v[224:231], v9
    v_exp_f32 v249, v249
    v_smfmac_f32_32x32x32_bf16 v[160:175], v[92:95], v[232:239], v9
    v_exp_f32 v250, v250
    v_exp_f32 v251, v251
    v_exp_f32 v252, v252
    v_smfmac_f32_16x16x64_bf16 v[20:23], v[28:31], v[232:239], v9
    v_exp_f32 v253, v253
    v_exp_f32 v254, v254
    v_exp_f32 v255, v255
    v_mfma_f32_32x32x16_bf16 v[208:223], v[96:99], v[40:43], 0
    s_add_u32 s54, s54, 8192
    s_and_b32 s54, s54, 0x1ffff
    s_add_u32 s55, s53, s54
    s_add_u32 s56, s55, 4194304
    buffer_load_dwordx4 v[80:83], v1, s[4:7], s55 offen offset:0 sc1
    v_exp_f32 v192, v192
    v_exp_f32 v193, v193
    v_exp_f32 v194, v194
    v_smfmac_f32_32x32x32_bf16 v[176:191], v[88:91], v[240:247], v9
    v_exp_f32 v195, v195
    v_exp_f32 v196, v196
    v_exp_f32 v197, v197
    v_mfma_f32_32x32x16_bf16 v[208:223], v[100:103], v[44:47], v[208:223]
    v_exp_f32 v198, v198
    v_exp_f32 v199, v199
    v_exp_f32 v200, v200
    v_smfmac_f32_16x16x64_bf16 v[24:27], v[28:31], v[240:247], v9
    v_exp_f32 v201, v201
    v_smfmac_f32_32x32x32_bf16 v[176:191], v[92:95], v[248:255], v9
    v_exp_f32 v202, v202
    v_exp_f32 v203, v203
    v_exp_f32 v204, v204
    v_smfmac_f32_16x16x64_bf16 v[24:27], v[28:31], v[248:255], v9
    v_exp_f32 v205, v205
    v_exp_f32 v206, v206
    v_exp_f32 v207, v207
    v_mfma_f32_32x32x16_bf16 v[224:239], v[96:99], v[48:51], 0
    buffer_load_dwordx4 v[84:87], v1, s[4:7], s55 offen offset:1024 sc1
    v_exp_f32 v208, v208
    v_exp_f32 v209, v209
    v_exp_f32 v210, v210
    v_smfmac_f32_32x32x32_bf16 v[128:143], v[104:107], v[192:199], v9
    v_exp_f32 v211, v211
    v_exp_f32 v212, v212
    v_exp_f32 v213, v213
    v_mfma_f32_32x32x16_bf16 v[224:239], v[100:103], v[52:55], v[224:239]
    v_exp_f32 v214, v214
    v_exp_f32 v215, v215
    v_exp_f32 v216, v216
    v_smfmac_f32_16x16x64_bf16 v[12:15], v[28:31], v[192:199], v9
    v_exp_f32 v217, v217
    v_smfmac_f32_32x32x32_bf16 v[128:143], v[108:111], v[200:207], v9
    v_exp_f32 v218, v218
    v_exp_f32 v219, v219
    v_exp_f32 v220, v220
    v_smfmac_f32_16x16x64_bf16 v[12:15], v[28:31], v[200:207], v9
    v_exp_f32 v221, v221
    v_exp_f32 v222, v222
    v_exp_f32 v223, v223
    v_mfma_f32_32x32x16_bf16 v[240:255], v[96:99], v[56:59], 0
    buffer_load_dwordx4 v[88:91], v1, s[4:7], s56 offen offset:0 sc1
    v_exp_f32 v224, v224
    v_exp_f32 v225, v225
    v_exp_f32 v226, v226
    v_smfmac_f32_32x32x32_bf16 v[144:159], v[104:107], v[208:215], v9
    v_exp_f32 v227, v227
    v_exp_f32 v228, v228
    v_exp_f32 v229, v229
    v_mfma_f32_32x32x16_bf16 v[240:255], v[100:103], v[60:63], v[240:255]
    v_exp_f32 v230, v230
    v_exp_f32 v231, v231
    v_exp_f32 v232, v232
    v_smfmac_f32_16x16x64_bf16 v[16:19], v[28:31], v[208:215], v9
    v_exp_f32 v233, v233
    v_smfmac_f32_32x32x32_bf16 v[144:159], v[108:111], v[216:223], v9
    v_exp_f32 v234, v234
    v_exp_f32 v235, v235
    v_exp_f32 v236, v236
    v_smfmac_f32_16x16x64_bf16 v[16:19], v[28:31], v[216:223], v9
    v_exp_f32 v237, v237
    v_exp_f32 v238, v238
    v_exp_f32 v239, v239
    s_waitcnt vmcnt(7)
    v_mfma_f32_32x32x16_bf16 v[192:207], v[112:115], v[32:35], 0
    buffer_load_dwordx4 v[92:95], v1, s[4:7], s56 offen offset:1024 sc1
    v_exp_f32 v240, v240
    v_exp_f32 v241, v241
    v_exp_f32 v242, v242
    v_smfmac_f32_32x32x32_bf16 v[160:175], v[104:107], v[224:231], v9
    v_exp_f32 v243, v243
    v_exp_f32 v244, v244
    v_exp_f32 v245, v245
    v_mfma_f32_32x32x16_bf16 v[192:207], v[116:119], v[36:39], v[192:207]
    v_exp_f32 v246, v246
    v_exp_f32 v247, v247
    v_exp_f32 v248, v248
    v_smfmac_f32_16x16x64_bf16 v[20:23], v[28:31], v[224:231], v9
    v_exp_f32 v249, v249
    v_smfmac_f32_32x32x32_bf16 v[160:175], v[108:111], v[232:239], v9
    v_exp_f32 v250, v250
    v_exp_f32 v251, v251
    v_exp_f32 v252, v252
    v_smfmac_f32_16x16x64_bf16 v[20:23], v[28:31], v[232:239], v9
    v_exp_f32 v253, v253
    v_exp_f32 v254, v254
    v_exp_f32 v255, v255
    v_mfma_f32_32x32x16_bf16 v[208:223], v[112:115], v[40:43], 0
    s_add_u32 s54, s54, 8192
    s_and_b32 s54, s54, 0x1ffff
    s_add_u32 s55, s53, s54
    s_add_u32 s56, s55, 4194304
    buffer_load_dwordx4 v[96:99], v1, s[4:7], s55 offen offset:0 sc1
    v_exp_f32 v192, v192
    v_exp_f32 v193, v193
    v_exp_f32 v194, v194
    v_smfmac_f32_32x32x32_bf16 v[176:191], v[104:107], v[240:247], v9
    v_exp_f32 v195, v195
    v_exp_f32 v196, v196
    v_exp_f32 v197, v197
    v_mfma_f32_32x32x16_bf16 v[208:223], v[116:119], v[44:47], v[208:223]
    v_exp_f32 v198, v198
    v_exp_f32 v199, v199
    v_exp_f32 v200, v200
    v_smfmac_f32_16x16x64_bf16 v[24:27], v[28:31], v[240:247], v9
    v_exp_f32 v201, v201
    v_smfmac_f32_32x32x32_bf16 v[176:191], v[108:111], v[248:255], v9
    v_exp_f32 v202, v202
    v_exp_f32 v203, v203
    v_exp_f32 v204, v204
    v_smfmac_f32_16x16x64_bf16 v[24:27], v[28:31], v[248:255], v9
    v_exp_f32 v205, v205
    v_exp_f32 v206, v206
    v_exp_f32 v207, v207
    v_mfma_f32_32x32x16_bf16 v[224:239], v[112:115], v[48:51], 0
    buffer_load_dwordx4 v[100:103], v1, s[4:7], s55 offen offset:1024 sc1
    v_exp_f32 v208, v208
    v_exp_f32 v209, v209
    v_exp_f32 v210, v210
    v_smfmac_f32_32x32x32_bf16 v[128:143], v[120:123], v[192:199], v9
    v_exp_f32 v211, v211
    v_exp_f32 v212, v212
    v_exp_f32 v213, v213
    v_mfma_f32_32x32x16_bf16 v[224:239], v[116:119], v[52:55], v[224:239]
    v_exp_f32 v214, v214
    v_exp_f32 v215, v215
    v_exp_f32 v216, v216
    v_smfmac_f32_16x16x64_bf16 v[12:15], v[28:31], v[192:199], v9
    v_exp_f32 v217, v217
    v_smfmac_f32_32x32x32_bf16 v[128:143], v[124:127], v[200:207], v9
    v_exp_f32 v218, v218
    v_exp_f32 v219, v219
    v_exp_f32 v220, v220
    v_smfmac_f32_16x16x64_bf16 v[12:15], v[28:31], v[200:207], v9
    v_exp_f32 v221, v221
    v_exp_f32 v222, v222
    v_exp_f32 v223, v223
    v_mfma_f32_32x32x16_bf16 v[240:255], v[112:115], v[56:59], 0
    buffer_load_dwordx4 v[104:107], v1, s[4:7], s56 offen offset:0 sc1
    v_exp_f32 v224, v224
    v_exp_f32 v225, v225
    v_exp_f32 v226, v226
    v_smfmac_f32_32x32x32_bf16 v[144:159], v[120:123], v[208:215], v9
    v_exp_f32 v227, v227
    v_exp_f32 v228, v228
    v_exp_f32 v229, v229
    v_mfma_f32_32x32x16_bf16 v[240:255], v[116:119], v[60:63], v[240:255]
    v_exp_f32 v230, v230
    v_exp_f32 v231, v231
    v_exp_f32 v232, v232
    v_smfmac_f32_16x16x64_bf16 v[16:19], v[28:31], v[208:215], v9
    v_exp_f32 v233, v233
    v_smfmac_f32_32x32x32_bf16 v[144:159], v[124:127], v[216:223], v9
    v_exp_f32 v234, v234
    v_exp_f32 v235, v235
    v_exp_f32 v236, v236
    v_smfmac_f32_16x16x64_bf16 v[16:19], v[28:31], v[216:223], v9
    v_exp_f32 v237, v237
    v_exp_f32 v238, v238
    v_exp_f32 v239, v239
    s_waitcnt vmcnt(7)
    v_mfma_f32_32x32x16_bf16 v[192:207], v[64:67], v[32:35], 0
    buffer_load_dwordx4 v[108:111], v1, s[4:7], s56 offen offset:1024 sc1
    v_exp_f32 v240, v240
    v_exp_f32 v241, v241
    v_exp_f32 v242, v242
    v_smfmac_f32_32x32x32_bf16 v[160:175], v[120:123], v[224:231], v9
    v_exp_f32 v243, v243
    v_exp_f32 v244, v244
    v_exp_f32 v245, v245
    v_mfma_f32_32x32x16_bf16 v[192:207], v[68:71], v[36:39], v[192:207]
    v_exp_f32 v246, v246
    v_exp_f32 v247, v247
    v_exp_f32 v248, v248
    v_smfmac_f32_16x16x64_bf16 v[20:23], v[28:31], v[224:231], v9
    v_exp_f32 v249, v249
    v_smfmac_f32_32x32x32_bf16 v[160:175], v[124:127], v[232:239], v9
    v_exp_f32 v250, v250
    v_exp_f32 v251, v251
    v_exp_f32 v252, v252
    v_smfmac_f32_16x16x64_bf16 v[20:23], v[28:31], v[232:239], v9
    v_exp_f32 v253, v253
    v_exp_f32 v254, v254
    v_exp_f32 v255, v255
    v_mfma_f32_32x32x16_bf16 v[208:223], v[64:67], v[40:43], 0
    s_add_u32 s54, s54, 8192
    s_and_b32 s54, s54, 0x1ffff
    s_add_u32 s55, s53, s54
    s_add_u32 s56, s55, 4194304
    buffer_load_dwordx4 v[112:115], v1, s[4:7], s55 offen offset:0 sc1
    v_exp_f32 v192, v192
    v_exp_f32 v193, v193
    v_exp_f32 v194, v194
    v_smfmac_f32_32x32x32_bf16 v[176:191], v[120:123], v[240:247], v9
    v_exp_f32 v195, v195
    v_exp_f32 v196, v196
    v_exp_f32 v197, v197
    v_mfma_f32_32x32x16_bf16 v[208:223], v[68:71], v[44:47], v[208:223]
    v_exp_f32 v198, v198
    v_exp_f32 v199, v199
    v_exp_f32 v200, v200
    v_smfmac_f32_16x16x64_bf16 v[24:27], v[28:31], v[240:247], v9
    v_exp_f32 v201, v201
    v_smfmac_f32_32x32x32_bf16 v[176:191], v[124:127], v[248:255], v9
    v_exp_f32 v202, v202
    v_exp_f32 v203, v203
    v_exp_f32 v204, v204
    v_smfmac_f32_16x16x64_bf16 v[24:27], v[28:31], v[248:255], v9
    v_exp_f32 v205, v205
    v_exp_f32 v206, v206
    v_exp_f32 v207, v207
    v_mfma_f32_32x32x16_bf16 v[224:239], v[64:67], v[48:51], 0
    buffer_load_dwordx4 v[116:119], v1, s[4:7], s55 offen offset:1024 sc1
    v_exp_f32 v208, v208
    v_exp_f32 v209, v209
    v_exp_f32 v210, v210
    v_smfmac_f32_32x32x32_bf16 v[128:143], v[72:75], v[192:199], v9
    v_exp_f32 v211, v211
    v_exp_f32 v212, v212
    v_exp_f32 v213, v213
    v_mfma_f32_32x32x16_bf16 v[224:239], v[68:71], v[52:55], v[224:239]
    v_exp_f32 v214, v214
    v_exp_f32 v215, v215
    v_exp_f32 v216, v216
    v_smfmac_f32_16x16x64_bf16 v[12:15], v[28:31], v[192:199], v9
    v_exp_f32 v217, v217
    v_smfmac_f32_32x32x32_bf16 v[128:143], v[76:79], v[200:207], v9
    v_exp_f32 v218, v218
    v_exp_f32 v219, v219
    v_exp_f32 v220, v220
    v_smfmac_f32_16x16x64_bf16 v[12:15], v[28:31], v[200:207], v9
    v_exp_f32 v221, v221
    v_exp_f32 v222, v222
    v_exp_f32 v223, v223
    s_sub_u32 s58, s58, 1
    s_cmp_lg_u32 s58, 0
    s_cbranch_scc1 b_loop
    v_mfma_f32_32x32x16_bf16 v[240:255], v[64:67], v[56:59], 0
    buffer_load_dwordx4 v[120:123], v1, s[4:7], s56 offen offset:0 sc1
    v_exp_f32 v224, v224
    v_exp_f32 v225, v225
    v_exp_f32 v226, v226
    v_smfmac_f32_32x32x32_bf16 v[144:159], v[72:75], v[208:215], v9
    v_exp_f32 v227, v227
    v_exp_f32 v228, v228
    v_exp_f32 v229, v229
    v_mfma_f32_32x32x16_bf16 v[240:255], v[68:71], v[60:63], v[240:255]
    v_exp_f32 v230, v230
    v_exp_f32 v231, v231
    v_exp_f32 v232, v232
    v_smfmac_f32_16x16x64_bf16 v[16:19], v[28:31], v[208:215], v9
    v_exp_f32 v233, v233
    v_smfmac_f32_32x32x32_bf16 v[144:159], v[76:79], v[216:223], v9
    v_exp_f32 v234, v234
    v_exp_f32 v235, v235
    v_exp_f32 v236, v236
    v_smfmac_f32_16x16x64_bf16 v[16:19], v[28:31], v[216:223], v9
    v_exp_f32 v237, v237
    v_exp_f32 v238, v238
    v_exp_f32 v239, v239
    s_waitcnt vmcnt(7)
    v_mfma_f32_32x32x16_bf16 v[192:207], v[80:83], v[32:35], 0
    buffer_load_dwordx4 v[124:127], v1, s[4:7], s56 offen offset:1024 sc1
    v_exp_f32 v240, v240
    v_exp_f32 v241, v241
    v_exp_f32 v242, v242
    v_smfmac_f32_32x32x32_bf16 v[160:175], v[72:75], v[224:231], v9
    v_exp_f32 v243, v243
    v_exp_f32 v244, v244
    v_exp_f32 v245, v245
    v_mfma_f32_32x32x16_bf16 v[192:207], v[84:87], v[36:39], v[192:207]
    v_exp_f32 v246, v246
    v_exp_f32 v247, v247
    v_exp_f32 v248, v248
    v_smfmac_f32_16x16x64_bf16 v[20:23], v[28:31], v[224:231], v9
    v_exp_f32 v249, v249
    v_smfmac_f32_32x32x32_bf16 v[160:175], v[76:79], v[232:239], v9
    v_exp_f32 v250, v250
    v_exp_f32 v251, v251
    v_exp_f32 v252, v252
    v_smfmac_f32_16x16x64_bf16 v[20:23], v[28:31], v[232:239], v9
    v_exp_f32 v253, v253
    v_exp_f32 v254, v254
    v_exp_f32 v255, v255
    s_add_u32 s53, s53, 131072
    s_cmp_eq_u32 s57, 0
    s_cselect_b32 s53, s53, 2146435072
    v_mfma_f32_32x32x16_bf16 v[208:223], v[80:83], v[40:43], 0
    s_add_u32 s54, s54, 8192
    s_and_b32 s54, s54, 0x1ffff
    s_add_u32 s55, s53, s54
    s_add_u32 s56, s55, 4194304
    buffer_load_dwordx4 v[64:67], v1, s[4:7], s55 offen offset:0 sc1
    v_exp_f32 v192, v192
    v_exp_f32 v193, v193
    v_exp_f32 v194, v194
    v_smfmac_f32_32x32x32_bf16 v[176:191], v[72:75], v[240:247], v9
    v_exp_f32 v195, v195
    v_exp_f32 v196, v196
    v_exp_f32 v197, v197
    v_mfma_f32_32x32x16_bf16 v[208:223], v[84:87], v[44:47], v[208:223]
    v_exp_f32 v198, v198
    v_exp_f32 v199, v199
    v_exp_f32 v200, v200
    v_smfmac_f32_16x16x64_bf16 v[24:27], v[28:31], v[240:247], v9
    v_exp_f32 v201, v201
    v_smfmac_f32_32x32x32_bf16 v[176:191], v[76:79], v[248:255], v9
    v_exp_f32 v202, v202
    v_exp_f32 v203, v203
    v_exp_f32 v204, v204
    v_smfmac_f32_16x16x64_bf16 v[24:27], v[28:31], v[248:255], v9
    v_exp_f32 v205, v205
    v_exp_f32 v206, v206
    v_exp_f32 v207, v207
    v_mfma_f32_32x32x16_bf16 v[224:239], v[80:83], v[48:51], 0
    buffer_load_dwordx4 v[68:71], v1, s[4:7], s55 offen offset:1024 sc1
    v_exp_f32 v208, v208
    v_exp_f32 v209, v209
    v_exp_f32 v210, v210
    v_smfmac_f32_32x32x32_bf16 v[128:143], v[88:91], v[192:199], v9
    v_exp_f32 v211, v211
    v_exp_f32 v212, v212
    v_exp_f32 v213, v213
    v_mfma_f32_32x32x16_bf16 v[224:239], v[84:87], v[52:55], v[224:239]
    v_exp_f32 v214, v214
    v_exp_f32 v215, v215
    v_exp_f32 v216, v216
    v_smfmac_f32_16x16x64_bf16 v[12:15], v[28:31], v[192:199], v9
    v_exp_f32 v217, v217
    v_smfmac_f32_32x32x32_bf16 v[128:143], v[92:95], v[200:207], v9
    v_exp_f32 v218, v218
    v_exp_f32 v219, v219
    v_exp_f32 v220, v220
    v_smfmac_f32_16x16x64_bf16 v[12:15], v[28:31], v[200:207], v9
    v_exp_f32 v221, v221
    v_exp_f32 v222, v222
    v_exp_f32 v223, v223
    v_mfma_f32_32x32x16_bf16 v[240:255], v[80:83], v[56:59], 0
    buffer_load_dwordx4 v[72:75], v1, s[4:7], s56 offen offset:0 sc1
    v_exp_f32 v224, v224
    v_exp_f32 v225, v225
    v_exp_f32 v226, v226
    v_smfmac_f32_32x32x32_bf16 v[144:159], v[88:91], v[208:215], v9
    v_exp_f32 v227, v227
    v_exp_f32 v228, v228
    v_exp_f32 v229, v229
    v_mfma_f32_32x32x16_bf16 v[240:255], v[84:87], v[60:63], v[240:255]
    v_exp_f32 v230, v230
    v_exp_f32 v231, v231
    v_exp_f32 v232, v232
    v_smfmac_f32_16x16x64_bf16 v[16:19], v[28:31], v[208:215], v9
    v_exp_f32 v233, v233
    v_smfmac_f32_32x32x32_bf16 v[144:159], v[92:95], v[216:223], v9
    v_exp_f32 v234, v234
    v_exp_f32 v235, v235
    v_exp_f32 v236, v236
    v_smfmac_f32_16x16x64_bf16 v[16:19], v[28:31], v[216:223], v9
    v_exp_f32 v237, v237
    v_exp_f32 v238, v238
    v_exp_f32 v239, v239
    s_waitcnt vmcnt(7)
    v_mfma_f32_32x32x16_bf16 v[192:207], v[96:99], v[32:35], 0
    buffer_load_dwordx4 v[76:79], v1, s[4:7], s56 offen offset:1024 sc1
    v_exp_f32 v240, v240
    v_exp_f32 v241, v241
    v_exp_f32 v242, v242
    v_smfmac_f32_32x32x32_bf16 v[160:175], v[88:91], v[224:231], v9
    v_exp_f32 v243, v243
    v_exp_f32 v244, v244
    v_exp_f32 v245, v245
    v_mfma_f32_32x32x16_bf16 v[192:207], v[100:103], v[36:39], v[192:207]
    v_exp_f32 v246, v246
    v_exp_f32 v247, v247
    v_exp_f32 v248, v248
    v_smfmac_f32_16x16x64_bf16 v[20:23], v[28:31], v[224:231], v9
    v_exp_f32 v249, v249
    v_smfmac_f32_32x32x32_bf16 v[160:175], v[92:95], v[232:239], v9
    v_exp_f32 v250, v250
    v_exp_f32 v251, v251
    v_exp_f32 v252, v252
    v_smfmac_f32_16x16x64_bf16 v[20:23], v[28:31], v[232:239], v9
    v_exp_f32 v253, v253
    v_exp_f32 v254, v254
    v_exp_f32 v255, v255
    v_mfma_f32_32x32x16_bf16 v[208:223], v[96:99], v[40:43], 0
    s_add_u32 s54, s54, 8192
    s_and_b32 s54, s54, 0x1ffff
    s_add_u32 s55, s53, s54
    s_add_u32 s56, s55, 4194304
    buffer_load_dwordx4 v[80:83], v1, s[4:7], s55 offen offset:0 sc1
    v_exp_f32 v192, v192
    v_exp_f32 v193, v193
    v_exp_f32 v194, v194
    v_smfmac_f32_32x32x32_bf16 v[176:191], v[88:91], v[240:247], v9
    v_exp_f32 v195, v195
    v_exp_f32 v196, v196
    v_exp_f32 v197, v197
    v_mfma_f32_32x32x16_bf16 v[208:223], v[100:103], v[44:47], v[208:223]
    v_exp_f32 v198, v198
    v_exp_f32 v199, v199
    v_exp_f32 v200, v200
    v_smfmac_f32_16x16x64_bf16 v[24:27], v[28:31], v[240:247], v9
    v_exp_f32 v201, v201
    v_smfmac_f32_32x32x32_bf16 v[176:191], v[92:95], v[248:255], v9
    v_exp_f32 v202, v202
    v_exp_f32 v203, v203
    v_exp_f32 v204, v204
    v_smfmac_f32_16x16x64_bf16 v[24:27], v[28:31], v[248:255], v9
    v_exp_f32 v205, v205
    v_exp_f32 v206, v206
    v_exp_f32 v207, v207
    v_mfma_f32_32x32x16_bf16 v[224:239], v[96:99], v[48:51], 0
    buffer_load_dwordx4 v[84:87], v1, s[4:7], s55 offen offset:1024 sc1
    v_exp_f32 v208, v208
    v_exp_f32 v209, v209
    v_exp_f32 v210, v210
    v_smfmac_f32_32x32x32_bf16 v[128:143], v[104:107], v[192:199], v9
    v_exp_f32 v211, v211
    v_exp_f32 v212, v212
    v_exp_f32 v213, v213
    v_mfma_f32_32x32x16_bf16 v[224:239], v[100:103], v[52:55], v[224:239]
    v_exp_f32 v214, v214
    v_exp_f32 v215, v215
    v_exp_f32 v216, v216
    v_smfmac_f32_16x16x64_bf16 v[12:15], v[28:31], v[192:199], v9
    v_exp_f32 v217, v217
    v_smfmac_f32_32x32x32_bf16 v[128:143], v[108:111], v[200:207], v9
    v_exp_f32 v218, v218
    v_exp_f32 v219, v219
    v_exp_f32 v220, v220
    v_smfmac_f32_16x16x64_bf16 v[12:15], v[28:31], v[200:207], v9
    v_exp_f32 v221, v221
    v_exp_f32 v222, v222
    v_exp_f32 v223, v223
    v_mfma_f32_32x32x16_bf16 v[240:255], v[96:99], v[56:59], 0
    buffer_load_dwordx4 v[88:91], v1, s[4:7], s56 offen offset:0 sc1
    v_exp_f32 v224, v224
    v_exp_f32 v225, v225
    v_exp_f32 v226, v226
    v_smfmac_f32_32x32x32_bf16 v[144:159], v[104:107], v[208:215], v9
    v_exp_f32 v227, v227
    v_exp_f32 v228, v228
    v_exp_f32 v229, v229
    v_mfma_f32_32x32x16_bf16 v[240:255], v[100:103], v[60:63], v[240:255]
    v_exp_f32 v230, v230
    v_exp_f32 v231, v231
    v_exp_f32 v232, v232
    v_smfmac_f32_16x16x64_bf16 v[16:19], v[28:31], v[208:215], v9
    v_exp_f32 v233, v233
    v_smfmac_f32_32x32x32_bf16 v[144:159], v[108:111], v[216:223], v9
    v_exp_f32 v234, v234
    v_exp_f32 v235, v235
    v_exp_f32 v236, v236
    v_smfmac_f32_16x16x64_bf16 v[16:19], v[28:31], v[216:223], v9
    v_exp_f32 v237, v237
    v_exp_f32 v238, v238
    v_exp_f32 v239, v239
    s_waitcnt vmcnt(7)
    v_mfma_f32_32x32x16_bf16 v[192:207], v[112:115], v[32:35], 0
    buffer_load_dwordx4 v[92:95], v1, s[4:7], s56 offen offset:1024 sc1
    v_exp_f32 v240, v240
    v_exp_f32 v241, v241
    v_exp_f32 v242, v242
    v_smfmac_f32_32x32x32_bf16 v[160:175], v[104:107], v[224:231], v9
    v_exp_f32 v243, v243
    v_exp_f32 v244, v244
    v_exp_f32 v245, v245
    v_mfma_f32_32x32x16_bf16 v[192:207], v[116:119], v[36:39], v[192:207]
    v_exp_f32 v246, v246
    v_exp_f32 v247, v247
    v_exp_f32 v248, v248
    v_smfmac_f32_16x16x64_bf16 v[20:23], v[28:31], v[224:231], v9
    v_exp_f32 v249, v249
    v_smfmac_f32_32x32x32_bf16 v[160:175], v[108:111], v[232:239], v9
    v_exp_f32 v250, v250
    v_exp_f32 v251, v251
    v_exp_f32 v252, v252
    v_smfmac_f32_16x16x64_bf16 v[20:23], v[28:31], v[232:239], v9
    v_exp_f32 v253, v253
    v_exp_f32 v254, v254
    v_exp_f32 v255, v255
    v_mfma_f32_32x32x16_bf16 v[208:223], v[112:115], v[40:43], 0
    s_add_u32 s54, s54, 8192
    s_and_b32 s54, s54, 0x1ffff
    s_add_u32 s55, s53, s54
    s_add_u32 s56, s55, 4194304
    buffer_load_dwordx4 v[96:99], v1, s[4:7], s55 offen offset:0 sc1
    v_exp_f32 v192, v192
    v_exp_f32 v193, v193
    v_exp_f32 v194, v194
    v_smfmac_f32_32x32x32_bf16 v[176:191], v[104:107], v[240:247], v9
    ds_read_b128 v[32:35], v4 offset:8192
    ds_read_b128 v[36:39], v4 offset:9216
    v_exp_f32 v195, v195
    v_exp_f32 v196, v196
    v_exp_f32 v197, v197
    v_mfma_f32_32x32x16_bf16 v[208:223], v[116:119], v[44:47], v[208:223]
    v_exp_f32 v198, v198
    v_exp_f32 v199, v199
    v_exp_f32 v200, v200
    v_smfmac_f32_16x16x64_bf16 v[24:27], v[28:31], v[240:247], v9
    v_exp_f32 v201, v201
    v_smfmac_f32_32x32x32_bf16 v[176:191], v[108:111], v[248:255], v9
    v_exp_f32 v202, v202
    v_exp_f32 v203, v203
    v_exp_f32 v204, v204
    v_smfmac_f32_16x16x64_bf16 v[24:27], v[28:31], v[248:255], v9
    v_exp_f32 v205, v205
    v_exp_f32 v206, v206
    v_exp_f32 v207, v207
    s_barrier
    v_mfma_f32_32x32x16_bf16 v[224:239], v[112:115], v[48:51], 0
    buffer_load_dwordx4 v[100:103], v1, s[4:7], s55 offen offset:1024 sc1
    v_exp_f32 v208, v208
    v_exp_f32 v209, v209
    v_exp_f32 v210, v210
    v_smfmac_f32_32x32x32_bf16 v[128:143], v[120:123], v[192:199], v9
    ds_read_b128 v[40:43], v4 offset:10240
    ds_read_b128 v[44:47], v4 offset:11264
    v_exp_f32 v211, v211
    v_exp_f32 v212, v212
    v_exp_f32 v213, v213
    v_mfma_f32_32x32x16_bf16 v[224:239], v[116:119], v[52:55], v[224:239]
    v_exp_f32 v214, v214
    v_exp_f32 v215, v215
    v_exp_f32 v216, v216
    v_smfmac_f32_16x16x64_bf16 v[12:15], v[28:31], v[192:199], v9
    v_exp_f32 v217, v217
    v_smfmac_f32_32x32x32_bf16 v[128:143], v[124:127], v[200:207], v9
    v_exp_f32 v218, v218
    v_exp_f32 v219, v219
    v_exp_f32 v220, v220
    v_smfmac_f32_16x16x64_bf16 v[12:15], v[28:31], v[200:207], v9
    v_exp_f32 v221, v221
    v_exp_f32 v222, v222
    v_exp_f32 v223, v223
    v_mfma_f32_32x32x16_bf16 v[240:255], v[112:115], v[56:59], 0
    buffer_load_dwordx4 v[104:107], v1, s[4:7], s56 offen offset:0 sc1
    v_exp_f32 v224, v224
    v_exp_f32 v225, v225
    v_exp_f32 v226, v226
    v_smfmac_f32_32x32x32_bf16 v[144:159], v[120:123], v[208:215], v9
    ds_read_b128 v[48:51], v4 offset:12288
    ds_read_b128 v[52:55], v4 offset:13312
    v_exp_f32 v227, v227
    ds_write_b128 v5, v[128:131] offset:0
    v_exp_f32 v228, v228
    v_exp_f32 v229, v229
    v_mfma_f32_32x32x16_bf16 v[240:255], v[116:119], v[60:63], v[240:255]
    ds_write_b128 v5, v[132:135] offset:1024
    v_exp_f32 v230, v230
    v_exp_f32 v231, v231
    v_exp_f32 v232, v232
    v_smfmac_f32_16x16x64_bf16 v[16:19], v[28:31], v[208:215], v9
    ds_write_b32 v6, v12 offset:0
    v_exp_f32 v233, v233
    v_smfmac_f32_32x32x32_bf16 v[144:159], v[124:127], v[216:223], v9
    ds_write_b128 v5, v[136:139] offset:2048
    v_exp_f32 v234, v234
    v_exp_f32 v235, v235
    v_exp_f32 v236, v236
    v_smfmac_f32_16x16x64_bf16 v[16:19], v[28:31], v[216:223], v9
    ds_write_b128 v5, v[140:143] offset:3072
    v_exp_f32 v237, v237
    v_exp_f32 v238, v238
    v_exp_f32 v239, v239
    s_waitcnt vmcnt(7)
    s_waitcnt lgkmcnt(9)
    v_mfma_f32_32x32x16_bf16 v[192:207], v[64:67], v[32:35], 0
    buffer_load_dwordx4 v[108:111], v1, s[4:7], s56 offen offset:1024 sc1
    v_exp_f32 v240, v240
    v_exp_f32 v241, v241
    v_exp_f32 v242, v242
    v_smfmac_f32_32x32x32_bf16 v[160:175], v[120:123], v[224:231], v9
    ds_read_b128 v[56:59], v4 offset:14336
    ds_read_b128 v[60:63], v4 offset:15360
    v_exp_f32 v243, v243
    ds_write_b128 v5, v[144:147] offset:16384
    v_exp_f32 v244, v244
    v_exp_f32 v245, v245
    v_mfma_f32_32x32x16_bf16 v[192:207], v[68:71], v[36:39], v[192:207]
    ds_write_b128 v5, v[148:151] offset:17408
    v_exp_f32 v246, v246
    v_exp_f32 v247, v247
    v_exp_f32 v248, v248
    s_waitcnt lgkmcnt(4)
    v_mfma_f32_32x32x8_bf16 v[128:143], v[10:11], v[10:11], 0
    v_mov_b32 v12, 0
    v_smfmac_f32_16x16x64_bf16 v[20:23], v[28:31], v[224:231], v9
    ds_write_b32 v6, v16 offset:1024
    v_exp_f32 v249, v249
    v_smfmac_f32_32x32x32_bf16 v[160:175], v[124:127], v[232:239], v9
    ds_write_b128 v5, v[152:155] offset:18432
    v_exp_f32 v250, v250
    v_exp_f32 v251, v251
    v_exp_f32 v252, v252
    v_smfmac_f32_16x16x64_bf16 v[20:23], v[28:31], v[232:239], v9
    ds_write_b128 v5, v[156:159] offset:19456
    v_exp_f32 v253, v253
    v_exp_f32 v254, v254
    v_exp_f32 v255, v255
    s_cmp_lg_u32 s57, 0
    s_cbranch_scc1 b_tail
    v_mfma_f32_32x32x16_bf16 v[208:223], v[64:67], v[40:43], 0
    s_add_u32 s54, s54, 8192
    s_and_b32 s54, s54, 0x1ffff
    s_add_u32 s55, s53, s54
    s_add_u32 s56, s55, 4194304
    buffer_load_dwordx4 v[112:115], v1, s[4:7], s55 offen offset:0 sc1
    v_exp_f32 v192, v192
    v_exp_f32 v193, v193
    v_exp_f32 v194, v194
    v_smfmac_f32_32x32x32_bf16 v[176:191], v[120:123], v[240:247], v9
    v_exp_f32 v195, v195
    ds_write_b128 v5, v[160:163] offset:32768
    v_exp_f32 v196, v196
    v_exp_f32 v197, v197
    v_mfma_f32_32x32x16_bf16 v[208:223], v[68:71], v[44:47], v[208:223]
    ds_write_b128 v5, v[164:167] offset:33792
    v_exp_f32 v198, v198
    v_exp_f32 v199, v199
    v_exp_f32 v200, v200
    s_waitcnt lgkmcnt(2)
    v_mfma_f32_32x32x8_bf16 v[144:159], v[10:11], v[10:11], 0
    v_mov_b32 v16, 0
    v_smfmac_f32_16x16x64_bf16 v[24:27], v[28:31], v[240:247], v9
    ds_write_b32 v6, v20 offset:2048
    v_exp_f32 v201, v201
    v_smfmac_f32_32x32x32_bf16 v[176:191], v[124:127], v[248:255], v9
    ds_write_b128 v5, v[168:171] offset:34816
    v_exp_f32 v202, v202
    v_exp_f32 v203, v203
    v_exp_f32 v204, v204
    v_smfmac_f32_16x16x64_bf16 v[24:27], v[28:31], v[248:255], v9
    ds_write_b128 v5, v[172:175] offset:35840
    v_exp_f32 v205, v205
    v_exp_f32 v206, v206
    v_exp_f32 v207, v207
    v_mfma_f32_32x32x16_bf16 v[224:239], v[64:67], v[48:51], 0
    buffer_load_dwordx4 v[116:119], v1, s[4:7], s55 offen offset:1024 sc1
    v_exp_f32 v208, v208
    v_exp_f32 v209, v209
    v_exp_f32 v210, v210
    v_smfmac_f32_32x32x32_bf16 v[128:143], v[72:75], v[192:199], v9
    v_exp_f32 v211, v211
    ds_write_b128 v5, v[176:179] offset:49152
    v_exp_f32 v212, v212
    v_exp_f32 v213, v213
    v_mfma_f32_32x32x16_bf16 v[224:239], v[68:71], v[52:55], v[224:239]
    ds_write_b128 v5, v[180:183] offset:50176
    v_exp_f32 v214, v214
    v_exp_f32 v215, v215
    v_exp_f32 v216, v216
    s_waitcnt lgkmcnt(2)
    v_mfma_f32_32x32x8_bf16 v[160:175], v[10:11], v[10:11], 0
    v_mov_b32 v20, 0
    v_smfmac_f32_16x16x64_bf16 v[12:15], v[28:31], v[192:199], v9
    ds_write_b32 v6, v24 offset:3072
    v_exp_f32 v217, v217
    v_smfmac_f32_32x32x32_bf16 v[128:143], v[76:79], v[200:207], v9
    ds_write_b128 v5, v[184:187] offset:51200
    v_exp_f32 v218, v218
    v_exp_f32 v219, v219
    v_exp_f32 v220, v220
    v_smfmac_f32_16x16x64_bf16 v[12:15], v[28:31], v[200:207], v9
    ds_write_b128 v5, v[188:191] offset:52224
    v_exp_f32 v221, v221
    v_exp_f32 v222, v222
    v_exp_f32 v223, v223
    s_waitcnt lgkmcnt(0)
    v_mfma_f32_32x32x8_bf16 v[176:191], v[10:11], v[10:11], 0
    v_mov_b32 v24, 0
    s_barrier
    s_mov_b32 s57, 1
    s_branch b_head
b_tail:
    v_smfmac_f32_32x32x32_bf16 v[176:191], v[120:123], v[240:247], v9
    v_smfmac_f32_16x16x64_bf16 v[24:27], v[28:31], v[240:247], v9
    v_smfmac_f32_32x32x32_bf16 v[176:191], v[124:127], v[248:255], v9
    v_smfmac_f32_16x16x64_bf16 v[24:27], v[28:31], v[248:255], v9
    s_nop 7
    ds_write_b128 v5, v[160:163] offset:32768
    ds_write_b128 v5, v[164:167] offset:33792
    ds_write_b128 v5, v[168:171] offset:34816
    ds_write_b128 v5, v[172:175] offset:35840
    ds_write_b32 v6, v20 offset:2048
    s_lshl_b32 s44, s21, 22
    s_lshl_b32 s45, s39, 16
    s_add_u32 s41, s44, s45
    s_lshl_b32 s45, s20, 12
    s_add_u32 s43, s41, s45
    s_add_u32 s41, s41, 16777216
    buffer_load_dwordx4 v[224:227], v2, s[4:7], s43 offen offset:0 sc1
    buffer_load_dwordx4 v[228:231], v2, s[4:7], s43 offen offset:256 sc1
    buffer_load_dwordx4 v[232:235], v2, s[4:7], s43 offen offset:2048 sc1
    buffer_load_dwordx4 v[236:239], v2, s[4:7], s43 offen offset:2304 sc1
    s_nop 3
    ds_write_b128 v5, v[176:179] offset:49152
    ds_write_b128 v5, v[180:183] offset:50176
    ds_write_b128 v5, v[184:187] offset:51200
    ds_write_b128 v5, v[188:191] offset:52224
    ds_write_b32 v6, v24 offset:3072
    s_waitcnt lgkmcnt(0)
    s_barrier
    v_xor_b32 v4, 32, v3
    v_xor_b32 v5, 64, v3
    v_xor_b32 v6, 96, v3
c_wo:
    s_add_u32 s42, s41, 0
    buffer_load_dwordx4 v[64:67], v2, s[4:7], s42 offen offset:0 sc1
    buffer_load_dwordx4 v[68:71], v2, s[4:7], s42 offen offset:256 sc1
    s_add_u32 s42, s41, 4096
    buffer_load_dwordx4 v[72:75], v2, s[4:7], s42 offen offset:0 sc1
    buffer_load_dwordx4 v[76:79], v2, s[4:7], s42 offen offset:256 sc1
    s_add_u32 s42, s41, 8192
    buffer_load_dwordx4 v[80:83], v2, s[4:7], s42 offen offset:0 sc1
    buffer_load_dwordx4 v[84:87], v2, s[4:7], s42 offen offset:256 sc1
    s_add_u32 s42, s41, 12288
    buffer_load_dwordx4 v[88:91], v2, s[4:7], s42 offen offset:0 sc1
    buffer_load_dwordx4 v[92:95], v2, s[4:7], s42 offen offset:256 sc1
    s_add_u32 s42, s41, 16384
    buffer_load_dwordx4 v[96:99], v2, s[4:7], s42 offen offset:0 sc1
    buffer_load_dwordx4 v[100:103], v2, s[4:7], s42 offen offset:256 sc1
    ds_read_b64_tr_b16 v[32:33], v3 offset:0
    ds_read_b64_tr_b16 v[34:35], v3 offset:1024
    ds_read_b64_tr_b16 v[36:37], v4 offset:0
    ds_read_b64_tr_b16 v[38:39], v4 offset:1024
    ds_read_b64_tr_b16 v[40:41], v5 offset:0
    ds_read_b64_tr_b16 v[42:43], v5 offset:1024
    ds_read_b64_tr_b16 v[44:45], v6 offset:0
    ds_read_b64_tr_b16 v[46:47], v6 offset:1024
    ds_read_b64_tr_b16 v[48:49], v3 offset:4096
    ds_read_b64_tr_b16 v[50:51], v3 offset:5120
    ds_read_b64_tr_b16 v[52:53], v4 offset:4096
    ds_read_b64_tr_b16 v[54:55], v4 offset:5120
    ds_read_b64_tr_b16 v[56:57], v5 offset:4096
    ds_read_b64_tr_b16 v[58:59], v5 offset:5120
    v_lshrrev_b32 v12, 4, v1
    v_and_b32 v13, 1, v12
    v_lshlrev_b32 v13, 4, v13
    v_mov_b32 v14, 0x3f80
    v_lshlrev_b32 v13, v13, v14
    v_lshrrev_b32 v14, 2, v12
    v_lshrrev_b32 v15, 4, v12
    v_xor_b32 v14, v14, v15
    v_and_b32 v14, 1, v14
    v_bfe_u32 v15, v12, 3, 1
    v_bfe_u32 v16, v12, 1, 1
    v_lshl_add_u32 v15, v15, 1, v16
    v_lshrrev_b32 v16, 5, v12
    v_lshl_add_u32 v15, v16, 2, v15
    v_lshl_add_u32 v15, v14, 3, v15
    v_cmp_eq_u32 vcc, 0, v15
    s_nop 1
    v_cndmask_b32 v240, 0, v13, vcc
    v_cmp_eq_u32 vcc, 1, v15
    s_nop 1
    v_cndmask_b32 v241, 0, v13, vcc
    v_cmp_eq_u32 vcc, 2, v15
    s_nop 1
    v_cndmask_b32 v242, 0, v13, vcc
    v_cmp_eq_u32 vcc, 3, v15
    s_nop 1
    v_cndmask_b32 v243, 0, v13, vcc
    v_cmp_eq_u32 vcc, 4, v15
    s_nop 1
    v_cndmask_b32 v244, 0, v13, vcc
    v_cmp_eq_u32 vcc, 5, v15
    s_nop 1
    v_cndmask_b32 v245, 0, v13, vcc
    v_cmp_eq_u32 vcc, 6, v15
    s_nop 1
    v_cndmask_b32 v246, 0, v13, vcc
    v_cmp_eq_u32 vcc, 7, v15
    s_nop 1
    v_cndmask_b32 v247, 0, v13, vcc
    s_waitcnt vmcnt(10)
    v_mfma_f32_16x16x32_bf16 v[128:131], v[240:243], v[224:227], 0
    v_mfma_f32_16x16x32_bf16 v[132:135], v[240:243], v[228:231], 0
    v_mfma_f32_16x16x32_bf16 v[136:139], v[244:247], v[224:227], 0
    v_mfma_f32_16x16x32_bf16 v[140:143], v[244:247], v[228:231], 0
    v_mfma_f32_16x16x32_bf16 v[144:147], v[240:243], v[232:235], 0
    v_mfma_f32_16x16x32_bf16 v[148:151], v[240:243], v[236:239], 0
    v_mfma_f32_16x16x32_bf16 v[152:155], v[244:247], v[232:235], 0
    v_mfma_f32_16x16x32_bf16 v[156:159], v[244:247], v[236:239], 0
    s_waitcnt vmcnt(8) lgkmcnt(10)
    v_mfma_f32_16x16x32_bf16 v[128:131], v[32:35], v[64:67], v[128:131]
    ds_read_b64_tr_b16 v[60:61], v6 offset:4096
    s_add_u32 s42, s41, 20480
    buffer_load_dwordx4 v[104:107], v2, s[4:7], s42 offen offset:0 sc1
    v_mfma_f32_16x16x32_bf16 v[132:135], v[32:35], v[68:71], v[132:135]
    ds_read_b64_tr_b16 v[62:63], v6 offset:5120
    v_mfma_f32_16x16x32_bf16 v[136:139], v[36:39], v[64:67], v[136:139]
    ds_read_b64_tr_b16 v[32:33], v3 offset:8192
    v_mfma_f32_16x16x32_bf16 v[140:143], v[36:39], v[68:71], v[140:143]
    ds_read_b64_tr_b16 v[34:35], v3 offset:9216
    s_waitcnt lgkmcnt(10)
    v_mfma_f32_16x16x32_bf16 v[144:147], v[40:43], v[64:67], v[144:147]
    ds_read_b64_tr_b16 v[36:37], v4 offset:8192
    buffer_load_dwordx4 v[108:111], v2, s[4:7], s42 offen offset:256 sc1
    v_mfma_f32_16x16x32_bf16 v[148:151], v[40:43], v[68:71], v[148:151]
    ds_read_b64_tr_b16 v[38:39], v4 offset:9216
    v_mfma_f32_16x16x32_bf16 v[152:155], v[44:47], v[64:67], v[152:155]
    ds_read_b64_tr_b16 v[40:41], v5 offset:8192
    v_mfma_f32_16x16x32_bf16 v[156:159], v[44:47], v[68:71], v[156:159]
    ds_read_b64_tr_b16 v[42:43], v5 offset:9216
    s_waitcnt vmcnt(8) lgkmcnt(10)
    v_mfma_f32_16x16x32_bf16 v[128:131], v[48:51], v[72:75], v[128:131]
    ds_read_b64_tr_b16 v[44:45], v6 offset:8192
    s_add_u32 s42, s41, 24576
    buffer_load_dwordx4 v[112:115], v2, s[4:7], s42 offen offset:0 sc1
    v_mfma_f32_16x16x32_bf16 v[132:135], v[48:51], v[76:79], v[132:135]
    ds_read_b64_tr_b16 v[46:47], v6 offset:9216
    v_mfma_f32_16x16x32_bf16 v[136:139], v[52:55], v[72:75], v[136:139]
    ds_read_b64_tr_b16 v[48:49], v3 offset:12288
    v_mfma_f32_16x16x32_bf16 v[140:143], v[52:55], v[76:79], v[140:143]
    ds_read_b64_tr_b16 v[50:51], v3 offset:13312
    s_waitcnt lgkmcnt(10)
    v_mfma_f32_16x16x32_bf16 v[144:147], v[56:59], v[72:75], v[144:147]
    ds_read_b64_tr_b16 v[52:53], v4 offset:12288
    buffer_load_dwordx4 v[116:119], v2, s[4:7], s42 offen offset:256 sc1
    v_mfma_f32_16x16x32_bf16 v[148:151], v[56:59], v[76:79], v[148:151]
    ds_read_b64_tr_b16 v[54:55], v4 offset:13312
    v_mfma_f32_16x16x32_bf16 v[152:155], v[60:63], v[72:75], v[152:155]
    ds_read_b64_tr_b16 v[56:57], v5 offset:12288
    v_mfma_f32_16x16x32_bf16 v[156:159], v[60:63], v[76:79], v[156:159]
    ds_read_b64_tr_b16 v[58:59], v5 offset:13312
    s_waitcnt vmcnt(8) lgkmcnt(10)
    v_mfma_f32_16x16x32_bf16 v[128:131], v[32:35], v[80:83], v[128:131]
    ds_read_b64_tr_b16 v[60:61], v6 offset:12288
    s_add_u32 s42, s41, 28672
    buffer_load_dwordx4 v[120:123], v2, s[4:7], s42 offen offset:0 sc1
    v_mfma_f32_16x16x32_bf16 v[132:135], v[32:35], v[84:87], v[132:135]
    ds_read_b64_tr_b16 v[62:63], v6 offset:13312
    v_mfma_f32_16x16x32_bf16 v[136:139], v[36:39], v[80:83], v[136:139]
    ds_read_b64_tr_b16 v[32:33], v3 offset:16384
    v_mfma_f32_16x16x32_bf16 v[140:143], v[36:39], v[84:87], v[140:143]
    ds_read_b64_tr_b16 v[34:35], v3 offset:17408
    s_waitcnt lgkmcnt(10)
    v_mfma_f32_16x16x32_bf16 v[144:147], v[40:43], v[80:83], v[144:147]
    ds_read_b64_tr_b16 v[36:37], v4 offset:16384
    buffer_load_dwordx4 v[124:127], v2, s[4:7], s42 offen offset:256 sc1
    v_mfma_f32_16x16x32_bf16 v[148:151], v[40:43], v[84:87], v[148:151]
    ds_read_b64_tr_b16 v[38:39], v4 offset:17408
    v_mfma_f32_16x16x32_bf16 v[152:155], v[44:47], v[80:83], v[152:155]
    ds_read_b64_tr_b16 v[40:41], v5 offset:16384
    v_mfma_f32_16x16x32_bf16 v[156:159], v[44:47], v[84:87], v[156:159]
    ds_read_b64_tr_b16 v[42:43], v5 offset:17408
    s_waitcnt vmcnt(8) lgkmcnt(10)
    v_mfma_f32_16x16x32_bf16 v[128:131], v[48:51], v[88:91], v[128:131]
    ds_read_b64_tr_b16 v[44:45], v6 offset:16384
    s_add_u32 s42, s41, 32768
    buffer_load_dwordx4 v[160:163], v2, s[4:7], s42 offen offset:0 sc1
    v_mfma_f32_16x16x32_bf16 v[132:135], v[48:51], v[92:95], v[132:135]
    ds_read_b64_tr_b16 v[46:47], v6 offset:17408
    v_mfma_f32_16x16x32_bf16 v[136:139], v[52:55], v[88:91], v[136:139]
    ds_read_b64_tr_b16 v[48:49], v3 offset:20480
    v_mfma_f32_16x16x32_bf16 v[140:143], v[52:55], v[92:95], v[140:143]
    ds_read_b64_tr_b16 v[50:51], v3 offset:21504
    s_waitcnt lgkmcnt(10)
    v_mfma_f32_16x16x32_bf16 v[144:147], v[56:59], v[88:91], v[144:147]
    ds_read_b64_tr_b16 v[52:53], v4 offset:20480
    buffer_load_dwordx4 v[164:167], v2, s[4:7], s42 offen offset:256 sc1
    v_mfma_f32_16x16x32_bf16 v[148:151], v[56:59], v[92:95], v[148:151]
    ds_read_b64_tr_b16 v[54:55], v4 offset:21504
    v_mfma_f32_16x16x32_bf16 v[152:155], v[60:63], v[88:91], v[152:155]
    ds_read_b64_tr_b16 v[56:57], v5 offset:20480
    v_mfma_f32_16x16x32_bf16 v[156:159], v[60:63], v[92:95], v[156:159]
    ds_read_b64_tr_b16 v[58:59], v5 offset:21504
    s_waitcnt vmcnt(8) lgkmcnt(10)
    v_mfma_f32_16x16x32_bf16 v[128:131], v[32:35], v[96:99], v[128:131]
    ds_read_b64_tr_b16 v[60:61], v6 offset:20480
    s_add_u32 s42, s41, 36864
    buffer_load_dwordx4 v[168:171], v2, s[4:7], s42 offen offset:0 sc1
    v_mfma_f32_16x16x32_bf16 v[132:135], v[32:35], v[100:103], v[132:135]
    ds_read_b64_tr_b16 v[62:63], v6 offset:21504
    v_mfma_f32_16x16x32_bf16 v[136:139], v[36:39], v[96:99], v[136:139]
    ds_read_b64_tr_b16 v[32:33], v3 offset:24576
    v_mfma_f32_16x16x32_bf16 v[140:143], v[36:39], v[100:103], v[140:143]
    ds_read_b64_tr_b16 v[34:35], v3 offset:25600
    s_waitcnt lgkmcnt(10)
    v_mfma_f32_16x16x32_bf16 v[144:147], v[40:43], v[96:99], v[144:147]
    ds_read_b64_tr_b16 v[36:37], v4 offset:24576
    buffer_load_dwordx4 v[172:175], v2, s[4:7], s42 offen offset:256 sc1
    v_mfma_f32_16x16x32_bf16 v[148:151], v[40:43], v[100:103], v[148:151]
    ds_read_b64_tr_b16 v[38:39], v4 offset:25600
    v_mfma_f32_16x16x32_bf16 v[152:155], v[44:47], v[96:99], v[152:155]
    ds_read_b64_tr_b16 v[40:41], v5 offset:24576
    v_mfma_f32_16x16x32_bf16 v[156:159], v[44:47], v[100:103], v[156:159]
    ds_read_b64_tr_b16 v[42:43], v5 offset:25600
    s_waitcnt vmcnt(8) lgkmcnt(10)
    v_mfma_f32_16x16x32_bf16 v[128:131], v[48:51], v[104:107], v[128:131]
    ds_read_b64_tr_b16 v[44:45], v6 offset:24576
    s_add_u32 s42, s41, 40960
    buffer_load_dwordx4 v[176:179], v2, s[4:7], s42 offen offset:0 sc1
    v_mfma_f32_16x16x32_bf16 v[132:135], v[48:51], v[108:111], v[132:135]
    ds_read_b64_tr_b16 v[46:47], v6 offset:25600
    v_mfma_f32_16x16x32_bf16 v[136:139], v[52:55], v[104:107], v[136:139]
    ds_read_b64_tr_b16 v[48:49], v3 offset:28672
    v_mfma_f32_16x16x32_bf16 v[140:143], v[52:55], v[108:111], v[140:143]
    ds_read_b64_tr_b16 v[50:51], v3 offset:29696
    s_waitcnt lgkmcnt(10)
    v_mfma_f32_16x16x32_bf16 v[144:147], v[56:59], v[104:107], v[144:147]
    ds_read_b64_tr_b16 v[52:53], v4 offset:28672
    buffer_load_dwordx4 v[180:183], v2, s[4:7], s42 offen offset:256 sc1
    v_mfma_f32_16x16x32_bf16 v[148:151], v[56:59], v[108:111], v[148:151]
    ds_read_b64_tr_b16 v[54:55], v4 offset:29696
    v_mfma_f32_16x16x32_bf16 v[152:155], v[60:63], v[104:107], v[152:155]
    ds_read_b64_tr_b16 v[56:57], v5 offset:28672
    v_mfma_f32_16x16x32_bf16 v[156:159], v[60:63], v[108:111], v[156:159]
    ds_read_b64_tr_b16 v[58:59], v5 offset:29696
    s_waitcnt vmcnt(8) lgkmcnt(10)
    v_mfma_f32_16x16x32_bf16 v[128:131], v[32:35], v[112:115], v[128:131]
    ds_read_b64_tr_b16 v[60:61], v6 offset:28672
    s_add_u32 s42, s41, 45056
    buffer_load_dwordx4 v[184:187], v2, s[4:7], s42 offen offset:0 sc1
    v_mfma_f32_16x16x32_bf16 v[132:135], v[32:35], v[116:119], v[132:135]
    ds_read_b64_tr_b16 v[62:63], v6 offset:29696
    v_mfma_f32_16x16x32_bf16 v[136:139], v[36:39], v[112:115], v[136:139]
    ds_read_b64_tr_b16 v[32:33], v3 offset:32768
    v_mfma_f32_16x16x32_bf16 v[140:143], v[36:39], v[116:119], v[140:143]
    ds_read_b64_tr_b16 v[34:35], v3 offset:33792
    s_waitcnt lgkmcnt(10)
    v_mfma_f32_16x16x32_bf16 v[144:147], v[40:43], v[112:115], v[144:147]
    ds_read_b64_tr_b16 v[36:37], v4 offset:32768
    buffer_load_dwordx4 v[188:191], v2, s[4:7], s42 offen offset:256 sc1
    v_mfma_f32_16x16x32_bf16 v[148:151], v[40:43], v[116:119], v[148:151]
    ds_read_b64_tr_b16 v[38:39], v4 offset:33792
    v_mfma_f32_16x16x32_bf16 v[152:155], v[44:47], v[112:115], v[152:155]
    ds_read_b64_tr_b16 v[40:41], v5 offset:32768
    v_mfma_f32_16x16x32_bf16 v[156:159], v[44:47], v[116:119], v[156:159]
    ds_read_b64_tr_b16 v[42:43], v5 offset:33792
    s_waitcnt vmcnt(8) lgkmcnt(10)
    v_mfma_f32_16x16x32_bf16 v[128:131], v[48:51], v[120:123], v[128:131]
    ds_read_b64_tr_b16 v[44:45], v6 offset:32768
    s_add_u32 s42, s41, 49152
    buffer_load_dwordx4 v[64:67], v2, s[4:7], s42 offen offset:0 sc1
    v_mfma_f32_16x16x32_bf16 v[132:135], v[48:51], v[124:127], v[132:135]
    ds_read_b64_tr_b16 v[46:47], v6 offset:33792
    v_mfma_f32_16x16x32_bf16 v[136:139], v[52:55], v[120:123], v[136:139]
    ds_read_b64_tr_b16 v[48:49], v3 offset:36864
    v_mfma_f32_16x16x32_bf16 v[140:143], v[52:55], v[124:127], v[140:143]
    ds_read_b64_tr_b16 v[50:51], v3 offset:37888
    s_waitcnt lgkmcnt(10)
    v_mfma_f32_16x16x32_bf16 v[144:147], v[56:59], v[120:123], v[144:147]
    ds_read_b64_tr_b16 v[52:53], v4 offset:36864
    buffer_load_dwordx4 v[68:71], v2, s[4:7], s42 offen offset:256 sc1
    v_mfma_f32_16x16x32_bf16 v[148:151], v[56:59], v[124:127], v[148:151]
    ds_read_b64_tr_b16 v[54:55], v4 offset:37888
    v_mfma_f32_16x16x32_bf16 v[152:155], v[60:63], v[120:123], v[152:155]
    ds_read_b64_tr_b16 v[56:57], v5 offset:36864
    v_mfma_f32_16x16x32_bf16 v[156:159], v[60:63], v[124:127], v[156:159]
    ds_read_b64_tr_b16 v[58:59], v5 offset:37888
    s_waitcnt vmcnt(8) lgkmcnt(10)
    v_mfma_f32_16x16x32_bf16 v[128:131], v[32:35], v[160:163], v[128:131]
    ds_read_b64_tr_b16 v[60:61], v6 offset:36864
    s_add_u32 s42, s41, 53248
    buffer_load_dwordx4 v[72:75], v2, s[4:7], s42 offen offset:0 sc1
    v_mfma_f32_16x16x32_bf16 v[132:135], v[32:35], v[164:167], v[132:135]
    ds_read_b64_tr_b16 v[62:63], v6 offset:37888
    v_mfma_f32_16x16x32_bf16 v[136:139], v[36:39], v[160:163], v[136:139]
    ds_read_b64_tr_b16 v[32:33], v3 offset:40960
    v_mfma_f32_16x16x32_bf16 v[140:143], v[36:39], v[164:167], v[140:143]
    ds_read_b64_tr_b16 v[34:35], v3 offset:41984
    s_waitcnt lgkmcnt(10)
    v_mfma_f32_16x16x32_bf16 v[144:147], v[40:43], v[160:163], v[144:147]
    ds_read_b64_tr_b16 v[36:37], v4 offset:40960
    buffer_load_dwordx4 v[76:79], v2, s[4:7], s42 offen offset:256 sc1
    v_mfma_f32_16x16x32_bf16 v[148:151], v[40:43], v[164:167], v[148:151]
    ds_read_b64_tr_b16 v[38:39], v4 offset:41984
    v_mfma_f32_16x16x32_bf16 v[152:155], v[44:47], v[160:163], v[152:155]
    ds_read_b64_tr_b16 v[40:41], v5 offset:40960
    v_mfma_f32_16x16x32_bf16 v[156:159], v[44:47], v[164:167], v[156:159]
    ds_read_b64_tr_b16 v[42:43], v5 offset:41984
    s_waitcnt vmcnt(8) lgkmcnt(10)
    v_mfma_f32_16x16x32_bf16 v[128:131], v[48:51], v[168:171], v[128:131]
    ds_read_b64_tr_b16 v[44:45], v6 offset:40960
    s_add_u32 s42, s41, 57344
    buffer_load_dwordx4 v[80:83], v2, s[4:7], s42 offen offset:0 sc1
    v_mfma_f32_16x16x32_bf16 v[132:135], v[48:51], v[172:175], v[132:135]
    ds_read_b64_tr_b16 v[46:47], v6 offset:41984
    v_mfma_f32_16x16x32_bf16 v[136:139], v[52:55], v[168:171], v[136:139]
    ds_read_b64_tr_b16 v[48:49], v3 offset:45056
    v_mfma_f32_16x16x32_bf16 v[140:143], v[52:55], v[172:175], v[140:143]
    ds_read_b64_tr_b16 v[50:51], v3 offset:46080
    s_waitcnt lgkmcnt(10)
    v_mfma_f32_16x16x32_bf16 v[144:147], v[56:59], v[168:171], v[144:147]
    ds_read_b64_tr_b16 v[52:53], v4 offset:45056
    buffer_load_dwordx4 v[84:87], v2, s[4:7], s42 offen offset:256 sc1
    v_mfma_f32_16x16x32_bf16 v[148:151], v[56:59], v[172:175], v[148:151]
    ds_read_b64_tr_b16 v[54:55], v4 offset:46080
    v_mfma_f32_16x16x32_bf16 v[152:155], v[60:63], v[168:171], v[152:155]
    ds_read_b64_tr_b16 v[56:57], v5 offset:45056
    v_mfma_f32_16x16x32_bf16 v[156:159], v[60:63], v[172:175], v[156:159]
    ds_read_b64_tr_b16 v[58:59], v5 offset:46080
    s_waitcnt vmcnt(8) lgkmcnt(10)
    v_mfma_f32_16x16x32_bf16 v[128:131], v[32:35], v[176:179], v[128:131]
    ds_read_b64_tr_b16 v[60:61], v6 offset:45056
    s_add_u32 s42, s41, 61440
    buffer_load_dwordx4 v[88:91], v2, s[4:7], s42 offen offset:0 sc1
    v_mfma_f32_16x16x32_bf16 v[132:135], v[32:35], v[180:183], v[132:135]
    ds_read_b64_tr_b16 v[62:63], v6 offset:46080
    s_barrier
    v_mfma_f32_16x16x32_bf16 v[136:139], v[36:39], v[176:179], v[136:139]
    ds_read_b64_tr_b16 v[32:33], v3 offset:49152
    v_mfma_f32_16x16x32_bf16 v[140:143], v[36:39], v[180:183], v[140:143]
    ds_read_b64_tr_b16 v[34:35], v3 offset:50176
    s_waitcnt lgkmcnt(10)
    v_mfma_f32_16x16x32_bf16 v[144:147], v[40:43], v[176:179], v[144:147]
    ds_read_b64_tr_b16 v[36:37], v4 offset:49152
    buffer_load_dwordx4 v[92:95], v2, s[4:7], s42 offen offset:256 sc1
    v_mfma_f32_16x16x32_bf16 v[148:151], v[40:43], v[180:183], v[148:151]
    ds_read_b64_tr_b16 v[38:39], v4 offset:50176
    v_mfma_f32_16x16x32_bf16 v[152:155], v[44:47], v[176:179], v[152:155]
    ds_read_b64_tr_b16 v[40:41], v5 offset:49152
    v_mfma_f32_16x16x32_bf16 v[156:159], v[44:47], v[180:183], v[156:159]
    ds_read_b64_tr_b16 v[42:43], v5 offset:50176
    s_waitcnt vmcnt(8) lgkmcnt(10)
    v_mfma_f32_16x16x32_bf16 v[128:131], v[48:51], v[184:187], v[128:131]
    ds_read_b64_tr_b16 v[44:45], v6 offset:49152
    s_add_u32 s42, s41, 0
    buffer_load_dwordx4 v[96:99], v2, s[4:7], s42 offen offset:2048 sc1
    v_mfma_f32_16x16x32_bf16 v[132:135], v[48:51], v[188:191], v[132:135]
    ds_read_b64_tr_b16 v[46:47], v6 offset:50176
    v_mfma_f32_16x16x32_bf16 v[136:139], v[52:55], v[184:187], v[136:139]
    ds_read_b64_tr_b16 v[48:49], v3 offset:53248
    v_mfma_f32_16x16x32_bf16 v[140:143], v[52:55], v[188:191], v[140:143]
    ds_read_b64_tr_b16 v[50:51], v3 offset:54272
    s_waitcnt lgkmcnt(10)
    v_mfma_f32_16x16x32_bf16 v[144:147], v[56:59], v[184:187], v[144:147]
    ds_read_b64_tr_b16 v[52:53], v4 offset:53248
    buffer_load_dwordx4 v[100:103], v2, s[4:7], s42 offen offset:2304 sc1
    v_mfma_f32_16x16x32_bf16 v[148:151], v[56:59], v[188:191], v[148:151]
    ds_read_b64_tr_b16 v[54:55], v4 offset:54272
    v_mfma_f32_16x16x32_bf16 v[152:155], v[60:63], v[184:187], v[152:155]
    ds_read_b64_tr_b16 v[56:57], v5 offset:53248
    v_mfma_f32_16x16x32_bf16 v[156:159], v[60:63], v[188:191], v[156:159]
    ds_read_b64_tr_b16 v[58:59], v5 offset:54272
    s_waitcnt vmcnt(8) lgkmcnt(10)
    v_mfma_f32_16x16x32_bf16 v[128:131], v[32:35], v[64:67], v[128:131]
    ds_read_b64_tr_b16 v[60:61], v6 offset:53248
    s_add_u32 s42, s41, 4096
    buffer_load_dwordx4 v[104:107], v2, s[4:7], s42 offen offset:2048 sc1
    v_mfma_f32_16x16x32_bf16 v[132:135], v[32:35], v[68:71], v[132:135]
    ds_read_b64_tr_b16 v[62:63], v6 offset:54272
    v_mfma_f32_16x16x32_bf16 v[136:139], v[36:39], v[64:67], v[136:139]
    ds_read_b64_tr_b16 v[32:33], v3 offset:57344
    v_mfma_f32_16x16x32_bf16 v[140:143], v[36:39], v[68:71], v[140:143]
    ds_read_b64_tr_b16 v[34:35], v3 offset:58368
    s_waitcnt lgkmcnt(10)
    v_mfma_f32_16x16x32_bf16 v[144:147], v[40:43], v[64:67], v[144:147]
    ds_read_b64_tr_b16 v[36:37], v4 offset:57344
    buffer_load_dwordx4 v[108:111], v2, s[4:7], s42 offen offset:2304 sc1
    v_mfma_f32_16x16x32_bf16 v[148:151], v[40:43], v[68:71], v[148:151]
    ds_read_b64_tr_b16 v[38:39], v4 offset:58368
    v_mfma_f32_16x16x32_bf16 v[152:155], v[44:47], v[64:67], v[152:155]
    ds_read_b64_tr_b16 v[40:41], v5 offset:57344
    v_mfma_f32_16x16x32_bf16 v[156:159], v[44:47], v[68:71], v[156:159]
    ds_read_b64_tr_b16 v[42:43], v5 offset:58368
    s_waitcnt vmcnt(8) lgkmcnt(10)
    v_mfma_f32_16x16x32_bf16 v[128:131], v[48:51], v[72:75], v[128:131]
    ds_read_b64_tr_b16 v[44:45], v6 offset:57344
    s_add_u32 s42, s41, 8192
    buffer_load_dwordx4 v[112:115], v2, s[4:7], s42 offen offset:2048 sc1
    v_mfma_f32_16x16x32_bf16 v[132:135], v[48:51], v[76:79], v[132:135]
    ds_read_b64_tr_b16 v[46:47], v6 offset:58368
    v_mfma_f32_16x16x32_bf16 v[136:139], v[52:55], v[72:75], v[136:139]
    ds_read_b64_tr_b16 v[48:49], v3 offset:61440
    v_mfma_f32_16x16x32_bf16 v[140:143], v[52:55], v[76:79], v[140:143]
    ds_read_b64_tr_b16 v[50:51], v3 offset:62464
    s_waitcnt lgkmcnt(10)
    v_mfma_f32_16x16x32_bf16 v[144:147], v[56:59], v[72:75], v[144:147]
    ds_read_b64_tr_b16 v[52:53], v4 offset:61440
    buffer_load_dwordx4 v[116:119], v2, s[4:7], s42 offen offset:2304 sc1
    v_mfma_f32_16x16x32_bf16 v[148:151], v[56:59], v[76:79], v[148:151]
    ds_read_b64_tr_b16 v[54:55], v4 offset:62464
    v_mfma_f32_16x16x32_bf16 v[152:155], v[60:63], v[72:75], v[152:155]
    ds_read_b64_tr_b16 v[56:57], v5 offset:61440
    v_mfma_f32_16x16x32_bf16 v[156:159], v[60:63], v[76:79], v[156:159]
    ds_read_b64_tr_b16 v[58:59], v5 offset:62464
    s_waitcnt vmcnt(8) lgkmcnt(10)
    v_mfma_f32_16x16x32_bf16 v[128:131], v[32:35], v[80:83], v[128:131]
    ds_read_b64_tr_b16 v[60:61], v6 offset:61440
    s_add_u32 s42, s41, 12288
    buffer_load_dwordx4 v[120:123], v2, s[4:7], s42 offen offset:2048 sc1
    v_mfma_f32_16x16x32_bf16 v[132:135], v[32:35], v[84:87], v[132:135]
    ds_read_b64_tr_b16 v[62:63], v6 offset:62464
    v_xor_b32 v3, 0x10000, v3
    v_xor_b32 v4, 0x10000, v4
    v_xor_b32 v5, 0x10000, v5
    v_xor_b32 v6, 0x10000, v6
    v_mfma_f32_16x16x32_bf16 v[136:139], v[36:39], v[80:83], v[136:139]
    ds_read_b64_tr_b16 v[32:33], v3 offset:0
    v_mfma_f32_16x16x32_bf16 v[140:143], v[36:39], v[84:87], v[140:143]
    ds_read_b64_tr_b16 v[34:35], v3 offset:1024
    s_waitcnt lgkmcnt(10)
    v_mfma_f32_16x16x32_bf16 v[144:147], v[40:43], v[80:83], v[144:147]
    ds_read_b64_tr_b16 v[36:37], v4 offset:0
    buffer_load_dwordx4 v[124:127], v2, s[4:7], s42 offen offset:2304 sc1
    v_mfma_f32_16x16x32_bf16 v[148:151], v[40:43], v[84:87], v[148:151]
    ds_read_b64_tr_b16 v[38:39], v4 offset:1024
    v_mfma_f32_16x16x32_bf16 v[152:155], v[44:47], v[80:83], v[152:155]
    ds_read_b64_tr_b16 v[40:41], v5 offset:0
    v_mfma_f32_16x16x32_bf16 v[156:159], v[44:47], v[84:87], v[156:159]
    ds_read_b64_tr_b16 v[42:43], v5 offset:1024
    s_waitcnt vmcnt(8) lgkmcnt(10)
    v_mfma_f32_16x16x32_bf16 v[128:131], v[48:51], v[88:91], v[128:131]
    ds_read_b64_tr_b16 v[44:45], v6 offset:0
    s_add_u32 s42, s41, 16384
    buffer_load_dwordx4 v[160:163], v2, s[4:7], s42 offen offset:2048 sc1
    v_mfma_f32_16x16x32_bf16 v[132:135], v[48:51], v[92:95], v[132:135]
    ds_read_b64_tr_b16 v[46:47], v6 offset:1024
    v_mfma_f32_16x16x32_bf16 v[136:139], v[52:55], v[88:91], v[136:139]
    ds_read_b64_tr_b16 v[48:49], v3 offset:4096
    v_mfma_f32_16x16x32_bf16 v[140:143], v[52:55], v[92:95], v[140:143]
    ds_read_b64_tr_b16 v[50:51], v3 offset:5120
    s_waitcnt lgkmcnt(10)
    v_mfma_f32_16x16x32_bf16 v[144:147], v[56:59], v[88:91], v[144:147]
    ds_read_b64_tr_b16 v[52:53], v4 offset:4096
    buffer_load_dwordx4 v[164:167], v2, s[4:7], s42 offen offset:2304 sc1
    v_mfma_f32_16x16x32_bf16 v[148:151], v[56:59], v[92:95], v[148:151]
    ds_read_b64_tr_b16 v[54:55], v4 offset:5120
    v_mfma_f32_16x16x32_bf16 v[152:155], v[60:63], v[88:91], v[152:155]
    ds_read_b64_tr_b16 v[56:57], v5 offset:4096
    v_mfma_f32_16x16x32_bf16 v[156:159], v[60:63], v[92:95], v[156:159]
    ds_read_b64_tr_b16 v[58:59], v5 offset:5120
    s_waitcnt vmcnt(8) lgkmcnt(10)
    v_mfma_f32_16x16x32_bf16 v[128:131], v[32:35], v[96:99], v[128:131]
    ds_read_b64_tr_b16 v[60:61], v6 offset:4096
    s_add_u32 s42, s41, 20480
    buffer_load_dwordx4 v[168:171], v2, s[4:7], s42 offen offset:2048 sc1
    v_mfma_f32_16x16x32_bf16 v[132:135], v[32:35], v[100:103], v[132:135]
    ds_read_b64_tr_b16 v[62:63], v6 offset:5120
    v_mfma_f32_16x16x32_bf16 v[136:139], v[36:39], v[96:99], v[136:139]
    ds_read_b64_tr_b16 v[32:33], v3 offset:8192
    v_mfma_f32_16x16x32_bf16 v[140:143], v[36:39], v[100:103], v[140:143]
    ds_read_b64_tr_b16 v[34:35], v3 offset:9216
    s_waitcnt lgkmcnt(10)
    v_mfma_f32_16x16x32_bf16 v[144:147], v[40:43], v[96:99], v[144:147]
    ds_read_b64_tr_b16 v[36:37], v4 offset:8192
    buffer_load_dwordx4 v[172:175], v2, s[4:7], s42 offen offset:2304 sc1
    v_mfma_f32_16x16x32_bf16 v[148:151], v[40:43], v[100:103], v[148:151]
    ds_read_b64_tr_b16 v[38:39], v4 offset:9216
    v_mfma_f32_16x16x32_bf16 v[152:155], v[44:47], v[96:99], v[152:155]
    ds_read_b64_tr_b16 v[40:41], v5 offset:8192
    v_mfma_f32_16x16x32_bf16 v[156:159], v[44:47], v[100:103], v[156:159]
    ds_read_b64_tr_b16 v[42:43], v5 offset:9216
    s_waitcnt vmcnt(8) lgkmcnt(10)
    v_mfma_f32_16x16x32_bf16 v[128:131], v[48:51], v[104:107], v[128:131]
    ds_read_b64_tr_b16 v[44:45], v6 offset:8192
    s_add_u32 s42, s41, 24576
    buffer_load_dwordx4 v[176:179], v2, s[4:7], s42 offen offset:2048 sc1
    v_mfma_f32_16x16x32_bf16 v[132:135], v[48:51], v[108:111], v[132:135]
    ds_read_b64_tr_b16 v[46:47], v6 offset:9216
    v_mfma_f32_16x16x32_bf16 v[136:139], v[52:55], v[104:107], v[136:139]
    ds_read_b64_tr_b16 v[48:49], v3 offset:12288
    v_mfma_f32_16x16x32_bf16 v[140:143], v[52:55], v[108:111], v[140:143]
    ds_read_b64_tr_b16 v[50:51], v3 offset:13312
    s_waitcnt lgkmcnt(10)
    v_mfma_f32_16x16x32_bf16 v[144:147], v[56:59], v[104:107], v[144:147]
    ds_read_b64_tr_b16 v[52:53], v4 offset:12288
    buffer_load_dwordx4 v[180:183], v2, s[4:7], s42 offen offset:2304 sc1
    v_mfma_f32_16x16x32_bf16 v[148:151], v[56:59], v[108:111], v[148:151]
    ds_read_b64_tr_b16 v[54:55], v4 offset:13312
    v_mfma_f32_16x16x32_bf16 v[152:155], v[60:63], v[104:107], v[152:155]
    ds_read_b64_tr_b16 v[56:57], v5 offset:12288
    v_mfma_f32_16x16x32_bf16 v[156:159], v[60:63], v[108:111], v[156:159]
    ds_read_b64_tr_b16 v[58:59], v5 offset:13312
    s_waitcnt vmcnt(8) lgkmcnt(10)
    v_mfma_f32_16x16x32_bf16 v[128:131], v[32:35], v[112:115], v[128:131]
    ds_read_b64_tr_b16 v[60:61], v6 offset:12288
    s_add_u32 s42, s41, 28672
    buffer_load_dwordx4 v[184:187], v2, s[4:7], s42 offen offset:2048 sc1
    v_mfma_f32_16x16x32_bf16 v[132:135], v[32:35], v[116:119], v[132:135]
    ds_read_b64_tr_b16 v[62:63], v6 offset:13312
    v_mfma_f32_16x16x32_bf16 v[136:139], v[36:39], v[112:115], v[136:139]
    ds_read_b64_tr_b16 v[32:33], v3 offset:16384
    v_mfma_f32_16x16x32_bf16 v[140:143], v[36:39], v[116:119], v[140:143]
    ds_read_b64_tr_b16 v[34:35], v3 offset:17408
    s_waitcnt lgkmcnt(10)
    v_mfma_f32_16x16x32_bf16 v[144:147], v[40:43], v[112:115], v[144:147]
    ds_read_b64_tr_b16 v[36:37], v4 offset:16384
    buffer_load_dwordx4 v[188:191], v2, s[4:7], s42 offen offset:2304 sc1
    v_mfma_f32_16x16x32_bf16 v[148:151], v[40:43], v[116:119], v[148:151]
    ds_read_b64_tr_b16 v[38:39], v4 offset:17408
    v_mfma_f32_16x16x32_bf16 v[152:155], v[44:47], v[112:115], v[152:155]
    ds_read_b64_tr_b16 v[40:41], v5 offset:16384
    v_mfma_f32_16x16x32_bf16 v[156:159], v[44:47], v[116:119], v[156:159]
    ds_read_b64_tr_b16 v[42:43], v5 offset:17408
    s_waitcnt vmcnt(8) lgkmcnt(10)
    v_mfma_f32_16x16x32_bf16 v[128:131], v[48:51], v[120:123], v[128:131]
    ds_read_b64_tr_b16 v[44:45], v6 offset:16384
    s_add_u32 s42, s41, 32768
    buffer_load_dwordx4 v[64:67], v2, s[4:7], s42 offen offset:2048 sc1
    v_mfma_f32_16x16x32_bf16 v[132:135], v[48:51], v[124:127], v[132:135]
    ds_read_b64_tr_b16 v[46:47], v6 offset:17408
    v_mfma_f32_16x16x32_bf16 v[136:139], v[52:55], v[120:123], v[136:139]
    ds_read_b64_tr_b16 v[48:49], v3 offset:20480
    v_mfma_f32_16x16x32_bf16 v[140:143], v[52:55], v[124:127], v[140:143]
    ds_read_b64_tr_b16 v[50:51], v3 offset:21504
    s_waitcnt lgkmcnt(10)
    v_mfma_f32_16x16x32_bf16 v[144:147], v[56:59], v[120:123], v[144:147]
    ds_read_b64_tr_b16 v[52:53], v4 offset:20480
    buffer_load_dwordx4 v[68:71], v2, s[4:7], s42 offen offset:2304 sc1
    v_mfma_f32_16x16x32_bf16 v[148:151], v[56:59], v[124:127], v[148:151]
    ds_read_b64_tr_b16 v[54:55], v4 offset:21504
    v_mfma_f32_16x16x32_bf16 v[152:155], v[60:63], v[120:123], v[152:155]
    ds_read_b64_tr_b16 v[56:57], v5 offset:20480
    v_mfma_f32_16x16x32_bf16 v[156:159], v[60:63], v[124:127], v[156:159]
    ds_read_b64_tr_b16 v[58:59], v5 offset:21504
    s_waitcnt vmcnt(8) lgkmcnt(10)
    v_mfma_f32_16x16x32_bf16 v[128:131], v[32:35], v[160:163], v[128:131]
    ds_read_b64_tr_b16 v[60:61], v6 offset:20480
    s_add_u32 s42, s41, 36864
    buffer_load_dwordx4 v[72:75], v2, s[4:7], s42 offen offset:2048 sc1
    v_mfma_f32_16x16x32_bf16 v[132:135], v[32:35], v[164:167], v[132:135]
    ds_read_b64_tr_b16 v[62:63], v6 offset:21504
    v_mfma_f32_16x16x32_bf16 v[136:139], v[36:39], v[160:163], v[136:139]
    ds_read_b64_tr_b16 v[32:33], v3 offset:24576
    v_mfma_f32_16x16x32_bf16 v[140:143], v[36:39], v[164:167], v[140:143]
    ds_read_b64_tr_b16 v[34:35], v3 offset:25600
    s_waitcnt lgkmcnt(10)
    v_mfma_f32_16x16x32_bf16 v[144:147], v[40:43], v[160:163], v[144:147]
    ds_read_b64_tr_b16 v[36:37], v4 offset:24576
    buffer_load_dwordx4 v[76:79], v2, s[4:7], s42 offen offset:2304 sc1
    v_mfma_f32_16x16x32_bf16 v[148:151], v[40:43], v[164:167], v[148:151]
    ds_read_b64_tr_b16 v[38:39], v4 offset:25600
    v_mfma_f32_16x16x32_bf16 v[152:155], v[44:47], v[160:163], v[152:155]
    ds_read_b64_tr_b16 v[40:41], v5 offset:24576
    v_mfma_f32_16x16x32_bf16 v[156:159], v[44:47], v[164:167], v[156:159]
    ds_read_b64_tr_b16 v[42:43], v5 offset:25600
    s_waitcnt vmcnt(8) lgkmcnt(10)
    v_mfma_f32_16x16x32_bf16 v[128:131], v[48:51], v[168:171], v[128:131]
    ds_read_b64_tr_b16 v[44:45], v6 offset:24576
    s_add_u32 s42, s41, 40960
    buffer_load_dwordx4 v[80:83], v2, s[4:7], s42 offen offset:2048 sc1
    v_mfma_f32_16x16x32_bf16 v[132:135], v[48:51], v[172:175], v[132:135]
    ds_read_b64_tr_b16 v[46:47], v6 offset:25600
    v_mfma_f32_16x16x32_bf16 v[136:139], v[52:55], v[168:171], v[136:139]
    ds_read_b64_tr_b16 v[48:49], v3 offset:28672
    v_mfma_f32_16x16x32_bf16 v[140:143], v[52:55], v[172:175], v[140:143]
    ds_read_b64_tr_b16 v[50:51], v3 offset:29696
    s_waitcnt lgkmcnt(10)
    v_mfma_f32_16x16x32_bf16 v[144:147], v[56:59], v[168:171], v[144:147]
    ds_read_b64_tr_b16 v[52:53], v4 offset:28672
    buffer_load_dwordx4 v[84:87], v2, s[4:7], s42 offen offset:2304 sc1
    v_mfma_f32_16x16x32_bf16 v[148:151], v[56:59], v[172:175], v[148:151]
    ds_read_b64_tr_b16 v[54:55], v4 offset:29696
    v_mfma_f32_16x16x32_bf16 v[152:155], v[60:63], v[168:171], v[152:155]
    ds_read_b64_tr_b16 v[56:57], v5 offset:28672
    v_mfma_f32_16x16x32_bf16 v[156:159], v[60:63], v[172:175], v[156:159]
    ds_read_b64_tr_b16 v[58:59], v5 offset:29696
    s_waitcnt vmcnt(8) lgkmcnt(10)
    v_mfma_f32_16x16x32_bf16 v[128:131], v[32:35], v[176:179], v[128:131]
    ds_read_b64_tr_b16 v[60:61], v6 offset:28672
    s_add_u32 s42, s41, 45056
    buffer_load_dwordx4 v[88:91], v2, s[4:7], s42 offen offset:2048 sc1
    v_mfma_f32_16x16x32_bf16 v[132:135], v[32:35], v[180:183], v[132:135]
    ds_read_b64_tr_b16 v[62:63], v6 offset:29696
    v_mfma_f32_16x16x32_bf16 v[136:139], v[36:39], v[176:179], v[136:139]
    ds_read_b64_tr_b16 v[32:33], v3 offset:32768
    v_mfma_f32_16x16x32_bf16 v[140:143], v[36:39], v[180:183], v[140:143]
    ds_read_b64_tr_b16 v[34:35], v3 offset:33792
    s_waitcnt lgkmcnt(10)
    v_mfma_f32_16x16x32_bf16 v[144:147], v[40:43], v[176:179], v[144:147]
    ds_read_b64_tr_b16 v[36:37], v4 offset:32768
    buffer_load_dwordx4 v[92:95], v2, s[4:7], s42 offen offset:2304 sc1
    v_mfma_f32_16x16x32_bf16 v[148:151], v[40:43], v[180:183], v[148:151]
    ds_read_b64_tr_b16 v[38:39], v4 offset:33792
    v_mfma_f32_16x16x32_bf16 v[152:155], v[44:47], v[176:179], v[152:155]
    ds_read_b64_tr_b16 v[40:41], v5 offset:32768
    v_mfma_f32_16x16x32_bf16 v[156:159], v[44:47], v[180:183], v[156:159]
    ds_read_b64_tr_b16 v[42:43], v5 offset:33792
    s_waitcnt vmcnt(8) lgkmcnt(10)
    v_mfma_f32_16x16x32_bf16 v[128:131], v[48:51], v[184:187], v[128:131]
    ds_read_b64_tr_b16 v[44:45], v6 offset:32768
    s_add_u32 s42, s41, 49152
    buffer_load_dwordx4 v[96:99], v2, s[4:7], s42 offen offset:2048 sc1
    v_mfma_f32_16x16x32_bf16 v[132:135], v[48:51], v[188:191], v[132:135]
    ds_read_b64_tr_b16 v[46:47], v6 offset:33792
    v_mfma_f32_16x16x32_bf16 v[136:139], v[52:55], v[184:187], v[136:139]
    ds_read_b64_tr_b16 v[48:49], v3 offset:36864
    v_mfma_f32_16x16x32_bf16 v[140:143], v[52:55], v[188:191], v[140:143]
    ds_read_b64_tr_b16 v[50:51], v3 offset:37888
    s_waitcnt lgkmcnt(10)
    v_mfma_f32_16x16x32_bf16 v[144:147], v[56:59], v[184:187], v[144:147]
    ds_read_b64_tr_b16 v[52:53], v4 offset:36864
    buffer_load_dwordx4 v[100:103], v2, s[4:7], s42 offen offset:2304 sc1
    v_mfma_f32_16x16x32_bf16 v[148:151], v[56:59], v[188:191], v[148:151]
    ds_read_b64_tr_b16 v[54:55], v4 offset:37888
    v_mfma_f32_16x16x32_bf16 v[152:155], v[60:63], v[184:187], v[152:155]
    ds_read_b64_tr_b16 v[56:57], v5 offset:36864
    v_mfma_f32_16x16x32_bf16 v[156:159], v[60:63], v[188:191], v[156:159]
    ds_read_b64_tr_b16 v[58:59], v5 offset:37888
    s_waitcnt vmcnt(8) lgkmcnt(10)
    v_mfma_f32_16x16x32_bf16 v[128:131], v[32:35], v[64:67], v[128:131]
    ds_read_b64_tr_b16 v[60:61], v6 offset:36864
    s_add_u32 s42, s41, 53248
    buffer_load_dwordx4 v[104:107], v2, s[4:7], s42 offen offset:2048 sc1
    v_mfma_f32_16x16x32_bf16 v[132:135], v[32:35], v[68:71], v[132:135]
    ds_read_b64_tr_b16 v[62:63], v6 offset:37888
    v_mfma_f32_16x16x32_bf16 v[136:139], v[36:39], v[64:67], v[136:139]
    ds_read_b64_tr_b16 v[32:33], v3 offset:40960
    v_mfma_f32_16x16x32_bf16 v[140:143], v[36:39], v[68:71], v[140:143]
    ds_read_b64_tr_b16 v[34:35], v3 offset:41984
    s_waitcnt lgkmcnt(10)
    v_mfma_f32_16x16x32_bf16 v[144:147], v[40:43], v[64:67], v[144:147]
    ds_read_b64_tr_b16 v[36:37], v4 offset:40960
    buffer_load_dwordx4 v[108:111], v2, s[4:7], s42 offen offset:2304 sc1
    v_mfma_f32_16x16x32_bf16 v[148:151], v[40:43], v[68:71], v[148:151]
    ds_read_b64_tr_b16 v[38:39], v4 offset:41984
    v_mfma_f32_16x16x32_bf16 v[152:155], v[44:47], v[64:67], v[152:155]
    ds_read_b64_tr_b16 v[40:41], v5 offset:40960
    v_mfma_f32_16x16x32_bf16 v[156:159], v[44:47], v[68:71], v[156:159]
    ds_read_b64_tr_b16 v[42:43], v5 offset:41984
    s_waitcnt vmcnt(8) lgkmcnt(10)
    v_mfma_f32_16x16x32_bf16 v[128:131], v[48:51], v[72:75], v[128:131]
    ds_read_b64_tr_b16 v[44:45], v6 offset:40960
    s_add_u32 s42, s41, 57344
    buffer_load_dwordx4 v[112:115], v2, s[4:7], s42 offen offset:2048 sc1
    v_mfma_f32_16x16x32_bf16 v[132:135], v[48:51], v[76:79], v[132:135]
    ds_read_b64_tr_b16 v[46:47], v6 offset:41984
    v_mfma_f32_16x16x32_bf16 v[136:139], v[52:55], v[72:75], v[136:139]
    ds_read_b64_tr_b16 v[48:49], v3 offset:45056
    v_mfma_f32_16x16x32_bf16 v[140:143], v[52:55], v[76:79], v[140:143]
    ds_read_b64_tr_b16 v[50:51], v3 offset:46080
    s_waitcnt lgkmcnt(10)
    v_mfma_f32_16x16x32_bf16 v[144:147], v[56:59], v[72:75], v[144:147]
    ds_read_b64_tr_b16 v[52:53], v4 offset:45056
    buffer_load_dwordx4 v[116:119], v2, s[4:7], s42 offen offset:2304 sc1
    v_mfma_f32_16x16x32_bf16 v[148:151], v[56:59], v[76:79], v[148:151]
    ds_read_b64_tr_b16 v[54:55], v4 offset:46080
    v_mfma_f32_16x16x32_bf16 v[152:155], v[60:63], v[72:75], v[152:155]
    ds_read_b64_tr_b16 v[56:57], v5 offset:45056
    v_mfma_f32_16x16x32_bf16 v[156:159], v[60:63], v[76:79], v[156:159]
    ds_read_b64_tr_b16 v[58:59], v5 offset:46080
    s_waitcnt vmcnt(8) lgkmcnt(10)
    v_mfma_f32_16x16x32_bf16 v[128:131], v[32:35], v[80:83], v[128:131]
    ds_read_b64_tr_b16 v[60:61], v6 offset:45056
    s_add_u32 s42, s41, 61440
    buffer_load_dwordx4 v[120:123], v2, s[4:7], s42 offen offset:2048 sc1
    v_mfma_f32_16x16x32_bf16 v[132:135], v[32:35], v[84:87], v[132:135]
    ds_read_b64_tr_b16 v[62:63], v6 offset:46080
    v_mfma_f32_16x16x32_bf16 v[136:139], v[36:39], v[80:83], v[136:139]
    ds_read_b64_tr_b16 v[32:33], v3 offset:49152
    v_mfma_f32_16x16x32_bf16 v[140:143], v[36:39], v[84:87], v[140:143]
    ds_read_b64_tr_b16 v[34:35], v3 offset:50176
    s_waitcnt lgkmcnt(10)
    v_mfma_f32_16x16x32_bf16 v[144:147], v[40:43], v[80:83], v[144:147]
    ds_read_b64_tr_b16 v[36:37], v4 offset:49152
    buffer_load_dwordx4 v[124:127], v2, s[4:7], s42 offen offset:2304 sc1
    v_mfma_f32_16x16x32_bf16 v[148:151], v[40:43], v[84:87], v[148:151]
    ds_read_b64_tr_b16 v[38:39], v4 offset:50176
    v_mfma_f32_16x16x32_bf16 v[152:155], v[44:47], v[80:83], v[152:155]
    ds_read_b64_tr_b16 v[40:41], v5 offset:49152
    v_mfma_f32_16x16x32_bf16 v[156:159], v[44:47], v[84:87], v[156:159]
    ds_read_b64_tr_b16 v[42:43], v5 offset:50176
    s_waitcnt vmcnt(8) lgkmcnt(10)
    v_mfma_f32_16x16x32_bf16 v[128:131], v[48:51], v[88:91], v[128:131]
    ds_read_b64_tr_b16 v[44:45], v6 offset:49152
    v_mfma_f32_16x16x32_bf16 v[132:135], v[48:51], v[92:95], v[132:135]
    ds_read_b64_tr_b16 v[46:47], v6 offset:50176
    v_mfma_f32_16x16x32_bf16 v[136:139], v[52:55], v[88:91], v[136:139]
    ds_read_b64_tr_b16 v[48:49], v3 offset:53248
    v_mfma_f32_16x16x32_bf16 v[140:143], v[52:55], v[92:95], v[140:143]
    ds_read_b64_tr_b16 v[50:51], v3 offset:54272
    s_waitcnt lgkmcnt(10)
    v_mfma_f32_16x16x32_bf16 v[144:147], v[56:59], v[88:91], v[144:147]
    ds_read_b64_tr_b16 v[52:53], v4 offset:53248
    v_mfma_f32_16x16x32_bf16 v[148:151], v[56:59], v[92:95], v[148:151]
    ds_read_b64_tr_b16 v[54:55], v4 offset:54272
    v_mfma_f32_16x16x32_bf16 v[152:155], v[60:63], v[88:91], v[152:155]
    ds_read_b64_tr_b16 v[56:57], v5 offset:53248
    v_mfma_f32_16x16x32_bf16 v[156:159], v[60:63], v[92:95], v[156:159]
    ds_read_b64_tr_b16 v[58:59], v5 offset:54272
    s_waitcnt vmcnt(6) lgkmcnt(10)
    v_mfma_f32_16x16x32_bf16 v[128:131], v[32:35], v[96:99], v[128:131]
    ds_read_b64_tr_b16 v[60:61], v6 offset:53248
    v_mfma_f32_16x16x32_bf16 v[132:135], v[32:35], v[100:103], v[132:135]
    ds_read_b64_tr_b16 v[62:63], v6 offset:54272
    v_mfma_f32_16x16x32_bf16 v[136:139], v[36:39], v[96:99], v[136:139]
    ds_read_b64_tr_b16 v[32:33], v3 offset:57344
    v_mfma_f32_16x16x32_bf16 v[140:143], v[36:39], v[100:103], v[140:143]
    ds_read_b64_tr_b16 v[34:35], v3 offset:58368
    s_waitcnt lgkmcnt(10)
    v_mfma_f32_16x16x32_bf16 v[144:147], v[40:43], v[96:99], v[144:147]
    ds_read_b64_tr_b16 v[36:37], v4 offset:57344
    v_mfma_f32_16x16x32_bf16 v[148:151], v[40:43], v[100:103], v[148:151]
    ds_read_b64_tr_b16 v[38:39], v4 offset:58368
    v_mfma_f32_16x16x32_bf16 v[152:155], v[44:47], v[96:99], v[152:155]
    ds_read_b64_tr_b16 v[40:41], v5 offset:57344
    v_mfma_f32_16x16x32_bf16 v[156:159], v[44:47], v[100:103], v[156:159]
    ds_read_b64_tr_b16 v[42:43], v5 offset:58368
    s_waitcnt vmcnt(4) lgkmcnt(10)
    v_mfma_f32_16x16x32_bf16 v[128:131], v[48:51], v[104:107], v[128:131]
    ds_read_b64_tr_b16 v[44:45], v6 offset:57344
    v_mfma_f32_16x16x32_bf16 v[132:135], v[48:51], v[108:111], v[132:135]
    ds_read_b64_tr_b16 v[46:47], v6 offset:58368
    v_mfma_f32_16x16x32_bf16 v[136:139], v[52:55], v[104:107], v[136:139]
    ds_read_b64_tr_b16 v[48:49], v3 offset:61440
    v_mfma_f32_16x16x32_bf16 v[140:143], v[52:55], v[108:111], v[140:143]
    ds_read_b64_tr_b16 v[50:51], v3 offset:62464
    s_waitcnt lgkmcnt(10)
    v_mfma_f32_16x16x32_bf16 v[144:147], v[56:59], v[104:107], v[144:147]
    ds_read_b64_tr_b16 v[52:53], v4 offset:61440
    v_mfma_f32_16x16x32_bf16 v[148:151], v[56:59], v[108:111], v[148:151]
    ds_read_b64_tr_b16 v[54:55], v4 offset:62464
    v_mfma_f32_16x16x32_bf16 v[152:155], v[60:63], v[104:107], v[152:155]
    ds_read_b64_tr_b16 v[56:57], v5 offset:61440
    v_mfma_f32_16x16x32_bf16 v[156:159], v[60:63], v[108:111], v[156:159]
    ds_read_b64_tr_b16 v[58:59], v5 offset:62464
    s_waitcnt vmcnt(2) lgkmcnt(10)
    v_mfma_f32_16x16x32_bf16 v[128:131], v[32:35], v[112:115], v[128:131]
    ds_read_b64_tr_b16 v[60:61], v6 offset:61440
    v_mfma_f32_16x16x32_bf16 v[132:135], v[32:35], v[116:119], v[132:135]
    ds_read_b64_tr_b16 v[62:63], v6 offset:62464
    v_xor_b32 v3, 0x10000, v3
    v_xor_b32 v4, 0x10000, v4
    v_xor_b32 v5, 0x10000, v5
    v_xor_b32 v6, 0x10000, v6
    v_mfma_f32_16x16x32_bf16 v[136:139], v[36:39], v[112:115], v[136:139]
    v_mfma_f32_16x16x32_bf16 v[140:143], v[36:39], v[116:119], v[140:143]
    s_waitcnt lgkmcnt(8)
    v_mfma_f32_16x16x32_bf16 v[144:147], v[40:43], v[112:115], v[144:147]
    v_mfma_f32_16x16x32_bf16 v[148:151], v[40:43], v[116:119], v[148:151]
    v_mfma_f32_16x16x32_bf16 v[152:155], v[44:47], v[112:115], v[152:155]
    v_mfma_f32_16x16x32_bf16 v[156:159], v[44:47], v[116:119], v[156:159]
    s_waitcnt vmcnt(0) lgkmcnt(4)
    v_mfma_f32_16x16x32_bf16 v[128:131], v[48:51], v[120:123], v[128:131]
    v_mfma_f32_16x16x32_bf16 v[132:135], v[48:51], v[124:127], v[132:135]
    v_mfma_f32_16x16x32_bf16 v[136:139], v[52:55], v[120:123], v[136:139]
    v_mfma_f32_16x16x32_bf16 v[140:143], v[52:55], v[124:127], v[140:143]
    s_waitcnt lgkmcnt(0)
    v_mfma_f32_16x16x32_bf16 v[144:147], v[56:59], v[120:123], v[144:147]
    v_mfma_f32_16x16x32_bf16 v[148:151], v[56:59], v[124:127], v[148:151]
    v_mfma_f32_16x16x32_bf16 v[152:155], v[60:63], v[120:123], v[152:155]
    v_mfma_f32_16x16x32_bf16 v[156:159], v[60:63], v[124:127], v[156:159]
    s_cmp_eq_u32 s21, 3
    s_cbranch_scc1 c_final
    s_add_u32 s43, s43, 4194304
    v_cvt_pk_bf16_f32 v128, v128, v129
    v_cvt_pk_bf16_f32 v129, v130, v131
    v_cvt_pk_bf16_f32 v130, v136, v137
    v_cvt_pk_bf16_f32 v131, v138, v139
    v_cvt_pk_bf16_f32 v144, v144, v145
    v_cvt_pk_bf16_f32 v145, v146, v147
    v_cvt_pk_bf16_f32 v146, v152, v153
    v_cvt_pk_bf16_f32 v147, v154, v155
    v_permlane32_swap_b32 v128, v130
    v_permlane32_swap_b32 v129, v131
    buffer_store_dwordx4 v[128:131], v2, s[4:7], s43 offen offset:0 sc1
    v_permlane32_swap_b32 v144, v146
    v_permlane32_swap_b32 v145, v147
    buffer_store_dwordx4 v[144:147], v2, s[4:7], s43 offen offset:2048 sc1
    v_cvt_pk_bf16_f32 v132, v132, v133
    v_cvt_pk_bf16_f32 v133, v134, v135
    v_cvt_pk_bf16_f32 v134, v140, v141
    v_cvt_pk_bf16_f32 v135, v142, v143
    v_cvt_pk_bf16_f32 v148, v148, v149
    v_cvt_pk_bf16_f32 v149, v150, v151
    v_cvt_pk_bf16_f32 v150, v156, v157
    v_cvt_pk_bf16_f32 v151, v158, v159
    v_permlane32_swap_b32 v132, v134
    v_permlane32_swap_b32 v133, v135
    buffer_store_dwordx4 v[132:135], v2, s[4:7], s43 offen offset:256 sc1
    v_permlane32_swap_b32 v148, v150
    v_permlane32_swap_b32 v149, v151
    buffer_store_dwordx4 v[148:151], v2, s[4:7], s43 offen offset:2304 sc1
    s_barrier
    v_mov_b32 v12, 0x3f803f80
    v_mov_b32 v14, 0
    v_mov_b32 v15, 0
    v_mov_b32 v16, 0
    v_mov_b32 v17, 0
    v_dot2_f32_bf16 v14, v128, v12, v14
    v_dot2_f32_bf16 v15, v128, v128, v15
    v_dot2_f32_bf16 v16, v132, v12, v16
    v_dot2_f32_bf16 v17, v132, v132, v17
    v_dot2_f32_bf16 v14, v129, v12, v14
    v_dot2_f32_bf16 v15, v129, v129, v15
    v_dot2_f32_bf16 v16, v133, v12, v16
    v_dot2_f32_bf16 v17, v133, v133, v17
    v_dot2_f32_bf16 v14, v130, v12, v14
    v_dot2_f32_bf16 v15, v130, v130, v15
    v_dot2_f32_bf16 v16, v134, v12, v16
    v_dot2_f32_bf16 v17, v134, v134, v17
    v_dot2_f32_bf16 v14, v131, v12, v14
    v_dot2_f32_bf16 v15, v131, v131, v15
    v_dot2_f32_bf16 v16, v135, v12, v16
    v_dot2_f32_bf16 v17, v135, v135, v17
    v_dot2_f32_bf16 v14, v144, v12, v14
    v_dot2_f32_bf16 v15, v144, v144, v15
    v_dot2_f32_bf16 v16, v148, v12, v16
    v_dot2_f32_bf16 v17, v148, v148, v17
    v_dot2_f32_bf16 v14, v145, v12, v14
    v_dot2_f32_bf16 v15, v145, v145, v15
    v_dot2_f32_bf16 v16, v149, v12, v16
    v_dot2_f32_bf16 v17, v149, v149, v17
    v_dot2_f32_bf16 v14, v146, v12, v14
    v_dot2_f32_bf16 v15, v146, v146, v15
    v_dot2_f32_bf16 v16, v150, v12, v16
    v_dot2_f32_bf16 v17, v150, v150, v17
    v_dot2_f32_bf16 v14, v147, v12, v14
    v_dot2_f32_bf16 v15, v147, v147, v15
    v_dot2_f32_bf16 v16, v151, v12, v16
    v_dot2_f32_bf16 v17, v151, v151, v17
    s_nop 2
    v_permlane16_swap_b32 v14, v16
    v_permlane16_swap_b32 v15, v17
    v_pk_add_f32 v[14:15], v[14:15], v[16:17]
    v_mov_b32 v16, v14
    v_mov_b32 v17, v15
    s_nop 0
    v_permlane32_swap_b32 v14, v16
    v_permlane32_swap_b32 v15, v17
    v_pk_add_f32 v[14:15], v[14:15], v[16:17]
    v_lshrrev_b32 v13, 1, v1
    v_and_b32 v13, 0xf8, v13
    s_add_u32 s21, s21, 1
    s_lshl_b32 s44, s21, 18
    s_lshl_b32 s45, s39, 12
    s_add_u32 s44, s44, s45
    s_lshl_b32 s45, s20, 8
    s_add_u32 s44, s44, s45
    s_add_u32 s44, s44, 50331648
    buffer_store_dwordx2 v[14:15], v13, s[4:7], s44 offen sc1
    s_lshl_b32 s46, s21, 14
    s_lshl_b32 s67, s39, 7
    s_add_u32 s46, s46, s67
    s_add_u32 s46, s46, 4096
    s_add_u32 s47, s46, 8192
    s_waitcnt vmcnt(1)
    s_atomic_add s40, s[22:23], s46
    s_branch c_layer
c_final:
    s_mov_b32 s8, s32
    s_mov_b32 s9, s33
    s_mov_b32 s10, 4194304
    s_mov_b32 s11, 0x00020000
    v_lshrrev_b32 v12, 4, v1
    s_mul_i32 s44, s16, 4608
    s_add_u32 s44, s44, 131072
    v_and_b32 v13, 15, v12
    v_mul_u32_u24 v13, 144, v13
    v_lshrrev_b32 v14, 4, v12
    v_lshl_add_u32 v13, v14, 3, v13
    v_add_u32 v13, s44, v13
    v_cvt_pk_bf16_f32 v128, v128, v129
    v_cvt_pk_bf16_f32 v129, v130, v131
    ds_write_b64 v13, v[128:129] offset:0
    v_cvt_pk_bf16_f32 v136, v136, v137
    v_cvt_pk_bf16_f32 v137, v138, v139
    ds_write_b64 v13, v[136:137] offset:32
    v_cvt_pk_bf16_f32 v144, v144, v145
    v_cvt_pk_bf16_f32 v145, v146, v147
    ds_write_b64 v13, v[144:145] offset:64
    v_cvt_pk_bf16_f32 v152, v152, v153
    v_cvt_pk_bf16_f32 v153, v154, v155
    ds_write_b64 v13, v[152:153] offset:96
    v_cvt_pk_bf16_f32 v132, v132, v133
    v_cvt_pk_bf16_f32 v133, v134, v135
    ds_write_b64 v13, v[132:133] offset:2304
    v_cvt_pk_bf16_f32 v140, v140, v141
    v_cvt_pk_bf16_f32 v141, v142, v143
    ds_write_b64 v13, v[140:141] offset:2336
    v_cvt_pk_bf16_f32 v148, v148, v149
    v_cvt_pk_bf16_f32 v149, v150, v151
    ds_write_b64 v13, v[148:149] offset:2368
    v_cvt_pk_bf16_f32 v156, v156, v157
    v_cvt_pk_bf16_f32 v157, v158, v159
    ds_write_b64 v13, v[156:157] offset:2400
    v_lshrrev_b32 v14, 3, v12
    v_and_b32 v15, 7, v12
    v_mul_u32_u24 v16, 144, v14
    v_lshl_add_u32 v16, v15, 4, v16
    v_add_u32 v16, s44, v16
    v_lshlrev_b32 v17, 11, v14
    v_lshl_add_u32 v17, v15, 4, v17
    ds_read_b128 v[32:35], v16 offset:0
    ds_read_b128 v[36:39], v16 offset:1152
    ds_read_b128 v[40:43], v16 offset:2304
    ds_read_b128 v[44:47], v16 offset:3456
    s_lshl_b32 s44, s39, 16
    s_lshl_b32 s45, s20, 7
    s_add_u32 s44, s44, s45
    s_waitcnt lgkmcnt(3)
    buffer_store_dwordx4 v[32:35], v17, s[8:11], s44 offen sc1
    s_add_u32 s44, s44, 16384
    s_waitcnt lgkmcnt(2)
    buffer_store_dwordx4 v[36:39], v17, s[8:11], s44 offen sc1
    s_add_u32 s44, s44, 16384
    s_waitcnt lgkmcnt(1)
    buffer_store_dwordx4 v[40:43], v17, s[8:11], s44 offen sc1
    s_add_u32 s44, s44, 16384
    s_waitcnt lgkmcnt(0)
    buffer_store_dwordx4 v[44:47], v17, s[8:11], s44 offen sc1
    s_endpgm
h_start:
    v_mov_b32 v20, 0
    v_mov_b32 v21, 0
    v_mov_b32 v22, 0
    v_mov_b32 v23, 0
    s_cmp_eq_u32 s2, 0
    s_cbranch_scc0 h_z0
    s_setprio 3
    s_load_dword s101, s[34:35], 192
    s_mov_b32 s44, 58720256
    buffer_store_dwordx4 v[20:23], v1, s[4:7], s44 offen offset:0 sc1
    buffer_store_dwordx4 v[20:23], v1, s[4:7], s44 offen offset:1024 sc1
    buffer_store_dwordx4 v[20:23], v1, s[4:7], s44 offen offset:2048 sc1
    buffer_store_dwordx4 v[20:23], v1, s[4:7], s44 offen offset:3072 sc1
    s_add_u32 s44, s44, 4096
    buffer_store_dwordx4 v[20:23], v1, s[4:7], s44 offen offset:0 sc1
    buffer_store_dwordx4 v[20:23], v1, s[4:7], s44 offen offset:1024 sc1
    buffer_store_dwordx4 v[20:23], v1, s[4:7], s44 offen offset:2048 sc1
    buffer_store_dwordx4 v[20:23], v1, s[4:7], s44 offen offset:3072 sc1
    s_add_u32 s44, s44, 4096
    buffer_store_dwordx4 v[20:23], v1, s[4:7], s44 offen offset:0 sc1
    buffer_store_dwordx4 v[20:23], v1, s[4:7], s44 offen offset:1024 sc1
    buffer_store_dwordx4 v[20:23], v1, s[4:7], s44 offen offset:2048 sc1
    buffer_store_dwordx4 v[20:23], v1, s[4:7], s44 offen offset:3072 sc1
    s_add_u32 s44, s44, 4096
    buffer_store_dwordx4 v[20:23], v1, s[4:7], s44 offen offset:0 sc1
    buffer_store_dwordx4 v[20:23], v1, s[4:7], s44 offen offset:1024 sc1
    buffer_store_dwordx4 v[20:23], v1, s[4:7], s44 offen offset:2048 sc1
    buffer_store_dwordx4 v[20:23], v1, s[4:7], s44 offen offset:3072 sc1
    s_add_u32 s44, s44, 4096
    buffer_store_dwordx4 v[20:23], v1, s[4:7], s44 offen offset:0 sc1
    buffer_store_dwordx4 v[20:23], v1, s[4:7], s44 offen offset:1024 sc1
    buffer_store_dwordx4 v[20:23], v1, s[4:7], s44 offen offset:2048 sc1
    buffer_store_dwordx4 v[20:23], v1, s[4:7], s44 offen offset:3072 sc1
    s_add_u32 s44, s44, 4096
    s_waitcnt vmcnt(0)
    s_atomic_add s40, s[34:35], 0
    s_setprio 0
h_z0:
    v_lshrrev_b32 v24, 4, v1
    v_lshrrev_b32 v25, 3, v24
    v_mul_u32_u24 v12, 6144, v25
    v_and_b32 v26, 2, v25
    v_lshrrev_b32 v25, 2, v25
    v_or_b32 v26, v26, v25
    v_bfe_u32 v25, v24, 1, 2
    v_xor_b32 v26, v26, v25
    v_lshl_add_u32 v12, v26, 5, v12
    v_and_b32 v26, 1, v24
    v_lshl_add_u32 v12, v26, 4, v12
    s_lshl_b32 s3, s18, 7
    v_add_u32 v12, s3, v12
    v_add_u32 v13, 48128, v12
    v_add_u32 v14, 96256, v12
    v_add_u32 v15, 144384, v12
    v_lshrrev_b32 v24, 4, v1
    v_lshrrev_b32 v25, 3, v24
    v_mul_u32_u24 v16, 2048, v25
    v_and_b32 v26, 2, v25
    v_lshrrev_b32 v25, 2, v25
    v_or_b32 v26, v26, v25
    v_bfe_u32 v25, v24, 1, 2
    v_xor_b32 v26, v26, v25
    v_lshl_add_u32 v16, v26, 5, v16
    v_and_b32 v26, 1, v24
    v_lshl_add_u32 v16, v26, 4, v16
    s_lshl_b32 s3, s20, 7
    v_add_u32 v16, s3, v16
    v_add_u32 v17, 15360, v16
    v_add_u32 v18, 30720, v16
    v_add_u32 v19, 46080, v16
    s_and_b32 s3, s16, 3
    s_lshl_b32 s3, s3, 10
    v_add_u32 v9, s3, v1
    v_add_u32 v10, 0x10000, v9
    v_lshrrev_b32 v24, 4, v1
    v_and_b32 v25, 15, v24
    v_lshrrev_b32 v24, 4, v24
    v_lshlrev_b32 v24, 2, v24
    v_sub_u32 v24, v25, v24
    v_mov_b32 v25, 0xf149f2ca
    v_add_u32 v26, 0x0, v24
    v_and_b32 v26, 0xfffffff1, v26
    v_cmp_eq_u32 vcc, 0, v26
    s_nop 1
    v_cndmask_b32 v32, v25, 0, vcc
    v_add_u32 v26, 0xffffffff, v24
    v_and_b32 v26, 0xfffffff1, v26
    v_cmp_eq_u32 vcc, 0, v26
    s_nop 1
    v_cndmask_b32 v33, v25, 0, vcc
    v_add_u32 v26, 0xfffffffe, v24
    v_and_b32 v26, 0xfffffff1, v26
    v_cmp_eq_u32 vcc, 0, v26
    s_nop 1
    v_cndmask_b32 v34, v25, 0, vcc
    v_add_u32 v26, 0xfffffffd, v24
    v_and_b32 v26, 0xfffffff1, v26
    v_cmp_eq_u32 vcc, 0, v26
    s_nop 1
    v_cndmask_b32 v35, v25, 0, vcc
    v_add_u32 v26, 0x10, v24
    v_and_b32 v26, 0xfffffff1, v26
    v_cmp_eq_u32 vcc, 0, v26
    s_nop 1
    v_cndmask_b32 v36, v25, 0, vcc
    v_add_u32 v26, 0xf, v24
    v_and_b32 v26, 0xfffffff1, v26
    v_cmp_eq_u32 vcc, 0, v26
    s_nop 1
    v_cndmask_b32 v37, v25, 0, vcc
    v_add_u32 v26, 0xe, v24
    v_and_b32 v26, 0xfffffff1, v26
    v_cmp_eq_u32 vcc, 0, v26
    s_nop 1
    v_cndmask_b32 v38, v25, 0, vcc
    v_add_u32 v26, 0xd, v24
    v_and_b32 v26, 0xfffffff1, v26
    v_cmp_eq_u32 vcc, 0, v26
    s_nop 1
    v_cndmask_b32 v39, v25, 0, vcc
    v_add_u32 v24, 153600, v1
    ds_write_b128 v24, v[32:35] offset:0
    ds_write_b128 v24, v[36:39] offset:1024
    s_barrier
    s_lshr_b32 s3, s2, 3
    s_cmp_eq_u32 s3, 1
    s_cbranch_scc0 h_layer
    s_mul_i32 s44, s2, 24576
    s_add_u32 s44, s44, 58544128
    s_mov_b32 s45, 24
    s_barrier
h_zloop:
    buffer_store_dwordx4 v[20:23], v1, s[4:7], s44 offen sc1
    s_add_u32 s44, s44, 1024
    s_sub_u32 s45, s45, 1
    s_cmp_lg_u32 s45, 0
    s_cbranch_scc1 h_zloop
    s_barrier
    s_waitcnt vmcnt(0)
    s_atomic_add s40, s[34:35], 128
    s_branch h_g2
h_layer:
    s_waitcnt lgkmcnt(0)
    s_barrier
    s_barrier
h_g2:
    s_lshl_b32 s44, s21, 14
    s_lshl_b32 s67, s17, 9
    s_add_u32 s44, s44, s67
    s_add_u32 s44, s44, 12288
    s_mov_b32 s66, 0x10000
h_s_poll:
    s_mov_b32 s68, 0
    s_mov_b32 s69, 0
    s_mov_b32 s70, 0
    s_mov_b32 s71, 0
    s_atomic_add s68, s[22:23], s44 offset:0 glc
    s_atomic_add s69, s[22:23], s44 offset:128 glc
    s_atomic_add s70, s[22:23], s44 offset:256 glc
    s_atomic_add s71, s[22:23], s44 offset:384 glc
    s_waitcnt lgkmcnt(0)
    s_and_b32 s68, s68, s69
    s_and_b32 s68, s68, s70
    s_and_b32 s68, s68, s71
    s_cmp_eq_u32 s68, 16
    s_cbranch_scc1 h_s_ok
    s_sub_u32 s66, s66, 1
    s_cmp_lg_u32 s66, 0
    s_cbranch_scc1 h_s_poll
h_s_ok:
    s_barrier
    s_lshl_b32 s44, s21, 18
    s_lshl_b32 s45, s17, 14
    s_add_u32 s44, s44, s45
    s_add_u32 s44, s44, 50331648
    buffer_load_dwordx4 v[32:35], v1, s[4:7], s44 offen offset:0 sc1
    buffer_load_dwordx4 v[36:39], v1, s[4:7], s44 offen offset:1024 sc1
    buffer_load_dwordx4 v[40:43], v1, s[4:7], s44 offen offset:2048 sc1
    buffer_load_dwordx4 v[44:47], v1, s[4:7], s44 offen offset:3072 sc1
    s_add_u32 s44, s44, 4096
    buffer_load_dwordx4 v[48:51], v1, s[4:7], s44 offen offset:0 sc1
    buffer_load_dwordx4 v[52:55], v1, s[4:7], s44 offen offset:1024 sc1
    buffer_load_dwordx4 v[56:59], v1, s[4:7], s44 offen offset:2048 sc1
    buffer_load_dwordx4 v[60:63], v1, s[4:7], s44 offen offset:3072 sc1
    s_add_u32 s44, s44, 4096
    buffer_load_dwordx4 v[64:67], v1, s[4:7], s44 offen offset:0 sc1
    buffer_load_dwordx4 v[68:71], v1, s[4:7], s44 offen offset:1024 sc1
    buffer_load_dwordx4 v[72:75], v1, s[4:7], s44 offen offset:2048 sc1
    buffer_load_dwordx4 v[76:79], v1, s[4:7], s44 offen offset:3072 sc1
    s_add_u32 s44, s44, 4096
    buffer_load_dwordx4 v[80:83], v1, s[4:7], s44 offen offset:0 sc1
    buffer_load_dwordx4 v[84:87], v1, s[4:7], s44 offen offset:1024 sc1
    buffer_load_dwordx4 v[88:91], v1, s[4:7], s44 offen offset:2048 sc1
    buffer_load_dwordx4 v[92:95], v1, s[4:7], s44 offen offset:3072 sc1
    s_barrier
    s_cmp_ge_u32 s21, 2
    s_cbranch_scc1 h_nocs
    s_barrier
    s_lshl_b32 s44, s21, 11
    s_lshl_b32 s67, s18, 7
    s_add_u32 s44, s44, s67
    s_add_u32 s44, s44, 0
    s_mov_b32 s66, 0x10000
h_c_poll:
    s_mov_b32 s68, 0
    s_atomic_add s68, s[22:23], s44 offset:0 glc
    s_waitcnt lgkmcnt(0)
    s_cmp_eq_u32 s68, 16
    s_cbranch_scc1 h_c_ok
    s_sub_u32 s66, s66, 1
    s_cmp_lg_u32 s66, 0
    s_cbranch_scc1 h_c_poll
h_c_ok:
    s_barrier
    s_lshl_b32 s44, s21, 18
    s_lshl_b32 s45, s18, 14
    s_add_u32 s44, s44, s45
    s_add_u32 s44, s44, 52428800
    buffer_load_dwordx4 v[96:99], v1, s[4:7], s44 offen offset:0 sc1
    buffer_load_dwordx4 v[100:103], v1, s[4:7], s44 offen offset:1024 sc1
    buffer_load_dwordx4 v[104:107], v1, s[4:7], s44 offen offset:2048 sc1
    buffer_load_dwordx4 v[108:111], v1, s[4:7], s44 offen offset:3072 sc1
    s_add_u32 s44, s44, 4096
    buffer_load_dwordx4 v[112:115], v1, s[4:7], s44 offen offset:0 sc1
    buffer_load_dwordx4 v[116:119], v1, s[4:7], s44 offen offset:1024 sc1
    buffer_load_dwordx4 v[120:123], v1, s[4:7], s44 offen offset:2048 sc1
    buffer_load_dwordx4 v[124:127], v1, s[4:7], s44 offen offset:3072 sc1
    s_add_u32 s44, s44, 4096
    buffer_load_dwordx4 v[128:131], v1, s[4:7], s44 offen offset:0 sc1
    buffer_load_dwordx4 v[132:135], v1, s[4:7], s44 offen offset:1024 sc1
    buffer_load_dwordx4 v[136:139], v1, s[4:7], s44 offen offset:2048 sc1
    buffer_load_dwordx4 v[140:143], v1, s[4:7], s44 offen offset:3072 sc1
    s_add_u32 s44, s44, 4096
    buffer_load_dwordx4 v[144:147], v1, s[4:7], s44 offen offset:0 sc1
    buffer_load_dwordx4 v[148:151], v1, s[4:7], s44 offen offset:1024 sc1
    buffer_load_dwordx4 v[152:155], v1, s[4:7], s44 offen offset:2048 sc1
    buffer_load_dwordx4 v[156:159], v1, s[4:7], s44 offen offset:3072 sc1
    s_waitcnt vmcnt(16)
    s_branch h_cs1
h_nocs:
    s_barrier
    s_barrier
    s_waitcnt vmcnt(0)
h_cs1:
    v_add_f32 v32, v32, v36
    v_add_f32 v33, v33, v37
    v_add_f32 v34, v34, v38
    v_add_f32 v35, v35, v39
    v_add_f32 v48, v48, v52
    v_add_f32 v49, v49, v53
    v_add_f32 v50, v50, v54
    v_add_f32 v51, v51, v55
    v_add_f32 v64, v64, v68
    v_add_f32 v65, v65, v69
    v_add_f32 v66, v66, v70
    v_add_f32 v67, v67, v71
    v_add_f32 v80, v80, v84
    v_add_f32 v81, v81, v85
    v_add_f32 v82, v82, v86
    v_add_f32 v83, v83, v87
    v_add_f32 v32, v32, v40
    v_add_f32 v33, v33, v41
    v_add_f32 v34, v34, v42
    v_add_f32 v35, v35, v43
    v_add_f32 v48, v48, v56
    v_add_f32 v49, v49, v57
    v_add_f32 v50, v50, v58
    v_add_f32 v51, v51, v59
    v_add_f32 v64, v64, v72
    v_add_f32 v65, v65, v73
    v_add_f32 v66, v66, v74
    v_add_f32 v67, v67, v75
    v_add_f32 v80, v80, v88
    v_add_f32 v81, v81, v89
    v_add_f32 v82, v82, v90
    v_add_f32 v83, v83, v91
    v_add_f32 v32, v32, v44
    v_add_f32 v33, v33, v45
    v_add_f32 v34, v34, v46
    v_add_f32 v35, v35, v47
    v_add_f32 v48, v48, v60
    v_add_f32 v49, v49, v61
    v_add_f32 v50, v50, v62
    v_add_f32 v51, v51, v63
    v_add_f32 v64, v64, v76
    v_add_f32 v65, v65, v77
    v_add_f32 v66, v66, v78
    v_add_f32 v67, v67, v79
    v_add_f32 v80, v80, v92
    v_add_f32 v81, v81, v93
    v_add_f32 v82, v82, v94
    v_add_f32 v83, v83, v95
    s_barrier
    v_permlane32_swap_b32 v32, v64
    v_permlane32_swap_b32 v33, v65
    v_permlane32_swap_b32 v34, v66
    v_permlane32_swap_b32 v35, v67
    v_add_f32 v32, v32, v64
    v_add_f32 v33, v33, v65
    v_add_f32 v34, v34, v66
    v_add_f32 v35, v35, v67
    v_permlane32_swap_b32 v48, v80
    v_permlane32_swap_b32 v49, v81
    v_permlane32_swap_b32 v50, v82
    v_permlane32_swap_b32 v51, v83
    v_add_f32 v48, v48, v80
    v_add_f32 v49, v49, v81
    v_add_f32 v50, v50, v82
    v_add_f32 v51, v51, v83
    v_permlane16_swap_b32 v32, v48
    v_permlane16_swap_b32 v33, v49
    v_permlane16_swap_b32 v34, v50
    v_permlane16_swap_b32 v35, v51
    v_add_f32 v32, v32, v48
    v_add_f32 v33, v33, v49
    v_add_f32 v34, v34, v50
    v_add_f32 v35, v35, v51
    s_barrier
    v_mul_f32 v32, 0x3a800000, v32
    v_mul_f32 v33, 0x3a800000, v33
    v_mul_f32 v34, 0x3a800000, v34
    v_mul_f32 v35, 0x3a800000, v35
    v_fma_f32 v33, -v32, v32, v33
    v_max_f32 v33, 0, v33
    v_add_f32 v33, 0x3727c5ac, v33
    v_rsq_f32 v33, v33
    v_fma_f32 v35, -v34, v34, v35
    v_max_f32 v35, 0, v35
    v_add_f32 v35, 0x3727c5ac, v35
    v_rsq_f32 v35, v35
    v_lshrrev_b32 v26, 1, v1
    v_add_u32 v26, 155648, v26
    ds_write2_b32 v26, v32, v34 offset0:0 offset1:1
    ds_write2_b32 v26, v33, v35 offset0:128 offset1:129
    s_barrier
    s_cmp_ge_u32 s21, 2
    s_cbranch_scc1 h_cs_done
    s_waitcnt vmcnt(0)
    v_add_f32 v96, v96, v100
    v_add_f32 v97, v97, v101
    v_add_f32 v98, v98, v102
    v_add_f32 v99, v99, v103
    v_add_f32 v96, v96, v104
    v_add_f32 v97, v97, v105
    v_add_f32 v98, v98, v106
    v_add_f32 v99, v99, v107
    v_add_f32 v96, v96, v108
    v_add_f32 v97, v97, v109
    v_add_f32 v98, v98, v110
    v_add_f32 v99, v99, v111
    v_add_f32 v96, v96, v112
    v_add_f32 v97, v97, v113
    v_add_f32 v98, v98, v114
    v_add_f32 v99, v99, v115
    v_add_f32 v96, v96, v116
    v_add_f32 v97, v97, v117
    v_add_f32 v98, v98, v118
    v_add_f32 v99, v99, v119
    v_add_f32 v96, v96, v120
    v_add_f32 v97, v97, v121
    v_add_f32 v98, v98, v122
    v_add_f32 v99, v99, v123
    v_add_f32 v96, v96, v124
    v_add_f32 v97, v97, v125
    v_add_f32 v98, v98, v126
    v_add_f32 v99, v99, v127
    v_add_f32 v96, v96, v128
    v_add_f32 v97, v97, v129
    v_add_f32 v98, v98, v130
    v_add_f32 v99, v99, v131
    v_add_f32 v96, v96, v132
    v_add_f32 v97, v97, v133
    v_add_f32 v98, v98, v134
    v_add_f32 v99, v99, v135
    v_add_f32 v96, v96, v136
    v_add_f32 v97, v97, v137
    v_add_f32 v98, v98, v138
    v_add_f32 v99, v99, v139
    v_add_f32 v96, v96, v140
    v_add_f32 v97, v97, v141
    v_add_f32 v98, v98, v142
    v_add_f32 v99, v99, v143
    v_add_f32 v96, v96, v144
    v_add_f32 v97, v97, v145
    v_add_f32 v98, v98, v146
    v_add_f32 v99, v99, v147
    v_add_f32 v96, v96, v148
    v_add_f32 v97, v97, v149
    v_add_f32 v98, v98, v150
    v_add_f32 v99, v99, v151
    v_add_f32 v96, v96, v152
    v_add_f32 v97, v97, v153
    v_add_f32 v98, v98, v154
    v_add_f32 v99, v99, v155
    v_add_f32 v96, v96, v156
    v_add_f32 v97, v97, v157
    v_add_f32 v98, v98, v158
    v_add_f32 v99, v99, v159
    s_lshl_b32 s44, s21, 10
    s_add_u32 s44, s44, 151552
    v_add_u32 v24, s44, v1
    ds_write_b128 v24, v[96:99]
h_cs_done:
    s_setprio 0
    s_cmp_lg_u32 s21, 0
    s_cbranch_scc1 h_f1_ok
    s_load_dword s68, s[34:35], 128
    s_mov_b32 s8, s34
    s_mov_b32 s9, s35
    s_mov_b32 s10, 256
    s_mov_b32 s11, 0x00020000
    s_mov_b32 s66, 0x10000
    v_mov_b32 v24, 0
    s_waitcnt lgkmcnt(0)
h_f1:
    s_cmp_eq_u32 s68, 8
    s_cbranch_scc1 h_f1_ok
    buffer_load_dword v25, v24, s[8:11], 0 offen offset:128 sc1
    s_waitcnt vmcnt(0)
    v_readfirstlane_b32 s68, v25
    s_sub_u32 s66, s66, 1
    s_cmp_lg_u32 s66, 0
    s_cbranch_scc1 h_f1
h_f1_ok:
    s_barrier
    s_waitcnt lgkmcnt(0)
    s_barrier
    s_barrier
    s_bitcmp1_b32 s21, 0
    s_cselect_b32 s8, s28, s24
    s_cselect_b32 s9, s29, s25
    s_cselect_b32 s12, s30, s26
    s_cselect_b32 s13, s31, s27
    s_mov_b32 s10, 6291456
    s_mov_b32 s11, 0x00020000
    s_mov_b32 s14, 2097152
    s_mov_b32 s15, 0x00020000
    s_branch s_tail
l_start:
    v_lshrrev_b32 v24, 4, v1
    v_lshrrev_b32 v25, 3, v24
    v_mul_u32_u24 v12, 6144, v25
    v_and_b32 v26, 2, v25
    v_lshrrev_b32 v25, 2, v25
    v_or_b32 v26, v26, v25
    v_bfe_u32 v25, v24, 1, 2
    v_xor_b32 v26, v26, v25
    v_lshl_add_u32 v12, v26, 5, v12
    v_and_b32 v26, 1, v24
    v_lshl_add_u32 v12, v26, 4, v12
    s_lshl_b32 s3, s18, 7
    v_add_u32 v12, s3, v12
    v_add_u32 v13, 48128, v12
    v_add_u32 v14, 96256, v12
    v_add_u32 v15, 144384, v12
    v_lshrrev_b32 v24, 4, v1
    v_lshrrev_b32 v25, 3, v24
    v_mul_u32_u24 v16, 2048, v25
    v_and_b32 v26, 2, v25
    v_lshrrev_b32 v25, 2, v25
    v_or_b32 v26, v26, v25
    v_bfe_u32 v25, v24, 1, 2
    v_xor_b32 v26, v26, v25
    v_lshl_add_u32 v16, v26, 5, v16
    v_and_b32 v26, 1, v24
    v_lshl_add_u32 v16, v26, 4, v16
    s_lshl_b32 s3, s20, 7
    v_add_u32 v16, s3, v16
    v_add_u32 v17, 15360, v16
    v_add_u32 v18, 30720, v16
    v_add_u32 v19, 46080, v16
    s_and_b32 s3, s16, 3
    s_lshl_b32 s3, s3, 10
    v_add_u32 v9, s3, v1
    v_add_u32 v10, 0x10000, v9
    s_sub_u32 s3, s16, 5
    s_lshl_b32 s41, s3, 11
    s_mul_i32 s42, s3, 98304
    s_lshl_b32 s62, s3, 15
    s_barrier
    s_bitcmp1_b32 s21, 0
    s_cselect_b32 s8, s28, s24
    s_cselect_b32 s9, s29, s25
    s_cselect_b32 s12, s30, s26
    s_cselect_b32 s13, s31, s27
    s_mov_b32 s10, 6291456
    s_mov_b32 s11, 0x00020000
    s_mov_b32 s14, 2097152
    s_mov_b32 s15, 0x00020000
    s_add_u32 m0, s41, 0
    s_add_u32 s44, s42, 2048
    buffer_load_dwordx4 v12, s[8:11], s44 offen offset:0 lds
    buffer_load_dwordx4 v13, s[8:11], s44 offen offset:1024 lds
    s_add_u32 m0, s41, 4096
    s_add_u32 s44, s42, 4096
    buffer_load_dwordx4 v12, s[8:11], s44 offen offset:0 lds
    buffer_load_dwordx4 v13, s[8:11], s44 offen offset:1024 lds
    s_add_u32 m0, s41, 8192
    s_add_u32 s44, s42, 0
    buffer_load_dwordx4 v12, s[8:11], s44 offen offset:0 lds
    buffer_load_dwordx4 v13, s[8:11], s44 offen offset:1024 lds
    s_add_u32 m0, s41, 12288
    s_add_u32 s44, s42, 198656
    buffer_load_dwordx4 v12, s[8:11], s44 offen offset:0 lds
    buffer_load_dwordx4 v13, s[8:11], s44 offen offset:1024 lds
    s_add_u32 m0, s41, 16384
    s_add_u32 s44, s42, 200704
    buffer_load_dwordx4 v12, s[8:11], s44 offen offset:0 lds
    buffer_load_dwordx4 v13, s[8:11], s44 offen offset:1024 lds
    s_add_u32 m0, s41, 20480
    s_add_u32 s44, s42, 196608
    buffer_load_dwordx4 v12, s[8:11], s44 offen offset:0 lds
    buffer_load_dwordx4 v13, s[8:11], s44 offen offset:1024 lds
    s_add_u32 m0, s41, 24576
    s_add_u32 s44, s42, 395264
    buffer_load_dwordx4 v12, s[8:11], s44 offen offset:0 lds
    buffer_load_dwordx4 v13, s[8:11], s44 offen offset:1024 lds
    s_add_u32 m0, s41, 28672
    s_add_u32 s44, s42, 397312
    buffer_load_dwordx4 v12, s[8:11], s44 offen offset:0 lds
    buffer_load_dwordx4 v13, s[8:11], s44 offen offset:1024 lds
    s_add_u32 m0, s41, 32768
    s_add_u32 s44, s42, 393216
    buffer_load_dwordx4 v12, s[8:11], s44 offen offset:0 lds
    buffer_load_dwordx4 v13, s[8:11], s44 offen offset:1024 lds
    s_add_u32 m0, s41, 36864
    s_add_u32 s44, s42, 591872
    buffer_load_dwordx4 v12, s[8:11], s44 offen offset:0 lds
    buffer_load_dwordx4 v13, s[8:11], s44 offen offset:1024 lds
    s_add_u32 m0, s41, 40960
    s_add_u32 s44, s42, 593920
    buffer_load_dwordx4 v12, s[8:11], s44 offen offset:0 lds
    buffer_load_dwordx4 v13, s[8:11], s44 offen offset:1024 lds
    s_add_u32 m0, s41, 45056
    s_add_u32 s44, s42, 589824
    buffer_load_dwordx4 v12, s[8:11], s44 offen offset:0 lds
    buffer_load_dwordx4 v13, s[8:11], s44 offen offset:1024 lds
    s_add_u32 m0, s41, 49152
    s_add_u32 s44, s42, 788480
    buffer_load_dwordx4 v12, s[8:11], s44 offen offset:0 lds
    buffer_load_dwordx4 v13, s[8:11], s44 offen offset:1024 lds
    s_add_u32 m0, s41, 53248
    s_add_u32 s44, s42, 790528
    buffer_load_dwordx4 v12, s[8:11], s44 offen offset:0 lds
    buffer_load_dwordx4 v13, s[8:11], s44 offen offset:1024 lds
    s_add_u32 m0, s41, 57344
    s_add_u32 s44, s42, 786432
    buffer_load_dwordx4 v12, s[8:11], s44 offen offset:0 lds
    buffer_load_dwordx4 v13, s[8:11], s44 offen offset:1024 lds
    s_add_u32 m0, s41, 61440
    s_add_u32 s44, s42, 985088
    buffer_load_dwordx4 v12, s[8:11], s44 offen offset:0 lds
    buffer_load_dwordx4 v13, s[8:11], s44 offen offset:1024 lds
    s_waitcnt vmcnt(16)
    s_barrier
    s_add_u32 m0, s41, 65536
    s_add_u32 s44, s42, 987136
    buffer_load_dwordx4 v12, s[8:11], s44 offen offset:0 lds
    buffer_load_dwordx4 v13, s[8:11], s44 offen offset:1024 lds
    s_add_u32 m0, s41, 69632
    s_add_u32 s44, s42, 983040
    buffer_load_dwordx4 v12, s[8:11], s44 offen offset:0 lds
    buffer_load_dwordx4 v13, s[8:11], s44 offen offset:1024 lds
    s_add_u32 m0, s41, 73728
    s_add_u32 s44, s42, 1181696
    buffer_load_dwordx4 v12, s[8:11], s44 offen offset:0 lds
    buffer_load_dwordx4 v13, s[8:11], s44 offen offset:1024 lds
    s_add_u32 m0, s41, 77824
    s_add_u32 s44, s42, 1183744
    buffer_load_dwordx4 v12, s[8:11], s44 offen offset:0 lds
    buffer_load_dwordx4 v13, s[8:11], s44 offen offset:1024 lds
    s_add_u32 m0, s41, 81920
    s_add_u32 s44, s42, 1179648
    buffer_load_dwordx4 v12, s[8:11], s44 offen offset:0 lds
    buffer_load_dwordx4 v13, s[8:11], s44 offen offset:1024 lds
    s_add_u32 m0, s41, 86016
    s_add_u32 s44, s42, 1378304
    buffer_load_dwordx4 v12, s[8:11], s44 offen offset:0 lds
    buffer_load_dwordx4 v13, s[8:11], s44 offen offset:1024 lds
    s_add_u32 m0, s41, 90112
    s_add_u32 s44, s42, 1380352
    buffer_load_dwordx4 v12, s[8:11], s44 offen offset:0 lds
    buffer_load_dwordx4 v13, s[8:11], s44 offen offset:1024 lds
    s_add_u32 m0, s41, 94208
    s_add_u32 s44, s42, 1376256
    buffer_load_dwordx4 v12, s[8:11], s44 offen offset:0 lds
    buffer_load_dwordx4 v13, s[8:11], s44 offen offset:1024 lds
    s_waitcnt vmcnt(16)
    s_barrier
    s_add_u32 m0, s41, 98304
    s_add_u32 s44, s42, 1574912
    buffer_load_dwordx4 v12, s[8:11], s44 offen offset:0 lds
    buffer_load_dwordx4 v13, s[8:11], s44 offen offset:1024 lds
    s_add_u32 m0, s41, 102400
    s_add_u32 s44, s42, 1576960
    buffer_load_dwordx4 v12, s[8:11], s44 offen offset:0 lds
    buffer_load_dwordx4 v13, s[8:11], s44 offen offset:1024 lds
    s_add_u32 m0, s41, 106496
    s_add_u32 s44, s42, 1572864
    buffer_load_dwordx4 v12, s[8:11], s44 offen offset:0 lds
    buffer_load_dwordx4 v13, s[8:11], s44 offen offset:1024 lds
    s_add_u32 m0, s41, 110592
    s_add_u32 s44, s42, 1771520
    buffer_load_dwordx4 v12, s[8:11], s44 offen offset:0 lds
    buffer_load_dwordx4 v13, s[8:11], s44 offen offset:1024 lds
    s_add_u32 m0, s41, 114688
    s_add_u32 s44, s42, 1773568
    buffer_load_dwordx4 v12, s[8:11], s44 offen offset:0 lds
    buffer_load_dwordx4 v13, s[8:11], s44 offen offset:1024 lds
    s_add_u32 m0, s41, 118784
    s_add_u32 s44, s42, 1769472
    buffer_load_dwordx4 v12, s[8:11], s44 offen offset:0 lds
    buffer_load_dwordx4 v13, s[8:11], s44 offen offset:1024 lds
    s_add_u32 m0, s41, 122880
    s_add_u32 s44, s42, 1968128
    buffer_load_dwordx4 v12, s[8:11], s44 offen offset:0 lds
    buffer_load_dwordx4 v13, s[8:11], s44 offen offset:1024 lds
    s_add_u32 m0, s41, 126976
    s_add_u32 s44, s42, 1970176
    buffer_load_dwordx4 v12, s[8:11], s44 offen offset:0 lds
    buffer_load_dwordx4 v13, s[8:11], s44 offen offset:1024 lds
    s_add_u32 m0, s41, 0
    s_add_u32 s44, s42, 1966080
    buffer_load_dwordx4 v12, s[8:11], s44 offen offset:0 lds
    buffer_load_dwordx4 v13, s[8:11], s44 offen offset:1024 lds
    s_add_u32 m0, s41, 4096
    s_add_u32 s44, s42, 2164736
    buffer_load_dwordx4 v12, s[8:11], s44 offen offset:0 lds
    buffer_load_dwordx4 v13, s[8:11], s44 offen offset:1024 lds
    s_add_u32 m0, s41, 8192
    s_add_u32 s44, s42, 2166784
    buffer_load_dwordx4 v12, s[8:11], s44 offen offset:0 lds
    buffer_load_dwordx4 v13, s[8:11], s44 offen offset:1024 lds
    s_add_u32 m0, s41, 12288
    s_add_u32 s44, s42, 2162688
    buffer_load_dwordx4 v12, s[8:11], s44 offen offset:0 lds
    buffer_load_dwordx4 v13, s[8:11], s44 offen offset:1024 lds
    s_waitcnt vmcnt(24)
    s_branch l_join
l_layer:
    s_bitcmp1_b32 s21, 0
    s_cselect_b32 s8, s28, s24
    s_cselect_b32 s9, s29, s25
    s_cselect_b32 s12, s30, s26
    s_cselect_b32 s13, s31, s27
    s_mov_b32 s10, 6291456
    s_mov_b32 s11, 0x00020000
    s_mov_b32 s14, 2097152
    s_mov_b32 s15, 0x00020000
    s_add_u32 m0, s41, 98304
    s_add_u32 s44, s42, 1574912
    buffer_load_dwordx4 v12, s[8:11], s44 offen offset:0 lds
    buffer_load_dwordx4 v13, s[8:11], s44 offen offset:1024 lds
    s_add_u32 m0, s41, 102400
    s_add_u32 s44, s42, 1576960
    buffer_load_dwordx4 v12, s[8:11], s44 offen offset:0 lds
    buffer_load_dwordx4 v13, s[8:11], s44 offen offset:1024 lds
    s_add_u32 m0, s41, 106496
    s_add_u32 s44, s42, 1572864
    buffer_load_dwordx4 v12, s[8:11], s44 offen offset:0 lds
    buffer_load_dwordx4 v13, s[8:11], s44 offen offset:1024 lds
    s_add_u32 m0, s41, 110592
    s_add_u32 s44, s42, 1771520
    buffer_load_dwordx4 v12, s[8:11], s44 offen offset:0 lds
    buffer_load_dwordx4 v13, s[8:11], s44 offen offset:1024 lds
    s_add_u32 m0, s41, 114688
    s_add_u32 s44, s42, 1773568
    buffer_load_dwordx4 v12, s[8:11], s44 offen offset:0 lds
    buffer_load_dwordx4 v13, s[8:11], s44 offen offset:1024 lds
    s_add_u32 m0, s41, 118784
    s_add_u32 s44, s42, 1769472
    buffer_load_dwordx4 v12, s[8:11], s44 offen offset:0 lds
    buffer_load_dwordx4 v13, s[8:11], s44 offen offset:1024 lds
    s_add_u32 m0, s41, 122880
    s_add_u32 s44, s42, 1968128
    buffer_load_dwordx4 v12, s[8:11], s44 offen offset:0 lds
    buffer_load_dwordx4 v13, s[8:11], s44 offen offset:1024 lds
    s_add_u32 m0, s41, 126976
    s_add_u32 s44, s42, 1970176
    buffer_load_dwordx4 v12, s[8:11], s44 offen offset:0 lds
    buffer_load_dwordx4 v13, s[8:11], s44 offen offset:1024 lds
    s_waitcnt lgkmcnt(0)
    s_barrier
    s_barrier
    s_add_u32 m0, s41, 0
    s_add_u32 s44, s42, 1966080
    buffer_load_dwordx4 v12, s[8:11], s44 offen offset:0 lds
    buffer_load_dwordx4 v13, s[8:11], s44 offen offset:1024 lds
    s_add_u32 m0, s41, 4096
    s_add_u32 s44, s42, 2164736
    buffer_load_dwordx4 v12, s[8:11], s44 offen offset:0 lds
    buffer_load_dwordx4 v13, s[8:11], s44 offen offset:1024 lds
    s_add_u32 m0, s41, 8192
    s_add_u32 s44, s42, 2166784
    buffer_load_dwordx4 v12, s[8:11], s44 offen offset:0 lds
    buffer_load_dwordx4 v13, s[8:11], s44 offen offset:1024 lds
    s_add_u32 m0, s41, 12288
    s_add_u32 s44, s42, 2162688
    buffer_load_dwordx4 v12, s[8:11], s44 offen offset:0 lds
    buffer_load_dwordx4 v13, s[8:11], s44 offen offset:1024 lds
l_join:
    s_barrier
    s_add_u32 m0, s41, 16384
    s_add_u32 s44, s42, 2361344
    buffer_load_dwordx4 v12, s[8:11], s44 offen offset:0 lds
    buffer_load_dwordx4 v13, s[8:11], s44 offen offset:1024 lds
    s_add_u32 m0, s41, 20480
    s_add_u32 s44, s42, 2363392
    buffer_load_dwordx4 v12, s[8:11], s44 offen offset:0 lds
    buffer_load_dwordx4 v13, s[8:11], s44 offen offset:1024 lds
    s_add_u32 m0, s41, 24576
    s_add_u32 s44, s42, 2359296
    buffer_load_dwordx4 v12, s[8:11], s44 offen offset:0 lds
    buffer_load_dwordx4 v13, s[8:11], s44 offen offset:1024 lds
    s_add_u32 m0, s41, 28672
    s_add_u32 s44, s42, 2557952
    buffer_load_dwordx4 v12, s[8:11], s44 offen offset:0 lds
    buffer_load_dwordx4 v13, s[8:11], s44 offen offset:1024 lds
    s_waitcnt vmcnt(16)
    s_barrier
    s_add_u32 m0, s41, 32768
    s_add_u32 s44, s42, 2560000
    buffer_load_dwordx4 v12, s[8:11], s44 offen offset:0 lds
    buffer_load_dwordx4 v13, s[8:11], s44 offen offset:1024 lds
    s_add_u32 m0, s41, 36864
    s_add_u32 s44, s42, 2555904
    buffer_load_dwordx4 v12, s[8:11], s44 offen offset:0 lds
    buffer_load_dwordx4 v13, s[8:11], s44 offen offset:1024 lds
    s_add_u32 m0, s41, 40960
    s_add_u32 s44, s42, 2754560
    buffer_load_dwordx4 v12, s[8:11], s44 offen offset:0 lds
    buffer_load_dwordx4 v13, s[8:11], s44 offen offset:1024 lds
    s_add_u32 m0, s41, 45056
    s_add_u32 s44, s42, 2756608
    buffer_load_dwordx4 v12, s[8:11], s44 offen offset:0 lds
    buffer_load_dwordx4 v13, s[8:11], s44 offen offset:1024 lds
    s_add_u32 m0, s41, 49152
    s_add_u32 s44, s42, 2752512
    buffer_load_dwordx4 v12, s[8:11], s44 offen offset:0 lds
    buffer_load_dwordx4 v13, s[8:11], s44 offen offset:1024 lds
    s_add_u32 m0, s41, 53248
    s_add_u32 s44, s42, 2951168
    buffer_load_dwordx4 v12, s[8:11], s44 offen offset:0 lds
    buffer_load_dwordx4 v13, s[8:11], s44 offen offset:1024 lds
    s_add_u32 m0, s41, 57344
    s_add_u32 s44, s42, 2953216
    buffer_load_dwordx4 v12, s[8:11], s44 offen offset:0 lds
    buffer_load_dwordx4 v13, s[8:11], s44 offen offset:1024 lds
    s_add_u32 m0, s41, 61440
    s_add_u32 s44, s42, 2949120
    buffer_load_dwordx4 v12, s[8:11], s44 offen offset:0 lds
    buffer_load_dwordx4 v13, s[8:11], s44 offen offset:1024 lds
    s_waitcnt vmcnt(16)
    s_barrier
    s_add_u32 m0, s41, 65536
    s_add_u32 s44, s42, 3147776
    buffer_load_dwordx4 v12, s[8:11], s44 offen offset:0 lds
    buffer_load_dwordx4 v13, s[8:11], s44 offen offset:1024 lds
    s_add_u32 m0, s41, 69632
    s_add_u32 s44, s42, 3149824
    buffer_load_dwordx4 v12, s[8:11], s44 offen offset:0 lds
    buffer_load_dwordx4 v13, s[8:11], s44 offen offset:1024 lds
    s_add_u32 m0, s41, 73728
    s_add_u32 s44, s42, 3145728
    buffer_load_dwordx4 v12, s[8:11], s44 offen offset:0 lds
    buffer_load_dwordx4 v13, s[8:11], s44 offen offset:1024 lds
    s_add_u32 m0, s41, 77824
    s_add_u32 s44, s42, 3344384
    buffer_load_dwordx4 v12, s[8:11], s44 offen offset:0 lds
    buffer_load_dwordx4 v13, s[8:11], s44 offen offset:1024 lds
    s_add_u32 m0, s41, 81920
    s_add_u32 s44, s42, 3346432
    buffer_load_dwordx4 v12, s[8:11], s44 offen offset:0 lds
    buffer_load_dwordx4 v13, s[8:11], s44 offen offset:1024 lds
    s_add_u32 m0, s41, 86016
    s_add_u32 s44, s42, 3342336
    buffer_load_dwordx4 v12, s[8:11], s44 offen offset:0 lds
    buffer_load_dwordx4 v13, s[8:11], s44 offen offset:1024 lds
    s_add_u32 m0, s41, 90112
    s_add_u32 s44, s42, 3540992
    buffer_load_dwordx4 v12, s[8:11], s44 offen offset:0 lds
    buffer_load_dwordx4 v13, s[8:11], s44 offen offset:1024 lds
    s_add_u32 m0, s41, 94208
    s_add_u32 s44, s42, 3543040
    buffer_load_dwordx4 v12, s[8:11], s44 offen offset:0 lds
    buffer_load_dwordx4 v13, s[8:11], s44 offen offset:1024 lds
    s_waitcnt vmcnt(16)
    s_barrier
    s_add_u32 m0, s41, 98304
    s_add_u32 s44, s42, 3538944
    buffer_load_dwordx4 v12, s[8:11], s44 offen offset:0 lds
    buffer_load_dwordx4 v13, s[8:11], s44 offen offset:1024 lds
    s_add_u32 m0, s41, 102400
    s_add_u32 s44, s42, 3737600
    buffer_load_dwordx4 v12, s[8:11], s44 offen offset:0 lds
    buffer_load_dwordx4 v13, s[8:11], s44 offen offset:1024 lds
    s_add_u32 m0, s41, 106496
    s_add_u32 s44, s42, 3739648
    buffer_load_dwordx4 v12, s[8:11], s44 offen offset:0 lds
    buffer_load_dwordx4 v13, s[8:11], s44 offen offset:1024 lds
    s_add_u32 m0, s41, 110592
    s_add_u32 s44, s42, 3735552
    buffer_load_dwordx4 v12, s[8:11], s44 offen offset:0 lds
    buffer_load_dwordx4 v13, s[8:11], s44 offen offset:1024 lds
    s_add_u32 m0, s41, 114688
    s_add_u32 s44, s42, 3934208
    buffer_load_dwordx4 v12, s[8:11], s44 offen offset:0 lds
    buffer_load_dwordx4 v13, s[8:11], s44 offen offset:1024 lds
    s_add_u32 m0, s41, 118784
    s_add_u32 s44, s42, 3936256
    buffer_load_dwordx4 v12, s[8:11], s44 offen offset:0 lds
    buffer_load_dwordx4 v13, s[8:11], s44 offen offset:1024 lds
    s_add_u32 m0, s41, 122880
    s_add_u32 s44, s42, 4130816
    buffer_load_dwordx4 v12, s[8:11], s44 offen offset:0 lds
    buffer_load_dwordx4 v13, s[8:11], s44 offen offset:1024 lds
    s_add_u32 m0, s41, 126976
    s_add_u32 s44, s42, 4132864
    buffer_load_dwordx4 v12, s[8:11], s44 offen offset:0 lds
    buffer_load_dwordx4 v13, s[8:11], s44 offen offset:1024 lds
    s_waitcnt vmcnt(16)
    s_barrier
    s_add_u32 m0, s41, 0
    s_add_u32 s44, s42, 4327424
    buffer_load_dwordx4 v12, s[8:11], s44 offen offset:0 lds
    buffer_load_dwordx4 v13, s[8:11], s44 offen offset:1024 lds
    s_add_u32 m0, s41, 4096
    s_add_u32 s44, s42, 4329472
    buffer_load_dwordx4 v12, s[8:11], s44 offen offset:0 lds
    buffer_load_dwordx4 v13, s[8:11], s44 offen offset:1024 lds
    s_add_u32 m0, s41, 8192
    s_add_u32 s44, s42, 4524032
    buffer_load_dwordx4 v12, s[8:11], s44 offen offset:0 lds
    buffer_load_dwordx4 v13, s[8:11], s44 offen offset:1024 lds
    s_add_u32 m0, s41, 12288
    s_add_u32 s44, s42, 4526080
    buffer_load_dwordx4 v12, s[8:11], s44 offen offset:0 lds
    buffer_load_dwordx4 v13, s[8:11], s44 offen offset:1024 lds
    s_add_u32 m0, s41, 16384
    s_add_u32 s44, s42, 4720640
    buffer_load_dwordx4 v12, s[8:11], s44 offen offset:0 lds
    buffer_load_dwordx4 v13, s[8:11], s44 offen offset:1024 lds
    s_add_u32 m0, s41, 20480
    s_add_u32 s44, s42, 4722688
    buffer_load_dwordx4 v12, s[8:11], s44 offen offset:0 lds
    buffer_load_dwordx4 v13, s[8:11], s44 offen offset:1024 lds
    s_add_u32 m0, s41, 24576
    s_add_u32 s44, s42, 4917248
    buffer_load_dwordx4 v12, s[8:11], s44 offen offset:0 lds
    buffer_load_dwordx4 v13, s[8:11], s44 offen offset:1024 lds
    s_add_u32 m0, s41, 28672
    s_add_u32 s44, s42, 4919296
    buffer_load_dwordx4 v12, s[8:11], s44 offen offset:0 lds
    buffer_load_dwordx4 v13, s[8:11], s44 offen offset:1024 lds
    s_waitcnt vmcnt(16)
    s_barrier
    s_add_u32 m0, s41, 32768
    s_add_u32 s44, s42, 5113856
    buffer_load_dwordx4 v12, s[8:11], s44 offen offset:0 lds
    buffer_load_dwordx4 v13, s[8:11], s44 offen offset:1024 lds
    s_add_u32 m0, s41, 36864
    s_add_u32 s44, s42, 5115904
    buffer_load_dwordx4 v12, s[8:11], s44 offen offset:0 lds
    buffer_load_dwordx4 v13, s[8:11], s44 offen offset:1024 lds
    s_add_u32 m0, s41, 40960
    s_add_u32 s44, s42, 5310464
    buffer_load_dwordx4 v12, s[8:11], s44 offen offset:0 lds
    buffer_load_dwordx4 v13, s[8:11], s44 offen offset:1024 lds
    s_add_u32 m0, s41, 45056
    s_add_u32 s44, s42, 5312512
    buffer_load_dwordx4 v12, s[8:11], s44 offen offset:0 lds
    buffer_load_dwordx4 v13, s[8:11], s44 offen offset:1024 lds
    s_add_u32 m0, s41, 49152
    s_add_u32 s44, s42, 5507072
    buffer_load_dwordx4 v12, s[8:11], s44 offen offset:0 lds
    buffer_load_dwordx4 v13, s[8:11], s44 offen offset:1024 lds
    s_add_u32 m0, s41, 53248
    s_add_u32 s44, s42, 5509120
    buffer_load_dwordx4 v12, s[8:11], s44 offen offset:0 lds
    buffer_load_dwordx4 v13, s[8:11], s44 offen offset:1024 lds
    s_add_u32 m0, s41, 57344
    s_add_u32 s44, s42, 5703680
    buffer_load_dwordx4 v12, s[8:11], s44 offen offset:0 lds
    buffer_load_dwordx4 v13, s[8:11], s44 offen offset:1024 lds
    s_add_u32 m0, s41, 61440
    s_add_u32 s44, s42, 5705728
    buffer_load_dwordx4 v12, s[8:11], s44 offen offset:0 lds
    buffer_load_dwordx4 v13, s[8:11], s44 offen offset:1024 lds
    s_waitcnt vmcnt(16)
    s_barrier
    s_add_u32 m0, s41, 65536
    s_add_u32 s44, s42, 5900288
    buffer_load_dwordx4 v12, s[8:11], s44 offen offset:0 lds
    buffer_load_dwordx4 v13, s[8:11], s44 offen offset:1024 lds
    s_add_u32 m0, s41, 69632
    s_add_u32 s44, s42, 5902336
    buffer_load_dwordx4 v12, s[8:11], s44 offen offset:0 lds
    buffer_load_dwordx4 v13, s[8:11], s44 offen offset:1024 lds
    s_add_u32 m0, s41, 73728
    s_add_u32 s44, s42, 6096896
    buffer_load_dwordx4 v12, s[8:11], s44 offen offset:0 lds
    buffer_load_dwordx4 v13, s[8:11], s44 offen offset:1024 lds
    s_add_u32 m0, s41, 77824
    s_add_u32 s44, s42, 6098944
    buffer_load_dwordx4 v12, s[8:11], s44 offen offset:0 lds
    buffer_load_dwordx4 v13, s[8:11], s44 offen offset:1024 lds
    s_add_u32 m0, s41, 81920
    s_add_u32 s44, s42, 3932160
    buffer_load_dwordx4 v12, s[8:11], s44 offen offset:0 lds
    buffer_load_dwordx4 v13, s[8:11], s44 offen offset:1024 lds
    s_add_u32 m0, s41, 86016
    s_add_u32 s44, s42, 4128768
    buffer_load_dwordx4 v12, s[8:11], s44 offen offset:0 lds
    buffer_load_dwordx4 v13, s[8:11], s44 offen offset:1024 lds
    s_add_u32 m0, s41, 90112
    s_add_u32 s44, s42, 4325376
    buffer_load_dwordx4 v12, s[8:11], s44 offen offset:0 lds
    buffer_load_dwordx4 v13, s[8:11], s44 offen offset:1024 lds
    s_add_u32 m0, s41, 94208
    s_add_u32 s44, s42, 4521984
    buffer_load_dwordx4 v12, s[8:11], s44 offen offset:0 lds
    buffer_load_dwordx4 v13, s[8:11], s44 offen offset:1024 lds
    s_waitcnt vmcnt(16)
    s_barrier
    s_add_u32 m0, s41, 98304
    s_add_u32 s44, s42, 4718592
    buffer_load_dwordx4 v12, s[8:11], s44 offen offset:0 lds
    buffer_load_dwordx4 v13, s[8:11], s44 offen offset:1024 lds
    s_add_u32 m0, s41, 102400
    s_add_u32 s44, s42, 4915200
    buffer_load_dwordx4 v12, s[8:11], s44 offen offset:0 lds
    buffer_load_dwordx4 v13, s[8:11], s44 offen offset:1024 lds
    s_add_u32 m0, s41, 106496
    s_add_u32 s44, s42, 5111808
    buffer_load_dwordx4 v12, s[8:11], s44 offen offset:0 lds
    buffer_load_dwordx4 v13, s[8:11], s44 offen offset:1024 lds
    s_add_u32 m0, s41, 110592
    s_add_u32 s44, s42, 5308416
    buffer_load_dwordx4 v12, s[8:11], s44 offen offset:0 lds
    buffer_load_dwordx4 v13, s[8:11], s44 offen offset:1024 lds
    s_add_u32 m0, s41, 114688
    s_add_u32 s44, s42, 5505024
    buffer_load_dwordx4 v12, s[8:11], s44 offen offset:0 lds
    buffer_load_dwordx4 v13, s[8:11], s44 offen offset:1024 lds
    s_add_u32 m0, s41, 118784
    s_add_u32 s44, s42, 5701632
    buffer_load_dwordx4 v12, s[8:11], s44 offen offset:0 lds
    buffer_load_dwordx4 v13, s[8:11], s44 offen offset:1024 lds
    s_add_u32 m0, s41, 122880
    s_add_u32 s44, s42, 5898240
    buffer_load_dwordx4 v12, s[8:11], s44 offen offset:0 lds
    buffer_load_dwordx4 v13, s[8:11], s44 offen offset:1024 lds
    s_add_u32 m0, s41, 126976
    s_add_u32 s44, s42, 6094848
    buffer_load_dwordx4 v12, s[8:11], s44 offen offset:0 lds
    buffer_load_dwordx4 v13, s[8:11], s44 offen offset:1024 lds
    s_waitcnt vmcnt(16)
    s_barrier
    s_waitcnt vmcnt(0)
    s_barrier
    s_bitcmp1_b32 s21, 0
    s_cbranch_scc1 s_B
    s_add_u32 m0, s41, 0
    s_add_u32 s44, s62, 0
    buffer_load_dwordx4 v16, s[12:15], s44 offen offset:0 lds
    buffer_load_dwordx4 v17, s[12:15], s44 offen offset:1024 lds
    s_add_u32 m0, s41, 4096
    s_add_u32 s44, s62, 131072
    buffer_load_dwordx4 v16, s[12:15], s44 offen offset:0 lds
    buffer_load_dwordx4 v17, s[12:15], s44 offen offset:1024 lds
    s_add_u32 m0, s41, 8192
    s_add_u32 s44, s62, 262144
    buffer_load_dwordx4 v16, s[12:15], s44 offen offset:0 lds
    buffer_load_dwordx4 v17, s[12:15], s44 offen offset:1024 lds
    s_add_u32 m0, s41, 12288
    s_add_u32 s44, s62, 393216
    buffer_load_dwordx4 v16, s[12:15], s44 offen offset:0 lds
    buffer_load_dwordx4 v17, s[12:15], s44 offen offset:1024 lds
    s_add_u32 m0, s41, 16384
    s_add_u32 s44, s62, 524288
    buffer_load_dwordx4 v16, s[12:15], s44 offen offset:0 lds
    buffer_load_dwordx4 v17, s[12:15], s44 offen offset:1024 lds
    s_add_u32 m0, s41, 20480
    s_add_u32 s44, s62, 655360
    buffer_load_dwordx4 v16, s[12:15], s44 offen offset:0 lds
    buffer_load_dwordx4 v17, s[12:15], s44 offen offset:1024 lds
    s_add_u32 m0, s41, 24576
    s_add_u32 s44, s62, 786432
    buffer_load_dwordx4 v16, s[12:15], s44 offen offset:0 lds
    buffer_load_dwordx4 v17, s[12:15], s44 offen offset:1024 lds
    s_add_u32 m0, s41, 28672
    s_add_u32 s44, s62, 917504
    buffer_load_dwordx4 v16, s[12:15], s44 offen offset:0 lds
    buffer_load_dwordx4 v17, s[12:15], s44 offen offset:1024 lds
    s_add_u32 m0, s41, 32768
    s_add_u32 s44, s62, 1048576
    buffer_load_dwordx4 v16, s[12:15], s44 offen offset:0 lds
    buffer_load_dwordx4 v17, s[12:15], s44 offen offset:1024 lds
    s_add_u32 m0, s41, 36864
    s_add_u32 s44, s62, 1179648
    buffer_load_dwordx4 v16, s[12:15], s44 offen offset:0 lds
    buffer_load_dwordx4 v17, s[12:15], s44 offen offset:1024 lds
    s_add_u32 m0, s41, 40960
    s_add_u32 s44, s62, 1310720
    buffer_load_dwordx4 v16, s[12:15], s44 offen offset:0 lds
    buffer_load_dwordx4 v17, s[12:15], s44 offen offset:1024 lds
    s_add_u32 m0, s41, 45056
    s_add_u32 s44, s62, 1441792
    buffer_load_dwordx4 v16, s[12:15], s44 offen offset:0 lds
    buffer_load_dwordx4 v17, s[12:15], s44 offen offset:1024 lds
    s_add_u32 m0, s41, 49152
    s_add_u32 s44, s62, 1572864
    buffer_load_dwordx4 v16, s[12:15], s44 offen offset:0 lds
    buffer_load_dwordx4 v17, s[12:15], s44 offen offset:1024 lds
    s_add_u32 m0, s41, 53248
    s_add_u32 s44, s62, 1703936
    buffer_load_dwordx4 v16, s[12:15], s44 offen offset:0 lds
    buffer_load_dwordx4 v17, s[12:15], s44 offen offset:1024 lds
    s_add_u32 m0, s41, 57344
    s_add_u32 s44, s62, 1835008
    buffer_load_dwordx4 v16, s[12:15], s44 offen offset:0 lds
    buffer_load_dwordx4 v17, s[12:15], s44 offen offset:1024 lds
    s_add_u32 m0, s41, 61440
    s_add_u32 s44, s62, 1966080
    buffer_load_dwordx4 v16, s[12:15], s44 offen offset:0 lds
    buffer_load_dwordx4 v17, s[12:15], s44 offen offset:1024 lds
    s_branch s_tail
z_start:
    v_lshrrev_b32 v24, 4, v1
    v_lshrrev_b32 v25, 3, v24
    v_mul_u32_u24 v20, 6144, v25
    v_and_b32 v25, 7, v24
    v_lshl_add_u32 v20, v25, 4, v20
    v_add_u32 v21, 4096, v20
    v_mov_b32 v22, 0x3f80
    v_mov_b32 v23, 0x3f800000
    v_lshrrev_b32 v24, 4, v1
    v_lshrrev_b32 v25, 3, v24
    v_mul_u32_u24 v12, 6144, v25
    v_and_b32 v26, 2, v25
    v_lshrrev_b32 v25, 2, v25
    v_or_b32 v26, v26, v25
    v_bfe_u32 v25, v24, 1, 2
    v_xor_b32 v26, v26, v25
    v_lshl_add_u32 v12, v26, 5, v12
    v_and_b32 v26, 1, v24
    v_lshl_add_u32 v12, v26, 4, v12
    s_lshl_b32 s3, s18, 7
    v_add_u32 v12, s3, v12
    v_add_u32 v13, 48128, v12
    v_add_u32 v14, 96256, v12
    v_add_u32 v15, 144384, v12
    v_lshrrev_b32 v24, 4, v1
    v_lshrrev_b32 v25, 3, v24
    v_mul_u32_u24 v16, 2048, v25
    v_and_b32 v26, 2, v25
    v_lshrrev_b32 v25, 2, v25
    v_or_b32 v26, v26, v25
    v_bfe_u32 v25, v24, 1, 2
    v_xor_b32 v26, v26, v25
    v_lshl_add_u32 v16, v26, 5, v16
    v_and_b32 v26, 1, v24
    v_lshl_add_u32 v16, v26, 4, v16
    s_lshl_b32 s3, s20, 7
    v_add_u32 v16, s3, v16
    v_add_u32 v17, 15360, v16
    v_add_u32 v18, 30720, v16
    v_add_u32 v19, 46080, v16
    s_and_b32 s3, s16, 3
    s_lshl_b32 s3, s3, 10
    v_add_u32 v9, s3, v1
    v_add_u32 v10, 0x10000, v9
    s_barrier
    s_mov_b32 s8, s24
    s_mov_b32 s9, s25
    s_mov_b32 s10, 6291456
    s_mov_b32 s11, 0x00020000
    s_mul_i32 s44, s17, 393216
    s_lshl_b32 s45, s18, 7
    s_add_u32 s44, s44, s45
    buffer_load_dwordx4 v[32:35], v20, s[8:11], s44 offen offset:0
    buffer_load_dwordx4 v[64:67], v20, s[8:11], s44 offen offset:2048
    buffer_load_dwordx4 v[96:99], v21, s[8:11], s44 offen
    s_add_u32 s44, s44, 49152
    buffer_load_dwordx4 v[36:39], v20, s[8:11], s44 offen offset:0
    buffer_load_dwordx4 v[68:71], v20, s[8:11], s44 offen offset:2048
    buffer_load_dwordx4 v[100:103], v21, s[8:11], s44 offen
    s_add_u32 s44, s44, 49152
    buffer_load_dwordx4 v[40:43], v20, s[8:11], s44 offen offset:0
    buffer_load_dwordx4 v[72:75], v20, s[8:11], s44 offen offset:2048
    buffer_load_dwordx4 v[104:107], v21, s[8:11], s44 offen
    s_add_u32 s44, s44, 49152
    buffer_load_dwordx4 v[44:47], v20, s[8:11], s44 offen offset:0
    buffer_load_dwordx4 v[76:79], v20, s[8:11], s44 offen offset:2048
    buffer_load_dwordx4 v[108:111], v21, s[8:11], s44 offen
    s_add_u32 s44, s44, 49152
    buffer_load_dwordx4 v[48:51], v20, s[8:11], s44 offen offset:0
    buffer_load_dwordx4 v[80:83], v20, s[8:11], s44 offen offset:2048
    buffer_load_dwordx4 v[112:115], v21, s[8:11], s44 offen
    s_add_u32 s44, s44, 49152
    buffer_load_dwordx4 v[52:55], v20, s[8:11], s44 offen offset:0
    buffer_load_dwordx4 v[84:87], v20, s[8:11], s44 offen offset:2048
    buffer_load_dwordx4 v[116:119], v21, s[8:11], s44 offen
    s_add_u32 s44, s44, 49152
    buffer_load_dwordx4 v[56:59], v20, s[8:11], s44 offen offset:0
    buffer_load_dwordx4 v[88:91], v20, s[8:11], s44 offen offset:2048
    buffer_load_dwordx4 v[120:123], v21, s[8:11], s44 offen
    s_add_u32 s44, s44, 49152
    buffer_load_dwordx4 v[60:63], v20, s[8:11], s44 offen offset:0
    buffer_load_dwordx4 v[92:95], v20, s[8:11], s44 offen offset:2048
    buffer_load_dwordx4 v[124:127], v21, s[8:11], s44 offen
    s_waitcnt vmcnt(0)
    v_dot2_f32_bf16 v128, v32, v22, 0
    v_dot2_f32_bf16 v129, v32, v23, 0
    v_dot2_f32_bf16 v130, v33, v22, 0
    v_dot2_f32_bf16 v131, v33, v23, 0
    v_dot2_f32_bf16 v132, v34, v22, 0
    v_dot2_f32_bf16 v133, v34, v23, 0
    v_dot2_f32_bf16 v134, v35, v22, 0
    v_dot2_f32_bf16 v135, v35, v23, 0
    v_dot2_f32_bf16 v128, v36, v22, v128
    v_dot2_f32_bf16 v129, v36, v23, v129
    v_dot2_f32_bf16 v130, v37, v22, v130
    v_dot2_f32_bf16 v131, v37, v23, v131
    v_dot2_f32_bf16 v132, v38, v22, v132
    v_dot2_f32_bf16 v133, v38, v23, v133
    v_dot2_f32_bf16 v134, v39, v22, v134
    v_dot2_f32_bf16 v135, v39, v23, v135
    v_dot2_f32_bf16 v128, v40, v22, v128
    v_dot2_f32_bf16 v129, v40, v23, v129
    v_dot2_f32_bf16 v130, v41, v22, v130
    v_dot2_f32_bf16 v131, v41, v23, v131
    v_dot2_f32_bf16 v132, v42, v22, v132
    v_dot2_f32_bf16 v133, v42, v23, v133
    v_dot2_f32_bf16 v134, v43, v22, v134
    v_dot2_f32_bf16 v135, v43, v23, v135
    v_dot2_f32_bf16 v128, v44, v22, v128
    v_dot2_f32_bf16 v129, v44, v23, v129
    v_dot2_f32_bf16 v130, v45, v22, v130
    v_dot2_f32_bf16 v131, v45, v23, v131
    v_dot2_f32_bf16 v132, v46, v22, v132
    v_dot2_f32_bf16 v133, v46, v23, v133
    v_dot2_f32_bf16 v134, v47, v22, v134
    v_dot2_f32_bf16 v135, v47, v23, v135
    v_dot2_f32_bf16 v128, v48, v22, v128
    v_dot2_f32_bf16 v129, v48, v23, v129
    v_dot2_f32_bf16 v130, v49, v22, v130
    v_dot2_f32_bf16 v131, v49, v23, v131
    v_dot2_f32_bf16 v132, v50, v22, v132
    v_dot2_f32_bf16 v133, v50, v23, v133
    v_dot2_f32_bf16 v134, v51, v22, v134
    v_dot2_f32_bf16 v135, v51, v23, v135
    v_dot2_f32_bf16 v128, v52, v22, v128
    v_dot2_f32_bf16 v129, v52, v23, v129
    v_dot2_f32_bf16 v130, v53, v22, v130
    v_dot2_f32_bf16 v131, v53, v23, v131
    v_dot2_f32_bf16 v132, v54, v22, v132
    v_dot2_f32_bf16 v133, v54, v23, v133
    v_dot2_f32_bf16 v134, v55, v22, v134
    v_dot2_f32_bf16 v135, v55, v23, v135
    v_dot2_f32_bf16 v128, v56, v22, v128
    v_dot2_f32_bf16 v129, v56, v23, v129
    v_dot2_f32_bf16 v130, v57, v22, v130
    v_dot2_f32_bf16 v131, v57, v23, v131
    v_dot2_f32_bf16 v132, v58, v22, v132
    v_dot2_f32_bf16 v133, v58, v23, v133
    v_dot2_f32_bf16 v134, v59, v22, v134
    v_dot2_f32_bf16 v135, v59, v23, v135
    v_dot2_f32_bf16 v128, v60, v22, v128
    v_dot2_f32_bf16 v129, v60, v23, v129
    v_dot2_f32_bf16 v130, v61, v22, v130
    v_dot2_f32_bf16 v131, v61, v23, v131
    v_dot2_f32_bf16 v132, v62, v22, v132
    v_dot2_f32_bf16 v133, v62, v23, v133
    v_dot2_f32_bf16 v134, v63, v22, v134
    v_dot2_f32_bf16 v135, v63, v23, v135
    s_barrier
    v_dot2_f32_bf16 v136, v64, v22, 0
    v_dot2_f32_bf16 v137, v64, v23, 0
    v_dot2_f32_bf16 v138, v65, v22, 0
    v_dot2_f32_bf16 v139, v65, v23, 0
    v_dot2_f32_bf16 v140, v66, v22, 0
    v_dot2_f32_bf16 v141, v66, v23, 0
    v_dot2_f32_bf16 v142, v67, v22, 0
    v_dot2_f32_bf16 v143, v67, v23, 0
    v_dot2_f32_bf16 v136, v68, v22, v136
    v_dot2_f32_bf16 v137, v68, v23, v137
    v_dot2_f32_bf16 v138, v69, v22, v138
    v_dot2_f32_bf16 v139, v69, v23, v139
    v_dot2_f32_bf16 v140, v70, v22, v140
    v_dot2_f32_bf16 v141, v70, v23, v141
    v_dot2_f32_bf16 v142, v71, v22, v142
    v_dot2_f32_bf16 v143, v71, v23, v143
    v_dot2_f32_bf16 v136, v72, v22, v136
    v_dot2_f32_bf16 v137, v72, v23, v137
    v_dot2_f32_bf16 v138, v73, v22, v138
    v_dot2_f32_bf16 v139, v73, v23, v139
    v_dot2_f32_bf16 v140, v74, v22, v140
    v_dot2_f32_bf16 v141, v74, v23, v141
    v_dot2_f32_bf16 v142, v75, v22, v142
    v_dot2_f32_bf16 v143, v75, v23, v143
    v_dot2_f32_bf16 v136, v76, v22, v136
    v_dot2_f32_bf16 v137, v76, v23, v137
    v_dot2_f32_bf16 v138, v77, v22, v138
    v_dot2_f32_bf16 v139, v77, v23, v139
    v_dot2_f32_bf16 v140, v78, v22, v140
    v_dot2_f32_bf16 v141, v78, v23, v141
    v_dot2_f32_bf16 v142, v79, v22, v142
    v_dot2_f32_bf16 v143, v79, v23, v143
    v_dot2_f32_bf16 v136, v80, v22, v136
    v_dot2_f32_bf16 v137, v80, v23, v137
    v_dot2_f32_bf16 v138, v81, v22, v138
    v_dot2_f32_bf16 v139, v81, v23, v139
    v_dot2_f32_bf16 v140, v82, v22, v140
    v_dot2_f32_bf16 v141, v82, v23, v141
    v_dot2_f32_bf16 v142, v83, v22, v142
    v_dot2_f32_bf16 v143, v83, v23, v143
    v_dot2_f32_bf16 v136, v84, v22, v136
    v_dot2_f32_bf16 v137, v84, v23, v137
    v_dot2_f32_bf16 v138, v85, v22, v138
    v_dot2_f32_bf16 v139, v85, v23, v139
    v_dot2_f32_bf16 v140, v86, v22, v140
    v_dot2_f32_bf16 v141, v86, v23, v141
    v_dot2_f32_bf16 v142, v87, v22, v142
    v_dot2_f32_bf16 v143, v87, v23, v143
    v_dot2_f32_bf16 v136, v88, v22, v136
    v_dot2_f32_bf16 v137, v88, v23, v137
    v_dot2_f32_bf16 v138, v89, v22, v138
    v_dot2_f32_bf16 v139, v89, v23, v139
    v_dot2_f32_bf16 v140, v90, v22, v140
    v_dot2_f32_bf16 v141, v90, v23, v141
    v_dot2_f32_bf16 v142, v91, v22, v142
    v_dot2_f32_bf16 v143, v91, v23, v143
    v_dot2_f32_bf16 v136, v92, v22, v136
    v_dot2_f32_bf16 v137, v92, v23, v137
    v_dot2_f32_bf16 v138, v93, v22, v138
    v_dot2_f32_bf16 v139, v93, v23, v139
    v_dot2_f32_bf16 v140, v94, v22, v140
    v_dot2_f32_bf16 v141, v94, v23, v141
    v_dot2_f32_bf16 v142, v95, v22, v142
    v_dot2_f32_bf16 v143, v95, v23, v143
    v_dot2_f32_bf16 v144, v96, v22, 0
    v_dot2_f32_bf16 v145, v96, v23, 0
    v_dot2_f32_bf16 v146, v97, v22, 0
    v_dot2_f32_bf16 v147, v97, v23, 0
    v_dot2_f32_bf16 v148, v98, v22, 0
    v_dot2_f32_bf16 v149, v98, v23, 0
    v_dot2_f32_bf16 v150, v99, v22, 0
    v_dot2_f32_bf16 v151, v99, v23, 0
    v_dot2_f32_bf16 v144, v100, v22, v144
    v_dot2_f32_bf16 v145, v100, v23, v145
    v_dot2_f32_bf16 v146, v101, v22, v146
    v_dot2_f32_bf16 v147, v101, v23, v147
    v_dot2_f32_bf16 v148, v102, v22, v148
    v_dot2_f32_bf16 v149, v102, v23, v149
    v_dot2_f32_bf16 v150, v103, v22, v150
    v_dot2_f32_bf16 v151, v103, v23, v151
    v_dot2_f32_bf16 v144, v104, v22, v144
    v_dot2_f32_bf16 v145, v104, v23, v145
    v_dot2_f32_bf16 v146, v105, v22, v146
    v_dot2_f32_bf16 v147, v105, v23, v147
    v_dot2_f32_bf16 v148, v106, v22, v148
    v_dot2_f32_bf16 v149, v106, v23, v149
    v_dot2_f32_bf16 v150, v107, v22, v150
    v_dot2_f32_bf16 v151, v107, v23, v151
    v_dot2_f32_bf16 v144, v108, v22, v144
    v_dot2_f32_bf16 v145, v108, v23, v145
    v_dot2_f32_bf16 v146, v109, v22, v146
    v_dot2_f32_bf16 v147, v109, v23, v147
    v_dot2_f32_bf16 v148, v110, v22, v148
    v_dot2_f32_bf16 v149, v110, v23, v149
    v_dot2_f32_bf16 v150, v111, v22, v150
    v_dot2_f32_bf16 v151, v111, v23, v151
    v_dot2_f32_bf16 v144, v112, v22, v144
    v_dot2_f32_bf16 v145, v112, v23, v145
    v_dot2_f32_bf16 v146, v113, v22, v146
    v_dot2_f32_bf16 v147, v113, v23, v147
    v_dot2_f32_bf16 v148, v114, v22, v148
    v_dot2_f32_bf16 v149, v114, v23, v149
    v_dot2_f32_bf16 v150, v115, v22, v150
    v_dot2_f32_bf16 v151, v115, v23, v151
    v_dot2_f32_bf16 v144, v116, v22, v144
    v_dot2_f32_bf16 v145, v116, v23, v145
    v_dot2_f32_bf16 v146, v117, v22, v146
    v_dot2_f32_bf16 v147, v117, v23, v147
    v_dot2_f32_bf16 v148, v118, v22, v148
    v_dot2_f32_bf16 v149, v118, v23, v149
    v_dot2_f32_bf16 v150, v119, v22, v150
    v_dot2_f32_bf16 v151, v119, v23, v151
    v_dot2_f32_bf16 v144, v120, v22, v144
    v_dot2_f32_bf16 v145, v120, v23, v145
    v_dot2_f32_bf16 v146, v121, v22, v146
    v_dot2_f32_bf16 v147, v121, v23, v147
    v_dot2_f32_bf16 v148, v122, v22, v148
    v_dot2_f32_bf16 v149, v122, v23, v149
    v_dot2_f32_bf16 v150, v123, v22, v150
    v_dot2_f32_bf16 v151, v123, v23, v151
    v_dot2_f32_bf16 v144, v124, v22, v144
    v_dot2_f32_bf16 v145, v124, v23, v145
    v_dot2_f32_bf16 v146, v125, v22, v146
    v_dot2_f32_bf16 v147, v125, v23, v147
    v_dot2_f32_bf16 v148, v126, v22, v148
    v_dot2_f32_bf16 v149, v126, v23, v149
    v_dot2_f32_bf16 v150, v127, v22, v150
    v_dot2_f32_bf16 v151, v127, v23, v151
    s_barrier
    s_nop 2
    v_permlane32_swap_b32 v128, v132
    v_permlane32_swap_b32 v129, v133
    v_permlane32_swap_b32 v130, v134
    v_permlane32_swap_b32 v131, v135
    v_add_f32 v128, v128, v132
    v_add_f32 v129, v129, v133
    v_add_f32 v130, v130, v134
    v_add_f32 v131, v131, v135
    v_permlane32_swap_b32 v136, v140
    v_permlane32_swap_b32 v137, v141
    v_permlane32_swap_b32 v138, v142
    v_permlane32_swap_b32 v139, v143
    v_add_f32 v136, v136, v140
    v_add_f32 v137, v137, v141
    v_add_f32 v138, v138, v142
    v_add_f32 v139, v139, v143
    v_permlane32_swap_b32 v144, v148
    v_permlane32_swap_b32 v145, v149
    v_permlane32_swap_b32 v146, v150
    v_permlane32_swap_b32 v147, v151
    v_add_f32 v144, v144, v148
    v_add_f32 v145, v145, v149
    v_add_f32 v146, v146, v150
    v_add_f32 v147, v147, v151
    v_mov_b32 v152, v144
    v_mov_b32 v153, v145
    v_mov_b32 v154, v146
    v_mov_b32 v155, v147
    v_permlane16_swap_b32 v128, v136
    v_permlane16_swap_b32 v129, v137
    v_permlane16_swap_b32 v130, v138
    v_permlane16_swap_b32 v131, v139
    v_add_f32 v128, v128, v136
    v_add_f32 v129, v129, v137
    v_add_f32 v130, v130, v138
    v_add_f32 v131, v131, v139
    v_permlane16_swap_b32 v144, v152
    v_permlane16_swap_b32 v145, v153
    v_permlane16_swap_b32 v146, v154
    v_permlane16_swap_b32 v147, v155
    v_add_f32 v144, v144, v152
    v_add_f32 v145, v145, v153
    v_add_f32 v146, v146, v154
    v_add_f32 v147, v147, v155
    v_add_f32_dpp v128, v128, v128 row_ror:8 row_mask:0xf bank_mask:0xf
    v_add_f32_dpp v129, v129, v129 row_ror:8 row_mask:0xf bank_mask:0xf
    v_add_f32_dpp v130, v130, v130 row_ror:8 row_mask:0xf bank_mask:0xf
    v_add_f32_dpp v131, v131, v131 row_ror:8 row_mask:0xf bank_mask:0xf
    v_add_f32_dpp v144, v144, v144 row_ror:8 row_mask:0xf bank_mask:0xf
    v_add_f32_dpp v145, v145, v145 row_ror:8 row_mask:0xf bank_mask:0xf
    v_add_f32_dpp v146, v146, v146 row_ror:8 row_mask:0xf bank_mask:0xf
    v_add_f32_dpp v147, v147, v147 row_ror:8 row_mask:0xf bank_mask:0xf
    v_lshrrev_b32 v24, 4, v1
    v_bfe_u32 v25, v24, 3, 1
    v_cmp_eq_u32 vcc, 1, v25
    s_nop 1
    v_cndmask_b32 v128, v128, v144, vcc
    v_cndmask_b32 v129, v129, v145, vcc
    v_cndmask_b32 v130, v130, v146, vcc
    v_cndmask_b32 v131, v131, v147, vcc
    v_lshlrev_b32 v25, 9, v25
    v_bfe_u32 v26, v24, 4, 1
    v_lshl_add_u32 v25, v26, 8, v25
    v_and_b32 v26, 7, v24
    v_lshl_add_u32 v25, v26, 5, v25
    v_lshrrev_b32 v26, 5, v24
    v_lshl_add_u32 v25, v26, 4, v25
    s_lshl_b32 s44, s18, 14
    s_lshl_b32 s45, s17, 10
    s_add_u32 s44, s44, s45
    s_add_u32 s44, s44, 52428800
    buffer_store_dwordx4 v[128:131], v25, s[4:7], s44 offen sc1
    s_lshl_b32 s44, s18, 7
    s_add_u32 s44, s44, 0
    s_barrier
    s_waitcnt vmcnt(0)
    s_atomic_add s40, s[22:23], s44
    s_barrier
    s_barrier
    s_barrier
    s_barrier
    s_barrier
    s_barrier
    s_barrier
    s_mov_b32 s12, s26
    s_mov_b32 s13, s27
    s_mov_b32 s14, 2097152
    s_mov_b32 s15, 0x00020000
    s_lshl_b32 s44, s2, 13
    buffer_load_dwordx4 v[160:163], v1, s[12:15], s44 offen offset:0
    buffer_load_dwordx4 v[164:167], v1, s[12:15], s44 offen offset:1024
    buffer_load_dwordx4 v[168:171], v1, s[12:15], s44 offen offset:2048
    buffer_load_dwordx4 v[172:175], v1, s[12:15], s44 offen offset:3072
    s_add_u32 s44, s44, 4096
    buffer_load_dwordx4 v[176:179], v1, s[12:15], s44 offen offset:0
    buffer_load_dwordx4 v[180:183], v1, s[12:15], s44 offen offset:1024
    buffer_load_dwordx4 v[184:187], v1, s[12:15], s44 offen offset:2048
    buffer_load_dwordx4 v[188:191], v1, s[12:15], s44 offen offset:3072
    s_mov_b32 s8, s28
    s_mov_b32 s9, s29
    s_mov_b32 s10, 6291456
    s_mov_b32 s11, 0x00020000
    s_mul_i32 s44, s17, 393216
    s_lshl_b32 s45, s18, 7
    s_add_u32 s44, s44, s45
    buffer_load_dwordx4 v[32:35], v20, s[8:11], s44 offen offset:0
    buffer_load_dwordx4 v[64:67], v20, s[8:11], s44 offen offset:2048
    buffer_load_dwordx4 v[96:99], v21, s[8:11], s44 offen
    s_add_u32 s44, s44, 49152
    buffer_load_dwordx4 v[36:39], v20, s[8:11], s44 offen offset:0
    buffer_load_dwordx4 v[68:71], v20, s[8:11], s44 offen offset:2048
    buffer_load_dwordx4 v[100:103], v21, s[8:11], s44 offen
    s_add_u32 s44, s44, 49152
    buffer_load_dwordx4 v[40:43], v20, s[8:11], s44 offen offset:0
    buffer_load_dwordx4 v[72:75], v20, s[8:11], s44 offen offset:2048
    buffer_load_dwordx4 v[104:107], v21, s[8:11], s44 offen
    s_add_u32 s44, s44, 49152
    s_barrier
    buffer_load_dwordx4 v[44:47], v20, s[8:11], s44 offen offset:0
    buffer_load_dwordx4 v[76:79], v20, s[8:11], s44 offen offset:2048
    buffer_load_dwordx4 v[108:111], v21, s[8:11], s44 offen
    s_add_u32 s44, s44, 49152
    buffer_load_dwordx4 v[48:51], v20, s[8:11], s44 offen offset:0
    buffer_load_dwordx4 v[80:83], v20, s[8:11], s44 offen offset:2048
    buffer_load_dwordx4 v[112:115], v21, s[8:11], s44 offen
    s_add_u32 s44, s44, 49152
    buffer_load_dwordx4 v[52:55], v20, s[8:11], s44 offen offset:0
    buffer_load_dwordx4 v[84:87], v20, s[8:11], s44 offen offset:2048
    buffer_load_dwordx4 v[116:119], v21, s[8:11], s44 offen
    s_add_u32 s44, s44, 49152
    buffer_load_dwordx4 v[56:59], v20, s[8:11], s44 offen offset:0
    buffer_load_dwordx4 v[88:91], v20, s[8:11], s44 offen offset:2048
    buffer_load_dwordx4 v[120:123], v21, s[8:11], s44 offen
    s_add_u32 s44, s44, 49152
    buffer_load_dwordx4 v[60:63], v20, s[8:11], s44 offen offset:0
    buffer_load_dwordx4 v[92:95], v20, s[8:11], s44 offen offset:2048
    buffer_load_dwordx4 v[124:127], v21, s[8:11], s44 offen
    s_barrier
    s_bitcmp1_b32 s21, 0
    s_cselect_b32 s8, s28, s24
    s_cselect_b32 s9, s29, s25
    s_cselect_b32 s12, s30, s26
    s_cselect_b32 s13, s31, s27
    s_mov_b32 s10, 6291456
    s_mov_b32 s11, 0x00020000
    s_mov_b32 s14, 2097152
    s_mov_b32 s15, 0x00020000
    s_branch s_tail
z_layer:
    s_waitcnt lgkmcnt(0)
    s_barrier
    s_barrier
    s_barrier
    s_barrier
    s_barrier
    s_barrier
    s_barrier
    s_barrier
    s_barrier
    s_barrier
    s_barrier
    s_barrier
    s_bitcmp1_b32 s21, 0
    s_cselect_b32 s8, s28, s24
    s_cselect_b32 s9, s29, s25
    s_cselect_b32 s12, s30, s26
    s_cselect_b32 s13, s31, s27
    s_mov_b32 s10, 6291456
    s_mov_b32 s11, 0x00020000
    s_mov_b32 s14, 2097152
    s_mov_b32 s15, 0x00020000
    s_branch s_tail
s_tail:
    s_bitcmp1_b32 s21, 0
    s_cbranch_scc1 s_B
    s_cmp_lg_u32 s16, 4
    s_cbranch_scc1 s_a1
    s_mov_b32 s45, 2146435072
    s_cmp_eq_u32 s17, 0
    s_cbranch_scc1 s_a0
    s_lshr_b32 s46, s21, 1
    s_lshl_b32 s44, s46, 15
    s_lshl_b32 s67, s17, 11
    s_add_u32 s44, s44, s67
    s_lshl_b32 s67, s18, 7
    s_add_u32 s44, s44, s67
    s_add_u32 s44, s44, 149504
    s_sub_u32 s45, s44, 151552
    s_lshl_b32 s45, s45, 5
    s_add_u32 s45, s45, 54525952
    s_mov_b32 s66, 0x10000
s_h_poll:
    s_mov_b32 s68, 0
    s_atomic_add s68, s[22:23], s44 offset:0 glc
    s_waitcnt lgkmcnt(0)
    s_cmp_eq_u32 s68, 1
    s_cbranch_scc1 s_h_ok
    s_sub_u32 s66, s66, 1
    s_cmp_lg_u32 s66, 0
    s_cbranch_scc1 s_h_poll
s_h_ok:
s_a0:
    s_mov_b32 m0, 131072
    s_nop 0
    buffer_load_dwordx4 v1, s[4:7], s45 offen offset:0 sc1 lds
    buffer_load_dwordx4 v1, s[4:7], s45 offen offset:1024 sc1 lds
    buffer_load_dwordx4 v1, s[4:7], s45 offen offset:2048 sc1 lds
    buffer_load_dwordx4 v1, s[4:7], s45 offen offset:3072 sc1 lds
    s_waitcnt vmcnt(0)
s_a1:
    s_barrier
    s_sub_u32 s3, s16, 5
    s_cmp_gt_u32 s3, 1
    s_cbranch_scc1 s_a2
    s_add_u32 m0, s41, 65536
    s_add_u32 s44, s62, 65536
    buffer_load_dwordx4 v16, s[12:15], s44 offen offset:0 lds
    buffer_load_dwordx4 v17, s[12:15], s44 offen offset:1024 lds
    s_add_u32 m0, s41, 69632
    s_add_u32 s44, s62, 196608
    buffer_load_dwordx4 v16, s[12:15], s44 offen offset:0 lds
    buffer_load_dwordx4 v17, s[12:15], s44 offen offset:1024 lds
    s_add_u32 m0, s41, 73728
    s_add_u32 s44, s62, 327680
    buffer_load_dwordx4 v16, s[12:15], s44 offen offset:0 lds
    buffer_load_dwordx4 v17, s[12:15], s44 offen offset:1024 lds
    s_add_u32 m0, s41, 77824
    s_add_u32 s44, s62, 458752
    buffer_load_dwordx4 v16, s[12:15], s44 offen offset:0 lds
    buffer_load_dwordx4 v17, s[12:15], s44 offen offset:1024 lds
    s_add_u32 m0, s41, 81920
    s_add_u32 s44, s62, 589824
    buffer_load_dwordx4 v16, s[12:15], s44 offen offset:0 lds
    buffer_load_dwordx4 v17, s[12:15], s44 offen offset:1024 lds
    s_add_u32 m0, s41, 86016
    s_add_u32 s44, s62, 720896
    buffer_load_dwordx4 v16, s[12:15], s44 offen offset:0 lds
    buffer_load_dwordx4 v17, s[12:15], s44 offen offset:1024 lds
    s_add_u32 m0, s41, 90112
    s_add_u32 s44, s62, 851968
    buffer_load_dwordx4 v16, s[12:15], s44 offen offset:0 lds
    buffer_load_dwordx4 v17, s[12:15], s44 offen offset:1024 lds
    s_add_u32 m0, s41, 94208
    s_add_u32 s44, s62, 983040
    buffer_load_dwordx4 v16, s[12:15], s44 offen offset:0 lds
    buffer_load_dwordx4 v17, s[12:15], s44 offen offset:1024 lds
    s_add_u32 m0, s41, 98304
    s_add_u32 s44, s62, 1114112
    buffer_load_dwordx4 v16, s[12:15], s44 offen offset:0 lds
    buffer_load_dwordx4 v17, s[12:15], s44 offen offset:1024 lds
    s_add_u32 m0, s41, 102400
    s_add_u32 s44, s62, 1245184
    buffer_load_dwordx4 v16, s[12:15], s44 offen offset:0 lds
    buffer_load_dwordx4 v17, s[12:15], s44 offen offset:1024 lds
    s_add_u32 m0, s41, 106496
    s_add_u32 s44, s62, 1376256
    buffer_load_dwordx4 v16, s[12:15], s44 offen offset:0 lds
    buffer_load_dwordx4 v17, s[12:15], s44 offen offset:1024 lds
    s_add_u32 m0, s41, 110592
    s_add_u32 s44, s62, 1507328
    buffer_load_dwordx4 v16, s[12:15], s44 offen offset:0 lds
    buffer_load_dwordx4 v17, s[12:15], s44 offen offset:1024 lds
    s_add_u32 m0, s41, 114688
    s_add_u32 s44, s62, 1638400
    buffer_load_dwordx4 v16, s[12:15], s44 offen offset:0 lds
    buffer_load_dwordx4 v17, s[12:15], s44 offen offset:1024 lds
    s_add_u32 m0, s41, 118784
    s_add_u32 s44, s62, 1769472
    buffer_load_dwordx4 v16, s[12:15], s44 offen offset:0 lds
    buffer_load_dwordx4 v17, s[12:15], s44 offen offset:1024 lds
    s_add_u32 m0, s41, 122880
    s_add_u32 s44, s62, 1900544
    buffer_load_dwordx4 v16, s[12:15], s44 offen offset:0 lds
    buffer_load_dwordx4 v17, s[12:15], s44 offen offset:1024 lds
    s_add_u32 m0, s41, 126976
    s_add_u32 s44, s62, 2031616
    buffer_load_dwordx4 v16, s[12:15], s44 offen offset:0 lds
    buffer_load_dwordx4 v17, s[12:15], s44 offen offset:1024 lds
    s_waitcnt vmcnt(32)
s_a2:
    s_bitcmp0_b32 s21, 0
    s_cselect_b32 s56, s28, s24
    s_cselect_b32 s57, s29, s25
    s_mov_b32 s58, 6291456
    s_mov_b32 s59, 0x00020000
    s_and_b32 s60, s16, 3
    s_mul_i32 s60, s60, 49152
    s_add_u32 s61, s60, 2048
    buffer_load_dwordx4 v[160:163], v12, s[56:59], s61 offen
    s_add_u32 s61, s60, 4096
    buffer_load_dwordx4 v[164:167], v12, s[56:59], s61 offen
    s_add_u32 s61, s60, 0
    buffer_load_dwordx4 v[168:171], v12, s[56:59], s61 offen
    s_add_u32 s61, s60, 198656
    buffer_load_dwordx4 v[172:175], v12, s[56:59], s61 offen
    s_add_u32 s61, s60, 200704
    buffer_load_dwordx4 v[176:179], v12, s[56:59], s61 offen
    s_add_u32 s61, s60, 196608
    buffer_load_dwordx4 v[180:183], v12, s[56:59], s61 offen
    s_add_u32 s61, s60, 395264
    buffer_load_dwordx4 v[184:187], v12, s[56:59], s61 offen
    s_add_u32 s61, s60, 397312
    buffer_load_dwordx4 v[188:191], v12, s[56:59], s61 offen
    s_add_u32 s61, s60, 393216
    buffer_load_dwordx4 v[192:195], v12, s[56:59], s61 offen
    s_add_u32 s61, s60, 591872
    buffer_load_dwordx4 v[196:199], v12, s[56:59], s61 offen
    s_add_u32 s61, s60, 593920
    buffer_load_dwordx4 v[200:203], v12, s[56:59], s61 offen
    s_add_u32 s61, s60, 589824
    buffer_load_dwordx4 v[204:207], v12, s[56:59], s61 offen
    s_add_u32 s61, s60, 788480
    buffer_load_dwordx4 v[208:211], v12, s[56:59], s61 offen
    s_add_u32 s61, s60, 790528
    buffer_load_dwordx4 v[212:215], v12, s[56:59], s61 offen
    s_add_u32 s61, s60, 786432
    buffer_load_dwordx4 v[216:219], v12, s[56:59], s61 offen
    s_add_u32 s61, s60, 985088
    buffer_load_dwordx4 v[220:223], v12, s[56:59], s61 offen
    s_add_u32 s61, s60, 987136
    buffer_load_dwordx4 v[224:227], v12, s[56:59], s61 offen
    s_add_u32 s61, s60, 983040
    buffer_load_dwordx4 v[228:231], v12, s[56:59], s61 offen
    s_add_u32 s61, s60, 1181696
    buffer_load_dwordx4 v[232:235], v12, s[56:59], s61 offen
    s_add_u32 s61, s60, 1183744
    buffer_load_dwordx4 v[236:239], v12, s[56:59], s61 offen
    s_add_u32 s61, s60, 1179648
    buffer_load_dwordx4 v[240:243], v12, s[56:59], s61 offen
    s_add_u32 s61, s60, 1378304
    buffer_load_dwordx4 v[244:247], v12, s[56:59], s61 offen
    s_add_u32 s61, s60, 1380352
    buffer_load_dwordx4 v[248:251], v12, s[56:59], s61 offen
    s_add_u32 s61, s60, 1376256
    buffer_load_dwordx4 v[252:255], v12, s[56:59], s61 offen
    s_barrier
    s_waitcnt vmcnt(0)
    s_lshl_b32 s3, s21, 3
    s_add_u32 s3, s3, s16
    s_cmp_lg_u32 s3, 7
    s_cbranch_scc1 s_g3
    v_dot2_f32_bf16 v128, v32, v22, 0
    v_dot2_f32_bf16 v129, v32, v23, 0
    v_dot2_f32_bf16 v130, v33, v22, 0
    v_dot2_f32_bf16 v131, v33, v23, 0
    v_dot2_f32_bf16 v132, v34, v22, 0
    v_dot2_f32_bf16 v133, v34, v23, 0
    v_dot2_f32_bf16 v134, v35, v22, 0
    v_dot2_f32_bf16 v135, v35, v23, 0
    v_dot2_f32_bf16 v128, v36, v22, v128
    v_dot2_f32_bf16 v129, v36, v23, v129
    v_dot2_f32_bf16 v130, v37, v22, v130
    v_dot2_f32_bf16 v131, v37, v23, v131
    v_dot2_f32_bf16 v132, v38, v22, v132
    v_dot2_f32_bf16 v133, v38, v23, v133
    v_dot2_f32_bf16 v134, v39, v22, v134
    v_dot2_f32_bf16 v135, v39, v23, v135
    v_dot2_f32_bf16 v128, v40, v22, v128
    v_dot2_f32_bf16 v129, v40, v23, v129
    v_dot2_f32_bf16 v130, v41, v22, v130
    v_dot2_f32_bf16 v131, v41, v23, v131
    v_dot2_f32_bf16 v132, v42, v22, v132
    v_dot2_f32_bf16 v133, v42, v23, v133
    v_dot2_f32_bf16 v134, v43, v22, v134
    v_dot2_f32_bf16 v135, v43, v23, v135
    v_dot2_f32_bf16 v128, v44, v22, v128
    v_dot2_f32_bf16 v129, v44, v23, v129
    v_dot2_f32_bf16 v130, v45, v22, v130
    v_dot2_f32_bf16 v131, v45, v23, v131
    v_dot2_f32_bf16 v132, v46, v22, v132
    v_dot2_f32_bf16 v133, v46, v23, v133
    v_dot2_f32_bf16 v134, v47, v22, v134
    v_dot2_f32_bf16 v135, v47, v23, v135
    v_dot2_f32_bf16 v128, v48, v22, v128
    v_dot2_f32_bf16 v129, v48, v23, v129
    v_dot2_f32_bf16 v130, v49, v22, v130
    v_dot2_f32_bf16 v131, v49, v23, v131
    v_dot2_f32_bf16 v132, v50, v22, v132
    v_dot2_f32_bf16 v133, v50, v23, v133
    v_dot2_f32_bf16 v134, v51, v22, v134
    v_dot2_f32_bf16 v135, v51, v23, v135
    v_dot2_f32_bf16 v128, v52, v22, v128
    v_dot2_f32_bf16 v129, v52, v23, v129
    v_dot2_f32_bf16 v130, v53, v22, v130
    v_dot2_f32_bf16 v131, v53, v23, v131
    v_dot2_f32_bf16 v132, v54, v22, v132
    v_dot2_f32_bf16 v133, v54, v23, v133
    v_dot2_f32_bf16 v134, v55, v22, v134
    v_dot2_f32_bf16 v135, v55, v23, v135
    v_dot2_f32_bf16 v128, v56, v22, v128
    v_dot2_f32_bf16 v129, v56, v23, v129
    v_dot2_f32_bf16 v130, v57, v22, v130
    v_dot2_f32_bf16 v131, v57, v23, v131
    v_dot2_f32_bf16 v132, v58, v22, v132
    v_dot2_f32_bf16 v133, v58, v23, v133
    v_dot2_f32_bf16 v134, v59, v22, v134
    v_dot2_f32_bf16 v135, v59, v23, v135
    v_dot2_f32_bf16 v128, v60, v22, v128
    v_dot2_f32_bf16 v129, v60, v23, v129
    v_dot2_f32_bf16 v130, v61, v22, v130
    v_dot2_f32_bf16 v131, v61, v23, v131
    v_dot2_f32_bf16 v132, v62, v22, v132
    v_dot2_f32_bf16 v133, v62, v23, v133
    v_dot2_f32_bf16 v134, v63, v22, v134
    v_dot2_f32_bf16 v135, v63, v23, v135
    v_dot2_f32_bf16 v136, v64, v22, 0
    v_dot2_f32_bf16 v137, v64, v23, 0
    v_dot2_f32_bf16 v138, v65, v22, 0
    v_dot2_f32_bf16 v139, v65, v23, 0
    v_dot2_f32_bf16 v140, v66, v22, 0
    v_dot2_f32_bf16 v141, v66, v23, 0
    v_dot2_f32_bf16 v142, v67, v22, 0
    v_dot2_f32_bf16 v143, v67, v23, 0
    v_dot2_f32_bf16 v136, v68, v22, v136
    v_dot2_f32_bf16 v137, v68, v23, v137
    v_dot2_f32_bf16 v138, v69, v22, v138
    v_dot2_f32_bf16 v139, v69, v23, v139
    v_dot2_f32_bf16 v140, v70, v22, v140
    v_dot2_f32_bf16 v141, v70, v23, v141
    v_dot2_f32_bf16 v142, v71, v22, v142
    v_dot2_f32_bf16 v143, v71, v23, v143
    v_dot2_f32_bf16 v136, v72, v22, v136
    v_dot2_f32_bf16 v137, v72, v23, v137
    v_dot2_f32_bf16 v138, v73, v22, v138
    v_dot2_f32_bf16 v139, v73, v23, v139
    v_dot2_f32_bf16 v140, v74, v22, v140
    v_dot2_f32_bf16 v141, v74, v23, v141
    v_dot2_f32_bf16 v142, v75, v22, v142
    v_dot2_f32_bf16 v143, v75, v23, v143
    v_dot2_f32_bf16 v136, v76, v22, v136
    v_dot2_f32_bf16 v137, v76, v23, v137
    v_dot2_f32_bf16 v138, v77, v22, v138
    v_dot2_f32_bf16 v139, v77, v23, v139
    v_dot2_f32_bf16 v140, v78, v22, v140
    v_dot2_f32_bf16 v141, v78, v23, v141
    v_dot2_f32_bf16 v142, v79, v22, v142
    v_dot2_f32_bf16 v143, v79, v23, v143
    v_dot2_f32_bf16 v136, v80, v22, v136
    v_dot2_f32_bf16 v137, v80, v23, v137
    v_dot2_f32_bf16 v138, v81, v22, v138
    v_dot2_f32_bf16 v139, v81, v23, v139
    v_dot2_f32_bf16 v140, v82, v22, v140
    v_dot2_f32_bf16 v141, v82, v23, v141
    v_dot2_f32_bf16 v142, v83, v22, v142
    v_dot2_f32_bf16 v143, v83, v23, v143
    v_dot2_f32_bf16 v136, v84, v22, v136
    v_dot2_f32_bf16 v137, v84, v23, v137
    v_dot2_f32_bf16 v138, v85, v22, v138
    v_dot2_f32_bf16 v139, v85, v23, v139
    v_dot2_f32_bf16 v140, v86, v22, v140
    v_dot2_f32_bf16 v141, v86, v23, v141
    v_dot2_f32_bf16 v142, v87, v22, v142
    v_dot2_f32_bf16 v143, v87, v23, v143
    v_dot2_f32_bf16 v136, v88, v22, v136
    v_dot2_f32_bf16 v137, v88, v23, v137
    v_dot2_f32_bf16 v138, v89, v22, v138
    v_dot2_f32_bf16 v139, v89, v23, v139
    v_dot2_f32_bf16 v140, v90, v22, v140
    v_dot2_f32_bf16 v141, v90, v23, v141
    v_dot2_f32_bf16 v142, v91, v22, v142
    v_dot2_f32_bf16 v143, v91, v23, v143
    v_dot2_f32_bf16 v136, v92, v22, v136
    v_dot2_f32_bf16 v137, v92, v23, v137
    v_dot2_f32_bf16 v138, v93, v22, v138
    v_dot2_f32_bf16 v139, v93, v23, v139
    v_dot2_f32_bf16 v140, v94, v22, v140
    v_dot2_f32_bf16 v141, v94, v23, v141
    v_dot2_f32_bf16 v142, v95, v22, v142
    v_dot2_f32_bf16 v143, v95, v23, v143
    v_dot2_f32_bf16 v144, v96, v22, 0
    v_dot2_f32_bf16 v145, v96, v23, 0
    v_dot2_f32_bf16 v146, v97, v22, 0
    v_dot2_f32_bf16 v147, v97, v23, 0
    v_dot2_f32_bf16 v148, v98, v22, 0
    v_dot2_f32_bf16 v149, v98, v23, 0
    v_dot2_f32_bf16 v150, v99, v22, 0
    v_dot2_f32_bf16 v151, v99, v23, 0
    v_dot2_f32_bf16 v144, v100, v22, v144
    v_dot2_f32_bf16 v145, v100, v23, v145
    v_dot2_f32_bf16 v146, v101, v22, v146
    v_dot2_f32_bf16 v147, v101, v23, v147
    v_dot2_f32_bf16 v148, v102, v22, v148
    v_dot2_f32_bf16 v149, v102, v23, v149
    v_dot2_f32_bf16 v150, v103, v22, v150
    v_dot2_f32_bf16 v151, v103, v23, v151
    v_dot2_f32_bf16 v144, v104, v22, v144
    v_dot2_f32_bf16 v145, v104, v23, v145
    v_dot2_f32_bf16 v146, v105, v22, v146
    v_dot2_f32_bf16 v147, v105, v23, v147
    v_dot2_f32_bf16 v148, v106, v22, v148
    v_dot2_f32_bf16 v149, v106, v23, v149
    v_dot2_f32_bf16 v150, v107, v22, v150
    v_dot2_f32_bf16 v151, v107, v23, v151
    v_dot2_f32_bf16 v144, v108, v22, v144
    v_dot2_f32_bf16 v145, v108, v23, v145
    v_dot2_f32_bf16 v146, v109, v22, v146
    v_dot2_f32_bf16 v147, v109, v23, v147
    v_dot2_f32_bf16 v148, v110, v22, v148
    v_dot2_f32_bf16 v149, v110, v23, v149
    v_dot2_f32_bf16 v150, v111, v22, v150
    v_dot2_f32_bf16 v151, v111, v23, v151
    v_dot2_f32_bf16 v144, v112, v22, v144
    v_dot2_f32_bf16 v145, v112, v23, v145
    v_dot2_f32_bf16 v146, v113, v22, v146
    v_dot2_f32_bf16 v147, v113, v23, v147
    v_dot2_f32_bf16 v148, v114, v22, v148
    v_dot2_f32_bf16 v149, v114, v23, v149
    v_dot2_f32_bf16 v150, v115, v22, v150
    v_dot2_f32_bf16 v151, v115, v23, v151
    v_dot2_f32_bf16 v144, v116, v22, v144
    v_dot2_f32_bf16 v145, v116, v23, v145
    v_dot2_f32_bf16 v146, v117, v22, v146
    v_dot2_f32_bf16 v147, v117, v23, v147
    v_dot2_f32_bf16 v148, v118, v22, v148
    v_dot2_f32_bf16 v149, v118, v23, v149
    v_dot2_f32_bf16 v150, v119, v22, v150
    v_dot2_f32_bf16 v151, v119, v23, v151
    v_dot2_f32_bf16 v144, v120, v22, v144
    v_dot2_f32_bf16 v145, v120, v23, v145
    v_dot2_f32_bf16 v146, v121, v22, v146
    v_dot2_f32_bf16 v147, v121, v23, v147
    v_dot2_f32_bf16 v148, v122, v22, v148
    v_dot2_f32_bf16 v149, v122, v23, v149
    v_dot2_f32_bf16 v150, v123, v22, v150
    v_dot2_f32_bf16 v151, v123, v23, v151
    v_dot2_f32_bf16 v144, v124, v22, v144
    v_dot2_f32_bf16 v145, v124, v23, v145
    v_dot2_f32_bf16 v146, v125, v22, v146
    v_dot2_f32_bf16 v147, v125, v23, v147
    v_dot2_f32_bf16 v148, v126, v22, v148
    v_dot2_f32_bf16 v149, v126, v23, v149
    v_dot2_f32_bf16 v150, v127, v22, v150
    v_dot2_f32_bf16 v151, v127, v23, v151
    s_nop 2
    v_permlane32_swap_b32 v128, v132
    v_permlane32_swap_b32 v129, v133
    v_permlane32_swap_b32 v130, v134
    v_permlane32_swap_b32 v131, v135
    v_add_f32 v128, v128, v132
    v_add_f32 v129, v129, v133
    v_add_f32 v130, v130, v134
    v_add_f32 v131, v131, v135
    v_permlane32_swap_b32 v136, v140
    v_permlane32_swap_b32 v137, v141
    v_permlane32_swap_b32 v138, v142
    v_permlane32_swap_b32 v139, v143
    v_add_f32 v136, v136, v140
    v_add_f32 v137, v137, v141
    v_add_f32 v138, v138, v142
    v_add_f32 v139, v139, v143
    v_permlane32_swap_b32 v144, v148
    v_permlane32_swap_b32 v145, v149
    v_permlane32_swap_b32 v146, v150
    v_permlane32_swap_b32 v147, v151
    v_add_f32 v144, v144, v148
    v_add_f32 v145, v145, v149
    v_add_f32 v146, v146, v150
    v_add_f32 v147, v147, v151
    v_mov_b32 v152, v144
    v_mov_b32 v153, v145
    v_mov_b32 v154, v146
    v_mov_b32 v155, v147
    v_permlane16_swap_b32 v128, v136
    v_permlane16_swap_b32 v129, v137
    v_permlane16_swap_b32 v130, v138
    v_permlane16_swap_b32 v131, v139
    v_add_f32 v128, v128, v136
    v_add_f32 v129, v129, v137
    v_add_f32 v130, v130, v138
    v_add_f32 v131, v131, v139
    v_permlane16_swap_b32 v144, v152
    v_permlane16_swap_b32 v145, v153
    v_permlane16_swap_b32 v146, v154
    v_permlane16_swap_b32 v147, v155
    v_add_f32 v144, v144, v152
    v_add_f32 v145, v145, v153
    v_add_f32 v146, v146, v154
    v_add_f32 v147, v147, v155
    v_add_f32_dpp v128, v128, v128 row_ror:8 row_mask:0xf bank_mask:0xf
    v_add_f32_dpp v129, v129, v129 row_ror:8 row_mask:0xf bank_mask:0xf
    v_add_f32_dpp v130, v130, v130 row_ror:8 row_mask:0xf bank_mask:0xf
    v_add_f32_dpp v131, v131, v131 row_ror:8 row_mask:0xf bank_mask:0xf
    v_add_f32_dpp v144, v144, v144 row_ror:8 row_mask:0xf bank_mask:0xf
    v_add_f32_dpp v145, v145, v145 row_ror:8 row_mask:0xf bank_mask:0xf
    v_add_f32_dpp v146, v146, v146 row_ror:8 row_mask:0xf bank_mask:0xf
    v_add_f32_dpp v147, v147, v147 row_ror:8 row_mask:0xf bank_mask:0xf
    v_lshrrev_b32 v24, 4, v1
    v_bfe_u32 v25, v24, 3, 1
    v_cmp_eq_u32 vcc, 1, v25
    s_nop 1
    v_cndmask_b32 v128, v128, v144, vcc
    v_cndmask_b32 v129, v129, v145, vcc
    v_cndmask_b32 v130, v130, v146, vcc
    v_cndmask_b32 v131, v131, v147, vcc
    v_lshlrev_b32 v25, 9, v25
    v_bfe_u32 v26, v24, 4, 1
    v_lshl_add_u32 v25, v26, 8, v25
    v_and_b32 v26, 7, v24
    v_lshl_add_u32 v25, v26, 5, v25
    v_lshrrev_b32 v26, 5, v24
    v_lshl_add_u32 v25, v26, 4, v25
    s_lshl_b32 s44, s18, 14
    s_lshl_b32 s45, s17, 10
    s_add_u32 s44, s44, s45
    s_add_u32 s44, s44, 52690944
    buffer_store_dwordx4 v[128:131], v25, s[4:7], s44 offen sc1
    s_lshl_b32 s44, s18, 7
    s_add_u32 s44, s44, 2048
    s_waitcnt vmcnt(0)
    s_atomic_add s40, s[22:23], s44
    s_branch s_g3
s_B:
    s_cmp_lg_u32 s16, 4
    s_cbranch_scc1 s_b0
    s_lshr_b32 s46, s21, 1
    s_lshl_b32 s44, s46, 13
    s_lshl_b32 s67, s18, 9
    s_add_u32 s44, s44, s67
    s_add_u32 s44, s44, 69632
    s_mov_b32 s66, 0x10000
s_k_poll:
    s_mov_b32 s68, 0
    s_mov_b32 s69, 0
    s_mov_b32 s70, 0
    s_mov_b32 s71, 0
    s_atomic_add s68, s[22:23], s44 offset:0 glc
    s_atomic_add s69, s[22:23], s44 offset:128 glc
    s_atomic_add s70, s[22:23], s44 offset:256 glc
    s_atomic_add s71, s[22:23], s44 offset:384 glc
    s_waitcnt lgkmcnt(0)
    s_and_b32 s68, s68, s69
    s_and_b32 s68, s68, s70
    s_and_b32 s68, s68, s71
    s_cmp_eq_u32 s68, 16
    s_cbranch_scc1 s_k_ok
    s_sub_u32 s66, s66, 1
    s_cmp_lg_u32 s66, 0
    s_cbranch_scc1 s_k_poll
s_k_ok:
s_b0:
    s_barrier
    s_setprio 3
    s_mov_b32 s52, 0
    s_lshl_b32 s44, s16, 14
    v_add_u32 v24, s44, v1
    s_and_b32 s3, s16, 3
    s_lshl_b32 s44, s3, 10
    s_add_u32 s44, s44, 147456
    v_lshrrev_b32 v25, 2, v1
    v_add_u32 v25, s44, v25
    s_lshl_b32 s53, s21, 22
    s_lshl_b32 s44, s38, 16
    s_add_u32 s53, s53, s44
    s_lshl_b32 s44, s18, 12
    s_add_u32 s53, s53, s44
    s_add_u32 s53, s53, 16777216
    s_lshl_b32 s54, s21, 14
    s_lshl_b32 s67, s38, 8
    s_add_u32 s54, s54, s67
    s_add_u32 s54, s54, 86016
s_bhead:
    s_barrier
    s_waitcnt vmcnt(0) lgkmcnt(0)
    s_barrier
    ds_read_b32 v28, v25 offset:0
    ds_read_b32 v29, v25 offset:256
    ds_read_b32 v30, v25 offset:512
    ds_read_b32 v31, v25 offset:768
    ds_read_b128 v[32:35], v24 offset:0
    ds_read_b128 v[36:39], v24 offset:1024
    ds_read_b128 v[40:43], v24 offset:2048
    ds_read_b128 v[44:47], v24 offset:3072
    ds_read_b128 v[48:51], v24 offset:4096
    ds_read_b128 v[52:55], v24 offset:5120
    ds_read_b128 v[56:59], v24 offset:6144
    ds_read_b128 v[60:63], v24 offset:7168
    ds_read_b128 v[64:67], v24 offset:8192
    ds_read_b128 v[68:71], v24 offset:9216
    ds_read_b128 v[72:75], v24 offset:10240
    ds_read_b128 v[76:79], v24 offset:11264
    ds_read_b128 v[80:83], v24 offset:12288
    ds_read_b128 v[84:87], v24 offset:13312
    ds_read_b128 v[88:91], v24 offset:14336
    ds_read_b128 v[92:95], v24 offset:15360
    s_waitcnt lgkmcnt(15)
    v_add_f32 v28, v28, v29
    v_add_f32 v30, v30, v31
    v_add_f32 v28, v28, v30
    v_mov_b32 v29, 0x5d800000
    v_mov_b32 v30, 0x21800000
    v_cmp_nlt_f32 s[44:45], v28, v29
    v_cmp_ngt_f32 vcc, v28, v30
    v_rcp_f32 v28, v28
    s_or_b64 vcc, vcc, s[44:45]
    s_waitcnt lgkmcnt(8)
    v_pk_add_f32 v[32:33], v[32:33], v[48:49]
    v_pk_add_f32 v[34:35], v[34:35], v[50:51]
    v_pk_add_f32 v[36:37], v[36:37], v[52:53]
    v_pk_add_f32 v[38:39], v[38:39], v[54:55]
    v_pk_add_f32 v[40:41], v[40:41], v[56:57]
    v_pk_add_f32 v[42:43], v[42:43], v[58:59]
    v_pk_add_f32 v[44:45], v[44:45], v[60:61]
    v_pk_add_f32 v[46:47], v[46:47], v[62:63]
    s_waitcnt lgkmcnt(4)
    v_pk_add_f32 v[32:33], v[32:33], v[64:65]
    v_pk_add_f32 v[34:35], v[34:35], v[66:67]
    v_pk_add_f32 v[36:37], v[36:37], v[68:69]
    v_pk_add_f32 v[38:39], v[38:39], v[70:71]
    v_pk_add_f32 v[40:41], v[40:41], v[72:73]
    v_pk_add_f32 v[42:43], v[42:43], v[74:75]
    v_pk_add_f32 v[44:45], v[44:45], v[76:77]
    v_pk_add_f32 v[46:47], v[46:47], v[78:79]
    s_waitcnt lgkmcnt(0)
    v_pk_add_f32 v[32:33], v[32:33], v[80:81]
    v_pk_add_f32 v[34:35], v[34:35], v[82:83]
    v_pk_add_f32 v[36:37], v[36:37], v[84:85]
    v_pk_add_f32 v[38:39], v[38:39], v[86:87]
    v_pk_add_f32 v[40:41], v[40:41], v[88:89]
    v_pk_add_f32 v[42:43], v[42:43], v[90:91]
    v_pk_add_f32 v[44:45], v[44:45], v[92:93]
    v_pk_add_f32 v[46:47], v[46:47], v[94:95]
    s_cbranch_vccnz s_slow
s_fin:
    v_pk_mul_f32 v[32:33], v[28:29], v[32:33] op_sel_hi:[0,1]
    v_pk_mul_f32 v[34:35], v[28:29], v[34:35] op_sel_hi:[0,1]
    v_pk_mul_f32 v[36:37], v[28:29], v[36:37] op_sel_hi:[0,1]
    v_pk_mul_f32 v[38:39], v[28:29], v[38:39] op_sel_hi:[0,1]
    v_pk_mul_f32 v[40:41], v[28:29], v[40:41] op_sel_hi:[0,1]
    v_pk_mul_f32 v[42:43], v[28:29], v[42:43] op_sel_hi:[0,1]
    v_pk_mul_f32 v[44:45], v[28:29], v[44:45] op_sel_hi:[0,1]
    v_pk_mul_f32 v[46:47], v[28:29], v[46:47] op_sel_hi:[0,1]
    v_cvt_pk_bf16_f32 v32, v32, v33
    v_cvt_pk_bf16_f32 v33, v34, v35
    v_cvt_pk_bf16_f32 v34, v36, v37
    v_cvt_pk_bf16_f32 v35, v38, v39
    v_cvt_pk_bf16_f32 v36, v40, v41
    v_cvt_pk_bf16_f32 v37, v42, v43
    v_cvt_pk_bf16_f32 v38, v44, v45
    v_cvt_pk_bf16_f32 v39, v46, v47
    buffer_store_dwordx4 v[32:35], v1, s[4:7], s53 offen offset:0 sc1
    buffer_store_dwordx4 v[36:39], v1, s[4:7], s53 offen offset:1024 sc1
    s_cmp_lg_u32 s52, 0
    s_cbranch_scc1 s_b2
    s_waitcnt vmcnt(0)
    s_atomic_add s40, s[22:23], s54
    s_mov_b32 s52, 1
    s_add_u32 s53, s53, 2048
    s_waitcnt lgkmcnt(0)
    s_add_u32 s54, s54, 128
    s_setprio 0
    s_and_b32 s3, s16, 3
    s_lshl_b32 s44, s3, 19
    s_lshl_b32 s45, s3, 14
    s_add_u32 m0, s45, 0
    s_nop 0
    buffer_load_dwordx4 v16, s[12:15], s44 offen offset:0 lds
    buffer_load_dwordx4 v17, s[12:15], s44 offen offset:1024 lds
    buffer_load_dwordx4 v18, s[12:15], s44 offen offset:2048 lds
    buffer_load_dwordx4 v19, s[12:15], s44 offen offset:3072 lds
    s_add_u32 s44, s44, 65536
    s_waitcnt vmcnt(2)
    buffer_load_dwordx4 v[96:99], v16, s[12:15], s44 offen offset:0
    buffer_load_dwordx4 v[100:103], v17, s[12:15], s44 offen offset:1024
    buffer_load_dwordx4 v[104:107], v18, s[12:15], s44 offen offset:2048
    buffer_load_dwordx4 v[108:111], v19, s[12:15], s44 offen offset:3072
    s_add_u32 s44, s44, 65536
    s_waitcnt vmcnt(2)
    s_add_u32 m0, s45, 4096
    s_nop 0
    buffer_load_dwordx4 v16, s[12:15], s44 offen offset:0 lds
    buffer_load_dwordx4 v17, s[12:15], s44 offen offset:1024 lds
    buffer_load_dwordx4 v18, s[12:15], s44 offen offset:2048 lds
    buffer_load_dwordx4 v19, s[12:15], s44 offen offset:3072 lds
    s_add_u32 s44, s44, 65536
    s_waitcnt vmcnt(2)
    buffer_load_dwordx4 v[112:115], v16, s[12:15], s44 offen offset:0
    buffer_load_dwordx4 v[116:119], v17, s[12:15], s44 offen offset:1024
    buffer_load_dwordx4 v[120:123], v18, s[12:15], s44 offen offset:2048
    buffer_load_dwordx4 v[124:127], v19, s[12:15], s44 offen offset:3072
    s_add_u32 s44, s44, 65536
    s_waitcnt vmcnt(2)
    s_add_u32 m0, s45, 8192
    s_nop 0
    buffer_load_dwordx4 v16, s[12:15], s44 offen offset:0 lds
    buffer_load_dwordx4 v17, s[12:15], s44 offen offset:1024 lds
    buffer_load_dwordx4 v18, s[12:15], s44 offen offset:2048 lds
    buffer_load_dwordx4 v19, s[12:15], s44 offen offset:3072 lds
    s_add_u32 s44, s44, 65536
    s_waitcnt vmcnt(2)
    buffer_load_dwordx4 v[128:131], v16, s[12:15], s44 offen offset:0
    buffer_load_dwordx4 v[132:135], v17, s[12:15], s44 offen offset:1024
    buffer_load_dwordx4 v[136:139], v18, s[12:15], s44 offen offset:2048
    buffer_load_dwordx4 v[140:143], v19, s[12:15], s44 offen offset:3072
    s_add_u32 s44, s44, 65536
    s_waitcnt vmcnt(2)
    s_add_u32 m0, s45, 12288
    s_nop 0
    buffer_load_dwordx4 v16, s[12:15], s44 offen offset:0 lds
    buffer_load_dwordx4 v17, s[12:15], s44 offen offset:1024 lds
    buffer_load_dwordx4 v18, s[12:15], s44 offen offset:2048 lds
    buffer_load_dwordx4 v19, s[12:15], s44 offen offset:3072 lds
    s_add_u32 s44, s44, 65536
    s_waitcnt vmcnt(2)
    buffer_load_dwordx4 v[144:147], v16, s[12:15], s44 offen offset:0
    buffer_load_dwordx4 v[148:151], v17, s[12:15], s44 offen offset:1024
    buffer_load_dwordx4 v[152:155], v18, s[12:15], s44 offen offset:2048
    buffer_load_dwordx4 v[156:159], v19, s[12:15], s44 offen offset:3072
    s_add_u32 s44, s44, 65536
    s_waitcnt vmcnt(2)
    s_cmp_eq_u32 s21, 3
    s_cbranch_scc1 s_nopf
    s_bitcmp0_b32 s21, 0
    s_cselect_b32 s56, s28, s24
    s_cselect_b32 s57, s29, s25
    s_mov_b32 s58, 6291456
    s_mov_b32 s59, 0x00020000
    s_and_b32 s60, s16, 3
    s_mul_i32 s60, s60, 49152
    s_add_u32 s61, s60, 2048
    buffer_load_dwordx4 v[160:163], v12, s[56:59], s61 offen
    s_add_u32 s61, s60, 4096
    buffer_load_dwordx4 v[164:167], v12, s[56:59], s61 offen
    s_add_u32 s61, s60, 0
    buffer_load_dwordx4 v[168:171], v12, s[56:59], s61 offen
    s_add_u32 s61, s60, 198656
    buffer_load_dwordx4 v[172:175], v12, s[56:59], s61 offen
    s_waitcnt vmcnt(2)
    s_add_u32 s61, s60, 200704
    buffer_load_dwordx4 v[176:179], v12, s[56:59], s61 offen
    s_add_u32 s61, s60, 196608
    buffer_load_dwordx4 v[180:183], v12, s[56:59], s61 offen
    s_add_u32 s61, s60, 395264
    buffer_load_dwordx4 v[184:187], v12, s[56:59], s61 offen
    s_add_u32 s61, s60, 397312
    buffer_load_dwordx4 v[188:191], v12, s[56:59], s61 offen
    s_waitcnt vmcnt(2)
    s_add_u32 s61, s60, 393216
    buffer_load_dwordx4 v[192:195], v12, s[56:59], s61 offen
    s_add_u32 s61, s60, 591872
    buffer_load_dwordx4 v[196:199], v12, s[56:59], s61 offen
    s_add_u32 s61, s60, 593920
    buffer_load_dwordx4 v[200:203], v12, s[56:59], s61 offen
    s_add_u32 s61, s60, 589824
    buffer_load_dwordx4 v[204:207], v12, s[56:59], s61 offen
    s_waitcnt vmcnt(2)
    s_add_u32 s61, s60, 788480
    buffer_load_dwordx4 v[208:211], v12, s[56:59], s61 offen
    s_add_u32 s61, s60, 790528
    buffer_load_dwordx4 v[212:215], v12, s[56:59], s61 offen
    s_add_u32 s61, s60, 786432
    buffer_load_dwordx4 v[216:219], v12, s[56:59], s61 offen
    s_add_u32 s61, s60, 985088
    buffer_load_dwordx4 v[220:223], v12, s[56:59], s61 offen
    s_waitcnt vmcnt(2)
    s_add_u32 s61, s60, 987136
    buffer_load_dwordx4 v[224:227], v12, s[56:59], s61 offen
    s_add_u32 s61, s60, 983040
    buffer_load_dwordx4 v[228:231], v12, s[56:59], s61 offen
    s_add_u32 s61, s60, 1181696
    buffer_load_dwordx4 v[232:235], v12, s[56:59], s61 offen
    s_add_u32 s61, s60, 1183744
    buffer_load_dwordx4 v[236:239], v12, s[56:59], s61 offen
    s_waitcnt vmcnt(2)
    s_add_u32 s61, s60, 1179648
    buffer_load_dwordx4 v[240:243], v12, s[56:59], s61 offen
    s_add_u32 s61, s60, 1378304
    buffer_load_dwordx4 v[244:247], v12, s[56:59], s61 offen
    s_add_u32 s61, s60, 1380352
    buffer_load_dwordx4 v[248:251], v12, s[56:59], s61 offen
    s_add_u32 s61, s60, 1376256
    buffer_load_dwordx4 v[252:255], v12, s[56:59], s61 offen
    s_waitcnt vmcnt(2)
s_nopf:
    s_setprio 3
    s_cmp_lg_u32 s16, 4
    s_cbranch_scc1 s_bhead
    s_lshl_b32 s44, s21, 14
    s_lshl_b32 s67, s19, 10
    s_add_u32 s44, s44, s67
    s_add_u32 s44, s44, 86016
    s_mov_b32 s66, 0x10000
s_o0_poll:
    s_mov_b32 s68, 0
    s_mov_b32 s69, 0
    s_mov_b32 s70, 0
    s_mov_b32 s71, 0
    s_atomic_add s68, s[22:23], s44 offset:0 glc
    s_atomic_add s69, s[22:23], s44 offset:256 glc
    s_atomic_add s70, s[22:23], s44 offset:512 glc
    s_atomic_add s71, s[22:23], s44 offset:768 glc
    s_waitcnt lgkmcnt(0)
    s_and_b32 s68, s68, s69
    s_and_b32 s68, s68, s70
    s_and_b32 s68, s68, s71
    s_cmp_eq_u32 s68, 16
    s_cbranch_scc1 s_o0_ok
    s_sub_u32 s66, s66, 1
    s_cmp_lg_u32 s66, 0
    s_cbranch_scc1 s_o0_poll
s_o0_ok:
    s_branch s_bhead
s_b2:
    ds_write_b128 v24, v[96:99] offset:0
    ds_write_b128 v24, v[100:103] offset:1024
    ds_write_b128 v24, v[104:107] offset:2048
    ds_write_b128 v24, v[108:111] offset:3072
    ds_write_b128 v24, v[112:115] offset:4096
    ds_write_b128 v24, v[116:119] offset:5120
    ds_write_b128 v24, v[120:123] offset:6144
    ds_write_b128 v24, v[124:127] offset:7168
    ds_write_b128 v24, v[128:131] offset:8192
    ds_write_b128 v24, v[132:135] offset:9216
    ds_write_b128 v24, v[136:139] offset:10240
    ds_write_b128 v24, v[140:143] offset:11264
    ds_write_b128 v24, v[144:147] offset:12288
    ds_write_b128 v24, v[148:151] offset:13312
    ds_write_b128 v24, v[152:155] offset:14336
    ds_write_b128 v24, v[156:159] offset:15360
    s_waitcnt vmcnt(0)
    s_atomic_add s40, s[22:23], s54
    s_cmp_lg_u32 s16, 4
    s_cbranch_scc1 s_b3
    s_lshl_b32 s44, s21, 14
    s_lshl_b32 s67, s19, 10
    s_add_u32 s44, s44, s67
    s_add_u32 s44, s44, 86144
    s_mov_b32 s66, 0x10000
s_o1_poll:
    s_mov_b32 s68, 0
    s_mov_b32 s69, 0
    s_mov_b32 s70, 0
    s_mov_b32 s71, 0
    s_atomic_add s68, s[22:23], s44 offset:0 glc
    s_atomic_add s69, s[22:23], s44 offset:256 glc
    s_atomic_add s70, s[22:23], s44 offset:512 glc
    s_atomic_add s71, s[22:23], s44 offset:768 glc
    s_waitcnt lgkmcnt(0)
    s_and_b32 s68, s68, s69
    s_and_b32 s68, s68, s70
    s_and_b32 s68, s68, s71
    s_cmp_eq_u32 s68, 16
    s_cbranch_scc1 s_o1_ok
    s_sub_u32 s66, s66, 1
    s_cmp_lg_u32 s66, 0
    s_cbranch_scc1 s_o1_poll
s_o1_ok:
s_b3:
    s_setprio 0
    s_waitcnt lgkmcnt(0)
s_g3:
    s_barrier
    s_cmp_eq_u32 s21, 3
    s_cbranch_scc1 s_end
    s_barrier
    ds_write_b128 v9, v[160:163] offset:0
    ds_write_b128 v9, v[164:167] offset:4096
    ds_write_b128 v9, v[168:171] offset:8192
    ds_write_b128 v9, v[172:175] offset:12288
    ds_write_b128 v9, v[176:179] offset:16384
    ds_write_b128 v9, v[180:183] offset:20480
    ds_write_b128 v9, v[184:187] offset:24576
    ds_write_b128 v9, v[188:191] offset:28672
    ds_write_b128 v9, v[192:195] offset:32768
    ds_write_b128 v9, v[196:199] offset:36864
    ds_write_b128 v9, v[200:203] offset:40960
    ds_write_b128 v9, v[204:207] offset:45056
    ds_write_b128 v9, v[208:211] offset:49152
    ds_write_b128 v9, v[212:215] offset:53248
    ds_write_b128 v9, v[216:219] offset:57344
    ds_write_b128 v9, v[220:223] offset:61440
    ds_write_b128 v10, v[224:227] offset:0
    ds_write_b128 v10, v[228:231] offset:4096
    ds_write_b128 v10, v[232:235] offset:8192
    ds_write_b128 v10, v[236:239] offset:12288
    ds_write_b128 v10, v[240:243] offset:16384
    ds_write_b128 v10, v[244:247] offset:20480
    ds_write_b128 v10, v[248:251] offset:24576
    ds_write_b128 v10, v[252:255] offset:28672
    s_add_u32 s21, s21, 1
    s_cmp_eq_u32 s16, 4
    s_cbranch_scc1 h_layer
    s_cmp_eq_u32 s16, 7
    s_cbranch_scc1 z_layer
    s_branch l_layer
s_end:
    s_lshl_b32 s3, s2, 3
    s_add_u32 s3, s3, s16
    s_cmp_lg_u32 s3, 7
    s_cbranch_scc1 k_exit
    s_mov_b32 s8, s34
    s_mov_b32 s9, s35
    s_mov_b32 s10, 256
    s_mov_b32 s11, 0x00020000
    v_lshrrev_b32 v24, 2, v1
    v_mov_b32 v25, 0
    buffer_store_dword v25, v24, s[8:11], 0 offen sc1
    s_branch k_exit
s_slow:
    s_and_b32 s3, s16, 3
    s_lshl_b32 s44, s3, 11
    s_lshl_b32 s45, s52, 13
    s_add_u32 s44, s44, s45
    s_add_u32 s44, s44, 131072
    v_add_u32 v26, s44, v1
    ds_read_b128 v[48:51], v26 offset:0
    ds_read_b128 v[52:55], v26 offset:1024
    s_lshr_b32 s55, s21, 1
    s_lshl_b32 s55, s55, 23
    s_lshl_b32 s44, s18, 18
    s_add_u32 s55, s55, s44
    s_lshl_b32 s44, s52, 17
    s_add_u32 s55, s55, s44
    s_add_u32 s55, s55, 33554432
    s_waitcnt lgkmcnt(0)
    v_mov_b32 v26, 0xff800000
    s_mov_b32 s61, 0
s_slow1:
    s_add_u32 s44, s55, s61
    buffer_load_dwordx4 v[56:59], v1, s[4:7], s44 offen offset:0 sc1
    buffer_load_dwordx4 v[60:63], v1, s[4:7], s44 offen offset:1024 sc1
    s_waitcnt vmcnt(0)
    v_mfma_f32_32x32x16_bf16 v[72:87], v[56:59], v[48:51], 0
    v_mfma_f32_32x32x16_bf16 v[72:87], v[60:63], v[52:55], v[72:87]
    s_nop 11
    v_max3_f32 v26, v26, v72, v73
    v_max3_f32 v26, v26, v74, v75
    v_max3_f32 v26, v26, v76, v77
    v_max3_f32 v26, v26, v78, v79
    v_max3_f32 v26, v26, v80, v81
    v_max3_f32 v26, v26, v82, v83
    v_max3_f32 v26, v26, v84, v85
    v_max3_f32 v26, v26, v86, v87
    s_add_u32 s61, s61, 2048
    s_cmp_lt_u32 s61, 131072
    s_cbranch_scc1 s_slow1
    v_mov_b32 v27, v26
    s_nop 1
    v_permlane32_swap_b32 v26, v27
    v_max_f32 v26, v26, v27
    v_mov_b32 v32, 0
    v_mov_b32 v33, 0
    v_mov_b32 v34, 0
    v_mov_b32 v35, 0
    v_mov_b32 v36, 0
    v_mov_b32 v37, 0
    v_mov_b32 v38, 0
    v_mov_b32 v39, 0
    v_mov_b32 v40, 0
    v_mov_b32 v41, 0
    v_mov_b32 v42, 0
    v_mov_b32 v43, 0
    v_mov_b32 v44, 0
    v_mov_b32 v45, 0
    v_mov_b32 v46, 0
    v_mov_b32 v47, 0
    v_mov_b32 v28, 0
    v_mov_b32 v29, 0xdddddddd
    s_mov_b32 s3, 0xffff0000
    s_mov_b32 s61, 0
s_slow2:
    s_add_u32 s44, s55, s61
    buffer_load_dwordx4 v[56:59], v1, s[4:7], s44 offen offset:0 sc1
    buffer_load_dwordx4 v[60:63], v1, s[4:7], s44 offen offset:1024 sc1
    s_add_u32 s44, s44, 4194304
    buffer_load_dwordx4 v[64:67], v1, s[4:7], s44 offen offset:0 sc1
    buffer_load_dwordx4 v[68:71], v1, s[4:7], s44 offen offset:1024 sc1
    s_waitcnt vmcnt(0)
    v_mfma_f32_32x32x16_bf16 v[72:87], v[56:59], v[48:51], 0
    v_mfma_f32_32x32x16_bf16 v[72:87], v[60:63], v[52:55], v[72:87]
    s_nop 11
    v_sub_f32 v72, v72, v26
    v_sub_f32 v73, v73, v26
    v_sub_f32 v74, v74, v26
    v_sub_f32 v75, v75, v26
    v_sub_f32 v76, v76, v26
    v_sub_f32 v77, v77, v26
    v_sub_f32 v78, v78, v26
    v_sub_f32 v79, v79, v26
    v_sub_f32 v80, v80, v26
    v_sub_f32 v81, v81, v26
    v_sub_f32 v82, v82, v26
    v_sub_f32 v83, v83, v26
    v_sub_f32 v84, v84, v26
    v_sub_f32 v85, v85, v26
    v_sub_f32 v86, v86, v26
    v_sub_f32 v87, v87, v26
    v_exp_f32 v72, v72
    v_exp_f32 v73, v73
    v_exp_f32 v74, v74
    v_exp_f32 v75, v75
    v_exp_f32 v76, v76
    v_exp_f32 v77, v77
    v_exp_f32 v78, v78
    v_exp_f32 v79, v79
    v_exp_f32 v80, v80
    v_exp_f32 v81, v81
    v_exp_f32 v82, v82
    v_exp_f32 v83, v83
    v_exp_f32 v84, v84
    v_exp_f32 v85, v85
    v_exp_f32 v86, v86
    v_exp_f32 v87, v87
    v_and_b32 v72, s3, v72
    v_and_b32 v73, s3, v73
    v_and_b32 v74, s3, v74
    v_and_b32 v75, s3, v75
    v_and_b32 v76, s3, v76
    v_and_b32 v77, s3, v77
    v_and_b32 v78, s3, v78
    v_and_b32 v79, s3, v79
    v_and_b32 v80, s3, v80
    v_and_b32 v81, s3, v81
    v_and_b32 v82, s3, v82
    v_and_b32 v83, s3, v83
    v_and_b32 v84, s3, v84
    v_and_b32 v85, s3, v85
    v_and_b32 v86, s3, v86
    v_and_b32 v87, s3, v87
    v_add_f32 v28, v28, v72
    v_add_f32 v28, v28, v73
    v_add_f32 v28, v28, v74
    v_add_f32 v28, v28, v75
    v_add_f32 v28, v28, v76
    v_add_f32 v28, v28, v77
    v_add_f32 v28, v28, v78
    v_add_f32 v28, v28, v79
    v_add_f32 v28, v28, v80
    v_add_f32 v28, v28, v81
    v_add_f32 v28, v28, v82
    v_add_f32 v28, v28, v83
    v_add_f32 v28, v28, v84
    v_add_f32 v28, v28, v85
    v_add_f32 v28, v28, v86
    v_add_f32 v28, v28, v87
    v_smfmac_f32_32x32x32_bf16 v[32:47], v[64:67], v[72:79], v29
    v_smfmac_f32_32x32x32_bf16 v[32:47], v[68:71], v[80:87], v29
    s_add_u32 s61, s61, 2048
    s_cmp_lt_u32 s61, 131072
    s_cbranch_scc1 s_slow2
    v_mov_b32 v29, v28
    s_nop 1
    v_permlane32_swap_b32 v28, v29
    v_add_f32 v28, v28, v29
    v_rcp_f32 v28, v28
    s_nop 7
    s_branch s_fin
k_exit:
    s_endpgm
.section .rodata,"a"
.p2align 6
.amdhsa_kernel interleave_layers__sliding_local_dilated__softmax_full_mha__prompt_kernel
  .amdhsa_next_free_vgpr 256
  .amdhsa_next_free_sgpr 102
  .amdhsa_accum_offset 256
  .amdhsa_group_segment_fixed_size 0
  .amdhsa_kernarg_size 72
  .amdhsa_user_sgpr_count 2
  .amdhsa_user_sgpr_kernarg_segment_ptr 1
  .amdhsa_system_sgpr_workgroup_id_x 1
.end_amdhsa_kernel
```

```asm
; @launch grid=(256,1,1) block=(512,1,1) lds=156736
.amdgcn_target "amdgcn-amd-amdhsa--gfx950"
.text
.globl interleave_layers__sliding_local_dilated__softmax_full_mha__prompt_kernel
.type interleave_layers__sliding_local_dilated__softmax_full_mha__prompt_kernel,@function
.p2align 8
interleave_layers__sliding_local_dilated__softmax_full_mha__prompt_kernel:
    s_cmp_ge_u32 s2, 256
    s_cbranch_scc1 k_exit
    s_load_dwordx2 s[36:37], s[0:1], 0
    s_load_dwordx4 s[24:27], s[0:1], 8
    s_load_dwordx8 s[28:35], s[0:1], 32
    s_load_dwordx2 s[44:45], s[0:1], 64
    v_lshrrev_b32 v2, 6, v0
    v_and_b32 v0, 63, v0
    v_readfirstlane_b32 s16, v2
    v_lshlrev_b32 v1, 4, v0
    s_mov_b32 s21, 0
    s_mov_b32 s40, 1
    s_and_b32 s3, s2, 1
    s_lshl_b32 s3, s3, 3
    s_bfe_u32 s17, s2, 0x30003
    s_add_u32 s17, s17, s3
    s_bfe_u32 s3, s2, 0x20001
    s_lshl_b32 s3, s3, 2
    s_lshr_b32 s18, s2, 6
    s_add_u32 s18, s18, s3
    s_and_b32 s3, s2, 3
    s_lshl_b32 s3, s3, 2
    s_bfe_u32 s19, s2, 0x20003
    s_add_u32 s19, s19, s3
    s_bfe_u32 s3, s2, 0x10002
    s_lshl_b32 s3, s3, 3
    s_lshr_b32 s20, s2, 5
    s_add_u32 s20, s20, s3
    s_mov_b32 s19, s17
    s_mov_b32 s20, s18
    s_and_b32 s3, s16, 3
    s_lshl_b32 s38, s17, 2
    s_add_u32 s38, s38, s3
    s_lshl_b32 s39, s19, 2
    s_add_u32 s39, s39, s3
    v_mov_b32 v12, 0
    v_mov_b32 v13, 0
    v_mov_b32 v14, 0
    v_mov_b32 v15, 0
    s_mov_b32 s41, 0
    s_mov_b32 s42, 0
    s_mov_b32 s43, 0
    s_mov_b32 s62, 0
    s_waitcnt lgkmcnt(0)
    s_mov_b32 s4, s44
    s_mov_b32 s5, s45
    s_mov_b32 s6, 67108864
    s_mov_b32 s7, 0x00020000
    s_add_u32 s22, s44, 58720256
    s_addc_u32 s23, s45, 0
    s_load_dword s100, s[22:23], 217088
    s_cmp_eq_u32 s16, 4
    s_cbranch_scc1 h_start
    s_cmp_eq_u32 s16, 7
    s_cbranch_scc1 z_start
    s_cmp_gt_u32 s16, 4
    s_cbranch_scc1 l_start
    s_mov_b32 s8, s36
    s_mov_b32 s9, s37
    s_mov_b32 s10, 4194304
    s_mov_b32 s11, 0x00020000
    v_lshrrev_b32 v8, 4, v1
    v_lshrrev_b32 v32, 3, v8
    v_and_b32 v33, 7, v8
    v_lshlrev_b32 v34, 11, v32
    v_lshl_add_u32 v34, v33, 4, v34
    s_lshl_b32 s44, s39, 16
    s_lshl_b32 s45, s20, 7
    s_add_u32 s46, s44, s45
    buffer_load_dwordx4 v[40:43], v34, s[8:11], s46 offen
    s_add_u32 s46, s46, 16384
    buffer_load_dwordx4 v[44:47], v34, s[8:11], s46 offen
    s_add_u32 s46, s46, 16384
    buffer_load_dwordx4 v[48:51], v34, s[8:11], s46 offen
    s_add_u32 s46, s46, 16384
    buffer_load_dwordx4 v[52:55], v34, s[8:11], s46 offen
    v_xor_b32 v88, v33, v32
    v_lshlrev_b32 v88, 4, v88
    v_lshl_add_u32 v88, v32, 11, v88
    v_xor_b32 v89, 16, v88
    v_add_u32 v89, 15360, v89
    v_add_u32 v90, 30720, v88
    v_add_u32 v91, 30720, v89
    s_mul_i32 s76, s16, 16384
    s_add_u32 s76, s76, 65536
    s_lshl_b32 s77, s38, 16
    s_mul_i32 s84, s18, 4096
    s_cmp_eq_u32 s18, 1
    s_cselect_b32 s85, 0, 4096
    s_cmp_eq_u32 s18, 2
    s_cselect_b32 s86, 0, 8192
    s_cmp_eq_u32 s18, 3
    s_cselect_b32 s87, 0, 12288
    s_cmp_eq_u32 s18, 4
    s_cselect_b32 s88, 0, 16384
    s_cmp_eq_u32 s18, 5
    s_cselect_b32 s89, 0, 20480
    s_cmp_eq_u32 s18, 6
    s_cselect_b32 s90, 0, 24576
    s_cmp_eq_u32 s18, 7
    s_cselect_b32 s91, 0, 28672
    s_cmp_eq_u32 s18, 8
    s_cselect_b32 s92, 0, 32768
    s_cmp_eq_u32 s18, 9
    s_cselect_b32 s93, 0, 36864
    s_cmp_eq_u32 s18, 10
    s_cselect_b32 s94, 0, 40960
    s_cmp_eq_u32 s18, 11
    s_cselect_b32 s95, 0, 45056
    s_cmp_eq_u32 s18, 12
    s_cselect_b32 s96, 0, 49152
    s_cmp_eq_u32 s18, 13
    s_cselect_b32 s97, 0, 53248
    s_cmp_eq_u32 s18, 14
    s_cselect_b32 s98, 0, 57344
    s_cmp_eq_u32 s18, 15
    s_cselect_b32 s99, 0, 61440
    v_lshrrev_b32 v12, 4, v1
    v_and_b32 v13, 15, v12
    v_bfe_u32 v14, v12, 4, 1
    v_lshrrev_b32 v12, 5, v12
    v_lshl_add_u32 v2, v14, 5, v13
    v_lshlrev_b32 v2, 4, v2
    v_lshl_add_u32 v2, v12, 10, v2
    v_lshrrev_b32 v15, 2, v13
    v_lshl_add_u32 v15, v14, 2, v15
    v_lshlrev_b32 v3, 7, v15
    v_lshl_add_u32 v3, v12, 11, v3
    v_and_b32 v15, 3, v13
    v_lshl_add_u32 v3, v15, 3, v3
    v_lshrrev_b32 v15, 3, v13
    v_lshl_add_u32 v15, v15, 1, v14
    v_lshl_add_u32 v3, v15, 5, v3
    v_xor_b32 v4, 32, v3
    v_xor_b32 v5, 64, v3
    v_xor_b32 v6, 96, v3
    s_lshl_b32 s45, s16, 12
    s_add_u32 s45, s45, 131072
    v_lshrrev_b32 v35, 1, v33
    v_lshlrev_b32 v35, 10, v35
    v_lshl_add_u32 v35, v32, 4, v35
    v_and_b32 v36, 1, v33
    v_lshl_add_u32 v35, v36, 3, v35
    v_add_u32 v35, s45, v35
    v_add_u32 v36, s45, v1
    v_mov_b32 v37, 0x3f803f80
    v_and_b32 v38, 3, v8
    v_lshl_add_u32 v39, v38, 3, v32
    v_lshlrev_b32 v39, 3, v39
    v_mov_b32 v56, 0
    v_mov_b32 v57, 0
    v_mov_b32 v58, 0
    v_mov_b32 v59, 0
    v_mov_b32 v60, 0
    v_mov_b32 v61, 0
    v_mov_b32 v62, 0
    v_mov_b32 v63, 0
    s_waitcnt vmcnt(3)
    ds_write_b64 v35, v[40:41] offset:0
    ds_write_b64 v35, v[42:43] offset:512
    s_waitcnt vmcnt(2)
    ds_write_b64 v35, v[44:45] offset:128
    ds_write_b64 v35, v[46:47] offset:640
    s_waitcnt vmcnt(1)
    ds_write_b64 v35, v[48:49] offset:256
    ds_write_b64 v35, v[50:51] offset:768
    s_waitcnt vmcnt(0)
    ds_write_b64 v35, v[52:53] offset:384
    ds_write_b64 v35, v[54:55] offset:896
    ds_read_b128 v[64:67], v36 offset:0
    ds_read_b128 v[68:71], v36 offset:1024
    ds_read_b128 v[72:75], v36 offset:2048
    ds_read_b128 v[76:79], v36 offset:3072
    s_lshl_b32 s45, s20, 12
    s_add_u32 s46, s44, s45
    s_waitcnt lgkmcnt(3)
    buffer_store_dwordx4 v[64:67], v1, s[4:7], s46 offen offset:0 sc1
    s_waitcnt lgkmcnt(2)
    buffer_store_dwordx4 v[68:71], v1, s[4:7], s46 offen offset:1024 sc1
    s_waitcnt lgkmcnt(1)
    buffer_store_dwordx4 v[72:75], v1, s[4:7], s46 offen offset:2048 sc1
    s_waitcnt lgkmcnt(0)
    buffer_store_dwordx4 v[76:79], v1, s[4:7], s46 offen offset:3072 sc1
    v_dot2_f32_bf16 v56, v40, v37, v56
    v_dot2_f32_bf16 v57, v40, v40, v57
    v_dot2_f32_bf16 v58, v44, v37, v58
    v_dot2_f32_bf16 v59, v44, v44, v59
    v_dot2_f32_bf16 v60, v48, v37, v60
    v_dot2_f32_bf16 v61, v48, v48, v61
    v_dot2_f32_bf16 v62, v52, v37, v62
    v_dot2_f32_bf16 v63, v52, v52, v63
    v_dot2_f32_bf16 v56, v41, v37, v56
    v_dot2_f32_bf16 v57, v41, v41, v57
    v_dot2_f32_bf16 v58, v45, v37, v58
    v_dot2_f32_bf16 v59, v45, v45, v59
    v_dot2_f32_bf16 v60, v49, v37, v60
    v_dot2_f32_bf16 v61, v49, v49, v61
    v_dot2_f32_bf16 v62, v53, v37, v62
    v_dot2_f32_bf16 v63, v53, v53, v63
    v_dot2_f32_bf16 v56, v42, v37, v56
    v_dot2_f32_bf16 v57, v42, v42, v57
    v_dot2_f32_bf16 v58, v46, v37, v58
    v_dot2_f32_bf16 v59, v46, v46, v59
    v_dot2_f32_bf16 v60, v50, v37, v60
    v_dot2_f32_bf16 v61, v50, v50, v61
    v_dot2_f32_bf16 v62, v54, v37, v62
    v_dot2_f32_bf16 v63, v54, v54, v63
    v_dot2_f32_bf16 v56, v43, v37, v56
    v_dot2_f32_bf16 v57, v43, v43, v57
    v_dot2_f32_bf16 v58, v47, v37, v58
    v_dot2_f32_bf16 v59, v47, v47, v59
    v_dot2_f32_bf16 v60, v51, v37, v60
    v_dot2_f32_bf16 v61, v51, v51, v61
    v_dot2_f32_bf16 v62, v55, v37, v62
    v_dot2_f32_bf16 v63, v55, v55, v63
    s_nop 2
    v_add_f32_dpp v56, v56, v56 quad_perm:[1,0,3,2] row_mask:0xf bank_mask:0xf
    v_add_f32_dpp v57, v57, v57 quad_perm:[1,0,3,2] row_mask:0xf bank_mask:0xf
    v_add_f32_dpp v58, v58, v58 quad_perm:[1,0,3,2] row_mask:0xf bank_mask:0xf
    v_add_f32_dpp v59, v59, v59 quad_perm:[1,0,3,2] row_mask:0xf bank_mask:0xf
    v_add_f32_dpp v60, v60, v60 quad_perm:[1,0,3,2] row_mask:0xf bank_mask:0xf
    v_add_f32_dpp v61, v61, v61 quad_perm:[1,0,3,2] row_mask:0xf bank_mask:0xf
    v_add_f32_dpp v62, v62, v62 quad_perm:[1,0,3,2] row_mask:0xf bank_mask:0xf
    v_add_f32_dpp v63, v63, v63 quad_perm:[1,0,3,2] row_mask:0xf bank_mask:0xf
    v_add_f32_dpp v56, v56, v56 quad_perm:[2,3,0,1] row_mask:0xf bank_mask:0xf
    v_add_f32_dpp v57, v57, v57 quad_perm:[2,3,0,1] row_mask:0xf bank_mask:0xf
    v_add_f32_dpp v58, v58, v58 quad_perm:[2,3,0,1] row_mask:0xf bank_mask:0xf
    v_add_f32_dpp v59, v59, v59 quad_perm:[2,3,0,1] row_mask:0xf bank_mask:0xf
    v_add_f32_dpp v60, v60, v60 quad_perm:[2,3,0,1] row_mask:0xf bank_mask:0xf
    v_add_f32_dpp v61, v61, v61 quad_perm:[2,3,0,1] row_mask:0xf bank_mask:0xf
    v_add_f32_dpp v62, v62, v62 quad_perm:[2,3,0,1] row_mask:0xf bank_mask:0xf
    v_add_f32_dpp v63, v63, v63 quad_perm:[2,3,0,1] row_mask:0xf bank_mask:0xf
    v_add_f32_dpp v56, v56, v56 row_half_mirror row_mask:0xf bank_mask:0xf
    v_add_f32_dpp v57, v57, v57 row_half_mirror row_mask:0xf bank_mask:0xf
    v_add_f32_dpp v58, v58, v58 row_half_mirror row_mask:0xf bank_mask:0xf
    v_add_f32_dpp v59, v59, v59 row_half_mirror row_mask:0xf bank_mask:0xf
    v_add_f32_dpp v60, v60, v60 row_half_mirror row_mask:0xf bank_mask:0xf
    v_add_f32_dpp v61, v61, v61 row_half_mirror row_mask:0xf bank_mask:0xf
    v_add_f32_dpp v62, v62, v62 row_half_mirror row_mask:0xf bank_mask:0xf
    v_add_f32_dpp v63, v63, v63 row_half_mirror row_mask:0xf bank_mask:0xf
    v_cmp_eq_u32 vcc, 1, v38
    s_nop 1
    v_cndmask_b32 v56, v56, v58, vcc
    v_cndmask_b32 v57, v57, v59, vcc
    v_cmp_eq_u32 vcc, 2, v38
    s_nop 1
    v_cndmask_b32 v56, v56, v60, vcc
    v_cndmask_b32 v57, v57, v61, vcc
    v_cmp_eq_u32 vcc, 3, v38
    s_nop 1
    v_cndmask_b32 v56, v56, v62, vcc
    v_cndmask_b32 v57, v57, v63, vcc
    s_lshl_b32 s44, s21, 18
    s_lshl_b32 s45, s39, 12
    s_add_u32 s44, s44, s45
    s_lshl_b32 s45, s20, 8
    s_add_u32 s44, s44, s45
    s_add_u32 s44, s44, 50331648
    buffer_store_dwordx2 v[56:57], v39, s[4:7], s44 offen sc1
    s_lshl_b32 s46, s21, 14
    s_lshl_b32 s67, s39, 7
    s_add_u32 s46, s46, s67
    s_add_u32 s46, s46, 4096
    s_add_u32 s47, s46, 8192
    s_lshl_b32 s48, s21, 22
    s_lshl_b32 s49, s38, 16
    s_add_u32 s41, s48, s49
    s_lshl_b32 s48, s21, 14
    s_lshl_b32 s67, s38, 7
    s_add_u32 s48, s48, s67
    s_add_u32 s48, s48, 4096
    v_lshrrev_b32 v16, 4, v1
    v_and_b32 v17, 15, v16
    v_lshrrev_b32 v16, 4, v16
    s_lshl_b32 s49, s16, 7
    s_add_u32 s50, s49, 151552
    s_and_b32 s49, s21, 1
    s_lshl_b32 s49, s49, 10
    s_add_u32 s49, s49, 151552
    v_lshlrev_b32 v11, 4, v16
    v_add_u32 v13, s50, v11
    v_add_u32 v11, s49, v11
    v_lshlrev_b32 v15, 2, v17
    v_add_u32 v9, s50, v15
    v_add_u32 v15, s49, v15
    s_lshr_b32 s49, s21, 1
    s_lshl_b32 s53, s49, 23
    s_lshl_b32 s50, s18, 18
    s_add_u32 s53, s53, s50
    s_add_u32 s53, s53, 33554432
    s_lshl_b32 s54, s38, 11
    s_add_u32 s52, s53, s54
    s_lshl_b32 s59, s49, 13
    s_lshl_b32 s67, s18, 9
    s_add_u32 s59, s59, s67
    s_lshl_b32 s67, s16, 7
    s_add_u32 s59, s59, s67
    s_add_u32 s59, s59, 69632
    s_lshl_b32 s61, s49, 15
    s_lshl_b32 s67, s17, 11
    s_add_u32 s61, s61, s67
    s_lshl_b32 s67, s18, 7
    s_add_u32 s61, s61, s67
    s_add_u32 s61, s61, 151552
    s_sub_u32 s60, s61, 151552
    s_lshl_b32 s60, s60, 5
    s_add_u32 s60, s60, 54525952
    s_lshl_b32 s62, s16, 12
    s_add_u32 s62, s62, 131072
    v_bfe_u32 v80, v8, 3, 1
    v_and_b32 v81, 7, v8
    v_lshrrev_b32 v82, 5, v8
    v_lshlrev_b32 v82, 1, v82
    v_xor_b32 v82, v82, v81
    v_xor_b32 v82, v82, v80
    v_lshlrev_b32 v82, 4, v82
    v_lshl_add_u32 v82, v81, 7, v82
    v_lshl_add_u32 v82, v80, 10, v82
    v_bfe_u32 v80, v8, 4, 1
    v_lshl_add_u32 v82, v80, 3, v82
    v_add_u32 v84, s76, v82
    v_xor_b32 v85, 16, v84
    v_xor_b32 v86, 64, v84
    v_xor_b32 v87, 80, v84
    s_waitcnt vmcnt(0)
    s_add_u32 m0, s76, 0
    s_lshr_b32 s78, s84, 5
    s_add_u32 s78, s78, s77
    buffer_load_dwordx4 v88, s[8:11], s78 offen offset:0 lds
    buffer_load_dwordx4 v89, s[8:11], s78 offen offset:1024 lds
    buffer_load_dwordx4 v90, s[8:11], s78 offen offset:2048 lds
    buffer_load_dwordx4 v91, s[8:11], s78 offen offset:3072 lds
    s_add_u32 m0, s76, 4096
    s_lshr_b32 s78, s85, 5
    s_add_u32 s78, s78, s77
    buffer_load_dwordx4 v88, s[8:11], s78 offen offset:0 lds
    buffer_load_dwordx4 v89, s[8:11], s78 offen offset:1024 lds
    buffer_load_dwordx4 v90, s[8:11], s78 offen offset:2048 lds
    buffer_load_dwordx4 v91, s[8:11], s78 offen offset:3072 lds
    s_add_u32 m0, s76, 8192
    s_lshr_b32 s78, s86, 5
    s_add_u32 s78, s78, s77
    buffer_load_dwordx4 v88, s[8:11], s78 offen offset:0 lds
    buffer_load_dwordx4 v89, s[8:11], s78 offen offset:1024 lds
    buffer_load_dwordx4 v90, s[8:11], s78 offen offset:2048 lds
    buffer_load_dwordx4 v91, s[8:11], s78 offen offset:3072 lds
    s_add_u32 m0, s76, 12288
    s_lshr_b32 s78, s87, 5
    s_add_u32 s78, s78, s77
    buffer_load_dwordx4 v88, s[8:11], s78 offen offset:0 lds
    buffer_load_dwordx4 v89, s[8:11], s78 offen offset:1024 lds
    buffer_load_dwordx4 v90, s[8:11], s78 offen offset:2048 lds
    buffer_load_dwordx4 v91, s[8:11], s78 offen offset:3072 lds
    s_barrier
    s_load_dword s68, s[34:35], 0
    s_mov_b32 s8, s34
    s_mov_b32 s9, s35
    s_mov_b32 s10, 256
    s_mov_b32 s11, 0x00020000
    s_mov_b32 s66, 0x10000
    v_mov_b32 v16, 0
    s_waitcnt lgkmcnt(0)
c_f0:
    s_cmp_eq_u32 s68, 6
    s_cbranch_scc1 c_f0_ok
    buffer_load_dword v17, v16, s[8:11], 0 offen offset:0 sc1
    s_waitcnt vmcnt(0)
    v_readfirstlane_b32 s68, v17
    s_sub_u32 s66, s66, 1
    s_cmp_lg_u32 s66, 0
    s_cbranch_scc1 c_f0
c_f0_ok:
    s_atomic_add s40, s[22:23], s47
    s_waitcnt vmcnt(0)
    ds_read_b64 v[160:161], v84 offset:0
    ds_read_b64 v[162:163], v85 offset:0
    ds_read_b64 v[164:165], v84 offset:2048
    ds_read_b64 v[166:167], v85 offset:2048
    ds_read_b64 v[168:169], v86 offset:0
    ds_read_b64 v[170:171], v87 offset:0
    ds_read_b64 v[172:173], v86 offset:2048
    ds_read_b64 v[174:175], v87 offset:2048
    ds_read_b64 v[176:177], v84 offset:4096
    ds_read_b64 v[178:179], v85 offset:4096
    ds_read_b64 v[180:181], v84 offset:6144
    ds_read_b64 v[182:183], v85 offset:6144
    ds_read_b64 v[184:185], v86 offset:4096
    ds_read_b64 v[186:187], v87 offset:4096
    ds_read_b64 v[188:189], v86 offset:6144
    ds_read_b64 v[190:191], v87 offset:6144
    ds_read_b64 v[192:193], v84 offset:8192
    ds_read_b64 v[194:195], v85 offset:8192
    ds_read_b64 v[196:197], v84 offset:10240
    ds_read_b64 v[198:199], v85 offset:10240
    ds_read_b64 v[200:201], v86 offset:8192
    ds_read_b64 v[202:203], v87 offset:8192
    ds_read_b64 v[204:205], v86 offset:10240
    ds_read_b64 v[206:207], v87 offset:10240
    ds_read_b64 v[208:209], v84 offset:12288
    ds_read_b64 v[210:211], v85 offset:12288
    ds_read_b64 v[212:213], v84 offset:14336
    ds_read_b64 v[214:215], v85 offset:14336
    ds_read_b64 v[216:217], v86 offset:12288
    ds_read_b64 v[218:219], v87 offset:12288
    ds_read_b64 v[220:221], v86 offset:14336
    ds_read_b64 v[222:223], v87 offset:14336
    s_waitcnt lgkmcnt(0)
    s_mov_b64 vcc, -1
    s_barrier
    ds_read_b64_tr_b16 v[32:33], v3 offset:0
    ds_read_b64_tr_b16 v[34:35], v3 offset:1024
    ds_read_b64_tr_b16 v[36:37], v4 offset:0
    ds_read_b64_tr_b16 v[38:39], v4 offset:1024
    ds_read_b64_tr_b16 v[40:41], v5 offset:0
    ds_read_b64_tr_b16 v[42:43], v5 offset:1024
    ds_read_b64_tr_b16 v[44:45], v6 offset:0
    ds_read_b64_tr_b16 v[46:47], v6 offset:1024
    ds_read_b64_tr_b16 v[48:49], v3 offset:4096
    ds_read_b64_tr_b16 v[50:51], v3 offset:5120
    ds_read_b64_tr_b16 v[52:53], v4 offset:4096
    ds_read_b64_tr_b16 v[54:55], v4 offset:5120
    ds_read_b64_tr_b16 v[56:57], v5 offset:4096
    ds_read_b64_tr_b16 v[58:59], v5 offset:5120
    s_branch c_g0
c_layer:
    s_lshl_b32 s48, s21, 22
    s_lshl_b32 s49, s38, 16
    s_add_u32 s41, s48, s49
    s_lshl_b32 s48, s21, 14
    s_lshl_b32 s67, s38, 7
    s_add_u32 s48, s48, s67
    s_add_u32 s48, s48, 4096
    v_lshrrev_b32 v16, 4, v1
    v_and_b32 v17, 15, v16
    v_lshrrev_b32 v16, 4, v16
    s_lshl_b32 s49, s16, 7
    s_add_u32 s50, s49, 151552
    s_and_b32 s49, s21, 1
    s_lshl_b32 s49, s49, 10
    s_add_u32 s49, s49, 151552
    v_lshlrev_b32 v11, 4, v16
    v_add_u32 v13, s50, v11
    v_add_u32 v11, s49, v11
    v_lshlrev_b32 v15, 2, v17
    v_add_u32 v9, s50, v15
    v_add_u32 v15, s49, v15
    s_lshr_b32 s49, s21, 1
    s_lshl_b32 s53, s49, 23
    s_lshl_b32 s50, s18, 18
    s_add_u32 s53, s53, s50
    s_add_u32 s53, s53, 33554432
    s_lshl_b32 s54, s38, 11
    s_add_u32 s52, s53, s54
    s_lshl_b32 s59, s49, 13
    s_lshl_b32 s67, s18, 9
    s_add_u32 s59, s59, s67
    s_lshl_b32 s67, s16, 7
    s_add_u32 s59, s59, s67
    s_add_u32 s59, s59, 69632
    s_lshl_b32 s61, s49, 15
    s_lshl_b32 s67, s17, 11
    s_add_u32 s61, s61, s67
    s_lshl_b32 s67, s18, 7
    s_add_u32 s61, s61, s67
    s_add_u32 s61, s61, 151552
    s_sub_u32 s60, s61, 151552
    s_lshl_b32 s60, s60, 5
    s_add_u32 s60, s60, 54525952
    s_lshl_b32 s62, s16, 12
    s_add_u32 s62, s62, 131072
    s_mov_b32 s68, 0
    s_atomic_add s68, s[22:23], s48 glc
    s_mov_b64 vcc, 0
    s_barrier
    ds_read_b64_tr_b16 v[32:33], v3 offset:0
    ds_read_b64_tr_b16 v[34:35], v3 offset:1024
    ds_read_b64_tr_b16 v[36:37], v4 offset:0
    ds_read_b64_tr_b16 v[38:39], v4 offset:1024
    ds_read_b64_tr_b16 v[40:41], v5 offset:0
    ds_read_b64_tr_b16 v[42:43], v5 offset:1024
    ds_read_b64_tr_b16 v[44:45], v6 offset:0
    ds_read_b64_tr_b16 v[46:47], v6 offset:1024
    ds_read_b64_tr_b16 v[48:49], v3 offset:4096
    ds_read_b64_tr_b16 v[50:51], v3 offset:5120
    ds_read_b64_tr_b16 v[52:53], v4 offset:4096
    ds_read_b64_tr_b16 v[54:55], v4 offset:5120
    ds_read_b64_tr_b16 v[56:57], v5 offset:4096
    ds_read_b64_tr_b16 v[58:59], v5 offset:5120
c_g0:
    s_waitcnt lgkmcnt(10)
    v_mfma_f32_16x16x32_bf16 v[64:67], v[32:35], v[160:163], 0
    ds_read_b64_tr_b16 v[60:61], v6 offset:4096
    v_mfma_f32_16x16x32_bf16 v[68:71], v[32:35], v[164:167], 0
    ds_read_b64_tr_b16 v[62:63], v6 offset:5120
    v_mfma_f32_16x16x32_bf16 v[72:75], v[36:39], v[160:163], 0
    ds_read_b64_tr_b16 v[32:33], v3 offset:8192
    v_mfma_f32_16x16x32_bf16 v[76:79], v[36:39], v[164:167], 0
    ds_read_b64_tr_b16 v[34:35], v3 offset:9216
    s_waitcnt lgkmcnt(10)
    v_mfma_f32_16x16x32_bf16 v[80:83], v[40:43], v[160:163], 0
    ds_read_b64_tr_b16 v[36:37], v4 offset:8192
    v_mfma_f32_16x16x32_bf16 v[84:87], v[40:43], v[164:167], 0
    ds_read_b64_tr_b16 v[38:39], v4 offset:9216
    v_mfma_f32_16x16x32_bf16 v[88:91], v[44:47], v[160:163], 0
    ds_read_b64_tr_b16 v[40:41], v5 offset:8192
    v_mfma_f32_16x16x32_bf16 v[92:95], v[44:47], v[164:167], 0
    ds_read_b64_tr_b16 v[42:43], v5 offset:9216
    s_waitcnt lgkmcnt(10)
    v_mfma_f32_16x16x32_bf16 v[96:99], v[160:163], v[48:51], 0
    ds_read_b64_tr_b16 v[44:45], v6 offset:8192
    v_mfma_f32_16x16x32_bf16 v[100:103], v[164:167], v[48:51], 0
    ds_read_b64_tr_b16 v[46:47], v6 offset:9216
    v_mfma_f32_16x16x32_bf16 v[104:107], v[160:163], v[52:55], 0
    ds_read_b64_tr_b16 v[48:49], v3 offset:12288
    v_mfma_f32_16x16x32_bf16 v[108:111], v[164:167], v[52:55], 0
    ds_read_b64_tr_b16 v[50:51], v3 offset:13312
    s_waitcnt lgkmcnt(10)
    v_mfma_f32_16x16x32_bf16 v[112:115], v[160:163], v[56:59], 0
    ds_read_b64_tr_b16 v[52:53], v4 offset:12288
    v_mfma_f32_16x16x32_bf16 v[116:119], v[164:167], v[56:59], 0
    ds_read_b64_tr_b16 v[54:55], v4 offset:13312
    v_mfma_f32_16x16x32_bf16 v[120:123], v[160:163], v[60:63], 0
    ds_read_b64_tr_b16 v[56:57], v5 offset:12288
    v_mfma_f32_16x16x32_bf16 v[124:127], v[164:167], v[60:63], 0
    ds_read_b64_tr_b16 v[58:59], v5 offset:13312
    s_cbranch_vccnz c_gate
    s_mov_b32 s66, 0x10000
    s_waitcnt lgkmcnt(0)
    s_cmp_eq_u32 s68, 16
    s_cbranch_scc1 c_x_ok
c_x_poll:
    s_mov_b32 s68, 0
    s_atomic_add s68, s[22:23], s48 offset:0 glc
    s_sub_u32 s66, s66, 1
    s_cselect_b32 s67, 16, 0
    s_waitcnt lgkmcnt(0)
    s_max_u32 s68, s68, s67
    s_cmp_lt_u32 s68, 16
    s_cbranch_scc1 c_x_poll
c_x_ok:
    s_add_u32 s42, s41, s85
    buffer_load_dwordx4 v[176:179], v2, s[4:7], s42 offen offset:0 sc1
    buffer_load_dwordx4 v[180:183], v2, s[4:7], s42 offen offset:256 sc1
    buffer_load_dwordx4 v[184:187], v2, s[4:7], s42 offen offset:2048 sc1
    buffer_load_dwordx4 v[188:191], v2, s[4:7], s42 offen offset:2304 sc1
    s_add_u32 s42, s41, s86
    buffer_load_dwordx4 v[192:195], v2, s[4:7], s42 offen offset:0 sc1
    buffer_load_dwordx4 v[196:199], v2, s[4:7], s42 offen offset:256 sc1
    buffer_load_dwordx4 v[200:203], v2, s[4:7], s42 offen offset:2048 sc1
    buffer_load_dwordx4 v[204:207], v2, s[4:7], s42 offen offset:2304 sc1
    s_add_u32 s42, s41, s87
    buffer_load_dwordx4 v[208:211], v2, s[4:7], s42 offen offset:0 sc1
    buffer_load_dwordx4 v[212:215], v2, s[4:7], s42 offen offset:256 sc1
    s_waitcnt vmcnt(10)
    s_atomic_add s40, s[22:23], s47
c_gate:
    s_waitcnt lgkmcnt(10)
    v_mfma_f32_16x16x32_bf16 v[128:131], v[32:35], v[160:163], 0
    ds_read_b64_tr_b16 v[60:61], v6 offset:12288
    v_mfma_f32_16x16x32_bf16 v[132:135], v[32:35], v[164:167], 0
    ds_read_b64_tr_b16 v[62:63], v6 offset:13312
    v_mfma_f32_16x16x32_bf16 v[136:139], v[36:39], v[160:163], 0
    ds_read_b64_tr_b16 v[32:33], v3 offset:16384
    v_mfma_f32_16x16x32_bf16 v[140:143], v[36:39], v[164:167], 0
    ds_read_b64_tr_b16 v[34:35], v3 offset:17408
    s_waitcnt lgkmcnt(10)
    v_mfma_f32_16x16x32_bf16 v[144:147], v[40:43], v[160:163], 0
    ds_read_b64_tr_b16 v[36:37], v4 offset:16384
    v_mfma_f32_16x16x32_bf16 v[148:151], v[40:43], v[164:167], 0
    ds_read_b64_tr_b16 v[38:39], v4 offset:17408
    v_mfma_f32_16x16x32_bf16 v[152:155], v[44:47], v[160:163], 0
    ds_read_b64_tr_b16 v[40:41], v5 offset:16384
    v_mfma_f32_16x16x32_bf16 v[156:159], v[44:47], v[164:167], 0
    ds_read_b64_tr_b16 v[42:43], v5 offset:17408
    s_waitcnt lgkmcnt(10)
    v_mfma_f32_16x16x32_bf16 v[64:67], v[48:51], v[168:171], v[64:67]
    ds_read_b64_tr_b16 v[44:45], v6 offset:16384
    v_mfma_f32_16x16x32_bf16 v[68:71], v[48:51], v[172:175], v[68:71]
    ds_read_b64_tr_b16 v[46:47], v6 offset:17408
    v_mfma_f32_16x16x32_bf16 v[72:75], v[52:55], v[168:171], v[72:75]
    ds_read_b64_tr_b16 v[48:49], v3 offset:20480
    v_mfma_f32_16x16x32_bf16 v[76:79], v[52:55], v[172:175], v[76:79]
    ds_read_b64_tr_b16 v[50:51], v3 offset:21504
    s_waitcnt lgkmcnt(10)
    v_mfma_f32_16x16x32_bf16 v[80:83], v[56:59], v[168:171], v[80:83]
    ds_read_b64_tr_b16 v[52:53], v4 offset:20480
    v_mfma_f32_16x16x32_bf16 v[84:87], v[56:59], v[172:175], v[84:87]
    ds_read_b64_tr_b16 v[54:55], v4 offset:21504
    v_mfma_f32_16x16x32_bf16 v[88:91], v[60:63], v[168:171], v[88:91]
    ds_read_b64_tr_b16 v[56:57], v5 offset:20480
    v_mfma_f32_16x16x32_bf16 v[92:95], v[60:63], v[172:175], v[92:95]
    ds_read_b64_tr_b16 v[58:59], v5 offset:21504
    s_waitcnt lgkmcnt(10)
    v_mfma_f32_16x16x32_bf16 v[96:99], v[168:171], v[32:35], v[96:99]
    ds_read_b64_tr_b16 v[60:61], v6 offset:20480
    v_mfma_f32_16x16x32_bf16 v[100:103], v[172:175], v[32:35], v[100:103]
    ds_read_b64_tr_b16 v[62:63], v6 offset:21504
    v_mfma_f32_16x16x32_bf16 v[104:107], v[168:171], v[36:39], v[104:107]
    ds_read_b64_tr_b16 v[32:33], v3 offset:24576
    v_mfma_f32_16x16x32_bf16 v[108:111], v[172:175], v[36:39], v[108:111]
    ds_read_b64_tr_b16 v[34:35], v3 offset:25600
    s_waitcnt lgkmcnt(10)
    v_mfma_f32_16x16x32_bf16 v[112:115], v[168:171], v[40:43], v[112:115]
    ds_read_b64_tr_b16 v[36:37], v4 offset:24576
    v_mfma_f32_16x16x32_bf16 v[116:119], v[172:175], v[40:43], v[116:119]
    ds_read_b64_tr_b16 v[38:39], v4 offset:25600
    v_mfma_f32_16x16x32_bf16 v[120:123], v[168:171], v[44:47], v[120:123]
    ds_read_b64_tr_b16 v[40:41], v5 offset:24576
    v_mfma_f32_16x16x32_bf16 v[124:127], v[172:175], v[44:47], v[124:127]
    ds_read_b64_tr_b16 v[42:43], v5 offset:25600
    s_waitcnt lgkmcnt(10)
    v_mfma_f32_16x16x32_bf16 v[128:131], v[48:51], v[168:171], v[128:131]
    ds_read_b64_tr_b16 v[44:45], v6 offset:24576
    v_mfma_f32_16x16x32_bf16 v[132:135], v[48:51], v[172:175], v[132:135]
    ds_read_b64_tr_b16 v[46:47], v6 offset:25600
    v_mfma_f32_16x16x32_bf16 v[136:139], v[52:55], v[168:171], v[136:139]
    ds_read_b64_tr_b16 v[48:49], v3 offset:28672
    v_mfma_f32_16x16x32_bf16 v[140:143], v[52:55], v[172:175], v[140:143]
    ds_read_b64_tr_b16 v[50:51], v3 offset:29696
    s_waitcnt lgkmcnt(10)
    v_mfma_f32_16x16x32_bf16 v[144:147], v[56:59], v[168:171], v[144:147]
    ds_read_b64_tr_b16 v[52:53], v4 offset:28672
    v_mfma_f32_16x16x32_bf16 v[148:151], v[56:59], v[172:175], v[148:151]
    ds_read_b64_tr_b16 v[54:55], v4 offset:29696
    v_mfma_f32_16x16x32_bf16 v[152:155], v[60:63], v[168:171], v[152:155]
    ds_read_b64_tr_b16 v[56:57], v5 offset:28672
    v_mfma_f32_16x16x32_bf16 v[156:159], v[60:63], v[172:175], v[156:159]
    ds_read_b64_tr_b16 v[58:59], v5 offset:29696
    s_waitcnt vmcnt(8) lgkmcnt(10)
    v_mfma_f32_16x16x32_bf16 v[64:67], v[32:35], v[176:179], v[64:67]
    ds_read_b64_tr_b16 v[60:61], v6 offset:28672
    v_mfma_f32_16x16x32_bf16 v[68:71], v[32:35], v[180:183], v[68:71]
    ds_read_b64_tr_b16 v[62:63], v6 offset:29696
    s_barrier
    v_mfma_f32_16x16x32_bf16 v[72:75], v[36:39], v[176:179], v[72:75]
    ds_read_b64_tr_b16 v[32:33], v3 offset:32768
    v_mfma_f32_16x16x32_bf16 v[76:79], v[36:39], v[180:183], v[76:79]
    ds_read_b64_tr_b16 v[34:35], v3 offset:33792
    s_waitcnt lgkmcnt(10)
    v_mfma_f32_16x16x32_bf16 v[80:83], v[40:43], v[176:179], v[80:83]
    ds_read_b64_tr_b16 v[36:37], v4 offset:32768
    v_mfma_f32_16x16x32_bf16 v[84:87], v[40:43], v[180:183], v[84:87]
    ds_read_b64_tr_b16 v[38:39], v4 offset:33792
    v_mfma_f32_16x16x32_bf16 v[88:91], v[44:47], v[176:179], v[88:91]
    ds_read_b64_tr_b16 v[40:41], v5 offset:32768
    v_mfma_f32_16x16x32_bf16 v[92:95], v[44:47], v[180:183], v[92:95]
    ds_read_b64_tr_b16 v[42:43], v5 offset:33792
    s_waitcnt lgkmcnt(10)
    v_mfma_f32_16x16x32_bf16 v[96:99], v[176:179], v[48:51], v[96:99]
    ds_read_b64_tr_b16 v[44:45], v6 offset:32768
    v_mfma_f32_16x16x32_bf16 v[100:103], v[180:183], v[48:51], v[100:103]
    ds_read_b64_tr_b16 v[46:47], v6 offset:33792
    v_mfma_f32_16x16x32_bf16 v[104:107], v[176:179], v[52:55], v[104:107]
    ds_read_b64_tr_b16 v[48:49], v3 offset:36864
    v_mfma_f32_16x16x32_bf16 v[108:111], v[180:183], v[52:55], v[108:111]
    ds_read_b64_tr_b16 v[50:51], v3 offset:37888
    s_waitcnt lgkmcnt(10)
    v_mfma_f32_16x16x32_bf16 v[112:115], v[176:179], v[56:59], v[112:115]
    ds_read_b64_tr_b16 v[52:53], v4 offset:36864
    v_mfma_f32_16x16x32_bf16 v[116:119], v[180:183], v[56:59], v[116:119]
    ds_read_b64_tr_b16 v[54:55], v4 offset:37888
    v_mfma_f32_16x16x32_bf16 v[120:123], v[176:179], v[60:63], v[120:123]
    ds_read_b64_tr_b16 v[56:57], v5 offset:36864
    v_mfma_f32_16x16x32_bf16 v[124:127], v[180:183], v[60:63], v[124:127]
    ds_read_b64_tr_b16 v[58:59], v5 offset:37888
    s_waitcnt lgkmcnt(10)
    v_mfma_f32_16x16x32_bf16 v[128:131], v[32:35], v[176:179], v[128:131]
    ds_read_b64_tr_b16 v[60:61], v6 offset:36864
    v_mfma_f32_16x16x32_bf16 v[132:135], v[32:35], v[180:183], v[132:135]
    ds_read_b64_tr_b16 v[62:63], v6 offset:37888
    v_mfma_f32_16x16x32_bf16 v[136:139], v[36:39], v[176:179], v[136:139]
    ds_read_b64_tr_b16 v[32:33], v3 offset:40960
    v_mfma_f32_16x16x32_bf16 v[140:143], v[36:39], v[180:183], v[140:143]
    ds_read_b64_tr_b16 v[34:35], v3 offset:41984
    s_waitcnt lgkmcnt(10)
    v_mfma_f32_16x16x32_bf16 v[144:147], v[40:43], v[176:179], v[144:147]
    ds_read_b64_tr_b16 v[36:37], v4 offset:40960
    v_mfma_f32_16x16x32_bf16 v[148:151], v[40:43], v[180:183], v[148:151]
    ds_read_b64_tr_b16 v[38:39], v4 offset:41984
    v_mfma_f32_16x16x32_bf16 v[152:155], v[44:47], v[176:179], v[152:155]
    ds_read_b64_tr_b16 v[40:41], v5 offset:40960
    v_mfma_f32_16x16x32_bf16 v[156:159], v[44:47], v[180:183], v[156:159]
    ds_read_b64_tr_b16 v[42:43], v5 offset:41984
    s_waitcnt vmcnt(6) lgkmcnt(10)
    v_mfma_f32_16x16x32_bf16 v[64:67], v[48:51], v[184:187], v[64:67]
    ds_read_b64_tr_b16 v[44:45], v6 offset:40960
    s_add_u32 s42, s41, s87
    s_cbranch_vccnz xs1
    buffer_load_dwordx4 v[216:219], v2, s[4:7], s42 offen offset:2048 sc1
xs1:
    v_mfma_f32_16x16x32_bf16 v[68:71], v[48:51], v[188:191], v[68:71]
    ds_read_b64_tr_b16 v[46:47], v6 offset:41984
    v_mfma_f32_16x16x32_bf16 v[72:75], v[52:55], v[184:187], v[72:75]
    ds_read_b64_tr_b16 v[48:49], v3 offset:45056
    s_cbranch_vccnz xs2
    buffer_load_dwordx4 v[220:223], v2, s[4:7], s42 offen offset:2304 sc1
xs2:
    v_mfma_f32_16x16x32_bf16 v[76:79], v[52:55], v[188:191], v[76:79]
    ds_read_b64_tr_b16 v[50:51], v3 offset:46080
    s_waitcnt lgkmcnt(10)
    v_mfma_f32_16x16x32_bf16 v[80:83], v[56:59], v[184:187], v[80:83]
    ds_read_b64_tr_b16 v[52:53], v4 offset:45056
    s_add_u32 s42, s41, s88
    buffer_load_dwordx4 v[224:227], v2, s[4:7], s42 offen offset:0 sc1
    v_mfma_f32_16x16x32_bf16 v[84:87], v[56:59], v[188:191], v[84:87]
    ds_read_b64_tr_b16 v[54:55], v4 offset:46080
    v_mfma_f32_16x16x32_bf16 v[88:91], v[60:63], v[184:187], v[88:91]
    ds_read_b64_tr_b16 v[56:57], v5 offset:45056
    buffer_load_dwordx4 v[228:231], v2, s[4:7], s42 offen offset:256 sc1
    v_mfma_f32_16x16x32_bf16 v[92:95], v[60:63], v[188:191], v[92:95]
    ds_read_b64_tr_b16 v[58:59], v5 offset:46080
    s_waitcnt lgkmcnt(10)
    v_mfma_f32_16x16x32_bf16 v[96:99], v[184:187], v[32:35], v[96:99]
    ds_read_b64_tr_b16 v[60:61], v6 offset:45056
    buffer_load_dwordx4 v[232:235], v2, s[4:7], s42 offen offset:2048 sc1
    v_mfma_f32_16x16x32_bf16 v[100:103], v[188:191], v[32:35], v[100:103]
    ds_read_b64_tr_b16 v[62:63], v6 offset:46080
    v_mfma_f32_16x16x32_bf16 v[104:107], v[184:187], v[36:39], v[104:107]
    ds_read_b64_tr_b16 v[32:33], v3 offset:49152
    buffer_load_dwordx4 v[236:239], v2, s[4:7], s42 offen offset:2304 sc1
    v_mfma_f32_16x16x32_bf16 v[108:111], v[188:191], v[36:39], v[108:111]
    ds_read_b64_tr_b16 v[34:35], v3 offset:50176
    s_waitcnt lgkmcnt(10)
    v_mfma_f32_16x16x32_bf16 v[112:115], v[184:187], v[40:43], v[112:115]
    ds_read_b64_tr_b16 v[36:37], v4 offset:49152
    s_add_u32 s42, s41, s89
    buffer_load_dwordx4 v[240:243], v2, s[4:7], s42 offen offset:0 sc1
    v_mfma_f32_16x16x32_bf16 v[116:119], v[188:191], v[40:43], v[116:119]
    ds_read_b64_tr_b16 v[38:39], v4 offset:50176
    v_mfma_f32_16x16x32_bf16 v[120:123], v[184:187], v[44:47], v[120:123]
    ds_read_b64_tr_b16 v[40:41], v5 offset:49152
    buffer_load_dwordx4 v[244:247], v2, s[4:7], s42 offen offset:256 sc1
    v_mfma_f32_16x16x32_bf16 v[124:127], v[188:191], v[44:47], v[124:127]
    ds_read_b64_tr_b16 v[42:43], v5 offset:50176
    s_waitcnt lgkmcnt(10)
    v_mfma_f32_16x16x32_bf16 v[128:131], v[48:51], v[184:187], v[128:131]
    ds_read_b64_tr_b16 v[44:45], v6 offset:49152
    buffer_load_dwordx4 v[248:251], v2, s[4:7], s42 offen offset:2048 sc1
    v_mfma_f32_16x16x32_bf16 v[132:135], v[48:51], v[188:191], v[132:135]
    ds_read_b64_tr_b16 v[46:47], v6 offset:50176
    v_mfma_f32_16x16x32_bf16 v[136:139], v[52:55], v[184:187], v[136:139]
    ds_read_b64_tr_b16 v[48:49], v3 offset:53248
    v_mfma_f32_16x16x32_bf16 v[140:143], v[52:55], v[188:191], v[140:143]
    ds_read_b64_tr_b16 v[50:51], v3 offset:54272
    s_waitcnt lgkmcnt(10)
    v_mfma_f32_16x16x32_bf16 v[144:147], v[56:59], v[184:187], v[144:147]
    ds_read_b64_tr_b16 v[52:53], v4 offset:53248
    v_mfma_f32_16x16x32_bf16 v[148:151], v[56:59], v[188:191], v[148:151]
    ds_read_b64_tr_b16 v[54:55], v4 offset:54272
    v_mfma_f32_16x16x32_bf16 v[152:155], v[60:63], v[184:187], v[152:155]
    ds_read_b64_tr_b16 v[56:57], v5 offset:53248
    v_mfma_f32_16x16x32_bf16 v[156:159], v[60:63], v[188:191], v[156:159]
    ds_read_b64_tr_b16 v[58:59], v5 offset:54272
    s_waitcnt vmcnt(13) lgkmcnt(10)
    v_mfma_f32_16x16x32_bf16 v[64:67], v[32:35], v[192:195], v[64:67]
    ds_read_b64_tr_b16 v[60:61], v6 offset:53248
    buffer_load_dwordx4 v[252:255], v2, s[4:7], s42 offen offset:2304 sc1
    v_mfma_f32_16x16x32_bf16 v[68:71], v[32:35], v[196:199], v[68:71]
    ds_read_b64_tr_b16 v[62:63], v6 offset:54272
    v_mfma_f32_16x16x32_bf16 v[72:75], v[36:39], v[192:195], v[72:75]
    ds_read_b64_tr_b16 v[32:33], v3 offset:57344
    v_mfma_f32_16x16x32_bf16 v[76:79], v[36:39], v[196:199], v[76:79]
    ds_read_b64_tr_b16 v[34:35], v3 offset:58368
    s_waitcnt lgkmcnt(10)
    v_mfma_f32_16x16x32_bf16 v[80:83], v[40:43], v[192:195], v[80:83]
    ds_read_b64_tr_b16 v[36:37], v4 offset:57344
    v_mfma_f32_16x16x32_bf16 v[84:87], v[40:43], v[196:199], v[84:87]
    ds_read_b64_tr_b16 v[38:39], v4 offset:58368
    v_mfma_f32_16x16x32_bf16 v[88:91], v[44:47], v[192:195], v[88:91]
    ds_read_b64_tr_b16 v[40:41], v5 offset:57344
    v_mfma_f32_16x16x32_bf16 v[92:95], v[44:47], v[196:199], v[92:95]
    ds_read_b64_tr_b16 v[42:43], v5 offset:58368
    s_waitcnt lgkmcnt(10)
    v_mfma_f32_16x16x32_bf16 v[96:99], v[192:195], v[48:51], v[96:99]
    ds_read_b64_tr_b16 v[44:45], v6 offset:57344
    s_add_u32 s42, s41, s90
    buffer_load_dwordx4 v[160:163], v2, s[4:7], s42 offen offset:0 sc1
    v_mfma_f32_16x16x32_bf16 v[100:103], v[196:199], v[48:51], v[100:103]
    ds_read_b64_tr_b16 v[46:47], v6 offset:58368
    v_mfma_f32_16x16x32_bf16 v[104:107], v[192:195], v[52:55], v[104:107]
    ds_read_b64_tr_b16 v[48:49], v3 offset:61440
    v_mfma_f32_16x16x32_bf16 v[108:111], v[196:199], v[52:55], v[108:111]
    ds_read_b64_tr_b16 v[50:51], v3 offset:62464
    s_waitcnt lgkmcnt(10)
    v_mfma_f32_16x16x32_bf16 v[112:115], v[192:195], v[56:59], v[112:115]
    ds_read_b64_tr_b16 v[52:53], v4 offset:61440
    v_mfma_f32_16x16x32_bf16 v[116:119], v[196:199], v[56:59], v[116:119]
    ds_read_b64_tr_b16 v[54:55], v4 offset:62464
    v_mfma_f32_16x16x32_bf16 v[120:123], v[192:195], v[60:63], v[120:123]
    ds_read_b64_tr_b16 v[56:57], v5 offset:61440
    v_mfma_f32_16x16x32_bf16 v[124:127], v[196:199], v[60:63], v[124:127]
    ds_read_b64_tr_b16 v[58:59], v5 offset:62464
    s_waitcnt lgkmcnt(10)
    v_mfma_f32_16x16x32_bf16 v[128:131], v[32:35], v[192:195], v[128:131]
    ds_read_b64_tr_b16 v[60:61], v6 offset:61440
    v_mfma_f32_16x16x32_bf16 v[132:135], v[32:35], v[196:199], v[132:135]
    ds_read_b64_tr_b16 v[62:63], v6 offset:62464
    s_barrier
    v_xor_b32 v3, 0x10000, v3
    v_xor_b32 v4, 0x10000, v4
    v_xor_b32 v5, 0x10000, v5
    v_xor_b32 v6, 0x10000, v6
    v_mfma_f32_16x16x32_bf16 v[136:139], v[36:39], v[192:195], v[136:139]
    ds_read_b64_tr_b16 v[32:33], v3 offset:0
    v_mfma_f32_16x16x32_bf16 v[140:143], v[36:39], v[196:199], v[140:143]
    ds_read_b64_tr_b16 v[34:35], v3 offset:1024
    s_waitcnt lgkmcnt(10)
    v_mfma_f32_16x16x32_bf16 v[144:147], v[40:43], v[192:195], v[144:147]
    ds_read_b64_tr_b16 v[36:37], v4 offset:0
    v_mfma_f32_16x16x32_bf16 v[148:151], v[40:43], v[196:199], v[148:151]
    ds_read_b64_tr_b16 v[38:39], v4 offset:1024
    v_mfma_f32_16x16x32_bf16 v[152:155], v[44:47], v[192:195], v[152:155]
    ds_read_b64_tr_b16 v[40:41], v5 offset:0
    v_mfma_f32_16x16x32_bf16 v[156:159], v[44:47], v[196:199], v[156:159]
    ds_read_b64_tr_b16 v[42:43], v5 offset:1024
    s_waitcnt vmcnt(13) lgkmcnt(10)
    v_mfma_f32_16x16x32_bf16 v[64:67], v[48:51], v[200:203], v[64:67]
    ds_read_b64_tr_b16 v[44:45], v6 offset:0
    v_mfma_f32_16x16x32_bf16 v[68:71], v[48:51], v[204:207], v[68:71]
    ds_read_b64_tr_b16 v[46:47], v6 offset:1024
    v_mfma_f32_16x16x32_bf16 v[72:75], v[52:55], v[200:203], v[72:75]
    ds_read_b64_tr_b16 v[48:49], v3 offset:4096
    v_mfma_f32_16x16x32_bf16 v[76:79], v[52:55], v[204:207], v[76:79]
    ds_read_b64_tr_b16 v[50:51], v3 offset:5120
    s_waitcnt lgkmcnt(10)
    v_mfma_f32_16x16x32_bf16 v[80:83], v[56:59], v[200:203], v[80:83]
    ds_read_b64_tr_b16 v[52:53], v4 offset:4096
    v_mfma_f32_16x16x32_bf16 v[84:87], v[56:59], v[204:207], v[84:87]
    ds_read_b64_tr_b16 v[54:55], v4 offset:5120
    v_mfma_f32_16x16x32_bf16 v[88:91], v[60:63], v[200:203], v[88:91]
    ds_read_b64_tr_b16 v[56:57], v5 offset:4096
    v_mfma_f32_16x16x32_bf16 v[92:95], v[60:63], v[204:207], v[92:95]
    ds_read_b64_tr_b16 v[58:59], v5 offset:5120
    s_waitcnt lgkmcnt(10)
    v_mfma_f32_16x16x32_bf16 v[96:99], v[200:203], v[32:35], v[96:99]
    ds_read_b64_tr_b16 v[60:61], v6 offset:4096
    v_mfma_f32_16x16x32_bf16 v[100:103], v[204:207], v[32:35], v[100:103]
    ds_read_b64_tr_b16 v[62:63], v6 offset:5120
    v_mfma_f32_16x16x32_bf16 v[104:107], v[200:203], v[36:39], v[104:107]
    ds_read_b64_tr_b16 v[32:33], v3 offset:8192
    v_mfma_f32_16x16x32_bf16 v[108:111], v[204:207], v[36:39], v[108:111]
    ds_read_b64_tr_b16 v[34:35], v3 offset:9216
    s_waitcnt lgkmcnt(10)
    v_mfma_f32_16x16x32_bf16 v[112:115], v[200:203], v[40:43], v[112:115]
    ds_read_b64_tr_b16 v[36:37], v4 offset:8192
    v_mfma_f32_16x16x32_bf16 v[116:119], v[204:207], v[40:43], v[116:119]
    ds_read_b64_tr_b16 v[38:39], v4 offset:9216
    v_mfma_f32_16x16x32_bf16 v[120:123], v[200:203], v[44:47], v[120:123]
    ds_read_b64_tr_b16 v[40:41], v5 offset:8192
    v_mfma_f32_16x16x32_bf16 v[124:127], v[204:207], v[44:47], v[124:127]
    ds_read_b64_tr_b16 v[42:43], v5 offset:9216
    s_waitcnt lgkmcnt(10)
    v_mfma_f32_16x16x32_bf16 v[128:131], v[48:51], v[200:203], v[128:131]
    ds_read_b64_tr_b16 v[44:45], v6 offset:8192
    v_mfma_f32_16x16x32_bf16 v[132:135], v[48:51], v[204:207], v[132:135]
    ds_read_b64_tr_b16 v[46:47], v6 offset:9216
    v_mfma_f32_16x16x32_bf16 v[136:139], v[52:55], v[200:203], v[136:139]
    ds_read_b64_tr_b16 v[48:49], v3 offset:12288
    v_mfma_f32_16x16x32_bf16 v[140:143], v[52:55], v[204:207], v[140:143]
    ds_read_b64_tr_b16 v[50:51], v3 offset:13312
    s_waitcnt lgkmcnt(10)
    v_mfma_f32_16x16x32_bf16 v[144:147], v[56:59], v[200:203], v[144:147]
    ds_read_b64_tr_b16 v[52:53], v4 offset:12288
    v_mfma_f32_16x16x32_bf16 v[148:151], v[56:59], v[204:207], v[148:151]
    ds_read_b64_tr_b16 v[54:55], v4 offset:13312
    v_mfma_f32_16x16x32_bf16 v[152:155], v[60:63], v[200:203], v[152:155]
    ds_read_b64_tr_b16 v[56:57], v5 offset:12288
    v_mfma_f32_16x16x32_bf16 v[156:159], v[60:63], v[204:207], v[156:159]
    ds_read_b64_tr_b16 v[58:59], v5 offset:13312
    s_waitcnt vmcnt(11) lgkmcnt(10)
    v_mfma_f32_16x16x32_bf16 v[64:67], v[32:35], v[208:211], v[64:67]
    ds_read_b64_tr_b16 v[60:61], v6 offset:12288
    v_mfma_f32_16x16x32_bf16 v[68:71], v[32:35], v[212:215], v[68:71]
    ds_read_b64_tr_b16 v[62:63], v6 offset:13312
    v_mfma_f32_16x16x32_bf16 v[72:75], v[36:39], v[208:211], v[72:75]
    ds_read_b64_tr_b16 v[32:33], v3 offset:16384
    v_mfma_f32_16x16x32_bf16 v[76:79], v[36:39], v[212:215], v[76:79]
    ds_read_b64_tr_b16 v[34:35], v3 offset:17408
    s_waitcnt lgkmcnt(10)
    v_mfma_f32_16x16x32_bf16 v[80:83], v[40:43], v[208:211], v[80:83]
    ds_read_b64_tr_b16 v[36:37], v4 offset:16384
    v_mfma_f32_16x16x32_bf16 v[84:87], v[40:43], v[212:215], v[84:87]
    ds_read_b64_tr_b16 v[38:39], v4 offset:17408
    v_mfma_f32_16x16x32_bf16 v[88:91], v[44:47], v[208:211], v[88:91]
    ds_read_b64_tr_b16 v[40:41], v5 offset:16384
    v_mfma_f32_16x16x32_bf16 v[92:95], v[44:47], v[212:215], v[92:95]
    ds_read_b64_tr_b16 v[42:43], v5 offset:17408
    s_waitcnt lgkmcnt(10)
    v_mfma_f32_16x16x32_bf16 v[96:99], v[208:211], v[48:51], v[96:99]
    ds_read_b64_tr_b16 v[44:45], v6 offset:16384
    buffer_load_dwordx4 v[164:167], v2, s[4:7], s42 offen offset:256 sc1
    v_mfma_f32_16x16x32_bf16 v[100:103], v[212:215], v[48:51], v[100:103]
    ds_read_b64_tr_b16 v[46:47], v6 offset:17408
    v_mfma_f32_16x16x32_bf16 v[104:107], v[208:211], v[52:55], v[104:107]
    ds_read_b64_tr_b16 v[48:49], v3 offset:20480
    buffer_load_dwordx4 v[168:171], v2, s[4:7], s42 offen offset:2048 sc1
    v_mfma_f32_16x16x32_bf16 v[108:111], v[212:215], v[52:55], v[108:111]
    ds_read_b64_tr_b16 v[50:51], v3 offset:21504
    s_waitcnt lgkmcnt(10)
    v_mfma_f32_16x16x32_bf16 v[112:115], v[208:211], v[56:59], v[112:115]
    ds_read_b64_tr_b16 v[52:53], v4 offset:20480
    buffer_load_dwordx4 v[172:175], v2, s[4:7], s42 offen offset:2304 sc1
    v_mfma_f32_16x16x32_bf16 v[116:119], v[212:215], v[56:59], v[116:119]
    ds_read_b64_tr_b16 v[54:55], v4 offset:21504
    v_mfma_f32_16x16x32_bf16 v[120:123], v[208:211], v[60:63], v[120:123]
    ds_read_b64_tr_b16 v[56:57], v5 offset:20480
    s_add_u32 s42, s41, s91
    buffer_load_dwordx4 v[176:179], v2, s[4:7], s42 offen offset:0 sc1
    v_mfma_f32_16x16x32_bf16 v[124:127], v[212:215], v[60:63], v[124:127]
    ds_read_b64_tr_b16 v[58:59], v5 offset:21504
    s_waitcnt lgkmcnt(10)
    v_mfma_f32_16x16x32_bf16 v[128:131], v[32:35], v[208:211], v[128:131]
    ds_read_b64_tr_b16 v[60:61], v6 offset:20480
    buffer_load_dwordx4 v[180:183], v2, s[4:7], s42 offen offset:256 sc1
    v_mfma_f32_16x16x32_bf16 v[132:135], v[32:35], v[212:215], v[132:135]
    ds_read_b64_tr_b16 v[62:63], v6 offset:21504
    v_mfma_f32_16x16x32_bf16 v[136:139], v[36:39], v[208:211], v[136:139]
    ds_read_b64_tr_b16 v[32:33], v3 offset:24576
    buffer_load_dwordx4 v[184:187], v2, s[4:7], s42 offen offset:2048 sc1
    v_mfma_f32_16x16x32_bf16 v[140:143], v[36:39], v[212:215], v[140:143]
    ds_read_b64_tr_b16 v[34:35], v3 offset:25600
    s_waitcnt lgkmcnt(10)
    v_mfma_f32_16x16x32_bf16 v[144:147], v[40:43], v[208:211], v[144:147]
    ds_read_b64_tr_b16 v[36:37], v4 offset:24576
    v_mfma_f32_16x16x32_bf16 v[148:151], v[40:43], v[212:215], v[148:151]
    ds_read_b64_tr_b16 v[38:39], v4 offset:25600
    v_mfma_f32_16x16x32_bf16 v[152:155], v[44:47], v[208:211], v[152:155]
    ds_read_b64_tr_b16 v[40:41], v5 offset:24576
    v_mfma_f32_16x16x32_bf16 v[156:159], v[44:47], v[212:215], v[156:159]
    ds_read_b64_tr_b16 v[42:43], v5 offset:25600
    s_waitcnt vmcnt(15) lgkmcnt(10)
    v_mfma_f32_16x16x32_bf16 v[64:67], v[48:51], v[216:219], v[64:67]
    ds_read_b64_tr_b16 v[44:45], v6 offset:24576
    v_mfma_f32_16x16x32_bf16 v[68:71], v[48:51], v[220:223], v[68:71]
    ds_read_b64_tr_b16 v[46:47], v6 offset:25600
    v_mfma_f32_16x16x32_bf16 v[72:75], v[52:55], v[216:219], v[72:75]
    ds_read_b64_tr_b16 v[48:49], v3 offset:28672
    v_mfma_f32_16x16x32_bf16 v[76:79], v[52:55], v[220:223], v[76:79]
    ds_read_b64_tr_b16 v[50:51], v3 offset:29696
    s_waitcnt lgkmcnt(10)
    v_mfma_f32_16x16x32_bf16 v[80:83], v[56:59], v[216:219], v[80:83]
    ds_read_b64_tr_b16 v[52:53], v4 offset:28672
    buffer_load_dwordx4 v[188:191], v2, s[4:7], s42 offen offset:2304 sc1
    v_mfma_f32_16x16x32_bf16 v[84:87], v[56:59], v[220:223], v[84:87]
    ds_read_b64_tr_b16 v[54:55], v4 offset:29696
    v_mfma_f32_16x16x32_bf16 v[88:91], v[60:63], v[216:219], v[88:91]
    ds_read_b64_tr_b16 v[56:57], v5 offset:28672
    v_mfma_f32_16x16x32_bf16 v[92:95], v[60:63], v[220:223], v[92:95]
    ds_read_b64_tr_b16 v[58:59], v5 offset:29696
    s_waitcnt lgkmcnt(10)
    v_mfma_f32_16x16x32_bf16 v[96:99], v[216:219], v[32:35], v[96:99]
    ds_read_b64_tr_b16 v[60:61], v6 offset:28672
    v_mfma_f32_16x16x32_bf16 v[100:103], v[220:223], v[32:35], v[100:103]
    ds_read_b64_tr_b16 v[62:63], v6 offset:29696
    s_barrier
    v_mfma_f32_16x16x32_bf16 v[104:107], v[216:219], v[36:39], v[104:107]
    ds_read_b64_tr_b16 v[32:33], v3 offset:32768
    v_mfma_f32_16x16x32_bf16 v[108:111], v[220:223], v[36:39], v[108:111]
    ds_read_b64_tr_b16 v[34:35], v3 offset:33792
    s_waitcnt lgkmcnt(10)
    v_mfma_f32_16x16x32_bf16 v[112:115], v[216:219], v[40:43], v[112:115]
    ds_read_b64_tr_b16 v[36:37], v4 offset:32768
    v_mfma_f32_16x16x32_bf16 v[116:119], v[220:223], v[40:43], v[116:119]
    ds_read_b64_tr_b16 v[38:39], v4 offset:33792
    v_mfma_f32_16x16x32_bf16 v[120:123], v[216:219], v[44:47], v[120:123]
    ds_read_b64_tr_b16 v[40:41], v5 offset:32768
    v_mfma_f32_16x16x32_bf16 v[124:127], v[220:223], v[44:47], v[124:127]
    ds_read_b64_tr_b16 v[42:43], v5 offset:33792
    s_waitcnt lgkmcnt(10)
    v_mfma_f32_16x16x32_bf16 v[128:131], v[48:51], v[216:219], v[128:131]
    ds_read_b64_tr_b16 v[44:45], v6 offset:32768
    v_mfma_f32_16x16x32_bf16 v[132:135], v[48:51], v[220:223], v[132:135]
    ds_read_b64_tr_b16 v[46:47], v6 offset:33792
    v_mfma_f32_16x16x32_bf16 v[136:139], v[52:55], v[216:219], v[136:139]
    ds_read_b64_tr_b16 v[48:49], v3 offset:36864
    v_mfma_f32_16x16x32_bf16 v[140:143], v[52:55], v[220:223], v[140:143]
    ds_read_b64_tr_b16 v[50:51], v3 offset:37888
    s_waitcnt lgkmcnt(10)
    v_mfma_f32_16x16x32_bf16 v[144:147], v[56:59], v[216:219], v[144:147]
    ds_read_b64_tr_b16 v[52:53], v4 offset:36864
    v_mfma_f32_16x16x32_bf16 v[148:151], v[56:59], v[220:223], v[148:151]
    ds_read_b64_tr_b16 v[54:55], v4 offset:37888
    v_mfma_f32_16x16x32_bf16 v[152:155], v[60:63], v[216:219], v[152:155]
    ds_read_b64_tr_b16 v[56:57], v5 offset:36864
    v_mfma_f32_16x16x32_bf16 v[156:159], v[60:63], v[220:223], v[156:159]
    ds_read_b64_tr_b16 v[58:59], v5 offset:37888
    s_waitcnt vmcnt(14) lgkmcnt(10)
    v_mfma_f32_16x16x32_bf16 v[64:67], v[32:35], v[224:227], v[64:67]
    ds_read_b64_tr_b16 v[60:61], v6 offset:36864
    v_mfma_f32_16x16x32_bf16 v[68:71], v[32:35], v[228:231], v[68:71]
    ds_read_b64_tr_b16 v[62:63], v6 offset:37888
    v_mfma_f32_16x16x32_bf16 v[72:75], v[36:39], v[224:227], v[72:75]
    ds_read_b64_tr_b16 v[32:33], v3 offset:40960
    v_mfma_f32_16x16x32_bf16 v[76:79], v[36:39], v[228:231], v[76:79]
    ds_read_b64_tr_b16 v[34:35], v3 offset:41984
    s_waitcnt lgkmcnt(10)
    v_mfma_f32_16x16x32_bf16 v[80:83], v[40:43], v[224:227], v[80:83]
    ds_read_b64_tr_b16 v[36:37], v4 offset:40960
    v_mfma_f32_16x16x32_bf16 v[84:87], v[40:43], v[228:231], v[84:87]
    ds_read_b64_tr_b16 v[38:39], v4 offset:41984
    v_mfma_f32_16x16x32_bf16 v[88:91], v[44:47], v[224:227], v[88:91]
    ds_read_b64_tr_b16 v[40:41], v5 offset:40960
    v_mfma_f32_16x16x32_bf16 v[92:95], v[44:47], v[228:231], v[92:95]
    ds_read_b64_tr_b16 v[42:43], v5 offset:41984
    s_waitcnt lgkmcnt(10)
    v_mfma_f32_16x16x32_bf16 v[96:99], v[224:227], v[48:51], v[96:99]
    ds_read_b64_tr_b16 v[44:45], v6 offset:40960
    v_mfma_f32_16x16x32_bf16 v[100:103], v[228:231], v[48:51], v[100:103]
    ds_read_b64_tr_b16 v[46:47], v6 offset:41984
    v_mfma_f32_16x16x32_bf16 v[104:107], v[224:227], v[52:55], v[104:107]
    ds_read_b64_tr_b16 v[48:49], v3 offset:45056
    v_mfma_f32_16x16x32_bf16 v[108:111], v[228:231], v[52:55], v[108:111]
    ds_read_b64_tr_b16 v[50:51], v3 offset:46080
    s_waitcnt lgkmcnt(10)
    v_mfma_f32_16x16x32_bf16 v[112:115], v[224:227], v[56:59], v[112:115]
    ds_read_b64_tr_b16 v[52:53], v4 offset:45056
    v_mfma_f32_16x16x32_bf16 v[116:119], v[228:231], v[56:59], v[116:119]
    ds_read_b64_tr_b16 v[54:55], v4 offset:46080
    v_mfma_f32_16x16x32_bf16 v[120:123], v[224:227], v[60:63], v[120:123]
    ds_read_b64_tr_b16 v[56:57], v5 offset:45056
    v_mfma_f32_16x16x32_bf16 v[124:127], v[228:231], v[60:63], v[124:127]
    ds_read_b64_tr_b16 v[58:59], v5 offset:46080
    s_waitcnt lgkmcnt(10)
    v_mfma_f32_16x16x32_bf16 v[128:131], v[32:35], v[224:227], v[128:131]
    ds_read_b64_tr_b16 v[60:61], v6 offset:45056
    v_mfma_f32_16x16x32_bf16 v[132:135], v[32:35], v[228:231], v[132:135]
    ds_read_b64_tr_b16 v[62:63], v6 offset:46080
    v_mfma_f32_16x16x32_bf16 v[136:139], v[36:39], v[224:227], v[136:139]
    ds_read_b64_tr_b16 v[32:33], v3 offset:49152
    v_mfma_f32_16x16x32_bf16 v[140:143], v[36:39], v[228:231], v[140:143]
    ds_read_b64_tr_b16 v[34:35], v3 offset:50176
    s_waitcnt lgkmcnt(10)
    v_mfma_f32_16x16x32_bf16 v[144:147], v[40:43], v[224:227], v[144:147]
    ds_read_b64_tr_b16 v[36:37], v4 offset:49152
    v_mfma_f32_16x16x32_bf16 v[148:151], v[40:43], v[228:231], v[148:151]
    ds_read_b64_tr_b16 v[38:39], v4 offset:50176
    v_mfma_f32_16x16x32_bf16 v[152:155], v[44:47], v[224:227], v[152:155]
    ds_read_b64_tr_b16 v[40:41], v5 offset:49152
    v_mfma_f32_16x16x32_bf16 v[156:159], v[44:47], v[228:231], v[156:159]
    ds_read_b64_tr_b16 v[42:43], v5 offset:50176
    s_waitcnt vmcnt(12) lgkmcnt(10)
    v_mfma_f32_16x16x32_bf16 v[64:67], v[48:51], v[232:235], v[64:67]
    ds_read_b64_tr_b16 v[44:45], v6 offset:49152
    s_add_u32 s42, s41, s92
    buffer_load_dwordx4 v[192:195], v2, s[4:7], s42 offen offset:0 sc1
    v_mfma_f32_16x16x32_bf16 v[68:71], v[48:51], v[236:239], v[68:71]
    ds_read_b64_tr_b16 v[46:47], v6 offset:50176
    v_mfma_f32_16x16x32_bf16 v[72:75], v[52:55], v[232:235], v[72:75]
    ds_read_b64_tr_b16 v[48:49], v3 offset:53248
    buffer_load_dwordx4 v[196:199], v2, s[4:7], s42 offen offset:256 sc1
    v_mfma_f32_16x16x32_bf16 v[76:79], v[52:55], v[236:239], v[76:79]
    ds_read_b64_tr_b16 v[50:51], v3 offset:54272
    s_waitcnt lgkmcnt(10)
    v_mfma_f32_16x16x32_bf16 v[80:83], v[56:59], v[232:235], v[80:83]
    ds_read_b64_tr_b16 v[52:53], v4 offset:53248
    buffer_load_dwordx4 v[200:203], v2, s[4:7], s42 offen offset:2048 sc1
    v_mfma_f32_16x16x32_bf16 v[84:87], v[56:59], v[236:239], v[84:87]
    ds_read_b64_tr_b16 v[54:55], v4 offset:54272
    v_mfma_f32_16x16x32_bf16 v[88:91], v[60:63], v[232:235], v[88:91]
    ds_read_b64_tr_b16 v[56:57], v5 offset:53248
    buffer_load_dwordx4 v[204:207], v2, s[4:7], s42 offen offset:2304 sc1
    v_mfma_f32_16x16x32_bf16 v[92:95], v[60:63], v[236:239], v[92:95]
    ds_read_b64_tr_b16 v[58:59], v5 offset:54272
    s_waitcnt lgkmcnt(10)
    v_mfma_f32_16x16x32_bf16 v[96:99], v[232:235], v[32:35], v[96:99]
    ds_read_b64_tr_b16 v[60:61], v6 offset:53248
    s_add_u32 s42, s41, s93
    buffer_load_dwordx4 v[208:211], v2, s[4:7], s42 offen offset:0 sc1
    v_mfma_f32_16x16x32_bf16 v[100:103], v[236:239], v[32:35], v[100:103]
    ds_read_b64_tr_b16 v[62:63], v6 offset:54272
    v_mfma_f32_16x16x32_bf16 v[104:107], v[232:235], v[36:39], v[104:107]
    ds_read_b64_tr_b16 v[32:33], v3 offset:57344
    v_mfma_f32_16x16x32_bf16 v[108:111], v[236:239], v[36:39], v[108:111]
    ds_read_b64_tr_b16 v[34:35], v3 offset:58368
    s_waitcnt lgkmcnt(10)
    v_mfma_f32_16x16x32_bf16 v[112:115], v[232:235], v[40:43], v[112:115]
    ds_read_b64_tr_b16 v[36:37], v4 offset:57344
    v_mfma_f32_16x16x32_bf16 v[116:119], v[236:239], v[40:43], v[116:119]
    ds_read_b64_tr_b16 v[38:39], v4 offset:58368
    v_mfma_f32_16x16x32_bf16 v[120:123], v[232:235], v[44:47], v[120:123]
    ds_read_b64_tr_b16 v[40:41], v5 offset:57344
    buffer_load_dwordx4 v[212:215], v2, s[4:7], s42 offen offset:256 sc1
    v_mfma_f32_16x16x32_bf16 v[124:127], v[236:239], v[44:47], v[124:127]
    ds_read_b64_tr_b16 v[42:43], v5 offset:58368
    s_waitcnt lgkmcnt(10)
    v_mfma_f32_16x16x32_bf16 v[128:131], v[48:51], v[232:235], v[128:131]
    ds_read_b64_tr_b16 v[44:45], v6 offset:57344
    v_mfma_f32_16x16x32_bf16 v[132:135], v[48:51], v[236:239], v[132:135]
    ds_read_b64_tr_b16 v[46:47], v6 offset:58368
    v_mfma_f32_16x16x32_bf16 v[136:139], v[52:55], v[232:235], v[136:139]
    ds_read_b64_tr_b16 v[48:49], v3 offset:61440
    v_mfma_f32_16x16x32_bf16 v[140:143], v[52:55], v[236:239], v[140:143]
    ds_read_b64_tr_b16 v[50:51], v3 offset:62464
    s_waitcnt lgkmcnt(10)
    v_mfma_f32_16x16x32_bf16 v[144:147], v[56:59], v[232:235], v[144:147]
    ds_read_b64_tr_b16 v[52:53], v4 offset:61440
    v_mfma_f32_16x16x32_bf16 v[148:151], v[56:59], v[236:239], v[148:151]
    ds_read_b64_tr_b16 v[54:55], v4 offset:62464
    v_mfma_f32_16x16x32_bf16 v[152:155], v[60:63], v[232:235], v[152:155]
    ds_read_b64_tr_b16 v[56:57], v5 offset:61440
    v_mfma_f32_16x16x32_bf16 v[156:159], v[60:63], v[236:239], v[156:159]
    ds_read_b64_tr_b16 v[58:59], v5 offset:62464
    s_waitcnt vmcnt(16) lgkmcnt(10)
    v_mfma_f32_16x16x32_bf16 v[64:67], v[32:35], v[240:243], v[64:67]
    ds_read_b64_tr_b16 v[60:61], v6 offset:61440
    v_mfma_f32_16x16x32_bf16 v[68:71], v[32:35], v[244:247], v[68:71]
    ds_read_b64_tr_b16 v[62:63], v6 offset:62464
    s_barrier
    v_xor_b32 v3, 0x10000, v3
    v_xor_b32 v4, 0x10000, v4
    v_xor_b32 v5, 0x10000, v5
    v_xor_b32 v6, 0x10000, v6
    v_mfma_f32_16x16x32_bf16 v[72:75], v[36:39], v[240:243], v[72:75]
    ds_read_b64_tr_b16 v[32:33], v3 offset:0
    v_mfma_f32_16x16x32_bf16 v[76:79], v[36:39], v[244:247], v[76:79]
    ds_read_b64_tr_b16 v[34:35], v3 offset:1024
    s_waitcnt lgkmcnt(10)
    v_mfma_f32_16x16x32_bf16 v[80:83], v[40:43], v[240:243], v[80:83]
    ds_read_b64_tr_b16 v[36:37], v4 offset:0
    v_mfma_f32_16x16x32_bf16 v[84:87], v[40:43], v[244:247], v[84:87]
    ds_read_b64_tr_b16 v[38:39], v4 offset:1024
    v_mfma_f32_16x16x32_bf16 v[88:91], v[44:47], v[240:243], v[88:91]
    ds_read_b64_tr_b16 v[40:41], v5 offset:0
    v_mfma_f32_16x16x32_bf16 v[92:95], v[44:47], v[244:247], v[92:95]
    ds_read_b64_tr_b16 v[42:43], v5 offset:1024
    s_waitcnt lgkmcnt(10)
    v_mfma_f32_16x16x32_bf16 v[96:99], v[240:243], v[48:51], v[96:99]
    ds_read_b64_tr_b16 v[44:45], v6 offset:0
    v_mfma_f32_16x16x32_bf16 v[100:103], v[244:247], v[48:51], v[100:103]
    ds_read_b64_tr_b16 v[46:47], v6 offset:1024
    v_mfma_f32_16x16x32_bf16 v[104:107], v[240:243], v[52:55], v[104:107]
    ds_read_b64_tr_b16 v[48:49], v3 offset:4096
    v_mfma_f32_16x16x32_bf16 v[108:111], v[244:247], v[52:55], v[108:111]
    ds_read_b64_tr_b16 v[50:51], v3 offset:5120
    s_waitcnt lgkmcnt(10)
    v_mfma_f32_16x16x32_bf16 v[112:115], v[240:243], v[56:59], v[112:115]
    ds_read_b64_tr_b16 v[52:53], v4 offset:4096
    v_mfma_f32_16x16x32_bf16 v[116:119], v[244:247], v[56:59], v[116:119]
    ds_read_b64_tr_b16 v[54:55], v4 offset:5120
    v_mfma_f32_16x16x32_bf16 v[120:123], v[240:243], v[60:63], v[120:123]
    ds_read_b64_tr_b16 v[56:57], v5 offset:4096
    v_mfma_f32_16x16x32_bf16 v[124:127], v[244:247], v[60:63], v[124:127]
    ds_read_b64_tr_b16 v[58:59], v5 offset:5120
    s_waitcnt lgkmcnt(10)
    v_mfma_f32_16x16x32_bf16 v[128:131], v[32:35], v[240:243], v[128:131]
    ds_read_b64_tr_b16 v[60:61], v6 offset:4096
    v_mfma_f32_16x16x32_bf16 v[132:135], v[32:35], v[244:247], v[132:135]
    ds_read_b64_tr_b16 v[62:63], v6 offset:5120
    v_mfma_f32_16x16x32_bf16 v[136:139], v[36:39], v[240:243], v[136:139]
    ds_read_b64_tr_b16 v[32:33], v3 offset:8192
    v_mfma_f32_16x16x32_bf16 v[140:143], v[36:39], v[244:247], v[140:143]
    ds_read_b64_tr_b16 v[34:35], v3 offset:9216
    s_waitcnt lgkmcnt(10)
    v_mfma_f32_16x16x32_bf16 v[144:147], v[40:43], v[240:243], v[144:147]
    ds_read_b64_tr_b16 v[36:37], v4 offset:8192
    v_mfma_f32_16x16x32_bf16 v[148:151], v[40:43], v[244:247], v[148:151]
    ds_read_b64_tr_b16 v[38:39], v4 offset:9216
    v_mfma_f32_16x16x32_bf16 v[152:155], v[44:47], v[240:243], v[152:155]
    ds_read_b64_tr_b16 v[40:41], v5 offset:8192
    v_mfma_f32_16x16x32_bf16 v[156:159], v[44:47], v[244:247], v[156:159]
    ds_read_b64_tr_b16 v[42:43], v5 offset:9216
    s_waitcnt vmcnt(14) lgkmcnt(10)
    v_mfma_f32_16x16x32_bf16 v[64:67], v[48:51], v[248:251], v[64:67]
    ds_read_b64_tr_b16 v[44:45], v6 offset:8192
    v_mfma_f32_16x16x32_bf16 v[68:71], v[48:51], v[252:255], v[68:71]
    ds_read_b64_tr_b16 v[46:47], v6 offset:9216
    v_mfma_f32_16x16x32_bf16 v[72:75], v[52:55], v[248:251], v[72:75]
    ds_read_b64_tr_b16 v[48:49], v3 offset:12288
    v_mfma_f32_16x16x32_bf16 v[76:79], v[52:55], v[252:255], v[76:79]
    ds_read_b64_tr_b16 v[50:51], v3 offset:13312
    s_waitcnt lgkmcnt(10)
    v_mfma_f32_16x16x32_bf16 v[80:83], v[56:59], v[248:251], v[80:83]
    ds_read_b64_tr_b16 v[52:53], v4 offset:12288
    v_mfma_f32_16x16x32_bf16 v[84:87], v[56:59], v[252:255], v[84:87]
    ds_read_b64_tr_b16 v[54:55], v4 offset:13312
    v_mfma_f32_16x16x32_bf16 v[88:91], v[60:63], v[248:251], v[88:91]
    ds_read_b64_tr_b16 v[56:57], v5 offset:12288
    v_mfma_f32_16x16x32_bf16 v[92:95], v[60:63], v[252:255], v[92:95]
    ds_read_b64_tr_b16 v[58:59], v5 offset:13312
    s_waitcnt lgkmcnt(10)
    v_mfma_f32_16x16x32_bf16 v[96:99], v[248:251], v[32:35], v[96:99]
    ds_read_b64_tr_b16 v[60:61], v6 offset:12288
    v_mfma_f32_16x16x32_bf16 v[100:103], v[252:255], v[32:35], v[100:103]
    ds_read_b64_tr_b16 v[62:63], v6 offset:13312
    v_mfma_f32_16x16x32_bf16 v[104:107], v[248:251], v[36:39], v[104:107]
    ds_read_b64_tr_b16 v[32:33], v3 offset:16384
    v_mfma_f32_16x16x32_bf16 v[108:111], v[252:255], v[36:39], v[108:111]
    ds_read_b64_tr_b16 v[34:35], v3 offset:17408
    s_waitcnt lgkmcnt(10)
    v_mfma_f32_16x16x32_bf16 v[112:115], v[248:251], v[40:43], v[112:115]
    ds_read_b64_tr_b16 v[36:37], v4 offset:16384
    v_mfma_f32_16x16x32_bf16 v[116:119], v[252:255], v[40:43], v[116:119]
    ds_read_b64_tr_b16 v[38:39], v4 offset:17408
    v_mfma_f32_16x16x32_bf16 v[120:123], v[248:251], v[44:47], v[120:123]
    ds_read_b64_tr_b16 v[40:41], v5 offset:16384
    v_mfma_f32_16x16x32_bf16 v[124:127], v[252:255], v[44:47], v[124:127]
    ds_read_b64_tr_b16 v[42:43], v5 offset:17408
    s_waitcnt lgkmcnt(10)
    v_mfma_f32_16x16x32_bf16 v[128:131], v[48:51], v[248:251], v[128:131]
    ds_read_b64_tr_b16 v[44:45], v6 offset:16384
    buffer_load_dwordx4 v[216:219], v2, s[4:7], s42 offen offset:2048 sc1
    v_mfma_f32_16x16x32_bf16 v[132:135], v[48:51], v[252:255], v[132:135]
    ds_read_b64_tr_b16 v[46:47], v6 offset:17408
    v_mfma_f32_16x16x32_bf16 v[136:139], v[52:55], v[248:251], v[136:139]
    ds_read_b64_tr_b16 v[48:49], v3 offset:20480
    buffer_load_dwordx4 v[220:223], v2, s[4:7], s42 offen offset:2304 sc1
    v_mfma_f32_16x16x32_bf16 v[140:143], v[52:55], v[252:255], v[140:143]
    ds_read_b64_tr_b16 v[50:51], v3 offset:21504
    s_waitcnt lgkmcnt(10)
    v_mfma_f32_16x16x32_bf16 v[144:147], v[56:59], v[248:251], v[144:147]
    ds_read_b64_tr_b16 v[52:53], v4 offset:20480
    s_add_u32 s42, s41, s94
    buffer_load_dwordx4 v[224:227], v2, s[4:7], s42 offen offset:0 sc1
    v_mfma_f32_16x16x32_bf16 v[148:151], v[56:59], v[252:255], v[148:151]
    ds_read_b64_tr_b16 v[54:55], v4 offset:21504
    v_mfma_f32_16x16x32_bf16 v[152:155], v[60:63], v[248:251], v[152:155]
    ds_read_b64_tr_b16 v[56:57], v5 offset:20480
    buffer_load_dwordx4 v[228:231], v2, s[4:7], s42 offen offset:256 sc1
    v_mfma_f32_16x16x32_bf16 v[156:159], v[60:63], v[252:255], v[156:159]
    ds_read_b64_tr_b16 v[58:59], v5 offset:21504
    s_waitcnt vmcnt(16) lgkmcnt(10)
    v_mfma_f32_16x16x32_bf16 v[64:67], v[32:35], v[160:163], v[64:67]
    ds_read_b64_tr_b16 v[60:61], v6 offset:20480
    buffer_load_dwordx4 v[232:235], v2, s[4:7], s42 offen offset:2048 sc1
    v_mfma_f32_16x16x32_bf16 v[68:71], v[32:35], v[164:167], v[68:71]
    ds_read_b64_tr_b16 v[62:63], v6 offset:21504
    v_mfma_f32_16x16x32_bf16 v[72:75], v[36:39], v[160:163], v[72:75]
    ds_read_b64_tr_b16 v[32:33], v3 offset:24576
    buffer_load_dwordx4 v[236:239], v2, s[4:7], s42 offen offset:2304 sc1
    v_mfma_f32_16x16x32_bf16 v[76:79], v[36:39], v[164:167], v[76:79]
    ds_read_b64_tr_b16 v[34:35], v3 offset:25600
    s_waitcnt lgkmcnt(10)
    v_mfma_f32_16x16x32_bf16 v[80:83], v[40:43], v[160:163], v[80:83]
    ds_read_b64_tr_b16 v[36:37], v4 offset:24576
    v_mfma_f32_16x16x32_bf16 v[84:87], v[40:43], v[164:167], v[84:87]
    ds_read_b64_tr_b16 v[38:39], v4 offset:25600
    v_mfma_f32_16x16x32_bf16 v[88:91], v[44:47], v[160:163], v[88:91]
    ds_read_b64_tr_b16 v[40:41], v5 offset:24576
    v_mfma_f32_16x16x32_bf16 v[92:95], v[44:47], v[164:167], v[92:95]
    ds_read_b64_tr_b16 v[42:43], v5 offset:25600
    s_waitcnt lgkmcnt(10)
    v_mfma_f32_16x16x32_bf16 v[96:99], v[160:163], v[48:51], v[96:99]
    ds_read_b64_tr_b16 v[44:45], v6 offset:24576
    s_add_u32 s42, s41, s95
    buffer_load_dwordx4 v[240:243], v2, s[4:7], s42 offen offset:0 sc1
    v_mfma_f32_16x16x32_bf16 v[100:103], v[164:167], v[48:51], v[100:103]
    ds_read_b64_tr_b16 v[46:47], v6 offset:25600
    v_mfma_f32_16x16x32_bf16 v[104:107], v[160:163], v[52:55], v[104:107]
    ds_read_b64_tr_b16 v[48:49], v3 offset:28672
    v_mfma_f32_16x16x32_bf16 v[108:111], v[164:167], v[52:55], v[108:111]
    ds_read_b64_tr_b16 v[50:51], v3 offset:29696
    s_waitcnt lgkmcnt(10)
    v_mfma_f32_16x16x32_bf16 v[112:115], v[160:163], v[56:59], v[112:115]
    ds_read_b64_tr_b16 v[52:53], v4 offset:28672
    v_mfma_f32_16x16x32_bf16 v[116:119], v[164:167], v[56:59], v[116:119]
    ds_read_b64_tr_b16 v[54:55], v4 offset:29696
    v_mfma_f32_16x16x32_bf16 v[120:123], v[160:163], v[60:63], v[120:123]
    ds_read_b64_tr_b16 v[56:57], v5 offset:28672
    v_mfma_f32_16x16x32_bf16 v[124:127], v[164:167], v[60:63], v[124:127]
    ds_read_b64_tr_b16 v[58:59], v5 offset:29696
    s_waitcnt lgkmcnt(10)
    v_mfma_f32_16x16x32_bf16 v[128:131], v[32:35], v[160:163], v[128:131]
    ds_read_b64_tr_b16 v[60:61], v6 offset:28672
    v_mfma_f32_16x16x32_bf16 v[132:135], v[32:35], v[164:167], v[132:135]
    ds_read_b64_tr_b16 v[62:63], v6 offset:29696
    s_barrier
    v_mfma_f32_16x16x32_bf16 v[136:139], v[36:39], v[160:163], v[136:139]
    ds_read_b64_tr_b16 v[32:33], v3 offset:32768
    v_mfma_f32_16x16x32_bf16 v[140:143], v[36:39], v[164:167], v[140:143]
    ds_read_b64_tr_b16 v[34:35], v3 offset:33792
    s_waitcnt lgkmcnt(10)
    v_mfma_f32_16x16x32_bf16 v[144:147], v[40:43], v[160:163], v[144:147]
    ds_read_b64_tr_b16 v[36:37], v4 offset:32768
    v_mfma_f32_16x16x32_bf16 v[148:151], v[40:43], v[164:167], v[148:151]
    ds_read_b64_tr_b16 v[38:39], v4 offset:33792
    v_mfma_f32_16x16x32_bf16 v[152:155], v[44:47], v[160:163], v[152:155]
    ds_read_b64_tr_b16 v[40:41], v5 offset:32768
    v_mfma_f32_16x16x32_bf16 v[156:159], v[44:47], v[164:167], v[156:159]
    ds_read_b64_tr_b16 v[42:43], v5 offset:33792
    s_waitcnt vmcnt(17) lgkmcnt(10)
    v_mfma_f32_16x16x32_bf16 v[64:67], v[48:51], v[168:171], v[64:67]
    ds_read_b64_tr_b16 v[44:45], v6 offset:32768
    v_mfma_f32_16x16x32_bf16 v[68:71], v[48:51], v[172:175], v[68:71]
    ds_read_b64_tr_b16 v[46:47], v6 offset:33792
    v_mfma_f32_16x16x32_bf16 v[72:75], v[52:55], v[168:171], v[72:75]
    ds_read_b64_tr_b16 v[48:49], v3 offset:36864
    v_mfma_f32_16x16x32_bf16 v[76:79], v[52:55], v[172:175], v[76:79]
    ds_read_b64_tr_b16 v[50:51], v3 offset:37888
    s_waitcnt lgkmcnt(10)
    v_mfma_f32_16x16x32_bf16 v[80:83], v[56:59], v[168:171], v[80:83]
    ds_read_b64_tr_b16 v[52:53], v4 offset:36864
    v_mfma_f32_16x16x32_bf16 v[84:87], v[56:59], v[172:175], v[84:87]
    ds_read_b64_tr_b16 v[54:55], v4 offset:37888
    v_mfma_f32_16x16x32_bf16 v[88:91], v[60:63], v[168:171], v[88:91]
    ds_read_b64_tr_b16 v[56:57], v5 offset:36864
    v_mfma_f32_16x16x32_bf16 v[92:95], v[60:63], v[172:175], v[92:95]
    ds_read_b64_tr_b16 v[58:59], v5 offset:37888
    s_waitcnt lgkmcnt(10)
    v_mfma_f32_16x16x32_bf16 v[96:99], v[168:171], v[32:35], v[96:99]
    ds_read_b64_tr_b16 v[60:61], v6 offset:36864
    v_mfma_f32_16x16x32_bf16 v[100:103], v[172:175], v[32:35], v[100:103]
    ds_read_b64_tr_b16 v[62:63], v6 offset:37888
    v_mfma_f32_16x16x32_bf16 v[104:107], v[168:171], v[36:39], v[104:107]
    ds_read_b64_tr_b16 v[32:33], v3 offset:40960
    v_mfma_f32_16x16x32_bf16 v[108:111], v[172:175], v[36:39], v[108:111]
    ds_read_b64_tr_b16 v[34:35], v3 offset:41984
    s_waitcnt lgkmcnt(10)
    v_mfma_f32_16x16x32_bf16 v[112:115], v[168:171], v[40:43], v[112:115]
    ds_read_b64_tr_b16 v[36:37], v4 offset:40960
    v_mfma_f32_16x16x32_bf16 v[116:119], v[172:175], v[40:43], v[116:119]
    ds_read_b64_tr_b16 v[38:39], v4 offset:41984
    v_mfma_f32_16x16x32_bf16 v[120:123], v[168:171], v[44:47], v[120:123]
    ds_read_b64_tr_b16 v[40:41], v5 offset:40960
    v_mfma_f32_16x16x32_bf16 v[124:127], v[172:175], v[44:47], v[124:127]
    ds_read_b64_tr_b16 v[42:43], v5 offset:41984
    s_waitcnt lgkmcnt(10)
    v_mfma_f32_16x16x32_bf16 v[128:131], v[48:51], v[168:171], v[128:131]
    ds_read_b64_tr_b16 v[44:45], v6 offset:40960
    v_mfma_f32_16x16x32_bf16 v[132:135], v[48:51], v[172:175], v[132:135]
    ds_read_b64_tr_b16 v[46:47], v6 offset:41984
    v_mfma_f32_16x16x32_bf16 v[136:139], v[52:55], v[168:171], v[136:139]
    ds_read_b64_tr_b16 v[48:49], v3 offset:45056
    v_mfma_f32_16x16x32_bf16 v[140:143], v[52:55], v[172:175], v[140:143]
    ds_read_b64_tr_b16 v[50:51], v3 offset:46080
    s_waitcnt lgkmcnt(10)
    v_mfma_f32_16x16x32_bf16 v[144:147], v[56:59], v[168:171], v[144:147]
    ds_read_b64_tr_b16 v[52:53], v4 offset:45056
    v_mfma_f32_16x16x32_bf16 v[148:151], v[56:59], v[172:175], v[148:151]
    ds_read_b64_tr_b16 v[54:55], v4 offset:46080
    v_mfma_f32_16x16x32_bf16 v[152:155], v[60:63], v[168:171], v[152:155]
    ds_read_b64_tr_b16 v[56:57], v5 offset:45056
    v_mfma_f32_16x16x32_bf16 v[156:159], v[60:63], v[172:175], v[156:159]
    ds_read_b64_tr_b16 v[58:59], v5 offset:46080
    s_waitcnt vmcnt(15) lgkmcnt(10)
    v_mfma_f32_16x16x32_bf16 v[64:67], v[32:35], v[176:179], v[64:67]
    ds_read_b64_tr_b16 v[60:61], v6 offset:45056
    v_mfma_f32_16x16x32_bf16 v[68:71], v[32:35], v[180:183], v[68:71]
    ds_read_b64_tr_b16 v[62:63], v6 offset:46080
    v_mfma_f32_16x16x32_bf16 v[72:75], v[36:39], v[176:179], v[72:75]
    ds_read_b64_tr_b16 v[32:33], v3 offset:49152
    v_mfma_f32_16x16x32_bf16 v[76:79], v[36:39], v[180:183], v[76:79]
    ds_read_b64_tr_b16 v[34:35], v3 offset:50176
    s_waitcnt lgkmcnt(10)
    v_mfma_f32_16x16x32_bf16 v[80:83], v[40:43], v[176:179], v[80:83]
    ds_read_b64_tr_b16 v[36:37], v4 offset:49152
    v_mfma_f32_16x16x32_bf16 v[84:87], v[40:43], v[180:183], v[84:87]
    ds_read_b64_tr_b16 v[38:39], v4 offset:50176
    v_mfma_f32_16x16x32_bf16 v[88:91], v[44:47], v[176:179], v[88:91]
    ds_read_b64_tr_b16 v[40:41], v5 offset:49152
    v_mfma_f32_16x16x32_bf16 v[92:95], v[44:47], v[180:183], v[92:95]
    ds_read_b64_tr_b16 v[42:43], v5 offset:50176
    s_waitcnt lgkmcnt(10)
    v_mfma_f32_16x16x32_bf16 v[96:99], v[176:179], v[48:51], v[96:99]
    ds_read_b64_tr_b16 v[44:45], v6 offset:49152
    buffer_load_dwordx4 v[244:247], v2, s[4:7], s42 offen offset:256 sc1
    v_mfma_f32_16x16x32_bf16 v[100:103], v[180:183], v[48:51], v[100:103]
    ds_read_b64_tr_b16 v[46:47], v6 offset:50176
    v_mfma_f32_16x16x32_bf16 v[104:107], v[176:179], v[52:55], v[104:107]
    ds_read_b64_tr_b16 v[48:49], v3 offset:53248
    buffer_load_dwordx4 v[248:251], v2, s[4:7], s42 offen offset:2048 sc1
    v_mfma_f32_16x16x32_bf16 v[108:111], v[180:183], v[52:55], v[108:111]
    ds_read_b64_tr_b16 v[50:51], v3 offset:54272
    s_waitcnt lgkmcnt(10)
    v_mfma_f32_16x16x32_bf16 v[112:115], v[176:179], v[56:59], v[112:115]
    ds_read_b64_tr_b16 v[52:53], v4 offset:53248
    buffer_load_dwordx4 v[252:255], v2, s[4:7], s42 offen offset:2304 sc1
    v_mfma_f32_16x16x32_bf16 v[116:119], v[180:183], v[56:59], v[116:119]
    ds_read_b64_tr_b16 v[54:55], v4 offset:54272
    v_mfma_f32_16x16x32_bf16 v[120:123], v[176:179], v[60:63], v[120:123]
    ds_read_b64_tr_b16 v[56:57], v5 offset:53248
    s_add_u32 s42, s41, s96
    buffer_load_dwordx4 v[160:163], v2, s[4:7], s42 offen offset:0 sc1
    v_mfma_f32_16x16x32_bf16 v[124:127], v[180:183], v[60:63], v[124:127]
    ds_read_b64_tr_b16 v[58:59], v5 offset:54272
    s_waitcnt lgkmcnt(10)
    v_mfma_f32_16x16x32_bf16 v[128:131], v[32:35], v[176:179], v[128:131]
    ds_read_b64_tr_b16 v[60:61], v6 offset:53248
    buffer_load_dwordx4 v[164:167], v2, s[4:7], s42 offen offset:256 sc1
    v_mfma_f32_16x16x32_bf16 v[132:135], v[32:35], v[180:183], v[132:135]
    ds_read_b64_tr_b16 v[62:63], v6 offset:54272
    v_mfma_f32_16x16x32_bf16 v[136:139], v[36:39], v[176:179], v[136:139]
    ds_read_b64_tr_b16 v[32:33], v3 offset:57344
    buffer_load_dwordx4 v[168:171], v2, s[4:7], s42 offen offset:2048 sc1
    v_mfma_f32_16x16x32_bf16 v[140:143], v[36:39], v[180:183], v[140:143]
    ds_read_b64_tr_b16 v[34:35], v3 offset:58368
    s_waitcnt lgkmcnt(10)
    v_mfma_f32_16x16x32_bf16 v[144:147], v[40:43], v[176:179], v[144:147]
    ds_read_b64_tr_b16 v[36:37], v4 offset:57344
    v_mfma_f32_16x16x32_bf16 v[148:151], v[40:43], v[180:183], v[148:151]
    ds_read_b64_tr_b16 v[38:39], v4 offset:58368
    v_mfma_f32_16x16x32_bf16 v[152:155], v[44:47], v[176:179], v[152:155]
    ds_read_b64_tr_b16 v[40:41], v5 offset:57344
    v_mfma_f32_16x16x32_bf16 v[156:159], v[44:47], v[180:183], v[156:159]
    ds_read_b64_tr_b16 v[42:43], v5 offset:58368
    s_waitcnt vmcnt(19) lgkmcnt(10)
    v_mfma_f32_16x16x32_bf16 v[64:67], v[48:51], v[184:187], v[64:67]
    ds_read_b64_tr_b16 v[44:45], v6 offset:57344
    v_mfma_f32_16x16x32_bf16 v[68:71], v[48:51], v[188:191], v[68:71]
    ds_read_b64_tr_b16 v[46:47], v6 offset:58368
    v_mfma_f32_16x16x32_bf16 v[72:75], v[52:55], v[184:187], v[72:75]
    ds_read_b64_tr_b16 v[48:49], v3 offset:61440
    v_mfma_f32_16x16x32_bf16 v[76:79], v[52:55], v[188:191], v[76:79]
    ds_read_b64_tr_b16 v[50:51], v3 offset:62464
    s_waitcnt lgkmcnt(10)
    v_mfma_f32_16x16x32_bf16 v[80:83], v[56:59], v[184:187], v[80:83]
    ds_read_b64_tr_b16 v[52:53], v4 offset:61440
    buffer_load_dwordx4 v[172:175], v2, s[4:7], s42 offen offset:2304 sc1
    v_mfma_f32_16x16x32_bf16 v[84:87], v[56:59], v[188:191], v[84:87]
    ds_read_b64_tr_b16 v[54:55], v4 offset:62464
    v_mfma_f32_16x16x32_bf16 v[88:91], v[60:63], v[184:187], v[88:91]
    ds_read_b64_tr_b16 v[56:57], v5 offset:61440
    v_mfma_f32_16x16x32_bf16 v[92:95], v[60:63], v[188:191], v[92:95]
    ds_read_b64_tr_b16 v[58:59], v5 offset:62464
    s_waitcnt lgkmcnt(10)
    v_mfma_f32_16x16x32_bf16 v[96:99], v[184:187], v[32:35], v[96:99]
    ds_read_b64_tr_b16 v[60:61], v6 offset:61440
    v_mfma_f32_16x16x32_bf16 v[100:103], v[188:191], v[32:35], v[100:103]
    ds_read_b64_tr_b16 v[62:63], v6 offset:62464
    s_barrier
    v_xor_b32 v3, 0x10000, v3
    v_xor_b32 v4, 0x10000, v4
    v_xor_b32 v5, 0x10000, v5
    v_xor_b32 v6, 0x10000, v6
    v_mfma_f32_16x16x32_bf16 v[104:107], v[184:187], v[36:39], v[104:107]
    ds_read_b64_tr_b16 v[32:33], v3 offset:0
    v_mfma_f32_16x16x32_bf16 v[108:111], v[188:191], v[36:39], v[108:111]
    ds_read_b64_tr_b16 v[34:35], v3 offset:1024
    s_waitcnt lgkmcnt(10)
    v_mfma_f32_16x16x32_bf16 v[112:115], v[184:187], v[40:43], v[112:115]
    ds_read_b64_tr_b16 v[36:37], v4 offset:0
    v_mfma_f32_16x16x32_bf16 v[116:119], v[188:191], v[40:43], v[116:119]
    ds_read_b64_tr_b16 v[38:39], v4 offset:1024
    v_mfma_f32_16x16x32_bf16 v[120:123], v[184:187], v[44:47], v[120:123]
    ds_read_b64_tr_b16 v[40:41], v5 offset:0
    v_mfma_f32_16x16x32_bf16 v[124:127], v[188:191], v[44:47], v[124:127]
    ds_read_b64_tr_b16 v[42:43], v5 offset:1024
    s_waitcnt lgkmcnt(10)
    v_mfma_f32_16x16x32_bf16 v[128:131], v[48:51], v[184:187], v[128:131]
    ds_read_b64_tr_b16 v[44:45], v6 offset:0
    v_mfma_f32_16x16x32_bf16 v[132:135], v[48:51], v[188:191], v[132:135]
    ds_read_b64_tr_b16 v[46:47], v6 offset:1024
    v_mfma_f32_16x16x32_bf16 v[136:139], v[52:55], v[184:187], v[136:139]
    ds_read_b64_tr_b16 v[48:49], v3 offset:4096
    v_mfma_f32_16x16x32_bf16 v[140:143], v[52:55], v[188:191], v[140:143]
    ds_read_b64_tr_b16 v[50:51], v3 offset:5120
    s_waitcnt lgkmcnt(10)
    v_mfma_f32_16x16x32_bf16 v[144:147], v[56:59], v[184:187], v[144:147]
    ds_read_b64_tr_b16 v[52:53], v4 offset:4096
    v_mfma_f32_16x16x32_bf16 v[148:151], v[56:59], v[188:191], v[148:151]
    ds_read_b64_tr_b16 v[54:55], v4 offset:5120
    v_mfma_f32_16x16x32_bf16 v[152:155], v[60:63], v[184:187], v[152:155]
    ds_read_b64_tr_b16 v[56:57], v5 offset:4096
    v_mfma_f32_16x16x32_bf16 v[156:159], v[60:63], v[188:191], v[156:159]
    ds_read_b64_tr_b16 v[58:59], v5 offset:5120
    s_waitcnt vmcnt(18) lgkmcnt(10)
    v_mfma_f32_16x16x32_bf16 v[64:67], v[32:35], v[192:195], v[64:67]
    ds_read_b64_tr_b16 v[60:61], v6 offset:4096
    v_mfma_f32_16x16x32_bf16 v[68:71], v[32:35], v[196:199], v[68:71]
    ds_read_b64_tr_b16 v[62:63], v6 offset:5120
    v_mfma_f32_16x16x32_bf16 v[72:75], v[36:39], v[192:195], v[72:75]
    ds_read_b64_tr_b16 v[32:33], v3 offset:8192
    v_mfma_f32_16x16x32_bf16 v[76:79], v[36:39], v[196:199], v[76:79]
    ds_read_b64_tr_b16 v[34:35], v3 offset:9216
    s_waitcnt lgkmcnt(10)
    v_mfma_f32_16x16x32_bf16 v[80:83], v[40:43], v[192:195], v[80:83]
    ds_read_b64_tr_b16 v[36:37], v4 offset:8192
    v_mfma_f32_16x16x32_bf16 v[84:87], v[40:43], v[196:199], v[84:87]
    ds_read_b64_tr_b16 v[38:39], v4 offset:9216
    v_mfma_f32_16x16x32_bf16 v[88:91], v[44:47], v[192:195], v[88:91]
    ds_read_b64_tr_b16 v[40:41], v5 offset:8192
    v_mfma_f32_16x16x32_bf16 v[92:95], v[44:47], v[196:199], v[92:95]
    ds_read_b64_tr_b16 v[42:43], v5 offset:9216
    s_waitcnt lgkmcnt(10)
    v_mfma_f32_16x16x32_bf16 v[96:99], v[192:195], v[48:51], v[96:99]
    ds_read_b64_tr_b16 v[44:45], v6 offset:8192
    v_mfma_f32_16x16x32_bf16 v[100:103], v[196:199], v[48:51], v[100:103]
    ds_read_b64_tr_b16 v[46:47], v6 offset:9216
    v_mfma_f32_16x16x32_bf16 v[104:107], v[192:195], v[52:55], v[104:107]
    ds_read_b64_tr_b16 v[48:49], v3 offset:12288
    v_mfma_f32_16x16x32_bf16 v[108:111], v[196:199], v[52:55], v[108:111]
    ds_read_b64_tr_b16 v[50:51], v3 offset:13312
    s_waitcnt lgkmcnt(10)
    v_mfma_f32_16x16x32_bf16 v[112:115], v[192:195], v[56:59], v[112:115]
    ds_read_b64_tr_b16 v[52:53], v4 offset:12288
    v_mfma_f32_16x16x32_bf16 v[116:119], v[196:199], v[56:59], v[116:119]
    ds_read_b64_tr_b16 v[54:55], v4 offset:13312
    v_mfma_f32_16x16x32_bf16 v[120:123], v[192:195], v[60:63], v[120:123]
    ds_read_b64_tr_b16 v[56:57], v5 offset:12288
    v_mfma_f32_16x16x32_bf16 v[124:127], v[196:199], v[60:63], v[124:127]
    ds_read_b64_tr_b16 v[58:59], v5 offset:13312
    s_waitcnt lgkmcnt(10)
    v_mfma_f32_16x16x32_bf16 v[128:131], v[32:35], v[192:195], v[128:131]
    ds_read_b64_tr_b16 v[60:61], v6 offset:12288
    v_mfma_f32_16x16x32_bf16 v[132:135], v[32:35], v[196:199], v[132:135]
    ds_read_b64_tr_b16 v[62:63], v6 offset:13312
    v_mfma_f32_16x16x32_bf16 v[136:139], v[36:39], v[192:195], v[136:139]
    ds_read_b64_tr_b16 v[32:33], v3 offset:16384
    v_mfma_f32_16x16x32_bf16 v[140:143], v[36:39], v[196:199], v[140:143]
    ds_read_b64_tr_b16 v[34:35], v3 offset:17408
    s_waitcnt lgkmcnt(10)
    v_mfma_f32_16x16x32_bf16 v[144:147], v[40:43], v[192:195], v[144:147]
    ds_read_b64_tr_b16 v[36:37], v4 offset:16384
    v_mfma_f32_16x16x32_bf16 v[148:151], v[40:43], v[196:199], v[148:151]
    ds_read_b64_tr_b16 v[38:39], v4 offset:17408
    v_mfma_f32_16x16x32_bf16 v[152:155], v[44:47], v[192:195], v[152:155]
    ds_read_b64_tr_b16 v[40:41], v5 offset:16384
    v_mfma_f32_16x16x32_bf16 v[156:159], v[44:47], v[196:199], v[156:159]
    ds_read_b64_tr_b16 v[42:43], v5 offset:17408
    s_waitcnt vmcnt(16) lgkmcnt(10)
    v_mfma_f32_16x16x32_bf16 v[64:67], v[48:51], v[200:203], v[64:67]
    ds_read_b64_tr_b16 v[44:45], v6 offset:16384
    s_add_u32 s42, s41, s97
    buffer_load_dwordx4 v[176:179], v2, s[4:7], s42 offen offset:0 sc1
    v_mfma_f32_16x16x32_bf16 v[68:71], v[48:51], v[204:207], v[68:71]
    ds_read_b64_tr_b16 v[46:47], v6 offset:17408
    v_mfma_f32_16x16x32_bf16 v[72:75], v[52:55], v[200:203], v[72:75]
    ds_read_b64_tr_b16 v[48:49], v3 offset:20480
    buffer_load_dwordx4 v[180:183], v2, s[4:7], s42 offen offset:256 sc1
    v_mfma_f32_16x16x32_bf16 v[76:79], v[52:55], v[204:207], v[76:79]
    ds_read_b64_tr_b16 v[50:51], v3 offset:21504
    s_waitcnt lgkmcnt(10)
    v_mfma_f32_16x16x32_bf16 v[80:83], v[56:59], v[200:203], v[80:83]
    ds_read_b64_tr_b16 v[52:53], v4 offset:20480
    buffer_load_dwordx4 v[184:187], v2, s[4:7], s42 offen offset:2048 sc1
    v_mfma_f32_16x16x32_bf16 v[84:87], v[56:59], v[204:207], v[84:87]
    ds_read_b64_tr_b16 v[54:55], v4 offset:21504
    v_mfma_f32_16x16x32_bf16 v[88:91], v[60:63], v[200:203], v[88:91]
    ds_read_b64_tr_b16 v[56:57], v5 offset:20480
    buffer_load_dwordx4 v[188:191], v2, s[4:7], s42 offen offset:2304 sc1
    v_mfma_f32_16x16x32_bf16 v[92:95], v[60:63], v[204:207], v[92:95]
    ds_read_b64_tr_b16 v[58:59], v5 offset:21504
    s_waitcnt lgkmcnt(10)
    v_mfma_f32_16x16x32_bf16 v[96:99], v[200:203], v[32:35], v[96:99]
    ds_read_b64_tr_b16 v[60:61], v6 offset:20480
    s_add_u32 s42, s41, s98
    buffer_load_dwordx4 v[192:195], v2, s[4:7], s42 offen offset:0 sc1
    v_mfma_f32_16x16x32_bf16 v[100:103], v[204:207], v[32:35], v[100:103]
    ds_read_b64_tr_b16 v[62:63], v6 offset:21504
    v_mfma_f32_16x16x32_bf16 v[104:107], v[200:203], v[36:39], v[104:107]
    ds_read_b64_tr_b16 v[32:33], v3 offset:24576
    v_mfma_f32_16x16x32_bf16 v[108:111], v[204:207], v[36:39], v[108:111]
    ds_read_b64_tr_b16 v[34:35], v3 offset:25600
    s_waitcnt lgkmcnt(10)
    v_mfma_f32_16x16x32_bf16 v[112:115], v[200:203], v[40:43], v[112:115]
    ds_read_b64_tr_b16 v[36:37], v4 offset:24576
    v_mfma_f32_16x16x32_bf16 v[116:119], v[204:207], v[40:43], v[116:119]
    ds_read_b64_tr_b16 v[38:39], v4 offset:25600
    v_mfma_f32_16x16x32_bf16 v[120:123], v[200:203], v[44:47], v[120:123]
    ds_read_b64_tr_b16 v[40:41], v5 offset:24576
    buffer_load_dwordx4 v[196:199], v2, s[4:7], s42 offen offset:256 sc1
    v_mfma_f32_16x16x32_bf16 v[124:127], v[204:207], v[44:47], v[124:127]
    ds_read_b64_tr_b16 v[42:43], v5 offset:25600
    s_waitcnt lgkmcnt(10)
    v_mfma_f32_16x16x32_bf16 v[128:131], v[48:51], v[200:203], v[128:131]
    ds_read_b64_tr_b16 v[44:45], v6 offset:24576
    v_mfma_f32_16x16x32_bf16 v[132:135], v[48:51], v[204:207], v[132:135]
    ds_read_b64_tr_b16 v[46:47], v6 offset:25600
    v_mfma_f32_16x16x32_bf16 v[136:139], v[52:55], v[200:203], v[136:139]
    ds_read_b64_tr_b16 v[48:49], v3 offset:28672
    v_mfma_f32_16x16x32_bf16 v[140:143], v[52:55], v[204:207], v[140:143]
    ds_read_b64_tr_b16 v[50:51], v3 offset:29696
    s_waitcnt lgkmcnt(10)
    v_mfma_f32_16x16x32_bf16 v[144:147], v[56:59], v[200:203], v[144:147]
    ds_read_b64_tr_b16 v[52:53], v4 offset:28672
    v_mfma_f32_16x16x32_bf16 v[148:151], v[56:59], v[204:207], v[148:151]
    ds_read_b64_tr_b16 v[54:55], v4 offset:29696
    v_mfma_f32_16x16x32_bf16 v[152:155], v[60:63], v[200:203], v[152:155]
    ds_read_b64_tr_b16 v[56:57], v5 offset:28672
    v_mfma_f32_16x16x32_bf16 v[156:159], v[60:63], v[204:207], v[156:159]
    ds_read_b64_tr_b16 v[58:59], v5 offset:29696
    s_waitcnt vmcnt(20) lgkmcnt(10)
    v_mfma_f32_16x16x32_bf16 v[64:67], v[32:35], v[208:211], v[64:67]
    ds_read_b64_tr_b16 v[60:61], v6 offset:28672
    v_mfma_f32_16x16x32_bf16 v[68:71], v[32:35], v[212:215], v[68:71]
    ds_read_b64_tr_b16 v[62:63], v6 offset:29696
    s_barrier
    v_mfma_f32_16x16x32_bf16 v[72:75], v[36:39], v[208:211], v[72:75]
    ds_read_b64_tr_b16 v[32:33], v3 offset:32768
    v_mfma_f32_16x16x32_bf16 v[76:79], v[36:39], v[212:215], v[76:79]
    ds_read_b64_tr_b16 v[34:35], v3 offset:33792
    s_waitcnt lgkmcnt(10)
    v_mfma_f32_16x16x32_bf16 v[80:83], v[40:43], v[208:211], v[80:83]
    ds_read_b64_tr_b16 v[36:37], v4 offset:32768
    v_mfma_f32_16x16x32_bf16 v[84:87], v[40:43], v[212:215], v[84:87]
    ds_read_b64_tr_b16 v[38:39], v4 offset:33792
    v_mfma_f32_16x16x32_bf16 v[88:91], v[44:47], v[208:211], v[88:91]
    ds_read_b64_tr_b16 v[40:41], v5 offset:32768
    v_mfma_f32_16x16x32_bf16 v[92:95], v[44:47], v[212:215], v[92:95]
    ds_read_b64_tr_b16 v[42:43], v5 offset:33792
    s_waitcnt lgkmcnt(10)
    v_mfma_f32_16x16x32_bf16 v[96:99], v[208:211], v[48:51], v[96:99]
    ds_read_b64_tr_b16 v[44:45], v6 offset:32768
    v_mfma_f32_16x16x32_bf16 v[100:103], v[212:215], v[48:51], v[100:103]
    ds_read_b64_tr_b16 v[46:47], v6 offset:33792
    v_mfma_f32_16x16x32_bf16 v[104:107], v[208:211], v[52:55], v[104:107]
    ds_read_b64_tr_b16 v[48:49], v3 offset:36864
    v_mfma_f32_16x16x32_bf16 v[108:111], v[212:215], v[52:55], v[108:111]
    ds_read_b64_tr_b16 v[50:51], v3 offset:37888
    s_waitcnt lgkmcnt(10)
    v_mfma_f32_16x16x32_bf16 v[112:115], v[208:211], v[56:59], v[112:115]
    ds_read_b64_tr_b16 v[52:53], v4 offset:36864
    v_mfma_f32_16x16x32_bf16 v[116:119], v[212:215], v[56:59], v[116:119]
    ds_read_b64_tr_b16 v[54:55], v4 offset:37888
    v_mfma_f32_16x16x32_bf16 v[120:123], v[208:211], v[60:63], v[120:123]
    ds_read_b64_tr_b16 v[56:57], v5 offset:36864
    v_mfma_f32_16x16x32_bf16 v[124:127], v[212:215], v[60:63], v[124:127]
    ds_read_b64_tr_b16 v[58:59], v5 offset:37888
    s_waitcnt lgkmcnt(10)
    v_mfma_f32_16x16x32_bf16 v[128:131], v[32:35], v[208:211], v[128:131]
    ds_read_b64_tr_b16 v[60:61], v6 offset:36864
    v_mfma_f32_16x16x32_bf16 v[132:135], v[32:35], v[212:215], v[132:135]
    ds_read_b64_tr_b16 v[62:63], v6 offset:37888
    v_mfma_f32_16x16x32_bf16 v[136:139], v[36:39], v[208:211], v[136:139]
    ds_read_b64_tr_b16 v[32:33], v3 offset:40960
    v_mfma_f32_16x16x32_bf16 v[140:143], v[36:39], v[212:215], v[140:143]
    ds_read_b64_tr_b16 v[34:35], v3 offset:41984
    s_waitcnt lgkmcnt(10)
    v_mfma_f32_16x16x32_bf16 v[144:147], v[40:43], v[208:211], v[144:147]
    ds_read_b64_tr_b16 v[36:37], v4 offset:40960
    v_mfma_f32_16x16x32_bf16 v[148:151], v[40:43], v[212:215], v[148:151]
    ds_read_b64_tr_b16 v[38:39], v4 offset:41984
    v_mfma_f32_16x16x32_bf16 v[152:155], v[44:47], v[208:211], v[152:155]
    ds_read_b64_tr_b16 v[40:41], v5 offset:40960
    v_mfma_f32_16x16x32_bf16 v[156:159], v[44:47], v[212:215], v[156:159]
    ds_read_b64_tr_b16 v[42:43], v5 offset:41984
    s_waitcnt vmcnt(18) lgkmcnt(10)
    v_mfma_f32_16x16x32_bf16 v[64:67], v[48:51], v[216:219], v[64:67]
    ds_read_b64_tr_b16 v[44:45], v6 offset:40960
    v_mfma_f32_16x16x32_bf16 v[68:71], v[48:51], v[220:223], v[68:71]
    ds_read_b64_tr_b16 v[46:47], v6 offset:41984
    v_mfma_f32_16x16x32_bf16 v[72:75], v[52:55], v[216:219], v[72:75]
    ds_read_b64_tr_b16 v[48:49], v3 offset:45056
    v_mfma_f32_16x16x32_bf16 v[76:79], v[52:55], v[220:223], v[76:79]
    ds_read_b64_tr_b16 v[50:51], v3 offset:46080
    s_waitcnt lgkmcnt(10)
    v_mfma_f32_16x16x32_bf16 v[80:83], v[56:59], v[216:219], v[80:83]
    ds_read_b64_tr_b16 v[52:53], v4 offset:45056
    v_mfma_f32_16x16x32_bf16 v[84:87], v[56:59], v[220:223], v[84:87]
    ds_read_b64_tr_b16 v[54:55], v4 offset:46080
    v_mfma_f32_16x16x32_bf16 v[88:91], v[60:63], v[216:219], v[88:91]
    ds_read_b64_tr_b16 v[56:57], v5 offset:45056
    v_mfma_f32_16x16x32_bf16 v[92:95], v[60:63], v[220:223], v[92:95]
    ds_read_b64_tr_b16 v[58:59], v5 offset:46080
    s_waitcnt lgkmcnt(10)
    v_mfma_f32_16x16x32_bf16 v[96:99], v[216:219], v[32:35], v[96:99]
    ds_read_b64_tr_b16 v[60:61], v6 offset:45056
    v_mfma_f32_16x16x32_bf16 v[100:103], v[220:223], v[32:35], v[100:103]
    ds_read_b64_tr_b16 v[62:63], v6 offset:46080
    v_mfma_f32_16x16x32_bf16 v[104:107], v[216:219], v[36:39], v[104:107]
    ds_read_b64_tr_b16 v[32:33], v3 offset:49152
    v_mfma_f32_16x16x32_bf16 v[108:111], v[220:223], v[36:39], v[108:111]
    ds_read_b64_tr_b16 v[34:35], v3 offset:50176
    s_waitcnt lgkmcnt(10)
    v_mfma_f32_16x16x32_bf16 v[112:115], v[216:219], v[40:43], v[112:115]
    ds_read_b64_tr_b16 v[36:37], v4 offset:49152
    v_mfma_f32_16x16x32_bf16 v[116:119], v[220:223], v[40:43], v[116:119]
    ds_read_b64_tr_b16 v[38:39], v4 offset:50176
    v_mfma_f32_16x16x32_bf16 v[120:123], v[216:219], v[44:47], v[120:123]
    ds_read_b64_tr_b16 v[40:41], v5 offset:49152
    v_mfma_f32_16x16x32_bf16 v[124:127], v[220:223], v[44:47], v[124:127]
    ds_read_b64_tr_b16 v[42:43], v5 offset:50176
    s_waitcnt lgkmcnt(10)
    v_mfma_f32_16x16x32_bf16 v[128:131], v[48:51], v[216:219], v[128:131]
    ds_read_b64_tr_b16 v[44:45], v6 offset:49152
    buffer_load_dwordx4 v[200:203], v2, s[4:7], s42 offen offset:2048 sc1
    v_mfma_f32_16x16x32_bf16 v[132:135], v[48:51], v[220:223], v[132:135]
    ds_read_b64_tr_b16 v[46:47], v6 offset:50176
    v_mfma_f32_16x16x32_bf16 v[136:139], v[52:55], v[216:219], v[136:139]
    ds_read_b64_tr_b16 v[48:49], v3 offset:53248
    buffer_load_dwordx4 v[204:207], v2, s[4:7], s42 offen offset:2304 sc1
    v_mfma_f32_16x16x32_bf16 v[140:143], v[52:55], v[220:223], v[140:143]
    ds_read_b64_tr_b16 v[50:51], v3 offset:54272
    s_waitcnt lgkmcnt(10)
    v_mfma_f32_16x16x32_bf16 v[144:147], v[56:59], v[216:219], v[144:147]
    ds_read_b64_tr_b16 v[52:53], v4 offset:53248
    s_add_u32 s42, s41, s99
    buffer_load_dwordx4 v[208:211], v2, s[4:7], s42 offen offset:0 sc1
    v_mfma_f32_16x16x32_bf16 v[148:151], v[56:59], v[220:223], v[148:151]
    ds_read_b64_tr_b16 v[54:55], v4 offset:54272
    v_mfma_f32_16x16x32_bf16 v[152:155], v[60:63], v[216:219], v[152:155]
    ds_read_b64_tr_b16 v[56:57], v5 offset:53248
    buffer_load_dwordx4 v[212:215], v2, s[4:7], s42 offen offset:256 sc1
    v_mfma_f32_16x16x32_bf16 v[156:159], v[60:63], v[220:223], v[156:159]
    ds_read_b64_tr_b16 v[58:59], v5 offset:54272
    s_waitcnt vmcnt(20) lgkmcnt(10)
    v_mfma_f32_16x16x32_bf16 v[64:67], v[32:35], v[224:227], v[64:67]
    ds_read_b64_tr_b16 v[60:61], v6 offset:53248
    buffer_load_dwordx4 v[216:219], v2, s[4:7], s42 offen offset:2048 sc1
    v_mfma_f32_16x16x32_bf16 v[68:71], v[32:35], v[228:231], v[68:71]
    ds_read_b64_tr_b16 v[62:63], v6 offset:54272
    v_mfma_f32_16x16x32_bf16 v[72:75], v[36:39], v[224:227], v[72:75]
    ds_read_b64_tr_b16 v[32:33], v3 offset:57344
    buffer_load_dwordx4 v[220:223], v2, s[4:7], s42 offen offset:2304 sc1
    v_mfma_f32_16x16x32_bf16 v[76:79], v[36:39], v[228:231], v[76:79]
    ds_read_b64_tr_b16 v[34:35], v3 offset:58368
    s_waitcnt lgkmcnt(10)
    v_mfma_f32_16x16x32_bf16 v[80:83], v[40:43], v[224:227], v[80:83]
    ds_read_b64_tr_b16 v[36:37], v4 offset:57344
    v_mfma_f32_16x16x32_bf16 v[84:87], v[40:43], v[228:231], v[84:87]
    ds_read_b64_tr_b16 v[38:39], v4 offset:58368
    v_mfma_f32_16x16x32_bf16 v[88:91], v[44:47], v[224:227], v[88:91]
    ds_read_b64_tr_b16 v[40:41], v5 offset:57344
    v_mfma_f32_16x16x32_bf16 v[92:95], v[44:47], v[228:231], v[92:95]
    ds_read_b64_tr_b16 v[42:43], v5 offset:58368
    s_waitcnt lgkmcnt(10)
    v_mfma_f32_16x16x32_bf16 v[96:99], v[224:227], v[48:51], v[96:99]
    ds_read_b64_tr_b16 v[44:45], v6 offset:57344
    v_mfma_f32_16x16x32_bf16 v[100:103], v[228:231], v[48:51], v[100:103]
    ds_read_b64_tr_b16 v[46:47], v6 offset:58368
    v_mfma_f32_16x16x32_bf16 v[104:107], v[224:227], v[52:55], v[104:107]
    ds_read_b64_tr_b16 v[48:49], v3 offset:61440
    v_mfma_f32_16x16x32_bf16 v[108:111], v[228:231], v[52:55], v[108:111]
    ds_read_b64_tr_b16 v[50:51], v3 offset:62464
    s_waitcnt lgkmcnt(10)
    v_mfma_f32_16x16x32_bf16 v[112:115], v[224:227], v[56:59], v[112:115]
    ds_read_b64_tr_b16 v[52:53], v4 offset:61440
    v_mfma_f32_16x16x32_bf16 v[116:119], v[228:231], v[56:59], v[116:119]
    ds_read_b64_tr_b16 v[54:55], v4 offset:62464
    v_mfma_f32_16x16x32_bf16 v[120:123], v[224:227], v[60:63], v[120:123]
    ds_read_b64_tr_b16 v[56:57], v5 offset:61440
    v_mfma_f32_16x16x32_bf16 v[124:127], v[228:231], v[60:63], v[124:127]
    ds_read_b64_tr_b16 v[58:59], v5 offset:62464
    s_waitcnt vmcnt(20) lgkmcnt(10)
    v_mfma_f32_16x16x32_bf16 v[64:67], v[32:35], v[232:235], v[64:67]
    ds_read_b64_tr_b16 v[60:61], v6 offset:61440
    v_mfma_f32_16x16x32_bf16 v[68:71], v[32:35], v[236:239], v[68:71]
    ds_read_b64_tr_b16 v[62:63], v6 offset:62464
    s_barrier
    v_xor_b32 v3, 0x10000, v3
    v_xor_b32 v4, 0x10000, v4
    v_xor_b32 v5, 0x10000, v5
    v_xor_b32 v6, 0x10000, v6
    v_mfma_f32_16x16x32_bf16 v[72:75], v[36:39], v[232:235], v[72:75]
    ds_read_b64_tr_b16 v[32:33], v3 offset:0
    v_mfma_f32_16x16x32_bf16 v[76:79], v[36:39], v[236:239], v[76:79]
    ds_read_b64_tr_b16 v[34:35], v3 offset:1024
    s_waitcnt lgkmcnt(10)
    v_mfma_f32_16x16x32_bf16 v[80:83], v[40:43], v[232:235], v[80:83]
    ds_read_b64_tr_b16 v[36:37], v4 offset:0
    v_mfma_f32_16x16x32_bf16 v[84:87], v[40:43], v[236:239], v[84:87]
    ds_read_b64_tr_b16 v[38:39], v4 offset:1024
    v_mfma_f32_16x16x32_bf16 v[88:91], v[44:47], v[232:235], v[88:91]
    ds_read_b64_tr_b16 v[40:41], v5 offset:0
    v_mfma_f32_16x16x32_bf16 v[92:95], v[44:47], v[236:239], v[92:95]
    ds_read_b64_tr_b16 v[42:43], v5 offset:1024
    s_waitcnt lgkmcnt(10)
    v_mfma_f32_16x16x32_bf16 v[96:99], v[232:235], v[48:51], v[96:99]
    ds_read_b64_tr_b16 v[44:45], v6 offset:0
    v_mfma_f32_16x16x32_bf16 v[100:103], v[236:239], v[48:51], v[100:103]
    ds_read_b64_tr_b16 v[46:47], v6 offset:1024
    v_mfma_f32_16x16x32_bf16 v[104:107], v[232:235], v[52:55], v[104:107]
    ds_read_b64_tr_b16 v[48:49], v3 offset:4096
    v_mfma_f32_16x16x32_bf16 v[108:111], v[236:239], v[52:55], v[108:111]
    ds_read_b64_tr_b16 v[50:51], v3 offset:5120
    s_waitcnt lgkmcnt(10)
    v_mfma_f32_16x16x32_bf16 v[112:115], v[232:235], v[56:59], v[112:115]
    ds_read_b64_tr_b16 v[52:53], v4 offset:4096
    v_mfma_f32_16x16x32_bf16 v[116:119], v[236:239], v[56:59], v[116:119]
    ds_read_b64_tr_b16 v[54:55], v4 offset:5120
    v_mfma_f32_16x16x32_bf16 v[120:123], v[232:235], v[60:63], v[120:123]
    ds_read_b64_tr_b16 v[56:57], v5 offset:4096
    v_mfma_f32_16x16x32_bf16 v[124:127], v[236:239], v[60:63], v[124:127]
    ds_read_b64_tr_b16 v[58:59], v5 offset:5120
    s_waitcnt vmcnt(18) lgkmcnt(10)
    v_mfma_f32_16x16x32_bf16 v[64:67], v[32:35], v[240:243], v[64:67]
    ds_read_b64_tr_b16 v[60:61], v6 offset:4096
    v_mfma_f32_16x16x32_bf16 v[68:71], v[32:35], v[244:247], v[68:71]
    ds_read_b64_tr_b16 v[62:63], v6 offset:5120
    v_mfma_f32_16x16x32_bf16 v[72:75], v[36:39], v[240:243], v[72:75]
    ds_read_b64_tr_b16 v[32:33], v3 offset:8192
    v_mfma_f32_16x16x32_bf16 v[76:79], v[36:39], v[244:247], v[76:79]
    ds_read_b64_tr_b16 v[34:35], v3 offset:9216
    s_waitcnt lgkmcnt(10)
    v_mfma_f32_16x16x32_bf16 v[80:83], v[40:43], v[240:243], v[80:83]
    ds_read_b64_tr_b16 v[36:37], v4 offset:8192
    v_mfma_f32_16x16x32_bf16 v[84:87], v[40:43], v[244:247], v[84:87]
    ds_read_b64_tr_b16 v[38:39], v4 offset:9216
    v_mfma_f32_16x16x32_bf16 v[88:91], v[44:47], v[240:243], v[88:91]
    ds_read_b64_tr_b16 v[40:41], v5 offset:8192
    v_mfma_f32_16x16x32_bf16 v[92:95], v[44:47], v[244:247], v[92:95]
    ds_read_b64_tr_b16 v[42:43], v5 offset:9216
    s_waitcnt lgkmcnt(10)
    v_mfma_f32_16x16x32_bf16 v[96:99], v[240:243], v[48:51], v[96:99]
    ds_read_b64_tr_b16 v[44:45], v6 offset:8192
    v_mfma_f32_16x16x32_bf16 v[100:103], v[244:247], v[48:51], v[100:103]
    ds_read_b64_tr_b16 v[46:47], v6 offset:9216
    v_mfma_f32_16x16x32_bf16 v[104:107], v[240:243], v[52:55], v[104:107]
    ds_read_b64_tr_b16 v[48:49], v3 offset:12288
    v_mfma_f32_16x16x32_bf16 v[108:111], v[244:247], v[52:55], v[108:111]
    ds_read_b64_tr_b16 v[50:51], v3 offset:13312
    s_waitcnt lgkmcnt(10)
    v_mfma_f32_16x16x32_bf16 v[112:115], v[240:243], v[56:59], v[112:115]
    ds_read_b64_tr_b16 v[52:53], v4 offset:12288
    v_mfma_f32_16x16x32_bf16 v[116:119], v[244:247], v[56:59], v[116:119]
    ds_read_b64_tr_b16 v[54:55], v4 offset:13312
    v_mfma_f32_16x16x32_bf16 v[120:123], v[240:243], v[60:63], v[120:123]
    ds_read_b64_tr_b16 v[56:57], v5 offset:12288
    v_mfma_f32_16x16x32_bf16 v[124:127], v[244:247], v[60:63], v[124:127]
    ds_read_b64_tr_b16 v[58:59], v5 offset:13312
    s_waitcnt vmcnt(16) lgkmcnt(10)
    v_mfma_f32_16x16x32_bf16 v[64:67], v[32:35], v[248:251], v[64:67]
    ds_read_b64_tr_b16 v[60:61], v6 offset:12288
    v_mfma_f32_16x16x32_bf16 v[68:71], v[32:35], v[252:255], v[68:71]
    ds_read_b64_tr_b16 v[62:63], v6 offset:13312
    v_mfma_f32_16x16x32_bf16 v[72:75], v[36:39], v[248:251], v[72:75]
    ds_read_b64_tr_b16 v[32:33], v3 offset:16384
    v_mfma_f32_16x16x32_bf16 v[76:79], v[36:39], v[252:255], v[76:79]
    ds_read_b64_tr_b16 v[34:35], v3 offset:17408
    s_waitcnt lgkmcnt(10)
    v_mfma_f32_16x16x32_bf16 v[80:83], v[40:43], v[248:251], v[80:83]
    ds_read_b64_tr_b16 v[36:37], v4 offset:16384
    v_mfma_f32_16x16x32_bf16 v[84:87], v[40:43], v[252:255], v[84:87]
    ds_read_b64_tr_b16 v[38:39], v4 offset:17408
    v_mfma_f32_16x16x32_bf16 v[88:91], v[44:47], v[248:251], v[88:91]
    ds_read_b64_tr_b16 v[40:41], v5 offset:16384
    v_mfma_f32_16x16x32_bf16 v[92:95], v[44:47], v[252:255], v[92:95]
    ds_read_b64_tr_b16 v[42:43], v5 offset:17408
    s_waitcnt lgkmcnt(10)
    v_mfma_f32_16x16x32_bf16 v[96:99], v[248:251], v[48:51], v[96:99]
    ds_read_b64_tr_b16 v[44:45], v6 offset:16384
    v_mfma_f32_16x16x32_bf16 v[100:103], v[252:255], v[48:51], v[100:103]
    ds_read_b64_tr_b16 v[46:47], v6 offset:17408
    v_mfma_f32_16x16x32_bf16 v[104:107], v[248:251], v[52:55], v[104:107]
    ds_read_b64_tr_b16 v[48:49], v3 offset:20480
    v_mfma_f32_16x16x32_bf16 v[108:111], v[252:255], v[52:55], v[108:111]
    ds_read_b64_tr_b16 v[50:51], v3 offset:21504
    s_waitcnt lgkmcnt(10)
    v_mfma_f32_16x16x32_bf16 v[112:115], v[248:251], v[56:59], v[112:115]
    ds_read_b64_tr_b16 v[52:53], v4 offset:20480
    v_mfma_f32_16x16x32_bf16 v[116:119], v[252:255], v[56:59], v[116:119]
    ds_read_b64_tr_b16 v[54:55], v4 offset:21504
    v_mfma_f32_16x16x32_bf16 v[120:123], v[248:251], v[60:63], v[120:123]
    ds_read_b64_tr_b16 v[56:57], v5 offset:20480
    v_mfma_f32_16x16x32_bf16 v[124:127], v[252:255], v[60:63], v[124:127]
    ds_read_b64_tr_b16 v[58:59], v5 offset:21504
    s_waitcnt vmcnt(14) lgkmcnt(10)
    v_mfma_f32_16x16x32_bf16 v[64:67], v[32:35], v[160:163], v[64:67]
    ds_read_b64_tr_b16 v[60:61], v6 offset:20480
    v_mfma_f32_16x16x32_bf16 v[68:71], v[32:35], v[164:167], v[68:71]
    ds_read_b64_tr_b16 v[62:63], v6 offset:21504
    v_mfma_f32_16x16x32_bf16 v[72:75], v[36:39], v[160:163], v[72:75]
    ds_read_b64_tr_b16 v[32:33], v3 offset:24576
    v_mfma_f32_16x16x32_bf16 v[76:79], v[36:39], v[164:167], v[76:79]
    ds_read_b64_tr_b16 v[34:35], v3 offset:25600
    s_waitcnt lgkmcnt(10)
    v_mfma_f32_16x16x32_bf16 v[80:83], v[40:43], v[160:163], v[80:83]
    ds_read_b64_tr_b16 v[36:37], v4 offset:24576
    v_mfma_f32_16x16x32_bf16 v[84:87], v[40:43], v[164:167], v[84:87]
    ds_read_b64_tr_b16 v[38:39], v4 offset:25600
    v_mfma_f32_16x16x32_bf16 v[88:91], v[44:47], v[160:163], v[88:91]
    ds_read_b64_tr_b16 v[40:41], v5 offset:24576
    v_mfma_f32_16x16x32_bf16 v[92:95], v[44:47], v[164:167], v[92:95]
    ds_read_b64_tr_b16 v[42:43], v5 offset:25600
    s_waitcnt lgkmcnt(10)
    v_mfma_f32_16x16x32_bf16 v[96:99], v[160:163], v[48:51], v[96:99]
    ds_read_b64_tr_b16 v[44:45], v6 offset:24576
    v_mfma_f32_16x16x32_bf16 v[100:103], v[164:167], v[48:51], v[100:103]
    ds_read_b64_tr_b16 v[46:47], v6 offset:25600
    v_mfma_f32_16x16x32_bf16 v[104:107], v[160:163], v[52:55], v[104:107]
    ds_read_b64_tr_b16 v[48:49], v3 offset:28672
    v_mfma_f32_16x16x32_bf16 v[108:111], v[164:167], v[52:55], v[108:111]
    ds_read_b64_tr_b16 v[50:51], v3 offset:29696
    s_waitcnt lgkmcnt(10)
    v_mfma_f32_16x16x32_bf16 v[112:115], v[160:163], v[56:59], v[112:115]
    ds_read_b64_tr_b16 v[52:53], v4 offset:28672
    v_mfma_f32_16x16x32_bf16 v[116:119], v[164:167], v[56:59], v[116:119]
    ds_read_b64_tr_b16 v[54:55], v4 offset:29696
    v_mfma_f32_16x16x32_bf16 v[120:123], v[160:163], v[60:63], v[120:123]
    ds_read_b64_tr_b16 v[56:57], v5 offset:28672
    v_mfma_f32_16x16x32_bf16 v[124:127], v[164:167], v[60:63], v[124:127]
    ds_read_b64_tr_b16 v[58:59], v5 offset:29696
    s_waitcnt vmcnt(12) lgkmcnt(10)
    v_mfma_f32_16x16x32_bf16 v[64:67], v[32:35], v[168:171], v[64:67]
    ds_read_b64_tr_b16 v[60:61], v6 offset:28672
    v_mfma_f32_16x16x32_bf16 v[68:71], v[32:35], v[172:175], v[68:71]
    ds_read_b64_tr_b16 v[62:63], v6 offset:29696
    s_barrier
    v_mfma_f32_16x16x32_bf16 v[72:75], v[36:39], v[168:171], v[72:75]
    ds_read_b64_tr_b16 v[32:33], v3 offset:32768
    v_mfma_f32_16x16x32_bf16 v[76:79], v[36:39], v[172:175], v[76:79]
    ds_read_b64_tr_b16 v[34:35], v3 offset:33792
    s_waitcnt lgkmcnt(10)
    v_mfma_f32_16x16x32_bf16 v[80:83], v[40:43], v[168:171], v[80:83]
    ds_read_b64_tr_b16 v[36:37], v4 offset:32768
    v_mfma_f32_16x16x32_bf16 v[84:87], v[40:43], v[172:175], v[84:87]
    ds_read_b64_tr_b16 v[38:39], v4 offset:33792
    v_mfma_f32_16x16x32_bf16 v[88:91], v[44:47], v[168:171], v[88:91]
    ds_read_b64_tr_b16 v[40:41], v5 offset:32768
    v_mfma_f32_16x16x32_bf16 v[92:95], v[44:47], v[172:175], v[92:95]
    ds_read_b64_tr_b16 v[42:43], v5 offset:33792
    s_waitcnt lgkmcnt(10)
    v_mfma_f32_16x16x32_bf16 v[96:99], v[168:171], v[48:51], v[96:99]
    ds_read_b64_tr_b16 v[44:45], v6 offset:32768
    v_mfma_f32_16x16x32_bf16 v[100:103], v[172:175], v[48:51], v[100:103]
    ds_read_b64_tr_b16 v[46:47], v6 offset:33792
    v_mfma_f32_16x16x32_bf16 v[104:107], v[168:171], v[52:55], v[104:107]
    ds_read_b64_tr_b16 v[48:49], v3 offset:36864
    v_mfma_f32_16x16x32_bf16 v[108:111], v[172:175], v[52:55], v[108:111]
    ds_read_b64_tr_b16 v[50:51], v3 offset:37888
    s_waitcnt lgkmcnt(10)
    v_mfma_f32_16x16x32_bf16 v[112:115], v[168:171], v[56:59], v[112:115]
    ds_read_b64_tr_b16 v[52:53], v4 offset:36864
    v_mfma_f32_16x16x32_bf16 v[116:119], v[172:175], v[56:59], v[116:119]
    ds_read_b64_tr_b16 v[54:55], v4 offset:37888
    v_mfma_f32_16x16x32_bf16 v[120:123], v[168:171], v[60:63], v[120:123]
    ds_read_b64_tr_b16 v[56:57], v5 offset:36864
    v_mfma_f32_16x16x32_bf16 v[124:127], v[172:175], v[60:63], v[124:127]
    ds_read_b64_tr_b16 v[58:59], v5 offset:37888
    s_waitcnt vmcnt(10) lgkmcnt(10)
    v_mfma_f32_16x16x32_bf16 v[64:67], v[32:35], v[176:179], v[64:67]
    ds_read_b64_tr_b16 v[60:61], v6 offset:36864
    v_mfma_f32_16x16x32_bf16 v[68:71], v[32:35], v[180:183], v[68:71]
    ds_read_b64_tr_b16 v[62:63], v6 offset:37888
    v_mfma_f32_16x16x32_bf16 v[72:75], v[36:39], v[176:179], v[72:75]
    ds_read_b64_tr_b16 v[32:33], v3 offset:40960
    v_mfma_f32_16x16x32_bf16 v[76:79], v[36:39], v[180:183], v[76:79]
    ds_read_b64_tr_b16 v[34:35], v3 offset:41984
    s_waitcnt lgkmcnt(10)
    v_mfma_f32_16x16x32_bf16 v[80:83], v[40:43], v[176:179], v[80:83]
    ds_read_b64_tr_b16 v[36:37], v4 offset:40960
    v_mfma_f32_16x16x32_bf16 v[84:87], v[40:43], v[180:183], v[84:87]
    ds_read_b64_tr_b16 v[38:39], v4 offset:41984
    v_mfma_f32_16x16x32_bf16 v[88:91], v[44:47], v[176:179], v[88:91]
    ds_read_b64_tr_b16 v[40:41], v5 offset:40960
    v_mfma_f32_16x16x32_bf16 v[92:95], v[44:47], v[180:183], v[92:95]
    ds_read_b64_tr_b16 v[42:43], v5 offset:41984
    s_waitcnt lgkmcnt(10)
    v_mfma_f32_16x16x32_bf16 v[96:99], v[176:179], v[48:51], v[96:99]
    ds_read_b64_tr_b16 v[44:45], v6 offset:40960
    v_mfma_f32_16x16x32_bf16 v[100:103], v[180:183], v[48:51], v[100:103]
    ds_read_b64_tr_b16 v[46:47], v6 offset:41984
    v_mfma_f32_16x16x32_bf16 v[104:107], v[176:179], v[52:55], v[104:107]
    ds_read_b64_tr_b16 v[48:49], v3 offset:45056
    v_mfma_f32_16x16x32_bf16 v[108:111], v[180:183], v[52:55], v[108:111]
    ds_read_b64_tr_b16 v[50:51], v3 offset:46080
    s_waitcnt lgkmcnt(10)
    v_mfma_f32_16x16x32_bf16 v[112:115], v[176:179], v[56:59], v[112:115]
    ds_read_b64_tr_b16 v[52:53], v4 offset:45056
    v_mfma_f32_16x16x32_bf16 v[116:119], v[180:183], v[56:59], v[116:119]
    ds_read_b64_tr_b16 v[54:55], v4 offset:46080
    v_mfma_f32_16x16x32_bf16 v[120:123], v[176:179], v[60:63], v[120:123]
    ds_read_b64_tr_b16 v[56:57], v5 offset:45056
    v_mfma_f32_16x16x32_bf16 v[124:127], v[180:183], v[60:63], v[124:127]
    ds_read_b64_tr_b16 v[58:59], v5 offset:46080
    s_waitcnt vmcnt(8) lgkmcnt(10)
    v_mfma_f32_16x16x32_bf16 v[64:67], v[32:35], v[184:187], v[64:67]
    ds_read_b64_tr_b16 v[60:61], v6 offset:45056
    v_mfma_f32_16x16x32_bf16 v[68:71], v[32:35], v[188:191], v[68:71]
    ds_read_b64_tr_b16 v[62:63], v6 offset:46080
    v_mfma_f32_16x16x32_bf16 v[72:75], v[36:39], v[184:187], v[72:75]
    ds_read_b64_tr_b16 v[32:33], v3 offset:49152
    v_mfma_f32_16x16x32_bf16 v[76:79], v[36:39], v[188:191], v[76:79]
    ds_read_b64_tr_b16 v[34:35], v3 offset:50176
    s_waitcnt lgkmcnt(10)
    v_mfma_f32_16x16x32_bf16 v[80:83], v[40:43], v[184:187], v[80:83]
    ds_read_b64_tr_b16 v[36:37], v4 offset:49152
    v_mfma_f32_16x16x32_bf16 v[84:87], v[40:43], v[188:191], v[84:87]
    ds_read_b64_tr_b16 v[38:39], v4 offset:50176
    v_mfma_f32_16x16x32_bf16 v[88:91], v[44:47], v[184:187], v[88:91]
    ds_read_b64_tr_b16 v[40:41], v5 offset:49152
    v_mfma_f32_16x16x32_bf16 v[92:95], v[44:47], v[188:191], v[92:95]
    ds_read_b64_tr_b16 v[42:43], v5 offset:50176
    s_waitcnt lgkmcnt(10)
    v_mfma_f32_16x16x32_bf16 v[96:99], v[184:187], v[48:51], v[96:99]
    ds_read_b64_tr_b16 v[44:45], v6 offset:49152
    v_mfma_f32_16x16x32_bf16 v[100:103], v[188:191], v[48:51], v[100:103]
    ds_read_b64_tr_b16 v[46:47], v6 offset:50176
    v_mfma_f32_16x16x32_bf16 v[104:107], v[184:187], v[52:55], v[104:107]
    ds_read_b64_tr_b16 v[48:49], v3 offset:53248
    v_mfma_f32_16x16x32_bf16 v[108:111], v[188:191], v[52:55], v[108:111]
    ds_read_b64_tr_b16 v[50:51], v3 offset:54272
    s_waitcnt lgkmcnt(10)
    v_mfma_f32_16x16x32_bf16 v[112:115], v[184:187], v[56:59], v[112:115]
    ds_read_b64_tr_b16 v[52:53], v4 offset:53248
    v_mfma_f32_16x16x32_bf16 v[116:119], v[188:191], v[56:59], v[116:119]
    ds_read_b64_tr_b16 v[54:55], v4 offset:54272
    v_mfma_f32_16x16x32_bf16 v[120:123], v[184:187], v[60:63], v[120:123]
    ds_read_b64_tr_b16 v[56:57], v5 offset:53248
    v_mfma_f32_16x16x32_bf16 v[124:127], v[188:191], v[60:63], v[124:127]
    ds_read_b64_tr_b16 v[58:59], v5 offset:54272
    s_waitcnt vmcnt(6) lgkmcnt(10)
    v_mfma_f32_16x16x32_bf16 v[64:67], v[32:35], v[192:195], v[64:67]
    ds_read_b64_tr_b16 v[60:61], v6 offset:53248
    v_mfma_f32_16x16x32_bf16 v[68:71], v[32:35], v[196:199], v[68:71]
    ds_read_b64_tr_b16 v[62:63], v6 offset:54272
    v_mfma_f32_16x16x32_bf16 v[72:75], v[36:39], v[192:195], v[72:75]
    ds_read_b64_tr_b16 v[32:33], v3 offset:57344
    v_mfma_f32_16x16x32_bf16 v[76:79], v[36:39], v[196:199], v[76:79]
    ds_read_b64_tr_b16 v[34:35], v3 offset:58368
    s_waitcnt lgkmcnt(10)
    v_mfma_f32_16x16x32_bf16 v[80:83], v[40:43], v[192:195], v[80:83]
    ds_read_b64_tr_b16 v[36:37], v4 offset:57344
    v_mfma_f32_16x16x32_bf16 v[84:87], v[40:43], v[196:199], v[84:87]
    ds_read_b64_tr_b16 v[38:39], v4 offset:58368
    v_mfma_f32_16x16x32_bf16 v[88:91], v[44:47], v[192:195], v[88:91]
    ds_read_b64_tr_b16 v[40:41], v5 offset:57344
    v_mfma_f32_16x16x32_bf16 v[92:95], v[44:47], v[196:199], v[92:95]
    ds_read_b64_tr_b16 v[42:43], v5 offset:58368
    s_waitcnt lgkmcnt(10)
    v_mfma_f32_16x16x32_bf16 v[96:99], v[192:195], v[48:51], v[96:99]
    ds_read_b64_tr_b16 v[44:45], v6 offset:57344
    v_mfma_f32_16x16x32_bf16 v[100:103], v[196:199], v[48:51], v[100:103]
    ds_read_b64_tr_b16 v[46:47], v6 offset:58368
    v_mfma_f32_16x16x32_bf16 v[104:107], v[192:195], v[52:55], v[104:107]
    ds_read_b64_tr_b16 v[48:49], v3 offset:61440
    v_mfma_f32_16x16x32_bf16 v[108:111], v[196:199], v[52:55], v[108:111]
    ds_read_b64_tr_b16 v[50:51], v3 offset:62464
    s_waitcnt lgkmcnt(10)
    v_mfma_f32_16x16x32_bf16 v[112:115], v[192:195], v[56:59], v[112:115]
    ds_read_b64_tr_b16 v[52:53], v4 offset:61440
    v_mfma_f32_16x16x32_bf16 v[116:119], v[196:199], v[56:59], v[116:119]
    ds_read_b64_tr_b16 v[54:55], v4 offset:62464
    v_mfma_f32_16x16x32_bf16 v[120:123], v[192:195], v[60:63], v[120:123]
    ds_read_b64_tr_b16 v[56:57], v5 offset:61440
    v_mfma_f32_16x16x32_bf16 v[124:127], v[196:199], v[60:63], v[124:127]
    ds_read_b64_tr_b16 v[58:59], v5 offset:62464
    s_waitcnt vmcnt(4) lgkmcnt(10)
    v_mfma_f32_16x16x32_bf16 v[64:67], v[32:35], v[200:203], v[64:67]
    ds_read_b64_tr_b16 v[60:61], v6 offset:61440
    v_mfma_f32_16x16x32_bf16 v[68:71], v[32:35], v[204:207], v[68:71]
    ds_read_b64_tr_b16 v[62:63], v6 offset:62464
    s_barrier
    v_xor_b32 v3, 0x10000, v3
    v_xor_b32 v4, 0x10000, v4
    v_xor_b32 v5, 0x10000, v5
    v_xor_b32 v6, 0x10000, v6
    v_mfma_f32_16x16x32_bf16 v[72:75], v[36:39], v[200:203], v[72:75]
    ds_read_b64_tr_b16 v[32:33], v3 offset:0
    v_mfma_f32_16x16x32_bf16 v[76:79], v[36:39], v[204:207], v[76:79]
    ds_read_b64_tr_b16 v[34:35], v3 offset:1024
    s_waitcnt lgkmcnt(10)
    v_mfma_f32_16x16x32_bf16 v[80:83], v[40:43], v[200:203], v[80:83]
    ds_read_b64_tr_b16 v[36:37], v4 offset:0
    v_mfma_f32_16x16x32_bf16 v[84:87], v[40:43], v[204:207], v[84:87]
    ds_read_b64_tr_b16 v[38:39], v4 offset:1024
    v_mfma_f32_16x16x32_bf16 v[88:91], v[44:47], v[200:203], v[88:91]
    ds_read_b64_tr_b16 v[40:41], v5 offset:0
    v_mfma_f32_16x16x32_bf16 v[92:95], v[44:47], v[204:207], v[92:95]
    ds_read_b64_tr_b16 v[42:43], v5 offset:1024
    s_waitcnt lgkmcnt(10)
    v_mfma_f32_16x16x32_bf16 v[96:99], v[200:203], v[48:51], v[96:99]
    ds_read_b64_tr_b16 v[44:45], v6 offset:0
    v_mfma_f32_16x16x32_bf16 v[100:103], v[204:207], v[48:51], v[100:103]
    ds_read_b64_tr_b16 v[46:47], v6 offset:1024
    v_mfma_f32_16x16x32_bf16 v[104:107], v[200:203], v[52:55], v[104:107]
    ds_read_b64_tr_b16 v[48:49], v3 offset:4096
    v_mfma_f32_16x16x32_bf16 v[108:111], v[204:207], v[52:55], v[108:111]
    ds_read_b64_tr_b16 v[50:51], v3 offset:5120
    s_waitcnt lgkmcnt(10)
    v_mfma_f32_16x16x32_bf16 v[112:115], v[200:203], v[56:59], v[112:115]
    ds_read_b64_tr_b16 v[52:53], v4 offset:4096
    v_mfma_f32_16x16x32_bf16 v[116:119], v[204:207], v[56:59], v[116:119]
    ds_read_b64_tr_b16 v[54:55], v4 offset:5120
    v_mfma_f32_16x16x32_bf16 v[120:123], v[200:203], v[60:63], v[120:123]
    ds_read_b64_tr_b16 v[56:57], v5 offset:4096
    v_mfma_f32_16x16x32_bf16 v[124:127], v[204:207], v[60:63], v[124:127]
    ds_read_b64_tr_b16 v[58:59], v5 offset:5120
    s_waitcnt vmcnt(2) lgkmcnt(10)
    v_mfma_f32_16x16x32_bf16 v[64:67], v[32:35], v[208:211], v[64:67]
    ds_read_b64_tr_b16 v[60:61], v6 offset:4096
    v_mfma_f32_16x16x32_bf16 v[68:71], v[32:35], v[212:215], v[68:71]
    ds_read_b64_tr_b16 v[62:63], v6 offset:5120
    v_mfma_f32_16x16x32_bf16 v[72:75], v[36:39], v[208:211], v[72:75]
    ds_read_b64_tr_b16 v[32:33], v3 offset:8192
    v_mfma_f32_16x16x32_bf16 v[76:79], v[36:39], v[212:215], v[76:79]
    ds_read_b64_tr_b16 v[34:35], v3 offset:9216
    s_waitcnt lgkmcnt(10)
    v_mfma_f32_16x16x32_bf16 v[80:83], v[40:43], v[208:211], v[80:83]
    ds_read_b64_tr_b16 v[36:37], v4 offset:8192
    v_mfma_f32_16x16x32_bf16 v[84:87], v[40:43], v[212:215], v[84:87]
    ds_read_b64_tr_b16 v[38:39], v4 offset:9216
    v_mfma_f32_16x16x32_bf16 v[88:91], v[44:47], v[208:211], v[88:91]
    ds_read_b64_tr_b16 v[40:41], v5 offset:8192
    v_mfma_f32_16x16x32_bf16 v[92:95], v[44:47], v[212:215], v[92:95]
    ds_read_b64_tr_b16 v[42:43], v5 offset:9216
    s_waitcnt lgkmcnt(10)
    v_mfma_f32_16x16x32_bf16 v[96:99], v[208:211], v[48:51], v[96:99]
    ds_read_b64_tr_b16 v[44:45], v6 offset:8192
    v_mfma_f32_16x16x32_bf16 v[100:103], v[212:215], v[48:51], v[100:103]
    ds_read_b64_tr_b16 v[46:47], v6 offset:9216
    v_mfma_f32_16x16x32_bf16 v[104:107], v[208:211], v[52:55], v[104:107]
    ds_read_b64_tr_b16 v[48:49], v3 offset:12288
    v_mfma_f32_16x16x32_bf16 v[108:111], v[212:215], v[52:55], v[108:111]
    ds_read_b64_tr_b16 v[50:51], v3 offset:13312
    s_waitcnt lgkmcnt(10)
    v_mfma_f32_16x16x32_bf16 v[112:115], v[208:211], v[56:59], v[112:115]
    ds_read_b64_tr_b16 v[52:53], v4 offset:12288
    v_mfma_f32_16x16x32_bf16 v[116:119], v[212:215], v[56:59], v[116:119]
    ds_read_b64_tr_b16 v[54:55], v4 offset:13312
    v_mfma_f32_16x16x32_bf16 v[120:123], v[208:211], v[60:63], v[120:123]
    ds_read_b64_tr_b16 v[56:57], v5 offset:12288
    v_mfma_f32_16x16x32_bf16 v[124:127], v[212:215], v[60:63], v[124:127]
    ds_read_b64_tr_b16 v[58:59], v5 offset:13312
    s_waitcnt vmcnt(0) lgkmcnt(10)
    v_mfma_f32_16x16x32_bf16 v[64:67], v[32:35], v[216:219], v[64:67]
    ds_read_b64_tr_b16 v[60:61], v6 offset:12288
    v_mfma_f32_16x16x32_bf16 v[68:71], v[32:35], v[220:223], v[68:71]
    ds_read_b64_tr_b16 v[62:63], v6 offset:13312
    v_mfma_f32_16x16x32_bf16 v[72:75], v[36:39], v[216:219], v[72:75]
    ds_read_b64_tr_b16 v[32:33], v3 offset:16384
    ds_read_b32 v8, v9 offset:4096
    v_mfma_f32_16x16x32_bf16 v[76:79], v[36:39], v[220:223], v[76:79]
    ds_read_b64_tr_b16 v[34:35], v3 offset:17408
    ds_read_b32 v10, v9 offset:4608
    s_waitcnt lgkmcnt(12)
    v_mfma_f32_16x16x32_bf16 v[80:83], v[40:43], v[216:219], v[80:83]
    ds_read_b64_tr_b16 v[36:37], v4 offset:16384
    ds_read_b32 v12, v9 offset:4160
    v_mfma_f32_16x16x32_bf16 v[84:87], v[40:43], v[220:223], v[84:87]
    ds_read_b64_tr_b16 v[38:39], v4 offset:17408
    ds_read_b32 v14, v9 offset:4672
    v_mfma_f32_16x16x32_bf16 v[88:91], v[44:47], v[216:219], v[88:91]
    ds_read_b64_tr_b16 v[40:41], v5 offset:16384
    ds_read_b128 v[16:19], v11 offset:256
    v_mfma_f32_16x16x32_bf16 v[92:95], v[44:47], v[220:223], v[92:95]
    ds_read_b64_tr_b16 v[42:43], v5 offset:17408
    ds_read_b128 v[20:23], v11 offset:320
    s_waitcnt lgkmcnt(15)
    v_mfma_f32_16x16x32_bf16 v[96:99], v[216:219], v[48:51], v[96:99]
    ds_read_b64_tr_b16 v[44:45], v6 offset:16384
    ds_read_b128 v[24:27], v11 offset:384
    v_mfma_f32_16x16x32_bf16 v[100:103], v[220:223], v[48:51], v[100:103]
    ds_read_b64_tr_b16 v[46:47], v6 offset:17408
    ds_read_b128 v[28:31], v11 offset:448
    v_mfma_f32_16x16x32_bf16 v[104:107], v[216:219], v[52:55], v[104:107]
    ds_read_b64_tr_b16 v[48:49], v3 offset:20480
    v_mfma_f32_16x16x32_bf16 v[108:111], v[220:223], v[52:55], v[108:111]
    ds_read_b64_tr_b16 v[50:51], v3 offset:21504
    s_waitcnt lgkmcnt(15)
    v_mfma_f32_16x16x32_bf16 v[112:115], v[216:219], v[56:59], v[112:115]
    ds_read_b64_tr_b16 v[52:53], v4 offset:20480
    v_mfma_f32_16x16x32_bf16 v[116:119], v[220:223], v[56:59], v[116:119]
    ds_read_b64_tr_b16 v[54:55], v4 offset:21504
    v_mfma_f32_16x16x32_bf16 v[120:123], v[216:219], v[60:63], v[120:123]
    ds_read_b64_tr_b16 v[56:57], v5 offset:20480
    v_mfma_f32_16x16x32_bf16 v[124:127], v[220:223], v[60:63], v[124:127]
    ds_read_b64_tr_b16 v[58:59], v5 offset:21504
    s_bitcmp1_b32 s21, 0
    s_cbranch_scc1 c_B
    v_add_u32 v7, s62, v1
    s_waitcnt lgkmcnt(6)
    v_pk_fma_f32 v[68:69], v[12:13], v[16:17], v[68:69] op_sel_hi:[0,1,1] neg_lo:[1,0,0] neg_hi:[1,0,0]
    v_pk_fma_f32 v[70:71], v[12:13], v[18:19], v[70:71] op_sel_hi:[0,1,1] neg_lo:[1,0,0] neg_hi:[1,0,0]
    v_pk_fma_f32 v[76:77], v[12:13], v[20:21], v[76:77] op_sel_hi:[0,1,1] neg_lo:[1,0,0] neg_hi:[1,0,0]
    v_pk_fma_f32 v[78:79], v[12:13], v[22:23], v[78:79] op_sel_hi:[0,1,1] neg_lo:[1,0,0] neg_hi:[1,0,0]
    v_pk_mul_f32 v[68:69], v[14:15], v[68:69] op_sel_hi:[0,1]
    v_pk_mul_f32 v[70:71], v[14:15], v[70:71] op_sel_hi:[0,1]
    v_pk_mul_f32 v[76:77], v[14:15], v[76:77] op_sel_hi:[0,1]
    v_pk_mul_f32 v[78:79], v[14:15], v[78:79] op_sel_hi:[0,1]
    v_cvt_pk_bf16_f32 v68, v68, v69
    v_cvt_pk_bf16_f32 v69, v70, v71
    v_cvt_pk_bf16_f32 v70, v76, v77
    v_cvt_pk_bf16_f32 v71, v78, v79
    ds_write_b128 v7, v[68:71] offset:4096
    v_pk_fma_f32 v[64:65], v[8:9], v[16:17], v[64:65] op_sel_hi:[0,1,1] neg_lo:[1,0,0] neg_hi:[1,0,0]
    v_pk_fma_f32 v[66:67], v[8:9], v[18:19], v[66:67] op_sel_hi:[0,1,1] neg_lo:[1,0,0] neg_hi:[1,0,0]
    v_pk_fma_f32 v[72:73], v[8:9], v[20:21], v[72:73] op_sel_hi:[0,1,1] neg_lo:[1,0,0] neg_hi:[1,0,0]
    v_pk_fma_f32 v[74:75], v[8:9], v[22:23], v[74:75] op_sel_hi:[0,1,1] neg_lo:[1,0,0] neg_hi:[1,0,0]
    v_pk_mul_f32 v[64:65], v[10:11], v[64:65] op_sel_hi:[0,1]
    v_pk_mul_f32 v[66:67], v[10:11], v[66:67] op_sel_hi:[0,1]
    v_pk_mul_f32 v[72:73], v[10:11], v[72:73] op_sel_hi:[0,1]
    v_pk_mul_f32 v[74:75], v[10:11], v[74:75] op_sel_hi:[0,1]
    ds_read_b128 v[16:19], v13 offset:4160
    ds_read_b128 v[20:23], v13 offset:4672
    v_cvt_pk_bf16_f32 v64, v64, v65
    v_cvt_pk_bf16_f32 v65, v66, v67
    v_cvt_pk_bf16_f32 v66, v72, v73
    v_cvt_pk_bf16_f32 v67, v74, v75
    v_pk_fma_f32 v[84:85], v[12:13], v[24:25], v[84:85] op_sel_hi:[0,1,1] neg_lo:[1,0,0] neg_hi:[1,0,0]
    v_pk_fma_f32 v[86:87], v[12:13], v[26:27], v[86:87] op_sel_hi:[0,1,1] neg_lo:[1,0,0] neg_hi:[1,0,0]
    v_pk_fma_f32 v[92:93], v[12:13], v[28:29], v[92:93] op_sel_hi:[0,1,1] neg_lo:[1,0,0] neg_hi:[1,0,0]
    v_pk_fma_f32 v[94:95], v[12:13], v[30:31], v[94:95] op_sel_hi:[0,1,1] neg_lo:[1,0,0] neg_hi:[1,0,0]
    v_pk_mul_f32 v[84:85], v[14:15], v[84:85] op_sel_hi:[0,1]
    v_pk_mul_f32 v[86:87], v[14:15], v[86:87] op_sel_hi:[0,1]
    v_pk_mul_f32 v[92:93], v[14:15], v[92:93] op_sel_hi:[0,1]
    v_pk_mul_f32 v[94:95], v[14:15], v[94:95] op_sel_hi:[0,1]
    ds_read_b32 v12, v15 offset:512
    ds_read_b32 v14, v15 offset:576
    v_cvt_pk_bf16_f32 v84, v84, v85
    v_cvt_pk_bf16_f32 v85, v86, v87
    v_cvt_pk_bf16_f32 v86, v92, v93
    v_cvt_pk_bf16_f32 v87, v94, v95
    ds_write_b128 v7, v[84:87] offset:5120
    v_pk_fma_f32 v[80:81], v[8:9], v[24:25], v[80:81] op_sel_hi:[0,1,1] neg_lo:[1,0,0] neg_hi:[1,0,0]
    v_pk_fma_f32 v[82:83], v[8:9], v[26:27], v[82:83] op_sel_hi:[0,1,1] neg_lo:[1,0,0] neg_hi:[1,0,0]
    v_pk_fma_f32 v[88:89], v[8:9], v[28:29], v[88:89] op_sel_hi:[0,1,1] neg_lo:[1,0,0] neg_hi:[1,0,0]
    v_pk_fma_f32 v[90:91], v[8:9], v[30:31], v[90:91] op_sel_hi:[0,1,1] neg_lo:[1,0,0] neg_hi:[1,0,0]
    v_pk_mul_f32 v[80:81], v[10:11], v[80:81] op_sel_hi:[0,1]
    v_pk_mul_f32 v[82:83], v[10:11], v[82:83] op_sel_hi:[0,1]
    v_pk_mul_f32 v[88:89], v[10:11], v[88:89] op_sel_hi:[0,1]
    v_pk_mul_f32 v[90:91], v[10:11], v[90:91] op_sel_hi:[0,1]
    ds_read_b128 v[24:27], v13 offset:4096
    ds_read_b128 v[28:31], v13 offset:4608
    ds_read_b32 v8, v15 offset:640
    ds_read_b32 v10, v15 offset:704
    v_cvt_pk_bf16_f32 v80, v80, v81
    v_cvt_pk_bf16_f32 v81, v82, v83
    v_cvt_pk_bf16_f32 v82, v88, v89
    v_cvt_pk_bf16_f32 v83, v90, v91
    s_waitcnt lgkmcnt(5)
    v_pk_fma_f32 v[100:101], v[12:13], v[16:17], v[100:101] op_sel_hi:[0,1,1] neg_lo:[1,0,0] neg_hi:[1,0,0]
    v_pk_fma_f32 v[102:103], v[12:13], v[18:19], v[102:103] op_sel_hi:[0,1,1] neg_lo:[1,0,0] neg_hi:[1,0,0]
    v_pk_fma_f32 v[108:109], v[14:15], v[16:17], v[108:109] op_sel_hi:[0,1,1] neg_lo:[1,0,0] neg_hi:[1,0,0]
    v_pk_fma_f32 v[110:111], v[14:15], v[18:19], v[110:111] op_sel_hi:[0,1,1] neg_lo:[1,0,0] neg_hi:[1,0,0]
    v_pk_mul_f32 v[100:101], v[20:21], v[100:101]
    v_pk_mul_f32 v[102:103], v[22:23], v[102:103]
    v_pk_mul_f32 v[108:109], v[20:21], v[108:109]
    v_pk_mul_f32 v[110:111], v[22:23], v[110:111]
    v_cvt_pk_bf16_f32 v74, v100, v101
    v_cvt_pk_bf16_f32 v75, v102, v103
    v_cvt_pk_bf16_f32 v78, v108, v109
    v_cvt_pk_bf16_f32 v79, v110, v111
    v_cvt_pk_bf16_f32 v100, v100, v101
    v_cvt_pk_bf16_f32 v101, v102, v103
    v_cvt_pk_bf16_f32 v102, v108, v109
    v_cvt_pk_bf16_f32 v103, v110, v111
    ds_write_b128 v7, v[100:103] offset:6144
    s_waitcnt lgkmcnt(1)
    v_pk_fma_f32 v[116:117], v[8:9], v[16:17], v[116:117] op_sel_hi:[0,1,1] neg_lo:[1,0,0] neg_hi:[1,0,0]
    v_pk_fma_f32 v[118:119], v[8:9], v[18:19], v[118:119] op_sel_hi:[0,1,1] neg_lo:[1,0,0] neg_hi:[1,0,0]
    v_pk_fma_f32 v[124:125], v[10:11], v[16:17], v[124:125] op_sel_hi:[0,1,1] neg_lo:[1,0,0] neg_hi:[1,0,0]
    v_pk_fma_f32 v[126:127], v[10:11], v[18:19], v[126:127] op_sel_hi:[0,1,1] neg_lo:[1,0,0] neg_hi:[1,0,0]
    v_pk_mul_f32 v[116:117], v[20:21], v[116:117]
    v_pk_mul_f32 v[118:119], v[22:23], v[118:119]
    v_pk_mul_f32 v[124:125], v[20:21], v[124:125]
    v_pk_mul_f32 v[126:127], v[22:23], v[126:127]
    v_cvt_pk_bf16_f32 v90, v116, v117
    v_cvt_pk_bf16_f32 v91, v118, v119
    v_cvt_pk_bf16_f32 v94, v124, v125
    v_cvt_pk_bf16_f32 v95, v126, v127
    v_cvt_pk_bf16_f32 v116, v116, v117
    v_cvt_pk_bf16_f32 v117, v118, v119
    v_cvt_pk_bf16_f32 v118, v124, v125
    v_cvt_pk_bf16_f32 v119, v126, v127
    ds_write_b128 v7, v[116:119] offset:7168
    s_cmp_lg_u32 s16, 3
    s_cbranch_scc1 a_nh
    buffer_store_dwordx4 v[68:71], v1, s[4:7], s60 offen offset:0 sc1
    buffer_store_dwordx4 v[84:87], v1, s[4:7], s60 offen offset:1024 sc1
    buffer_store_dwordx4 v[100:103], v1, s[4:7], s60 offen offset:2048 sc1
    buffer_store_dwordx4 v[116:119], v1, s[4:7], s60 offen offset:3072 sc1
a_nh:
    v_pk_fma_f32 v[96:97], v[12:13], v[24:25], v[96:97] op_sel_hi:[0,1,1] neg_lo:[1,0,0] neg_hi:[1,0,0]
    v_pk_fma_f32 v[98:99], v[12:13], v[26:27], v[98:99] op_sel_hi:[0,1,1] neg_lo:[1,0,0] neg_hi:[1,0,0]
    v_pk_fma_f32 v[104:105], v[14:15], v[24:25], v[104:105] op_sel_hi:[0,1,1] neg_lo:[1,0,0] neg_hi:[1,0,0]
    v_pk_fma_f32 v[106:107], v[14:15], v[26:27], v[106:107] op_sel_hi:[0,1,1] neg_lo:[1,0,0] neg_hi:[1,0,0]
    v_pk_mul_f32 v[96:97], v[28:29], v[96:97]
    v_pk_mul_f32 v[98:99], v[30:31], v[98:99]
    v_pk_mul_f32 v[104:105], v[28:29], v[104:105]
    v_pk_mul_f32 v[106:107], v[30:31], v[106:107]
    v_cvt_pk_bf16_f32 v72, v96, v97
    v_cvt_pk_bf16_f32 v73, v98, v99
    v_cvt_pk_bf16_f32 v76, v104, v105
    v_cvt_pk_bf16_f32 v77, v106, v107
    v_pk_fma_f32 v[112:113], v[8:9], v[24:25], v[112:113] op_sel_hi:[0,1,1] neg_lo:[1,0,0] neg_hi:[1,0,0]
    v_pk_fma_f32 v[114:115], v[8:9], v[26:27], v[114:115] op_sel_hi:[0,1,1] neg_lo:[1,0,0] neg_hi:[1,0,0]
    v_pk_fma_f32 v[120:121], v[10:11], v[24:25], v[120:121] op_sel_hi:[0,1,1] neg_lo:[1,0,0] neg_hi:[1,0,0]
    v_pk_fma_f32 v[122:123], v[10:11], v[26:27], v[122:123] op_sel_hi:[0,1,1] neg_lo:[1,0,0] neg_hi:[1,0,0]
    v_pk_mul_f32 v[112:113], v[28:29], v[112:113]
    v_pk_mul_f32 v[114:115], v[30:31], v[114:115]
    v_pk_mul_f32 v[120:121], v[28:29], v[120:121]
    v_pk_mul_f32 v[122:123], v[30:31], v[122:123]
    v_cvt_pk_bf16_f32 v88, v112, v113
    v_cvt_pk_bf16_f32 v89, v114, v115
    v_cvt_pk_bf16_f32 v92, v120, v121
    v_cvt_pk_bf16_f32 v93, v122, v123
    v_mfma_f32_16x16x32_bf16 v[128:131], v[32:35], v[224:227], v[128:131]
    ds_read_b64_tr_b16 v[60:61], v6 offset:20480
    v_mfma_f32_16x16x32_bf16 v[132:135], v[32:35], v[228:231], v[132:135]
    ds_read_b64_tr_b16 v[62:63], v6 offset:21504
    v_mfma_f32_16x16x32_bf16 v[136:139], v[36:39], v[224:227], v[136:139]
    ds_read_b64_tr_b16 v[32:33], v3 offset:24576
    v_mfma_f32_16x16x32_bf16 v[140:143], v[36:39], v[228:231], v[140:143]
    ds_read_b64_tr_b16 v[34:35], v3 offset:25600
    v_mfma_f32_16x16x32_bf16 v[144:147], v[40:43], v[224:227], v[144:147]
    ds_read_b64_tr_b16 v[36:37], v4 offset:24576
    v_mfma_f32_16x16x32_bf16 v[148:151], v[40:43], v[228:231], v[148:151]
    ds_read_b64_tr_b16 v[38:39], v4 offset:25600
    v_mfma_f32_16x16x32_bf16 v[152:155], v[44:47], v[224:227], v[152:155]
    ds_read_b64_tr_b16 v[40:41], v5 offset:24576
    v_mfma_f32_16x16x32_bf16 v[156:159], v[44:47], v[228:231], v[156:159]
    ds_read_b64_tr_b16 v[42:43], v5 offset:25600
    v_mfma_f32_16x16x32_bf16 v[128:131], v[48:51], v[232:235], v[128:131]
    ds_read_b64_tr_b16 v[44:45], v6 offset:24576
    v_mfma_f32_16x16x32_bf16 v[132:135], v[48:51], v[236:239], v[132:135]
    ds_read_b64_tr_b16 v[46:47], v6 offset:25600
    v_mfma_f32_16x16x32_bf16 v[136:139], v[52:55], v[232:235], v[136:139]
    ds_read_b64_tr_b16 v[48:49], v3 offset:28672
    v_mfma_f32_16x16x32_bf16 v[140:143], v[52:55], v[236:239], v[140:143]
    ds_read_b64_tr_b16 v[50:51], v3 offset:29696
    s_waitcnt lgkmcnt(10)
    v_mfma_f32_16x16x32_bf16 v[144:147], v[56:59], v[232:235], v[144:147]
    ds_read_b64_tr_b16 v[52:53], v4 offset:28672
    v_mfma_f32_16x16x32_bf16 v[148:151], v[56:59], v[236:239], v[148:151]
    ds_read_b64_tr_b16 v[54:55], v4 offset:29696
    v_mfma_f32_16x16x32_bf16 v[152:155], v[60:63], v[232:235], v[152:155]
    ds_read_b64_tr_b16 v[56:57], v5 offset:28672
    v_mfma_f32_16x16x32_bf16 v[156:159], v[60:63], v[236:239], v[156:159]
    ds_read_b64_tr_b16 v[58:59], v5 offset:29696
    s_waitcnt lgkmcnt(10)
    v_mfma_f32_16x16x32_bf16 v[128:131], v[32:35], v[240:243], v[128:131]
    ds_read_b64_tr_b16 v[60:61], v6 offset:28672
    v_mfma_f32_16x16x32_bf16 v[132:135], v[32:35], v[244:247], v[132:135]
    ds_read_b64_tr_b16 v[62:63], v6 offset:29696
    s_barrier
    v_mfma_f32_16x16x32_bf16 v[136:139], v[36:39], v[240:243], v[136:139]
    ds_read_b64_tr_b16 v[32:33], v3 offset:32768
    v_mfma_f32_16x16x32_bf16 v[140:143], v[36:39], v[244:247], v[140:143]
    ds_read_b64_tr_b16 v[34:35], v3 offset:33792
    s_waitcnt lgkmcnt(10)
    v_mfma_f32_16x16x32_bf16 v[144:147], v[40:43], v[240:243], v[144:147]
    ds_read_b64_tr_b16 v[36:37], v4 offset:32768
    v_mfma_f32_16x16x32_bf16 v[148:151], v[40:43], v[244:247], v[148:151]
    ds_read_b64_tr_b16 v[38:39], v4 offset:33792
    v_mfma_f32_16x16x32_bf16 v[152:155], v[44:47], v[240:243], v[152:155]
    ds_read_b64_tr_b16 v[40:41], v5 offset:32768
    v_mfma_f32_16x16x32_bf16 v[156:159], v[44:47], v[244:247], v[156:159]
    ds_read_b64_tr_b16 v[42:43], v5 offset:33792
    s_waitcnt lgkmcnt(10)
    v_mfma_f32_16x16x32_bf16 v[128:131], v[48:51], v[248:251], v[128:131]
    ds_read_b64_tr_b16 v[44:45], v6 offset:32768
    v_mfma_f32_16x16x32_bf16 v[132:135], v[48:51], v[252:255], v[132:135]
    ds_read_b64_tr_b16 v[46:47], v6 offset:33792
    v_mfma_f32_16x16x32_bf16 v[136:139], v[52:55], v[248:251], v[136:139]
    ds_read_b64_tr_b16 v[48:49], v3 offset:36864
    v_mfma_f32_16x16x32_bf16 v[140:143], v[52:55], v[252:255], v[140:143]
    ds_read_b64_tr_b16 v[50:51], v3 offset:37888
    s_waitcnt lgkmcnt(10)
    v_mfma_f32_16x16x32_bf16 v[144:147], v[56:59], v[248:251], v[144:147]
    ds_read_b64_tr_b16 v[52:53], v4 offset:36864
    v_mfma_f32_16x16x32_bf16 v[148:151], v[56:59], v[252:255], v[148:151]
    ds_read_b64_tr_b16 v[54:55], v4 offset:37888
    v_mfma_f32_16x16x32_bf16 v[152:155], v[60:63], v[248:251], v[152:155]
    ds_read_b64_tr_b16 v[56:57], v5 offset:36864
    v_mfma_f32_16x16x32_bf16 v[156:159], v[60:63], v[252:255], v[156:159]
    ds_read_b64_tr_b16 v[58:59], v5 offset:37888
    s_waitcnt lgkmcnt(10)
    v_mfma_f32_16x16x32_bf16 v[128:131], v[32:35], v[160:163], v[128:131]
    ds_read_b64_tr_b16 v[60:61], v6 offset:36864
    v_mfma_f32_16x16x32_bf16 v[132:135], v[32:35], v[164:167], v[132:135]
    ds_read_b64_tr_b16 v[62:63], v6 offset:37888
    v_mfma_f32_16x16x32_bf16 v[136:139], v[36:39], v[160:163], v[136:139]
    ds_read_b64_tr_b16 v[32:33], v3 offset:40960
    v_mfma_f32_16x16x32_bf16 v[140:143], v[36:39], v[164:167], v[140:143]
    ds_read_b64_tr_b16 v[34:35], v3 offset:41984
    s_waitcnt lgkmcnt(10)
    v_mfma_f32_16x16x32_bf16 v[144:147], v[40:43], v[160:163], v[144:147]
    ds_read_b64_tr_b16 v[36:37], v4 offset:40960
    v_mfma_f32_16x16x32_bf16 v[148:151], v[40:43], v[164:167], v[148:151]
    ds_read_b64_tr_b16 v[38:39], v4 offset:41984
    v_mfma_f32_16x16x32_bf16 v[152:155], v[44:47], v[160:163], v[152:155]
    ds_read_b64_tr_b16 v[40:41], v5 offset:40960
    v_mfma_f32_16x16x32_bf16 v[156:159], v[44:47], v[164:167], v[156:159]
    ds_read_b64_tr_b16 v[42:43], v5 offset:41984
    s_waitcnt lgkmcnt(10)
    v_mfma_f32_16x16x32_bf16 v[128:131], v[48:51], v[168:171], v[128:131]
    ds_read_b64_tr_b16 v[44:45], v6 offset:40960
    s_cmp_lg_u32 s16, 3
    s_cbranch_scc1 a_nopub
    s_waitcnt vmcnt(0)
    s_atomic_add s40, s[22:23], s61
a_nopub:
    v_mfma_f32_16x16x32_bf16 v[132:135], v[48:51], v[172:175], v[132:135]
    ds_read_b64_tr_b16 v[46:47], v6 offset:41984
    v_mfma_f32_16x16x32_bf16 v[136:139], v[52:55], v[168:171], v[136:139]
    ds_read_b64_tr_b16 v[48:49], v3 offset:45056
    v_mfma_f32_16x16x32_bf16 v[140:143], v[52:55], v[172:175], v[140:143]
    ds_read_b64_tr_b16 v[50:51], v3 offset:46080
    s_waitcnt lgkmcnt(10)
    v_mfma_f32_16x16x32_bf16 v[144:147], v[56:59], v[168:171], v[144:147]
    ds_read_b64_tr_b16 v[52:53], v4 offset:45056
    v_mfma_f32_16x16x32_bf16 v[148:151], v[56:59], v[172:175], v[148:151]
    ds_read_b64_tr_b16 v[54:55], v4 offset:46080
    v_mfma_f32_16x16x32_bf16 v[152:155], v[60:63], v[168:171], v[152:155]
    ds_read_b64_tr_b16 v[56:57], v5 offset:45056
    v_mfma_f32_16x16x32_bf16 v[156:159], v[60:63], v[172:175], v[156:159]
    ds_read_b64_tr_b16 v[58:59], v5 offset:46080
    s_waitcnt lgkmcnt(10)
    v_mfma_f32_16x16x32_bf16 v[128:131], v[32:35], v[176:179], v[128:131]
    ds_read_b64_tr_b16 v[60:61], v6 offset:45056
    v_mfma_f32_16x16x32_bf16 v[132:135], v[32:35], v[180:183], v[132:135]
    ds_read_b64_tr_b16 v[62:63], v6 offset:46080
    v_mfma_f32_16x16x32_bf16 v[136:139], v[36:39], v[176:179], v[136:139]
    ds_read_b64_tr_b16 v[32:33], v3 offset:49152
    v_mfma_f32_16x16x32_bf16 v[140:143], v[36:39], v[180:183], v[140:143]
    ds_read_b64_tr_b16 v[34:35], v3 offset:50176
    s_waitcnt lgkmcnt(10)
    v_mfma_f32_16x16x32_bf16 v[144:147], v[40:43], v[176:179], v[144:147]
    ds_read_b64_tr_b16 v[36:37], v4 offset:49152
    v_mfma_f32_16x16x32_bf16 v[148:151], v[40:43], v[180:183], v[148:151]
    ds_read_b64_tr_b16 v[38:39], v4 offset:50176
    v_mfma_f32_16x16x32_bf16 v[152:155], v[44:47], v[176:179], v[152:155]
    ds_read_b64_tr_b16 v[40:41], v5 offset:49152
    v_mfma_f32_16x16x32_bf16 v[156:159], v[44:47], v[180:183], v[156:159]
    ds_read_b64_tr_b16 v[42:43], v5 offset:50176
    s_waitcnt lgkmcnt(10)
    v_mfma_f32_16x16x32_bf16 v[128:131], v[48:51], v[184:187], v[128:131]
    ds_read_b64_tr_b16 v[44:45], v6 offset:49152
    ds_read_b32 v8, v9 offset:4096
    v_mfma_f32_16x16x32_bf16 v[132:135], v[48:51], v[188:191], v[132:135]
    ds_read_b64_tr_b16 v[46:47], v6 offset:50176
    ds_read_b32 v10, v9 offset:4608
    v_mfma_f32_16x16x32_bf16 v[136:139], v[52:55], v[184:187], v[136:139]
    ds_read_b64_tr_b16 v[48:49], v3 offset:53248
    ds_read_b32 v12, v9 offset:4160
    v_mfma_f32_16x16x32_bf16 v[140:143], v[52:55], v[188:191], v[140:143]
    ds_read_b64_tr_b16 v[50:51], v3 offset:54272
    ds_read_b32 v14, v9 offset:4672
    s_waitcnt lgkmcnt(14)
    v_mfma_f32_16x16x32_bf16 v[144:147], v[56:59], v[184:187], v[144:147]
    ds_read_b64_tr_b16 v[52:53], v4 offset:53248
    ds_read_b128 v[16:19], v11 offset:0
    v_mfma_f32_16x16x32_bf16 v[148:151], v[56:59], v[188:191], v[148:151]
    ds_read_b64_tr_b16 v[54:55], v4 offset:54272
    ds_read_b128 v[20:23], v11 offset:64
    v_mfma_f32_16x16x32_bf16 v[152:155], v[60:63], v[184:187], v[152:155]
    ds_read_b64_tr_b16 v[56:57], v5 offset:53248
    ds_read_b128 v[24:27], v11 offset:128
    v_mfma_f32_16x16x32_bf16 v[156:159], v[60:63], v[188:191], v[156:159]
    ds_read_b64_tr_b16 v[58:59], v5 offset:54272
    ds_read_b128 v[28:31], v11 offset:192
    s_waitcnt lgkmcnt(15)
    v_mfma_f32_16x16x32_bf16 v[128:131], v[32:35], v[192:195], v[128:131]
    ds_read_b64_tr_b16 v[60:61], v6 offset:53248
    v_add_u32 v13, 153600, v1
    v_mfma_f32_16x16x32_bf16 v[132:135], v[32:35], v[196:199], v[132:135]
    ds_read_b64_tr_b16 v[62:63], v6 offset:54272
    v_mfma_f32_16x16x32_bf16 v[136:139], v[36:39], v[192:195], v[136:139]
    ds_read_b64_tr_b16 v[32:33], v3 offset:57344
    v_mfma_f32_16x16x32_bf16 v[140:143], v[36:39], v[196:199], v[140:143]
    ds_read_b64_tr_b16 v[34:35], v3 offset:58368
    s_waitcnt lgkmcnt(15)
    v_mfma_f32_16x16x32_bf16 v[144:147], v[40:43], v[192:195], v[144:147]
    ds_read_b64_tr_b16 v[36:37], v4 offset:57344
    v_mfma_f32_16x16x32_bf16 v[148:151], v[40:43], v[196:199], v[148:151]
    ds_read_b64_tr_b16 v[38:39], v4 offset:58368
    v_mfma_f32_16x16x32_bf16 v[152:155], v[44:47], v[192:195], v[152:155]
    ds_read_b64_tr_b16 v[40:41], v5 offset:57344
    v_mfma_f32_16x16x32_bf16 v[156:159], v[44:47], v[196:199], v[156:159]
    ds_read_b64_tr_b16 v[42:43], v5 offset:58368
    s_waitcnt lgkmcnt(13)
    v_mfma_f32_16x16x32_bf16 v[128:131], v[48:51], v[200:203], v[128:131]
    ds_read_b64_tr_b16 v[44:45], v6 offset:57344
    s_waitcnt lgkmcnt(9)
    v_mfma_f32_16x16x32_bf16 v[132:135], v[48:51], v[204:207], v[132:135]
    ds_read_b64_tr_b16 v[46:47], v6 offset:58368
    v_mul_f32 v10, 0x3e8293ee, v10
    v_mfma_f32_16x16x32_bf16 v[136:139], v[52:55], v[200:203], v[136:139]
    ds_read_b64_tr_b16 v[48:49], v3 offset:61440
    v_mul_f32 v14, 0x3e8293ee, v14
    v_mfma_f32_16x16x32_bf16 v[140:143], v[52:55], v[204:207], v[140:143]
    ds_read_b64_tr_b16 v[50:51], v3 offset:62464
    ds_read_b128 v[120:123], v13 offset:0
    s_waitcnt lgkmcnt(11)
    v_mfma_f32_16x16x32_bf16 v[144:147], v[56:59], v[200:203], v[144:147]
    ds_read_b64_tr_b16 v[52:53], v4 offset:61440
    ds_read_b128 v[124:127], v13 offset:1024
    v_mfma_f32_16x16x32_bf16 v[148:151], v[56:59], v[204:207], v[148:151]
    ds_read_b64_tr_b16 v[54:55], v4 offset:62464
    v_mfma_f32_16x16x32_bf16 v[152:155], v[60:63], v[200:203], v[152:155]
    ds_read_b64_tr_b16 v[56:57], v5 offset:61440
    v_mfma_f32_16x16x32_bf16 v[156:159], v[60:63], v[204:207], v[156:159]
    ds_read_b64_tr_b16 v[58:59], v5 offset:62464
    s_waitcnt lgkmcnt(12)
    v_mfma_f32_16x16x32_bf16 v[128:131], v[32:35], v[208:211], v[128:131]
    ds_read_b64_tr_b16 v[60:61], v6 offset:61440
    v_mfma_f32_16x16x32_bf16 v[132:135], v[32:35], v[212:215], v[132:135]
    ds_read_b64_tr_b16 v[62:63], v6 offset:62464
    v_xor_b32 v3, 0x10000, v3
    v_xor_b32 v4, 0x10000, v4
    v_xor_b32 v5, 0x10000, v5
    v_xor_b32 v6, 0x10000, v6
    v_mfma_f32_16x16x32_bf16 v[136:139], v[36:39], v[208:211], v[136:139]
    v_mfma_f32_16x16x32_bf16 v[140:143], v[36:39], v[212:215], v[140:143]
    s_waitcnt lgkmcnt(10)
    v_mfma_f32_16x16x32_bf16 v[144:147], v[40:43], v[208:211], v[144:147]
    v_mfma_f32_16x16x32_bf16 v[148:151], v[40:43], v[212:215], v[148:151]
    v_mfma_f32_16x16x32_bf16 v[152:155], v[44:47], v[208:211], v[152:155]
    v_mfma_f32_16x16x32_bf16 v[156:159], v[44:47], v[212:215], v[156:159]
    s_waitcnt lgkmcnt(4)
    v_mfma_f32_16x16x32_bf16 v[128:131], v[48:51], v[216:219], v[128:131]
    v_mfma_f32_16x16x32_bf16 v[132:135], v[48:51], v[220:223], v[132:135]
    v_mfma_f32_16x16x32_bf16 v[136:139], v[52:55], v[216:219], v[136:139]
    v_mfma_f32_16x16x32_bf16 v[140:143], v[52:55], v[220:223], v[140:143]
    s_waitcnt lgkmcnt(0)
    v_mfma_f32_16x16x32_bf16 v[144:147], v[56:59], v[216:219], v[144:147]
    v_mfma_f32_16x16x32_bf16 v[148:151], v[56:59], v[220:223], v[148:151]
    v_mfma_f32_16x16x32_bf16 v[152:155], v[60:63], v[216:219], v[152:155]
    v_mfma_f32_16x16x32_bf16 v[156:159], v[60:63], v[220:223], v[156:159]
    s_lshl_b32 s44, s21, 22
    s_lshl_b32 s45, s38, 16
    s_add_u32 s44, s44, s45
    s_lshl_b32 s45, s18, 12
    s_add_u32 s44, s44, s45
    s_add_u32 s52, s44, 16777216
    v_pk_fma_f32 v[132:133], v[12:13], v[16:17], v[132:133] op_sel_hi:[0,1,1] neg_lo:[1,0,0] neg_hi:[1,0,0]
    v_pk_fma_f32 v[134:135], v[12:13], v[18:19], v[134:135] op_sel_hi:[0,1,1] neg_lo:[1,0,0] neg_hi:[1,0,0]
    v_pk_fma_f32 v[140:141], v[12:13], v[20:21], v[140:141] op_sel_hi:[0,1,1] neg_lo:[1,0,0] neg_hi:[1,0,0]
    v_pk_fma_f32 v[142:143], v[12:13], v[22:23], v[142:143] op_sel_hi:[0,1,1] neg_lo:[1,0,0] neg_hi:[1,0,0]
    v_pk_fma_f32 v[148:149], v[12:13], v[24:25], v[148:149] op_sel_hi:[0,1,1] neg_lo:[1,0,0] neg_hi:[1,0,0]
    v_pk_fma_f32 v[150:151], v[12:13], v[26:27], v[150:151] op_sel_hi:[0,1,1] neg_lo:[1,0,0] neg_hi:[1,0,0]
    v_pk_fma_f32 v[156:157], v[12:13], v[28:29], v[156:157] op_sel_hi:[0,1,1] neg_lo:[1,0,0] neg_hi:[1,0,0]
    v_pk_fma_f32 v[158:159], v[12:13], v[30:31], v[158:159] op_sel_hi:[0,1,1] neg_lo:[1,0,0] neg_hi:[1,0,0]
    v_pk_mul_f32 v[132:133], v[14:15], v[132:133] op_sel_hi:[0,1]
    v_pk_mul_f32 v[134:135], v[14:15], v[134:135] op_sel_hi:[0,1]
    v_pk_mul_f32 v[140:141], v[14:15], v[140:141] op_sel_hi:[0,1]
    v_pk_mul_f32 v[142:143], v[14:15], v[142:143] op_sel_hi:[0,1]
    v_pk_mul_f32 v[148:149], v[14:15], v[148:149] op_sel_hi:[0,1]
    v_pk_mul_f32 v[150:151], v[14:15], v[150:151] op_sel_hi:[0,1]
    v_pk_mul_f32 v[156:157], v[14:15], v[156:157] op_sel_hi:[0,1]
    v_pk_mul_f32 v[158:159], v[14:15], v[158:159] op_sel_hi:[0,1]
    v_cvt_pk_bf16_f32 v132, v132, v133
    v_cvt_pk_bf16_f32 v133, v134, v135
    v_cvt_pk_bf16_f32 v134, v140, v141
    v_cvt_pk_bf16_f32 v135, v142, v143
    v_cvt_pk_bf16_f32 v148, v148, v149
    v_cvt_pk_bf16_f32 v149, v150, v151
    v_cvt_pk_bf16_f32 v150, v156, v157
    v_cvt_pk_bf16_f32 v151, v158, v159
    v_mfma_f32_16x16x32_bf16 v[172:175], v[68:71], v[132:135], v[120:123]
    v_mfma_f32_16x16x32_bf16 v[168:171], v[64:67], v[132:135], v[124:127]
    v_mfma_f32_16x16x32_bf16 v[188:191], v[84:87], v[148:151], v[120:123]
    v_mfma_f32_16x16x32_bf16 v[184:187], v[80:83], v[148:151], v[124:127]
    v_pk_fma_f32 v[128:129], v[8:9], v[16:17], v[128:129] op_sel_hi:[0,1,1] neg_lo:[1,0,0] neg_hi:[1,0,0]
    v_pk_fma_f32 v[130:131], v[8:9], v[18:19], v[130:131] op_sel_hi:[0,1,1] neg_lo:[1,0,0] neg_hi:[1,0,0]
    v_pk_fma_f32 v[136:137], v[8:9], v[20:21], v[136:137] op_sel_hi:[0,1,1] neg_lo:[1,0,0] neg_hi:[1,0,0]
    v_pk_fma_f32 v[138:139], v[8:9], v[22:23], v[138:139] op_sel_hi:[0,1,1] neg_lo:[1,0,0] neg_hi:[1,0,0]
    v_pk_fma_f32 v[144:145], v[8:9], v[24:25], v[144:145] op_sel_hi:[0,1,1] neg_lo:[1,0,0] neg_hi:[1,0,0]
    v_pk_fma_f32 v[146:147], v[8:9], v[26:27], v[146:147] op_sel_hi:[0,1,1] neg_lo:[1,0,0] neg_hi:[1,0,0]
    v_pk_fma_f32 v[152:153], v[8:9], v[28:29], v[152:153] op_sel_hi:[0,1,1] neg_lo:[1,0,0] neg_hi:[1,0,0]
    v_pk_fma_f32 v[154:155], v[8:9], v[30:31], v[154:155] op_sel_hi:[0,1,1] neg_lo:[1,0,0] neg_hi:[1,0,0]
    v_pk_mul_f32 v[128:129], v[10:11], v[128:129] op_sel_hi:[0,1]
    v_pk_mul_f32 v[130:131], v[10:11], v[130:131] op_sel_hi:[0,1]
    v_pk_mul_f32 v[136:137], v[10:11], v[136:137] op_sel_hi:[0,1]
    v_pk_mul_f32 v[138:139], v[10:11], v[138:139] op_sel_hi:[0,1]
    v_pk_mul_f32 v[144:145], v[10:11], v[144:145] op_sel_hi:[0,1]
    v_pk_mul_f32 v[146:147], v[10:11], v[146:147] op_sel_hi:[0,1]
    v_pk_mul_f32 v[152:153], v[10:11], v[152:153] op_sel_hi:[0,1]
    v_pk_mul_f32 v[154:155], v[10:11], v[154:155] op_sel_hi:[0,1]
    v_cvt_pk_bf16_f32 v128, v128, v129
    v_cvt_pk_bf16_f32 v129, v130, v131
    v_cvt_pk_bf16_f32 v130, v136, v137
    v_cvt_pk_bf16_f32 v131, v138, v139
    v_cvt_pk_bf16_f32 v144, v144, v145
    v_cvt_pk_bf16_f32 v145, v146, v147
    v_cvt_pk_bf16_f32 v146, v152, v153
    v_cvt_pk_bf16_f32 v147, v154, v155
    v_mfma_f32_16x16x32_bf16 v[164:167], v[64:67], v[128:131], v[120:123]
    s_nop 0
    v_mfma_f32_16x16x32_bf16 v[180:183], v[80:83], v[144:147], v[120:123]
    v_mov_b32 v232, 0x3f803f80
    v_mov_b32 v233, 0x3f803f80
    v_mov_b32 v234, 0x3f803f80
    v_mov_b32 v235, 0x3f803f80
    v_exp_f32 v172, v172
    v_exp_f32 v173, v173
    v_exp_f32 v174, v174
    v_exp_f32 v175, v175
    v_exp_f32 v188, v188
    v_exp_f32 v189, v189
    v_exp_f32 v190, v190
    v_exp_f32 v191, v191
    s_mov_b32 s46, 1006632960
a_exp1:
    v_exp_f32 v168, v168
    v_exp_f32 v169, v169
    v_exp_f32 v170, v170
    v_exp_f32 v171, v171
    v_exp_f32 v184, v184
    v_exp_f32 v185, v185
    v_exp_f32 v186, v186
    v_exp_f32 v187, v187
    v_cvt_pk_bf16_f32 v200, v168, v169
    v_cvt_pk_bf16_f32 v201, v170, v171
    v_cvt_pk_bf16_f32 v202, v172, v173
    v_cvt_pk_bf16_f32 v203, v174, v175
    v_cvt_pk_bf16_f32 v204, v184, v185
    v_cvt_pk_bf16_f32 v205, v186, v187
    v_cvt_pk_bf16_f32 v206, v188, v189
    v_cvt_pk_bf16_f32 v207, v190, v191
    v_mfma_f32_16x16x32_bf16 v[16:19], v[232:235], v[200:203], 0
    s_nop 0
    v_mfma_f32_16x16x32_bf16 v[20:23], v[232:235], v[204:207], 0
    v_mfma_f32_16x16x32_bf16 v[40:43], v[72:75], v[200:203], 0
    v_mfma_f32_16x16x32_bf16 v[44:47], v[76:79], v[200:203], 0
    v_mfma_f32_16x16x32_bf16 v[56:59], v[88:91], v[204:207], 0
    v_mfma_f32_16x16x32_bf16 v[60:63], v[92:95], v[204:207], 0
    v_mov_b32 v218, v72
    v_mov_b32 v219, v73
    v_mov_b32 v222, v76
    v_mov_b32 v223, v77
    v_mov_b32 v226, v88
    v_mov_b32 v227, v89
    v_mov_b32 v230, v92
    v_mov_b32 v231, v93
    v_subrev_u32 v18, 0x21800000, v16
    v_subrev_u32 v22, 0x21800000, v20
    v_max_u32 v18, v18, v22
    v_cmp_le_u32 vcc, s46, v18
    v_rcp_f32 v16, v16
    v_rcp_f32 v20, v20
    s_cbranch_vccnz a_slow1
a_fin1:
    v_pk_mul_f32 v[40:41], v[16:17], v[40:41] op_sel_hi:[0,1]
    v_pk_mul_f32 v[42:43], v[16:17], v[42:43] op_sel_hi:[0,1]
    v_pk_mul_f32 v[44:45], v[16:17], v[44:45] op_sel_hi:[0,1]
    v_pk_mul_f32 v[46:47], v[16:17], v[46:47] op_sel_hi:[0,1]
    v_pk_mul_f32 v[56:57], v[20:21], v[56:57] op_sel_hi:[0,1]
    v_pk_mul_f32 v[58:59], v[20:21], v[58:59] op_sel_hi:[0,1]
    v_pk_mul_f32 v[60:61], v[20:21], v[60:61] op_sel_hi:[0,1]
    v_pk_mul_f32 v[62:63], v[20:21], v[62:63] op_sel_hi:[0,1]
    v_cvt_pk_bf16_f32 v40, v40, v41
    v_cvt_pk_bf16_f32 v41, v42, v43
    v_cvt_pk_bf16_f32 v42, v44, v45
    v_cvt_pk_bf16_f32 v43, v46, v47
    v_cvt_pk_bf16_f32 v56, v56, v57
    v_cvt_pk_bf16_f32 v57, v58, v59
    v_cvt_pk_bf16_f32 v58, v60, v61
    v_cvt_pk_bf16_f32 v59, v62, v63
    v_permlane32_swap_b32 v40, v42
    v_permlane32_swap_b32 v41, v43
    buffer_store_dwordx4 v[40:43], v2, s[4:7], s52 offen offset:256 sc1
    v_permlane32_swap_b32 v56, v58
    v_permlane32_swap_b32 v57, v59
    buffer_store_dwordx4 v[56:59], v2, s[4:7], s52 offen offset:2304 sc1
    s_cmp_lg_u32 s38, 0
    s_cbranch_scc1 a_hasprev
    v_mov_b32 v124, 0xf149f2ca
    v_mov_b32 v125, 0xf149f2ca
    v_mov_b32 v126, 0xf149f2ca
    v_mov_b32 v127, 0xf149f2ca
a_hasprev:
    s_waitcnt lgkmcnt(0)
    s_barrier
    ds_read_b128 v[192:195], v7 offset:0
    ds_read_b128 v[196:199], v7 offset:1024
    ds_read_b64 v[216:217], v7 offset:2048
    ds_read_b64 v[220:221], v7 offset:2056
    ds_read_b64 v[224:225], v7 offset:3072
    ds_read_b64 v[228:229], v7 offset:3080
    s_waitcnt lgkmcnt(4)
    v_mfma_f32_16x16x32_bf16 v[160:163], v[192:195], v[128:131], v[124:127]
    v_mfma_f32_16x16x32_bf16 v[176:179], v[196:199], v[144:147], v[124:127]
    v_exp_f32 v164, v164
    v_exp_f32 v165, v165
    v_exp_f32 v166, v166
    v_exp_f32 v167, v167
    v_exp_f32 v180, v180
    v_exp_f32 v181, v181
    v_exp_f32 v182, v182
    v_exp_f32 v183, v183
    s_waitcnt lgkmcnt(0)
    s_mov_b32 s46, 1006632960
a_exp0:
    v_exp_f32 v160, v160
    v_exp_f32 v161, v161
    v_exp_f32 v162, v162
    v_exp_f32 v163, v163
    v_exp_f32 v176, v176
    v_exp_f32 v177, v177
    v_exp_f32 v178, v178
    v_exp_f32 v179, v179
    v_cvt_pk_bf16_f32 v200, v160, v161
    v_cvt_pk_bf16_f32 v201, v162, v163
    v_cvt_pk_bf16_f32 v202, v164, v165
    v_cvt_pk_bf16_f32 v203, v166, v167
    v_cvt_pk_bf16_f32 v204, v176, v177
    v_cvt_pk_bf16_f32 v205, v178, v179
    v_cvt_pk_bf16_f32 v206, v180, v181
    v_cvt_pk_bf16_f32 v207, v182, v183
    v_mfma_f32_16x16x32_bf16 v[16:19], v[232:235], v[200:203], 0
    s_nop 0
    v_mfma_f32_16x16x32_bf16 v[20:23], v[232:235], v[204:207], 0
    v_mfma_f32_16x16x32_bf16 v[32:35], v[216:219], v[200:203], 0
    v_mfma_f32_16x16x32_bf16 v[36:39], v[220:223], v[200:203], 0
    v_mfma_f32_16x16x32_bf16 v[48:51], v[224:227], v[204:207], 0
    v_mfma_f32_16x16x32_bf16 v[52:55], v[228:231], v[204:207], 0
    s_nop 1
    v_subrev_u32 v18, 0x21800000, v16
    s_nop 0
    v_subrev_u32 v22, 0x21800000, v20
    v_max_u32 v18, v18, v22
    v_cmp_le_u32 vcc, s46, v18
    v_rcp_f32 v16, v16
    v_rcp_f32 v20, v20
    s_cbranch_vccnz a_slow0
a_fin0:
    v_pk_mul_f32 v[32:33], v[16:17], v[32:33] op_sel_hi:[0,1]
    v_pk_mul_f32 v[34:35], v[16:17], v[34:35] op_sel_hi:[0,1]
    v_pk_mul_f32 v[36:37], v[16:17], v[36:37] op_sel_hi:[0,1]
    v_pk_mul_f32 v[38:39], v[16:17], v[38:39] op_sel_hi:[0,1]
    v_pk_mul_f32 v[48:49], v[20:21], v[48:49] op_sel_hi:[0,1]
    v_pk_mul_f32 v[50:51], v[20:21], v[50:51] op_sel_hi:[0,1]
    v_pk_mul_f32 v[52:53], v[20:21], v[52:53] op_sel_hi:[0,1]
    v_pk_mul_f32 v[54:55], v[20:21], v[54:55] op_sel_hi:[0,1]
    v_cvt_pk_bf16_f32 v32, v32, v33
    v_cvt_pk_bf16_f32 v33, v34, v35
    v_cvt_pk_bf16_f32 v34, v36, v37
    v_cvt_pk_bf16_f32 v35, v38, v39
    v_cvt_pk_bf16_f32 v48, v48, v49
    v_cvt_pk_bf16_f32 v49, v50, v51
    v_cvt_pk_bf16_f32 v50, v52, v53
    v_cvt_pk_bf16_f32 v51, v54, v55
    v_permlane32_swap_b32 v32, v34
    v_permlane32_swap_b32 v33, v35
    buffer_store_dwordx4 v[32:35], v2, s[4:7], s52 offen offset:0 sc1
    v_permlane32_swap_b32 v48, v50
    v_permlane32_swap_b32 v49, v51
    buffer_store_dwordx4 v[48:51], v2, s[4:7], s52 offen offset:2048 sc1
    s_lshl_b32 s44, s21, 22
    s_lshl_b32 s45, s39, 16
    s_add_u32 s41, s44, s45
    s_lshl_b32 s45, s20, 12
    s_add_u32 s43, s41, s45
    s_and_b32 s45, s45, 0
    s_add_u32 s41, s41, s45
    s_add_u32 s41, s41, 16777216
    buffer_load_dwordx4 v[224:227], v2, s[4:7], s43 offen offset:0 sc1
    buffer_load_dwordx4 v[228:231], v2, s[4:7], s43 offen offset:256 sc1
    buffer_load_dwordx4 v[232:235], v2, s[4:7], s43 offen offset:2048 sc1
    buffer_load_dwordx4 v[236:239], v2, s[4:7], s43 offen offset:2304 sc1
    s_barrier
    s_lshl_b32 s46, s21, 14
    s_lshl_b32 s67, s38, 8
    s_add_u32 s46, s46, s67
    s_add_u32 s46, s46, 86144
    s_lshl_b32 s47, s21, 14
    s_lshl_b32 s67, s39, 8
    s_add_u32 s47, s47, s67
    s_add_u32 s47, s47, 86144
    s_waitcnt vmcnt(4)
    s_atomic_add s40, s[22:23], s46
    s_mov_b32 s66, 0x10000
c_o_poll:
    s_mov_b32 s68, 0
    s_atomic_add s68, s[22:23], s47 offset:0 glc
    s_sub_u32 s66, s66, 1
    s_cselect_b32 s67, 16, 0
    s_waitcnt lgkmcnt(0)
    s_max_u32 s68, s68, s67
    s_cmp_lt_u32 s68, 16
    s_cbranch_scc1 c_o_poll
c_o_ok:
    s_branch c_wo
a_slow1:
    s_cmp_eq_u32 s46, 0
    s_cbranch_scc1 a_fin1
    s_mov_b32 s46, 0
    v_mfma_f32_16x16x32_bf16 v[172:175], v[68:71], v[132:135], v[120:123]
    v_mfma_f32_16x16x32_bf16 v[168:171], v[64:67], v[132:135], v[124:127]
    v_mfma_f32_16x16x32_bf16 v[188:191], v[84:87], v[148:151], v[120:123]
    v_mfma_f32_16x16x32_bf16 v[184:187], v[80:83], v[148:151], v[124:127]
    s_nop 5
    v_max3_f32 v24, v168, v169, v170
    v_max3_f32 v24, v24, v171, v172
    v_max3_f32 v24, v24, v173, v174
    v_max_f32 v24, v24, v175
    v_max3_f32 v26, v184, v185, v186
    v_max3_f32 v26, v26, v187, v188
    v_max3_f32 v26, v26, v189, v190
    v_max_f32 v26, v26, v191
    v_mov_b32 v25, v24
    v_mov_b32 v27, v26
    s_nop 0
    v_permlane32_swap_b32 v24, v25
    v_permlane32_swap_b32 v26, v27
    v_max_f32 v24, v24, v25
    v_max_f32 v26, v26, v27
    v_mov_b32 v25, v24
    v_mov_b32 v27, v26
    s_nop 0
    v_permlane16_swap_b32 v24, v25
    v_permlane16_swap_b32 v26, v27
    v_max_f32 v24, v24, v25
    v_max_f32 v26, v26, v27
    v_sub_f32 v168, v168, v24
    v_sub_f32 v169, v169, v24
    v_sub_f32 v170, v170, v24
    v_sub_f32 v171, v171, v24
    v_sub_f32 v172, v172, v24
    v_sub_f32 v173, v173, v24
    v_sub_f32 v174, v174, v24
    v_sub_f32 v175, v175, v24
    v_sub_f32 v184, v184, v26
    v_sub_f32 v185, v185, v26
    v_sub_f32 v186, v186, v26
    v_sub_f32 v187, v187, v26
    v_sub_f32 v188, v188, v26
    v_sub_f32 v189, v189, v26
    v_sub_f32 v190, v190, v26
    v_sub_f32 v191, v191, v26
    v_exp_f32 v172, v172
    v_exp_f32 v173, v173
    v_exp_f32 v174, v174
    v_exp_f32 v175, v175
    v_exp_f32 v188, v188
    v_exp_f32 v189, v189
    v_exp_f32 v190, v190
    v_exp_f32 v191, v191
    s_branch a_exp1
a_slow0:
    s_cmp_eq_u32 s46, 0
    s_cbranch_scc1 a_fin0
    s_mov_b32 s46, 0
    v_mfma_f32_16x16x32_bf16 v[164:167], v[64:67], v[128:131], v[120:123]
    v_mfma_f32_16x16x32_bf16 v[160:163], v[192:195], v[128:131], v[124:127]
    v_mfma_f32_16x16x32_bf16 v[180:183], v[80:83], v[144:147], v[120:123]
    v_mfma_f32_16x16x32_bf16 v[176:179], v[196:199], v[144:147], v[124:127]
    s_nop 5
    v_max3_f32 v24, v160, v161, v162
    v_max3_f32 v24, v24, v163, v164
    v_max3_f32 v24, v24, v165, v166
    v_max_f32 v24, v24, v167
    v_max3_f32 v26, v176, v177, v178
    v_max3_f32 v26, v26, v179, v180
    v_max3_f32 v26, v26, v181, v182
    v_max_f32 v26, v26, v183
    v_mov_b32 v25, v24
    v_mov_b32 v27, v26
    s_nop 0
    v_permlane32_swap_b32 v24, v25
    v_permlane32_swap_b32 v26, v27
    v_max_f32 v24, v24, v25
    v_max_f32 v26, v26, v27
    v_mov_b32 v25, v24
    v_mov_b32 v27, v26
    s_nop 0
    v_permlane16_swap_b32 v24, v25
    v_permlane16_swap_b32 v26, v27
    v_max_f32 v24, v24, v25
    v_max_f32 v26, v26, v27
    v_sub_f32 v160, v160, v24
    v_sub_f32 v161, v161, v24
    v_sub_f32 v162, v162, v24
    v_sub_f32 v163, v163, v24
    v_sub_f32 v164, v164, v24
    v_sub_f32 v165, v165, v24
    v_sub_f32 v166, v166, v24
    v_sub_f32 v167, v167, v24
    v_sub_f32 v176, v176, v26
    v_sub_f32 v177, v177, v26
    v_sub_f32 v178, v178, v26
    v_sub_f32 v179, v179, v26
    v_sub_f32 v180, v180, v26
    v_sub_f32 v181, v181, v26
    v_sub_f32 v182, v182, v26
    v_sub_f32 v183, v183, v26
    v_exp_f32 v164, v164
    v_exp_f32 v165, v165
    v_exp_f32 v166, v166
    v_exp_f32 v167, v167
    v_exp_f32 v180, v180
    v_exp_f32 v181, v181
    v_exp_f32 v182, v182
    v_exp_f32 v183, v183
    s_branch a_exp0
c_B:
    s_waitcnt lgkmcnt(6)
    v_pk_fma_f32 v[64:65], v[8:9], v[16:17], v[64:65] op_sel_hi:[0,1,1] neg_lo:[1,0,0] neg_hi:[1,0,0]
    v_pk_fma_f32 v[66:67], v[8:9], v[18:19], v[66:67] op_sel_hi:[0,1,1] neg_lo:[1,0,0] neg_hi:[1,0,0]
    v_pk_fma_f32 v[72:73], v[8:9], v[20:21], v[72:73] op_sel_hi:[0,1,1] neg_lo:[1,0,0] neg_hi:[1,0,0]
    v_pk_fma_f32 v[74:75], v[8:9], v[22:23], v[74:75] op_sel_hi:[0,1,1] neg_lo:[1,0,0] neg_hi:[1,0,0]
    v_pk_mul_f32 v[64:65], v[10:11], v[64:65] op_sel_hi:[0,1]
    v_pk_mul_f32 v[66:67], v[10:11], v[66:67] op_sel_hi:[0,1]
    v_pk_mul_f32 v[72:73], v[10:11], v[72:73] op_sel_hi:[0,1]
    v_pk_mul_f32 v[74:75], v[10:11], v[74:75] op_sel_hi:[0,1]
    v_cvt_pk_bf16_f32 v64, v64, v65
    v_cvt_pk_bf16_f32 v65, v66, v67
    v_cvt_pk_bf16_f32 v66, v72, v73
    v_cvt_pk_bf16_f32 v67, v74, v75
    s_add_u32 s55, s52, 0
    buffer_store_dwordx4 v[64:67], v2, s[4:7], s55 offen offset:0 sc1
    v_pk_fma_f32 v[68:69], v[12:13], v[16:17], v[68:69] op_sel_hi:[0,1,1] neg_lo:[1,0,0] neg_hi:[1,0,0]
    v_pk_fma_f32 v[70:71], v[12:13], v[18:19], v[70:71] op_sel_hi:[0,1,1] neg_lo:[1,0,0] neg_hi:[1,0,0]
    v_pk_fma_f32 v[76:77], v[12:13], v[20:21], v[76:77] op_sel_hi:[0,1,1] neg_lo:[1,0,0] neg_hi:[1,0,0]
    v_pk_fma_f32 v[78:79], v[12:13], v[22:23], v[78:79] op_sel_hi:[0,1,1] neg_lo:[1,0,0] neg_hi:[1,0,0]
    v_pk_mul_f32 v[68:69], v[14:15], v[68:69] op_sel_hi:[0,1]
    v_pk_mul_f32 v[70:71], v[14:15], v[70:71] op_sel_hi:[0,1]
    v_pk_mul_f32 v[76:77], v[14:15], v[76:77] op_sel_hi:[0,1]
    v_pk_mul_f32 v[78:79], v[14:15], v[78:79] op_sel_hi:[0,1]
    ds_read_b128 v[16:19], v13 offset:4096
    ds_read_b128 v[20:23], v13 offset:4608
    v_cvt_pk_bf16_f32 v68, v68, v69
    v_cvt_pk_bf16_f32 v69, v70, v71
    v_cvt_pk_bf16_f32 v70, v76, v77
    v_cvt_pk_bf16_f32 v71, v78, v79
    buffer_store_dwordx4 v[68:71], v2, s[4:7], s55 offen offset:256 sc1
    v_pk_fma_f32 v[80:81], v[8:9], v[24:25], v[80:81] op_sel_hi:[0,1,1] neg_lo:[1,0,0] neg_hi:[1,0,0]
    v_pk_fma_f32 v[82:83], v[8:9], v[26:27], v[82:83] op_sel_hi:[0,1,1] neg_lo:[1,0,0] neg_hi:[1,0,0]
    v_pk_fma_f32 v[88:89], v[8:9], v[28:29], v[88:89] op_sel_hi:[0,1,1] neg_lo:[1,0,0] neg_hi:[1,0,0]
    v_pk_fma_f32 v[90:91], v[8:9], v[30:31], v[90:91] op_sel_hi:[0,1,1] neg_lo:[1,0,0] neg_hi:[1,0,0]
    v_pk_mul_f32 v[80:81], v[10:11], v[80:81] op_sel_hi:[0,1]
    v_pk_mul_f32 v[82:83], v[10:11], v[82:83] op_sel_hi:[0,1]
    v_pk_mul_f32 v[88:89], v[10:11], v[88:89] op_sel_hi:[0,1]
    v_pk_mul_f32 v[90:91], v[10:11], v[90:91] op_sel_hi:[0,1]
    ds_read_b32 v8, v15 offset:512
    ds_read_b32 v10, v15 offset:576
    v_cvt_pk_bf16_f32 v80, v80, v81
    v_cvt_pk_bf16_f32 v81, v82, v83
    v_cvt_pk_bf16_f32 v82, v88, v89
    v_cvt_pk_bf16_f32 v83, v90, v91
    s_add_u32 s55, s52, 131072
    buffer_store_dwordx4 v[80:83], v2, s[4:7], s55 offen offset:0 sc1
    v_pk_fma_f32 v[84:85], v[12:13], v[24:25], v[84:85] op_sel_hi:[0,1,1] neg_lo:[1,0,0] neg_hi:[1,0,0]
    v_pk_fma_f32 v[86:87], v[12:13], v[26:27], v[86:87] op_sel_hi:[0,1,1] neg_lo:[1,0,0] neg_hi:[1,0,0]
    v_pk_fma_f32 v[92:93], v[12:13], v[28:29], v[92:93] op_sel_hi:[0,1,1] neg_lo:[1,0,0] neg_hi:[1,0,0]
    v_pk_fma_f32 v[94:95], v[12:13], v[30:31], v[94:95] op_sel_hi:[0,1,1] neg_lo:[1,0,0] neg_hi:[1,0,0]
    v_pk_mul_f32 v[84:85], v[14:15], v[84:85] op_sel_hi:[0,1]
    v_pk_mul_f32 v[86:87], v[14:15], v[86:87] op_sel_hi:[0,1]
    v_pk_mul_f32 v[92:93], v[14:15], v[92:93] op_sel_hi:[0,1]
    v_pk_mul_f32 v[94:95], v[14:15], v[94:95] op_sel_hi:[0,1]
    ds_read_b128 v[24:27], v13 offset:4160
    ds_read_b128 v[28:31], v13 offset:4672
    ds_read_b32 v12, v15 offset:640
    ds_read_b32 v14, v15 offset:704
    v_cvt_pk_bf16_f32 v84, v84, v85
    v_cvt_pk_bf16_f32 v85, v86, v87
    v_cvt_pk_bf16_f32 v86, v92, v93
    v_cvt_pk_bf16_f32 v87, v94, v95
    buffer_store_dwordx4 v[84:87], v2, s[4:7], s55 offen offset:256 sc1
    s_waitcnt lgkmcnt(4)
    v_pk_fma_f32 v[96:97], v[8:9], v[16:17], v[96:97] op_sel_hi:[0,1,1] neg_lo:[1,0,0] neg_hi:[1,0,0]
    v_pk_fma_f32 v[98:99], v[8:9], v[18:19], v[98:99] op_sel_hi:[0,1,1] neg_lo:[1,0,0] neg_hi:[1,0,0]
    v_pk_fma_f32 v[104:105], v[10:11], v[16:17], v[104:105] op_sel_hi:[0,1,1] neg_lo:[1,0,0] neg_hi:[1,0,0]
    v_pk_fma_f32 v[106:107], v[10:11], v[18:19], v[106:107] op_sel_hi:[0,1,1] neg_lo:[1,0,0] neg_hi:[1,0,0]
    v_pk_mul_f32 v[96:97], v[20:21], v[96:97]
    v_pk_mul_f32 v[98:99], v[22:23], v[98:99]
    v_pk_mul_f32 v[104:105], v[20:21], v[104:105]
    v_pk_mul_f32 v[106:107], v[22:23], v[106:107]
    v_cvt_pk_bf16_f32 v72, v96, v97
    v_cvt_pk_bf16_f32 v73, v98, v99
    v_cvt_pk_bf16_f32 v74, v104, v105
    v_cvt_pk_bf16_f32 v75, v106, v107
    s_add_u32 s56, s52, 4194304
    v_permlane16_swap_b32 v72, v74
    v_permlane16_swap_b32 v73, v75
    buffer_store_dwordx4 v[72:75], v1, s[4:7], s56 offen offset:0 sc1
    s_waitcnt lgkmcnt(0)
    v_pk_fma_f32 v[112:113], v[12:13], v[16:17], v[112:113] op_sel_hi:[0,1,1] neg_lo:[1,0,0] neg_hi:[1,0,0]
    v_pk_fma_f32 v[114:115], v[12:13], v[18:19], v[114:115] op_sel_hi:[0,1,1] neg_lo:[1,0,0] neg_hi:[1,0,0]
    v_pk_fma_f32 v[120:121], v[14:15], v[16:17], v[120:121] op_sel_hi:[0,1,1] neg_lo:[1,0,0] neg_hi:[1,0,0]
    v_pk_fma_f32 v[122:123], v[14:15], v[18:19], v[122:123] op_sel_hi:[0,1,1] neg_lo:[1,0,0] neg_hi:[1,0,0]
    v_pk_mul_f32 v[112:113], v[20:21], v[112:113]
    v_pk_mul_f32 v[114:115], v[22:23], v[114:115]
    v_pk_mul_f32 v[120:121], v[20:21], v[120:121]
    v_pk_mul_f32 v[122:123], v[22:23], v[122:123]
    v_cvt_pk_bf16_f32 v88, v112, v113
    v_cvt_pk_bf16_f32 v89, v114, v115
    v_cvt_pk_bf16_f32 v90, v120, v121
    v_cvt_pk_bf16_f32 v91, v122, v123
    s_add_u32 s56, s52, 4325376
    v_permlane16_swap_b32 v88, v90
    v_permlane16_swap_b32 v89, v91
    buffer_store_dwordx4 v[88:91], v1, s[4:7], s56 offen offset:0 sc1
    v_pk_fma_f32 v[100:101], v[8:9], v[24:25], v[100:101] op_sel_hi:[0,1,1] neg_lo:[1,0,0] neg_hi:[1,0,0]
    v_pk_fma_f32 v[102:103], v[8:9], v[26:27], v[102:103] op_sel_hi:[0,1,1] neg_lo:[1,0,0] neg_hi:[1,0,0]
    v_pk_fma_f32 v[108:109], v[10:11], v[24:25], v[108:109] op_sel_hi:[0,1,1] neg_lo:[1,0,0] neg_hi:[1,0,0]
    v_pk_fma_f32 v[110:111], v[10:11], v[26:27], v[110:111] op_sel_hi:[0,1,1] neg_lo:[1,0,0] neg_hi:[1,0,0]
    v_pk_mul_f32 v[100:101], v[28:29], v[100:101]
    v_pk_mul_f32 v[102:103], v[30:31], v[102:103]
    v_pk_mul_f32 v[108:109], v[28:29], v[108:109]
    v_pk_mul_f32 v[110:111], v[30:31], v[110:111]
    v_cvt_pk_bf16_f32 v76, v100, v101
    v_cvt_pk_bf16_f32 v77, v102, v103
    v_cvt_pk_bf16_f32 v78, v108, v109
    v_cvt_pk_bf16_f32 v79, v110, v111
    s_add_u32 s56, s52, 4194304
    v_permlane16_swap_b32 v76, v78
    v_permlane16_swap_b32 v77, v79
    buffer_store_dwordx4 v[76:79], v1, s[4:7], s56 offen offset:1024 sc1
    v_pk_fma_f32 v[116:117], v[12:13], v[24:25], v[116:117] op_sel_hi:[0,1,1] neg_lo:[1,0,0] neg_hi:[1,0,0]
    v_pk_fma_f32 v[118:119], v[12:13], v[26:27], v[118:119] op_sel_hi:[0,1,1] neg_lo:[1,0,0] neg_hi:[1,0,0]
    v_pk_fma_f32 v[124:125], v[14:15], v[24:25], v[124:125] op_sel_hi:[0,1,1] neg_lo:[1,0,0] neg_hi:[1,0,0]
    v_pk_fma_f32 v[126:127], v[14:15], v[26:27], v[126:127] op_sel_hi:[0,1,1] neg_lo:[1,0,0] neg_hi:[1,0,0]
    v_pk_mul_f32 v[116:117], v[28:29], v[116:117]
    v_pk_mul_f32 v[118:119], v[30:31], v[118:119]
    v_pk_mul_f32 v[124:125], v[28:29], v[124:125]
    v_pk_mul_f32 v[126:127], v[30:31], v[126:127]
    v_cvt_pk_bf16_f32 v92, v116, v117
    v_cvt_pk_bf16_f32 v93, v118, v119
    v_cvt_pk_bf16_f32 v94, v124, v125
    v_cvt_pk_bf16_f32 v95, v126, v127
    s_add_u32 s56, s52, 4325376
    v_permlane16_swap_b32 v92, v94
    v_permlane16_swap_b32 v93, v95
    buffer_store_dwordx4 v[92:95], v1, s[4:7], s56 offen offset:1024 sc1
    v_mfma_f32_16x16x32_bf16 v[128:131], v[32:35], v[224:227], v[128:131]
    ds_read_b64_tr_b16 v[60:61], v6 offset:20480
    v_mfma_f32_16x16x32_bf16 v[132:135], v[32:35], v[228:231], v[132:135]
    ds_read_b64_tr_b16 v[62:63], v6 offset:21504
    v_mfma_f32_16x16x32_bf16 v[136:139], v[36:39], v[224:227], v[136:139]
    ds_read_b64_tr_b16 v[32:33], v3 offset:24576
    v_mfma_f32_16x16x32_bf16 v[140:143], v[36:39], v[228:231], v[140:143]
    ds_read_b64_tr_b16 v[34:35], v3 offset:25600
    v_mfma_f32_16x16x32_bf16 v[144:147], v[40:43], v[224:227], v[144:147]
    ds_read_b64_tr_b16 v[36:37], v4 offset:24576
    v_mfma_f32_16x16x32_bf16 v[148:151], v[40:43], v[228:231], v[148:151]
    ds_read_b64_tr_b16 v[38:39], v4 offset:25600
    v_mfma_f32_16x16x32_bf16 v[152:155], v[44:47], v[224:227], v[152:155]
    ds_read_b64_tr_b16 v[40:41], v5 offset:24576
    v_mfma_f32_16x16x32_bf16 v[156:159], v[44:47], v[228:231], v[156:159]
    ds_read_b64_tr_b16 v[42:43], v5 offset:25600
    v_mfma_f32_16x16x32_bf16 v[128:131], v[48:51], v[232:235], v[128:131]
    ds_read_b64_tr_b16 v[44:45], v6 offset:24576
    v_mfma_f32_16x16x32_bf16 v[132:135], v[48:51], v[236:239], v[132:135]
    ds_read_b64_tr_b16 v[46:47], v6 offset:25600
    v_mfma_f32_16x16x32_bf16 v[136:139], v[52:55], v[232:235], v[136:139]
    ds_read_b64_tr_b16 v[48:49], v3 offset:28672
    v_mfma_f32_16x16x32_bf16 v[140:143], v[52:55], v[236:239], v[140:143]
    ds_read_b64_tr_b16 v[50:51], v3 offset:29696
    s_waitcnt lgkmcnt(10)
    v_mfma_f32_16x16x32_bf16 v[144:147], v[56:59], v[232:235], v[144:147]
    ds_read_b64_tr_b16 v[52:53], v4 offset:28672
    v_mfma_f32_16x16x32_bf16 v[148:151], v[56:59], v[236:239], v[148:151]
    ds_read_b64_tr_b16 v[54:55], v4 offset:29696
    v_mfma_f32_16x16x32_bf16 v[152:155], v[60:63], v[232:235], v[152:155]
    ds_read_b64_tr_b16 v[56:57], v5 offset:28672
    v_mfma_f32_16x16x32_bf16 v[156:159], v[60:63], v[236:239], v[156:159]
    ds_read_b64_tr_b16 v[58:59], v5 offset:29696
    s_waitcnt lgkmcnt(10)
    v_mfma_f32_16x16x32_bf16 v[128:131], v[32:35], v[240:243], v[128:131]
    ds_read_b64_tr_b16 v[60:61], v6 offset:28672
    v_mfma_f32_16x16x32_bf16 v[132:135], v[32:35], v[244:247], v[132:135]
    ds_read_b64_tr_b16 v[62:63], v6 offset:29696
    s_barrier
    v_mfma_f32_16x16x32_bf16 v[136:139], v[36:39], v[240:243], v[136:139]
    ds_read_b64_tr_b16 v[32:33], v3 offset:32768
    v_mfma_f32_16x16x32_bf16 v[140:143], v[36:39], v[244:247], v[140:143]
    ds_read_b64_tr_b16 v[34:35], v3 offset:33792
    s_waitcnt lgkmcnt(10)
    v_mfma_f32_16x16x32_bf16 v[144:147], v[40:43], v[240:243], v[144:147]
    ds_read_b64_tr_b16 v[36:37], v4 offset:32768
    v_mfma_f32_16x16x32_bf16 v[148:151], v[40:43], v[244:247], v[148:151]
    ds_read_b64_tr_b16 v[38:39], v4 offset:33792
    v_mfma_f32_16x16x32_bf16 v[152:155], v[44:47], v[240:243], v[152:155]
    ds_read_b64_tr_b16 v[40:41], v5 offset:32768
    v_mfma_f32_16x16x32_bf16 v[156:159], v[44:47], v[244:247], v[156:159]
    ds_read_b64_tr_b16 v[42:43], v5 offset:33792
    s_waitcnt lgkmcnt(10)
    v_mfma_f32_16x16x32_bf16 v[128:131], v[48:51], v[248:251], v[128:131]
    ds_read_b64_tr_b16 v[44:45], v6 offset:32768
    v_mfma_f32_16x16x32_bf16 v[132:135], v[48:51], v[252:255], v[132:135]
    ds_read_b64_tr_b16 v[46:47], v6 offset:33792
    v_mfma_f32_16x16x32_bf16 v[136:139], v[52:55], v[248:251], v[136:139]
    ds_read_b64_tr_b16 v[48:49], v3 offset:36864
    v_mfma_f32_16x16x32_bf16 v[140:143], v[52:55], v[252:255], v[140:143]
    ds_read_b64_tr_b16 v[50:51], v3 offset:37888
    s_waitcnt lgkmcnt(10)
    v_mfma_f32_16x16x32_bf16 v[144:147], v[56:59], v[248:251], v[144:147]
    ds_read_b64_tr_b16 v[52:53], v4 offset:36864
    v_mfma_f32_16x16x32_bf16 v[148:151], v[56:59], v[252:255], v[148:151]
    ds_read_b64_tr_b16 v[54:55], v4 offset:37888
    v_mfma_f32_16x16x32_bf16 v[152:155], v[60:63], v[248:251], v[152:155]
    ds_read_b64_tr_b16 v[56:57], v5 offset:36864
    v_mfma_f32_16x16x32_bf16 v[156:159], v[60:63], v[252:255], v[156:159]
    ds_read_b64_tr_b16 v[58:59], v5 offset:37888
    s_waitcnt lgkmcnt(10)
    v_mfma_f32_16x16x32_bf16 v[128:131], v[32:35], v[160:163], v[128:131]
    ds_read_b64_tr_b16 v[60:61], v6 offset:36864
    v_mfma_f32_16x16x32_bf16 v[132:135], v[32:35], v[164:167], v[132:135]
    ds_read_b64_tr_b16 v[62:63], v6 offset:37888
    v_mfma_f32_16x16x32_bf16 v[136:139], v[36:39], v[160:163], v[136:139]
    ds_read_b64_tr_b16 v[32:33], v3 offset:40960
    v_mfma_f32_16x16x32_bf16 v[140:143], v[36:39], v[164:167], v[140:143]
    ds_read_b64_tr_b16 v[34:35], v3 offset:41984
    s_waitcnt lgkmcnt(10)
    v_mfma_f32_16x16x32_bf16 v[144:147], v[40:43], v[160:163], v[144:147]
    ds_read_b64_tr_b16 v[36:37], v4 offset:40960
    v_mfma_f32_16x16x32_bf16 v[148:151], v[40:43], v[164:167], v[148:151]
    ds_read_b64_tr_b16 v[38:39], v4 offset:41984
    v_mfma_f32_16x16x32_bf16 v[152:155], v[44:47], v[160:163], v[152:155]
    ds_read_b64_tr_b16 v[40:41], v5 offset:40960
    v_mfma_f32_16x16x32_bf16 v[156:159], v[44:47], v[164:167], v[156:159]
    ds_read_b64_tr_b16 v[42:43], v5 offset:41984
    s_waitcnt lgkmcnt(10)
    v_mfma_f32_16x16x32_bf16 v[128:131], v[48:51], v[168:171], v[128:131]
    ds_read_b64_tr_b16 v[44:45], v6 offset:40960
    v_mfma_f32_16x16x32_bf16 v[132:135], v[48:51], v[172:175], v[132:135]
    ds_read_b64_tr_b16 v[46:47], v6 offset:41984
    v_mfma_f32_16x16x32_bf16 v[136:139], v[52:55], v[168:171], v[136:139]
    ds_read_b64_tr_b16 v[48:49], v3 offset:45056
    v_mfma_f32_16x16x32_bf16 v[140:143], v[52:55], v[172:175], v[140:143]
    ds_read_b64_tr_b16 v[50:51], v3 offset:46080
    s_waitcnt lgkmcnt(10)
    v_mfma_f32_16x16x32_bf16 v[144:147], v[56:59], v[168:171], v[144:147]
    ds_read_b64_tr_b16 v[52:53], v4 offset:45056
    v_mfma_f32_16x16x32_bf16 v[148:151], v[56:59], v[172:175], v[148:151]
    ds_read_b64_tr_b16 v[54:55], v4 offset:46080
    v_mfma_f32_16x16x32_bf16 v[152:155], v[60:63], v[168:171], v[152:155]
    ds_read_b64_tr_b16 v[56:57], v5 offset:45056
    v_mfma_f32_16x16x32_bf16 v[156:159], v[60:63], v[172:175], v[156:159]
    ds_read_b64_tr_b16 v[58:59], v5 offset:46080
    s_waitcnt lgkmcnt(10)
    v_mfma_f32_16x16x32_bf16 v[128:131], v[32:35], v[176:179], v[128:131]
    ds_read_b64_tr_b16 v[60:61], v6 offset:45056
    v_mfma_f32_16x16x32_bf16 v[132:135], v[32:35], v[180:183], v[132:135]
    ds_read_b64_tr_b16 v[62:63], v6 offset:46080
    v_mfma_f32_16x16x32_bf16 v[136:139], v[36:39], v[176:179], v[136:139]
    ds_read_b64_tr_b16 v[32:33], v3 offset:49152
    v_mfma_f32_16x16x32_bf16 v[140:143], v[36:39], v[180:183], v[140:143]
    ds_read_b64_tr_b16 v[34:35], v3 offset:50176
    s_waitcnt lgkmcnt(10)
    v_mfma_f32_16x16x32_bf16 v[144:147], v[40:43], v[176:179], v[144:147]
    ds_read_b64_tr_b16 v[36:37], v4 offset:49152
    v_mfma_f32_16x16x32_bf16 v[148:151], v[40:43], v[180:183], v[148:151]
    ds_read_b64_tr_b16 v[38:39], v4 offset:50176
    v_mfma_f32_16x16x32_bf16 v[152:155], v[44:47], v[176:179], v[152:155]
    ds_read_b64_tr_b16 v[40:41], v5 offset:49152
    v_mfma_f32_16x16x32_bf16 v[156:159], v[44:47], v[180:183], v[156:159]
    ds_read_b64_tr_b16 v[42:43], v5 offset:50176
    s_waitcnt lgkmcnt(10)
    v_mfma_f32_16x16x32_bf16 v[128:131], v[48:51], v[184:187], v[128:131]
    ds_read_b64_tr_b16 v[44:45], v6 offset:49152
    s_waitcnt vmcnt(0)
    s_atomic_add s40, s[22:23], s59
    s_mov_b32 s68, 0
    s_atomic_add s68, s[22:23], s59 glc
    s_mov_b32 s55, s52
    s_add_u32 s56, s52, 4194304
    ds_read_b32 v8, v9 offset:4096
    v_mfma_f32_16x16x32_bf16 v[132:135], v[48:51], v[188:191], v[132:135]
    ds_read_b64_tr_b16 v[46:47], v6 offset:50176
    buffer_load_dwordx4 v[64:67], v1, s[4:7], s55 offen offset:0 sc1
    ds_read_b32 v10, v9 offset:4608
    v_mfma_f32_16x16x32_bf16 v[136:139], v[52:55], v[184:187], v[136:139]
    ds_read_b64_tr_b16 v[48:49], v3 offset:53248
    buffer_load_dwordx4 v[68:71], v1, s[4:7], s55 offen offset:1024 sc1
    ds_read_b32 v12, v9 offset:4160
    v_mfma_f32_16x16x32_bf16 v[140:143], v[52:55], v[188:191], v[140:143]
    ds_read_b64_tr_b16 v[50:51], v3 offset:54272
    buffer_load_dwordx4 v[72:75], v1, s[4:7], s56 offen offset:0 sc1
    ds_read_b32 v14, v9 offset:4672
    s_waitcnt lgkmcnt(14)
    v_mfma_f32_16x16x32_bf16 v[144:147], v[56:59], v[184:187], v[144:147]
    ds_read_b64_tr_b16 v[52:53], v4 offset:53248
    buffer_load_dwordx4 v[76:79], v1, s[4:7], s56 offen offset:1024 sc1
    ds_read_b128 v[16:19], v11 offset:0
    v_mfma_f32_16x16x32_bf16 v[148:151], v[56:59], v[188:191], v[148:151]
    ds_read_b64_tr_b16 v[54:55], v4 offset:54272
    ds_read_b128 v[20:23], v11 offset:64
    v_mfma_f32_16x16x32_bf16 v[152:155], v[60:63], v[184:187], v[152:155]
    ds_read_b64_tr_b16 v[56:57], v5 offset:53248
    ds_read_b128 v[24:27], v11 offset:128
    v_mfma_f32_16x16x32_bf16 v[156:159], v[60:63], v[188:191], v[156:159]
    ds_read_b64_tr_b16 v[58:59], v5 offset:54272
    ds_read_b128 v[28:31], v11 offset:192
    s_waitcnt lgkmcnt(15)
    v_mfma_f32_16x16x32_bf16 v[128:131], v[32:35], v[192:195], v[128:131]
    ds_read_b64_tr_b16 v[60:61], v6 offset:53248
    v_mfma_f32_16x16x32_bf16 v[132:135], v[32:35], v[196:199], v[132:135]
    ds_read_b64_tr_b16 v[62:63], v6 offset:54272
    v_mfma_f32_16x16x32_bf16 v[136:139], v[36:39], v[192:195], v[136:139]
    ds_read_b64_tr_b16 v[32:33], v3 offset:57344
    v_mfma_f32_16x16x32_bf16 v[140:143], v[36:39], v[196:199], v[140:143]
    ds_read_b64_tr_b16 v[34:35], v3 offset:58368
    s_waitcnt lgkmcnt(15)
    v_mfma_f32_16x16x32_bf16 v[144:147], v[40:43], v[192:195], v[144:147]
    ds_read_b64_tr_b16 v[36:37], v4 offset:57344
    v_mfma_f32_16x16x32_bf16 v[148:151], v[40:43], v[196:199], v[148:151]
    ds_read_b64_tr_b16 v[38:39], v4 offset:58368
    v_mfma_f32_16x16x32_bf16 v[152:155], v[44:47], v[192:195], v[152:155]
    ds_read_b64_tr_b16 v[40:41], v5 offset:57344
    v_mfma_f32_16x16x32_bf16 v[156:159], v[44:47], v[196:199], v[156:159]
    ds_read_b64_tr_b16 v[42:43], v5 offset:58368
    s_waitcnt lgkmcnt(13)
    v_mfma_f32_16x16x32_bf16 v[128:131], v[48:51], v[200:203], v[128:131]
    ds_read_b64_tr_b16 v[44:45], v6 offset:57344
    s_waitcnt lgkmcnt(9)
    v_mfma_f32_16x16x32_bf16 v[132:135], v[48:51], v[204:207], v[132:135]
    ds_read_b64_tr_b16 v[46:47], v6 offset:58368
    v_mul_f32 v10, 0x3e8293ee, v10
    v_mfma_f32_16x16x32_bf16 v[136:139], v[52:55], v[200:203], v[136:139]
    ds_read_b64_tr_b16 v[48:49], v3 offset:61440
    v_mul_f32 v14, 0x3e8293ee, v14
    v_mfma_f32_16x16x32_bf16 v[140:143], v[52:55], v[204:207], v[140:143]
    ds_read_b64_tr_b16 v[50:51], v3 offset:62464
    s_lshl_b32 s44, s16, 11
    s_waitcnt lgkmcnt(10)
    v_mfma_f32_16x16x32_bf16 v[144:147], v[56:59], v[200:203], v[144:147]
    ds_read_b64_tr_b16 v[52:53], v4 offset:61440
    s_add_u32 s44, s44, 131072
    v_mfma_f32_16x16x32_bf16 v[148:151], v[56:59], v[204:207], v[148:151]
    ds_read_b64_tr_b16 v[54:55], v4 offset:62464
    v_add_u32 v13, s44, v2
    v_mfma_f32_16x16x32_bf16 v[152:155], v[60:63], v[200:203], v[152:155]
    ds_read_b64_tr_b16 v[56:57], v5 offset:61440
    v_mfma_f32_16x16x32_bf16 v[156:159], v[60:63], v[204:207], v[156:159]
    ds_read_b64_tr_b16 v[58:59], v5 offset:62464
    s_waitcnt lgkmcnt(10)
    v_mfma_f32_16x16x32_bf16 v[128:131], v[32:35], v[208:211], v[128:131]
    ds_read_b64_tr_b16 v[60:61], v6 offset:61440
    v_mfma_f32_16x16x32_bf16 v[132:135], v[32:35], v[212:215], v[132:135]
    ds_read_b64_tr_b16 v[62:63], v6 offset:62464
    v_xor_b32 v3, 0x10000, v3
    v_xor_b32 v4, 0x10000, v4
    v_xor_b32 v5, 0x10000, v5
    v_xor_b32 v6, 0x10000, v6
    v_mfma_f32_16x16x32_bf16 v[136:139], v[36:39], v[208:211], v[136:139]
    v_mfma_f32_16x16x32_bf16 v[140:143], v[36:39], v[212:215], v[140:143]
    s_waitcnt lgkmcnt(8)
    v_mfma_f32_16x16x32_bf16 v[144:147], v[40:43], v[208:211], v[144:147]
    v_mfma_f32_16x16x32_bf16 v[148:151], v[40:43], v[212:215], v[148:151]
    v_mfma_f32_16x16x32_bf16 v[152:155], v[44:47], v[208:211], v[152:155]
    v_mfma_f32_16x16x32_bf16 v[156:159], v[44:47], v[212:215], v[156:159]
    s_waitcnt lgkmcnt(4)
    v_mfma_f32_16x16x32_bf16 v[128:131], v[48:51], v[216:219], v[128:131]
    v_mfma_f32_16x16x32_bf16 v[132:135], v[48:51], v[220:223], v[132:135]
    v_mfma_f32_16x16x32_bf16 v[136:139], v[52:55], v[216:219], v[136:139]
    v_mfma_f32_16x16x32_bf16 v[140:143], v[52:55], v[220:223], v[140:143]
    s_waitcnt lgkmcnt(0)
    v_mfma_f32_16x16x32_bf16 v[144:147], v[56:59], v[216:219], v[144:147]
    v_mfma_f32_16x16x32_bf16 v[148:151], v[56:59], v[220:223], v[148:151]
    v_mfma_f32_16x16x32_bf16 v[152:155], v[60:63], v[216:219], v[152:155]
    v_mfma_f32_16x16x32_bf16 v[156:159], v[60:63], v[220:223], v[156:159]
    v_pk_fma_f32 v[128:129], v[8:9], v[16:17], v[128:129] op_sel_hi:[0,1,1] neg_lo:[1,0,0] neg_hi:[1,0,0]
    v_pk_fma_f32 v[130:131], v[8:9], v[18:19], v[130:131] op_sel_hi:[0,1,1] neg_lo:[1,0,0] neg_hi:[1,0,0]
    v_pk_mul_f32 v[128:129], v[10:11], v[128:129] op_sel_hi:[0,1]
    v_pk_mul_f32 v[130:131], v[10:11], v[130:131] op_sel_hi:[0,1]
    v_pk_fma_f32 v[136:137], v[8:9], v[20:21], v[136:137] op_sel_hi:[0,1,1] neg_lo:[1,0,0] neg_hi:[1,0,0]
    v_pk_fma_f32 v[138:139], v[8:9], v[22:23], v[138:139] op_sel_hi:[0,1,1] neg_lo:[1,0,0] neg_hi:[1,0,0]
    v_pk_mul_f32 v[136:137], v[10:11], v[136:137] op_sel_hi:[0,1]
    v_pk_mul_f32 v[138:139], v[10:11], v[138:139] op_sel_hi:[0,1]
    v_cvt_pk_bf16_f32 v128, v128, v129
    v_cvt_pk_bf16_f32 v129, v130, v131
    v_cvt_pk_bf16_f32 v130, v136, v137
    v_cvt_pk_bf16_f32 v131, v138, v139
    ds_write_b128 v13, v[128:131] offset:0
    v_pk_fma_f32 v[132:133], v[12:13], v[16:17], v[132:133] op_sel_hi:[0,1,1] neg_lo:[1,0,0] neg_hi:[1,0,0]
    v_pk_fma_f32 v[134:135], v[12:13], v[18:19], v[134:135] op_sel_hi:[0,1,1] neg_lo:[1,0,0] neg_hi:[1,0,0]
    v_pk_mul_f32 v[132:133], v[14:15], v[132:133] op_sel_hi:[0,1]
    v_pk_mul_f32 v[134:135], v[14:15], v[134:135] op_sel_hi:[0,1]
    v_pk_fma_f32 v[140:141], v[12:13], v[20:21], v[140:141] op_sel_hi:[0,1,1] neg_lo:[1,0,0] neg_hi:[1,0,0]
    v_pk_fma_f32 v[142:143], v[12:13], v[22:23], v[142:143] op_sel_hi:[0,1,1] neg_lo:[1,0,0] neg_hi:[1,0,0]
    v_pk_mul_f32 v[140:141], v[14:15], v[140:141] op_sel_hi:[0,1]
    v_pk_mul_f32 v[142:143], v[14:15], v[142:143] op_sel_hi:[0,1]
    v_cvt_pk_bf16_f32 v132, v132, v133
    v_cvt_pk_bf16_f32 v133, v134, v135
    v_cvt_pk_bf16_f32 v134, v140, v141
    v_cvt_pk_bf16_f32 v135, v142, v143
    ds_write_b128 v13, v[132:135] offset:256
    v_pk_fma_f32 v[144:145], v[8:9], v[24:25], v[144:145] op_sel_hi:[0,1,1] neg_lo:[1,0,0] neg_hi:[1,0,0]
    v_pk_fma_f32 v[146:147], v[8:9], v[26:27], v[146:147] op_sel_hi:[0,1,1] neg_lo:[1,0,0] neg_hi:[1,0,0]
    v_pk_mul_f32 v[144:145], v[10:11], v[144:145] op_sel_hi:[0,1]
    v_pk_mul_f32 v[146:147], v[10:11], v[146:147] op_sel_hi:[0,1]
    v_pk_fma_f32 v[152:153], v[8:9], v[28:29], v[152:153] op_sel_hi:[0,1,1] neg_lo:[1,0,0] neg_hi:[1,0,0]
    v_pk_fma_f32 v[154:155], v[8:9], v[30:31], v[154:155] op_sel_hi:[0,1,1] neg_lo:[1,0,0] neg_hi:[1,0,0]
    v_pk_mul_f32 v[152:153], v[10:11], v[152:153] op_sel_hi:[0,1]
    v_pk_mul_f32 v[154:155], v[10:11], v[154:155] op_sel_hi:[0,1]
    v_cvt_pk_bf16_f32 v144, v144, v145
    v_cvt_pk_bf16_f32 v145, v146, v147
    v_cvt_pk_bf16_f32 v146, v152, v153
    v_cvt_pk_bf16_f32 v147, v154, v155
    ds_write_b128 v13, v[144:147] offset:8192
    v_pk_fma_f32 v[148:149], v[12:13], v[24:25], v[148:149] op_sel_hi:[0,1,1] neg_lo:[1,0,0] neg_hi:[1,0,0]
    v_pk_fma_f32 v[150:151], v[12:13], v[26:27], v[150:151] op_sel_hi:[0,1,1] neg_lo:[1,0,0] neg_hi:[1,0,0]
    v_pk_mul_f32 v[148:149], v[14:15], v[148:149] op_sel_hi:[0,1]
    v_pk_mul_f32 v[150:151], v[14:15], v[150:151] op_sel_hi:[0,1]
    v_pk_fma_f32 v[156:157], v[12:13], v[28:29], v[156:157] op_sel_hi:[0,1,1] neg_lo:[1,0,0] neg_hi:[1,0,0]
    v_pk_fma_f32 v[158:159], v[12:13], v[30:31], v[158:159] op_sel_hi:[0,1,1] neg_lo:[1,0,0] neg_hi:[1,0,0]
    v_pk_mul_f32 v[156:157], v[14:15], v[156:157] op_sel_hi:[0,1]
    v_pk_mul_f32 v[158:159], v[14:15], v[158:159] op_sel_hi:[0,1]
    v_cvt_pk_bf16_f32 v148, v148, v149
    v_cvt_pk_bf16_f32 v149, v150, v151
    v_cvt_pk_bf16_f32 v150, v156, v157
    v_cvt_pk_bf16_f32 v151, v158, v159
    ds_write_b128 v13, v[148:151] offset:8448
    v_add_u32 v4, 131072, v1
    s_lshl_b32 s44, s16, 12
    s_add_u32 s44, s44, 65536
    v_add_u32 v5, s44, v1
    s_lshl_b32 s44, s16, 8
    s_add_u32 s44, s44, 147456
    v_lshrrev_b32 v6, 2, v1
    v_add_u32 v6, s44, v6
    v_mov_b32 v8, 156672
    v_mov_b32 v9, 0xdddddddd
    v_bfe_u32 v10, v1, 4, 3
    v_mov_b32 v11, 0x3f803f80
    v_cmp_eq_u32 vcc, 0, v10
    s_nop 1
    v_cndmask_b32 v28, 0, v11, vcc
    v_cndmask_b32 v29, 0, v11, vcc
    v_cmp_eq_u32 vcc, 4, v10
    s_nop 1
    v_cndmask_b32 v30, 0, v11, vcc
    v_cndmask_b32 v31, 0, v11, vcc
    v_mov_b32 v10, 0
    v_mov_b32 v11, 0
    v_mov_b32 v13, 0
    v_mov_b32 v14, 0
    v_mov_b32 v15, 0
    v_mov_b32 v17, 0
    v_mov_b32 v18, 0
    v_mov_b32 v19, 0
    v_mov_b32 v21, 0
    v_mov_b32 v22, 0
    v_mov_b32 v23, 0
    v_mov_b32 v25, 0
    v_mov_b32 v26, 0
    v_mov_b32 v27, 0
    v_mfma_f32_32x32x8_bf16 v[160:175], v[10:11], v[10:11], 0
    v_mov_b32 v20, 0
    v_mfma_f32_32x32x8_bf16 v[176:191], v[10:11], v[10:11], 0
    v_mov_b32 v24, 0
    s_waitcnt lgkmcnt(0)
    v_mfma_f32_32x32x8_bf16 v[128:143], v[10:11], v[10:11], 0
    v_mov_b32 v12, 0
    v_mfma_f32_32x32x8_bf16 v[144:159], v[10:11], v[10:11], 0
    v_mov_b32 v16, 0
    s_barrier
    ds_read_b128 v[32:35], v4 offset:0
    ds_read_b128 v[36:39], v4 offset:1024
    ds_read_b128 v[40:43], v4 offset:2048
    ds_read_b128 v[44:47], v4 offset:3072
    ds_read_b128 v[48:51], v4 offset:4096
    ds_read_b128 v[52:55], v4 offset:5120
    ds_read_b128 v[56:59], v4 offset:6144
    ds_read_b128 v[60:63], v4 offset:7168
    s_mov_b32 s57, 0
    s_waitcnt vmcnt(0) lgkmcnt(6)
    v_mfma_f32_32x32x16_bf16 v[192:207], v[64:67], v[32:35], 0
    v_mfma_f32_32x32x16_bf16 v[192:207], v[68:71], v[36:39], v[192:207]
    s_mov_b32 s66, 0x10000
    s_waitcnt lgkmcnt(0)
    s_cmp_eq_u32 s68, 16
    s_cbranch_scc1 c_k_ok
c_k_poll:
    s_mov_b32 s68, 0
    s_atomic_add s68, s[22:23], s59 offset:0 glc
    s_sub_u32 s66, s66, 1
    s_cselect_b32 s67, 16, 0
    s_waitcnt lgkmcnt(0)
    s_max_u32 s68, s68, s67
    s_cmp_lt_u32 s68, 16
    s_cbranch_scc1 c_k_poll
c_k_ok:
    s_add_u32 s54, s54, 8192
    s_and_b32 s54, s54, 0x1ffff
    s_add_u32 s55, s53, s54
    s_add_u32 s56, s55, 4194304
    buffer_load_dwordx4 v[80:83], v1, s[4:7], s55 offen offset:0 sc1
    buffer_load_dwordx4 v[84:87], v1, s[4:7], s55 offen offset:1024 sc1
    buffer_load_dwordx4 v[88:91], v1, s[4:7], s56 offen offset:0 sc1
    buffer_load_dwordx4 v[92:95], v1, s[4:7], s56 offen offset:1024 sc1
    s_add_u32 s54, s54, 8192
    s_and_b32 s54, s54, 0x1ffff
    s_add_u32 s55, s53, s54
    s_add_u32 s56, s55, 4194304
    buffer_load_dwordx4 v[96:99], v1, s[4:7], s55 offen offset:0 sc1
    buffer_load_dwordx4 v[100:103], v1, s[4:7], s55 offen offset:1024 sc1
    buffer_load_dwordx4 v[104:107], v1, s[4:7], s56 offen offset:0 sc1
    buffer_load_dwordx4 v[108:111], v1, s[4:7], s56 offen offset:1024 sc1
    v_mfma_f32_32x32x16_bf16 v[208:223], v[64:67], v[40:43], 0
    s_add_u32 s54, s54, 8192
    s_and_b32 s54, s54, 0x1ffff
    s_add_u32 s55, s53, s54
    s_add_u32 s56, s55, 4194304
    buffer_load_dwordx4 v[112:115], v1, s[4:7], s55 offen offset:0 sc1
    v_exp_f32 v192, v192
    v_exp_f32 v193, v193
    v_exp_f32 v194, v194
    v_exp_f32 v195, v195
    v_exp_f32 v196, v196
    v_exp_f32 v197, v197
    v_mfma_f32_32x32x16_bf16 v[208:223], v[68:71], v[44:47], v[208:223]
    v_exp_f32 v198, v198
    v_exp_f32 v199, v199
    v_exp_f32 v200, v200
    v_exp_f32 v201, v201
    v_exp_f32 v202, v202
    v_exp_f32 v203, v203
    v_exp_f32 v204, v204
    v_exp_f32 v205, v205
    v_exp_f32 v206, v206
    v_exp_f32 v207, v207
    v_mfma_f32_32x32x16_bf16 v[224:239], v[64:67], v[48:51], 0
    buffer_load_dwordx4 v[116:119], v1, s[4:7], s55 offen offset:1024 sc1
    v_exp_f32 v208, v208
    v_exp_f32 v209, v209
    v_exp_f32 v210, v210
    v_smfmac_f32_32x32x32_bf16 v[128:143], v[72:75], v[192:199], v9
    v_exp_f32 v211, v211
    v_exp_f32 v212, v212
    v_exp_f32 v213, v213
    v_mfma_f32_32x32x16_bf16 v[224:239], v[68:71], v[52:55], v[224:239]
    v_exp_f32 v214, v214
    v_exp_f32 v215, v215
    v_exp_f32 v216, v216
    v_smfmac_f32_16x16x64_bf16 v[12:15], v[28:31], v[192:199], v9
    v_exp_f32 v217, v217
    v_smfmac_f32_32x32x32_bf16 v[128:143], v[76:79], v[200:207], v9
    v_exp_f32 v218, v218
    v_exp_f32 v219, v219
    v_exp_f32 v220, v220
    v_smfmac_f32_16x16x64_bf16 v[12:15], v[28:31], v[200:207], v9
    v_exp_f32 v221, v221
    v_exp_f32 v222, v222
    v_exp_f32 v223, v223
b_head:
    s_mov_b32 s58, 3
b_loop:
    v_mfma_f32_32x32x16_bf16 v[240:255], v[64:67], v[56:59], 0
    buffer_load_dwordx4 v[120:123], v1, s[4:7], s56 offen offset:0 sc1
    v_exp_f32 v224, v224
    v_exp_f32 v225, v225
    v_exp_f32 v226, v226
    v_smfmac_f32_32x32x32_bf16 v[144:159], v[72:75], v[208:215], v9
    v_exp_f32 v227, v227
    v_exp_f32 v228, v228
    v_exp_f32 v229, v229
    v_mfma_f32_32x32x16_bf16 v[240:255], v[68:71], v[60:63], v[240:255]
    v_exp_f32 v230, v230
    v_exp_f32 v231, v231
    v_exp_f32 v232, v232
    v_smfmac_f32_16x16x64_bf16 v[16:19], v[28:31], v[208:215], v9
    v_exp_f32 v233, v233
    v_smfmac_f32_32x32x32_bf16 v[144:159], v[76:79], v[216:223], v9
    v_exp_f32 v234, v234
    v_exp_f32 v235, v235
    v_exp_f32 v236, v236
    v_smfmac_f32_16x16x64_bf16 v[16:19], v[28:31], v[216:223], v9
    v_exp_f32 v237, v237
    v_exp_f32 v238, v238
    v_exp_f32 v239, v239
    s_waitcnt vmcnt(7)
    v_mfma_f32_32x32x16_bf16 v[192:207], v[80:83], v[32:35], 0
    buffer_load_dwordx4 v[124:127], v1, s[4:7], s56 offen offset:1024 sc1
    v_exp_f32 v240, v240
    v_exp_f32 v241, v241
    v_exp_f32 v242, v242
    v_smfmac_f32_32x32x32_bf16 v[160:175], v[72:75], v[224:231], v9
    v_exp_f32 v243, v243
    v_exp_f32 v244, v244
    v_exp_f32 v245, v245
    v_mfma_f32_32x32x16_bf16 v[192:207], v[84:87], v[36:39], v[192:207]
    v_exp_f32 v246, v246
    v_exp_f32 v247, v247
    v_exp_f32 v248, v248
    v_smfmac_f32_16x16x64_bf16 v[20:23], v[28:31], v[224:231], v9
    v_exp_f32 v249, v249
    v_smfmac_f32_32x32x32_bf16 v[160:175], v[76:79], v[232:239], v9
    v_exp_f32 v250, v250
    v_exp_f32 v251, v251
    v_exp_f32 v252, v252
    v_smfmac_f32_16x16x64_bf16 v[20:23], v[28:31], v[232:239], v9
    v_exp_f32 v253, v253
    v_exp_f32 v254, v254
    v_exp_f32 v255, v255
    v_mfma_f32_32x32x16_bf16 v[208:223], v[80:83], v[40:43], 0
    s_add_u32 s54, s54, 8192
    s_and_b32 s54, s54, 0x1ffff
    s_add_u32 s55, s53, s54
    s_add_u32 s56, s55, 4194304
    buffer_load_dwordx4 v[64:67], v1, s[4:7], s55 offen offset:0 sc1
    v_exp_f32 v192, v192
    v_exp_f32 v193, v193
    v_exp_f32 v194, v194
    v_smfmac_f32_32x32x32_bf16 v[176:191], v[72:75], v[240:247], v9
    v_exp_f32 v195, v195
    v_exp_f32 v196, v196
    v_exp_f32 v197, v197
    v_mfma_f32_32x32x16_bf16 v[208:223], v[84:87], v[44:47], v[208:223]
    v_exp_f32 v198, v198
    v_exp_f32 v199, v199
    v_exp_f32 v200, v200
    v_smfmac_f32_16x16x64_bf16 v[24:27], v[28:31], v[240:247], v9
    v_exp_f32 v201, v201
    v_smfmac_f32_32x32x32_bf16 v[176:191], v[76:79], v[248:255], v9
    v_exp_f32 v202, v202
    v_exp_f32 v203, v203
    v_exp_f32 v204, v204
    v_smfmac_f32_16x16x64_bf16 v[24:27], v[28:31], v[248:255], v9
    v_exp_f32 v205, v205
    v_exp_f32 v206, v206
    v_exp_f32 v207, v207
    v_mfma_f32_32x32x16_bf16 v[224:239], v[80:83], v[48:51], 0
    buffer_load_dwordx4 v[68:71], v1, s[4:7], s55 offen offset:1024 sc1
    v_exp_f32 v208, v208
    v_exp_f32 v209, v209
    v_exp_f32 v210, v210
    v_smfmac_f32_32x32x32_bf16 v[128:143], v[88:91], v[192:199], v9
    v_exp_f32 v211, v211
    v_exp_f32 v212, v212
    v_exp_f32 v213, v213
    v_mfma_f32_32x32x16_bf16 v[224:239], v[84:87], v[52:55], v[224:239]
    v_exp_f32 v214, v214
    v_exp_f32 v215, v215
    v_exp_f32 v216, v216
    v_smfmac_f32_16x16x64_bf16 v[12:15], v[28:31], v[192:199], v9
    v_exp_f32 v217, v217
    v_smfmac_f32_32x32x32_bf16 v[128:143], v[92:95], v[200:207], v9
    v_exp_f32 v218, v218
    v_exp_f32 v219, v219
    v_exp_f32 v220, v220
    v_smfmac_f32_16x16x64_bf16 v[12:15], v[28:31], v[200:207], v9
    v_exp_f32 v221, v221
    v_exp_f32 v222, v222
    v_exp_f32 v223, v223
    v_mfma_f32_32x32x16_bf16 v[240:255], v[80:83], v[56:59], 0
    buffer_load_dwordx4 v[72:75], v1, s[4:7], s56 offen offset:0 sc1
    v_exp_f32 v224, v224
    v_exp_f32 v225, v225
    v_exp_f32 v226, v226
    v_smfmac_f32_32x32x32_bf16 v[144:159], v[88:91], v[208:215], v9
    v_exp_f32 v227, v227
    v_exp_f32 v228, v228
    v_exp_f32 v229, v229
    v_mfma_f32_32x32x16_bf16 v[240:255], v[84:87], v[60:63], v[240:255]
    v_exp_f32 v230, v230
    v_exp_f32 v231, v231
    v_exp_f32 v232, v232
    v_smfmac_f32_16x16x64_bf16 v[16:19], v[28:31], v[208:215], v9
    v_exp_f32 v233, v233
    v_smfmac_f32_32x32x32_bf16 v[144:159], v[92:95], v[216:223], v9
    v_exp_f32 v234, v234
    v_exp_f32 v235, v235
    v_exp_f32 v236, v236
    v_smfmac_f32_16x16x64_bf16 v[16:19], v[28:31], v[216:223], v9
    v_exp_f32 v237, v237
    v_exp_f32 v238, v238
    v_exp_f32 v239, v239
    s_waitcnt vmcnt(7)
    v_mfma_f32_32x32x16_bf16 v[192:207], v[96:99], v[32:35], 0
    buffer_load_dwordx4 v[76:79], v1, s[4:7], s56 offen offset:1024 sc1
    v_exp_f32 v240, v240
    v_exp_f32 v241, v241
    v_exp_f32 v242, v242
    v_smfmac_f32_32x32x32_bf16 v[160:175], v[88:91], v[224:231], v9
    v_exp_f32 v243, v243
    v_exp_f32 v244, v244
    v_exp_f32 v245, v245
    v_mfma_f32_32x32x16_bf16 v[192:207], v[100:103], v[36:39], v[192:207]
    v_exp_f32 v246, v246
    v_exp_f32 v247, v247
    v_exp_f32 v248, v248
    v_smfmac_f32_16x16x64_bf16 v[20:23], v[28:31], v[224:231], v9
    v_exp_f32 v249, v249
    v_smfmac_f32_32x32x32_bf16 v[160:175], v[92:95], v[232:239], v9
    v_exp_f32 v250, v250
    v_exp_f32 v251, v251
    v_exp_f32 v252, v252
    v_smfmac_f32_16x16x64_bf16 v[20:23], v[28:31], v[232:239], v9
    v_exp_f32 v253, v253
    v_exp_f32 v254, v254
    v_exp_f32 v255, v255
    v_mfma_f32_32x32x16_bf16 v[208:223], v[96:99], v[40:43], 0
    s_add_u32 s54, s54, 8192
    s_and_b32 s54, s54, 0x1ffff
    s_add_u32 s55, s53, s54
    s_add_u32 s56, s55, 4194304
    buffer_load_dwordx4 v[80:83], v1, s[4:7], s55 offen offset:0 sc1
    v_exp_f32 v192, v192
    v_exp_f32 v193, v193
    v_exp_f32 v194, v194
    v_smfmac_f32_32x32x32_bf16 v[176:191], v[88:91], v[240:247], v9
    v_exp_f32 v195, v195
    v_exp_f32 v196, v196
    v_exp_f32 v197, v197
    v_mfma_f32_32x32x16_bf16 v[208:223], v[100:103], v[44:47], v[208:223]
    v_exp_f32 v198, v198
    v_exp_f32 v199, v199
    v_exp_f32 v200, v200
    v_smfmac_f32_16x16x64_bf16 v[24:27], v[28:31], v[240:247], v9
    v_exp_f32 v201, v201
    v_smfmac_f32_32x32x32_bf16 v[176:191], v[92:95], v[248:255], v9
    v_exp_f32 v202, v202
    v_exp_f32 v203, v203
    v_exp_f32 v204, v204
    v_smfmac_f32_16x16x64_bf16 v[24:27], v[28:31], v[248:255], v9
    v_exp_f32 v205, v205
    v_exp_f32 v206, v206
    v_exp_f32 v207, v207
    v_mfma_f32_32x32x16_bf16 v[224:239], v[96:99], v[48:51], 0
    buffer_load_dwordx4 v[84:87], v1, s[4:7], s55 offen offset:1024 sc1
    v_exp_f32 v208, v208
    v_exp_f32 v209, v209
    v_exp_f32 v210, v210
    v_smfmac_f32_32x32x32_bf16 v[128:143], v[104:107], v[192:199], v9
    v_exp_f32 v211, v211
    v_exp_f32 v212, v212
    v_exp_f32 v213, v213
    v_mfma_f32_32x32x16_bf16 v[224:239], v[100:103], v[52:55], v[224:239]
    v_exp_f32 v214, v214
    v_exp_f32 v215, v215
    v_exp_f32 v216, v216
    v_smfmac_f32_16x16x64_bf16 v[12:15], v[28:31], v[192:199], v9
    v_exp_f32 v217, v217
    v_smfmac_f32_32x32x32_bf16 v[128:143], v[108:111], v[200:207], v9
    v_exp_f32 v218, v218
    v_exp_f32 v219, v219
    v_exp_f32 v220, v220
    v_smfmac_f32_16x16x64_bf16 v[12:15], v[28:31], v[200:207], v9
    v_exp_f32 v221, v221
    v_exp_f32 v222, v222
    v_exp_f32 v223, v223
    v_mfma_f32_32x32x16_bf16 v[240:255], v[96:99], v[56:59], 0
    buffer_load_dwordx4 v[88:91], v1, s[4:7], s56 offen offset:0 sc1
    v_exp_f32 v224, v224
    v_exp_f32 v225, v225
    v_exp_f32 v226, v226
    v_smfmac_f32_32x32x32_bf16 v[144:159], v[104:107], v[208:215], v9
    v_exp_f32 v227, v227
    v_exp_f32 v228, v228
    v_exp_f32 v229, v229
    v_mfma_f32_32x32x16_bf16 v[240:255], v[100:103], v[60:63], v[240:255]
    v_exp_f32 v230, v230
    v_exp_f32 v231, v231
    v_exp_f32 v232, v232
    v_smfmac_f32_16x16x64_bf16 v[16:19], v[28:31], v[208:215], v9
    v_exp_f32 v233, v233
    v_smfmac_f32_32x32x32_bf16 v[144:159], v[108:111], v[216:223], v9
    v_exp_f32 v234, v234
    v_exp_f32 v235, v235
    v_exp_f32 v236, v236
    v_smfmac_f32_16x16x64_bf16 v[16:19], v[28:31], v[216:223], v9
    v_exp_f32 v237, v237
    v_exp_f32 v238, v238
    v_exp_f32 v239, v239
    s_waitcnt vmcnt(7)
    v_mfma_f32_32x32x16_bf16 v[192:207], v[112:115], v[32:35], 0
    buffer_load_dwordx4 v[92:95], v1, s[4:7], s56 offen offset:1024 sc1
    v_exp_f32 v240, v240
    v_exp_f32 v241, v241
    v_exp_f32 v242, v242
    v_smfmac_f32_32x32x32_bf16 v[160:175], v[104:107], v[224:231], v9
    v_exp_f32 v243, v243
    v_exp_f32 v244, v244
    v_exp_f32 v245, v245
    v_mfma_f32_32x32x16_bf16 v[192:207], v[116:119], v[36:39], v[192:207]
    v_exp_f32 v246, v246
    v_exp_f32 v247, v247
    v_exp_f32 v248, v248
    v_smfmac_f32_16x16x64_bf16 v[20:23], v[28:31], v[224:231], v9
    v_exp_f32 v249, v249
    v_smfmac_f32_32x32x32_bf16 v[160:175], v[108:111], v[232:239], v9
    v_exp_f32 v250, v250
    v_exp_f32 v251, v251
    v_exp_f32 v252, v252
    v_smfmac_f32_16x16x64_bf16 v[20:23], v[28:31], v[232:239], v9
    v_exp_f32 v253, v253
    v_exp_f32 v254, v254
    v_exp_f32 v255, v255
    v_mfma_f32_32x32x16_bf16 v[208:223], v[112:115], v[40:43], 0
    s_add_u32 s54, s54, 8192
    s_and_b32 s54, s54, 0x1ffff
    s_add_u32 s55, s53, s54
    s_add_u32 s56, s55, 4194304
    buffer_load_dwordx4 v[96:99], v1, s[4:7], s55 offen offset:0 sc1
    v_exp_f32 v192, v192
    v_exp_f32 v193, v193
    v_exp_f32 v194, v194
    v_smfmac_f32_32x32x32_bf16 v[176:191], v[104:107], v[240:247], v9
    v_exp_f32 v195, v195
    v_exp_f32 v196, v196
    v_exp_f32 v197, v197
    v_mfma_f32_32x32x16_bf16 v[208:223], v[116:119], v[44:47], v[208:223]
    v_exp_f32 v198, v198
    v_exp_f32 v199, v199
    v_exp_f32 v200, v200
    v_smfmac_f32_16x16x64_bf16 v[24:27], v[28:31], v[240:247], v9
    v_exp_f32 v201, v201
    v_smfmac_f32_32x32x32_bf16 v[176:191], v[108:111], v[248:255], v9
    v_exp_f32 v202, v202
    v_exp_f32 v203, v203
    v_exp_f32 v204, v204
    v_smfmac_f32_16x16x64_bf16 v[24:27], v[28:31], v[248:255], v9
    v_exp_f32 v205, v205
    v_exp_f32 v206, v206
    v_exp_f32 v207, v207
    v_mfma_f32_32x32x16_bf16 v[224:239], v[112:115], v[48:51], 0
    buffer_load_dwordx4 v[100:103], v1, s[4:7], s55 offen offset:1024 sc1
    v_exp_f32 v208, v208
    v_exp_f32 v209, v209
    v_exp_f32 v210, v210
    v_smfmac_f32_32x32x32_bf16 v[128:143], v[120:123], v[192:199], v9
    v_exp_f32 v211, v211
    v_exp_f32 v212, v212
    v_exp_f32 v213, v213
    v_mfma_f32_32x32x16_bf16 v[224:239], v[116:119], v[52:55], v[224:239]
    v_exp_f32 v214, v214
    v_exp_f32 v215, v215
    v_exp_f32 v216, v216
    v_smfmac_f32_16x16x64_bf16 v[12:15], v[28:31], v[192:199], v9
    v_exp_f32 v217, v217
    v_smfmac_f32_32x32x32_bf16 v[128:143], v[124:127], v[200:207], v9
    v_exp_f32 v218, v218
    v_exp_f32 v219, v219
    v_exp_f32 v220, v220
    v_smfmac_f32_16x16x64_bf16 v[12:15], v[28:31], v[200:207], v9
    v_exp_f32 v221, v221
    v_exp_f32 v222, v222
    v_exp_f32 v223, v223
    v_mfma_f32_32x32x16_bf16 v[240:255], v[112:115], v[56:59], 0
    buffer_load_dwordx4 v[104:107], v1, s[4:7], s56 offen offset:0 sc1
    v_exp_f32 v224, v224
    v_exp_f32 v225, v225
    v_exp_f32 v226, v226
    v_smfmac_f32_32x32x32_bf16 v[144:159], v[120:123], v[208:215], v9
    v_exp_f32 v227, v227
    v_exp_f32 v228, v228
    v_exp_f32 v229, v229
    v_mfma_f32_32x32x16_bf16 v[240:255], v[116:119], v[60:63], v[240:255]
    v_exp_f32 v230, v230
    v_exp_f32 v231, v231
    v_exp_f32 v232, v232
    v_smfmac_f32_16x16x64_bf16 v[16:19], v[28:31], v[208:215], v9
    v_exp_f32 v233, v233
    v_smfmac_f32_32x32x32_bf16 v[144:159], v[124:127], v[216:223], v9
    v_exp_f32 v234, v234
    v_exp_f32 v235, v235
    v_exp_f32 v236, v236
    v_smfmac_f32_16x16x64_bf16 v[16:19], v[28:31], v[216:223], v9
    v_exp_f32 v237, v237
    v_exp_f32 v238, v238
    v_exp_f32 v239, v239
    s_waitcnt vmcnt(7)
    v_mfma_f32_32x32x16_bf16 v[192:207], v[64:67], v[32:35], 0
    buffer_load_dwordx4 v[108:111], v1, s[4:7], s56 offen offset:1024 sc1
    v_exp_f32 v240, v240
    v_exp_f32 v241, v241
    v_exp_f32 v242, v242
    v_smfmac_f32_32x32x32_bf16 v[160:175], v[120:123], v[224:231], v9
    v_exp_f32 v243, v243
    v_exp_f32 v244, v244
    v_exp_f32 v245, v245
    v_mfma_f32_32x32x16_bf16 v[192:207], v[68:71], v[36:39], v[192:207]
    v_exp_f32 v246, v246
    v_exp_f32 v247, v247
    v_exp_f32 v248, v248
    v_smfmac_f32_16x16x64_bf16 v[20:23], v[28:31], v[224:231], v9
    v_exp_f32 v249, v249
    v_smfmac_f32_32x32x32_bf16 v[160:175], v[124:127], v[232:239], v9
    v_exp_f32 v250, v250
    v_exp_f32 v251, v251
    v_exp_f32 v252, v252
    v_smfmac_f32_16x16x64_bf16 v[20:23], v[28:31], v[232:239], v9
    v_exp_f32 v253, v253
    v_exp_f32 v254, v254
    v_exp_f32 v255, v255
    v_mfma_f32_32x32x16_bf16 v[208:223], v[64:67], v[40:43], 0
    s_add_u32 s54, s54, 8192
    s_and_b32 s54, s54, 0x1ffff
    s_add_u32 s55, s53, s54
    s_add_u32 s56, s55, 4194304
    buffer_load_dwordx4 v[112:115], v1, s[4:7], s55 offen offset:0 sc1
    v_exp_f32 v192, v192
    v_exp_f32 v193, v193
    v_exp_f32 v194, v194
    v_smfmac_f32_32x32x32_bf16 v[176:191], v[120:123], v[240:247], v9
    v_exp_f32 v195, v195
    v_exp_f32 v196, v196
    v_exp_f32 v197, v197
    v_mfma_f32_32x32x16_bf16 v[208:223], v[68:71], v[44:47], v[208:223]
    v_exp_f32 v198, v198
    v_exp_f32 v199, v199
    v_exp_f32 v200, v200
    v_smfmac_f32_16x16x64_bf16 v[24:27], v[28:31], v[240:247], v9
    v_exp_f32 v201, v201
    v_smfmac_f32_32x32x32_bf16 v[176:191], v[124:127], v[248:255], v9
    v_exp_f32 v202, v202
    v_exp_f32 v203, v203
    v_exp_f32 v204, v204
    v_smfmac_f32_16x16x64_bf16 v[24:27], v[28:31], v[248:255], v9
    v_exp_f32 v205, v205
    v_exp_f32 v206, v206
    v_exp_f32 v207, v207
    v_mfma_f32_32x32x16_bf16 v[224:239], v[64:67], v[48:51], 0
    buffer_load_dwordx4 v[116:119], v1, s[4:7], s55 offen offset:1024 sc1
    v_exp_f32 v208, v208
    v_exp_f32 v209, v209
    v_exp_f32 v210, v210
    v_smfmac_f32_32x32x32_bf16 v[128:143], v[72:75], v[192:199], v9
    v_exp_f32 v211, v211
    v_exp_f32 v212, v212
    v_exp_f32 v213, v213
    v_mfma_f32_32x32x16_bf16 v[224:239], v[68:71], v[52:55], v[224:239]
    v_exp_f32 v214, v214
    v_exp_f32 v215, v215
    v_exp_f32 v216, v216
    v_smfmac_f32_16x16x64_bf16 v[12:15], v[28:31], v[192:199], v9
    v_exp_f32 v217, v217
    v_smfmac_f32_32x32x32_bf16 v[128:143], v[76:79], v[200:207], v9
    v_exp_f32 v218, v218
    v_exp_f32 v219, v219
    v_exp_f32 v220, v220
    v_smfmac_f32_16x16x64_bf16 v[12:15], v[28:31], v[200:207], v9
    v_exp_f32 v221, v221
    v_exp_f32 v222, v222
    v_exp_f32 v223, v223
    s_sub_u32 s58, s58, 1
    s_cmp_lg_u32 s58, 0
    s_cbranch_scc1 b_loop
    v_mfma_f32_32x32x16_bf16 v[240:255], v[64:67], v[56:59], 0
    buffer_load_dwordx4 v[120:123], v1, s[4:7], s56 offen offset:0 sc1
    v_exp_f32 v224, v224
    v_exp_f32 v225, v225
    v_exp_f32 v226, v226
    v_smfmac_f32_32x32x32_bf16 v[144:159], v[72:75], v[208:215], v9
    v_exp_f32 v227, v227
    v_exp_f32 v228, v228
    v_exp_f32 v229, v229
    v_mfma_f32_32x32x16_bf16 v[240:255], v[68:71], v[60:63], v[240:255]
    v_exp_f32 v230, v230
    v_exp_f32 v231, v231
    v_exp_f32 v232, v232
    v_smfmac_f32_16x16x64_bf16 v[16:19], v[28:31], v[208:215], v9
    v_exp_f32 v233, v233
    v_smfmac_f32_32x32x32_bf16 v[144:159], v[76:79], v[216:223], v9
    v_exp_f32 v234, v234
    v_exp_f32 v235, v235
    v_exp_f32 v236, v236
    v_smfmac_f32_16x16x64_bf16 v[16:19], v[28:31], v[216:223], v9
    v_exp_f32 v237, v237
    v_exp_f32 v238, v238
    v_exp_f32 v239, v239
    s_waitcnt vmcnt(7)
    v_mfma_f32_32x32x16_bf16 v[192:207], v[80:83], v[32:35], 0
    buffer_load_dwordx4 v[124:127], v1, s[4:7], s56 offen offset:1024 sc1
    v_exp_f32 v240, v240
    v_exp_f32 v241, v241
    v_exp_f32 v242, v242
    v_smfmac_f32_32x32x32_bf16 v[160:175], v[72:75], v[224:231], v9
    v_exp_f32 v243, v243
    v_exp_f32 v244, v244
    v_exp_f32 v245, v245
    v_mfma_f32_32x32x16_bf16 v[192:207], v[84:87], v[36:39], v[192:207]
    v_exp_f32 v246, v246
    v_exp_f32 v247, v247
    v_exp_f32 v248, v248
    v_smfmac_f32_16x16x64_bf16 v[20:23], v[28:31], v[224:231], v9
    v_exp_f32 v249, v249
    v_smfmac_f32_32x32x32_bf16 v[160:175], v[76:79], v[232:239], v9
    v_exp_f32 v250, v250
    v_exp_f32 v251, v251
    v_exp_f32 v252, v252
    v_smfmac_f32_16x16x64_bf16 v[20:23], v[28:31], v[232:239], v9
    v_exp_f32 v253, v253
    v_exp_f32 v254, v254
    v_exp_f32 v255, v255
    s_add_u32 s53, s53, 131072
    s_cmp_eq_u32 s57, 0
    s_cselect_b32 s53, s53, 2146435072
    v_mfma_f32_32x32x16_bf16 v[208:223], v[80:83], v[40:43], 0
    s_add_u32 s54, s54, 8192
    s_and_b32 s54, s54, 0x1ffff
    s_add_u32 s55, s53, s54
    s_add_u32 s56, s55, 4194304
    buffer_load_dwordx4 v[64:67], v1, s[4:7], s55 offen offset:0 sc1
    v_exp_f32 v192, v192
    v_exp_f32 v193, v193
    v_exp_f32 v194, v194
    v_smfmac_f32_32x32x32_bf16 v[176:191], v[72:75], v[240:247], v9
    v_exp_f32 v195, v195
    v_exp_f32 v196, v196
    v_exp_f32 v197, v197
    v_mfma_f32_32x32x16_bf16 v[208:223], v[84:87], v[44:47], v[208:223]
    v_exp_f32 v198, v198
    v_exp_f32 v199, v199
    v_exp_f32 v200, v200
    v_smfmac_f32_16x16x64_bf16 v[24:27], v[28:31], v[240:247], v9
    v_exp_f32 v201, v201
    v_smfmac_f32_32x32x32_bf16 v[176:191], v[76:79], v[248:255], v9
    v_exp_f32 v202, v202
    v_exp_f32 v203, v203
    v_exp_f32 v204, v204
    v_smfmac_f32_16x16x64_bf16 v[24:27], v[28:31], v[248:255], v9
    v_exp_f32 v205, v205
    v_exp_f32 v206, v206
    v_exp_f32 v207, v207
    v_mfma_f32_32x32x16_bf16 v[224:239], v[80:83], v[48:51], 0
    buffer_load_dwordx4 v[68:71], v1, s[4:7], s55 offen offset:1024 sc1
    v_exp_f32 v208, v208
    v_exp_f32 v209, v209
    v_exp_f32 v210, v210
    v_smfmac_f32_32x32x32_bf16 v[128:143], v[88:91], v[192:199], v9
    v_exp_f32 v211, v211
    v_exp_f32 v212, v212
    v_exp_f32 v213, v213
    v_mfma_f32_32x32x16_bf16 v[224:239], v[84:87], v[52:55], v[224:239]
    v_exp_f32 v214, v214
    v_exp_f32 v215, v215
    v_exp_f32 v216, v216
    v_smfmac_f32_16x16x64_bf16 v[12:15], v[28:31], v[192:199], v9
    v_exp_f32 v217, v217
    v_smfmac_f32_32x32x32_bf16 v[128:143], v[92:95], v[200:207], v9
    v_exp_f32 v218, v218
    v_exp_f32 v219, v219
    v_exp_f32 v220, v220
    v_smfmac_f32_16x16x64_bf16 v[12:15], v[28:31], v[200:207], v9
    v_exp_f32 v221, v221
    v_exp_f32 v222, v222
    v_exp_f32 v223, v223
    v_mfma_f32_32x32x16_bf16 v[240:255], v[80:83], v[56:59], 0
    buffer_load_dwordx4 v[72:75], v1, s[4:7], s56 offen offset:0 sc1
    v_exp_f32 v224, v224
    v_exp_f32 v225, v225
    v_exp_f32 v226, v226
    v_smfmac_f32_32x32x32_bf16 v[144:159], v[88:91], v[208:215], v9
    v_exp_f32 v227, v227
    v_exp_f32 v228, v228
    v_exp_f32 v229, v229
    v_mfma_f32_32x32x16_bf16 v[240:255], v[84:87], v[60:63], v[240:255]
    v_exp_f32 v230, v230
    v_exp_f32 v231, v231
    v_exp_f32 v232, v232
    v_smfmac_f32_16x16x64_bf16 v[16:19], v[28:31], v[208:215], v9
    v_exp_f32 v233, v233
    v_smfmac_f32_32x32x32_bf16 v[144:159], v[92:95], v[216:223], v9
    v_exp_f32 v234, v234
    v_exp_f32 v235, v235
    v_exp_f32 v236, v236
    v_smfmac_f32_16x16x64_bf16 v[16:19], v[28:31], v[216:223], v9
    v_exp_f32 v237, v237
    v_exp_f32 v238, v238
    v_exp_f32 v239, v239
    s_waitcnt vmcnt(7)
    v_mfma_f32_32x32x16_bf16 v[192:207], v[96:99], v[32:35], 0
    buffer_load_dwordx4 v[76:79], v1, s[4:7], s56 offen offset:1024 sc1
    v_exp_f32 v240, v240
    v_exp_f32 v241, v241
    v_exp_f32 v242, v242
    v_smfmac_f32_32x32x32_bf16 v[160:175], v[88:91], v[224:231], v9
    v_exp_f32 v243, v243
    v_exp_f32 v244, v244
    v_exp_f32 v245, v245
    v_mfma_f32_32x32x16_bf16 v[192:207], v[100:103], v[36:39], v[192:207]
    v_exp_f32 v246, v246
    v_exp_f32 v247, v247
    v_exp_f32 v248, v248
    v_smfmac_f32_16x16x64_bf16 v[20:23], v[28:31], v[224:231], v9
    v_exp_f32 v249, v249
    v_smfmac_f32_32x32x32_bf16 v[160:175], v[92:95], v[232:239], v9
    v_exp_f32 v250, v250
    v_exp_f32 v251, v251
    v_exp_f32 v252, v252
    v_smfmac_f32_16x16x64_bf16 v[20:23], v[28:31], v[232:239], v9
    v_exp_f32 v253, v253
    v_exp_f32 v254, v254
    v_exp_f32 v255, v255
    v_mfma_f32_32x32x16_bf16 v[208:223], v[96:99], v[40:43], 0
    s_add_u32 s54, s54, 8192
    s_and_b32 s54, s54, 0x1ffff
    s_add_u32 s55, s53, s54
    s_add_u32 s56, s55, 4194304
    buffer_load_dwordx4 v[80:83], v1, s[4:7], s55 offen offset:0 sc1
    v_exp_f32 v192, v192
    v_exp_f32 v193, v193
    v_exp_f32 v194, v194
    v_smfmac_f32_32x32x32_bf16 v[176:191], v[88:91], v[240:247], v9
    v_exp_f32 v195, v195
    v_exp_f32 v196, v196
    v_exp_f32 v197, v197
    v_mfma_f32_32x32x16_bf16 v[208:223], v[100:103], v[44:47], v[208:223]
    v_exp_f32 v198, v198
    v_exp_f32 v199, v199
    v_exp_f32 v200, v200
    v_smfmac_f32_16x16x64_bf16 v[24:27], v[28:31], v[240:247], v9
    v_exp_f32 v201, v201
    v_smfmac_f32_32x32x32_bf16 v[176:191], v[92:95], v[248:255], v9
    v_exp_f32 v202, v202
    v_exp_f32 v203, v203
    v_exp_f32 v204, v204
    v_smfmac_f32_16x16x64_bf16 v[24:27], v[28:31], v[248:255], v9
    v_exp_f32 v205, v205
    v_exp_f32 v206, v206
    v_exp_f32 v207, v207
    v_mfma_f32_32x32x16_bf16 v[224:239], v[96:99], v[48:51], 0
    buffer_load_dwordx4 v[84:87], v1, s[4:7], s55 offen offset:1024 sc1
    v_exp_f32 v208, v208
    v_exp_f32 v209, v209
    v_exp_f32 v210, v210
    v_smfmac_f32_32x32x32_bf16 v[128:143], v[104:107], v[192:199], v9
    v_exp_f32 v211, v211
    v_exp_f32 v212, v212
    v_exp_f32 v213, v213
    v_mfma_f32_32x32x16_bf16 v[224:239], v[100:103], v[52:55], v[224:239]
    v_exp_f32 v214, v214
    v_exp_f32 v215, v215
    v_exp_f32 v216, v216
    v_smfmac_f32_16x16x64_bf16 v[12:15], v[28:31], v[192:199], v9
    v_exp_f32 v217, v217
    v_smfmac_f32_32x32x32_bf16 v[128:143], v[108:111], v[200:207], v9
    v_exp_f32 v218, v218
    v_exp_f32 v219, v219
    v_exp_f32 v220, v220
    v_smfmac_f32_16x16x64_bf16 v[12:15], v[28:31], v[200:207], v9
    v_exp_f32 v221, v221
    v_exp_f32 v222, v222
    v_exp_f32 v223, v223
    v_mfma_f32_32x32x16_bf16 v[240:255], v[96:99], v[56:59], 0
    buffer_load_dwordx4 v[88:91], v1, s[4:7], s56 offen offset:0 sc1
    v_exp_f32 v224, v224
    v_exp_f32 v225, v225
    v_exp_f32 v226, v226
    v_smfmac_f32_32x32x32_bf16 v[144:159], v[104:107], v[208:215], v9
    v_exp_f32 v227, v227
    v_exp_f32 v228, v228
    v_exp_f32 v229, v229
    v_mfma_f32_32x32x16_bf16 v[240:255], v[100:103], v[60:63], v[240:255]
    v_exp_f32 v230, v230
    v_exp_f32 v231, v231
    v_exp_f32 v232, v232
    v_smfmac_f32_16x16x64_bf16 v[16:19], v[28:31], v[208:215], v9
    v_exp_f32 v233, v233
    v_smfmac_f32_32x32x32_bf16 v[144:159], v[108:111], v[216:223], v9
    v_exp_f32 v234, v234
    v_exp_f32 v235, v235
    v_exp_f32 v236, v236
    v_smfmac_f32_16x16x64_bf16 v[16:19], v[28:31], v[216:223], v9
    v_exp_f32 v237, v237
    v_exp_f32 v238, v238
    v_exp_f32 v239, v239
    s_waitcnt vmcnt(7)
    v_mfma_f32_32x32x16_bf16 v[192:207], v[112:115], v[32:35], 0
    buffer_load_dwordx4 v[92:95], v1, s[4:7], s56 offen offset:1024 sc1
    v_exp_f32 v240, v240
    v_exp_f32 v241, v241
    v_exp_f32 v242, v242
    v_smfmac_f32_32x32x32_bf16 v[160:175], v[104:107], v[224:231], v9
    v_exp_f32 v243, v243
    v_exp_f32 v244, v244
    v_exp_f32 v245, v245
    v_mfma_f32_32x32x16_bf16 v[192:207], v[116:119], v[36:39], v[192:207]
    v_exp_f32 v246, v246
    v_exp_f32 v247, v247
    v_exp_f32 v248, v248
    v_smfmac_f32_16x16x64_bf16 v[20:23], v[28:31], v[224:231], v9
    v_exp_f32 v249, v249
    v_smfmac_f32_32x32x32_bf16 v[160:175], v[108:111], v[232:239], v9
    v_exp_f32 v250, v250
    v_exp_f32 v251, v251
    v_exp_f32 v252, v252
    v_smfmac_f32_16x16x64_bf16 v[20:23], v[28:31], v[232:239], v9
    v_exp_f32 v253, v253
    v_exp_f32 v254, v254
    v_exp_f32 v255, v255
    v_mfma_f32_32x32x16_bf16 v[208:223], v[112:115], v[40:43], 0
    s_add_u32 s54, s54, 8192
    s_and_b32 s54, s54, 0x1ffff
    s_add_u32 s55, s53, s54
    s_add_u32 s56, s55, 4194304
    buffer_load_dwordx4 v[96:99], v1, s[4:7], s55 offen offset:0 sc1
    v_exp_f32 v192, v192
    v_exp_f32 v193, v193
    v_exp_f32 v194, v194
    v_smfmac_f32_32x32x32_bf16 v[176:191], v[104:107], v[240:247], v9
    ds_read_b128 v[32:35], v4 offset:8192
    ds_read_b128 v[36:39], v4 offset:9216
    v_exp_f32 v195, v195
    v_exp_f32 v196, v196
    v_exp_f32 v197, v197
    v_mfma_f32_32x32x16_bf16 v[208:223], v[116:119], v[44:47], v[208:223]
    v_exp_f32 v198, v198
    v_exp_f32 v199, v199
    v_exp_f32 v200, v200
    v_smfmac_f32_16x16x64_bf16 v[24:27], v[28:31], v[240:247], v9
    v_exp_f32 v201, v201
    v_smfmac_f32_32x32x32_bf16 v[176:191], v[108:111], v[248:255], v9
    v_exp_f32 v202, v202
    v_exp_f32 v203, v203
    v_exp_f32 v204, v204
    v_smfmac_f32_16x16x64_bf16 v[24:27], v[28:31], v[248:255], v9
    v_exp_f32 v205, v205
    v_exp_f32 v206, v206
    v_exp_f32 v207, v207
    s_barrier
    v_mfma_f32_32x32x16_bf16 v[224:239], v[112:115], v[48:51], 0
    buffer_load_dwordx4 v[100:103], v1, s[4:7], s55 offen offset:1024 sc1
    v_exp_f32 v208, v208
    v_exp_f32 v209, v209
    v_exp_f32 v210, v210
    v_smfmac_f32_32x32x32_bf16 v[128:143], v[120:123], v[192:199], v9
    ds_read_b128 v[40:43], v4 offset:10240
    ds_read_b128 v[44:47], v4 offset:11264
    v_exp_f32 v211, v211
    v_exp_f32 v212, v212
    v_exp_f32 v213, v213
    v_mfma_f32_32x32x16_bf16 v[224:239], v[116:119], v[52:55], v[224:239]
    v_exp_f32 v214, v214
    v_exp_f32 v215, v215
    v_exp_f32 v216, v216
    v_smfmac_f32_16x16x64_bf16 v[12:15], v[28:31], v[192:199], v9
    v_exp_f32 v217, v217
    v_smfmac_f32_32x32x32_bf16 v[128:143], v[124:127], v[200:207], v9
    v_exp_f32 v218, v218
    v_exp_f32 v219, v219
    v_exp_f32 v220, v220
    v_smfmac_f32_16x16x64_bf16 v[12:15], v[28:31], v[200:207], v9
    v_exp_f32 v221, v221
    v_exp_f32 v222, v222
    v_exp_f32 v223, v223
    v_mfma_f32_32x32x16_bf16 v[240:255], v[112:115], v[56:59], 0
    buffer_load_dwordx4 v[104:107], v1, s[4:7], s56 offen offset:0 sc1
    v_exp_f32 v224, v224
    v_exp_f32 v225, v225
    v_exp_f32 v226, v226
    v_smfmac_f32_32x32x32_bf16 v[144:159], v[120:123], v[208:215], v9
    ds_read_b128 v[48:51], v4 offset:12288
    ds_read_b128 v[52:55], v4 offset:13312
    v_exp_f32 v227, v227
    ds_write_b128 v5, v[128:131] offset:0
    v_exp_f32 v228, v228
    v_exp_f32 v229, v229
    v_mfma_f32_32x32x16_bf16 v[240:255], v[116:119], v[60:63], v[240:255]
    ds_write_b128 v5, v[132:135] offset:1024
    v_exp_f32 v230, v230
    v_exp_f32 v231, v231
    v_exp_f32 v232, v232
    v_smfmac_f32_16x16x64_bf16 v[16:19], v[28:31], v[208:215], v9
    ds_write_b32 v6, v12 offset:0
    v_exp_f32 v233, v233
    v_smfmac_f32_32x32x32_bf16 v[144:159], v[124:127], v[216:223], v9
    ds_write_b128 v5, v[136:139] offset:2048
    v_exp_f32 v234, v234
    v_exp_f32 v235, v235
    v_exp_f32 v236, v236
    v_smfmac_f32_16x16x64_bf16 v[16:19], v[28:31], v[216:223], v9
    ds_write_b128 v5, v[140:143] offset:3072
    v_exp_f32 v237, v237
    v_exp_f32 v238, v238
    v_exp_f32 v239, v239
    s_waitcnt vmcnt(7)
    s_waitcnt lgkmcnt(9)
    v_mfma_f32_32x32x16_bf16 v[192:207], v[64:67], v[32:35], 0
    buffer_load_dwordx4 v[108:111], v1, s[4:7], s56 offen offset:1024 sc1
    v_exp_f32 v240, v240
    v_exp_f32 v241, v241
    v_exp_f32 v242, v242
    v_smfmac_f32_32x32x32_bf16 v[160:175], v[120:123], v[224:231], v9
    ds_read_b128 v[56:59], v4 offset:14336
    ds_read_b128 v[60:63], v4 offset:15360
    v_exp_f32 v243, v243
    ds_write_b128 v5, v[144:147] offset:16384
    v_exp_f32 v244, v244
    v_exp_f32 v245, v245
    v_mfma_f32_32x32x16_bf16 v[192:207], v[68:71], v[36:39], v[192:207]
    ds_write_b128 v5, v[148:151] offset:17408
    v_exp_f32 v246, v246
    v_exp_f32 v247, v247
    v_exp_f32 v248, v248
    s_waitcnt lgkmcnt(4)
    v_mfma_f32_32x32x8_bf16 v[128:143], v[10:11], v[10:11], 0
    v_mov_b32 v12, 0
    v_smfmac_f32_16x16x64_bf16 v[20:23], v[28:31], v[224:231], v9
    ds_write_b32 v6, v16 offset:1024
    v_exp_f32 v249, v249
    v_smfmac_f32_32x32x32_bf16 v[160:175], v[124:127], v[232:239], v9
    ds_write_b128 v5, v[152:155] offset:18432
    v_exp_f32 v250, v250
    v_exp_f32 v251, v251
    v_exp_f32 v252, v252
    v_smfmac_f32_16x16x64_bf16 v[20:23], v[28:31], v[232:239], v9
    ds_write_b128 v5, v[156:159] offset:19456
    v_exp_f32 v253, v253
    v_exp_f32 v254, v254
    v_exp_f32 v255, v255
    s_cmp_lg_u32 s57, 0
    s_cbranch_scc1 b_tail
    v_mfma_f32_32x32x16_bf16 v[208:223], v[64:67], v[40:43], 0
    s_add_u32 s54, s54, 8192
    s_and_b32 s54, s54, 0x1ffff
    s_add_u32 s55, s53, s54
    s_add_u32 s56, s55, 4194304
    buffer_load_dwordx4 v[112:115], v1, s[4:7], s55 offen offset:0 sc1
    v_exp_f32 v192, v192
    v_exp_f32 v193, v193
    v_exp_f32 v194, v194
    v_smfmac_f32_32x32x32_bf16 v[176:191], v[120:123], v[240:247], v9
    v_exp_f32 v195, v195
    ds_write_b128 v5, v[160:163] offset:32768
    v_exp_f32 v196, v196
    v_exp_f32 v197, v197
    v_mfma_f32_32x32x16_bf16 v[208:223], v[68:71], v[44:47], v[208:223]
    ds_write_b128 v5, v[164:167] offset:33792
    v_exp_f32 v198, v198
    v_exp_f32 v199, v199
    v_exp_f32 v200, v200
    s_waitcnt lgkmcnt(2)
    v_mfma_f32_32x32x8_bf16 v[144:159], v[10:11], v[10:11], 0
    v_mov_b32 v16, 0
    v_smfmac_f32_16x16x64_bf16 v[24:27], v[28:31], v[240:247], v9
    ds_write_b32 v6, v20 offset:2048
    v_exp_f32 v201, v201
    v_smfmac_f32_32x32x32_bf16 v[176:191], v[124:127], v[248:255], v9
    ds_write_b128 v5, v[168:171] offset:34816
    v_exp_f32 v202, v202
    v_exp_f32 v203, v203
    v_exp_f32 v204, v204
    v_smfmac_f32_16x16x64_bf16 v[24:27], v[28:31], v[248:255], v9
    ds_write_b128 v5, v[172:175] offset:35840
    v_exp_f32 v205, v205
    v_exp_f32 v206, v206
    v_exp_f32 v207, v207
    v_mfma_f32_32x32x16_bf16 v[224:239], v[64:67], v[48:51], 0
    buffer_load_dwordx4 v[116:119], v1, s[4:7], s55 offen offset:1024 sc1
    v_exp_f32 v208, v208
    v_exp_f32 v209, v209
    v_exp_f32 v210, v210
    v_smfmac_f32_32x32x32_bf16 v[128:143], v[72:75], v[192:199], v9
    v_exp_f32 v211, v211
    ds_write_b128 v5, v[176:179] offset:49152
    v_exp_f32 v212, v212
    v_exp_f32 v213, v213
    v_mfma_f32_32x32x16_bf16 v[224:239], v[68:71], v[52:55], v[224:239]
    ds_write_b128 v5, v[180:183] offset:50176
    v_exp_f32 v214, v214
    v_exp_f32 v215, v215
    v_exp_f32 v216, v216
    s_waitcnt lgkmcnt(2)
    v_mfma_f32_32x32x8_bf16 v[160:175], v[10:11], v[10:11], 0
    v_mov_b32 v20, 0
    v_smfmac_f32_16x16x64_bf16 v[12:15], v[28:31], v[192:199], v9
    ds_write_b32 v6, v24 offset:3072
    v_exp_f32 v217, v217
    v_smfmac_f32_32x32x32_bf16 v[128:143], v[76:79], v[200:207], v9
    ds_write_b128 v5, v[184:187] offset:51200
    v_exp_f32 v218, v218
    v_exp_f32 v219, v219
    v_exp_f32 v220, v220
    v_smfmac_f32_16x16x64_bf16 v[12:15], v[28:31], v[200:207], v9
    ds_write_b128 v5, v[188:191] offset:52224
    v_exp_f32 v221, v221
    v_exp_f32 v222, v222
    v_exp_f32 v223, v223
    s_waitcnt lgkmcnt(0)
    v_mfma_f32_32x32x8_bf16 v[176:191], v[10:11], v[10:11], 0
    v_mov_b32 v24, 0
    s_barrier
    s_mov_b32 s57, 1
    s_branch b_head
b_tail:
    v_smfmac_f32_32x32x32_bf16 v[176:191], v[120:123], v[240:247], v9
    v_smfmac_f32_16x16x64_bf16 v[24:27], v[28:31], v[240:247], v9
    v_smfmac_f32_32x32x32_bf16 v[176:191], v[124:127], v[248:255], v9
    v_smfmac_f32_16x16x64_bf16 v[24:27], v[28:31], v[248:255], v9
    s_nop 7
    ds_write_b128 v5, v[160:163] offset:32768
    ds_write_b128 v5, v[164:167] offset:33792
    ds_write_b128 v5, v[168:171] offset:34816
    ds_write_b128 v5, v[172:175] offset:35840
    ds_write_b32 v6, v20 offset:2048
    s_lshl_b32 s44, s21, 22
    s_lshl_b32 s45, s39, 16
    s_add_u32 s41, s44, s45
    s_lshl_b32 s45, s20, 12
    s_add_u32 s43, s41, s45
    s_and_b32 s45, s45, 0
    s_add_u32 s41, s41, s45
    s_add_u32 s41, s41, 16777216
    buffer_load_dwordx4 v[224:227], v2, s[4:7], s43 offen offset:0 sc1
    buffer_load_dwordx4 v[228:231], v2, s[4:7], s43 offen offset:256 sc1
    buffer_load_dwordx4 v[232:235], v2, s[4:7], s43 offen offset:2048 sc1
    buffer_load_dwordx4 v[236:239], v2, s[4:7], s43 offen offset:2304 sc1
    s_nop 3
    ds_write_b128 v5, v[176:179] offset:49152
    ds_write_b128 v5, v[180:183] offset:50176
    ds_write_b128 v5, v[184:187] offset:51200
    ds_write_b128 v5, v[188:191] offset:52224
    ds_write_b32 v6, v24 offset:3072
    s_waitcnt lgkmcnt(0)
    s_barrier
    v_xor_b32 v4, 32, v3
    v_xor_b32 v5, 64, v3
    v_xor_b32 v6, 96, v3
c_wo:
    s_xor_b32 s42, s41, 0
    buffer_load_dwordx4 v[64:67], v2, s[4:7], s42 offen offset:0 sc1
    buffer_load_dwordx4 v[68:71], v2, s[4:7], s42 offen offset:256 sc1
    s_xor_b32 s42, s41, 4096
    buffer_load_dwordx4 v[72:75], v2, s[4:7], s42 offen offset:0 sc1
    buffer_load_dwordx4 v[76:79], v2, s[4:7], s42 offen offset:256 sc1
    s_xor_b32 s42, s41, 8192
    buffer_load_dwordx4 v[80:83], v2, s[4:7], s42 offen offset:0 sc1
    buffer_load_dwordx4 v[84:87], v2, s[4:7], s42 offen offset:256 sc1
    s_xor_b32 s42, s41, 12288
    buffer_load_dwordx4 v[88:91], v2, s[4:7], s42 offen offset:0 sc1
    buffer_load_dwordx4 v[92:95], v2, s[4:7], s42 offen offset:256 sc1
    s_xor_b32 s42, s41, 16384
    buffer_load_dwordx4 v[96:99], v2, s[4:7], s42 offen offset:0 sc1
    buffer_load_dwordx4 v[100:103], v2, s[4:7], s42 offen offset:256 sc1
    ds_read_b64_tr_b16 v[32:33], v3 offset:0
    ds_read_b64_tr_b16 v[34:35], v3 offset:1024
    ds_read_b64_tr_b16 v[36:37], v4 offset:0
    ds_read_b64_tr_b16 v[38:39], v4 offset:1024
    ds_read_b64_tr_b16 v[40:41], v5 offset:0
    ds_read_b64_tr_b16 v[42:43], v5 offset:1024
    ds_read_b64_tr_b16 v[44:45], v6 offset:0
    ds_read_b64_tr_b16 v[46:47], v6 offset:1024
    ds_read_b64_tr_b16 v[48:49], v3 offset:4096
    ds_read_b64_tr_b16 v[50:51], v3 offset:5120
    ds_read_b64_tr_b16 v[52:53], v4 offset:4096
    ds_read_b64_tr_b16 v[54:55], v4 offset:5120
    ds_read_b64_tr_b16 v[56:57], v5 offset:4096
    ds_read_b64_tr_b16 v[58:59], v5 offset:5120
    v_lshrrev_b32 v12, 4, v1
    v_and_b32 v13, 1, v12
    v_lshlrev_b32 v13, 4, v13
    v_mov_b32 v14, 0x3f80
    v_lshlrev_b32 v13, v13, v14
    v_lshrrev_b32 v14, 2, v12
    v_lshrrev_b32 v15, 4, v12
    v_xor_b32 v14, v14, v15
    v_and_b32 v14, 1, v14
    v_bfe_u32 v15, v12, 3, 1
    v_bfe_u32 v16, v12, 1, 1
    v_lshl_add_u32 v15, v15, 1, v16
    v_lshrrev_b32 v16, 5, v12
    v_lshl_add_u32 v15, v16, 2, v15
    v_lshl_add_u32 v15, v14, 3, v15
    v_cmp_eq_u32 vcc, 0, v15
    s_nop 1
    v_cndmask_b32 v240, 0, v13, vcc
    v_cmp_eq_u32 vcc, 1, v15
    s_nop 1
    v_cndmask_b32 v241, 0, v13, vcc
    v_cmp_eq_u32 vcc, 2, v15
    s_nop 1
    v_cndmask_b32 v242, 0, v13, vcc
    v_cmp_eq_u32 vcc, 3, v15
    s_nop 1
    v_cndmask_b32 v243, 0, v13, vcc
    v_cmp_eq_u32 vcc, 4, v15
    s_nop 1
    v_cndmask_b32 v244, 0, v13, vcc
    v_cmp_eq_u32 vcc, 5, v15
    s_nop 1
    v_cndmask_b32 v245, 0, v13, vcc
    v_cmp_eq_u32 vcc, 6, v15
    s_nop 1
    v_cndmask_b32 v246, 0, v13, vcc
    v_cmp_eq_u32 vcc, 7, v15
    s_nop 1
    v_cndmask_b32 v247, 0, v13, vcc
    s_waitcnt vmcnt(10)
    v_mfma_f32_16x16x32_bf16 v[128:131], v[240:243], v[224:227], 0
    v_mfma_f32_16x16x32_bf16 v[132:135], v[240:243], v[228:231], 0
    v_mfma_f32_16x16x32_bf16 v[136:139], v[244:247], v[224:227], 0
    v_mfma_f32_16x16x32_bf16 v[140:143], v[244:247], v[228:231], 0
    v_mfma_f32_16x16x32_bf16 v[144:147], v[240:243], v[232:235], 0
    v_mfma_f32_16x16x32_bf16 v[148:151], v[240:243], v[236:239], 0
    v_mfma_f32_16x16x32_bf16 v[152:155], v[244:247], v[232:235], 0
    v_mfma_f32_16x16x32_bf16 v[156:159], v[244:247], v[236:239], 0
    s_waitcnt vmcnt(8) lgkmcnt(10)
    v_mfma_f32_16x16x32_bf16 v[128:131], v[32:35], v[64:67], v[128:131]
    ds_read_b64_tr_b16 v[60:61], v6 offset:4096
    s_xor_b32 s42, s41, 20480
    buffer_load_dwordx4 v[104:107], v2, s[4:7], s42 offen offset:0 sc1
    v_mfma_f32_16x16x32_bf16 v[132:135], v[32:35], v[68:71], v[132:135]
    ds_read_b64_tr_b16 v[62:63], v6 offset:5120
    v_mfma_f32_16x16x32_bf16 v[136:139], v[36:39], v[64:67], v[136:139]
    ds_read_b64_tr_b16 v[32:33], v3 offset:8192
    v_mfma_f32_16x16x32_bf16 v[140:143], v[36:39], v[68:71], v[140:143]
    ds_read_b64_tr_b16 v[34:35], v3 offset:9216
    s_waitcnt lgkmcnt(10)
    v_mfma_f32_16x16x32_bf16 v[144:147], v[40:43], v[64:67], v[144:147]
    ds_read_b64_tr_b16 v[36:37], v4 offset:8192
    buffer_load_dwordx4 v[108:111], v2, s[4:7], s42 offen offset:256 sc1
    v_mfma_f32_16x16x32_bf16 v[148:151], v[40:43], v[68:71], v[148:151]
    ds_read_b64_tr_b16 v[38:39], v4 offset:9216
    v_mfma_f32_16x16x32_bf16 v[152:155], v[44:47], v[64:67], v[152:155]
    ds_read_b64_tr_b16 v[40:41], v5 offset:8192
    v_mfma_f32_16x16x32_bf16 v[156:159], v[44:47], v[68:71], v[156:159]
    ds_read_b64_tr_b16 v[42:43], v5 offset:9216
    s_waitcnt vmcnt(8) lgkmcnt(10)
    v_mfma_f32_16x16x32_bf16 v[128:131], v[48:51], v[72:75], v[128:131]
    ds_read_b64_tr_b16 v[44:45], v6 offset:8192
    s_xor_b32 s42, s41, 24576
    buffer_load_dwordx4 v[112:115], v2, s[4:7], s42 offen offset:0 sc1
    v_mfma_f32_16x16x32_bf16 v[132:135], v[48:51], v[76:79], v[132:135]
    ds_read_b64_tr_b16 v[46:47], v6 offset:9216
    v_mfma_f32_16x16x32_bf16 v[136:139], v[52:55], v[72:75], v[136:139]
    ds_read_b64_tr_b16 v[48:49], v3 offset:12288
    v_mfma_f32_16x16x32_bf16 v[140:143], v[52:55], v[76:79], v[140:143]
    ds_read_b64_tr_b16 v[50:51], v3 offset:13312
    s_waitcnt lgkmcnt(10)
    v_mfma_f32_16x16x32_bf16 v[144:147], v[56:59], v[72:75], v[144:147]
    ds_read_b64_tr_b16 v[52:53], v4 offset:12288
    buffer_load_dwordx4 v[116:119], v2, s[4:7], s42 offen offset:256 sc1
    v_mfma_f32_16x16x32_bf16 v[148:151], v[56:59], v[76:79], v[148:151]
    ds_read_b64_tr_b16 v[54:55], v4 offset:13312
    v_mfma_f32_16x16x32_bf16 v[152:155], v[60:63], v[72:75], v[152:155]
    ds_read_b64_tr_b16 v[56:57], v5 offset:12288
    v_mfma_f32_16x16x32_bf16 v[156:159], v[60:63], v[76:79], v[156:159]
    ds_read_b64_tr_b16 v[58:59], v5 offset:13312
    s_waitcnt vmcnt(8) lgkmcnt(10)
    v_mfma_f32_16x16x32_bf16 v[128:131], v[32:35], v[80:83], v[128:131]
    ds_read_b64_tr_b16 v[60:61], v6 offset:12288
    s_xor_b32 s42, s41, 28672
    buffer_load_dwordx4 v[120:123], v2, s[4:7], s42 offen offset:0 sc1
    v_mfma_f32_16x16x32_bf16 v[132:135], v[32:35], v[84:87], v[132:135]
    ds_read_b64_tr_b16 v[62:63], v6 offset:13312
    v_mfma_f32_16x16x32_bf16 v[136:139], v[36:39], v[80:83], v[136:139]
    ds_read_b64_tr_b16 v[32:33], v3 offset:16384
    v_mfma_f32_16x16x32_bf16 v[140:143], v[36:39], v[84:87], v[140:143]
    ds_read_b64_tr_b16 v[34:35], v3 offset:17408
    s_waitcnt lgkmcnt(10)
    v_mfma_f32_16x16x32_bf16 v[144:147], v[40:43], v[80:83], v[144:147]
    ds_read_b64_tr_b16 v[36:37], v4 offset:16384
    buffer_load_dwordx4 v[124:127], v2, s[4:7], s42 offen offset:256 sc1
    v_mfma_f32_16x16x32_bf16 v[148:151], v[40:43], v[84:87], v[148:151]
    ds_read_b64_tr_b16 v[38:39], v4 offset:17408
    v_mfma_f32_16x16x32_bf16 v[152:155], v[44:47], v[80:83], v[152:155]
    ds_read_b64_tr_b16 v[40:41], v5 offset:16384
    v_mfma_f32_16x16x32_bf16 v[156:159], v[44:47], v[84:87], v[156:159]
    ds_read_b64_tr_b16 v[42:43], v5 offset:17408
    s_waitcnt vmcnt(8) lgkmcnt(10)
    v_mfma_f32_16x16x32_bf16 v[128:131], v[48:51], v[88:91], v[128:131]
    ds_read_b64_tr_b16 v[44:45], v6 offset:16384
    s_xor_b32 s42, s41, 32768
    buffer_load_dwordx4 v[160:163], v2, s[4:7], s42 offen offset:0 sc1
    v_mfma_f32_16x16x32_bf16 v[132:135], v[48:51], v[92:95], v[132:135]
    ds_read_b64_tr_b16 v[46:47], v6 offset:17408
    v_mfma_f32_16x16x32_bf16 v[136:139], v[52:55], v[88:91], v[136:139]
    ds_read_b64_tr_b16 v[48:49], v3 offset:20480
    v_mfma_f32_16x16x32_bf16 v[140:143], v[52:55], v[92:95], v[140:143]
    ds_read_b64_tr_b16 v[50:51], v3 offset:21504
    s_waitcnt lgkmcnt(10)
    v_mfma_f32_16x16x32_bf16 v[144:147], v[56:59], v[88:91], v[144:147]
    ds_read_b64_tr_b16 v[52:53], v4 offset:20480
    buffer_load_dwordx4 v[164:167], v2, s[4:7], s42 offen offset:256 sc1
    v_mfma_f32_16x16x32_bf16 v[148:151], v[56:59], v[92:95], v[148:151]
    ds_read_b64_tr_b16 v[54:55], v4 offset:21504
    v_mfma_f32_16x16x32_bf16 v[152:155], v[60:63], v[88:91], v[152:155]
    ds_read_b64_tr_b16 v[56:57], v5 offset:20480
    v_mfma_f32_16x16x32_bf16 v[156:159], v[60:63], v[92:95], v[156:159]
    ds_read_b64_tr_b16 v[58:59], v5 offset:21504
    s_waitcnt vmcnt(8) lgkmcnt(10)
    v_mfma_f32_16x16x32_bf16 v[128:131], v[32:35], v[96:99], v[128:131]
    ds_read_b64_tr_b16 v[60:61], v6 offset:20480
    s_xor_b32 s42, s41, 36864
    buffer_load_dwordx4 v[168:171], v2, s[4:7], s42 offen offset:0 sc1
    v_mfma_f32_16x16x32_bf16 v[132:135], v[32:35], v[100:103], v[132:135]
    ds_read_b64_tr_b16 v[62:63], v6 offset:21504
    v_mfma_f32_16x16x32_bf16 v[136:139], v[36:39], v[96:99], v[136:139]
    ds_read_b64_tr_b16 v[32:33], v3 offset:24576
    v_mfma_f32_16x16x32_bf16 v[140:143], v[36:39], v[100:103], v[140:143]
    ds_read_b64_tr_b16 v[34:35], v3 offset:25600
    s_waitcnt lgkmcnt(10)
    v_mfma_f32_16x16x32_bf16 v[144:147], v[40:43], v[96:99], v[144:147]
    ds_read_b64_tr_b16 v[36:37], v4 offset:24576
    buffer_load_dwordx4 v[172:175], v2, s[4:7], s42 offen offset:256 sc1
    v_mfma_f32_16x16x32_bf16 v[148:151], v[40:43], v[100:103], v[148:151]
    ds_read_b64_tr_b16 v[38:39], v4 offset:25600
    v_mfma_f32_16x16x32_bf16 v[152:155], v[44:47], v[96:99], v[152:155]
    ds_read_b64_tr_b16 v[40:41], v5 offset:24576
    v_mfma_f32_16x16x32_bf16 v[156:159], v[44:47], v[100:103], v[156:159]
    ds_read_b64_tr_b16 v[42:43], v5 offset:25600
    s_waitcnt vmcnt(8) lgkmcnt(10)
    v_mfma_f32_16x16x32_bf16 v[128:131], v[48:51], v[104:107], v[128:131]
    ds_read_b64_tr_b16 v[44:45], v6 offset:24576
    s_xor_b32 s42, s41, 40960
    buffer_load_dwordx4 v[176:179], v2, s[4:7], s42 offen offset:0 sc1
    v_mfma_f32_16x16x32_bf16 v[132:135], v[48:51], v[108:111], v[132:135]
    ds_read_b64_tr_b16 v[46:47], v6 offset:25600
    v_mfma_f32_16x16x32_bf16 v[136:139], v[52:55], v[104:107], v[136:139]
    ds_read_b64_tr_b16 v[48:49], v3 offset:28672
    v_mfma_f32_16x16x32_bf16 v[140:143], v[52:55], v[108:111], v[140:143]
    ds_read_b64_tr_b16 v[50:51], v3 offset:29696
    s_waitcnt lgkmcnt(10)
    v_mfma_f32_16x16x32_bf16 v[144:147], v[56:59], v[104:107], v[144:147]
    ds_read_b64_tr_b16 v[52:53], v4 offset:28672
    buffer_load_dwordx4 v[180:183], v2, s[4:7], s42 offen offset:256 sc1
    v_mfma_f32_16x16x32_bf16 v[148:151], v[56:59], v[108:111], v[148:151]
    ds_read_b64_tr_b16 v[54:55], v4 offset:29696
    v_mfma_f32_16x16x32_bf16 v[152:155], v[60:63], v[104:107], v[152:155]
    ds_read_b64_tr_b16 v[56:57], v5 offset:28672
    v_mfma_f32_16x16x32_bf16 v[156:159], v[60:63], v[108:111], v[156:159]
    ds_read_b64_tr_b16 v[58:59], v5 offset:29696
    s_waitcnt vmcnt(8) lgkmcnt(10)
    v_mfma_f32_16x16x32_bf16 v[128:131], v[32:35], v[112:115], v[128:131]
    ds_read_b64_tr_b16 v[60:61], v6 offset:28672
    s_xor_b32 s42, s41, 45056
    buffer_load_dwordx4 v[184:187], v2, s[4:7], s42 offen offset:0 sc1
    v_mfma_f32_16x16x32_bf16 v[132:135], v[32:35], v[116:119], v[132:135]
    ds_read_b64_tr_b16 v[62:63], v6 offset:29696
    v_mfma_f32_16x16x32_bf16 v[136:139], v[36:39], v[112:115], v[136:139]
    ds_read_b64_tr_b16 v[32:33], v3 offset:32768
    v_mfma_f32_16x16x32_bf16 v[140:143], v[36:39], v[116:119], v[140:143]
    ds_read_b64_tr_b16 v[34:35], v3 offset:33792
    s_waitcnt lgkmcnt(10)
    v_mfma_f32_16x16x32_bf16 v[144:147], v[40:43], v[112:115], v[144:147]
    ds_read_b64_tr_b16 v[36:37], v4 offset:32768
    buffer_load_dwordx4 v[188:191], v2, s[4:7], s42 offen offset:256 sc1
    v_mfma_f32_16x16x32_bf16 v[148:151], v[40:43], v[116:119], v[148:151]
    ds_read_b64_tr_b16 v[38:39], v4 offset:33792
    v_mfma_f32_16x16x32_bf16 v[152:155], v[44:47], v[112:115], v[152:155]
    ds_read_b64_tr_b16 v[40:41], v5 offset:32768
    v_mfma_f32_16x16x32_bf16 v[156:159], v[44:47], v[116:119], v[156:159]
    ds_read_b64_tr_b16 v[42:43], v5 offset:33792
    s_waitcnt vmcnt(8) lgkmcnt(10)
    v_mfma_f32_16x16x32_bf16 v[128:131], v[48:51], v[120:123], v[128:131]
    ds_read_b64_tr_b16 v[44:45], v6 offset:32768
    s_xor_b32 s42, s41, 49152
    buffer_load_dwordx4 v[64:67], v2, s[4:7], s42 offen offset:0 sc1
    v_mfma_f32_16x16x32_bf16 v[132:135], v[48:51], v[124:127], v[132:135]
    ds_read_b64_tr_b16 v[46:47], v6 offset:33792
    v_mfma_f32_16x16x32_bf16 v[136:139], v[52:55], v[120:123], v[136:139]
    ds_read_b64_tr_b16 v[48:49], v3 offset:36864
    v_mfma_f32_16x16x32_bf16 v[140:143], v[52:55], v[124:127], v[140:143]
    ds_read_b64_tr_b16 v[50:51], v3 offset:37888
    s_waitcnt lgkmcnt(10)
    v_mfma_f32_16x16x32_bf16 v[144:147], v[56:59], v[120:123], v[144:147]
    ds_read_b64_tr_b16 v[52:53], v4 offset:36864
    buffer_load_dwordx4 v[68:71], v2, s[4:7], s42 offen offset:256 sc1
    v_mfma_f32_16x16x32_bf16 v[148:151], v[56:59], v[124:127], v[148:151]
    ds_read_b64_tr_b16 v[54:55], v4 offset:37888
    v_mfma_f32_16x16x32_bf16 v[152:155], v[60:63], v[120:123], v[152:155]
    ds_read_b64_tr_b16 v[56:57], v5 offset:36864
    v_mfma_f32_16x16x32_bf16 v[156:159], v[60:63], v[124:127], v[156:159]
    ds_read_b64_tr_b16 v[58:59], v5 offset:37888
    s_waitcnt vmcnt(8) lgkmcnt(10)
    v_mfma_f32_16x16x32_bf16 v[128:131], v[32:35], v[160:163], v[128:131]
    ds_read_b64_tr_b16 v[60:61], v6 offset:36864
    s_xor_b32 s42, s41, 53248
    buffer_load_dwordx4 v[72:75], v2, s[4:7], s42 offen offset:0 sc1
    v_mfma_f32_16x16x32_bf16 v[132:135], v[32:35], v[164:167], v[132:135]
    ds_read_b64_tr_b16 v[62:63], v6 offset:37888
    v_mfma_f32_16x16x32_bf16 v[136:139], v[36:39], v[160:163], v[136:139]
    ds_read_b64_tr_b16 v[32:33], v3 offset:40960
    v_mfma_f32_16x16x32_bf16 v[140:143], v[36:39], v[164:167], v[140:143]
    ds_read_b64_tr_b16 v[34:35], v3 offset:41984
    s_waitcnt lgkmcnt(10)
    v_mfma_f32_16x16x32_bf16 v[144:147], v[40:43], v[160:163], v[144:147]
    ds_read_b64_tr_b16 v[36:37], v4 offset:40960
    buffer_load_dwordx4 v[76:79], v2, s[4:7], s42 offen offset:256 sc1
    v_mfma_f32_16x16x32_bf16 v[148:151], v[40:43], v[164:167], v[148:151]
    ds_read_b64_tr_b16 v[38:39], v4 offset:41984
    v_mfma_f32_16x16x32_bf16 v[152:155], v[44:47], v[160:163], v[152:155]
    ds_read_b64_tr_b16 v[40:41], v5 offset:40960
    v_mfma_f32_16x16x32_bf16 v[156:159], v[44:47], v[164:167], v[156:159]
    ds_read_b64_tr_b16 v[42:43], v5 offset:41984
    s_waitcnt vmcnt(8) lgkmcnt(10)
    v_mfma_f32_16x16x32_bf16 v[128:131], v[48:51], v[168:171], v[128:131]
    ds_read_b64_tr_b16 v[44:45], v6 offset:40960
    s_xor_b32 s42, s41, 57344
    buffer_load_dwordx4 v[80:83], v2, s[4:7], s42 offen offset:0 sc1
    v_mfma_f32_16x16x32_bf16 v[132:135], v[48:51], v[172:175], v[132:135]
    ds_read_b64_tr_b16 v[46:47], v6 offset:41984
    v_mfma_f32_16x16x32_bf16 v[136:139], v[52:55], v[168:171], v[136:139]
    ds_read_b64_tr_b16 v[48:49], v3 offset:45056
    v_mfma_f32_16x16x32_bf16 v[140:143], v[52:55], v[172:175], v[140:143]
    ds_read_b64_tr_b16 v[50:51], v3 offset:46080
    s_waitcnt lgkmcnt(10)
    v_mfma_f32_16x16x32_bf16 v[144:147], v[56:59], v[168:171], v[144:147]
    ds_read_b64_tr_b16 v[52:53], v4 offset:45056
    buffer_load_dwordx4 v[84:87], v2, s[4:7], s42 offen offset:256 sc1
    v_mfma_f32_16x16x32_bf16 v[148:151], v[56:59], v[172:175], v[148:151]
    ds_read_b64_tr_b16 v[54:55], v4 offset:46080
    v_mfma_f32_16x16x32_bf16 v[152:155], v[60:63], v[168:171], v[152:155]
    ds_read_b64_tr_b16 v[56:57], v5 offset:45056
    v_mfma_f32_16x16x32_bf16 v[156:159], v[60:63], v[172:175], v[156:159]
    ds_read_b64_tr_b16 v[58:59], v5 offset:46080
    s_waitcnt vmcnt(8) lgkmcnt(10)
    v_mfma_f32_16x16x32_bf16 v[128:131], v[32:35], v[176:179], v[128:131]
    ds_read_b64_tr_b16 v[60:61], v6 offset:45056
    s_xor_b32 s42, s41, 61440
    buffer_load_dwordx4 v[88:91], v2, s[4:7], s42 offen offset:0 sc1
    v_mfma_f32_16x16x32_bf16 v[132:135], v[32:35], v[180:183], v[132:135]
    ds_read_b64_tr_b16 v[62:63], v6 offset:46080
    s_barrier
    v_mfma_f32_16x16x32_bf16 v[136:139], v[36:39], v[176:179], v[136:139]
    ds_read_b64_tr_b16 v[32:33], v3 offset:49152
    v_mfma_f32_16x16x32_bf16 v[140:143], v[36:39], v[180:183], v[140:143]
    ds_read_b64_tr_b16 v[34:35], v3 offset:50176
    s_waitcnt lgkmcnt(10)
    v_mfma_f32_16x16x32_bf16 v[144:147], v[40:43], v[176:179], v[144:147]
    ds_read_b64_tr_b16 v[36:37], v4 offset:49152
    buffer_load_dwordx4 v[92:95], v2, s[4:7], s42 offen offset:256 sc1
    v_mfma_f32_16x16x32_bf16 v[148:151], v[40:43], v[180:183], v[148:151]
    ds_read_b64_tr_b16 v[38:39], v4 offset:50176
    v_mfma_f32_16x16x32_bf16 v[152:155], v[44:47], v[176:179], v[152:155]
    ds_read_b64_tr_b16 v[40:41], v5 offset:49152
    v_mfma_f32_16x16x32_bf16 v[156:159], v[44:47], v[180:183], v[156:159]
    ds_read_b64_tr_b16 v[42:43], v5 offset:50176
    s_waitcnt vmcnt(8) lgkmcnt(10)
    v_mfma_f32_16x16x32_bf16 v[128:131], v[48:51], v[184:187], v[128:131]
    ds_read_b64_tr_b16 v[44:45], v6 offset:49152
    s_xor_b32 s42, s41, 0
    buffer_load_dwordx4 v[96:99], v2, s[4:7], s42 offen offset:2048 sc1
    v_mfma_f32_16x16x32_bf16 v[132:135], v[48:51], v[188:191], v[132:135]
    ds_read_b64_tr_b16 v[46:47], v6 offset:50176
    v_mfma_f32_16x16x32_bf16 v[136:139], v[52:55], v[184:187], v[136:139]
    ds_read_b64_tr_b16 v[48:49], v3 offset:53248
    v_mfma_f32_16x16x32_bf16 v[140:143], v[52:55], v[188:191], v[140:143]
    ds_read_b64_tr_b16 v[50:51], v3 offset:54272
    s_waitcnt lgkmcnt(10)
    v_mfma_f32_16x16x32_bf16 v[144:147], v[56:59], v[184:187], v[144:147]
    ds_read_b64_tr_b16 v[52:53], v4 offset:53248
    buffer_load_dwordx4 v[100:103], v2, s[4:7], s42 offen offset:2304 sc1
    v_mfma_f32_16x16x32_bf16 v[148:151], v[56:59], v[188:191], v[148:151]
    ds_read_b64_tr_b16 v[54:55], v4 offset:54272
    v_mfma_f32_16x16x32_bf16 v[152:155], v[60:63], v[184:187], v[152:155]
    ds_read_b64_tr_b16 v[56:57], v5 offset:53248
    v_mfma_f32_16x16x32_bf16 v[156:159], v[60:63], v[188:191], v[156:159]
    ds_read_b64_tr_b16 v[58:59], v5 offset:54272
    s_waitcnt vmcnt(8) lgkmcnt(10)
    v_mfma_f32_16x16x32_bf16 v[128:131], v[32:35], v[64:67], v[128:131]
    ds_read_b64_tr_b16 v[60:61], v6 offset:53248
    s_xor_b32 s42, s41, 4096
    buffer_load_dwordx4 v[104:107], v2, s[4:7], s42 offen offset:2048 sc1
    v_mfma_f32_16x16x32_bf16 v[132:135], v[32:35], v[68:71], v[132:135]
    ds_read_b64_tr_b16 v[62:63], v6 offset:54272
    v_mfma_f32_16x16x32_bf16 v[136:139], v[36:39], v[64:67], v[136:139]
    ds_read_b64_tr_b16 v[32:33], v3 offset:57344
    v_mfma_f32_16x16x32_bf16 v[140:143], v[36:39], v[68:71], v[140:143]
    ds_read_b64_tr_b16 v[34:35], v3 offset:58368
    s_waitcnt lgkmcnt(10)
    v_mfma_f32_16x16x32_bf16 v[144:147], v[40:43], v[64:67], v[144:147]
    ds_read_b64_tr_b16 v[36:37], v4 offset:57344
    buffer_load_dwordx4 v[108:111], v2, s[4:7], s42 offen offset:2304 sc1
    v_mfma_f32_16x16x32_bf16 v[148:151], v[40:43], v[68:71], v[148:151]
    ds_read_b64_tr_b16 v[38:39], v4 offset:58368
    v_mfma_f32_16x16x32_bf16 v[152:155], v[44:47], v[64:67], v[152:155]
    ds_read_b64_tr_b16 v[40:41], v5 offset:57344
    v_mfma_f32_16x16x32_bf16 v[156:159], v[44:47], v[68:71], v[156:159]
    ds_read_b64_tr_b16 v[42:43], v5 offset:58368
    s_waitcnt vmcnt(8) lgkmcnt(10)
    v_mfma_f32_16x16x32_bf16 v[128:131], v[48:51], v[72:75], v[128:131]
    ds_read_b64_tr_b16 v[44:45], v6 offset:57344
    s_xor_b32 s42, s41, 8192
    buffer_load_dwordx4 v[112:115], v2, s[4:7], s42 offen offset:2048 sc1
    v_mfma_f32_16x16x32_bf16 v[132:135], v[48:51], v[76:79], v[132:135]
    ds_read_b64_tr_b16 v[46:47], v6 offset:58368
    v_mfma_f32_16x16x32_bf16 v[136:139], v[52:55], v[72:75], v[136:139]
    ds_read_b64_tr_b16 v[48:49], v3 offset:61440
    v_mfma_f32_16x16x32_bf16 v[140:143], v[52:55], v[76:79], v[140:143]
    ds_read_b64_tr_b16 v[50:51], v3 offset:62464
    s_waitcnt lgkmcnt(10)
    v_mfma_f32_16x16x32_bf16 v[144:147], v[56:59], v[72:75], v[144:147]
    ds_read_b64_tr_b16 v[52:53], v4 offset:61440
    buffer_load_dwordx4 v[116:119], v2, s[4:7], s42 offen offset:2304 sc1
    v_mfma_f32_16x16x32_bf16 v[148:151], v[56:59], v[76:79], v[148:151]
    ds_read_b64_tr_b16 v[54:55], v4 offset:62464
    v_mfma_f32_16x16x32_bf16 v[152:155], v[60:63], v[72:75], v[152:155]
    ds_read_b64_tr_b16 v[56:57], v5 offset:61440
    v_mfma_f32_16x16x32_bf16 v[156:159], v[60:63], v[76:79], v[156:159]
    ds_read_b64_tr_b16 v[58:59], v5 offset:62464
    s_waitcnt vmcnt(8) lgkmcnt(10)
    v_mfma_f32_16x16x32_bf16 v[128:131], v[32:35], v[80:83], v[128:131]
    ds_read_b64_tr_b16 v[60:61], v6 offset:61440
    s_xor_b32 s42, s41, 12288
    buffer_load_dwordx4 v[120:123], v2, s[4:7], s42 offen offset:2048 sc1
    v_mfma_f32_16x16x32_bf16 v[132:135], v[32:35], v[84:87], v[132:135]
    ds_read_b64_tr_b16 v[62:63], v6 offset:62464
    v_xor_b32 v3, 0x10000, v3
    v_xor_b32 v4, 0x10000, v4
    v_xor_b32 v5, 0x10000, v5
    v_xor_b32 v6, 0x10000, v6
    v_mfma_f32_16x16x32_bf16 v[136:139], v[36:39], v[80:83], v[136:139]
    ds_read_b64_tr_b16 v[32:33], v3 offset:0
    v_mfma_f32_16x16x32_bf16 v[140:143], v[36:39], v[84:87], v[140:143]
    ds_read_b64_tr_b16 v[34:35], v3 offset:1024
    s_waitcnt lgkmcnt(10)
    v_mfma_f32_16x16x32_bf16 v[144:147], v[40:43], v[80:83], v[144:147]
    ds_read_b64_tr_b16 v[36:37], v4 offset:0
    buffer_load_dwordx4 v[124:127], v2, s[4:7], s42 offen offset:2304 sc1
    v_mfma_f32_16x16x32_bf16 v[148:151], v[40:43], v[84:87], v[148:151]
    ds_read_b64_tr_b16 v[38:39], v4 offset:1024
    v_mfma_f32_16x16x32_bf16 v[152:155], v[44:47], v[80:83], v[152:155]
    ds_read_b64_tr_b16 v[40:41], v5 offset:0
    v_mfma_f32_16x16x32_bf16 v[156:159], v[44:47], v[84:87], v[156:159]
    ds_read_b64_tr_b16 v[42:43], v5 offset:1024
    s_waitcnt vmcnt(8) lgkmcnt(10)
    v_mfma_f32_16x16x32_bf16 v[128:131], v[48:51], v[88:91], v[128:131]
    ds_read_b64_tr_b16 v[44:45], v6 offset:0
    s_xor_b32 s42, s41, 16384
    buffer_load_dwordx4 v[160:163], v2, s[4:7], s42 offen offset:2048 sc1
    v_mfma_f32_16x16x32_bf16 v[132:135], v[48:51], v[92:95], v[132:135]
    ds_read_b64_tr_b16 v[46:47], v6 offset:1024
    v_mfma_f32_16x16x32_bf16 v[136:139], v[52:55], v[88:91], v[136:139]
    ds_read_b64_tr_b16 v[48:49], v3 offset:4096
    v_mfma_f32_16x16x32_bf16 v[140:143], v[52:55], v[92:95], v[140:143]
    ds_read_b64_tr_b16 v[50:51], v3 offset:5120
    s_waitcnt lgkmcnt(10)
    v_mfma_f32_16x16x32_bf16 v[144:147], v[56:59], v[88:91], v[144:147]
    ds_read_b64_tr_b16 v[52:53], v4 offset:4096
    buffer_load_dwordx4 v[164:167], v2, s[4:7], s42 offen offset:2304 sc1
    v_mfma_f32_16x16x32_bf16 v[148:151], v[56:59], v[92:95], v[148:151]
    ds_read_b64_tr_b16 v[54:55], v4 offset:5120
    v_mfma_f32_16x16x32_bf16 v[152:155], v[60:63], v[88:91], v[152:155]
    ds_read_b64_tr_b16 v[56:57], v5 offset:4096
    v_mfma_f32_16x16x32_bf16 v[156:159], v[60:63], v[92:95], v[156:159]
    ds_read_b64_tr_b16 v[58:59], v5 offset:5120
    s_waitcnt vmcnt(8) lgkmcnt(10)
    v_mfma_f32_16x16x32_bf16 v[128:131], v[32:35], v[96:99], v[128:131]
    ds_read_b64_tr_b16 v[60:61], v6 offset:4096
    s_xor_b32 s42, s41, 20480
    buffer_load_dwordx4 v[168:171], v2, s[4:7], s42 offen offset:2048 sc1
    v_mfma_f32_16x16x32_bf16 v[132:135], v[32:35], v[100:103], v[132:135]
    ds_read_b64_tr_b16 v[62:63], v6 offset:5120
    v_mfma_f32_16x16x32_bf16 v[136:139], v[36:39], v[96:99], v[136:139]
    ds_read_b64_tr_b16 v[32:33], v3 offset:8192
    v_mfma_f32_16x16x32_bf16 v[140:143], v[36:39], v[100:103], v[140:143]
    ds_read_b64_tr_b16 v[34:35], v3 offset:9216
    s_waitcnt lgkmcnt(10)
    v_mfma_f32_16x16x32_bf16 v[144:147], v[40:43], v[96:99], v[144:147]
    ds_read_b64_tr_b16 v[36:37], v4 offset:8192
    buffer_load_dwordx4 v[172:175], v2, s[4:7], s42 offen offset:2304 sc1
    v_mfma_f32_16x16x32_bf16 v[148:151], v[40:43], v[100:103], v[148:151]
    ds_read_b64_tr_b16 v[38:39], v4 offset:9216
    v_mfma_f32_16x16x32_bf16 v[152:155], v[44:47], v[96:99], v[152:155]
    ds_read_b64_tr_b16 v[40:41], v5 offset:8192
    v_mfma_f32_16x16x32_bf16 v[156:159], v[44:47], v[100:103], v[156:159]
    ds_read_b64_tr_b16 v[42:43], v5 offset:9216
    s_waitcnt vmcnt(8) lgkmcnt(10)
    v_mfma_f32_16x16x32_bf16 v[128:131], v[48:51], v[104:107], v[128:131]
    ds_read_b64_tr_b16 v[44:45], v6 offset:8192
    s_xor_b32 s42, s41, 24576
    buffer_load_dwordx4 v[176:179], v2, s[4:7], s42 offen offset:2048 sc1
    v_mfma_f32_16x16x32_bf16 v[132:135], v[48:51], v[108:111], v[132:135]
    ds_read_b64_tr_b16 v[46:47], v6 offset:9216
    v_mfma_f32_16x16x32_bf16 v[136:139], v[52:55], v[104:107], v[136:139]
    ds_read_b64_tr_b16 v[48:49], v3 offset:12288
    v_mfma_f32_16x16x32_bf16 v[140:143], v[52:55], v[108:111], v[140:143]
    ds_read_b64_tr_b16 v[50:51], v3 offset:13312
    s_waitcnt lgkmcnt(10)
    v_mfma_f32_16x16x32_bf16 v[144:147], v[56:59], v[104:107], v[144:147]
    ds_read_b64_tr_b16 v[52:53], v4 offset:12288
    buffer_load_dwordx4 v[180:183], v2, s[4:7], s42 offen offset:2304 sc1
    v_mfma_f32_16x16x32_bf16 v[148:151], v[56:59], v[108:111], v[148:151]
    ds_read_b64_tr_b16 v[54:55], v4 offset:13312
    v_mfma_f32_16x16x32_bf16 v[152:155], v[60:63], v[104:107], v[152:155]
    ds_read_b64_tr_b16 v[56:57], v5 offset:12288
    v_mfma_f32_16x16x32_bf16 v[156:159], v[60:63], v[108:111], v[156:159]
    ds_read_b64_tr_b16 v[58:59], v5 offset:13312
    s_waitcnt vmcnt(8) lgkmcnt(10)
    v_mfma_f32_16x16x32_bf16 v[128:131], v[32:35], v[112:115], v[128:131]
    ds_read_b64_tr_b16 v[60:61], v6 offset:12288
    s_xor_b32 s42, s41, 28672
    buffer_load_dwordx4 v[184:187], v2, s[4:7], s42 offen offset:2048 sc1
    v_mfma_f32_16x16x32_bf16 v[132:135], v[32:35], v[116:119], v[132:135]
    ds_read_b64_tr_b16 v[62:63], v6 offset:13312
    v_mfma_f32_16x16x32_bf16 v[136:139], v[36:39], v[112:115], v[136:139]
    ds_read_b64_tr_b16 v[32:33], v3 offset:16384
    v_mfma_f32_16x16x32_bf16 v[140:143], v[36:39], v[116:119], v[140:143]
    ds_read_b64_tr_b16 v[34:35], v3 offset:17408
    s_waitcnt lgkmcnt(10)
    v_mfma_f32_16x16x32_bf16 v[144:147], v[40:43], v[112:115], v[144:147]
    ds_read_b64_tr_b16 v[36:37], v4 offset:16384
    buffer_load_dwordx4 v[188:191], v2, s[4:7], s42 offen offset:2304 sc1
    v_mfma_f32_16x16x32_bf16 v[148:151], v[40:43], v[116:119], v[148:151]
    ds_read_b64_tr_b16 v[38:39], v4 offset:17408
    v_mfma_f32_16x16x32_bf16 v[152:155], v[44:47], v[112:115], v[152:155]
    ds_read_b64_tr_b16 v[40:41], v5 offset:16384
    v_mfma_f32_16x16x32_bf16 v[156:159], v[44:47], v[116:119], v[156:159]
    ds_read_b64_tr_b16 v[42:43], v5 offset:17408
    s_waitcnt vmcnt(8) lgkmcnt(10)
    v_mfma_f32_16x16x32_bf16 v[128:131], v[48:51], v[120:123], v[128:131]
    ds_read_b64_tr_b16 v[44:45], v6 offset:16384
    s_xor_b32 s42, s41, 32768
    buffer_load_dwordx4 v[64:67], v2, s[4:7], s42 offen offset:2048 sc1
    v_mfma_f32_16x16x32_bf16 v[132:135], v[48:51], v[124:127], v[132:135]
    ds_read_b64_tr_b16 v[46:47], v6 offset:17408
    v_mfma_f32_16x16x32_bf16 v[136:139], v[52:55], v[120:123], v[136:139]
    ds_read_b64_tr_b16 v[48:49], v3 offset:20480
    v_mfma_f32_16x16x32_bf16 v[140:143], v[52:55], v[124:127], v[140:143]
    ds_read_b64_tr_b16 v[50:51], v3 offset:21504
    s_waitcnt lgkmcnt(10)
    v_mfma_f32_16x16x32_bf16 v[144:147], v[56:59], v[120:123], v[144:147]
    ds_read_b64_tr_b16 v[52:53], v4 offset:20480
    buffer_load_dwordx4 v[68:71], v2, s[4:7], s42 offen offset:2304 sc1
    v_mfma_f32_16x16x32_bf16 v[148:151], v[56:59], v[124:127], v[148:151]
    ds_read_b64_tr_b16 v[54:55], v4 offset:21504
    v_mfma_f32_16x16x32_bf16 v[152:155], v[60:63], v[120:123], v[152:155]
    ds_read_b64_tr_b16 v[56:57], v5 offset:20480
    v_mfma_f32_16x16x32_bf16 v[156:159], v[60:63], v[124:127], v[156:159]
    ds_read_b64_tr_b16 v[58:59], v5 offset:21504
    s_waitcnt vmcnt(8) lgkmcnt(10)
    v_mfma_f32_16x16x32_bf16 v[128:131], v[32:35], v[160:163], v[128:131]
    ds_read_b64_tr_b16 v[60:61], v6 offset:20480
    s_xor_b32 s42, s41, 36864
    buffer_load_dwordx4 v[72:75], v2, s[4:7], s42 offen offset:2048 sc1
    v_mfma_f32_16x16x32_bf16 v[132:135], v[32:35], v[164:167], v[132:135]
    ds_read_b64_tr_b16 v[62:63], v6 offset:21504
    v_mfma_f32_16x16x32_bf16 v[136:139], v[36:39], v[160:163], v[136:139]
    ds_read_b64_tr_b16 v[32:33], v3 offset:24576
    v_mfma_f32_16x16x32_bf16 v[140:143], v[36:39], v[164:167], v[140:143]
    ds_read_b64_tr_b16 v[34:35], v3 offset:25600
    s_waitcnt lgkmcnt(10)
    v_mfma_f32_16x16x32_bf16 v[144:147], v[40:43], v[160:163], v[144:147]
    ds_read_b64_tr_b16 v[36:37], v4 offset:24576
    buffer_load_dwordx4 v[76:79], v2, s[4:7], s42 offen offset:2304 sc1
    v_mfma_f32_16x16x32_bf16 v[148:151], v[40:43], v[164:167], v[148:151]
    ds_read_b64_tr_b16 v[38:39], v4 offset:25600
    v_mfma_f32_16x16x32_bf16 v[152:155], v[44:47], v[160:163], v[152:155]
    ds_read_b64_tr_b16 v[40:41], v5 offset:24576
    v_mfma_f32_16x16x32_bf16 v[156:159], v[44:47], v[164:167], v[156:159]
    ds_read_b64_tr_b16 v[42:43], v5 offset:25600
    s_waitcnt vmcnt(8) lgkmcnt(10)
    v_mfma_f32_16x16x32_bf16 v[128:131], v[48:51], v[168:171], v[128:131]
    ds_read_b64_tr_b16 v[44:45], v6 offset:24576
    s_xor_b32 s42, s41, 40960
    buffer_load_dwordx4 v[80:83], v2, s[4:7], s42 offen offset:2048 sc1
    v_mfma_f32_16x16x32_bf16 v[132:135], v[48:51], v[172:175], v[132:135]
    ds_read_b64_tr_b16 v[46:47], v6 offset:25600
    v_mfma_f32_16x16x32_bf16 v[136:139], v[52:55], v[168:171], v[136:139]
    ds_read_b64_tr_b16 v[48:49], v3 offset:28672
    v_mfma_f32_16x16x32_bf16 v[140:143], v[52:55], v[172:175], v[140:143]
    ds_read_b64_tr_b16 v[50:51], v3 offset:29696
    s_waitcnt lgkmcnt(10)
    v_mfma_f32_16x16x32_bf16 v[144:147], v[56:59], v[168:171], v[144:147]
    ds_read_b64_tr_b16 v[52:53], v4 offset:28672
    buffer_load_dwordx4 v[84:87], v2, s[4:7], s42 offen offset:2304 sc1
    v_mfma_f32_16x16x32_bf16 v[148:151], v[56:59], v[172:175], v[148:151]
    ds_read_b64_tr_b16 v[54:55], v4 offset:29696
    v_mfma_f32_16x16x32_bf16 v[152:155], v[60:63], v[168:171], v[152:155]
    ds_read_b64_tr_b16 v[56:57], v5 offset:28672
    v_mfma_f32_16x16x32_bf16 v[156:159], v[60:63], v[172:175], v[156:159]
    ds_read_b64_tr_b16 v[58:59], v5 offset:29696
    s_waitcnt vmcnt(8) lgkmcnt(10)
    v_mfma_f32_16x16x32_bf16 v[128:131], v[32:35], v[176:179], v[128:131]
    ds_read_b64_tr_b16 v[60:61], v6 offset:28672
    s_xor_b32 s42, s41, 45056
    buffer_load_dwordx4 v[88:91], v2, s[4:7], s42 offen offset:2048 sc1
    v_mfma_f32_16x16x32_bf16 v[132:135], v[32:35], v[180:183], v[132:135]
    ds_read_b64_tr_b16 v[62:63], v6 offset:29696
    v_mfma_f32_16x16x32_bf16 v[136:139], v[36:39], v[176:179], v[136:139]
    ds_read_b64_tr_b16 v[32:33], v3 offset:32768
    v_mfma_f32_16x16x32_bf16 v[140:143], v[36:39], v[180:183], v[140:143]
    ds_read_b64_tr_b16 v[34:35], v3 offset:33792
    s_waitcnt lgkmcnt(10)
    v_mfma_f32_16x16x32_bf16 v[144:147], v[40:43], v[176:179], v[144:147]
    ds_read_b64_tr_b16 v[36:37], v4 offset:32768
    buffer_load_dwordx4 v[92:95], v2, s[4:7], s42 offen offset:2304 sc1
    v_mfma_f32_16x16x32_bf16 v[148:151], v[40:43], v[180:183], v[148:151]
    ds_read_b64_tr_b16 v[38:39], v4 offset:33792
    v_mfma_f32_16x16x32_bf16 v[152:155], v[44:47], v[176:179], v[152:155]
    ds_read_b64_tr_b16 v[40:41], v5 offset:32768
    v_mfma_f32_16x16x32_bf16 v[156:159], v[44:47], v[180:183], v[156:159]
    ds_read_b64_tr_b16 v[42:43], v5 offset:33792
    s_waitcnt vmcnt(8) lgkmcnt(10)
    v_mfma_f32_16x16x32_bf16 v[128:131], v[48:51], v[184:187], v[128:131]
    ds_read_b64_tr_b16 v[44:45], v6 offset:32768
    s_xor_b32 s42, s41, 49152
    buffer_load_dwordx4 v[96:99], v2, s[4:7], s42 offen offset:2048 sc1
    v_mfma_f32_16x16x32_bf16 v[132:135], v[48:51], v[188:191], v[132:135]
    ds_read_b64_tr_b16 v[46:47], v6 offset:33792
    v_mfma_f32_16x16x32_bf16 v[136:139], v[52:55], v[184:187], v[136:139]
    ds_read_b64_tr_b16 v[48:49], v3 offset:36864
    v_mfma_f32_16x16x32_bf16 v[140:143], v[52:55], v[188:191], v[140:143]
    ds_read_b64_tr_b16 v[50:51], v3 offset:37888
    s_waitcnt lgkmcnt(10)
    v_mfma_f32_16x16x32_bf16 v[144:147], v[56:59], v[184:187], v[144:147]
    ds_read_b64_tr_b16 v[52:53], v4 offset:36864
    buffer_load_dwordx4 v[100:103], v2, s[4:7], s42 offen offset:2304 sc1
    v_mfma_f32_16x16x32_bf16 v[148:151], v[56:59], v[188:191], v[148:151]
    ds_read_b64_tr_b16 v[54:55], v4 offset:37888
    v_mfma_f32_16x16x32_bf16 v[152:155], v[60:63], v[184:187], v[152:155]
    ds_read_b64_tr_b16 v[56:57], v5 offset:36864
    v_mfma_f32_16x16x32_bf16 v[156:159], v[60:63], v[188:191], v[156:159]
    ds_read_b64_tr_b16 v[58:59], v5 offset:37888
    s_waitcnt vmcnt(8) lgkmcnt(10)
    v_mfma_f32_16x16x32_bf16 v[128:131], v[32:35], v[64:67], v[128:131]
    ds_read_b64_tr_b16 v[60:61], v6 offset:36864
    s_xor_b32 s42, s41, 53248
    buffer_load_dwordx4 v[104:107], v2, s[4:7], s42 offen offset:2048 sc1
    v_mfma_f32_16x16x32_bf16 v[132:135], v[32:35], v[68:71], v[132:135]
    ds_read_b64_tr_b16 v[62:63], v6 offset:37888
    v_mfma_f32_16x16x32_bf16 v[136:139], v[36:39], v[64:67], v[136:139]
    ds_read_b64_tr_b16 v[32:33], v3 offset:40960
    v_mfma_f32_16x16x32_bf16 v[140:143], v[36:39], v[68:71], v[140:143]
    ds_read_b64_tr_b16 v[34:35], v3 offset:41984
    s_waitcnt lgkmcnt(10)
    v_mfma_f32_16x16x32_bf16 v[144:147], v[40:43], v[64:67], v[144:147]
    ds_read_b64_tr_b16 v[36:37], v4 offset:40960
    buffer_load_dwordx4 v[108:111], v2, s[4:7], s42 offen offset:2304 sc1
    v_mfma_f32_16x16x32_bf16 v[148:151], v[40:43], v[68:71], v[148:151]
    ds_read_b64_tr_b16 v[38:39], v4 offset:41984
    v_mfma_f32_16x16x32_bf16 v[152:155], v[44:47], v[64:67], v[152:155]
    ds_read_b64_tr_b16 v[40:41], v5 offset:40960
    v_mfma_f32_16x16x32_bf16 v[156:159], v[44:47], v[68:71], v[156:159]
    ds_read_b64_tr_b16 v[42:43], v5 offset:41984
    s_waitcnt vmcnt(8) lgkmcnt(10)
    v_mfma_f32_16x16x32_bf16 v[128:131], v[48:51], v[72:75], v[128:131]
    ds_read_b64_tr_b16 v[44:45], v6 offset:40960
    s_xor_b32 s42, s41, 57344
    buffer_load_dwordx4 v[112:115], v2, s[4:7], s42 offen offset:2048 sc1
    v_mfma_f32_16x16x32_bf16 v[132:135], v[48:51], v[76:79], v[132:135]
    ds_read_b64_tr_b16 v[46:47], v6 offset:41984
    v_mfma_f32_16x16x32_bf16 v[136:139], v[52:55], v[72:75], v[136:139]
    ds_read_b64_tr_b16 v[48:49], v3 offset:45056
    v_mfma_f32_16x16x32_bf16 v[140:143], v[52:55], v[76:79], v[140:143]
    ds_read_b64_tr_b16 v[50:51], v3 offset:46080
    s_waitcnt lgkmcnt(10)
    v_mfma_f32_16x16x32_bf16 v[144:147], v[56:59], v[72:75], v[144:147]
    ds_read_b64_tr_b16 v[52:53], v4 offset:45056
    buffer_load_dwordx4 v[116:119], v2, s[4:7], s42 offen offset:2304 sc1
    v_mfma_f32_16x16x32_bf16 v[148:151], v[56:59], v[76:79], v[148:151]
    ds_read_b64_tr_b16 v[54:55], v4 offset:46080
    v_mfma_f32_16x16x32_bf16 v[152:155], v[60:63], v[72:75], v[152:155]
    ds_read_b64_tr_b16 v[56:57], v5 offset:45056
    v_mfma_f32_16x16x32_bf16 v[156:159], v[60:63], v[76:79], v[156:159]
    ds_read_b64_tr_b16 v[58:59], v5 offset:46080
    s_waitcnt vmcnt(8) lgkmcnt(10)
    v_mfma_f32_16x16x32_bf16 v[128:131], v[32:35], v[80:83], v[128:131]
    ds_read_b64_tr_b16 v[60:61], v6 offset:45056
    s_xor_b32 s42, s41, 61440
    buffer_load_dwordx4 v[120:123], v2, s[4:7], s42 offen offset:2048 sc1
    v_mfma_f32_16x16x32_bf16 v[132:135], v[32:35], v[84:87], v[132:135]
    ds_read_b64_tr_b16 v[62:63], v6 offset:46080
    v_mfma_f32_16x16x32_bf16 v[136:139], v[36:39], v[80:83], v[136:139]
    ds_read_b64_tr_b16 v[32:33], v3 offset:49152
    v_mfma_f32_16x16x32_bf16 v[140:143], v[36:39], v[84:87], v[140:143]
    ds_read_b64_tr_b16 v[34:35], v3 offset:50176
    s_waitcnt lgkmcnt(10)
    v_mfma_f32_16x16x32_bf16 v[144:147], v[40:43], v[80:83], v[144:147]
    ds_read_b64_tr_b16 v[36:37], v4 offset:49152
    buffer_load_dwordx4 v[124:127], v2, s[4:7], s42 offen offset:2304 sc1
    v_mfma_f32_16x16x32_bf16 v[148:151], v[40:43], v[84:87], v[148:151]
    ds_read_b64_tr_b16 v[38:39], v4 offset:50176
    v_mfma_f32_16x16x32_bf16 v[152:155], v[44:47], v[80:83], v[152:155]
    ds_read_b64_tr_b16 v[40:41], v5 offset:49152
    v_mfma_f32_16x16x32_bf16 v[156:159], v[44:47], v[84:87], v[156:159]
    ds_read_b64_tr_b16 v[42:43], v5 offset:50176
    s_waitcnt vmcnt(8) lgkmcnt(10)
    v_mfma_f32_16x16x32_bf16 v[128:131], v[48:51], v[88:91], v[128:131]
    ds_read_b64_tr_b16 v[44:45], v6 offset:49152
    v_mfma_f32_16x16x32_bf16 v[132:135], v[48:51], v[92:95], v[132:135]
    ds_read_b64_tr_b16 v[46:47], v6 offset:50176
    v_mfma_f32_16x16x32_bf16 v[136:139], v[52:55], v[88:91], v[136:139]
    ds_read_b64_tr_b16 v[48:49], v3 offset:53248
    v_mfma_f32_16x16x32_bf16 v[140:143], v[52:55], v[92:95], v[140:143]
    ds_read_b64_tr_b16 v[50:51], v3 offset:54272
    s_waitcnt lgkmcnt(10)
    v_mfma_f32_16x16x32_bf16 v[144:147], v[56:59], v[88:91], v[144:147]
    ds_read_b64_tr_b16 v[52:53], v4 offset:53248
    v_mfma_f32_16x16x32_bf16 v[148:151], v[56:59], v[92:95], v[148:151]
    ds_read_b64_tr_b16 v[54:55], v4 offset:54272
    v_mfma_f32_16x16x32_bf16 v[152:155], v[60:63], v[88:91], v[152:155]
    ds_read_b64_tr_b16 v[56:57], v5 offset:53248
    v_mfma_f32_16x16x32_bf16 v[156:159], v[60:63], v[92:95], v[156:159]
    ds_read_b64_tr_b16 v[58:59], v5 offset:54272
    s_waitcnt vmcnt(6) lgkmcnt(10)
    v_mfma_f32_16x16x32_bf16 v[128:131], v[32:35], v[96:99], v[128:131]
    ds_read_b64_tr_b16 v[60:61], v6 offset:53248
    v_mfma_f32_16x16x32_bf16 v[132:135], v[32:35], v[100:103], v[132:135]
    ds_read_b64_tr_b16 v[62:63], v6 offset:54272
    v_mfma_f32_16x16x32_bf16 v[136:139], v[36:39], v[96:99], v[136:139]
    ds_read_b64_tr_b16 v[32:33], v3 offset:57344
    v_mfma_f32_16x16x32_bf16 v[140:143], v[36:39], v[100:103], v[140:143]
    ds_read_b64_tr_b16 v[34:35], v3 offset:58368
    s_waitcnt lgkmcnt(10)
    v_mfma_f32_16x16x32_bf16 v[144:147], v[40:43], v[96:99], v[144:147]
    ds_read_b64_tr_b16 v[36:37], v4 offset:57344
    v_mfma_f32_16x16x32_bf16 v[148:151], v[40:43], v[100:103], v[148:151]
    ds_read_b64_tr_b16 v[38:39], v4 offset:58368
    v_mfma_f32_16x16x32_bf16 v[152:155], v[44:47], v[96:99], v[152:155]
    ds_read_b64_tr_b16 v[40:41], v5 offset:57344
    v_mfma_f32_16x16x32_bf16 v[156:159], v[44:47], v[100:103], v[156:159]
    ds_read_b64_tr_b16 v[42:43], v5 offset:58368
    s_waitcnt vmcnt(4) lgkmcnt(10)
    v_mfma_f32_16x16x32_bf16 v[128:131], v[48:51], v[104:107], v[128:131]
    ds_read_b64_tr_b16 v[44:45], v6 offset:57344
    v_mfma_f32_16x16x32_bf16 v[132:135], v[48:51], v[108:111], v[132:135]
    ds_read_b64_tr_b16 v[46:47], v6 offset:58368
    v_mfma_f32_16x16x32_bf16 v[136:139], v[52:55], v[104:107], v[136:139]
    ds_read_b64_tr_b16 v[48:49], v3 offset:61440
    v_mfma_f32_16x16x32_bf16 v[140:143], v[52:55], v[108:111], v[140:143]
    ds_read_b64_tr_b16 v[50:51], v3 offset:62464
    s_waitcnt lgkmcnt(10)
    v_mfma_f32_16x16x32_bf16 v[144:147], v[56:59], v[104:107], v[144:147]
    ds_read_b64_tr_b16 v[52:53], v4 offset:61440
    v_mfma_f32_16x16x32_bf16 v[148:151], v[56:59], v[108:111], v[148:151]
    ds_read_b64_tr_b16 v[54:55], v4 offset:62464
    v_mfma_f32_16x16x32_bf16 v[152:155], v[60:63], v[104:107], v[152:155]
    ds_read_b64_tr_b16 v[56:57], v5 offset:61440
    v_mfma_f32_16x16x32_bf16 v[156:159], v[60:63], v[108:111], v[156:159]
    ds_read_b64_tr_b16 v[58:59], v5 offset:62464
    s_waitcnt vmcnt(2) lgkmcnt(10)
    v_mfma_f32_16x16x32_bf16 v[128:131], v[32:35], v[112:115], v[128:131]
    ds_read_b64_tr_b16 v[60:61], v6 offset:61440
    v_mfma_f32_16x16x32_bf16 v[132:135], v[32:35], v[116:119], v[132:135]
    ds_read_b64_tr_b16 v[62:63], v6 offset:62464
    v_xor_b32 v3, 0x10000, v3
    v_xor_b32 v4, 0x10000, v4
    v_xor_b32 v5, 0x10000, v5
    v_xor_b32 v6, 0x10000, v6
    v_mfma_f32_16x16x32_bf16 v[136:139], v[36:39], v[112:115], v[136:139]
    v_mfma_f32_16x16x32_bf16 v[140:143], v[36:39], v[116:119], v[140:143]
    s_waitcnt lgkmcnt(8)
    v_mfma_f32_16x16x32_bf16 v[144:147], v[40:43], v[112:115], v[144:147]
    v_mfma_f32_16x16x32_bf16 v[148:151], v[40:43], v[116:119], v[148:151]
    v_mfma_f32_16x16x32_bf16 v[152:155], v[44:47], v[112:115], v[152:155]
    v_mfma_f32_16x16x32_bf16 v[156:159], v[44:47], v[116:119], v[156:159]
    s_waitcnt vmcnt(0) lgkmcnt(4)
    v_mfma_f32_16x16x32_bf16 v[128:131], v[48:51], v[120:123], v[128:131]
    v_mfma_f32_16x16x32_bf16 v[132:135], v[48:51], v[124:127], v[132:135]
    v_mfma_f32_16x16x32_bf16 v[136:139], v[52:55], v[120:123], v[136:139]
    v_mfma_f32_16x16x32_bf16 v[140:143], v[52:55], v[124:127], v[140:143]
    s_waitcnt lgkmcnt(0)
    v_mfma_f32_16x16x32_bf16 v[144:147], v[56:59], v[120:123], v[144:147]
    v_mfma_f32_16x16x32_bf16 v[148:151], v[56:59], v[124:127], v[148:151]
    v_mfma_f32_16x16x32_bf16 v[152:155], v[60:63], v[120:123], v[152:155]
    v_mfma_f32_16x16x32_bf16 v[156:159], v[60:63], v[124:127], v[156:159]
    s_cmp_eq_u32 s21, 3
    s_cbranch_scc1 c_final
    s_add_u32 s43, s43, 4194304
    v_cvt_pk_bf16_f32 v160, v128, v129
    v_cvt_pk_bf16_f32 v161, v130, v131
    v_cvt_pk_bf16_f32 v162, v136, v137
    v_cvt_pk_bf16_f32 v163, v138, v139
    v_cvt_pk_bf16_f32 v168, v144, v145
    v_cvt_pk_bf16_f32 v169, v146, v147
    v_cvt_pk_bf16_f32 v170, v152, v153
    v_cvt_pk_bf16_f32 v171, v154, v155
    v_permlane32_swap_b32 v160, v162
    v_permlane32_swap_b32 v161, v163
    buffer_store_dwordx4 v[160:163], v2, s[4:7], s43 offen offset:0 sc1
    v_permlane32_swap_b32 v168, v170
    v_permlane32_swap_b32 v169, v171
    buffer_store_dwordx4 v[168:171], v2, s[4:7], s43 offen offset:2048 sc1
    v_cvt_pk_bf16_f32 v164, v132, v133
    v_cvt_pk_bf16_f32 v165, v134, v135
    v_cvt_pk_bf16_f32 v166, v140, v141
    v_cvt_pk_bf16_f32 v167, v142, v143
    v_cvt_pk_bf16_f32 v172, v148, v149
    v_cvt_pk_bf16_f32 v173, v150, v151
    v_cvt_pk_bf16_f32 v174, v156, v157
    v_cvt_pk_bf16_f32 v175, v158, v159
    v_permlane32_swap_b32 v164, v166
    v_permlane32_swap_b32 v165, v167
    buffer_store_dwordx4 v[164:167], v2, s[4:7], s43 offen offset:256 sc1
    v_permlane32_swap_b32 v172, v174
    v_permlane32_swap_b32 v173, v175
    buffer_store_dwordx4 v[172:175], v2, s[4:7], s43 offen offset:2304 sc1
    s_barrier
    v_mov_b32 v12, 0x3f803f80
    v_mov_b32 v14, 0
    v_mov_b32 v15, 0
    v_mov_b32 v16, 0
    v_mov_b32 v17, 0
    v_dot2_f32_bf16 v14, v160, v12, v14
    v_dot2_f32_bf16 v15, v160, v160, v15
    v_dot2_f32_bf16 v16, v164, v12, v16
    v_dot2_f32_bf16 v17, v164, v164, v17
    v_dot2_f32_bf16 v14, v161, v12, v14
    v_dot2_f32_bf16 v15, v161, v161, v15
    v_dot2_f32_bf16 v16, v165, v12, v16
    v_dot2_f32_bf16 v17, v165, v165, v17
    v_dot2_f32_bf16 v14, v162, v12, v14
    v_dot2_f32_bf16 v15, v162, v162, v15
    v_dot2_f32_bf16 v16, v166, v12, v16
    v_dot2_f32_bf16 v17, v166, v166, v17
    v_dot2_f32_bf16 v14, v163, v12, v14
    v_dot2_f32_bf16 v15, v163, v163, v15
    v_dot2_f32_bf16 v16, v167, v12, v16
    v_dot2_f32_bf16 v17, v167, v167, v17
    v_dot2_f32_bf16 v14, v168, v12, v14
    v_dot2_f32_bf16 v15, v168, v168, v15
    v_dot2_f32_bf16 v16, v172, v12, v16
    v_dot2_f32_bf16 v17, v172, v172, v17
    v_dot2_f32_bf16 v14, v169, v12, v14
    v_dot2_f32_bf16 v15, v169, v169, v15
    v_dot2_f32_bf16 v16, v173, v12, v16
    v_dot2_f32_bf16 v17, v173, v173, v17
    v_dot2_f32_bf16 v14, v170, v12, v14
    v_dot2_f32_bf16 v15, v170, v170, v15
    v_dot2_f32_bf16 v16, v174, v12, v16
    v_dot2_f32_bf16 v17, v174, v174, v17
    v_dot2_f32_bf16 v14, v171, v12, v14
    v_dot2_f32_bf16 v15, v171, v171, v15
    v_dot2_f32_bf16 v16, v175, v12, v16
    v_dot2_f32_bf16 v17, v175, v175, v17
    s_nop 2
    v_permlane16_swap_b32 v14, v16
    v_permlane16_swap_b32 v15, v17
    v_pk_add_f32 v[14:15], v[14:15], v[16:17]
    v_mov_b32 v16, v14
    v_mov_b32 v17, v15
    s_nop 0
    v_permlane32_swap_b32 v14, v16
    v_permlane32_swap_b32 v15, v17
    v_pk_add_f32 v[14:15], v[14:15], v[16:17]
    v_lshrrev_b32 v13, 1, v1
    v_and_b32 v13, 0xf8, v13
    s_add_u32 s21, s21, 1
    s_lshl_b32 s44, s21, 18
    s_lshl_b32 s45, s39, 12
    s_add_u32 s44, s44, s45
    s_lshl_b32 s45, s20, 8
    s_add_u32 s44, s44, s45
    s_add_u32 s44, s44, 50331648
    buffer_store_dwordx2 v[14:15], v13, s[4:7], s44 offen sc1
    s_lshl_b32 s46, s21, 14
    s_lshl_b32 s67, s39, 7
    s_add_u32 s46, s46, s67
    s_add_u32 s46, s46, 4096
    s_add_u32 s47, s46, 8192
    s_waitcnt vmcnt(1)
    s_atomic_add s40, s[22:23], s46
    s_branch c_layer
c_final:
    s_mov_b32 s8, s32
    s_mov_b32 s9, s33
    s_mov_b32 s10, 4194304
    s_mov_b32 s11, 0x00020000
    v_lshrrev_b32 v12, 4, v1
    s_mul_i32 s44, s16, 4608
    s_add_u32 s44, s44, 131072
    v_and_b32 v13, 15, v12
    v_mul_u32_u24 v13, 144, v13
    v_lshrrev_b32 v14, 4, v12
    v_lshl_add_u32 v13, v14, 3, v13
    v_add_u32 v13, s44, v13
    v_cvt_pk_bf16_f32 v128, v128, v129
    v_cvt_pk_bf16_f32 v129, v130, v131
    ds_write_b64 v13, v[128:129] offset:0
    v_cvt_pk_bf16_f32 v136, v136, v137
    v_cvt_pk_bf16_f32 v137, v138, v139
    ds_write_b64 v13, v[136:137] offset:32
    v_cvt_pk_bf16_f32 v144, v144, v145
    v_cvt_pk_bf16_f32 v145, v146, v147
    ds_write_b64 v13, v[144:145] offset:64
    v_cvt_pk_bf16_f32 v152, v152, v153
    v_cvt_pk_bf16_f32 v153, v154, v155
    ds_write_b64 v13, v[152:153] offset:96
    v_cvt_pk_bf16_f32 v132, v132, v133
    v_cvt_pk_bf16_f32 v133, v134, v135
    ds_write_b64 v13, v[132:133] offset:2304
    v_cvt_pk_bf16_f32 v140, v140, v141
    v_cvt_pk_bf16_f32 v141, v142, v143
    ds_write_b64 v13, v[140:141] offset:2336
    v_cvt_pk_bf16_f32 v148, v148, v149
    v_cvt_pk_bf16_f32 v149, v150, v151
    ds_write_b64 v13, v[148:149] offset:2368
    v_cvt_pk_bf16_f32 v156, v156, v157
    v_cvt_pk_bf16_f32 v157, v158, v159
    ds_write_b64 v13, v[156:157] offset:2400
    v_lshrrev_b32 v14, 3, v12
    v_and_b32 v15, 7, v12
    v_mul_u32_u24 v16, 144, v14
    v_lshl_add_u32 v16, v15, 4, v16
    v_add_u32 v16, s44, v16
    v_lshlrev_b32 v17, 11, v14
    v_lshl_add_u32 v17, v15, 4, v17
    ds_read_b128 v[32:35], v16 offset:0
    ds_read_b128 v[36:39], v16 offset:1152
    ds_read_b128 v[40:43], v16 offset:2304
    ds_read_b128 v[44:47], v16 offset:3456
    s_lshl_b32 s44, s39, 16
    s_lshl_b32 s45, s20, 7
    s_add_u32 s44, s44, s45
    s_waitcnt lgkmcnt(3)
    buffer_store_dwordx4 v[32:35], v17, s[8:11], s44 offen sc1
    s_add_u32 s44, s44, 16384
    s_waitcnt lgkmcnt(2)
    buffer_store_dwordx4 v[36:39], v17, s[8:11], s44 offen sc1
    s_add_u32 s44, s44, 16384
    s_waitcnt lgkmcnt(1)
    buffer_store_dwordx4 v[40:43], v17, s[8:11], s44 offen sc1
    s_add_u32 s44, s44, 16384
    s_waitcnt lgkmcnt(0)
    buffer_store_dwordx4 v[44:47], v17, s[8:11], s44 offen sc1
    s_endpgm
h_start:
    v_mov_b32 v20, 0
    v_mov_b32 v21, 0
    v_mov_b32 v22, 0
    v_mov_b32 v23, 0
    s_cmp_lt_u32 s2, 6
    s_cbranch_scc0 h_z0
    s_load_dword s101, s[34:35], 192
    s_lshl_b32 s44, s2, 11
    s_cmp_ge_u32 s2, 2
    s_cselect_b32 s3, 8192, 0
    s_add_u32 s44, s44, s3
    s_mov_b32 s45, 0
    s_atomic_swap s45, s[22:23], s44 offset:0
    s_atomic_swap s45, s[22:23], s44 offset:128
    s_atomic_swap s45, s[22:23], s44 offset:256
    s_atomic_swap s45, s[22:23], s44 offset:384
    s_atomic_swap s45, s[22:23], s44 offset:512
    s_atomic_swap s45, s[22:23], s44 offset:640
    s_atomic_swap s45, s[22:23], s44 offset:768
    s_atomic_swap s45, s[22:23], s44 offset:896
    s_atomic_swap s45, s[22:23], s44 offset:1024
    s_atomic_swap s45, s[22:23], s44 offset:1152
    s_atomic_swap s45, s[22:23], s44 offset:1280
    s_atomic_swap s45, s[22:23], s44 offset:1408
    s_atomic_swap s45, s[22:23], s44 offset:1536
    s_atomic_swap s45, s[22:23], s44 offset:1664
    s_atomic_swap s45, s[22:23], s44 offset:1792
    s_atomic_swap s45, s[22:23], s44 offset:1920
    s_waitcnt lgkmcnt(0)
    s_atomic_add s40, s[34:35], 0
h_z0:
    v_lshrrev_b32 v24, 4, v1
    v_lshrrev_b32 v25, 3, v24
    v_mul_u32_u24 v12, 6144, v25
    v_and_b32 v26, 2, v25
    v_lshrrev_b32 v25, 2, v25
    v_or_b32 v26, v26, v25
    v_bfe_u32 v25, v24, 1, 2
    v_xor_b32 v26, v26, v25
    v_lshl_add_u32 v12, v26, 5, v12
    v_and_b32 v26, 1, v24
    v_lshl_add_u32 v12, v26, 4, v12
    s_lshl_b32 s3, s18, 7
    v_add_u32 v12, s3, v12
    v_add_u32 v13, 48128, v12
    v_add_u32 v14, 96256, v12
    v_add_u32 v15, 144384, v12
    v_lshrrev_b32 v24, 4, v1
    v_lshrrev_b32 v25, 3, v24
    v_mul_u32_u24 v16, 2048, v25
    v_and_b32 v26, 2, v25
    v_lshrrev_b32 v25, 2, v25
    v_or_b32 v26, v26, v25
    v_bfe_u32 v25, v24, 1, 2
    v_xor_b32 v26, v26, v25
    v_lshl_add_u32 v16, v26, 5, v16
    v_and_b32 v26, 1, v24
    v_lshl_add_u32 v16, v26, 4, v16
    s_lshl_b32 s3, s20, 7
    v_add_u32 v16, s3, v16
    v_add_u32 v17, 15360, v16
    v_add_u32 v18, 30720, v16
    v_add_u32 v19, 46080, v16
    s_mul_i32 s84, s18, 393216
    s_cmp_eq_u32 s18, 1
    s_cselect_b32 s85, 0, 393216
    s_cmp_eq_u32 s18, 2
    s_cselect_b32 s86, 0, 786432
    s_cmp_eq_u32 s18, 3
    s_cselect_b32 s87, 0, 1179648
    s_cmp_eq_u32 s18, 4
    s_cselect_b32 s88, 0, 1572864
    s_cmp_eq_u32 s18, 5
    s_cselect_b32 s89, 0, 1966080
    s_cmp_eq_u32 s18, 6
    s_cselect_b32 s90, 0, 2359296
    s_cmp_eq_u32 s18, 7
    s_cselect_b32 s91, 0, 2752512
    s_cmp_eq_u32 s18, 8
    s_cselect_b32 s92, 0, 3145728
    s_cmp_eq_u32 s18, 9
    s_cselect_b32 s93, 0, 3538944
    s_cmp_eq_u32 s18, 10
    s_cselect_b32 s94, 0, 3932160
    s_cmp_eq_u32 s18, 11
    s_cselect_b32 s95, 0, 4325376
    s_cmp_eq_u32 s18, 12
    s_cselect_b32 s96, 0, 4718592
    s_cmp_eq_u32 s18, 13
    s_cselect_b32 s97, 0, 5111808
    s_cmp_eq_u32 s18, 14
    s_cselect_b32 s98, 0, 5505024
    s_cmp_eq_u32 s18, 15
    s_cselect_b32 s99, 0, 5898240
    s_and_b32 s3, s16, 3
    s_mul_i32 s3, s3, 49152
    v_add_u32 v11, s3, v12
    s_and_b32 s3, s16, 3
    s_lshl_b32 s3, s3, 10
    v_add_u32 v9, s3, v1
    v_add_u32 v10, 0x10000, v9
    v_lshrrev_b32 v24, 4, v1
    v_and_b32 v25, 15, v24
    v_lshrrev_b32 v24, 4, v24
    v_lshlrev_b32 v24, 2, v24
    v_sub_u32 v24, v25, v24
    v_mov_b32 v25, 0xf149f2ca
    v_add_u32 v26, 0x0, v24
    v_and_b32 v26, 0xfffffff1, v26
    v_cmp_eq_u32 vcc, 0, v26
    s_nop 1
    v_cndmask_b32 v32, v25, 0, vcc
    v_add_u32 v26, 0xffffffff, v24
    v_and_b32 v26, 0xfffffff1, v26
    v_cmp_eq_u32 vcc, 0, v26
    s_nop 1
    v_cndmask_b32 v33, v25, 0, vcc
    v_add_u32 v26, 0xfffffffe, v24
    v_and_b32 v26, 0xfffffff1, v26
    v_cmp_eq_u32 vcc, 0, v26
    s_nop 1
    v_cndmask_b32 v34, v25, 0, vcc
    v_add_u32 v26, 0xfffffffd, v24
    v_and_b32 v26, 0xfffffff1, v26
    v_cmp_eq_u32 vcc, 0, v26
    s_nop 1
    v_cndmask_b32 v35, v25, 0, vcc
    v_add_u32 v26, 0x10, v24
    v_and_b32 v26, 0xfffffff1, v26
    v_cmp_eq_u32 vcc, 0, v26
    s_nop 1
    v_cndmask_b32 v36, v25, 0, vcc
    v_add_u32 v26, 0xf, v24
    v_and_b32 v26, 0xfffffff1, v26
    v_cmp_eq_u32 vcc, 0, v26
    s_nop 1
    v_cndmask_b32 v37, v25, 0, vcc
    v_add_u32 v26, 0xe, v24
    v_and_b32 v26, 0xfffffff1, v26
    v_cmp_eq_u32 vcc, 0, v26
    s_nop 1
    v_cndmask_b32 v38, v25, 0, vcc
    v_add_u32 v26, 0xd, v24
    v_and_b32 v26, 0xfffffff1, v26
    v_cmp_eq_u32 vcc, 0, v26
    s_nop 1
    v_cndmask_b32 v39, v25, 0, vcc
    v_add_u32 v24, 153600, v1
    ds_write_b128 v24, v[32:35] offset:0
    ds_write_b128 v24, v[36:39] offset:1024
    s_barrier
    s_waitcnt lgkmcnt(0)
    s_lshl_b32 s44, s21, 14
    s_lshl_b32 s67, s17, 9
    s_add_u32 s44, s44, s67
    s_add_u32 s44, s44, 12288
    s_barrier
    s_mov_b32 s66, 0x10000
h_s0_poll:
    s_mov_b32 s68, 0
    s_mov_b32 s69, 0
    s_mov_b32 s70, 0
    s_mov_b32 s71, 0
    s_atomic_add s68, s[22:23], s44 offset:0 glc
    s_atomic_add s69, s[22:23], s44 offset:128 glc
    s_atomic_add s70, s[22:23], s44 offset:256 glc
    s_atomic_add s71, s[22:23], s44 offset:384 glc
    s_sub_u32 s66, s66, 1
    s_cselect_b32 s67, 16, 0
    s_waitcnt lgkmcnt(0)
    s_and_b32 s68, s68, s69
    s_and_b32 s68, s68, s70
    s_and_b32 s68, s68, s71
    s_max_u32 s68, s68, s67
    s_cmp_lt_u32 s68, 16
    s_cbranch_scc1 h_s0_poll
h_s0_ok:
    s_barrier
    s_barrier
    s_lshr_b32 s3, s2, 3
    s_cmp_eq_u32 s3, 1
    s_cbranch_scc0 h_s_ok
    s_mul_i32 s44, s2, 24576
    s_add_u32 s44, s44, 58544128
    s_mov_b32 s45, 24
h_zloop:
    buffer_store_dwordx4 v[20:23], v1, s[4:7], s44 offen sc1
    s_add_u32 s44, s44, 1024
    s_sub_u32 s45, s45, 1
    s_cmp_lg_u32 s45, 0
    s_cbranch_scc1 h_zloop
    s_branch h_s_ok
h_layer:
    s_waitcnt lgkmcnt(0)
    s_barrier
    s_barrier
    s_lshl_b32 s44, s21, 14
    s_lshl_b32 s67, s17, 9
    s_add_u32 s44, s44, s67
    s_add_u32 s44, s44, 12288
    s_mov_b32 s66, 0x10000
h_s_poll:
    s_mov_b32 s68, 0
    s_mov_b32 s69, 0
    s_mov_b32 s70, 0
    s_mov_b32 s71, 0
    s_atomic_add s68, s[22:23], s44 offset:0 glc
    s_atomic_add s69, s[22:23], s44 offset:128 glc
    s_atomic_add s70, s[22:23], s44 offset:256 glc
    s_atomic_add s71, s[22:23], s44 offset:384 glc
    s_sub_u32 s66, s66, 1
    s_cselect_b32 s67, 16, 0
    s_waitcnt lgkmcnt(0)
    s_and_b32 s68, s68, s69
    s_and_b32 s68, s68, s70
    s_and_b32 s68, s68, s71
    s_max_u32 s68, s68, s67
    s_cmp_lt_u32 s68, 16
    s_cbranch_scc1 h_s_poll
h_s_ok:
    s_barrier
    s_lshl_b32 s44, s21, 18
    s_lshl_b32 s45, s17, 14
    s_add_u32 s44, s44, s45
    s_add_u32 s44, s44, 50331648
    buffer_load_dwordx4 v[32:35], v1, s[4:7], s44 offen offset:0 sc1
    buffer_load_dwordx4 v[36:39], v1, s[4:7], s44 offen offset:1024 sc1
    buffer_load_dwordx4 v[40:43], v1, s[4:7], s44 offen offset:2048 sc1
    buffer_load_dwordx4 v[44:47], v1, s[4:7], s44 offen offset:3072 sc1
    s_add_u32 s44, s44, 4096
    buffer_load_dwordx4 v[48:51], v1, s[4:7], s44 offen offset:0 sc1
    buffer_load_dwordx4 v[52:55], v1, s[4:7], s44 offen offset:1024 sc1
    buffer_load_dwordx4 v[56:59], v1, s[4:7], s44 offen offset:2048 sc1
    buffer_load_dwordx4 v[60:63], v1, s[4:7], s44 offen offset:3072 sc1
    s_add_u32 s44, s44, 4096
    buffer_load_dwordx4 v[64:67], v1, s[4:7], s44 offen offset:0 sc1
    buffer_load_dwordx4 v[68:71], v1, s[4:7], s44 offen offset:1024 sc1
    buffer_load_dwordx4 v[72:75], v1, s[4:7], s44 offen offset:2048 sc1
    buffer_load_dwordx4 v[76:79], v1, s[4:7], s44 offen offset:3072 sc1
    s_add_u32 s44, s44, 4096
    buffer_load_dwordx4 v[80:83], v1, s[4:7], s44 offen offset:0 sc1
    buffer_load_dwordx4 v[84:87], v1, s[4:7], s44 offen offset:1024 sc1
    buffer_load_dwordx4 v[88:91], v1, s[4:7], s44 offen offset:2048 sc1
    buffer_load_dwordx4 v[92:95], v1, s[4:7], s44 offen offset:3072 sc1
    s_barrier
    s_waitcnt vmcnt(0)
    s_lshl_b32 s3, s21, 8
    s_add_u32 s3, s3, s2
    s_lshr_b32 s3, s3, 3
    s_cmp_eq_u32 s3, 1
    s_cbranch_scc0 h_nf1
    s_atomic_add s40, s[34:35], 128
h_nf1:
    v_add_f32 v32, v32, v36
    v_add_f32 v33, v33, v37
    v_add_f32 v34, v34, v38
    v_add_f32 v35, v35, v39
    v_add_f32 v48, v48, v52
    v_add_f32 v49, v49, v53
    v_add_f32 v50, v50, v54
    v_add_f32 v51, v51, v55
    v_add_f32 v64, v64, v68
    v_add_f32 v65, v65, v69
    v_add_f32 v66, v66, v70
    v_add_f32 v67, v67, v71
    v_add_f32 v80, v80, v84
    v_add_f32 v81, v81, v85
    v_add_f32 v82, v82, v86
    v_add_f32 v83, v83, v87
    v_add_f32 v32, v32, v40
    v_add_f32 v33, v33, v41
    v_add_f32 v34, v34, v42
    v_add_f32 v35, v35, v43
    v_add_f32 v48, v48, v56
    v_add_f32 v49, v49, v57
    v_add_f32 v50, v50, v58
    v_add_f32 v51, v51, v59
    v_add_f32 v64, v64, v72
    v_add_f32 v65, v65, v73
    v_add_f32 v66, v66, v74
    v_add_f32 v67, v67, v75
    v_add_f32 v80, v80, v88
    v_add_f32 v81, v81, v89
    v_add_f32 v82, v82, v90
    v_add_f32 v83, v83, v91
    v_add_f32 v32, v32, v44
    v_add_f32 v33, v33, v45
    v_add_f32 v34, v34, v46
    v_add_f32 v35, v35, v47
    v_add_f32 v48, v48, v60
    v_add_f32 v49, v49, v61
    v_add_f32 v50, v50, v62
    v_add_f32 v51, v51, v63
    v_add_f32 v64, v64, v76
    v_add_f32 v65, v65, v77
    v_add_f32 v66, v66, v78
    v_add_f32 v67, v67, v79
    v_add_f32 v80, v80, v92
    v_add_f32 v81, v81, v93
    v_add_f32 v82, v82, v94
    v_add_f32 v83, v83, v95
    s_barrier
    v_permlane32_swap_b32 v32, v64
    v_permlane32_swap_b32 v33, v65
    v_permlane32_swap_b32 v34, v66
    v_permlane32_swap_b32 v35, v67
    v_add_f32 v32, v32, v64
    v_add_f32 v33, v33, v65
    v_add_f32 v34, v34, v66
    v_add_f32 v35, v35, v67
    v_permlane32_swap_b32 v48, v80
    v_permlane32_swap_b32 v49, v81
    v_permlane32_swap_b32 v50, v82
    v_permlane32_swap_b32 v51, v83
    v_add_f32 v48, v48, v80
    v_add_f32 v49, v49, v81
    v_add_f32 v50, v50, v82
    v_add_f32 v51, v51, v83
    v_permlane16_swap_b32 v32, v48
    v_permlane16_swap_b32 v33, v49
    v_permlane16_swap_b32 v34, v50
    v_permlane16_swap_b32 v35, v51
    v_add_f32 v32, v32, v48
    v_add_f32 v33, v33, v49
    v_add_f32 v34, v34, v50
    v_add_f32 v35, v35, v51
    s_barrier
    s_cmp_ge_u32 s21, 2
    s_cbranch_scc1 h_c_ok
    s_lshl_b32 s44, s21, 11
    s_lshl_b32 s67, s18, 7
    s_add_u32 s44, s44, s67
    s_add_u32 s44, s44, 0
    s_mov_b32 s66, 0x10000
h_c_poll:
    s_mov_b32 s68, 0
    s_atomic_add s68, s[22:23], s44 offset:0 glc
    s_sub_u32 s66, s66, 1
    s_cselect_b32 s67, 48, 0
    s_waitcnt lgkmcnt(0)
    s_max_u32 s68, s68, s67
    s_cmp_lt_u32 s68, 48
    s_cbranch_scc1 h_c_poll
h_c_ok:
    s_barrier
    s_cmp_ge_u32 s21, 2
    s_cbranch_scc1 h_cs1
    s_lshl_b32 s44, s21, 18
    s_lshl_b32 s45, s18, 14
    s_add_u32 s44, s44, s45
    s_add_u32 s44, s44, 52428800
    buffer_load_dwordx4 v[96:99], v1, s[4:7], s44 offen offset:0 sc1
    buffer_load_dwordx4 v[100:103], v1, s[4:7], s44 offen offset:1024 sc1
    buffer_load_dwordx4 v[104:107], v1, s[4:7], s44 offen offset:2048 sc1
    buffer_load_dwordx4 v[108:111], v1, s[4:7], s44 offen offset:3072 sc1
    s_add_u32 s44, s44, 4096
    buffer_load_dwordx4 v[112:115], v1, s[4:7], s44 offen offset:0 sc1
    buffer_load_dwordx4 v[116:119], v1, s[4:7], s44 offen offset:1024 sc1
    buffer_load_dwordx4 v[120:123], v1, s[4:7], s44 offen offset:2048 sc1
    buffer_load_dwordx4 v[124:127], v1, s[4:7], s44 offen offset:3072 sc1
    s_add_u32 s44, s44, 4096
    buffer_load_dwordx4 v[128:131], v1, s[4:7], s44 offen offset:0 sc1
    buffer_load_dwordx4 v[132:135], v1, s[4:7], s44 offen offset:1024 sc1
    buffer_load_dwordx4 v[136:139], v1, s[4:7], s44 offen offset:2048 sc1
    buffer_load_dwordx4 v[140:143], v1, s[4:7], s44 offen offset:3072 sc1
    s_add_u32 s44, s44, 4096
    buffer_load_dwordx4 v[144:147], v1, s[4:7], s44 offen offset:0 sc1
    buffer_load_dwordx4 v[148:151], v1, s[4:7], s44 offen offset:1024 sc1
    buffer_load_dwordx4 v[152:155], v1, s[4:7], s44 offen offset:2048 sc1
    buffer_load_dwordx4 v[156:159], v1, s[4:7], s44 offen offset:3072 sc1
h_cs1:
    s_barrier
    v_mul_f32 v32, 0x3a800000, v32
    v_mul_f32 v33, 0x3a800000, v33
    v_mul_f32 v34, 0x3a800000, v34
    v_mul_f32 v35, 0x3a800000, v35
    v_fma_f32 v33, -v32, v32, v33
    v_max_f32 v33, 0, v33
    v_add_f32 v33, 0x3727c5ac, v33
    v_rsq_f32 v33, v33
    v_fma_f32 v35, -v34, v34, v35
    v_max_f32 v35, 0, v35
    v_add_f32 v35, 0x3727c5ac, v35
    v_rsq_f32 v35, v35
    v_lshrrev_b32 v26, 1, v1
    v_add_u32 v26, 155648, v26
    ds_write2_b32 v26, v32, v34 offset0:0 offset1:1
    ds_write2_b32 v26, v33, v35 offset0:128 offset1:129
    s_cmp_lg_u32 s21, 0
    s_cbranch_scc1 h_f1_ok
    s_load_dword s68, s[34:35], 128
    s_mov_b32 s8, s34
    s_mov_b32 s9, s35
    s_mov_b32 s10, 256
    s_mov_b32 s11, 0x00020000
    s_mov_b32 s66, 0x10000
    v_mov_b32 v24, 0
    s_waitcnt lgkmcnt(0)
h_f1:
    s_cmp_eq_u32 s68, 8
    s_cbranch_scc1 h_f1_ok
    buffer_load_dword v25, v24, s[8:11], 0 offen offset:128 sc1
    s_waitcnt vmcnt(0)
    v_readfirstlane_b32 s68, v25
    s_sub_u32 s66, s66, 1
    s_cmp_lg_u32 s66, 0
    s_cbranch_scc1 h_f1
h_f1_ok:
    s_barrier
    s_cmp_ge_u32 s21, 2
    s_cbranch_scc1 h_cs_done
    s_waitcnt vmcnt(0)
    v_add_f32 v96, v96, v100
    v_add_f32 v97, v97, v101
    v_add_f32 v98, v98, v102
    v_add_f32 v99, v99, v103
    v_add_f32 v96, v96, v104
    v_add_f32 v97, v97, v105
    v_add_f32 v98, v98, v106
    v_add_f32 v99, v99, v107
    v_add_f32 v96, v96, v108
    v_add_f32 v97, v97, v109
    v_add_f32 v98, v98, v110
    v_add_f32 v99, v99, v111
    v_add_f32 v96, v96, v112
    v_add_f32 v97, v97, v113
    v_add_f32 v98, v98, v114
    v_add_f32 v99, v99, v115
    v_add_f32 v96, v96, v116
    v_add_f32 v97, v97, v117
    v_add_f32 v98, v98, v118
    v_add_f32 v99, v99, v119
    v_add_f32 v96, v96, v120
    v_add_f32 v97, v97, v121
    v_add_f32 v98, v98, v122
    v_add_f32 v99, v99, v123
    v_add_f32 v96, v96, v124
    v_add_f32 v97, v97, v125
    v_add_f32 v98, v98, v126
    v_add_f32 v99, v99, v127
    v_add_f32 v96, v96, v128
    v_add_f32 v97, v97, v129
    v_add_f32 v98, v98, v130
    v_add_f32 v99, v99, v131
    v_add_f32 v96, v96, v132
    v_add_f32 v97, v97, v133
    v_add_f32 v98, v98, v134
    v_add_f32 v99, v99, v135
    v_add_f32 v96, v96, v136
    v_add_f32 v97, v97, v137
    v_add_f32 v98, v98, v138
    v_add_f32 v99, v99, v139
    v_add_f32 v96, v96, v140
    v_add_f32 v97, v97, v141
    v_add_f32 v98, v98, v142
    v_add_f32 v99, v99, v143
    v_add_f32 v96, v96, v144
    v_add_f32 v97, v97, v145
    v_add_f32 v98, v98, v146
    v_add_f32 v99, v99, v147
    v_add_f32 v96, v96, v148
    v_add_f32 v97, v97, v149
    v_add_f32 v98, v98, v150
    v_add_f32 v99, v99, v151
    v_add_f32 v96, v96, v152
    v_add_f32 v97, v97, v153
    v_add_f32 v98, v98, v154
    v_add_f32 v99, v99, v155
    v_add_f32 v96, v96, v156
    v_add_f32 v97, v97, v157
    v_add_f32 v98, v98, v158
    v_add_f32 v99, v99, v159
    s_lshl_b32 s44, s21, 10
    s_add_u32 s44, s44, 151552
    v_add_u32 v24, s44, v1
    ds_write_b128 v24, v[96:99]
h_cs_done:
    s_waitcnt lgkmcnt(0)
    s_barrier
    s_bitcmp1_b32 s21, 0
    s_cselect_b32 s8, s28, s24
    s_cselect_b32 s9, s29, s25
    s_cselect_b32 s12, s30, s26
    s_cselect_b32 s13, s31, s27
    s_mov_b32 s10, 6291456
    s_mov_b32 s11, 0x00020000
    s_mov_b32 s14, 2097152
    s_mov_b32 s15, 0x00020000
    v_lshrrev_b32 v28, 4, v1
    v_and_b32 v29, 7, v28
    v_lshrrev_b32 v28, 3, v28
    v_mul_u32_u24 v28, 2048, v28
    v_lshl_add_u32 v28, v29, 4, v28
    s_and_b32 s3, s20, 12
    s_or_b32 s3, s3, 3
    s_lshl_b32 s3, s3, 7
    v_add_u32 v28, s3, v28
    s_lshr_b32 s3, s2, 3
    s_lshl_b32 s3, s3, 2
    s_and_b32 s60, s16, 3
    s_add_u32 s60, s60, s3
    s_lshl_b32 s61, s60, 14
    buffer_load_dwordx4 v[144:147], v28, s[12:15], s61 offen
    s_bitcmp0_b32 s21, 0
    s_cselect_b32 s56, s28, s24
    s_cselect_b32 s57, s29, s25
    s_mov_b32 s58, 6291456
    s_mov_b32 s59, 0x00020000
    v_lshrrev_b32 v28, 4, v1
    v_and_b32 v29, 7, v28
    v_lshrrev_b32 v28, 3, v28
    v_mul_u32_u24 v28, 6144, v28
    v_lshl_add_u32 v28, v29, 4, v28
    s_and_b32 s3, s18, 12
    s_or_b32 s3, s3, 3
    s_lshl_b32 s3, s3, 7
    v_add_u32 v28, s3, v28
    s_lshr_b32 s3, s2, 3
    s_lshl_b32 s3, s3, 2
    s_and_b32 s60, s16, 3
    s_add_u32 s60, s60, s3
    s_and_b32 s3, s60, 31
    s_mul_i32 s3, s3, 49152
    s_lshr_b32 s61, s60, 5
    s_min_u32 s61, s61, 2
    s_lshl_b32 s61, s61, 11
    s_add_u32 s61, s61, s3
    s_and_b32 s3, s18, 0
    s_mul_i32 s3, s3, 393216
    s_add_u32 s61, s61, s3
    buffer_load_dwordx4 v[148:151], v28, s[56:59], s61 offen
    s_cmp_lg_u32 s21, 2
    s_cbranch_scc1 h_pe
    s_bitcmp0_b32 s21, 0
    s_cselect_b32 s56, s28, s24
    s_cselect_b32 s57, s29, s25
    s_mov_b32 s58, 6291456
    s_mov_b32 s59, 0x00020000
    s_add_u32 s61, s84, 2048
    buffer_load_dwordx4 v[160:163], v11, s[56:59], s61 offen
    s_add_u32 s61, s84, 4096
    buffer_load_dwordx4 v[164:167], v11, s[56:59], s61 offen
    s_add_u32 s61, s84, 0
    buffer_load_dwordx4 v[168:171], v11, s[56:59], s61 offen
    s_add_u32 s61, s84, 198656
    buffer_load_dwordx4 v[172:175], v11, s[56:59], s61 offen
    s_add_u32 s61, s84, 200704
    buffer_load_dwordx4 v[176:179], v11, s[56:59], s61 offen
    s_add_u32 s61, s84, 196608
    buffer_load_dwordx4 v[180:183], v11, s[56:59], s61 offen
    s_add_u32 s61, s85, 2048
    buffer_load_dwordx4 v[184:187], v11, s[56:59], s61 offen
    s_add_u32 s61, s85, 4096
    buffer_load_dwordx4 v[188:191], v11, s[56:59], s61 offen
    s_add_u32 s61, s85, 0
    buffer_load_dwordx4 v[192:195], v11, s[56:59], s61 offen
    s_add_u32 s61, s85, 198656
    buffer_load_dwordx4 v[196:199], v11, s[56:59], s61 offen
h_pe:
    s_barrier
    s_branch s_tail
l_start:
    v_lshrrev_b32 v24, 4, v1
    v_lshrrev_b32 v25, 3, v24
    v_mul_u32_u24 v12, 6144, v25
    v_and_b32 v26, 2, v25
    v_lshrrev_b32 v25, 2, v25
    v_or_b32 v26, v26, v25
    v_bfe_u32 v25, v24, 1, 2
    v_xor_b32 v26, v26, v25
    v_lshl_add_u32 v12, v26, 5, v12
    v_and_b32 v26, 1, v24
    v_lshl_add_u32 v12, v26, 4, v12
    s_lshl_b32 s3, s18, 7
    v_add_u32 v12, s3, v12
    v_add_u32 v13, 48128, v12
    v_add_u32 v14, 96256, v12
    v_add_u32 v15, 144384, v12
    v_lshrrev_b32 v24, 4, v1
    v_lshrrev_b32 v25, 3, v24
    v_mul_u32_u24 v16, 2048, v25
    v_and_b32 v26, 2, v25
    v_lshrrev_b32 v25, 2, v25
    v_or_b32 v26, v26, v25
    v_bfe_u32 v25, v24, 1, 2
    v_xor_b32 v26, v26, v25
    v_lshl_add_u32 v16, v26, 5, v16
    v_and_b32 v26, 1, v24
    v_lshl_add_u32 v16, v26, 4, v16
    s_lshl_b32 s3, s20, 7
    v_add_u32 v16, s3, v16
    v_add_u32 v17, 15360, v16
    v_add_u32 v18, 30720, v16
    v_add_u32 v19, 46080, v16
    s_mul_i32 s84, s18, 393216
    s_cmp_eq_u32 s18, 1
    s_cselect_b32 s85, 0, 393216
    s_cmp_eq_u32 s18, 2
    s_cselect_b32 s86, 0, 786432
    s_cmp_eq_u32 s18, 3
    s_cselect_b32 s87, 0, 1179648
    s_cmp_eq_u32 s18, 4
    s_cselect_b32 s88, 0, 1572864
    s_cmp_eq_u32 s18, 5
    s_cselect_b32 s89, 0, 1966080
    s_cmp_eq_u32 s18, 6
    s_cselect_b32 s90, 0, 2359296
    s_cmp_eq_u32 s18, 7
    s_cselect_b32 s91, 0, 2752512
    s_cmp_eq_u32 s18, 8
    s_cselect_b32 s92, 0, 3145728
    s_cmp_eq_u32 s18, 9
    s_cselect_b32 s93, 0, 3538944
    s_cmp_eq_u32 s18, 10
    s_cselect_b32 s94, 0, 3932160
    s_cmp_eq_u32 s18, 11
    s_cselect_b32 s95, 0, 4325376
    s_cmp_eq_u32 s18, 12
    s_cselect_b32 s96, 0, 4718592
    s_cmp_eq_u32 s18, 13
    s_cselect_b32 s97, 0, 5111808
    s_cmp_eq_u32 s18, 14
    s_cselect_b32 s98, 0, 5505024
    s_cmp_eq_u32 s18, 15
    s_cselect_b32 s99, 0, 5898240
    s_and_b32 s3, s16, 3
    s_mul_i32 s3, s3, 49152
    v_add_u32 v11, s3, v12
    s_and_b32 s3, s16, 3
    s_lshl_b32 s3, s3, 10
    v_add_u32 v9, s3, v1
    v_add_u32 v10, 0x10000, v9
    s_sub_u32 s3, s16, 5
    s_lshl_b32 s41, s3, 11
    s_mul_i32 s42, s3, 98304
    s_lshl_b32 s62, s3, 15
    v_add_u32 v14, s42, v12
    v_add_u32 v15, s42, v13
    s_and_b32 s3, s20, 0
    s_lshl_b32 s3, s3, 17
    s_add_u32 s62, s62, s3
    s_barrier
    s_bitcmp1_b32 s21, 0
    s_cselect_b32 s8, s28, s24
    s_cselect_b32 s9, s29, s25
    s_cselect_b32 s12, s30, s26
    s_cselect_b32 s13, s31, s27
    s_mov_b32 s10, 6291456
    s_mov_b32 s11, 0x00020000
    s_mov_b32 s14, 2097152
    s_mov_b32 s15, 0x00020000
    s_add_u32 m0, s41, 0
    s_add_u32 s44, s84, 2048
    buffer_load_dwordx4 v14, s[8:11], s44 offen offset:0 lds
    buffer_load_dwordx4 v15, s[8:11], s44 offen offset:1024 lds
    s_add_u32 m0, s41, 4096
    s_add_u32 s44, s84, 4096
    buffer_load_dwordx4 v14, s[8:11], s44 offen offset:0 lds
    buffer_load_dwordx4 v15, s[8:11], s44 offen offset:1024 lds
    s_add_u32 m0, s41, 8192
    s_add_u32 s44, s84, 0
    buffer_load_dwordx4 v14, s[8:11], s44 offen offset:0 lds
    buffer_load_dwordx4 v15, s[8:11], s44 offen offset:1024 lds
    s_add_u32 m0, s41, 12288
    s_add_u32 s44, s84, 198656
    buffer_load_dwordx4 v14, s[8:11], s44 offen offset:0 lds
    buffer_load_dwordx4 v15, s[8:11], s44 offen offset:1024 lds
    s_add_u32 m0, s41, 16384
    s_add_u32 s44, s84, 200704
    buffer_load_dwordx4 v14, s[8:11], s44 offen offset:0 lds
    buffer_load_dwordx4 v15, s[8:11], s44 offen offset:1024 lds
    s_add_u32 m0, s41, 20480
    s_add_u32 s44, s84, 196608
    buffer_load_dwordx4 v14, s[8:11], s44 offen offset:0 lds
    buffer_load_dwordx4 v15, s[8:11], s44 offen offset:1024 lds
    s_add_u32 m0, s41, 24576
    s_add_u32 s44, s85, 2048
    buffer_load_dwordx4 v14, s[8:11], s44 offen offset:0 lds
    buffer_load_dwordx4 v15, s[8:11], s44 offen offset:1024 lds
    s_add_u32 m0, s41, 28672
    s_add_u32 s44, s85, 4096
    buffer_load_dwordx4 v14, s[8:11], s44 offen offset:0 lds
    buffer_load_dwordx4 v15, s[8:11], s44 offen offset:1024 lds
    s_add_u32 m0, s41, 32768
    s_add_u32 s44, s85, 0
    buffer_load_dwordx4 v14, s[8:11], s44 offen offset:0 lds
    buffer_load_dwordx4 v15, s[8:11], s44 offen offset:1024 lds
    s_add_u32 m0, s41, 36864
    s_add_u32 s44, s85, 198656
    buffer_load_dwordx4 v14, s[8:11], s44 offen offset:0 lds
    buffer_load_dwordx4 v15, s[8:11], s44 offen offset:1024 lds
    s_add_u32 m0, s41, 40960
    s_add_u32 s44, s85, 200704
    buffer_load_dwordx4 v14, s[8:11], s44 offen offset:0 lds
    buffer_load_dwordx4 v15, s[8:11], s44 offen offset:1024 lds
    s_add_u32 m0, s41, 45056
    s_add_u32 s44, s85, 196608
    buffer_load_dwordx4 v14, s[8:11], s44 offen offset:0 lds
    buffer_load_dwordx4 v15, s[8:11], s44 offen offset:1024 lds
    s_waitcnt vmcnt(8)
    s_barrier
    s_add_u32 m0, s41, 49152
    s_add_u32 s44, s86, 2048
    buffer_load_dwordx4 v14, s[8:11], s44 offen offset:0 lds
    buffer_load_dwordx4 v15, s[8:11], s44 offen offset:1024 lds
    s_add_u32 m0, s41, 53248
    s_add_u32 s44, s86, 4096
    buffer_load_dwordx4 v14, s[8:11], s44 offen offset:0 lds
    buffer_load_dwordx4 v15, s[8:11], s44 offen offset:1024 lds
    s_add_u32 m0, s41, 57344
    s_add_u32 s44, s86, 0
    buffer_load_dwordx4 v14, s[8:11], s44 offen offset:0 lds
    buffer_load_dwordx4 v15, s[8:11], s44 offen offset:1024 lds
    s_add_u32 m0, s41, 61440
    s_add_u32 s44, s86, 198656
    buffer_load_dwordx4 v14, s[8:11], s44 offen offset:0 lds
    buffer_load_dwordx4 v15, s[8:11], s44 offen offset:1024 lds
    s_add_u32 m0, s41, 65536
    s_add_u32 s44, s86, 200704
    buffer_load_dwordx4 v14, s[8:11], s44 offen offset:0 lds
    buffer_load_dwordx4 v15, s[8:11], s44 offen offset:1024 lds
    s_add_u32 m0, s41, 69632
    s_add_u32 s44, s86, 196608
    buffer_load_dwordx4 v14, s[8:11], s44 offen offset:0 lds
    buffer_load_dwordx4 v15, s[8:11], s44 offen offset:1024 lds
    s_add_u32 m0, s41, 73728
    s_add_u32 s44, s87, 2048
    buffer_load_dwordx4 v14, s[8:11], s44 offen offset:0 lds
    buffer_load_dwordx4 v15, s[8:11], s44 offen offset:1024 lds
    s_add_u32 m0, s41, 77824
    s_add_u32 s44, s87, 4096
    buffer_load_dwordx4 v14, s[8:11], s44 offen offset:0 lds
    buffer_load_dwordx4 v15, s[8:11], s44 offen offset:1024 lds
    s_add_u32 m0, s41, 81920
    s_add_u32 s44, s87, 0
    buffer_load_dwordx4 v14, s[8:11], s44 offen offset:0 lds
    buffer_load_dwordx4 v15, s[8:11], s44 offen offset:1024 lds
    s_add_u32 m0, s41, 86016
    s_add_u32 s44, s87, 198656
    buffer_load_dwordx4 v14, s[8:11], s44 offen offset:0 lds
    buffer_load_dwordx4 v15, s[8:11], s44 offen offset:1024 lds
    s_add_u32 m0, s41, 90112
    s_add_u32 s44, s87, 200704
    buffer_load_dwordx4 v14, s[8:11], s44 offen offset:0 lds
    buffer_load_dwordx4 v15, s[8:11], s44 offen offset:1024 lds
    s_add_u32 m0, s41, 94208
    s_add_u32 s44, s87, 196608
    buffer_load_dwordx4 v14, s[8:11], s44 offen offset:0 lds
    buffer_load_dwordx4 v15, s[8:11], s44 offen offset:1024 lds
    s_waitcnt vmcnt(16)
    s_barrier
    s_add_u32 m0, s41, 98304
    s_add_u32 s44, s88, 2048
    buffer_load_dwordx4 v14, s[8:11], s44 offen offset:0 lds
    buffer_load_dwordx4 v15, s[8:11], s44 offen offset:1024 lds
    s_add_u32 m0, s41, 102400
    s_add_u32 s44, s88, 4096
    buffer_load_dwordx4 v14, s[8:11], s44 offen offset:0 lds
    buffer_load_dwordx4 v15, s[8:11], s44 offen offset:1024 lds
    s_add_u32 m0, s41, 106496
    s_add_u32 s44, s88, 0
    buffer_load_dwordx4 v14, s[8:11], s44 offen offset:0 lds
    buffer_load_dwordx4 v15, s[8:11], s44 offen offset:1024 lds
    s_add_u32 m0, s41, 110592
    s_add_u32 s44, s88, 198656
    buffer_load_dwordx4 v14, s[8:11], s44 offen offset:0 lds
    buffer_load_dwordx4 v15, s[8:11], s44 offen offset:1024 lds
    s_add_u32 m0, s41, 114688
    s_add_u32 s44, s88, 200704
    buffer_load_dwordx4 v14, s[8:11], s44 offen offset:0 lds
    buffer_load_dwordx4 v15, s[8:11], s44 offen offset:1024 lds
    s_add_u32 m0, s41, 118784
    s_add_u32 s44, s88, 196608
    buffer_load_dwordx4 v14, s[8:11], s44 offen offset:0 lds
    buffer_load_dwordx4 v15, s[8:11], s44 offen offset:1024 lds
    s_add_u32 m0, s41, 122880
    s_add_u32 s44, s89, 2048
    buffer_load_dwordx4 v14, s[8:11], s44 offen offset:0 lds
    buffer_load_dwordx4 v15, s[8:11], s44 offen offset:1024 lds
    s_add_u32 m0, s41, 126976
    s_add_u32 s44, s89, 4096
    buffer_load_dwordx4 v14, s[8:11], s44 offen offset:0 lds
    buffer_load_dwordx4 v15, s[8:11], s44 offen offset:1024 lds
    s_add_u32 m0, s41, 0
    s_add_u32 s44, s89, 0
    buffer_load_dwordx4 v14, s[8:11], s44 offen offset:0 lds
    buffer_load_dwordx4 v15, s[8:11], s44 offen offset:1024 lds
    s_add_u32 m0, s41, 4096
    s_add_u32 s44, s89, 198656
    buffer_load_dwordx4 v14, s[8:11], s44 offen offset:0 lds
    buffer_load_dwordx4 v15, s[8:11], s44 offen offset:1024 lds
    s_add_u32 m0, s41, 8192
    s_add_u32 s44, s89, 200704
    buffer_load_dwordx4 v14, s[8:11], s44 offen offset:0 lds
    buffer_load_dwordx4 v15, s[8:11], s44 offen offset:1024 lds
    s_add_u32 m0, s41, 12288
    s_add_u32 s44, s89, 196608
    buffer_load_dwordx4 v14, s[8:11], s44 offen offset:0 lds
    buffer_load_dwordx4 v15, s[8:11], s44 offen offset:1024 lds
    s_waitcnt vmcnt(24)
    s_branch l_join
l_layer:
    s_add_u32 m0, s41, 98304
    s_add_u32 s44, s88, 2048
    buffer_load_dwordx4 v14, s[8:11], s44 offen offset:0 lds
    buffer_load_dwordx4 v15, s[8:11], s44 offen offset:1024 lds
    s_add_u32 m0, s41, 102400
    s_add_u32 s44, s88, 4096
    buffer_load_dwordx4 v14, s[8:11], s44 offen offset:0 lds
    buffer_load_dwordx4 v15, s[8:11], s44 offen offset:1024 lds
    s_add_u32 m0, s41, 106496
    s_add_u32 s44, s88, 0
    buffer_load_dwordx4 v14, s[8:11], s44 offen offset:0 lds
    buffer_load_dwordx4 v15, s[8:11], s44 offen offset:1024 lds
    s_add_u32 m0, s41, 110592
    s_add_u32 s44, s88, 198656
    buffer_load_dwordx4 v14, s[8:11], s44 offen offset:0 lds
    buffer_load_dwordx4 v15, s[8:11], s44 offen offset:1024 lds
    s_add_u32 m0, s41, 114688
    s_add_u32 s44, s88, 200704
    buffer_load_dwordx4 v14, s[8:11], s44 offen offset:0 lds
    buffer_load_dwordx4 v15, s[8:11], s44 offen offset:1024 lds
    s_add_u32 m0, s41, 118784
    s_add_u32 s44, s88, 196608
    buffer_load_dwordx4 v14, s[8:11], s44 offen offset:0 lds
    buffer_load_dwordx4 v15, s[8:11], s44 offen offset:1024 lds
    s_add_u32 m0, s41, 122880
    s_add_u32 s44, s89, 2048
    buffer_load_dwordx4 v14, s[8:11], s44 offen offset:0 lds
    buffer_load_dwordx4 v15, s[8:11], s44 offen offset:1024 lds
    s_add_u32 m0, s41, 126976
    s_add_u32 s44, s89, 4096
    buffer_load_dwordx4 v14, s[8:11], s44 offen offset:0 lds
    buffer_load_dwordx4 v15, s[8:11], s44 offen offset:1024 lds
    s_waitcnt lgkmcnt(0)
    s_barrier
    s_add_u32 m0, s41, 0
    s_add_u32 s44, s89, 0
    buffer_load_dwordx4 v14, s[8:11], s44 offen offset:0 lds
    buffer_load_dwordx4 v15, s[8:11], s44 offen offset:1024 lds
    s_add_u32 m0, s41, 4096
    s_add_u32 s44, s89, 198656
    buffer_load_dwordx4 v14, s[8:11], s44 offen offset:0 lds
    buffer_load_dwordx4 v15, s[8:11], s44 offen offset:1024 lds
    s_add_u32 m0, s41, 8192
    s_add_u32 s44, s89, 200704
    buffer_load_dwordx4 v14, s[8:11], s44 offen offset:0 lds
    buffer_load_dwordx4 v15, s[8:11], s44 offen offset:1024 lds
    s_add_u32 m0, s41, 12288
    s_add_u32 s44, s89, 196608
    buffer_load_dwordx4 v14, s[8:11], s44 offen offset:0 lds
    buffer_load_dwordx4 v15, s[8:11], s44 offen offset:1024 lds
l_join:
    s_barrier
    s_add_u32 m0, s41, 16384
    s_add_u32 s44, s90, 2048
    buffer_load_dwordx4 v14, s[8:11], s44 offen offset:0 lds
    buffer_load_dwordx4 v15, s[8:11], s44 offen offset:1024 lds
    s_add_u32 m0, s41, 20480
    s_add_u32 s44, s90, 4096
    buffer_load_dwordx4 v14, s[8:11], s44 offen offset:0 lds
    buffer_load_dwordx4 v15, s[8:11], s44 offen offset:1024 lds
    s_add_u32 m0, s41, 24576
    s_add_u32 s44, s90, 0
    buffer_load_dwordx4 v14, s[8:11], s44 offen offset:0 lds
    buffer_load_dwordx4 v15, s[8:11], s44 offen offset:1024 lds
    s_add_u32 m0, s41, 28672
    s_add_u32 s44, s90, 198656
    buffer_load_dwordx4 v14, s[8:11], s44 offen offset:0 lds
    buffer_load_dwordx4 v15, s[8:11], s44 offen offset:1024 lds
    s_add_u32 m0, s41, 32768
    s_add_u32 s44, s90, 200704
    buffer_load_dwordx4 v14, s[8:11], s44 offen offset:0 lds
    buffer_load_dwordx4 v15, s[8:11], s44 offen offset:1024 lds
    s_add_u32 m0, s41, 36864
    s_add_u32 s44, s90, 196608
    buffer_load_dwordx4 v14, s[8:11], s44 offen offset:0 lds
    buffer_load_dwordx4 v15, s[8:11], s44 offen offset:1024 lds
    s_add_u32 m0, s41, 40960
    s_add_u32 s44, s91, 2048
    buffer_load_dwordx4 v14, s[8:11], s44 offen offset:0 lds
    buffer_load_dwordx4 v15, s[8:11], s44 offen offset:1024 lds
    s_add_u32 m0, s41, 45056
    s_add_u32 s44, s91, 4096
    buffer_load_dwordx4 v14, s[8:11], s44 offen offset:0 lds
    buffer_load_dwordx4 v15, s[8:11], s44 offen offset:1024 lds
    s_waitcnt vmcnt(24)
    s_barrier
    s_add_u32 m0, s41, 49152
    s_add_u32 s44, s91, 0
    buffer_load_dwordx4 v14, s[8:11], s44 offen offset:0 lds
    buffer_load_dwordx4 v15, s[8:11], s44 offen offset:1024 lds
    s_add_u32 m0, s41, 53248
    s_add_u32 s44, s91, 198656
    buffer_load_dwordx4 v14, s[8:11], s44 offen offset:0 lds
    buffer_load_dwordx4 v15, s[8:11], s44 offen offset:1024 lds
    s_add_u32 m0, s41, 57344
    s_add_u32 s44, s91, 200704
    buffer_load_dwordx4 v14, s[8:11], s44 offen offset:0 lds
    buffer_load_dwordx4 v15, s[8:11], s44 offen offset:1024 lds
    s_add_u32 m0, s41, 61440
    s_add_u32 s44, s91, 196608
    buffer_load_dwordx4 v14, s[8:11], s44 offen offset:0 lds
    buffer_load_dwordx4 v15, s[8:11], s44 offen offset:1024 lds
    s_waitcnt vmcnt(16)
    s_barrier
    s_add_u32 m0, s41, 65536
    s_add_u32 s44, s92, 2048
    buffer_load_dwordx4 v14, s[8:11], s44 offen offset:0 lds
    buffer_load_dwordx4 v15, s[8:11], s44 offen offset:1024 lds
    s_add_u32 m0, s41, 69632
    s_add_u32 s44, s92, 4096
    buffer_load_dwordx4 v14, s[8:11], s44 offen offset:0 lds
    buffer_load_dwordx4 v15, s[8:11], s44 offen offset:1024 lds
    s_add_u32 m0, s41, 73728
    s_add_u32 s44, s92, 0
    buffer_load_dwordx4 v14, s[8:11], s44 offen offset:0 lds
    buffer_load_dwordx4 v15, s[8:11], s44 offen offset:1024 lds
    s_add_u32 m0, s41, 77824
    s_add_u32 s44, s92, 198656
    buffer_load_dwordx4 v14, s[8:11], s44 offen offset:0 lds
    buffer_load_dwordx4 v15, s[8:11], s44 offen offset:1024 lds
    s_add_u32 m0, s41, 81920
    s_add_u32 s44, s92, 200704
    buffer_load_dwordx4 v14, s[8:11], s44 offen offset:0 lds
    buffer_load_dwordx4 v15, s[8:11], s44 offen offset:1024 lds
    s_add_u32 m0, s41, 86016
    s_add_u32 s44, s92, 196608
    buffer_load_dwordx4 v14, s[8:11], s44 offen offset:0 lds
    buffer_load_dwordx4 v15, s[8:11], s44 offen offset:1024 lds
    s_add_u32 m0, s41, 90112
    s_add_u32 s44, s93, 2048
    buffer_load_dwordx4 v14, s[8:11], s44 offen offset:0 lds
    buffer_load_dwordx4 v15, s[8:11], s44 offen offset:1024 lds
    s_add_u32 m0, s41, 94208
    s_add_u32 s44, s93, 4096
    buffer_load_dwordx4 v14, s[8:11], s44 offen offset:0 lds
    buffer_load_dwordx4 v15, s[8:11], s44 offen offset:1024 lds
    s_waitcnt vmcnt(16)
    s_barrier
    s_add_u32 m0, s41, 98304
    s_add_u32 s44, s93, 0
    buffer_load_dwordx4 v14, s[8:11], s44 offen offset:0 lds
    buffer_load_dwordx4 v15, s[8:11], s44 offen offset:1024 lds
    s_add_u32 m0, s41, 102400
    s_add_u32 s44, s93, 198656
    buffer_load_dwordx4 v14, s[8:11], s44 offen offset:0 lds
    buffer_load_dwordx4 v15, s[8:11], s44 offen offset:1024 lds
    s_add_u32 m0, s41, 106496
    s_add_u32 s44, s93, 200704
    buffer_load_dwordx4 v14, s[8:11], s44 offen offset:0 lds
    buffer_load_dwordx4 v15, s[8:11], s44 offen offset:1024 lds
    s_add_u32 m0, s41, 110592
    s_add_u32 s44, s93, 196608
    buffer_load_dwordx4 v14, s[8:11], s44 offen offset:0 lds
    buffer_load_dwordx4 v15, s[8:11], s44 offen offset:1024 lds
    s_add_u32 m0, s41, 114688
    s_add_u32 s44, s94, 2048
    buffer_load_dwordx4 v14, s[8:11], s44 offen offset:0 lds
    buffer_load_dwordx4 v15, s[8:11], s44 offen offset:1024 lds
    s_add_u32 m0, s41, 118784
    s_add_u32 s44, s94, 4096
    buffer_load_dwordx4 v14, s[8:11], s44 offen offset:0 lds
    buffer_load_dwordx4 v15, s[8:11], s44 offen offset:1024 lds
    s_add_u32 m0, s41, 122880
    s_add_u32 s44, s94, 198656
    buffer_load_dwordx4 v14, s[8:11], s44 offen offset:0 lds
    buffer_load_dwordx4 v15, s[8:11], s44 offen offset:1024 lds
    s_add_u32 m0, s41, 126976
    s_add_u32 s44, s94, 200704
    buffer_load_dwordx4 v14, s[8:11], s44 offen offset:0 lds
    buffer_load_dwordx4 v15, s[8:11], s44 offen offset:1024 lds
    s_waitcnt vmcnt(16)
    s_barrier
    s_add_u32 m0, s41, 0
    s_add_u32 s44, s95, 2048
    buffer_load_dwordx4 v14, s[8:11], s44 offen offset:0 lds
    buffer_load_dwordx4 v15, s[8:11], s44 offen offset:1024 lds
    s_add_u32 m0, s41, 4096
    s_add_u32 s44, s95, 4096
    buffer_load_dwordx4 v14, s[8:11], s44 offen offset:0 lds
    buffer_load_dwordx4 v15, s[8:11], s44 offen offset:1024 lds
    s_add_u32 m0, s41, 8192
    s_add_u32 s44, s95, 198656
    buffer_load_dwordx4 v14, s[8:11], s44 offen offset:0 lds
    buffer_load_dwordx4 v15, s[8:11], s44 offen offset:1024 lds
    s_add_u32 m0, s41, 12288
    s_add_u32 s44, s95, 200704
    buffer_load_dwordx4 v14, s[8:11], s44 offen offset:0 lds
    buffer_load_dwordx4 v15, s[8:11], s44 offen offset:1024 lds
    s_add_u32 m0, s41, 16384
    s_add_u32 s44, s96, 2048
    buffer_load_dwordx4 v14, s[8:11], s44 offen offset:0 lds
    buffer_load_dwordx4 v15, s[8:11], s44 offen offset:1024 lds
    s_add_u32 m0, s41, 20480
    s_add_u32 s44, s96, 4096
    buffer_load_dwordx4 v14, s[8:11], s44 offen offset:0 lds
    buffer_load_dwordx4 v15, s[8:11], s44 offen offset:1024 lds
    s_add_u32 m0, s41, 24576
    s_add_u32 s44, s96, 198656
    buffer_load_dwordx4 v14, s[8:11], s44 offen offset:0 lds
    buffer_load_dwordx4 v15, s[8:11], s44 offen offset:1024 lds
    s_add_u32 m0, s41, 28672
    s_add_u32 s44, s96, 200704
    buffer_load_dwordx4 v14, s[8:11], s44 offen offset:0 lds
    buffer_load_dwordx4 v15, s[8:11], s44 offen offset:1024 lds
    s_waitcnt vmcnt(16)
    s_barrier
    s_add_u32 m0, s41, 32768
    s_add_u32 s44, s97, 2048
    buffer_load_dwordx4 v14, s[8:11], s44 offen offset:0 lds
    buffer_load_dwordx4 v15, s[8:11], s44 offen offset:1024 lds
    s_add_u32 m0, s41, 36864
    s_add_u32 s44, s97, 4096
    buffer_load_dwordx4 v14, s[8:11], s44 offen offset:0 lds
    buffer_load_dwordx4 v15, s[8:11], s44 offen offset:1024 lds
    s_add_u32 m0, s41, 40960
    s_add_u32 s44, s97, 198656
    buffer_load_dwordx4 v14, s[8:11], s44 offen offset:0 lds
    buffer_load_dwordx4 v15, s[8:11], s44 offen offset:1024 lds
    s_add_u32 m0, s41, 45056
    s_add_u32 s44, s97, 200704
    buffer_load_dwordx4 v14, s[8:11], s44 offen offset:0 lds
    buffer_load_dwordx4 v15, s[8:11], s44 offen offset:1024 lds
    s_add_u32 m0, s41, 49152
    s_add_u32 s44, s98, 2048
    buffer_load_dwordx4 v14, s[8:11], s44 offen offset:0 lds
    buffer_load_dwordx4 v15, s[8:11], s44 offen offset:1024 lds
    s_add_u32 m0, s41, 53248
    s_add_u32 s44, s98, 4096
    buffer_load_dwordx4 v14, s[8:11], s44 offen offset:0 lds
    buffer_load_dwordx4 v15, s[8:11], s44 offen offset:1024 lds
    s_add_u32 m0, s41, 57344
    s_add_u32 s44, s98, 198656
    buffer_load_dwordx4 v14, s[8:11], s44 offen offset:0 lds
    buffer_load_dwordx4 v15, s[8:11], s44 offen offset:1024 lds
    s_add_u32 m0, s41, 61440
    s_add_u32 s44, s98, 200704
    buffer_load_dwordx4 v14, s[8:11], s44 offen offset:0 lds
    buffer_load_dwordx4 v15, s[8:11], s44 offen offset:1024 lds
    s_waitcnt vmcnt(16)
    s_barrier
    s_add_u32 m0, s41, 65536
    s_add_u32 s44, s99, 2048
    buffer_load_dwordx4 v14, s[8:11], s44 offen offset:0 lds
    buffer_load_dwordx4 v15, s[8:11], s44 offen offset:1024 lds
    s_add_u32 m0, s41, 69632
    s_add_u32 s44, s99, 4096
    buffer_load_dwordx4 v14, s[8:11], s44 offen offset:0 lds
    buffer_load_dwordx4 v15, s[8:11], s44 offen offset:1024 lds
    s_add_u32 m0, s41, 73728
    s_add_u32 s44, s99, 198656
    buffer_load_dwordx4 v14, s[8:11], s44 offen offset:0 lds
    buffer_load_dwordx4 v15, s[8:11], s44 offen offset:1024 lds
    s_add_u32 m0, s41, 77824
    s_add_u32 s44, s99, 200704
    buffer_load_dwordx4 v14, s[8:11], s44 offen offset:0 lds
    buffer_load_dwordx4 v15, s[8:11], s44 offen offset:1024 lds
    s_add_u32 m0, s41, 81920
    s_add_u32 s44, s94, 0
    buffer_load_dwordx4 v14, s[8:11], s44 offen offset:0 lds
    buffer_load_dwordx4 v15, s[8:11], s44 offen offset:1024 lds
    s_add_u32 m0, s41, 86016
    s_add_u32 s44, s94, 196608
    buffer_load_dwordx4 v14, s[8:11], s44 offen offset:0 lds
    buffer_load_dwordx4 v15, s[8:11], s44 offen offset:1024 lds
    s_add_u32 m0, s41, 90112
    s_add_u32 s44, s95, 0
    buffer_load_dwordx4 v14, s[8:11], s44 offen offset:0 lds
    buffer_load_dwordx4 v15, s[8:11], s44 offen offset:1024 lds
    s_add_u32 m0, s41, 94208
    s_add_u32 s44, s95, 196608
    buffer_load_dwordx4 v14, s[8:11], s44 offen offset:0 lds
    buffer_load_dwordx4 v15, s[8:11], s44 offen offset:1024 lds
    s_waitcnt vmcnt(16)
    s_barrier
    s_add_u32 m0, s41, 98304
    s_add_u32 s44, s96, 0
    buffer_load_dwordx4 v14, s[8:11], s44 offen offset:0 lds
    buffer_load_dwordx4 v15, s[8:11], s44 offen offset:1024 lds
    s_add_u32 m0, s41, 102400
    s_add_u32 s44, s96, 196608
    buffer_load_dwordx4 v14, s[8:11], s44 offen offset:0 lds
    buffer_load_dwordx4 v15, s[8:11], s44 offen offset:1024 lds
    s_add_u32 m0, s41, 106496
    s_add_u32 s44, s97, 0
    buffer_load_dwordx4 v14, s[8:11], s44 offen offset:0 lds
    buffer_load_dwordx4 v15, s[8:11], s44 offen offset:1024 lds
    s_add_u32 m0, s41, 110592
    s_add_u32 s44, s97, 196608
    buffer_load_dwordx4 v14, s[8:11], s44 offen offset:0 lds
    buffer_load_dwordx4 v15, s[8:11], s44 offen offset:1024 lds
    s_add_u32 m0, s41, 114688
    s_add_u32 s44, s98, 0
    buffer_load_dwordx4 v14, s[8:11], s44 offen offset:0 lds
    buffer_load_dwordx4 v15, s[8:11], s44 offen offset:1024 lds
    s_add_u32 m0, s41, 118784
    s_add_u32 s44, s98, 196608
    buffer_load_dwordx4 v14, s[8:11], s44 offen offset:0 lds
    buffer_load_dwordx4 v15, s[8:11], s44 offen offset:1024 lds
    s_add_u32 m0, s41, 122880
    s_add_u32 s44, s99, 0
    buffer_load_dwordx4 v14, s[8:11], s44 offen offset:0 lds
    buffer_load_dwordx4 v15, s[8:11], s44 offen offset:1024 lds
    s_add_u32 m0, s41, 126976
    s_add_u32 s44, s99, 196608
    buffer_load_dwordx4 v14, s[8:11], s44 offen offset:0 lds
    buffer_load_dwordx4 v15, s[8:11], s44 offen offset:1024 lds
    s_waitcnt vmcnt(16)
    s_barrier
    v_lshrrev_b32 v28, 4, v1
    v_and_b32 v29, 7, v28
    v_lshrrev_b32 v28, 3, v28
    v_mul_u32_u24 v28, 2048, v28
    v_lshl_add_u32 v28, v29, 4, v28
    s_and_b32 s3, s20, 12
    s_or_b32 s3, s3, 3
    s_lshl_b32 s3, s3, 7
    v_add_u32 v28, s3, v28
    s_lshr_b32 s3, s2, 3
    s_lshl_b32 s3, s3, 2
    s_and_b32 s60, s16, 3
    s_add_u32 s60, s60, s3
    s_lshl_b32 s61, s60, 14
    buffer_load_dwordx4 v[144:147], v28, s[12:15], s61 offen
    s_bitcmp0_b32 s21, 0
    s_cselect_b32 s56, s28, s24
    s_cselect_b32 s57, s29, s25
    s_mov_b32 s58, 6291456
    s_mov_b32 s59, 0x00020000
    v_lshrrev_b32 v28, 4, v1
    v_and_b32 v29, 7, v28
    v_lshrrev_b32 v28, 3, v28
    v_mul_u32_u24 v28, 6144, v28
    v_lshl_add_u32 v28, v29, 4, v28
    s_and_b32 s3, s18, 12
    s_or_b32 s3, s3, 3
    s_lshl_b32 s3, s3, 7
    v_add_u32 v28, s3, v28
    s_lshr_b32 s3, s2, 3
    s_lshl_b32 s3, s3, 2
    s_and_b32 s60, s16, 3
    s_add_u32 s60, s60, s3
    s_and_b32 s3, s60, 31
    s_mul_i32 s3, s3, 49152
    s_lshr_b32 s61, s60, 5
    s_min_u32 s61, s61, 2
    s_lshl_b32 s61, s61, 11
    s_add_u32 s61, s61, s3
    s_and_b32 s3, s18, 0
    s_mul_i32 s3, s3, 393216
    s_add_u32 s61, s61, s3
    buffer_load_dwordx4 v[148:151], v28, s[56:59], s61 offen
    s_waitcnt vmcnt(2)
    s_cmp_lg_u32 s21, 2
    s_cbranch_scc1 l_pe
    s_bitcmp0_b32 s21, 0
    s_cselect_b32 s56, s28, s24
    s_cselect_b32 s57, s29, s25
    s_mov_b32 s58, 6291456
    s_mov_b32 s59, 0x00020000
    s_add_u32 s61, s84, 2048
    buffer_load_dwordx4 v[160:163], v11, s[56:59], s61 offen
    s_add_u32 s61, s84, 4096
    buffer_load_dwordx4 v[164:167], v11, s[56:59], s61 offen
    s_add_u32 s61, s84, 0
    buffer_load_dwordx4 v[168:171], v11, s[56:59], s61 offen
    s_add_u32 s61, s84, 198656
    buffer_load_dwordx4 v[172:175], v11, s[56:59], s61 offen
    s_add_u32 s61, s84, 200704
    buffer_load_dwordx4 v[176:179], v11, s[56:59], s61 offen
    s_add_u32 s61, s84, 196608
    buffer_load_dwordx4 v[180:183], v11, s[56:59], s61 offen
    s_add_u32 s61, s85, 2048
    buffer_load_dwordx4 v[184:187], v11, s[56:59], s61 offen
    s_add_u32 s61, s85, 4096
    buffer_load_dwordx4 v[188:191], v11, s[56:59], s61 offen
    s_add_u32 s61, s85, 0
    buffer_load_dwordx4 v[192:195], v11, s[56:59], s61 offen
    s_add_u32 s61, s85, 198656
    buffer_load_dwordx4 v[196:199], v11, s[56:59], s61 offen
l_pe:
    s_barrier
    s_bitcmp1_b32 s21, 0
    s_cbranch_scc1 s_B
    s_add_u32 m0, s41, 0
    s_xor_b32 s44, s62, 0
    buffer_load_dwordx4 v16, s[12:15], s44 offen offset:0 lds
    buffer_load_dwordx4 v17, s[12:15], s44 offen offset:1024 lds
    s_add_u32 m0, s41, 4096
    s_xor_b32 s44, s62, 131072
    buffer_load_dwordx4 v16, s[12:15], s44 offen offset:0 lds
    buffer_load_dwordx4 v17, s[12:15], s44 offen offset:1024 lds
    s_add_u32 m0, s41, 8192
    s_xor_b32 s44, s62, 262144
    buffer_load_dwordx4 v16, s[12:15], s44 offen offset:0 lds
    buffer_load_dwordx4 v17, s[12:15], s44 offen offset:1024 lds
    s_add_u32 m0, s41, 12288
    s_xor_b32 s44, s62, 393216
    buffer_load_dwordx4 v16, s[12:15], s44 offen offset:0 lds
    buffer_load_dwordx4 v17, s[12:15], s44 offen offset:1024 lds
    s_add_u32 m0, s41, 16384
    s_xor_b32 s44, s62, 524288
    buffer_load_dwordx4 v16, s[12:15], s44 offen offset:0 lds
    buffer_load_dwordx4 v17, s[12:15], s44 offen offset:1024 lds
    s_add_u32 m0, s41, 20480
    s_xor_b32 s44, s62, 655360
    buffer_load_dwordx4 v16, s[12:15], s44 offen offset:0 lds
    buffer_load_dwordx4 v17, s[12:15], s44 offen offset:1024 lds
    s_add_u32 m0, s41, 24576
    s_xor_b32 s44, s62, 786432
    buffer_load_dwordx4 v16, s[12:15], s44 offen offset:0 lds
    buffer_load_dwordx4 v17, s[12:15], s44 offen offset:1024 lds
    s_add_u32 m0, s41, 28672
    s_xor_b32 s44, s62, 917504
    buffer_load_dwordx4 v16, s[12:15], s44 offen offset:0 lds
    buffer_load_dwordx4 v17, s[12:15], s44 offen offset:1024 lds
    s_add_u32 m0, s41, 32768
    s_xor_b32 s44, s62, 1048576
    buffer_load_dwordx4 v16, s[12:15], s44 offen offset:0 lds
    buffer_load_dwordx4 v17, s[12:15], s44 offen offset:1024 lds
    s_add_u32 m0, s41, 36864
    s_xor_b32 s44, s62, 1179648
    buffer_load_dwordx4 v16, s[12:15], s44 offen offset:0 lds
    buffer_load_dwordx4 v17, s[12:15], s44 offen offset:1024 lds
    s_add_u32 m0, s41, 40960
    s_xor_b32 s44, s62, 1310720
    buffer_load_dwordx4 v16, s[12:15], s44 offen offset:0 lds
    buffer_load_dwordx4 v17, s[12:15], s44 offen offset:1024 lds
    s_add_u32 m0, s41, 45056
    s_xor_b32 s44, s62, 1441792
    buffer_load_dwordx4 v16, s[12:15], s44 offen offset:0 lds
    buffer_load_dwordx4 v17, s[12:15], s44 offen offset:1024 lds
    s_add_u32 m0, s41, 49152
    s_xor_b32 s44, s62, 1572864
    buffer_load_dwordx4 v16, s[12:15], s44 offen offset:0 lds
    buffer_load_dwordx4 v17, s[12:15], s44 offen offset:1024 lds
    s_add_u32 m0, s41, 53248
    s_xor_b32 s44, s62, 1703936
    buffer_load_dwordx4 v16, s[12:15], s44 offen offset:0 lds
    buffer_load_dwordx4 v17, s[12:15], s44 offen offset:1024 lds
    s_add_u32 m0, s41, 57344
    s_xor_b32 s44, s62, 1835008
    buffer_load_dwordx4 v16, s[12:15], s44 offen offset:0 lds
    buffer_load_dwordx4 v17, s[12:15], s44 offen offset:1024 lds
    s_add_u32 m0, s41, 61440
    s_xor_b32 s44, s62, 1966080
    buffer_load_dwordx4 v16, s[12:15], s44 offen offset:0 lds
    buffer_load_dwordx4 v17, s[12:15], s44 offen offset:1024 lds
    s_branch s_tail
z_start:
    v_lshrrev_b32 v24, 4, v1
    v_lshrrev_b32 v25, 3, v24
    v_mul_u32_u24 v20, 6144, v25
    v_and_b32 v25, 7, v24
    v_lshl_add_u32 v20, v25, 4, v20
    s_add_u32 s3, s18, 2
    s_and_b32 s3, s3, 15
    s_lshl_b32 s3, s3, 7
    s_add_u32 s3, s3, 4096
    v_add_u32 v22, s3, v20
    s_add_u32 s3, s18, 1
    s_and_b32 s3, s3, 15
    s_lshl_b32 s3, s3, 7
    s_add_u32 s3, s3, 2048
    v_add_u32 v21, s3, v20
    s_add_u32 s3, s18, 0
    s_and_b32 s3, s3, 15
    s_lshl_b32 s3, s3, 7
    s_add_u32 s3, s3, 0
    v_add_u32 v20, s3, v20
    s_waitcnt lgkmcnt(0)
    s_mov_b32 s8, s24
    s_mov_b32 s9, s25
    s_mov_b32 s10, 6291456
    s_mov_b32 s11, 0x00020000
    s_mul_i32 s44, s17, 393216
    buffer_load_dwordx4 v[32:35], v20, s[8:11], s44 offen
    buffer_load_dwordx4 v[64:67], v21, s[8:11], s44 offen
    buffer_load_dwordx4 v[96:99], v22, s[8:11], s44 offen
    s_add_u32 s44, s44, 49152
    buffer_load_dwordx4 v[36:39], v20, s[8:11], s44 offen
    buffer_load_dwordx4 v[68:71], v21, s[8:11], s44 offen
    buffer_load_dwordx4 v[100:103], v22, s[8:11], s44 offen
    s_add_u32 s44, s44, 49152
    buffer_load_dwordx4 v[40:43], v20, s[8:11], s44 offen
    buffer_load_dwordx4 v[72:75], v21, s[8:11], s44 offen
    buffer_load_dwordx4 v[104:107], v22, s[8:11], s44 offen
    s_add_u32 s44, s44, 49152
    buffer_load_dwordx4 v[44:47], v20, s[8:11], s44 offen
    buffer_load_dwordx4 v[76:79], v21, s[8:11], s44 offen
    buffer_load_dwordx4 v[108:111], v22, s[8:11], s44 offen
    s_add_u32 s44, s44, 49152
    buffer_load_dwordx4 v[48:51], v20, s[8:11], s44 offen
    buffer_load_dwordx4 v[80:83], v21, s[8:11], s44 offen
    buffer_load_dwordx4 v[112:115], v22, s[8:11], s44 offen
    s_add_u32 s44, s44, 49152
    buffer_load_dwordx4 v[52:55], v20, s[8:11], s44 offen
    buffer_load_dwordx4 v[84:87], v21, s[8:11], s44 offen
    buffer_load_dwordx4 v[116:119], v22, s[8:11], s44 offen
    s_add_u32 s44, s44, 49152
    buffer_load_dwordx4 v[56:59], v20, s[8:11], s44 offen
    buffer_load_dwordx4 v[88:91], v21, s[8:11], s44 offen
    buffer_load_dwordx4 v[120:123], v22, s[8:11], s44 offen
    s_add_u32 s44, s44, 49152
    buffer_load_dwordx4 v[60:63], v20, s[8:11], s44 offen
    buffer_load_dwordx4 v[92:95], v21, s[8:11], s44 offen
    buffer_load_dwordx4 v[124:127], v22, s[8:11], s44 offen
    v_lshrrev_b32 v24, 4, v1
    v_lshrrev_b32 v25, 3, v24
    v_mul_u32_u24 v12, 6144, v25
    v_and_b32 v26, 2, v25
    v_lshrrev_b32 v25, 2, v25
    v_or_b32 v26, v26, v25
    v_bfe_u32 v25, v24, 1, 2
    v_xor_b32 v26, v26, v25
    v_lshl_add_u32 v12, v26, 5, v12
    v_and_b32 v26, 1, v24
    v_lshl_add_u32 v12, v26, 4, v12
    s_lshl_b32 s3, s18, 7
    v_add_u32 v12, s3, v12
    v_add_u32 v13, 48128, v12
    v_add_u32 v14, 96256, v12
    v_add_u32 v15, 144384, v12
    v_lshrrev_b32 v24, 4, v1
    v_lshrrev_b32 v25, 3, v24
    v_mul_u32_u24 v16, 2048, v25
    v_and_b32 v26, 2, v25
    v_lshrrev_b32 v25, 2, v25
    v_or_b32 v26, v26, v25
    v_bfe_u32 v25, v24, 1, 2
    v_xor_b32 v26, v26, v25
    v_lshl_add_u32 v16, v26, 5, v16
    v_and_b32 v26, 1, v24
    v_lshl_add_u32 v16, v26, 4, v16
    s_lshl_b32 s3, s20, 7
    v_add_u32 v16, s3, v16
    v_add_u32 v17, 15360, v16
    v_add_u32 v18, 30720, v16
    v_add_u32 v19, 46080, v16
    s_mul_i32 s84, s18, 393216
    s_cmp_eq_u32 s18, 1
    s_cselect_b32 s85, 0, 393216
    s_cmp_eq_u32 s18, 2
    s_cselect_b32 s86, 0, 786432
    s_cmp_eq_u32 s18, 3
    s_cselect_b32 s87, 0, 1179648
    s_cmp_eq_u32 s18, 4
    s_cselect_b32 s88, 0, 1572864
    s_cmp_eq_u32 s18, 5
    s_cselect_b32 s89, 0, 1966080
    s_cmp_eq_u32 s18, 6
    s_cselect_b32 s90, 0, 2359296
    s_cmp_eq_u32 s18, 7
    s_cselect_b32 s91, 0, 2752512
    s_cmp_eq_u32 s18, 8
    s_cselect_b32 s92, 0, 3145728
    s_cmp_eq_u32 s18, 9
    s_cselect_b32 s93, 0, 3538944
    s_cmp_eq_u32 s18, 10
    s_cselect_b32 s94, 0, 3932160
    s_cmp_eq_u32 s18, 11
    s_cselect_b32 s95, 0, 4325376
    s_cmp_eq_u32 s18, 12
    s_cselect_b32 s96, 0, 4718592
    s_cmp_eq_u32 s18, 13
    s_cselect_b32 s97, 0, 5111808
    s_cmp_eq_u32 s18, 14
    s_cselect_b32 s98, 0, 5505024
    s_cmp_eq_u32 s18, 15
    s_cselect_b32 s99, 0, 5898240
    s_and_b32 s3, s16, 3
    s_mul_i32 s3, s3, 49152
    v_add_u32 v11, s3, v12
    s_and_b32 s3, s16, 3
    s_lshl_b32 s3, s3, 10
    v_add_u32 v9, s3, v1
    v_add_u32 v10, 0x10000, v9
    s_barrier
    s_setprio 3
    v_lshrrev_b32 v28, 4, v1
    v_and_b32 v29, 7, v28
    v_lshrrev_b32 v28, 3, v28
    v_mul_u32_u24 v28, 6144, v28
    v_lshl_add_u32 v28, v29, 4, v28
    s_and_b32 s3, s18, 12
    s_or_b32 s3, s3, 3
    s_lshl_b32 s3, s3, 7
    v_add_u32 v28, s3, v28
    s_lshr_b32 s3, s2, 3
    s_lshl_b32 s3, s3, 2
    s_and_b32 s60, s16, 3
    s_add_u32 s60, s60, s3
    s_lshr_b32 s60, s60, 2
    s_mul_i32 s60, s60, 49152
    s_and_b32 s3, s18, 0
    s_xor_b32 s3, s3, 0
    s_mul_i32 s3, s3, 393216
    s_add_u32 s3, s3, s60
    s_add_u32 s61, s3, 0
    buffer_load_dwordx4 v[160:163], v28, s[8:11], s61 offen
    s_add_u32 s61, s3, 2048
    buffer_load_dwordx4 v[164:167], v28, s[8:11], s61 offen
    s_add_u32 s61, s3, 4096
    buffer_load_dwordx4 v[168:171], v28, s[8:11], s61 offen
    s_setprio 0
    s_waitcnt vmcnt(3)
    v_lshrrev_b32 v24, 4, v1
    v_and_b32 v25, 1, v24
    v_lshlrev_b32 v25, 4, v25
    v_mov_b32 v26, 0x3f80
    v_lshlrev_b32 v25, v25, v26
    v_bfe_u32 v26, v24, 1, 2
    v_cmp_eq_u32 vcc, 0, v26
    s_nop 1
    v_cndmask_b32 v140, 0, v25, vcc
    v_cmp_eq_u32 vcc, 1, v26
    s_nop 1
    v_cndmask_b32 v141, 0, v25, vcc
    v_cmp_eq_u32 vcc, 2, v26
    s_nop 1
    v_cndmask_b32 v142, 0, v25, vcc
    v_cmp_eq_u32 vcc, 3, v26
    s_nop 1
    v_cndmask_b32 v143, 0, v25, vcc
    s_nop 1
    v_mfma_f32_16x16x32_bf16 v[128:131], v[140:143], v[32:35], 0
    v_mfma_f32_16x16x32_bf16 v[132:135], v[140:143], v[64:67], 0
    v_mfma_f32_16x16x32_bf16 v[136:139], v[140:143], v[96:99], 0
    v_mfma_f32_16x16x32_bf16 v[128:131], v[140:143], v[36:39], v[128:131]
    v_mfma_f32_16x16x32_bf16 v[132:135], v[140:143], v[68:71], v[132:135]
    v_mfma_f32_16x16x32_bf16 v[136:139], v[140:143], v[100:103], v[136:139]
    v_mfma_f32_16x16x32_bf16 v[128:131], v[140:143], v[40:43], v[128:131]
    v_mfma_f32_16x16x32_bf16 v[132:135], v[140:143], v[72:75], v[132:135]
    v_mfma_f32_16x16x32_bf16 v[136:139], v[140:143], v[104:107], v[136:139]
    v_mfma_f32_16x16x32_bf16 v[128:131], v[140:143], v[44:47], v[128:131]
    v_mfma_f32_16x16x32_bf16 v[132:135], v[140:143], v[76:79], v[132:135]
    v_mfma_f32_16x16x32_bf16 v[136:139], v[140:143], v[108:111], v[136:139]
    v_mfma_f32_16x16x32_bf16 v[128:131], v[140:143], v[48:51], v[128:131]
    v_mfma_f32_16x16x32_bf16 v[132:135], v[140:143], v[80:83], v[132:135]
    v_mfma_f32_16x16x32_bf16 v[136:139], v[140:143], v[112:115], v[136:139]
    v_mfma_f32_16x16x32_bf16 v[128:131], v[140:143], v[52:55], v[128:131]
    v_mfma_f32_16x16x32_bf16 v[132:135], v[140:143], v[84:87], v[132:135]
    v_mfma_f32_16x16x32_bf16 v[136:139], v[140:143], v[116:119], v[136:139]
    v_mfma_f32_16x16x32_bf16 v[128:131], v[140:143], v[56:59], v[128:131]
    v_mfma_f32_16x16x32_bf16 v[132:135], v[140:143], v[88:91], v[132:135]
    v_mfma_f32_16x16x32_bf16 v[136:139], v[140:143], v[120:123], v[136:139]
    v_mfma_f32_16x16x32_bf16 v[128:131], v[140:143], v[60:63], v[128:131]
    v_mfma_f32_16x16x32_bf16 v[132:135], v[140:143], v[92:95], v[132:135]
    v_mfma_f32_16x16x32_bf16 v[136:139], v[140:143], v[124:127], v[136:139]
    v_bfe_u32 v25, v24, 3, 1
    v_lshrrev_b32 v26, 5, v24
    v_lshl_add_u32 v26, v26, 1, v25
    v_lshlrev_b32 v25, 8, v26
    v_and_b32 v27, 7, v24
    v_lshl_add_u32 v25, v27, 5, v25
    v_bfe_u32 v27, v24, 4, 1
    v_lshl_add_u32 v25, v27, 4, v25
    v_add_f32_dpp v128, v128, v128 row_ror:8 row_mask:0xf bank_mask:0xf
    v_add_f32_dpp v129, v129, v129 row_ror:8 row_mask:0xf bank_mask:0xf
    v_add_f32_dpp v130, v130, v130 row_ror:8 row_mask:0xf bank_mask:0xf
    v_add_f32_dpp v131, v131, v131 row_ror:8 row_mask:0xf bank_mask:0xf
    v_add_f32_dpp v132, v132, v132 row_ror:8 row_mask:0xf bank_mask:0xf
    v_add_f32_dpp v133, v133, v133 row_ror:8 row_mask:0xf bank_mask:0xf
    v_add_f32_dpp v134, v134, v134 row_ror:8 row_mask:0xf bank_mask:0xf
    v_add_f32_dpp v135, v135, v135 row_ror:8 row_mask:0xf bank_mask:0xf
    v_add_f32_dpp v136, v136, v136 row_ror:8 row_mask:0xf bank_mask:0xf
    v_add_f32_dpp v137, v137, v137 row_ror:8 row_mask:0xf bank_mask:0xf
    v_add_f32_dpp v138, v138, v138 row_ror:8 row_mask:0xf bank_mask:0xf
    v_add_f32_dpp v139, v139, v139 row_ror:8 row_mask:0xf bank_mask:0xf
    v_cmp_le_u32 vcc, 1, v26
    s_nop 1
    v_cndmask_b32 v128, v128, v132, vcc
    v_cndmask_b32 v129, v129, v133, vcc
    v_cndmask_b32 v130, v130, v134, vcc
    v_cndmask_b32 v131, v131, v135, vcc
    v_cmp_le_u32 vcc, 2, v26
    s_nop 1
    v_cndmask_b32 v128, v128, v136, vcc
    v_cndmask_b32 v129, v129, v137, vcc
    v_cndmask_b32 v130, v130, v138, vcc
    v_cndmask_b32 v131, v131, v139, vcc
    v_add_u32 v27, s18, v26
    v_and_b32 v27, 15, v27
    v_lshl_add_u32 v25, v27, 14, v25
    s_lshl_b32 s44, s17, 10
    s_add_u32 s44, s44, 52428800
    buffer_store_dwordx4 v[128:131], v25, s[4:7], s44 offen sc1
    s_barrier
    v_lshrrev_b32 v28, 4, v1
    v_and_b32 v29, 7, v28
    v_lshrrev_b32 v28, 3, v28
    v_mul_u32_u24 v28, 6144, v28
    v_lshl_add_u32 v28, v29, 4, v28
    s_and_b32 s3, s18, 12
    s_or_b32 s3, s3, 3
    s_lshl_b32 s3, s3, 7
    v_add_u32 v28, s3, v28
    s_lshr_b32 s3, s2, 3
    s_lshl_b32 s3, s3, 2
    s_and_b32 s60, s16, 3
    s_add_u32 s60, s60, s3
    s_lshr_b32 s60, s60, 2
    s_mul_i32 s60, s60, 49152
    s_and_b32 s3, s18, 0
    s_xor_b32 s3, s3, 4
    s_mul_i32 s3, s3, 393216
    s_add_u32 s3, s3, s60
    s_add_u32 s61, s3, 0
    buffer_load_dwordx4 v[160:163], v28, s[8:11], s61 offen
    s_add_u32 s61, s3, 2048
    buffer_load_dwordx4 v[164:167], v28, s[8:11], s61 offen
    s_add_u32 s61, s3, 4096
    buffer_load_dwordx4 v[168:171], v28, s[8:11], s61 offen
    s_and_b32 s3, s18, 0
    s_xor_b32 s3, s3, 8
    s_mul_i32 s3, s3, 393216
    s_add_u32 s3, s3, s60
    s_add_u32 s61, s3, 0
    buffer_load_dwordx4 v[172:175], v28, s[8:11], s61 offen
    s_add_u32 s61, s3, 2048
    buffer_load_dwordx4 v[176:179], v28, s[8:11], s61 offen
    s_add_u32 s61, s3, 4096
    buffer_load_dwordx4 v[180:183], v28, s[8:11], s61 offen
    s_and_b32 s3, s18, 0
    s_xor_b32 s3, s3, 12
    s_mul_i32 s3, s3, 393216
    s_add_u32 s3, s3, s60
    s_add_u32 s61, s3, 0
    buffer_load_dwordx4 v[184:187], v28, s[8:11], s61 offen
    s_add_u32 s61, s3, 2048
    buffer_load_dwordx4 v[188:191], v28, s[8:11], s61 offen
    s_add_u32 s61, s3, 4096
    buffer_load_dwordx4 v[192:195], v28, s[8:11], s61 offen
    s_barrier
    s_barrier
    s_waitcnt vmcnt(0)
    s_add_u32 s44, s18, 0
    s_and_b32 s44, s44, 15
    s_lshl_b32 s44, s44, 7
    s_add_u32 s44, s44, 0
    s_atomic_add s40, s[22:23], s44
    s_add_u32 s45, s18, 1
    s_and_b32 s45, s45, 15
    s_lshl_b32 s45, s45, 7
    s_add_u32 s45, s45, 0
    s_atomic_add s40, s[22:23], s45
    s_add_u32 s46, s18, 2
    s_and_b32 s46, s46, 15
    s_lshl_b32 s46, s46, 7
    s_add_u32 s46, s46, 0
    s_atomic_add s40, s[22:23], s46
    s_barrier
    s_barrier
    s_barrier
    s_bfe_u32 s48, s2, 0x20003
    s_min_u32 s48, s48, 4
    s_max_u32 s48, s48, 4
    s_sub_u32 s49, 5, s48
z_n3:
    s_cmp_eq_u32 s48, 0
    s_cbranch_scc1 z_n3e
    s_barrier
    s_sub_u32 s48, s48, 1
    s_branch z_n3
z_n3e:
    s_mov_b32 s12, s26
    s_mov_b32 s13, s27
    s_mov_b32 s14, 2097152
    s_mov_b32 s15, 0x00020000
    s_lshl_b32 s44, s2, 13
    buffer_load_dwordx4 v[160:163], v1, s[12:15], s44 offen offset:0
    buffer_load_dwordx4 v[164:167], v1, s[12:15], s44 offen offset:1024
    buffer_load_dwordx4 v[168:171], v1, s[12:15], s44 offen offset:2048
    buffer_load_dwordx4 v[172:175], v1, s[12:15], s44 offen offset:3072
    s_add_u32 s44, s44, 4096
    buffer_load_dwordx4 v[176:179], v1, s[12:15], s44 offen offset:0
    buffer_load_dwordx4 v[180:183], v1, s[12:15], s44 offen offset:1024
    buffer_load_dwordx4 v[184:187], v1, s[12:15], s44 offen offset:2048
    buffer_load_dwordx4 v[188:191], v1, s[12:15], s44 offen offset:3072
    s_mov_b32 s8, s28
    s_mov_b32 s9, s29
    s_mov_b32 s10, 6291456
    s_mov_b32 s11, 0x00020000
    s_mul_i32 s44, s17, 393216
    buffer_load_dwordx4 v[32:35], v20, s[8:11], s44 offen
    buffer_load_dwordx4 v[64:67], v21, s[8:11], s44 offen
    buffer_load_dwordx4 v[96:99], v22, s[8:11], s44 offen
    s_add_u32 s44, s44, 49152
    buffer_load_dwordx4 v[36:39], v20, s[8:11], s44 offen
    buffer_load_dwordx4 v[68:71], v21, s[8:11], s44 offen
    buffer_load_dwordx4 v[100:103], v22, s[8:11], s44 offen
    s_add_u32 s44, s44, 49152
    buffer_load_dwordx4 v[40:43], v20, s[8:11], s44 offen
    buffer_load_dwordx4 v[72:75], v21, s[8:11], s44 offen
    buffer_load_dwordx4 v[104:107], v22, s[8:11], s44 offen
    s_add_u32 s44, s44, 49152
    s_barrier
    buffer_load_dwordx4 v[44:47], v20, s[8:11], s44 offen
    buffer_load_dwordx4 v[76:79], v21, s[8:11], s44 offen
    buffer_load_dwordx4 v[108:111], v22, s[8:11], s44 offen
    s_add_u32 s44, s44, 49152
    buffer_load_dwordx4 v[48:51], v20, s[8:11], s44 offen
    buffer_load_dwordx4 v[80:83], v21, s[8:11], s44 offen
    buffer_load_dwordx4 v[112:115], v22, s[8:11], s44 offen
    s_add_u32 s44, s44, 49152
    buffer_load_dwordx4 v[52:55], v20, s[8:11], s44 offen
    buffer_load_dwordx4 v[84:87], v21, s[8:11], s44 offen
    buffer_load_dwordx4 v[116:119], v22, s[8:11], s44 offen
    s_add_u32 s44, s44, 49152
    buffer_load_dwordx4 v[56:59], v20, s[8:11], s44 offen
    buffer_load_dwordx4 v[88:91], v21, s[8:11], s44 offen
    buffer_load_dwordx4 v[120:123], v22, s[8:11], s44 offen
    s_add_u32 s44, s44, 49152
    buffer_load_dwordx4 v[60:63], v20, s[8:11], s44 offen
    buffer_load_dwordx4 v[92:95], v21, s[8:11], s44 offen
    buffer_load_dwordx4 v[124:127], v22, s[8:11], s44 offen
z_n4:
    s_cmp_eq_u32 s49, 0
    s_cbranch_scc1 z_n4e
    s_barrier
    s_sub_u32 s49, s49, 1
    s_branch z_n4
z_n4e:
    s_bitcmp1_b32 s21, 0
    s_cselect_b32 s8, s28, s24
    s_cselect_b32 s9, s29, s25
    s_cselect_b32 s12, s30, s26
    s_cselect_b32 s13, s31, s27
    s_mov_b32 s10, 6291456
    s_mov_b32 s11, 0x00020000
    s_mov_b32 s14, 2097152
    s_mov_b32 s15, 0x00020000
    s_branch s_tail
z_layer:
    s_waitcnt lgkmcnt(0)
    s_barrier
    v_lshrrev_b32 v28, 4, v1
    v_and_b32 v29, 7, v28
    v_lshrrev_b32 v28, 3, v28
    v_mul_u32_u24 v28, 6144, v28
    v_lshl_add_u32 v28, v29, 4, v28
    s_and_b32 s3, s18, 12
    s_or_b32 s3, s3, 3
    s_lshl_b32 s3, s3, 7
    v_add_u32 v28, s3, v28
    s_lshr_b32 s3, s2, 3
    s_lshl_b32 s3, s3, 2
    s_and_b32 s60, s16, 3
    s_add_u32 s60, s60, s3
    s_lshr_b32 s60, s60, 2
    s_mul_i32 s60, s60, 49152
    s_and_b32 s3, s18, 0
    s_xor_b32 s3, s3, 4
    s_mul_i32 s3, s3, 393216
    s_add_u32 s3, s3, s60
    s_add_u32 s61, s3, 0
    buffer_load_dwordx4 v[160:163], v28, s[8:11], s61 offen
    s_add_u32 s61, s3, 2048
    buffer_load_dwordx4 v[164:167], v28, s[8:11], s61 offen
    s_add_u32 s61, s3, 4096
    buffer_load_dwordx4 v[168:171], v28, s[8:11], s61 offen
    s_and_b32 s3, s18, 0
    s_xor_b32 s3, s3, 8
    s_mul_i32 s3, s3, 393216
    s_add_u32 s3, s3, s60
    s_add_u32 s61, s3, 0
    buffer_load_dwordx4 v[172:175], v28, s[8:11], s61 offen
    s_add_u32 s61, s3, 2048
    buffer_load_dwordx4 v[176:179], v28, s[8:11], s61 offen
    s_add_u32 s61, s3, 4096
    buffer_load_dwordx4 v[180:183], v28, s[8:11], s61 offen
    s_and_b32 s3, s18, 0
    s_xor_b32 s3, s3, 12
    s_mul_i32 s3, s3, 393216
    s_add_u32 s3, s3, s60
    s_add_u32 s61, s3, 0
    buffer_load_dwordx4 v[184:187], v28, s[8:11], s61 offen
    s_add_u32 s61, s3, 2048
    buffer_load_dwordx4 v[188:191], v28, s[8:11], s61 offen
    s_add_u32 s61, s3, 4096
    buffer_load_dwordx4 v[192:195], v28, s[8:11], s61 offen
    s_barrier
    s_barrier
    s_barrier
    s_barrier
    s_barrier
    s_barrier
    s_barrier
    s_barrier
    s_barrier
    v_lshrrev_b32 v28, 4, v1
    v_and_b32 v29, 7, v28
    v_lshrrev_b32 v28, 3, v28
    v_mul_u32_u24 v28, 2048, v28
    v_lshl_add_u32 v28, v29, 4, v28
    s_and_b32 s3, s20, 12
    s_or_b32 s3, s3, 3
    s_lshl_b32 s3, s3, 7
    v_add_u32 v28, s3, v28
    s_lshr_b32 s3, s2, 3
    s_lshl_b32 s3, s3, 2
    s_and_b32 s60, s16, 3
    s_add_u32 s60, s60, s3
    s_lshl_b32 s61, s60, 14
    buffer_load_dwordx4 v[144:147], v28, s[12:15], s61 offen
    s_bitcmp0_b32 s21, 0
    s_cselect_b32 s56, s28, s24
    s_cselect_b32 s57, s29, s25
    s_mov_b32 s58, 6291456
    s_mov_b32 s59, 0x00020000
    v_lshrrev_b32 v28, 4, v1
    v_and_b32 v29, 7, v28
    v_lshrrev_b32 v28, 3, v28
    v_mul_u32_u24 v28, 6144, v28
    v_lshl_add_u32 v28, v29, 4, v28
    s_and_b32 s3, s18, 12
    s_or_b32 s3, s3, 3
    s_lshl_b32 s3, s3, 7
    v_add_u32 v28, s3, v28
    s_lshr_b32 s3, s2, 3
    s_lshl_b32 s3, s3, 2
    s_and_b32 s60, s16, 3
    s_add_u32 s60, s60, s3
    s_and_b32 s3, s60, 31
    s_mul_i32 s3, s3, 49152
    s_lshr_b32 s61, s60, 5
    s_min_u32 s61, s61, 2
    s_lshl_b32 s61, s61, 11
    s_add_u32 s61, s61, s3
    s_and_b32 s3, s18, 0
    s_mul_i32 s3, s3, 393216
    s_add_u32 s61, s61, s3
    buffer_load_dwordx4 v[148:151], v28, s[56:59], s61 offen
    s_cmp_lg_u32 s21, 2
    s_cbranch_scc1 z_pe
    s_bitcmp0_b32 s21, 0
    s_cselect_b32 s56, s28, s24
    s_cselect_b32 s57, s29, s25
    s_mov_b32 s58, 6291456
    s_mov_b32 s59, 0x00020000
    s_add_u32 s61, s84, 2048
    buffer_load_dwordx4 v[160:163], v11, s[56:59], s61 offen
    s_add_u32 s61, s84, 4096
    buffer_load_dwordx4 v[164:167], v11, s[56:59], s61 offen
    s_add_u32 s61, s84, 0
    buffer_load_dwordx4 v[168:171], v11, s[56:59], s61 offen
    s_add_u32 s61, s84, 198656
    buffer_load_dwordx4 v[172:175], v11, s[56:59], s61 offen
    s_add_u32 s61, s84, 200704
    buffer_load_dwordx4 v[176:179], v11, s[56:59], s61 offen
    s_add_u32 s61, s84, 196608
    buffer_load_dwordx4 v[180:183], v11, s[56:59], s61 offen
    s_add_u32 s61, s85, 2048
    buffer_load_dwordx4 v[184:187], v11, s[56:59], s61 offen
    s_add_u32 s61, s85, 4096
    buffer_load_dwordx4 v[188:191], v11, s[56:59], s61 offen
    s_add_u32 s61, s85, 0
    buffer_load_dwordx4 v[192:195], v11, s[56:59], s61 offen
    s_add_u32 s61, s85, 198656
    buffer_load_dwordx4 v[196:199], v11, s[56:59], s61 offen
z_pe:
    s_barrier
    s_branch s_tail
s_tail:
    s_bitcmp1_b32 s21, 0
    s_cbranch_scc1 s_B
    s_cmp_lg_u32 s16, 4
    s_cbranch_scc1 s_a1
    s_mov_b32 s45, 2146435072
    s_cmp_eq_u32 s17, 0
    s_cbranch_scc1 s_a0
    s_lshr_b32 s46, s21, 1
    s_lshl_b32 s44, s46, 15
    s_lshl_b32 s67, s17, 11
    s_add_u32 s44, s44, s67
    s_lshl_b32 s67, s18, 7
    s_add_u32 s44, s44, s67
    s_add_u32 s44, s44, 149504
    s_sub_u32 s45, s44, 151552
    s_lshl_b32 s45, s45, 5
    s_add_u32 s45, s45, 54525952
    s_mov_b32 s66, 0x10000
s_h_poll:
    s_mov_b32 s68, 0
    s_atomic_add s68, s[22:23], s44 offset:0 glc
    s_sub_u32 s66, s66, 1
    s_cselect_b32 s67, 1, 0
    s_waitcnt lgkmcnt(0)
    s_max_u32 s68, s68, s67
    s_cmp_lt_u32 s68, 1
    s_cbranch_scc1 s_h_poll
s_h_ok:
s_a0:
    s_mov_b32 m0, 131072
    s_nop 0
    buffer_load_dwordx4 v1, s[4:7], s45 offen offset:0 sc1 lds
    buffer_load_dwordx4 v1, s[4:7], s45 offen offset:1024 sc1 lds
    buffer_load_dwordx4 v1, s[4:7], s45 offen offset:2048 sc1 lds
    buffer_load_dwordx4 v1, s[4:7], s45 offen offset:3072 sc1 lds
    s_waitcnt vmcnt(0)
s_a1:
    s_barrier
    s_waitcnt vmcnt(0)
    s_barrier
    s_sub_u32 s3, s16, 5
    s_cmp_gt_u32 s3, 1
    s_cbranch_scc1 s_a2
    s_add_u32 m0, s41, 65536
    s_xor_b32 s44, s62, 65536
    buffer_load_dwordx4 v16, s[12:15], s44 offen offset:0 lds
    buffer_load_dwordx4 v17, s[12:15], s44 offen offset:1024 lds
    s_add_u32 m0, s41, 69632
    s_xor_b32 s44, s62, 196608
    buffer_load_dwordx4 v16, s[12:15], s44 offen offset:0 lds
    buffer_load_dwordx4 v17, s[12:15], s44 offen offset:1024 lds
    s_add_u32 m0, s41, 73728
    s_xor_b32 s44, s62, 327680
    buffer_load_dwordx4 v16, s[12:15], s44 offen offset:0 lds
    buffer_load_dwordx4 v17, s[12:15], s44 offen offset:1024 lds
    s_add_u32 m0, s41, 77824
    s_xor_b32 s44, s62, 458752
    buffer_load_dwordx4 v16, s[12:15], s44 offen offset:0 lds
    buffer_load_dwordx4 v17, s[12:15], s44 offen offset:1024 lds
    s_add_u32 m0, s41, 81920
    s_xor_b32 s44, s62, 589824
    buffer_load_dwordx4 v16, s[12:15], s44 offen offset:0 lds
    buffer_load_dwordx4 v17, s[12:15], s44 offen offset:1024 lds
    s_add_u32 m0, s41, 86016
    s_xor_b32 s44, s62, 720896
    buffer_load_dwordx4 v16, s[12:15], s44 offen offset:0 lds
    buffer_load_dwordx4 v17, s[12:15], s44 offen offset:1024 lds
    s_add_u32 m0, s41, 90112
    s_xor_b32 s44, s62, 851968
    buffer_load_dwordx4 v16, s[12:15], s44 offen offset:0 lds
    buffer_load_dwordx4 v17, s[12:15], s44 offen offset:1024 lds
    s_add_u32 m0, s41, 94208
    s_xor_b32 s44, s62, 983040
    buffer_load_dwordx4 v16, s[12:15], s44 offen offset:0 lds
    buffer_load_dwordx4 v17, s[12:15], s44 offen offset:1024 lds
    s_add_u32 m0, s41, 98304
    s_xor_b32 s44, s62, 1114112
    buffer_load_dwordx4 v16, s[12:15], s44 offen offset:0 lds
    buffer_load_dwordx4 v17, s[12:15], s44 offen offset:1024 lds
    s_add_u32 m0, s41, 102400
    s_xor_b32 s44, s62, 1245184
    buffer_load_dwordx4 v16, s[12:15], s44 offen offset:0 lds
    buffer_load_dwordx4 v17, s[12:15], s44 offen offset:1024 lds
    s_add_u32 m0, s41, 106496
    s_xor_b32 s44, s62, 1376256
    buffer_load_dwordx4 v16, s[12:15], s44 offen offset:0 lds
    buffer_load_dwordx4 v17, s[12:15], s44 offen offset:1024 lds
    s_add_u32 m0, s41, 110592
    s_xor_b32 s44, s62, 1507328
    buffer_load_dwordx4 v16, s[12:15], s44 offen offset:0 lds
    buffer_load_dwordx4 v17, s[12:15], s44 offen offset:1024 lds
    s_add_u32 m0, s41, 114688
    s_xor_b32 s44, s62, 1638400
    buffer_load_dwordx4 v16, s[12:15], s44 offen offset:0 lds
    buffer_load_dwordx4 v17, s[12:15], s44 offen offset:1024 lds
    s_add_u32 m0, s41, 118784
    s_xor_b32 s44, s62, 1769472
    buffer_load_dwordx4 v16, s[12:15], s44 offen offset:0 lds
    buffer_load_dwordx4 v17, s[12:15], s44 offen offset:1024 lds
    s_add_u32 m0, s41, 122880
    s_xor_b32 s44, s62, 1900544
    buffer_load_dwordx4 v16, s[12:15], s44 offen offset:0 lds
    buffer_load_dwordx4 v17, s[12:15], s44 offen offset:1024 lds
    s_add_u32 m0, s41, 126976
    s_xor_b32 s44, s62, 2031616
    buffer_load_dwordx4 v16, s[12:15], s44 offen offset:0 lds
    buffer_load_dwordx4 v17, s[12:15], s44 offen offset:1024 lds
s_a2:
    s_cmp_eq_u32 s21, 2
    s_cbranch_scc1 s_a3
    s_bitcmp0_b32 s21, 0
    s_cselect_b32 s56, s28, s24
    s_cselect_b32 s57, s29, s25
    s_mov_b32 s58, 6291456
    s_mov_b32 s59, 0x00020000
    s_add_u32 s61, s84, 2048
    buffer_load_dwordx4 v[160:163], v11, s[56:59], s61 offen
    s_add_u32 s61, s84, 4096
    buffer_load_dwordx4 v[164:167], v11, s[56:59], s61 offen
    s_add_u32 s61, s84, 0
    buffer_load_dwordx4 v[168:171], v11, s[56:59], s61 offen
    s_add_u32 s61, s84, 198656
    buffer_load_dwordx4 v[172:175], v11, s[56:59], s61 offen
    s_add_u32 s61, s84, 200704
    buffer_load_dwordx4 v[176:179], v11, s[56:59], s61 offen
    s_add_u32 s61, s84, 196608
    buffer_load_dwordx4 v[180:183], v11, s[56:59], s61 offen
    s_add_u32 s61, s85, 2048
    buffer_load_dwordx4 v[184:187], v11, s[56:59], s61 offen
    s_add_u32 s61, s85, 4096
    buffer_load_dwordx4 v[188:191], v11, s[56:59], s61 offen
    s_add_u32 s61, s85, 0
    buffer_load_dwordx4 v[192:195], v11, s[56:59], s61 offen
    s_add_u32 s61, s85, 198656
    buffer_load_dwordx4 v[196:199], v11, s[56:59], s61 offen
s_a3:
    s_bitcmp0_b32 s21, 0
    s_cselect_b32 s56, s28, s24
    s_cselect_b32 s57, s29, s25
    s_mov_b32 s58, 6291456
    s_mov_b32 s59, 0x00020000
    s_add_u32 s61, s85, 200704
    buffer_load_dwordx4 v[200:203], v11, s[56:59], s61 offen
    s_add_u32 s61, s85, 196608
    buffer_load_dwordx4 v[204:207], v11, s[56:59], s61 offen
    s_add_u32 s61, s86, 2048
    buffer_load_dwordx4 v[208:211], v11, s[56:59], s61 offen
    s_add_u32 s61, s86, 4096
    buffer_load_dwordx4 v[212:215], v11, s[56:59], s61 offen
    s_add_u32 s61, s86, 0
    buffer_load_dwordx4 v[216:219], v11, s[56:59], s61 offen
    s_add_u32 s61, s86, 198656
    buffer_load_dwordx4 v[220:223], v11, s[56:59], s61 offen
    s_add_u32 s61, s86, 200704
    buffer_load_dwordx4 v[224:227], v11, s[56:59], s61 offen
    s_add_u32 s61, s86, 196608
    buffer_load_dwordx4 v[228:231], v11, s[56:59], s61 offen
    s_add_u32 s61, s87, 2048
    buffer_load_dwordx4 v[232:235], v11, s[56:59], s61 offen
    s_add_u32 s61, s87, 4096
    buffer_load_dwordx4 v[236:239], v11, s[56:59], s61 offen
    s_add_u32 s61, s87, 0
    buffer_load_dwordx4 v[240:243], v11, s[56:59], s61 offen
    s_add_u32 s61, s87, 198656
    buffer_load_dwordx4 v[244:247], v11, s[56:59], s61 offen
    s_add_u32 s61, s87, 200704
    buffer_load_dwordx4 v[248:251], v11, s[56:59], s61 offen
    s_add_u32 s61, s87, 196608
    buffer_load_dwordx4 v[252:255], v11, s[56:59], s61 offen
    s_waitcnt vmcnt(0)
    s_lshl_b32 s3, s21, 3
    s_add_u32 s3, s3, s16
    s_cmp_lg_u32 s3, 7
    s_cbranch_scc1 s_g3
    v_lshrrev_b32 v24, 4, v1
    v_and_b32 v25, 1, v24
    v_lshlrev_b32 v25, 4, v25
    v_mov_b32 v26, 0x3f80
    v_lshlrev_b32 v25, v25, v26
    v_bfe_u32 v26, v24, 1, 2
    v_cmp_eq_u32 vcc, 0, v26
    s_nop 1
    v_cndmask_b32 v140, 0, v25, vcc
    v_cmp_eq_u32 vcc, 1, v26
    s_nop 1
    v_cndmask_b32 v141, 0, v25, vcc
    v_cmp_eq_u32 vcc, 2, v26
    s_nop 1
    v_cndmask_b32 v142, 0, v25, vcc
    v_cmp_eq_u32 vcc, 3, v26
    s_nop 1
    v_cndmask_b32 v143, 0, v25, vcc
    s_nop 1
    v_mfma_f32_16x16x32_bf16 v[128:131], v[140:143], v[32:35], 0
    v_mfma_f32_16x16x32_bf16 v[132:135], v[140:143], v[64:67], 0
    v_mfma_f32_16x16x32_bf16 v[136:139], v[140:143], v[96:99], 0
    v_mfma_f32_16x16x32_bf16 v[128:131], v[140:143], v[36:39], v[128:131]
    v_mfma_f32_16x16x32_bf16 v[132:135], v[140:143], v[68:71], v[132:135]
    v_mfma_f32_16x16x32_bf16 v[136:139], v[140:143], v[100:103], v[136:139]
    v_mfma_f32_16x16x32_bf16 v[128:131], v[140:143], v[40:43], v[128:131]
    v_mfma_f32_16x16x32_bf16 v[132:135], v[140:143], v[72:75], v[132:135]
    v_mfma_f32_16x16x32_bf16 v[136:139], v[140:143], v[104:107], v[136:139]
    v_mfma_f32_16x16x32_bf16 v[128:131], v[140:143], v[44:47], v[128:131]
    v_mfma_f32_16x16x32_bf16 v[132:135], v[140:143], v[76:79], v[132:135]
    v_mfma_f32_16x16x32_bf16 v[136:139], v[140:143], v[108:111], v[136:139]
    v_mfma_f32_16x16x32_bf16 v[128:131], v[140:143], v[48:51], v[128:131]
    v_mfma_f32_16x16x32_bf16 v[132:135], v[140:143], v[80:83], v[132:135]
    v_mfma_f32_16x16x32_bf16 v[136:139], v[140:143], v[112:115], v[136:139]
    v_mfma_f32_16x16x32_bf16 v[128:131], v[140:143], v[52:55], v[128:131]
    v_mfma_f32_16x16x32_bf16 v[132:135], v[140:143], v[84:87], v[132:135]
    v_mfma_f32_16x16x32_bf16 v[136:139], v[140:143], v[116:119], v[136:139]
    v_mfma_f32_16x16x32_bf16 v[128:131], v[140:143], v[56:59], v[128:131]
    v_mfma_f32_16x16x32_bf16 v[132:135], v[140:143], v[88:91], v[132:135]
    v_mfma_f32_16x16x32_bf16 v[136:139], v[140:143], v[120:123], v[136:139]
    v_mfma_f32_16x16x32_bf16 v[128:131], v[140:143], v[60:63], v[128:131]
    v_mfma_f32_16x16x32_bf16 v[132:135], v[140:143], v[92:95], v[132:135]
    v_mfma_f32_16x16x32_bf16 v[136:139], v[140:143], v[124:127], v[136:139]
    v_bfe_u32 v25, v24, 3, 1
    v_lshrrev_b32 v26, 5, v24
    v_lshl_add_u32 v26, v26, 1, v25
    v_lshlrev_b32 v25, 8, v26
    v_and_b32 v27, 7, v24
    v_lshl_add_u32 v25, v27, 5, v25
    v_bfe_u32 v27, v24, 4, 1
    v_lshl_add_u32 v25, v27, 4, v25
    v_add_f32_dpp v128, v128, v128 row_ror:8 row_mask:0xf bank_mask:0xf
    v_add_f32_dpp v129, v129, v129 row_ror:8 row_mask:0xf bank_mask:0xf
    v_add_f32_dpp v130, v130, v130 row_ror:8 row_mask:0xf bank_mask:0xf
    v_add_f32_dpp v131, v131, v131 row_ror:8 row_mask:0xf bank_mask:0xf
    v_add_f32_dpp v132, v132, v132 row_ror:8 row_mask:0xf bank_mask:0xf
    v_add_f32_dpp v133, v133, v133 row_ror:8 row_mask:0xf bank_mask:0xf
    v_add_f32_dpp v134, v134, v134 row_ror:8 row_mask:0xf bank_mask:0xf
    v_add_f32_dpp v135, v135, v135 row_ror:8 row_mask:0xf bank_mask:0xf
    v_add_f32_dpp v136, v136, v136 row_ror:8 row_mask:0xf bank_mask:0xf
    v_add_f32_dpp v137, v137, v137 row_ror:8 row_mask:0xf bank_mask:0xf
    v_add_f32_dpp v138, v138, v138 row_ror:8 row_mask:0xf bank_mask:0xf
    v_add_f32_dpp v139, v139, v139 row_ror:8 row_mask:0xf bank_mask:0xf
    v_cmp_le_u32 vcc, 1, v26
    s_nop 1
    v_cndmask_b32 v128, v128, v132, vcc
    v_cndmask_b32 v129, v129, v133, vcc
    v_cndmask_b32 v130, v130, v134, vcc
    v_cndmask_b32 v131, v131, v135, vcc
    v_cmp_le_u32 vcc, 2, v26
    s_nop 1
    v_cndmask_b32 v128, v128, v136, vcc
    v_cndmask_b32 v129, v129, v137, vcc
    v_cndmask_b32 v130, v130, v138, vcc
    v_cndmask_b32 v131, v131, v139, vcc
    v_add_u32 v27, s18, v26
    v_and_b32 v27, 15, v27
    v_lshl_add_u32 v25, v27, 14, v25
    s_lshl_b32 s44, s17, 10
    s_add_u32 s44, s44, 52690944
    buffer_store_dwordx4 v[128:131], v25, s[4:7], s44 offen sc1
    s_waitcnt vmcnt(0)
    s_add_u32 s44, s18, 0
    s_and_b32 s44, s44, 15
    s_lshl_b32 s44, s44, 7
    s_add_u32 s44, s44, 2048
    s_atomic_add s40, s[22:23], s44
    s_add_u32 s45, s18, 1
    s_and_b32 s45, s45, 15
    s_lshl_b32 s45, s45, 7
    s_add_u32 s45, s45, 2048
    s_atomic_add s40, s[22:23], s45
    s_add_u32 s46, s18, 2
    s_and_b32 s46, s46, 15
    s_lshl_b32 s46, s46, 7
    s_add_u32 s46, s46, 2048
    s_atomic_add s40, s[22:23], s46
    s_branch s_g3
s_B:
    s_barrier
    s_setprio 3
    s_mov_b32 s52, 0
    s_lshl_b32 s44, s16, 14
    v_add_u32 v24, s44, v1
    s_and_b32 s3, s16, 3
    s_lshl_b32 s44, s3, 10
    s_add_u32 s44, s44, 147456
    v_lshrrev_b32 v25, 2, v1
    v_add_u32 v25, s44, v25
    s_lshl_b32 s53, s21, 22
    s_lshl_b32 s44, s38, 16
    s_add_u32 s53, s53, s44
    s_lshl_b32 s44, s18, 12
    s_add_u32 s53, s53, s44
    s_add_u32 s53, s53, 16777216
    s_lshl_b32 s54, s21, 14
    s_lshl_b32 s67, s38, 8
    s_add_u32 s54, s54, s67
    s_add_u32 s54, s54, 86016
s_bhead:
    s_barrier
    s_waitcnt vmcnt(0) lgkmcnt(0)
    s_barrier
    ds_read_b32 v28, v25 offset:0
    ds_read_b32 v29, v25 offset:256
    ds_read_b32 v30, v25 offset:512
    ds_read_b32 v31, v25 offset:768
    ds_read_b128 v[32:35], v24 offset:0
    ds_read_b128 v[36:39], v24 offset:1024
    ds_read_b128 v[40:43], v24 offset:2048
    ds_read_b128 v[44:47], v24 offset:3072
    ds_read_b128 v[48:51], v24 offset:4096
    ds_read_b128 v[52:55], v24 offset:5120
    ds_read_b128 v[56:59], v24 offset:6144
    ds_read_b128 v[60:63], v24 offset:7168
    ds_read_b128 v[64:67], v24 offset:8192
    ds_read_b128 v[68:71], v24 offset:9216
    ds_read_b128 v[72:75], v24 offset:10240
    ds_read_b128 v[76:79], v24 offset:11264
    ds_read_b128 v[80:83], v24 offset:12288
    ds_read_b128 v[84:87], v24 offset:13312
    ds_read_b128 v[88:91], v24 offset:14336
    ds_read_b128 v[92:95], v24 offset:15360
    s_waitcnt lgkmcnt(15)
    v_add_f32 v28, v28, v29
    v_add_f32 v30, v30, v31
    v_add_f32 v28, v28, v30
    v_mov_b32 v29, 0x5d800000
    v_mov_b32 v30, 0x21800000
    v_cmp_nlt_f32 s[44:45], v28, v29
    v_cmp_ngt_f32 vcc, v28, v30
    v_rcp_f32 v28, v28
    s_or_b64 vcc, vcc, s[44:45]
    s_waitcnt lgkmcnt(8)
    v_pk_add_f32 v[32:33], v[32:33], v[48:49]
    v_pk_add_f32 v[34:35], v[34:35], v[50:51]
    v_pk_add_f32 v[36:37], v[36:37], v[52:53]
    v_pk_add_f32 v[38:39], v[38:39], v[54:55]
    v_pk_add_f32 v[40:41], v[40:41], v[56:57]
    v_pk_add_f32 v[42:43], v[42:43], v[58:59]
    v_pk_add_f32 v[44:45], v[44:45], v[60:61]
    v_pk_add_f32 v[46:47], v[46:47], v[62:63]
    s_waitcnt lgkmcnt(4)
    v_pk_add_f32 v[32:33], v[32:33], v[64:65]
    v_pk_add_f32 v[34:35], v[34:35], v[66:67]
    v_pk_add_f32 v[36:37], v[36:37], v[68:69]
    v_pk_add_f32 v[38:39], v[38:39], v[70:71]
    v_pk_add_f32 v[40:41], v[40:41], v[72:73]
    v_pk_add_f32 v[42:43], v[42:43], v[74:75]
    v_pk_add_f32 v[44:45], v[44:45], v[76:77]
    v_pk_add_f32 v[46:47], v[46:47], v[78:79]
    s_waitcnt lgkmcnt(0)
    v_pk_add_f32 v[32:33], v[32:33], v[80:81]
    v_pk_add_f32 v[34:35], v[34:35], v[82:83]
    v_pk_add_f32 v[36:37], v[36:37], v[84:85]
    v_pk_add_f32 v[38:39], v[38:39], v[86:87]
    v_pk_add_f32 v[40:41], v[40:41], v[88:89]
    v_pk_add_f32 v[42:43], v[42:43], v[90:91]
    v_pk_add_f32 v[44:45], v[44:45], v[92:93]
    v_pk_add_f32 v[46:47], v[46:47], v[94:95]
    s_cbranch_vccnz s_slow
s_fin:
    v_pk_mul_f32 v[32:33], v[28:29], v[32:33] op_sel_hi:[0,1]
    v_pk_mul_f32 v[34:35], v[28:29], v[34:35] op_sel_hi:[0,1]
    v_pk_mul_f32 v[36:37], v[28:29], v[36:37] op_sel_hi:[0,1]
    v_pk_mul_f32 v[38:39], v[28:29], v[38:39] op_sel_hi:[0,1]
    v_pk_mul_f32 v[40:41], v[28:29], v[40:41] op_sel_hi:[0,1]
    v_pk_mul_f32 v[42:43], v[28:29], v[42:43] op_sel_hi:[0,1]
    v_pk_mul_f32 v[44:45], v[28:29], v[44:45] op_sel_hi:[0,1]
    v_pk_mul_f32 v[46:47], v[28:29], v[46:47] op_sel_hi:[0,1]
    v_cvt_pk_bf16_f32 v32, v32, v33
    v_cvt_pk_bf16_f32 v33, v34, v35
    v_cvt_pk_bf16_f32 v34, v36, v37
    v_cvt_pk_bf16_f32 v35, v38, v39
    v_cvt_pk_bf16_f32 v36, v40, v41
    v_cvt_pk_bf16_f32 v37, v42, v43
    v_cvt_pk_bf16_f32 v38, v44, v45
    v_cvt_pk_bf16_f32 v39, v46, v47
    buffer_store_dwordx4 v[32:35], v1, s[4:7], s53 offen offset:0 sc1
    buffer_store_dwordx4 v[36:39], v1, s[4:7], s53 offen offset:1024 sc1
    s_cmp_lg_u32 s52, 0
    s_cbranch_scc1 s_b2
    s_waitcnt vmcnt(0)
    s_atomic_add s40, s[22:23], s54
    s_mov_b32 s52, 1
    s_add_u32 s53, s53, 2048
    s_waitcnt lgkmcnt(0)
    s_add_u32 s54, s54, 128
    s_setprio 0
    s_and_b32 s3, s16, 3
    s_lshl_b32 s46, s3, 19
    s_lshl_b32 s45, s3, 14
    s_and_b32 s3, s20, 0
    s_lshl_b32 s3, s3, 17
    s_xor_b32 s46, s46, s3
    s_add_u32 m0, s45, 0
    s_xor_b32 s44, s46, 0
    buffer_load_dwordx4 v16, s[12:15], s44 offen offset:0 lds
    buffer_load_dwordx4 v17, s[12:15], s44 offen offset:1024 lds
    buffer_load_dwordx4 v18, s[12:15], s44 offen offset:2048 lds
    buffer_load_dwordx4 v19, s[12:15], s44 offen offset:3072 lds
    s_add_u32 s44, s44, 65536
    s_waitcnt vmcnt(2)
    buffer_load_dwordx4 v[96:99], v16, s[12:15], s44 offen offset:0
    buffer_load_dwordx4 v[100:103], v17, s[12:15], s44 offen offset:1024
    buffer_load_dwordx4 v[104:107], v18, s[12:15], s44 offen offset:2048
    buffer_load_dwordx4 v[108:111], v19, s[12:15], s44 offen offset:3072
    s_waitcnt vmcnt(2)
    s_add_u32 m0, s45, 4096
    s_xor_b32 s44, s46, 131072
    buffer_load_dwordx4 v16, s[12:15], s44 offen offset:0 lds
    buffer_load_dwordx4 v17, s[12:15], s44 offen offset:1024 lds
    buffer_load_dwordx4 v18, s[12:15], s44 offen offset:2048 lds
    buffer_load_dwordx4 v19, s[12:15], s44 offen offset:3072 lds
    s_add_u32 s44, s44, 65536
    s_waitcnt vmcnt(2)
    buffer_load_dwordx4 v[112:115], v16, s[12:15], s44 offen offset:0
    buffer_load_dwordx4 v[116:119], v17, s[12:15], s44 offen offset:1024
    buffer_load_dwordx4 v[120:123], v18, s[12:15], s44 offen offset:2048
    buffer_load_dwordx4 v[124:127], v19, s[12:15], s44 offen offset:3072
    s_waitcnt vmcnt(2)
    s_add_u32 m0, s45, 8192
    s_xor_b32 s44, s46, 262144
    buffer_load_dwordx4 v16, s[12:15], s44 offen offset:0 lds
    buffer_load_dwordx4 v17, s[12:15], s44 offen offset:1024 lds
    buffer_load_dwordx4 v18, s[12:15], s44 offen offset:2048 lds
    buffer_load_dwordx4 v19, s[12:15], s44 offen offset:3072 lds
    s_add_u32 s44, s44, 65536
    s_waitcnt vmcnt(2)
    buffer_load_dwordx4 v[128:131], v16, s[12:15], s44 offen offset:0
    buffer_load_dwordx4 v[132:135], v17, s[12:15], s44 offen offset:1024
    buffer_load_dwordx4 v[136:139], v18, s[12:15], s44 offen offset:2048
    buffer_load_dwordx4 v[140:143], v19, s[12:15], s44 offen offset:3072
    s_waitcnt vmcnt(2)
    s_add_u32 m0, s45, 12288
    s_xor_b32 s44, s46, 393216
    buffer_load_dwordx4 v16, s[12:15], s44 offen offset:0 lds
    buffer_load_dwordx4 v17, s[12:15], s44 offen offset:1024 lds
    buffer_load_dwordx4 v18, s[12:15], s44 offen offset:2048 lds
    buffer_load_dwordx4 v19, s[12:15], s44 offen offset:3072 lds
    s_add_u32 s44, s44, 65536
    s_waitcnt vmcnt(2)
    buffer_load_dwordx4 v[144:147], v16, s[12:15], s44 offen offset:0
    buffer_load_dwordx4 v[148:151], v17, s[12:15], s44 offen offset:1024
    buffer_load_dwordx4 v[152:155], v18, s[12:15], s44 offen offset:2048
    buffer_load_dwordx4 v[156:159], v19, s[12:15], s44 offen offset:3072
    s_waitcnt vmcnt(2)
    s_cmp_eq_u32 s21, 3
    s_cbranch_scc1 s_nopf
    s_bitcmp0_b32 s21, 0
    s_cselect_b32 s56, s28, s24
    s_cselect_b32 s57, s29, s25
    s_mov_b32 s58, 6291456
    s_mov_b32 s59, 0x00020000
    s_add_u32 s61, s84, 2048
    buffer_load_dwordx4 v[160:163], v11, s[56:59], s61 offen
    s_add_u32 s61, s84, 4096
    buffer_load_dwordx4 v[164:167], v11, s[56:59], s61 offen
    s_add_u32 s61, s84, 0
    buffer_load_dwordx4 v[168:171], v11, s[56:59], s61 offen
    s_add_u32 s61, s84, 198656
    buffer_load_dwordx4 v[172:175], v11, s[56:59], s61 offen
    s_waitcnt vmcnt(2)
    s_add_u32 s61, s84, 200704
    buffer_load_dwordx4 v[176:179], v11, s[56:59], s61 offen
    s_add_u32 s61, s84, 196608
    buffer_load_dwordx4 v[180:183], v11, s[56:59], s61 offen
    s_add_u32 s61, s85, 2048
    buffer_load_dwordx4 v[184:187], v11, s[56:59], s61 offen
    s_add_u32 s61, s85, 4096
    buffer_load_dwordx4 v[188:191], v11, s[56:59], s61 offen
    s_waitcnt vmcnt(2)
    s_add_u32 s61, s85, 0
    buffer_load_dwordx4 v[192:195], v11, s[56:59], s61 offen
    s_add_u32 s61, s85, 198656
    buffer_load_dwordx4 v[196:199], v11, s[56:59], s61 offen
    s_add_u32 s61, s85, 200704
    buffer_load_dwordx4 v[200:203], v11, s[56:59], s61 offen
    s_add_u32 s61, s85, 196608
    buffer_load_dwordx4 v[204:207], v11, s[56:59], s61 offen
    s_waitcnt vmcnt(2)
    s_add_u32 s61, s86, 2048
    buffer_load_dwordx4 v[208:211], v11, s[56:59], s61 offen
    s_add_u32 s61, s86, 4096
    buffer_load_dwordx4 v[212:215], v11, s[56:59], s61 offen
    s_add_u32 s61, s86, 0
    buffer_load_dwordx4 v[216:219], v11, s[56:59], s61 offen
    s_add_u32 s61, s86, 198656
    buffer_load_dwordx4 v[220:223], v11, s[56:59], s61 offen
    s_waitcnt vmcnt(2)
    s_add_u32 s61, s86, 200704
    buffer_load_dwordx4 v[224:227], v11, s[56:59], s61 offen
    s_add_u32 s61, s86, 196608
    buffer_load_dwordx4 v[228:231], v11, s[56:59], s61 offen
    s_add_u32 s61, s87, 2048
    buffer_load_dwordx4 v[232:235], v11, s[56:59], s61 offen
    s_add_u32 s61, s87, 4096
    buffer_load_dwordx4 v[236:239], v11, s[56:59], s61 offen
    s_waitcnt vmcnt(2)
    s_add_u32 s61, s87, 0
    buffer_load_dwordx4 v[240:243], v11, s[56:59], s61 offen
    s_add_u32 s61, s87, 198656
    buffer_load_dwordx4 v[244:247], v11, s[56:59], s61 offen
    s_add_u32 s61, s87, 200704
    buffer_load_dwordx4 v[248:251], v11, s[56:59], s61 offen
    s_add_u32 s61, s87, 196608
    buffer_load_dwordx4 v[252:255], v11, s[56:59], s61 offen
    s_waitcnt vmcnt(2)
s_nopf:
    s_setprio 3
    s_sub_u32 s44, s54, 128
    s_mov_b32 s66, 0x10000
s_o0_poll:
    s_mov_b32 s68, 0
    s_atomic_add s68, s[22:23], s44 offset:0 glc
    s_sub_u32 s66, s66, 1
    s_cselect_b32 s67, 16, 0
    s_waitcnt lgkmcnt(0)
    s_max_u32 s68, s68, s67
    s_cmp_lt_u32 s68, 16
    s_cbranch_scc1 s_o0_poll
s_o0_ok:
    s_branch s_bhead
s_b2:
    ds_write_b128 v24, v[96:99] offset:0
    ds_write_b128 v24, v[100:103] offset:1024
    ds_write_b128 v24, v[104:107] offset:2048
    ds_write_b128 v24, v[108:111] offset:3072
    ds_write_b128 v24, v[112:115] offset:4096
    ds_write_b128 v24, v[116:119] offset:5120
    ds_write_b128 v24, v[120:123] offset:6144
    ds_write_b128 v24, v[124:127] offset:7168
    ds_write_b128 v24, v[128:131] offset:8192
    ds_write_b128 v24, v[132:135] offset:9216
    ds_write_b128 v24, v[136:139] offset:10240
    ds_write_b128 v24, v[140:143] offset:11264
    ds_write_b128 v24, v[144:147] offset:12288
    ds_write_b128 v24, v[148:151] offset:13312
    ds_write_b128 v24, v[152:155] offset:14336
    ds_write_b128 v24, v[156:159] offset:15360
    s_waitcnt vmcnt(0)
    s_atomic_add s40, s[22:23], s54
    s_mov_b32 s66, 0x10000
s_o1_poll:
    s_mov_b32 s68, 0
    s_atomic_add s68, s[22:23], s54 offset:0 glc
    s_sub_u32 s66, s66, 1
    s_cselect_b32 s67, 16, 0
    s_waitcnt lgkmcnt(0)
    s_max_u32 s68, s68, s67
    s_cmp_lt_u32 s68, 16
    s_cbranch_scc1 s_o1_poll
s_o1_ok:
s_b3:
    s_setprio 0
    s_waitcnt lgkmcnt(0)
s_g3:
    s_barrier
    s_cmp_eq_u32 s21, 3
    s_cbranch_scc1 s_end
    s_barrier
    ds_write_b128 v9, v[160:163] offset:0
    ds_write_b128 v9, v[164:167] offset:4096
    ds_write_b128 v9, v[168:171] offset:8192
    ds_write_b128 v9, v[172:175] offset:12288
    ds_write_b128 v9, v[176:179] offset:16384
    ds_write_b128 v9, v[180:183] offset:20480
    ds_write_b128 v9, v[184:187] offset:24576
    ds_write_b128 v9, v[188:191] offset:28672
    s_add_u32 s21, s21, 1
    s_bitcmp1_b32 s21, 0
    s_cselect_b32 s8, s28, s24
    s_cselect_b32 s9, s29, s25
    s_cselect_b32 s12, s30, s26
    s_cselect_b32 s13, s31, s27
    s_mov_b32 s10, 6291456
    s_mov_b32 s11, 0x00020000
    s_mov_b32 s14, 2097152
    s_mov_b32 s15, 0x00020000
    s_waitcnt lgkmcnt(0)
    s_barrier
    ds_write_b128 v9, v[192:195] offset:32768
    ds_write_b128 v9, v[196:199] offset:36864
    ds_write_b128 v9, v[200:203] offset:40960
    ds_write_b128 v9, v[204:207] offset:45056
    ds_write_b128 v9, v[208:211] offset:49152
    ds_write_b128 v9, v[212:215] offset:53248
    ds_write_b128 v9, v[216:219] offset:57344
    ds_write_b128 v9, v[220:223] offset:61440
    ds_write_b128 v10, v[224:227] offset:0
    ds_write_b128 v10, v[228:231] offset:4096
    ds_write_b128 v10, v[232:235] offset:8192
    ds_write_b128 v10, v[236:239] offset:12288
    ds_write_b128 v10, v[240:243] offset:16384
    ds_write_b128 v10, v[244:247] offset:20480
    ds_write_b128 v10, v[248:251] offset:24576
    ds_write_b128 v10, v[252:255] offset:28672
    s_cmp_eq_u32 s16, 4
    s_cbranch_scc1 h_layer
    s_cmp_eq_u32 s16, 7
    s_cbranch_scc1 z_layer
    s_branch l_layer
s_end:
    s_lshl_b32 s3, s2, 3
    s_add_u32 s3, s3, s16
    s_cmp_lg_u32 s3, 7
    s_cbranch_scc1 k_exit
    s_mov_b32 s8, s34
    s_mov_b32 s9, s35
    s_mov_b32 s10, 256
    s_mov_b32 s11, 0x00020000
    v_lshrrev_b32 v24, 2, v1
    v_mov_b32 v25, 0
    buffer_store_dword v25, v24, s[8:11], 0 offen sc1
    s_branch k_exit
s_slow:
    s_and_b32 s3, s16, 3
    s_lshl_b32 s44, s3, 11
    s_lshl_b32 s45, s52, 13
    s_add_u32 s44, s44, s45
    s_add_u32 s44, s44, 131072
    v_add_u32 v26, s44, v1
    ds_read_b128 v[48:51], v26 offset:0
    ds_read_b128 v[52:55], v26 offset:1024
    s_lshr_b32 s55, s21, 1
    s_lshl_b32 s55, s55, 23
    s_lshl_b32 s44, s18, 18
    s_add_u32 s55, s55, s44
    s_lshl_b32 s44, s52, 17
    s_add_u32 s55, s55, s44
    s_add_u32 s55, s55, 33554432
    s_waitcnt lgkmcnt(0)
    v_mov_b32 v26, 0xff800000
    s_mov_b32 s61, 0
s_slow1:
    s_add_u32 s44, s55, s61
    buffer_load_dwordx4 v[56:59], v1, s[4:7], s44 offen offset:0 sc1
    buffer_load_dwordx4 v[60:63], v1, s[4:7], s44 offen offset:1024 sc1
    s_waitcnt vmcnt(0)
    v_mfma_f32_32x32x16_bf16 v[72:87], v[56:59], v[48:51], 0
    v_mfma_f32_32x32x16_bf16 v[72:87], v[60:63], v[52:55], v[72:87]
    s_nop 11
    v_max3_f32 v26, v26, v72, v73
    v_max3_f32 v26, v26, v74, v75
    v_max3_f32 v26, v26, v76, v77
    v_max3_f32 v26, v26, v78, v79
    v_max3_f32 v26, v26, v80, v81
    v_max3_f32 v26, v26, v82, v83
    v_max3_f32 v26, v26, v84, v85
    v_max3_f32 v26, v26, v86, v87
    s_add_u32 s61, s61, 2048
    s_cmp_lt_u32 s61, 131072
    s_cbranch_scc1 s_slow1
    v_mov_b32 v27, v26
    s_nop 1
    v_permlane32_swap_b32 v26, v27
    v_max_f32 v26, v26, v27
    v_mov_b32 v32, 0
    v_mov_b32 v33, 0
    v_mov_b32 v34, 0
    v_mov_b32 v35, 0
    v_mov_b32 v36, 0
    v_mov_b32 v37, 0
    v_mov_b32 v38, 0
    v_mov_b32 v39, 0
    v_mov_b32 v40, 0
    v_mov_b32 v41, 0
    v_mov_b32 v42, 0
    v_mov_b32 v43, 0
    v_mov_b32 v44, 0
    v_mov_b32 v45, 0
    v_mov_b32 v46, 0
    v_mov_b32 v47, 0
    v_mov_b32 v28, 0
    v_mov_b32 v29, 0xdddddddd
    s_mov_b32 s3, 0xffff0000
    s_mov_b32 s61, 0
s_slow2:
    s_add_u32 s44, s55, s61
    buffer_load_dwordx4 v[56:59], v1, s[4:7], s44 offen offset:0 sc1
    buffer_load_dwordx4 v[60:63], v1, s[4:7], s44 offen offset:1024 sc1
    s_add_u32 s44, s44, 4194304
    buffer_load_dwordx4 v[64:67], v1, s[4:7], s44 offen offset:0 sc1
    buffer_load_dwordx4 v[68:71], v1, s[4:7], s44 offen offset:1024 sc1
    s_waitcnt vmcnt(0)
    v_mfma_f32_32x32x16_bf16 v[72:87], v[56:59], v[48:51], 0
    v_mfma_f32_32x32x16_bf16 v[72:87], v[60:63], v[52:55], v[72:87]
    s_nop 11
    v_sub_f32 v72, v72, v26
    v_sub_f32 v73, v73, v26
    v_sub_f32 v74, v74, v26
    v_sub_f32 v75, v75, v26
    v_sub_f32 v76, v76, v26
    v_sub_f32 v77, v77, v26
    v_sub_f32 v78, v78, v26
    v_sub_f32 v79, v79, v26
    v_sub_f32 v80, v80, v26
    v_sub_f32 v81, v81, v26
    v_sub_f32 v82, v82, v26
    v_sub_f32 v83, v83, v26
    v_sub_f32 v84, v84, v26
    v_sub_f32 v85, v85, v26
    v_sub_f32 v86, v86, v26
    v_sub_f32 v87, v87, v26
    v_exp_f32 v72, v72
    v_exp_f32 v73, v73
    v_exp_f32 v74, v74
    v_exp_f32 v75, v75
    v_exp_f32 v76, v76
    v_exp_f32 v77, v77
    v_exp_f32 v78, v78
    v_exp_f32 v79, v79
    v_exp_f32 v80, v80
    v_exp_f32 v81, v81
    v_exp_f32 v82, v82
    v_exp_f32 v83, v83
    v_exp_f32 v84, v84
    v_exp_f32 v85, v85
    v_exp_f32 v86, v86
    v_exp_f32 v87, v87
    v_and_b32 v72, s3, v72
    v_and_b32 v73, s3, v73
    v_and_b32 v74, s3, v74
    v_and_b32 v75, s3, v75
    v_and_b32 v76, s3, v76
    v_and_b32 v77, s3, v77
    v_and_b32 v78, s3, v78
    v_and_b32 v79, s3, v79
    v_and_b32 v80, s3, v80
    v_and_b32 v81, s3, v81
    v_and_b32 v82, s3, v82
    v_and_b32 v83, s3, v83
    v_and_b32 v84, s3, v84
    v_and_b32 v85, s3, v85
    v_and_b32 v86, s3, v86
    v_and_b32 v87, s3, v87
    v_add_f32 v28, v28, v72
    v_add_f32 v28, v28, v73
    v_add_f32 v28, v28, v74
    v_add_f32 v28, v28, v75
    v_add_f32 v28, v28, v76
    v_add_f32 v28, v28, v77
    v_add_f32 v28, v28, v78
    v_add_f32 v28, v28, v79
    v_add_f32 v28, v28, v80
    v_add_f32 v28, v28, v81
    v_add_f32 v28, v28, v82
    v_add_f32 v28, v28, v83
    v_add_f32 v28, v28, v84
    v_add_f32 v28, v28, v85
    v_add_f32 v28, v28, v86
    v_add_f32 v28, v28, v87
    v_smfmac_f32_32x32x32_bf16 v[32:47], v[64:67], v[72:79], v29
    v_smfmac_f32_32x32x32_bf16 v[32:47], v[68:71], v[80:87], v29
    s_add_u32 s61, s61, 2048
    s_cmp_lt_u32 s61, 131072
    s_cbranch_scc1 s_slow2
    v_mov_b32 v29, v28
    s_nop 1
    v_permlane32_swap_b32 v28, v29
    v_add_f32 v28, v28, v29
    v_rcp_f32 v28, v28
    s_nop 7
    s_branch s_fin
k_exit:
    s_endpgm
.section .rodata,"a"
.p2align 6
.amdhsa_kernel interleave_layers__sliding_local_dilated__softmax_full_mha__prompt_kernel
  .amdhsa_next_free_vgpr 256
  .amdhsa_next_free_sgpr 102
  .amdhsa_accum_offset 256
  .amdhsa_group_segment_fixed_size 0
  .amdhsa_kernarg_size 72
  .amdhsa_user_sgpr_count 2
  .amdhsa_user_sgpr_kernarg_segment_ptr 1
  .amdhsa_system_sgpr_workgroup_id_x 1
.end_amdhsa_kernel
```

```asm
; @launch grid=(256,1,1) block=(512,1,1) lds=156736
.amdgcn_target "amdgcn-amd-amdhsa--gfx950"
.text
.globl interleave_layers__sliding_local_dilated__softmax_full_mha__prompt_kernel
.type interleave_layers__sliding_local_dilated__softmax_full_mha__prompt_kernel,@function
.p2align 8
interleave_layers__sliding_local_dilated__softmax_full_mha__prompt_kernel:
    s_cmp_ge_u32 s2, 256
    s_cbranch_scc1 k_exit
    s_load_dwordx2 s[36:37], s[0:1], 0
    s_load_dwordx4 s[24:27], s[0:1], 8
    s_load_dwordx8 s[28:35], s[0:1], 32
    s_load_dwordx2 s[44:45], s[0:1], 64
    v_lshrrev_b32 v2, 6, v0
    v_and_b32 v0, 63, v0
    v_readfirstlane_b32 s16, v2
    v_lshlrev_b32 v1, 4, v0
    s_mov_b32 s21, 0
    s_mov_b32 s40, 1
    s_and_b32 s3, s2, 1
    s_lshl_b32 s3, s3, 3
    s_bfe_u32 s17, s2, 0x30003
    s_add_u32 s17, s17, s3
    s_bfe_u32 s3, s2, 0x20001
    s_lshl_b32 s3, s3, 2
    s_lshr_b32 s18, s2, 6
    s_add_u32 s18, s18, s3
    s_and_b32 s3, s2, 3
    s_lshl_b32 s3, s3, 2
    s_bfe_u32 s19, s2, 0x20003
    s_add_u32 s19, s19, s3
    s_bfe_u32 s3, s2, 0x10002
    s_lshl_b32 s3, s3, 3
    s_lshr_b32 s20, s2, 5
    s_add_u32 s20, s20, s3
    s_mov_b32 s19, s17
    s_mov_b32 s20, s18
    s_and_b32 s3, s16, 3
    s_lshl_b32 s38, s17, 2
    s_add_u32 s38, s38, s3
    s_lshl_b32 s39, s19, 2
    s_add_u32 s39, s39, s3
    v_mov_b32 v12, 0
    v_mov_b32 v13, 0
    v_mov_b32 v14, 0
    v_mov_b32 v15, 0
    s_mov_b32 s41, 0
    s_mov_b32 s42, 0
    s_mov_b32 s43, 0
    s_mov_b32 s62, 0
    s_waitcnt lgkmcnt(0)
    s_mov_b32 s4, s44
    s_mov_b32 s5, s45
    s_mov_b32 s6, 67108864
    s_mov_b32 s7, 0x00020000
    s_add_u32 s22, s44, 58720256
    s_addc_u32 s23, s45, 0
    s_load_dword s100, s[22:23], 217088
    s_cmp_eq_u32 s16, 4
    s_cbranch_scc1 h_start
    s_cmp_eq_u32 s16, 7
    s_cbranch_scc1 z_start
    s_cmp_gt_u32 s16, 4
    s_cbranch_scc1 l_start
    s_mov_b32 s8, s36
    s_mov_b32 s9, s37
    s_mov_b32 s10, 4194304
    s_mov_b32 s11, 0x00020000
    v_lshrrev_b32 v8, 4, v1
    v_lshrrev_b32 v32, 3, v8
    v_and_b32 v33, 7, v8
    v_lshlrev_b32 v34, 11, v32
    v_lshl_add_u32 v34, v33, 4, v34
    s_lshl_b32 s44, s39, 16
    s_lshl_b32 s45, s20, 7
    s_add_u32 s46, s44, s45
    buffer_load_dwordx4 v[40:43], v34, s[8:11], s46 offen
    s_add_u32 s46, s46, 16384
    buffer_load_dwordx4 v[44:47], v34, s[8:11], s46 offen
    s_add_u32 s46, s46, 16384
    buffer_load_dwordx4 v[48:51], v34, s[8:11], s46 offen
    s_add_u32 s46, s46, 16384
    buffer_load_dwordx4 v[52:55], v34, s[8:11], s46 offen
    v_xor_b32 v88, v33, v32
    v_lshlrev_b32 v88, 4, v88
    v_lshl_add_u32 v88, v32, 11, v88
    v_xor_b32 v89, 16, v88
    v_add_u32 v89, 15360, v89
    v_add_u32 v90, 30720, v88
    v_add_u32 v91, 30720, v89
    s_mul_i32 s76, s16, 16384
    s_add_u32 s76, s76, 65536
    s_lshl_b32 s77, s38, 16
    s_mul_i32 s84, s18, 4096
    s_cmp_eq_u32 s18, 1
    s_cselect_b32 s85, 0, 4096
    s_cmp_eq_u32 s18, 2
    s_cselect_b32 s86, 0, 8192
    s_cmp_eq_u32 s18, 3
    s_cselect_b32 s87, 0, 12288
    s_cmp_eq_u32 s18, 4
    s_cselect_b32 s88, 0, 16384
    s_cmp_eq_u32 s18, 5
    s_cselect_b32 s89, 0, 20480
    s_cmp_eq_u32 s18, 6
    s_cselect_b32 s90, 0, 24576
    s_cmp_eq_u32 s18, 7
    s_cselect_b32 s91, 0, 28672
    s_cmp_eq_u32 s18, 8
    s_cselect_b32 s92, 0, 32768
    s_cmp_eq_u32 s18, 9
    s_cselect_b32 s93, 0, 36864
    s_cmp_eq_u32 s18, 10
    s_cselect_b32 s94, 0, 40960
    s_cmp_eq_u32 s18, 11
    s_cselect_b32 s95, 0, 45056
    s_cmp_eq_u32 s18, 12
    s_cselect_b32 s96, 0, 49152
    s_cmp_eq_u32 s18, 13
    s_cselect_b32 s97, 0, 53248
    s_cmp_eq_u32 s18, 14
    s_cselect_b32 s98, 0, 57344
    s_cmp_eq_u32 s18, 15
    s_cselect_b32 s99, 0, 61440
    v_lshrrev_b32 v12, 4, v1
    v_and_b32 v13, 15, v12
    v_bfe_u32 v14, v12, 4, 1
    v_lshrrev_b32 v12, 5, v12
    v_lshl_add_u32 v2, v14, 5, v13
    v_lshlrev_b32 v2, 4, v2
    v_lshl_add_u32 v2, v12, 10, v2
    v_lshrrev_b32 v15, 2, v13
    v_lshl_add_u32 v15, v14, 2, v15
    v_lshlrev_b32 v3, 7, v15
    v_lshl_add_u32 v3, v12, 11, v3
    v_and_b32 v15, 3, v13
    v_lshl_add_u32 v3, v15, 3, v3
    v_lshrrev_b32 v15, 3, v13
    v_lshl_add_u32 v15, v15, 1, v14
    v_lshl_add_u32 v3, v15, 5, v3
    v_xor_b32 v4, 32, v3
    v_xor_b32 v5, 64, v3
    v_xor_b32 v6, 96, v3
    s_lshl_b32 s45, s16, 12
    s_add_u32 s45, s45, 131072
    v_lshrrev_b32 v35, 1, v33
    v_lshlrev_b32 v35, 10, v35
    v_lshl_add_u32 v35, v32, 4, v35
    v_and_b32 v36, 1, v33
    v_lshl_add_u32 v35, v36, 3, v35
    v_add_u32 v35, s45, v35
    v_add_u32 v36, s45, v1
    v_mov_b32 v37, 0x3f803f80
    v_and_b32 v38, 3, v8
    v_lshl_add_u32 v39, v38, 3, v32
    v_lshlrev_b32 v39, 3, v39
    v_mov_b32 v56, 0
    v_mov_b32 v57, 0
    v_mov_b32 v58, 0
    v_mov_b32 v59, 0
    v_mov_b32 v60, 0
    v_mov_b32 v61, 0
    v_mov_b32 v62, 0
    v_mov_b32 v63, 0
    s_waitcnt vmcnt(3)
    ds_write_b64 v35, v[40:41] offset:0
    ds_write_b64 v35, v[42:43] offset:512
    s_waitcnt vmcnt(2)
    ds_write_b64 v35, v[44:45] offset:128
    ds_write_b64 v35, v[46:47] offset:640
    s_waitcnt vmcnt(1)
    ds_write_b64 v35, v[48:49] offset:256
    ds_write_b64 v35, v[50:51] offset:768
    s_waitcnt vmcnt(0)
    ds_write_b64 v35, v[52:53] offset:384
    ds_write_b64 v35, v[54:55] offset:896
    ds_read_b128 v[64:67], v36 offset:0
    ds_read_b128 v[68:71], v36 offset:1024
    ds_read_b128 v[72:75], v36 offset:2048
    ds_read_b128 v[76:79], v36 offset:3072
    s_lshl_b32 s45, s20, 12
    s_add_u32 s46, s44, s45
    s_waitcnt lgkmcnt(3)
    buffer_store_dwordx4 v[64:67], v1, s[4:7], s46 offen offset:0 sc1
    s_waitcnt lgkmcnt(2)
    buffer_store_dwordx4 v[68:71], v1, s[4:7], s46 offen offset:1024 sc1
    s_waitcnt lgkmcnt(1)
    buffer_store_dwordx4 v[72:75], v1, s[4:7], s46 offen offset:2048 sc1
    s_waitcnt lgkmcnt(0)
    buffer_store_dwordx4 v[76:79], v1, s[4:7], s46 offen offset:3072 sc1
    v_dot2_f32_bf16 v56, v40, v37, v56
    v_dot2_f32_bf16 v57, v40, v40, v57
    v_dot2_f32_bf16 v58, v44, v37, v58
    v_dot2_f32_bf16 v59, v44, v44, v59
    v_dot2_f32_bf16 v60, v48, v37, v60
    v_dot2_f32_bf16 v61, v48, v48, v61
    v_dot2_f32_bf16 v62, v52, v37, v62
    v_dot2_f32_bf16 v63, v52, v52, v63
    v_dot2_f32_bf16 v56, v41, v37, v56
    v_dot2_f32_bf16 v57, v41, v41, v57
    v_dot2_f32_bf16 v58, v45, v37, v58
    v_dot2_f32_bf16 v59, v45, v45, v59
    v_dot2_f32_bf16 v60, v49, v37, v60
    v_dot2_f32_bf16 v61, v49, v49, v61
    v_dot2_f32_bf16 v62, v53, v37, v62
    v_dot2_f32_bf16 v63, v53, v53, v63
    v_dot2_f32_bf16 v56, v42, v37, v56
    v_dot2_f32_bf16 v57, v42, v42, v57
    v_dot2_f32_bf16 v58, v46, v37, v58
    v_dot2_f32_bf16 v59, v46, v46, v59
    v_dot2_f32_bf16 v60, v50, v37, v60
    v_dot2_f32_bf16 v61, v50, v50, v61
    v_dot2_f32_bf16 v62, v54, v37, v62
    v_dot2_f32_bf16 v63, v54, v54, v63
    v_dot2_f32_bf16 v56, v43, v37, v56
    v_dot2_f32_bf16 v57, v43, v43, v57
    v_dot2_f32_bf16 v58, v47, v37, v58
    v_dot2_f32_bf16 v59, v47, v47, v59
    v_dot2_f32_bf16 v60, v51, v37, v60
    v_dot2_f32_bf16 v61, v51, v51, v61
    v_dot2_f32_bf16 v62, v55, v37, v62
    v_dot2_f32_bf16 v63, v55, v55, v63
    s_nop 2
    v_add_f32_dpp v56, v56, v56 quad_perm:[1,0,3,2] row_mask:0xf bank_mask:0xf
    v_add_f32_dpp v57, v57, v57 quad_perm:[1,0,3,2] row_mask:0xf bank_mask:0xf
    v_add_f32_dpp v58, v58, v58 quad_perm:[1,0,3,2] row_mask:0xf bank_mask:0xf
    v_add_f32_dpp v59, v59, v59 quad_perm:[1,0,3,2] row_mask:0xf bank_mask:0xf
    v_add_f32_dpp v60, v60, v60 quad_perm:[1,0,3,2] row_mask:0xf bank_mask:0xf
    v_add_f32_dpp v61, v61, v61 quad_perm:[1,0,3,2] row_mask:0xf bank_mask:0xf
    v_add_f32_dpp v62, v62, v62 quad_perm:[1,0,3,2] row_mask:0xf bank_mask:0xf
    v_add_f32_dpp v63, v63, v63 quad_perm:[1,0,3,2] row_mask:0xf bank_mask:0xf
    v_add_f32_dpp v56, v56, v56 quad_perm:[2,3,0,1] row_mask:0xf bank_mask:0xf
    v_add_f32_dpp v57, v57, v57 quad_perm:[2,3,0,1] row_mask:0xf bank_mask:0xf
    v_add_f32_dpp v58, v58, v58 quad_perm:[2,3,0,1] row_mask:0xf bank_mask:0xf
    v_add_f32_dpp v59, v59, v59 quad_perm:[2,3,0,1] row_mask:0xf bank_mask:0xf
    v_add_f32_dpp v60, v60, v60 quad_perm:[2,3,0,1] row_mask:0xf bank_mask:0xf
    v_add_f32_dpp v61, v61, v61 quad_perm:[2,3,0,1] row_mask:0xf bank_mask:0xf
    v_add_f32_dpp v62, v62, v62 quad_perm:[2,3,0,1] row_mask:0xf bank_mask:0xf
    v_add_f32_dpp v63, v63, v63 quad_perm:[2,3,0,1] row_mask:0xf bank_mask:0xf
    v_add_f32_dpp v56, v56, v56 row_half_mirror row_mask:0xf bank_mask:0xf
    v_add_f32_dpp v57, v57, v57 row_half_mirror row_mask:0xf bank_mask:0xf
    v_add_f32_dpp v58, v58, v58 row_half_mirror row_mask:0xf bank_mask:0xf
    v_add_f32_dpp v59, v59, v59 row_half_mirror row_mask:0xf bank_mask:0xf
    v_add_f32_dpp v60, v60, v60 row_half_mirror row_mask:0xf bank_mask:0xf
    v_add_f32_dpp v61, v61, v61 row_half_mirror row_mask:0xf bank_mask:0xf
    v_add_f32_dpp v62, v62, v62 row_half_mirror row_mask:0xf bank_mask:0xf
    v_add_f32_dpp v63, v63, v63 row_half_mirror row_mask:0xf bank_mask:0xf
    v_cmp_eq_u32 vcc, 1, v38
    s_nop 1
    v_cndmask_b32 v56, v56, v58, vcc
    v_cndmask_b32 v57, v57, v59, vcc
    v_cmp_eq_u32 vcc, 2, v38
    s_nop 1
    v_cndmask_b32 v56, v56, v60, vcc
    v_cndmask_b32 v57, v57, v61, vcc
    v_cmp_eq_u32 vcc, 3, v38
    s_nop 1
    v_cndmask_b32 v56, v56, v62, vcc
    v_cndmask_b32 v57, v57, v63, vcc
    s_lshl_b32 s44, s21, 18
    s_lshl_b32 s45, s39, 12
    s_add_u32 s44, s44, s45
    s_lshl_b32 s45, s20, 8
    s_add_u32 s44, s44, s45
    s_add_u32 s44, s44, 50331648
    buffer_store_dwordx2 v[56:57], v39, s[4:7], s44 offen sc1
    s_lshl_b32 s46, s21, 14
    s_lshl_b32 s67, s39, 7
    s_add_u32 s46, s46, s67
    s_add_u32 s46, s46, 4096
    s_add_u32 s47, s46, 8192
    s_lshl_b32 s48, s21, 22
    s_lshl_b32 s49, s38, 16
    s_add_u32 s41, s48, s49
    s_lshl_b32 s48, s21, 14
    s_lshl_b32 s67, s38, 7
    s_add_u32 s48, s48, s67
    s_add_u32 s48, s48, 4096
    v_lshrrev_b32 v16, 4, v1
    v_and_b32 v17, 15, v16
    v_lshrrev_b32 v16, 4, v16
    s_lshl_b32 s49, s16, 7
    s_add_u32 s50, s49, 151552
    s_and_b32 s49, s21, 1
    s_lshl_b32 s49, s49, 10
    s_add_u32 s49, s49, 151552
    v_lshlrev_b32 v11, 4, v16
    v_add_u32 v13, s50, v11
    v_add_u32 v11, s49, v11
    v_lshlrev_b32 v15, 2, v17
    v_add_u32 v9, s50, v15
    v_add_u32 v15, s49, v15
    s_lshr_b32 s49, s21, 1
    s_lshl_b32 s53, s49, 23
    s_lshl_b32 s50, s18, 18
    s_add_u32 s53, s53, s50
    s_add_u32 s53, s53, 33554432
    s_lshl_b32 s54, s38, 11
    s_add_u32 s52, s53, s54
    s_lshl_b32 s59, s49, 13
    s_lshl_b32 s67, s18, 9
    s_add_u32 s59, s59, s67
    s_lshl_b32 s67, s16, 7
    s_add_u32 s59, s59, s67
    s_add_u32 s59, s59, 69632
    s_lshl_b32 s61, s49, 15
    s_lshl_b32 s67, s17, 11
    s_add_u32 s61, s61, s67
    s_lshl_b32 s67, s18, 7
    s_add_u32 s61, s61, s67
    s_add_u32 s61, s61, 151552
    s_sub_u32 s60, s61, 151552
    s_lshl_b32 s60, s60, 5
    s_add_u32 s60, s60, 54525952
    s_lshl_b32 s62, s16, 12
    s_add_u32 s62, s62, 131072
    v_bfe_u32 v80, v8, 3, 1
    v_and_b32 v81, 7, v8
    v_lshrrev_b32 v82, 5, v8
    v_lshlrev_b32 v82, 1, v82
    v_xor_b32 v82, v82, v81
    v_xor_b32 v82, v82, v80
    v_lshlrev_b32 v82, 4, v82
    v_lshl_add_u32 v82, v81, 7, v82
    v_lshl_add_u32 v82, v80, 10, v82
    v_bfe_u32 v80, v8, 4, 1
    v_lshl_add_u32 v82, v80, 3, v82
    v_add_u32 v84, s76, v82
    v_xor_b32 v85, 16, v84
    v_xor_b32 v86, 64, v84
    v_xor_b32 v87, 80, v84
    s_waitcnt vmcnt(0)
    s_add_u32 m0, s76, 0
    s_lshr_b32 s78, s84, 5
    s_add_u32 s78, s78, s77
    buffer_load_dwordx4 v88, s[8:11], s78 offen offset:0 lds
    buffer_load_dwordx4 v89, s[8:11], s78 offen offset:1024 lds
    buffer_load_dwordx4 v90, s[8:11], s78 offen offset:2048 lds
    buffer_load_dwordx4 v91, s[8:11], s78 offen offset:3072 lds
    s_add_u32 m0, s76, 4096
    s_lshr_b32 s78, s85, 5
    s_add_u32 s78, s78, s77
    buffer_load_dwordx4 v88, s[8:11], s78 offen offset:0 lds
    buffer_load_dwordx4 v89, s[8:11], s78 offen offset:1024 lds
    buffer_load_dwordx4 v90, s[8:11], s78 offen offset:2048 lds
    buffer_load_dwordx4 v91, s[8:11], s78 offen offset:3072 lds
    s_add_u32 m0, s76, 8192
    s_lshr_b32 s78, s86, 5
    s_add_u32 s78, s78, s77
    buffer_load_dwordx4 v88, s[8:11], s78 offen offset:0 lds
    buffer_load_dwordx4 v89, s[8:11], s78 offen offset:1024 lds
    buffer_load_dwordx4 v90, s[8:11], s78 offen offset:2048 lds
    buffer_load_dwordx4 v91, s[8:11], s78 offen offset:3072 lds
    s_add_u32 m0, s76, 12288
    s_lshr_b32 s78, s87, 5
    s_add_u32 s78, s78, s77
    buffer_load_dwordx4 v88, s[8:11], s78 offen offset:0 lds
    buffer_load_dwordx4 v89, s[8:11], s78 offen offset:1024 lds
    buffer_load_dwordx4 v90, s[8:11], s78 offen offset:2048 lds
    buffer_load_dwordx4 v91, s[8:11], s78 offen offset:3072 lds
    s_barrier
    s_load_dword s68, s[34:35], 0
    s_mov_b32 s8, s34
    s_mov_b32 s9, s35
    s_mov_b32 s10, 256
    s_mov_b32 s11, 0x00020000
    s_mov_b32 s66, 0x10000
    v_mov_b32 v16, 0
    s_waitcnt lgkmcnt(0)
c_f0:
    s_cmp_eq_u32 s68, 6
    s_cbranch_scc1 c_f0_ok
    buffer_load_dword v17, v16, s[8:11], 0 offen offset:0 sc1
    s_waitcnt vmcnt(0)
    v_readfirstlane_b32 s68, v17
    s_sub_u32 s66, s66, 1
    s_cmp_lg_u32 s66, 0
    s_cbranch_scc1 c_f0
c_f0_ok:
    s_atomic_add s40, s[22:23], s47
    s_waitcnt vmcnt(0)
    ds_read_b64 v[160:161], v84 offset:0
    ds_read_b64 v[162:163], v85 offset:0
    ds_read_b64 v[164:165], v84 offset:2048
    ds_read_b64 v[166:167], v85 offset:2048
    ds_read_b64 v[168:169], v86 offset:0
    ds_read_b64 v[170:171], v87 offset:0
    ds_read_b64 v[172:173], v86 offset:2048
    ds_read_b64 v[174:175], v87 offset:2048
    ds_read_b64 v[176:177], v84 offset:4096
    ds_read_b64 v[178:179], v85 offset:4096
    ds_read_b64 v[180:181], v84 offset:6144
    ds_read_b64 v[182:183], v85 offset:6144
    ds_read_b64 v[184:185], v86 offset:4096
    ds_read_b64 v[186:187], v87 offset:4096
    ds_read_b64 v[188:189], v86 offset:6144
    ds_read_b64 v[190:191], v87 offset:6144
    ds_read_b64 v[192:193], v84 offset:8192
    ds_read_b64 v[194:195], v85 offset:8192
    ds_read_b64 v[196:197], v84 offset:10240
    ds_read_b64 v[198:199], v85 offset:10240
    ds_read_b64 v[200:201], v86 offset:8192
    ds_read_b64 v[202:203], v87 offset:8192
    ds_read_b64 v[204:205], v86 offset:10240
    ds_read_b64 v[206:207], v87 offset:10240
    ds_read_b64 v[208:209], v84 offset:12288
    ds_read_b64 v[210:211], v85 offset:12288
    ds_read_b64 v[212:213], v84 offset:14336
    ds_read_b64 v[214:215], v85 offset:14336
    ds_read_b64 v[216:217], v86 offset:12288
    ds_read_b64 v[218:219], v87 offset:12288
    ds_read_b64 v[220:221], v86 offset:14336
    ds_read_b64 v[222:223], v87 offset:14336
    s_waitcnt lgkmcnt(0)
    s_mov_b64 vcc, -1
    s_barrier
    ds_read_b64_tr_b16 v[32:33], v3 offset:0
    ds_read_b64_tr_b16 v[34:35], v3 offset:1024
    ds_read_b64_tr_b16 v[36:37], v4 offset:0
    ds_read_b64_tr_b16 v[38:39], v4 offset:1024
    ds_read_b64_tr_b16 v[40:41], v5 offset:0
    ds_read_b64_tr_b16 v[42:43], v5 offset:1024
    ds_read_b64_tr_b16 v[44:45], v6 offset:0
    ds_read_b64_tr_b16 v[46:47], v6 offset:1024
    ds_read_b64_tr_b16 v[48:49], v3 offset:4096
    ds_read_b64_tr_b16 v[50:51], v3 offset:5120
    ds_read_b64_tr_b16 v[52:53], v4 offset:4096
    ds_read_b64_tr_b16 v[54:55], v4 offset:5120
    ds_read_b64_tr_b16 v[56:57], v5 offset:4096
    ds_read_b64_tr_b16 v[58:59], v5 offset:5120
    s_branch c_g0
c_layer:
    s_lshl_b32 s48, s21, 22
    s_lshl_b32 s49, s38, 16
    s_add_u32 s41, s48, s49
    s_lshl_b32 s48, s21, 14
    s_lshl_b32 s67, s38, 7
    s_add_u32 s48, s48, s67
    s_add_u32 s48, s48, 4096
    v_lshrrev_b32 v16, 4, v1
    v_and_b32 v17, 15, v16
    v_lshrrev_b32 v16, 4, v16
    s_lshl_b32 s49, s16, 7
    s_add_u32 s50, s49, 151552
    s_and_b32 s49, s21, 1
    s_lshl_b32 s49, s49, 10
    s_add_u32 s49, s49, 151552
    v_lshlrev_b32 v11, 4, v16
    v_add_u32 v13, s50, v11
    v_add_u32 v11, s49, v11
    v_lshlrev_b32 v15, 2, v17
    v_add_u32 v9, s50, v15
    v_add_u32 v15, s49, v15
    s_lshr_b32 s49, s21, 1
    s_lshl_b32 s53, s49, 23
    s_lshl_b32 s50, s18, 18
    s_add_u32 s53, s53, s50
    s_add_u32 s53, s53, 33554432
    s_lshl_b32 s54, s38, 11
    s_add_u32 s52, s53, s54
    s_lshl_b32 s59, s49, 13
    s_lshl_b32 s67, s18, 9
    s_add_u32 s59, s59, s67
    s_lshl_b32 s67, s16, 7
    s_add_u32 s59, s59, s67
    s_add_u32 s59, s59, 69632
    s_lshl_b32 s61, s49, 15
    s_lshl_b32 s67, s17, 11
    s_add_u32 s61, s61, s67
    s_lshl_b32 s67, s18, 7
    s_add_u32 s61, s61, s67
    s_add_u32 s61, s61, 151552
    s_sub_u32 s60, s61, 151552
    s_lshl_b32 s60, s60, 5
    s_add_u32 s60, s60, 54525952
    s_lshl_b32 s62, s16, 12
    s_add_u32 s62, s62, 131072
    s_mov_b32 s68, 0
    s_atomic_add s68, s[22:23], s48 glc
    s_mov_b64 vcc, 0
    s_barrier
    ds_read_b64_tr_b16 v[32:33], v3 offset:0
    ds_read_b64_tr_b16 v[34:35], v3 offset:1024
    ds_read_b64_tr_b16 v[36:37], v4 offset:0
    ds_read_b64_tr_b16 v[38:39], v4 offset:1024
    ds_read_b64_tr_b16 v[40:41], v5 offset:0
    ds_read_b64_tr_b16 v[42:43], v5 offset:1024
    ds_read_b64_tr_b16 v[44:45], v6 offset:0
    ds_read_b64_tr_b16 v[46:47], v6 offset:1024
    ds_read_b64_tr_b16 v[48:49], v3 offset:4096
    ds_read_b64_tr_b16 v[50:51], v3 offset:5120
    ds_read_b64_tr_b16 v[52:53], v4 offset:4096
    ds_read_b64_tr_b16 v[54:55], v4 offset:5120
    ds_read_b64_tr_b16 v[56:57], v5 offset:4096
    ds_read_b64_tr_b16 v[58:59], v5 offset:5120
c_g0:
    s_waitcnt lgkmcnt(10)
    v_mfma_f32_16x16x32_bf16 v[64:67], v[32:35], v[160:163], 0
    ds_read_b64_tr_b16 v[60:61], v6 offset:4096
    v_mfma_f32_16x16x32_bf16 v[68:71], v[32:35], v[164:167], 0
    ds_read_b64_tr_b16 v[62:63], v6 offset:5120
    v_mfma_f32_16x16x32_bf16 v[72:75], v[36:39], v[160:163], 0
    ds_read_b64_tr_b16 v[32:33], v3 offset:8192
    v_mfma_f32_16x16x32_bf16 v[76:79], v[36:39], v[164:167], 0
    ds_read_b64_tr_b16 v[34:35], v3 offset:9216
    s_waitcnt lgkmcnt(10)
    v_mfma_f32_16x16x32_bf16 v[80:83], v[40:43], v[160:163], 0
    ds_read_b64_tr_b16 v[36:37], v4 offset:8192
    v_mfma_f32_16x16x32_bf16 v[84:87], v[40:43], v[164:167], 0
    ds_read_b64_tr_b16 v[38:39], v4 offset:9216
    v_mfma_f32_16x16x32_bf16 v[88:91], v[44:47], v[160:163], 0
    ds_read_b64_tr_b16 v[40:41], v5 offset:8192
    v_mfma_f32_16x16x32_bf16 v[92:95], v[44:47], v[164:167], 0
    ds_read_b64_tr_b16 v[42:43], v5 offset:9216
    s_waitcnt lgkmcnt(10)
    v_mfma_f32_16x16x32_bf16 v[96:99], v[160:163], v[48:51], 0
    ds_read_b64_tr_b16 v[44:45], v6 offset:8192
    v_mfma_f32_16x16x32_bf16 v[100:103], v[164:167], v[48:51], 0
    ds_read_b64_tr_b16 v[46:47], v6 offset:9216
    v_mfma_f32_16x16x32_bf16 v[104:107], v[160:163], v[52:55], 0
    ds_read_b64_tr_b16 v[48:49], v3 offset:12288
    v_mfma_f32_16x16x32_bf16 v[108:111], v[164:167], v[52:55], 0
    ds_read_b64_tr_b16 v[50:51], v3 offset:13312
    s_waitcnt lgkmcnt(10)
    v_mfma_f32_16x16x32_bf16 v[112:115], v[160:163], v[56:59], 0
    ds_read_b64_tr_b16 v[52:53], v4 offset:12288
    v_mfma_f32_16x16x32_bf16 v[116:119], v[164:167], v[56:59], 0
    ds_read_b64_tr_b16 v[54:55], v4 offset:13312
    v_mfma_f32_16x16x32_bf16 v[120:123], v[160:163], v[60:63], 0
    ds_read_b64_tr_b16 v[56:57], v5 offset:12288
    v_mfma_f32_16x16x32_bf16 v[124:127], v[164:167], v[60:63], 0
    ds_read_b64_tr_b16 v[58:59], v5 offset:13312
    s_cbranch_vccnz c_gate
    s_mov_b32 s66, 0x10000
    s_waitcnt lgkmcnt(0)
    s_cmp_eq_u32 s68, 16
    s_cbranch_scc1 c_x_ok
c_x_poll:
    s_mov_b32 s68, 0
    s_atomic_add s68, s[22:23], s48 offset:0 glc
    s_sub_u32 s66, s66, 1
    s_cselect_b32 s67, 16, 0
    s_waitcnt lgkmcnt(0)
    s_max_u32 s68, s68, s67
    s_cmp_lt_u32 s68, 16
    s_cbranch_scc1 c_x_poll
c_x_ok:
    s_add_u32 s42, s41, s85
    buffer_load_dwordx4 v[176:179], v2, s[4:7], s42 offen offset:0 sc1
    buffer_load_dwordx4 v[180:183], v2, s[4:7], s42 offen offset:256 sc1
    buffer_load_dwordx4 v[184:187], v2, s[4:7], s42 offen offset:2048 sc1
    buffer_load_dwordx4 v[188:191], v2, s[4:7], s42 offen offset:2304 sc1
    s_add_u32 s42, s41, s86
    buffer_load_dwordx4 v[192:195], v2, s[4:7], s42 offen offset:0 sc1
    buffer_load_dwordx4 v[196:199], v2, s[4:7], s42 offen offset:256 sc1
    buffer_load_dwordx4 v[200:203], v2, s[4:7], s42 offen offset:2048 sc1
    buffer_load_dwordx4 v[204:207], v2, s[4:7], s42 offen offset:2304 sc1
    s_add_u32 s42, s41, s87
    buffer_load_dwordx4 v[208:211], v2, s[4:7], s42 offen offset:0 sc1
    buffer_load_dwordx4 v[212:215], v2, s[4:7], s42 offen offset:256 sc1
    s_waitcnt vmcnt(10)
    s_atomic_add s40, s[22:23], s47
c_gate:
    s_waitcnt lgkmcnt(10)
    v_mfma_f32_16x16x32_bf16 v[128:131], v[32:35], v[160:163], 0
    ds_read_b64_tr_b16 v[60:61], v6 offset:12288
    v_mfma_f32_16x16x32_bf16 v[132:135], v[32:35], v[164:167], 0
    ds_read_b64_tr_b16 v[62:63], v6 offset:13312
    v_mfma_f32_16x16x32_bf16 v[136:139], v[36:39], v[160:163], 0
    ds_read_b64_tr_b16 v[32:33], v3 offset:16384
    v_mfma_f32_16x16x32_bf16 v[140:143], v[36:39], v[164:167], 0
    ds_read_b64_tr_b16 v[34:35], v3 offset:17408
    s_waitcnt lgkmcnt(10)
    v_mfma_f32_16x16x32_bf16 v[144:147], v[40:43], v[160:163], 0
    ds_read_b64_tr_b16 v[36:37], v4 offset:16384
    v_mfma_f32_16x16x32_bf16 v[148:151], v[40:43], v[164:167], 0
    ds_read_b64_tr_b16 v[38:39], v4 offset:17408
    v_mfma_f32_16x16x32_bf16 v[152:155], v[44:47], v[160:163], 0
    ds_read_b64_tr_b16 v[40:41], v5 offset:16384
    v_mfma_f32_16x16x32_bf16 v[156:159], v[44:47], v[164:167], 0
    ds_read_b64_tr_b16 v[42:43], v5 offset:17408
    s_waitcnt lgkmcnt(10)
    v_mfma_f32_16x16x32_bf16 v[64:67], v[48:51], v[168:171], v[64:67]
    ds_read_b64_tr_b16 v[44:45], v6 offset:16384
    v_mfma_f32_16x16x32_bf16 v[68:71], v[48:51], v[172:175], v[68:71]
    ds_read_b64_tr_b16 v[46:47], v6 offset:17408
    v_mfma_f32_16x16x32_bf16 v[72:75], v[52:55], v[168:171], v[72:75]
    ds_read_b64_tr_b16 v[48:49], v3 offset:20480
    v_mfma_f32_16x16x32_bf16 v[76:79], v[52:55], v[172:175], v[76:79]
    ds_read_b64_tr_b16 v[50:51], v3 offset:21504
    s_waitcnt lgkmcnt(10)
    v_mfma_f32_16x16x32_bf16 v[80:83], v[56:59], v[168:171], v[80:83]
    ds_read_b64_tr_b16 v[52:53], v4 offset:20480
    v_mfma_f32_16x16x32_bf16 v[84:87], v[56:59], v[172:175], v[84:87]
    ds_read_b64_tr_b16 v[54:55], v4 offset:21504
    v_mfma_f32_16x16x32_bf16 v[88:91], v[60:63], v[168:171], v[88:91]
    ds_read_b64_tr_b16 v[56:57], v5 offset:20480
    v_mfma_f32_16x16x32_bf16 v[92:95], v[60:63], v[172:175], v[92:95]
    ds_read_b64_tr_b16 v[58:59], v5 offset:21504
    s_waitcnt lgkmcnt(10)
    v_mfma_f32_16x16x32_bf16 v[96:99], v[168:171], v[32:35], v[96:99]
    ds_read_b64_tr_b16 v[60:61], v6 offset:20480
    v_mfma_f32_16x16x32_bf16 v[100:103], v[172:175], v[32:35], v[100:103]
    ds_read_b64_tr_b16 v[62:63], v6 offset:21504
    v_mfma_f32_16x16x32_bf16 v[104:107], v[168:171], v[36:39], v[104:107]
    ds_read_b64_tr_b16 v[32:33], v3 offset:24576
    v_mfma_f32_16x16x32_bf16 v[108:111], v[172:175], v[36:39], v[108:111]
    ds_read_b64_tr_b16 v[34:35], v3 offset:25600
    s_waitcnt lgkmcnt(10)
    v_mfma_f32_16x16x32_bf16 v[112:115], v[168:171], v[40:43], v[112:115]
    ds_read_b64_tr_b16 v[36:37], v4 offset:24576
    v_mfma_f32_16x16x32_bf16 v[116:119], v[172:175], v[40:43], v[116:119]
    ds_read_b64_tr_b16 v[38:39], v4 offset:25600
    v_mfma_f32_16x16x32_bf16 v[120:123], v[168:171], v[44:47], v[120:123]
    ds_read_b64_tr_b16 v[40:41], v5 offset:24576
    v_mfma_f32_16x16x32_bf16 v[124:127], v[172:175], v[44:47], v[124:127]
    ds_read_b64_tr_b16 v[42:43], v5 offset:25600
    s_waitcnt lgkmcnt(10)
    v_mfma_f32_16x16x32_bf16 v[128:131], v[48:51], v[168:171], v[128:131]
    ds_read_b64_tr_b16 v[44:45], v6 offset:24576
    v_mfma_f32_16x16x32_bf16 v[132:135], v[48:51], v[172:175], v[132:135]
    ds_read_b64_tr_b16 v[46:47], v6 offset:25600
    v_mfma_f32_16x16x32_bf16 v[136:139], v[52:55], v[168:171], v[136:139]
    ds_read_b64_tr_b16 v[48:49], v3 offset:28672
    v_mfma_f32_16x16x32_bf16 v[140:143], v[52:55], v[172:175], v[140:143]
    ds_read_b64_tr_b16 v[50:51], v3 offset:29696
    s_waitcnt lgkmcnt(10)
    v_mfma_f32_16x16x32_bf16 v[144:147], v[56:59], v[168:171], v[144:147]
    ds_read_b64_tr_b16 v[52:53], v4 offset:28672
    v_mfma_f32_16x16x32_bf16 v[148:151], v[56:59], v[172:175], v[148:151]
    ds_read_b64_tr_b16 v[54:55], v4 offset:29696
    v_mfma_f32_16x16x32_bf16 v[152:155], v[60:63], v[168:171], v[152:155]
    ds_read_b64_tr_b16 v[56:57], v5 offset:28672
    v_mfma_f32_16x16x32_bf16 v[156:159], v[60:63], v[172:175], v[156:159]
    ds_read_b64_tr_b16 v[58:59], v5 offset:29696
    s_waitcnt vmcnt(8) lgkmcnt(10)
    v_mfma_f32_16x16x32_bf16 v[64:67], v[32:35], v[176:179], v[64:67]
    ds_read_b64_tr_b16 v[60:61], v6 offset:28672
    v_mfma_f32_16x16x32_bf16 v[68:71], v[32:35], v[180:183], v[68:71]
    ds_read_b64_tr_b16 v[62:63], v6 offset:29696
    s_barrier
    v_mfma_f32_16x16x32_bf16 v[72:75], v[36:39], v[176:179], v[72:75]
    ds_read_b64_tr_b16 v[32:33], v3 offset:32768
    v_mfma_f32_16x16x32_bf16 v[76:79], v[36:39], v[180:183], v[76:79]
    ds_read_b64_tr_b16 v[34:35], v3 offset:33792
    s_waitcnt lgkmcnt(10)
    v_mfma_f32_16x16x32_bf16 v[80:83], v[40:43], v[176:179], v[80:83]
    ds_read_b64_tr_b16 v[36:37], v4 offset:32768
    v_mfma_f32_16x16x32_bf16 v[84:87], v[40:43], v[180:183], v[84:87]
    ds_read_b64_tr_b16 v[38:39], v4 offset:33792
    v_mfma_f32_16x16x32_bf16 v[88:91], v[44:47], v[176:179], v[88:91]
    ds_read_b64_tr_b16 v[40:41], v5 offset:32768
    v_mfma_f32_16x16x32_bf16 v[92:95], v[44:47], v[180:183], v[92:95]
    ds_read_b64_tr_b16 v[42:43], v5 offset:33792
    s_waitcnt lgkmcnt(10)
    v_mfma_f32_16x16x32_bf16 v[96:99], v[176:179], v[48:51], v[96:99]
    ds_read_b64_tr_b16 v[44:45], v6 offset:32768
    v_mfma_f32_16x16x32_bf16 v[100:103], v[180:183], v[48:51], v[100:103]
    ds_read_b64_tr_b16 v[46:47], v6 offset:33792
    v_mfma_f32_16x16x32_bf16 v[104:107], v[176:179], v[52:55], v[104:107]
    ds_read_b64_tr_b16 v[48:49], v3 offset:36864
    v_mfma_f32_16x16x32_bf16 v[108:111], v[180:183], v[52:55], v[108:111]
    ds_read_b64_tr_b16 v[50:51], v3 offset:37888
    s_waitcnt lgkmcnt(10)
    v_mfma_f32_16x16x32_bf16 v[112:115], v[176:179], v[56:59], v[112:115]
    ds_read_b64_tr_b16 v[52:53], v4 offset:36864
    v_mfma_f32_16x16x32_bf16 v[116:119], v[180:183], v[56:59], v[116:119]
    ds_read_b64_tr_b16 v[54:55], v4 offset:37888
    v_mfma_f32_16x16x32_bf16 v[120:123], v[176:179], v[60:63], v[120:123]
    ds_read_b64_tr_b16 v[56:57], v5 offset:36864
    v_mfma_f32_16x16x32_bf16 v[124:127], v[180:183], v[60:63], v[124:127]
    ds_read_b64_tr_b16 v[58:59], v5 offset:37888
    s_waitcnt lgkmcnt(10)
    v_mfma_f32_16x16x32_bf16 v[128:131], v[32:35], v[176:179], v[128:131]
    ds_read_b64_tr_b16 v[60:61], v6 offset:36864
    v_mfma_f32_16x16x32_bf16 v[132:135], v[32:35], v[180:183], v[132:135]
    ds_read_b64_tr_b16 v[62:63], v6 offset:37888
    v_mfma_f32_16x16x32_bf16 v[136:139], v[36:39], v[176:179], v[136:139]
    ds_read_b64_tr_b16 v[32:33], v3 offset:40960
    v_mfma_f32_16x16x32_bf16 v[140:143], v[36:39], v[180:183], v[140:143]
    ds_read_b64_tr_b16 v[34:35], v3 offset:41984
    s_waitcnt lgkmcnt(10)
    v_mfma_f32_16x16x32_bf16 v[144:147], v[40:43], v[176:179], v[144:147]
    ds_read_b64_tr_b16 v[36:37], v4 offset:40960
    v_mfma_f32_16x16x32_bf16 v[148:151], v[40:43], v[180:183], v[148:151]
    ds_read_b64_tr_b16 v[38:39], v4 offset:41984
    v_mfma_f32_16x16x32_bf16 v[152:155], v[44:47], v[176:179], v[152:155]
    ds_read_b64_tr_b16 v[40:41], v5 offset:40960
    v_mfma_f32_16x16x32_bf16 v[156:159], v[44:47], v[180:183], v[156:159]
    ds_read_b64_tr_b16 v[42:43], v5 offset:41984
    s_waitcnt vmcnt(6) lgkmcnt(10)
    v_mfma_f32_16x16x32_bf16 v[64:67], v[48:51], v[184:187], v[64:67]
    ds_read_b64_tr_b16 v[44:45], v6 offset:40960
    s_add_u32 s42, s41, s87
    s_cbranch_vccnz xs1
    buffer_load_dwordx4 v[216:219], v2, s[4:7], s42 offen offset:2048 sc1
xs1:
    v_mfma_f32_16x16x32_bf16 v[68:71], v[48:51], v[188:191], v[68:71]
    ds_read_b64_tr_b16 v[46:47], v6 offset:41984
    v_mfma_f32_16x16x32_bf16 v[72:75], v[52:55], v[184:187], v[72:75]
    ds_read_b64_tr_b16 v[48:49], v3 offset:45056
    s_cbranch_vccnz xs2
    buffer_load_dwordx4 v[220:223], v2, s[4:7], s42 offen offset:2304 sc1
xs2:
    v_mfma_f32_16x16x32_bf16 v[76:79], v[52:55], v[188:191], v[76:79]
    ds_read_b64_tr_b16 v[50:51], v3 offset:46080
    s_waitcnt lgkmcnt(10)
    v_mfma_f32_16x16x32_bf16 v[80:83], v[56:59], v[184:187], v[80:83]
    ds_read_b64_tr_b16 v[52:53], v4 offset:45056
    s_add_u32 s42, s41, s88
    buffer_load_dwordx4 v[224:227], v2, s[4:7], s42 offen offset:0 sc1
    v_mfma_f32_16x16x32_bf16 v[84:87], v[56:59], v[188:191], v[84:87]
    ds_read_b64_tr_b16 v[54:55], v4 offset:46080
    v_mfma_f32_16x16x32_bf16 v[88:91], v[60:63], v[184:187], v[88:91]
    ds_read_b64_tr_b16 v[56:57], v5 offset:45056
    buffer_load_dwordx4 v[228:231], v2, s[4:7], s42 offen offset:256 sc1
    v_mfma_f32_16x16x32_bf16 v[92:95], v[60:63], v[188:191], v[92:95]
    ds_read_b64_tr_b16 v[58:59], v5 offset:46080
    s_waitcnt lgkmcnt(10)
    v_mfma_f32_16x16x32_bf16 v[96:99], v[184:187], v[32:35], v[96:99]
    ds_read_b64_tr_b16 v[60:61], v6 offset:45056
    buffer_load_dwordx4 v[232:235], v2, s[4:7], s42 offen offset:2048 sc1
    v_mfma_f32_16x16x32_bf16 v[100:103], v[188:191], v[32:35], v[100:103]
    ds_read_b64_tr_b16 v[62:63], v6 offset:46080
    v_mfma_f32_16x16x32_bf16 v[104:107], v[184:187], v[36:39], v[104:107]
    ds_read_b64_tr_b16 v[32:33], v3 offset:49152
    buffer_load_dwordx4 v[236:239], v2, s[4:7], s42 offen offset:2304 sc1
    v_mfma_f32_16x16x32_bf16 v[108:111], v[188:191], v[36:39], v[108:111]
    ds_read_b64_tr_b16 v[34:35], v3 offset:50176
    s_waitcnt lgkmcnt(10)
    v_mfma_f32_16x16x32_bf16 v[112:115], v[184:187], v[40:43], v[112:115]
    ds_read_b64_tr_b16 v[36:37], v4 offset:49152
    s_add_u32 s42, s41, s89
    buffer_load_dwordx4 v[240:243], v2, s[4:7], s42 offen offset:0 sc1
    v_mfma_f32_16x16x32_bf16 v[116:119], v[188:191], v[40:43], v[116:119]
    ds_read_b64_tr_b16 v[38:39], v4 offset:50176
    v_mfma_f32_16x16x32_bf16 v[120:123], v[184:187], v[44:47], v[120:123]
    ds_read_b64_tr_b16 v[40:41], v5 offset:49152
    buffer_load_dwordx4 v[244:247], v2, s[4:7], s42 offen offset:256 sc1
    v_mfma_f32_16x16x32_bf16 v[124:127], v[188:191], v[44:47], v[124:127]
    ds_read_b64_tr_b16 v[42:43], v5 offset:50176
    s_waitcnt lgkmcnt(10)
    v_mfma_f32_16x16x32_bf16 v[128:131], v[48:51], v[184:187], v[128:131]
    ds_read_b64_tr_b16 v[44:45], v6 offset:49152
    buffer_load_dwordx4 v[248:251], v2, s[4:7], s42 offen offset:2048 sc1
    v_mfma_f32_16x16x32_bf16 v[132:135], v[48:51], v[188:191], v[132:135]
    ds_read_b64_tr_b16 v[46:47], v6 offset:50176
    v_mfma_f32_16x16x32_bf16 v[136:139], v[52:55], v[184:187], v[136:139]
    ds_read_b64_tr_b16 v[48:49], v3 offset:53248
    v_mfma_f32_16x16x32_bf16 v[140:143], v[52:55], v[188:191], v[140:143]
    ds_read_b64_tr_b16 v[50:51], v3 offset:54272
    s_waitcnt lgkmcnt(10)
    v_mfma_f32_16x16x32_bf16 v[144:147], v[56:59], v[184:187], v[144:147]
    ds_read_b64_tr_b16 v[52:53], v4 offset:53248
    v_mfma_f32_16x16x32_bf16 v[148:151], v[56:59], v[188:191], v[148:151]
    ds_read_b64_tr_b16 v[54:55], v4 offset:54272
    v_mfma_f32_16x16x32_bf16 v[152:155], v[60:63], v[184:187], v[152:155]
    ds_read_b64_tr_b16 v[56:57], v5 offset:53248
    v_mfma_f32_16x16x32_bf16 v[156:159], v[60:63], v[188:191], v[156:159]
    ds_read_b64_tr_b16 v[58:59], v5 offset:54272
    s_waitcnt vmcnt(13) lgkmcnt(10)
    v_mfma_f32_16x16x32_bf16 v[64:67], v[32:35], v[192:195], v[64:67]
    ds_read_b64_tr_b16 v[60:61], v6 offset:53248
    buffer_load_dwordx4 v[252:255], v2, s[4:7], s42 offen offset:2304 sc1
    v_mfma_f32_16x16x32_bf16 v[68:71], v[32:35], v[196:199], v[68:71]
    ds_read_b64_tr_b16 v[62:63], v6 offset:54272
    v_mfma_f32_16x16x32_bf16 v[72:75], v[36:39], v[192:195], v[72:75]
    ds_read_b64_tr_b16 v[32:33], v3 offset:57344
    v_mfma_f32_16x16x32_bf16 v[76:79], v[36:39], v[196:199], v[76:79]
    ds_read_b64_tr_b16 v[34:35], v3 offset:58368
    s_waitcnt lgkmcnt(10)
    v_mfma_f32_16x16x32_bf16 v[80:83], v[40:43], v[192:195], v[80:83]
    ds_read_b64_tr_b16 v[36:37], v4 offset:57344
    v_mfma_f32_16x16x32_bf16 v[84:87], v[40:43], v[196:199], v[84:87]
    ds_read_b64_tr_b16 v[38:39], v4 offset:58368
    v_mfma_f32_16x16x32_bf16 v[88:91], v[44:47], v[192:195], v[88:91]
    ds_read_b64_tr_b16 v[40:41], v5 offset:57344
    v_mfma_f32_16x16x32_bf16 v[92:95], v[44:47], v[196:199], v[92:95]
    ds_read_b64_tr_b16 v[42:43], v5 offset:58368
    s_waitcnt lgkmcnt(10)
    v_mfma_f32_16x16x32_bf16 v[96:99], v[192:195], v[48:51], v[96:99]
    ds_read_b64_tr_b16 v[44:45], v6 offset:57344
    s_add_u32 s42, s41, s90
    buffer_load_dwordx4 v[160:163], v2, s[4:7], s42 offen offset:0 sc1
    v_mfma_f32_16x16x32_bf16 v[100:103], v[196:199], v[48:51], v[100:103]
    ds_read_b64_tr_b16 v[46:47], v6 offset:58368
    v_mfma_f32_16x16x32_bf16 v[104:107], v[192:195], v[52:55], v[104:107]
    ds_read_b64_tr_b16 v[48:49], v3 offset:61440
    v_mfma_f32_16x16x32_bf16 v[108:111], v[196:199], v[52:55], v[108:111]
    ds_read_b64_tr_b16 v[50:51], v3 offset:62464
    s_waitcnt lgkmcnt(10)
    v_mfma_f32_16x16x32_bf16 v[112:115], v[192:195], v[56:59], v[112:115]
    ds_read_b64_tr_b16 v[52:53], v4 offset:61440
    v_mfma_f32_16x16x32_bf16 v[116:119], v[196:199], v[56:59], v[116:119]
    ds_read_b64_tr_b16 v[54:55], v4 offset:62464
    v_mfma_f32_16x16x32_bf16 v[120:123], v[192:195], v[60:63], v[120:123]
    ds_read_b64_tr_b16 v[56:57], v5 offset:61440
    v_mfma_f32_16x16x32_bf16 v[124:127], v[196:199], v[60:63], v[124:127]
    ds_read_b64_tr_b16 v[58:59], v5 offset:62464
    s_waitcnt lgkmcnt(10)
    v_mfma_f32_16x16x32_bf16 v[128:131], v[32:35], v[192:195], v[128:131]
    ds_read_b64_tr_b16 v[60:61], v6 offset:61440
    v_mfma_f32_16x16x32_bf16 v[132:135], v[32:35], v[196:199], v[132:135]
    ds_read_b64_tr_b16 v[62:63], v6 offset:62464
    s_barrier
    v_xor_b32 v3, 0x10000, v3
    v_xor_b32 v4, 0x10000, v4
    v_xor_b32 v5, 0x10000, v5
    v_xor_b32 v6, 0x10000, v6
    v_mfma_f32_16x16x32_bf16 v[136:139], v[36:39], v[192:195], v[136:139]
    ds_read_b64_tr_b16 v[32:33], v3 offset:0
    v_mfma_f32_16x16x32_bf16 v[140:143], v[36:39], v[196:199], v[140:143]
    ds_read_b64_tr_b16 v[34:35], v3 offset:1024
    s_waitcnt lgkmcnt(10)
    v_mfma_f32_16x16x32_bf16 v[144:147], v[40:43], v[192:195], v[144:147]
    ds_read_b64_tr_b16 v[36:37], v4 offset:0
    v_mfma_f32_16x16x32_bf16 v[148:151], v[40:43], v[196:199], v[148:151]
    ds_read_b64_tr_b16 v[38:39], v4 offset:1024
    v_mfma_f32_16x16x32_bf16 v[152:155], v[44:47], v[192:195], v[152:155]
    ds_read_b64_tr_b16 v[40:41], v5 offset:0
    v_mfma_f32_16x16x32_bf16 v[156:159], v[44:47], v[196:199], v[156:159]
    ds_read_b64_tr_b16 v[42:43], v5 offset:1024
    s_waitcnt vmcnt(13) lgkmcnt(10)
    v_mfma_f32_16x16x32_bf16 v[64:67], v[48:51], v[200:203], v[64:67]
    ds_read_b64_tr_b16 v[44:45], v6 offset:0
    v_mfma_f32_16x16x32_bf16 v[68:71], v[48:51], v[204:207], v[68:71]
    ds_read_b64_tr_b16 v[46:47], v6 offset:1024
    v_mfma_f32_16x16x32_bf16 v[72:75], v[52:55], v[200:203], v[72:75]
    ds_read_b64_tr_b16 v[48:49], v3 offset:4096
    v_mfma_f32_16x16x32_bf16 v[76:79], v[52:55], v[204:207], v[76:79]
    ds_read_b64_tr_b16 v[50:51], v3 offset:5120
    s_waitcnt lgkmcnt(10)
    v_mfma_f32_16x16x32_bf16 v[80:83], v[56:59], v[200:203], v[80:83]
    ds_read_b64_tr_b16 v[52:53], v4 offset:4096
    v_mfma_f32_16x16x32_bf16 v[84:87], v[56:59], v[204:207], v[84:87]
    ds_read_b64_tr_b16 v[54:55], v4 offset:5120
    v_mfma_f32_16x16x32_bf16 v[88:91], v[60:63], v[200:203], v[88:91]
    ds_read_b64_tr_b16 v[56:57], v5 offset:4096
    v_mfma_f32_16x16x32_bf16 v[92:95], v[60:63], v[204:207], v[92:95]
    ds_read_b64_tr_b16 v[58:59], v5 offset:5120
    s_waitcnt lgkmcnt(10)
    v_mfma_f32_16x16x32_bf16 v[96:99], v[200:203], v[32:35], v[96:99]
    ds_read_b64_tr_b16 v[60:61], v6 offset:4096
    v_mfma_f32_16x16x32_bf16 v[100:103], v[204:207], v[32:35], v[100:103]
    ds_read_b64_tr_b16 v[62:63], v6 offset:5120
    v_mfma_f32_16x16x32_bf16 v[104:107], v[200:203], v[36:39], v[104:107]
    ds_read_b64_tr_b16 v[32:33], v3 offset:8192
    v_mfma_f32_16x16x32_bf16 v[108:111], v[204:207], v[36:39], v[108:111]
    ds_read_b64_tr_b16 v[34:35], v3 offset:9216
    s_waitcnt lgkmcnt(10)
    v_mfma_f32_16x16x32_bf16 v[112:115], v[200:203], v[40:43], v[112:115]
    ds_read_b64_tr_b16 v[36:37], v4 offset:8192
    v_mfma_f32_16x16x32_bf16 v[116:119], v[204:207], v[40:43], v[116:119]
    ds_read_b64_tr_b16 v[38:39], v4 offset:9216
    v_mfma_f32_16x16x32_bf16 v[120:123], v[200:203], v[44:47], v[120:123]
    ds_read_b64_tr_b16 v[40:41], v5 offset:8192
    v_mfma_f32_16x16x32_bf16 v[124:127], v[204:207], v[44:47], v[124:127]
    ds_read_b64_tr_b16 v[42:43], v5 offset:9216
    s_waitcnt lgkmcnt(10)
    v_mfma_f32_16x16x32_bf16 v[128:131], v[48:51], v[200:203], v[128:131]
    ds_read_b64_tr_b16 v[44:45], v6 offset:8192
    v_mfma_f32_16x16x32_bf16 v[132:135], v[48:51], v[204:207], v[132:135]
    ds_read_b64_tr_b16 v[46:47], v6 offset:9216
    v_mfma_f32_16x16x32_bf16 v[136:139], v[52:55], v[200:203], v[136:139]
    ds_read_b64_tr_b16 v[48:49], v3 offset:12288
    v_mfma_f32_16x16x32_bf16 v[140:143], v[52:55], v[204:207], v[140:143]
    ds_read_b64_tr_b16 v[50:51], v3 offset:13312
    s_waitcnt lgkmcnt(10)
    v_mfma_f32_16x16x32_bf16 v[144:147], v[56:59], v[200:203], v[144:147]
    ds_read_b64_tr_b16 v[52:53], v4 offset:12288
    v_mfma_f32_16x16x32_bf16 v[148:151], v[56:59], v[204:207], v[148:151]
    ds_read_b64_tr_b16 v[54:55], v4 offset:13312
    v_mfma_f32_16x16x32_bf16 v[152:155], v[60:63], v[200:203], v[152:155]
    ds_read_b64_tr_b16 v[56:57], v5 offset:12288
    v_mfma_f32_16x16x32_bf16 v[156:159], v[60:63], v[204:207], v[156:159]
    ds_read_b64_tr_b16 v[58:59], v5 offset:13312
    s_waitcnt vmcnt(11) lgkmcnt(10)
    v_mfma_f32_16x16x32_bf16 v[64:67], v[32:35], v[208:211], v[64:67]
    ds_read_b64_tr_b16 v[60:61], v6 offset:12288
    v_mfma_f32_16x16x32_bf16 v[68:71], v[32:35], v[212:215], v[68:71]
    ds_read_b64_tr_b16 v[62:63], v6 offset:13312
    v_mfma_f32_16x16x32_bf16 v[72:75], v[36:39], v[208:211], v[72:75]
    ds_read_b64_tr_b16 v[32:33], v3 offset:16384
    v_mfma_f32_16x16x32_bf16 v[76:79], v[36:39], v[212:215], v[76:79]
    ds_read_b64_tr_b16 v[34:35], v3 offset:17408
    s_waitcnt lgkmcnt(10)
    v_mfma_f32_16x16x32_bf16 v[80:83], v[40:43], v[208:211], v[80:83]
    ds_read_b64_tr_b16 v[36:37], v4 offset:16384
    v_mfma_f32_16x16x32_bf16 v[84:87], v[40:43], v[212:215], v[84:87]
    ds_read_b64_tr_b16 v[38:39], v4 offset:17408
    v_mfma_f32_16x16x32_bf16 v[88:91], v[44:47], v[208:211], v[88:91]
    ds_read_b64_tr_b16 v[40:41], v5 offset:16384
    v_mfma_f32_16x16x32_bf16 v[92:95], v[44:47], v[212:215], v[92:95]
    ds_read_b64_tr_b16 v[42:43], v5 offset:17408
    s_waitcnt lgkmcnt(10)
    v_mfma_f32_16x16x32_bf16 v[96:99], v[208:211], v[48:51], v[96:99]
    ds_read_b64_tr_b16 v[44:45], v6 offset:16384
    buffer_load_dwordx4 v[164:167], v2, s[4:7], s42 offen offset:256 sc1
    v_mfma_f32_16x16x32_bf16 v[100:103], v[212:215], v[48:51], v[100:103]
    ds_read_b64_tr_b16 v[46:47], v6 offset:17408
    v_mfma_f32_16x16x32_bf16 v[104:107], v[208:211], v[52:55], v[104:107]
    ds_read_b64_tr_b16 v[48:49], v3 offset:20480
    buffer_load_dwordx4 v[168:171], v2, s[4:7], s42 offen offset:2048 sc1
    v_mfma_f32_16x16x32_bf16 v[108:111], v[212:215], v[52:55], v[108:111]
    ds_read_b64_tr_b16 v[50:51], v3 offset:21504
    s_waitcnt lgkmcnt(10)
    v_mfma_f32_16x16x32_bf16 v[112:115], v[208:211], v[56:59], v[112:115]
    ds_read_b64_tr_b16 v[52:53], v4 offset:20480
    buffer_load_dwordx4 v[172:175], v2, s[4:7], s42 offen offset:2304 sc1
    v_mfma_f32_16x16x32_bf16 v[116:119], v[212:215], v[56:59], v[116:119]
    ds_read_b64_tr_b16 v[54:55], v4 offset:21504
    v_mfma_f32_16x16x32_bf16 v[120:123], v[208:211], v[60:63], v[120:123]
    ds_read_b64_tr_b16 v[56:57], v5 offset:20480
    s_add_u32 s42, s41, s91
    buffer_load_dwordx4 v[176:179], v2, s[4:7], s42 offen offset:0 sc1
    v_mfma_f32_16x16x32_bf16 v[124:127], v[212:215], v[60:63], v[124:127]
    ds_read_b64_tr_b16 v[58:59], v5 offset:21504
    s_waitcnt lgkmcnt(10)
    v_mfma_f32_16x16x32_bf16 v[128:131], v[32:35], v[208:211], v[128:131]
    ds_read_b64_tr_b16 v[60:61], v6 offset:20480
    buffer_load_dwordx4 v[180:183], v2, s[4:7], s42 offen offset:256 sc1
    v_mfma_f32_16x16x32_bf16 v[132:135], v[32:35], v[212:215], v[132:135]
    ds_read_b64_tr_b16 v[62:63], v6 offset:21504
    v_mfma_f32_16x16x32_bf16 v[136:139], v[36:39], v[208:211], v[136:139]
    ds_read_b64_tr_b16 v[32:33], v3 offset:24576
    buffer_load_dwordx4 v[184:187], v2, s[4:7], s42 offen offset:2048 sc1
    v_mfma_f32_16x16x32_bf16 v[140:143], v[36:39], v[212:215], v[140:143]
    ds_read_b64_tr_b16 v[34:35], v3 offset:25600
    s_waitcnt lgkmcnt(10)
    v_mfma_f32_16x16x32_bf16 v[144:147], v[40:43], v[208:211], v[144:147]
    ds_read_b64_tr_b16 v[36:37], v4 offset:24576
    v_mfma_f32_16x16x32_bf16 v[148:151], v[40:43], v[212:215], v[148:151]
    ds_read_b64_tr_b16 v[38:39], v4 offset:25600
    v_mfma_f32_16x16x32_bf16 v[152:155], v[44:47], v[208:211], v[152:155]
    ds_read_b64_tr_b16 v[40:41], v5 offset:24576
    v_mfma_f32_16x16x32_bf16 v[156:159], v[44:47], v[212:215], v[156:159]
    ds_read_b64_tr_b16 v[42:43], v5 offset:25600
    s_waitcnt vmcnt(15) lgkmcnt(10)
    v_mfma_f32_16x16x32_bf16 v[64:67], v[48:51], v[216:219], v[64:67]
    ds_read_b64_tr_b16 v[44:45], v6 offset:24576
    v_mfma_f32_16x16x32_bf16 v[68:71], v[48:51], v[220:223], v[68:71]
    ds_read_b64_tr_b16 v[46:47], v6 offset:25600
    v_mfma_f32_16x16x32_bf16 v[72:75], v[52:55], v[216:219], v[72:75]
    ds_read_b64_tr_b16 v[48:49], v3 offset:28672
    v_mfma_f32_16x16x32_bf16 v[76:79], v[52:55], v[220:223], v[76:79]
    ds_read_b64_tr_b16 v[50:51], v3 offset:29696
    s_waitcnt lgkmcnt(10)
    v_mfma_f32_16x16x32_bf16 v[80:83], v[56:59], v[216:219], v[80:83]
    ds_read_b64_tr_b16 v[52:53], v4 offset:28672
    buffer_load_dwordx4 v[188:191], v2, s[4:7], s42 offen offset:2304 sc1
    v_mfma_f32_16x16x32_bf16 v[84:87], v[56:59], v[220:223], v[84:87]
    ds_read_b64_tr_b16 v[54:55], v4 offset:29696
    v_mfma_f32_16x16x32_bf16 v[88:91], v[60:63], v[216:219], v[88:91]
    ds_read_b64_tr_b16 v[56:57], v5 offset:28672
    v_mfma_f32_16x16x32_bf16 v[92:95], v[60:63], v[220:223], v[92:95]
    ds_read_b64_tr_b16 v[58:59], v5 offset:29696
    s_waitcnt lgkmcnt(10)
    v_mfma_f32_16x16x32_bf16 v[96:99], v[216:219], v[32:35], v[96:99]
    ds_read_b64_tr_b16 v[60:61], v6 offset:28672
    v_mfma_f32_16x16x32_bf16 v[100:103], v[220:223], v[32:35], v[100:103]
    ds_read_b64_tr_b16 v[62:63], v6 offset:29696
    s_barrier
    v_mfma_f32_16x16x32_bf16 v[104:107], v[216:219], v[36:39], v[104:107]
    ds_read_b64_tr_b16 v[32:33], v3 offset:32768
    v_mfma_f32_16x16x32_bf16 v[108:111], v[220:223], v[36:39], v[108:111]
    ds_read_b64_tr_b16 v[34:35], v3 offset:33792
    s_waitcnt lgkmcnt(10)
    v_mfma_f32_16x16x32_bf16 v[112:115], v[216:219], v[40:43], v[112:115]
    ds_read_b64_tr_b16 v[36:37], v4 offset:32768
    v_mfma_f32_16x16x32_bf16 v[116:119], v[220:223], v[40:43], v[116:119]
    ds_read_b64_tr_b16 v[38:39], v4 offset:33792
    v_mfma_f32_16x16x32_bf16 v[120:123], v[216:219], v[44:47], v[120:123]
    ds_read_b64_tr_b16 v[40:41], v5 offset:32768
    v_mfma_f32_16x16x32_bf16 v[124:127], v[220:223], v[44:47], v[124:127]
    ds_read_b64_tr_b16 v[42:43], v5 offset:33792
    s_waitcnt lgkmcnt(10)
    v_mfma_f32_16x16x32_bf16 v[128:131], v[48:51], v[216:219], v[128:131]
    ds_read_b64_tr_b16 v[44:45], v6 offset:32768
    v_mfma_f32_16x16x32_bf16 v[132:135], v[48:51], v[220:223], v[132:135]
    ds_read_b64_tr_b16 v[46:47], v6 offset:33792
    v_mfma_f32_16x16x32_bf16 v[136:139], v[52:55], v[216:219], v[136:139]
    ds_read_b64_tr_b16 v[48:49], v3 offset:36864
    v_mfma_f32_16x16x32_bf16 v[140:143], v[52:55], v[220:223], v[140:143]
    ds_read_b64_tr_b16 v[50:51], v3 offset:37888
    s_waitcnt lgkmcnt(10)
    v_mfma_f32_16x16x32_bf16 v[144:147], v[56:59], v[216:219], v[144:147]
    ds_read_b64_tr_b16 v[52:53], v4 offset:36864
    v_mfma_f32_16x16x32_bf16 v[148:151], v[56:59], v[220:223], v[148:151]
    ds_read_b64_tr_b16 v[54:55], v4 offset:37888
    v_mfma_f32_16x16x32_bf16 v[152:155], v[60:63], v[216:219], v[152:155]
    ds_read_b64_tr_b16 v[56:57], v5 offset:36864
    v_mfma_f32_16x16x32_bf16 v[156:159], v[60:63], v[220:223], v[156:159]
    ds_read_b64_tr_b16 v[58:59], v5 offset:37888
    s_waitcnt vmcnt(14) lgkmcnt(10)
    v_mfma_f32_16x16x32_bf16 v[64:67], v[32:35], v[224:227], v[64:67]
    ds_read_b64_tr_b16 v[60:61], v6 offset:36864
    v_mfma_f32_16x16x32_bf16 v[68:71], v[32:35], v[228:231], v[68:71]
    ds_read_b64_tr_b16 v[62:63], v6 offset:37888
    v_mfma_f32_16x16x32_bf16 v[72:75], v[36:39], v[224:227], v[72:75]
    ds_read_b64_tr_b16 v[32:33], v3 offset:40960
    v_mfma_f32_16x16x32_bf16 v[76:79], v[36:39], v[228:231], v[76:79]
    ds_read_b64_tr_b16 v[34:35], v3 offset:41984
    s_waitcnt lgkmcnt(10)
    v_mfma_f32_16x16x32_bf16 v[80:83], v[40:43], v[224:227], v[80:83]
    ds_read_b64_tr_b16 v[36:37], v4 offset:40960
    v_mfma_f32_16x16x32_bf16 v[84:87], v[40:43], v[228:231], v[84:87]
    ds_read_b64_tr_b16 v[38:39], v4 offset:41984
    v_mfma_f32_16x16x32_bf16 v[88:91], v[44:47], v[224:227], v[88:91]
    ds_read_b64_tr_b16 v[40:41], v5 offset:40960
    v_mfma_f32_16x16x32_bf16 v[92:95], v[44:47], v[228:231], v[92:95]
    ds_read_b64_tr_b16 v[42:43], v5 offset:41984
    s_waitcnt lgkmcnt(10)
    v_mfma_f32_16x16x32_bf16 v[96:99], v[224:227], v[48:51], v[96:99]
    ds_read_b64_tr_b16 v[44:45], v6 offset:40960
    v_mfma_f32_16x16x32_bf16 v[100:103], v[228:231], v[48:51], v[100:103]
    ds_read_b64_tr_b16 v[46:47], v6 offset:41984
    v_mfma_f32_16x16x32_bf16 v[104:107], v[224:227], v[52:55], v[104:107]
    ds_read_b64_tr_b16 v[48:49], v3 offset:45056
    v_mfma_f32_16x16x32_bf16 v[108:111], v[228:231], v[52:55], v[108:111]
    ds_read_b64_tr_b16 v[50:51], v3 offset:46080
    s_waitcnt lgkmcnt(10)
    v_mfma_f32_16x16x32_bf16 v[112:115], v[224:227], v[56:59], v[112:115]
    ds_read_b64_tr_b16 v[52:53], v4 offset:45056
    v_mfma_f32_16x16x32_bf16 v[116:119], v[228:231], v[56:59], v[116:119]
    ds_read_b64_tr_b16 v[54:55], v4 offset:46080
    v_mfma_f32_16x16x32_bf16 v[120:123], v[224:227], v[60:63], v[120:123]
    ds_read_b64_tr_b16 v[56:57], v5 offset:45056
    v_mfma_f32_16x16x32_bf16 v[124:127], v[228:231], v[60:63], v[124:127]
    ds_read_b64_tr_b16 v[58:59], v5 offset:46080
    s_waitcnt lgkmcnt(10)
    v_mfma_f32_16x16x32_bf16 v[128:131], v[32:35], v[224:227], v[128:131]
    ds_read_b64_tr_b16 v[60:61], v6 offset:45056
    v_mfma_f32_16x16x32_bf16 v[132:135], v[32:35], v[228:231], v[132:135]
    ds_read_b64_tr_b16 v[62:63], v6 offset:46080
    v_mfma_f32_16x16x32_bf16 v[136:139], v[36:39], v[224:227], v[136:139]
    ds_read_b64_tr_b16 v[32:33], v3 offset:49152
    v_mfma_f32_16x16x32_bf16 v[140:143], v[36:39], v[228:231], v[140:143]
    ds_read_b64_tr_b16 v[34:35], v3 offset:50176
    s_waitcnt lgkmcnt(10)
    v_mfma_f32_16x16x32_bf16 v[144:147], v[40:43], v[224:227], v[144:147]
    ds_read_b64_tr_b16 v[36:37], v4 offset:49152
    v_mfma_f32_16x16x32_bf16 v[148:151], v[40:43], v[228:231], v[148:151]
    ds_read_b64_tr_b16 v[38:39], v4 offset:50176
    v_mfma_f32_16x16x32_bf16 v[152:155], v[44:47], v[224:227], v[152:155]
    ds_read_b64_tr_b16 v[40:41], v5 offset:49152
    v_mfma_f32_16x16x32_bf16 v[156:159], v[44:47], v[228:231], v[156:159]
    ds_read_b64_tr_b16 v[42:43], v5 offset:50176
    s_waitcnt vmcnt(12) lgkmcnt(10)
    v_mfma_f32_16x16x32_bf16 v[64:67], v[48:51], v[232:235], v[64:67]
    ds_read_b64_tr_b16 v[44:45], v6 offset:49152
    s_add_u32 s42, s41, s92
    buffer_load_dwordx4 v[192:195], v2, s[4:7], s42 offen offset:0 sc1
    v_mfma_f32_16x16x32_bf16 v[68:71], v[48:51], v[236:239], v[68:71]
    ds_read_b64_tr_b16 v[46:47], v6 offset:50176
    v_mfma_f32_16x16x32_bf16 v[72:75], v[52:55], v[232:235], v[72:75]
    ds_read_b64_tr_b16 v[48:49], v3 offset:53248
    buffer_load_dwordx4 v[196:199], v2, s[4:7], s42 offen offset:256 sc1
    v_mfma_f32_16x16x32_bf16 v[76:79], v[52:55], v[236:239], v[76:79]
    ds_read_b64_tr_b16 v[50:51], v3 offset:54272
    s_waitcnt lgkmcnt(10)
    v_mfma_f32_16x16x32_bf16 v[80:83], v[56:59], v[232:235], v[80:83]
    ds_read_b64_tr_b16 v[52:53], v4 offset:53248
    buffer_load_dwordx4 v[200:203], v2, s[4:7], s42 offen offset:2048 sc1
    v_mfma_f32_16x16x32_bf16 v[84:87], v[56:59], v[236:239], v[84:87]
    ds_read_b64_tr_b16 v[54:55], v4 offset:54272
    v_mfma_f32_16x16x32_bf16 v[88:91], v[60:63], v[232:235], v[88:91]
    ds_read_b64_tr_b16 v[56:57], v5 offset:53248
    buffer_load_dwordx4 v[204:207], v2, s[4:7], s42 offen offset:2304 sc1
    v_mfma_f32_16x16x32_bf16 v[92:95], v[60:63], v[236:239], v[92:95]
    ds_read_b64_tr_b16 v[58:59], v5 offset:54272
    s_waitcnt lgkmcnt(10)
    v_mfma_f32_16x16x32_bf16 v[96:99], v[232:235], v[32:35], v[96:99]
    ds_read_b64_tr_b16 v[60:61], v6 offset:53248
    s_add_u32 s42, s41, s93
    buffer_load_dwordx4 v[208:211], v2, s[4:7], s42 offen offset:0 sc1
    v_mfma_f32_16x16x32_bf16 v[100:103], v[236:239], v[32:35], v[100:103]
    ds_read_b64_tr_b16 v[62:63], v6 offset:54272
    v_mfma_f32_16x16x32_bf16 v[104:107], v[232:235], v[36:39], v[104:107]
    ds_read_b64_tr_b16 v[32:33], v3 offset:57344
    v_mfma_f32_16x16x32_bf16 v[108:111], v[236:239], v[36:39], v[108:111]
    ds_read_b64_tr_b16 v[34:35], v3 offset:58368
    s_waitcnt lgkmcnt(10)
    v_mfma_f32_16x16x32_bf16 v[112:115], v[232:235], v[40:43], v[112:115]
    ds_read_b64_tr_b16 v[36:37], v4 offset:57344
    v_mfma_f32_16x16x32_bf16 v[116:119], v[236:239], v[40:43], v[116:119]
    ds_read_b64_tr_b16 v[38:39], v4 offset:58368
    v_mfma_f32_16x16x32_bf16 v[120:123], v[232:235], v[44:47], v[120:123]
    ds_read_b64_tr_b16 v[40:41], v5 offset:57344
    buffer_load_dwordx4 v[212:215], v2, s[4:7], s42 offen offset:256 sc1
    v_mfma_f32_16x16x32_bf16 v[124:127], v[236:239], v[44:47], v[124:127]
    ds_read_b64_tr_b16 v[42:43], v5 offset:58368
    s_waitcnt lgkmcnt(10)
    v_mfma_f32_16x16x32_bf16 v[128:131], v[48:51], v[232:235], v[128:131]
    ds_read_b64_tr_b16 v[44:45], v6 offset:57344
    v_mfma_f32_16x16x32_bf16 v[132:135], v[48:51], v[236:239], v[132:135]
    ds_read_b64_tr_b16 v[46:47], v6 offset:58368
    v_mfma_f32_16x16x32_bf16 v[136:139], v[52:55], v[232:235], v[136:139]
    ds_read_b64_tr_b16 v[48:49], v3 offset:61440
    v_mfma_f32_16x16x32_bf16 v[140:143], v[52:55], v[236:239], v[140:143]
    ds_read_b64_tr_b16 v[50:51], v3 offset:62464
    s_waitcnt lgkmcnt(10)
    v_mfma_f32_16x16x32_bf16 v[144:147], v[56:59], v[232:235], v[144:147]
    ds_read_b64_tr_b16 v[52:53], v4 offset:61440
    v_mfma_f32_16x16x32_bf16 v[148:151], v[56:59], v[236:239], v[148:151]
    ds_read_b64_tr_b16 v[54:55], v4 offset:62464
    v_mfma_f32_16x16x32_bf16 v[152:155], v[60:63], v[232:235], v[152:155]
    ds_read_b64_tr_b16 v[56:57], v5 offset:61440
    v_mfma_f32_16x16x32_bf16 v[156:159], v[60:63], v[236:239], v[156:159]
    ds_read_b64_tr_b16 v[58:59], v5 offset:62464
    s_waitcnt vmcnt(16) lgkmcnt(10)
    v_mfma_f32_16x16x32_bf16 v[64:67], v[32:35], v[240:243], v[64:67]
    ds_read_b64_tr_b16 v[60:61], v6 offset:61440
    v_mfma_f32_16x16x32_bf16 v[68:71], v[32:35], v[244:247], v[68:71]
    ds_read_b64_tr_b16 v[62:63], v6 offset:62464
    s_barrier
    v_xor_b32 v3, 0x10000, v3
    v_xor_b32 v4, 0x10000, v4
    v_xor_b32 v5, 0x10000, v5
    v_xor_b32 v6, 0x10000, v6
    v_mfma_f32_16x16x32_bf16 v[72:75], v[36:39], v[240:243], v[72:75]
    ds_read_b64_tr_b16 v[32:33], v3 offset:0
    v_mfma_f32_16x16x32_bf16 v[76:79], v[36:39], v[244:247], v[76:79]
    ds_read_b64_tr_b16 v[34:35], v3 offset:1024
    s_waitcnt lgkmcnt(10)
    v_mfma_f32_16x16x32_bf16 v[80:83], v[40:43], v[240:243], v[80:83]
    ds_read_b64_tr_b16 v[36:37], v4 offset:0
    v_mfma_f32_16x16x32_bf16 v[84:87], v[40:43], v[244:247], v[84:87]
    ds_read_b64_tr_b16 v[38:39], v4 offset:1024
    v_mfma_f32_16x16x32_bf16 v[88:91], v[44:47], v[240:243], v[88:91]
    ds_read_b64_tr_b16 v[40:41], v5 offset:0
    v_mfma_f32_16x16x32_bf16 v[92:95], v[44:47], v[244:247], v[92:95]
    ds_read_b64_tr_b16 v[42:43], v5 offset:1024
    s_waitcnt lgkmcnt(10)
    v_mfma_f32_16x16x32_bf16 v[96:99], v[240:243], v[48:51], v[96:99]
    ds_read_b64_tr_b16 v[44:45], v6 offset:0
    v_mfma_f32_16x16x32_bf16 v[100:103], v[244:247], v[48:51], v[100:103]
    ds_read_b64_tr_b16 v[46:47], v6 offset:1024
    v_mfma_f32_16x16x32_bf16 v[104:107], v[240:243], v[52:55], v[104:107]
    ds_read_b64_tr_b16 v[48:49], v3 offset:4096
    v_mfma_f32_16x16x32_bf16 v[108:111], v[244:247], v[52:55], v[108:111]
    ds_read_b64_tr_b16 v[50:51], v3 offset:5120
    s_waitcnt lgkmcnt(10)
    v_mfma_f32_16x16x32_bf16 v[112:115], v[240:243], v[56:59], v[112:115]
    ds_read_b64_tr_b16 v[52:53], v4 offset:4096
    v_mfma_f32_16x16x32_bf16 v[116:119], v[244:247], v[56:59], v[116:119]
    ds_read_b64_tr_b16 v[54:55], v4 offset:5120
    v_mfma_f32_16x16x32_bf16 v[120:123], v[240:243], v[60:63], v[120:123]
    ds_read_b64_tr_b16 v[56:57], v5 offset:4096
    v_mfma_f32_16x16x32_bf16 v[124:127], v[244:247], v[60:63], v[124:127]
    ds_read_b64_tr_b16 v[58:59], v5 offset:5120
    s_waitcnt lgkmcnt(10)
    v_mfma_f32_16x16x32_bf16 v[128:131], v[32:35], v[240:243], v[128:131]
    ds_read_b64_tr_b16 v[60:61], v6 offset:4096
    v_mfma_f32_16x16x32_bf16 v[132:135], v[32:35], v[244:247], v[132:135]
    ds_read_b64_tr_b16 v[62:63], v6 offset:5120
    v_mfma_f32_16x16x32_bf16 v[136:139], v[36:39], v[240:243], v[136:139]
    ds_read_b64_tr_b16 v[32:33], v3 offset:8192
    v_mfma_f32_16x16x32_bf16 v[140:143], v[36:39], v[244:247], v[140:143]
    ds_read_b64_tr_b16 v[34:35], v3 offset:9216
    s_waitcnt lgkmcnt(10)
    v_mfma_f32_16x16x32_bf16 v[144:147], v[40:43], v[240:243], v[144:147]
    ds_read_b64_tr_b16 v[36:37], v4 offset:8192
    v_mfma_f32_16x16x32_bf16 v[148:151], v[40:43], v[244:247], v[148:151]
    ds_read_b64_tr_b16 v[38:39], v4 offset:9216
    v_mfma_f32_16x16x32_bf16 v[152:155], v[44:47], v[240:243], v[152:155]
    ds_read_b64_tr_b16 v[40:41], v5 offset:8192
    v_mfma_f32_16x16x32_bf16 v[156:159], v[44:47], v[244:247], v[156:159]
    ds_read_b64_tr_b16 v[42:43], v5 offset:9216
    s_waitcnt vmcnt(14) lgkmcnt(10)
    v_mfma_f32_16x16x32_bf16 v[64:67], v[48:51], v[248:251], v[64:67]
    ds_read_b64_tr_b16 v[44:45], v6 offset:8192
    v_mfma_f32_16x16x32_bf16 v[68:71], v[48:51], v[252:255], v[68:71]
    ds_read_b64_tr_b16 v[46:47], v6 offset:9216
    v_mfma_f32_16x16x32_bf16 v[72:75], v[52:55], v[248:251], v[72:75]
    ds_read_b64_tr_b16 v[48:49], v3 offset:12288
    v_mfma_f32_16x16x32_bf16 v[76:79], v[52:55], v[252:255], v[76:79]
    ds_read_b64_tr_b16 v[50:51], v3 offset:13312
    s_waitcnt lgkmcnt(10)
    v_mfma_f32_16x16x32_bf16 v[80:83], v[56:59], v[248:251], v[80:83]
    ds_read_b64_tr_b16 v[52:53], v4 offset:12288
    v_mfma_f32_16x16x32_bf16 v[84:87], v[56:59], v[252:255], v[84:87]
    ds_read_b64_tr_b16 v[54:55], v4 offset:13312
    v_mfma_f32_16x16x32_bf16 v[88:91], v[60:63], v[248:251], v[88:91]
    ds_read_b64_tr_b16 v[56:57], v5 offset:12288
    v_mfma_f32_16x16x32_bf16 v[92:95], v[60:63], v[252:255], v[92:95]
    ds_read_b64_tr_b16 v[58:59], v5 offset:13312
    s_waitcnt lgkmcnt(10)
    v_mfma_f32_16x16x32_bf16 v[96:99], v[248:251], v[32:35], v[96:99]
    ds_read_b64_tr_b16 v[60:61], v6 offset:12288
    v_mfma_f32_16x16x32_bf16 v[100:103], v[252:255], v[32:35], v[100:103]
    ds_read_b64_tr_b16 v[62:63], v6 offset:13312
    v_mfma_f32_16x16x32_bf16 v[104:107], v[248:251], v[36:39], v[104:107]
    ds_read_b64_tr_b16 v[32:33], v3 offset:16384
    v_mfma_f32_16x16x32_bf16 v[108:111], v[252:255], v[36:39], v[108:111]
    ds_read_b64_tr_b16 v[34:35], v3 offset:17408
    s_waitcnt lgkmcnt(10)
    v_mfma_f32_16x16x32_bf16 v[112:115], v[248:251], v[40:43], v[112:115]
    ds_read_b64_tr_b16 v[36:37], v4 offset:16384
    v_mfma_f32_16x16x32_bf16 v[116:119], v[252:255], v[40:43], v[116:119]
    ds_read_b64_tr_b16 v[38:39], v4 offset:17408
    v_mfma_f32_16x16x32_bf16 v[120:123], v[248:251], v[44:47], v[120:123]
    ds_read_b64_tr_b16 v[40:41], v5 offset:16384
    v_mfma_f32_16x16x32_bf16 v[124:127], v[252:255], v[44:47], v[124:127]
    ds_read_b64_tr_b16 v[42:43], v5 offset:17408
    s_waitcnt lgkmcnt(10)
    v_mfma_f32_16x16x32_bf16 v[128:131], v[48:51], v[248:251], v[128:131]
    ds_read_b64_tr_b16 v[44:45], v6 offset:16384
    buffer_load_dwordx4 v[216:219], v2, s[4:7], s42 offen offset:2048 sc1
    v_mfma_f32_16x16x32_bf16 v[132:135], v[48:51], v[252:255], v[132:135]
    ds_read_b64_tr_b16 v[46:47], v6 offset:17408
    v_mfma_f32_16x16x32_bf16 v[136:139], v[52:55], v[248:251], v[136:139]
    ds_read_b64_tr_b16 v[48:49], v3 offset:20480
    buffer_load_dwordx4 v[220:223], v2, s[4:7], s42 offen offset:2304 sc1
    v_mfma_f32_16x16x32_bf16 v[140:143], v[52:55], v[252:255], v[140:143]
    ds_read_b64_tr_b16 v[50:51], v3 offset:21504
    s_waitcnt lgkmcnt(10)
    v_mfma_f32_16x16x32_bf16 v[144:147], v[56:59], v[248:251], v[144:147]
    ds_read_b64_tr_b16 v[52:53], v4 offset:20480
    s_add_u32 s42, s41, s94
    buffer_load_dwordx4 v[224:227], v2, s[4:7], s42 offen offset:0 sc1
    v_mfma_f32_16x16x32_bf16 v[148:151], v[56:59], v[252:255], v[148:151]
    ds_read_b64_tr_b16 v[54:55], v4 offset:21504
    v_mfma_f32_16x16x32_bf16 v[152:155], v[60:63], v[248:251], v[152:155]
    ds_read_b64_tr_b16 v[56:57], v5 offset:20480
    buffer_load_dwordx4 v[228:231], v2, s[4:7], s42 offen offset:256 sc1
    v_mfma_f32_16x16x32_bf16 v[156:159], v[60:63], v[252:255], v[156:159]
    ds_read_b64_tr_b16 v[58:59], v5 offset:21504
    s_waitcnt vmcnt(16) lgkmcnt(10)
    v_mfma_f32_16x16x32_bf16 v[64:67], v[32:35], v[160:163], v[64:67]
    ds_read_b64_tr_b16 v[60:61], v6 offset:20480
    buffer_load_dwordx4 v[232:235], v2, s[4:7], s42 offen offset:2048 sc1
    v_mfma_f32_16x16x32_bf16 v[68:71], v[32:35], v[164:167], v[68:71]
    ds_read_b64_tr_b16 v[62:63], v6 offset:21504
    v_mfma_f32_16x16x32_bf16 v[72:75], v[36:39], v[160:163], v[72:75]
    ds_read_b64_tr_b16 v[32:33], v3 offset:24576
    buffer_load_dwordx4 v[236:239], v2, s[4:7], s42 offen offset:2304 sc1
    v_mfma_f32_16x16x32_bf16 v[76:79], v[36:39], v[164:167], v[76:79]
    ds_read_b64_tr_b16 v[34:35], v3 offset:25600
    s_waitcnt lgkmcnt(10)
    v_mfma_f32_16x16x32_bf16 v[80:83], v[40:43], v[160:163], v[80:83]
    ds_read_b64_tr_b16 v[36:37], v4 offset:24576
    v_mfma_f32_16x16x32_bf16 v[84:87], v[40:43], v[164:167], v[84:87]
    ds_read_b64_tr_b16 v[38:39], v4 offset:25600
    v_mfma_f32_16x16x32_bf16 v[88:91], v[44:47], v[160:163], v[88:91]
    ds_read_b64_tr_b16 v[40:41], v5 offset:24576
    v_mfma_f32_16x16x32_bf16 v[92:95], v[44:47], v[164:167], v[92:95]
    ds_read_b64_tr_b16 v[42:43], v5 offset:25600
    s_waitcnt lgkmcnt(10)
    v_mfma_f32_16x16x32_bf16 v[96:99], v[160:163], v[48:51], v[96:99]
    ds_read_b64_tr_b16 v[44:45], v6 offset:24576
    s_add_u32 s42, s41, s95
    buffer_load_dwordx4 v[240:243], v2, s[4:7], s42 offen offset:0 sc1
    v_mfma_f32_16x16x32_bf16 v[100:103], v[164:167], v[48:51], v[100:103]
    ds_read_b64_tr_b16 v[46:47], v6 offset:25600
    v_mfma_f32_16x16x32_bf16 v[104:107], v[160:163], v[52:55], v[104:107]
    ds_read_b64_tr_b16 v[48:49], v3 offset:28672
    v_mfma_f32_16x16x32_bf16 v[108:111], v[164:167], v[52:55], v[108:111]
    ds_read_b64_tr_b16 v[50:51], v3 offset:29696
    s_waitcnt lgkmcnt(10)
    v_mfma_f32_16x16x32_bf16 v[112:115], v[160:163], v[56:59], v[112:115]
    ds_read_b64_tr_b16 v[52:53], v4 offset:28672
    v_mfma_f32_16x16x32_bf16 v[116:119], v[164:167], v[56:59], v[116:119]
    ds_read_b64_tr_b16 v[54:55], v4 offset:29696
    v_mfma_f32_16x16x32_bf16 v[120:123], v[160:163], v[60:63], v[120:123]
    ds_read_b64_tr_b16 v[56:57], v5 offset:28672
    v_mfma_f32_16x16x32_bf16 v[124:127], v[164:167], v[60:63], v[124:127]
    ds_read_b64_tr_b16 v[58:59], v5 offset:29696
    s_waitcnt lgkmcnt(10)
    v_mfma_f32_16x16x32_bf16 v[128:131], v[32:35], v[160:163], v[128:131]
    ds_read_b64_tr_b16 v[60:61], v6 offset:28672
    v_mfma_f32_16x16x32_bf16 v[132:135], v[32:35], v[164:167], v[132:135]
    ds_read_b64_tr_b16 v[62:63], v6 offset:29696
    s_barrier
    v_mfma_f32_16x16x32_bf16 v[136:139], v[36:39], v[160:163], v[136:139]
    ds_read_b64_tr_b16 v[32:33], v3 offset:32768
    v_mfma_f32_16x16x32_bf16 v[140:143], v[36:39], v[164:167], v[140:143]
    ds_read_b64_tr_b16 v[34:35], v3 offset:33792
    s_waitcnt lgkmcnt(10)
    v_mfma_f32_16x16x32_bf16 v[144:147], v[40:43], v[160:163], v[144:147]
    ds_read_b64_tr_b16 v[36:37], v4 offset:32768
    v_mfma_f32_16x16x32_bf16 v[148:151], v[40:43], v[164:167], v[148:151]
    ds_read_b64_tr_b16 v[38:39], v4 offset:33792
    v_mfma_f32_16x16x32_bf16 v[152:155], v[44:47], v[160:163], v[152:155]
    ds_read_b64_tr_b16 v[40:41], v5 offset:32768
    v_mfma_f32_16x16x32_bf16 v[156:159], v[44:47], v[164:167], v[156:159]
    ds_read_b64_tr_b16 v[42:43], v5 offset:33792
    s_waitcnt vmcnt(17) lgkmcnt(10)
    v_mfma_f32_16x16x32_bf16 v[64:67], v[48:51], v[168:171], v[64:67]
    ds_read_b64_tr_b16 v[44:45], v6 offset:32768
    v_mfma_f32_16x16x32_bf16 v[68:71], v[48:51], v[172:175], v[68:71]
    ds_read_b64_tr_b16 v[46:47], v6 offset:33792
    v_mfma_f32_16x16x32_bf16 v[72:75], v[52:55], v[168:171], v[72:75]
    ds_read_b64_tr_b16 v[48:49], v3 offset:36864
    v_mfma_f32_16x16x32_bf16 v[76:79], v[52:55], v[172:175], v[76:79]
    ds_read_b64_tr_b16 v[50:51], v3 offset:37888
    s_waitcnt lgkmcnt(10)
    v_mfma_f32_16x16x32_bf16 v[80:83], v[56:59], v[168:171], v[80:83]
    ds_read_b64_tr_b16 v[52:53], v4 offset:36864
    v_mfma_f32_16x16x32_bf16 v[84:87], v[56:59], v[172:175], v[84:87]
    ds_read_b64_tr_b16 v[54:55], v4 offset:37888
    v_mfma_f32_16x16x32_bf16 v[88:91], v[60:63], v[168:171], v[88:91]
    ds_read_b64_tr_b16 v[56:57], v5 offset:36864
    v_mfma_f32_16x16x32_bf16 v[92:95], v[60:63], v[172:175], v[92:95]
    ds_read_b64_tr_b16 v[58:59], v5 offset:37888
    s_waitcnt lgkmcnt(10)
    v_mfma_f32_16x16x32_bf16 v[96:99], v[168:171], v[32:35], v[96:99]
    ds_read_b64_tr_b16 v[60:61], v6 offset:36864
    v_mfma_f32_16x16x32_bf16 v[100:103], v[172:175], v[32:35], v[100:103]
    ds_read_b64_tr_b16 v[62:63], v6 offset:37888
    v_mfma_f32_16x16x32_bf16 v[104:107], v[168:171], v[36:39], v[104:107]
    ds_read_b64_tr_b16 v[32:33], v3 offset:40960
    v_mfma_f32_16x16x32_bf16 v[108:111], v[172:175], v[36:39], v[108:111]
    ds_read_b64_tr_b16 v[34:35], v3 offset:41984
    s_waitcnt lgkmcnt(10)
    v_mfma_f32_16x16x32_bf16 v[112:115], v[168:171], v[40:43], v[112:115]
    ds_read_b64_tr_b16 v[36:37], v4 offset:40960
    v_mfma_f32_16x16x32_bf16 v[116:119], v[172:175], v[40:43], v[116:119]
    ds_read_b64_tr_b16 v[38:39], v4 offset:41984
    v_mfma_f32_16x16x32_bf16 v[120:123], v[168:171], v[44:47], v[120:123]
    ds_read_b64_tr_b16 v[40:41], v5 offset:40960
    v_mfma_f32_16x16x32_bf16 v[124:127], v[172:175], v[44:47], v[124:127]
    ds_read_b64_tr_b16 v[42:43], v5 offset:41984
    s_waitcnt lgkmcnt(10)
    v_mfma_f32_16x16x32_bf16 v[128:131], v[48:51], v[168:171], v[128:131]
    ds_read_b64_tr_b16 v[44:45], v6 offset:40960
    v_mfma_f32_16x16x32_bf16 v[132:135], v[48:51], v[172:175], v[132:135]
    ds_read_b64_tr_b16 v[46:47], v6 offset:41984
    v_mfma_f32_16x16x32_bf16 v[136:139], v[52:55], v[168:171], v[136:139]
    ds_read_b64_tr_b16 v[48:49], v3 offset:45056
    v_mfma_f32_16x16x32_bf16 v[140:143], v[52:55], v[172:175], v[140:143]
    ds_read_b64_tr_b16 v[50:51], v3 offset:46080
    s_waitcnt lgkmcnt(10)
    v_mfma_f32_16x16x32_bf16 v[144:147], v[56:59], v[168:171], v[144:147]
    ds_read_b64_tr_b16 v[52:53], v4 offset:45056
    v_mfma_f32_16x16x32_bf16 v[148:151], v[56:59], v[172:175], v[148:151]
    ds_read_b64_tr_b16 v[54:55], v4 offset:46080
    v_mfma_f32_16x16x32_bf16 v[152:155], v[60:63], v[168:171], v[152:155]
    ds_read_b64_tr_b16 v[56:57], v5 offset:45056
    v_mfma_f32_16x16x32_bf16 v[156:159], v[60:63], v[172:175], v[156:159]
    ds_read_b64_tr_b16 v[58:59], v5 offset:46080
    s_waitcnt vmcnt(15) lgkmcnt(10)
    v_mfma_f32_16x16x32_bf16 v[64:67], v[32:35], v[176:179], v[64:67]
    ds_read_b64_tr_b16 v[60:61], v6 offset:45056
    v_mfma_f32_16x16x32_bf16 v[68:71], v[32:35], v[180:183], v[68:71]
    ds_read_b64_tr_b16 v[62:63], v6 offset:46080
    v_mfma_f32_16x16x32_bf16 v[72:75], v[36:39], v[176:179], v[72:75]
    ds_read_b64_tr_b16 v[32:33], v3 offset:49152
    v_mfma_f32_16x16x32_bf16 v[76:79], v[36:39], v[180:183], v[76:79]
    ds_read_b64_tr_b16 v[34:35], v3 offset:50176
    s_waitcnt lgkmcnt(10)
    v_mfma_f32_16x16x32_bf16 v[80:83], v[40:43], v[176:179], v[80:83]
    ds_read_b64_tr_b16 v[36:37], v4 offset:49152
    v_mfma_f32_16x16x32_bf16 v[84:87], v[40:43], v[180:183], v[84:87]
    ds_read_b64_tr_b16 v[38:39], v4 offset:50176
    v_mfma_f32_16x16x32_bf16 v[88:91], v[44:47], v[176:179], v[88:91]
    ds_read_b64_tr_b16 v[40:41], v5 offset:49152
    v_mfma_f32_16x16x32_bf16 v[92:95], v[44:47], v[180:183], v[92:95]
    ds_read_b64_tr_b16 v[42:43], v5 offset:50176
    s_waitcnt lgkmcnt(10)
    v_mfma_f32_16x16x32_bf16 v[96:99], v[176:179], v[48:51], v[96:99]
    ds_read_b64_tr_b16 v[44:45], v6 offset:49152
    buffer_load_dwordx4 v[244:247], v2, s[4:7], s42 offen offset:256 sc1
    v_mfma_f32_16x16x32_bf16 v[100:103], v[180:183], v[48:51], v[100:103]
    ds_read_b64_tr_b16 v[46:47], v6 offset:50176
    v_mfma_f32_16x16x32_bf16 v[104:107], v[176:179], v[52:55], v[104:107]
    ds_read_b64_tr_b16 v[48:49], v3 offset:53248
    buffer_load_dwordx4 v[248:251], v2, s[4:7], s42 offen offset:2048 sc1
    v_mfma_f32_16x16x32_bf16 v[108:111], v[180:183], v[52:55], v[108:111]
    ds_read_b64_tr_b16 v[50:51], v3 offset:54272
    s_waitcnt lgkmcnt(10)
    v_mfma_f32_16x16x32_bf16 v[112:115], v[176:179], v[56:59], v[112:115]
    ds_read_b64_tr_b16 v[52:53], v4 offset:53248
    buffer_load_dwordx4 v[252:255], v2, s[4:7], s42 offen offset:2304 sc1
    v_mfma_f32_16x16x32_bf16 v[116:119], v[180:183], v[56:59], v[116:119]
    ds_read_b64_tr_b16 v[54:55], v4 offset:54272
    v_mfma_f32_16x16x32_bf16 v[120:123], v[176:179], v[60:63], v[120:123]
    ds_read_b64_tr_b16 v[56:57], v5 offset:53248
    s_add_u32 s42, s41, s96
    buffer_load_dwordx4 v[160:163], v2, s[4:7], s42 offen offset:0 sc1
    v_mfma_f32_16x16x32_bf16 v[124:127], v[180:183], v[60:63], v[124:127]
    ds_read_b64_tr_b16 v[58:59], v5 offset:54272
    s_waitcnt lgkmcnt(10)
    v_mfma_f32_16x16x32_bf16 v[128:131], v[32:35], v[176:179], v[128:131]
    ds_read_b64_tr_b16 v[60:61], v6 offset:53248
    buffer_load_dwordx4 v[164:167], v2, s[4:7], s42 offen offset:256 sc1
    v_mfma_f32_16x16x32_bf16 v[132:135], v[32:35], v[180:183], v[132:135]
    ds_read_b64_tr_b16 v[62:63], v6 offset:54272
    v_mfma_f32_16x16x32_bf16 v[136:139], v[36:39], v[176:179], v[136:139]
    ds_read_b64_tr_b16 v[32:33], v3 offset:57344
    buffer_load_dwordx4 v[168:171], v2, s[4:7], s42 offen offset:2048 sc1
    v_mfma_f32_16x16x32_bf16 v[140:143], v[36:39], v[180:183], v[140:143]
    ds_read_b64_tr_b16 v[34:35], v3 offset:58368
    s_waitcnt lgkmcnt(10)
    v_mfma_f32_16x16x32_bf16 v[144:147], v[40:43], v[176:179], v[144:147]
    ds_read_b64_tr_b16 v[36:37], v4 offset:57344
    v_mfma_f32_16x16x32_bf16 v[148:151], v[40:43], v[180:183], v[148:151]
    ds_read_b64_tr_b16 v[38:39], v4 offset:58368
    v_mfma_f32_16x16x32_bf16 v[152:155], v[44:47], v[176:179], v[152:155]
    ds_read_b64_tr_b16 v[40:41], v5 offset:57344
    v_mfma_f32_16x16x32_bf16 v[156:159], v[44:47], v[180:183], v[156:159]
    ds_read_b64_tr_b16 v[42:43], v5 offset:58368
    s_waitcnt vmcnt(19) lgkmcnt(10)
    v_mfma_f32_16x16x32_bf16 v[64:67], v[48:51], v[184:187], v[64:67]
    ds_read_b64_tr_b16 v[44:45], v6 offset:57344
    v_mfma_f32_16x16x32_bf16 v[68:71], v[48:51], v[188:191], v[68:71]
    ds_read_b64_tr_b16 v[46:47], v6 offset:58368
    v_mfma_f32_16x16x32_bf16 v[72:75], v[52:55], v[184:187], v[72:75]
    ds_read_b64_tr_b16 v[48:49], v3 offset:61440
    v_mfma_f32_16x16x32_bf16 v[76:79], v[52:55], v[188:191], v[76:79]
    ds_read_b64_tr_b16 v[50:51], v3 offset:62464
    s_waitcnt lgkmcnt(10)
    v_mfma_f32_16x16x32_bf16 v[80:83], v[56:59], v[184:187], v[80:83]
    ds_read_b64_tr_b16 v[52:53], v4 offset:61440
    buffer_load_dwordx4 v[172:175], v2, s[4:7], s42 offen offset:2304 sc1
    v_mfma_f32_16x16x32_bf16 v[84:87], v[56:59], v[188:191], v[84:87]
    ds_read_b64_tr_b16 v[54:55], v4 offset:62464
    v_mfma_f32_16x16x32_bf16 v[88:91], v[60:63], v[184:187], v[88:91]
    ds_read_b64_tr_b16 v[56:57], v5 offset:61440
    v_mfma_f32_16x16x32_bf16 v[92:95], v[60:63], v[188:191], v[92:95]
    ds_read_b64_tr_b16 v[58:59], v5 offset:62464
    s_waitcnt lgkmcnt(10)
    v_mfma_f32_16x16x32_bf16 v[96:99], v[184:187], v[32:35], v[96:99]
    ds_read_b64_tr_b16 v[60:61], v6 offset:61440
    v_mfma_f32_16x16x32_bf16 v[100:103], v[188:191], v[32:35], v[100:103]
    ds_read_b64_tr_b16 v[62:63], v6 offset:62464
    s_barrier
    v_xor_b32 v3, 0x10000, v3
    v_xor_b32 v4, 0x10000, v4
    v_xor_b32 v5, 0x10000, v5
    v_xor_b32 v6, 0x10000, v6
    v_mfma_f32_16x16x32_bf16 v[104:107], v[184:187], v[36:39], v[104:107]
    ds_read_b64_tr_b16 v[32:33], v3 offset:0
    v_mfma_f32_16x16x32_bf16 v[108:111], v[188:191], v[36:39], v[108:111]
    ds_read_b64_tr_b16 v[34:35], v3 offset:1024
    s_waitcnt lgkmcnt(10)
    v_mfma_f32_16x16x32_bf16 v[112:115], v[184:187], v[40:43], v[112:115]
    ds_read_b64_tr_b16 v[36:37], v4 offset:0
    v_mfma_f32_16x16x32_bf16 v[116:119], v[188:191], v[40:43], v[116:119]
    ds_read_b64_tr_b16 v[38:39], v4 offset:1024
    v_mfma_f32_16x16x32_bf16 v[120:123], v[184:187], v[44:47], v[120:123]
    ds_read_b64_tr_b16 v[40:41], v5 offset:0
    v_mfma_f32_16x16x32_bf16 v[124:127], v[188:191], v[44:47], v[124:127]
    ds_read_b64_tr_b16 v[42:43], v5 offset:1024
    s_waitcnt lgkmcnt(10)
    v_mfma_f32_16x16x32_bf16 v[128:131], v[48:51], v[184:187], v[128:131]
    ds_read_b64_tr_b16 v[44:45], v6 offset:0
    v_mfma_f32_16x16x32_bf16 v[132:135], v[48:51], v[188:191], v[132:135]
    ds_read_b64_tr_b16 v[46:47], v6 offset:1024
    v_mfma_f32_16x16x32_bf16 v[136:139], v[52:55], v[184:187], v[136:139]
    ds_read_b64_tr_b16 v[48:49], v3 offset:4096
    v_mfma_f32_16x16x32_bf16 v[140:143], v[52:55], v[188:191], v[140:143]
    ds_read_b64_tr_b16 v[50:51], v3 offset:5120
    s_waitcnt lgkmcnt(10)
    v_mfma_f32_16x16x32_bf16 v[144:147], v[56:59], v[184:187], v[144:147]
    ds_read_b64_tr_b16 v[52:53], v4 offset:4096
    v_mfma_f32_16x16x32_bf16 v[148:151], v[56:59], v[188:191], v[148:151]
    ds_read_b64_tr_b16 v[54:55], v4 offset:5120
    v_mfma_f32_16x16x32_bf16 v[152:155], v[60:63], v[184:187], v[152:155]
    ds_read_b64_tr_b16 v[56:57], v5 offset:4096
    v_mfma_f32_16x16x32_bf16 v[156:159], v[60:63], v[188:191], v[156:159]
    ds_read_b64_tr_b16 v[58:59], v5 offset:5120
    s_waitcnt vmcnt(18) lgkmcnt(10)
    v_mfma_f32_16x16x32_bf16 v[64:67], v[32:35], v[192:195], v[64:67]
    ds_read_b64_tr_b16 v[60:61], v6 offset:4096
    v_mfma_f32_16x16x32_bf16 v[68:71], v[32:35], v[196:199], v[68:71]
    ds_read_b64_tr_b16 v[62:63], v6 offset:5120
    v_mfma_f32_16x16x32_bf16 v[72:75], v[36:39], v[192:195], v[72:75]
    ds_read_b64_tr_b16 v[32:33], v3 offset:8192
    v_mfma_f32_16x16x32_bf16 v[76:79], v[36:39], v[196:199], v[76:79]
    ds_read_b64_tr_b16 v[34:35], v3 offset:9216
    s_waitcnt lgkmcnt(10)
    v_mfma_f32_16x16x32_bf16 v[80:83], v[40:43], v[192:195], v[80:83]
    ds_read_b64_tr_b16 v[36:37], v4 offset:8192
    v_mfma_f32_16x16x32_bf16 v[84:87], v[40:43], v[196:199], v[84:87]
    ds_read_b64_tr_b16 v[38:39], v4 offset:9216
    v_mfma_f32_16x16x32_bf16 v[88:91], v[44:47], v[192:195], v[88:91]
    ds_read_b64_tr_b16 v[40:41], v5 offset:8192
    v_mfma_f32_16x16x32_bf16 v[92:95], v[44:47], v[196:199], v[92:95]
    ds_read_b64_tr_b16 v[42:43], v5 offset:9216
    s_waitcnt lgkmcnt(10)
    v_mfma_f32_16x16x32_bf16 v[96:99], v[192:195], v[48:51], v[96:99]
    ds_read_b64_tr_b16 v[44:45], v6 offset:8192
    v_mfma_f32_16x16x32_bf16 v[100:103], v[196:199], v[48:51], v[100:103]
    ds_read_b64_tr_b16 v[46:47], v6 offset:9216
    v_mfma_f32_16x16x32_bf16 v[104:107], v[192:195], v[52:55], v[104:107]
    ds_read_b64_tr_b16 v[48:49], v3 offset:12288
    v_mfma_f32_16x16x32_bf16 v[108:111], v[196:199], v[52:55], v[108:111]
    ds_read_b64_tr_b16 v[50:51], v3 offset:13312
    s_waitcnt lgkmcnt(10)
    v_mfma_f32_16x16x32_bf16 v[112:115], v[192:195], v[56:59], v[112:115]
    ds_read_b64_tr_b16 v[52:53], v4 offset:12288
    v_mfma_f32_16x16x32_bf16 v[116:119], v[196:199], v[56:59], v[116:119]
    ds_read_b64_tr_b16 v[54:55], v4 offset:13312
    v_mfma_f32_16x16x32_bf16 v[120:123], v[192:195], v[60:63], v[120:123]
    ds_read_b64_tr_b16 v[56:57], v5 offset:12288
    v_mfma_f32_16x16x32_bf16 v[124:127], v[196:199], v[60:63], v[124:127]
    ds_read_b64_tr_b16 v[58:59], v5 offset:13312
    s_waitcnt lgkmcnt(10)
    v_mfma_f32_16x16x32_bf16 v[128:131], v[32:35], v[192:195], v[128:131]
    ds_read_b64_tr_b16 v[60:61], v6 offset:12288
    v_mfma_f32_16x16x32_bf16 v[132:135], v[32:35], v[196:199], v[132:135]
    ds_read_b64_tr_b16 v[62:63], v6 offset:13312
    v_mfma_f32_16x16x32_bf16 v[136:139], v[36:39], v[192:195], v[136:139]
    ds_read_b64_tr_b16 v[32:33], v3 offset:16384
    v_mfma_f32_16x16x32_bf16 v[140:143], v[36:39], v[196:199], v[140:143]
    ds_read_b64_tr_b16 v[34:35], v3 offset:17408
    s_waitcnt lgkmcnt(10)
    v_mfma_f32_16x16x32_bf16 v[144:147], v[40:43], v[192:195], v[144:147]
    ds_read_b64_tr_b16 v[36:37], v4 offset:16384
    v_mfma_f32_16x16x32_bf16 v[148:151], v[40:43], v[196:199], v[148:151]
    ds_read_b64_tr_b16 v[38:39], v4 offset:17408
    v_mfma_f32_16x16x32_bf16 v[152:155], v[44:47], v[192:195], v[152:155]
    ds_read_b64_tr_b16 v[40:41], v5 offset:16384
    v_mfma_f32_16x16x32_bf16 v[156:159], v[44:47], v[196:199], v[156:159]
    ds_read_b64_tr_b16 v[42:43], v5 offset:17408
    s_waitcnt vmcnt(16) lgkmcnt(10)
    v_mfma_f32_16x16x32_bf16 v[64:67], v[48:51], v[200:203], v[64:67]
    ds_read_b64_tr_b16 v[44:45], v6 offset:16384
    s_add_u32 s42, s41, s97
    buffer_load_dwordx4 v[176:179], v2, s[4:7], s42 offen offset:0 sc1
    v_mfma_f32_16x16x32_bf16 v[68:71], v[48:51], v[204:207], v[68:71]
    ds_read_b64_tr_b16 v[46:47], v6 offset:17408
    v_mfma_f32_16x16x32_bf16 v[72:75], v[52:55], v[200:203], v[72:75]
    ds_read_b64_tr_b16 v[48:49], v3 offset:20480
    buffer_load_dwordx4 v[180:183], v2, s[4:7], s42 offen offset:256 sc1
    v_mfma_f32_16x16x32_bf16 v[76:79], v[52:55], v[204:207], v[76:79]
    ds_read_b64_tr_b16 v[50:51], v3 offset:21504
    s_waitcnt lgkmcnt(10)
    v_mfma_f32_16x16x32_bf16 v[80:83], v[56:59], v[200:203], v[80:83]
    ds_read_b64_tr_b16 v[52:53], v4 offset:20480
    buffer_load_dwordx4 v[184:187], v2, s[4:7], s42 offen offset:2048 sc1
    v_mfma_f32_16x16x32_bf16 v[84:87], v[56:59], v[204:207], v[84:87]
    ds_read_b64_tr_b16 v[54:55], v4 offset:21504
    v_mfma_f32_16x16x32_bf16 v[88:91], v[60:63], v[200:203], v[88:91]
    ds_read_b64_tr_b16 v[56:57], v5 offset:20480
    buffer_load_dwordx4 v[188:191], v2, s[4:7], s42 offen offset:2304 sc1
    v_mfma_f32_16x16x32_bf16 v[92:95], v[60:63], v[204:207], v[92:95]
    ds_read_b64_tr_b16 v[58:59], v5 offset:21504
    s_waitcnt lgkmcnt(10)
    v_mfma_f32_16x16x32_bf16 v[96:99], v[200:203], v[32:35], v[96:99]
    ds_read_b64_tr_b16 v[60:61], v6 offset:20480
    s_add_u32 s42, s41, s98
    buffer_load_dwordx4 v[192:195], v2, s[4:7], s42 offen offset:0 sc1
    v_mfma_f32_16x16x32_bf16 v[100:103], v[204:207], v[32:35], v[100:103]
    ds_read_b64_tr_b16 v[62:63], v6 offset:21504
    v_mfma_f32_16x16x32_bf16 v[104:107], v[200:203], v[36:39], v[104:107]
    ds_read_b64_tr_b16 v[32:33], v3 offset:24576
    v_mfma_f32_16x16x32_bf16 v[108:111], v[204:207], v[36:39], v[108:111]
    ds_read_b64_tr_b16 v[34:35], v3 offset:25600
    s_waitcnt lgkmcnt(10)
    v_mfma_f32_16x16x32_bf16 v[112:115], v[200:203], v[40:43], v[112:115]
    ds_read_b64_tr_b16 v[36:37], v4 offset:24576
    v_mfma_f32_16x16x32_bf16 v[116:119], v[204:207], v[40:43], v[116:119]
    ds_read_b64_tr_b16 v[38:39], v4 offset:25600
    v_mfma_f32_16x16x32_bf16 v[120:123], v[200:203], v[44:47], v[120:123]
    ds_read_b64_tr_b16 v[40:41], v5 offset:24576
    buffer_load_dwordx4 v[196:199], v2, s[4:7], s42 offen offset:256 sc1
    v_mfma_f32_16x16x32_bf16 v[124:127], v[204:207], v[44:47], v[124:127]
    ds_read_b64_tr_b16 v[42:43], v5 offset:25600
    s_waitcnt lgkmcnt(10)
    v_mfma_f32_16x16x32_bf16 v[128:131], v[48:51], v[200:203], v[128:131]
    ds_read_b64_tr_b16 v[44:45], v6 offset:24576
    v_mfma_f32_16x16x32_bf16 v[132:135], v[48:51], v[204:207], v[132:135]
    ds_read_b64_tr_b16 v[46:47], v6 offset:25600
    v_mfma_f32_16x16x32_bf16 v[136:139], v[52:55], v[200:203], v[136:139]
    ds_read_b64_tr_b16 v[48:49], v3 offset:28672
    v_mfma_f32_16x16x32_bf16 v[140:143], v[52:55], v[204:207], v[140:143]
    ds_read_b64_tr_b16 v[50:51], v3 offset:29696
    s_waitcnt lgkmcnt(10)
    v_mfma_f32_16x16x32_bf16 v[144:147], v[56:59], v[200:203], v[144:147]
    ds_read_b64_tr_b16 v[52:53], v4 offset:28672
    v_mfma_f32_16x16x32_bf16 v[148:151], v[56:59], v[204:207], v[148:151]
    ds_read_b64_tr_b16 v[54:55], v4 offset:29696
    v_mfma_f32_16x16x32_bf16 v[152:155], v[60:63], v[200:203], v[152:155]
    ds_read_b64_tr_b16 v[56:57], v5 offset:28672
    v_mfma_f32_16x16x32_bf16 v[156:159], v[60:63], v[204:207], v[156:159]
    ds_read_b64_tr_b16 v[58:59], v5 offset:29696
    s_waitcnt vmcnt(20) lgkmcnt(10)
    v_mfma_f32_16x16x32_bf16 v[64:67], v[32:35], v[208:211], v[64:67]
    ds_read_b64_tr_b16 v[60:61], v6 offset:28672
    v_mfma_f32_16x16x32_bf16 v[68:71], v[32:35], v[212:215], v[68:71]
    ds_read_b64_tr_b16 v[62:63], v6 offset:29696
    s_barrier
    v_mfma_f32_16x16x32_bf16 v[72:75], v[36:39], v[208:211], v[72:75]
    ds_read_b64_tr_b16 v[32:33], v3 offset:32768
    v_mfma_f32_16x16x32_bf16 v[76:79], v[36:39], v[212:215], v[76:79]
    ds_read_b64_tr_b16 v[34:35], v3 offset:33792
    s_waitcnt lgkmcnt(10)
    v_mfma_f32_16x16x32_bf16 v[80:83], v[40:43], v[208:211], v[80:83]
    ds_read_b64_tr_b16 v[36:37], v4 offset:32768
    v_mfma_f32_16x16x32_bf16 v[84:87], v[40:43], v[212:215], v[84:87]
    ds_read_b64_tr_b16 v[38:39], v4 offset:33792
    v_mfma_f32_16x16x32_bf16 v[88:91], v[44:47], v[208:211], v[88:91]
    ds_read_b64_tr_b16 v[40:41], v5 offset:32768
    v_mfma_f32_16x16x32_bf16 v[92:95], v[44:47], v[212:215], v[92:95]
    ds_read_b64_tr_b16 v[42:43], v5 offset:33792
    s_waitcnt lgkmcnt(10)
    v_mfma_f32_16x16x32_bf16 v[96:99], v[208:211], v[48:51], v[96:99]
    ds_read_b64_tr_b16 v[44:45], v6 offset:32768
    v_mfma_f32_16x16x32_bf16 v[100:103], v[212:215], v[48:51], v[100:103]
    ds_read_b64_tr_b16 v[46:47], v6 offset:33792
    v_mfma_f32_16x16x32_bf16 v[104:107], v[208:211], v[52:55], v[104:107]
    ds_read_b64_tr_b16 v[48:49], v3 offset:36864
    v_mfma_f32_16x16x32_bf16 v[108:111], v[212:215], v[52:55], v[108:111]
    ds_read_b64_tr_b16 v[50:51], v3 offset:37888
    s_waitcnt lgkmcnt(10)
    v_mfma_f32_16x16x32_bf16 v[112:115], v[208:211], v[56:59], v[112:115]
    ds_read_b64_tr_b16 v[52:53], v4 offset:36864
    v_mfma_f32_16x16x32_bf16 v[116:119], v[212:215], v[56:59], v[116:119]
    ds_read_b64_tr_b16 v[54:55], v4 offset:37888
    v_mfma_f32_16x16x32_bf16 v[120:123], v[208:211], v[60:63], v[120:123]
    ds_read_b64_tr_b16 v[56:57], v5 offset:36864
    v_mfma_f32_16x16x32_bf16 v[124:127], v[212:215], v[60:63], v[124:127]
    ds_read_b64_tr_b16 v[58:59], v5 offset:37888
    s_waitcnt lgkmcnt(10)
    v_mfma_f32_16x16x32_bf16 v[128:131], v[32:35], v[208:211], v[128:131]
    ds_read_b64_tr_b16 v[60:61], v6 offset:36864
    v_mfma_f32_16x16x32_bf16 v[132:135], v[32:35], v[212:215], v[132:135]
    ds_read_b64_tr_b16 v[62:63], v6 offset:37888
    v_mfma_f32_16x16x32_bf16 v[136:139], v[36:39], v[208:211], v[136:139]
    ds_read_b64_tr_b16 v[32:33], v3 offset:40960
    v_mfma_f32_16x16x32_bf16 v[140:143], v[36:39], v[212:215], v[140:143]
    ds_read_b64_tr_b16 v[34:35], v3 offset:41984
    s_waitcnt lgkmcnt(10)
    v_mfma_f32_16x16x32_bf16 v[144:147], v[40:43], v[208:211], v[144:147]
    ds_read_b64_tr_b16 v[36:37], v4 offset:40960
    v_mfma_f32_16x16x32_bf16 v[148:151], v[40:43], v[212:215], v[148:151]
    ds_read_b64_tr_b16 v[38:39], v4 offset:41984
    v_mfma_f32_16x16x32_bf16 v[152:155], v[44:47], v[208:211], v[152:155]
    ds_read_b64_tr_b16 v[40:41], v5 offset:40960
    v_mfma_f32_16x16x32_bf16 v[156:159], v[44:47], v[212:215], v[156:159]
    ds_read_b64_tr_b16 v[42:43], v5 offset:41984
    s_waitcnt vmcnt(18) lgkmcnt(10)
    v_mfma_f32_16x16x32_bf16 v[64:67], v[48:51], v[216:219], v[64:67]
    ds_read_b64_tr_b16 v[44:45], v6 offset:40960
    v_mfma_f32_16x16x32_bf16 v[68:71], v[48:51], v[220:223], v[68:71]
    ds_read_b64_tr_b16 v[46:47], v6 offset:41984
    v_mfma_f32_16x16x32_bf16 v[72:75], v[52:55], v[216:219], v[72:75]
    ds_read_b64_tr_b16 v[48:49], v3 offset:45056
    v_mfma_f32_16x16x32_bf16 v[76:79], v[52:55], v[220:223], v[76:79]
    ds_read_b64_tr_b16 v[50:51], v3 offset:46080
    s_waitcnt lgkmcnt(10)
    v_mfma_f32_16x16x32_bf16 v[80:83], v[56:59], v[216:219], v[80:83]
    ds_read_b64_tr_b16 v[52:53], v4 offset:45056
    v_mfma_f32_16x16x32_bf16 v[84:87], v[56:59], v[220:223], v[84:87]
    ds_read_b64_tr_b16 v[54:55], v4 offset:46080
    v_mfma_f32_16x16x32_bf16 v[88:91], v[60:63], v[216:219], v[88:91]
    ds_read_b64_tr_b16 v[56:57], v5 offset:45056
    v_mfma_f32_16x16x32_bf16 v[92:95], v[60:63], v[220:223], v[92:95]
    ds_read_b64_tr_b16 v[58:59], v5 offset:46080
    s_waitcnt lgkmcnt(10)
    v_mfma_f32_16x16x32_bf16 v[96:99], v[216:219], v[32:35], v[96:99]
    ds_read_b64_tr_b16 v[60:61], v6 offset:45056
    v_mfma_f32_16x16x32_bf16 v[100:103], v[220:223], v[32:35], v[100:103]
    ds_read_b64_tr_b16 v[62:63], v6 offset:46080
    v_mfma_f32_16x16x32_bf16 v[104:107], v[216:219], v[36:39], v[104:107]
    ds_read_b64_tr_b16 v[32:33], v3 offset:49152
    v_mfma_f32_16x16x32_bf16 v[108:111], v[220:223], v[36:39], v[108:111]
    ds_read_b64_tr_b16 v[34:35], v3 offset:50176
    s_waitcnt lgkmcnt(10)
    v_mfma_f32_16x16x32_bf16 v[112:115], v[216:219], v[40:43], v[112:115]
    ds_read_b64_tr_b16 v[36:37], v4 offset:49152
    v_mfma_f32_16x16x32_bf16 v[116:119], v[220:223], v[40:43], v[116:119]
    ds_read_b64_tr_b16 v[38:39], v4 offset:50176
    v_mfma_f32_16x16x32_bf16 v[120:123], v[216:219], v[44:47], v[120:123]
    ds_read_b64_tr_b16 v[40:41], v5 offset:49152
    v_mfma_f32_16x16x32_bf16 v[124:127], v[220:223], v[44:47], v[124:127]
    ds_read_b64_tr_b16 v[42:43], v5 offset:50176
    s_waitcnt lgkmcnt(10)
    v_mfma_f32_16x16x32_bf16 v[128:131], v[48:51], v[216:219], v[128:131]
    ds_read_b64_tr_b16 v[44:45], v6 offset:49152
    buffer_load_dwordx4 v[200:203], v2, s[4:7], s42 offen offset:2048 sc1
    v_mfma_f32_16x16x32_bf16 v[132:135], v[48:51], v[220:223], v[132:135]
    ds_read_b64_tr_b16 v[46:47], v6 offset:50176
    v_mfma_f32_16x16x32_bf16 v[136:139], v[52:55], v[216:219], v[136:139]
    ds_read_b64_tr_b16 v[48:49], v3 offset:53248
    buffer_load_dwordx4 v[204:207], v2, s[4:7], s42 offen offset:2304 sc1
    v_mfma_f32_16x16x32_bf16 v[140:143], v[52:55], v[220:223], v[140:143]
    ds_read_b64_tr_b16 v[50:51], v3 offset:54272
    s_waitcnt lgkmcnt(10)
    v_mfma_f32_16x16x32_bf16 v[144:147], v[56:59], v[216:219], v[144:147]
    ds_read_b64_tr_b16 v[52:53], v4 offset:53248
    s_add_u32 s42, s41, s99
    buffer_load_dwordx4 v[208:211], v2, s[4:7], s42 offen offset:0 sc1
    v_mfma_f32_16x16x32_bf16 v[148:151], v[56:59], v[220:223], v[148:151]
    ds_read_b64_tr_b16 v[54:55], v4 offset:54272
    v_mfma_f32_16x16x32_bf16 v[152:155], v[60:63], v[216:219], v[152:155]
    ds_read_b64_tr_b16 v[56:57], v5 offset:53248
    buffer_load_dwordx4 v[212:215], v2, s[4:7], s42 offen offset:256 sc1
    v_mfma_f32_16x16x32_bf16 v[156:159], v[60:63], v[220:223], v[156:159]
    ds_read_b64_tr_b16 v[58:59], v5 offset:54272
    s_waitcnt vmcnt(20) lgkmcnt(10)
    v_mfma_f32_16x16x32_bf16 v[64:67], v[32:35], v[224:227], v[64:67]
    ds_read_b64_tr_b16 v[60:61], v6 offset:53248
    buffer_load_dwordx4 v[216:219], v2, s[4:7], s42 offen offset:2048 sc1
    v_mfma_f32_16x16x32_bf16 v[68:71], v[32:35], v[228:231], v[68:71]
    ds_read_b64_tr_b16 v[62:63], v6 offset:54272
    v_mfma_f32_16x16x32_bf16 v[72:75], v[36:39], v[224:227], v[72:75]
    ds_read_b64_tr_b16 v[32:33], v3 offset:57344
    buffer_load_dwordx4 v[220:223], v2, s[4:7], s42 offen offset:2304 sc1
    v_mfma_f32_16x16x32_bf16 v[76:79], v[36:39], v[228:231], v[76:79]
    ds_read_b64_tr_b16 v[34:35], v3 offset:58368
    s_waitcnt lgkmcnt(10)
    v_mfma_f32_16x16x32_bf16 v[80:83], v[40:43], v[224:227], v[80:83]
    ds_read_b64_tr_b16 v[36:37], v4 offset:57344
    v_mfma_f32_16x16x32_bf16 v[84:87], v[40:43], v[228:231], v[84:87]
    ds_read_b64_tr_b16 v[38:39], v4 offset:58368
    v_mfma_f32_16x16x32_bf16 v[88:91], v[44:47], v[224:227], v[88:91]
    ds_read_b64_tr_b16 v[40:41], v5 offset:57344
    v_mfma_f32_16x16x32_bf16 v[92:95], v[44:47], v[228:231], v[92:95]
    ds_read_b64_tr_b16 v[42:43], v5 offset:58368
    s_waitcnt lgkmcnt(10)
    v_mfma_f32_16x16x32_bf16 v[96:99], v[224:227], v[48:51], v[96:99]
    ds_read_b64_tr_b16 v[44:45], v6 offset:57344
    v_mfma_f32_16x16x32_bf16 v[100:103], v[228:231], v[48:51], v[100:103]
    ds_read_b64_tr_b16 v[46:47], v6 offset:58368
    v_mfma_f32_16x16x32_bf16 v[104:107], v[224:227], v[52:55], v[104:107]
    ds_read_b64_tr_b16 v[48:49], v3 offset:61440
    v_mfma_f32_16x16x32_bf16 v[108:111], v[228:231], v[52:55], v[108:111]
    ds_read_b64_tr_b16 v[50:51], v3 offset:62464
    s_waitcnt lgkmcnt(10)
    v_mfma_f32_16x16x32_bf16 v[112:115], v[224:227], v[56:59], v[112:115]
    ds_read_b64_tr_b16 v[52:53], v4 offset:61440
    v_mfma_f32_16x16x32_bf16 v[116:119], v[228:231], v[56:59], v[116:119]
    ds_read_b64_tr_b16 v[54:55], v4 offset:62464
    v_mfma_f32_16x16x32_bf16 v[120:123], v[224:227], v[60:63], v[120:123]
    ds_read_b64_tr_b16 v[56:57], v5 offset:61440
    v_mfma_f32_16x16x32_bf16 v[124:127], v[228:231], v[60:63], v[124:127]
    ds_read_b64_tr_b16 v[58:59], v5 offset:62464
    s_waitcnt vmcnt(20) lgkmcnt(10)
    v_mfma_f32_16x16x32_bf16 v[64:67], v[32:35], v[232:235], v[64:67]
    ds_read_b64_tr_b16 v[60:61], v6 offset:61440
    v_mfma_f32_16x16x32_bf16 v[68:71], v[32:35], v[236:239], v[68:71]
    ds_read_b64_tr_b16 v[62:63], v6 offset:62464
    s_barrier
    v_xor_b32 v3, 0x10000, v3
    v_xor_b32 v4, 0x10000, v4
    v_xor_b32 v5, 0x10000, v5
    v_xor_b32 v6, 0x10000, v6
    v_mfma_f32_16x16x32_bf16 v[72:75], v[36:39], v[232:235], v[72:75]
    ds_read_b64_tr_b16 v[32:33], v3 offset:0
    v_mfma_f32_16x16x32_bf16 v[76:79], v[36:39], v[236:239], v[76:79]
    ds_read_b64_tr_b16 v[34:35], v3 offset:1024
    s_waitcnt lgkmcnt(10)
    v_mfma_f32_16x16x32_bf16 v[80:83], v[40:43], v[232:235], v[80:83]
    ds_read_b64_tr_b16 v[36:37], v4 offset:0
    v_mfma_f32_16x16x32_bf16 v[84:87], v[40:43], v[236:239], v[84:87]
    ds_read_b64_tr_b16 v[38:39], v4 offset:1024
    v_mfma_f32_16x16x32_bf16 v[88:91], v[44:47], v[232:235], v[88:91]
    ds_read_b64_tr_b16 v[40:41], v5 offset:0
    v_mfma_f32_16x16x32_bf16 v[92:95], v[44:47], v[236:239], v[92:95]
    ds_read_b64_tr_b16 v[42:43], v5 offset:1024
    s_waitcnt lgkmcnt(10)
    v_mfma_f32_16x16x32_bf16 v[96:99], v[232:235], v[48:51], v[96:99]
    ds_read_b64_tr_b16 v[44:45], v6 offset:0
    v_mfma_f32_16x16x32_bf16 v[100:103], v[236:239], v[48:51], v[100:103]
    ds_read_b64_tr_b16 v[46:47], v6 offset:1024
    v_mfma_f32_16x16x32_bf16 v[104:107], v[232:235], v[52:55], v[104:107]
    ds_read_b64_tr_b16 v[48:49], v3 offset:4096
    v_mfma_f32_16x16x32_bf16 v[108:111], v[236:239], v[52:55], v[108:111]
    ds_read_b64_tr_b16 v[50:51], v3 offset:5120
    s_waitcnt lgkmcnt(10)
    v_mfma_f32_16x16x32_bf16 v[112:115], v[232:235], v[56:59], v[112:115]
    ds_read_b64_tr_b16 v[52:53], v4 offset:4096
    v_mfma_f32_16x16x32_bf16 v[116:119], v[236:239], v[56:59], v[116:119]
    ds_read_b64_tr_b16 v[54:55], v4 offset:5120
    v_mfma_f32_16x16x32_bf16 v[120:123], v[232:235], v[60:63], v[120:123]
    ds_read_b64_tr_b16 v[56:57], v5 offset:4096
    v_mfma_f32_16x16x32_bf16 v[124:127], v[236:239], v[60:63], v[124:127]
    ds_read_b64_tr_b16 v[58:59], v5 offset:5120
    s_waitcnt vmcnt(18) lgkmcnt(10)
    v_mfma_f32_16x16x32_bf16 v[64:67], v[32:35], v[240:243], v[64:67]
    ds_read_b64_tr_b16 v[60:61], v6 offset:4096
    v_mfma_f32_16x16x32_bf16 v[68:71], v[32:35], v[244:247], v[68:71]
    ds_read_b64_tr_b16 v[62:63], v6 offset:5120
    v_mfma_f32_16x16x32_bf16 v[72:75], v[36:39], v[240:243], v[72:75]
    ds_read_b64_tr_b16 v[32:33], v3 offset:8192
    v_mfma_f32_16x16x32_bf16 v[76:79], v[36:39], v[244:247], v[76:79]
    ds_read_b64_tr_b16 v[34:35], v3 offset:9216
    s_waitcnt lgkmcnt(10)
    v_mfma_f32_16x16x32_bf16 v[80:83], v[40:43], v[240:243], v[80:83]
    ds_read_b64_tr_b16 v[36:37], v4 offset:8192
    v_mfma_f32_16x16x32_bf16 v[84:87], v[40:43], v[244:247], v[84:87]
    ds_read_b64_tr_b16 v[38:39], v4 offset:9216
    v_mfma_f32_16x16x32_bf16 v[88:91], v[44:47], v[240:243], v[88:91]
    ds_read_b64_tr_b16 v[40:41], v5 offset:8192
    v_mfma_f32_16x16x32_bf16 v[92:95], v[44:47], v[244:247], v[92:95]
    ds_read_b64_tr_b16 v[42:43], v5 offset:9216
    s_waitcnt lgkmcnt(10)
    v_mfma_f32_16x16x32_bf16 v[96:99], v[240:243], v[48:51], v[96:99]
    ds_read_b64_tr_b16 v[44:45], v6 offset:8192
    v_mfma_f32_16x16x32_bf16 v[100:103], v[244:247], v[48:51], v[100:103]
    ds_read_b64_tr_b16 v[46:47], v6 offset:9216
    v_mfma_f32_16x16x32_bf16 v[104:107], v[240:243], v[52:55], v[104:107]
    ds_read_b64_tr_b16 v[48:49], v3 offset:12288
    v_mfma_f32_16x16x32_bf16 v[108:111], v[244:247], v[52:55], v[108:111]
    ds_read_b64_tr_b16 v[50:51], v3 offset:13312
    s_waitcnt lgkmcnt(10)
    v_mfma_f32_16x16x32_bf16 v[112:115], v[240:243], v[56:59], v[112:115]
    ds_read_b64_tr_b16 v[52:53], v4 offset:12288
    v_mfma_f32_16x16x32_bf16 v[116:119], v[244:247], v[56:59], v[116:119]
    ds_read_b64_tr_b16 v[54:55], v4 offset:13312
    v_mfma_f32_16x16x32_bf16 v[120:123], v[240:243], v[60:63], v[120:123]
    ds_read_b64_tr_b16 v[56:57], v5 offset:12288
    v_mfma_f32_16x16x32_bf16 v[124:127], v[244:247], v[60:63], v[124:127]
    ds_read_b64_tr_b16 v[58:59], v5 offset:13312
    s_waitcnt vmcnt(16) lgkmcnt(10)
    v_mfma_f32_16x16x32_bf16 v[64:67], v[32:35], v[248:251], v[64:67]
    ds_read_b64_tr_b16 v[60:61], v6 offset:12288
    v_mfma_f32_16x16x32_bf16 v[68:71], v[32:35], v[252:255], v[68:71]
    ds_read_b64_tr_b16 v[62:63], v6 offset:13312
    v_mfma_f32_16x16x32_bf16 v[72:75], v[36:39], v[248:251], v[72:75]
    ds_read_b64_tr_b16 v[32:33], v3 offset:16384
    v_mfma_f32_16x16x32_bf16 v[76:79], v[36:39], v[252:255], v[76:79]
    ds_read_b64_tr_b16 v[34:35], v3 offset:17408
    s_waitcnt lgkmcnt(10)
    v_mfma_f32_16x16x32_bf16 v[80:83], v[40:43], v[248:251], v[80:83]
    ds_read_b64_tr_b16 v[36:37], v4 offset:16384
    v_mfma_f32_16x16x32_bf16 v[84:87], v[40:43], v[252:255], v[84:87]
    ds_read_b64_tr_b16 v[38:39], v4 offset:17408
    v_mfma_f32_16x16x32_bf16 v[88:91], v[44:47], v[248:251], v[88:91]
    ds_read_b64_tr_b16 v[40:41], v5 offset:16384
    v_mfma_f32_16x16x32_bf16 v[92:95], v[44:47], v[252:255], v[92:95]
    ds_read_b64_tr_b16 v[42:43], v5 offset:17408
    s_waitcnt lgkmcnt(10)
    v_mfma_f32_16x16x32_bf16 v[96:99], v[248:251], v[48:51], v[96:99]
    ds_read_b64_tr_b16 v[44:45], v6 offset:16384
    v_mfma_f32_16x16x32_bf16 v[100:103], v[252:255], v[48:51], v[100:103]
    ds_read_b64_tr_b16 v[46:47], v6 offset:17408
    v_mfma_f32_16x16x32_bf16 v[104:107], v[248:251], v[52:55], v[104:107]
    ds_read_b64_tr_b16 v[48:49], v3 offset:20480
    v_mfma_f32_16x16x32_bf16 v[108:111], v[252:255], v[52:55], v[108:111]
    ds_read_b64_tr_b16 v[50:51], v3 offset:21504
    s_waitcnt lgkmcnt(10)
    v_mfma_f32_16x16x32_bf16 v[112:115], v[248:251], v[56:59], v[112:115]
    ds_read_b64_tr_b16 v[52:53], v4 offset:20480
    v_mfma_f32_16x16x32_bf16 v[116:119], v[252:255], v[56:59], v[116:119]
    ds_read_b64_tr_b16 v[54:55], v4 offset:21504
    v_mfma_f32_16x16x32_bf16 v[120:123], v[248:251], v[60:63], v[120:123]
    ds_read_b64_tr_b16 v[56:57], v5 offset:20480
    v_mfma_f32_16x16x32_bf16 v[124:127], v[252:255], v[60:63], v[124:127]
    ds_read_b64_tr_b16 v[58:59], v5 offset:21504
    s_waitcnt vmcnt(14) lgkmcnt(10)
    v_mfma_f32_16x16x32_bf16 v[64:67], v[32:35], v[160:163], v[64:67]
    ds_read_b64_tr_b16 v[60:61], v6 offset:20480
    v_mfma_f32_16x16x32_bf16 v[68:71], v[32:35], v[164:167], v[68:71]
    ds_read_b64_tr_b16 v[62:63], v6 offset:21504
    v_mfma_f32_16x16x32_bf16 v[72:75], v[36:39], v[160:163], v[72:75]
    ds_read_b64_tr_b16 v[32:33], v3 offset:24576
    v_mfma_f32_16x16x32_bf16 v[76:79], v[36:39], v[164:167], v[76:79]
    ds_read_b64_tr_b16 v[34:35], v3 offset:25600
    s_waitcnt lgkmcnt(10)
    v_mfma_f32_16x16x32_bf16 v[80:83], v[40:43], v[160:163], v[80:83]
    ds_read_b64_tr_b16 v[36:37], v4 offset:24576
    v_mfma_f32_16x16x32_bf16 v[84:87], v[40:43], v[164:167], v[84:87]
    ds_read_b64_tr_b16 v[38:39], v4 offset:25600
    v_mfma_f32_16x16x32_bf16 v[88:91], v[44:47], v[160:163], v[88:91]
    ds_read_b64_tr_b16 v[40:41], v5 offset:24576
    v_mfma_f32_16x16x32_bf16 v[92:95], v[44:47], v[164:167], v[92:95]
    ds_read_b64_tr_b16 v[42:43], v5 offset:25600
    s_waitcnt vmcnt(12) lgkmcnt(10)
    v_mfma_f32_16x16x32_bf16 v[64:67], v[48:51], v[168:171], v[64:67]
    ds_read_b64_tr_b16 v[44:45], v6 offset:24576
    v_mfma_f32_16x16x32_bf16 v[68:71], v[48:51], v[172:175], v[68:71]
    ds_read_b64_tr_b16 v[46:47], v6 offset:25600
    v_mfma_f32_16x16x32_bf16 v[72:75], v[52:55], v[168:171], v[72:75]
    ds_read_b64_tr_b16 v[48:49], v3 offset:28672
    v_mfma_f32_16x16x32_bf16 v[76:79], v[52:55], v[172:175], v[76:79]
    ds_read_b64_tr_b16 v[50:51], v3 offset:29696
    s_waitcnt lgkmcnt(10)
    v_mfma_f32_16x16x32_bf16 v[80:83], v[56:59], v[168:171], v[80:83]
    ds_read_b64_tr_b16 v[52:53], v4 offset:28672
    v_mfma_f32_16x16x32_bf16 v[84:87], v[56:59], v[172:175], v[84:87]
    ds_read_b64_tr_b16 v[54:55], v4 offset:29696
    v_mfma_f32_16x16x32_bf16 v[88:91], v[60:63], v[168:171], v[88:91]
    ds_read_b64_tr_b16 v[56:57], v5 offset:28672
    v_mfma_f32_16x16x32_bf16 v[92:95], v[60:63], v[172:175], v[92:95]
    ds_read_b64_tr_b16 v[58:59], v5 offset:29696
    s_waitcnt vmcnt(10) lgkmcnt(10)
    v_mfma_f32_16x16x32_bf16 v[64:67], v[32:35], v[176:179], v[64:67]
    ds_read_b64_tr_b16 v[60:61], v6 offset:28672
    v_mfma_f32_16x16x32_bf16 v[68:71], v[32:35], v[180:183], v[68:71]
    ds_read_b64_tr_b16 v[62:63], v6 offset:29696
    s_barrier
    v_mfma_f32_16x16x32_bf16 v[72:75], v[36:39], v[176:179], v[72:75]
    ds_read_b64_tr_b16 v[32:33], v3 offset:32768
    v_mfma_f32_16x16x32_bf16 v[76:79], v[36:39], v[180:183], v[76:79]
    ds_read_b64_tr_b16 v[34:35], v3 offset:33792
    s_waitcnt lgkmcnt(10)
    v_mfma_f32_16x16x32_bf16 v[80:83], v[40:43], v[176:179], v[80:83]
    ds_read_b64_tr_b16 v[36:37], v4 offset:32768
    v_mfma_f32_16x16x32_bf16 v[84:87], v[40:43], v[180:183], v[84:87]
    ds_read_b64_tr_b16 v[38:39], v4 offset:33792
    v_mfma_f32_16x16x32_bf16 v[88:91], v[44:47], v[176:179], v[88:91]
    ds_read_b64_tr_b16 v[40:41], v5 offset:32768
    v_mfma_f32_16x16x32_bf16 v[92:95], v[44:47], v[180:183], v[92:95]
    ds_read_b64_tr_b16 v[42:43], v5 offset:33792
    s_waitcnt vmcnt(8) lgkmcnt(10)
    v_mfma_f32_16x16x32_bf16 v[64:67], v[48:51], v[184:187], v[64:67]
    ds_read_b64_tr_b16 v[44:45], v6 offset:32768
    v_mfma_f32_16x16x32_bf16 v[68:71], v[48:51], v[188:191], v[68:71]
    ds_read_b64_tr_b16 v[46:47], v6 offset:33792
    v_mfma_f32_16x16x32_bf16 v[72:75], v[52:55], v[184:187], v[72:75]
    ds_read_b64_tr_b16 v[48:49], v3 offset:36864
    v_mfma_f32_16x16x32_bf16 v[76:79], v[52:55], v[188:191], v[76:79]
    ds_read_b64_tr_b16 v[50:51], v3 offset:37888
    s_waitcnt lgkmcnt(10)
    v_mfma_f32_16x16x32_bf16 v[80:83], v[56:59], v[184:187], v[80:83]
    ds_read_b64_tr_b16 v[52:53], v4 offset:36864
    v_mfma_f32_16x16x32_bf16 v[84:87], v[56:59], v[188:191], v[84:87]
    ds_read_b64_tr_b16 v[54:55], v4 offset:37888
    v_mfma_f32_16x16x32_bf16 v[88:91], v[60:63], v[184:187], v[88:91]
    ds_read_b64_tr_b16 v[56:57], v5 offset:36864
    v_mfma_f32_16x16x32_bf16 v[92:95], v[60:63], v[188:191], v[92:95]
    ds_read_b64_tr_b16 v[58:59], v5 offset:37888
    s_waitcnt vmcnt(6) lgkmcnt(10)
    v_mfma_f32_16x16x32_bf16 v[64:67], v[32:35], v[192:195], v[64:67]
    ds_read_b64_tr_b16 v[60:61], v6 offset:36864
    v_mfma_f32_16x16x32_bf16 v[68:71], v[32:35], v[196:199], v[68:71]
    ds_read_b64_tr_b16 v[62:63], v6 offset:37888
    v_mfma_f32_16x16x32_bf16 v[72:75], v[36:39], v[192:195], v[72:75]
    ds_read_b64_tr_b16 v[32:33], v3 offset:40960
    v_mfma_f32_16x16x32_bf16 v[76:79], v[36:39], v[196:199], v[76:79]
    ds_read_b64_tr_b16 v[34:35], v3 offset:41984
    s_waitcnt lgkmcnt(10)
    v_mfma_f32_16x16x32_bf16 v[80:83], v[40:43], v[192:195], v[80:83]
    ds_read_b64_tr_b16 v[36:37], v4 offset:40960
    v_mfma_f32_16x16x32_bf16 v[84:87], v[40:43], v[196:199], v[84:87]
    ds_read_b64_tr_b16 v[38:39], v4 offset:41984
    v_mfma_f32_16x16x32_bf16 v[88:91], v[44:47], v[192:195], v[88:91]
    ds_read_b64_tr_b16 v[40:41], v5 offset:40960
    v_mfma_f32_16x16x32_bf16 v[92:95], v[44:47], v[196:199], v[92:95]
    ds_read_b64_tr_b16 v[42:43], v5 offset:41984
    s_waitcnt vmcnt(4) lgkmcnt(10)
    v_mfma_f32_16x16x32_bf16 v[64:67], v[48:51], v[200:203], v[64:67]
    ds_read_b64_tr_b16 v[44:45], v6 offset:40960
    v_mfma_f32_16x16x32_bf16 v[68:71], v[48:51], v[204:207], v[68:71]
    ds_read_b64_tr_b16 v[46:47], v6 offset:41984
    v_mfma_f32_16x16x32_bf16 v[72:75], v[52:55], v[200:203], v[72:75]
    ds_read_b64_tr_b16 v[48:49], v3 offset:45056
    v_mfma_f32_16x16x32_bf16 v[76:79], v[52:55], v[204:207], v[76:79]
    ds_read_b64_tr_b16 v[50:51], v3 offset:46080
    s_waitcnt lgkmcnt(10)
    v_mfma_f32_16x16x32_bf16 v[80:83], v[56:59], v[200:203], v[80:83]
    ds_read_b64_tr_b16 v[52:53], v4 offset:45056
    v_mfma_f32_16x16x32_bf16 v[84:87], v[56:59], v[204:207], v[84:87]
    ds_read_b64_tr_b16 v[54:55], v4 offset:46080
    v_mfma_f32_16x16x32_bf16 v[88:91], v[60:63], v[200:203], v[88:91]
    ds_read_b64_tr_b16 v[56:57], v5 offset:45056
    v_mfma_f32_16x16x32_bf16 v[92:95], v[60:63], v[204:207], v[92:95]
    ds_read_b64_tr_b16 v[58:59], v5 offset:46080
    s_waitcnt vmcnt(2) lgkmcnt(10)
    v_mfma_f32_16x16x32_bf16 v[64:67], v[32:35], v[208:211], v[64:67]
    ds_read_b64_tr_b16 v[60:61], v6 offset:45056
    v_mfma_f32_16x16x32_bf16 v[68:71], v[32:35], v[212:215], v[68:71]
    ds_read_b64_tr_b16 v[62:63], v6 offset:46080
    v_mfma_f32_16x16x32_bf16 v[72:75], v[36:39], v[208:211], v[72:75]
    ds_read_b64_tr_b16 v[32:33], v3 offset:49152
    ds_read_b32 v8, v9 offset:4096
    v_mfma_f32_16x16x32_bf16 v[76:79], v[36:39], v[212:215], v[76:79]
    ds_read_b64_tr_b16 v[34:35], v3 offset:50176
    ds_read_b32 v10, v9 offset:4608
    s_waitcnt lgkmcnt(12)
    v_mfma_f32_16x16x32_bf16 v[80:83], v[40:43], v[208:211], v[80:83]
    ds_read_b64_tr_b16 v[36:37], v4 offset:49152
    ds_read_b32 v12, v9 offset:4160
    v_mfma_f32_16x16x32_bf16 v[84:87], v[40:43], v[212:215], v[84:87]
    ds_read_b64_tr_b16 v[38:39], v4 offset:50176
    ds_read_b32 v14, v9 offset:4672
    v_mfma_f32_16x16x32_bf16 v[88:91], v[44:47], v[208:211], v[88:91]
    ds_read_b64_tr_b16 v[40:41], v5 offset:49152
    ds_read_b128 v[16:19], v11 offset:256
    v_mfma_f32_16x16x32_bf16 v[92:95], v[44:47], v[212:215], v[92:95]
    ds_read_b64_tr_b16 v[42:43], v5 offset:50176
    ds_read_b128 v[20:23], v11 offset:320
    s_waitcnt vmcnt(0) lgkmcnt(14)
    v_mfma_f32_16x16x32_bf16 v[64:67], v[48:51], v[216:219], v[64:67]
    ds_read_b64_tr_b16 v[44:45], v6 offset:49152
    ds_read_b128 v[24:27], v11 offset:384
    v_mfma_f32_16x16x32_bf16 v[68:71], v[48:51], v[220:223], v[68:71]
    ds_read_b64_tr_b16 v[46:47], v6 offset:50176
    ds_read_b128 v[28:31], v11 offset:448
    v_mfma_f32_16x16x32_bf16 v[72:75], v[52:55], v[216:219], v[72:75]
    ds_read_b64_tr_b16 v[48:49], v3 offset:53248
    v_mfma_f32_16x16x32_bf16 v[76:79], v[52:55], v[220:223], v[76:79]
    ds_read_b64_tr_b16 v[50:51], v3 offset:54272
    s_waitcnt lgkmcnt(14)
    v_mfma_f32_16x16x32_bf16 v[80:83], v[56:59], v[216:219], v[80:83]
    ds_read_b64_tr_b16 v[52:53], v4 offset:53248
    v_mfma_f32_16x16x32_bf16 v[84:87], v[56:59], v[220:223], v[84:87]
    ds_read_b64_tr_b16 v[54:55], v4 offset:54272
    v_mfma_f32_16x16x32_bf16 v[88:91], v[60:63], v[216:219], v[88:91]
    ds_read_b64_tr_b16 v[56:57], v5 offset:53248
    v_mfma_f32_16x16x32_bf16 v[92:95], v[60:63], v[220:223], v[92:95]
    ds_read_b64_tr_b16 v[58:59], v5 offset:54272
    s_bitcmp1_b32 s21, 0
    s_cbranch_scc1 c_B
    v_add_u32 v7, s62, v1
    s_waitcnt lgkmcnt(6)
    v_pk_fma_f32 v[68:69], v[12:13], v[16:17], v[68:69] op_sel_hi:[0,1,1] neg_lo:[1,0,0] neg_hi:[1,0,0]
    v_pk_fma_f32 v[70:71], v[12:13], v[18:19], v[70:71] op_sel_hi:[0,1,1] neg_lo:[1,0,0] neg_hi:[1,0,0]
    v_pk_fma_f32 v[76:77], v[12:13], v[20:21], v[76:77] op_sel_hi:[0,1,1] neg_lo:[1,0,0] neg_hi:[1,0,0]
    v_pk_fma_f32 v[78:79], v[12:13], v[22:23], v[78:79] op_sel_hi:[0,1,1] neg_lo:[1,0,0] neg_hi:[1,0,0]
    v_pk_mul_f32 v[68:69], v[14:15], v[68:69] op_sel_hi:[0,1]
    v_pk_mul_f32 v[70:71], v[14:15], v[70:71] op_sel_hi:[0,1]
    v_pk_mul_f32 v[76:77], v[14:15], v[76:77] op_sel_hi:[0,1]
    v_pk_mul_f32 v[78:79], v[14:15], v[78:79] op_sel_hi:[0,1]
    v_cvt_pk_bf16_f32 v68, v68, v69
    v_cvt_pk_bf16_f32 v69, v70, v71
    v_cvt_pk_bf16_f32 v70, v76, v77
    v_cvt_pk_bf16_f32 v71, v78, v79
    ds_write_b128 v7, v[68:71] offset:4096
    v_pk_fma_f32 v[64:65], v[8:9], v[16:17], v[64:65] op_sel_hi:[0,1,1] neg_lo:[1,0,0] neg_hi:[1,0,0]
    v_pk_fma_f32 v[66:67], v[8:9], v[18:19], v[66:67] op_sel_hi:[0,1,1] neg_lo:[1,0,0] neg_hi:[1,0,0]
    v_pk_fma_f32 v[72:73], v[8:9], v[20:21], v[72:73] op_sel_hi:[0,1,1] neg_lo:[1,0,0] neg_hi:[1,0,0]
    v_pk_fma_f32 v[74:75], v[8:9], v[22:23], v[74:75] op_sel_hi:[0,1,1] neg_lo:[1,0,0] neg_hi:[1,0,0]
    v_pk_mul_f32 v[64:65], v[10:11], v[64:65] op_sel_hi:[0,1]
    v_pk_mul_f32 v[66:67], v[10:11], v[66:67] op_sel_hi:[0,1]
    v_pk_mul_f32 v[72:73], v[10:11], v[72:73] op_sel_hi:[0,1]
    v_pk_mul_f32 v[74:75], v[10:11], v[74:75] op_sel_hi:[0,1]
    v_cvt_pk_bf16_f32 v64, v64, v65
    v_cvt_pk_bf16_f32 v65, v66, v67
    v_cvt_pk_bf16_f32 v66, v72, v73
    v_cvt_pk_bf16_f32 v67, v74, v75
    v_pk_fma_f32 v[84:85], v[12:13], v[24:25], v[84:85] op_sel_hi:[0,1,1] neg_lo:[1,0,0] neg_hi:[1,0,0]
    v_pk_fma_f32 v[86:87], v[12:13], v[26:27], v[86:87] op_sel_hi:[0,1,1] neg_lo:[1,0,0] neg_hi:[1,0,0]
    v_pk_fma_f32 v[92:93], v[12:13], v[28:29], v[92:93] op_sel_hi:[0,1,1] neg_lo:[1,0,0] neg_hi:[1,0,0]
    v_pk_fma_f32 v[94:95], v[12:13], v[30:31], v[94:95] op_sel_hi:[0,1,1] neg_lo:[1,0,0] neg_hi:[1,0,0]
    v_pk_mul_f32 v[84:85], v[14:15], v[84:85] op_sel_hi:[0,1]
    v_pk_mul_f32 v[86:87], v[14:15], v[86:87] op_sel_hi:[0,1]
    v_pk_mul_f32 v[92:93], v[14:15], v[92:93] op_sel_hi:[0,1]
    v_pk_mul_f32 v[94:95], v[14:15], v[94:95] op_sel_hi:[0,1]
    v_cvt_pk_bf16_f32 v84, v84, v85
    v_cvt_pk_bf16_f32 v85, v86, v87
    v_cvt_pk_bf16_f32 v86, v92, v93
    v_cvt_pk_bf16_f32 v87, v94, v95
    ds_write_b128 v7, v[84:87] offset:5120
    v_pk_fma_f32 v[80:81], v[8:9], v[24:25], v[80:81] op_sel_hi:[0,1,1] neg_lo:[1,0,0] neg_hi:[1,0,0]
    v_pk_fma_f32 v[82:83], v[8:9], v[26:27], v[82:83] op_sel_hi:[0,1,1] neg_lo:[1,0,0] neg_hi:[1,0,0]
    v_pk_fma_f32 v[88:89], v[8:9], v[28:29], v[88:89] op_sel_hi:[0,1,1] neg_lo:[1,0,0] neg_hi:[1,0,0]
    v_pk_fma_f32 v[90:91], v[8:9], v[30:31], v[90:91] op_sel_hi:[0,1,1] neg_lo:[1,0,0] neg_hi:[1,0,0]
    v_pk_mul_f32 v[80:81], v[10:11], v[80:81] op_sel_hi:[0,1]
    v_pk_mul_f32 v[82:83], v[10:11], v[82:83] op_sel_hi:[0,1]
    v_pk_mul_f32 v[88:89], v[10:11], v[88:89] op_sel_hi:[0,1]
    v_pk_mul_f32 v[90:91], v[10:11], v[90:91] op_sel_hi:[0,1]
    v_cvt_pk_bf16_f32 v80, v80, v81
    v_cvt_pk_bf16_f32 v81, v82, v83
    v_cvt_pk_bf16_f32 v82, v88, v89
    v_cvt_pk_bf16_f32 v83, v90, v91
    v_mfma_f32_16x16x32_bf16 v[96:99], v[160:163], v[32:35], v[96:99]
    ds_read_b64_tr_b16 v[60:61], v6 offset:53248
    v_mfma_f32_16x16x32_bf16 v[100:103], v[164:167], v[32:35], v[100:103]
    ds_read_b64_tr_b16 v[62:63], v6 offset:54272
    v_mfma_f32_16x16x32_bf16 v[104:107], v[160:163], v[36:39], v[104:107]
    ds_read_b64_tr_b16 v[32:33], v3 offset:57344
    v_mfma_f32_16x16x32_bf16 v[108:111], v[164:167], v[36:39], v[108:111]
    ds_read_b64_tr_b16 v[34:35], v3 offset:58368
    v_mfma_f32_16x16x32_bf16 v[112:115], v[160:163], v[40:43], v[112:115]
    ds_read_b64_tr_b16 v[36:37], v4 offset:57344
    v_mfma_f32_16x16x32_bf16 v[116:119], v[164:167], v[40:43], v[116:119]
    ds_read_b64_tr_b16 v[38:39], v4 offset:58368
    v_mfma_f32_16x16x32_bf16 v[120:123], v[160:163], v[44:47], v[120:123]
    ds_read_b64_tr_b16 v[40:41], v5 offset:57344
    v_mfma_f32_16x16x32_bf16 v[124:127], v[164:167], v[44:47], v[124:127]
    ds_read_b64_tr_b16 v[42:43], v5 offset:58368
    s_waitcnt lgkmcnt(12)
    v_mfma_f32_16x16x32_bf16 v[96:99], v[168:171], v[48:51], v[96:99]
    ds_read_b64_tr_b16 v[44:45], v6 offset:57344
    v_mfma_f32_16x16x32_bf16 v[100:103], v[172:175], v[48:51], v[100:103]
    ds_read_b64_tr_b16 v[46:47], v6 offset:58368
    v_mfma_f32_16x16x32_bf16 v[104:107], v[168:171], v[52:55], v[104:107]
    ds_read_b64_tr_b16 v[48:49], v3 offset:61440
    v_mfma_f32_16x16x32_bf16 v[108:111], v[172:175], v[52:55], v[108:111]
    ds_read_b64_tr_b16 v[50:51], v3 offset:62464
    s_waitcnt lgkmcnt(10)
    v_mfma_f32_16x16x32_bf16 v[112:115], v[168:171], v[56:59], v[112:115]
    ds_read_b64_tr_b16 v[52:53], v4 offset:61440
    v_mfma_f32_16x16x32_bf16 v[116:119], v[172:175], v[56:59], v[116:119]
    ds_read_b64_tr_b16 v[54:55], v4 offset:62464
    v_mfma_f32_16x16x32_bf16 v[120:123], v[168:171], v[60:63], v[120:123]
    ds_read_b64_tr_b16 v[56:57], v5 offset:61440
    v_mfma_f32_16x16x32_bf16 v[124:127], v[172:175], v[60:63], v[124:127]
    ds_read_b64_tr_b16 v[58:59], v5 offset:62464
    s_waitcnt lgkmcnt(10)
    v_mfma_f32_16x16x32_bf16 v[96:99], v[176:179], v[32:35], v[96:99]
    ds_read_b64_tr_b16 v[60:61], v6 offset:61440
    v_mfma_f32_16x16x32_bf16 v[100:103], v[180:183], v[32:35], v[100:103]
    ds_read_b64_tr_b16 v[62:63], v6 offset:62464
    s_barrier
    v_xor_b32 v3, 0x10000, v3
    v_xor_b32 v4, 0x10000, v4
    v_xor_b32 v5, 0x10000, v5
    v_xor_b32 v6, 0x10000, v6
    v_mfma_f32_16x16x32_bf16 v[104:107], v[176:179], v[36:39], v[104:107]
    ds_read_b64_tr_b16 v[32:33], v3 offset:0
    v_mfma_f32_16x16x32_bf16 v[108:111], v[180:183], v[36:39], v[108:111]
    ds_read_b64_tr_b16 v[34:35], v3 offset:1024
    s_waitcnt lgkmcnt(10)
    v_mfma_f32_16x16x32_bf16 v[112:115], v[176:179], v[40:43], v[112:115]
    ds_read_b64_tr_b16 v[36:37], v4 offset:0
    v_mfma_f32_16x16x32_bf16 v[116:119], v[180:183], v[40:43], v[116:119]
    ds_read_b64_tr_b16 v[38:39], v4 offset:1024
    v_mfma_f32_16x16x32_bf16 v[120:123], v[176:179], v[44:47], v[120:123]
    ds_read_b64_tr_b16 v[40:41], v5 offset:0
    v_mfma_f32_16x16x32_bf16 v[124:127], v[180:183], v[44:47], v[124:127]
    ds_read_b64_tr_b16 v[42:43], v5 offset:1024
    s_waitcnt lgkmcnt(10)
    v_mfma_f32_16x16x32_bf16 v[96:99], v[184:187], v[48:51], v[96:99]
    ds_read_b64_tr_b16 v[44:45], v6 offset:0
    v_mfma_f32_16x16x32_bf16 v[100:103], v[188:191], v[48:51], v[100:103]
    ds_read_b64_tr_b16 v[46:47], v6 offset:1024
    v_mfma_f32_16x16x32_bf16 v[104:107], v[184:187], v[52:55], v[104:107]
    ds_read_b64_tr_b16 v[48:49], v3 offset:4096
    v_mfma_f32_16x16x32_bf16 v[108:111], v[188:191], v[52:55], v[108:111]
    ds_read_b64_tr_b16 v[50:51], v3 offset:5120
    s_waitcnt lgkmcnt(10)
    v_mfma_f32_16x16x32_bf16 v[112:115], v[184:187], v[56:59], v[112:115]
    ds_read_b64_tr_b16 v[52:53], v4 offset:4096
    v_mfma_f32_16x16x32_bf16 v[116:119], v[188:191], v[56:59], v[116:119]
    ds_read_b64_tr_b16 v[54:55], v4 offset:5120
    v_mfma_f32_16x16x32_bf16 v[120:123], v[184:187], v[60:63], v[120:123]
    ds_read_b64_tr_b16 v[56:57], v5 offset:4096
    v_mfma_f32_16x16x32_bf16 v[124:127], v[188:191], v[60:63], v[124:127]
    ds_read_b64_tr_b16 v[58:59], v5 offset:5120
    s_waitcnt lgkmcnt(10)
    v_mfma_f32_16x16x32_bf16 v[96:99], v[192:195], v[32:35], v[96:99]
    ds_read_b64_tr_b16 v[60:61], v6 offset:4096
    v_mfma_f32_16x16x32_bf16 v[100:103], v[196:199], v[32:35], v[100:103]
    ds_read_b64_tr_b16 v[62:63], v6 offset:5120
    v_mfma_f32_16x16x32_bf16 v[104:107], v[192:195], v[36:39], v[104:107]
    ds_read_b64_tr_b16 v[32:33], v3 offset:8192
    v_mfma_f32_16x16x32_bf16 v[108:111], v[196:199], v[36:39], v[108:111]
    ds_read_b64_tr_b16 v[34:35], v3 offset:9216
    s_waitcnt lgkmcnt(10)
    v_mfma_f32_16x16x32_bf16 v[112:115], v[192:195], v[40:43], v[112:115]
    ds_read_b64_tr_b16 v[36:37], v4 offset:8192
    v_mfma_f32_16x16x32_bf16 v[116:119], v[196:199], v[40:43], v[116:119]
    ds_read_b64_tr_b16 v[38:39], v4 offset:9216
    v_mfma_f32_16x16x32_bf16 v[120:123], v[192:195], v[44:47], v[120:123]
    ds_read_b64_tr_b16 v[40:41], v5 offset:8192
    v_mfma_f32_16x16x32_bf16 v[124:127], v[196:199], v[44:47], v[124:127]
    ds_read_b64_tr_b16 v[42:43], v5 offset:9216
    s_waitcnt lgkmcnt(10)
    v_mfma_f32_16x16x32_bf16 v[96:99], v[200:203], v[48:51], v[96:99]
    ds_read_b64_tr_b16 v[44:45], v6 offset:8192
    v_mfma_f32_16x16x32_bf16 v[100:103], v[204:207], v[48:51], v[100:103]
    ds_read_b64_tr_b16 v[46:47], v6 offset:9216
    v_mfma_f32_16x16x32_bf16 v[104:107], v[200:203], v[52:55], v[104:107]
    ds_read_b64_tr_b16 v[48:49], v3 offset:12288
    v_mfma_f32_16x16x32_bf16 v[108:111], v[204:207], v[52:55], v[108:111]
    ds_read_b64_tr_b16 v[50:51], v3 offset:13312
    s_waitcnt lgkmcnt(10)
    v_mfma_f32_16x16x32_bf16 v[112:115], v[200:203], v[56:59], v[112:115]
    ds_read_b64_tr_b16 v[52:53], v4 offset:12288
    v_mfma_f32_16x16x32_bf16 v[116:119], v[204:207], v[56:59], v[116:119]
    ds_read_b64_tr_b16 v[54:55], v4 offset:13312
    v_mfma_f32_16x16x32_bf16 v[120:123], v[200:203], v[60:63], v[120:123]
    ds_read_b64_tr_b16 v[56:57], v5 offset:12288
    v_mfma_f32_16x16x32_bf16 v[124:127], v[204:207], v[60:63], v[124:127]
    ds_read_b64_tr_b16 v[58:59], v5 offset:13312
    s_waitcnt lgkmcnt(10)
    v_mfma_f32_16x16x32_bf16 v[96:99], v[208:211], v[32:35], v[96:99]
    ds_read_b64_tr_b16 v[60:61], v6 offset:12288
    v_mfma_f32_16x16x32_bf16 v[100:103], v[212:215], v[32:35], v[100:103]
    ds_read_b64_tr_b16 v[62:63], v6 offset:13312
    v_mfma_f32_16x16x32_bf16 v[104:107], v[208:211], v[36:39], v[104:107]
    ds_read_b64_tr_b16 v[32:33], v3 offset:16384
    ds_read_b128 v[16:19], v13 offset:4096
    v_mfma_f32_16x16x32_bf16 v[108:111], v[212:215], v[36:39], v[108:111]
    ds_read_b64_tr_b16 v[34:35], v3 offset:17408
    ds_read_b128 v[20:23], v13 offset:4608
    s_waitcnt lgkmcnt(12)
    v_mfma_f32_16x16x32_bf16 v[112:115], v[208:211], v[40:43], v[112:115]
    ds_read_b64_tr_b16 v[36:37], v4 offset:16384
    ds_read_b128 v[24:27], v13 offset:4160
    v_mfma_f32_16x16x32_bf16 v[116:119], v[212:215], v[40:43], v[116:119]
    ds_read_b64_tr_b16 v[38:39], v4 offset:17408
    ds_read_b128 v[28:31], v13 offset:4672
    v_mfma_f32_16x16x32_bf16 v[120:123], v[208:211], v[44:47], v[120:123]
    ds_read_b64_tr_b16 v[40:41], v5 offset:16384
    ds_read_b32 v8, v15 offset:512
    v_mfma_f32_16x16x32_bf16 v[124:127], v[212:215], v[44:47], v[124:127]
    ds_read_b64_tr_b16 v[42:43], v5 offset:17408
    ds_read_b32 v10, v15 offset:576
    s_waitcnt lgkmcnt(14)
    v_mfma_f32_16x16x32_bf16 v[96:99], v[216:219], v[48:51], v[96:99]
    ds_read_b64_tr_b16 v[44:45], v6 offset:16384
    ds_read_b32 v12, v15 offset:640
    v_mfma_f32_16x16x32_bf16 v[100:103], v[220:223], v[48:51], v[100:103]
    ds_read_b64_tr_b16 v[46:47], v6 offset:17408
    ds_read_b32 v14, v15 offset:704
    v_mfma_f32_16x16x32_bf16 v[104:107], v[216:219], v[52:55], v[104:107]
    ds_read_b64_tr_b16 v[48:49], v3 offset:20480
    v_mfma_f32_16x16x32_bf16 v[108:111], v[220:223], v[52:55], v[108:111]
    ds_read_b64_tr_b16 v[50:51], v3 offset:21504
    s_waitcnt lgkmcnt(14)
    v_mfma_f32_16x16x32_bf16 v[112:115], v[216:219], v[56:59], v[112:115]
    ds_read_b64_tr_b16 v[52:53], v4 offset:20480
    v_mfma_f32_16x16x32_bf16 v[116:119], v[220:223], v[56:59], v[116:119]
    ds_read_b64_tr_b16 v[54:55], v4 offset:21504
    v_mfma_f32_16x16x32_bf16 v[120:123], v[216:219], v[60:63], v[120:123]
    ds_read_b64_tr_b16 v[56:57], v5 offset:20480
    v_mfma_f32_16x16x32_bf16 v[124:127], v[220:223], v[60:63], v[124:127]
    ds_read_b64_tr_b16 v[58:59], v5 offset:21504
    s_waitcnt lgkmcnt(6)
    v_pk_fma_f32 v[100:101], v[8:9], v[24:25], v[100:101] op_sel_hi:[0,1,1] neg_lo:[1,0,0] neg_hi:[1,0,0]
    v_pk_fma_f32 v[102:103], v[8:9], v[26:27], v[102:103] op_sel_hi:[0,1,1] neg_lo:[1,0,0] neg_hi:[1,0,0]
    v_pk_fma_f32 v[108:109], v[10:11], v[24:25], v[108:109] op_sel_hi:[0,1,1] neg_lo:[1,0,0] neg_hi:[1,0,0]
    v_pk_fma_f32 v[110:111], v[10:11], v[26:27], v[110:111] op_sel_hi:[0,1,1] neg_lo:[1,0,0] neg_hi:[1,0,0]
    v_pk_mul_f32 v[100:101], v[28:29], v[100:101]
    v_pk_mul_f32 v[102:103], v[30:31], v[102:103]
    v_pk_mul_f32 v[108:109], v[28:29], v[108:109]
    v_pk_mul_f32 v[110:111], v[30:31], v[110:111]
    v_cvt_pk_bf16_f32 v74, v100, v101
    v_cvt_pk_bf16_f32 v75, v102, v103
    v_cvt_pk_bf16_f32 v78, v108, v109
    v_cvt_pk_bf16_f32 v79, v110, v111
    v_cvt_pk_bf16_f32 v100, v100, v101
    v_cvt_pk_bf16_f32 v101, v102, v103
    v_cvt_pk_bf16_f32 v102, v108, v109
    v_cvt_pk_bf16_f32 v103, v110, v111
    ds_write_b128 v7, v[100:103] offset:6144
    v_pk_fma_f32 v[116:117], v[12:13], v[24:25], v[116:117] op_sel_hi:[0,1,1] neg_lo:[1,0,0] neg_hi:[1,0,0]
    v_pk_fma_f32 v[118:119], v[12:13], v[26:27], v[118:119] op_sel_hi:[0,1,1] neg_lo:[1,0,0] neg_hi:[1,0,0]
    v_pk_fma_f32 v[124:125], v[14:15], v[24:25], v[124:125] op_sel_hi:[0,1,1] neg_lo:[1,0,0] neg_hi:[1,0,0]
    v_pk_fma_f32 v[126:127], v[14:15], v[26:27], v[126:127] op_sel_hi:[0,1,1] neg_lo:[1,0,0] neg_hi:[1,0,0]
    v_pk_mul_f32 v[116:117], v[28:29], v[116:117]
    v_pk_mul_f32 v[118:119], v[30:31], v[118:119]
    v_pk_mul_f32 v[124:125], v[28:29], v[124:125]
    v_pk_mul_f32 v[126:127], v[30:31], v[126:127]
    v_cvt_pk_bf16_f32 v90, v116, v117
    v_cvt_pk_bf16_f32 v91, v118, v119
    v_cvt_pk_bf16_f32 v94, v124, v125
    v_cvt_pk_bf16_f32 v95, v126, v127
    v_cvt_pk_bf16_f32 v116, v116, v117
    v_cvt_pk_bf16_f32 v117, v118, v119
    v_cvt_pk_bf16_f32 v118, v124, v125
    v_cvt_pk_bf16_f32 v119, v126, v127
    ds_write_b128 v7, v[116:119] offset:7168
    s_cmp_lg_u32 s16, 3
    s_cbranch_scc1 a_nh
    buffer_store_dwordx4 v[68:71], v1, s[4:7], s60 offen offset:0 sc1
    buffer_store_dwordx4 v[84:87], v1, s[4:7], s60 offen offset:1024 sc1
    buffer_store_dwordx4 v[100:103], v1, s[4:7], s60 offen offset:2048 sc1
    buffer_store_dwordx4 v[116:119], v1, s[4:7], s60 offen offset:3072 sc1
a_nh:
    v_pk_fma_f32 v[96:97], v[8:9], v[16:17], v[96:97] op_sel_hi:[0,1,1] neg_lo:[1,0,0] neg_hi:[1,0,0]
    v_pk_fma_f32 v[98:99], v[8:9], v[18:19], v[98:99] op_sel_hi:[0,1,1] neg_lo:[1,0,0] neg_hi:[1,0,0]
    v_pk_fma_f32 v[104:105], v[10:11], v[16:17], v[104:105] op_sel_hi:[0,1,1] neg_lo:[1,0,0] neg_hi:[1,0,0]
    v_pk_fma_f32 v[106:107], v[10:11], v[18:19], v[106:107] op_sel_hi:[0,1,1] neg_lo:[1,0,0] neg_hi:[1,0,0]
    v_pk_mul_f32 v[96:97], v[20:21], v[96:97]
    v_pk_mul_f32 v[98:99], v[22:23], v[98:99]
    v_pk_mul_f32 v[104:105], v[20:21], v[104:105]
    v_pk_mul_f32 v[106:107], v[22:23], v[106:107]
    v_cvt_pk_bf16_f32 v72, v96, v97
    v_cvt_pk_bf16_f32 v73, v98, v99
    v_cvt_pk_bf16_f32 v76, v104, v105
    v_cvt_pk_bf16_f32 v77, v106, v107
    v_pk_fma_f32 v[112:113], v[12:13], v[16:17], v[112:113] op_sel_hi:[0,1,1] neg_lo:[1,0,0] neg_hi:[1,0,0]
    v_pk_fma_f32 v[114:115], v[12:13], v[18:19], v[114:115] op_sel_hi:[0,1,1] neg_lo:[1,0,0] neg_hi:[1,0,0]
    v_pk_fma_f32 v[120:121], v[14:15], v[16:17], v[120:121] op_sel_hi:[0,1,1] neg_lo:[1,0,0] neg_hi:[1,0,0]
    v_pk_fma_f32 v[122:123], v[14:15], v[18:19], v[122:123] op_sel_hi:[0,1,1] neg_lo:[1,0,0] neg_hi:[1,0,0]
    v_pk_mul_f32 v[112:113], v[20:21], v[112:113]
    v_pk_mul_f32 v[114:115], v[22:23], v[114:115]
    v_pk_mul_f32 v[120:121], v[20:21], v[120:121]
    v_pk_mul_f32 v[122:123], v[22:23], v[122:123]
    v_cvt_pk_bf16_f32 v88, v112, v113
    v_cvt_pk_bf16_f32 v89, v114, v115
    v_cvt_pk_bf16_f32 v92, v120, v121
    v_cvt_pk_bf16_f32 v93, v122, v123
    v_mfma_f32_16x16x32_bf16 v[128:131], v[32:35], v[224:227], v[128:131]
    ds_read_b64_tr_b16 v[60:61], v6 offset:20480
    v_mfma_f32_16x16x32_bf16 v[132:135], v[32:35], v[228:231], v[132:135]
    ds_read_b64_tr_b16 v[62:63], v6 offset:21504
    v_mfma_f32_16x16x32_bf16 v[136:139], v[36:39], v[224:227], v[136:139]
    ds_read_b64_tr_b16 v[32:33], v3 offset:24576
    v_mfma_f32_16x16x32_bf16 v[140:143], v[36:39], v[228:231], v[140:143]
    ds_read_b64_tr_b16 v[34:35], v3 offset:25600
    v_mfma_f32_16x16x32_bf16 v[144:147], v[40:43], v[224:227], v[144:147]
    ds_read_b64_tr_b16 v[36:37], v4 offset:24576
    v_mfma_f32_16x16x32_bf16 v[148:151], v[40:43], v[228:231], v[148:151]
    ds_read_b64_tr_b16 v[38:39], v4 offset:25600
    v_mfma_f32_16x16x32_bf16 v[152:155], v[44:47], v[224:227], v[152:155]
    ds_read_b64_tr_b16 v[40:41], v5 offset:24576
    v_mfma_f32_16x16x32_bf16 v[156:159], v[44:47], v[228:231], v[156:159]
    ds_read_b64_tr_b16 v[42:43], v5 offset:25600
    s_waitcnt lgkmcnt(12)
    v_mfma_f32_16x16x32_bf16 v[128:131], v[48:51], v[232:235], v[128:131]
    ds_read_b64_tr_b16 v[44:45], v6 offset:24576
    v_mfma_f32_16x16x32_bf16 v[132:135], v[48:51], v[236:239], v[132:135]
    ds_read_b64_tr_b16 v[46:47], v6 offset:25600
    v_mfma_f32_16x16x32_bf16 v[136:139], v[52:55], v[232:235], v[136:139]
    ds_read_b64_tr_b16 v[48:49], v3 offset:28672
    v_mfma_f32_16x16x32_bf16 v[140:143], v[52:55], v[236:239], v[140:143]
    ds_read_b64_tr_b16 v[50:51], v3 offset:29696
    s_waitcnt lgkmcnt(10)
    v_mfma_f32_16x16x32_bf16 v[144:147], v[56:59], v[232:235], v[144:147]
    ds_read_b64_tr_b16 v[52:53], v4 offset:28672
    v_mfma_f32_16x16x32_bf16 v[148:151], v[56:59], v[236:239], v[148:151]
    ds_read_b64_tr_b16 v[54:55], v4 offset:29696
    v_mfma_f32_16x16x32_bf16 v[152:155], v[60:63], v[232:235], v[152:155]
    ds_read_b64_tr_b16 v[56:57], v5 offset:28672
    v_mfma_f32_16x16x32_bf16 v[156:159], v[60:63], v[236:239], v[156:159]
    ds_read_b64_tr_b16 v[58:59], v5 offset:29696
    s_waitcnt lgkmcnt(10)
    v_mfma_f32_16x16x32_bf16 v[128:131], v[32:35], v[240:243], v[128:131]
    ds_read_b64_tr_b16 v[60:61], v6 offset:28672
    v_mfma_f32_16x16x32_bf16 v[132:135], v[32:35], v[244:247], v[132:135]
    ds_read_b64_tr_b16 v[62:63], v6 offset:29696
    s_barrier
    v_mfma_f32_16x16x32_bf16 v[136:139], v[36:39], v[240:243], v[136:139]
    ds_read_b64_tr_b16 v[32:33], v3 offset:32768
    v_mfma_f32_16x16x32_bf16 v[140:143], v[36:39], v[244:247], v[140:143]
    ds_read_b64_tr_b16 v[34:35], v3 offset:33792
    s_waitcnt lgkmcnt(10)
    v_mfma_f32_16x16x32_bf16 v[144:147], v[40:43], v[240:243], v[144:147]
    ds_read_b64_tr_b16 v[36:37], v4 offset:32768
    v_mfma_f32_16x16x32_bf16 v[148:151], v[40:43], v[244:247], v[148:151]
    ds_read_b64_tr_b16 v[38:39], v4 offset:33792
    v_mfma_f32_16x16x32_bf16 v[152:155], v[44:47], v[240:243], v[152:155]
    ds_read_b64_tr_b16 v[40:41], v5 offset:32768
    v_mfma_f32_16x16x32_bf16 v[156:159], v[44:47], v[244:247], v[156:159]
    ds_read_b64_tr_b16 v[42:43], v5 offset:33792
    s_waitcnt lgkmcnt(10)
    v_mfma_f32_16x16x32_bf16 v[128:131], v[48:51], v[248:251], v[128:131]
    ds_read_b64_tr_b16 v[44:45], v6 offset:32768
    v_mfma_f32_16x16x32_bf16 v[132:135], v[48:51], v[252:255], v[132:135]
    ds_read_b64_tr_b16 v[46:47], v6 offset:33792
    v_mfma_f32_16x16x32_bf16 v[136:139], v[52:55], v[248:251], v[136:139]
    ds_read_b64_tr_b16 v[48:49], v3 offset:36864
    v_mfma_f32_16x16x32_bf16 v[140:143], v[52:55], v[252:255], v[140:143]
    ds_read_b64_tr_b16 v[50:51], v3 offset:37888
    s_waitcnt lgkmcnt(10)
    v_mfma_f32_16x16x32_bf16 v[144:147], v[56:59], v[248:251], v[144:147]
    ds_read_b64_tr_b16 v[52:53], v4 offset:36864
    v_mfma_f32_16x16x32_bf16 v[148:151], v[56:59], v[252:255], v[148:151]
    ds_read_b64_tr_b16 v[54:55], v4 offset:37888
    v_mfma_f32_16x16x32_bf16 v[152:155], v[60:63], v[248:251], v[152:155]
    ds_read_b64_tr_b16 v[56:57], v5 offset:36864
    v_mfma_f32_16x16x32_bf16 v[156:159], v[60:63], v[252:255], v[156:159]
    ds_read_b64_tr_b16 v[58:59], v5 offset:37888
    s_waitcnt lgkmcnt(10)
    v_mfma_f32_16x16x32_bf16 v[128:131], v[32:35], v[160:163], v[128:131]
    ds_read_b64_tr_b16 v[60:61], v6 offset:36864
    v_mfma_f32_16x16x32_bf16 v[132:135], v[32:35], v[164:167], v[132:135]
    ds_read_b64_tr_b16 v[62:63], v6 offset:37888
    v_mfma_f32_16x16x32_bf16 v[136:139], v[36:39], v[160:163], v[136:139]
    ds_read_b64_tr_b16 v[32:33], v3 offset:40960
    v_mfma_f32_16x16x32_bf16 v[140:143], v[36:39], v[164:167], v[140:143]
    ds_read_b64_tr_b16 v[34:35], v3 offset:41984
    s_waitcnt lgkmcnt(10)
    v_mfma_f32_16x16x32_bf16 v[144:147], v[40:43], v[160:163], v[144:147]
    ds_read_b64_tr_b16 v[36:37], v4 offset:40960
    v_mfma_f32_16x16x32_bf16 v[148:151], v[40:43], v[164:167], v[148:151]
    ds_read_b64_tr_b16 v[38:39], v4 offset:41984
    v_mfma_f32_16x16x32_bf16 v[152:155], v[44:47], v[160:163], v[152:155]
    ds_read_b64_tr_b16 v[40:41], v5 offset:40960
    v_mfma_f32_16x16x32_bf16 v[156:159], v[44:47], v[164:167], v[156:159]
    ds_read_b64_tr_b16 v[42:43], v5 offset:41984
    s_waitcnt lgkmcnt(10)
    v_mfma_f32_16x16x32_bf16 v[128:131], v[48:51], v[168:171], v[128:131]
    ds_read_b64_tr_b16 v[44:45], v6 offset:40960
    s_cmp_lg_u32 s16, 3
    s_cbranch_scc1 a_nopub
    s_waitcnt vmcnt(0)
    s_atomic_add s40, s[22:23], s61
a_nopub:
    v_mfma_f32_16x16x32_bf16 v[132:135], v[48:51], v[172:175], v[132:135]
    ds_read_b64_tr_b16 v[46:47], v6 offset:41984
    v_mfma_f32_16x16x32_bf16 v[136:139], v[52:55], v[168:171], v[136:139]
    ds_read_b64_tr_b16 v[48:49], v3 offset:45056
    v_mfma_f32_16x16x32_bf16 v[140:143], v[52:55], v[172:175], v[140:143]
    ds_read_b64_tr_b16 v[50:51], v3 offset:46080
    s_waitcnt lgkmcnt(10)
    v_mfma_f32_16x16x32_bf16 v[144:147], v[56:59], v[168:171], v[144:147]
    ds_read_b64_tr_b16 v[52:53], v4 offset:45056
    v_mfma_f32_16x16x32_bf16 v[148:151], v[56:59], v[172:175], v[148:151]
    ds_read_b64_tr_b16 v[54:55], v4 offset:46080
    v_mfma_f32_16x16x32_bf16 v[152:155], v[60:63], v[168:171], v[152:155]
    ds_read_b64_tr_b16 v[56:57], v5 offset:45056
    v_mfma_f32_16x16x32_bf16 v[156:159], v[60:63], v[172:175], v[156:159]
    ds_read_b64_tr_b16 v[58:59], v5 offset:46080
    s_waitcnt lgkmcnt(10)
    v_mfma_f32_16x16x32_bf16 v[128:131], v[32:35], v[176:179], v[128:131]
    ds_read_b64_tr_b16 v[60:61], v6 offset:45056
    v_mfma_f32_16x16x32_bf16 v[132:135], v[32:35], v[180:183], v[132:135]
    ds_read_b64_tr_b16 v[62:63], v6 offset:46080
    v_mfma_f32_16x16x32_bf16 v[136:139], v[36:39], v[176:179], v[136:139]
    ds_read_b64_tr_b16 v[32:33], v3 offset:49152
    v_mfma_f32_16x16x32_bf16 v[140:143], v[36:39], v[180:183], v[140:143]
    ds_read_b64_tr_b16 v[34:35], v3 offset:50176
    s_waitcnt lgkmcnt(10)
    v_mfma_f32_16x16x32_bf16 v[144:147], v[40:43], v[176:179], v[144:147]
    ds_read_b64_tr_b16 v[36:37], v4 offset:49152
    v_mfma_f32_16x16x32_bf16 v[148:151], v[40:43], v[180:183], v[148:151]
    ds_read_b64_tr_b16 v[38:39], v4 offset:50176
    v_mfma_f32_16x16x32_bf16 v[152:155], v[44:47], v[176:179], v[152:155]
    ds_read_b64_tr_b16 v[40:41], v5 offset:49152
    v_mfma_f32_16x16x32_bf16 v[156:159], v[44:47], v[180:183], v[156:159]
    ds_read_b64_tr_b16 v[42:43], v5 offset:50176
    s_waitcnt lgkmcnt(10)
    v_mfma_f32_16x16x32_bf16 v[128:131], v[48:51], v[184:187], v[128:131]
    ds_read_b64_tr_b16 v[44:45], v6 offset:49152
    ds_read_b32 v8, v9 offset:4096
    v_mfma_f32_16x16x32_bf16 v[132:135], v[48:51], v[188:191], v[132:135]
    ds_read_b64_tr_b16 v[46:47], v6 offset:50176
    ds_read_b32 v10, v9 offset:4608
    v_mfma_f32_16x16x32_bf16 v[136:139], v[52:55], v[184:187], v[136:139]
    ds_read_b64_tr_b16 v[48:49], v3 offset:53248
    ds_read_b32 v12, v9 offset:4160
    v_mfma_f32_16x16x32_bf16 v[140:143], v[52:55], v[188:191], v[140:143]
    ds_read_b64_tr_b16 v[50:51], v3 offset:54272
    ds_read_b32 v14, v9 offset:4672
    s_waitcnt lgkmcnt(14)
    v_mfma_f32_16x16x32_bf16 v[144:147], v[56:59], v[184:187], v[144:147]
    ds_read_b64_tr_b16 v[52:53], v4 offset:53248
    ds_read_b128 v[16:19], v11 offset:0
    v_mfma_f32_16x16x32_bf16 v[148:151], v[56:59], v[188:191], v[148:151]
    ds_read_b64_tr_b16 v[54:55], v4 offset:54272
    ds_read_b128 v[20:23], v11 offset:64
    v_mfma_f32_16x16x32_bf16 v[152:155], v[60:63], v[184:187], v[152:155]
    ds_read_b64_tr_b16 v[56:57], v5 offset:53248
    ds_read_b128 v[24:27], v11 offset:128
    v_mfma_f32_16x16x32_bf16 v[156:159], v[60:63], v[188:191], v[156:159]
    ds_read_b64_tr_b16 v[58:59], v5 offset:54272
    ds_read_b128 v[28:31], v11 offset:192
    s_waitcnt lgkmcnt(14)
    v_mfma_f32_16x16x32_bf16 v[128:131], v[32:35], v[192:195], v[128:131]
    ds_read_b64_tr_b16 v[60:61], v6 offset:53248
    v_add_u32 v13, 153600, v1
    v_mfma_f32_16x16x32_bf16 v[132:135], v[32:35], v[196:199], v[132:135]
    ds_read_b64_tr_b16 v[62:63], v6 offset:54272
    v_mfma_f32_16x16x32_bf16 v[136:139], v[36:39], v[192:195], v[136:139]
    ds_read_b64_tr_b16 v[32:33], v3 offset:57344
    v_mfma_f32_16x16x32_bf16 v[140:143], v[36:39], v[196:199], v[140:143]
    ds_read_b64_tr_b16 v[34:35], v3 offset:58368
    s_waitcnt lgkmcnt(14)
    v_mfma_f32_16x16x32_bf16 v[144:147], v[40:43], v[192:195], v[144:147]
    ds_read_b64_tr_b16 v[36:37], v4 offset:57344
    v_mfma_f32_16x16x32_bf16 v[148:151], v[40:43], v[196:199], v[148:151]
    ds_read_b64_tr_b16 v[38:39], v4 offset:58368
    v_mfma_f32_16x16x32_bf16 v[152:155], v[44:47], v[192:195], v[152:155]
    ds_read_b64_tr_b16 v[40:41], v5 offset:57344
    v_mfma_f32_16x16x32_bf16 v[156:159], v[44:47], v[196:199], v[156:159]
    ds_read_b64_tr_b16 v[42:43], v5 offset:58368
    s_waitcnt lgkmcnt(13)
    v_mfma_f32_16x16x32_bf16 v[128:131], v[48:51], v[200:203], v[128:131]
    ds_read_b64_tr_b16 v[44:45], v6 offset:57344
    s_waitcnt lgkmcnt(9)
    v_mfma_f32_16x16x32_bf16 v[132:135], v[48:51], v[204:207], v[132:135]
    ds_read_b64_tr_b16 v[46:47], v6 offset:58368
    v_mul_f32 v10, 0x3e8293ee, v10
    v_mfma_f32_16x16x32_bf16 v[136:139], v[52:55], v[200:203], v[136:139]
    ds_read_b64_tr_b16 v[48:49], v3 offset:61440
    v_mul_f32 v14, 0x3e8293ee, v14
    v_mfma_f32_16x16x32_bf16 v[140:143], v[52:55], v[204:207], v[140:143]
    ds_read_b64_tr_b16 v[50:51], v3 offset:62464
    ds_read_b128 v[120:123], v13 offset:0
    s_waitcnt lgkmcnt(11)
    v_mfma_f32_16x16x32_bf16 v[144:147], v[56:59], v[200:203], v[144:147]
    ds_read_b64_tr_b16 v[52:53], v4 offset:61440
    ds_read_b128 v[124:127], v13 offset:1024
    v_mfma_f32_16x16x32_bf16 v[148:151], v[56:59], v[204:207], v[148:151]
    ds_read_b64_tr_b16 v[54:55], v4 offset:62464
    v_mfma_f32_16x16x32_bf16 v[152:155], v[60:63], v[200:203], v[152:155]
    ds_read_b64_tr_b16 v[56:57], v5 offset:61440
    v_mfma_f32_16x16x32_bf16 v[156:159], v[60:63], v[204:207], v[156:159]
    ds_read_b64_tr_b16 v[58:59], v5 offset:62464
    s_waitcnt lgkmcnt(12)
    v_mfma_f32_16x16x32_bf16 v[128:131], v[32:35], v[208:211], v[128:131]
    ds_read_b64_tr_b16 v[60:61], v6 offset:61440
    v_mfma_f32_16x16x32_bf16 v[132:135], v[32:35], v[212:215], v[132:135]
    ds_read_b64_tr_b16 v[62:63], v6 offset:62464
    v_xor_b32 v3, 0x10000, v3
    v_xor_b32 v4, 0x10000, v4
    v_xor_b32 v5, 0x10000, v5
    v_xor_b32 v6, 0x10000, v6
    v_mfma_f32_16x16x32_bf16 v[136:139], v[36:39], v[208:211], v[136:139]
    v_mfma_f32_16x16x32_bf16 v[140:143], v[36:39], v[212:215], v[140:143]
    s_waitcnt lgkmcnt(10)
    v_mfma_f32_16x16x32_bf16 v[144:147], v[40:43], v[208:211], v[144:147]
    v_mfma_f32_16x16x32_bf16 v[148:151], v[40:43], v[212:215], v[148:151]
    v_mfma_f32_16x16x32_bf16 v[152:155], v[44:47], v[208:211], v[152:155]
    v_mfma_f32_16x16x32_bf16 v[156:159], v[44:47], v[212:215], v[156:159]
    s_waitcnt lgkmcnt(4)
    v_mfma_f32_16x16x32_bf16 v[128:131], v[48:51], v[216:219], v[128:131]
    v_mfma_f32_16x16x32_bf16 v[132:135], v[48:51], v[220:223], v[132:135]
    v_mfma_f32_16x16x32_bf16 v[136:139], v[52:55], v[216:219], v[136:139]
    v_mfma_f32_16x16x32_bf16 v[140:143], v[52:55], v[220:223], v[140:143]
    s_waitcnt lgkmcnt(0)
    v_mfma_f32_16x16x32_bf16 v[144:147], v[56:59], v[216:219], v[144:147]
    v_mfma_f32_16x16x32_bf16 v[148:151], v[56:59], v[220:223], v[148:151]
    v_mfma_f32_16x16x32_bf16 v[152:155], v[60:63], v[216:219], v[152:155]
    v_mfma_f32_16x16x32_bf16 v[156:159], v[60:63], v[220:223], v[156:159]
    s_lshl_b32 s44, s21, 22
    s_lshl_b32 s45, s38, 16
    s_add_u32 s44, s44, s45
    s_lshl_b32 s45, s18, 12
    s_add_u32 s44, s44, s45
    s_add_u32 s52, s44, 16777216
    v_pk_fma_f32 v[132:133], v[12:13], v[16:17], v[132:133] op_sel_hi:[0,1,1] neg_lo:[1,0,0] neg_hi:[1,0,0]
    v_pk_fma_f32 v[134:135], v[12:13], v[18:19], v[134:135] op_sel_hi:[0,1,1] neg_lo:[1,0,0] neg_hi:[1,0,0]
    v_pk_fma_f32 v[140:141], v[12:13], v[20:21], v[140:141] op_sel_hi:[0,1,1] neg_lo:[1,0,0] neg_hi:[1,0,0]
    v_pk_fma_f32 v[142:143], v[12:13], v[22:23], v[142:143] op_sel_hi:[0,1,1] neg_lo:[1,0,0] neg_hi:[1,0,0]
    v_pk_fma_f32 v[148:149], v[12:13], v[24:25], v[148:149] op_sel_hi:[0,1,1] neg_lo:[1,0,0] neg_hi:[1,0,0]
    v_pk_fma_f32 v[150:151], v[12:13], v[26:27], v[150:151] op_sel_hi:[0,1,1] neg_lo:[1,0,0] neg_hi:[1,0,0]
    v_pk_fma_f32 v[156:157], v[12:13], v[28:29], v[156:157] op_sel_hi:[0,1,1] neg_lo:[1,0,0] neg_hi:[1,0,0]
    v_pk_fma_f32 v[158:159], v[12:13], v[30:31], v[158:159] op_sel_hi:[0,1,1] neg_lo:[1,0,0] neg_hi:[1,0,0]
    v_pk_mul_f32 v[132:133], v[14:15], v[132:133] op_sel_hi:[0,1]
    v_pk_mul_f32 v[134:135], v[14:15], v[134:135] op_sel_hi:[0,1]
    v_pk_mul_f32 v[140:141], v[14:15], v[140:141] op_sel_hi:[0,1]
    v_pk_mul_f32 v[142:143], v[14:15], v[142:143] op_sel_hi:[0,1]
    v_pk_mul_f32 v[148:149], v[14:15], v[148:149] op_sel_hi:[0,1]
    v_pk_mul_f32 v[150:151], v[14:15], v[150:151] op_sel_hi:[0,1]
    v_pk_mul_f32 v[156:157], v[14:15], v[156:157] op_sel_hi:[0,1]
    v_pk_mul_f32 v[158:159], v[14:15], v[158:159] op_sel_hi:[0,1]
    v_cvt_pk_bf16_f32 v132, v132, v133
    v_cvt_pk_bf16_f32 v133, v134, v135
    v_cvt_pk_bf16_f32 v134, v140, v141
    v_cvt_pk_bf16_f32 v135, v142, v143
    v_cvt_pk_bf16_f32 v148, v148, v149
    v_cvt_pk_bf16_f32 v149, v150, v151
    v_cvt_pk_bf16_f32 v150, v156, v157
    v_cvt_pk_bf16_f32 v151, v158, v159
    v_mfma_f32_16x16x32_bf16 v[172:175], v[68:71], v[132:135], v[120:123]
    v_mfma_f32_16x16x32_bf16 v[168:171], v[64:67], v[132:135], v[124:127]
    v_mfma_f32_16x16x32_bf16 v[188:191], v[84:87], v[148:151], v[120:123]
    v_mfma_f32_16x16x32_bf16 v[184:187], v[80:83], v[148:151], v[124:127]
    v_pk_fma_f32 v[128:129], v[8:9], v[16:17], v[128:129] op_sel_hi:[0,1,1] neg_lo:[1,0,0] neg_hi:[1,0,0]
    v_pk_fma_f32 v[130:131], v[8:9], v[18:19], v[130:131] op_sel_hi:[0,1,1] neg_lo:[1,0,0] neg_hi:[1,0,0]
    v_pk_fma_f32 v[136:137], v[8:9], v[20:21], v[136:137] op_sel_hi:[0,1,1] neg_lo:[1,0,0] neg_hi:[1,0,0]
    v_pk_fma_f32 v[138:139], v[8:9], v[22:23], v[138:139] op_sel_hi:[0,1,1] neg_lo:[1,0,0] neg_hi:[1,0,0]
    v_pk_fma_f32 v[144:145], v[8:9], v[24:25], v[144:145] op_sel_hi:[0,1,1] neg_lo:[1,0,0] neg_hi:[1,0,0]
    v_pk_fma_f32 v[146:147], v[8:9], v[26:27], v[146:147] op_sel_hi:[0,1,1] neg_lo:[1,0,0] neg_hi:[1,0,0]
    v_pk_fma_f32 v[152:153], v[8:9], v[28:29], v[152:153] op_sel_hi:[0,1,1] neg_lo:[1,0,0] neg_hi:[1,0,0]
    v_pk_fma_f32 v[154:155], v[8:9], v[30:31], v[154:155] op_sel_hi:[0,1,1] neg_lo:[1,0,0] neg_hi:[1,0,0]
    v_pk_mul_f32 v[128:129], v[10:11], v[128:129] op_sel_hi:[0,1]
    v_pk_mul_f32 v[130:131], v[10:11], v[130:131] op_sel_hi:[0,1]
    v_pk_mul_f32 v[136:137], v[10:11], v[136:137] op_sel_hi:[0,1]
    v_pk_mul_f32 v[138:139], v[10:11], v[138:139] op_sel_hi:[0,1]
    v_pk_mul_f32 v[144:145], v[10:11], v[144:145] op_sel_hi:[0,1]
    v_pk_mul_f32 v[146:147], v[10:11], v[146:147] op_sel_hi:[0,1]
    v_pk_mul_f32 v[152:153], v[10:11], v[152:153] op_sel_hi:[0,1]
    v_pk_mul_f32 v[154:155], v[10:11], v[154:155] op_sel_hi:[0,1]
    v_cvt_pk_bf16_f32 v128, v128, v129
    v_cvt_pk_bf16_f32 v129, v130, v131
    v_cvt_pk_bf16_f32 v130, v136, v137
    v_cvt_pk_bf16_f32 v131, v138, v139
    v_cvt_pk_bf16_f32 v144, v144, v145
    v_cvt_pk_bf16_f32 v145, v146, v147
    v_cvt_pk_bf16_f32 v146, v152, v153
    v_cvt_pk_bf16_f32 v147, v154, v155
    v_mfma_f32_16x16x32_bf16 v[164:167], v[64:67], v[128:131], v[120:123]
    s_nop 0
    v_mfma_f32_16x16x32_bf16 v[180:183], v[80:83], v[144:147], v[120:123]
    v_mov_b32 v232, 0x3f803f80
    v_mov_b32 v233, 0x3f803f80
    v_mov_b32 v234, 0x3f803f80
    v_mov_b32 v235, 0x3f803f80
    v_exp_f32 v172, v172
    v_exp_f32 v173, v173
    v_exp_f32 v174, v174
    v_exp_f32 v175, v175
    v_exp_f32 v188, v188
    v_exp_f32 v189, v189
    v_exp_f32 v190, v190
    v_exp_f32 v191, v191
    s_mov_b32 s46, 1006632960
a_exp1:
    v_exp_f32 v168, v168
    v_exp_f32 v169, v169
    v_exp_f32 v170, v170
    v_exp_f32 v171, v171
    v_exp_f32 v184, v184
    v_exp_f32 v185, v185
    v_exp_f32 v186, v186
    v_exp_f32 v187, v187
    v_cvt_pk_bf16_f32 v200, v168, v169
    v_cvt_pk_bf16_f32 v201, v170, v171
    v_cvt_pk_bf16_f32 v202, v172, v173
    v_cvt_pk_bf16_f32 v203, v174, v175
    v_cvt_pk_bf16_f32 v204, v184, v185
    v_cvt_pk_bf16_f32 v205, v186, v187
    v_cvt_pk_bf16_f32 v206, v188, v189
    v_cvt_pk_bf16_f32 v207, v190, v191
    v_mfma_f32_16x16x32_bf16 v[16:19], v[232:235], v[200:203], 0
    s_nop 0
    v_mfma_f32_16x16x32_bf16 v[20:23], v[232:235], v[204:207], 0
    v_mfma_f32_16x16x32_bf16 v[40:43], v[72:75], v[200:203], 0
    v_mfma_f32_16x16x32_bf16 v[44:47], v[76:79], v[200:203], 0
    v_mfma_f32_16x16x32_bf16 v[56:59], v[88:91], v[204:207], 0
    v_mfma_f32_16x16x32_bf16 v[60:63], v[92:95], v[204:207], 0
    v_mov_b32 v218, v72
    v_mov_b32 v219, v73
    v_mov_b32 v222, v76
    v_mov_b32 v223, v77
    v_mov_b32 v226, v88
    v_mov_b32 v227, v89
    v_mov_b32 v230, v92
    v_mov_b32 v231, v93
    v_subrev_u32 v18, 0x21800000, v16
    v_subrev_u32 v22, 0x21800000, v20
    v_max_u32 v18, v18, v22
    v_cmp_le_u32 vcc, s46, v18
    v_rcp_f32 v16, v16
    v_rcp_f32 v20, v20
    s_cbranch_vccnz a_slow1
a_fin1:
    v_pk_mul_f32 v[40:41], v[16:17], v[40:41] op_sel_hi:[0,1]
    v_pk_mul_f32 v[42:43], v[16:17], v[42:43] op_sel_hi:[0,1]
    v_pk_mul_f32 v[44:45], v[16:17], v[44:45] op_sel_hi:[0,1]
    v_pk_mul_f32 v[46:47], v[16:17], v[46:47] op_sel_hi:[0,1]
    v_pk_mul_f32 v[56:57], v[20:21], v[56:57] op_sel_hi:[0,1]
    v_pk_mul_f32 v[58:59], v[20:21], v[58:59] op_sel_hi:[0,1]
    v_pk_mul_f32 v[60:61], v[20:21], v[60:61] op_sel_hi:[0,1]
    v_pk_mul_f32 v[62:63], v[20:21], v[62:63] op_sel_hi:[0,1]
    v_cvt_pk_bf16_f32 v40, v40, v41
    v_cvt_pk_bf16_f32 v41, v42, v43
    v_cvt_pk_bf16_f32 v42, v44, v45
    v_cvt_pk_bf16_f32 v43, v46, v47
    v_cvt_pk_bf16_f32 v56, v56, v57
    v_cvt_pk_bf16_f32 v57, v58, v59
    v_cvt_pk_bf16_f32 v58, v60, v61
    v_cvt_pk_bf16_f32 v59, v62, v63
    v_permlane32_swap_b32 v40, v42
    v_permlane32_swap_b32 v41, v43
    buffer_store_dwordx4 v[40:43], v2, s[4:7], s52 offen offset:256 sc1
    v_permlane32_swap_b32 v56, v58
    v_permlane32_swap_b32 v57, v59
    buffer_store_dwordx4 v[56:59], v2, s[4:7], s52 offen offset:2304 sc1
    s_cmp_lg_u32 s38, 0
    s_cbranch_scc1 a_hasprev
    v_mov_b32 v124, 0xf149f2ca
    v_mov_b32 v125, 0xf149f2ca
    v_mov_b32 v126, 0xf149f2ca
    v_mov_b32 v127, 0xf149f2ca
a_hasprev:
    s_waitcnt lgkmcnt(0)
    s_barrier
    ds_read_b128 v[192:195], v7 offset:0
    ds_read_b128 v[196:199], v7 offset:1024
    ds_read_b64 v[216:217], v7 offset:2048
    ds_read_b64 v[220:221], v7 offset:2056
    ds_read_b64 v[224:225], v7 offset:3072
    ds_read_b64 v[228:229], v7 offset:3080
    s_waitcnt lgkmcnt(4)
    v_mfma_f32_16x16x32_bf16 v[160:163], v[192:195], v[128:131], v[124:127]
    v_mfma_f32_16x16x32_bf16 v[176:179], v[196:199], v[144:147], v[124:127]
    v_exp_f32 v164, v164
    v_exp_f32 v165, v165
    v_exp_f32 v166, v166
    v_exp_f32 v167, v167
    v_exp_f32 v180, v180
    v_exp_f32 v181, v181
    v_exp_f32 v182, v182
    v_exp_f32 v183, v183
    s_waitcnt lgkmcnt(0)
    s_mov_b32 s46, 1006632960
a_exp0:
    v_exp_f32 v160, v160
    v_exp_f32 v161, v161
    v_exp_f32 v162, v162
    v_exp_f32 v163, v163
    v_exp_f32 v176, v176
    v_exp_f32 v177, v177
    v_exp_f32 v178, v178
    v_exp_f32 v179, v179
    v_cvt_pk_bf16_f32 v200, v160, v161
    v_cvt_pk_bf16_f32 v201, v162, v163
    v_cvt_pk_bf16_f32 v202, v164, v165
    v_cvt_pk_bf16_f32 v203, v166, v167
    v_cvt_pk_bf16_f32 v204, v176, v177
    v_cvt_pk_bf16_f32 v205, v178, v179
    v_cvt_pk_bf16_f32 v206, v180, v181
    v_cvt_pk_bf16_f32 v207, v182, v183
    v_mfma_f32_16x16x32_bf16 v[16:19], v[232:235], v[200:203], 0
    s_nop 0
    v_mfma_f32_16x16x32_bf16 v[20:23], v[232:235], v[204:207], 0
    v_mfma_f32_16x16x32_bf16 v[32:35], v[216:219], v[200:203], 0
    v_mfma_f32_16x16x32_bf16 v[36:39], v[220:223], v[200:203], 0
    v_mfma_f32_16x16x32_bf16 v[48:51], v[224:227], v[204:207], 0
    v_mfma_f32_16x16x32_bf16 v[52:55], v[228:231], v[204:207], 0
    s_nop 1
    v_subrev_u32 v18, 0x21800000, v16
    s_nop 0
    v_subrev_u32 v22, 0x21800000, v20
    v_max_u32 v18, v18, v22
    v_cmp_le_u32 vcc, s46, v18
    v_rcp_f32 v16, v16
    v_rcp_f32 v20, v20
    s_cbranch_vccnz a_slow0
a_fin0:
    v_pk_mul_f32 v[32:33], v[16:17], v[32:33] op_sel_hi:[0,1]
    v_pk_mul_f32 v[34:35], v[16:17], v[34:35] op_sel_hi:[0,1]
    v_pk_mul_f32 v[36:37], v[16:17], v[36:37] op_sel_hi:[0,1]
    v_pk_mul_f32 v[38:39], v[16:17], v[38:39] op_sel_hi:[0,1]
    v_pk_mul_f32 v[48:49], v[20:21], v[48:49] op_sel_hi:[0,1]
    v_pk_mul_f32 v[50:51], v[20:21], v[50:51] op_sel_hi:[0,1]
    v_pk_mul_f32 v[52:53], v[20:21], v[52:53] op_sel_hi:[0,1]
    v_pk_mul_f32 v[54:55], v[20:21], v[54:55] op_sel_hi:[0,1]
    v_cvt_pk_bf16_f32 v32, v32, v33
    v_cvt_pk_bf16_f32 v33, v34, v35
    v_cvt_pk_bf16_f32 v34, v36, v37
    v_cvt_pk_bf16_f32 v35, v38, v39
    v_cvt_pk_bf16_f32 v48, v48, v49
    v_cvt_pk_bf16_f32 v49, v50, v51
    v_cvt_pk_bf16_f32 v50, v52, v53
    v_cvt_pk_bf16_f32 v51, v54, v55
    v_permlane32_swap_b32 v32, v34
    v_permlane32_swap_b32 v33, v35
    buffer_store_dwordx4 v[32:35], v2, s[4:7], s52 offen offset:0 sc1
    v_permlane32_swap_b32 v48, v50
    v_permlane32_swap_b32 v49, v51
    buffer_store_dwordx4 v[48:51], v2, s[4:7], s52 offen offset:2048 sc1
    s_lshl_b32 s44, s21, 22
    s_lshl_b32 s45, s39, 16
    s_add_u32 s41, s44, s45
    s_lshl_b32 s45, s20, 12
    s_add_u32 s43, s41, s45
    s_and_b32 s45, s45, 0
    s_add_u32 s41, s41, s45
    s_add_u32 s41, s41, 16777216
    buffer_load_dwordx4 v[224:227], v2, s[4:7], s43 offen offset:0 sc1
    buffer_load_dwordx4 v[228:231], v2, s[4:7], s43 offen offset:256 sc1
    buffer_load_dwordx4 v[232:235], v2, s[4:7], s43 offen offset:2048 sc1
    buffer_load_dwordx4 v[236:239], v2, s[4:7], s43 offen offset:2304 sc1
    s_barrier
    s_lshl_b32 s46, s21, 14
    s_lshl_b32 s67, s38, 8
    s_add_u32 s46, s46, s67
    s_add_u32 s46, s46, 86144
    s_lshl_b32 s47, s21, 14
    s_lshl_b32 s67, s39, 8
    s_add_u32 s47, s47, s67
    s_add_u32 s47, s47, 86144
    s_waitcnt vmcnt(4)
    s_atomic_add s40, s[22:23], s46
    s_mov_b32 s66, 0x10000
c_o_poll:
    s_mov_b32 s68, 0
    s_atomic_add s68, s[22:23], s47 offset:0 glc
    s_sub_u32 s66, s66, 1
    s_cselect_b32 s67, 16, 0
    s_waitcnt lgkmcnt(0)
    s_max_u32 s68, s68, s67
    s_cmp_lt_u32 s68, 16
    s_cbranch_scc1 c_o_poll
c_o_ok:
    s_branch c_wo
a_slow1:
    s_cmp_eq_u32 s46, 0
    s_cbranch_scc1 a_fin1
    s_mov_b32 s46, 0
    v_mfma_f32_16x16x32_bf16 v[172:175], v[68:71], v[132:135], v[120:123]
    v_mfma_f32_16x16x32_bf16 v[168:171], v[64:67], v[132:135], v[124:127]
    v_mfma_f32_16x16x32_bf16 v[188:191], v[84:87], v[148:151], v[120:123]
    v_mfma_f32_16x16x32_bf16 v[184:187], v[80:83], v[148:151], v[124:127]
    s_nop 5
    v_max3_f32 v24, v168, v169, v170
    v_max3_f32 v24, v24, v171, v172
    v_max3_f32 v24, v24, v173, v174
    v_max_f32 v24, v24, v175
    v_max3_f32 v26, v184, v185, v186
    v_max3_f32 v26, v26, v187, v188
    v_max3_f32 v26, v26, v189, v190
    v_max_f32 v26, v26, v191
    v_mov_b32 v25, v24
    v_mov_b32 v27, v26
    s_nop 0
    v_permlane32_swap_b32 v24, v25
    v_permlane32_swap_b32 v26, v27
    v_max_f32 v24, v24, v25
    v_max_f32 v26, v26, v27
    v_mov_b32 v25, v24
    v_mov_b32 v27, v26
    s_nop 0
    v_permlane16_swap_b32 v24, v25
    v_permlane16_swap_b32 v26, v27
    v_max_f32 v24, v24, v25
    v_max_f32 v26, v26, v27
    v_sub_f32 v168, v168, v24
    v_sub_f32 v169, v169, v24
    v_sub_f32 v170, v170, v24
    v_sub_f32 v171, v171, v24
    v_sub_f32 v172, v172, v24
    v_sub_f32 v173, v173, v24
    v_sub_f32 v174, v174, v24
    v_sub_f32 v175, v175, v24
    v_sub_f32 v184, v184, v26
    v_sub_f32 v185, v185, v26
    v_sub_f32 v186, v186, v26
    v_sub_f32 v187, v187, v26
    v_sub_f32 v188, v188, v26
    v_sub_f32 v189, v189, v26
    v_sub_f32 v190, v190, v26
    v_sub_f32 v191, v191, v26
    v_exp_f32 v172, v172
    v_exp_f32 v173, v173
    v_exp_f32 v174, v174
    v_exp_f32 v175, v175
    v_exp_f32 v188, v188
    v_exp_f32 v189, v189
    v_exp_f32 v190, v190
    v_exp_f32 v191, v191
    s_branch a_exp1
a_slow0:
    s_cmp_eq_u32 s46, 0
    s_cbranch_scc1 a_fin0
    s_mov_b32 s46, 0
    v_mfma_f32_16x16x32_bf16 v[164:167], v[64:67], v[128:131], v[120:123]
    v_mfma_f32_16x16x32_bf16 v[160:163], v[192:195], v[128:131], v[124:127]
    v_mfma_f32_16x16x32_bf16 v[180:183], v[80:83], v[144:147], v[120:123]
    v_mfma_f32_16x16x32_bf16 v[176:179], v[196:199], v[144:147], v[124:127]
    s_nop 5
    v_max3_f32 v24, v160, v161, v162
    v_max3_f32 v24, v24, v163, v164
    v_max3_f32 v24, v24, v165, v166
    v_max_f32 v24, v24, v167
    v_max3_f32 v26, v176, v177, v178
    v_max3_f32 v26, v26, v179, v180
    v_max3_f32 v26, v26, v181, v182
    v_max_f32 v26, v26, v183
    v_mov_b32 v25, v24
    v_mov_b32 v27, v26
    s_nop 0
    v_permlane32_swap_b32 v24, v25
    v_permlane32_swap_b32 v26, v27
    v_max_f32 v24, v24, v25
    v_max_f32 v26, v26, v27
    v_mov_b32 v25, v24
    v_mov_b32 v27, v26
    s_nop 0
    v_permlane16_swap_b32 v24, v25
    v_permlane16_swap_b32 v26, v27
    v_max_f32 v24, v24, v25
    v_max_f32 v26, v26, v27
    v_sub_f32 v160, v160, v24
    v_sub_f32 v161, v161, v24
    v_sub_f32 v162, v162, v24
    v_sub_f32 v163, v163, v24
    v_sub_f32 v164, v164, v24
    v_sub_f32 v165, v165, v24
    v_sub_f32 v166, v166, v24
    v_sub_f32 v167, v167, v24
    v_sub_f32 v176, v176, v26
    v_sub_f32 v177, v177, v26
    v_sub_f32 v178, v178, v26
    v_sub_f32 v179, v179, v26
    v_sub_f32 v180, v180, v26
    v_sub_f32 v181, v181, v26
    v_sub_f32 v182, v182, v26
    v_sub_f32 v183, v183, v26
    v_exp_f32 v164, v164
    v_exp_f32 v165, v165
    v_exp_f32 v166, v166
    v_exp_f32 v167, v167
    v_exp_f32 v180, v180
    v_exp_f32 v181, v181
    v_exp_f32 v182, v182
    v_exp_f32 v183, v183
    s_branch a_exp0
c_B:
    s_waitcnt lgkmcnt(6)
    v_pk_fma_f32 v[64:65], v[8:9], v[16:17], v[64:65] op_sel_hi:[0,1,1] neg_lo:[1,0,0] neg_hi:[1,0,0]
    v_pk_fma_f32 v[66:67], v[8:9], v[18:19], v[66:67] op_sel_hi:[0,1,1] neg_lo:[1,0,0] neg_hi:[1,0,0]
    v_pk_fma_f32 v[72:73], v[8:9], v[20:21], v[72:73] op_sel_hi:[0,1,1] neg_lo:[1,0,0] neg_hi:[1,0,0]
    v_pk_fma_f32 v[74:75], v[8:9], v[22:23], v[74:75] op_sel_hi:[0,1,1] neg_lo:[1,0,0] neg_hi:[1,0,0]
    v_pk_mul_f32 v[64:65], v[10:11], v[64:65] op_sel_hi:[0,1]
    v_pk_mul_f32 v[66:67], v[10:11], v[66:67] op_sel_hi:[0,1]
    v_pk_mul_f32 v[72:73], v[10:11], v[72:73] op_sel_hi:[0,1]
    v_pk_mul_f32 v[74:75], v[10:11], v[74:75] op_sel_hi:[0,1]
    v_cvt_pk_bf16_f32 v64, v64, v65
    v_cvt_pk_bf16_f32 v65, v66, v67
    v_cvt_pk_bf16_f32 v66, v72, v73
    v_cvt_pk_bf16_f32 v67, v74, v75
    s_add_u32 s55, s52, 0
    buffer_store_dwordx4 v[64:67], v2, s[4:7], s55 offen offset:0 sc1
    v_pk_fma_f32 v[68:69], v[12:13], v[16:17], v[68:69] op_sel_hi:[0,1,1] neg_lo:[1,0,0] neg_hi:[1,0,0]
    v_pk_fma_f32 v[70:71], v[12:13], v[18:19], v[70:71] op_sel_hi:[0,1,1] neg_lo:[1,0,0] neg_hi:[1,0,0]
    v_pk_fma_f32 v[76:77], v[12:13], v[20:21], v[76:77] op_sel_hi:[0,1,1] neg_lo:[1,0,0] neg_hi:[1,0,0]
    v_pk_fma_f32 v[78:79], v[12:13], v[22:23], v[78:79] op_sel_hi:[0,1,1] neg_lo:[1,0,0] neg_hi:[1,0,0]
    v_pk_mul_f32 v[68:69], v[14:15], v[68:69] op_sel_hi:[0,1]
    v_pk_mul_f32 v[70:71], v[14:15], v[70:71] op_sel_hi:[0,1]
    v_pk_mul_f32 v[76:77], v[14:15], v[76:77] op_sel_hi:[0,1]
    v_pk_mul_f32 v[78:79], v[14:15], v[78:79] op_sel_hi:[0,1]
    v_cvt_pk_bf16_f32 v68, v68, v69
    v_cvt_pk_bf16_f32 v69, v70, v71
    v_cvt_pk_bf16_f32 v70, v76, v77
    v_cvt_pk_bf16_f32 v71, v78, v79
    buffer_store_dwordx4 v[68:71], v2, s[4:7], s55 offen offset:256 sc1
    v_pk_fma_f32 v[80:81], v[8:9], v[24:25], v[80:81] op_sel_hi:[0,1,1] neg_lo:[1,0,0] neg_hi:[1,0,0]
    v_pk_fma_f32 v[82:83], v[8:9], v[26:27], v[82:83] op_sel_hi:[0,1,1] neg_lo:[1,0,0] neg_hi:[1,0,0]
    v_pk_fma_f32 v[88:89], v[8:9], v[28:29], v[88:89] op_sel_hi:[0,1,1] neg_lo:[1,0,0] neg_hi:[1,0,0]
    v_pk_fma_f32 v[90:91], v[8:9], v[30:31], v[90:91] op_sel_hi:[0,1,1] neg_lo:[1,0,0] neg_hi:[1,0,0]
    v_pk_mul_f32 v[80:81], v[10:11], v[80:81] op_sel_hi:[0,1]
    v_pk_mul_f32 v[82:83], v[10:11], v[82:83] op_sel_hi:[0,1]
    v_pk_mul_f32 v[88:89], v[10:11], v[88:89] op_sel_hi:[0,1]
    v_pk_mul_f32 v[90:91], v[10:11], v[90:91] op_sel_hi:[0,1]
    v_cvt_pk_bf16_f32 v80, v80, v81
    v_cvt_pk_bf16_f32 v81, v82, v83
    v_cvt_pk_bf16_f32 v82, v88, v89
    v_cvt_pk_bf16_f32 v83, v90, v91
    s_add_u32 s55, s52, 131072
    buffer_store_dwordx4 v[80:83], v2, s[4:7], s55 offen offset:0 sc1
    v_pk_fma_f32 v[84:85], v[12:13], v[24:25], v[84:85] op_sel_hi:[0,1,1] neg_lo:[1,0,0] neg_hi:[1,0,0]
    v_pk_fma_f32 v[86:87], v[12:13], v[26:27], v[86:87] op_sel_hi:[0,1,1] neg_lo:[1,0,0] neg_hi:[1,0,0]
    v_pk_fma_f32 v[92:93], v[12:13], v[28:29], v[92:93] op_sel_hi:[0,1,1] neg_lo:[1,0,0] neg_hi:[1,0,0]
    v_pk_fma_f32 v[94:95], v[12:13], v[30:31], v[94:95] op_sel_hi:[0,1,1] neg_lo:[1,0,0] neg_hi:[1,0,0]
    v_pk_mul_f32 v[84:85], v[14:15], v[84:85] op_sel_hi:[0,1]
    v_pk_mul_f32 v[86:87], v[14:15], v[86:87] op_sel_hi:[0,1]
    v_pk_mul_f32 v[92:93], v[14:15], v[92:93] op_sel_hi:[0,1]
    v_pk_mul_f32 v[94:95], v[14:15], v[94:95] op_sel_hi:[0,1]
    v_cvt_pk_bf16_f32 v84, v84, v85
    v_cvt_pk_bf16_f32 v85, v86, v87
    v_cvt_pk_bf16_f32 v86, v92, v93
    v_cvt_pk_bf16_f32 v87, v94, v95
    buffer_store_dwordx4 v[84:87], v2, s[4:7], s55 offen offset:256 sc1
    v_mfma_f32_16x16x32_bf16 v[96:99], v[160:163], v[32:35], v[96:99]
    ds_read_b64_tr_b16 v[60:61], v6 offset:53248
    v_mfma_f32_16x16x32_bf16 v[100:103], v[164:167], v[32:35], v[100:103]
    ds_read_b64_tr_b16 v[62:63], v6 offset:54272
    v_mfma_f32_16x16x32_bf16 v[104:107], v[160:163], v[36:39], v[104:107]
    ds_read_b64_tr_b16 v[32:33], v3 offset:57344
    v_mfma_f32_16x16x32_bf16 v[108:111], v[164:167], v[36:39], v[108:111]
    ds_read_b64_tr_b16 v[34:35], v3 offset:58368
    v_mfma_f32_16x16x32_bf16 v[112:115], v[160:163], v[40:43], v[112:115]
    ds_read_b64_tr_b16 v[36:37], v4 offset:57344
    v_mfma_f32_16x16x32_bf16 v[116:119], v[164:167], v[40:43], v[116:119]
    ds_read_b64_tr_b16 v[38:39], v4 offset:58368
    v_mfma_f32_16x16x32_bf16 v[120:123], v[160:163], v[44:47], v[120:123]
    ds_read_b64_tr_b16 v[40:41], v5 offset:57344
    v_mfma_f32_16x16x32_bf16 v[124:127], v[164:167], v[44:47], v[124:127]
    ds_read_b64_tr_b16 v[42:43], v5 offset:58368
    s_waitcnt lgkmcnt(10)
    v_mfma_f32_16x16x32_bf16 v[96:99], v[168:171], v[48:51], v[96:99]
    ds_read_b64_tr_b16 v[44:45], v6 offset:57344
    v_mfma_f32_16x16x32_bf16 v[100:103], v[172:175], v[48:51], v[100:103]
    ds_read_b64_tr_b16 v[46:47], v6 offset:58368
    v_mfma_f32_16x16x32_bf16 v[104:107], v[168:171], v[52:55], v[104:107]
    ds_read_b64_tr_b16 v[48:49], v3 offset:61440
    v_mfma_f32_16x16x32_bf16 v[108:111], v[172:175], v[52:55], v[108:111]
    ds_read_b64_tr_b16 v[50:51], v3 offset:62464
    s_waitcnt lgkmcnt(10)
    v_mfma_f32_16x16x32_bf16 v[112:115], v[168:171], v[56:59], v[112:115]
    ds_read_b64_tr_b16 v[52:53], v4 offset:61440
    v_mfma_f32_16x16x32_bf16 v[116:119], v[172:175], v[56:59], v[116:119]
    ds_read_b64_tr_b16 v[54:55], v4 offset:62464
    v_mfma_f32_16x16x32_bf16 v[120:123], v[168:171], v[60:63], v[120:123]
    ds_read_b64_tr_b16 v[56:57], v5 offset:61440
    v_mfma_f32_16x16x32_bf16 v[124:127], v[172:175], v[60:63], v[124:127]
    ds_read_b64_tr_b16 v[58:59], v5 offset:62464
    s_waitcnt lgkmcnt(10)
    v_mfma_f32_16x16x32_bf16 v[96:99], v[176:179], v[32:35], v[96:99]
    ds_read_b64_tr_b16 v[60:61], v6 offset:61440
    v_mfma_f32_16x16x32_bf16 v[100:103], v[180:183], v[32:35], v[100:103]
    ds_read_b64_tr_b16 v[62:63], v6 offset:62464
    s_barrier
    v_xor_b32 v3, 0x10000, v3
    v_xor_b32 v4, 0x10000, v4
    v_xor_b32 v5, 0x10000, v5
    v_xor_b32 v6, 0x10000, v6
    v_mfma_f32_16x16x32_bf16 v[104:107], v[176:179], v[36:39], v[104:107]
    ds_read_b64_tr_b16 v[32:33], v3 offset:0
    v_mfma_f32_16x16x32_bf16 v[108:111], v[180:183], v[36:39], v[108:111]
    ds_read_b64_tr_b16 v[34:35], v3 offset:1024
    s_waitcnt lgkmcnt(10)
    v_mfma_f32_16x16x32_bf16 v[112:115], v[176:179], v[40:43], v[112:115]
    ds_read_b64_tr_b16 v[36:37], v4 offset:0
    v_mfma_f32_16x16x32_bf16 v[116:119], v[180:183], v[40:43], v[116:119]
    ds_read_b64_tr_b16 v[38:39], v4 offset:1024
    v_mfma_f32_16x16x32_bf16 v[120:123], v[176:179], v[44:47], v[120:123]
    ds_read_b64_tr_b16 v[40:41], v5 offset:0
    v_mfma_f32_16x16x32_bf16 v[124:127], v[180:183], v[44:47], v[124:127]
    ds_read_b64_tr_b16 v[42:43], v5 offset:1024
    s_waitcnt lgkmcnt(10)
    v_mfma_f32_16x16x32_bf16 v[96:99], v[184:187], v[48:51], v[96:99]
    ds_read_b64_tr_b16 v[44:45], v6 offset:0
    v_mfma_f32_16x16x32_bf16 v[100:103], v[188:191], v[48:51], v[100:103]
    ds_read_b64_tr_b16 v[46:47], v6 offset:1024
    v_mfma_f32_16x16x32_bf16 v[104:107], v[184:187], v[52:55], v[104:107]
    ds_read_b64_tr_b16 v[48:49], v3 offset:4096
    v_mfma_f32_16x16x32_bf16 v[108:111], v[188:191], v[52:55], v[108:111]
    ds_read_b64_tr_b16 v[50:51], v3 offset:5120
    s_waitcnt lgkmcnt(10)
    v_mfma_f32_16x16x32_bf16 v[112:115], v[184:187], v[56:59], v[112:115]
    ds_read_b64_tr_b16 v[52:53], v4 offset:4096
    v_mfma_f32_16x16x32_bf16 v[116:119], v[188:191], v[56:59], v[116:119]
    ds_read_b64_tr_b16 v[54:55], v4 offset:5120
    v_mfma_f32_16x16x32_bf16 v[120:123], v[184:187], v[60:63], v[120:123]
    ds_read_b64_tr_b16 v[56:57], v5 offset:4096
    v_mfma_f32_16x16x32_bf16 v[124:127], v[188:191], v[60:63], v[124:127]
    ds_read_b64_tr_b16 v[58:59], v5 offset:5120
    s_waitcnt lgkmcnt(10)
    v_mfma_f32_16x16x32_bf16 v[96:99], v[192:195], v[32:35], v[96:99]
    ds_read_b64_tr_b16 v[60:61], v6 offset:4096
    v_mfma_f32_16x16x32_bf16 v[100:103], v[196:199], v[32:35], v[100:103]
    ds_read_b64_tr_b16 v[62:63], v6 offset:5120
    v_mfma_f32_16x16x32_bf16 v[104:107], v[192:195], v[36:39], v[104:107]
    ds_read_b64_tr_b16 v[32:33], v3 offset:8192
    v_mfma_f32_16x16x32_bf16 v[108:111], v[196:199], v[36:39], v[108:111]
    ds_read_b64_tr_b16 v[34:35], v3 offset:9216
    s_waitcnt lgkmcnt(10)
    v_mfma_f32_16x16x32_bf16 v[112:115], v[192:195], v[40:43], v[112:115]
    ds_read_b64_tr_b16 v[36:37], v4 offset:8192
    v_mfma_f32_16x16x32_bf16 v[116:119], v[196:199], v[40:43], v[116:119]
    ds_read_b64_tr_b16 v[38:39], v4 offset:9216
    v_mfma_f32_16x16x32_bf16 v[120:123], v[192:195], v[44:47], v[120:123]
    ds_read_b64_tr_b16 v[40:41], v5 offset:8192
    v_mfma_f32_16x16x32_bf16 v[124:127], v[196:199], v[44:47], v[124:127]
    ds_read_b64_tr_b16 v[42:43], v5 offset:9216
    s_waitcnt lgkmcnt(10)
    v_mfma_f32_16x16x32_bf16 v[96:99], v[200:203], v[48:51], v[96:99]
    ds_read_b64_tr_b16 v[44:45], v6 offset:8192
    v_mfma_f32_16x16x32_bf16 v[100:103], v[204:207], v[48:51], v[100:103]
    ds_read_b64_tr_b16 v[46:47], v6 offset:9216
    v_mfma_f32_16x16x32_bf16 v[104:107], v[200:203], v[52:55], v[104:107]
    ds_read_b64_tr_b16 v[48:49], v3 offset:12288
    v_mfma_f32_16x16x32_bf16 v[108:111], v[204:207], v[52:55], v[108:111]
    ds_read_b64_tr_b16 v[50:51], v3 offset:13312
    s_waitcnt lgkmcnt(10)
    v_mfma_f32_16x16x32_bf16 v[112:115], v[200:203], v[56:59], v[112:115]
    ds_read_b64_tr_b16 v[52:53], v4 offset:12288
    v_mfma_f32_16x16x32_bf16 v[116:119], v[204:207], v[56:59], v[116:119]
    ds_read_b64_tr_b16 v[54:55], v4 offset:13312
    v_mfma_f32_16x16x32_bf16 v[120:123], v[200:203], v[60:63], v[120:123]
    ds_read_b64_tr_b16 v[56:57], v5 offset:12288
    v_mfma_f32_16x16x32_bf16 v[124:127], v[204:207], v[60:63], v[124:127]
    ds_read_b64_tr_b16 v[58:59], v5 offset:13312
    s_waitcnt lgkmcnt(10)
    v_mfma_f32_16x16x32_bf16 v[96:99], v[208:211], v[32:35], v[96:99]
    ds_read_b64_tr_b16 v[60:61], v6 offset:12288
    v_mfma_f32_16x16x32_bf16 v[100:103], v[212:215], v[32:35], v[100:103]
    ds_read_b64_tr_b16 v[62:63], v6 offset:13312
    v_mfma_f32_16x16x32_bf16 v[104:107], v[208:211], v[36:39], v[104:107]
    ds_read_b64_tr_b16 v[32:33], v3 offset:16384
    ds_read_b128 v[16:19], v13 offset:4096
    v_mfma_f32_16x16x32_bf16 v[108:111], v[212:215], v[36:39], v[108:111]
    ds_read_b64_tr_b16 v[34:35], v3 offset:17408
    ds_read_b128 v[20:23], v13 offset:4608
    s_waitcnt lgkmcnt(12)
    v_mfma_f32_16x16x32_bf16 v[112:115], v[208:211], v[40:43], v[112:115]
    ds_read_b64_tr_b16 v[36:37], v4 offset:16384
    ds_read_b128 v[24:27], v13 offset:4160
    v_mfma_f32_16x16x32_bf16 v[116:119], v[212:215], v[40:43], v[116:119]
    ds_read_b64_tr_b16 v[38:39], v4 offset:17408
    ds_read_b128 v[28:31], v13 offset:4672
    v_mfma_f32_16x16x32_bf16 v[120:123], v[208:211], v[44:47], v[120:123]
    ds_read_b64_tr_b16 v[40:41], v5 offset:16384
    ds_read_b32 v8, v15 offset:512
    v_mfma_f32_16x16x32_bf16 v[124:127], v[212:215], v[44:47], v[124:127]
    ds_read_b64_tr_b16 v[42:43], v5 offset:17408
    ds_read_b32 v10, v15 offset:576
    s_waitcnt lgkmcnt(14)
    v_mfma_f32_16x16x32_bf16 v[96:99], v[216:219], v[48:51], v[96:99]
    ds_read_b64_tr_b16 v[44:45], v6 offset:16384
    ds_read_b32 v12, v15 offset:640
    v_mfma_f32_16x16x32_bf16 v[100:103], v[220:223], v[48:51], v[100:103]
    ds_read_b64_tr_b16 v[46:47], v6 offset:17408
    ds_read_b32 v14, v15 offset:704
    v_mfma_f32_16x16x32_bf16 v[104:107], v[216:219], v[52:55], v[104:107]
    ds_read_b64_tr_b16 v[48:49], v3 offset:20480
    v_mfma_f32_16x16x32_bf16 v[108:111], v[220:223], v[52:55], v[108:111]
    ds_read_b64_tr_b16 v[50:51], v3 offset:21504
    s_waitcnt lgkmcnt(14)
    v_mfma_f32_16x16x32_bf16 v[112:115], v[216:219], v[56:59], v[112:115]
    ds_read_b64_tr_b16 v[52:53], v4 offset:20480
    v_mfma_f32_16x16x32_bf16 v[116:119], v[220:223], v[56:59], v[116:119]
    ds_read_b64_tr_b16 v[54:55], v4 offset:21504
    v_mfma_f32_16x16x32_bf16 v[120:123], v[216:219], v[60:63], v[120:123]
    ds_read_b64_tr_b16 v[56:57], v5 offset:20480
    v_mfma_f32_16x16x32_bf16 v[124:127], v[220:223], v[60:63], v[124:127]
    ds_read_b64_tr_b16 v[58:59], v5 offset:21504
    s_waitcnt lgkmcnt(6)
    v_pk_fma_f32 v[96:97], v[8:9], v[16:17], v[96:97] op_sel_hi:[0,1,1] neg_lo:[1,0,0] neg_hi:[1,0,0]
    v_pk_fma_f32 v[98:99], v[8:9], v[18:19], v[98:99] op_sel_hi:[0,1,1] neg_lo:[1,0,0] neg_hi:[1,0,0]
    v_pk_fma_f32 v[104:105], v[10:11], v[16:17], v[104:105] op_sel_hi:[0,1,1] neg_lo:[1,0,0] neg_hi:[1,0,0]
    v_pk_fma_f32 v[106:107], v[10:11], v[18:19], v[106:107] op_sel_hi:[0,1,1] neg_lo:[1,0,0] neg_hi:[1,0,0]
    v_pk_mul_f32 v[96:97], v[20:21], v[96:97]
    v_pk_mul_f32 v[98:99], v[22:23], v[98:99]
    v_pk_mul_f32 v[104:105], v[20:21], v[104:105]
    v_pk_mul_f32 v[106:107], v[22:23], v[106:107]
    v_cvt_pk_bf16_f32 v72, v96, v97
    v_cvt_pk_bf16_f32 v73, v98, v99
    v_cvt_pk_bf16_f32 v74, v104, v105
    v_cvt_pk_bf16_f32 v75, v106, v107
    s_add_u32 s56, s52, 4194304
    v_permlane16_swap_b32 v72, v74
    v_permlane16_swap_b32 v73, v75
    buffer_store_dwordx4 v[72:75], v1, s[4:7], s56 offen offset:0 sc1
    v_pk_fma_f32 v[112:113], v[12:13], v[16:17], v[112:113] op_sel_hi:[0,1,1] neg_lo:[1,0,0] neg_hi:[1,0,0]
    v_pk_fma_f32 v[114:115], v[12:13], v[18:19], v[114:115] op_sel_hi:[0,1,1] neg_lo:[1,0,0] neg_hi:[1,0,0]
    v_pk_fma_f32 v[120:121], v[14:15], v[16:17], v[120:121] op_sel_hi:[0,1,1] neg_lo:[1,0,0] neg_hi:[1,0,0]
    v_pk_fma_f32 v[122:123], v[14:15], v[18:19], v[122:123] op_sel_hi:[0,1,1] neg_lo:[1,0,0] neg_hi:[1,0,0]
    v_pk_mul_f32 v[112:113], v[20:21], v[112:113]
    v_pk_mul_f32 v[114:115], v[22:23], v[114:115]
    v_pk_mul_f32 v[120:121], v[20:21], v[120:121]
    v_pk_mul_f32 v[122:123], v[22:23], v[122:123]
    v_cvt_pk_bf16_f32 v88, v112, v113
    v_cvt_pk_bf16_f32 v89, v114, v115
    v_cvt_pk_bf16_f32 v90, v120, v121
    v_cvt_pk_bf16_f32 v91, v122, v123
    s_add_u32 s56, s52, 4325376
    v_permlane16_swap_b32 v88, v90
    v_permlane16_swap_b32 v89, v91
    buffer_store_dwordx4 v[88:91], v1, s[4:7], s56 offen offset:0 sc1
    v_pk_fma_f32 v[100:101], v[8:9], v[24:25], v[100:101] op_sel_hi:[0,1,1] neg_lo:[1,0,0] neg_hi:[1,0,0]
    v_pk_fma_f32 v[102:103], v[8:9], v[26:27], v[102:103] op_sel_hi:[0,1,1] neg_lo:[1,0,0] neg_hi:[1,0,0]
    v_pk_fma_f32 v[108:109], v[10:11], v[24:25], v[108:109] op_sel_hi:[0,1,1] neg_lo:[1,0,0] neg_hi:[1,0,0]
    v_pk_fma_f32 v[110:111], v[10:11], v[26:27], v[110:111] op_sel_hi:[0,1,1] neg_lo:[1,0,0] neg_hi:[1,0,0]
    v_pk_mul_f32 v[100:101], v[28:29], v[100:101]
    v_pk_mul_f32 v[102:103], v[30:31], v[102:103]
    v_pk_mul_f32 v[108:109], v[28:29], v[108:109]
    v_pk_mul_f32 v[110:111], v[30:31], v[110:111]
    v_cvt_pk_bf16_f32 v76, v100, v101
    v_cvt_pk_bf16_f32 v77, v102, v103
    v_cvt_pk_bf16_f32 v78, v108, v109
    v_cvt_pk_bf16_f32 v79, v110, v111
    s_add_u32 s56, s52, 4194304
    v_permlane16_swap_b32 v76, v78
    v_permlane16_swap_b32 v77, v79
    buffer_store_dwordx4 v[76:79], v1, s[4:7], s56 offen offset:1024 sc1
    v_pk_fma_f32 v[116:117], v[12:13], v[24:25], v[116:117] op_sel_hi:[0,1,1] neg_lo:[1,0,0] neg_hi:[1,0,0]
    v_pk_fma_f32 v[118:119], v[12:13], v[26:27], v[118:119] op_sel_hi:[0,1,1] neg_lo:[1,0,0] neg_hi:[1,0,0]
    v_pk_fma_f32 v[124:125], v[14:15], v[24:25], v[124:125] op_sel_hi:[0,1,1] neg_lo:[1,0,0] neg_hi:[1,0,0]
    v_pk_fma_f32 v[126:127], v[14:15], v[26:27], v[126:127] op_sel_hi:[0,1,1] neg_lo:[1,0,0] neg_hi:[1,0,0]
    v_pk_mul_f32 v[116:117], v[28:29], v[116:117]
    v_pk_mul_f32 v[118:119], v[30:31], v[118:119]
    v_pk_mul_f32 v[124:125], v[28:29], v[124:125]
    v_pk_mul_f32 v[126:127], v[30:31], v[126:127]
    v_cvt_pk_bf16_f32 v92, v116, v117
    v_cvt_pk_bf16_f32 v93, v118, v119
    v_cvt_pk_bf16_f32 v94, v124, v125
    v_cvt_pk_bf16_f32 v95, v126, v127
    s_add_u32 s56, s52, 4325376
    v_permlane16_swap_b32 v92, v94
    v_permlane16_swap_b32 v93, v95
    buffer_store_dwordx4 v[92:95], v1, s[4:7], s56 offen offset:1024 sc1
    v_mfma_f32_16x16x32_bf16 v[128:131], v[32:35], v[224:227], v[128:131]
    ds_read_b64_tr_b16 v[60:61], v6 offset:20480
    v_mfma_f32_16x16x32_bf16 v[132:135], v[32:35], v[228:231], v[132:135]
    ds_read_b64_tr_b16 v[62:63], v6 offset:21504
    v_mfma_f32_16x16x32_bf16 v[136:139], v[36:39], v[224:227], v[136:139]
    ds_read_b64_tr_b16 v[32:33], v3 offset:24576
    v_mfma_f32_16x16x32_bf16 v[140:143], v[36:39], v[228:231], v[140:143]
    ds_read_b64_tr_b16 v[34:35], v3 offset:25600
    v_mfma_f32_16x16x32_bf16 v[144:147], v[40:43], v[224:227], v[144:147]
    ds_read_b64_tr_b16 v[36:37], v4 offset:24576
    v_mfma_f32_16x16x32_bf16 v[148:151], v[40:43], v[228:231], v[148:151]
    ds_read_b64_tr_b16 v[38:39], v4 offset:25600
    v_mfma_f32_16x16x32_bf16 v[152:155], v[44:47], v[224:227], v[152:155]
    ds_read_b64_tr_b16 v[40:41], v5 offset:24576
    v_mfma_f32_16x16x32_bf16 v[156:159], v[44:47], v[228:231], v[156:159]
    ds_read_b64_tr_b16 v[42:43], v5 offset:25600
    s_waitcnt lgkmcnt(10)
    v_mfma_f32_16x16x32_bf16 v[128:131], v[48:51], v[232:235], v[128:131]
    ds_read_b64_tr_b16 v[44:45], v6 offset:24576
    v_mfma_f32_16x16x32_bf16 v[132:135], v[48:51], v[236:239], v[132:135]
    ds_read_b64_tr_b16 v[46:47], v6 offset:25600
    v_mfma_f32_16x16x32_bf16 v[136:139], v[52:55], v[232:235], v[136:139]
    ds_read_b64_tr_b16 v[48:49], v3 offset:28672
    v_mfma_f32_16x16x32_bf16 v[140:143], v[52:55], v[236:239], v[140:143]
    ds_read_b64_tr_b16 v[50:51], v3 offset:29696
    s_waitcnt lgkmcnt(10)
    v_mfma_f32_16x16x32_bf16 v[144:147], v[56:59], v[232:235], v[144:147]
    ds_read_b64_tr_b16 v[52:53], v4 offset:28672
    v_mfma_f32_16x16x32_bf16 v[148:151], v[56:59], v[236:239], v[148:151]
    ds_read_b64_tr_b16 v[54:55], v4 offset:29696
    v_mfma_f32_16x16x32_bf16 v[152:155], v[60:63], v[232:235], v[152:155]
    ds_read_b64_tr_b16 v[56:57], v5 offset:28672
    v_mfma_f32_16x16x32_bf16 v[156:159], v[60:63], v[236:239], v[156:159]
    ds_read_b64_tr_b16 v[58:59], v5 offset:29696
    s_waitcnt lgkmcnt(10)
    v_mfma_f32_16x16x32_bf16 v[128:131], v[32:35], v[240:243], v[128:131]
    ds_read_b64_tr_b16 v[60:61], v6 offset:28672
    v_mfma_f32_16x16x32_bf16 v[132:135], v[32:35], v[244:247], v[132:135]
    ds_read_b64_tr_b16 v[62:63], v6 offset:29696
    s_barrier
    v_mfma_f32_16x16x32_bf16 v[136:139], v[36:39], v[240:243], v[136:139]
    ds_read_b64_tr_b16 v[32:33], v3 offset:32768
    v_mfma_f32_16x16x32_bf16 v[140:143], v[36:39], v[244:247], v[140:143]
    ds_read_b64_tr_b16 v[34:35], v3 offset:33792
    s_waitcnt lgkmcnt(10)
    v_mfma_f32_16x16x32_bf16 v[144:147], v[40:43], v[240:243], v[144:147]
    ds_read_b64_tr_b16 v[36:37], v4 offset:32768
    v_mfma_f32_16x16x32_bf16 v[148:151], v[40:43], v[244:247], v[148:151]
    ds_read_b64_tr_b16 v[38:39], v4 offset:33792
    v_mfma_f32_16x16x32_bf16 v[152:155], v[44:47], v[240:243], v[152:155]
    ds_read_b64_tr_b16 v[40:41], v5 offset:32768
    v_mfma_f32_16x16x32_bf16 v[156:159], v[44:47], v[244:247], v[156:159]
    ds_read_b64_tr_b16 v[42:43], v5 offset:33792
    s_waitcnt lgkmcnt(10)
    v_mfma_f32_16x16x32_bf16 v[128:131], v[48:51], v[248:251], v[128:131]
    ds_read_b64_tr_b16 v[44:45], v6 offset:32768
    v_mfma_f32_16x16x32_bf16 v[132:135], v[48:51], v[252:255], v[132:135]
    ds_read_b64_tr_b16 v[46:47], v6 offset:33792
    v_mfma_f32_16x16x32_bf16 v[136:139], v[52:55], v[248:251], v[136:139]
    ds_read_b64_tr_b16 v[48:49], v3 offset:36864
    v_mfma_f32_16x16x32_bf16 v[140:143], v[52:55], v[252:255], v[140:143]
    ds_read_b64_tr_b16 v[50:51], v3 offset:37888
    s_waitcnt lgkmcnt(10)
    v_mfma_f32_16x16x32_bf16 v[144:147], v[56:59], v[248:251], v[144:147]
    ds_read_b64_tr_b16 v[52:53], v4 offset:36864
    v_mfma_f32_16x16x32_bf16 v[148:151], v[56:59], v[252:255], v[148:151]
    ds_read_b64_tr_b16 v[54:55], v4 offset:37888
    v_mfma_f32_16x16x32_bf16 v[152:155], v[60:63], v[248:251], v[152:155]
    ds_read_b64_tr_b16 v[56:57], v5 offset:36864
    v_mfma_f32_16x16x32_bf16 v[156:159], v[60:63], v[252:255], v[156:159]
    ds_read_b64_tr_b16 v[58:59], v5 offset:37888
    s_waitcnt lgkmcnt(10)
    v_mfma_f32_16x16x32_bf16 v[128:131], v[32:35], v[160:163], v[128:131]
    ds_read_b64_tr_b16 v[60:61], v6 offset:36864
    v_mfma_f32_16x16x32_bf16 v[132:135], v[32:35], v[164:167], v[132:135]
    ds_read_b64_tr_b16 v[62:63], v6 offset:37888
    v_mfma_f32_16x16x32_bf16 v[136:139], v[36:39], v[160:163], v[136:139]
    ds_read_b64_tr_b16 v[32:33], v3 offset:40960
    v_mfma_f32_16x16x32_bf16 v[140:143], v[36:39], v[164:167], v[140:143]
    ds_read_b64_tr_b16 v[34:35], v3 offset:41984
    s_waitcnt lgkmcnt(10)
    v_mfma_f32_16x16x32_bf16 v[144:147], v[40:43], v[160:163], v[144:147]
    ds_read_b64_tr_b16 v[36:37], v4 offset:40960
    v_mfma_f32_16x16x32_bf16 v[148:151], v[40:43], v[164:167], v[148:151]
    ds_read_b64_tr_b16 v[38:39], v4 offset:41984
    v_mfma_f32_16x16x32_bf16 v[152:155], v[44:47], v[160:163], v[152:155]
    ds_read_b64_tr_b16 v[40:41], v5 offset:40960
    v_mfma_f32_16x16x32_bf16 v[156:159], v[44:47], v[164:167], v[156:159]
    ds_read_b64_tr_b16 v[42:43], v5 offset:41984
    s_waitcnt lgkmcnt(10)
    v_mfma_f32_16x16x32_bf16 v[128:131], v[48:51], v[168:171], v[128:131]
    ds_read_b64_tr_b16 v[44:45], v6 offset:40960
    v_mfma_f32_16x16x32_bf16 v[132:135], v[48:51], v[172:175], v[132:135]
    ds_read_b64_tr_b16 v[46:47], v6 offset:41984
    v_mfma_f32_16x16x32_bf16 v[136:139], v[52:55], v[168:171], v[136:139]
    ds_read_b64_tr_b16 v[48:49], v3 offset:45056
    v_mfma_f32_16x16x32_bf16 v[140:143], v[52:55], v[172:175], v[140:143]
    ds_read_b64_tr_b16 v[50:51], v3 offset:46080
    s_waitcnt lgkmcnt(10)
    v_mfma_f32_16x16x32_bf16 v[144:147], v[56:59], v[168:171], v[144:147]
    ds_read_b64_tr_b16 v[52:53], v4 offset:45056
    v_mfma_f32_16x16x32_bf16 v[148:151], v[56:59], v[172:175], v[148:151]
    ds_read_b64_tr_b16 v[54:55], v4 offset:46080
    v_mfma_f32_16x16x32_bf16 v[152:155], v[60:63], v[168:171], v[152:155]
    ds_read_b64_tr_b16 v[56:57], v5 offset:45056
    v_mfma_f32_16x16x32_bf16 v[156:159], v[60:63], v[172:175], v[156:159]
    ds_read_b64_tr_b16 v[58:59], v5 offset:46080
    s_waitcnt lgkmcnt(10)
    v_mfma_f32_16x16x32_bf16 v[128:131], v[32:35], v[176:179], v[128:131]
    ds_read_b64_tr_b16 v[60:61], v6 offset:45056
    v_mfma_f32_16x16x32_bf16 v[132:135], v[32:35], v[180:183], v[132:135]
    ds_read_b64_tr_b16 v[62:63], v6 offset:46080
    v_mfma_f32_16x16x32_bf16 v[136:139], v[36:39], v[176:179], v[136:139]
    ds_read_b64_tr_b16 v[32:33], v3 offset:49152
    v_mfma_f32_16x16x32_bf16 v[140:143], v[36:39], v[180:183], v[140:143]
    ds_read_b64_tr_b16 v[34:35], v3 offset:50176
    s_waitcnt lgkmcnt(10)
    v_mfma_f32_16x16x32_bf16 v[144:147], v[40:43], v[176:179], v[144:147]
    ds_read_b64_tr_b16 v[36:37], v4 offset:49152
    v_mfma_f32_16x16x32_bf16 v[148:151], v[40:43], v[180:183], v[148:151]
    ds_read_b64_tr_b16 v[38:39], v4 offset:50176
    v_mfma_f32_16x16x32_bf16 v[152:155], v[44:47], v[176:179], v[152:155]
    ds_read_b64_tr_b16 v[40:41], v5 offset:49152
    v_mfma_f32_16x16x32_bf16 v[156:159], v[44:47], v[180:183], v[156:159]
    ds_read_b64_tr_b16 v[42:43], v5 offset:50176
    s_waitcnt lgkmcnt(10)
    v_mfma_f32_16x16x32_bf16 v[128:131], v[48:51], v[184:187], v[128:131]
    ds_read_b64_tr_b16 v[44:45], v6 offset:49152
    s_waitcnt vmcnt(0)
    s_atomic_add s40, s[22:23], s59
    s_mov_b32 s68, 0
    s_atomic_add s68, s[22:23], s59 glc
    s_mov_b32 s55, s52
    s_add_u32 s56, s52, 4194304
    ds_read_b32 v8, v9 offset:4096
    v_mfma_f32_16x16x32_bf16 v[132:135], v[48:51], v[188:191], v[132:135]
    ds_read_b64_tr_b16 v[46:47], v6 offset:50176
    buffer_load_dwordx4 v[64:67], v1, s[4:7], s55 offen offset:0 sc1
    ds_read_b32 v10, v9 offset:4608
    v_mfma_f32_16x16x32_bf16 v[136:139], v[52:55], v[184:187], v[136:139]
    ds_read_b64_tr_b16 v[48:49], v3 offset:53248
    buffer_load_dwordx4 v[68:71], v1, s[4:7], s55 offen offset:1024 sc1
    ds_read_b32 v12, v9 offset:4160
    v_mfma_f32_16x16x32_bf16 v[140:143], v[52:55], v[188:191], v[140:143]
    ds_read_b64_tr_b16 v[50:51], v3 offset:54272
    buffer_load_dwordx4 v[72:75], v1, s[4:7], s56 offen offset:0 sc1
    ds_read_b32 v14, v9 offset:4672
    s_waitcnt lgkmcnt(14)
    v_mfma_f32_16x16x32_bf16 v[144:147], v[56:59], v[184:187], v[144:147]
    ds_read_b64_tr_b16 v[52:53], v4 offset:53248
    buffer_load_dwordx4 v[76:79], v1, s[4:7], s56 offen offset:1024 sc1
    ds_read_b128 v[16:19], v11 offset:0
    v_mfma_f32_16x16x32_bf16 v[148:151], v[56:59], v[188:191], v[148:151]
    ds_read_b64_tr_b16 v[54:55], v4 offset:54272
    ds_read_b128 v[20:23], v11 offset:64
    v_mfma_f32_16x16x32_bf16 v[152:155], v[60:63], v[184:187], v[152:155]
    ds_read_b64_tr_b16 v[56:57], v5 offset:53248
    ds_read_b128 v[24:27], v11 offset:128
    v_mfma_f32_16x16x32_bf16 v[156:159], v[60:63], v[188:191], v[156:159]
    ds_read_b64_tr_b16 v[58:59], v5 offset:54272
    ds_read_b128 v[28:31], v11 offset:192
    s_waitcnt lgkmcnt(14)
    v_mfma_f32_16x16x32_bf16 v[128:131], v[32:35], v[192:195], v[128:131]
    ds_read_b64_tr_b16 v[60:61], v6 offset:53248
    v_mfma_f32_16x16x32_bf16 v[132:135], v[32:35], v[196:199], v[132:135]
    ds_read_b64_tr_b16 v[62:63], v6 offset:54272
    v_mfma_f32_16x16x32_bf16 v[136:139], v[36:39], v[192:195], v[136:139]
    ds_read_b64_tr_b16 v[32:33], v3 offset:57344
    v_mfma_f32_16x16x32_bf16 v[140:143], v[36:39], v[196:199], v[140:143]
    ds_read_b64_tr_b16 v[34:35], v3 offset:58368
    s_waitcnt lgkmcnt(14)
    v_mfma_f32_16x16x32_bf16 v[144:147], v[40:43], v[192:195], v[144:147]
    ds_read_b64_tr_b16 v[36:37], v4 offset:57344
    v_mfma_f32_16x16x32_bf16 v[148:151], v[40:43], v[196:199], v[148:151]
    ds_read_b64_tr_b16 v[38:39], v4 offset:58368
    v_mfma_f32_16x16x32_bf16 v[152:155], v[44:47], v[192:195], v[152:155]
    ds_read_b64_tr_b16 v[40:41], v5 offset:57344
    v_mfma_f32_16x16x32_bf16 v[156:159], v[44:47], v[196:199], v[156:159]
    ds_read_b64_tr_b16 v[42:43], v5 offset:58368
    s_waitcnt lgkmcnt(13)
    v_mfma_f32_16x16x32_bf16 v[128:131], v[48:51], v[200:203], v[128:131]
    ds_read_b64_tr_b16 v[44:45], v6 offset:57344
    s_waitcnt lgkmcnt(9)
    v_mfma_f32_16x16x32_bf16 v[132:135], v[48:51], v[204:207], v[132:135]
    ds_read_b64_tr_b16 v[46:47], v6 offset:58368
    v_mul_f32 v10, 0x3e8293ee, v10
    v_mfma_f32_16x16x32_bf16 v[136:139], v[52:55], v[200:203], v[136:139]
    ds_read_b64_tr_b16 v[48:49], v3 offset:61440
    v_mul_f32 v14, 0x3e8293ee, v14
    v_mfma_f32_16x16x32_bf16 v[140:143], v[52:55], v[204:207], v[140:143]
    ds_read_b64_tr_b16 v[50:51], v3 offset:62464
    s_lshl_b32 s44, s16, 11
    s_waitcnt lgkmcnt(10)
    v_mfma_f32_16x16x32_bf16 v[144:147], v[56:59], v[200:203], v[144:147]
    ds_read_b64_tr_b16 v[52:53], v4 offset:61440
    s_add_u32 s44, s44, 131072
    v_mfma_f32_16x16x32_bf16 v[148:151], v[56:59], v[204:207], v[148:151]
    ds_read_b64_tr_b16 v[54:55], v4 offset:62464
    v_add_u32 v13, s44, v2
    v_mfma_f32_16x16x32_bf16 v[152:155], v[60:63], v[200:203], v[152:155]
    ds_read_b64_tr_b16 v[56:57], v5 offset:61440
    v_mfma_f32_16x16x32_bf16 v[156:159], v[60:63], v[204:207], v[156:159]
    ds_read_b64_tr_b16 v[58:59], v5 offset:62464
    s_waitcnt lgkmcnt(10)
    v_mfma_f32_16x16x32_bf16 v[128:131], v[32:35], v[208:211], v[128:131]
    ds_read_b64_tr_b16 v[60:61], v6 offset:61440
    v_mfma_f32_16x16x32_bf16 v[132:135], v[32:35], v[212:215], v[132:135]
    ds_read_b64_tr_b16 v[62:63], v6 offset:62464
    v_xor_b32 v3, 0x10000, v3
    v_xor_b32 v4, 0x10000, v4
    v_xor_b32 v5, 0x10000, v5
    v_xor_b32 v6, 0x10000, v6
    v_mfma_f32_16x16x32_bf16 v[136:139], v[36:39], v[208:211], v[136:139]
    v_mfma_f32_16x16x32_bf16 v[140:143], v[36:39], v[212:215], v[140:143]
    s_waitcnt lgkmcnt(8)
    v_mfma_f32_16x16x32_bf16 v[144:147], v[40:43], v[208:211], v[144:147]
    v_mfma_f32_16x16x32_bf16 v[148:151], v[40:43], v[212:215], v[148:151]
    v_mfma_f32_16x16x32_bf16 v[152:155], v[44:47], v[208:211], v[152:155]
    v_mfma_f32_16x16x32_bf16 v[156:159], v[44:47], v[212:215], v[156:159]
    s_waitcnt lgkmcnt(4)
    v_mfma_f32_16x16x32_bf16 v[128:131], v[48:51], v[216:219], v[128:131]
    v_mfma_f32_16x16x32_bf16 v[132:135], v[48:51], v[220:223], v[132:135]
    v_mfma_f32_16x16x32_bf16 v[136:139], v[52:55], v[216:219], v[136:139]
    v_mfma_f32_16x16x32_bf16 v[140:143], v[52:55], v[220:223], v[140:143]
    s_waitcnt lgkmcnt(0)
    v_mfma_f32_16x16x32_bf16 v[144:147], v[56:59], v[216:219], v[144:147]
    v_mfma_f32_16x16x32_bf16 v[148:151], v[56:59], v[220:223], v[148:151]
    v_mfma_f32_16x16x32_bf16 v[152:155], v[60:63], v[216:219], v[152:155]
    v_mfma_f32_16x16x32_bf16 v[156:159], v[60:63], v[220:223], v[156:159]
    v_pk_fma_f32 v[128:129], v[8:9], v[16:17], v[128:129] op_sel_hi:[0,1,1] neg_lo:[1,0,0] neg_hi:[1,0,0]
    v_pk_fma_f32 v[130:131], v[8:9], v[18:19], v[130:131] op_sel_hi:[0,1,1] neg_lo:[1,0,0] neg_hi:[1,0,0]
    v_pk_fma_f32 v[136:137], v[8:9], v[20:21], v[136:137] op_sel_hi:[0,1,1] neg_lo:[1,0,0] neg_hi:[1,0,0]
    v_pk_fma_f32 v[138:139], v[8:9], v[22:23], v[138:139] op_sel_hi:[0,1,1] neg_lo:[1,0,0] neg_hi:[1,0,0]
    v_pk_mul_f32 v[128:129], v[10:11], v[128:129] op_sel_hi:[0,1]
    v_pk_mul_f32 v[130:131], v[10:11], v[130:131] op_sel_hi:[0,1]
    v_pk_mul_f32 v[136:137], v[10:11], v[136:137] op_sel_hi:[0,1]
    v_pk_mul_f32 v[138:139], v[10:11], v[138:139] op_sel_hi:[0,1]
    v_cvt_pk_bf16_f32 v128, v128, v129
    v_cvt_pk_bf16_f32 v129, v130, v131
    v_cvt_pk_bf16_f32 v130, v136, v137
    v_cvt_pk_bf16_f32 v131, v138, v139
    ds_write_b128 v13, v[128:131] offset:0
    v_pk_fma_f32 v[132:133], v[12:13], v[16:17], v[132:133] op_sel_hi:[0,1,1] neg_lo:[1,0,0] neg_hi:[1,0,0]
    v_pk_fma_f32 v[134:135], v[12:13], v[18:19], v[134:135] op_sel_hi:[0,1,1] neg_lo:[1,0,0] neg_hi:[1,0,0]
    v_pk_fma_f32 v[140:141], v[12:13], v[20:21], v[140:141] op_sel_hi:[0,1,1] neg_lo:[1,0,0] neg_hi:[1,0,0]
    v_pk_fma_f32 v[142:143], v[12:13], v[22:23], v[142:143] op_sel_hi:[0,1,1] neg_lo:[1,0,0] neg_hi:[1,0,0]
    v_pk_mul_f32 v[132:133], v[14:15], v[132:133] op_sel_hi:[0,1]
    v_pk_mul_f32 v[134:135], v[14:15], v[134:135] op_sel_hi:[0,1]
    v_pk_mul_f32 v[140:141], v[14:15], v[140:141] op_sel_hi:[0,1]
    v_pk_mul_f32 v[142:143], v[14:15], v[142:143] op_sel_hi:[0,1]
    v_cvt_pk_bf16_f32 v132, v132, v133
    v_cvt_pk_bf16_f32 v133, v134, v135
    v_cvt_pk_bf16_f32 v134, v140, v141
    v_cvt_pk_bf16_f32 v135, v142, v143
    ds_write_b128 v13, v[132:135] offset:256
    v_add_u32 v4, 131072, v1
    s_waitcnt lgkmcnt(0)
    s_barrier
    ds_read_b128 v[32:35], v4 offset:0
    ds_read_b128 v[36:39], v4 offset:1024
    ds_read_b128 v[40:43], v4 offset:2048
    ds_read_b128 v[44:47], v4 offset:3072
    ds_read_b128 v[48:51], v4 offset:4096
    ds_read_b128 v[52:55], v4 offset:5120
    ds_read_b128 v[56:59], v4 offset:6144
    ds_read_b128 v[60:63], v4 offset:7168
    v_pk_fma_f32 v[144:145], v[8:9], v[24:25], v[144:145] op_sel_hi:[0,1,1] neg_lo:[1,0,0] neg_hi:[1,0,0]
    v_pk_fma_f32 v[146:147], v[8:9], v[26:27], v[146:147] op_sel_hi:[0,1,1] neg_lo:[1,0,0] neg_hi:[1,0,0]
    v_pk_fma_f32 v[152:153], v[8:9], v[28:29], v[152:153] op_sel_hi:[0,1,1] neg_lo:[1,0,0] neg_hi:[1,0,0]
    v_pk_fma_f32 v[154:155], v[8:9], v[30:31], v[154:155] op_sel_hi:[0,1,1] neg_lo:[1,0,0] neg_hi:[1,0,0]
    v_pk_mul_f32 v[144:145], v[10:11], v[144:145] op_sel_hi:[0,1]
    v_pk_mul_f32 v[146:147], v[10:11], v[146:147] op_sel_hi:[0,1]
    v_pk_mul_f32 v[152:153], v[10:11], v[152:153] op_sel_hi:[0,1]
    v_pk_mul_f32 v[154:155], v[10:11], v[154:155] op_sel_hi:[0,1]
    v_cvt_pk_bf16_f32 v144, v144, v145
    v_cvt_pk_bf16_f32 v145, v146, v147
    v_cvt_pk_bf16_f32 v146, v152, v153
    v_cvt_pk_bf16_f32 v147, v154, v155
    ds_write_b128 v13, v[144:147] offset:8192
    s_waitcnt vmcnt(0) lgkmcnt(7)
    v_mfma_f32_32x32x16_bf16 v[192:207], v[64:67], v[32:35], 0
    v_mfma_f32_32x32x16_bf16 v[192:207], v[68:71], v[36:39], v[192:207]
    v_pk_fma_f32 v[148:149], v[12:13], v[24:25], v[148:149] op_sel_hi:[0,1,1] neg_lo:[1,0,0] neg_hi:[1,0,0]
    v_pk_fma_f32 v[150:151], v[12:13], v[26:27], v[150:151] op_sel_hi:[0,1,1] neg_lo:[1,0,0] neg_hi:[1,0,0]
    v_pk_fma_f32 v[156:157], v[12:13], v[28:29], v[156:157] op_sel_hi:[0,1,1] neg_lo:[1,0,0] neg_hi:[1,0,0]
    v_pk_fma_f32 v[158:159], v[12:13], v[30:31], v[158:159] op_sel_hi:[0,1,1] neg_lo:[1,0,0] neg_hi:[1,0,0]
    v_pk_mul_f32 v[148:149], v[14:15], v[148:149] op_sel_hi:[0,1]
    v_pk_mul_f32 v[150:151], v[14:15], v[150:151] op_sel_hi:[0,1]
    v_pk_mul_f32 v[156:157], v[14:15], v[156:157] op_sel_hi:[0,1]
    v_pk_mul_f32 v[158:159], v[14:15], v[158:159] op_sel_hi:[0,1]
    v_cvt_pk_bf16_f32 v148, v148, v149
    v_cvt_pk_bf16_f32 v149, v150, v151
    v_cvt_pk_bf16_f32 v150, v156, v157
    v_cvt_pk_bf16_f32 v151, v158, v159
    ds_write_b128 v13, v[148:151] offset:8448
    v_mov_b32 v9, 0xdddddddd
    v_bfe_u32 v10, v1, 4, 3
    v_mov_b32 v11, 0x3f803f80
    v_cmp_eq_u32 vcc, 0, v10
    v_cmp_eq_u32 s[44:45], 4, v10
    s_mov_b32 s57, 0
    v_cndmask_b32 v28, 0, v11, vcc
    v_cndmask_b32 v29, 0, v11, vcc
    v_cndmask_b32 v30, 0, v11, s[44:45]
    v_cndmask_b32 v31, 0, v11, s[44:45]
    v_mov_b32 v10, 0
    v_mov_b32 v11, 0
    s_mov_b32 s66, 0x10000
    s_waitcnt lgkmcnt(0)
    s_cmp_eq_u32 s68, 16
    s_cbranch_scc1 c_k_ok
c_k_poll:
    s_mov_b32 s68, 0
    s_atomic_add s68, s[22:23], s59 offset:0 glc
    s_sub_u32 s66, s66, 1
    s_cselect_b32 s67, 16, 0
    s_waitcnt lgkmcnt(0)
    s_max_u32 s68, s68, s67
    s_cmp_lt_u32 s68, 16
    s_cbranch_scc1 c_k_poll
c_k_ok:
    s_add_u32 s54, s54, 8192
    s_and_b32 s54, s54, 0x1ffff
    s_add_u32 s55, s53, s54
    s_add_u32 s56, s55, 4194304
    buffer_load_dwordx4 v[80:83], v1, s[4:7], s55 offen offset:0 sc1
    buffer_load_dwordx4 v[84:87], v1, s[4:7], s55 offen offset:1024 sc1
    buffer_load_dwordx4 v[88:91], v1, s[4:7], s56 offen offset:0 sc1
    buffer_load_dwordx4 v[92:95], v1, s[4:7], s56 offen offset:1024 sc1
    s_add_u32 s54, s54, 8192
    s_and_b32 s54, s54, 0x1ffff
    s_add_u32 s55, s53, s54
    s_add_u32 s56, s55, 4194304
    buffer_load_dwordx4 v[96:99], v1, s[4:7], s55 offen offset:0 sc1
    buffer_load_dwordx4 v[100:103], v1, s[4:7], s55 offen offset:1024 sc1
    buffer_load_dwordx4 v[104:107], v1, s[4:7], s56 offen offset:0 sc1
    buffer_load_dwordx4 v[108:111], v1, s[4:7], s56 offen offset:1024 sc1
    v_mfma_f32_32x32x16_bf16 v[208:223], v[64:67], v[40:43], 0
    s_add_u32 s54, s54, 8192
    s_and_b32 s54, s54, 0x1ffff
    s_add_u32 s55, s53, s54
    s_add_u32 s56, s55, 4194304
    v_exp_f32 v192, v192
    v_exp_f32 v193, v193
    v_exp_f32 v194, v194
    v_mfma_f32_32x32x8_bf16 v[128:143], v[10:11], v[10:11], 0
    v_mov_b32 v12, 0
    buffer_load_dwordx4 v[112:115], v1, s[4:7], s55 offen offset:0 sc1
    v_exp_f32 v195, v195
    v_exp_f32 v196, v196
    v_exp_f32 v197, v197
    v_mfma_f32_32x32x16_bf16 v[208:223], v[68:71], v[44:47], v[208:223]
    v_exp_f32 v198, v198
    v_exp_f32 v199, v199
    v_exp_f32 v200, v200
    v_mfma_f32_32x32x8_bf16 v[144:159], v[10:11], v[10:11], 0
    v_mov_b32 v16, 0
    v_exp_f32 v201, v201
    v_exp_f32 v202, v202
    v_mfma_f32_32x32x8_bf16 v[160:175], v[10:11], v[10:11], 0
    v_mov_b32 v20, 0
    s_lshl_b32 s44, s16, 12
    s_add_u32 s44, s44, 65536
    v_add_u32 v5, s44, v1
    s_lshl_b32 s44, s16, 8
    s_add_u32 s44, s44, 147456
    v_lshrrev_b32 v6, 2, v1
    v_add_u32 v6, s44, v6
    s_lshl_b32 s44, s21, 22
    s_lshl_b32 s45, s39, 16
    s_add_u32 s41, s44, s45
    s_lshl_b32 s45, s20, 12
    s_add_u32 s43, s41, s45
    s_and_b32 s45, s45, 0
    s_add_u32 s41, s41, s45
    s_add_u32 s41, s41, 16777216
    v_exp_f32 v203, v203
    v_exp_f32 v204, v204
    v_exp_f32 v205, v205
    v_mfma_f32_32x32x8_bf16 v[176:191], v[10:11], v[10:11], 0
    v_mov_b32 v24, 0
    v_exp_f32 v206, v206
    v_exp_f32 v207, v207
    v_mfma_f32_32x32x16_bf16 v[224:239], v[64:67], v[48:51], 0
    v_exp_f32 v208, v208
    v_exp_f32 v209, v209
    v_exp_f32 v210, v210
    v_smfmac_f32_32x32x32_bf16 v[128:143], v[72:75], v[192:199], v9
    buffer_load_dwordx4 v[116:119], v1, s[4:7], s55 offen offset:1024 sc1
    v_exp_f32 v211, v211
    v_exp_f32 v212, v212
    v_exp_f32 v213, v213
    v_mfma_f32_32x32x16_bf16 v[224:239], v[68:71], v[52:55], v[224:239]
    v_exp_f32 v214, v214
    v_exp_f32 v215, v215
    v_exp_f32 v216, v216
    v_smfmac_f32_16x16x64_bf16 v[12:15], v[28:31], v[192:199], v9
    v_exp_f32 v217, v217
    v_smfmac_f32_32x32x32_bf16 v[128:143], v[76:79], v[200:207], v9
    v_exp_f32 v218, v218
    v_exp_f32 v219, v219
    v_exp_f32 v220, v220
    v_smfmac_f32_16x16x64_bf16 v[12:15], v[28:31], v[200:207], v9
    v_exp_f32 v221, v221
    v_exp_f32 v222, v222
    v_exp_f32 v223, v223
b_head:
    s_mov_b32 s58, 3
b_loop:
    v_mfma_f32_32x32x16_bf16 v[240:255], v[64:67], v[56:59], 0
    v_exp_f32 v224, v224
    v_exp_f32 v225, v225
    v_exp_f32 v226, v226
    v_smfmac_f32_32x32x32_bf16 v[144:159], v[72:75], v[208:215], v9
    buffer_load_dwordx4 v[120:123], v1, s[4:7], s56 offen offset:0 sc1
    v_exp_f32 v227, v227
    v_exp_f32 v228, v228
    v_exp_f32 v229, v229
    v_mfma_f32_32x32x16_bf16 v[240:255], v[68:71], v[60:63], v[240:255]
    v_exp_f32 v230, v230
    v_exp_f32 v231, v231
    v_exp_f32 v232, v232
    v_smfmac_f32_16x16x64_bf16 v[16:19], v[28:31], v[208:215], v9
    v_exp_f32 v233, v233
    v_smfmac_f32_32x32x32_bf16 v[144:159], v[76:79], v[216:223], v9
    v_exp_f32 v234, v234
    v_exp_f32 v235, v235
    v_exp_f32 v236, v236
    v_smfmac_f32_16x16x64_bf16 v[16:19], v[28:31], v[216:223], v9
    v_exp_f32 v237, v237
    v_exp_f32 v238, v238
    v_exp_f32 v239, v239
    s_waitcnt vmcnt(7)
    v_mfma_f32_32x32x16_bf16 v[192:207], v[80:83], v[32:35], 0
    v_exp_f32 v240, v240
    v_exp_f32 v241, v241
    v_exp_f32 v242, v242
    v_smfmac_f32_32x32x32_bf16 v[160:175], v[72:75], v[224:231], v9
    buffer_load_dwordx4 v[124:127], v1, s[4:7], s56 offen offset:1024 sc1
    v_exp_f32 v243, v243
    v_exp_f32 v244, v244
    v_exp_f32 v245, v245
    v_mfma_f32_32x32x16_bf16 v[192:207], v[84:87], v[36:39], v[192:207]
    v_exp_f32 v246, v246
    v_exp_f32 v247, v247
    v_exp_f32 v248, v248
    v_smfmac_f32_16x16x64_bf16 v[20:23], v[28:31], v[224:231], v9
    v_exp_f32 v249, v249
    v_smfmac_f32_32x32x32_bf16 v[160:175], v[76:79], v[232:239], v9
    v_exp_f32 v250, v250
    v_exp_f32 v251, v251
    v_exp_f32 v252, v252
    v_smfmac_f32_16x16x64_bf16 v[20:23], v[28:31], v[232:239], v9
    v_exp_f32 v253, v253
    v_exp_f32 v254, v254
    v_exp_f32 v255, v255
    v_mfma_f32_32x32x16_bf16 v[208:223], v[80:83], v[40:43], 0
    s_add_u32 s54, s54, 8192
    s_and_b32 s54, s54, 0x1ffff
    s_add_u32 s55, s53, s54
    s_add_u32 s56, s55, 4194304
    v_exp_f32 v192, v192
    v_exp_f32 v193, v193
    v_exp_f32 v194, v194
    v_smfmac_f32_32x32x32_bf16 v[176:191], v[72:75], v[240:247], v9
    buffer_load_dwordx4 v[64:67], v1, s[4:7], s55 offen offset:0 sc1
    v_exp_f32 v195, v195
    v_exp_f32 v196, v196
    v_exp_f32 v197, v197
    v_mfma_f32_32x32x16_bf16 v[208:223], v[84:87], v[44:47], v[208:223]
    v_exp_f32 v198, v198
    v_exp_f32 v199, v199
    v_exp_f32 v200, v200
    v_smfmac_f32_16x16x64_bf16 v[24:27], v[28:31], v[240:247], v9
    v_exp_f32 v201, v201
    v_smfmac_f32_32x32x32_bf16 v[176:191], v[76:79], v[248:255], v9
    v_exp_f32 v202, v202
    v_exp_f32 v203, v203
    v_exp_f32 v204, v204
    v_smfmac_f32_16x16x64_bf16 v[24:27], v[28:31], v[248:255], v9
    v_exp_f32 v205, v205
    v_exp_f32 v206, v206
    v_exp_f32 v207, v207
    v_mfma_f32_32x32x16_bf16 v[224:239], v[80:83], v[48:51], 0
    v_exp_f32 v208, v208
    v_exp_f32 v209, v209
    v_exp_f32 v210, v210
    v_smfmac_f32_32x32x32_bf16 v[128:143], v[88:91], v[192:199], v9
    buffer_load_dwordx4 v[68:71], v1, s[4:7], s55 offen offset:1024 sc1
    v_exp_f32 v211, v211
    v_exp_f32 v212, v212
    v_exp_f32 v213, v213
    v_mfma_f32_32x32x16_bf16 v[224:239], v[84:87], v[52:55], v[224:239]
    v_exp_f32 v214, v214
    v_exp_f32 v215, v215
    v_exp_f32 v216, v216
    v_smfmac_f32_16x16x64_bf16 v[12:15], v[28:31], v[192:199], v9
    v_exp_f32 v217, v217
    v_smfmac_f32_32x32x32_bf16 v[128:143], v[92:95], v[200:207], v9
    v_exp_f32 v218, v218
    v_exp_f32 v219, v219
    v_exp_f32 v220, v220
    v_smfmac_f32_16x16x64_bf16 v[12:15], v[28:31], v[200:207], v9
    v_exp_f32 v221, v221
    v_exp_f32 v222, v222
    v_exp_f32 v223, v223
    v_mfma_f32_32x32x16_bf16 v[240:255], v[80:83], v[56:59], 0
    v_exp_f32 v224, v224
    v_exp_f32 v225, v225
    v_exp_f32 v226, v226
    v_smfmac_f32_32x32x32_bf16 v[144:159], v[88:91], v[208:215], v9
    buffer_load_dwordx4 v[72:75], v1, s[4:7], s56 offen offset:0 sc1
    v_exp_f32 v227, v227
    v_exp_f32 v228, v228
    v_exp_f32 v229, v229
    v_mfma_f32_32x32x16_bf16 v[240:255], v[84:87], v[60:63], v[240:255]
    v_exp_f32 v230, v230
    v_exp_f32 v231, v231
    v_exp_f32 v232, v232
    v_smfmac_f32_16x16x64_bf16 v[16:19], v[28:31], v[208:215], v9
    v_exp_f32 v233, v233
    v_smfmac_f32_32x32x32_bf16 v[144:159], v[92:95], v[216:223], v9
    v_exp_f32 v234, v234
    v_exp_f32 v235, v235
    v_exp_f32 v236, v236
    v_smfmac_f32_16x16x64_bf16 v[16:19], v[28:31], v[216:223], v9
    v_exp_f32 v237, v237
    v_exp_f32 v238, v238
    v_exp_f32 v239, v239
    s_waitcnt vmcnt(7)
    v_mfma_f32_32x32x16_bf16 v[192:207], v[96:99], v[32:35], 0
    v_exp_f32 v240, v240
    v_exp_f32 v241, v241
    v_exp_f32 v242, v242
    v_smfmac_f32_32x32x32_bf16 v[160:175], v[88:91], v[224:231], v9
    buffer_load_dwordx4 v[76:79], v1, s[4:7], s56 offen offset:1024 sc1
    v_exp_f32 v243, v243
    v_exp_f32 v244, v244
    v_exp_f32 v245, v245
    v_mfma_f32_32x32x16_bf16 v[192:207], v[100:103], v[36:39], v[192:207]
    v_exp_f32 v246, v246
    v_exp_f32 v247, v247
    v_exp_f32 v248, v248
    v_smfmac_f32_16x16x64_bf16 v[20:23], v[28:31], v[224:231], v9
    v_exp_f32 v249, v249
    v_smfmac_f32_32x32x32_bf16 v[160:175], v[92:95], v[232:239], v9
    v_exp_f32 v250, v250
    v_exp_f32 v251, v251
    v_exp_f32 v252, v252
    v_smfmac_f32_16x16x64_bf16 v[20:23], v[28:31], v[232:239], v9
    v_exp_f32 v253, v253
    v_exp_f32 v254, v254
    v_exp_f32 v255, v255
    v_mfma_f32_32x32x16_bf16 v[208:223], v[96:99], v[40:43], 0
    s_add_u32 s54, s54, 8192
    s_and_b32 s54, s54, 0x1ffff
    s_add_u32 s55, s53, s54
    s_add_u32 s56, s55, 4194304
    v_exp_f32 v192, v192
    v_exp_f32 v193, v193
    v_exp_f32 v194, v194
    v_smfmac_f32_32x32x32_bf16 v[176:191], v[88:91], v[240:247], v9
    buffer_load_dwordx4 v[80:83], v1, s[4:7], s55 offen offset:0 sc1
    v_exp_f32 v195, v195
    v_exp_f32 v196, v196
    v_exp_f32 v197, v197
    v_mfma_f32_32x32x16_bf16 v[208:223], v[100:103], v[44:47], v[208:223]
    v_exp_f32 v198, v198
    v_exp_f32 v199, v199
    v_exp_f32 v200, v200
    v_smfmac_f32_16x16x64_bf16 v[24:27], v[28:31], v[240:247], v9
    v_exp_f32 v201, v201
    v_smfmac_f32_32x32x32_bf16 v[176:191], v[92:95], v[248:255], v9
    v_exp_f32 v202, v202
    v_exp_f32 v203, v203
    v_exp_f32 v204, v204
    v_smfmac_f32_16x16x64_bf16 v[24:27], v[28:31], v[248:255], v9
    v_exp_f32 v205, v205
    v_exp_f32 v206, v206
    v_exp_f32 v207, v207
    v_mfma_f32_32x32x16_bf16 v[224:239], v[96:99], v[48:51], 0
    v_exp_f32 v208, v208
    v_exp_f32 v209, v209
    v_exp_f32 v210, v210
    v_smfmac_f32_32x32x32_bf16 v[128:143], v[104:107], v[192:199], v9
    buffer_load_dwordx4 v[84:87], v1, s[4:7], s55 offen offset:1024 sc1
    v_exp_f32 v211, v211
    v_exp_f32 v212, v212
    v_exp_f32 v213, v213
    v_mfma_f32_32x32x16_bf16 v[224:239], v[100:103], v[52:55], v[224:239]
    v_exp_f32 v214, v214
    v_exp_f32 v215, v215
    v_exp_f32 v216, v216
    v_smfmac_f32_16x16x64_bf16 v[12:15], v[28:31], v[192:199], v9
    v_exp_f32 v217, v217
    v_smfmac_f32_32x32x32_bf16 v[128:143], v[108:111], v[200:207], v9
    v_exp_f32 v218, v218
    v_exp_f32 v219, v219
    v_exp_f32 v220, v220
    v_smfmac_f32_16x16x64_bf16 v[12:15], v[28:31], v[200:207], v9
    v_exp_f32 v221, v221
    v_exp_f32 v222, v222
    v_exp_f32 v223, v223
    v_mfma_f32_32x32x16_bf16 v[240:255], v[96:99], v[56:59], 0
    v_exp_f32 v224, v224
    v_exp_f32 v225, v225
    v_exp_f32 v226, v226
    v_smfmac_f32_32x32x32_bf16 v[144:159], v[104:107], v[208:215], v9
    buffer_load_dwordx4 v[88:91], v1, s[4:7], s56 offen offset:0 sc1
    v_exp_f32 v227, v227
    v_exp_f32 v228, v228
    v_exp_f32 v229, v229
    v_mfma_f32_32x32x16_bf16 v[240:255], v[100:103], v[60:63], v[240:255]
    v_exp_f32 v230, v230
    v_exp_f32 v231, v231
    v_exp_f32 v232, v232
    v_smfmac_f32_16x16x64_bf16 v[16:19], v[28:31], v[208:215], v9
    v_exp_f32 v233, v233
    v_smfmac_f32_32x32x32_bf16 v[144:159], v[108:111], v[216:223], v9
    v_exp_f32 v234, v234
    v_exp_f32 v235, v235
    v_exp_f32 v236, v236
    v_smfmac_f32_16x16x64_bf16 v[16:19], v[28:31], v[216:223], v9
    v_exp_f32 v237, v237
    v_exp_f32 v238, v238
    v_exp_f32 v239, v239
    s_waitcnt vmcnt(7)
    v_mfma_f32_32x32x16_bf16 v[192:207], v[112:115], v[32:35], 0
    v_exp_f32 v240, v240
    v_exp_f32 v241, v241
    v_exp_f32 v242, v242
    v_smfmac_f32_32x32x32_bf16 v[160:175], v[104:107], v[224:231], v9
    buffer_load_dwordx4 v[92:95], v1, s[4:7], s56 offen offset:1024 sc1
    v_exp_f32 v243, v243
    v_exp_f32 v244, v244
    v_exp_f32 v245, v245
    v_mfma_f32_32x32x16_bf16 v[192:207], v[116:119], v[36:39], v[192:207]
    v_exp_f32 v246, v246
    v_exp_f32 v247, v247
    v_exp_f32 v248, v248
    v_smfmac_f32_16x16x64_bf16 v[20:23], v[28:31], v[224:231], v9
    v_exp_f32 v249, v249
    v_smfmac_f32_32x32x32_bf16 v[160:175], v[108:111], v[232:239], v9
    v_exp_f32 v250, v250
    v_exp_f32 v251, v251
    v_exp_f32 v252, v252
    v_smfmac_f32_16x16x64_bf16 v[20:23], v[28:31], v[232:239], v9
    v_exp_f32 v253, v253
    v_exp_f32 v254, v254
    v_exp_f32 v255, v255
    v_mfma_f32_32x32x16_bf16 v[208:223], v[112:115], v[40:43], 0
    s_add_u32 s54, s54, 8192
    s_and_b32 s54, s54, 0x1ffff
    s_add_u32 s55, s53, s54
    s_add_u32 s56, s55, 4194304
    v_exp_f32 v192, v192
    v_exp_f32 v193, v193
    v_exp_f32 v194, v194
    v_smfmac_f32_32x32x32_bf16 v[176:191], v[104:107], v[240:247], v9
    buffer_load_dwordx4 v[96:99], v1, s[4:7], s55 offen offset:0 sc1
    v_exp_f32 v195, v195
    v_exp_f32 v196, v196
    v_exp_f32 v197, v197
    v_mfma_f32_32x32x16_bf16 v[208:223], v[116:119], v[44:47], v[208:223]
    v_exp_f32 v198, v198
    v_exp_f32 v199, v199
    v_exp_f32 v200, v200
    v_smfmac_f32_16x16x64_bf16 v[24:27], v[28:31], v[240:247], v9
    v_exp_f32 v201, v201
    v_smfmac_f32_32x32x32_bf16 v[176:191], v[108:111], v[248:255], v9
    v_exp_f32 v202, v202
    v_exp_f32 v203, v203
    v_exp_f32 v204, v204
    v_smfmac_f32_16x16x64_bf16 v[24:27], v[28:31], v[248:255], v9
    v_exp_f32 v205, v205
    v_exp_f32 v206, v206
    v_exp_f32 v207, v207
    v_mfma_f32_32x32x16_bf16 v[224:239], v[112:115], v[48:51], 0
    v_exp_f32 v208, v208
    v_exp_f32 v209, v209
    v_exp_f32 v210, v210
    v_smfmac_f32_32x32x32_bf16 v[128:143], v[120:123], v[192:199], v9
    buffer_load_dwordx4 v[100:103], v1, s[4:7], s55 offen offset:1024 sc1
    v_exp_f32 v211, v211
    v_exp_f32 v212, v212
    v_exp_f32 v213, v213
    v_mfma_f32_32x32x16_bf16 v[224:239], v[116:119], v[52:55], v[224:239]
    v_exp_f32 v214, v214
    v_exp_f32 v215, v215
    v_exp_f32 v216, v216
    v_smfmac_f32_16x16x64_bf16 v[12:15], v[28:31], v[192:199], v9
    v_exp_f32 v217, v217
    v_smfmac_f32_32x32x32_bf16 v[128:143], v[124:127], v[200:207], v9
    v_exp_f32 v218, v218
    v_exp_f32 v219, v219
    v_exp_f32 v220, v220
    v_smfmac_f32_16x16x64_bf16 v[12:15], v[28:31], v[200:207], v9
    v_exp_f32 v221, v221
    v_exp_f32 v222, v222
    v_exp_f32 v223, v223
    v_mfma_f32_32x32x16_bf16 v[240:255], v[112:115], v[56:59], 0
    v_exp_f32 v224, v224
    v_exp_f32 v225, v225
    v_exp_f32 v226, v226
    v_smfmac_f32_32x32x32_bf16 v[144:159], v[120:123], v[208:215], v9
    buffer_load_dwordx4 v[104:107], v1, s[4:7], s56 offen offset:0 sc1
    v_exp_f32 v227, v227
    v_exp_f32 v228, v228
    v_exp_f32 v229, v229
    v_mfma_f32_32x32x16_bf16 v[240:255], v[116:119], v[60:63], v[240:255]
    v_exp_f32 v230, v230
    v_exp_f32 v231, v231
    v_exp_f32 v232, v232
    v_smfmac_f32_16x16x64_bf16 v[16:19], v[28:31], v[208:215], v9
    v_exp_f32 v233, v233
    v_smfmac_f32_32x32x32_bf16 v[144:159], v[124:127], v[216:223], v9
    v_exp_f32 v234, v234
    v_exp_f32 v235, v235
    v_exp_f32 v236, v236
    v_smfmac_f32_16x16x64_bf16 v[16:19], v[28:31], v[216:223], v9
    v_exp_f32 v237, v237
    v_exp_f32 v238, v238
    v_exp_f32 v239, v239
    s_waitcnt vmcnt(7)
    v_mfma_f32_32x32x16_bf16 v[192:207], v[64:67], v[32:35], 0
    v_exp_f32 v240, v240
    v_exp_f32 v241, v241
    v_exp_f32 v242, v242
    v_smfmac_f32_32x32x32_bf16 v[160:175], v[120:123], v[224:231], v9
    buffer_load_dwordx4 v[108:111], v1, s[4:7], s56 offen offset:1024 sc1
    v_exp_f32 v243, v243
    v_exp_f32 v244, v244
    v_exp_f32 v245, v245
    v_mfma_f32_32x32x16_bf16 v[192:207], v[68:71], v[36:39], v[192:207]
    v_exp_f32 v246, v246
    v_exp_f32 v247, v247
    v_exp_f32 v248, v248
    v_smfmac_f32_16x16x64_bf16 v[20:23], v[28:31], v[224:231], v9
    v_exp_f32 v249, v249
    v_smfmac_f32_32x32x32_bf16 v[160:175], v[124:127], v[232:239], v9
    v_exp_f32 v250, v250
    v_exp_f32 v251, v251
    v_exp_f32 v252, v252
    v_smfmac_f32_16x16x64_bf16 v[20:23], v[28:31], v[232:239], v9
    v_exp_f32 v253, v253
    v_exp_f32 v254, v254
    v_exp_f32 v255, v255
    v_mfma_f32_32x32x16_bf16 v[208:223], v[64:67], v[40:43], 0
    s_add_u32 s54, s54, 8192
    s_and_b32 s54, s54, 0x1ffff
    s_add_u32 s55, s53, s54
    s_add_u32 s56, s55, 4194304
    v_exp_f32 v192, v192
    v_exp_f32 v193, v193
    v_exp_f32 v194, v194
    v_smfmac_f32_32x32x32_bf16 v[176:191], v[120:123], v[240:247], v9
    buffer_load_dwordx4 v[112:115], v1, s[4:7], s55 offen offset:0 sc1
    v_exp_f32 v195, v195
    v_exp_f32 v196, v196
    v_exp_f32 v197, v197
    v_mfma_f32_32x32x16_bf16 v[208:223], v[68:71], v[44:47], v[208:223]
    v_exp_f32 v198, v198
    v_exp_f32 v199, v199
    v_exp_f32 v200, v200
    v_smfmac_f32_16x16x64_bf16 v[24:27], v[28:31], v[240:247], v9
    v_exp_f32 v201, v201
    v_smfmac_f32_32x32x32_bf16 v[176:191], v[124:127], v[248:255], v9
    v_exp_f32 v202, v202
    v_exp_f32 v203, v203
    v_exp_f32 v204, v204
    v_smfmac_f32_16x16x64_bf16 v[24:27], v[28:31], v[248:255], v9
    v_exp_f32 v205, v205
    v_exp_f32 v206, v206
    v_exp_f32 v207, v207
    v_mfma_f32_32x32x16_bf16 v[224:239], v[64:67], v[48:51], 0
    v_exp_f32 v208, v208
    v_exp_f32 v209, v209
    v_exp_f32 v210, v210
    v_smfmac_f32_32x32x32_bf16 v[128:143], v[72:75], v[192:199], v9
    buffer_load_dwordx4 v[116:119], v1, s[4:7], s55 offen offset:1024 sc1
    v_exp_f32 v211, v211
    v_exp_f32 v212, v212
    v_exp_f32 v213, v213
    v_mfma_f32_32x32x16_bf16 v[224:239], v[68:71], v[52:55], v[224:239]
    v_exp_f32 v214, v214
    v_exp_f32 v215, v215
    v_exp_f32 v216, v216
    v_smfmac_f32_16x16x64_bf16 v[12:15], v[28:31], v[192:199], v9
    v_exp_f32 v217, v217
    v_smfmac_f32_32x32x32_bf16 v[128:143], v[76:79], v[200:207], v9
    v_exp_f32 v218, v218
    v_exp_f32 v219, v219
    v_exp_f32 v220, v220
    v_smfmac_f32_16x16x64_bf16 v[12:15], v[28:31], v[200:207], v9
    v_exp_f32 v221, v221
    v_exp_f32 v222, v222
    v_exp_f32 v223, v223
    s_sub_u32 s58, s58, 1
    s_cmp_lg_u32 s58, 0
    s_cbranch_scc1 b_loop
    v_mfma_f32_32x32x16_bf16 v[240:255], v[64:67], v[56:59], 0
    v_exp_f32 v224, v224
    v_exp_f32 v225, v225
    v_exp_f32 v226, v226
    v_smfmac_f32_32x32x32_bf16 v[144:159], v[72:75], v[208:215], v9
    buffer_load_dwordx4 v[120:123], v1, s[4:7], s56 offen offset:0 sc1
    v_exp_f32 v227, v227
    v_exp_f32 v228, v228
    v_exp_f32 v229, v229
    v_mfma_f32_32x32x16_bf16 v[240:255], v[68:71], v[60:63], v[240:255]
    v_exp_f32 v230, v230
    v_exp_f32 v231, v231
    v_exp_f32 v232, v232
    v_smfmac_f32_16x16x64_bf16 v[16:19], v[28:31], v[208:215], v9
    v_exp_f32 v233, v233
    v_smfmac_f32_32x32x32_bf16 v[144:159], v[76:79], v[216:223], v9
    v_exp_f32 v234, v234
    v_exp_f32 v235, v235
    v_exp_f32 v236, v236
    v_smfmac_f32_16x16x64_bf16 v[16:19], v[28:31], v[216:223], v9
    v_exp_f32 v237, v237
    v_exp_f32 v238, v238
    v_exp_f32 v239, v239
    s_waitcnt vmcnt(7)
    v_mfma_f32_32x32x16_bf16 v[192:207], v[80:83], v[32:35], 0
    v_exp_f32 v240, v240
    v_exp_f32 v241, v241
    v_exp_f32 v242, v242
    v_smfmac_f32_32x32x32_bf16 v[160:175], v[72:75], v[224:231], v9
    buffer_load_dwordx4 v[124:127], v1, s[4:7], s56 offen offset:1024 sc1
    v_exp_f32 v243, v243
    v_exp_f32 v244, v244
    v_exp_f32 v245, v245
    v_mfma_f32_32x32x16_bf16 v[192:207], v[84:87], v[36:39], v[192:207]
    v_exp_f32 v246, v246
    v_exp_f32 v247, v247
    v_exp_f32 v248, v248
    v_smfmac_f32_16x16x64_bf16 v[20:23], v[28:31], v[224:231], v9
    v_exp_f32 v249, v249
    v_smfmac_f32_32x32x32_bf16 v[160:175], v[76:79], v[232:239], v9
    v_exp_f32 v250, v250
    v_exp_f32 v251, v251
    v_exp_f32 v252, v252
    v_smfmac_f32_16x16x64_bf16 v[20:23], v[28:31], v[232:239], v9
    v_exp_f32 v253, v253
    v_exp_f32 v254, v254
    v_exp_f32 v255, v255
    s_add_u32 s53, s53, 131072
    s_cmp_eq_u32 s57, 0
    s_cselect_b32 s53, s53, 2146435072
    v_mfma_f32_32x32x16_bf16 v[208:223], v[80:83], v[40:43], 0
    s_add_u32 s54, s54, 8192
    s_and_b32 s54, s54, 0x1ffff
    s_add_u32 s55, s53, s54
    s_add_u32 s56, s55, 4194304
    v_exp_f32 v192, v192
    v_exp_f32 v193, v193
    v_exp_f32 v194, v194
    v_smfmac_f32_32x32x32_bf16 v[176:191], v[72:75], v[240:247], v9
    buffer_load_dwordx4 v[64:67], v1, s[4:7], s55 offen offset:0 sc1
    v_exp_f32 v195, v195
    v_exp_f32 v196, v196
    v_exp_f32 v197, v197
    v_mfma_f32_32x32x16_bf16 v[208:223], v[84:87], v[44:47], v[208:223]
    v_exp_f32 v198, v198
    v_exp_f32 v199, v199
    v_exp_f32 v200, v200
    v_smfmac_f32_16x16x64_bf16 v[24:27], v[28:31], v[240:247], v9
    v_exp_f32 v201, v201
    v_smfmac_f32_32x32x32_bf16 v[176:191], v[76:79], v[248:255], v9
    v_exp_f32 v202, v202
    v_exp_f32 v203, v203
    v_exp_f32 v204, v204
    v_smfmac_f32_16x16x64_bf16 v[24:27], v[28:31], v[248:255], v9
    v_exp_f32 v205, v205
    v_exp_f32 v206, v206
    v_exp_f32 v207, v207
    v_mfma_f32_32x32x16_bf16 v[224:239], v[80:83], v[48:51], 0
    v_exp_f32 v208, v208
    v_exp_f32 v209, v209
    v_exp_f32 v210, v210
    v_smfmac_f32_32x32x32_bf16 v[128:143], v[88:91], v[192:199], v9
    buffer_load_dwordx4 v[68:71], v1, s[4:7], s55 offen offset:1024 sc1
    v_exp_f32 v211, v211
    v_exp_f32 v212, v212
    v_exp_f32 v213, v213
    v_mfma_f32_32x32x16_bf16 v[224:239], v[84:87], v[52:55], v[224:239]
    v_exp_f32 v214, v214
    v_exp_f32 v215, v215
    v_exp_f32 v216, v216
    v_smfmac_f32_16x16x64_bf16 v[12:15], v[28:31], v[192:199], v9
    v_exp_f32 v217, v217
    v_smfmac_f32_32x32x32_bf16 v[128:143], v[92:95], v[200:207], v9
    v_exp_f32 v218, v218
    v_exp_f32 v219, v219
    v_exp_f32 v220, v220
    v_smfmac_f32_16x16x64_bf16 v[12:15], v[28:31], v[200:207], v9
    v_exp_f32 v221, v221
    v_exp_f32 v222, v222
    v_exp_f32 v223, v223
    v_mfma_f32_32x32x16_bf16 v[240:255], v[80:83], v[56:59], 0
    v_exp_f32 v224, v224
    v_exp_f32 v225, v225
    v_exp_f32 v226, v226
    v_smfmac_f32_32x32x32_bf16 v[144:159], v[88:91], v[208:215], v9
    buffer_load_dwordx4 v[72:75], v1, s[4:7], s56 offen offset:0 sc1
    v_exp_f32 v227, v227
    v_exp_f32 v228, v228
    v_exp_f32 v229, v229
    v_mfma_f32_32x32x16_bf16 v[240:255], v[84:87], v[60:63], v[240:255]
    v_exp_f32 v230, v230
    v_exp_f32 v231, v231
    v_exp_f32 v232, v232
    v_smfmac_f32_16x16x64_bf16 v[16:19], v[28:31], v[208:215], v9
    v_exp_f32 v233, v233
    v_smfmac_f32_32x32x32_bf16 v[144:159], v[92:95], v[216:223], v9
    v_exp_f32 v234, v234
    v_exp_f32 v235, v235
    v_exp_f32 v236, v236
    v_smfmac_f32_16x16x64_bf16 v[16:19], v[28:31], v[216:223], v9
    v_exp_f32 v237, v237
    v_exp_f32 v238, v238
    v_exp_f32 v239, v239
    s_waitcnt vmcnt(7)
    v_mfma_f32_32x32x16_bf16 v[192:207], v[96:99], v[32:35], 0
    v_exp_f32 v240, v240
    v_exp_f32 v241, v241
    v_exp_f32 v242, v242
    v_smfmac_f32_32x32x32_bf16 v[160:175], v[88:91], v[224:231], v9
    buffer_load_dwordx4 v[76:79], v1, s[4:7], s56 offen offset:1024 sc1
    v_exp_f32 v243, v243
    v_exp_f32 v244, v244
    v_exp_f32 v245, v245
    v_mfma_f32_32x32x16_bf16 v[192:207], v[100:103], v[36:39], v[192:207]
    v_exp_f32 v246, v246
    v_exp_f32 v247, v247
    v_exp_f32 v248, v248
    v_smfmac_f32_16x16x64_bf16 v[20:23], v[28:31], v[224:231], v9
    v_exp_f32 v249, v249
    v_smfmac_f32_32x32x32_bf16 v[160:175], v[92:95], v[232:239], v9
    v_exp_f32 v250, v250
    v_exp_f32 v251, v251
    v_exp_f32 v252, v252
    v_smfmac_f32_16x16x64_bf16 v[20:23], v[28:31], v[232:239], v9
    v_exp_f32 v253, v253
    v_exp_f32 v254, v254
    v_exp_f32 v255, v255
    v_mfma_f32_32x32x16_bf16 v[208:223], v[96:99], v[40:43], 0
    s_add_u32 s54, s54, 8192
    s_and_b32 s54, s54, 0x1ffff
    s_add_u32 s55, s53, s54
    s_add_u32 s56, s55, 4194304
    v_exp_f32 v192, v192
    v_exp_f32 v193, v193
    v_exp_f32 v194, v194
    v_smfmac_f32_32x32x32_bf16 v[176:191], v[88:91], v[240:247], v9
    buffer_load_dwordx4 v[80:83], v1, s[4:7], s55 offen offset:0 sc1
    v_exp_f32 v195, v195
    v_exp_f32 v196, v196
    v_exp_f32 v197, v197
    v_mfma_f32_32x32x16_bf16 v[208:223], v[100:103], v[44:47], v[208:223]
    v_exp_f32 v198, v198
    v_exp_f32 v199, v199
    v_exp_f32 v200, v200
    v_smfmac_f32_16x16x64_bf16 v[24:27], v[28:31], v[240:247], v9
    v_exp_f32 v201, v201
    v_smfmac_f32_32x32x32_bf16 v[176:191], v[92:95], v[248:255], v9
    v_exp_f32 v202, v202
    v_exp_f32 v203, v203
    v_exp_f32 v204, v204
    v_smfmac_f32_16x16x64_bf16 v[24:27], v[28:31], v[248:255], v9
    v_exp_f32 v205, v205
    v_exp_f32 v206, v206
    v_exp_f32 v207, v207
    v_mfma_f32_32x32x16_bf16 v[224:239], v[96:99], v[48:51], 0
    v_exp_f32 v208, v208
    v_exp_f32 v209, v209
    v_exp_f32 v210, v210
    v_smfmac_f32_32x32x32_bf16 v[128:143], v[104:107], v[192:199], v9
    buffer_load_dwordx4 v[84:87], v1, s[4:7], s55 offen offset:1024 sc1
    v_exp_f32 v211, v211
    v_exp_f32 v212, v212
    v_exp_f32 v213, v213
    v_mfma_f32_32x32x16_bf16 v[224:239], v[100:103], v[52:55], v[224:239]
    v_exp_f32 v214, v214
    v_exp_f32 v215, v215
    v_exp_f32 v216, v216
    v_smfmac_f32_16x16x64_bf16 v[12:15], v[28:31], v[192:199], v9
    v_exp_f32 v217, v217
    v_smfmac_f32_32x32x32_bf16 v[128:143], v[108:111], v[200:207], v9
    v_exp_f32 v218, v218
    v_exp_f32 v219, v219
    v_exp_f32 v220, v220
    v_smfmac_f32_16x16x64_bf16 v[12:15], v[28:31], v[200:207], v9
    v_exp_f32 v221, v221
    v_exp_f32 v222, v222
    v_exp_f32 v223, v223
    v_mfma_f32_32x32x16_bf16 v[240:255], v[96:99], v[56:59], 0
    v_exp_f32 v224, v224
    v_exp_f32 v225, v225
    v_exp_f32 v226, v226
    v_smfmac_f32_32x32x32_bf16 v[144:159], v[104:107], v[208:215], v9
    buffer_load_dwordx4 v[88:91], v1, s[4:7], s56 offen offset:0 sc1
    v_exp_f32 v227, v227
    v_exp_f32 v228, v228
    v_exp_f32 v229, v229
    v_mfma_f32_32x32x16_bf16 v[240:255], v[100:103], v[60:63], v[240:255]
    v_exp_f32 v230, v230
    v_exp_f32 v231, v231
    v_exp_f32 v232, v232
    v_smfmac_f32_16x16x64_bf16 v[16:19], v[28:31], v[208:215], v9
    v_exp_f32 v233, v233
    v_smfmac_f32_32x32x32_bf16 v[144:159], v[108:111], v[216:223], v9
    v_exp_f32 v234, v234
    v_exp_f32 v235, v235
    v_exp_f32 v236, v236
    v_smfmac_f32_16x16x64_bf16 v[16:19], v[28:31], v[216:223], v9
    v_exp_f32 v237, v237
    v_exp_f32 v238, v238
    v_exp_f32 v239, v239
    s_waitcnt vmcnt(7)
    v_mfma_f32_32x32x16_bf16 v[192:207], v[112:115], v[32:35], 0
    v_exp_f32 v240, v240
    v_exp_f32 v241, v241
    v_exp_f32 v242, v242
    v_smfmac_f32_32x32x32_bf16 v[160:175], v[104:107], v[224:231], v9
    buffer_load_dwordx4 v[92:95], v1, s[4:7], s56 offen offset:1024 sc1
    v_exp_f32 v243, v243
    v_exp_f32 v244, v244
    v_exp_f32 v245, v245
    v_mfma_f32_32x32x16_bf16 v[192:207], v[116:119], v[36:39], v[192:207]
    v_exp_f32 v246, v246
    v_exp_f32 v247, v247
    v_exp_f32 v248, v248
    v_smfmac_f32_16x16x64_bf16 v[20:23], v[28:31], v[224:231], v9
    v_exp_f32 v249, v249
    v_smfmac_f32_32x32x32_bf16 v[160:175], v[108:111], v[232:239], v9
    v_exp_f32 v250, v250
    v_exp_f32 v251, v251
    v_exp_f32 v252, v252
    v_smfmac_f32_16x16x64_bf16 v[20:23], v[28:31], v[232:239], v9
    v_exp_f32 v253, v253
    v_exp_f32 v254, v254
    v_exp_f32 v255, v255
    s_barrier
    v_mfma_f32_32x32x16_bf16 v[208:223], v[112:115], v[40:43], 0
    s_add_u32 s54, s54, 8192
    s_and_b32 s54, s54, 0x1ffff
    s_add_u32 s55, s53, s54
    s_add_u32 s56, s55, 4194304
    ds_read_b128 v[32:35], v4 offset:8192
    ds_read_b128 v[36:39], v4 offset:9216
    v_exp_f32 v192, v192
    v_exp_f32 v193, v193
    v_exp_f32 v194, v194
    v_smfmac_f32_32x32x32_bf16 v[176:191], v[104:107], v[240:247], v9
    buffer_load_dwordx4 v[96:99], v1, s[4:7], s55 offen offset:0 sc1
    v_exp_f32 v195, v195
    v_exp_f32 v196, v196
    v_exp_f32 v197, v197
    v_mfma_f32_32x32x16_bf16 v[208:223], v[116:119], v[44:47], v[208:223]
    v_exp_f32 v198, v198
    v_exp_f32 v199, v199
    v_exp_f32 v200, v200
    v_smfmac_f32_16x16x64_bf16 v[24:27], v[28:31], v[240:247], v9
    v_exp_f32 v201, v201
    v_smfmac_f32_32x32x32_bf16 v[176:191], v[108:111], v[248:255], v9
    v_exp_f32 v202, v202
    v_exp_f32 v203, v203
    v_exp_f32 v204, v204
    v_smfmac_f32_16x16x64_bf16 v[24:27], v[28:31], v[248:255], v9
    v_exp_f32 v205, v205
    v_exp_f32 v206, v206
    v_exp_f32 v207, v207
    v_mfma_f32_32x32x16_bf16 v[224:239], v[112:115], v[48:51], 0
    ds_read_b128 v[40:43], v4 offset:10240
    ds_read_b128 v[44:47], v4 offset:11264
    v_exp_f32 v208, v208
    v_exp_f32 v209, v209
    v_exp_f32 v210, v210
    v_smfmac_f32_32x32x32_bf16 v[128:143], v[120:123], v[192:199], v9
    buffer_load_dwordx4 v[100:103], v1, s[4:7], s55 offen offset:1024 sc1
    v_exp_f32 v211, v211
    v_exp_f32 v212, v212
    v_exp_f32 v213, v213
    v_mfma_f32_32x32x16_bf16 v[224:239], v[116:119], v[52:55], v[224:239]
    v_exp_f32 v214, v214
    v_exp_f32 v215, v215
    v_exp_f32 v216, v216
    v_smfmac_f32_16x16x64_bf16 v[12:15], v[28:31], v[192:199], v9
    v_exp_f32 v217, v217
    v_smfmac_f32_32x32x32_bf16 v[128:143], v[124:127], v[200:207], v9
    v_exp_f32 v218, v218
    v_exp_f32 v219, v219
    v_exp_f32 v220, v220
    v_smfmac_f32_16x16x64_bf16 v[12:15], v[28:31], v[200:207], v9
    v_exp_f32 v221, v221
    v_exp_f32 v222, v222
    v_exp_f32 v223, v223
    v_mfma_f32_32x32x16_bf16 v[240:255], v[112:115], v[56:59], 0
    ds_read_b128 v[48:51], v4 offset:12288
    ds_read_b128 v[52:55], v4 offset:13312
    v_exp_f32 v224, v224
    v_exp_f32 v225, v225
    v_exp_f32 v226, v226
    v_smfmac_f32_32x32x32_bf16 v[144:159], v[120:123], v[208:215], v9
    buffer_load_dwordx4 v[104:107], v1, s[4:7], s56 offen offset:0 sc1
    v_exp_f32 v227, v227
    ds_write_b128 v5, v[128:131] offset:0
    v_exp_f32 v228, v228
    v_exp_f32 v229, v229
    v_mfma_f32_32x32x16_bf16 v[240:255], v[116:119], v[60:63], v[240:255]
    ds_write_b128 v5, v[132:135] offset:1024
    v_exp_f32 v230, v230
    v_exp_f32 v231, v231
    v_exp_f32 v232, v232
    v_smfmac_f32_16x16x64_bf16 v[16:19], v[28:31], v[208:215], v9
    ds_write_b32 v6, v12 offset:0
    v_exp_f32 v233, v233
    v_smfmac_f32_32x32x32_bf16 v[144:159], v[124:127], v[216:223], v9
    ds_write_b128 v5, v[136:139] offset:2048
    v_exp_f32 v234, v234
    v_exp_f32 v235, v235
    v_exp_f32 v236, v236
    v_smfmac_f32_16x16x64_bf16 v[16:19], v[28:31], v[216:223], v9
    ds_write_b128 v5, v[140:143] offset:3072
    v_exp_f32 v237, v237
    v_exp_f32 v238, v238
    v_exp_f32 v239, v239
    s_waitcnt vmcnt(7)
    s_waitcnt lgkmcnt(9)
    v_mfma_f32_32x32x16_bf16 v[192:207], v[64:67], v[32:35], 0
    ds_read_b128 v[56:59], v4 offset:14336
    ds_read_b128 v[60:63], v4 offset:15360
    v_exp_f32 v240, v240
    v_exp_f32 v241, v241
    v_exp_f32 v242, v242
    v_smfmac_f32_32x32x32_bf16 v[160:175], v[120:123], v[224:231], v9
    buffer_load_dwordx4 v[108:111], v1, s[4:7], s56 offen offset:1024 sc1
    v_exp_f32 v243, v243
    ds_write_b128 v5, v[144:147] offset:16384
    v_exp_f32 v244, v244
    v_exp_f32 v245, v245
    v_mfma_f32_32x32x16_bf16 v[192:207], v[68:71], v[36:39], v[192:207]
    ds_write_b128 v5, v[148:151] offset:17408
    v_exp_f32 v246, v246
    v_exp_f32 v247, v247
    v_exp_f32 v248, v248
    s_waitcnt lgkmcnt(4)
    v_mfma_f32_32x32x8_bf16 v[128:143], v[10:11], v[10:11], 0
    v_mov_b32 v12, 0
    v_smfmac_f32_16x16x64_bf16 v[20:23], v[28:31], v[224:231], v9
    ds_write_b32 v6, v16 offset:1024
    v_exp_f32 v249, v249
    v_smfmac_f32_32x32x32_bf16 v[160:175], v[124:127], v[232:239], v9
    ds_write_b128 v5, v[152:155] offset:18432
    v_exp_f32 v250, v250
    v_exp_f32 v251, v251
    v_exp_f32 v252, v252
    v_smfmac_f32_16x16x64_bf16 v[20:23], v[28:31], v[232:239], v9
    ds_write_b128 v5, v[156:159] offset:19456
    v_exp_f32 v253, v253
    v_exp_f32 v254, v254
    v_exp_f32 v255, v255
    s_cmp_lg_u32 s57, 0
    s_cbranch_scc1 b_tail
    v_mfma_f32_32x32x16_bf16 v[208:223], v[64:67], v[40:43], 0
    s_add_u32 s54, s54, 8192
    s_and_b32 s54, s54, 0x1ffff
    s_add_u32 s55, s53, s54
    s_add_u32 s56, s55, 4194304
    v_exp_f32 v192, v192
    v_exp_f32 v193, v193
    v_exp_f32 v194, v194
    v_smfmac_f32_32x32x32_bf16 v[176:191], v[120:123], v[240:247], v9
    buffer_load_dwordx4 v[112:115], v1, s[4:7], s55 offen offset:0 sc1
    v_exp_f32 v195, v195
    ds_write_b128 v5, v[160:163] offset:32768
    v_exp_f32 v196, v196
    v_exp_f32 v197, v197
    v_mfma_f32_32x32x16_bf16 v[208:223], v[68:71], v[44:47], v[208:223]
    ds_write_b128 v5, v[164:167] offset:33792
    v_exp_f32 v198, v198
    v_exp_f32 v199, v199
    v_exp_f32 v200, v200
    s_waitcnt lgkmcnt(2)
    v_mfma_f32_32x32x8_bf16 v[144:159], v[10:11], v[10:11], 0
    v_mov_b32 v16, 0
    v_smfmac_f32_16x16x64_bf16 v[24:27], v[28:31], v[240:247], v9
    ds_write_b32 v6, v20 offset:2048
    v_exp_f32 v201, v201
    v_smfmac_f32_32x32x32_bf16 v[176:191], v[124:127], v[248:255], v9
    ds_write_b128 v5, v[168:171] offset:34816
    v_exp_f32 v202, v202
    v_exp_f32 v203, v203
    v_exp_f32 v204, v204
    v_smfmac_f32_16x16x64_bf16 v[24:27], v[28:31], v[248:255], v9
    ds_write_b128 v5, v[172:175] offset:35840
    v_exp_f32 v205, v205
    v_exp_f32 v206, v206
    v_exp_f32 v207, v207
    v_mfma_f32_32x32x16_bf16 v[224:239], v[64:67], v[48:51], 0
    v_exp_f32 v208, v208
    v_exp_f32 v209, v209
    v_exp_f32 v210, v210
    v_smfmac_f32_32x32x32_bf16 v[128:143], v[72:75], v[192:199], v9
    buffer_load_dwordx4 v[116:119], v1, s[4:7], s55 offen offset:1024 sc1
    v_exp_f32 v211, v211
    ds_write_b128 v5, v[176:179] offset:49152
    v_exp_f32 v212, v212
    v_exp_f32 v213, v213
    v_mfma_f32_32x32x16_bf16 v[224:239], v[68:71], v[52:55], v[224:239]
    ds_write_b128 v5, v[180:183] offset:50176
    v_exp_f32 v214, v214
    v_exp_f32 v215, v215
    v_exp_f32 v216, v216
    s_waitcnt lgkmcnt(2)
    v_mfma_f32_32x32x8_bf16 v[160:175], v[10:11], v[10:11], 0
    v_mov_b32 v20, 0
    v_smfmac_f32_16x16x64_bf16 v[12:15], v[28:31], v[192:199], v9
    ds_write_b32 v6, v24 offset:3072
    v_exp_f32 v217, v217
    v_smfmac_f32_32x32x32_bf16 v[128:143], v[76:79], v[200:207], v9
    ds_write_b128 v5, v[184:187] offset:51200
    v_exp_f32 v218, v218
    v_exp_f32 v219, v219
    v_exp_f32 v220, v220
    v_smfmac_f32_16x16x64_bf16 v[12:15], v[28:31], v[200:207], v9
    ds_write_b128 v5, v[188:191] offset:52224
    v_exp_f32 v221, v221
    v_exp_f32 v222, v222
    v_exp_f32 v223, v223
    s_waitcnt lgkmcnt(0)
    v_mfma_f32_32x32x8_bf16 v[176:191], v[10:11], v[10:11], 0
    v_mov_b32 v24, 0
    s_barrier
    s_mov_b32 s57, 1
    s_branch b_head
b_tail:
    v_smfmac_f32_32x32x32_bf16 v[176:191], v[120:123], v[240:247], v9
    v_smfmac_f32_32x32x32_bf16 v[176:191], v[124:127], v[248:255], v9
    ds_write_b128 v5, v[160:163] offset:32768
    ds_write_b128 v5, v[164:167] offset:33792
    v_smfmac_f32_16x16x64_bf16 v[24:27], v[28:31], v[240:247], v9
    ds_write_b128 v5, v[168:171] offset:34816
    v_smfmac_f32_16x16x64_bf16 v[24:27], v[28:31], v[248:255], v9
    ds_write_b128 v5, v[172:175] offset:35840
    ds_write_b32 v6, v20 offset:2048
    s_nop 4
    ds_write_b128 v5, v[176:179] offset:49152
    ds_write_b128 v5, v[180:183] offset:50176
    ds_write_b128 v5, v[184:187] offset:51200
    ds_write_b128 v5, v[188:191] offset:52224
    s_nop 0
    ds_write_b32 v6, v24 offset:3072
    buffer_load_dwordx4 v[224:227], v2, s[4:7], s43 offen offset:0 sc1
    buffer_load_dwordx4 v[228:231], v2, s[4:7], s43 offen offset:256 sc1
    buffer_load_dwordx4 v[232:235], v2, s[4:7], s43 offen offset:2048 sc1
    buffer_load_dwordx4 v[236:239], v2, s[4:7], s43 offen offset:2304 sc1
    s_waitcnt lgkmcnt(0)
    s_barrier
    v_xor_b32 v4, 32, v3
    v_xor_b32 v5, 64, v3
    v_xor_b32 v6, 96, v3
c_wo:
    s_xor_b32 s42, s41, 0
    buffer_load_dwordx4 v[64:67], v2, s[4:7], s42 offen offset:0 sc1
    buffer_load_dwordx4 v[68:71], v2, s[4:7], s42 offen offset:256 sc1
    s_xor_b32 s42, s41, 4096
    buffer_load_dwordx4 v[72:75], v2, s[4:7], s42 offen offset:0 sc1
    buffer_load_dwordx4 v[76:79], v2, s[4:7], s42 offen offset:256 sc1
    s_xor_b32 s42, s41, 8192
    buffer_load_dwordx4 v[80:83], v2, s[4:7], s42 offen offset:0 sc1
    buffer_load_dwordx4 v[84:87], v2, s[4:7], s42 offen offset:256 sc1
    s_xor_b32 s42, s41, 12288
    buffer_load_dwordx4 v[88:91], v2, s[4:7], s42 offen offset:0 sc1
    buffer_load_dwordx4 v[92:95], v2, s[4:7], s42 offen offset:256 sc1
    s_xor_b32 s42, s41, 16384
    buffer_load_dwordx4 v[96:99], v2, s[4:7], s42 offen offset:0 sc1
    buffer_load_dwordx4 v[100:103], v2, s[4:7], s42 offen offset:256 sc1
    ds_read_b64_tr_b16 v[32:33], v3 offset:0
    ds_read_b64_tr_b16 v[34:35], v3 offset:1024
    ds_read_b64_tr_b16 v[36:37], v4 offset:0
    ds_read_b64_tr_b16 v[38:39], v4 offset:1024
    ds_read_b64_tr_b16 v[40:41], v5 offset:0
    ds_read_b64_tr_b16 v[42:43], v5 offset:1024
    ds_read_b64_tr_b16 v[44:45], v6 offset:0
    ds_read_b64_tr_b16 v[46:47], v6 offset:1024
    ds_read_b64_tr_b16 v[48:49], v3 offset:4096
    ds_read_b64_tr_b16 v[50:51], v3 offset:5120
    ds_read_b64_tr_b16 v[52:53], v4 offset:4096
    ds_read_b64_tr_b16 v[54:55], v4 offset:5120
    ds_read_b64_tr_b16 v[56:57], v5 offset:4096
    ds_read_b64_tr_b16 v[58:59], v5 offset:5120
    v_lshrrev_b32 v12, 4, v1
    v_and_b32 v13, 1, v12
    v_lshlrev_b32 v13, 4, v13
    v_mov_b32 v14, 0x3f80
    v_lshlrev_b32 v13, v13, v14
    v_lshrrev_b32 v14, 2, v12
    v_lshrrev_b32 v15, 4, v12
    v_xor_b32 v14, v14, v15
    v_and_b32 v14, 1, v14
    v_bfe_u32 v15, v12, 3, 1
    v_bfe_u32 v16, v12, 1, 1
    v_lshl_add_u32 v15, v15, 1, v16
    v_lshrrev_b32 v16, 5, v12
    v_lshl_add_u32 v15, v16, 2, v15
    v_lshl_add_u32 v15, v14, 3, v15
    v_cmp_eq_u32 vcc, 0, v15
    s_nop 1
    v_cndmask_b32 v240, 0, v13, vcc
    v_cmp_eq_u32 vcc, 1, v15
    s_nop 1
    v_cndmask_b32 v241, 0, v13, vcc
    v_cmp_eq_u32 vcc, 2, v15
    s_nop 1
    v_cndmask_b32 v242, 0, v13, vcc
    v_cmp_eq_u32 vcc, 3, v15
    s_nop 1
    v_cndmask_b32 v243, 0, v13, vcc
    v_cmp_eq_u32 vcc, 4, v15
    s_nop 1
    v_cndmask_b32 v244, 0, v13, vcc
    v_cmp_eq_u32 vcc, 5, v15
    s_nop 1
    v_cndmask_b32 v245, 0, v13, vcc
    v_cmp_eq_u32 vcc, 6, v15
    s_nop 1
    v_cndmask_b32 v246, 0, v13, vcc
    v_cmp_eq_u32 vcc, 7, v15
    s_nop 1
    v_cndmask_b32 v247, 0, v13, vcc
    s_waitcnt vmcnt(10)
    v_mfma_f32_16x16x32_bf16 v[128:131], v[240:243], v[224:227], 0
    v_mfma_f32_16x16x32_bf16 v[132:135], v[240:243], v[228:231], 0
    v_mfma_f32_16x16x32_bf16 v[136:139], v[244:247], v[224:227], 0
    v_mfma_f32_16x16x32_bf16 v[140:143], v[244:247], v[228:231], 0
    v_mfma_f32_16x16x32_bf16 v[144:147], v[240:243], v[232:235], 0
    v_mfma_f32_16x16x32_bf16 v[148:151], v[240:243], v[236:239], 0
    v_mfma_f32_16x16x32_bf16 v[152:155], v[244:247], v[232:235], 0
    v_mfma_f32_16x16x32_bf16 v[156:159], v[244:247], v[236:239], 0
    s_waitcnt vmcnt(8) lgkmcnt(10)
    v_mfma_f32_16x16x32_bf16 v[128:131], v[32:35], v[64:67], v[128:131]
    ds_read_b64_tr_b16 v[60:61], v6 offset:4096
    s_xor_b32 s42, s41, 20480
    buffer_load_dwordx4 v[104:107], v2, s[4:7], s42 offen offset:0 sc1
    v_mfma_f32_16x16x32_bf16 v[132:135], v[32:35], v[68:71], v[132:135]
    ds_read_b64_tr_b16 v[62:63], v6 offset:5120
    v_mfma_f32_16x16x32_bf16 v[136:139], v[36:39], v[64:67], v[136:139]
    ds_read_b64_tr_b16 v[32:33], v3 offset:8192
    v_mfma_f32_16x16x32_bf16 v[140:143], v[36:39], v[68:71], v[140:143]
    ds_read_b64_tr_b16 v[34:35], v3 offset:9216
    s_waitcnt lgkmcnt(10)
    v_mfma_f32_16x16x32_bf16 v[144:147], v[40:43], v[64:67], v[144:147]
    ds_read_b64_tr_b16 v[36:37], v4 offset:8192
    buffer_load_dwordx4 v[108:111], v2, s[4:7], s42 offen offset:256 sc1
    v_mfma_f32_16x16x32_bf16 v[148:151], v[40:43], v[68:71], v[148:151]
    ds_read_b64_tr_b16 v[38:39], v4 offset:9216
    v_mfma_f32_16x16x32_bf16 v[152:155], v[44:47], v[64:67], v[152:155]
    ds_read_b64_tr_b16 v[40:41], v5 offset:8192
    v_mfma_f32_16x16x32_bf16 v[156:159], v[44:47], v[68:71], v[156:159]
    ds_read_b64_tr_b16 v[42:43], v5 offset:9216
    s_waitcnt vmcnt(8) lgkmcnt(10)
    v_mfma_f32_16x16x32_bf16 v[128:131], v[48:51], v[72:75], v[128:131]
    ds_read_b64_tr_b16 v[44:45], v6 offset:8192
    s_xor_b32 s42, s41, 24576
    buffer_load_dwordx4 v[112:115], v2, s[4:7], s42 offen offset:0 sc1
    v_mfma_f32_16x16x32_bf16 v[132:135], v[48:51], v[76:79], v[132:135]
    ds_read_b64_tr_b16 v[46:47], v6 offset:9216
    v_mfma_f32_16x16x32_bf16 v[136:139], v[52:55], v[72:75], v[136:139]
    ds_read_b64_tr_b16 v[48:49], v3 offset:12288
    v_mfma_f32_16x16x32_bf16 v[140:143], v[52:55], v[76:79], v[140:143]
    ds_read_b64_tr_b16 v[50:51], v3 offset:13312
    s_waitcnt lgkmcnt(10)
    v_mfma_f32_16x16x32_bf16 v[144:147], v[56:59], v[72:75], v[144:147]
    ds_read_b64_tr_b16 v[52:53], v4 offset:12288
    buffer_load_dwordx4 v[116:119], v2, s[4:7], s42 offen offset:256 sc1
    v_mfma_f32_16x16x32_bf16 v[148:151], v[56:59], v[76:79], v[148:151]
    ds_read_b64_tr_b16 v[54:55], v4 offset:13312
    v_mfma_f32_16x16x32_bf16 v[152:155], v[60:63], v[72:75], v[152:155]
    ds_read_b64_tr_b16 v[56:57], v5 offset:12288
    v_mfma_f32_16x16x32_bf16 v[156:159], v[60:63], v[76:79], v[156:159]
    ds_read_b64_tr_b16 v[58:59], v5 offset:13312
    s_waitcnt vmcnt(8) lgkmcnt(10)
    v_mfma_f32_16x16x32_bf16 v[128:131], v[32:35], v[80:83], v[128:131]
    ds_read_b64_tr_b16 v[60:61], v6 offset:12288
    s_xor_b32 s42, s41, 28672
    buffer_load_dwordx4 v[120:123], v2, s[4:7], s42 offen offset:0 sc1
    v_mfma_f32_16x16x32_bf16 v[132:135], v[32:35], v[84:87], v[132:135]
    ds_read_b64_tr_b16 v[62:63], v6 offset:13312
    v_mfma_f32_16x16x32_bf16 v[136:139], v[36:39], v[80:83], v[136:139]
    ds_read_b64_tr_b16 v[32:33], v3 offset:16384
    v_mfma_f32_16x16x32_bf16 v[140:143], v[36:39], v[84:87], v[140:143]
    ds_read_b64_tr_b16 v[34:35], v3 offset:17408
    s_waitcnt lgkmcnt(10)
    v_mfma_f32_16x16x32_bf16 v[144:147], v[40:43], v[80:83], v[144:147]
    ds_read_b64_tr_b16 v[36:37], v4 offset:16384
    buffer_load_dwordx4 v[124:127], v2, s[4:7], s42 offen offset:256 sc1
    v_mfma_f32_16x16x32_bf16 v[148:151], v[40:43], v[84:87], v[148:151]
    ds_read_b64_tr_b16 v[38:39], v4 offset:17408
    v_mfma_f32_16x16x32_bf16 v[152:155], v[44:47], v[80:83], v[152:155]
    ds_read_b64_tr_b16 v[40:41], v5 offset:16384
    v_mfma_f32_16x16x32_bf16 v[156:159], v[44:47], v[84:87], v[156:159]
    ds_read_b64_tr_b16 v[42:43], v5 offset:17408
    s_waitcnt vmcnt(8) lgkmcnt(10)
    v_mfma_f32_16x16x32_bf16 v[128:131], v[48:51], v[88:91], v[128:131]
    ds_read_b64_tr_b16 v[44:45], v6 offset:16384
    s_xor_b32 s42, s41, 32768
    buffer_load_dwordx4 v[160:163], v2, s[4:7], s42 offen offset:0 sc1
    v_mfma_f32_16x16x32_bf16 v[132:135], v[48:51], v[92:95], v[132:135]
    ds_read_b64_tr_b16 v[46:47], v6 offset:17408
    v_mfma_f32_16x16x32_bf16 v[136:139], v[52:55], v[88:91], v[136:139]
    ds_read_b64_tr_b16 v[48:49], v3 offset:20480
    v_mfma_f32_16x16x32_bf16 v[140:143], v[52:55], v[92:95], v[140:143]
    ds_read_b64_tr_b16 v[50:51], v3 offset:21504
    s_waitcnt lgkmcnt(10)
    v_mfma_f32_16x16x32_bf16 v[144:147], v[56:59], v[88:91], v[144:147]
    ds_read_b64_tr_b16 v[52:53], v4 offset:20480
    buffer_load_dwordx4 v[164:167], v2, s[4:7], s42 offen offset:256 sc1
    v_mfma_f32_16x16x32_bf16 v[148:151], v[56:59], v[92:95], v[148:151]
    ds_read_b64_tr_b16 v[54:55], v4 offset:21504
    v_mfma_f32_16x16x32_bf16 v[152:155], v[60:63], v[88:91], v[152:155]
    ds_read_b64_tr_b16 v[56:57], v5 offset:20480
    v_mfma_f32_16x16x32_bf16 v[156:159], v[60:63], v[92:95], v[156:159]
    ds_read_b64_tr_b16 v[58:59], v5 offset:21504
    s_waitcnt vmcnt(8) lgkmcnt(10)
    v_mfma_f32_16x16x32_bf16 v[128:131], v[32:35], v[96:99], v[128:131]
    ds_read_b64_tr_b16 v[60:61], v6 offset:20480
    s_xor_b32 s42, s41, 36864
    buffer_load_dwordx4 v[168:171], v2, s[4:7], s42 offen offset:0 sc1
    v_mfma_f32_16x16x32_bf16 v[132:135], v[32:35], v[100:103], v[132:135]
    ds_read_b64_tr_b16 v[62:63], v6 offset:21504
    v_mfma_f32_16x16x32_bf16 v[136:139], v[36:39], v[96:99], v[136:139]
    ds_read_b64_tr_b16 v[32:33], v3 offset:24576
    v_mfma_f32_16x16x32_bf16 v[140:143], v[36:39], v[100:103], v[140:143]
    ds_read_b64_tr_b16 v[34:35], v3 offset:25600
    s_waitcnt lgkmcnt(10)
    v_mfma_f32_16x16x32_bf16 v[144:147], v[40:43], v[96:99], v[144:147]
    ds_read_b64_tr_b16 v[36:37], v4 offset:24576
    buffer_load_dwordx4 v[172:175], v2, s[4:7], s42 offen offset:256 sc1
    v_mfma_f32_16x16x32_bf16 v[148:151], v[40:43], v[100:103], v[148:151]
    ds_read_b64_tr_b16 v[38:39], v4 offset:25600
    v_mfma_f32_16x16x32_bf16 v[152:155], v[44:47], v[96:99], v[152:155]
    ds_read_b64_tr_b16 v[40:41], v5 offset:24576
    v_mfma_f32_16x16x32_bf16 v[156:159], v[44:47], v[100:103], v[156:159]
    ds_read_b64_tr_b16 v[42:43], v5 offset:25600
    s_waitcnt vmcnt(8) lgkmcnt(10)
    v_mfma_f32_16x16x32_bf16 v[128:131], v[48:51], v[104:107], v[128:131]
    ds_read_b64_tr_b16 v[44:45], v6 offset:24576
    s_xor_b32 s42, s41, 40960
    buffer_load_dwordx4 v[176:179], v2, s[4:7], s42 offen offset:0 sc1
    v_mfma_f32_16x16x32_bf16 v[132:135], v[48:51], v[108:111], v[132:135]
    ds_read_b64_tr_b16 v[46:47], v6 offset:25600
    v_mfma_f32_16x16x32_bf16 v[136:139], v[52:55], v[104:107], v[136:139]
    ds_read_b64_tr_b16 v[48:49], v3 offset:28672
    v_mfma_f32_16x16x32_bf16 v[140:143], v[52:55], v[108:111], v[140:143]
    ds_read_b64_tr_b16 v[50:51], v3 offset:29696
    s_waitcnt lgkmcnt(10)
    v_mfma_f32_16x16x32_bf16 v[144:147], v[56:59], v[104:107], v[144:147]
    ds_read_b64_tr_b16 v[52:53], v4 offset:28672
    buffer_load_dwordx4 v[180:183], v2, s[4:7], s42 offen offset:256 sc1
    v_mfma_f32_16x16x32_bf16 v[148:151], v[56:59], v[108:111], v[148:151]
    ds_read_b64_tr_b16 v[54:55], v4 offset:29696
    v_mfma_f32_16x16x32_bf16 v[152:155], v[60:63], v[104:107], v[152:155]
    ds_read_b64_tr_b16 v[56:57], v5 offset:28672
    v_mfma_f32_16x16x32_bf16 v[156:159], v[60:63], v[108:111], v[156:159]
    ds_read_b64_tr_b16 v[58:59], v5 offset:29696
    s_waitcnt vmcnt(8) lgkmcnt(10)
    v_mfma_f32_16x16x32_bf16 v[128:131], v[32:35], v[112:115], v[128:131]
    ds_read_b64_tr_b16 v[60:61], v6 offset:28672
    s_xor_b32 s42, s41, 45056
    buffer_load_dwordx4 v[184:187], v2, s[4:7], s42 offen offset:0 sc1
    v_mfma_f32_16x16x32_bf16 v[132:135], v[32:35], v[116:119], v[132:135]
    ds_read_b64_tr_b16 v[62:63], v6 offset:29696
    v_mfma_f32_16x16x32_bf16 v[136:139], v[36:39], v[112:115], v[136:139]
    ds_read_b64_tr_b16 v[32:33], v3 offset:32768
    v_mfma_f32_16x16x32_bf16 v[140:143], v[36:39], v[116:119], v[140:143]
    ds_read_b64_tr_b16 v[34:35], v3 offset:33792
    s_waitcnt lgkmcnt(10)
    v_mfma_f32_16x16x32_bf16 v[144:147], v[40:43], v[112:115], v[144:147]
    ds_read_b64_tr_b16 v[36:37], v4 offset:32768
    buffer_load_dwordx4 v[188:191], v2, s[4:7], s42 offen offset:256 sc1
    v_mfma_f32_16x16x32_bf16 v[148:151], v[40:43], v[116:119], v[148:151]
    ds_read_b64_tr_b16 v[38:39], v4 offset:33792
    v_mfma_f32_16x16x32_bf16 v[152:155], v[44:47], v[112:115], v[152:155]
    ds_read_b64_tr_b16 v[40:41], v5 offset:32768
    v_mfma_f32_16x16x32_bf16 v[156:159], v[44:47], v[116:119], v[156:159]
    ds_read_b64_tr_b16 v[42:43], v5 offset:33792
    s_waitcnt vmcnt(8) lgkmcnt(10)
    v_mfma_f32_16x16x32_bf16 v[128:131], v[48:51], v[120:123], v[128:131]
    ds_read_b64_tr_b16 v[44:45], v6 offset:32768
    s_xor_b32 s42, s41, 49152
    buffer_load_dwordx4 v[64:67], v2, s[4:7], s42 offen offset:0 sc1
    v_mfma_f32_16x16x32_bf16 v[132:135], v[48:51], v[124:127], v[132:135]
    ds_read_b64_tr_b16 v[46:47], v6 offset:33792
    v_mfma_f32_16x16x32_bf16 v[136:139], v[52:55], v[120:123], v[136:139]
    ds_read_b64_tr_b16 v[48:49], v3 offset:36864
    v_mfma_f32_16x16x32_bf16 v[140:143], v[52:55], v[124:127], v[140:143]
    ds_read_b64_tr_b16 v[50:51], v3 offset:37888
    s_waitcnt lgkmcnt(10)
    v_mfma_f32_16x16x32_bf16 v[144:147], v[56:59], v[120:123], v[144:147]
    ds_read_b64_tr_b16 v[52:53], v4 offset:36864
    buffer_load_dwordx4 v[68:71], v2, s[4:7], s42 offen offset:256 sc1
    v_mfma_f32_16x16x32_bf16 v[148:151], v[56:59], v[124:127], v[148:151]
    ds_read_b64_tr_b16 v[54:55], v4 offset:37888
    v_mfma_f32_16x16x32_bf16 v[152:155], v[60:63], v[120:123], v[152:155]
    ds_read_b64_tr_b16 v[56:57], v5 offset:36864
    v_mfma_f32_16x16x32_bf16 v[156:159], v[60:63], v[124:127], v[156:159]
    ds_read_b64_tr_b16 v[58:59], v5 offset:37888
    s_waitcnt vmcnt(8) lgkmcnt(10)
    v_mfma_f32_16x16x32_bf16 v[128:131], v[32:35], v[160:163], v[128:131]
    ds_read_b64_tr_b16 v[60:61], v6 offset:36864
    s_xor_b32 s42, s41, 53248
    buffer_load_dwordx4 v[72:75], v2, s[4:7], s42 offen offset:0 sc1
    v_mfma_f32_16x16x32_bf16 v[132:135], v[32:35], v[164:167], v[132:135]
    ds_read_b64_tr_b16 v[62:63], v6 offset:37888
    v_mfma_f32_16x16x32_bf16 v[136:139], v[36:39], v[160:163], v[136:139]
    ds_read_b64_tr_b16 v[32:33], v3 offset:40960
    v_mfma_f32_16x16x32_bf16 v[140:143], v[36:39], v[164:167], v[140:143]
    ds_read_b64_tr_b16 v[34:35], v3 offset:41984
    s_waitcnt lgkmcnt(10)
    v_mfma_f32_16x16x32_bf16 v[144:147], v[40:43], v[160:163], v[144:147]
    ds_read_b64_tr_b16 v[36:37], v4 offset:40960
    buffer_load_dwordx4 v[76:79], v2, s[4:7], s42 offen offset:256 sc1
    v_mfma_f32_16x16x32_bf16 v[148:151], v[40:43], v[164:167], v[148:151]
    ds_read_b64_tr_b16 v[38:39], v4 offset:41984
    v_mfma_f32_16x16x32_bf16 v[152:155], v[44:47], v[160:163], v[152:155]
    ds_read_b64_tr_b16 v[40:41], v5 offset:40960
    v_mfma_f32_16x16x32_bf16 v[156:159], v[44:47], v[164:167], v[156:159]
    ds_read_b64_tr_b16 v[42:43], v5 offset:41984
    s_waitcnt vmcnt(8) lgkmcnt(10)
    v_mfma_f32_16x16x32_bf16 v[128:131], v[48:51], v[168:171], v[128:131]
    ds_read_b64_tr_b16 v[44:45], v6 offset:40960
    s_xor_b32 s42, s41, 57344
    buffer_load_dwordx4 v[80:83], v2, s[4:7], s42 offen offset:0 sc1
    v_mfma_f32_16x16x32_bf16 v[132:135], v[48:51], v[172:175], v[132:135]
    ds_read_b64_tr_b16 v[46:47], v6 offset:41984
    v_mfma_f32_16x16x32_bf16 v[136:139], v[52:55], v[168:171], v[136:139]
    ds_read_b64_tr_b16 v[48:49], v3 offset:45056
    v_mfma_f32_16x16x32_bf16 v[140:143], v[52:55], v[172:175], v[140:143]
    ds_read_b64_tr_b16 v[50:51], v3 offset:46080
    s_waitcnt lgkmcnt(10)
    v_mfma_f32_16x16x32_bf16 v[144:147], v[56:59], v[168:171], v[144:147]
    ds_read_b64_tr_b16 v[52:53], v4 offset:45056
    buffer_load_dwordx4 v[84:87], v2, s[4:7], s42 offen offset:256 sc1
    v_mfma_f32_16x16x32_bf16 v[148:151], v[56:59], v[172:175], v[148:151]
    ds_read_b64_tr_b16 v[54:55], v4 offset:46080
    v_mfma_f32_16x16x32_bf16 v[152:155], v[60:63], v[168:171], v[152:155]
    ds_read_b64_tr_b16 v[56:57], v5 offset:45056
    v_mfma_f32_16x16x32_bf16 v[156:159], v[60:63], v[172:175], v[156:159]
    ds_read_b64_tr_b16 v[58:59], v5 offset:46080
    s_waitcnt vmcnt(8) lgkmcnt(10)
    v_mfma_f32_16x16x32_bf16 v[128:131], v[32:35], v[176:179], v[128:131]
    ds_read_b64_tr_b16 v[60:61], v6 offset:45056
    s_xor_b32 s42, s41, 61440
    buffer_load_dwordx4 v[88:91], v2, s[4:7], s42 offen offset:0 sc1
    v_mfma_f32_16x16x32_bf16 v[132:135], v[32:35], v[180:183], v[132:135]
    ds_read_b64_tr_b16 v[62:63], v6 offset:46080
    s_barrier
    v_mfma_f32_16x16x32_bf16 v[136:139], v[36:39], v[176:179], v[136:139]
    ds_read_b64_tr_b16 v[32:33], v3 offset:49152
    v_mfma_f32_16x16x32_bf16 v[140:143], v[36:39], v[180:183], v[140:143]
    ds_read_b64_tr_b16 v[34:35], v3 offset:50176
    s_waitcnt lgkmcnt(10)
    v_mfma_f32_16x16x32_bf16 v[144:147], v[40:43], v[176:179], v[144:147]
    ds_read_b64_tr_b16 v[36:37], v4 offset:49152
    buffer_load_dwordx4 v[92:95], v2, s[4:7], s42 offen offset:256 sc1
    v_mfma_f32_16x16x32_bf16 v[148:151], v[40:43], v[180:183], v[148:151]
    ds_read_b64_tr_b16 v[38:39], v4 offset:50176
    v_mfma_f32_16x16x32_bf16 v[152:155], v[44:47], v[176:179], v[152:155]
    ds_read_b64_tr_b16 v[40:41], v5 offset:49152
    v_mfma_f32_16x16x32_bf16 v[156:159], v[44:47], v[180:183], v[156:159]
    ds_read_b64_tr_b16 v[42:43], v5 offset:50176
    s_waitcnt vmcnt(8) lgkmcnt(10)
    v_mfma_f32_16x16x32_bf16 v[128:131], v[48:51], v[184:187], v[128:131]
    ds_read_b64_tr_b16 v[44:45], v6 offset:49152
    s_xor_b32 s42, s41, 0
    buffer_load_dwordx4 v[96:99], v2, s[4:7], s42 offen offset:2048 sc1
    v_mfma_f32_16x16x32_bf16 v[132:135], v[48:51], v[188:191], v[132:135]
    ds_read_b64_tr_b16 v[46:47], v6 offset:50176
    v_mfma_f32_16x16x32_bf16 v[136:139], v[52:55], v[184:187], v[136:139]
    ds_read_b64_tr_b16 v[48:49], v3 offset:53248
    v_mfma_f32_16x16x32_bf16 v[140:143], v[52:55], v[188:191], v[140:143]
    ds_read_b64_tr_b16 v[50:51], v3 offset:54272
    s_waitcnt lgkmcnt(10)
    v_mfma_f32_16x16x32_bf16 v[144:147], v[56:59], v[184:187], v[144:147]
    ds_read_b64_tr_b16 v[52:53], v4 offset:53248
    buffer_load_dwordx4 v[100:103], v2, s[4:7], s42 offen offset:2304 sc1
    v_mfma_f32_16x16x32_bf16 v[148:151], v[56:59], v[188:191], v[148:151]
    ds_read_b64_tr_b16 v[54:55], v4 offset:54272
    v_mfma_f32_16x16x32_bf16 v[152:155], v[60:63], v[184:187], v[152:155]
    ds_read_b64_tr_b16 v[56:57], v5 offset:53248
    v_mfma_f32_16x16x32_bf16 v[156:159], v[60:63], v[188:191], v[156:159]
    ds_read_b64_tr_b16 v[58:59], v5 offset:54272
    s_waitcnt vmcnt(8) lgkmcnt(10)
    v_mfma_f32_16x16x32_bf16 v[128:131], v[32:35], v[64:67], v[128:131]
    ds_read_b64_tr_b16 v[60:61], v6 offset:53248
    s_xor_b32 s42, s41, 4096
    buffer_load_dwordx4 v[104:107], v2, s[4:7], s42 offen offset:2048 sc1
    v_mfma_f32_16x16x32_bf16 v[132:135], v[32:35], v[68:71], v[132:135]
    ds_read_b64_tr_b16 v[62:63], v6 offset:54272
    v_mfma_f32_16x16x32_bf16 v[136:139], v[36:39], v[64:67], v[136:139]
    ds_read_b64_tr_b16 v[32:33], v3 offset:57344
    v_mfma_f32_16x16x32_bf16 v[140:143], v[36:39], v[68:71], v[140:143]
    ds_read_b64_tr_b16 v[34:35], v3 offset:58368
    s_waitcnt lgkmcnt(10)
    v_mfma_f32_16x16x32_bf16 v[144:147], v[40:43], v[64:67], v[144:147]
    ds_read_b64_tr_b16 v[36:37], v4 offset:57344
    buffer_load_dwordx4 v[108:111], v2, s[4:7], s42 offen offset:2304 sc1
    v_mfma_f32_16x16x32_bf16 v[148:151], v[40:43], v[68:71], v[148:151]
    ds_read_b64_tr_b16 v[38:39], v4 offset:58368
    v_mfma_f32_16x16x32_bf16 v[152:155], v[44:47], v[64:67], v[152:155]
    ds_read_b64_tr_b16 v[40:41], v5 offset:57344
    v_mfma_f32_16x16x32_bf16 v[156:159], v[44:47], v[68:71], v[156:159]
    ds_read_b64_tr_b16 v[42:43], v5 offset:58368
    s_waitcnt vmcnt(8) lgkmcnt(10)
    v_mfma_f32_16x16x32_bf16 v[128:131], v[48:51], v[72:75], v[128:131]
    ds_read_b64_tr_b16 v[44:45], v6 offset:57344
    s_xor_b32 s42, s41, 8192
    buffer_load_dwordx4 v[112:115], v2, s[4:7], s42 offen offset:2048 sc1
    v_mfma_f32_16x16x32_bf16 v[132:135], v[48:51], v[76:79], v[132:135]
    ds_read_b64_tr_b16 v[46:47], v6 offset:58368
    v_mfma_f32_16x16x32_bf16 v[136:139], v[52:55], v[72:75], v[136:139]
    ds_read_b64_tr_b16 v[48:49], v3 offset:61440
    v_mfma_f32_16x16x32_bf16 v[140:143], v[52:55], v[76:79], v[140:143]
    ds_read_b64_tr_b16 v[50:51], v3 offset:62464
    s_waitcnt lgkmcnt(10)
    v_mfma_f32_16x16x32_bf16 v[144:147], v[56:59], v[72:75], v[144:147]
    ds_read_b64_tr_b16 v[52:53], v4 offset:61440
    buffer_load_dwordx4 v[116:119], v2, s[4:7], s42 offen offset:2304 sc1
    v_mfma_f32_16x16x32_bf16 v[148:151], v[56:59], v[76:79], v[148:151]
    ds_read_b64_tr_b16 v[54:55], v4 offset:62464
    v_mfma_f32_16x16x32_bf16 v[152:155], v[60:63], v[72:75], v[152:155]
    ds_read_b64_tr_b16 v[56:57], v5 offset:61440
    v_mfma_f32_16x16x32_bf16 v[156:159], v[60:63], v[76:79], v[156:159]
    ds_read_b64_tr_b16 v[58:59], v5 offset:62464
    s_waitcnt vmcnt(8) lgkmcnt(10)
    v_mfma_f32_16x16x32_bf16 v[128:131], v[32:35], v[80:83], v[128:131]
    ds_read_b64_tr_b16 v[60:61], v6 offset:61440
    s_xor_b32 s42, s41, 12288
    buffer_load_dwordx4 v[120:123], v2, s[4:7], s42 offen offset:2048 sc1
    v_mfma_f32_16x16x32_bf16 v[132:135], v[32:35], v[84:87], v[132:135]
    ds_read_b64_tr_b16 v[62:63], v6 offset:62464
    v_xor_b32 v3, 0x10000, v3
    v_xor_b32 v4, 0x10000, v4
    v_xor_b32 v5, 0x10000, v5
    v_xor_b32 v6, 0x10000, v6
    v_mfma_f32_16x16x32_bf16 v[136:139], v[36:39], v[80:83], v[136:139]
    ds_read_b64_tr_b16 v[32:33], v3 offset:0
    v_mfma_f32_16x16x32_bf16 v[140:143], v[36:39], v[84:87], v[140:143]
    ds_read_b64_tr_b16 v[34:35], v3 offset:1024
    s_waitcnt lgkmcnt(10)
    v_mfma_f32_16x16x32_bf16 v[144:147], v[40:43], v[80:83], v[144:147]
    ds_read_b64_tr_b16 v[36:37], v4 offset:0
    buffer_load_dwordx4 v[124:127], v2, s[4:7], s42 offen offset:2304 sc1
    v_mfma_f32_16x16x32_bf16 v[148:151], v[40:43], v[84:87], v[148:151]
    ds_read_b64_tr_b16 v[38:39], v4 offset:1024
    v_mfma_f32_16x16x32_bf16 v[152:155], v[44:47], v[80:83], v[152:155]
    ds_read_b64_tr_b16 v[40:41], v5 offset:0
    v_mfma_f32_16x16x32_bf16 v[156:159], v[44:47], v[84:87], v[156:159]
    ds_read_b64_tr_b16 v[42:43], v5 offset:1024
    s_waitcnt vmcnt(8) lgkmcnt(10)
    v_mfma_f32_16x16x32_bf16 v[128:131], v[48:51], v[88:91], v[128:131]
    ds_read_b64_tr_b16 v[44:45], v6 offset:0
    s_xor_b32 s42, s41, 16384
    buffer_load_dwordx4 v[160:163], v2, s[4:7], s42 offen offset:2048 sc1
    v_mfma_f32_16x16x32_bf16 v[132:135], v[48:51], v[92:95], v[132:135]
    ds_read_b64_tr_b16 v[46:47], v6 offset:1024
    v_mfma_f32_16x16x32_bf16 v[136:139], v[52:55], v[88:91], v[136:139]
    ds_read_b64_tr_b16 v[48:49], v3 offset:4096
    v_mfma_f32_16x16x32_bf16 v[140:143], v[52:55], v[92:95], v[140:143]
    ds_read_b64_tr_b16 v[50:51], v3 offset:5120
    s_waitcnt lgkmcnt(10)
    v_mfma_f32_16x16x32_bf16 v[144:147], v[56:59], v[88:91], v[144:147]
    ds_read_b64_tr_b16 v[52:53], v4 offset:4096
    buffer_load_dwordx4 v[164:167], v2, s[4:7], s42 offen offset:2304 sc1
    v_mfma_f32_16x16x32_bf16 v[148:151], v[56:59], v[92:95], v[148:151]
    ds_read_b64_tr_b16 v[54:55], v4 offset:5120
    v_mfma_f32_16x16x32_bf16 v[152:155], v[60:63], v[88:91], v[152:155]
    ds_read_b64_tr_b16 v[56:57], v5 offset:4096
    v_mfma_f32_16x16x32_bf16 v[156:159], v[60:63], v[92:95], v[156:159]
    ds_read_b64_tr_b16 v[58:59], v5 offset:5120
    s_waitcnt vmcnt(8) lgkmcnt(10)
    v_mfma_f32_16x16x32_bf16 v[128:131], v[32:35], v[96:99], v[128:131]
    ds_read_b64_tr_b16 v[60:61], v6 offset:4096
    s_xor_b32 s42, s41, 20480
    buffer_load_dwordx4 v[168:171], v2, s[4:7], s42 offen offset:2048 sc1
    v_mfma_f32_16x16x32_bf16 v[132:135], v[32:35], v[100:103], v[132:135]
    ds_read_b64_tr_b16 v[62:63], v6 offset:5120
    v_mfma_f32_16x16x32_bf16 v[136:139], v[36:39], v[96:99], v[136:139]
    ds_read_b64_tr_b16 v[32:33], v3 offset:8192
    v_mfma_f32_16x16x32_bf16 v[140:143], v[36:39], v[100:103], v[140:143]
    ds_read_b64_tr_b16 v[34:35], v3 offset:9216
    s_waitcnt lgkmcnt(10)
    v_mfma_f32_16x16x32_bf16 v[144:147], v[40:43], v[96:99], v[144:147]
    ds_read_b64_tr_b16 v[36:37], v4 offset:8192
    buffer_load_dwordx4 v[172:175], v2, s[4:7], s42 offen offset:2304 sc1
    v_mfma_f32_16x16x32_bf16 v[148:151], v[40:43], v[100:103], v[148:151]
    ds_read_b64_tr_b16 v[38:39], v4 offset:9216
    v_mfma_f32_16x16x32_bf16 v[152:155], v[44:47], v[96:99], v[152:155]
    ds_read_b64_tr_b16 v[40:41], v5 offset:8192
    v_mfma_f32_16x16x32_bf16 v[156:159], v[44:47], v[100:103], v[156:159]
    ds_read_b64_tr_b16 v[42:43], v5 offset:9216
    s_waitcnt vmcnt(8) lgkmcnt(10)
    v_mfma_f32_16x16x32_bf16 v[128:131], v[48:51], v[104:107], v[128:131]
    ds_read_b64_tr_b16 v[44:45], v6 offset:8192
    s_xor_b32 s42, s41, 24576
    buffer_load_dwordx4 v[176:179], v2, s[4:7], s42 offen offset:2048 sc1
    v_mfma_f32_16x16x32_bf16 v[132:135], v[48:51], v[108:111], v[132:135]
    ds_read_b64_tr_b16 v[46:47], v6 offset:9216
    v_mfma_f32_16x16x32_bf16 v[136:139], v[52:55], v[104:107], v[136:139]
    ds_read_b64_tr_b16 v[48:49], v3 offset:12288
    v_mfma_f32_16x16x32_bf16 v[140:143], v[52:55], v[108:111], v[140:143]
    ds_read_b64_tr_b16 v[50:51], v3 offset:13312
    s_waitcnt lgkmcnt(10)
    v_mfma_f32_16x16x32_bf16 v[144:147], v[56:59], v[104:107], v[144:147]
    ds_read_b64_tr_b16 v[52:53], v4 offset:12288
    buffer_load_dwordx4 v[180:183], v2, s[4:7], s42 offen offset:2304 sc1
    v_mfma_f32_16x16x32_bf16 v[148:151], v[56:59], v[108:111], v[148:151]
    ds_read_b64_tr_b16 v[54:55], v4 offset:13312
    v_mfma_f32_16x16x32_bf16 v[152:155], v[60:63], v[104:107], v[152:155]
    ds_read_b64_tr_b16 v[56:57], v5 offset:12288
    v_mfma_f32_16x16x32_bf16 v[156:159], v[60:63], v[108:111], v[156:159]
    ds_read_b64_tr_b16 v[58:59], v5 offset:13312
    s_waitcnt vmcnt(8) lgkmcnt(10)
    v_mfma_f32_16x16x32_bf16 v[128:131], v[32:35], v[112:115], v[128:131]
    ds_read_b64_tr_b16 v[60:61], v6 offset:12288
    s_xor_b32 s42, s41, 28672
    buffer_load_dwordx4 v[184:187], v2, s[4:7], s42 offen offset:2048 sc1
    v_mfma_f32_16x16x32_bf16 v[132:135], v[32:35], v[116:119], v[132:135]
    ds_read_b64_tr_b16 v[62:63], v6 offset:13312
    v_mfma_f32_16x16x32_bf16 v[136:139], v[36:39], v[112:115], v[136:139]
    ds_read_b64_tr_b16 v[32:33], v3 offset:16384
    v_mfma_f32_16x16x32_bf16 v[140:143], v[36:39], v[116:119], v[140:143]
    ds_read_b64_tr_b16 v[34:35], v3 offset:17408
    s_waitcnt lgkmcnt(10)
    v_mfma_f32_16x16x32_bf16 v[144:147], v[40:43], v[112:115], v[144:147]
    ds_read_b64_tr_b16 v[36:37], v4 offset:16384
    buffer_load_dwordx4 v[188:191], v2, s[4:7], s42 offen offset:2304 sc1
    v_mfma_f32_16x16x32_bf16 v[148:151], v[40:43], v[116:119], v[148:151]
    ds_read_b64_tr_b16 v[38:39], v4 offset:17408
    v_mfma_f32_16x16x32_bf16 v[152:155], v[44:47], v[112:115], v[152:155]
    ds_read_b64_tr_b16 v[40:41], v5 offset:16384
    v_mfma_f32_16x16x32_bf16 v[156:159], v[44:47], v[116:119], v[156:159]
    ds_read_b64_tr_b16 v[42:43], v5 offset:17408
    s_waitcnt vmcnt(8) lgkmcnt(10)
    v_mfma_f32_16x16x32_bf16 v[128:131], v[48:51], v[120:123], v[128:131]
    ds_read_b64_tr_b16 v[44:45], v6 offset:16384
    s_xor_b32 s42, s41, 32768
    buffer_load_dwordx4 v[64:67], v2, s[4:7], s42 offen offset:2048 sc1
    v_mfma_f32_16x16x32_bf16 v[132:135], v[48:51], v[124:127], v[132:135]
    ds_read_b64_tr_b16 v[46:47], v6 offset:17408
    v_mfma_f32_16x16x32_bf16 v[136:139], v[52:55], v[120:123], v[136:139]
    ds_read_b64_tr_b16 v[48:49], v3 offset:20480
    v_mfma_f32_16x16x32_bf16 v[140:143], v[52:55], v[124:127], v[140:143]
    ds_read_b64_tr_b16 v[50:51], v3 offset:21504
    s_waitcnt lgkmcnt(10)
    v_mfma_f32_16x16x32_bf16 v[144:147], v[56:59], v[120:123], v[144:147]
    ds_read_b64_tr_b16 v[52:53], v4 offset:20480
    buffer_load_dwordx4 v[68:71], v2, s[4:7], s42 offen offset:2304 sc1
    v_mfma_f32_16x16x32_bf16 v[148:151], v[56:59], v[124:127], v[148:151]
    ds_read_b64_tr_b16 v[54:55], v4 offset:21504
    v_mfma_f32_16x16x32_bf16 v[152:155], v[60:63], v[120:123], v[152:155]
    ds_read_b64_tr_b16 v[56:57], v5 offset:20480
    v_mfma_f32_16x16x32_bf16 v[156:159], v[60:63], v[124:127], v[156:159]
    ds_read_b64_tr_b16 v[58:59], v5 offset:21504
    s_waitcnt vmcnt(8) lgkmcnt(10)
    v_mfma_f32_16x16x32_bf16 v[128:131], v[32:35], v[160:163], v[128:131]
    ds_read_b64_tr_b16 v[60:61], v6 offset:20480
    s_xor_b32 s42, s41, 36864
    buffer_load_dwordx4 v[72:75], v2, s[4:7], s42 offen offset:2048 sc1
    v_mfma_f32_16x16x32_bf16 v[132:135], v[32:35], v[164:167], v[132:135]
    ds_read_b64_tr_b16 v[62:63], v6 offset:21504
    v_mfma_f32_16x16x32_bf16 v[136:139], v[36:39], v[160:163], v[136:139]
    ds_read_b64_tr_b16 v[32:33], v3 offset:24576
    v_mfma_f32_16x16x32_bf16 v[140:143], v[36:39], v[164:167], v[140:143]
    ds_read_b64_tr_b16 v[34:35], v3 offset:25600
    s_waitcnt lgkmcnt(10)
    v_mfma_f32_16x16x32_bf16 v[144:147], v[40:43], v[160:163], v[144:147]
    ds_read_b64_tr_b16 v[36:37], v4 offset:24576
    buffer_load_dwordx4 v[76:79], v2, s[4:7], s42 offen offset:2304 sc1
    v_mfma_f32_16x16x32_bf16 v[148:151], v[40:43], v[164:167], v[148:151]
    ds_read_b64_tr_b16 v[38:39], v4 offset:25600
    v_mfma_f32_16x16x32_bf16 v[152:155], v[44:47], v[160:163], v[152:155]
    ds_read_b64_tr_b16 v[40:41], v5 offset:24576
    v_mfma_f32_16x16x32_bf16 v[156:159], v[44:47], v[164:167], v[156:159]
    ds_read_b64_tr_b16 v[42:43], v5 offset:25600
    s_waitcnt vmcnt(8) lgkmcnt(10)
    v_mfma_f32_16x16x32_bf16 v[128:131], v[48:51], v[168:171], v[128:131]
    ds_read_b64_tr_b16 v[44:45], v6 offset:24576
    s_xor_b32 s42, s41, 40960
    buffer_load_dwordx4 v[80:83], v2, s[4:7], s42 offen offset:2048 sc1
    v_mfma_f32_16x16x32_bf16 v[132:135], v[48:51], v[172:175], v[132:135]
    ds_read_b64_tr_b16 v[46:47], v6 offset:25600
    v_mfma_f32_16x16x32_bf16 v[136:139], v[52:55], v[168:171], v[136:139]
    ds_read_b64_tr_b16 v[48:49], v3 offset:28672
    v_mfma_f32_16x16x32_bf16 v[140:143], v[52:55], v[172:175], v[140:143]
    ds_read_b64_tr_b16 v[50:51], v3 offset:29696
    s_waitcnt lgkmcnt(10)
    v_mfma_f32_16x16x32_bf16 v[144:147], v[56:59], v[168:171], v[144:147]
    ds_read_b64_tr_b16 v[52:53], v4 offset:28672
    buffer_load_dwordx4 v[84:87], v2, s[4:7], s42 offen offset:2304 sc1
    v_mfma_f32_16x16x32_bf16 v[148:151], v[56:59], v[172:175], v[148:151]
    ds_read_b64_tr_b16 v[54:55], v4 offset:29696
    v_mfma_f32_16x16x32_bf16 v[152:155], v[60:63], v[168:171], v[152:155]
    ds_read_b64_tr_b16 v[56:57], v5 offset:28672
    v_mfma_f32_16x16x32_bf16 v[156:159], v[60:63], v[172:175], v[156:159]
    ds_read_b64_tr_b16 v[58:59], v5 offset:29696
    s_waitcnt vmcnt(8) lgkmcnt(10)
    v_mfma_f32_16x16x32_bf16 v[128:131], v[32:35], v[176:179], v[128:131]
    ds_read_b64_tr_b16 v[60:61], v6 offset:28672
    s_xor_b32 s42, s41, 45056
    buffer_load_dwordx4 v[88:91], v2, s[4:7], s42 offen offset:2048 sc1
    v_mfma_f32_16x16x32_bf16 v[132:135], v[32:35], v[180:183], v[132:135]
    ds_read_b64_tr_b16 v[62:63], v6 offset:29696
    v_mfma_f32_16x16x32_bf16 v[136:139], v[36:39], v[176:179], v[136:139]
    ds_read_b64_tr_b16 v[32:33], v3 offset:32768
    v_mfma_f32_16x16x32_bf16 v[140:143], v[36:39], v[180:183], v[140:143]
    ds_read_b64_tr_b16 v[34:35], v3 offset:33792
    s_waitcnt lgkmcnt(10)
    v_mfma_f32_16x16x32_bf16 v[144:147], v[40:43], v[176:179], v[144:147]
    ds_read_b64_tr_b16 v[36:37], v4 offset:32768
    buffer_load_dwordx4 v[92:95], v2, s[4:7], s42 offen offset:2304 sc1
    v_mfma_f32_16x16x32_bf16 v[148:151], v[40:43], v[180:183], v[148:151]
    ds_read_b64_tr_b16 v[38:39], v4 offset:33792
    v_mfma_f32_16x16x32_bf16 v[152:155], v[44:47], v[176:179], v[152:155]
    ds_read_b64_tr_b16 v[40:41], v5 offset:32768
    v_mfma_f32_16x16x32_bf16 v[156:159], v[44:47], v[180:183], v[156:159]
    ds_read_b64_tr_b16 v[42:43], v5 offset:33792
    s_waitcnt vmcnt(8) lgkmcnt(10)
    v_mfma_f32_16x16x32_bf16 v[128:131], v[48:51], v[184:187], v[128:131]
    ds_read_b64_tr_b16 v[44:45], v6 offset:32768
    s_xor_b32 s42, s41, 49152
    buffer_load_dwordx4 v[96:99], v2, s[4:7], s42 offen offset:2048 sc1
    v_mfma_f32_16x16x32_bf16 v[132:135], v[48:51], v[188:191], v[132:135]
    ds_read_b64_tr_b16 v[46:47], v6 offset:33792
    v_mfma_f32_16x16x32_bf16 v[136:139], v[52:55], v[184:187], v[136:139]
    ds_read_b64_tr_b16 v[48:49], v3 offset:36864
    v_mfma_f32_16x16x32_bf16 v[140:143], v[52:55], v[188:191], v[140:143]
    ds_read_b64_tr_b16 v[50:51], v3 offset:37888
    s_waitcnt lgkmcnt(10)
    v_mfma_f32_16x16x32_bf16 v[144:147], v[56:59], v[184:187], v[144:147]
    ds_read_b64_tr_b16 v[52:53], v4 offset:36864
    buffer_load_dwordx4 v[100:103], v2, s[4:7], s42 offen offset:2304 sc1
    v_mfma_f32_16x16x32_bf16 v[148:151], v[56:59], v[188:191], v[148:151]
    ds_read_b64_tr_b16 v[54:55], v4 offset:37888
    v_mfma_f32_16x16x32_bf16 v[152:155], v[60:63], v[184:187], v[152:155]
    ds_read_b64_tr_b16 v[56:57], v5 offset:36864
    v_mfma_f32_16x16x32_bf16 v[156:159], v[60:63], v[188:191], v[156:159]
    ds_read_b64_tr_b16 v[58:59], v5 offset:37888
    s_waitcnt vmcnt(8) lgkmcnt(10)
    v_mfma_f32_16x16x32_bf16 v[128:131], v[32:35], v[64:67], v[128:131]
    ds_read_b64_tr_b16 v[60:61], v6 offset:36864
    s_xor_b32 s42, s41, 53248
    buffer_load_dwordx4 v[104:107], v2, s[4:7], s42 offen offset:2048 sc1
    v_mfma_f32_16x16x32_bf16 v[132:135], v[32:35], v[68:71], v[132:135]
    ds_read_b64_tr_b16 v[62:63], v6 offset:37888
    v_mfma_f32_16x16x32_bf16 v[136:139], v[36:39], v[64:67], v[136:139]
    ds_read_b64_tr_b16 v[32:33], v3 offset:40960
    v_mfma_f32_16x16x32_bf16 v[140:143], v[36:39], v[68:71], v[140:143]
    ds_read_b64_tr_b16 v[34:35], v3 offset:41984
    s_waitcnt lgkmcnt(10)
    v_mfma_f32_16x16x32_bf16 v[144:147], v[40:43], v[64:67], v[144:147]
    ds_read_b64_tr_b16 v[36:37], v4 offset:40960
    buffer_load_dwordx4 v[108:111], v2, s[4:7], s42 offen offset:2304 sc1
    v_mfma_f32_16x16x32_bf16 v[148:151], v[40:43], v[68:71], v[148:151]
    ds_read_b64_tr_b16 v[38:39], v4 offset:41984
    v_mfma_f32_16x16x32_bf16 v[152:155], v[44:47], v[64:67], v[152:155]
    ds_read_b64_tr_b16 v[40:41], v5 offset:40960
    v_mfma_f32_16x16x32_bf16 v[156:159], v[44:47], v[68:71], v[156:159]
    ds_read_b64_tr_b16 v[42:43], v5 offset:41984
    s_waitcnt vmcnt(8) lgkmcnt(10)
    v_mfma_f32_16x16x32_bf16 v[128:131], v[48:51], v[72:75], v[128:131]
    ds_read_b64_tr_b16 v[44:45], v6 offset:40960
    s_xor_b32 s42, s41, 57344
    buffer_load_dwordx4 v[112:115], v2, s[4:7], s42 offen offset:2048 sc1
    v_mfma_f32_16x16x32_bf16 v[132:135], v[48:51], v[76:79], v[132:135]
    ds_read_b64_tr_b16 v[46:47], v6 offset:41984
    v_mfma_f32_16x16x32_bf16 v[136:139], v[52:55], v[72:75], v[136:139]
    ds_read_b64_tr_b16 v[48:49], v3 offset:45056
    v_mfma_f32_16x16x32_bf16 v[140:143], v[52:55], v[76:79], v[140:143]
    ds_read_b64_tr_b16 v[50:51], v3 offset:46080
    s_waitcnt lgkmcnt(10)
    v_mfma_f32_16x16x32_bf16 v[144:147], v[56:59], v[72:75], v[144:147]
    ds_read_b64_tr_b16 v[52:53], v4 offset:45056
    buffer_load_dwordx4 v[116:119], v2, s[4:7], s42 offen offset:2304 sc1
    v_mfma_f32_16x16x32_bf16 v[148:151], v[56:59], v[76:79], v[148:151]
    ds_read_b64_tr_b16 v[54:55], v4 offset:46080
    v_mfma_f32_16x16x32_bf16 v[152:155], v[60:63], v[72:75], v[152:155]
    ds_read_b64_tr_b16 v[56:57], v5 offset:45056
    v_mfma_f32_16x16x32_bf16 v[156:159], v[60:63], v[76:79], v[156:159]
    ds_read_b64_tr_b16 v[58:59], v5 offset:46080
    s_waitcnt vmcnt(8) lgkmcnt(10)
    v_mfma_f32_16x16x32_bf16 v[128:131], v[32:35], v[80:83], v[128:131]
    ds_read_b64_tr_b16 v[60:61], v6 offset:45056
    s_xor_b32 s42, s41, 61440
    buffer_load_dwordx4 v[120:123], v2, s[4:7], s42 offen offset:2048 sc1
    v_mfma_f32_16x16x32_bf16 v[132:135], v[32:35], v[84:87], v[132:135]
    ds_read_b64_tr_b16 v[62:63], v6 offset:46080
    v_mfma_f32_16x16x32_bf16 v[136:139], v[36:39], v[80:83], v[136:139]
    ds_read_b64_tr_b16 v[32:33], v3 offset:49152
    v_mfma_f32_16x16x32_bf16 v[140:143], v[36:39], v[84:87], v[140:143]
    ds_read_b64_tr_b16 v[34:35], v3 offset:50176
    s_waitcnt lgkmcnt(10)
    v_mfma_f32_16x16x32_bf16 v[144:147], v[40:43], v[80:83], v[144:147]
    ds_read_b64_tr_b16 v[36:37], v4 offset:49152
    buffer_load_dwordx4 v[124:127], v2, s[4:7], s42 offen offset:2304 sc1
    v_mfma_f32_16x16x32_bf16 v[148:151], v[40:43], v[84:87], v[148:151]
    ds_read_b64_tr_b16 v[38:39], v4 offset:50176
    v_mfma_f32_16x16x32_bf16 v[152:155], v[44:47], v[80:83], v[152:155]
    ds_read_b64_tr_b16 v[40:41], v5 offset:49152
    v_mfma_f32_16x16x32_bf16 v[156:159], v[44:47], v[84:87], v[156:159]
    ds_read_b64_tr_b16 v[42:43], v5 offset:50176
    s_waitcnt vmcnt(8) lgkmcnt(10)
    v_mfma_f32_16x16x32_bf16 v[128:131], v[48:51], v[88:91], v[128:131]
    ds_read_b64_tr_b16 v[44:45], v6 offset:49152
    v_mfma_f32_16x16x32_bf16 v[132:135], v[48:51], v[92:95], v[132:135]
    ds_read_b64_tr_b16 v[46:47], v6 offset:50176
    v_mfma_f32_16x16x32_bf16 v[136:139], v[52:55], v[88:91], v[136:139]
    ds_read_b64_tr_b16 v[48:49], v3 offset:53248
    v_mfma_f32_16x16x32_bf16 v[140:143], v[52:55], v[92:95], v[140:143]
    ds_read_b64_tr_b16 v[50:51], v3 offset:54272
    s_waitcnt lgkmcnt(10)
    v_mfma_f32_16x16x32_bf16 v[144:147], v[56:59], v[88:91], v[144:147]
    ds_read_b64_tr_b16 v[52:53], v4 offset:53248
    v_mfma_f32_16x16x32_bf16 v[148:151], v[56:59], v[92:95], v[148:151]
    ds_read_b64_tr_b16 v[54:55], v4 offset:54272
    v_mfma_f32_16x16x32_bf16 v[152:155], v[60:63], v[88:91], v[152:155]
    ds_read_b64_tr_b16 v[56:57], v5 offset:53248
    v_mfma_f32_16x16x32_bf16 v[156:159], v[60:63], v[92:95], v[156:159]
    ds_read_b64_tr_b16 v[58:59], v5 offset:54272
    s_waitcnt vmcnt(6) lgkmcnt(10)
    v_mfma_f32_16x16x32_bf16 v[128:131], v[32:35], v[96:99], v[128:131]
    ds_read_b64_tr_b16 v[60:61], v6 offset:53248
    v_mfma_f32_16x16x32_bf16 v[132:135], v[32:35], v[100:103], v[132:135]
    ds_read_b64_tr_b16 v[62:63], v6 offset:54272
    v_mfma_f32_16x16x32_bf16 v[136:139], v[36:39], v[96:99], v[136:139]
    ds_read_b64_tr_b16 v[32:33], v3 offset:57344
    v_mfma_f32_16x16x32_bf16 v[140:143], v[36:39], v[100:103], v[140:143]
    ds_read_b64_tr_b16 v[34:35], v3 offset:58368
    s_waitcnt lgkmcnt(10)
    v_mfma_f32_16x16x32_bf16 v[144:147], v[40:43], v[96:99], v[144:147]
    ds_read_b64_tr_b16 v[36:37], v4 offset:57344
    v_mfma_f32_16x16x32_bf16 v[148:151], v[40:43], v[100:103], v[148:151]
    ds_read_b64_tr_b16 v[38:39], v4 offset:58368
    v_mfma_f32_16x16x32_bf16 v[152:155], v[44:47], v[96:99], v[152:155]
    ds_read_b64_tr_b16 v[40:41], v5 offset:57344
    v_mfma_f32_16x16x32_bf16 v[156:159], v[44:47], v[100:103], v[156:159]
    ds_read_b64_tr_b16 v[42:43], v5 offset:58368
    s_waitcnt vmcnt(4) lgkmcnt(10)
    v_mfma_f32_16x16x32_bf16 v[128:131], v[48:51], v[104:107], v[128:131]
    ds_read_b64_tr_b16 v[44:45], v6 offset:57344
    v_mfma_f32_16x16x32_bf16 v[132:135], v[48:51], v[108:111], v[132:135]
    ds_read_b64_tr_b16 v[46:47], v6 offset:58368
    v_mfma_f32_16x16x32_bf16 v[136:139], v[52:55], v[104:107], v[136:139]
    ds_read_b64_tr_b16 v[48:49], v3 offset:61440
    v_mfma_f32_16x16x32_bf16 v[140:143], v[52:55], v[108:111], v[140:143]
    ds_read_b64_tr_b16 v[50:51], v3 offset:62464
    s_waitcnt lgkmcnt(10)
    v_mfma_f32_16x16x32_bf16 v[144:147], v[56:59], v[104:107], v[144:147]
    ds_read_b64_tr_b16 v[52:53], v4 offset:61440
    v_mfma_f32_16x16x32_bf16 v[148:151], v[56:59], v[108:111], v[148:151]
    ds_read_b64_tr_b16 v[54:55], v4 offset:62464
    v_mfma_f32_16x16x32_bf16 v[152:155], v[60:63], v[104:107], v[152:155]
    ds_read_b64_tr_b16 v[56:57], v5 offset:61440
    v_mfma_f32_16x16x32_bf16 v[156:159], v[60:63], v[108:111], v[156:159]
    ds_read_b64_tr_b16 v[58:59], v5 offset:62464
    s_waitcnt vmcnt(2) lgkmcnt(10)
    v_mfma_f32_16x16x32_bf16 v[128:131], v[32:35], v[112:115], v[128:131]
    ds_read_b64_tr_b16 v[60:61], v6 offset:61440
    v_mfma_f32_16x16x32_bf16 v[132:135], v[32:35], v[116:119], v[132:135]
    ds_read_b64_tr_b16 v[62:63], v6 offset:62464
    v_xor_b32 v3, 0x10000, v3
    v_xor_b32 v4, 0x10000, v4
    v_xor_b32 v5, 0x10000, v5
    v_xor_b32 v6, 0x10000, v6
    v_mfma_f32_16x16x32_bf16 v[136:139], v[36:39], v[112:115], v[136:139]
    v_mfma_f32_16x16x32_bf16 v[140:143], v[36:39], v[116:119], v[140:143]
    s_waitcnt lgkmcnt(8)
    v_mfma_f32_16x16x32_bf16 v[144:147], v[40:43], v[112:115], v[144:147]
    v_mfma_f32_16x16x32_bf16 v[148:151], v[40:43], v[116:119], v[148:151]
    v_mfma_f32_16x16x32_bf16 v[152:155], v[44:47], v[112:115], v[152:155]
    v_mfma_f32_16x16x32_bf16 v[156:159], v[44:47], v[116:119], v[156:159]
    s_waitcnt vmcnt(0) lgkmcnt(4)
    v_mfma_f32_16x16x32_bf16 v[128:131], v[48:51], v[120:123], v[128:131]
    v_mfma_f32_16x16x32_bf16 v[132:135], v[48:51], v[124:127], v[132:135]
    v_mfma_f32_16x16x32_bf16 v[136:139], v[52:55], v[120:123], v[136:139]
    v_mfma_f32_16x16x32_bf16 v[140:143], v[52:55], v[124:127], v[140:143]
    s_waitcnt lgkmcnt(0)
    v_mfma_f32_16x16x32_bf16 v[144:147], v[56:59], v[120:123], v[144:147]
    v_mfma_f32_16x16x32_bf16 v[148:151], v[56:59], v[124:127], v[148:151]
    v_mfma_f32_16x16x32_bf16 v[152:155], v[60:63], v[120:123], v[152:155]
    v_mfma_f32_16x16x32_bf16 v[156:159], v[60:63], v[124:127], v[156:159]
    s_cmp_eq_u32 s21, 3
    s_cbranch_scc1 c_final
    s_add_u32 s43, s43, 4194304
    v_cvt_pk_bf16_f32 v160, v128, v129
    v_cvt_pk_bf16_f32 v161, v130, v131
    v_cvt_pk_bf16_f32 v162, v136, v137
    v_cvt_pk_bf16_f32 v163, v138, v139
    v_cvt_pk_bf16_f32 v168, v144, v145
    v_cvt_pk_bf16_f32 v169, v146, v147
    v_cvt_pk_bf16_f32 v170, v152, v153
    v_cvt_pk_bf16_f32 v171, v154, v155
    v_permlane32_swap_b32 v160, v162
    v_permlane32_swap_b32 v161, v163
    buffer_store_dwordx4 v[160:163], v2, s[4:7], s43 offen offset:0 sc1
    v_permlane32_swap_b32 v168, v170
    v_permlane32_swap_b32 v169, v171
    buffer_store_dwordx4 v[168:171], v2, s[4:7], s43 offen offset:2048 sc1
    v_cvt_pk_bf16_f32 v164, v132, v133
    v_cvt_pk_bf16_f32 v165, v134, v135
    v_cvt_pk_bf16_f32 v166, v140, v141
    v_cvt_pk_bf16_f32 v167, v142, v143
    v_cvt_pk_bf16_f32 v172, v148, v149
    v_cvt_pk_bf16_f32 v173, v150, v151
    v_cvt_pk_bf16_f32 v174, v156, v157
    v_cvt_pk_bf16_f32 v175, v158, v159
    v_permlane32_swap_b32 v164, v166
    v_permlane32_swap_b32 v165, v167
    buffer_store_dwordx4 v[164:167], v2, s[4:7], s43 offen offset:256 sc1
    v_permlane32_swap_b32 v172, v174
    v_permlane32_swap_b32 v173, v175
    buffer_store_dwordx4 v[172:175], v2, s[4:7], s43 offen offset:2304 sc1
    s_barrier
    v_mov_b32 v12, 0x3f803f80
    v_mov_b32 v14, 0
    v_mov_b32 v15, 0
    v_mov_b32 v16, 0
    v_mov_b32 v17, 0
    v_dot2_f32_bf16 v14, v160, v12, v14
    v_dot2_f32_bf16 v15, v160, v160, v15
    v_dot2_f32_bf16 v16, v164, v12, v16
    v_dot2_f32_bf16 v17, v164, v164, v17
    v_dot2_f32_bf16 v14, v161, v12, v14
    v_dot2_f32_bf16 v15, v161, v161, v15
    v_dot2_f32_bf16 v16, v165, v12, v16
    v_dot2_f32_bf16 v17, v165, v165, v17
    v_dot2_f32_bf16 v14, v162, v12, v14
    v_dot2_f32_bf16 v15, v162, v162, v15
    v_dot2_f32_bf16 v16, v166, v12, v16
    v_dot2_f32_bf16 v17, v166, v166, v17
    v_dot2_f32_bf16 v14, v163, v12, v14
    v_dot2_f32_bf16 v15, v163, v163, v15
    v_dot2_f32_bf16 v16, v167, v12, v16
    v_dot2_f32_bf16 v17, v167, v167, v17
    v_dot2_f32_bf16 v14, v168, v12, v14
    v_dot2_f32_bf16 v15, v168, v168, v15
    v_dot2_f32_bf16 v16, v172, v12, v16
    v_dot2_f32_bf16 v17, v172, v172, v17
    v_dot2_f32_bf16 v14, v169, v12, v14
    v_dot2_f32_bf16 v15, v169, v169, v15
    v_dot2_f32_bf16 v16, v173, v12, v16
    v_dot2_f32_bf16 v17, v173, v173, v17
    v_dot2_f32_bf16 v14, v170, v12, v14
    v_dot2_f32_bf16 v15, v170, v170, v15
    v_dot2_f32_bf16 v16, v174, v12, v16
    v_dot2_f32_bf16 v17, v174, v174, v17
    v_dot2_f32_bf16 v14, v171, v12, v14
    v_dot2_f32_bf16 v15, v171, v171, v15
    v_dot2_f32_bf16 v16, v175, v12, v16
    v_dot2_f32_bf16 v17, v175, v175, v17
    s_nop 2
    v_permlane16_swap_b32 v14, v16
    v_permlane16_swap_b32 v15, v17
    v_pk_add_f32 v[14:15], v[14:15], v[16:17]
    v_mov_b32 v16, v14
    v_mov_b32 v17, v15
    s_nop 0
    v_permlane32_swap_b32 v14, v16
    v_permlane32_swap_b32 v15, v17
    v_pk_add_f32 v[14:15], v[14:15], v[16:17]
    v_lshrrev_b32 v13, 1, v1
    v_and_b32 v13, 0xf8, v13
    s_add_u32 s21, s21, 1
    s_lshl_b32 s44, s21, 18
    s_lshl_b32 s45, s39, 12
    s_add_u32 s44, s44, s45
    s_lshl_b32 s45, s20, 8
    s_add_u32 s44, s44, s45
    s_add_u32 s44, s44, 50331648
    buffer_store_dwordx2 v[14:15], v13, s[4:7], s44 offen sc1
    s_lshl_b32 s46, s21, 14
    s_lshl_b32 s67, s39, 7
    s_add_u32 s46, s46, s67
    s_add_u32 s46, s46, 4096
    s_add_u32 s47, s46, 8192
    s_waitcnt vmcnt(1)
    s_atomic_add s40, s[22:23], s46
    s_branch c_layer
c_final:
    s_mov_b32 s8, s32
    s_mov_b32 s9, s33
    s_mov_b32 s10, 4194304
    s_mov_b32 s11, 0x00020000
    v_lshrrev_b32 v12, 4, v1
    s_mul_i32 s44, s16, 4608
    s_add_u32 s44, s44, 131072
    v_and_b32 v13, 15, v12
    v_mul_u32_u24 v13, 144, v13
    v_lshrrev_b32 v14, 4, v12
    v_lshl_add_u32 v13, v14, 3, v13
    v_add_u32 v13, s44, v13
    v_cvt_pk_bf16_f32 v128, v128, v129
    v_cvt_pk_bf16_f32 v129, v130, v131
    ds_write_b64 v13, v[128:129] offset:0
    v_cvt_pk_bf16_f32 v136, v136, v137
    v_cvt_pk_bf16_f32 v137, v138, v139
    ds_write_b64 v13, v[136:137] offset:32
    v_cvt_pk_bf16_f32 v144, v144, v145
    v_cvt_pk_bf16_f32 v145, v146, v147
    ds_write_b64 v13, v[144:145] offset:64
    v_cvt_pk_bf16_f32 v152, v152, v153
    v_cvt_pk_bf16_f32 v153, v154, v155
    ds_write_b64 v13, v[152:153] offset:96
    v_cvt_pk_bf16_f32 v132, v132, v133
    v_cvt_pk_bf16_f32 v133, v134, v135
    ds_write_b64 v13, v[132:133] offset:2304
    v_cvt_pk_bf16_f32 v140, v140, v141
    v_cvt_pk_bf16_f32 v141, v142, v143
    ds_write_b64 v13, v[140:141] offset:2336
    v_cvt_pk_bf16_f32 v148, v148, v149
    v_cvt_pk_bf16_f32 v149, v150, v151
    ds_write_b64 v13, v[148:149] offset:2368
    v_cvt_pk_bf16_f32 v156, v156, v157
    v_cvt_pk_bf16_f32 v157, v158, v159
    ds_write_b64 v13, v[156:157] offset:2400
    v_lshrrev_b32 v14, 3, v12
    v_and_b32 v15, 7, v12
    v_mul_u32_u24 v16, 144, v14
    v_lshl_add_u32 v16, v15, 4, v16
    v_add_u32 v16, s44, v16
    v_lshlrev_b32 v17, 11, v14
    v_lshl_add_u32 v17, v15, 4, v17
    ds_read_b128 v[32:35], v16 offset:0
    ds_read_b128 v[36:39], v16 offset:1152
    ds_read_b128 v[40:43], v16 offset:2304
    ds_read_b128 v[44:47], v16 offset:3456
    s_lshl_b32 s44, s39, 16
    s_lshl_b32 s45, s20, 7
    s_add_u32 s44, s44, s45
    s_waitcnt lgkmcnt(3)
    buffer_store_dwordx4 v[32:35], v17, s[8:11], s44 offen sc1
    s_add_u32 s44, s44, 16384
    s_waitcnt lgkmcnt(2)
    buffer_store_dwordx4 v[36:39], v17, s[8:11], s44 offen sc1
    s_add_u32 s44, s44, 16384
    s_waitcnt lgkmcnt(1)
    buffer_store_dwordx4 v[40:43], v17, s[8:11], s44 offen sc1
    s_add_u32 s44, s44, 16384
    s_waitcnt lgkmcnt(0)
    buffer_store_dwordx4 v[44:47], v17, s[8:11], s44 offen sc1
    s_endpgm
h_start:
    v_mov_b32 v20, 0
    v_mov_b32 v21, 0
    v_mov_b32 v22, 0
    v_mov_b32 v23, 0
    s_cmp_lt_u32 s2, 6
    s_cbranch_scc0 h_z0
    s_load_dword s101, s[34:35], 192
    s_lshl_b32 s44, s2, 11
    s_cmp_ge_u32 s2, 2
    s_cselect_b32 s3, 8192, 0
    s_add_u32 s44, s44, s3
    s_mov_b32 s45, 0
    s_atomic_swap s45, s[22:23], s44 offset:0
    s_atomic_swap s45, s[22:23], s44 offset:128
    s_atomic_swap s45, s[22:23], s44 offset:256
    s_atomic_swap s45, s[22:23], s44 offset:384
    s_atomic_swap s45, s[22:23], s44 offset:512
    s_atomic_swap s45, s[22:23], s44 offset:640
    s_atomic_swap s45, s[22:23], s44 offset:768
    s_atomic_swap s45, s[22:23], s44 offset:896
    s_atomic_swap s45, s[22:23], s44 offset:1024
    s_atomic_swap s45, s[22:23], s44 offset:1152
    s_atomic_swap s45, s[22:23], s44 offset:1280
    s_atomic_swap s45, s[22:23], s44 offset:1408
    s_atomic_swap s45, s[22:23], s44 offset:1536
    s_atomic_swap s45, s[22:23], s44 offset:1664
    s_atomic_swap s45, s[22:23], s44 offset:1792
    s_atomic_swap s45, s[22:23], s44 offset:1920
    s_waitcnt lgkmcnt(0)
    s_atomic_add s40, s[34:35], 0
h_z0:
    v_lshrrev_b32 v24, 4, v1
    v_lshrrev_b32 v25, 3, v24
    v_mul_u32_u24 v12, 6144, v25
    v_and_b32 v26, 2, v25
    v_lshrrev_b32 v25, 2, v25
    v_or_b32 v26, v26, v25
    v_bfe_u32 v25, v24, 1, 2
    v_xor_b32 v26, v26, v25
    v_lshl_add_u32 v12, v26, 5, v12
    v_and_b32 v26, 1, v24
    v_lshl_add_u32 v12, v26, 4, v12
    s_lshl_b32 s3, s18, 7
    v_add_u32 v12, s3, v12
    v_add_u32 v13, 48128, v12
    v_add_u32 v14, 96256, v12
    v_add_u32 v15, 144384, v12
    v_lshrrev_b32 v24, 4, v1
    v_lshrrev_b32 v25, 3, v24
    v_mul_u32_u24 v16, 2048, v25
    v_and_b32 v26, 2, v25
    v_lshrrev_b32 v25, 2, v25
    v_or_b32 v26, v26, v25
    v_bfe_u32 v25, v24, 1, 2
    v_xor_b32 v26, v26, v25
    v_lshl_add_u32 v16, v26, 5, v16
    v_and_b32 v26, 1, v24
    v_lshl_add_u32 v16, v26, 4, v16
    s_lshl_b32 s3, s20, 7
    v_add_u32 v16, s3, v16
    v_add_u32 v17, 15360, v16
    v_add_u32 v18, 30720, v16
    v_add_u32 v19, 46080, v16
    s_mul_i32 s84, s18, 393216
    s_cmp_eq_u32 s18, 1
    s_cselect_b32 s85, 0, 393216
    s_cmp_eq_u32 s18, 2
    s_cselect_b32 s86, 0, 786432
    s_cmp_eq_u32 s18, 3
    s_cselect_b32 s87, 0, 1179648
    s_cmp_eq_u32 s18, 4
    s_cselect_b32 s88, 0, 1572864
    s_cmp_eq_u32 s18, 5
    s_cselect_b32 s89, 0, 1966080
    s_cmp_eq_u32 s18, 6
    s_cselect_b32 s90, 0, 2359296
    s_cmp_eq_u32 s18, 7
    s_cselect_b32 s91, 0, 2752512
    s_cmp_eq_u32 s18, 8
    s_cselect_b32 s92, 0, 3145728
    s_cmp_eq_u32 s18, 9
    s_cselect_b32 s93, 0, 3538944
    s_cmp_eq_u32 s18, 10
    s_cselect_b32 s94, 0, 3932160
    s_cmp_eq_u32 s18, 11
    s_cselect_b32 s95, 0, 4325376
    s_cmp_eq_u32 s18, 12
    s_cselect_b32 s96, 0, 4718592
    s_cmp_eq_u32 s18, 13
    s_cselect_b32 s97, 0, 5111808
    s_cmp_eq_u32 s18, 14
    s_cselect_b32 s98, 0, 5505024
    s_cmp_eq_u32 s18, 15
    s_cselect_b32 s99, 0, 5898240
    s_and_b32 s3, s16, 3
    s_mul_i32 s3, s3, 49152
    v_add_u32 v11, s3, v12
    s_and_b32 s3, s16, 3
    s_lshl_b32 s3, s3, 10
    v_add_u32 v9, s3, v1
    v_add_u32 v10, 0x10000, v9
    v_lshrrev_b32 v24, 4, v1
    v_and_b32 v25, 15, v24
    v_lshrrev_b32 v24, 4, v24
    v_lshlrev_b32 v24, 2, v24
    v_sub_u32 v24, v25, v24
    v_mov_b32 v25, 0xf149f2ca
    v_add_u32 v26, 0x0, v24
    v_and_b32 v26, 0xfffffff1, v26
    v_cmp_eq_u32 vcc, 0, v26
    s_nop 1
    v_cndmask_b32 v32, v25, 0, vcc
    v_add_u32 v26, 0xffffffff, v24
    v_and_b32 v26, 0xfffffff1, v26
    v_cmp_eq_u32 vcc, 0, v26
    s_nop 1
    v_cndmask_b32 v33, v25, 0, vcc
    v_add_u32 v26, 0xfffffffe, v24
    v_and_b32 v26, 0xfffffff1, v26
    v_cmp_eq_u32 vcc, 0, v26
    s_nop 1
    v_cndmask_b32 v34, v25, 0, vcc
    v_add_u32 v26, 0xfffffffd, v24
    v_and_b32 v26, 0xfffffff1, v26
    v_cmp_eq_u32 vcc, 0, v26
    s_nop 1
    v_cndmask_b32 v35, v25, 0, vcc
    v_add_u32 v26, 0x10, v24
    v_and_b32 v26, 0xfffffff1, v26
    v_cmp_eq_u32 vcc, 0, v26
    s_nop 1
    v_cndmask_b32 v36, v25, 0, vcc
    v_add_u32 v26, 0xf, v24
    v_and_b32 v26, 0xfffffff1, v26
    v_cmp_eq_u32 vcc, 0, v26
    s_nop 1
    v_cndmask_b32 v37, v25, 0, vcc
    v_add_u32 v26, 0xe, v24
    v_and_b32 v26, 0xfffffff1, v26
    v_cmp_eq_u32 vcc, 0, v26
    s_nop 1
    v_cndmask_b32 v38, v25, 0, vcc
    v_add_u32 v26, 0xd, v24
    v_and_b32 v26, 0xfffffff1, v26
    v_cmp_eq_u32 vcc, 0, v26
    s_nop 1
    v_cndmask_b32 v39, v25, 0, vcc
    v_add_u32 v24, 153600, v1
    ds_write_b128 v24, v[32:35] offset:0
    ds_write_b128 v24, v[36:39] offset:1024
    s_barrier
    s_waitcnt lgkmcnt(0)
    s_lshl_b32 s44, s21, 14
    s_lshl_b32 s67, s17, 9
    s_add_u32 s44, s44, s67
    s_add_u32 s44, s44, 12288
    s_barrier
    s_mov_b32 s66, 0x10000
h_s0_poll:
    s_mov_b32 s68, 0
    s_mov_b32 s69, 0
    s_mov_b32 s70, 0
    s_mov_b32 s71, 0
    s_atomic_add s68, s[22:23], s44 offset:0 glc
    s_atomic_add s69, s[22:23], s44 offset:128 glc
    s_atomic_add s70, s[22:23], s44 offset:256 glc
    s_atomic_add s71, s[22:23], s44 offset:384 glc
    s_sub_u32 s66, s66, 1
    s_cselect_b32 s67, 16, 0
    s_waitcnt lgkmcnt(0)
    s_and_b32 s68, s68, s69
    s_and_b32 s68, s68, s70
    s_and_b32 s68, s68, s71
    s_max_u32 s68, s68, s67
    s_cmp_lt_u32 s68, 16
    s_cbranch_scc1 h_s0_poll
h_s0_ok:
    s_barrier
    s_barrier
    s_lshr_b32 s3, s2, 3
    s_cmp_eq_u32 s3, 1
    s_cbranch_scc0 h_s_ok
    s_mul_i32 s44, s2, 24576
    s_add_u32 s44, s44, 58544128
    s_mov_b32 s45, 24
h_zloop:
    buffer_store_dwordx4 v[20:23], v1, s[4:7], s44 offen sc1
    s_add_u32 s44, s44, 1024
    s_sub_u32 s45, s45, 1
    s_cmp_lg_u32 s45, 0
    s_cbranch_scc1 h_zloop
    s_branch h_s_ok
h_layer:
    s_waitcnt lgkmcnt(0)
    s_barrier
    s_barrier
    s_lshl_b32 s44, s21, 14
    s_lshl_b32 s67, s17, 9
    s_add_u32 s44, s44, s67
    s_add_u32 s44, s44, 12288
    s_mov_b32 s66, 0x10000
h_s_poll:
    s_mov_b32 s68, 0
    s_mov_b32 s69, 0
    s_mov_b32 s70, 0
    s_mov_b32 s71, 0
    s_atomic_add s68, s[22:23], s44 offset:0 glc
    s_atomic_add s69, s[22:23], s44 offset:128 glc
    s_atomic_add s70, s[22:23], s44 offset:256 glc
    s_atomic_add s71, s[22:23], s44 offset:384 glc
    s_sub_u32 s66, s66, 1
    s_cselect_b32 s67, 16, 0
    s_waitcnt lgkmcnt(0)
    s_and_b32 s68, s68, s69
    s_and_b32 s68, s68, s70
    s_and_b32 s68, s68, s71
    s_max_u32 s68, s68, s67
    s_cmp_lt_u32 s68, 16
    s_cbranch_scc1 h_s_poll
h_s_ok:
    s_barrier
    s_lshl_b32 s44, s21, 18
    s_lshl_b32 s45, s17, 14
    s_add_u32 s44, s44, s45
    s_add_u32 s44, s44, 50331648
    buffer_load_dwordx4 v[32:35], v1, s[4:7], s44 offen offset:0 sc1
    buffer_load_dwordx4 v[36:39], v1, s[4:7], s44 offen offset:1024 sc1
    buffer_load_dwordx4 v[40:43], v1, s[4:7], s44 offen offset:2048 sc1
    buffer_load_dwordx4 v[44:47], v1, s[4:7], s44 offen offset:3072 sc1
    s_add_u32 s44, s44, 4096
    buffer_load_dwordx4 v[48:51], v1, s[4:7], s44 offen offset:0 sc1
    buffer_load_dwordx4 v[52:55], v1, s[4:7], s44 offen offset:1024 sc1
    buffer_load_dwordx4 v[56:59], v1, s[4:7], s44 offen offset:2048 sc1
    buffer_load_dwordx4 v[60:63], v1, s[4:7], s44 offen offset:3072 sc1
    s_add_u32 s44, s44, 4096
    buffer_load_dwordx4 v[64:67], v1, s[4:7], s44 offen offset:0 sc1
    buffer_load_dwordx4 v[68:71], v1, s[4:7], s44 offen offset:1024 sc1
    buffer_load_dwordx4 v[72:75], v1, s[4:7], s44 offen offset:2048 sc1
    buffer_load_dwordx4 v[76:79], v1, s[4:7], s44 offen offset:3072 sc1
    s_add_u32 s44, s44, 4096
    buffer_load_dwordx4 v[80:83], v1, s[4:7], s44 offen offset:0 sc1
    buffer_load_dwordx4 v[84:87], v1, s[4:7], s44 offen offset:1024 sc1
    buffer_load_dwordx4 v[88:91], v1, s[4:7], s44 offen offset:2048 sc1
    buffer_load_dwordx4 v[92:95], v1, s[4:7], s44 offen offset:3072 sc1
    s_barrier
    s_cmp_ge_u32 s21, 2
    s_cbranch_scc1 h_c_ok
    s_lshl_b32 s44, s21, 11
    s_lshl_b32 s67, s18, 7
    s_add_u32 s44, s44, s67
    s_add_u32 s44, s44, 0
    s_mov_b32 s66, 0x10000
h_c_poll:
    s_mov_b32 s68, 0
    s_atomic_add s68, s[22:23], s44 offset:0 glc
    s_sub_u32 s66, s66, 1
    s_cselect_b32 s67, 48, 0
    s_waitcnt lgkmcnt(0)
    s_max_u32 s68, s68, s67
    s_cmp_lt_u32 s68, 48
    s_cbranch_scc1 h_c_poll
h_c_ok:
    s_waitcnt vmcnt(0)
    s_lshl_b32 s3, s21, 8
    s_add_u32 s3, s3, s2
    s_lshr_b32 s3, s3, 3
    s_cmp_eq_u32 s3, 1
    s_cbranch_scc0 h_nf1
    s_atomic_add s40, s[34:35], 128
h_nf1:
    s_barrier
    s_cmp_ge_u32 s21, 2
    s_cbranch_scc1 h_cs1
    s_lshl_b32 s44, s21, 18
    s_lshl_b32 s45, s18, 14
    s_add_u32 s44, s44, s45
    s_add_u32 s44, s44, 52428800
    buffer_load_dwordx4 v[96:99], v1, s[4:7], s44 offen offset:0 sc1
    buffer_load_dwordx4 v[100:103], v1, s[4:7], s44 offen offset:1024 sc1
    buffer_load_dwordx4 v[104:107], v1, s[4:7], s44 offen offset:2048 sc1
    buffer_load_dwordx4 v[108:111], v1, s[4:7], s44 offen offset:3072 sc1
    s_add_u32 s44, s44, 4096
    buffer_load_dwordx4 v[112:115], v1, s[4:7], s44 offen offset:0 sc1
    buffer_load_dwordx4 v[116:119], v1, s[4:7], s44 offen offset:1024 sc1
    buffer_load_dwordx4 v[120:123], v1, s[4:7], s44 offen offset:2048 sc1
    buffer_load_dwordx4 v[124:127], v1, s[4:7], s44 offen offset:3072 sc1
    s_add_u32 s44, s44, 4096
    buffer_load_dwordx4 v[128:131], v1, s[4:7], s44 offen offset:0 sc1
    buffer_load_dwordx4 v[132:135], v1, s[4:7], s44 offen offset:1024 sc1
    buffer_load_dwordx4 v[136:139], v1, s[4:7], s44 offen offset:2048 sc1
    buffer_load_dwordx4 v[140:143], v1, s[4:7], s44 offen offset:3072 sc1
    s_add_u32 s44, s44, 4096
    buffer_load_dwordx4 v[144:147], v1, s[4:7], s44 offen offset:0 sc1
    buffer_load_dwordx4 v[148:151], v1, s[4:7], s44 offen offset:1024 sc1
    buffer_load_dwordx4 v[152:155], v1, s[4:7], s44 offen offset:2048 sc1
    buffer_load_dwordx4 v[156:159], v1, s[4:7], s44 offen offset:3072 sc1
h_cs1:
    v_add_f32 v32, v32, v36
    v_add_f32 v33, v33, v37
    v_add_f32 v34, v34, v38
    v_add_f32 v35, v35, v39
    v_add_f32 v48, v48, v52
    v_add_f32 v49, v49, v53
    v_add_f32 v50, v50, v54
    v_add_f32 v51, v51, v55
    v_add_f32 v64, v64, v68
    v_add_f32 v65, v65, v69
    v_add_f32 v66, v66, v70
    v_add_f32 v67, v67, v71
    v_add_f32 v80, v80, v84
    v_add_f32 v81, v81, v85
    v_add_f32 v82, v82, v86
    v_add_f32 v83, v83, v87
    v_add_f32 v32, v32, v40
    v_add_f32 v33, v33, v41
    v_add_f32 v34, v34, v42
    v_add_f32 v35, v35, v43
    v_add_f32 v48, v48, v56
    v_add_f32 v49, v49, v57
    v_add_f32 v50, v50, v58
    v_add_f32 v51, v51, v59
    v_add_f32 v64, v64, v72
    v_add_f32 v65, v65, v73
    v_add_f32 v66, v66, v74
    v_add_f32 v67, v67, v75
    v_add_f32 v80, v80, v88
    v_add_f32 v81, v81, v89
    v_add_f32 v82, v82, v90
    v_add_f32 v83, v83, v91
    s_barrier
    v_add_f32 v32, v32, v44
    v_add_f32 v33, v33, v45
    v_add_f32 v34, v34, v46
    v_add_f32 v35, v35, v47
    v_add_f32 v48, v48, v60
    v_add_f32 v49, v49, v61
    v_add_f32 v50, v50, v62
    v_add_f32 v51, v51, v63
    v_add_f32 v64, v64, v76
    v_add_f32 v65, v65, v77
    v_add_f32 v66, v66, v78
    v_add_f32 v67, v67, v79
    v_add_f32 v80, v80, v92
    v_add_f32 v81, v81, v93
    v_add_f32 v82, v82, v94
    v_add_f32 v83, v83, v95
    v_permlane32_swap_b32 v32, v64
    v_permlane32_swap_b32 v33, v65
    v_permlane32_swap_b32 v34, v66
    v_permlane32_swap_b32 v35, v67
    v_add_f32 v32, v32, v64
    v_add_f32 v33, v33, v65
    v_add_f32 v34, v34, v66
    v_add_f32 v35, v35, v67
    v_permlane32_swap_b32 v48, v80
    v_permlane32_swap_b32 v49, v81
    v_permlane32_swap_b32 v50, v82
    v_permlane32_swap_b32 v51, v83
    v_add_f32 v48, v48, v80
    v_add_f32 v49, v49, v81
    v_add_f32 v50, v50, v82
    v_add_f32 v51, v51, v83
    v_permlane16_swap_b32 v32, v48
    v_permlane16_swap_b32 v33, v49
    v_permlane16_swap_b32 v34, v50
    v_permlane16_swap_b32 v35, v51
    v_add_f32 v32, v32, v48
    v_add_f32 v33, v33, v49
    v_add_f32 v34, v34, v50
    v_add_f32 v35, v35, v51
    s_barrier
    v_mul_f32 v32, 0x3a800000, v32
    v_mul_f32 v33, 0x3a800000, v33
    v_mul_f32 v34, 0x3a800000, v34
    v_mul_f32 v35, 0x3a800000, v35
    v_fma_f32 v33, -v32, v32, v33
    v_fma_f32 v35, -v34, v34, v35
    v_max_f32 v33, 0, v33
    v_max_f32 v35, 0, v35
    v_add_f32 v33, 0x3727c5ac, v33
    v_add_f32 v35, 0x3727c5ac, v35
    v_rsq_f32 v33, v33
    v_rsq_f32 v35, v35
    v_lshrrev_b32 v26, 1, v1
    v_add_u32 v26, 155648, v26
    ds_write2_b32 v26, v32, v34 offset0:0 offset1:1
    ds_write2_b32 v26, v33, v35 offset0:128 offset1:129
    s_barrier
    s_cmp_ge_u32 s21, 2
    s_cbranch_scc1 h_cs_done
    s_waitcnt vmcnt(0)
    v_add_f32 v96, v96, v100
    v_add_f32 v97, v97, v101
    v_add_f32 v98, v98, v102
    v_add_f32 v99, v99, v103
    v_add_f32 v96, v96, v104
    v_add_f32 v97, v97, v105
    v_add_f32 v98, v98, v106
    v_add_f32 v99, v99, v107
    v_add_f32 v96, v96, v108
    v_add_f32 v97, v97, v109
    v_add_f32 v98, v98, v110
    v_add_f32 v99, v99, v111
    v_add_f32 v96, v96, v112
    v_add_f32 v97, v97, v113
    v_add_f32 v98, v98, v114
    v_add_f32 v99, v99, v115
    v_add_f32 v96, v96, v116
    v_add_f32 v97, v97, v117
    v_add_f32 v98, v98, v118
    v_add_f32 v99, v99, v119
    v_add_f32 v96, v96, v120
    v_add_f32 v97, v97, v121
    v_add_f32 v98, v98, v122
    v_add_f32 v99, v99, v123
    v_add_f32 v96, v96, v124
    v_add_f32 v97, v97, v125
    v_add_f32 v98, v98, v126
    v_add_f32 v99, v99, v127
    v_add_f32 v96, v96, v128
    v_add_f32 v97, v97, v129
    v_add_f32 v98, v98, v130
    v_add_f32 v99, v99, v131
    v_add_f32 v96, v96, v132
    v_add_f32 v97, v97, v133
    v_add_f32 v98, v98, v134
    v_add_f32 v99, v99, v135
    v_add_f32 v96, v96, v136
    v_add_f32 v97, v97, v137
    v_add_f32 v98, v98, v138
    v_add_f32 v99, v99, v139
    v_add_f32 v96, v96, v140
    v_add_f32 v97, v97, v141
    v_add_f32 v98, v98, v142
    v_add_f32 v99, v99, v143
    v_add_f32 v96, v96, v144
    v_add_f32 v97, v97, v145
    v_add_f32 v98, v98, v146
    v_add_f32 v99, v99, v147
    v_add_f32 v96, v96, v148
    v_add_f32 v97, v97, v149
    v_add_f32 v98, v98, v150
    v_add_f32 v99, v99, v151
    v_add_f32 v96, v96, v152
    v_add_f32 v97, v97, v153
    v_add_f32 v98, v98, v154
    v_add_f32 v99, v99, v155
    v_add_f32 v96, v96, v156
    v_add_f32 v97, v97, v157
    v_add_f32 v98, v98, v158
    v_add_f32 v99, v99, v159
    s_lshl_b32 s44, s21, 10
    s_add_u32 s44, s44, 151552
    v_add_u32 v24, s44, v1
    ds_write_b128 v24, v[96:99]
h_cs_done:
    s_waitcnt lgkmcnt(0)
    s_barrier
    s_cmp_lg_u32 s21, 0
    s_cbranch_scc1 h_f1_ok
    s_load_dword s68, s[34:35], 128
    s_mov_b32 s8, s34
    s_mov_b32 s9, s35
    s_mov_b32 s10, 256
    s_mov_b32 s11, 0x00020000
    s_mov_b32 s66, 0x10000
    v_mov_b32 v24, 0
    s_waitcnt lgkmcnt(0)
h_f1:
    s_cmp_eq_u32 s68, 8
    s_cbranch_scc1 h_f1_ok
    buffer_load_dword v25, v24, s[8:11], 0 offen offset:128 sc1
    s_waitcnt vmcnt(0)
    v_readfirstlane_b32 s68, v25
    s_sub_u32 s66, s66, 1
    s_cmp_lg_u32 s66, 0
    s_cbranch_scc1 h_f1
h_f1_ok:
    s_barrier
    s_bitcmp1_b32 s21, 0
    s_cselect_b32 s8, s28, s24
    s_cselect_b32 s9, s29, s25
    s_cselect_b32 s12, s30, s26
    s_cselect_b32 s13, s31, s27
    s_mov_b32 s10, 6291456
    s_mov_b32 s11, 0x00020000
    s_mov_b32 s14, 2097152
    s_mov_b32 s15, 0x00020000
    v_lshrrev_b32 v28, 4, v1
    v_and_b32 v29, 7, v28
    v_lshrrev_b32 v28, 3, v28
    v_mul_u32_u24 v28, 2048, v28
    v_lshl_add_u32 v28, v29, 4, v28
    s_and_b32 s3, s20, 12
    s_or_b32 s3, s3, 3
    s_lshl_b32 s3, s3, 7
    v_add_u32 v28, s3, v28
    s_lshr_b32 s3, s2, 3
    s_lshl_b32 s3, s3, 2
    s_and_b32 s60, s16, 3
    s_add_u32 s60, s60, s3
    s_lshl_b32 s61, s60, 14
    buffer_load_dwordx4 v[144:147], v28, s[12:15], s61 offen
    s_bitcmp0_b32 s21, 0
    s_cselect_b32 s56, s28, s24
    s_cselect_b32 s57, s29, s25
    s_mov_b32 s58, 6291456
    s_mov_b32 s59, 0x00020000
    v_lshrrev_b32 v28, 4, v1
    v_and_b32 v29, 7, v28
    v_lshrrev_b32 v28, 3, v28
    v_mul_u32_u24 v28, 6144, v28
    v_lshl_add_u32 v28, v29, 4, v28
    s_and_b32 s3, s18, 12
    s_or_b32 s3, s3, 3
    s_lshl_b32 s3, s3, 7
    v_add_u32 v28, s3, v28
    s_lshr_b32 s3, s2, 3
    s_lshl_b32 s3, s3, 2
    s_and_b32 s60, s16, 3
    s_add_u32 s60, s60, s3
    s_and_b32 s3, s60, 31
    s_mul_i32 s3, s3, 49152
    s_lshr_b32 s61, s60, 5
    s_min_u32 s61, s61, 2
    s_lshl_b32 s61, s61, 11
    s_add_u32 s61, s61, s3
    s_and_b32 s3, s18, 0
    s_mul_i32 s3, s3, 393216
    s_add_u32 s61, s61, s3
    buffer_load_dwordx4 v[148:151], v28, s[56:59], s61 offen
    s_cmp_lg_u32 s21, 2
    s_cbranch_scc1 h_pe
    s_bitcmp0_b32 s21, 0
    s_cselect_b32 s56, s28, s24
    s_cselect_b32 s57, s29, s25
    s_mov_b32 s58, 6291456
    s_mov_b32 s59, 0x00020000
    s_add_u32 s61, s84, 2048
    buffer_load_dwordx4 v[160:163], v11, s[56:59], s61 offen
    s_add_u32 s61, s84, 4096
    buffer_load_dwordx4 v[164:167], v11, s[56:59], s61 offen
    s_add_u32 s61, s84, 0
    buffer_load_dwordx4 v[168:171], v11, s[56:59], s61 offen
    s_add_u32 s61, s84, 198656
    buffer_load_dwordx4 v[172:175], v11, s[56:59], s61 offen
    s_add_u32 s61, s84, 200704
    buffer_load_dwordx4 v[176:179], v11, s[56:59], s61 offen
    s_add_u32 s61, s84, 196608
    buffer_load_dwordx4 v[180:183], v11, s[56:59], s61 offen
    s_add_u32 s61, s85, 2048
    buffer_load_dwordx4 v[184:187], v11, s[56:59], s61 offen
    s_add_u32 s61, s85, 4096
    buffer_load_dwordx4 v[188:191], v11, s[56:59], s61 offen
    s_add_u32 s61, s85, 0
    buffer_load_dwordx4 v[192:195], v11, s[56:59], s61 offen
    s_add_u32 s61, s85, 198656
    buffer_load_dwordx4 v[196:199], v11, s[56:59], s61 offen
h_pe:
    s_barrier
    s_branch s_tail
l_start:
    v_lshrrev_b32 v24, 4, v1
    v_lshrrev_b32 v25, 3, v24
    v_mul_u32_u24 v12, 6144, v25
    v_and_b32 v26, 2, v25
    v_lshrrev_b32 v25, 2, v25
    v_or_b32 v26, v26, v25
    v_bfe_u32 v25, v24, 1, 2
    v_xor_b32 v26, v26, v25
    v_lshl_add_u32 v12, v26, 5, v12
    v_and_b32 v26, 1, v24
    v_lshl_add_u32 v12, v26, 4, v12
    s_lshl_b32 s3, s18, 7
    v_add_u32 v12, s3, v12
    v_add_u32 v13, 48128, v12
    v_add_u32 v14, 96256, v12
    v_add_u32 v15, 144384, v12
    v_lshrrev_b32 v24, 4, v1
    v_lshrrev_b32 v25, 3, v24
    v_mul_u32_u24 v16, 2048, v25
    v_and_b32 v26, 2, v25
    v_lshrrev_b32 v25, 2, v25
    v_or_b32 v26, v26, v25
    v_bfe_u32 v25, v24, 1, 2
    v_xor_b32 v26, v26, v25
    v_lshl_add_u32 v16, v26, 5, v16
    v_and_b32 v26, 1, v24
    v_lshl_add_u32 v16, v26, 4, v16
    s_lshl_b32 s3, s20, 7
    v_add_u32 v16, s3, v16
    v_add_u32 v17, 15360, v16
    v_add_u32 v18, 30720, v16
    v_add_u32 v19, 46080, v16
    s_mul_i32 s84, s18, 393216
    s_cmp_eq_u32 s18, 1
    s_cselect_b32 s85, 0, 393216
    s_cmp_eq_u32 s18, 2
    s_cselect_b32 s86, 0, 786432
    s_cmp_eq_u32 s18, 3
    s_cselect_b32 s87, 0, 1179648
    s_cmp_eq_u32 s18, 4
    s_cselect_b32 s88, 0, 1572864
    s_cmp_eq_u32 s18, 5
    s_cselect_b32 s89, 0, 1966080
    s_cmp_eq_u32 s18, 6
    s_cselect_b32 s90, 0, 2359296
    s_cmp_eq_u32 s18, 7
    s_cselect_b32 s91, 0, 2752512
    s_cmp_eq_u32 s18, 8
    s_cselect_b32 s92, 0, 3145728
    s_cmp_eq_u32 s18, 9
    s_cselect_b32 s93, 0, 3538944
    s_cmp_eq_u32 s18, 10
    s_cselect_b32 s94, 0, 3932160
    s_cmp_eq_u32 s18, 11
    s_cselect_b32 s95, 0, 4325376
    s_cmp_eq_u32 s18, 12
    s_cselect_b32 s96, 0, 4718592
    s_cmp_eq_u32 s18, 13
    s_cselect_b32 s97, 0, 5111808
    s_cmp_eq_u32 s18, 14
    s_cselect_b32 s98, 0, 5505024
    s_cmp_eq_u32 s18, 15
    s_cselect_b32 s99, 0, 5898240
    s_and_b32 s3, s16, 3
    s_mul_i32 s3, s3, 49152
    v_add_u32 v11, s3, v12
    s_and_b32 s3, s16, 3
    s_lshl_b32 s3, s3, 10
    v_add_u32 v9, s3, v1
    v_add_u32 v10, 0x10000, v9
    s_sub_u32 s3, s16, 5
    s_lshl_b32 s41, s3, 11
    s_mul_i32 s42, s3, 98304
    s_lshl_b32 s62, s3, 15
    v_add_u32 v14, s42, v12
    v_add_u32 v15, s42, v13
    s_and_b32 s3, s20, 0
    s_lshl_b32 s3, s3, 17
    s_add_u32 s62, s62, s3
    s_barrier
    s_bitcmp1_b32 s21, 0
    s_cselect_b32 s8, s28, s24
    s_cselect_b32 s9, s29, s25
    s_cselect_b32 s12, s30, s26
    s_cselect_b32 s13, s31, s27
    s_mov_b32 s10, 6291456
    s_mov_b32 s11, 0x00020000
    s_mov_b32 s14, 2097152
    s_mov_b32 s15, 0x00020000
    s_add_u32 m0, s41, 0
    s_add_u32 s44, s84, 2048
    buffer_load_dwordx4 v14, s[8:11], s44 offen offset:0 lds
    buffer_load_dwordx4 v15, s[8:11], s44 offen offset:1024 lds
    s_add_u32 m0, s41, 4096
    s_add_u32 s44, s84, 4096
    buffer_load_dwordx4 v14, s[8:11], s44 offen offset:0 lds
    buffer_load_dwordx4 v15, s[8:11], s44 offen offset:1024 lds
    s_add_u32 m0, s41, 8192
    s_add_u32 s44, s84, 0
    buffer_load_dwordx4 v14, s[8:11], s44 offen offset:0 lds
    buffer_load_dwordx4 v15, s[8:11], s44 offen offset:1024 lds
    s_add_u32 m0, s41, 12288
    s_add_u32 s44, s84, 198656
    buffer_load_dwordx4 v14, s[8:11], s44 offen offset:0 lds
    buffer_load_dwordx4 v15, s[8:11], s44 offen offset:1024 lds
    s_add_u32 m0, s41, 16384
    s_add_u32 s44, s84, 200704
    buffer_load_dwordx4 v14, s[8:11], s44 offen offset:0 lds
    buffer_load_dwordx4 v15, s[8:11], s44 offen offset:1024 lds
    s_add_u32 m0, s41, 20480
    s_add_u32 s44, s84, 196608
    buffer_load_dwordx4 v14, s[8:11], s44 offen offset:0 lds
    buffer_load_dwordx4 v15, s[8:11], s44 offen offset:1024 lds
    s_add_u32 m0, s41, 24576
    s_add_u32 s44, s85, 2048
    buffer_load_dwordx4 v14, s[8:11], s44 offen offset:0 lds
    buffer_load_dwordx4 v15, s[8:11], s44 offen offset:1024 lds
    s_add_u32 m0, s41, 28672
    s_add_u32 s44, s85, 4096
    buffer_load_dwordx4 v14, s[8:11], s44 offen offset:0 lds
    buffer_load_dwordx4 v15, s[8:11], s44 offen offset:1024 lds
    s_add_u32 m0, s41, 32768
    s_add_u32 s44, s85, 0
    buffer_load_dwordx4 v14, s[8:11], s44 offen offset:0 lds
    buffer_load_dwordx4 v15, s[8:11], s44 offen offset:1024 lds
    s_add_u32 m0, s41, 36864
    s_add_u32 s44, s85, 198656
    buffer_load_dwordx4 v14, s[8:11], s44 offen offset:0 lds
    buffer_load_dwordx4 v15, s[8:11], s44 offen offset:1024 lds
    s_add_u32 m0, s41, 40960
    s_add_u32 s44, s85, 200704
    buffer_load_dwordx4 v14, s[8:11], s44 offen offset:0 lds
    buffer_load_dwordx4 v15, s[8:11], s44 offen offset:1024 lds
    s_add_u32 m0, s41, 45056
    s_add_u32 s44, s85, 196608
    buffer_load_dwordx4 v14, s[8:11], s44 offen offset:0 lds
    buffer_load_dwordx4 v15, s[8:11], s44 offen offset:1024 lds
    s_waitcnt vmcnt(8)
    s_barrier
    s_add_u32 m0, s41, 49152
    s_add_u32 s44, s86, 2048
    buffer_load_dwordx4 v14, s[8:11], s44 offen offset:0 lds
    buffer_load_dwordx4 v15, s[8:11], s44 offen offset:1024 lds
    s_add_u32 m0, s41, 53248
    s_add_u32 s44, s86, 4096
    buffer_load_dwordx4 v14, s[8:11], s44 offen offset:0 lds
    buffer_load_dwordx4 v15, s[8:11], s44 offen offset:1024 lds
    s_add_u32 m0, s41, 57344
    s_add_u32 s44, s86, 0
    buffer_load_dwordx4 v14, s[8:11], s44 offen offset:0 lds
    buffer_load_dwordx4 v15, s[8:11], s44 offen offset:1024 lds
    s_add_u32 m0, s41, 61440
    s_add_u32 s44, s86, 198656
    buffer_load_dwordx4 v14, s[8:11], s44 offen offset:0 lds
    buffer_load_dwordx4 v15, s[8:11], s44 offen offset:1024 lds
    s_add_u32 m0, s41, 65536
    s_add_u32 s44, s86, 200704
    buffer_load_dwordx4 v14, s[8:11], s44 offen offset:0 lds
    buffer_load_dwordx4 v15, s[8:11], s44 offen offset:1024 lds
    s_add_u32 m0, s41, 69632
    s_add_u32 s44, s86, 196608
    buffer_load_dwordx4 v14, s[8:11], s44 offen offset:0 lds
    buffer_load_dwordx4 v15, s[8:11], s44 offen offset:1024 lds
    s_add_u32 m0, s41, 73728
    s_add_u32 s44, s87, 2048
    buffer_load_dwordx4 v14, s[8:11], s44 offen offset:0 lds
    buffer_load_dwordx4 v15, s[8:11], s44 offen offset:1024 lds
    s_add_u32 m0, s41, 77824
    s_add_u32 s44, s87, 4096
    buffer_load_dwordx4 v14, s[8:11], s44 offen offset:0 lds
    buffer_load_dwordx4 v15, s[8:11], s44 offen offset:1024 lds
    s_add_u32 m0, s41, 81920
    s_add_u32 s44, s87, 0
    buffer_load_dwordx4 v14, s[8:11], s44 offen offset:0 lds
    buffer_load_dwordx4 v15, s[8:11], s44 offen offset:1024 lds
    s_add_u32 m0, s41, 86016
    s_add_u32 s44, s87, 198656
    buffer_load_dwordx4 v14, s[8:11], s44 offen offset:0 lds
    buffer_load_dwordx4 v15, s[8:11], s44 offen offset:1024 lds
    s_add_u32 m0, s41, 90112
    s_add_u32 s44, s87, 200704
    buffer_load_dwordx4 v14, s[8:11], s44 offen offset:0 lds
    buffer_load_dwordx4 v15, s[8:11], s44 offen offset:1024 lds
    s_add_u32 m0, s41, 94208
    s_add_u32 s44, s87, 196608
    buffer_load_dwordx4 v14, s[8:11], s44 offen offset:0 lds
    buffer_load_dwordx4 v15, s[8:11], s44 offen offset:1024 lds
    s_waitcnt vmcnt(16)
    s_barrier
    s_add_u32 m0, s41, 98304
    s_add_u32 s44, s88, 2048
    buffer_load_dwordx4 v14, s[8:11], s44 offen offset:0 lds
    buffer_load_dwordx4 v15, s[8:11], s44 offen offset:1024 lds
    s_add_u32 m0, s41, 102400
    s_add_u32 s44, s88, 4096
    buffer_load_dwordx4 v14, s[8:11], s44 offen offset:0 lds
    buffer_load_dwordx4 v15, s[8:11], s44 offen offset:1024 lds
    s_add_u32 m0, s41, 106496
    s_add_u32 s44, s88, 0
    buffer_load_dwordx4 v14, s[8:11], s44 offen offset:0 lds
    buffer_load_dwordx4 v15, s[8:11], s44 offen offset:1024 lds
    s_add_u32 m0, s41, 110592
    s_add_u32 s44, s88, 198656
    buffer_load_dwordx4 v14, s[8:11], s44 offen offset:0 lds
    buffer_load_dwordx4 v15, s[8:11], s44 offen offset:1024 lds
    s_add_u32 m0, s41, 114688
    s_add_u32 s44, s88, 200704
    buffer_load_dwordx4 v14, s[8:11], s44 offen offset:0 lds
    buffer_load_dwordx4 v15, s[8:11], s44 offen offset:1024 lds
    s_add_u32 m0, s41, 118784
    s_add_u32 s44, s88, 196608
    buffer_load_dwordx4 v14, s[8:11], s44 offen offset:0 lds
    buffer_load_dwordx4 v15, s[8:11], s44 offen offset:1024 lds
    s_add_u32 m0, s41, 122880
    s_add_u32 s44, s89, 2048
    buffer_load_dwordx4 v14, s[8:11], s44 offen offset:0 lds
    buffer_load_dwordx4 v15, s[8:11], s44 offen offset:1024 lds
    s_add_u32 m0, s41, 126976
    s_add_u32 s44, s89, 4096
    buffer_load_dwordx4 v14, s[8:11], s44 offen offset:0 lds
    buffer_load_dwordx4 v15, s[8:11], s44 offen offset:1024 lds
    s_add_u32 m0, s41, 0
    s_add_u32 s44, s89, 0
    buffer_load_dwordx4 v14, s[8:11], s44 offen offset:0 lds
    buffer_load_dwordx4 v15, s[8:11], s44 offen offset:1024 lds
    s_add_u32 m0, s41, 4096
    s_add_u32 s44, s89, 198656
    buffer_load_dwordx4 v14, s[8:11], s44 offen offset:0 lds
    buffer_load_dwordx4 v15, s[8:11], s44 offen offset:1024 lds
    s_add_u32 m0, s41, 8192
    s_add_u32 s44, s89, 200704
    buffer_load_dwordx4 v14, s[8:11], s44 offen offset:0 lds
    buffer_load_dwordx4 v15, s[8:11], s44 offen offset:1024 lds
    s_add_u32 m0, s41, 12288
    s_add_u32 s44, s89, 196608
    buffer_load_dwordx4 v14, s[8:11], s44 offen offset:0 lds
    buffer_load_dwordx4 v15, s[8:11], s44 offen offset:1024 lds
    s_waitcnt vmcnt(24)
    s_branch l_join
l_layer:
    s_waitcnt lgkmcnt(0)
    s_barrier
    s_add_u32 m0, s41, 0
    s_add_u32 s44, s89, 0
    buffer_load_dwordx4 v14, s[8:11], s44 offen offset:0 lds
    buffer_load_dwordx4 v15, s[8:11], s44 offen offset:1024 lds
    s_add_u32 m0, s41, 4096
    s_add_u32 s44, s89, 198656
    buffer_load_dwordx4 v14, s[8:11], s44 offen offset:0 lds
    buffer_load_dwordx4 v15, s[8:11], s44 offen offset:1024 lds
    s_add_u32 m0, s41, 8192
    s_add_u32 s44, s89, 200704
    buffer_load_dwordx4 v14, s[8:11], s44 offen offset:0 lds
    buffer_load_dwordx4 v15, s[8:11], s44 offen offset:1024 lds
    s_add_u32 m0, s41, 12288
    s_add_u32 s44, s89, 196608
    buffer_load_dwordx4 v14, s[8:11], s44 offen offset:0 lds
    buffer_load_dwordx4 v15, s[8:11], s44 offen offset:1024 lds
l_join:
    s_barrier
    s_add_u32 m0, s41, 16384
    s_add_u32 s44, s90, 2048
    buffer_load_dwordx4 v14, s[8:11], s44 offen offset:0 lds
    buffer_load_dwordx4 v15, s[8:11], s44 offen offset:1024 lds
    s_add_u32 m0, s41, 20480
    s_add_u32 s44, s90, 4096
    buffer_load_dwordx4 v14, s[8:11], s44 offen offset:0 lds
    buffer_load_dwordx4 v15, s[8:11], s44 offen offset:1024 lds
    s_add_u32 m0, s41, 24576
    s_add_u32 s44, s90, 0
    buffer_load_dwordx4 v14, s[8:11], s44 offen offset:0 lds
    buffer_load_dwordx4 v15, s[8:11], s44 offen offset:1024 lds
    s_add_u32 m0, s41, 28672
    s_add_u32 s44, s90, 198656
    buffer_load_dwordx4 v14, s[8:11], s44 offen offset:0 lds
    buffer_load_dwordx4 v15, s[8:11], s44 offen offset:1024 lds
    s_add_u32 m0, s41, 32768
    s_add_u32 s44, s90, 200704
    buffer_load_dwordx4 v14, s[8:11], s44 offen offset:0 lds
    buffer_load_dwordx4 v15, s[8:11], s44 offen offset:1024 lds
    s_add_u32 m0, s41, 36864
    s_add_u32 s44, s90, 196608
    buffer_load_dwordx4 v14, s[8:11], s44 offen offset:0 lds
    buffer_load_dwordx4 v15, s[8:11], s44 offen offset:1024 lds
    s_add_u32 m0, s41, 40960
    s_add_u32 s44, s91, 2048
    buffer_load_dwordx4 v14, s[8:11], s44 offen offset:0 lds
    buffer_load_dwordx4 v15, s[8:11], s44 offen offset:1024 lds
    s_add_u32 m0, s41, 45056
    s_add_u32 s44, s91, 4096
    buffer_load_dwordx4 v14, s[8:11], s44 offen offset:0 lds
    buffer_load_dwordx4 v15, s[8:11], s44 offen offset:1024 lds
    s_waitcnt vmcnt(24)
    s_barrier
    s_add_u32 m0, s41, 49152
    s_add_u32 s44, s91, 0
    buffer_load_dwordx4 v14, s[8:11], s44 offen offset:0 lds
    buffer_load_dwordx4 v15, s[8:11], s44 offen offset:1024 lds
    s_add_u32 m0, s41, 53248
    s_add_u32 s44, s91, 198656
    buffer_load_dwordx4 v14, s[8:11], s44 offen offset:0 lds
    buffer_load_dwordx4 v15, s[8:11], s44 offen offset:1024 lds
    s_add_u32 m0, s41, 57344
    s_add_u32 s44, s91, 200704
    buffer_load_dwordx4 v14, s[8:11], s44 offen offset:0 lds
    buffer_load_dwordx4 v15, s[8:11], s44 offen offset:1024 lds
    s_add_u32 m0, s41, 61440
    s_add_u32 s44, s91, 196608
    buffer_load_dwordx4 v14, s[8:11], s44 offen offset:0 lds
    buffer_load_dwordx4 v15, s[8:11], s44 offen offset:1024 lds
    s_waitcnt vmcnt(16)
    s_barrier
    s_add_u32 m0, s41, 65536
    s_add_u32 s44, s92, 2048
    buffer_load_dwordx4 v14, s[8:11], s44 offen offset:0 lds
    buffer_load_dwordx4 v15, s[8:11], s44 offen offset:1024 lds
    s_add_u32 m0, s41, 69632
    s_add_u32 s44, s92, 4096
    buffer_load_dwordx4 v14, s[8:11], s44 offen offset:0 lds
    buffer_load_dwordx4 v15, s[8:11], s44 offen offset:1024 lds
    s_add_u32 m0, s41, 73728
    s_add_u32 s44, s92, 0
    buffer_load_dwordx4 v14, s[8:11], s44 offen offset:0 lds
    buffer_load_dwordx4 v15, s[8:11], s44 offen offset:1024 lds
    s_add_u32 m0, s41, 77824
    s_add_u32 s44, s92, 198656
    buffer_load_dwordx4 v14, s[8:11], s44 offen offset:0 lds
    buffer_load_dwordx4 v15, s[8:11], s44 offen offset:1024 lds
    s_add_u32 m0, s41, 81920
    s_add_u32 s44, s92, 200704
    buffer_load_dwordx4 v14, s[8:11], s44 offen offset:0 lds
    buffer_load_dwordx4 v15, s[8:11], s44 offen offset:1024 lds
    s_add_u32 m0, s41, 86016
    s_add_u32 s44, s92, 196608
    buffer_load_dwordx4 v14, s[8:11], s44 offen offset:0 lds
    buffer_load_dwordx4 v15, s[8:11], s44 offen offset:1024 lds
    s_add_u32 m0, s41, 90112
    s_add_u32 s44, s93, 2048
    buffer_load_dwordx4 v14, s[8:11], s44 offen offset:0 lds
    buffer_load_dwordx4 v15, s[8:11], s44 offen offset:1024 lds
    s_add_u32 m0, s41, 94208
    s_add_u32 s44, s93, 4096
    buffer_load_dwordx4 v14, s[8:11], s44 offen offset:0 lds
    buffer_load_dwordx4 v15, s[8:11], s44 offen offset:1024 lds
    s_waitcnt vmcnt(16)
    s_barrier
    s_add_u32 m0, s41, 98304
    s_add_u32 s44, s93, 0
    buffer_load_dwordx4 v14, s[8:11], s44 offen offset:0 lds
    buffer_load_dwordx4 v15, s[8:11], s44 offen offset:1024 lds
    s_add_u32 m0, s41, 102400
    s_add_u32 s44, s93, 198656
    buffer_load_dwordx4 v14, s[8:11], s44 offen offset:0 lds
    buffer_load_dwordx4 v15, s[8:11], s44 offen offset:1024 lds
    s_add_u32 m0, s41, 106496
    s_add_u32 s44, s93, 200704
    buffer_load_dwordx4 v14, s[8:11], s44 offen offset:0 lds
    buffer_load_dwordx4 v15, s[8:11], s44 offen offset:1024 lds
    s_add_u32 m0, s41, 110592
    s_add_u32 s44, s93, 196608
    buffer_load_dwordx4 v14, s[8:11], s44 offen offset:0 lds
    buffer_load_dwordx4 v15, s[8:11], s44 offen offset:1024 lds
    s_add_u32 m0, s41, 114688
    s_add_u32 s44, s94, 2048
    buffer_load_dwordx4 v14, s[8:11], s44 offen offset:0 lds
    buffer_load_dwordx4 v15, s[8:11], s44 offen offset:1024 lds
    s_add_u32 m0, s41, 118784
    s_add_u32 s44, s94, 4096
    buffer_load_dwordx4 v14, s[8:11], s44 offen offset:0 lds
    buffer_load_dwordx4 v15, s[8:11], s44 offen offset:1024 lds
    s_add_u32 m0, s41, 122880
    s_add_u32 s44, s94, 198656
    buffer_load_dwordx4 v14, s[8:11], s44 offen offset:0 lds
    buffer_load_dwordx4 v15, s[8:11], s44 offen offset:1024 lds
    s_add_u32 m0, s41, 126976
    s_add_u32 s44, s94, 200704
    buffer_load_dwordx4 v14, s[8:11], s44 offen offset:0 lds
    buffer_load_dwordx4 v15, s[8:11], s44 offen offset:1024 lds
    s_waitcnt vmcnt(16)
    s_barrier
    s_add_u32 m0, s41, 0
    s_add_u32 s44, s95, 2048
    buffer_load_dwordx4 v14, s[8:11], s44 offen offset:0 lds
    buffer_load_dwordx4 v15, s[8:11], s44 offen offset:1024 lds
    s_add_u32 m0, s41, 4096
    s_add_u32 s44, s95, 4096
    buffer_load_dwordx4 v14, s[8:11], s44 offen offset:0 lds
    buffer_load_dwordx4 v15, s[8:11], s44 offen offset:1024 lds
    s_add_u32 m0, s41, 8192
    s_add_u32 s44, s95, 198656
    buffer_load_dwordx4 v14, s[8:11], s44 offen offset:0 lds
    buffer_load_dwordx4 v15, s[8:11], s44 offen offset:1024 lds
    s_add_u32 m0, s41, 12288
    s_add_u32 s44, s95, 200704
    buffer_load_dwordx4 v14, s[8:11], s44 offen offset:0 lds
    buffer_load_dwordx4 v15, s[8:11], s44 offen offset:1024 lds
    s_add_u32 m0, s41, 16384
    s_add_u32 s44, s96, 2048
    buffer_load_dwordx4 v14, s[8:11], s44 offen offset:0 lds
    buffer_load_dwordx4 v15, s[8:11], s44 offen offset:1024 lds
    s_add_u32 m0, s41, 20480
    s_add_u32 s44, s96, 198656
    buffer_load_dwordx4 v14, s[8:11], s44 offen offset:0 lds
    buffer_load_dwordx4 v15, s[8:11], s44 offen offset:1024 lds
    s_add_u32 m0, s41, 24576
    s_add_u32 s44, s97, 2048
    buffer_load_dwordx4 v14, s[8:11], s44 offen offset:0 lds
    buffer_load_dwordx4 v15, s[8:11], s44 offen offset:1024 lds
    s_add_u32 m0, s41, 28672
    s_add_u32 s44, s97, 198656
    buffer_load_dwordx4 v14, s[8:11], s44 offen offset:0 lds
    buffer_load_dwordx4 v15, s[8:11], s44 offen offset:1024 lds
    s_waitcnt vmcnt(16)
    s_barrier
    s_add_u32 m0, s41, 32768
    s_add_u32 s44, s98, 2048
    buffer_load_dwordx4 v14, s[8:11], s44 offen offset:0 lds
    buffer_load_dwordx4 v15, s[8:11], s44 offen offset:1024 lds
    s_add_u32 m0, s41, 36864
    s_add_u32 s44, s98, 198656
    buffer_load_dwordx4 v14, s[8:11], s44 offen offset:0 lds
    buffer_load_dwordx4 v15, s[8:11], s44 offen offset:1024 lds
    s_add_u32 m0, s41, 40960
    s_add_u32 s44, s99, 2048
    buffer_load_dwordx4 v14, s[8:11], s44 offen offset:0 lds
    buffer_load_dwordx4 v15, s[8:11], s44 offen offset:1024 lds
    s_add_u32 m0, s41, 45056
    s_add_u32 s44, s99, 198656
    buffer_load_dwordx4 v14, s[8:11], s44 offen offset:0 lds
    buffer_load_dwordx4 v15, s[8:11], s44 offen offset:1024 lds
    s_add_u32 m0, s41, 49152
    s_add_u32 s44, s96, 4096
    buffer_load_dwordx4 v14, s[8:11], s44 offen offset:0 lds
    buffer_load_dwordx4 v15, s[8:11], s44 offen offset:1024 lds
    s_add_u32 m0, s41, 53248
    s_add_u32 s44, s96, 200704
    buffer_load_dwordx4 v14, s[8:11], s44 offen offset:0 lds
    buffer_load_dwordx4 v15, s[8:11], s44 offen offset:1024 lds
    s_add_u32 m0, s41, 57344
    s_add_u32 s44, s97, 4096
    buffer_load_dwordx4 v14, s[8:11], s44 offen offset:0 lds
    buffer_load_dwordx4 v15, s[8:11], s44 offen offset:1024 lds
    s_add_u32 m0, s41, 61440
    s_add_u32 s44, s97, 200704
    buffer_load_dwordx4 v14, s[8:11], s44 offen offset:0 lds
    buffer_load_dwordx4 v15, s[8:11], s44 offen offset:1024 lds
    s_waitcnt vmcnt(16)
    s_barrier
    s_add_u32 m0, s41, 65536
    s_add_u32 s44, s98, 4096
    buffer_load_dwordx4 v14, s[8:11], s44 offen offset:0 lds
    buffer_load_dwordx4 v15, s[8:11], s44 offen offset:1024 lds
    s_add_u32 m0, s41, 69632
    s_add_u32 s44, s98, 200704
    buffer_load_dwordx4 v14, s[8:11], s44 offen offset:0 lds
    buffer_load_dwordx4 v15, s[8:11], s44 offen offset:1024 lds
    s_add_u32 m0, s41, 73728
    s_add_u32 s44, s99, 4096
    buffer_load_dwordx4 v14, s[8:11], s44 offen offset:0 lds
    buffer_load_dwordx4 v15, s[8:11], s44 offen offset:1024 lds
    s_add_u32 m0, s41, 77824
    s_add_u32 s44, s99, 200704
    buffer_load_dwordx4 v14, s[8:11], s44 offen offset:0 lds
    buffer_load_dwordx4 v15, s[8:11], s44 offen offset:1024 lds
    s_add_u32 m0, s41, 81920
    s_add_u32 s44, s94, 0
    buffer_load_dwordx4 v14, s[8:11], s44 offen offset:0 lds
    buffer_load_dwordx4 v15, s[8:11], s44 offen offset:1024 lds
    s_add_u32 m0, s41, 86016
    s_add_u32 s44, s94, 196608
    buffer_load_dwordx4 v14, s[8:11], s44 offen offset:0 lds
    buffer_load_dwordx4 v15, s[8:11], s44 offen offset:1024 lds
    s_add_u32 m0, s41, 90112
    s_add_u32 s44, s95, 0
    buffer_load_dwordx4 v14, s[8:11], s44 offen offset:0 lds
    buffer_load_dwordx4 v15, s[8:11], s44 offen offset:1024 lds
    s_add_u32 m0, s41, 94208
    s_add_u32 s44, s95, 196608
    buffer_load_dwordx4 v14, s[8:11], s44 offen offset:0 lds
    buffer_load_dwordx4 v15, s[8:11], s44 offen offset:1024 lds
    s_waitcnt vmcnt(16)
    s_barrier
    s_add_u32 m0, s41, 98304
    s_add_u32 s44, s96, 0
    buffer_load_dwordx4 v14, s[8:11], s44 offen offset:0 lds
    buffer_load_dwordx4 v15, s[8:11], s44 offen offset:1024 lds
    s_add_u32 m0, s41, 102400
    s_add_u32 s44, s96, 196608
    buffer_load_dwordx4 v14, s[8:11], s44 offen offset:0 lds
    buffer_load_dwordx4 v15, s[8:11], s44 offen offset:1024 lds
    s_add_u32 m0, s41, 106496
    s_add_u32 s44, s97, 0
    buffer_load_dwordx4 v14, s[8:11], s44 offen offset:0 lds
    buffer_load_dwordx4 v15, s[8:11], s44 offen offset:1024 lds
    s_add_u32 m0, s41, 110592
    s_add_u32 s44, s97, 196608
    buffer_load_dwordx4 v14, s[8:11], s44 offen offset:0 lds
    buffer_load_dwordx4 v15, s[8:11], s44 offen offset:1024 lds
    s_add_u32 m0, s41, 114688
    s_add_u32 s44, s98, 0
    buffer_load_dwordx4 v14, s[8:11], s44 offen offset:0 lds
    buffer_load_dwordx4 v15, s[8:11], s44 offen offset:1024 lds
    s_add_u32 m0, s41, 118784
    s_add_u32 s44, s98, 196608
    buffer_load_dwordx4 v14, s[8:11], s44 offen offset:0 lds
    buffer_load_dwordx4 v15, s[8:11], s44 offen offset:1024 lds
    s_add_u32 m0, s41, 122880
    s_add_u32 s44, s99, 0
    buffer_load_dwordx4 v14, s[8:11], s44 offen offset:0 lds
    buffer_load_dwordx4 v15, s[8:11], s44 offen offset:1024 lds
    s_add_u32 m0, s41, 126976
    s_add_u32 s44, s99, 196608
    buffer_load_dwordx4 v14, s[8:11], s44 offen offset:0 lds
    buffer_load_dwordx4 v15, s[8:11], s44 offen offset:1024 lds
    s_waitcnt vmcnt(16)
    s_barrier
    v_lshrrev_b32 v28, 4, v1
    v_and_b32 v29, 7, v28
    v_lshrrev_b32 v28, 3, v28
    v_mul_u32_u24 v28, 2048, v28
    v_lshl_add_u32 v28, v29, 4, v28
    s_and_b32 s3, s20, 12
    s_or_b32 s3, s3, 3
    s_lshl_b32 s3, s3, 7
    v_add_u32 v28, s3, v28
    s_lshr_b32 s3, s2, 3
    s_lshl_b32 s3, s3, 2
    s_and_b32 s60, s16, 3
    s_add_u32 s60, s60, s3
    s_lshl_b32 s61, s60, 14
    buffer_load_dwordx4 v[144:147], v28, s[12:15], s61 offen
    s_bitcmp0_b32 s21, 0
    s_cselect_b32 s56, s28, s24
    s_cselect_b32 s57, s29, s25
    s_mov_b32 s58, 6291456
    s_mov_b32 s59, 0x00020000
    v_lshrrev_b32 v28, 4, v1
    v_and_b32 v29, 7, v28
    v_lshrrev_b32 v28, 3, v28
    v_mul_u32_u24 v28, 6144, v28
    v_lshl_add_u32 v28, v29, 4, v28
    s_and_b32 s3, s18, 12
    s_or_b32 s3, s3, 3
    s_lshl_b32 s3, s3, 7
    v_add_u32 v28, s3, v28
    s_lshr_b32 s3, s2, 3
    s_lshl_b32 s3, s3, 2
    s_and_b32 s60, s16, 3
    s_add_u32 s60, s60, s3
    s_and_b32 s3, s60, 31
    s_mul_i32 s3, s3, 49152
    s_lshr_b32 s61, s60, 5
    s_min_u32 s61, s61, 2
    s_lshl_b32 s61, s61, 11
    s_add_u32 s61, s61, s3
    s_and_b32 s3, s18, 0
    s_mul_i32 s3, s3, 393216
    s_add_u32 s61, s61, s3
    buffer_load_dwordx4 v[148:151], v28, s[56:59], s61 offen
    s_waitcnt vmcnt(2)
    s_cmp_lg_u32 s21, 2
    s_cbranch_scc1 l_pe
    s_bitcmp0_b32 s21, 0
    s_cselect_b32 s56, s28, s24
    s_cselect_b32 s57, s29, s25
    s_mov_b32 s58, 6291456
    s_mov_b32 s59, 0x00020000
    s_add_u32 s61, s84, 2048
    buffer_load_dwordx4 v[160:163], v11, s[56:59], s61 offen
    s_add_u32 s61, s84, 4096
    buffer_load_dwordx4 v[164:167], v11, s[56:59], s61 offen
    s_add_u32 s61, s84, 0
    buffer_load_dwordx4 v[168:171], v11, s[56:59], s61 offen
    s_add_u32 s61, s84, 198656
    buffer_load_dwordx4 v[172:175], v11, s[56:59], s61 offen
    s_add_u32 s61, s84, 200704
    buffer_load_dwordx4 v[176:179], v11, s[56:59], s61 offen
    s_add_u32 s61, s84, 196608
    buffer_load_dwordx4 v[180:183], v11, s[56:59], s61 offen
    s_add_u32 s61, s85, 2048
    buffer_load_dwordx4 v[184:187], v11, s[56:59], s61 offen
    s_add_u32 s61, s85, 4096
    buffer_load_dwordx4 v[188:191], v11, s[56:59], s61 offen
    s_add_u32 s61, s85, 0
    buffer_load_dwordx4 v[192:195], v11, s[56:59], s61 offen
    s_add_u32 s61, s85, 198656
    buffer_load_dwordx4 v[196:199], v11, s[56:59], s61 offen
l_pe:
    s_barrier
    s_bitcmp1_b32 s21, 0
    s_cbranch_scc1 s_B
    s_add_u32 m0, s41, 0
    s_xor_b32 s44, s62, 0
    buffer_load_dwordx4 v16, s[12:15], s44 offen offset:0 lds
    buffer_load_dwordx4 v17, s[12:15], s44 offen offset:1024 lds
    s_add_u32 m0, s41, 4096
    s_xor_b32 s44, s62, 131072
    buffer_load_dwordx4 v16, s[12:15], s44 offen offset:0 lds
    buffer_load_dwordx4 v17, s[12:15], s44 offen offset:1024 lds
    s_add_u32 m0, s41, 8192
    s_xor_b32 s44, s62, 262144
    buffer_load_dwordx4 v16, s[12:15], s44 offen offset:0 lds
    buffer_load_dwordx4 v17, s[12:15], s44 offen offset:1024 lds
    s_add_u32 m0, s41, 12288
    s_xor_b32 s44, s62, 393216
    buffer_load_dwordx4 v16, s[12:15], s44 offen offset:0 lds
    buffer_load_dwordx4 v17, s[12:15], s44 offen offset:1024 lds
    s_add_u32 m0, s41, 16384
    s_xor_b32 s44, s62, 524288
    buffer_load_dwordx4 v16, s[12:15], s44 offen offset:0 lds
    buffer_load_dwordx4 v17, s[12:15], s44 offen offset:1024 lds
    s_add_u32 m0, s41, 20480
    s_xor_b32 s44, s62, 655360
    buffer_load_dwordx4 v16, s[12:15], s44 offen offset:0 lds
    buffer_load_dwordx4 v17, s[12:15], s44 offen offset:1024 lds
    s_add_u32 m0, s41, 24576
    s_xor_b32 s44, s62, 786432
    buffer_load_dwordx4 v16, s[12:15], s44 offen offset:0 lds
    buffer_load_dwordx4 v17, s[12:15], s44 offen offset:1024 lds
    s_add_u32 m0, s41, 28672
    s_xor_b32 s44, s62, 917504
    buffer_load_dwordx4 v16, s[12:15], s44 offen offset:0 lds
    buffer_load_dwordx4 v17, s[12:15], s44 offen offset:1024 lds
    s_add_u32 m0, s41, 32768
    s_xor_b32 s44, s62, 1048576
    buffer_load_dwordx4 v16, s[12:15], s44 offen offset:0 lds
    buffer_load_dwordx4 v17, s[12:15], s44 offen offset:1024 lds
    s_add_u32 m0, s41, 36864
    s_xor_b32 s44, s62, 1179648
    buffer_load_dwordx4 v16, s[12:15], s44 offen offset:0 lds
    buffer_load_dwordx4 v17, s[12:15], s44 offen offset:1024 lds
    s_add_u32 m0, s41, 40960
    s_xor_b32 s44, s62, 1310720
    buffer_load_dwordx4 v16, s[12:15], s44 offen offset:0 lds
    buffer_load_dwordx4 v17, s[12:15], s44 offen offset:1024 lds
    s_add_u32 m0, s41, 45056
    s_xor_b32 s44, s62, 1441792
    buffer_load_dwordx4 v16, s[12:15], s44 offen offset:0 lds
    buffer_load_dwordx4 v17, s[12:15], s44 offen offset:1024 lds
    s_add_u32 m0, s41, 49152
    s_xor_b32 s44, s62, 1572864
    buffer_load_dwordx4 v16, s[12:15], s44 offen offset:0 lds
    buffer_load_dwordx4 v17, s[12:15], s44 offen offset:1024 lds
    s_add_u32 m0, s41, 53248
    s_xor_b32 s44, s62, 1703936
    buffer_load_dwordx4 v16, s[12:15], s44 offen offset:0 lds
    buffer_load_dwordx4 v17, s[12:15], s44 offen offset:1024 lds
    s_add_u32 m0, s41, 57344
    s_xor_b32 s44, s62, 1835008
    buffer_load_dwordx4 v16, s[12:15], s44 offen offset:0 lds
    buffer_load_dwordx4 v17, s[12:15], s44 offen offset:1024 lds
    s_add_u32 m0, s41, 61440
    s_xor_b32 s44, s62, 1966080
    buffer_load_dwordx4 v16, s[12:15], s44 offen offset:0 lds
    buffer_load_dwordx4 v17, s[12:15], s44 offen offset:1024 lds
    s_branch s_tail
z_start:
    v_lshrrev_b32 v24, 4, v1
    v_lshrrev_b32 v25, 3, v24
    v_mul_u32_u24 v20, 6144, v25
    v_and_b32 v25, 7, v24
    v_lshl_add_u32 v20, v25, 4, v20
    s_add_u32 s3, s18, 2
    s_and_b32 s3, s3, 15
    s_lshl_b32 s3, s3, 7
    s_add_u32 s3, s3, 4096
    v_add_u32 v22, s3, v20
    s_add_u32 s3, s18, 1
    s_and_b32 s3, s3, 15
    s_lshl_b32 s3, s3, 7
    s_add_u32 s3, s3, 2048
    v_add_u32 v21, s3, v20
    s_add_u32 s3, s18, 0
    s_and_b32 s3, s3, 15
    s_lshl_b32 s3, s3, 7
    s_add_u32 s3, s3, 0
    v_add_u32 v20, s3, v20
    s_waitcnt lgkmcnt(0)
    s_mov_b32 s8, s24
    s_mov_b32 s9, s25
    s_mov_b32 s10, 6291456
    s_mov_b32 s11, 0x00020000
    s_mul_i32 s44, s17, 393216
    buffer_load_dwordx4 v[32:35], v20, s[8:11], s44 offen
    buffer_load_dwordx4 v[64:67], v21, s[8:11], s44 offen
    buffer_load_dwordx4 v[96:99], v22, s[8:11], s44 offen
    s_add_u32 s44, s44, 49152
    buffer_load_dwordx4 v[36:39], v20, s[8:11], s44 offen
    buffer_load_dwordx4 v[68:71], v21, s[8:11], s44 offen
    buffer_load_dwordx4 v[100:103], v22, s[8:11], s44 offen
    s_add_u32 s44, s44, 49152
    buffer_load_dwordx4 v[40:43], v20, s[8:11], s44 offen
    buffer_load_dwordx4 v[72:75], v21, s[8:11], s44 offen
    buffer_load_dwordx4 v[104:107], v22, s[8:11], s44 offen
    s_add_u32 s44, s44, 49152
    buffer_load_dwordx4 v[44:47], v20, s[8:11], s44 offen
    buffer_load_dwordx4 v[76:79], v21, s[8:11], s44 offen
    buffer_load_dwordx4 v[108:111], v22, s[8:11], s44 offen
    s_add_u32 s44, s44, 49152
    buffer_load_dwordx4 v[48:51], v20, s[8:11], s44 offen
    buffer_load_dwordx4 v[80:83], v21, s[8:11], s44 offen
    buffer_load_dwordx4 v[112:115], v22, s[8:11], s44 offen
    s_add_u32 s44, s44, 49152
    buffer_load_dwordx4 v[52:55], v20, s[8:11], s44 offen
    buffer_load_dwordx4 v[84:87], v21, s[8:11], s44 offen
    buffer_load_dwordx4 v[116:119], v22, s[8:11], s44 offen
    s_add_u32 s44, s44, 49152
    buffer_load_dwordx4 v[56:59], v20, s[8:11], s44 offen
    buffer_load_dwordx4 v[88:91], v21, s[8:11], s44 offen
    buffer_load_dwordx4 v[120:123], v22, s[8:11], s44 offen
    s_add_u32 s44, s44, 49152
    buffer_load_dwordx4 v[60:63], v20, s[8:11], s44 offen
    buffer_load_dwordx4 v[92:95], v21, s[8:11], s44 offen
    buffer_load_dwordx4 v[124:127], v22, s[8:11], s44 offen
    v_lshrrev_b32 v24, 4, v1
    v_lshrrev_b32 v25, 3, v24
    v_mul_u32_u24 v12, 6144, v25
    v_and_b32 v26, 2, v25
    v_lshrrev_b32 v25, 2, v25
    v_or_b32 v26, v26, v25
    v_bfe_u32 v25, v24, 1, 2
    v_xor_b32 v26, v26, v25
    v_lshl_add_u32 v12, v26, 5, v12
    v_and_b32 v26, 1, v24
    v_lshl_add_u32 v12, v26, 4, v12
    s_lshl_b32 s3, s18, 7
    v_add_u32 v12, s3, v12
    v_add_u32 v13, 48128, v12
    v_add_u32 v14, 96256, v12
    v_add_u32 v15, 144384, v12
    v_lshrrev_b32 v24, 4, v1
    v_lshrrev_b32 v25, 3, v24
    v_mul_u32_u24 v16, 2048, v25
    v_and_b32 v26, 2, v25
    v_lshrrev_b32 v25, 2, v25
    v_or_b32 v26, v26, v25
    v_bfe_u32 v25, v24, 1, 2
    v_xor_b32 v26, v26, v25
    v_lshl_add_u32 v16, v26, 5, v16
    v_and_b32 v26, 1, v24
    v_lshl_add_u32 v16, v26, 4, v16
    s_lshl_b32 s3, s20, 7
    v_add_u32 v16, s3, v16
    v_add_u32 v17, 15360, v16
    v_add_u32 v18, 30720, v16
    v_add_u32 v19, 46080, v16
    s_mul_i32 s84, s18, 393216
    s_cmp_eq_u32 s18, 1
    s_cselect_b32 s85, 0, 393216
    s_cmp_eq_u32 s18, 2
    s_cselect_b32 s86, 0, 786432
    s_cmp_eq_u32 s18, 3
    s_cselect_b32 s87, 0, 1179648
    s_cmp_eq_u32 s18, 4
    s_cselect_b32 s88, 0, 1572864
    s_cmp_eq_u32 s18, 5
    s_cselect_b32 s89, 0, 1966080
    s_cmp_eq_u32 s18, 6
    s_cselect_b32 s90, 0, 2359296
    s_cmp_eq_u32 s18, 7
    s_cselect_b32 s91, 0, 2752512
    s_cmp_eq_u32 s18, 8
    s_cselect_b32 s92, 0, 3145728
    s_cmp_eq_u32 s18, 9
    s_cselect_b32 s93, 0, 3538944
    s_cmp_eq_u32 s18, 10
    s_cselect_b32 s94, 0, 3932160
    s_cmp_eq_u32 s18, 11
    s_cselect_b32 s95, 0, 4325376
    s_cmp_eq_u32 s18, 12
    s_cselect_b32 s96, 0, 4718592
    s_cmp_eq_u32 s18, 13
    s_cselect_b32 s97, 0, 5111808
    s_cmp_eq_u32 s18, 14
    s_cselect_b32 s98, 0, 5505024
    s_cmp_eq_u32 s18, 15
    s_cselect_b32 s99, 0, 5898240
    s_and_b32 s3, s16, 3
    s_mul_i32 s3, s3, 49152
    v_add_u32 v11, s3, v12
    s_and_b32 s3, s16, 3
    s_lshl_b32 s3, s3, 10
    v_add_u32 v9, s3, v1
    v_add_u32 v10, 0x10000, v9
    s_barrier
    s_setprio 3
    v_lshrrev_b32 v28, 4, v1
    v_and_b32 v29, 7, v28
    v_lshrrev_b32 v28, 3, v28
    v_mul_u32_u24 v28, 6144, v28
    v_lshl_add_u32 v28, v29, 4, v28
    s_and_b32 s3, s18, 12
    s_or_b32 s3, s3, 3
    s_lshl_b32 s3, s3, 7
    v_add_u32 v28, s3, v28
    s_lshr_b32 s3, s2, 3
    s_lshl_b32 s3, s3, 2
    s_and_b32 s60, s16, 3
    s_add_u32 s60, s60, s3
    s_lshr_b32 s60, s60, 2
    s_mul_i32 s60, s60, 49152
    s_and_b32 s3, s18, 0
    s_xor_b32 s3, s3, 0
    s_mul_i32 s3, s3, 393216
    s_add_u32 s3, s3, s60
    s_add_u32 s61, s3, 0
    buffer_load_dwordx4 v[160:163], v28, s[8:11], s61 offen
    s_add_u32 s61, s3, 2048
    buffer_load_dwordx4 v[164:167], v28, s[8:11], s61 offen
    s_add_u32 s61, s3, 4096
    buffer_load_dwordx4 v[168:171], v28, s[8:11], s61 offen
    s_setprio 0
    s_waitcnt vmcnt(3)
    v_lshrrev_b32 v24, 4, v1
    v_and_b32 v25, 1, v24
    v_lshlrev_b32 v25, 4, v25
    v_mov_b32 v26, 0x3f80
    v_lshlrev_b32 v25, v25, v26
    v_bfe_u32 v26, v24, 1, 2
    v_cmp_eq_u32 vcc, 0, v26
    s_nop 1
    v_cndmask_b32 v140, 0, v25, vcc
    v_cmp_eq_u32 vcc, 1, v26
    s_nop 1
    v_cndmask_b32 v141, 0, v25, vcc
    v_cmp_eq_u32 vcc, 2, v26
    s_nop 1
    v_cndmask_b32 v142, 0, v25, vcc
    v_cmp_eq_u32 vcc, 3, v26
    s_nop 1
    v_cndmask_b32 v143, 0, v25, vcc
    s_nop 1
    v_mfma_f32_16x16x32_bf16 v[128:131], v[140:143], v[32:35], 0
    v_mfma_f32_16x16x32_bf16 v[132:135], v[140:143], v[64:67], 0
    v_mfma_f32_16x16x32_bf16 v[136:139], v[140:143], v[96:99], 0
    v_mfma_f32_16x16x32_bf16 v[128:131], v[140:143], v[36:39], v[128:131]
    v_mfma_f32_16x16x32_bf16 v[132:135], v[140:143], v[68:71], v[132:135]
    v_mfma_f32_16x16x32_bf16 v[136:139], v[140:143], v[100:103], v[136:139]
    v_mfma_f32_16x16x32_bf16 v[128:131], v[140:143], v[40:43], v[128:131]
    v_mfma_f32_16x16x32_bf16 v[132:135], v[140:143], v[72:75], v[132:135]
    v_mfma_f32_16x16x32_bf16 v[136:139], v[140:143], v[104:107], v[136:139]
    v_mfma_f32_16x16x32_bf16 v[128:131], v[140:143], v[44:47], v[128:131]
    v_mfma_f32_16x16x32_bf16 v[132:135], v[140:143], v[76:79], v[132:135]
    v_mfma_f32_16x16x32_bf16 v[136:139], v[140:143], v[108:111], v[136:139]
    v_mfma_f32_16x16x32_bf16 v[128:131], v[140:143], v[48:51], v[128:131]
    v_mfma_f32_16x16x32_bf16 v[132:135], v[140:143], v[80:83], v[132:135]
    v_mfma_f32_16x16x32_bf16 v[136:139], v[140:143], v[112:115], v[136:139]
    v_mfma_f32_16x16x32_bf16 v[128:131], v[140:143], v[52:55], v[128:131]
    v_mfma_f32_16x16x32_bf16 v[132:135], v[140:143], v[84:87], v[132:135]
    v_mfma_f32_16x16x32_bf16 v[136:139], v[140:143], v[116:119], v[136:139]
    v_mfma_f32_16x16x32_bf16 v[128:131], v[140:143], v[56:59], v[128:131]
    v_mfma_f32_16x16x32_bf16 v[132:135], v[140:143], v[88:91], v[132:135]
    v_mfma_f32_16x16x32_bf16 v[136:139], v[140:143], v[120:123], v[136:139]
    v_mfma_f32_16x16x32_bf16 v[128:131], v[140:143], v[60:63], v[128:131]
    v_mfma_f32_16x16x32_bf16 v[132:135], v[140:143], v[92:95], v[132:135]
    v_mfma_f32_16x16x32_bf16 v[136:139], v[140:143], v[124:127], v[136:139]
    v_bfe_u32 v25, v24, 3, 1
    v_lshrrev_b32 v26, 5, v24
    v_lshl_add_u32 v26, v26, 1, v25
    v_lshlrev_b32 v25, 8, v26
    v_and_b32 v27, 7, v24
    v_lshl_add_u32 v25, v27, 5, v25
    v_bfe_u32 v27, v24, 4, 1
    v_lshl_add_u32 v25, v27, 4, v25
    v_add_f32_dpp v128, v128, v128 row_ror:8 row_mask:0xf bank_mask:0xf
    v_add_f32_dpp v129, v129, v129 row_ror:8 row_mask:0xf bank_mask:0xf
    v_add_f32_dpp v130, v130, v130 row_ror:8 row_mask:0xf bank_mask:0xf
    v_add_f32_dpp v131, v131, v131 row_ror:8 row_mask:0xf bank_mask:0xf
    v_add_f32_dpp v132, v132, v132 row_ror:8 row_mask:0xf bank_mask:0xf
    v_add_f32_dpp v133, v133, v133 row_ror:8 row_mask:0xf bank_mask:0xf
    v_add_f32_dpp v134, v134, v134 row_ror:8 row_mask:0xf bank_mask:0xf
    v_add_f32_dpp v135, v135, v135 row_ror:8 row_mask:0xf bank_mask:0xf
    v_add_f32_dpp v136, v136, v136 row_ror:8 row_mask:0xf bank_mask:0xf
    v_add_f32_dpp v137, v137, v137 row_ror:8 row_mask:0xf bank_mask:0xf
    v_add_f32_dpp v138, v138, v138 row_ror:8 row_mask:0xf bank_mask:0xf
    v_add_f32_dpp v139, v139, v139 row_ror:8 row_mask:0xf bank_mask:0xf
    v_cmp_le_u32 vcc, 1, v26
    s_nop 1
    v_cndmask_b32 v128, v128, v132, vcc
    v_cndmask_b32 v129, v129, v133, vcc
    v_cndmask_b32 v130, v130, v134, vcc
    v_cndmask_b32 v131, v131, v135, vcc
    v_cmp_le_u32 vcc, 2, v26
    s_nop 1
    v_cndmask_b32 v128, v128, v136, vcc
    v_cndmask_b32 v129, v129, v137, vcc
    v_cndmask_b32 v130, v130, v138, vcc
    v_cndmask_b32 v131, v131, v139, vcc
    v_add_u32 v27, s18, v26
    v_and_b32 v27, 15, v27
    v_lshl_add_u32 v25, v27, 14, v25
    s_lshl_b32 s44, s17, 10
    s_add_u32 s44, s44, 52428800
    buffer_store_dwordx4 v[128:131], v25, s[4:7], s44 offen sc1
    s_barrier
    v_lshrrev_b32 v28, 4, v1
    v_and_b32 v29, 7, v28
    v_lshrrev_b32 v28, 3, v28
    v_mul_u32_u24 v28, 6144, v28
    v_lshl_add_u32 v28, v29, 4, v28
    s_and_b32 s3, s18, 12
    s_or_b32 s3, s3, 3
    s_lshl_b32 s3, s3, 7
    v_add_u32 v28, s3, v28
    s_lshr_b32 s3, s2, 3
    s_lshl_b32 s3, s3, 2
    s_and_b32 s60, s16, 3
    s_add_u32 s60, s60, s3
    s_lshr_b32 s60, s60, 2
    s_mul_i32 s60, s60, 49152
    s_and_b32 s3, s18, 0
    s_xor_b32 s3, s3, 4
    s_mul_i32 s3, s3, 393216
    s_add_u32 s3, s3, s60
    s_add_u32 s61, s3, 0
    buffer_load_dwordx4 v[160:163], v28, s[8:11], s61 offen
    s_add_u32 s61, s3, 2048
    buffer_load_dwordx4 v[164:167], v28, s[8:11], s61 offen
    s_add_u32 s61, s3, 4096
    buffer_load_dwordx4 v[168:171], v28, s[8:11], s61 offen
    s_and_b32 s3, s18, 0
    s_xor_b32 s3, s3, 8
    s_mul_i32 s3, s3, 393216
    s_add_u32 s3, s3, s60
    s_add_u32 s61, s3, 0
    buffer_load_dwordx4 v[172:175], v28, s[8:11], s61 offen
    s_add_u32 s61, s3, 2048
    buffer_load_dwordx4 v[176:179], v28, s[8:11], s61 offen
    s_add_u32 s61, s3, 4096
    buffer_load_dwordx4 v[180:183], v28, s[8:11], s61 offen
    s_and_b32 s3, s18, 0
    s_xor_b32 s3, s3, 12
    s_mul_i32 s3, s3, 393216
    s_add_u32 s3, s3, s60
    s_add_u32 s61, s3, 0
    buffer_load_dwordx4 v[184:187], v28, s[8:11], s61 offen
    s_add_u32 s61, s3, 2048
    buffer_load_dwordx4 v[188:191], v28, s[8:11], s61 offen
    s_add_u32 s61, s3, 4096
    buffer_load_dwordx4 v[192:195], v28, s[8:11], s61 offen
    s_barrier
    s_barrier
    s_waitcnt vmcnt(0)
    s_add_u32 s44, s18, 0
    s_and_b32 s44, s44, 15
    s_lshl_b32 s44, s44, 7
    s_add_u32 s44, s44, 0
    s_atomic_add s40, s[22:23], s44
    s_add_u32 s45, s18, 1
    s_and_b32 s45, s45, 15
    s_lshl_b32 s45, s45, 7
    s_add_u32 s45, s45, 0
    s_atomic_add s40, s[22:23], s45
    s_add_u32 s46, s18, 2
    s_and_b32 s46, s46, 15
    s_lshl_b32 s46, s46, 7
    s_add_u32 s46, s46, 0
    s_atomic_add s40, s[22:23], s46
    s_barrier
    s_barrier
    s_barrier
    s_bfe_u32 s48, s2, 0x20003
    s_min_u32 s48, s48, 4
    s_max_u32 s48, s48, 4
    s_sub_u32 s49, 5, s48
z_n3:
    s_cmp_eq_u32 s48, 0
    s_cbranch_scc1 z_n3e
    s_barrier
    s_sub_u32 s48, s48, 1
    s_branch z_n3
z_n3e:
    s_mov_b32 s12, s26
    s_mov_b32 s13, s27
    s_mov_b32 s14, 2097152
    s_mov_b32 s15, 0x00020000
    s_lshl_b32 s44, s2, 13
    buffer_load_dwordx4 v[160:163], v1, s[12:15], s44 offen offset:0
    buffer_load_dwordx4 v[164:167], v1, s[12:15], s44 offen offset:1024
    buffer_load_dwordx4 v[168:171], v1, s[12:15], s44 offen offset:2048
    buffer_load_dwordx4 v[172:175], v1, s[12:15], s44 offen offset:3072
    s_add_u32 s44, s44, 4096
    buffer_load_dwordx4 v[176:179], v1, s[12:15], s44 offen offset:0
    buffer_load_dwordx4 v[180:183], v1, s[12:15], s44 offen offset:1024
    buffer_load_dwordx4 v[184:187], v1, s[12:15], s44 offen offset:2048
    buffer_load_dwordx4 v[188:191], v1, s[12:15], s44 offen offset:3072
    s_mov_b32 s8, s28
    s_mov_b32 s9, s29
    s_mov_b32 s10, 6291456
    s_mov_b32 s11, 0x00020000
    s_mul_i32 s44, s17, 393216
    buffer_load_dwordx4 v[32:35], v20, s[8:11], s44 offen
    buffer_load_dwordx4 v[64:67], v21, s[8:11], s44 offen
    buffer_load_dwordx4 v[96:99], v22, s[8:11], s44 offen
    s_add_u32 s44, s44, 49152
    buffer_load_dwordx4 v[36:39], v20, s[8:11], s44 offen
    buffer_load_dwordx4 v[68:71], v21, s[8:11], s44 offen
    buffer_load_dwordx4 v[100:103], v22, s[8:11], s44 offen
    s_add_u32 s44, s44, 49152
    buffer_load_dwordx4 v[40:43], v20, s[8:11], s44 offen
    buffer_load_dwordx4 v[72:75], v21, s[8:11], s44 offen
    buffer_load_dwordx4 v[104:107], v22, s[8:11], s44 offen
    s_add_u32 s44, s44, 49152
    s_barrier
    buffer_load_dwordx4 v[44:47], v20, s[8:11], s44 offen
    buffer_load_dwordx4 v[76:79], v21, s[8:11], s44 offen
    buffer_load_dwordx4 v[108:111], v22, s[8:11], s44 offen
    s_add_u32 s44, s44, 49152
    buffer_load_dwordx4 v[48:51], v20, s[8:11], s44 offen
    buffer_load_dwordx4 v[80:83], v21, s[8:11], s44 offen
    buffer_load_dwordx4 v[112:115], v22, s[8:11], s44 offen
    s_add_u32 s44, s44, 49152
    buffer_load_dwordx4 v[52:55], v20, s[8:11], s44 offen
    buffer_load_dwordx4 v[84:87], v21, s[8:11], s44 offen
    buffer_load_dwordx4 v[116:119], v22, s[8:11], s44 offen
    s_add_u32 s44, s44, 49152
    buffer_load_dwordx4 v[56:59], v20, s[8:11], s44 offen
    buffer_load_dwordx4 v[88:91], v21, s[8:11], s44 offen
    buffer_load_dwordx4 v[120:123], v22, s[8:11], s44 offen
    s_add_u32 s44, s44, 49152
    buffer_load_dwordx4 v[60:63], v20, s[8:11], s44 offen
    buffer_load_dwordx4 v[92:95], v21, s[8:11], s44 offen
    buffer_load_dwordx4 v[124:127], v22, s[8:11], s44 offen
z_n4:
    s_cmp_eq_u32 s49, 0
    s_cbranch_scc1 z_n4e
    s_barrier
    s_sub_u32 s49, s49, 1
    s_branch z_n4
z_n4e:
    s_bitcmp1_b32 s21, 0
    s_cselect_b32 s8, s28, s24
    s_cselect_b32 s9, s29, s25
    s_cselect_b32 s12, s30, s26
    s_cselect_b32 s13, s31, s27
    s_mov_b32 s10, 6291456
    s_mov_b32 s11, 0x00020000
    s_mov_b32 s14, 2097152
    s_mov_b32 s15, 0x00020000
    s_branch s_tail
z_layer:
    s_waitcnt lgkmcnt(0)
    v_lshrrev_b32 v28, 4, v1
    v_and_b32 v29, 7, v28
    v_lshrrev_b32 v28, 3, v28
    v_mul_u32_u24 v28, 6144, v28
    v_lshl_add_u32 v28, v29, 4, v28
    s_and_b32 s3, s18, 12
    s_or_b32 s3, s3, 3
    s_lshl_b32 s3, s3, 7
    v_add_u32 v28, s3, v28
    s_lshr_b32 s3, s2, 3
    s_lshl_b32 s3, s3, 2
    s_and_b32 s60, s16, 3
    s_add_u32 s60, s60, s3
    s_lshr_b32 s60, s60, 2
    s_mul_i32 s60, s60, 49152
    s_and_b32 s3, s18, 0
    s_xor_b32 s3, s3, 4
    s_mul_i32 s3, s3, 393216
    s_add_u32 s3, s3, s60
    s_add_u32 s61, s3, 0
    buffer_load_dwordx4 v[160:163], v28, s[8:11], s61 offen
    s_add_u32 s61, s3, 2048
    buffer_load_dwordx4 v[164:167], v28, s[8:11], s61 offen
    s_add_u32 s61, s3, 4096
    buffer_load_dwordx4 v[168:171], v28, s[8:11], s61 offen
    s_and_b32 s3, s18, 0
    s_xor_b32 s3, s3, 8
    s_mul_i32 s3, s3, 393216
    s_add_u32 s3, s3, s60
    s_add_u32 s61, s3, 0
    buffer_load_dwordx4 v[172:175], v28, s[8:11], s61 offen
    s_add_u32 s61, s3, 2048
    buffer_load_dwordx4 v[176:179], v28, s[8:11], s61 offen
    s_add_u32 s61, s3, 4096
    buffer_load_dwordx4 v[180:183], v28, s[8:11], s61 offen
    s_and_b32 s3, s18, 0
    s_xor_b32 s3, s3, 12
    s_mul_i32 s3, s3, 393216
    s_add_u32 s3, s3, s60
    s_add_u32 s61, s3, 0
    buffer_load_dwordx4 v[184:187], v28, s[8:11], s61 offen
    s_add_u32 s61, s3, 2048
    buffer_load_dwordx4 v[188:191], v28, s[8:11], s61 offen
    s_add_u32 s61, s3, 4096
    buffer_load_dwordx4 v[192:195], v28, s[8:11], s61 offen
    s_barrier
    s_barrier
    s_barrier
    s_barrier
    s_barrier
    s_barrier
    s_barrier
    s_barrier
    s_barrier
    s_barrier
    v_lshrrev_b32 v28, 4, v1
    v_and_b32 v29, 7, v28
    v_lshrrev_b32 v28, 3, v28
    v_mul_u32_u24 v28, 2048, v28
    v_lshl_add_u32 v28, v29, 4, v28
    s_and_b32 s3, s20, 12
    s_or_b32 s3, s3, 3
    s_lshl_b32 s3, s3, 7
    v_add_u32 v28, s3, v28
    s_lshr_b32 s3, s2, 3
    s_lshl_b32 s3, s3, 2
    s_and_b32 s60, s16, 3
    s_add_u32 s60, s60, s3
    s_lshl_b32 s61, s60, 14
    buffer_load_dwordx4 v[144:147], v28, s[12:15], s61 offen
    s_bitcmp0_b32 s21, 0
    s_cselect_b32 s56, s28, s24
    s_cselect_b32 s57, s29, s25
    s_mov_b32 s58, 6291456
    s_mov_b32 s59, 0x00020000
    v_lshrrev_b32 v28, 4, v1
    v_and_b32 v29, 7, v28
    v_lshrrev_b32 v28, 3, v28
    v_mul_u32_u24 v28, 6144, v28
    v_lshl_add_u32 v28, v29, 4, v28
    s_and_b32 s3, s18, 12
    s_or_b32 s3, s3, 3
    s_lshl_b32 s3, s3, 7
    v_add_u32 v28, s3, v28
    s_lshr_b32 s3, s2, 3
    s_lshl_b32 s3, s3, 2
    s_and_b32 s60, s16, 3
    s_add_u32 s60, s60, s3
    s_and_b32 s3, s60, 31
    s_mul_i32 s3, s3, 49152
    s_lshr_b32 s61, s60, 5
    s_min_u32 s61, s61, 2
    s_lshl_b32 s61, s61, 11
    s_add_u32 s61, s61, s3
    s_and_b32 s3, s18, 0
    s_mul_i32 s3, s3, 393216
    s_add_u32 s61, s61, s3
    buffer_load_dwordx4 v[148:151], v28, s[56:59], s61 offen
    s_cmp_lg_u32 s21, 2
    s_cbranch_scc1 z_pe
    s_bitcmp0_b32 s21, 0
    s_cselect_b32 s56, s28, s24
    s_cselect_b32 s57, s29, s25
    s_mov_b32 s58, 6291456
    s_mov_b32 s59, 0x00020000
    s_add_u32 s61, s84, 2048
    buffer_load_dwordx4 v[160:163], v11, s[56:59], s61 offen
    s_add_u32 s61, s84, 4096
    buffer_load_dwordx4 v[164:167], v11, s[56:59], s61 offen
    s_add_u32 s61, s84, 0
    buffer_load_dwordx4 v[168:171], v11, s[56:59], s61 offen
    s_add_u32 s61, s84, 198656
    buffer_load_dwordx4 v[172:175], v11, s[56:59], s61 offen
    s_add_u32 s61, s84, 200704
    buffer_load_dwordx4 v[176:179], v11, s[56:59], s61 offen
    s_add_u32 s61, s84, 196608
    buffer_load_dwordx4 v[180:183], v11, s[56:59], s61 offen
    s_add_u32 s61, s85, 2048
    buffer_load_dwordx4 v[184:187], v11, s[56:59], s61 offen
    s_add_u32 s61, s85, 4096
    buffer_load_dwordx4 v[188:191], v11, s[56:59], s61 offen
    s_add_u32 s61, s85, 0
    buffer_load_dwordx4 v[192:195], v11, s[56:59], s61 offen
    s_add_u32 s61, s85, 198656
    buffer_load_dwordx4 v[196:199], v11, s[56:59], s61 offen
z_pe:
    s_barrier
    s_branch s_tail
s_tail:
    s_bitcmp1_b32 s21, 0
    s_cbranch_scc1 s_B
    s_cmp_lg_u32 s16, 4
    s_cbranch_scc1 s_a1
    s_mov_b32 s45, 2146435072
    s_cmp_eq_u32 s17, 0
    s_cbranch_scc1 s_a0
    s_lshr_b32 s46, s21, 1
    s_lshl_b32 s44, s46, 15
    s_lshl_b32 s67, s17, 11
    s_add_u32 s44, s44, s67
    s_lshl_b32 s67, s18, 7
    s_add_u32 s44, s44, s67
    s_add_u32 s44, s44, 149504
    s_sub_u32 s45, s44, 151552
    s_lshl_b32 s45, s45, 5
    s_add_u32 s45, s45, 54525952
    s_mov_b32 s66, 0x10000
s_h_poll:
    s_mov_b32 s68, 0
    s_atomic_add s68, s[22:23], s44 offset:0 glc
    s_sub_u32 s66, s66, 1
    s_cselect_b32 s67, 1, 0
    s_waitcnt lgkmcnt(0)
    s_max_u32 s68, s68, s67
    s_cmp_lt_u32 s68, 1
    s_cbranch_scc1 s_h_poll
s_h_ok:
s_a0:
    s_mov_b32 m0, 131072
    s_nop 0
    buffer_load_dwordx4 v1, s[4:7], s45 offen offset:0 sc1 lds
    buffer_load_dwordx4 v1, s[4:7], s45 offen offset:1024 sc1 lds
    buffer_load_dwordx4 v1, s[4:7], s45 offen offset:2048 sc1 lds
    buffer_load_dwordx4 v1, s[4:7], s45 offen offset:3072 sc1 lds
    s_waitcnt vmcnt(0)
s_a1:
    s_barrier
    s_waitcnt vmcnt(0)
    s_barrier
    s_sub_u32 s3, s16, 5
    s_cmp_gt_u32 s3, 1
    s_cbranch_scc1 s_a2
    s_add_u32 m0, s41, 65536
    s_xor_b32 s44, s62, 65536
    buffer_load_dwordx4 v16, s[12:15], s44 offen offset:0 lds
    buffer_load_dwordx4 v17, s[12:15], s44 offen offset:1024 lds
    s_add_u32 m0, s41, 69632
    s_xor_b32 s44, s62, 196608
    buffer_load_dwordx4 v16, s[12:15], s44 offen offset:0 lds
    buffer_load_dwordx4 v17, s[12:15], s44 offen offset:1024 lds
    s_add_u32 m0, s41, 73728
    s_xor_b32 s44, s62, 327680
    buffer_load_dwordx4 v16, s[12:15], s44 offen offset:0 lds
    buffer_load_dwordx4 v17, s[12:15], s44 offen offset:1024 lds
    s_add_u32 m0, s41, 77824
    s_xor_b32 s44, s62, 458752
    buffer_load_dwordx4 v16, s[12:15], s44 offen offset:0 lds
    buffer_load_dwordx4 v17, s[12:15], s44 offen offset:1024 lds
    s_add_u32 m0, s41, 81920
    s_xor_b32 s44, s62, 589824
    buffer_load_dwordx4 v16, s[12:15], s44 offen offset:0 lds
    buffer_load_dwordx4 v17, s[12:15], s44 offen offset:1024 lds
    s_add_u32 m0, s41, 86016
    s_xor_b32 s44, s62, 720896
    buffer_load_dwordx4 v16, s[12:15], s44 offen offset:0 lds
    buffer_load_dwordx4 v17, s[12:15], s44 offen offset:1024 lds
    s_add_u32 m0, s41, 90112
    s_xor_b32 s44, s62, 851968
    buffer_load_dwordx4 v16, s[12:15], s44 offen offset:0 lds
    buffer_load_dwordx4 v17, s[12:15], s44 offen offset:1024 lds
    s_add_u32 m0, s41, 94208
    s_xor_b32 s44, s62, 983040
    buffer_load_dwordx4 v16, s[12:15], s44 offen offset:0 lds
    buffer_load_dwordx4 v17, s[12:15], s44 offen offset:1024 lds
    s_add_u32 m0, s41, 98304
    s_xor_b32 s44, s62, 1114112
    buffer_load_dwordx4 v16, s[12:15], s44 offen offset:0 lds
    buffer_load_dwordx4 v17, s[12:15], s44 offen offset:1024 lds
    s_add_u32 m0, s41, 102400
    s_xor_b32 s44, s62, 1245184
    buffer_load_dwordx4 v16, s[12:15], s44 offen offset:0 lds
    buffer_load_dwordx4 v17, s[12:15], s44 offen offset:1024 lds
    s_add_u32 m0, s41, 106496
    s_xor_b32 s44, s62, 1376256
    buffer_load_dwordx4 v16, s[12:15], s44 offen offset:0 lds
    buffer_load_dwordx4 v17, s[12:15], s44 offen offset:1024 lds
    s_add_u32 m0, s41, 110592
    s_xor_b32 s44, s62, 1507328
    buffer_load_dwordx4 v16, s[12:15], s44 offen offset:0 lds
    buffer_load_dwordx4 v17, s[12:15], s44 offen offset:1024 lds
    s_add_u32 m0, s41, 114688
    s_xor_b32 s44, s62, 1638400
    buffer_load_dwordx4 v16, s[12:15], s44 offen offset:0 lds
    buffer_load_dwordx4 v17, s[12:15], s44 offen offset:1024 lds
    s_add_u32 m0, s41, 118784
    s_xor_b32 s44, s62, 1769472
    buffer_load_dwordx4 v16, s[12:15], s44 offen offset:0 lds
    buffer_load_dwordx4 v17, s[12:15], s44 offen offset:1024 lds
    s_add_u32 m0, s41, 122880
    s_xor_b32 s44, s62, 1900544
    buffer_load_dwordx4 v16, s[12:15], s44 offen offset:0 lds
    buffer_load_dwordx4 v17, s[12:15], s44 offen offset:1024 lds
    s_add_u32 m0, s41, 126976
    s_xor_b32 s44, s62, 2031616
    buffer_load_dwordx4 v16, s[12:15], s44 offen offset:0 lds
    buffer_load_dwordx4 v17, s[12:15], s44 offen offset:1024 lds
s_a2:
    s_cmp_eq_u32 s21, 2
    s_cbranch_scc1 s_a3
    s_bitcmp0_b32 s21, 0
    s_cselect_b32 s56, s28, s24
    s_cselect_b32 s57, s29, s25
    s_mov_b32 s58, 6291456
    s_mov_b32 s59, 0x00020000
    s_add_u32 s61, s84, 2048
    buffer_load_dwordx4 v[160:163], v11, s[56:59], s61 offen
    s_add_u32 s61, s84, 4096
    buffer_load_dwordx4 v[164:167], v11, s[56:59], s61 offen
    s_add_u32 s61, s84, 0
    buffer_load_dwordx4 v[168:171], v11, s[56:59], s61 offen
    s_add_u32 s61, s84, 198656
    buffer_load_dwordx4 v[172:175], v11, s[56:59], s61 offen
    s_add_u32 s61, s84, 200704
    buffer_load_dwordx4 v[176:179], v11, s[56:59], s61 offen
    s_add_u32 s61, s84, 196608
    buffer_load_dwordx4 v[180:183], v11, s[56:59], s61 offen
    s_add_u32 s61, s85, 2048
    buffer_load_dwordx4 v[184:187], v11, s[56:59], s61 offen
    s_add_u32 s61, s85, 4096
    buffer_load_dwordx4 v[188:191], v11, s[56:59], s61 offen
    s_add_u32 s61, s85, 0
    buffer_load_dwordx4 v[192:195], v11, s[56:59], s61 offen
    s_add_u32 s61, s85, 198656
    buffer_load_dwordx4 v[196:199], v11, s[56:59], s61 offen
s_a3:
    s_bitcmp0_b32 s21, 0
    s_cselect_b32 s56, s28, s24
    s_cselect_b32 s57, s29, s25
    s_mov_b32 s58, 6291456
    s_mov_b32 s59, 0x00020000
    s_add_u32 s61, s85, 200704
    buffer_load_dwordx4 v[200:203], v11, s[56:59], s61 offen
    s_add_u32 s61, s85, 196608
    buffer_load_dwordx4 v[204:207], v11, s[56:59], s61 offen
    s_add_u32 s61, s86, 2048
    buffer_load_dwordx4 v[208:211], v11, s[56:59], s61 offen
    s_add_u32 s61, s86, 4096
    buffer_load_dwordx4 v[212:215], v11, s[56:59], s61 offen
    s_add_u32 s61, s86, 0
    buffer_load_dwordx4 v[216:219], v11, s[56:59], s61 offen
    s_add_u32 s61, s86, 198656
    buffer_load_dwordx4 v[220:223], v11, s[56:59], s61 offen
    s_add_u32 s61, s86, 200704
    buffer_load_dwordx4 v[224:227], v11, s[56:59], s61 offen
    s_add_u32 s61, s86, 196608
    buffer_load_dwordx4 v[228:231], v11, s[56:59], s61 offen
    s_add_u32 s61, s87, 2048
    buffer_load_dwordx4 v[232:235], v11, s[56:59], s61 offen
    s_add_u32 s61, s87, 4096
    buffer_load_dwordx4 v[236:239], v11, s[56:59], s61 offen
    s_add_u32 s61, s87, 0
    buffer_load_dwordx4 v[240:243], v11, s[56:59], s61 offen
    s_add_u32 s61, s87, 198656
    buffer_load_dwordx4 v[244:247], v11, s[56:59], s61 offen
    s_add_u32 s61, s87, 200704
    buffer_load_dwordx4 v[248:251], v11, s[56:59], s61 offen
    s_add_u32 s61, s87, 196608
    buffer_load_dwordx4 v[252:255], v11, s[56:59], s61 offen
    s_waitcnt vmcnt(0)
    s_lshl_b32 s3, s21, 3
    s_add_u32 s3, s3, s16
    s_cmp_lg_u32 s3, 7
    s_cbranch_scc1 s_g3
    v_lshrrev_b32 v24, 4, v1
    v_and_b32 v25, 1, v24
    v_lshlrev_b32 v25, 4, v25
    v_mov_b32 v26, 0x3f80
    v_lshlrev_b32 v25, v25, v26
    v_bfe_u32 v26, v24, 1, 2
    v_cmp_eq_u32 vcc, 0, v26
    s_nop 1
    v_cndmask_b32 v140, 0, v25, vcc
    v_cmp_eq_u32 vcc, 1, v26
    s_nop 1
    v_cndmask_b32 v141, 0, v25, vcc
    v_cmp_eq_u32 vcc, 2, v26
    s_nop 1
    v_cndmask_b32 v142, 0, v25, vcc
    v_cmp_eq_u32 vcc, 3, v26
    s_nop 1
    v_cndmask_b32 v143, 0, v25, vcc
    s_nop 1
    v_mfma_f32_16x16x32_bf16 v[128:131], v[140:143], v[32:35], 0
    v_mfma_f32_16x16x32_bf16 v[132:135], v[140:143], v[64:67], 0
    v_mfma_f32_16x16x32_bf16 v[136:139], v[140:143], v[96:99], 0
    v_mfma_f32_16x16x32_bf16 v[128:131], v[140:143], v[36:39], v[128:131]
    v_mfma_f32_16x16x32_bf16 v[132:135], v[140:143], v[68:71], v[132:135]
    v_mfma_f32_16x16x32_bf16 v[136:139], v[140:143], v[100:103], v[136:139]
    v_mfma_f32_16x16x32_bf16 v[128:131], v[140:143], v[40:43], v[128:131]
    v_mfma_f32_16x16x32_bf16 v[132:135], v[140:143], v[72:75], v[132:135]
    v_mfma_f32_16x16x32_bf16 v[136:139], v[140:143], v[104:107], v[136:139]
    v_mfma_f32_16x16x32_bf16 v[128:131], v[140:143], v[44:47], v[128:131]
    v_mfma_f32_16x16x32_bf16 v[132:135], v[140:143], v[76:79], v[132:135]
    v_mfma_f32_16x16x32_bf16 v[136:139], v[140:143], v[108:111], v[136:139]
    v_mfma_f32_16x16x32_bf16 v[128:131], v[140:143], v[48:51], v[128:131]
    v_mfma_f32_16x16x32_bf16 v[132:135], v[140:143], v[80:83], v[132:135]
    v_mfma_f32_16x16x32_bf16 v[136:139], v[140:143], v[112:115], v[136:139]
    v_mfma_f32_16x16x32_bf16 v[128:131], v[140:143], v[52:55], v[128:131]
    v_mfma_f32_16x16x32_bf16 v[132:135], v[140:143], v[84:87], v[132:135]
    v_mfma_f32_16x16x32_bf16 v[136:139], v[140:143], v[116:119], v[136:139]
    v_mfma_f32_16x16x32_bf16 v[128:131], v[140:143], v[56:59], v[128:131]
    v_mfma_f32_16x16x32_bf16 v[132:135], v[140:143], v[88:91], v[132:135]
    v_mfma_f32_16x16x32_bf16 v[136:139], v[140:143], v[120:123], v[136:139]
    v_mfma_f32_16x16x32_bf16 v[128:131], v[140:143], v[60:63], v[128:131]
    v_mfma_f32_16x16x32_bf16 v[132:135], v[140:143], v[92:95], v[132:135]
    v_mfma_f32_16x16x32_bf16 v[136:139], v[140:143], v[124:127], v[136:139]
    v_bfe_u32 v25, v24, 3, 1
    v_lshrrev_b32 v26, 5, v24
    v_lshl_add_u32 v26, v26, 1, v25
    v_lshlrev_b32 v25, 8, v26
    v_and_b32 v27, 7, v24
    v_lshl_add_u32 v25, v27, 5, v25
    v_bfe_u32 v27, v24, 4, 1
    v_lshl_add_u32 v25, v27, 4, v25
    v_add_f32_dpp v128, v128, v128 row_ror:8 row_mask:0xf bank_mask:0xf
    v_add_f32_dpp v129, v129, v129 row_ror:8 row_mask:0xf bank_mask:0xf
    v_add_f32_dpp v130, v130, v130 row_ror:8 row_mask:0xf bank_mask:0xf
    v_add_f32_dpp v131, v131, v131 row_ror:8 row_mask:0xf bank_mask:0xf
    v_add_f32_dpp v132, v132, v132 row_ror:8 row_mask:0xf bank_mask:0xf
    v_add_f32_dpp v133, v133, v133 row_ror:8 row_mask:0xf bank_mask:0xf
    v_add_f32_dpp v134, v134, v134 row_ror:8 row_mask:0xf bank_mask:0xf
    v_add_f32_dpp v135, v135, v135 row_ror:8 row_mask:0xf bank_mask:0xf
    v_add_f32_dpp v136, v136, v136 row_ror:8 row_mask:0xf bank_mask:0xf
    v_add_f32_dpp v137, v137, v137 row_ror:8 row_mask:0xf bank_mask:0xf
    v_add_f32_dpp v138, v138, v138 row_ror:8 row_mask:0xf bank_mask:0xf
    v_add_f32_dpp v139, v139, v139 row_ror:8 row_mask:0xf bank_mask:0xf
    v_cmp_le_u32 vcc, 1, v26
    s_nop 1
    v_cndmask_b32 v128, v128, v132, vcc
    v_cndmask_b32 v129, v129, v133, vcc
    v_cndmask_b32 v130, v130, v134, vcc
    v_cndmask_b32 v131, v131, v135, vcc
    v_cmp_le_u32 vcc, 2, v26
    s_nop 1
    v_cndmask_b32 v128, v128, v136, vcc
    v_cndmask_b32 v129, v129, v137, vcc
    v_cndmask_b32 v130, v130, v138, vcc
    v_cndmask_b32 v131, v131, v139, vcc
    v_add_u32 v27, s18, v26
    v_and_b32 v27, 15, v27
    v_lshl_add_u32 v25, v27, 14, v25
    s_lshl_b32 s44, s17, 10
    s_add_u32 s44, s44, 52690944
    buffer_store_dwordx4 v[128:131], v25, s[4:7], s44 offen sc1
    s_waitcnt vmcnt(0)
    s_add_u32 s44, s18, 0
    s_and_b32 s44, s44, 15
    s_lshl_b32 s44, s44, 7
    s_add_u32 s44, s44, 2048
    s_atomic_add s40, s[22:23], s44
    s_add_u32 s45, s18, 1
    s_and_b32 s45, s45, 15
    s_lshl_b32 s45, s45, 7
    s_add_u32 s45, s45, 2048
    s_atomic_add s40, s[22:23], s45
    s_add_u32 s46, s18, 2
    s_and_b32 s46, s46, 15
    s_lshl_b32 s46, s46, 7
    s_add_u32 s46, s46, 2048
    s_atomic_add s40, s[22:23], s46
    s_branch s_g3
s_B:
    s_barrier
    s_cmp_eq_u32 s21, 3
    s_cbranch_scc1 s_nopf
    s_bitcmp0_b32 s21, 0
    s_cselect_b32 s56, s28, s24
    s_cselect_b32 s57, s29, s25
    s_mov_b32 s58, 6291456
    s_mov_b32 s59, 0x00020000
    s_add_u32 s61, s84, 2048
    buffer_load_dwordx4 v[160:163], v11, s[56:59], s61 offen
    s_add_u32 s61, s84, 4096
    buffer_load_dwordx4 v[164:167], v11, s[56:59], s61 offen
    s_add_u32 s61, s84, 0
    buffer_load_dwordx4 v[168:171], v11, s[56:59], s61 offen
    s_add_u32 s61, s84, 198656
    buffer_load_dwordx4 v[172:175], v11, s[56:59], s61 offen
    s_waitcnt vmcnt(2)
    s_add_u32 s61, s84, 200704
    buffer_load_dwordx4 v[176:179], v11, s[56:59], s61 offen
    s_add_u32 s61, s84, 196608
    buffer_load_dwordx4 v[180:183], v11, s[56:59], s61 offen
    s_add_u32 s61, s85, 2048
    buffer_load_dwordx4 v[184:187], v11, s[56:59], s61 offen
    s_add_u32 s61, s85, 4096
    buffer_load_dwordx4 v[188:191], v11, s[56:59], s61 offen
    s_waitcnt vmcnt(2)
    s_add_u32 s61, s85, 0
    buffer_load_dwordx4 v[192:195], v11, s[56:59], s61 offen
    s_add_u32 s61, s85, 198656
    buffer_load_dwordx4 v[196:199], v11, s[56:59], s61 offen
    s_add_u32 s61, s85, 200704
    buffer_load_dwordx4 v[200:203], v11, s[56:59], s61 offen
    s_add_u32 s61, s85, 196608
    buffer_load_dwordx4 v[204:207], v11, s[56:59], s61 offen
    s_waitcnt vmcnt(2)
    s_add_u32 s61, s86, 2048
    buffer_load_dwordx4 v[208:211], v11, s[56:59], s61 offen
    s_add_u32 s61, s86, 4096
    buffer_load_dwordx4 v[212:215], v11, s[56:59], s61 offen
    s_add_u32 s61, s86, 0
    buffer_load_dwordx4 v[216:219], v11, s[56:59], s61 offen
    s_add_u32 s61, s86, 198656
    buffer_load_dwordx4 v[220:223], v11, s[56:59], s61 offen
    s_waitcnt vmcnt(2)
    s_add_u32 s61, s86, 200704
    buffer_load_dwordx4 v[224:227], v11, s[56:59], s61 offen
    s_add_u32 s61, s86, 196608
    buffer_load_dwordx4 v[228:231], v11, s[56:59], s61 offen
    s_add_u32 s61, s87, 2048
    buffer_load_dwordx4 v[232:235], v11, s[56:59], s61 offen
    s_add_u32 s61, s87, 4096
    buffer_load_dwordx4 v[236:239], v11, s[56:59], s61 offen
    s_waitcnt vmcnt(2)
    s_add_u32 s61, s87, 0
    buffer_load_dwordx4 v[240:243], v11, s[56:59], s61 offen
    s_add_u32 s61, s87, 198656
    buffer_load_dwordx4 v[244:247], v11, s[56:59], s61 offen
    s_add_u32 s61, s87, 200704
    buffer_load_dwordx4 v[248:251], v11, s[56:59], s61 offen
    s_add_u32 s61, s87, 196608
    buffer_load_dwordx4 v[252:255], v11, s[56:59], s61 offen
    s_waitcnt vmcnt(2)
    s_lshl_b32 s3, s2, 2
    s_and_b32 s60, s16, 3
    s_add_u32 s60, s60, s3
    s_lshl_b32 s60, s60, 11
    buffer_load_dwordx4 v[96:99], v1, s[12:15], s60 offen offset:0
    buffer_load_dwordx4 v[100:103], v1, s[12:15], s60 offen offset:1024
s_nopf:
    s_setprio 3
    s_mov_b32 s52, 0
    s_lshl_b32 s44, s16, 14
    v_add_u32 v24, s44, v1
    s_and_b32 s3, s16, 3
    s_lshl_b32 s44, s3, 10
    s_add_u32 s44, s44, 147456
    v_lshrrev_b32 v25, 2, v1
    v_add_u32 v25, s44, v25
    s_lshl_b32 s53, s21, 22
    s_lshl_b32 s44, s38, 16
    s_add_u32 s53, s53, s44
    s_lshl_b32 s44, s18, 12
    s_add_u32 s53, s53, s44
    s_add_u32 s53, s53, 16777216
    s_lshl_b32 s54, s21, 14
    s_lshl_b32 s67, s38, 8
    s_add_u32 s54, s54, s67
    s_add_u32 s54, s54, 86016
s_bhead:
    s_barrier
    s_waitcnt vmcnt(0) lgkmcnt(0)
    s_barrier
    ds_read_b32 v28, v25 offset:0
    ds_read_b32 v29, v25 offset:256
    ds_read_b32 v30, v25 offset:512
    ds_read_b32 v31, v25 offset:768
    ds_read_b128 v[32:35], v24 offset:0
    ds_read_b128 v[36:39], v24 offset:1024
    ds_read_b128 v[40:43], v24 offset:2048
    ds_read_b128 v[44:47], v24 offset:3072
    ds_read_b128 v[48:51], v24 offset:4096
    ds_read_b128 v[52:55], v24 offset:5120
    ds_read_b128 v[56:59], v24 offset:6144
    ds_read_b128 v[60:63], v24 offset:7168
    ds_read_b128 v[64:67], v24 offset:8192
    ds_read_b128 v[68:71], v24 offset:9216
    ds_read_b128 v[72:75], v24 offset:10240
    ds_read_b128 v[76:79], v24 offset:11264
    ds_read_b128 v[80:83], v24 offset:12288
    ds_read_b128 v[84:87], v24 offset:13312
    ds_read_b128 v[88:91], v24 offset:14336
    ds_read_b128 v[92:95], v24 offset:15360
    s_waitcnt lgkmcnt(14)
    v_add_f32 v28, v28, v29
    v_add_f32 v30, v30, v31
    v_add_f32 v28, v28, v30
    v_mov_b32 v29, 0x5d800000
    v_mov_b32 v30, 0x21800000
    v_cmp_nlt_f32 s[44:45], v28, v29
    v_cmp_ngt_f32 vcc, v28, v30
    v_rcp_f32 v28, v28
    s_or_b64 vcc, vcc, s[44:45]
    s_waitcnt lgkmcnt(8)
    v_pk_add_f32 v[32:33], v[32:33], v[48:49]
    v_pk_add_f32 v[34:35], v[34:35], v[50:51]
    v_pk_add_f32 v[36:37], v[36:37], v[52:53]
    v_pk_add_f32 v[38:39], v[38:39], v[54:55]
    v_pk_add_f32 v[40:41], v[40:41], v[56:57]
    v_pk_add_f32 v[42:43], v[42:43], v[58:59]
    v_pk_add_f32 v[44:45], v[44:45], v[60:61]
    v_pk_add_f32 v[46:47], v[46:47], v[62:63]
    s_waitcnt lgkmcnt(4)
    v_pk_add_f32 v[32:33], v[32:33], v[64:65]
    v_pk_add_f32 v[34:35], v[34:35], v[66:67]
    v_pk_add_f32 v[36:37], v[36:37], v[68:69]
    v_pk_add_f32 v[38:39], v[38:39], v[70:71]
    v_pk_add_f32 v[40:41], v[40:41], v[72:73]
    v_pk_add_f32 v[42:43], v[42:43], v[74:75]
    v_pk_add_f32 v[44:45], v[44:45], v[76:77]
    v_pk_add_f32 v[46:47], v[46:47], v[78:79]
    s_waitcnt lgkmcnt(0)
    v_pk_add_f32 v[32:33], v[32:33], v[80:81]
    v_pk_add_f32 v[34:35], v[34:35], v[82:83]
    v_pk_add_f32 v[36:37], v[36:37], v[84:85]
    v_pk_add_f32 v[38:39], v[38:39], v[86:87]
    v_pk_add_f32 v[40:41], v[40:41], v[88:89]
    v_pk_add_f32 v[42:43], v[42:43], v[90:91]
    v_pk_add_f32 v[44:45], v[44:45], v[92:93]
    v_pk_add_f32 v[46:47], v[46:47], v[94:95]
    s_cbranch_vccnz s_slow
s_fin:
    v_pk_mul_f32 v[32:33], v[28:29], v[32:33] op_sel_hi:[0,1]
    v_pk_mul_f32 v[34:35], v[28:29], v[34:35] op_sel_hi:[0,1]
    v_pk_mul_f32 v[36:37], v[28:29], v[36:37] op_sel_hi:[0,1]
    v_pk_mul_f32 v[38:39], v[28:29], v[38:39] op_sel_hi:[0,1]
    v_pk_mul_f32 v[40:41], v[28:29], v[40:41] op_sel_hi:[0,1]
    v_pk_mul_f32 v[42:43], v[28:29], v[42:43] op_sel_hi:[0,1]
    v_pk_mul_f32 v[44:45], v[28:29], v[44:45] op_sel_hi:[0,1]
    v_pk_mul_f32 v[46:47], v[28:29], v[46:47] op_sel_hi:[0,1]
    v_cvt_pk_bf16_f32 v32, v32, v33
    v_cvt_pk_bf16_f32 v33, v34, v35
    v_cvt_pk_bf16_f32 v34, v36, v37
    v_cvt_pk_bf16_f32 v35, v38, v39
    v_cvt_pk_bf16_f32 v36, v40, v41
    v_cvt_pk_bf16_f32 v37, v42, v43
    v_cvt_pk_bf16_f32 v38, v44, v45
    v_cvt_pk_bf16_f32 v39, v46, v47
    buffer_store_dwordx4 v[32:35], v1, s[4:7], s53 offen offset:0 sc1
    buffer_store_dwordx4 v[36:39], v1, s[4:7], s53 offen offset:1024 sc1
    s_cmp_lg_u32 s52, 0
    s_cbranch_scc1 s_b2
    s_waitcnt vmcnt(0)
    s_atomic_add s40, s[22:23], s54
    s_mov_b32 s52, 1
    s_add_u32 s53, s53, 2048
    s_waitcnt lgkmcnt(0)
    s_add_u32 s54, s54, 128
    s_setprio 0
    s_and_b32 s3, s16, 3
    s_lshl_b32 s46, s3, 19
    s_lshl_b32 s45, s3, 14
    s_and_b32 s3, s20, 0
    s_lshl_b32 s3, s3, 17
    s_xor_b32 s46, s46, s3
    s_add_u32 m0, s45, 0
    s_xor_b32 s44, s46, 0
    buffer_load_dwordx4 v16, s[12:15], s44 offen offset:0 lds
    buffer_load_dwordx4 v17, s[12:15], s44 offen offset:1024 lds
    buffer_load_dwordx4 v18, s[12:15], s44 offen offset:2048 lds
    buffer_load_dwordx4 v19, s[12:15], s44 offen offset:3072 lds
    s_add_u32 s44, s44, 65536
    s_waitcnt vmcnt(2)
    buffer_load_dwordx4 v[96:99], v16, s[12:15], s44 offen offset:0
    buffer_load_dwordx4 v[100:103], v17, s[12:15], s44 offen offset:1024
    buffer_load_dwordx4 v[104:107], v18, s[12:15], s44 offen offset:2048
    buffer_load_dwordx4 v[108:111], v19, s[12:15], s44 offen offset:3072
    s_waitcnt vmcnt(2)
    s_add_u32 m0, s45, 4096
    s_xor_b32 s44, s46, 131072
    buffer_load_dwordx4 v16, s[12:15], s44 offen offset:0 lds
    buffer_load_dwordx4 v17, s[12:15], s44 offen offset:1024 lds
    buffer_load_dwordx4 v18, s[12:15], s44 offen offset:2048 lds
    buffer_load_dwordx4 v19, s[12:15], s44 offen offset:3072 lds
    s_add_u32 s44, s44, 65536
    s_waitcnt vmcnt(2)
    buffer_load_dwordx4 v[112:115], v16, s[12:15], s44 offen offset:0
    buffer_load_dwordx4 v[116:119], v17, s[12:15], s44 offen offset:1024
    buffer_load_dwordx4 v[120:123], v18, s[12:15], s44 offen offset:2048
    buffer_load_dwordx4 v[124:127], v19, s[12:15], s44 offen offset:3072
    s_waitcnt vmcnt(2)
    s_add_u32 m0, s45, 8192
    s_xor_b32 s44, s46, 262144
    buffer_load_dwordx4 v16, s[12:15], s44 offen offset:0 lds
    buffer_load_dwordx4 v17, s[12:15], s44 offen offset:1024 lds
    buffer_load_dwordx4 v18, s[12:15], s44 offen offset:2048 lds
    buffer_load_dwordx4 v19, s[12:15], s44 offen offset:3072 lds
    s_add_u32 s44, s44, 65536
    s_waitcnt vmcnt(2)
    buffer_load_dwordx4 v[128:131], v16, s[12:15], s44 offen offset:0
    buffer_load_dwordx4 v[132:135], v17, s[12:15], s44 offen offset:1024
    buffer_load_dwordx4 v[136:139], v18, s[12:15], s44 offen offset:2048
    buffer_load_dwordx4 v[140:143], v19, s[12:15], s44 offen offset:3072
    s_waitcnt vmcnt(2)
    s_add_u32 m0, s45, 12288
    s_xor_b32 s44, s46, 393216
    buffer_load_dwordx4 v16, s[12:15], s44 offen offset:0 lds
    buffer_load_dwordx4 v17, s[12:15], s44 offen offset:1024 lds
    buffer_load_dwordx4 v18, s[12:15], s44 offen offset:2048 lds
    buffer_load_dwordx4 v19, s[12:15], s44 offen offset:3072 lds
    s_add_u32 s44, s44, 65536
    s_waitcnt vmcnt(2)
    buffer_load_dwordx4 v[144:147], v16, s[12:15], s44 offen offset:0
    buffer_load_dwordx4 v[148:151], v17, s[12:15], s44 offen offset:1024
    buffer_load_dwordx4 v[152:155], v18, s[12:15], s44 offen offset:2048
    buffer_load_dwordx4 v[156:159], v19, s[12:15], s44 offen offset:3072
    s_waitcnt vmcnt(2)
    s_setprio 3
    s_sub_u32 s44, s54, 128
    s_mov_b32 s66, 0x10000
s_o0_poll:
    s_mov_b32 s68, 0
    s_atomic_add s68, s[22:23], s44 offset:0 glc
    s_sub_u32 s66, s66, 1
    s_cselect_b32 s67, 16, 0
    s_waitcnt lgkmcnt(0)
    s_max_u32 s68, s68, s67
    s_cmp_lt_u32 s68, 16
    s_cbranch_scc1 s_o0_poll
s_o0_ok:
    s_branch s_bhead
s_b2:
    ds_write_b128 v24, v[96:99] offset:0
    ds_write_b128 v24, v[100:103] offset:1024
    ds_write_b128 v24, v[104:107] offset:2048
    ds_write_b128 v24, v[108:111] offset:3072
    ds_write_b128 v24, v[112:115] offset:4096
    ds_write_b128 v24, v[116:119] offset:5120
    ds_write_b128 v24, v[120:123] offset:6144
    ds_write_b128 v24, v[124:127] offset:7168
    ds_write_b128 v24, v[128:131] offset:8192
    ds_write_b128 v24, v[132:135] offset:9216
    ds_write_b128 v24, v[136:139] offset:10240
    ds_write_b128 v24, v[140:143] offset:11264
    ds_write_b128 v24, v[144:147] offset:12288
    ds_write_b128 v24, v[148:151] offset:13312
    ds_write_b128 v24, v[152:155] offset:14336
    ds_write_b128 v24, v[156:159] offset:15360
    s_waitcnt vmcnt(0)
    s_atomic_add s40, s[22:23], s54
    s_mov_b32 s66, 0x10000
s_o1_poll:
    s_mov_b32 s68, 0
    s_atomic_add s68, s[22:23], s54 offset:0 glc
    s_sub_u32 s66, s66, 1
    s_cselect_b32 s67, 16, 0
    s_waitcnt lgkmcnt(0)
    s_max_u32 s68, s68, s67
    s_cmp_lt_u32 s68, 16
    s_cbranch_scc1 s_o1_poll
s_o1_ok:
s_b3:
    s_setprio 0
    s_waitcnt lgkmcnt(0)
s_g3:
    s_barrier
    s_cmp_eq_u32 s21, 3
    s_cbranch_scc1 s_end
    s_barrier
    ds_write_b128 v9, v[160:163] offset:0
    ds_write_b128 v9, v[164:167] offset:4096
    ds_write_b128 v9, v[168:171] offset:8192
    ds_write_b128 v9, v[172:175] offset:12288
    ds_write_b128 v9, v[176:179] offset:16384
    ds_write_b128 v9, v[180:183] offset:20480
    ds_write_b128 v9, v[184:187] offset:24576
    ds_write_b128 v9, v[188:191] offset:28672
    s_add_u32 s21, s21, 1
    s_bitcmp1_b32 s21, 0
    s_cselect_b32 s8, s28, s24
    s_cselect_b32 s9, s29, s25
    s_cselect_b32 s12, s30, s26
    s_cselect_b32 s13, s31, s27
    s_mov_b32 s10, 6291456
    s_mov_b32 s11, 0x00020000
    s_mov_b32 s14, 2097152
    s_mov_b32 s15, 0x00020000
    s_sub_u32 s3, s16, 5
    s_cmp_gt_u32 s3, 1
    s_cbranch_scc1 s_n67
    s_add_u32 m0, s41, 98304
    s_add_u32 s44, s88, 2048
    buffer_load_dwordx4 v14, s[8:11], s44 offen offset:0 lds
    buffer_load_dwordx4 v15, s[8:11], s44 offen offset:1024 lds
    s_add_u32 m0, s41, 102400
    s_add_u32 s44, s88, 4096
    buffer_load_dwordx4 v14, s[8:11], s44 offen offset:0 lds
    buffer_load_dwordx4 v15, s[8:11], s44 offen offset:1024 lds
    s_add_u32 m0, s41, 106496
    s_add_u32 s44, s88, 0
    buffer_load_dwordx4 v14, s[8:11], s44 offen offset:0 lds
    buffer_load_dwordx4 v15, s[8:11], s44 offen offset:1024 lds
    s_add_u32 m0, s41, 110592
    s_add_u32 s44, s88, 198656
    buffer_load_dwordx4 v14, s[8:11], s44 offen offset:0 lds
    buffer_load_dwordx4 v15, s[8:11], s44 offen offset:1024 lds
    s_add_u32 m0, s41, 114688
    s_add_u32 s44, s88, 200704
    buffer_load_dwordx4 v14, s[8:11], s44 offen offset:0 lds
    buffer_load_dwordx4 v15, s[8:11], s44 offen offset:1024 lds
    s_add_u32 m0, s41, 118784
    s_add_u32 s44, s88, 196608
    buffer_load_dwordx4 v14, s[8:11], s44 offen offset:0 lds
    buffer_load_dwordx4 v15, s[8:11], s44 offen offset:1024 lds
    s_add_u32 m0, s41, 122880
    s_add_u32 s44, s89, 2048
    buffer_load_dwordx4 v14, s[8:11], s44 offen offset:0 lds
    buffer_load_dwordx4 v15, s[8:11], s44 offen offset:1024 lds
    s_add_u32 m0, s41, 126976
    s_add_u32 s44, s89, 4096
    buffer_load_dwordx4 v14, s[8:11], s44 offen offset:0 lds
    buffer_load_dwordx4 v15, s[8:11], s44 offen offset:1024 lds
s_n67:
    s_waitcnt lgkmcnt(0)
    s_barrier
    ds_write_b128 v9, v[192:195] offset:32768
    ds_write_b128 v9, v[196:199] offset:36864
    ds_write_b128 v9, v[200:203] offset:40960
    ds_write_b128 v9, v[204:207] offset:45056
    ds_write_b128 v9, v[208:211] offset:49152
    ds_write_b128 v9, v[212:215] offset:53248
    ds_write_b128 v9, v[216:219] offset:57344
    ds_write_b128 v9, v[220:223] offset:61440
    ds_write_b128 v10, v[224:227] offset:0
    ds_write_b128 v10, v[228:231] offset:4096
    ds_write_b128 v10, v[232:235] offset:8192
    ds_write_b128 v10, v[236:239] offset:12288
    ds_write_b128 v10, v[240:243] offset:16384
    ds_write_b128 v10, v[244:247] offset:20480
    ds_write_b128 v10, v[248:251] offset:24576
    ds_write_b128 v10, v[252:255] offset:28672
    s_cmp_eq_u32 s16, 4
    s_cbranch_scc1 h_layer
    s_cmp_eq_u32 s16, 7
    s_cbranch_scc1 z_layer
    s_branch l_layer
s_end:
    s_lshl_b32 s3, s2, 3
    s_add_u32 s3, s3, s16
    s_cmp_lg_u32 s3, 7
    s_cbranch_scc1 k_exit
    s_mov_b32 s8, s34
    s_mov_b32 s9, s35
    s_mov_b32 s10, 256
    s_mov_b32 s11, 0x00020000
    v_lshrrev_b32 v24, 2, v1
    v_mov_b32 v25, 0
    buffer_store_dword v25, v24, s[8:11], 0 offen sc1
    s_branch k_exit
s_slow:
    s_and_b32 s3, s16, 3
    s_lshl_b32 s44, s3, 11
    s_lshl_b32 s45, s52, 13
    s_add_u32 s44, s44, s45
    s_add_u32 s44, s44, 131072
    v_add_u32 v26, s44, v1
    ds_read_b128 v[48:51], v26 offset:0
    ds_read_b128 v[52:55], v26 offset:1024
    s_lshr_b32 s55, s21, 1
    s_lshl_b32 s55, s55, 23
    s_lshl_b32 s44, s18, 18
    s_add_u32 s55, s55, s44
    s_lshl_b32 s44, s52, 17
    s_add_u32 s55, s55, s44
    s_add_u32 s55, s55, 33554432
    s_waitcnt lgkmcnt(0)
    v_mov_b32 v26, 0xff800000
    s_mov_b32 s61, 0
s_slow1:
    s_add_u32 s44, s55, s61
    buffer_load_dwordx4 v[56:59], v1, s[4:7], s44 offen offset:0 sc1
    buffer_load_dwordx4 v[60:63], v1, s[4:7], s44 offen offset:1024 sc1
    s_waitcnt vmcnt(0)
    v_mfma_f32_32x32x16_bf16 v[72:87], v[56:59], v[48:51], 0
    v_mfma_f32_32x32x16_bf16 v[72:87], v[60:63], v[52:55], v[72:87]
    s_nop 11
    v_max3_f32 v26, v26, v72, v73
    v_max3_f32 v26, v26, v74, v75
    v_max3_f32 v26, v26, v76, v77
    v_max3_f32 v26, v26, v78, v79
    v_max3_f32 v26, v26, v80, v81
    v_max3_f32 v26, v26, v82, v83
    v_max3_f32 v26, v26, v84, v85
    v_max3_f32 v26, v26, v86, v87
    s_add_u32 s61, s61, 2048
    s_cmp_lt_u32 s61, 131072
    s_cbranch_scc1 s_slow1
    v_mov_b32 v27, v26
    s_nop 1
    v_permlane32_swap_b32 v26, v27
    v_max_f32 v26, v26, v27
    v_mov_b32 v32, 0
    v_mov_b32 v33, 0
    v_mov_b32 v34, 0
    v_mov_b32 v35, 0
    v_mov_b32 v36, 0
    v_mov_b32 v37, 0
    v_mov_b32 v38, 0
    v_mov_b32 v39, 0
    v_mov_b32 v40, 0
    v_mov_b32 v41, 0
    v_mov_b32 v42, 0
    v_mov_b32 v43, 0
    v_mov_b32 v44, 0
    v_mov_b32 v45, 0
    v_mov_b32 v46, 0
    v_mov_b32 v47, 0
    v_mov_b32 v28, 0
    v_mov_b32 v29, 0xdddddddd
    s_mov_b32 s3, 0xffff0000
    s_mov_b32 s61, 0
s_slow2:
    s_add_u32 s44, s55, s61
    buffer_load_dwordx4 v[56:59], v1, s[4:7], s44 offen offset:0 sc1
    buffer_load_dwordx4 v[60:63], v1, s[4:7], s44 offen offset:1024 sc1
    s_add_u32 s44, s44, 4194304
    buffer_load_dwordx4 v[64:67], v1, s[4:7], s44 offen offset:0 sc1
    buffer_load_dwordx4 v[68:71], v1, s[4:7], s44 offen offset:1024 sc1
    s_waitcnt vmcnt(0)
    v_mfma_f32_32x32x16_bf16 v[72:87], v[56:59], v[48:51], 0
    v_mfma_f32_32x32x16_bf16 v[72:87], v[60:63], v[52:55], v[72:87]
    s_nop 11
    v_sub_f32 v72, v72, v26
    v_sub_f32 v73, v73, v26
    v_sub_f32 v74, v74, v26
    v_sub_f32 v75, v75, v26
    v_sub_f32 v76, v76, v26
    v_sub_f32 v77, v77, v26
    v_sub_f32 v78, v78, v26
    v_sub_f32 v79, v79, v26
    v_sub_f32 v80, v80, v26
    v_sub_f32 v81, v81, v26
    v_sub_f32 v82, v82, v26
    v_sub_f32 v83, v83, v26
    v_sub_f32 v84, v84, v26
    v_sub_f32 v85, v85, v26
    v_sub_f32 v86, v86, v26
    v_sub_f32 v87, v87, v26
    v_exp_f32 v72, v72
    v_exp_f32 v73, v73
    v_exp_f32 v74, v74
    v_exp_f32 v75, v75
    v_exp_f32 v76, v76
    v_exp_f32 v77, v77
    v_exp_f32 v78, v78
    v_exp_f32 v79, v79
    v_exp_f32 v80, v80
    v_exp_f32 v81, v81
    v_exp_f32 v82, v82
    v_exp_f32 v83, v83
    v_exp_f32 v84, v84
    v_exp_f32 v85, v85
    v_exp_f32 v86, v86
    v_exp_f32 v87, v87
    v_and_b32 v72, s3, v72
    v_and_b32 v73, s3, v73
    v_and_b32 v74, s3, v74
    v_and_b32 v75, s3, v75
    v_and_b32 v76, s3, v76
    v_and_b32 v77, s3, v77
    v_and_b32 v78, s3, v78
    v_and_b32 v79, s3, v79
    v_and_b32 v80, s3, v80
    v_and_b32 v81, s3, v81
    v_and_b32 v82, s3, v82
    v_and_b32 v83, s3, v83
    v_and_b32 v84, s3, v84
    v_and_b32 v85, s3, v85
    v_and_b32 v86, s3, v86
    v_and_b32 v87, s3, v87
    v_add_f32 v28, v28, v72
    v_add_f32 v28, v28, v73
    v_add_f32 v28, v28, v74
    v_add_f32 v28, v28, v75
    v_add_f32 v28, v28, v76
    v_add_f32 v28, v28, v77
    v_add_f32 v28, v28, v78
    v_add_f32 v28, v28, v79
    v_add_f32 v28, v28, v80
    v_add_f32 v28, v28, v81
    v_add_f32 v28, v28, v82
    v_add_f32 v28, v28, v83
    v_add_f32 v28, v28, v84
    v_add_f32 v28, v28, v85
    v_add_f32 v28, v28, v86
    v_add_f32 v28, v28, v87
    v_smfmac_f32_32x32x32_bf16 v[32:47], v[64:67], v[72:79], v29
    v_smfmac_f32_32x32x32_bf16 v[32:47], v[68:71], v[80:87], v29
    s_add_u32 s61, s61, 2048
    s_cmp_lt_u32 s61, 131072
    s_cbranch_scc1 s_slow2
    v_mov_b32 v29, v28
    s_nop 1
    v_permlane32_swap_b32 v28, v29
    v_add_f32 v28, v28, v29
    v_rcp_f32 v28, v28
    s_nop 7
    s_branch s_fin
k_exit:
    s_endpgm
.section .rodata,"a"
.p2align 6
.amdhsa_kernel interleave_layers__sliding_local_dilated__softmax_full_mha__prompt_kernel
  .amdhsa_next_free_vgpr 256
  .amdhsa_next_free_sgpr 102
  .amdhsa_accum_offset 256
  .amdhsa_group_segment_fixed_size 0
  .amdhsa_kernarg_size 72
  .amdhsa_user_sgpr_count 2
  .amdhsa_user_sgpr_kernarg_segment_ptr 1
  .amdhsa_system_sgpr_workgroup_id_x 1
.end_amdhsa_kernel
```

```asm
; @launch grid=(256,1,1) block=(512,1,1) lds=156736
.amdgcn_target "amdgcn-amd-amdhsa--gfx950"
.text
.globl interleave_layers__sliding_local_dilated__softmax_full_mha__prompt_kernel
.type interleave_layers__sliding_local_dilated__softmax_full_mha__prompt_kernel,@function
.p2align 8
interleave_layers__sliding_local_dilated__softmax_full_mha__prompt_kernel:
    s_cmp_ge_u32 s2, 256
    s_cbranch_scc1 k_exit
    s_load_dwordx2 s[36:37], s[0:1], 0
    s_load_dwordx4 s[24:27], s[0:1], 8
    s_load_dwordx8 s[28:35], s[0:1], 32
    s_load_dwordx2 s[44:45], s[0:1], 64
    v_lshrrev_b32 v2, 6, v0
    v_and_b32 v0, 63, v0
    v_readfirstlane_b32 s16, v2
    v_lshlrev_b32 v1, 4, v0
    s_mov_b32 s21, 0
    s_mov_b32 s40, 1
    s_and_b32 s3, s2, 1
    s_lshl_b32 s3, s3, 3
    s_bfe_u32 s17, s2, 0x30003
    s_add_u32 s17, s17, s3
    s_bfe_u32 s3, s2, 0x20001
    s_lshl_b32 s3, s3, 2
    s_lshr_b32 s18, s2, 6
    s_add_u32 s18, s18, s3
    s_and_b32 s3, s2, 3
    s_lshl_b32 s3, s3, 2
    s_bfe_u32 s19, s2, 0x20003
    s_add_u32 s19, s19, s3
    s_bfe_u32 s3, s2, 0x10002
    s_lshl_b32 s3, s3, 3
    s_lshr_b32 s20, s2, 5
    s_add_u32 s20, s20, s3
    s_mov_b32 s19, s17
    s_mov_b32 s20, s18
    s_and_b32 s3, s16, 3
    s_lshl_b32 s38, s17, 2
    s_add_u32 s38, s38, s3
    s_lshl_b32 s39, s19, 2
    s_add_u32 s39, s39, s3
    v_mov_b32 v12, 0
    v_mov_b32 v13, 0
    v_mov_b32 v14, 0
    v_mov_b32 v15, 0
    s_mov_b32 s41, 0
    s_mov_b32 s42, 0
    s_mov_b32 s43, 0
    s_mov_b32 s62, 0
    s_waitcnt lgkmcnt(0)
    s_mov_b32 s4, s44
    s_mov_b32 s5, s45
    s_mov_b32 s6, 67108864
    s_mov_b32 s7, 0x00020000
    s_add_u32 s22, s44, 58720256
    s_addc_u32 s23, s45, 0
    s_load_dword s100, s[22:23], 217088
    s_cmp_eq_u32 s16, 4
    s_cbranch_scc1 h_start
    s_cmp_eq_u32 s16, 7
    s_cbranch_scc1 z_start
    s_cmp_gt_u32 s16, 4
    s_cbranch_scc1 l_start
    s_mov_b32 s8, s36
    s_mov_b32 s9, s37
    s_mov_b32 s10, 4194304
    s_mov_b32 s11, 0x00020000
    v_lshrrev_b32 v8, 4, v1
    v_lshrrev_b32 v32, 3, v8
    v_and_b32 v33, 7, v8
    v_lshlrev_b32 v34, 11, v32
    v_lshl_add_u32 v34, v33, 4, v34
    s_lshl_b32 s44, s39, 16
    s_lshl_b32 s45, s20, 7
    s_add_u32 s46, s44, s45
    buffer_load_dwordx4 v[40:43], v34, s[8:11], s46 offen
    s_add_u32 s46, s46, 16384
    buffer_load_dwordx4 v[44:47], v34, s[8:11], s46 offen
    s_add_u32 s46, s46, 16384
    buffer_load_dwordx4 v[48:51], v34, s[8:11], s46 offen
    s_add_u32 s46, s46, 16384
    buffer_load_dwordx4 v[52:55], v34, s[8:11], s46 offen
    v_xor_b32 v88, v33, v32
    v_lshlrev_b32 v88, 4, v88
    v_lshl_add_u32 v88, v32, 11, v88
    v_xor_b32 v89, 16, v88
    v_add_u32 v89, 15360, v89
    v_add_u32 v90, 30720, v88
    v_add_u32 v91, 30720, v89
    s_mul_i32 s76, s16, 16384
    s_add_u32 s76, s76, 65536
    s_lshl_b32 s77, s38, 16
    s_mul_i32 s84, s18, 4096
    s_cmp_eq_u32 s18, 1
    s_cselect_b32 s85, 0, 4096
    s_cmp_eq_u32 s18, 2
    s_cselect_b32 s86, 0, 8192
    s_cmp_eq_u32 s18, 3
    s_cselect_b32 s87, 0, 12288
    s_cmp_eq_u32 s18, 4
    s_cselect_b32 s88, 0, 16384
    s_cmp_eq_u32 s18, 5
    s_cselect_b32 s89, 0, 20480
    s_cmp_eq_u32 s18, 6
    s_cselect_b32 s90, 0, 24576
    s_cmp_eq_u32 s18, 7
    s_cselect_b32 s91, 0, 28672
    s_cmp_eq_u32 s18, 8
    s_cselect_b32 s92, 0, 32768
    s_cmp_eq_u32 s18, 9
    s_cselect_b32 s93, 0, 36864
    s_cmp_eq_u32 s18, 10
    s_cselect_b32 s94, 0, 40960
    s_cmp_eq_u32 s18, 11
    s_cselect_b32 s95, 0, 45056
    s_cmp_eq_u32 s18, 12
    s_cselect_b32 s96, 0, 49152
    s_cmp_eq_u32 s18, 13
    s_cselect_b32 s97, 0, 53248
    s_cmp_eq_u32 s18, 14
    s_cselect_b32 s98, 0, 57344
    s_cmp_eq_u32 s18, 15
    s_cselect_b32 s99, 0, 61440
    v_lshrrev_b32 v12, 4, v1
    v_and_b32 v13, 15, v12
    v_bfe_u32 v14, v12, 4, 1
    v_lshrrev_b32 v12, 5, v12
    v_lshl_add_u32 v2, v14, 5, v13
    v_lshlrev_b32 v2, 4, v2
    v_lshl_add_u32 v2, v12, 10, v2
    v_lshrrev_b32 v15, 2, v13
    v_lshl_add_u32 v15, v14, 2, v15
    v_lshlrev_b32 v3, 7, v15
    v_lshl_add_u32 v3, v12, 11, v3
    v_and_b32 v15, 3, v13
    v_lshl_add_u32 v3, v15, 3, v3
    v_lshrrev_b32 v15, 3, v13
    v_lshl_add_u32 v15, v15, 1, v14
    v_lshl_add_u32 v3, v15, 5, v3
    v_xor_b32 v4, 32, v3
    v_xor_b32 v5, 64, v3
    v_xor_b32 v6, 96, v3
    s_lshl_b32 s45, s16, 12
    s_add_u32 s45, s45, 131072
    v_lshrrev_b32 v35, 1, v33
    v_lshlrev_b32 v35, 10, v35
    v_lshl_add_u32 v35, v32, 4, v35
    v_and_b32 v36, 1, v33
    v_lshl_add_u32 v35, v36, 3, v35
    v_add_u32 v35, s45, v35
    v_add_u32 v36, s45, v1
    v_mov_b32 v37, 0x3f803f80
    v_and_b32 v38, 3, v8
    v_lshl_add_u32 v39, v38, 3, v32
    v_lshlrev_b32 v39, 3, v39
    v_mov_b32 v56, 0
    v_mov_b32 v57, 0
    v_mov_b32 v58, 0
    v_mov_b32 v59, 0
    v_mov_b32 v60, 0
    v_mov_b32 v61, 0
    v_mov_b32 v62, 0
    v_mov_b32 v63, 0
    s_waitcnt vmcnt(3)
    ds_write_b64 v35, v[40:41] offset:0
    ds_write_b64 v35, v[42:43] offset:512
    s_waitcnt vmcnt(2)
    ds_write_b64 v35, v[44:45] offset:128
    ds_write_b64 v35, v[46:47] offset:640
    s_waitcnt vmcnt(1)
    ds_write_b64 v35, v[48:49] offset:256
    ds_write_b64 v35, v[50:51] offset:768
    s_waitcnt vmcnt(0)
    ds_write_b64 v35, v[52:53] offset:384
    ds_write_b64 v35, v[54:55] offset:896
    ds_read_b128 v[64:67], v36 offset:0
    ds_read_b128 v[68:71], v36 offset:1024
    ds_read_b128 v[72:75], v36 offset:2048
    ds_read_b128 v[76:79], v36 offset:3072
    s_lshl_b32 s45, s20, 12
    s_add_u32 s46, s44, s45
    s_waitcnt lgkmcnt(3)
    buffer_store_dwordx4 v[64:67], v1, s[4:7], s46 offen offset:0 sc1
    s_waitcnt lgkmcnt(2)
    buffer_store_dwordx4 v[68:71], v1, s[4:7], s46 offen offset:1024 sc1
    s_waitcnt lgkmcnt(1)
    buffer_store_dwordx4 v[72:75], v1, s[4:7], s46 offen offset:2048 sc1
    s_waitcnt lgkmcnt(0)
    buffer_store_dwordx4 v[76:79], v1, s[4:7], s46 offen offset:3072 sc1
    v_dot2_f32_bf16 v56, v40, v37, v56
    v_dot2_f32_bf16 v57, v40, v40, v57
    v_dot2_f32_bf16 v58, v44, v37, v58
    v_dot2_f32_bf16 v59, v44, v44, v59
    v_dot2_f32_bf16 v60, v48, v37, v60
    v_dot2_f32_bf16 v61, v48, v48, v61
    v_dot2_f32_bf16 v62, v52, v37, v62
    v_dot2_f32_bf16 v63, v52, v52, v63
    v_dot2_f32_bf16 v56, v41, v37, v56
    v_dot2_f32_bf16 v57, v41, v41, v57
    v_dot2_f32_bf16 v58, v45, v37, v58
    v_dot2_f32_bf16 v59, v45, v45, v59
    v_dot2_f32_bf16 v60, v49, v37, v60
    v_dot2_f32_bf16 v61, v49, v49, v61
    v_dot2_f32_bf16 v62, v53, v37, v62
    v_dot2_f32_bf16 v63, v53, v53, v63
    v_dot2_f32_bf16 v56, v42, v37, v56
    v_dot2_f32_bf16 v57, v42, v42, v57
    v_dot2_f32_bf16 v58, v46, v37, v58
    v_dot2_f32_bf16 v59, v46, v46, v59
    v_dot2_f32_bf16 v60, v50, v37, v60
    v_dot2_f32_bf16 v61, v50, v50, v61
    v_dot2_f32_bf16 v62, v54, v37, v62
    v_dot2_f32_bf16 v63, v54, v54, v63
    v_dot2_f32_bf16 v56, v43, v37, v56
    v_dot2_f32_bf16 v57, v43, v43, v57
    v_dot2_f32_bf16 v58, v47, v37, v58
    v_dot2_f32_bf16 v59, v47, v47, v59
    v_dot2_f32_bf16 v60, v51, v37, v60
    v_dot2_f32_bf16 v61, v51, v51, v61
    v_dot2_f32_bf16 v62, v55, v37, v62
    v_dot2_f32_bf16 v63, v55, v55, v63
    s_nop 2
    v_add_f32_dpp v56, v56, v56 quad_perm:[1,0,3,2] row_mask:0xf bank_mask:0xf
    v_add_f32_dpp v57, v57, v57 quad_perm:[1,0,3,2] row_mask:0xf bank_mask:0xf
    v_add_f32_dpp v58, v58, v58 quad_perm:[1,0,3,2] row_mask:0xf bank_mask:0xf
    v_add_f32_dpp v59, v59, v59 quad_perm:[1,0,3,2] row_mask:0xf bank_mask:0xf
    v_add_f32_dpp v60, v60, v60 quad_perm:[1,0,3,2] row_mask:0xf bank_mask:0xf
    v_add_f32_dpp v61, v61, v61 quad_perm:[1,0,3,2] row_mask:0xf bank_mask:0xf
    v_add_f32_dpp v62, v62, v62 quad_perm:[1,0,3,2] row_mask:0xf bank_mask:0xf
    v_add_f32_dpp v63, v63, v63 quad_perm:[1,0,3,2] row_mask:0xf bank_mask:0xf
    v_add_f32_dpp v56, v56, v56 quad_perm:[2,3,0,1] row_mask:0xf bank_mask:0xf
    v_add_f32_dpp v57, v57, v57 quad_perm:[2,3,0,1] row_mask:0xf bank_mask:0xf
    v_add_f32_dpp v58, v58, v58 quad_perm:[2,3,0,1] row_mask:0xf bank_mask:0xf
    v_add_f32_dpp v59, v59, v59 quad_perm:[2,3,0,1] row_mask:0xf bank_mask:0xf
    v_add_f32_dpp v60, v60, v60 quad_perm:[2,3,0,1] row_mask:0xf bank_mask:0xf
    v_add_f32_dpp v61, v61, v61 quad_perm:[2,3,0,1] row_mask:0xf bank_mask:0xf
    v_add_f32_dpp v62, v62, v62 quad_perm:[2,3,0,1] row_mask:0xf bank_mask:0xf
    v_add_f32_dpp v63, v63, v63 quad_perm:[2,3,0,1] row_mask:0xf bank_mask:0xf
    v_add_f32_dpp v56, v56, v56 row_half_mirror row_mask:0xf bank_mask:0xf
    v_add_f32_dpp v57, v57, v57 row_half_mirror row_mask:0xf bank_mask:0xf
    v_add_f32_dpp v58, v58, v58 row_half_mirror row_mask:0xf bank_mask:0xf
    v_add_f32_dpp v59, v59, v59 row_half_mirror row_mask:0xf bank_mask:0xf
    v_add_f32_dpp v60, v60, v60 row_half_mirror row_mask:0xf bank_mask:0xf
    v_add_f32_dpp v61, v61, v61 row_half_mirror row_mask:0xf bank_mask:0xf
    v_add_f32_dpp v62, v62, v62 row_half_mirror row_mask:0xf bank_mask:0xf
    v_add_f32_dpp v63, v63, v63 row_half_mirror row_mask:0xf bank_mask:0xf
    v_cmp_eq_u32 vcc, 1, v38
    s_nop 1
    v_cndmask_b32 v56, v56, v58, vcc
    v_cndmask_b32 v57, v57, v59, vcc
    v_cmp_eq_u32 vcc, 2, v38
    s_nop 1
    v_cndmask_b32 v56, v56, v60, vcc
    v_cndmask_b32 v57, v57, v61, vcc
    v_cmp_eq_u32 vcc, 3, v38
    s_nop 1
    v_cndmask_b32 v56, v56, v62, vcc
    v_cndmask_b32 v57, v57, v63, vcc
    s_lshl_b32 s44, s21, 18
    s_lshl_b32 s45, s39, 12
    s_add_u32 s44, s44, s45
    s_lshl_b32 s45, s20, 8
    s_add_u32 s44, s44, s45
    s_add_u32 s44, s44, 50331648
    buffer_store_dwordx2 v[56:57], v39, s[4:7], s44 offen sc1
    s_lshl_b32 s46, s21, 14
    s_lshl_b32 s67, s39, 7
    s_add_u32 s46, s46, s67
    s_add_u32 s46, s46, 4096
    s_add_u32 s47, s46, 8192
    s_lshl_b32 s48, s21, 22
    s_lshl_b32 s49, s38, 16
    s_add_u32 s41, s48, s49
    s_lshl_b32 s48, s21, 14
    s_lshl_b32 s67, s38, 7
    s_add_u32 s48, s48, s67
    s_add_u32 s48, s48, 4096
    v_lshrrev_b32 v16, 4, v1
    v_and_b32 v17, 15, v16
    v_lshrrev_b32 v16, 4, v16
    s_lshl_b32 s49, s16, 7
    s_add_u32 s50, s49, 151552
    s_and_b32 s49, s21, 1
    s_lshl_b32 s49, s49, 10
    s_add_u32 s49, s49, 151552
    v_lshlrev_b32 v11, 4, v16
    v_add_u32 v13, s50, v11
    v_add_u32 v11, s49, v11
    v_lshlrev_b32 v15, 2, v17
    v_add_u32 v9, s50, v15
    v_add_u32 v15, s49, v15
    s_lshr_b32 s49, s21, 1
    s_lshl_b32 s53, s49, 23
    s_lshl_b32 s50, s18, 18
    s_add_u32 s53, s53, s50
    s_add_u32 s53, s53, 33554432
    s_lshl_b32 s54, s38, 11
    s_add_u32 s52, s53, s54
    s_lshl_b32 s59, s49, 13
    s_lshl_b32 s67, s18, 9
    s_add_u32 s59, s59, s67
    s_lshl_b32 s67, s16, 7
    s_add_u32 s59, s59, s67
    s_add_u32 s59, s59, 69632
    s_lshl_b32 s61, s49, 15
    s_lshl_b32 s67, s17, 11
    s_add_u32 s61, s61, s67
    s_lshl_b32 s67, s18, 7
    s_add_u32 s61, s61, s67
    s_add_u32 s61, s61, 151552
    s_sub_u32 s60, s61, 151552
    s_lshl_b32 s60, s60, 5
    s_add_u32 s60, s60, 54525952
    s_lshl_b32 s62, s16, 12
    s_add_u32 s62, s62, 131072
    v_bfe_u32 v80, v8, 3, 1
    v_and_b32 v81, 7, v8
    v_lshrrev_b32 v82, 5, v8
    v_lshlrev_b32 v82, 1, v82
    v_xor_b32 v82, v82, v81
    v_xor_b32 v82, v82, v80
    v_lshlrev_b32 v82, 4, v82
    v_lshl_add_u32 v82, v81, 7, v82
    v_lshl_add_u32 v82, v80, 10, v82
    v_bfe_u32 v80, v8, 4, 1
    v_lshl_add_u32 v82, v80, 3, v82
    v_add_u32 v84, s76, v82
    v_xor_b32 v85, 16, v84
    v_xor_b32 v86, 64, v84
    v_xor_b32 v87, 80, v84
    s_waitcnt vmcnt(0)
    s_add_u32 m0, s76, 0
    s_lshr_b32 s78, s84, 5
    s_add_u32 s78, s78, s77
    buffer_load_dwordx4 v88, s[8:11], s78 offen offset:0 lds
    buffer_load_dwordx4 v89, s[8:11], s78 offen offset:1024 lds
    buffer_load_dwordx4 v90, s[8:11], s78 offen offset:2048 lds
    buffer_load_dwordx4 v91, s[8:11], s78 offen offset:3072 lds
    s_add_u32 m0, s76, 4096
    s_lshr_b32 s78, s85, 5
    s_add_u32 s78, s78, s77
    buffer_load_dwordx4 v88, s[8:11], s78 offen offset:0 lds
    buffer_load_dwordx4 v89, s[8:11], s78 offen offset:1024 lds
    buffer_load_dwordx4 v90, s[8:11], s78 offen offset:2048 lds
    buffer_load_dwordx4 v91, s[8:11], s78 offen offset:3072 lds
    s_add_u32 m0, s76, 8192
    s_lshr_b32 s78, s86, 5
    s_add_u32 s78, s78, s77
    buffer_load_dwordx4 v88, s[8:11], s78 offen offset:0 lds
    buffer_load_dwordx4 v89, s[8:11], s78 offen offset:1024 lds
    buffer_load_dwordx4 v90, s[8:11], s78 offen offset:2048 lds
    buffer_load_dwordx4 v91, s[8:11], s78 offen offset:3072 lds
    s_add_u32 m0, s76, 12288
    s_lshr_b32 s78, s87, 5
    s_add_u32 s78, s78, s77
    buffer_load_dwordx4 v88, s[8:11], s78 offen offset:0 lds
    buffer_load_dwordx4 v89, s[8:11], s78 offen offset:1024 lds
    buffer_load_dwordx4 v90, s[8:11], s78 offen offset:2048 lds
    buffer_load_dwordx4 v91, s[8:11], s78 offen offset:3072 lds
    s_barrier
    s_load_dword s68, s[34:35], 0
    s_mov_b32 s8, s34
    s_mov_b32 s9, s35
    s_mov_b32 s10, 256
    s_mov_b32 s11, 0x00020000
    s_mov_b32 s66, 0x10000
    v_mov_b32 v16, 0
    s_waitcnt lgkmcnt(0)
c_f0:
    s_cmp_eq_u32 s68, 6
    s_cbranch_scc1 c_f0_ok
    buffer_load_dword v17, v16, s[8:11], 0 offen offset:0 sc1
    s_waitcnt vmcnt(0)
    v_readfirstlane_b32 s68, v17
    s_sub_u32 s66, s66, 1
    s_cmp_lg_u32 s66, 0
    s_cbranch_scc1 c_f0
c_f0_ok:
    s_atomic_add s40, s[22:23], s47
    s_waitcnt vmcnt(0)
    ds_read_b64 v[160:161], v84 offset:0
    ds_read_b64 v[162:163], v85 offset:0
    ds_read_b64 v[164:165], v84 offset:2048
    ds_read_b64 v[166:167], v85 offset:2048
    ds_read_b64 v[168:169], v86 offset:0
    ds_read_b64 v[170:171], v87 offset:0
    ds_read_b64 v[172:173], v86 offset:2048
    ds_read_b64 v[174:175], v87 offset:2048
    ds_read_b64 v[176:177], v84 offset:4096
    ds_read_b64 v[178:179], v85 offset:4096
    ds_read_b64 v[180:181], v84 offset:6144
    ds_read_b64 v[182:183], v85 offset:6144
    ds_read_b64 v[184:185], v86 offset:4096
    ds_read_b64 v[186:187], v87 offset:4096
    ds_read_b64 v[188:189], v86 offset:6144
    ds_read_b64 v[190:191], v87 offset:6144
    ds_read_b64 v[192:193], v84 offset:8192
    ds_read_b64 v[194:195], v85 offset:8192
    ds_read_b64 v[196:197], v84 offset:10240
    ds_read_b64 v[198:199], v85 offset:10240
    ds_read_b64 v[200:201], v86 offset:8192
    ds_read_b64 v[202:203], v87 offset:8192
    ds_read_b64 v[204:205], v86 offset:10240
    ds_read_b64 v[206:207], v87 offset:10240
    ds_read_b64 v[208:209], v84 offset:12288
    ds_read_b64 v[210:211], v85 offset:12288
    ds_read_b64 v[212:213], v84 offset:14336
    ds_read_b64 v[214:215], v85 offset:14336
    ds_read_b64 v[216:217], v86 offset:12288
    ds_read_b64 v[218:219], v87 offset:12288
    ds_read_b64 v[220:221], v86 offset:14336
    ds_read_b64 v[222:223], v87 offset:14336
    s_waitcnt lgkmcnt(0)
    s_mov_b64 vcc, -1
    s_barrier
    ds_read_b64_tr_b16 v[32:33], v3 offset:0
    ds_read_b64_tr_b16 v[34:35], v3 offset:1024
    ds_read_b64_tr_b16 v[36:37], v4 offset:0
    ds_read_b64_tr_b16 v[38:39], v4 offset:1024
    ds_read_b64_tr_b16 v[40:41], v5 offset:0
    ds_read_b64_tr_b16 v[42:43], v5 offset:1024
    ds_read_b64_tr_b16 v[44:45], v6 offset:0
    ds_read_b64_tr_b16 v[46:47], v6 offset:1024
    ds_read_b64_tr_b16 v[48:49], v3 offset:4096
    ds_read_b64_tr_b16 v[50:51], v3 offset:5120
    ds_read_b64_tr_b16 v[52:53], v4 offset:4096
    ds_read_b64_tr_b16 v[54:55], v4 offset:5120
    ds_read_b64_tr_b16 v[56:57], v5 offset:4096
    ds_read_b64_tr_b16 v[58:59], v5 offset:5120
    s_branch c_g0
c_layer:
    s_lshl_b32 s48, s21, 22
    s_lshl_b32 s49, s38, 16
    s_add_u32 s41, s48, s49
    s_lshl_b32 s48, s21, 14
    s_lshl_b32 s67, s38, 7
    s_add_u32 s48, s48, s67
    s_add_u32 s48, s48, 4096
    v_lshrrev_b32 v16, 4, v1
    v_and_b32 v17, 15, v16
    v_lshrrev_b32 v16, 4, v16
    s_lshl_b32 s49, s16, 7
    s_add_u32 s50, s49, 151552
    s_and_b32 s49, s21, 1
    s_lshl_b32 s49, s49, 10
    s_add_u32 s49, s49, 151552
    v_lshlrev_b32 v11, 4, v16
    v_add_u32 v13, s50, v11
    v_add_u32 v11, s49, v11
    v_lshlrev_b32 v15, 2, v17
    v_add_u32 v9, s50, v15
    v_add_u32 v15, s49, v15
    s_lshr_b32 s49, s21, 1
    s_lshl_b32 s53, s49, 23
    s_lshl_b32 s50, s18, 18
    s_add_u32 s53, s53, s50
    s_add_u32 s53, s53, 33554432
    s_lshl_b32 s54, s38, 11
    s_add_u32 s52, s53, s54
    s_lshl_b32 s59, s49, 13
    s_lshl_b32 s67, s18, 9
    s_add_u32 s59, s59, s67
    s_lshl_b32 s67, s16, 7
    s_add_u32 s59, s59, s67
    s_add_u32 s59, s59, 69632
    s_lshl_b32 s61, s49, 15
    s_lshl_b32 s67, s17, 11
    s_add_u32 s61, s61, s67
    s_lshl_b32 s67, s18, 7
    s_add_u32 s61, s61, s67
    s_add_u32 s61, s61, 151552
    s_sub_u32 s60, s61, 151552
    s_lshl_b32 s60, s60, 5
    s_add_u32 s60, s60, 54525952
    s_lshl_b32 s62, s16, 12
    s_add_u32 s62, s62, 131072
    s_mov_b32 s68, 0
    s_atomic_add s68, s[22:23], s48 glc
    s_mov_b64 vcc, 0
    s_barrier
    ds_read_b64_tr_b16 v[32:33], v3 offset:0
    ds_read_b64_tr_b16 v[34:35], v3 offset:1024
    ds_read_b64_tr_b16 v[36:37], v4 offset:0
    ds_read_b64_tr_b16 v[38:39], v4 offset:1024
    ds_read_b64_tr_b16 v[40:41], v5 offset:0
    ds_read_b64_tr_b16 v[42:43], v5 offset:1024
    ds_read_b64_tr_b16 v[44:45], v6 offset:0
    ds_read_b64_tr_b16 v[46:47], v6 offset:1024
    ds_read_b64_tr_b16 v[48:49], v3 offset:4096
    ds_read_b64_tr_b16 v[50:51], v3 offset:5120
    ds_read_b64_tr_b16 v[52:53], v4 offset:4096
    ds_read_b64_tr_b16 v[54:55], v4 offset:5120
    ds_read_b64_tr_b16 v[56:57], v5 offset:4096
    ds_read_b64_tr_b16 v[58:59], v5 offset:5120
c_g0:
    s_waitcnt lgkmcnt(10)
    v_mfma_f32_16x16x32_bf16 v[64:67], v[32:35], v[160:163], 0
    ds_read_b64_tr_b16 v[60:61], v6 offset:4096
    v_mfma_f32_16x16x32_bf16 v[68:71], v[32:35], v[164:167], 0
    ds_read_b64_tr_b16 v[62:63], v6 offset:5120
    v_mfma_f32_16x16x32_bf16 v[72:75], v[36:39], v[160:163], 0
    ds_read_b64_tr_b16 v[32:33], v3 offset:8192
    v_mfma_f32_16x16x32_bf16 v[76:79], v[36:39], v[164:167], 0
    ds_read_b64_tr_b16 v[34:35], v3 offset:9216
    s_waitcnt lgkmcnt(10)
    v_mfma_f32_16x16x32_bf16 v[80:83], v[40:43], v[160:163], 0
    ds_read_b64_tr_b16 v[36:37], v4 offset:8192
    v_mfma_f32_16x16x32_bf16 v[84:87], v[40:43], v[164:167], 0
    ds_read_b64_tr_b16 v[38:39], v4 offset:9216
    v_mfma_f32_16x16x32_bf16 v[88:91], v[44:47], v[160:163], 0
    ds_read_b64_tr_b16 v[40:41], v5 offset:8192
    v_mfma_f32_16x16x32_bf16 v[92:95], v[44:47], v[164:167], 0
    ds_read_b64_tr_b16 v[42:43], v5 offset:9216
    s_waitcnt lgkmcnt(10)
    v_mfma_f32_16x16x32_bf16 v[96:99], v[160:163], v[48:51], 0
    ds_read_b64_tr_b16 v[44:45], v6 offset:8192
    v_mfma_f32_16x16x32_bf16 v[100:103], v[164:167], v[48:51], 0
    ds_read_b64_tr_b16 v[46:47], v6 offset:9216
    v_mfma_f32_16x16x32_bf16 v[104:107], v[160:163], v[52:55], 0
    ds_read_b64_tr_b16 v[48:49], v3 offset:12288
    v_mfma_f32_16x16x32_bf16 v[108:111], v[164:167], v[52:55], 0
    ds_read_b64_tr_b16 v[50:51], v3 offset:13312
    s_waitcnt lgkmcnt(10)
    v_mfma_f32_16x16x32_bf16 v[112:115], v[160:163], v[56:59], 0
    ds_read_b64_tr_b16 v[52:53], v4 offset:12288
    v_mfma_f32_16x16x32_bf16 v[116:119], v[164:167], v[56:59], 0
    ds_read_b64_tr_b16 v[54:55], v4 offset:13312
    v_mfma_f32_16x16x32_bf16 v[120:123], v[160:163], v[60:63], 0
    ds_read_b64_tr_b16 v[56:57], v5 offset:12288
    v_mfma_f32_16x16x32_bf16 v[124:127], v[164:167], v[60:63], 0
    ds_read_b64_tr_b16 v[58:59], v5 offset:13312
    s_cbranch_vccnz c_gate
    s_mov_b32 s66, 0x10000
    s_waitcnt lgkmcnt(0)
    s_cmp_eq_u32 s68, 16
    s_cbranch_scc1 c_x_ok
c_x_poll:
    s_mov_b32 s68, 0
    s_atomic_add s68, s[22:23], s48 offset:0 glc
    s_sub_u32 s66, s66, 1
    s_cselect_b32 s67, 16, 0
    s_waitcnt lgkmcnt(0)
    s_max_u32 s68, s68, s67
    s_cmp_lt_u32 s68, 16
    s_cbranch_scc1 c_x_poll
c_x_ok:
    s_add_u32 s42, s41, s85
    buffer_load_dwordx4 v[176:179], v2, s[4:7], s42 offen offset:0 sc1
    buffer_load_dwordx4 v[180:183], v2, s[4:7], s42 offen offset:256 sc1
    buffer_load_dwordx4 v[184:187], v2, s[4:7], s42 offen offset:2048 sc1
    buffer_load_dwordx4 v[188:191], v2, s[4:7], s42 offen offset:2304 sc1
    s_add_u32 s42, s41, s86
    buffer_load_dwordx4 v[192:195], v2, s[4:7], s42 offen offset:0 sc1
    buffer_load_dwordx4 v[196:199], v2, s[4:7], s42 offen offset:256 sc1
    buffer_load_dwordx4 v[200:203], v2, s[4:7], s42 offen offset:2048 sc1
    buffer_load_dwordx4 v[204:207], v2, s[4:7], s42 offen offset:2304 sc1
    s_add_u32 s42, s41, s87
    buffer_load_dwordx4 v[208:211], v2, s[4:7], s42 offen offset:0 sc1
    buffer_load_dwordx4 v[212:215], v2, s[4:7], s42 offen offset:256 sc1
    s_waitcnt vmcnt(10)
    s_atomic_add s40, s[22:23], s47
c_gate:
    s_waitcnt lgkmcnt(10)
    v_mfma_f32_16x16x32_bf16 v[128:131], v[32:35], v[160:163], 0
    ds_read_b64_tr_b16 v[60:61], v6 offset:12288
    v_mfma_f32_16x16x32_bf16 v[132:135], v[32:35], v[164:167], 0
    ds_read_b64_tr_b16 v[62:63], v6 offset:13312
    v_mfma_f32_16x16x32_bf16 v[136:139], v[36:39], v[160:163], 0
    ds_read_b64_tr_b16 v[32:33], v3 offset:16384
    v_mfma_f32_16x16x32_bf16 v[140:143], v[36:39], v[164:167], 0
    ds_read_b64_tr_b16 v[34:35], v3 offset:17408
    s_waitcnt lgkmcnt(10)
    v_mfma_f32_16x16x32_bf16 v[144:147], v[40:43], v[160:163], 0
    ds_read_b64_tr_b16 v[36:37], v4 offset:16384
    v_mfma_f32_16x16x32_bf16 v[148:151], v[40:43], v[164:167], 0
    ds_read_b64_tr_b16 v[38:39], v4 offset:17408
    v_mfma_f32_16x16x32_bf16 v[152:155], v[44:47], v[160:163], 0
    ds_read_b64_tr_b16 v[40:41], v5 offset:16384
    v_mfma_f32_16x16x32_bf16 v[156:159], v[44:47], v[164:167], 0
    ds_read_b64_tr_b16 v[42:43], v5 offset:17408
    s_waitcnt lgkmcnt(10)
    v_mfma_f32_16x16x32_bf16 v[64:67], v[48:51], v[168:171], v[64:67]
    ds_read_b64_tr_b16 v[44:45], v6 offset:16384
    v_mfma_f32_16x16x32_bf16 v[68:71], v[48:51], v[172:175], v[68:71]
    ds_read_b64_tr_b16 v[46:47], v6 offset:17408
    v_mfma_f32_16x16x32_bf16 v[72:75], v[52:55], v[168:171], v[72:75]
    ds_read_b64_tr_b16 v[48:49], v3 offset:20480
    v_mfma_f32_16x16x32_bf16 v[76:79], v[52:55], v[172:175], v[76:79]
    ds_read_b64_tr_b16 v[50:51], v3 offset:21504
    s_waitcnt lgkmcnt(10)
    v_mfma_f32_16x16x32_bf16 v[80:83], v[56:59], v[168:171], v[80:83]
    ds_read_b64_tr_b16 v[52:53], v4 offset:20480
    v_mfma_f32_16x16x32_bf16 v[84:87], v[56:59], v[172:175], v[84:87]
    ds_read_b64_tr_b16 v[54:55], v4 offset:21504
    v_mfma_f32_16x16x32_bf16 v[88:91], v[60:63], v[168:171], v[88:91]
    ds_read_b64_tr_b16 v[56:57], v5 offset:20480
    v_mfma_f32_16x16x32_bf16 v[92:95], v[60:63], v[172:175], v[92:95]
    ds_read_b64_tr_b16 v[58:59], v5 offset:21504
    s_waitcnt lgkmcnt(10)
    v_mfma_f32_16x16x32_bf16 v[96:99], v[168:171], v[32:35], v[96:99]
    ds_read_b64_tr_b16 v[60:61], v6 offset:20480
    v_mfma_f32_16x16x32_bf16 v[100:103], v[172:175], v[32:35], v[100:103]
    ds_read_b64_tr_b16 v[62:63], v6 offset:21504
    v_mfma_f32_16x16x32_bf16 v[104:107], v[168:171], v[36:39], v[104:107]
    ds_read_b64_tr_b16 v[32:33], v3 offset:24576
    v_mfma_f32_16x16x32_bf16 v[108:111], v[172:175], v[36:39], v[108:111]
    ds_read_b64_tr_b16 v[34:35], v3 offset:25600
    s_waitcnt lgkmcnt(10)
    v_mfma_f32_16x16x32_bf16 v[112:115], v[168:171], v[40:43], v[112:115]
    ds_read_b64_tr_b16 v[36:37], v4 offset:24576
    v_mfma_f32_16x16x32_bf16 v[116:119], v[172:175], v[40:43], v[116:119]
    ds_read_b64_tr_b16 v[38:39], v4 offset:25600
    v_mfma_f32_16x16x32_bf16 v[120:123], v[168:171], v[44:47], v[120:123]
    ds_read_b64_tr_b16 v[40:41], v5 offset:24576
    v_mfma_f32_16x16x32_bf16 v[124:127], v[172:175], v[44:47], v[124:127]
    ds_read_b64_tr_b16 v[42:43], v5 offset:25600
    s_waitcnt lgkmcnt(10)
    v_mfma_f32_16x16x32_bf16 v[128:131], v[48:51], v[168:171], v[128:131]
    ds_read_b64_tr_b16 v[44:45], v6 offset:24576
    v_mfma_f32_16x16x32_bf16 v[132:135], v[48:51], v[172:175], v[132:135]
    ds_read_b64_tr_b16 v[46:47], v6 offset:25600
    v_mfma_f32_16x16x32_bf16 v[136:139], v[52:55], v[168:171], v[136:139]
    ds_read_b64_tr_b16 v[48:49], v3 offset:28672
    v_mfma_f32_16x16x32_bf16 v[140:143], v[52:55], v[172:175], v[140:143]
    ds_read_b64_tr_b16 v[50:51], v3 offset:29696
    s_waitcnt lgkmcnt(10)
    v_mfma_f32_16x16x32_bf16 v[144:147], v[56:59], v[168:171], v[144:147]
    ds_read_b64_tr_b16 v[52:53], v4 offset:28672
    v_mfma_f32_16x16x32_bf16 v[148:151], v[56:59], v[172:175], v[148:151]
    ds_read_b64_tr_b16 v[54:55], v4 offset:29696
    v_mfma_f32_16x16x32_bf16 v[152:155], v[60:63], v[168:171], v[152:155]
    ds_read_b64_tr_b16 v[56:57], v5 offset:28672
    v_mfma_f32_16x16x32_bf16 v[156:159], v[60:63], v[172:175], v[156:159]
    ds_read_b64_tr_b16 v[58:59], v5 offset:29696
    s_waitcnt vmcnt(8) lgkmcnt(10)
    v_mfma_f32_16x16x32_bf16 v[64:67], v[32:35], v[176:179], v[64:67]
    ds_read_b64_tr_b16 v[60:61], v6 offset:28672
    v_mfma_f32_16x16x32_bf16 v[68:71], v[32:35], v[180:183], v[68:71]
    ds_read_b64_tr_b16 v[62:63], v6 offset:29696
    s_barrier
    v_mfma_f32_16x16x32_bf16 v[72:75], v[36:39], v[176:179], v[72:75]
    ds_read_b64_tr_b16 v[32:33], v3 offset:32768
    v_mfma_f32_16x16x32_bf16 v[76:79], v[36:39], v[180:183], v[76:79]
    ds_read_b64_tr_b16 v[34:35], v3 offset:33792
    s_waitcnt lgkmcnt(10)
    v_mfma_f32_16x16x32_bf16 v[80:83], v[40:43], v[176:179], v[80:83]
    ds_read_b64_tr_b16 v[36:37], v4 offset:32768
    v_mfma_f32_16x16x32_bf16 v[84:87], v[40:43], v[180:183], v[84:87]
    ds_read_b64_tr_b16 v[38:39], v4 offset:33792
    v_mfma_f32_16x16x32_bf16 v[88:91], v[44:47], v[176:179], v[88:91]
    ds_read_b64_tr_b16 v[40:41], v5 offset:32768
    v_mfma_f32_16x16x32_bf16 v[92:95], v[44:47], v[180:183], v[92:95]
    ds_read_b64_tr_b16 v[42:43], v5 offset:33792
    s_waitcnt lgkmcnt(10)
    v_mfma_f32_16x16x32_bf16 v[96:99], v[176:179], v[48:51], v[96:99]
    ds_read_b64_tr_b16 v[44:45], v6 offset:32768
    v_mfma_f32_16x16x32_bf16 v[100:103], v[180:183], v[48:51], v[100:103]
    ds_read_b64_tr_b16 v[46:47], v6 offset:33792
    v_mfma_f32_16x16x32_bf16 v[104:107], v[176:179], v[52:55], v[104:107]
    ds_read_b64_tr_b16 v[48:49], v3 offset:36864
    v_mfma_f32_16x16x32_bf16 v[108:111], v[180:183], v[52:55], v[108:111]
    ds_read_b64_tr_b16 v[50:51], v3 offset:37888
    s_waitcnt lgkmcnt(10)
    v_mfma_f32_16x16x32_bf16 v[112:115], v[176:179], v[56:59], v[112:115]
    ds_read_b64_tr_b16 v[52:53], v4 offset:36864
    v_mfma_f32_16x16x32_bf16 v[116:119], v[180:183], v[56:59], v[116:119]
    ds_read_b64_tr_b16 v[54:55], v4 offset:37888
    v_mfma_f32_16x16x32_bf16 v[120:123], v[176:179], v[60:63], v[120:123]
    ds_read_b64_tr_b16 v[56:57], v5 offset:36864
    v_mfma_f32_16x16x32_bf16 v[124:127], v[180:183], v[60:63], v[124:127]
    ds_read_b64_tr_b16 v[58:59], v5 offset:37888
    s_waitcnt lgkmcnt(10)
    v_mfma_f32_16x16x32_bf16 v[128:131], v[32:35], v[176:179], v[128:131]
    ds_read_b64_tr_b16 v[60:61], v6 offset:36864
    v_mfma_f32_16x16x32_bf16 v[132:135], v[32:35], v[180:183], v[132:135]
    ds_read_b64_tr_b16 v[62:63], v6 offset:37888
    v_mfma_f32_16x16x32_bf16 v[136:139], v[36:39], v[176:179], v[136:139]
    ds_read_b64_tr_b16 v[32:33], v3 offset:40960
    v_mfma_f32_16x16x32_bf16 v[140:143], v[36:39], v[180:183], v[140:143]
    ds_read_b64_tr_b16 v[34:35], v3 offset:41984
    s_waitcnt lgkmcnt(10)
    v_mfma_f32_16x16x32_bf16 v[144:147], v[40:43], v[176:179], v[144:147]
    ds_read_b64_tr_b16 v[36:37], v4 offset:40960
    v_mfma_f32_16x16x32_bf16 v[148:151], v[40:43], v[180:183], v[148:151]
    ds_read_b64_tr_b16 v[38:39], v4 offset:41984
    v_mfma_f32_16x16x32_bf16 v[152:155], v[44:47], v[176:179], v[152:155]
    ds_read_b64_tr_b16 v[40:41], v5 offset:40960
    v_mfma_f32_16x16x32_bf16 v[156:159], v[44:47], v[180:183], v[156:159]
    ds_read_b64_tr_b16 v[42:43], v5 offset:41984
    s_waitcnt vmcnt(6) lgkmcnt(10)
    v_mfma_f32_16x16x32_bf16 v[64:67], v[48:51], v[184:187], v[64:67]
    ds_read_b64_tr_b16 v[44:45], v6 offset:40960
    s_add_u32 s42, s41, s87
    s_cbranch_vccnz xs1
    buffer_load_dwordx4 v[216:219], v2, s[4:7], s42 offen offset:2048 sc1
xs1:
    v_mfma_f32_16x16x32_bf16 v[68:71], v[48:51], v[188:191], v[68:71]
    ds_read_b64_tr_b16 v[46:47], v6 offset:41984
    v_mfma_f32_16x16x32_bf16 v[72:75], v[52:55], v[184:187], v[72:75]
    ds_read_b64_tr_b16 v[48:49], v3 offset:45056
    s_cbranch_vccnz xs2
    buffer_load_dwordx4 v[220:223], v2, s[4:7], s42 offen offset:2304 sc1
xs2:
    v_mfma_f32_16x16x32_bf16 v[76:79], v[52:55], v[188:191], v[76:79]
    ds_read_b64_tr_b16 v[50:51], v3 offset:46080
    s_waitcnt lgkmcnt(10)
    v_mfma_f32_16x16x32_bf16 v[80:83], v[56:59], v[184:187], v[80:83]
    ds_read_b64_tr_b16 v[52:53], v4 offset:45056
    s_add_u32 s42, s41, s88
    buffer_load_dwordx4 v[224:227], v2, s[4:7], s42 offen offset:0 sc1
    v_mfma_f32_16x16x32_bf16 v[84:87], v[56:59], v[188:191], v[84:87]
    ds_read_b64_tr_b16 v[54:55], v4 offset:46080
    v_mfma_f32_16x16x32_bf16 v[88:91], v[60:63], v[184:187], v[88:91]
    ds_read_b64_tr_b16 v[56:57], v5 offset:45056
    buffer_load_dwordx4 v[228:231], v2, s[4:7], s42 offen offset:256 sc1
    v_mfma_f32_16x16x32_bf16 v[92:95], v[60:63], v[188:191], v[92:95]
    ds_read_b64_tr_b16 v[58:59], v5 offset:46080
    s_waitcnt lgkmcnt(10)
    v_mfma_f32_16x16x32_bf16 v[96:99], v[184:187], v[32:35], v[96:99]
    ds_read_b64_tr_b16 v[60:61], v6 offset:45056
    buffer_load_dwordx4 v[232:235], v2, s[4:7], s42 offen offset:2048 sc1
    v_mfma_f32_16x16x32_bf16 v[100:103], v[188:191], v[32:35], v[100:103]
    ds_read_b64_tr_b16 v[62:63], v6 offset:46080
    v_mfma_f32_16x16x32_bf16 v[104:107], v[184:187], v[36:39], v[104:107]
    ds_read_b64_tr_b16 v[32:33], v3 offset:49152
    buffer_load_dwordx4 v[236:239], v2, s[4:7], s42 offen offset:2304 sc1
    v_mfma_f32_16x16x32_bf16 v[108:111], v[188:191], v[36:39], v[108:111]
    ds_read_b64_tr_b16 v[34:35], v3 offset:50176
    s_waitcnt lgkmcnt(10)
    v_mfma_f32_16x16x32_bf16 v[112:115], v[184:187], v[40:43], v[112:115]
    ds_read_b64_tr_b16 v[36:37], v4 offset:49152
    s_add_u32 s42, s41, s89
    buffer_load_dwordx4 v[240:243], v2, s[4:7], s42 offen offset:0 sc1
    v_mfma_f32_16x16x32_bf16 v[116:119], v[188:191], v[40:43], v[116:119]
    ds_read_b64_tr_b16 v[38:39], v4 offset:50176
    v_mfma_f32_16x16x32_bf16 v[120:123], v[184:187], v[44:47], v[120:123]
    ds_read_b64_tr_b16 v[40:41], v5 offset:49152
    buffer_load_dwordx4 v[244:247], v2, s[4:7], s42 offen offset:256 sc1
    v_mfma_f32_16x16x32_bf16 v[124:127], v[188:191], v[44:47], v[124:127]
    ds_read_b64_tr_b16 v[42:43], v5 offset:50176
    s_waitcnt lgkmcnt(10)
    v_mfma_f32_16x16x32_bf16 v[128:131], v[48:51], v[184:187], v[128:131]
    ds_read_b64_tr_b16 v[44:45], v6 offset:49152
    buffer_load_dwordx4 v[248:251], v2, s[4:7], s42 offen offset:2048 sc1
    v_mfma_f32_16x16x32_bf16 v[132:135], v[48:51], v[188:191], v[132:135]
    ds_read_b64_tr_b16 v[46:47], v6 offset:50176
    v_mfma_f32_16x16x32_bf16 v[136:139], v[52:55], v[184:187], v[136:139]
    ds_read_b64_tr_b16 v[48:49], v3 offset:53248
    v_mfma_f32_16x16x32_bf16 v[140:143], v[52:55], v[188:191], v[140:143]
    ds_read_b64_tr_b16 v[50:51], v3 offset:54272
    s_waitcnt lgkmcnt(10)
    v_mfma_f32_16x16x32_bf16 v[144:147], v[56:59], v[184:187], v[144:147]
    ds_read_b64_tr_b16 v[52:53], v4 offset:53248
    v_mfma_f32_16x16x32_bf16 v[148:151], v[56:59], v[188:191], v[148:151]
    ds_read_b64_tr_b16 v[54:55], v4 offset:54272
    v_mfma_f32_16x16x32_bf16 v[152:155], v[60:63], v[184:187], v[152:155]
    ds_read_b64_tr_b16 v[56:57], v5 offset:53248
    v_mfma_f32_16x16x32_bf16 v[156:159], v[60:63], v[188:191], v[156:159]
    ds_read_b64_tr_b16 v[58:59], v5 offset:54272
    s_waitcnt vmcnt(13) lgkmcnt(10)
    v_mfma_f32_16x16x32_bf16 v[64:67], v[32:35], v[192:195], v[64:67]
    ds_read_b64_tr_b16 v[60:61], v6 offset:53248
    buffer_load_dwordx4 v[252:255], v2, s[4:7], s42 offen offset:2304 sc1
    v_mfma_f32_16x16x32_bf16 v[68:71], v[32:35], v[196:199], v[68:71]
    ds_read_b64_tr_b16 v[62:63], v6 offset:54272
    v_mfma_f32_16x16x32_bf16 v[72:75], v[36:39], v[192:195], v[72:75]
    ds_read_b64_tr_b16 v[32:33], v3 offset:57344
    v_mfma_f32_16x16x32_bf16 v[76:79], v[36:39], v[196:199], v[76:79]
    ds_read_b64_tr_b16 v[34:35], v3 offset:58368
    s_waitcnt lgkmcnt(10)
    v_mfma_f32_16x16x32_bf16 v[80:83], v[40:43], v[192:195], v[80:83]
    ds_read_b64_tr_b16 v[36:37], v4 offset:57344
    v_mfma_f32_16x16x32_bf16 v[84:87], v[40:43], v[196:199], v[84:87]
    ds_read_b64_tr_b16 v[38:39], v4 offset:58368
    v_mfma_f32_16x16x32_bf16 v[88:91], v[44:47], v[192:195], v[88:91]
    ds_read_b64_tr_b16 v[40:41], v5 offset:57344
    v_mfma_f32_16x16x32_bf16 v[92:95], v[44:47], v[196:199], v[92:95]
    ds_read_b64_tr_b16 v[42:43], v5 offset:58368
    s_waitcnt lgkmcnt(10)
    v_mfma_f32_16x16x32_bf16 v[96:99], v[192:195], v[48:51], v[96:99]
    ds_read_b64_tr_b16 v[44:45], v6 offset:57344
    s_add_u32 s42, s41, s90
    buffer_load_dwordx4 v[160:163], v2, s[4:7], s42 offen offset:0 sc1
    v_mfma_f32_16x16x32_bf16 v[100:103], v[196:199], v[48:51], v[100:103]
    ds_read_b64_tr_b16 v[46:47], v6 offset:58368
    v_mfma_f32_16x16x32_bf16 v[104:107], v[192:195], v[52:55], v[104:107]
    ds_read_b64_tr_b16 v[48:49], v3 offset:61440
    v_mfma_f32_16x16x32_bf16 v[108:111], v[196:199], v[52:55], v[108:111]
    ds_read_b64_tr_b16 v[50:51], v3 offset:62464
    s_waitcnt lgkmcnt(10)
    v_mfma_f32_16x16x32_bf16 v[112:115], v[192:195], v[56:59], v[112:115]
    ds_read_b64_tr_b16 v[52:53], v4 offset:61440
    v_mfma_f32_16x16x32_bf16 v[116:119], v[196:199], v[56:59], v[116:119]
    ds_read_b64_tr_b16 v[54:55], v4 offset:62464
    v_mfma_f32_16x16x32_bf16 v[120:123], v[192:195], v[60:63], v[120:123]
    ds_read_b64_tr_b16 v[56:57], v5 offset:61440
    v_mfma_f32_16x16x32_bf16 v[124:127], v[196:199], v[60:63], v[124:127]
    ds_read_b64_tr_b16 v[58:59], v5 offset:62464
    s_waitcnt lgkmcnt(10)
    v_mfma_f32_16x16x32_bf16 v[128:131], v[32:35], v[192:195], v[128:131]
    ds_read_b64_tr_b16 v[60:61], v6 offset:61440
    v_mfma_f32_16x16x32_bf16 v[132:135], v[32:35], v[196:199], v[132:135]
    ds_read_b64_tr_b16 v[62:63], v6 offset:62464
    s_barrier
    v_xor_b32 v3, 0x10000, v3
    v_xor_b32 v4, 0x10000, v4
    v_xor_b32 v5, 0x10000, v5
    v_xor_b32 v6, 0x10000, v6
    v_mfma_f32_16x16x32_bf16 v[136:139], v[36:39], v[192:195], v[136:139]
    ds_read_b64_tr_b16 v[32:33], v3 offset:0
    v_mfma_f32_16x16x32_bf16 v[140:143], v[36:39], v[196:199], v[140:143]
    ds_read_b64_tr_b16 v[34:35], v3 offset:1024
    s_waitcnt lgkmcnt(10)
    v_mfma_f32_16x16x32_bf16 v[144:147], v[40:43], v[192:195], v[144:147]
    ds_read_b64_tr_b16 v[36:37], v4 offset:0
    v_mfma_f32_16x16x32_bf16 v[148:151], v[40:43], v[196:199], v[148:151]
    ds_read_b64_tr_b16 v[38:39], v4 offset:1024
    v_mfma_f32_16x16x32_bf16 v[152:155], v[44:47], v[192:195], v[152:155]
    ds_read_b64_tr_b16 v[40:41], v5 offset:0
    v_mfma_f32_16x16x32_bf16 v[156:159], v[44:47], v[196:199], v[156:159]
    ds_read_b64_tr_b16 v[42:43], v5 offset:1024
    s_waitcnt vmcnt(13) lgkmcnt(10)
    v_mfma_f32_16x16x32_bf16 v[64:67], v[48:51], v[200:203], v[64:67]
    ds_read_b64_tr_b16 v[44:45], v6 offset:0
    v_mfma_f32_16x16x32_bf16 v[68:71], v[48:51], v[204:207], v[68:71]
    ds_read_b64_tr_b16 v[46:47], v6 offset:1024
    v_mfma_f32_16x16x32_bf16 v[72:75], v[52:55], v[200:203], v[72:75]
    ds_read_b64_tr_b16 v[48:49], v3 offset:4096
    v_mfma_f32_16x16x32_bf16 v[76:79], v[52:55], v[204:207], v[76:79]
    ds_read_b64_tr_b16 v[50:51], v3 offset:5120
    s_waitcnt lgkmcnt(10)
    v_mfma_f32_16x16x32_bf16 v[80:83], v[56:59], v[200:203], v[80:83]
    ds_read_b64_tr_b16 v[52:53], v4 offset:4096
    v_mfma_f32_16x16x32_bf16 v[84:87], v[56:59], v[204:207], v[84:87]
    ds_read_b64_tr_b16 v[54:55], v4 offset:5120
    v_mfma_f32_16x16x32_bf16 v[88:91], v[60:63], v[200:203], v[88:91]
    ds_read_b64_tr_b16 v[56:57], v5 offset:4096
    v_mfma_f32_16x16x32_bf16 v[92:95], v[60:63], v[204:207], v[92:95]
    ds_read_b64_tr_b16 v[58:59], v5 offset:5120
    s_waitcnt lgkmcnt(10)
    v_mfma_f32_16x16x32_bf16 v[96:99], v[200:203], v[32:35], v[96:99]
    ds_read_b64_tr_b16 v[60:61], v6 offset:4096
    v_mfma_f32_16x16x32_bf16 v[100:103], v[204:207], v[32:35], v[100:103]
    ds_read_b64_tr_b16 v[62:63], v6 offset:5120
    v_mfma_f32_16x16x32_bf16 v[104:107], v[200:203], v[36:39], v[104:107]
    ds_read_b64_tr_b16 v[32:33], v3 offset:8192
    v_mfma_f32_16x16x32_bf16 v[108:111], v[204:207], v[36:39], v[108:111]
    ds_read_b64_tr_b16 v[34:35], v3 offset:9216
    s_waitcnt lgkmcnt(10)
    v_mfma_f32_16x16x32_bf16 v[112:115], v[200:203], v[40:43], v[112:115]
    ds_read_b64_tr_b16 v[36:37], v4 offset:8192
    v_mfma_f32_16x16x32_bf16 v[116:119], v[204:207], v[40:43], v[116:119]
    ds_read_b64_tr_b16 v[38:39], v4 offset:9216
    v_mfma_f32_16x16x32_bf16 v[120:123], v[200:203], v[44:47], v[120:123]
    ds_read_b64_tr_b16 v[40:41], v5 offset:8192
    v_mfma_f32_16x16x32_bf16 v[124:127], v[204:207], v[44:47], v[124:127]
    ds_read_b64_tr_b16 v[42:43], v5 offset:9216
    s_waitcnt lgkmcnt(10)
    v_mfma_f32_16x16x32_bf16 v[128:131], v[48:51], v[200:203], v[128:131]
    ds_read_b64_tr_b16 v[44:45], v6 offset:8192
    v_mfma_f32_16x16x32_bf16 v[132:135], v[48:51], v[204:207], v[132:135]
    ds_read_b64_tr_b16 v[46:47], v6 offset:9216
    v_mfma_f32_16x16x32_bf16 v[136:139], v[52:55], v[200:203], v[136:139]
    ds_read_b64_tr_b16 v[48:49], v3 offset:12288
    v_mfma_f32_16x16x32_bf16 v[140:143], v[52:55], v[204:207], v[140:143]
    ds_read_b64_tr_b16 v[50:51], v3 offset:13312
    s_waitcnt lgkmcnt(10)
    v_mfma_f32_16x16x32_bf16 v[144:147], v[56:59], v[200:203], v[144:147]
    ds_read_b64_tr_b16 v[52:53], v4 offset:12288
    v_mfma_f32_16x16x32_bf16 v[148:151], v[56:59], v[204:207], v[148:151]
    ds_read_b64_tr_b16 v[54:55], v4 offset:13312
    v_mfma_f32_16x16x32_bf16 v[152:155], v[60:63], v[200:203], v[152:155]
    ds_read_b64_tr_b16 v[56:57], v5 offset:12288
    v_mfma_f32_16x16x32_bf16 v[156:159], v[60:63], v[204:207], v[156:159]
    ds_read_b64_tr_b16 v[58:59], v5 offset:13312
    s_waitcnt vmcnt(11) lgkmcnt(10)
    v_mfma_f32_16x16x32_bf16 v[64:67], v[32:35], v[208:211], v[64:67]
    ds_read_b64_tr_b16 v[60:61], v6 offset:12288
    v_mfma_f32_16x16x32_bf16 v[68:71], v[32:35], v[212:215], v[68:71]
    ds_read_b64_tr_b16 v[62:63], v6 offset:13312
    v_mfma_f32_16x16x32_bf16 v[72:75], v[36:39], v[208:211], v[72:75]
    ds_read_b64_tr_b16 v[32:33], v3 offset:16384
    v_mfma_f32_16x16x32_bf16 v[76:79], v[36:39], v[212:215], v[76:79]
    ds_read_b64_tr_b16 v[34:35], v3 offset:17408
    s_waitcnt lgkmcnt(10)
    v_mfma_f32_16x16x32_bf16 v[80:83], v[40:43], v[208:211], v[80:83]
    ds_read_b64_tr_b16 v[36:37], v4 offset:16384
    v_mfma_f32_16x16x32_bf16 v[84:87], v[40:43], v[212:215], v[84:87]
    ds_read_b64_tr_b16 v[38:39], v4 offset:17408
    v_mfma_f32_16x16x32_bf16 v[88:91], v[44:47], v[208:211], v[88:91]
    ds_read_b64_tr_b16 v[40:41], v5 offset:16384
    v_mfma_f32_16x16x32_bf16 v[92:95], v[44:47], v[212:215], v[92:95]
    ds_read_b64_tr_b16 v[42:43], v5 offset:17408
    s_waitcnt lgkmcnt(10)
    v_mfma_f32_16x16x32_bf16 v[96:99], v[208:211], v[48:51], v[96:99]
    ds_read_b64_tr_b16 v[44:45], v6 offset:16384
    buffer_load_dwordx4 v[164:167], v2, s[4:7], s42 offen offset:256 sc1
    v_mfma_f32_16x16x32_bf16 v[100:103], v[212:215], v[48:51], v[100:103]
    ds_read_b64_tr_b16 v[46:47], v6 offset:17408
    v_mfma_f32_16x16x32_bf16 v[104:107], v[208:211], v[52:55], v[104:107]
    ds_read_b64_tr_b16 v[48:49], v3 offset:20480
    buffer_load_dwordx4 v[168:171], v2, s[4:7], s42 offen offset:2048 sc1
    v_mfma_f32_16x16x32_bf16 v[108:111], v[212:215], v[52:55], v[108:111]
    ds_read_b64_tr_b16 v[50:51], v3 offset:21504
    s_waitcnt lgkmcnt(10)
    v_mfma_f32_16x16x32_bf16 v[112:115], v[208:211], v[56:59], v[112:115]
    ds_read_b64_tr_b16 v[52:53], v4 offset:20480
    buffer_load_dwordx4 v[172:175], v2, s[4:7], s42 offen offset:2304 sc1
    v_mfma_f32_16x16x32_bf16 v[116:119], v[212:215], v[56:59], v[116:119]
    ds_read_b64_tr_b16 v[54:55], v4 offset:21504
    v_mfma_f32_16x16x32_bf16 v[120:123], v[208:211], v[60:63], v[120:123]
    ds_read_b64_tr_b16 v[56:57], v5 offset:20480
    s_add_u32 s42, s41, s91
    buffer_load_dwordx4 v[176:179], v2, s[4:7], s42 offen offset:0 sc1
    v_mfma_f32_16x16x32_bf16 v[124:127], v[212:215], v[60:63], v[124:127]
    ds_read_b64_tr_b16 v[58:59], v5 offset:21504
    s_waitcnt lgkmcnt(10)
    v_mfma_f32_16x16x32_bf16 v[128:131], v[32:35], v[208:211], v[128:131]
    ds_read_b64_tr_b16 v[60:61], v6 offset:20480
    buffer_load_dwordx4 v[180:183], v2, s[4:7], s42 offen offset:256 sc1
    v_mfma_f32_16x16x32_bf16 v[132:135], v[32:35], v[212:215], v[132:135]
    ds_read_b64_tr_b16 v[62:63], v6 offset:21504
    v_mfma_f32_16x16x32_bf16 v[136:139], v[36:39], v[208:211], v[136:139]
    ds_read_b64_tr_b16 v[32:33], v3 offset:24576
    buffer_load_dwordx4 v[184:187], v2, s[4:7], s42 offen offset:2048 sc1
    v_mfma_f32_16x16x32_bf16 v[140:143], v[36:39], v[212:215], v[140:143]
    ds_read_b64_tr_b16 v[34:35], v3 offset:25600
    s_waitcnt lgkmcnt(10)
    v_mfma_f32_16x16x32_bf16 v[144:147], v[40:43], v[208:211], v[144:147]
    ds_read_b64_tr_b16 v[36:37], v4 offset:24576
    v_mfma_f32_16x16x32_bf16 v[148:151], v[40:43], v[212:215], v[148:151]
    ds_read_b64_tr_b16 v[38:39], v4 offset:25600
    v_mfma_f32_16x16x32_bf16 v[152:155], v[44:47], v[208:211], v[152:155]
    ds_read_b64_tr_b16 v[40:41], v5 offset:24576
    v_mfma_f32_16x16x32_bf16 v[156:159], v[44:47], v[212:215], v[156:159]
    ds_read_b64_tr_b16 v[42:43], v5 offset:25600
    s_waitcnt vmcnt(15) lgkmcnt(10)
    v_mfma_f32_16x16x32_bf16 v[64:67], v[48:51], v[216:219], v[64:67]
    ds_read_b64_tr_b16 v[44:45], v6 offset:24576
    v_mfma_f32_16x16x32_bf16 v[68:71], v[48:51], v[220:223], v[68:71]
    ds_read_b64_tr_b16 v[46:47], v6 offset:25600
    v_mfma_f32_16x16x32_bf16 v[72:75], v[52:55], v[216:219], v[72:75]
    ds_read_b64_tr_b16 v[48:49], v3 offset:28672
    v_mfma_f32_16x16x32_bf16 v[76:79], v[52:55], v[220:223], v[76:79]
    ds_read_b64_tr_b16 v[50:51], v3 offset:29696
    s_waitcnt lgkmcnt(10)
    v_mfma_f32_16x16x32_bf16 v[80:83], v[56:59], v[216:219], v[80:83]
    ds_read_b64_tr_b16 v[52:53], v4 offset:28672
    buffer_load_dwordx4 v[188:191], v2, s[4:7], s42 offen offset:2304 sc1
    v_mfma_f32_16x16x32_bf16 v[84:87], v[56:59], v[220:223], v[84:87]
    ds_read_b64_tr_b16 v[54:55], v4 offset:29696
    v_mfma_f32_16x16x32_bf16 v[88:91], v[60:63], v[216:219], v[88:91]
    ds_read_b64_tr_b16 v[56:57], v5 offset:28672
    v_mfma_f32_16x16x32_bf16 v[92:95], v[60:63], v[220:223], v[92:95]
    ds_read_b64_tr_b16 v[58:59], v5 offset:29696
    s_waitcnt lgkmcnt(10)
    v_mfma_f32_16x16x32_bf16 v[96:99], v[216:219], v[32:35], v[96:99]
    ds_read_b64_tr_b16 v[60:61], v6 offset:28672
    v_mfma_f32_16x16x32_bf16 v[100:103], v[220:223], v[32:35], v[100:103]
    ds_read_b64_tr_b16 v[62:63], v6 offset:29696
    s_barrier
    v_mfma_f32_16x16x32_bf16 v[104:107], v[216:219], v[36:39], v[104:107]
    ds_read_b64_tr_b16 v[32:33], v3 offset:32768
    v_mfma_f32_16x16x32_bf16 v[108:111], v[220:223], v[36:39], v[108:111]
    ds_read_b64_tr_b16 v[34:35], v3 offset:33792
    s_waitcnt lgkmcnt(10)
    v_mfma_f32_16x16x32_bf16 v[112:115], v[216:219], v[40:43], v[112:115]
    ds_read_b64_tr_b16 v[36:37], v4 offset:32768
    v_mfma_f32_16x16x32_bf16 v[116:119], v[220:223], v[40:43], v[116:119]
    ds_read_b64_tr_b16 v[38:39], v4 offset:33792
    v_mfma_f32_16x16x32_bf16 v[120:123], v[216:219], v[44:47], v[120:123]
    ds_read_b64_tr_b16 v[40:41], v5 offset:32768
    v_mfma_f32_16x16x32_bf16 v[124:127], v[220:223], v[44:47], v[124:127]
    ds_read_b64_tr_b16 v[42:43], v5 offset:33792
    s_waitcnt lgkmcnt(10)
    v_mfma_f32_16x16x32_bf16 v[128:131], v[48:51], v[216:219], v[128:131]
    ds_read_b64_tr_b16 v[44:45], v6 offset:32768
    v_mfma_f32_16x16x32_bf16 v[132:135], v[48:51], v[220:223], v[132:135]
    ds_read_b64_tr_b16 v[46:47], v6 offset:33792
    v_mfma_f32_16x16x32_bf16 v[136:139], v[52:55], v[216:219], v[136:139]
    ds_read_b64_tr_b16 v[48:49], v3 offset:36864
    v_mfma_f32_16x16x32_bf16 v[140:143], v[52:55], v[220:223], v[140:143]
    ds_read_b64_tr_b16 v[50:51], v3 offset:37888
    s_waitcnt lgkmcnt(10)
    v_mfma_f32_16x16x32_bf16 v[144:147], v[56:59], v[216:219], v[144:147]
    ds_read_b64_tr_b16 v[52:53], v4 offset:36864
    v_mfma_f32_16x16x32_bf16 v[148:151], v[56:59], v[220:223], v[148:151]
    ds_read_b64_tr_b16 v[54:55], v4 offset:37888
    v_mfma_f32_16x16x32_bf16 v[152:155], v[60:63], v[216:219], v[152:155]
    ds_read_b64_tr_b16 v[56:57], v5 offset:36864
    v_mfma_f32_16x16x32_bf16 v[156:159], v[60:63], v[220:223], v[156:159]
    ds_read_b64_tr_b16 v[58:59], v5 offset:37888
    s_waitcnt vmcnt(14) lgkmcnt(10)
    v_mfma_f32_16x16x32_bf16 v[64:67], v[32:35], v[224:227], v[64:67]
    ds_read_b64_tr_b16 v[60:61], v6 offset:36864
    v_mfma_f32_16x16x32_bf16 v[68:71], v[32:35], v[228:231], v[68:71]
    ds_read_b64_tr_b16 v[62:63], v6 offset:37888
    v_mfma_f32_16x16x32_bf16 v[72:75], v[36:39], v[224:227], v[72:75]
    ds_read_b64_tr_b16 v[32:33], v3 offset:40960
    v_mfma_f32_16x16x32_bf16 v[76:79], v[36:39], v[228:231], v[76:79]
    ds_read_b64_tr_b16 v[34:35], v3 offset:41984
    s_waitcnt lgkmcnt(10)
    v_mfma_f32_16x16x32_bf16 v[80:83], v[40:43], v[224:227], v[80:83]
    ds_read_b64_tr_b16 v[36:37], v4 offset:40960
    v_mfma_f32_16x16x32_bf16 v[84:87], v[40:43], v[228:231], v[84:87]
    ds_read_b64_tr_b16 v[38:39], v4 offset:41984
    v_mfma_f32_16x16x32_bf16 v[88:91], v[44:47], v[224:227], v[88:91]
    ds_read_b64_tr_b16 v[40:41], v5 offset:40960
    v_mfma_f32_16x16x32_bf16 v[92:95], v[44:47], v[228:231], v[92:95]
    ds_read_b64_tr_b16 v[42:43], v5 offset:41984
    s_waitcnt lgkmcnt(10)
    v_mfma_f32_16x16x32_bf16 v[96:99], v[224:227], v[48:51], v[96:99]
    ds_read_b64_tr_b16 v[44:45], v6 offset:40960
    v_mfma_f32_16x16x32_bf16 v[100:103], v[228:231], v[48:51], v[100:103]
    ds_read_b64_tr_b16 v[46:47], v6 offset:41984
    v_mfma_f32_16x16x32_bf16 v[104:107], v[224:227], v[52:55], v[104:107]
    ds_read_b64_tr_b16 v[48:49], v3 offset:45056
    v_mfma_f32_16x16x32_bf16 v[108:111], v[228:231], v[52:55], v[108:111]
    ds_read_b64_tr_b16 v[50:51], v3 offset:46080
    s_waitcnt lgkmcnt(10)
    v_mfma_f32_16x16x32_bf16 v[112:115], v[224:227], v[56:59], v[112:115]
    ds_read_b64_tr_b16 v[52:53], v4 offset:45056
    v_mfma_f32_16x16x32_bf16 v[116:119], v[228:231], v[56:59], v[116:119]
    ds_read_b64_tr_b16 v[54:55], v4 offset:46080
    v_mfma_f32_16x16x32_bf16 v[120:123], v[224:227], v[60:63], v[120:123]
    ds_read_b64_tr_b16 v[56:57], v5 offset:45056
    v_mfma_f32_16x16x32_bf16 v[124:127], v[228:231], v[60:63], v[124:127]
    ds_read_b64_tr_b16 v[58:59], v5 offset:46080
    s_waitcnt lgkmcnt(10)
    v_mfma_f32_16x16x32_bf16 v[128:131], v[32:35], v[224:227], v[128:131]
    ds_read_b64_tr_b16 v[60:61], v6 offset:45056
    v_mfma_f32_16x16x32_bf16 v[132:135], v[32:35], v[228:231], v[132:135]
    ds_read_b64_tr_b16 v[62:63], v6 offset:46080
    v_mfma_f32_16x16x32_bf16 v[136:139], v[36:39], v[224:227], v[136:139]
    ds_read_b64_tr_b16 v[32:33], v3 offset:49152
    v_mfma_f32_16x16x32_bf16 v[140:143], v[36:39], v[228:231], v[140:143]
    ds_read_b64_tr_b16 v[34:35], v3 offset:50176
    s_waitcnt lgkmcnt(10)
    v_mfma_f32_16x16x32_bf16 v[144:147], v[40:43], v[224:227], v[144:147]
    ds_read_b64_tr_b16 v[36:37], v4 offset:49152
    v_mfma_f32_16x16x32_bf16 v[148:151], v[40:43], v[228:231], v[148:151]
    ds_read_b64_tr_b16 v[38:39], v4 offset:50176
    v_mfma_f32_16x16x32_bf16 v[152:155], v[44:47], v[224:227], v[152:155]
    ds_read_b64_tr_b16 v[40:41], v5 offset:49152
    v_mfma_f32_16x16x32_bf16 v[156:159], v[44:47], v[228:231], v[156:159]
    ds_read_b64_tr_b16 v[42:43], v5 offset:50176
    s_waitcnt vmcnt(12) lgkmcnt(10)
    v_mfma_f32_16x16x32_bf16 v[64:67], v[48:51], v[232:235], v[64:67]
    ds_read_b64_tr_b16 v[44:45], v6 offset:49152
    s_add_u32 s42, s41, s92
    buffer_load_dwordx4 v[192:195], v2, s[4:7], s42 offen offset:0 sc1
    v_mfma_f32_16x16x32_bf16 v[68:71], v[48:51], v[236:239], v[68:71]
    ds_read_b64_tr_b16 v[46:47], v6 offset:50176
    v_mfma_f32_16x16x32_bf16 v[72:75], v[52:55], v[232:235], v[72:75]
    ds_read_b64_tr_b16 v[48:49], v3 offset:53248
    buffer_load_dwordx4 v[196:199], v2, s[4:7], s42 offen offset:256 sc1
    v_mfma_f32_16x16x32_bf16 v[76:79], v[52:55], v[236:239], v[76:79]
    ds_read_b64_tr_b16 v[50:51], v3 offset:54272
    s_waitcnt lgkmcnt(10)
    v_mfma_f32_16x16x32_bf16 v[80:83], v[56:59], v[232:235], v[80:83]
    ds_read_b64_tr_b16 v[52:53], v4 offset:53248
    buffer_load_dwordx4 v[200:203], v2, s[4:7], s42 offen offset:2048 sc1
    v_mfma_f32_16x16x32_bf16 v[84:87], v[56:59], v[236:239], v[84:87]
    ds_read_b64_tr_b16 v[54:55], v4 offset:54272
    v_mfma_f32_16x16x32_bf16 v[88:91], v[60:63], v[232:235], v[88:91]
    ds_read_b64_tr_b16 v[56:57], v5 offset:53248
    buffer_load_dwordx4 v[204:207], v2, s[4:7], s42 offen offset:2304 sc1
    v_mfma_f32_16x16x32_bf16 v[92:95], v[60:63], v[236:239], v[92:95]
    ds_read_b64_tr_b16 v[58:59], v5 offset:54272
    s_waitcnt lgkmcnt(10)
    v_mfma_f32_16x16x32_bf16 v[96:99], v[232:235], v[32:35], v[96:99]
    ds_read_b64_tr_b16 v[60:61], v6 offset:53248
    s_add_u32 s42, s41, s93
    buffer_load_dwordx4 v[208:211], v2, s[4:7], s42 offen offset:0 sc1
    v_mfma_f32_16x16x32_bf16 v[100:103], v[236:239], v[32:35], v[100:103]
    ds_read_b64_tr_b16 v[62:63], v6 offset:54272
    v_mfma_f32_16x16x32_bf16 v[104:107], v[232:235], v[36:39], v[104:107]
    ds_read_b64_tr_b16 v[32:33], v3 offset:57344
    v_mfma_f32_16x16x32_bf16 v[108:111], v[236:239], v[36:39], v[108:111]
    ds_read_b64_tr_b16 v[34:35], v3 offset:58368
    s_waitcnt lgkmcnt(10)
    v_mfma_f32_16x16x32_bf16 v[112:115], v[232:235], v[40:43], v[112:115]
    ds_read_b64_tr_b16 v[36:37], v4 offset:57344
    v_mfma_f32_16x16x32_bf16 v[116:119], v[236:239], v[40:43], v[116:119]
    ds_read_b64_tr_b16 v[38:39], v4 offset:58368
    v_mfma_f32_16x16x32_bf16 v[120:123], v[232:235], v[44:47], v[120:123]
    ds_read_b64_tr_b16 v[40:41], v5 offset:57344
    buffer_load_dwordx4 v[212:215], v2, s[4:7], s42 offen offset:256 sc1
    v_mfma_f32_16x16x32_bf16 v[124:127], v[236:239], v[44:47], v[124:127]
    ds_read_b64_tr_b16 v[42:43], v5 offset:58368
    s_waitcnt lgkmcnt(10)
    v_mfma_f32_16x16x32_bf16 v[128:131], v[48:51], v[232:235], v[128:131]
    ds_read_b64_tr_b16 v[44:45], v6 offset:57344
    v_mfma_f32_16x16x32_bf16 v[132:135], v[48:51], v[236:239], v[132:135]
    ds_read_b64_tr_b16 v[46:47], v6 offset:58368
    v_mfma_f32_16x16x32_bf16 v[136:139], v[52:55], v[232:235], v[136:139]
    ds_read_b64_tr_b16 v[48:49], v3 offset:61440
    v_mfma_f32_16x16x32_bf16 v[140:143], v[52:55], v[236:239], v[140:143]
    ds_read_b64_tr_b16 v[50:51], v3 offset:62464
    s_waitcnt lgkmcnt(10)
    v_mfma_f32_16x16x32_bf16 v[144:147], v[56:59], v[232:235], v[144:147]
    ds_read_b64_tr_b16 v[52:53], v4 offset:61440
    v_mfma_f32_16x16x32_bf16 v[148:151], v[56:59], v[236:239], v[148:151]
    ds_read_b64_tr_b16 v[54:55], v4 offset:62464
    v_mfma_f32_16x16x32_bf16 v[152:155], v[60:63], v[232:235], v[152:155]
    ds_read_b64_tr_b16 v[56:57], v5 offset:61440
    v_mfma_f32_16x16x32_bf16 v[156:159], v[60:63], v[236:239], v[156:159]
    ds_read_b64_tr_b16 v[58:59], v5 offset:62464
    s_waitcnt vmcnt(16) lgkmcnt(10)
    v_mfma_f32_16x16x32_bf16 v[64:67], v[32:35], v[240:243], v[64:67]
    ds_read_b64_tr_b16 v[60:61], v6 offset:61440
    v_mfma_f32_16x16x32_bf16 v[68:71], v[32:35], v[244:247], v[68:71]
    ds_read_b64_tr_b16 v[62:63], v6 offset:62464
    s_barrier
    v_xor_b32 v3, 0x10000, v3
    v_xor_b32 v4, 0x10000, v4
    v_xor_b32 v5, 0x10000, v5
    v_xor_b32 v6, 0x10000, v6
    v_mfma_f32_16x16x32_bf16 v[72:75], v[36:39], v[240:243], v[72:75]
    ds_read_b64_tr_b16 v[32:33], v3 offset:0
    v_mfma_f32_16x16x32_bf16 v[76:79], v[36:39], v[244:247], v[76:79]
    ds_read_b64_tr_b16 v[34:35], v3 offset:1024
    s_waitcnt lgkmcnt(10)
    v_mfma_f32_16x16x32_bf16 v[80:83], v[40:43], v[240:243], v[80:83]
    ds_read_b64_tr_b16 v[36:37], v4 offset:0
    v_mfma_f32_16x16x32_bf16 v[84:87], v[40:43], v[244:247], v[84:87]
    ds_read_b64_tr_b16 v[38:39], v4 offset:1024
    v_mfma_f32_16x16x32_bf16 v[88:91], v[44:47], v[240:243], v[88:91]
    ds_read_b64_tr_b16 v[40:41], v5 offset:0
    v_mfma_f32_16x16x32_bf16 v[92:95], v[44:47], v[244:247], v[92:95]
    ds_read_b64_tr_b16 v[42:43], v5 offset:1024
    s_waitcnt lgkmcnt(10)
    v_mfma_f32_16x16x32_bf16 v[96:99], v[240:243], v[48:51], v[96:99]
    ds_read_b64_tr_b16 v[44:45], v6 offset:0
    v_mfma_f32_16x16x32_bf16 v[100:103], v[244:247], v[48:51], v[100:103]
    ds_read_b64_tr_b16 v[46:47], v6 offset:1024
    v_mfma_f32_16x16x32_bf16 v[104:107], v[240:243], v[52:55], v[104:107]
    ds_read_b64_tr_b16 v[48:49], v3 offset:4096
    v_mfma_f32_16x16x32_bf16 v[108:111], v[244:247], v[52:55], v[108:111]
    ds_read_b64_tr_b16 v[50:51], v3 offset:5120
    s_waitcnt lgkmcnt(10)
    v_mfma_f32_16x16x32_bf16 v[112:115], v[240:243], v[56:59], v[112:115]
    ds_read_b64_tr_b16 v[52:53], v4 offset:4096
    v_mfma_f32_16x16x32_bf16 v[116:119], v[244:247], v[56:59], v[116:119]
    ds_read_b64_tr_b16 v[54:55], v4 offset:5120
    v_mfma_f32_16x16x32_bf16 v[120:123], v[240:243], v[60:63], v[120:123]
    ds_read_b64_tr_b16 v[56:57], v5 offset:4096
    v_mfma_f32_16x16x32_bf16 v[124:127], v[244:247], v[60:63], v[124:127]
    ds_read_b64_tr_b16 v[58:59], v5 offset:5120
    s_waitcnt lgkmcnt(10)
    v_mfma_f32_16x16x32_bf16 v[128:131], v[32:35], v[240:243], v[128:131]
    ds_read_b64_tr_b16 v[60:61], v6 offset:4096
    v_mfma_f32_16x16x32_bf16 v[132:135], v[32:35], v[244:247], v[132:135]
    ds_read_b64_tr_b16 v[62:63], v6 offset:5120
    v_mfma_f32_16x16x32_bf16 v[136:139], v[36:39], v[240:243], v[136:139]
    ds_read_b64_tr_b16 v[32:33], v3 offset:8192
    v_mfma_f32_16x16x32_bf16 v[140:143], v[36:39], v[244:247], v[140:143]
    ds_read_b64_tr_b16 v[34:35], v3 offset:9216
    s_waitcnt lgkmcnt(10)
    v_mfma_f32_16x16x32_bf16 v[144:147], v[40:43], v[240:243], v[144:147]
    ds_read_b64_tr_b16 v[36:37], v4 offset:8192
    v_mfma_f32_16x16x32_bf16 v[148:151], v[40:43], v[244:247], v[148:151]
    ds_read_b64_tr_b16 v[38:39], v4 offset:9216
    v_mfma_f32_16x16x32_bf16 v[152:155], v[44:47], v[240:243], v[152:155]
    ds_read_b64_tr_b16 v[40:41], v5 offset:8192
    v_mfma_f32_16x16x32_bf16 v[156:159], v[44:47], v[244:247], v[156:159]
    ds_read_b64_tr_b16 v[42:43], v5 offset:9216
    s_waitcnt vmcnt(14) lgkmcnt(10)
    v_mfma_f32_16x16x32_bf16 v[64:67], v[48:51], v[248:251], v[64:67]
    ds_read_b64_tr_b16 v[44:45], v6 offset:8192
    v_mfma_f32_16x16x32_bf16 v[68:71], v[48:51], v[252:255], v[68:71]
    ds_read_b64_tr_b16 v[46:47], v6 offset:9216
    v_mfma_f32_16x16x32_bf16 v[72:75], v[52:55], v[248:251], v[72:75]
    ds_read_b64_tr_b16 v[48:49], v3 offset:12288
    v_mfma_f32_16x16x32_bf16 v[76:79], v[52:55], v[252:255], v[76:79]
    ds_read_b64_tr_b16 v[50:51], v3 offset:13312
    s_waitcnt lgkmcnt(10)
    v_mfma_f32_16x16x32_bf16 v[80:83], v[56:59], v[248:251], v[80:83]
    ds_read_b64_tr_b16 v[52:53], v4 offset:12288
    v_mfma_f32_16x16x32_bf16 v[84:87], v[56:59], v[252:255], v[84:87]
    ds_read_b64_tr_b16 v[54:55], v4 offset:13312
    v_mfma_f32_16x16x32_bf16 v[88:91], v[60:63], v[248:251], v[88:91]
    ds_read_b64_tr_b16 v[56:57], v5 offset:12288
    v_mfma_f32_16x16x32_bf16 v[92:95], v[60:63], v[252:255], v[92:95]
    ds_read_b64_tr_b16 v[58:59], v5 offset:13312
    s_waitcnt lgkmcnt(10)
    v_mfma_f32_16x16x32_bf16 v[96:99], v[248:251], v[32:35], v[96:99]
    ds_read_b64_tr_b16 v[60:61], v6 offset:12288
    v_mfma_f32_16x16x32_bf16 v[100:103], v[252:255], v[32:35], v[100:103]
    ds_read_b64_tr_b16 v[62:63], v6 offset:13312
    v_mfma_f32_16x16x32_bf16 v[104:107], v[248:251], v[36:39], v[104:107]
    ds_read_b64_tr_b16 v[32:33], v3 offset:16384
    v_mfma_f32_16x16x32_bf16 v[108:111], v[252:255], v[36:39], v[108:111]
    ds_read_b64_tr_b16 v[34:35], v3 offset:17408
    s_waitcnt lgkmcnt(10)
    v_mfma_f32_16x16x32_bf16 v[112:115], v[248:251], v[40:43], v[112:115]
    ds_read_b64_tr_b16 v[36:37], v4 offset:16384
    v_mfma_f32_16x16x32_bf16 v[116:119], v[252:255], v[40:43], v[116:119]
    ds_read_b64_tr_b16 v[38:39], v4 offset:17408
    v_mfma_f32_16x16x32_bf16 v[120:123], v[248:251], v[44:47], v[120:123]
    ds_read_b64_tr_b16 v[40:41], v5 offset:16384
    v_mfma_f32_16x16x32_bf16 v[124:127], v[252:255], v[44:47], v[124:127]
    ds_read_b64_tr_b16 v[42:43], v5 offset:17408
    s_waitcnt lgkmcnt(10)
    v_mfma_f32_16x16x32_bf16 v[128:131], v[48:51], v[248:251], v[128:131]
    ds_read_b64_tr_b16 v[44:45], v6 offset:16384
    buffer_load_dwordx4 v[216:219], v2, s[4:7], s42 offen offset:2048 sc1
    v_mfma_f32_16x16x32_bf16 v[132:135], v[48:51], v[252:255], v[132:135]
    ds_read_b64_tr_b16 v[46:47], v6 offset:17408
    v_mfma_f32_16x16x32_bf16 v[136:139], v[52:55], v[248:251], v[136:139]
    ds_read_b64_tr_b16 v[48:49], v3 offset:20480
    buffer_load_dwordx4 v[220:223], v2, s[4:7], s42 offen offset:2304 sc1
    v_mfma_f32_16x16x32_bf16 v[140:143], v[52:55], v[252:255], v[140:143]
    ds_read_b64_tr_b16 v[50:51], v3 offset:21504
    s_waitcnt lgkmcnt(10)
    v_mfma_f32_16x16x32_bf16 v[144:147], v[56:59], v[248:251], v[144:147]
    ds_read_b64_tr_b16 v[52:53], v4 offset:20480
    s_add_u32 s42, s41, s94
    buffer_load_dwordx4 v[224:227], v2, s[4:7], s42 offen offset:0 sc1
    v_mfma_f32_16x16x32_bf16 v[148:151], v[56:59], v[252:255], v[148:151]
    ds_read_b64_tr_b16 v[54:55], v4 offset:21504
    v_mfma_f32_16x16x32_bf16 v[152:155], v[60:63], v[248:251], v[152:155]
    ds_read_b64_tr_b16 v[56:57], v5 offset:20480
    buffer_load_dwordx4 v[228:231], v2, s[4:7], s42 offen offset:256 sc1
    v_mfma_f32_16x16x32_bf16 v[156:159], v[60:63], v[252:255], v[156:159]
    ds_read_b64_tr_b16 v[58:59], v5 offset:21504
    s_waitcnt vmcnt(16) lgkmcnt(10)
    v_mfma_f32_16x16x32_bf16 v[64:67], v[32:35], v[160:163], v[64:67]
    ds_read_b64_tr_b16 v[60:61], v6 offset:20480
    buffer_load_dwordx4 v[232:235], v2, s[4:7], s42 offen offset:2048 sc1
    v_mfma_f32_16x16x32_bf16 v[68:71], v[32:35], v[164:167], v[68:71]
    ds_read_b64_tr_b16 v[62:63], v6 offset:21504
    v_mfma_f32_16x16x32_bf16 v[72:75], v[36:39], v[160:163], v[72:75]
    ds_read_b64_tr_b16 v[32:33], v3 offset:24576
    buffer_load_dwordx4 v[236:239], v2, s[4:7], s42 offen offset:2304 sc1
    v_mfma_f32_16x16x32_bf16 v[76:79], v[36:39], v[164:167], v[76:79]
    ds_read_b64_tr_b16 v[34:35], v3 offset:25600
    s_waitcnt lgkmcnt(10)
    v_mfma_f32_16x16x32_bf16 v[80:83], v[40:43], v[160:163], v[80:83]
    ds_read_b64_tr_b16 v[36:37], v4 offset:24576
    v_mfma_f32_16x16x32_bf16 v[84:87], v[40:43], v[164:167], v[84:87]
    ds_read_b64_tr_b16 v[38:39], v4 offset:25600
    v_mfma_f32_16x16x32_bf16 v[88:91], v[44:47], v[160:163], v[88:91]
    ds_read_b64_tr_b16 v[40:41], v5 offset:24576
    v_mfma_f32_16x16x32_bf16 v[92:95], v[44:47], v[164:167], v[92:95]
    ds_read_b64_tr_b16 v[42:43], v5 offset:25600
    s_waitcnt lgkmcnt(10)
    v_mfma_f32_16x16x32_bf16 v[96:99], v[160:163], v[48:51], v[96:99]
    ds_read_b64_tr_b16 v[44:45], v6 offset:24576
    s_add_u32 s42, s41, s95
    buffer_load_dwordx4 v[240:243], v2, s[4:7], s42 offen offset:0 sc1
    v_mfma_f32_16x16x32_bf16 v[100:103], v[164:167], v[48:51], v[100:103]
    ds_read_b64_tr_b16 v[46:47], v6 offset:25600
    v_mfma_f32_16x16x32_bf16 v[104:107], v[160:163], v[52:55], v[104:107]
    ds_read_b64_tr_b16 v[48:49], v3 offset:28672
    v_mfma_f32_16x16x32_bf16 v[108:111], v[164:167], v[52:55], v[108:111]
    ds_read_b64_tr_b16 v[50:51], v3 offset:29696
    s_waitcnt lgkmcnt(10)
    v_mfma_f32_16x16x32_bf16 v[112:115], v[160:163], v[56:59], v[112:115]
    ds_read_b64_tr_b16 v[52:53], v4 offset:28672
    v_mfma_f32_16x16x32_bf16 v[116:119], v[164:167], v[56:59], v[116:119]
    ds_read_b64_tr_b16 v[54:55], v4 offset:29696
    v_mfma_f32_16x16x32_bf16 v[120:123], v[160:163], v[60:63], v[120:123]
    ds_read_b64_tr_b16 v[56:57], v5 offset:28672
    v_mfma_f32_16x16x32_bf16 v[124:127], v[164:167], v[60:63], v[124:127]
    ds_read_b64_tr_b16 v[58:59], v5 offset:29696
    s_waitcnt lgkmcnt(10)
    v_mfma_f32_16x16x32_bf16 v[128:131], v[32:35], v[160:163], v[128:131]
    ds_read_b64_tr_b16 v[60:61], v6 offset:28672
    v_mfma_f32_16x16x32_bf16 v[132:135], v[32:35], v[164:167], v[132:135]
    ds_read_b64_tr_b16 v[62:63], v6 offset:29696
    s_barrier
    v_mfma_f32_16x16x32_bf16 v[136:139], v[36:39], v[160:163], v[136:139]
    ds_read_b64_tr_b16 v[32:33], v3 offset:32768
    v_mfma_f32_16x16x32_bf16 v[140:143], v[36:39], v[164:167], v[140:143]
    ds_read_b64_tr_b16 v[34:35], v3 offset:33792
    s_waitcnt lgkmcnt(10)
    v_mfma_f32_16x16x32_bf16 v[144:147], v[40:43], v[160:163], v[144:147]
    ds_read_b64_tr_b16 v[36:37], v4 offset:32768
    v_mfma_f32_16x16x32_bf16 v[148:151], v[40:43], v[164:167], v[148:151]
    ds_read_b64_tr_b16 v[38:39], v4 offset:33792
    v_mfma_f32_16x16x32_bf16 v[152:155], v[44:47], v[160:163], v[152:155]
    ds_read_b64_tr_b16 v[40:41], v5 offset:32768
    v_mfma_f32_16x16x32_bf16 v[156:159], v[44:47], v[164:167], v[156:159]
    ds_read_b64_tr_b16 v[42:43], v5 offset:33792
    s_waitcnt vmcnt(17) lgkmcnt(10)
    v_mfma_f32_16x16x32_bf16 v[64:67], v[48:51], v[168:171], v[64:67]
    ds_read_b64_tr_b16 v[44:45], v6 offset:32768
    v_mfma_f32_16x16x32_bf16 v[68:71], v[48:51], v[172:175], v[68:71]
    ds_read_b64_tr_b16 v[46:47], v6 offset:33792
    v_mfma_f32_16x16x32_bf16 v[72:75], v[52:55], v[168:171], v[72:75]
    ds_read_b64_tr_b16 v[48:49], v3 offset:36864
    v_mfma_f32_16x16x32_bf16 v[76:79], v[52:55], v[172:175], v[76:79]
    ds_read_b64_tr_b16 v[50:51], v3 offset:37888
    s_waitcnt lgkmcnt(10)
    v_mfma_f32_16x16x32_bf16 v[80:83], v[56:59], v[168:171], v[80:83]
    ds_read_b64_tr_b16 v[52:53], v4 offset:36864
    v_mfma_f32_16x16x32_bf16 v[84:87], v[56:59], v[172:175], v[84:87]
    ds_read_b64_tr_b16 v[54:55], v4 offset:37888
    v_mfma_f32_16x16x32_bf16 v[88:91], v[60:63], v[168:171], v[88:91]
    ds_read_b64_tr_b16 v[56:57], v5 offset:36864
    v_mfma_f32_16x16x32_bf16 v[92:95], v[60:63], v[172:175], v[92:95]
    ds_read_b64_tr_b16 v[58:59], v5 offset:37888
    s_waitcnt lgkmcnt(10)
    v_mfma_f32_16x16x32_bf16 v[96:99], v[168:171], v[32:35], v[96:99]
    ds_read_b64_tr_b16 v[60:61], v6 offset:36864
    v_mfma_f32_16x16x32_bf16 v[100:103], v[172:175], v[32:35], v[100:103]
    ds_read_b64_tr_b16 v[62:63], v6 offset:37888
    v_mfma_f32_16x16x32_bf16 v[104:107], v[168:171], v[36:39], v[104:107]
    ds_read_b64_tr_b16 v[32:33], v3 offset:40960
    v_mfma_f32_16x16x32_bf16 v[108:111], v[172:175], v[36:39], v[108:111]
    ds_read_b64_tr_b16 v[34:35], v3 offset:41984
    s_waitcnt lgkmcnt(10)
    v_mfma_f32_16x16x32_bf16 v[112:115], v[168:171], v[40:43], v[112:115]
    ds_read_b64_tr_b16 v[36:37], v4 offset:40960
    v_mfma_f32_16x16x32_bf16 v[116:119], v[172:175], v[40:43], v[116:119]
    ds_read_b64_tr_b16 v[38:39], v4 offset:41984
    v_mfma_f32_16x16x32_bf16 v[120:123], v[168:171], v[44:47], v[120:123]
    ds_read_b64_tr_b16 v[40:41], v5 offset:40960
    v_mfma_f32_16x16x32_bf16 v[124:127], v[172:175], v[44:47], v[124:127]
    ds_read_b64_tr_b16 v[42:43], v5 offset:41984
    s_waitcnt lgkmcnt(10)
    v_mfma_f32_16x16x32_bf16 v[128:131], v[48:51], v[168:171], v[128:131]
    ds_read_b64_tr_b16 v[44:45], v6 offset:40960
    v_mfma_f32_16x16x32_bf16 v[132:135], v[48:51], v[172:175], v[132:135]
    ds_read_b64_tr_b16 v[46:47], v6 offset:41984
    v_mfma_f32_16x16x32_bf16 v[136:139], v[52:55], v[168:171], v[136:139]
    ds_read_b64_tr_b16 v[48:49], v3 offset:45056
    v_mfma_f32_16x16x32_bf16 v[140:143], v[52:55], v[172:175], v[140:143]
    ds_read_b64_tr_b16 v[50:51], v3 offset:46080
    s_waitcnt lgkmcnt(10)
    v_mfma_f32_16x16x32_bf16 v[144:147], v[56:59], v[168:171], v[144:147]
    ds_read_b64_tr_b16 v[52:53], v4 offset:45056
    v_mfma_f32_16x16x32_bf16 v[148:151], v[56:59], v[172:175], v[148:151]
    ds_read_b64_tr_b16 v[54:55], v4 offset:46080
    v_mfma_f32_16x16x32_bf16 v[152:155], v[60:63], v[168:171], v[152:155]
    ds_read_b64_tr_b16 v[56:57], v5 offset:45056
    v_mfma_f32_16x16x32_bf16 v[156:159], v[60:63], v[172:175], v[156:159]
    ds_read_b64_tr_b16 v[58:59], v5 offset:46080
    s_waitcnt vmcnt(15) lgkmcnt(10)
    v_mfma_f32_16x16x32_bf16 v[64:67], v[32:35], v[176:179], v[64:67]
    ds_read_b64_tr_b16 v[60:61], v6 offset:45056
    v_mfma_f32_16x16x32_bf16 v[68:71], v[32:35], v[180:183], v[68:71]
    ds_read_b64_tr_b16 v[62:63], v6 offset:46080
    v_mfma_f32_16x16x32_bf16 v[72:75], v[36:39], v[176:179], v[72:75]
    ds_read_b64_tr_b16 v[32:33], v3 offset:49152
    v_mfma_f32_16x16x32_bf16 v[76:79], v[36:39], v[180:183], v[76:79]
    ds_read_b64_tr_b16 v[34:35], v3 offset:50176
    s_waitcnt lgkmcnt(10)
    v_mfma_f32_16x16x32_bf16 v[80:83], v[40:43], v[176:179], v[80:83]
    ds_read_b64_tr_b16 v[36:37], v4 offset:49152
    v_mfma_f32_16x16x32_bf16 v[84:87], v[40:43], v[180:183], v[84:87]
    ds_read_b64_tr_b16 v[38:39], v4 offset:50176
    v_mfma_f32_16x16x32_bf16 v[88:91], v[44:47], v[176:179], v[88:91]
    ds_read_b64_tr_b16 v[40:41], v5 offset:49152
    v_mfma_f32_16x16x32_bf16 v[92:95], v[44:47], v[180:183], v[92:95]
    ds_read_b64_tr_b16 v[42:43], v5 offset:50176
    s_waitcnt lgkmcnt(10)
    v_mfma_f32_16x16x32_bf16 v[96:99], v[176:179], v[48:51], v[96:99]
    ds_read_b64_tr_b16 v[44:45], v6 offset:49152
    buffer_load_dwordx4 v[244:247], v2, s[4:7], s42 offen offset:256 sc1
    v_mfma_f32_16x16x32_bf16 v[100:103], v[180:183], v[48:51], v[100:103]
    ds_read_b64_tr_b16 v[46:47], v6 offset:50176
    v_mfma_f32_16x16x32_bf16 v[104:107], v[176:179], v[52:55], v[104:107]
    ds_read_b64_tr_b16 v[48:49], v3 offset:53248
    buffer_load_dwordx4 v[248:251], v2, s[4:7], s42 offen offset:2048 sc1
    v_mfma_f32_16x16x32_bf16 v[108:111], v[180:183], v[52:55], v[108:111]
    ds_read_b64_tr_b16 v[50:51], v3 offset:54272
    s_waitcnt lgkmcnt(10)
    v_mfma_f32_16x16x32_bf16 v[112:115], v[176:179], v[56:59], v[112:115]
    ds_read_b64_tr_b16 v[52:53], v4 offset:53248
    buffer_load_dwordx4 v[252:255], v2, s[4:7], s42 offen offset:2304 sc1
    v_mfma_f32_16x16x32_bf16 v[116:119], v[180:183], v[56:59], v[116:119]
    ds_read_b64_tr_b16 v[54:55], v4 offset:54272
    v_mfma_f32_16x16x32_bf16 v[120:123], v[176:179], v[60:63], v[120:123]
    ds_read_b64_tr_b16 v[56:57], v5 offset:53248
    s_add_u32 s42, s41, s96
    buffer_load_dwordx4 v[160:163], v2, s[4:7], s42 offen offset:0 sc1
    v_mfma_f32_16x16x32_bf16 v[124:127], v[180:183], v[60:63], v[124:127]
    ds_read_b64_tr_b16 v[58:59], v5 offset:54272
    s_waitcnt lgkmcnt(10)
    v_mfma_f32_16x16x32_bf16 v[128:131], v[32:35], v[176:179], v[128:131]
    ds_read_b64_tr_b16 v[60:61], v6 offset:53248
    buffer_load_dwordx4 v[164:167], v2, s[4:7], s42 offen offset:256 sc1
    v_mfma_f32_16x16x32_bf16 v[132:135], v[32:35], v[180:183], v[132:135]
    ds_read_b64_tr_b16 v[62:63], v6 offset:54272
    v_mfma_f32_16x16x32_bf16 v[136:139], v[36:39], v[176:179], v[136:139]
    ds_read_b64_tr_b16 v[32:33], v3 offset:57344
    buffer_load_dwordx4 v[168:171], v2, s[4:7], s42 offen offset:2048 sc1
    v_mfma_f32_16x16x32_bf16 v[140:143], v[36:39], v[180:183], v[140:143]
    ds_read_b64_tr_b16 v[34:35], v3 offset:58368
    s_waitcnt lgkmcnt(10)
    v_mfma_f32_16x16x32_bf16 v[144:147], v[40:43], v[176:179], v[144:147]
    ds_read_b64_tr_b16 v[36:37], v4 offset:57344
    v_mfma_f32_16x16x32_bf16 v[148:151], v[40:43], v[180:183], v[148:151]
    ds_read_b64_tr_b16 v[38:39], v4 offset:58368
    v_mfma_f32_16x16x32_bf16 v[152:155], v[44:47], v[176:179], v[152:155]
    ds_read_b64_tr_b16 v[40:41], v5 offset:57344
    v_mfma_f32_16x16x32_bf16 v[156:159], v[44:47], v[180:183], v[156:159]
    ds_read_b64_tr_b16 v[42:43], v5 offset:58368
    s_waitcnt vmcnt(19) lgkmcnt(10)
    v_mfma_f32_16x16x32_bf16 v[64:67], v[48:51], v[184:187], v[64:67]
    ds_read_b64_tr_b16 v[44:45], v6 offset:57344
    v_mfma_f32_16x16x32_bf16 v[68:71], v[48:51], v[188:191], v[68:71]
    ds_read_b64_tr_b16 v[46:47], v6 offset:58368
    v_mfma_f32_16x16x32_bf16 v[72:75], v[52:55], v[184:187], v[72:75]
    ds_read_b64_tr_b16 v[48:49], v3 offset:61440
    v_mfma_f32_16x16x32_bf16 v[76:79], v[52:55], v[188:191], v[76:79]
    ds_read_b64_tr_b16 v[50:51], v3 offset:62464
    s_waitcnt lgkmcnt(10)
    v_mfma_f32_16x16x32_bf16 v[80:83], v[56:59], v[184:187], v[80:83]
    ds_read_b64_tr_b16 v[52:53], v4 offset:61440
    buffer_load_dwordx4 v[172:175], v2, s[4:7], s42 offen offset:2304 sc1
    v_mfma_f32_16x16x32_bf16 v[84:87], v[56:59], v[188:191], v[84:87]
    ds_read_b64_tr_b16 v[54:55], v4 offset:62464
    v_mfma_f32_16x16x32_bf16 v[88:91], v[60:63], v[184:187], v[88:91]
    ds_read_b64_tr_b16 v[56:57], v5 offset:61440
    v_mfma_f32_16x16x32_bf16 v[92:95], v[60:63], v[188:191], v[92:95]
    ds_read_b64_tr_b16 v[58:59], v5 offset:62464
    s_waitcnt lgkmcnt(10)
    v_mfma_f32_16x16x32_bf16 v[96:99], v[184:187], v[32:35], v[96:99]
    ds_read_b64_tr_b16 v[60:61], v6 offset:61440
    v_mfma_f32_16x16x32_bf16 v[100:103], v[188:191], v[32:35], v[100:103]
    ds_read_b64_tr_b16 v[62:63], v6 offset:62464
    s_barrier
    v_xor_b32 v3, 0x10000, v3
    v_xor_b32 v4, 0x10000, v4
    v_xor_b32 v5, 0x10000, v5
    v_xor_b32 v6, 0x10000, v6
    v_mfma_f32_16x16x32_bf16 v[104:107], v[184:187], v[36:39], v[104:107]
    ds_read_b64_tr_b16 v[32:33], v3 offset:0
    v_mfma_f32_16x16x32_bf16 v[108:111], v[188:191], v[36:39], v[108:111]
    ds_read_b64_tr_b16 v[34:35], v3 offset:1024
    s_waitcnt lgkmcnt(10)
    v_mfma_f32_16x16x32_bf16 v[112:115], v[184:187], v[40:43], v[112:115]
    ds_read_b64_tr_b16 v[36:37], v4 offset:0
    v_mfma_f32_16x16x32_bf16 v[116:119], v[188:191], v[40:43], v[116:119]
    ds_read_b64_tr_b16 v[38:39], v4 offset:1024
    v_mfma_f32_16x16x32_bf16 v[120:123], v[184:187], v[44:47], v[120:123]
    ds_read_b64_tr_b16 v[40:41], v5 offset:0
    v_mfma_f32_16x16x32_bf16 v[124:127], v[188:191], v[44:47], v[124:127]
    ds_read_b64_tr_b16 v[42:43], v5 offset:1024
    s_waitcnt lgkmcnt(10)
    v_mfma_f32_16x16x32_bf16 v[128:131], v[48:51], v[184:187], v[128:131]
    ds_read_b64_tr_b16 v[44:45], v6 offset:0
    v_mfma_f32_16x16x32_bf16 v[132:135], v[48:51], v[188:191], v[132:135]
    ds_read_b64_tr_b16 v[46:47], v6 offset:1024
    v_mfma_f32_16x16x32_bf16 v[136:139], v[52:55], v[184:187], v[136:139]
    ds_read_b64_tr_b16 v[48:49], v3 offset:4096
    v_mfma_f32_16x16x32_bf16 v[140:143], v[52:55], v[188:191], v[140:143]
    ds_read_b64_tr_b16 v[50:51], v3 offset:5120
    s_waitcnt lgkmcnt(10)
    v_mfma_f32_16x16x32_bf16 v[144:147], v[56:59], v[184:187], v[144:147]
    ds_read_b64_tr_b16 v[52:53], v4 offset:4096
    v_mfma_f32_16x16x32_bf16 v[148:151], v[56:59], v[188:191], v[148:151]
    ds_read_b64_tr_b16 v[54:55], v4 offset:5120
    v_mfma_f32_16x16x32_bf16 v[152:155], v[60:63], v[184:187], v[152:155]
    ds_read_b64_tr_b16 v[56:57], v5 offset:4096
    v_mfma_f32_16x16x32_bf16 v[156:159], v[60:63], v[188:191], v[156:159]
    ds_read_b64_tr_b16 v[58:59], v5 offset:5120
    s_waitcnt vmcnt(18) lgkmcnt(10)
    v_mfma_f32_16x16x32_bf16 v[64:67], v[32:35], v[192:195], v[64:67]
    ds_read_b64_tr_b16 v[60:61], v6 offset:4096
    v_mfma_f32_16x16x32_bf16 v[68:71], v[32:35], v[196:199], v[68:71]
    ds_read_b64_tr_b16 v[62:63], v6 offset:5120
    v_mfma_f32_16x16x32_bf16 v[72:75], v[36:39], v[192:195], v[72:75]
    ds_read_b64_tr_b16 v[32:33], v3 offset:8192
    v_mfma_f32_16x16x32_bf16 v[76:79], v[36:39], v[196:199], v[76:79]
    ds_read_b64_tr_b16 v[34:35], v3 offset:9216
    s_waitcnt lgkmcnt(10)
    v_mfma_f32_16x16x32_bf16 v[80:83], v[40:43], v[192:195], v[80:83]
    ds_read_b64_tr_b16 v[36:37], v4 offset:8192
    v_mfma_f32_16x16x32_bf16 v[84:87], v[40:43], v[196:199], v[84:87]
    ds_read_b64_tr_b16 v[38:39], v4 offset:9216
    v_mfma_f32_16x16x32_bf16 v[88:91], v[44:47], v[192:195], v[88:91]
    ds_read_b64_tr_b16 v[40:41], v5 offset:8192
    v_mfma_f32_16x16x32_bf16 v[92:95], v[44:47], v[196:199], v[92:95]
    ds_read_b64_tr_b16 v[42:43], v5 offset:9216
    s_waitcnt lgkmcnt(10)
    v_mfma_f32_16x16x32_bf16 v[96:99], v[192:195], v[48:51], v[96:99]
    ds_read_b64_tr_b16 v[44:45], v6 offset:8192
    v_mfma_f32_16x16x32_bf16 v[100:103], v[196:199], v[48:51], v[100:103]
    ds_read_b64_tr_b16 v[46:47], v6 offset:9216
    v_mfma_f32_16x16x32_bf16 v[104:107], v[192:195], v[52:55], v[104:107]
    ds_read_b64_tr_b16 v[48:49], v3 offset:12288
    v_mfma_f32_16x16x32_bf16 v[108:111], v[196:199], v[52:55], v[108:111]
    ds_read_b64_tr_b16 v[50:51], v3 offset:13312
    s_waitcnt lgkmcnt(10)
    v_mfma_f32_16x16x32_bf16 v[112:115], v[192:195], v[56:59], v[112:115]
    ds_read_b64_tr_b16 v[52:53], v4 offset:12288
    v_mfma_f32_16x16x32_bf16 v[116:119], v[196:199], v[56:59], v[116:119]
    ds_read_b64_tr_b16 v[54:55], v4 offset:13312
    v_mfma_f32_16x16x32_bf16 v[120:123], v[192:195], v[60:63], v[120:123]
    ds_read_b64_tr_b16 v[56:57], v5 offset:12288
    v_mfma_f32_16x16x32_bf16 v[124:127], v[196:199], v[60:63], v[124:127]
    ds_read_b64_tr_b16 v[58:59], v5 offset:13312
    s_waitcnt lgkmcnt(10)
    v_mfma_f32_16x16x32_bf16 v[128:131], v[32:35], v[192:195], v[128:131]
    ds_read_b64_tr_b16 v[60:61], v6 offset:12288
    v_mfma_f32_16x16x32_bf16 v[132:135], v[32:35], v[196:199], v[132:135]
    ds_read_b64_tr_b16 v[62:63], v6 offset:13312
    v_mfma_f32_16x16x32_bf16 v[136:139], v[36:39], v[192:195], v[136:139]
    ds_read_b64_tr_b16 v[32:33], v3 offset:16384
    v_mfma_f32_16x16x32_bf16 v[140:143], v[36:39], v[196:199], v[140:143]
    ds_read_b64_tr_b16 v[34:35], v3 offset:17408
    s_waitcnt lgkmcnt(10)
    v_mfma_f32_16x16x32_bf16 v[144:147], v[40:43], v[192:195], v[144:147]
    ds_read_b64_tr_b16 v[36:37], v4 offset:16384
    v_mfma_f32_16x16x32_bf16 v[148:151], v[40:43], v[196:199], v[148:151]
    ds_read_b64_tr_b16 v[38:39], v4 offset:17408
    v_mfma_f32_16x16x32_bf16 v[152:155], v[44:47], v[192:195], v[152:155]
    ds_read_b64_tr_b16 v[40:41], v5 offset:16384
    v_mfma_f32_16x16x32_bf16 v[156:159], v[44:47], v[196:199], v[156:159]
    ds_read_b64_tr_b16 v[42:43], v5 offset:17408
    s_waitcnt vmcnt(16) lgkmcnt(10)
    v_mfma_f32_16x16x32_bf16 v[64:67], v[48:51], v[200:203], v[64:67]
    ds_read_b64_tr_b16 v[44:45], v6 offset:16384
    s_add_u32 s42, s41, s97
    buffer_load_dwordx4 v[176:179], v2, s[4:7], s42 offen offset:0 sc1
    v_mfma_f32_16x16x32_bf16 v[68:71], v[48:51], v[204:207], v[68:71]
    ds_read_b64_tr_b16 v[46:47], v6 offset:17408
    v_mfma_f32_16x16x32_bf16 v[72:75], v[52:55], v[200:203], v[72:75]
    ds_read_b64_tr_b16 v[48:49], v3 offset:20480
    buffer_load_dwordx4 v[180:183], v2, s[4:7], s42 offen offset:256 sc1
    v_mfma_f32_16x16x32_bf16 v[76:79], v[52:55], v[204:207], v[76:79]
    ds_read_b64_tr_b16 v[50:51], v3 offset:21504
    s_waitcnt lgkmcnt(10)
    v_mfma_f32_16x16x32_bf16 v[80:83], v[56:59], v[200:203], v[80:83]
    ds_read_b64_tr_b16 v[52:53], v4 offset:20480
    buffer_load_dwordx4 v[184:187], v2, s[4:7], s42 offen offset:2048 sc1
    v_mfma_f32_16x16x32_bf16 v[84:87], v[56:59], v[204:207], v[84:87]
    ds_read_b64_tr_b16 v[54:55], v4 offset:21504
    v_mfma_f32_16x16x32_bf16 v[88:91], v[60:63], v[200:203], v[88:91]
    ds_read_b64_tr_b16 v[56:57], v5 offset:20480
    buffer_load_dwordx4 v[188:191], v2, s[4:7], s42 offen offset:2304 sc1
    v_mfma_f32_16x16x32_bf16 v[92:95], v[60:63], v[204:207], v[92:95]
    ds_read_b64_tr_b16 v[58:59], v5 offset:21504
    s_waitcnt lgkmcnt(10)
    v_mfma_f32_16x16x32_bf16 v[96:99], v[200:203], v[32:35], v[96:99]
    ds_read_b64_tr_b16 v[60:61], v6 offset:20480
    s_add_u32 s42, s41, s98
    buffer_load_dwordx4 v[192:195], v2, s[4:7], s42 offen offset:0 sc1
    v_mfma_f32_16x16x32_bf16 v[100:103], v[204:207], v[32:35], v[100:103]
    ds_read_b64_tr_b16 v[62:63], v6 offset:21504
    v_mfma_f32_16x16x32_bf16 v[104:107], v[200:203], v[36:39], v[104:107]
    ds_read_b64_tr_b16 v[32:33], v3 offset:24576
    v_mfma_f32_16x16x32_bf16 v[108:111], v[204:207], v[36:39], v[108:111]
    ds_read_b64_tr_b16 v[34:35], v3 offset:25600
    s_waitcnt lgkmcnt(10)
    v_mfma_f32_16x16x32_bf16 v[112:115], v[200:203], v[40:43], v[112:115]
    ds_read_b64_tr_b16 v[36:37], v4 offset:24576
    v_mfma_f32_16x16x32_bf16 v[116:119], v[204:207], v[40:43], v[116:119]
    ds_read_b64_tr_b16 v[38:39], v4 offset:25600
    v_mfma_f32_16x16x32_bf16 v[120:123], v[200:203], v[44:47], v[120:123]
    ds_read_b64_tr_b16 v[40:41], v5 offset:24576
    buffer_load_dwordx4 v[196:199], v2, s[4:7], s42 offen offset:256 sc1
    v_mfma_f32_16x16x32_bf16 v[124:127], v[204:207], v[44:47], v[124:127]
    ds_read_b64_tr_b16 v[42:43], v5 offset:25600
    s_waitcnt lgkmcnt(10)
    v_mfma_f32_16x16x32_bf16 v[128:131], v[48:51], v[200:203], v[128:131]
    ds_read_b64_tr_b16 v[44:45], v6 offset:24576
    v_mfma_f32_16x16x32_bf16 v[132:135], v[48:51], v[204:207], v[132:135]
    ds_read_b64_tr_b16 v[46:47], v6 offset:25600
    v_mfma_f32_16x16x32_bf16 v[136:139], v[52:55], v[200:203], v[136:139]
    ds_read_b64_tr_b16 v[48:49], v3 offset:28672
    v_mfma_f32_16x16x32_bf16 v[140:143], v[52:55], v[204:207], v[140:143]
    ds_read_b64_tr_b16 v[50:51], v3 offset:29696
    s_waitcnt lgkmcnt(10)
    v_mfma_f32_16x16x32_bf16 v[144:147], v[56:59], v[200:203], v[144:147]
    ds_read_b64_tr_b16 v[52:53], v4 offset:28672
    v_mfma_f32_16x16x32_bf16 v[148:151], v[56:59], v[204:207], v[148:151]
    ds_read_b64_tr_b16 v[54:55], v4 offset:29696
    v_mfma_f32_16x16x32_bf16 v[152:155], v[60:63], v[200:203], v[152:155]
    ds_read_b64_tr_b16 v[56:57], v5 offset:28672
    v_mfma_f32_16x16x32_bf16 v[156:159], v[60:63], v[204:207], v[156:159]
    ds_read_b64_tr_b16 v[58:59], v5 offset:29696
    s_waitcnt vmcnt(20) lgkmcnt(10)
    v_mfma_f32_16x16x32_bf16 v[64:67], v[32:35], v[208:211], v[64:67]
    ds_read_b64_tr_b16 v[60:61], v6 offset:28672
    v_mfma_f32_16x16x32_bf16 v[68:71], v[32:35], v[212:215], v[68:71]
    ds_read_b64_tr_b16 v[62:63], v6 offset:29696
    s_barrier
    v_mfma_f32_16x16x32_bf16 v[72:75], v[36:39], v[208:211], v[72:75]
    ds_read_b64_tr_b16 v[32:33], v3 offset:32768
    v_mfma_f32_16x16x32_bf16 v[76:79], v[36:39], v[212:215], v[76:79]
    ds_read_b64_tr_b16 v[34:35], v3 offset:33792
    s_waitcnt lgkmcnt(10)
    v_mfma_f32_16x16x32_bf16 v[80:83], v[40:43], v[208:211], v[80:83]
    ds_read_b64_tr_b16 v[36:37], v4 offset:32768
    v_mfma_f32_16x16x32_bf16 v[84:87], v[40:43], v[212:215], v[84:87]
    ds_read_b64_tr_b16 v[38:39], v4 offset:33792
    v_mfma_f32_16x16x32_bf16 v[88:91], v[44:47], v[208:211], v[88:91]
    ds_read_b64_tr_b16 v[40:41], v5 offset:32768
    v_mfma_f32_16x16x32_bf16 v[92:95], v[44:47], v[212:215], v[92:95]
    ds_read_b64_tr_b16 v[42:43], v5 offset:33792
    s_waitcnt lgkmcnt(10)
    v_mfma_f32_16x16x32_bf16 v[96:99], v[208:211], v[48:51], v[96:99]
    ds_read_b64_tr_b16 v[44:45], v6 offset:32768
    v_mfma_f32_16x16x32_bf16 v[100:103], v[212:215], v[48:51], v[100:103]
    ds_read_b64_tr_b16 v[46:47], v6 offset:33792
    v_mfma_f32_16x16x32_bf16 v[104:107], v[208:211], v[52:55], v[104:107]
    ds_read_b64_tr_b16 v[48:49], v3 offset:36864
    v_mfma_f32_16x16x32_bf16 v[108:111], v[212:215], v[52:55], v[108:111]
    ds_read_b64_tr_b16 v[50:51], v3 offset:37888
    s_waitcnt lgkmcnt(10)
    v_mfma_f32_16x16x32_bf16 v[112:115], v[208:211], v[56:59], v[112:115]
    ds_read_b64_tr_b16 v[52:53], v4 offset:36864
    v_mfma_f32_16x16x32_bf16 v[116:119], v[212:215], v[56:59], v[116:119]
    ds_read_b64_tr_b16 v[54:55], v4 offset:37888
    v_mfma_f32_16x16x32_bf16 v[120:123], v[208:211], v[60:63], v[120:123]
    ds_read_b64_tr_b16 v[56:57], v5 offset:36864
    v_mfma_f32_16x16x32_bf16 v[124:127], v[212:215], v[60:63], v[124:127]
    ds_read_b64_tr_b16 v[58:59], v5 offset:37888
    s_waitcnt lgkmcnt(10)
    v_mfma_f32_16x16x32_bf16 v[128:131], v[32:35], v[208:211], v[128:131]
    ds_read_b64_tr_b16 v[60:61], v6 offset:36864
    v_mfma_f32_16x16x32_bf16 v[132:135], v[32:35], v[212:215], v[132:135]
    ds_read_b64_tr_b16 v[62:63], v6 offset:37888
    v_mfma_f32_16x16x32_bf16 v[136:139], v[36:39], v[208:211], v[136:139]
    ds_read_b64_tr_b16 v[32:33], v3 offset:40960
    v_mfma_f32_16x16x32_bf16 v[140:143], v[36:39], v[212:215], v[140:143]
    ds_read_b64_tr_b16 v[34:35], v3 offset:41984
    s_waitcnt lgkmcnt(10)
    v_mfma_f32_16x16x32_bf16 v[144:147], v[40:43], v[208:211], v[144:147]
    ds_read_b64_tr_b16 v[36:37], v4 offset:40960
    v_mfma_f32_16x16x32_bf16 v[148:151], v[40:43], v[212:215], v[148:151]
    ds_read_b64_tr_b16 v[38:39], v4 offset:41984
    v_mfma_f32_16x16x32_bf16 v[152:155], v[44:47], v[208:211], v[152:155]
    ds_read_b64_tr_b16 v[40:41], v5 offset:40960
    v_mfma_f32_16x16x32_bf16 v[156:159], v[44:47], v[212:215], v[156:159]
    ds_read_b64_tr_b16 v[42:43], v5 offset:41984
    s_waitcnt vmcnt(18) lgkmcnt(10)
    v_mfma_f32_16x16x32_bf16 v[64:67], v[48:51], v[216:219], v[64:67]
    ds_read_b64_tr_b16 v[44:45], v6 offset:40960
    v_mfma_f32_16x16x32_bf16 v[68:71], v[48:51], v[220:223], v[68:71]
    ds_read_b64_tr_b16 v[46:47], v6 offset:41984
    v_mfma_f32_16x16x32_bf16 v[72:75], v[52:55], v[216:219], v[72:75]
    ds_read_b64_tr_b16 v[48:49], v3 offset:45056
    v_mfma_f32_16x16x32_bf16 v[76:79], v[52:55], v[220:223], v[76:79]
    ds_read_b64_tr_b16 v[50:51], v3 offset:46080
    s_waitcnt lgkmcnt(10)
    v_mfma_f32_16x16x32_bf16 v[80:83], v[56:59], v[216:219], v[80:83]
    ds_read_b64_tr_b16 v[52:53], v4 offset:45056
    v_mfma_f32_16x16x32_bf16 v[84:87], v[56:59], v[220:223], v[84:87]
    ds_read_b64_tr_b16 v[54:55], v4 offset:46080
    v_mfma_f32_16x16x32_bf16 v[88:91], v[60:63], v[216:219], v[88:91]
    ds_read_b64_tr_b16 v[56:57], v5 offset:45056
    v_mfma_f32_16x16x32_bf16 v[92:95], v[60:63], v[220:223], v[92:95]
    ds_read_b64_tr_b16 v[58:59], v5 offset:46080
    s_waitcnt lgkmcnt(10)
    v_mfma_f32_16x16x32_bf16 v[96:99], v[216:219], v[32:35], v[96:99]
    ds_read_b64_tr_b16 v[60:61], v6 offset:45056
    v_mfma_f32_16x16x32_bf16 v[100:103], v[220:223], v[32:35], v[100:103]
    ds_read_b64_tr_b16 v[62:63], v6 offset:46080
    v_mfma_f32_16x16x32_bf16 v[104:107], v[216:219], v[36:39], v[104:107]
    ds_read_b64_tr_b16 v[32:33], v3 offset:49152
    v_mfma_f32_16x16x32_bf16 v[108:111], v[220:223], v[36:39], v[108:111]
    ds_read_b64_tr_b16 v[34:35], v3 offset:50176
    s_waitcnt lgkmcnt(10)
    v_mfma_f32_16x16x32_bf16 v[112:115], v[216:219], v[40:43], v[112:115]
    ds_read_b64_tr_b16 v[36:37], v4 offset:49152
    v_mfma_f32_16x16x32_bf16 v[116:119], v[220:223], v[40:43], v[116:119]
    ds_read_b64_tr_b16 v[38:39], v4 offset:50176
    v_mfma_f32_16x16x32_bf16 v[120:123], v[216:219], v[44:47], v[120:123]
    ds_read_b64_tr_b16 v[40:41], v5 offset:49152
    v_mfma_f32_16x16x32_bf16 v[124:127], v[220:223], v[44:47], v[124:127]
    ds_read_b64_tr_b16 v[42:43], v5 offset:50176
    s_waitcnt lgkmcnt(10)
    v_mfma_f32_16x16x32_bf16 v[128:131], v[48:51], v[216:219], v[128:131]
    ds_read_b64_tr_b16 v[44:45], v6 offset:49152
    buffer_load_dwordx4 v[200:203], v2, s[4:7], s42 offen offset:2048 sc1
    v_mfma_f32_16x16x32_bf16 v[132:135], v[48:51], v[220:223], v[132:135]
    ds_read_b64_tr_b16 v[46:47], v6 offset:50176
    v_mfma_f32_16x16x32_bf16 v[136:139], v[52:55], v[216:219], v[136:139]
    ds_read_b64_tr_b16 v[48:49], v3 offset:53248
    buffer_load_dwordx4 v[204:207], v2, s[4:7], s42 offen offset:2304 sc1
    v_mfma_f32_16x16x32_bf16 v[140:143], v[52:55], v[220:223], v[140:143]
    ds_read_b64_tr_b16 v[50:51], v3 offset:54272
    s_waitcnt lgkmcnt(10)
    v_mfma_f32_16x16x32_bf16 v[144:147], v[56:59], v[216:219], v[144:147]
    ds_read_b64_tr_b16 v[52:53], v4 offset:53248
    s_add_u32 s42, s41, s99
    buffer_load_dwordx4 v[208:211], v2, s[4:7], s42 offen offset:0 sc1
    v_mfma_f32_16x16x32_bf16 v[148:151], v[56:59], v[220:223], v[148:151]
    ds_read_b64_tr_b16 v[54:55], v4 offset:54272
    v_mfma_f32_16x16x32_bf16 v[152:155], v[60:63], v[216:219], v[152:155]
    ds_read_b64_tr_b16 v[56:57], v5 offset:53248
    buffer_load_dwordx4 v[212:215], v2, s[4:7], s42 offen offset:256 sc1
    v_mfma_f32_16x16x32_bf16 v[156:159], v[60:63], v[220:223], v[156:159]
    ds_read_b64_tr_b16 v[58:59], v5 offset:54272
    s_waitcnt vmcnt(20) lgkmcnt(10)
    v_mfma_f32_16x16x32_bf16 v[64:67], v[32:35], v[224:227], v[64:67]
    ds_read_b64_tr_b16 v[60:61], v6 offset:53248
    buffer_load_dwordx4 v[216:219], v2, s[4:7], s42 offen offset:2048 sc1
    v_mfma_f32_16x16x32_bf16 v[68:71], v[32:35], v[228:231], v[68:71]
    ds_read_b64_tr_b16 v[62:63], v6 offset:54272
    v_mfma_f32_16x16x32_bf16 v[72:75], v[36:39], v[224:227], v[72:75]
    ds_read_b64_tr_b16 v[32:33], v3 offset:57344
    buffer_load_dwordx4 v[220:223], v2, s[4:7], s42 offen offset:2304 sc1
    v_mfma_f32_16x16x32_bf16 v[76:79], v[36:39], v[228:231], v[76:79]
    ds_read_b64_tr_b16 v[34:35], v3 offset:58368
    s_waitcnt lgkmcnt(10)
    v_mfma_f32_16x16x32_bf16 v[80:83], v[40:43], v[224:227], v[80:83]
    ds_read_b64_tr_b16 v[36:37], v4 offset:57344
    v_mfma_f32_16x16x32_bf16 v[84:87], v[40:43], v[228:231], v[84:87]
    ds_read_b64_tr_b16 v[38:39], v4 offset:58368
    v_mfma_f32_16x16x32_bf16 v[88:91], v[44:47], v[224:227], v[88:91]
    ds_read_b64_tr_b16 v[40:41], v5 offset:57344
    v_mfma_f32_16x16x32_bf16 v[92:95], v[44:47], v[228:231], v[92:95]
    ds_read_b64_tr_b16 v[42:43], v5 offset:58368
    s_waitcnt lgkmcnt(10)
    v_mfma_f32_16x16x32_bf16 v[96:99], v[224:227], v[48:51], v[96:99]
    ds_read_b64_tr_b16 v[44:45], v6 offset:57344
    v_mfma_f32_16x16x32_bf16 v[100:103], v[228:231], v[48:51], v[100:103]
    ds_read_b64_tr_b16 v[46:47], v6 offset:58368
    v_mfma_f32_16x16x32_bf16 v[104:107], v[224:227], v[52:55], v[104:107]
    ds_read_b64_tr_b16 v[48:49], v3 offset:61440
    v_mfma_f32_16x16x32_bf16 v[108:111], v[228:231], v[52:55], v[108:111]
    ds_read_b64_tr_b16 v[50:51], v3 offset:62464
    s_waitcnt lgkmcnt(10)
    v_mfma_f32_16x16x32_bf16 v[112:115], v[224:227], v[56:59], v[112:115]
    ds_read_b64_tr_b16 v[52:53], v4 offset:61440
    v_mfma_f32_16x16x32_bf16 v[116:119], v[228:231], v[56:59], v[116:119]
    ds_read_b64_tr_b16 v[54:55], v4 offset:62464
    v_mfma_f32_16x16x32_bf16 v[120:123], v[224:227], v[60:63], v[120:123]
    ds_read_b64_tr_b16 v[56:57], v5 offset:61440
    v_mfma_f32_16x16x32_bf16 v[124:127], v[228:231], v[60:63], v[124:127]
    ds_read_b64_tr_b16 v[58:59], v5 offset:62464
    s_waitcnt vmcnt(20) lgkmcnt(10)
    v_mfma_f32_16x16x32_bf16 v[64:67], v[32:35], v[232:235], v[64:67]
    ds_read_b64_tr_b16 v[60:61], v6 offset:61440
    v_mfma_f32_16x16x32_bf16 v[68:71], v[32:35], v[236:239], v[68:71]
    ds_read_b64_tr_b16 v[62:63], v6 offset:62464
    s_barrier
    v_xor_b32 v3, 0x10000, v3
    v_xor_b32 v4, 0x10000, v4
    v_xor_b32 v5, 0x10000, v5
    v_xor_b32 v6, 0x10000, v6
    v_mfma_f32_16x16x32_bf16 v[72:75], v[36:39], v[232:235], v[72:75]
    ds_read_b64_tr_b16 v[32:33], v3 offset:0
    v_mfma_f32_16x16x32_bf16 v[76:79], v[36:39], v[236:239], v[76:79]
    ds_read_b64_tr_b16 v[34:35], v3 offset:1024
    s_waitcnt lgkmcnt(10)
    v_mfma_f32_16x16x32_bf16 v[80:83], v[40:43], v[232:235], v[80:83]
    ds_read_b64_tr_b16 v[36:37], v4 offset:0
    v_mfma_f32_16x16x32_bf16 v[84:87], v[40:43], v[236:239], v[84:87]
    ds_read_b64_tr_b16 v[38:39], v4 offset:1024
    v_mfma_f32_16x16x32_bf16 v[88:91], v[44:47], v[232:235], v[88:91]
    ds_read_b64_tr_b16 v[40:41], v5 offset:0
    v_mfma_f32_16x16x32_bf16 v[92:95], v[44:47], v[236:239], v[92:95]
    ds_read_b64_tr_b16 v[42:43], v5 offset:1024
    s_waitcnt lgkmcnt(10)
    v_mfma_f32_16x16x32_bf16 v[96:99], v[232:235], v[48:51], v[96:99]
    ds_read_b64_tr_b16 v[44:45], v6 offset:0
    v_mfma_f32_16x16x32_bf16 v[100:103], v[236:239], v[48:51], v[100:103]
    ds_read_b64_tr_b16 v[46:47], v6 offset:1024
    v_mfma_f32_16x16x32_bf16 v[104:107], v[232:235], v[52:55], v[104:107]
    ds_read_b64_tr_b16 v[48:49], v3 offset:4096
    v_mfma_f32_16x16x32_bf16 v[108:111], v[236:239], v[52:55], v[108:111]
    ds_read_b64_tr_b16 v[50:51], v3 offset:5120
    s_waitcnt lgkmcnt(10)
    v_mfma_f32_16x16x32_bf16 v[112:115], v[232:235], v[56:59], v[112:115]
    ds_read_b64_tr_b16 v[52:53], v4 offset:4096
    v_mfma_f32_16x16x32_bf16 v[116:119], v[236:239], v[56:59], v[116:119]
    ds_read_b64_tr_b16 v[54:55], v4 offset:5120
    v_mfma_f32_16x16x32_bf16 v[120:123], v[232:235], v[60:63], v[120:123]
    ds_read_b64_tr_b16 v[56:57], v5 offset:4096
    v_mfma_f32_16x16x32_bf16 v[124:127], v[236:239], v[60:63], v[124:127]
    ds_read_b64_tr_b16 v[58:59], v5 offset:5120
    s_waitcnt vmcnt(18) lgkmcnt(10)
    v_mfma_f32_16x16x32_bf16 v[64:67], v[32:35], v[240:243], v[64:67]
    ds_read_b64_tr_b16 v[60:61], v6 offset:4096
    v_mfma_f32_16x16x32_bf16 v[68:71], v[32:35], v[244:247], v[68:71]
    ds_read_b64_tr_b16 v[62:63], v6 offset:5120
    v_mfma_f32_16x16x32_bf16 v[72:75], v[36:39], v[240:243], v[72:75]
    ds_read_b64_tr_b16 v[32:33], v3 offset:8192
    v_mfma_f32_16x16x32_bf16 v[76:79], v[36:39], v[244:247], v[76:79]
    ds_read_b64_tr_b16 v[34:35], v3 offset:9216
    s_waitcnt lgkmcnt(10)
    v_mfma_f32_16x16x32_bf16 v[80:83], v[40:43], v[240:243], v[80:83]
    ds_read_b64_tr_b16 v[36:37], v4 offset:8192
    v_mfma_f32_16x16x32_bf16 v[84:87], v[40:43], v[244:247], v[84:87]
    ds_read_b64_tr_b16 v[38:39], v4 offset:9216
    v_mfma_f32_16x16x32_bf16 v[88:91], v[44:47], v[240:243], v[88:91]
    ds_read_b64_tr_b16 v[40:41], v5 offset:8192
    v_mfma_f32_16x16x32_bf16 v[92:95], v[44:47], v[244:247], v[92:95]
    ds_read_b64_tr_b16 v[42:43], v5 offset:9216
    s_waitcnt lgkmcnt(10)
    v_mfma_f32_16x16x32_bf16 v[96:99], v[240:243], v[48:51], v[96:99]
    ds_read_b64_tr_b16 v[44:45], v6 offset:8192
    v_mfma_f32_16x16x32_bf16 v[100:103], v[244:247], v[48:51], v[100:103]
    ds_read_b64_tr_b16 v[46:47], v6 offset:9216
    v_mfma_f32_16x16x32_bf16 v[104:107], v[240:243], v[52:55], v[104:107]
    ds_read_b64_tr_b16 v[48:49], v3 offset:12288
    v_mfma_f32_16x16x32_bf16 v[108:111], v[244:247], v[52:55], v[108:111]
    ds_read_b64_tr_b16 v[50:51], v3 offset:13312
    s_waitcnt lgkmcnt(10)
    v_mfma_f32_16x16x32_bf16 v[112:115], v[240:243], v[56:59], v[112:115]
    ds_read_b64_tr_b16 v[52:53], v4 offset:12288
    v_mfma_f32_16x16x32_bf16 v[116:119], v[244:247], v[56:59], v[116:119]
    ds_read_b64_tr_b16 v[54:55], v4 offset:13312
    v_mfma_f32_16x16x32_bf16 v[120:123], v[240:243], v[60:63], v[120:123]
    ds_read_b64_tr_b16 v[56:57], v5 offset:12288
    v_mfma_f32_16x16x32_bf16 v[124:127], v[244:247], v[60:63], v[124:127]
    ds_read_b64_tr_b16 v[58:59], v5 offset:13312
    s_waitcnt vmcnt(16) lgkmcnt(10)
    v_mfma_f32_16x16x32_bf16 v[64:67], v[32:35], v[248:251], v[64:67]
    ds_read_b64_tr_b16 v[60:61], v6 offset:12288
    v_mfma_f32_16x16x32_bf16 v[68:71], v[32:35], v[252:255], v[68:71]
    ds_read_b64_tr_b16 v[62:63], v6 offset:13312
    v_mfma_f32_16x16x32_bf16 v[72:75], v[36:39], v[248:251], v[72:75]
    ds_read_b64_tr_b16 v[32:33], v3 offset:16384
    v_mfma_f32_16x16x32_bf16 v[76:79], v[36:39], v[252:255], v[76:79]
    ds_read_b64_tr_b16 v[34:35], v3 offset:17408
    s_waitcnt lgkmcnt(10)
    v_mfma_f32_16x16x32_bf16 v[80:83], v[40:43], v[248:251], v[80:83]
    ds_read_b64_tr_b16 v[36:37], v4 offset:16384
    v_mfma_f32_16x16x32_bf16 v[84:87], v[40:43], v[252:255], v[84:87]
    ds_read_b64_tr_b16 v[38:39], v4 offset:17408
    v_mfma_f32_16x16x32_bf16 v[88:91], v[44:47], v[248:251], v[88:91]
    ds_read_b64_tr_b16 v[40:41], v5 offset:16384
    v_mfma_f32_16x16x32_bf16 v[92:95], v[44:47], v[252:255], v[92:95]
    ds_read_b64_tr_b16 v[42:43], v5 offset:17408
    s_waitcnt lgkmcnt(10)
    v_mfma_f32_16x16x32_bf16 v[96:99], v[248:251], v[48:51], v[96:99]
    ds_read_b64_tr_b16 v[44:45], v6 offset:16384
    v_mfma_f32_16x16x32_bf16 v[100:103], v[252:255], v[48:51], v[100:103]
    ds_read_b64_tr_b16 v[46:47], v6 offset:17408
    v_mfma_f32_16x16x32_bf16 v[104:107], v[248:251], v[52:55], v[104:107]
    ds_read_b64_tr_b16 v[48:49], v3 offset:20480
    v_mfma_f32_16x16x32_bf16 v[108:111], v[252:255], v[52:55], v[108:111]
    ds_read_b64_tr_b16 v[50:51], v3 offset:21504
    s_waitcnt lgkmcnt(10)
    v_mfma_f32_16x16x32_bf16 v[112:115], v[248:251], v[56:59], v[112:115]
    ds_read_b64_tr_b16 v[52:53], v4 offset:20480
    v_mfma_f32_16x16x32_bf16 v[116:119], v[252:255], v[56:59], v[116:119]
    ds_read_b64_tr_b16 v[54:55], v4 offset:21504
    v_mfma_f32_16x16x32_bf16 v[120:123], v[248:251], v[60:63], v[120:123]
    ds_read_b64_tr_b16 v[56:57], v5 offset:20480
    v_mfma_f32_16x16x32_bf16 v[124:127], v[252:255], v[60:63], v[124:127]
    ds_read_b64_tr_b16 v[58:59], v5 offset:21504
    s_waitcnt vmcnt(14) lgkmcnt(10)
    v_mfma_f32_16x16x32_bf16 v[64:67], v[32:35], v[160:163], v[64:67]
    ds_read_b64_tr_b16 v[60:61], v6 offset:20480
    v_mfma_f32_16x16x32_bf16 v[68:71], v[32:35], v[164:167], v[68:71]
    ds_read_b64_tr_b16 v[62:63], v6 offset:21504
    v_mfma_f32_16x16x32_bf16 v[72:75], v[36:39], v[160:163], v[72:75]
    ds_read_b64_tr_b16 v[32:33], v3 offset:24576
    v_mfma_f32_16x16x32_bf16 v[76:79], v[36:39], v[164:167], v[76:79]
    ds_read_b64_tr_b16 v[34:35], v3 offset:25600
    s_waitcnt lgkmcnt(10)
    v_mfma_f32_16x16x32_bf16 v[80:83], v[40:43], v[160:163], v[80:83]
    ds_read_b64_tr_b16 v[36:37], v4 offset:24576
    v_mfma_f32_16x16x32_bf16 v[84:87], v[40:43], v[164:167], v[84:87]
    ds_read_b64_tr_b16 v[38:39], v4 offset:25600
    v_mfma_f32_16x16x32_bf16 v[88:91], v[44:47], v[160:163], v[88:91]
    ds_read_b64_tr_b16 v[40:41], v5 offset:24576
    v_mfma_f32_16x16x32_bf16 v[92:95], v[44:47], v[164:167], v[92:95]
    ds_read_b64_tr_b16 v[42:43], v5 offset:25600
    s_waitcnt vmcnt(12) lgkmcnt(10)
    v_mfma_f32_16x16x32_bf16 v[64:67], v[48:51], v[168:171], v[64:67]
    ds_read_b64_tr_b16 v[44:45], v6 offset:24576
    v_mfma_f32_16x16x32_bf16 v[68:71], v[48:51], v[172:175], v[68:71]
    ds_read_b64_tr_b16 v[46:47], v6 offset:25600
    v_mfma_f32_16x16x32_bf16 v[72:75], v[52:55], v[168:171], v[72:75]
    ds_read_b64_tr_b16 v[48:49], v3 offset:28672
    v_mfma_f32_16x16x32_bf16 v[76:79], v[52:55], v[172:175], v[76:79]
    ds_read_b64_tr_b16 v[50:51], v3 offset:29696
    s_waitcnt lgkmcnt(10)
    v_mfma_f32_16x16x32_bf16 v[80:83], v[56:59], v[168:171], v[80:83]
    ds_read_b64_tr_b16 v[52:53], v4 offset:28672
    v_mfma_f32_16x16x32_bf16 v[84:87], v[56:59], v[172:175], v[84:87]
    ds_read_b64_tr_b16 v[54:55], v4 offset:29696
    v_mfma_f32_16x16x32_bf16 v[88:91], v[60:63], v[168:171], v[88:91]
    ds_read_b64_tr_b16 v[56:57], v5 offset:28672
    v_mfma_f32_16x16x32_bf16 v[92:95], v[60:63], v[172:175], v[92:95]
    ds_read_b64_tr_b16 v[58:59], v5 offset:29696
    s_waitcnt vmcnt(10) lgkmcnt(10)
    v_mfma_f32_16x16x32_bf16 v[64:67], v[32:35], v[176:179], v[64:67]
    ds_read_b64_tr_b16 v[60:61], v6 offset:28672
    v_mfma_f32_16x16x32_bf16 v[68:71], v[32:35], v[180:183], v[68:71]
    ds_read_b64_tr_b16 v[62:63], v6 offset:29696
    s_barrier
    v_mfma_f32_16x16x32_bf16 v[72:75], v[36:39], v[176:179], v[72:75]
    ds_read_b64_tr_b16 v[32:33], v3 offset:32768
    v_mfma_f32_16x16x32_bf16 v[76:79], v[36:39], v[180:183], v[76:79]
    ds_read_b64_tr_b16 v[34:35], v3 offset:33792
    s_waitcnt lgkmcnt(10)
    v_mfma_f32_16x16x32_bf16 v[80:83], v[40:43], v[176:179], v[80:83]
    ds_read_b64_tr_b16 v[36:37], v4 offset:32768
    v_mfma_f32_16x16x32_bf16 v[84:87], v[40:43], v[180:183], v[84:87]
    ds_read_b64_tr_b16 v[38:39], v4 offset:33792
    v_mfma_f32_16x16x32_bf16 v[88:91], v[44:47], v[176:179], v[88:91]
    ds_read_b64_tr_b16 v[40:41], v5 offset:32768
    v_mfma_f32_16x16x32_bf16 v[92:95], v[44:47], v[180:183], v[92:95]
    ds_read_b64_tr_b16 v[42:43], v5 offset:33792
    s_waitcnt vmcnt(8) lgkmcnt(10)
    v_mfma_f32_16x16x32_bf16 v[64:67], v[48:51], v[184:187], v[64:67]
    ds_read_b64_tr_b16 v[44:45], v6 offset:32768
    v_mfma_f32_16x16x32_bf16 v[68:71], v[48:51], v[188:191], v[68:71]
    ds_read_b64_tr_b16 v[46:47], v6 offset:33792
    v_mfma_f32_16x16x32_bf16 v[72:75], v[52:55], v[184:187], v[72:75]
    ds_read_b64_tr_b16 v[48:49], v3 offset:36864
    v_mfma_f32_16x16x32_bf16 v[76:79], v[52:55], v[188:191], v[76:79]
    ds_read_b64_tr_b16 v[50:51], v3 offset:37888
    s_waitcnt lgkmcnt(10)
    v_mfma_f32_16x16x32_bf16 v[80:83], v[56:59], v[184:187], v[80:83]
    ds_read_b64_tr_b16 v[52:53], v4 offset:36864
    v_mfma_f32_16x16x32_bf16 v[84:87], v[56:59], v[188:191], v[84:87]
    ds_read_b64_tr_b16 v[54:55], v4 offset:37888
    v_mfma_f32_16x16x32_bf16 v[88:91], v[60:63], v[184:187], v[88:91]
    ds_read_b64_tr_b16 v[56:57], v5 offset:36864
    v_mfma_f32_16x16x32_bf16 v[92:95], v[60:63], v[188:191], v[92:95]
    ds_read_b64_tr_b16 v[58:59], v5 offset:37888
    s_waitcnt vmcnt(6) lgkmcnt(10)
    v_mfma_f32_16x16x32_bf16 v[64:67], v[32:35], v[192:195], v[64:67]
    ds_read_b64_tr_b16 v[60:61], v6 offset:36864
    v_mfma_f32_16x16x32_bf16 v[68:71], v[32:35], v[196:199], v[68:71]
    ds_read_b64_tr_b16 v[62:63], v6 offset:37888
    v_mfma_f32_16x16x32_bf16 v[72:75], v[36:39], v[192:195], v[72:75]
    ds_read_b64_tr_b16 v[32:33], v3 offset:40960
    v_mfma_f32_16x16x32_bf16 v[76:79], v[36:39], v[196:199], v[76:79]
    ds_read_b64_tr_b16 v[34:35], v3 offset:41984
    s_waitcnt lgkmcnt(10)
    v_mfma_f32_16x16x32_bf16 v[80:83], v[40:43], v[192:195], v[80:83]
    ds_read_b64_tr_b16 v[36:37], v4 offset:40960
    v_mfma_f32_16x16x32_bf16 v[84:87], v[40:43], v[196:199], v[84:87]
    ds_read_b64_tr_b16 v[38:39], v4 offset:41984
    v_mfma_f32_16x16x32_bf16 v[88:91], v[44:47], v[192:195], v[88:91]
    ds_read_b64_tr_b16 v[40:41], v5 offset:40960
    v_mfma_f32_16x16x32_bf16 v[92:95], v[44:47], v[196:199], v[92:95]
    ds_read_b64_tr_b16 v[42:43], v5 offset:41984
    s_waitcnt vmcnt(4) lgkmcnt(10)
    v_mfma_f32_16x16x32_bf16 v[64:67], v[48:51], v[200:203], v[64:67]
    ds_read_b64_tr_b16 v[44:45], v6 offset:40960
    v_mfma_f32_16x16x32_bf16 v[68:71], v[48:51], v[204:207], v[68:71]
    ds_read_b64_tr_b16 v[46:47], v6 offset:41984
    v_mfma_f32_16x16x32_bf16 v[72:75], v[52:55], v[200:203], v[72:75]
    ds_read_b64_tr_b16 v[48:49], v3 offset:45056
    v_mfma_f32_16x16x32_bf16 v[76:79], v[52:55], v[204:207], v[76:79]
    ds_read_b64_tr_b16 v[50:51], v3 offset:46080
    s_waitcnt lgkmcnt(10)
    v_mfma_f32_16x16x32_bf16 v[80:83], v[56:59], v[200:203], v[80:83]
    ds_read_b64_tr_b16 v[52:53], v4 offset:45056
    v_mfma_f32_16x16x32_bf16 v[84:87], v[56:59], v[204:207], v[84:87]
    ds_read_b64_tr_b16 v[54:55], v4 offset:46080
    v_mfma_f32_16x16x32_bf16 v[88:91], v[60:63], v[200:203], v[88:91]
    ds_read_b64_tr_b16 v[56:57], v5 offset:45056
    v_mfma_f32_16x16x32_bf16 v[92:95], v[60:63], v[204:207], v[92:95]
    ds_read_b64_tr_b16 v[58:59], v5 offset:46080
    s_waitcnt vmcnt(2) lgkmcnt(10)
    v_mfma_f32_16x16x32_bf16 v[64:67], v[32:35], v[208:211], v[64:67]
    ds_read_b64_tr_b16 v[60:61], v6 offset:45056
    v_mfma_f32_16x16x32_bf16 v[68:71], v[32:35], v[212:215], v[68:71]
    ds_read_b64_tr_b16 v[62:63], v6 offset:46080
    v_mfma_f32_16x16x32_bf16 v[72:75], v[36:39], v[208:211], v[72:75]
    ds_read_b64_tr_b16 v[32:33], v3 offset:49152
    ds_read_b32 v8, v9 offset:4096
    v_mfma_f32_16x16x32_bf16 v[76:79], v[36:39], v[212:215], v[76:79]
    ds_read_b64_tr_b16 v[34:35], v3 offset:50176
    ds_read_b32 v10, v9 offset:4608
    s_waitcnt lgkmcnt(12)
    v_mfma_f32_16x16x32_bf16 v[80:83], v[40:43], v[208:211], v[80:83]
    ds_read_b64_tr_b16 v[36:37], v4 offset:49152
    ds_read_b32 v12, v9 offset:4160
    v_mfma_f32_16x16x32_bf16 v[84:87], v[40:43], v[212:215], v[84:87]
    ds_read_b64_tr_b16 v[38:39], v4 offset:50176
    ds_read_b32 v14, v9 offset:4672
    v_mfma_f32_16x16x32_bf16 v[88:91], v[44:47], v[208:211], v[88:91]
    ds_read_b64_tr_b16 v[40:41], v5 offset:49152
    ds_read_b128 v[16:19], v11 offset:256
    v_mfma_f32_16x16x32_bf16 v[92:95], v[44:47], v[212:215], v[92:95]
    ds_read_b64_tr_b16 v[42:43], v5 offset:50176
    ds_read_b128 v[20:23], v11 offset:320
    s_waitcnt vmcnt(0) lgkmcnt(14)
    v_mfma_f32_16x16x32_bf16 v[64:67], v[48:51], v[216:219], v[64:67]
    ds_read_b64_tr_b16 v[44:45], v6 offset:49152
    ds_read_b128 v[24:27], v11 offset:384
    v_mfma_f32_16x16x32_bf16 v[68:71], v[48:51], v[220:223], v[68:71]
    ds_read_b64_tr_b16 v[46:47], v6 offset:50176
    ds_read_b128 v[28:31], v11 offset:448
    v_mfma_f32_16x16x32_bf16 v[72:75], v[52:55], v[216:219], v[72:75]
    ds_read_b64_tr_b16 v[48:49], v3 offset:53248
    v_mfma_f32_16x16x32_bf16 v[76:79], v[52:55], v[220:223], v[76:79]
    ds_read_b64_tr_b16 v[50:51], v3 offset:54272
    s_waitcnt lgkmcnt(14)
    v_mfma_f32_16x16x32_bf16 v[80:83], v[56:59], v[216:219], v[80:83]
    ds_read_b64_tr_b16 v[52:53], v4 offset:53248
    v_mfma_f32_16x16x32_bf16 v[84:87], v[56:59], v[220:223], v[84:87]
    ds_read_b64_tr_b16 v[54:55], v4 offset:54272
    v_mfma_f32_16x16x32_bf16 v[88:91], v[60:63], v[216:219], v[88:91]
    ds_read_b64_tr_b16 v[56:57], v5 offset:53248
    v_mfma_f32_16x16x32_bf16 v[92:95], v[60:63], v[220:223], v[92:95]
    ds_read_b64_tr_b16 v[58:59], v5 offset:54272
    s_bitcmp1_b32 s21, 0
    s_cbranch_scc1 c_B
    v_add_u32 v7, s62, v1
    s_waitcnt lgkmcnt(6)
    v_pk_fma_f32 v[68:69], v[12:13], v[16:17], v[68:69] op_sel_hi:[0,1,1] neg_lo:[1,0,0] neg_hi:[1,0,0]
    v_pk_fma_f32 v[70:71], v[12:13], v[18:19], v[70:71] op_sel_hi:[0,1,1] neg_lo:[1,0,0] neg_hi:[1,0,0]
    v_pk_fma_f32 v[76:77], v[12:13], v[20:21], v[76:77] op_sel_hi:[0,1,1] neg_lo:[1,0,0] neg_hi:[1,0,0]
    v_pk_fma_f32 v[78:79], v[12:13], v[22:23], v[78:79] op_sel_hi:[0,1,1] neg_lo:[1,0,0] neg_hi:[1,0,0]
    v_pk_mul_f32 v[68:69], v[14:15], v[68:69] op_sel_hi:[0,1]
    v_pk_mul_f32 v[70:71], v[14:15], v[70:71] op_sel_hi:[0,1]
    v_pk_mul_f32 v[76:77], v[14:15], v[76:77] op_sel_hi:[0,1]
    v_pk_mul_f32 v[78:79], v[14:15], v[78:79] op_sel_hi:[0,1]
    v_cvt_pk_bf16_f32 v68, v68, v69
    v_cvt_pk_bf16_f32 v69, v70, v71
    v_cvt_pk_bf16_f32 v70, v76, v77
    v_cvt_pk_bf16_f32 v71, v78, v79
    ds_write_b128 v7, v[68:71] offset:4096
    v_pk_fma_f32 v[64:65], v[8:9], v[16:17], v[64:65] op_sel_hi:[0,1,1] neg_lo:[1,0,0] neg_hi:[1,0,0]
    v_pk_fma_f32 v[66:67], v[8:9], v[18:19], v[66:67] op_sel_hi:[0,1,1] neg_lo:[1,0,0] neg_hi:[1,0,0]
    v_pk_fma_f32 v[72:73], v[8:9], v[20:21], v[72:73] op_sel_hi:[0,1,1] neg_lo:[1,0,0] neg_hi:[1,0,0]
    v_pk_fma_f32 v[74:75], v[8:9], v[22:23], v[74:75] op_sel_hi:[0,1,1] neg_lo:[1,0,0] neg_hi:[1,0,0]
    v_pk_mul_f32 v[64:65], v[10:11], v[64:65] op_sel_hi:[0,1]
    v_pk_mul_f32 v[66:67], v[10:11], v[66:67] op_sel_hi:[0,1]
    v_pk_mul_f32 v[72:73], v[10:11], v[72:73] op_sel_hi:[0,1]
    v_pk_mul_f32 v[74:75], v[10:11], v[74:75] op_sel_hi:[0,1]
    v_cvt_pk_bf16_f32 v64, v64, v65
    v_cvt_pk_bf16_f32 v65, v66, v67
    v_cvt_pk_bf16_f32 v66, v72, v73
    v_cvt_pk_bf16_f32 v67, v74, v75
    v_pk_fma_f32 v[84:85], v[12:13], v[24:25], v[84:85] op_sel_hi:[0,1,1] neg_lo:[1,0,0] neg_hi:[1,0,0]
    v_pk_fma_f32 v[86:87], v[12:13], v[26:27], v[86:87] op_sel_hi:[0,1,1] neg_lo:[1,0,0] neg_hi:[1,0,0]
    v_pk_fma_f32 v[92:93], v[12:13], v[28:29], v[92:93] op_sel_hi:[0,1,1] neg_lo:[1,0,0] neg_hi:[1,0,0]
    v_pk_fma_f32 v[94:95], v[12:13], v[30:31], v[94:95] op_sel_hi:[0,1,1] neg_lo:[1,0,0] neg_hi:[1,0,0]
    v_pk_mul_f32 v[84:85], v[14:15], v[84:85] op_sel_hi:[0,1]
    v_pk_mul_f32 v[86:87], v[14:15], v[86:87] op_sel_hi:[0,1]
    v_pk_mul_f32 v[92:93], v[14:15], v[92:93] op_sel_hi:[0,1]
    v_pk_mul_f32 v[94:95], v[14:15], v[94:95] op_sel_hi:[0,1]
    v_cvt_pk_bf16_f32 v84, v84, v85
    v_cvt_pk_bf16_f32 v85, v86, v87
    v_cvt_pk_bf16_f32 v86, v92, v93
    v_cvt_pk_bf16_f32 v87, v94, v95
    ds_write_b128 v7, v[84:87] offset:5120
    v_pk_fma_f32 v[80:81], v[8:9], v[24:25], v[80:81] op_sel_hi:[0,1,1] neg_lo:[1,0,0] neg_hi:[1,0,0]
    v_pk_fma_f32 v[82:83], v[8:9], v[26:27], v[82:83] op_sel_hi:[0,1,1] neg_lo:[1,0,0] neg_hi:[1,0,0]
    v_pk_fma_f32 v[88:89], v[8:9], v[28:29], v[88:89] op_sel_hi:[0,1,1] neg_lo:[1,0,0] neg_hi:[1,0,0]
    v_pk_fma_f32 v[90:91], v[8:9], v[30:31], v[90:91] op_sel_hi:[0,1,1] neg_lo:[1,0,0] neg_hi:[1,0,0]
    v_pk_mul_f32 v[80:81], v[10:11], v[80:81] op_sel_hi:[0,1]
    v_pk_mul_f32 v[82:83], v[10:11], v[82:83] op_sel_hi:[0,1]
    v_pk_mul_f32 v[88:89], v[10:11], v[88:89] op_sel_hi:[0,1]
    v_pk_mul_f32 v[90:91], v[10:11], v[90:91] op_sel_hi:[0,1]
    v_cvt_pk_bf16_f32 v80, v80, v81
    v_cvt_pk_bf16_f32 v81, v82, v83
    v_cvt_pk_bf16_f32 v82, v88, v89
    v_cvt_pk_bf16_f32 v83, v90, v91
    v_mfma_f32_16x16x32_bf16 v[96:99], v[160:163], v[32:35], v[96:99]
    ds_read_b64_tr_b16 v[60:61], v6 offset:53248
    v_mfma_f32_16x16x32_bf16 v[100:103], v[164:167], v[32:35], v[100:103]
    ds_read_b64_tr_b16 v[62:63], v6 offset:54272
    v_mfma_f32_16x16x32_bf16 v[104:107], v[160:163], v[36:39], v[104:107]
    ds_read_b64_tr_b16 v[32:33], v3 offset:57344
    v_mfma_f32_16x16x32_bf16 v[108:111], v[164:167], v[36:39], v[108:111]
    ds_read_b64_tr_b16 v[34:35], v3 offset:58368
    v_mfma_f32_16x16x32_bf16 v[112:115], v[160:163], v[40:43], v[112:115]
    ds_read_b64_tr_b16 v[36:37], v4 offset:57344
    v_mfma_f32_16x16x32_bf16 v[116:119], v[164:167], v[40:43], v[116:119]
    ds_read_b64_tr_b16 v[38:39], v4 offset:58368
    v_mfma_f32_16x16x32_bf16 v[120:123], v[160:163], v[44:47], v[120:123]
    ds_read_b64_tr_b16 v[40:41], v5 offset:57344
    v_mfma_f32_16x16x32_bf16 v[124:127], v[164:167], v[44:47], v[124:127]
    ds_read_b64_tr_b16 v[42:43], v5 offset:58368
    s_waitcnt lgkmcnt(12)
    v_mfma_f32_16x16x32_bf16 v[96:99], v[168:171], v[48:51], v[96:99]
    ds_read_b64_tr_b16 v[44:45], v6 offset:57344
    v_mfma_f32_16x16x32_bf16 v[100:103], v[172:175], v[48:51], v[100:103]
    ds_read_b64_tr_b16 v[46:47], v6 offset:58368
    v_mfma_f32_16x16x32_bf16 v[104:107], v[168:171], v[52:55], v[104:107]
    ds_read_b64_tr_b16 v[48:49], v3 offset:61440
    v_mfma_f32_16x16x32_bf16 v[108:111], v[172:175], v[52:55], v[108:111]
    ds_read_b64_tr_b16 v[50:51], v3 offset:62464
    s_waitcnt lgkmcnt(10)
    v_mfma_f32_16x16x32_bf16 v[112:115], v[168:171], v[56:59], v[112:115]
    ds_read_b64_tr_b16 v[52:53], v4 offset:61440
    v_mfma_f32_16x16x32_bf16 v[116:119], v[172:175], v[56:59], v[116:119]
    ds_read_b64_tr_b16 v[54:55], v4 offset:62464
    v_mfma_f32_16x16x32_bf16 v[120:123], v[168:171], v[60:63], v[120:123]
    ds_read_b64_tr_b16 v[56:57], v5 offset:61440
    v_mfma_f32_16x16x32_bf16 v[124:127], v[172:175], v[60:63], v[124:127]
    ds_read_b64_tr_b16 v[58:59], v5 offset:62464
    s_waitcnt lgkmcnt(10)
    v_mfma_f32_16x16x32_bf16 v[96:99], v[176:179], v[32:35], v[96:99]
    ds_read_b64_tr_b16 v[60:61], v6 offset:61440
    v_mfma_f32_16x16x32_bf16 v[100:103], v[180:183], v[32:35], v[100:103]
    ds_read_b64_tr_b16 v[62:63], v6 offset:62464
    s_barrier
    v_xor_b32 v3, 0x10000, v3
    v_xor_b32 v4, 0x10000, v4
    v_xor_b32 v5, 0x10000, v5
    v_xor_b32 v6, 0x10000, v6
    v_mfma_f32_16x16x32_bf16 v[104:107], v[176:179], v[36:39], v[104:107]
    ds_read_b64_tr_b16 v[32:33], v3 offset:0
    v_mfma_f32_16x16x32_bf16 v[108:111], v[180:183], v[36:39], v[108:111]
    ds_read_b64_tr_b16 v[34:35], v3 offset:1024
    s_waitcnt lgkmcnt(10)
    v_mfma_f32_16x16x32_bf16 v[112:115], v[176:179], v[40:43], v[112:115]
    ds_read_b64_tr_b16 v[36:37], v4 offset:0
    v_mfma_f32_16x16x32_bf16 v[116:119], v[180:183], v[40:43], v[116:119]
    ds_read_b64_tr_b16 v[38:39], v4 offset:1024
    v_mfma_f32_16x16x32_bf16 v[120:123], v[176:179], v[44:47], v[120:123]
    ds_read_b64_tr_b16 v[40:41], v5 offset:0
    v_mfma_f32_16x16x32_bf16 v[124:127], v[180:183], v[44:47], v[124:127]
    ds_read_b64_tr_b16 v[42:43], v5 offset:1024
    s_waitcnt lgkmcnt(10)
    v_mfma_f32_16x16x32_bf16 v[96:99], v[184:187], v[48:51], v[96:99]
    ds_read_b64_tr_b16 v[44:45], v6 offset:0
    v_mfma_f32_16x16x32_bf16 v[100:103], v[188:191], v[48:51], v[100:103]
    ds_read_b64_tr_b16 v[46:47], v6 offset:1024
    v_mfma_f32_16x16x32_bf16 v[104:107], v[184:187], v[52:55], v[104:107]
    ds_read_b64_tr_b16 v[48:49], v3 offset:4096
    v_mfma_f32_16x16x32_bf16 v[108:111], v[188:191], v[52:55], v[108:111]
    ds_read_b64_tr_b16 v[50:51], v3 offset:5120
    s_waitcnt lgkmcnt(10)
    v_mfma_f32_16x16x32_bf16 v[112:115], v[184:187], v[56:59], v[112:115]
    ds_read_b64_tr_b16 v[52:53], v4 offset:4096
    v_mfma_f32_16x16x32_bf16 v[116:119], v[188:191], v[56:59], v[116:119]
    ds_read_b64_tr_b16 v[54:55], v4 offset:5120
    v_mfma_f32_16x16x32_bf16 v[120:123], v[184:187], v[60:63], v[120:123]
    ds_read_b64_tr_b16 v[56:57], v5 offset:4096
    v_mfma_f32_16x16x32_bf16 v[124:127], v[188:191], v[60:63], v[124:127]
    ds_read_b64_tr_b16 v[58:59], v5 offset:5120
    s_waitcnt lgkmcnt(10)
    v_mfma_f32_16x16x32_bf16 v[96:99], v[192:195], v[32:35], v[96:99]
    ds_read_b64_tr_b16 v[60:61], v6 offset:4096
    v_mfma_f32_16x16x32_bf16 v[100:103], v[196:199], v[32:35], v[100:103]
    ds_read_b64_tr_b16 v[62:63], v6 offset:5120
    v_mfma_f32_16x16x32_bf16 v[104:107], v[192:195], v[36:39], v[104:107]
    ds_read_b64_tr_b16 v[32:33], v3 offset:8192
    v_mfma_f32_16x16x32_bf16 v[108:111], v[196:199], v[36:39], v[108:111]
    ds_read_b64_tr_b16 v[34:35], v3 offset:9216
    s_waitcnt lgkmcnt(10)
    v_mfma_f32_16x16x32_bf16 v[112:115], v[192:195], v[40:43], v[112:115]
    ds_read_b64_tr_b16 v[36:37], v4 offset:8192
    v_mfma_f32_16x16x32_bf16 v[116:119], v[196:199], v[40:43], v[116:119]
    ds_read_b64_tr_b16 v[38:39], v4 offset:9216
    v_mfma_f32_16x16x32_bf16 v[120:123], v[192:195], v[44:47], v[120:123]
    ds_read_b64_tr_b16 v[40:41], v5 offset:8192
    v_mfma_f32_16x16x32_bf16 v[124:127], v[196:199], v[44:47], v[124:127]
    ds_read_b64_tr_b16 v[42:43], v5 offset:9216
    s_waitcnt lgkmcnt(10)
    v_mfma_f32_16x16x32_bf16 v[96:99], v[200:203], v[48:51], v[96:99]
    ds_read_b64_tr_b16 v[44:45], v6 offset:8192
    v_mfma_f32_16x16x32_bf16 v[100:103], v[204:207], v[48:51], v[100:103]
    ds_read_b64_tr_b16 v[46:47], v6 offset:9216
    v_mfma_f32_16x16x32_bf16 v[104:107], v[200:203], v[52:55], v[104:107]
    ds_read_b64_tr_b16 v[48:49], v3 offset:12288
    v_mfma_f32_16x16x32_bf16 v[108:111], v[204:207], v[52:55], v[108:111]
    ds_read_b64_tr_b16 v[50:51], v3 offset:13312
    s_waitcnt lgkmcnt(10)
    v_mfma_f32_16x16x32_bf16 v[112:115], v[200:203], v[56:59], v[112:115]
    ds_read_b64_tr_b16 v[52:53], v4 offset:12288
    v_mfma_f32_16x16x32_bf16 v[116:119], v[204:207], v[56:59], v[116:119]
    ds_read_b64_tr_b16 v[54:55], v4 offset:13312
    v_mfma_f32_16x16x32_bf16 v[120:123], v[200:203], v[60:63], v[120:123]
    ds_read_b64_tr_b16 v[56:57], v5 offset:12288
    v_mfma_f32_16x16x32_bf16 v[124:127], v[204:207], v[60:63], v[124:127]
    ds_read_b64_tr_b16 v[58:59], v5 offset:13312
    s_waitcnt lgkmcnt(10)
    v_mfma_f32_16x16x32_bf16 v[96:99], v[208:211], v[32:35], v[96:99]
    ds_read_b64_tr_b16 v[60:61], v6 offset:12288
    v_mfma_f32_16x16x32_bf16 v[100:103], v[212:215], v[32:35], v[100:103]
    ds_read_b64_tr_b16 v[62:63], v6 offset:13312
    v_mfma_f32_16x16x32_bf16 v[104:107], v[208:211], v[36:39], v[104:107]
    ds_read_b64_tr_b16 v[32:33], v3 offset:16384
    ds_read_b128 v[16:19], v13 offset:4096
    v_mfma_f32_16x16x32_bf16 v[108:111], v[212:215], v[36:39], v[108:111]
    ds_read_b64_tr_b16 v[34:35], v3 offset:17408
    ds_read_b128 v[20:23], v13 offset:4608
    s_waitcnt lgkmcnt(12)
    v_mfma_f32_16x16x32_bf16 v[112:115], v[208:211], v[40:43], v[112:115]
    ds_read_b64_tr_b16 v[36:37], v4 offset:16384
    ds_read_b128 v[24:27], v13 offset:4160
    v_mfma_f32_16x16x32_bf16 v[116:119], v[212:215], v[40:43], v[116:119]
    ds_read_b64_tr_b16 v[38:39], v4 offset:17408
    ds_read_b128 v[28:31], v13 offset:4672
    v_mfma_f32_16x16x32_bf16 v[120:123], v[208:211], v[44:47], v[120:123]
    ds_read_b64_tr_b16 v[40:41], v5 offset:16384
    ds_read_b32 v8, v15 offset:512
    v_mfma_f32_16x16x32_bf16 v[124:127], v[212:215], v[44:47], v[124:127]
    ds_read_b64_tr_b16 v[42:43], v5 offset:17408
    ds_read_b32 v10, v15 offset:576
    s_waitcnt lgkmcnt(14)
    v_mfma_f32_16x16x32_bf16 v[96:99], v[216:219], v[48:51], v[96:99]
    ds_read_b64_tr_b16 v[44:45], v6 offset:16384
    ds_read_b32 v12, v15 offset:640
    v_mfma_f32_16x16x32_bf16 v[100:103], v[220:223], v[48:51], v[100:103]
    ds_read_b64_tr_b16 v[46:47], v6 offset:17408
    ds_read_b32 v14, v15 offset:704
    v_mfma_f32_16x16x32_bf16 v[104:107], v[216:219], v[52:55], v[104:107]
    ds_read_b64_tr_b16 v[48:49], v3 offset:20480
    v_mfma_f32_16x16x32_bf16 v[108:111], v[220:223], v[52:55], v[108:111]
    ds_read_b64_tr_b16 v[50:51], v3 offset:21504
    s_waitcnt lgkmcnt(14)
    v_mfma_f32_16x16x32_bf16 v[112:115], v[216:219], v[56:59], v[112:115]
    ds_read_b64_tr_b16 v[52:53], v4 offset:20480
    v_mfma_f32_16x16x32_bf16 v[116:119], v[220:223], v[56:59], v[116:119]
    ds_read_b64_tr_b16 v[54:55], v4 offset:21504
    v_mfma_f32_16x16x32_bf16 v[120:123], v[216:219], v[60:63], v[120:123]
    ds_read_b64_tr_b16 v[56:57], v5 offset:20480
    v_mfma_f32_16x16x32_bf16 v[124:127], v[220:223], v[60:63], v[124:127]
    ds_read_b64_tr_b16 v[58:59], v5 offset:21504
    s_waitcnt lgkmcnt(6)
    v_pk_fma_f32 v[100:101], v[8:9], v[24:25], v[100:101] op_sel_hi:[0,1,1] neg_lo:[1,0,0] neg_hi:[1,0,0]
    v_pk_fma_f32 v[102:103], v[8:9], v[26:27], v[102:103] op_sel_hi:[0,1,1] neg_lo:[1,0,0] neg_hi:[1,0,0]
    v_pk_fma_f32 v[108:109], v[10:11], v[24:25], v[108:109] op_sel_hi:[0,1,1] neg_lo:[1,0,0] neg_hi:[1,0,0]
    v_pk_fma_f32 v[110:111], v[10:11], v[26:27], v[110:111] op_sel_hi:[0,1,1] neg_lo:[1,0,0] neg_hi:[1,0,0]
    v_pk_mul_f32 v[100:101], v[28:29], v[100:101]
    v_pk_mul_f32 v[102:103], v[30:31], v[102:103]
    v_pk_mul_f32 v[108:109], v[28:29], v[108:109]
    v_pk_mul_f32 v[110:111], v[30:31], v[110:111]
    v_cvt_pk_bf16_f32 v74, v100, v101
    v_cvt_pk_bf16_f32 v75, v102, v103
    v_cvt_pk_bf16_f32 v78, v108, v109
    v_cvt_pk_bf16_f32 v79, v110, v111
    v_cvt_pk_bf16_f32 v100, v100, v101
    v_cvt_pk_bf16_f32 v101, v102, v103
    v_cvt_pk_bf16_f32 v102, v108, v109
    v_cvt_pk_bf16_f32 v103, v110, v111
    ds_write_b128 v7, v[100:103] offset:6144
    v_pk_fma_f32 v[116:117], v[12:13], v[24:25], v[116:117] op_sel_hi:[0,1,1] neg_lo:[1,0,0] neg_hi:[1,0,0]
    v_pk_fma_f32 v[118:119], v[12:13], v[26:27], v[118:119] op_sel_hi:[0,1,1] neg_lo:[1,0,0] neg_hi:[1,0,0]
    v_pk_fma_f32 v[124:125], v[14:15], v[24:25], v[124:125] op_sel_hi:[0,1,1] neg_lo:[1,0,0] neg_hi:[1,0,0]
    v_pk_fma_f32 v[126:127], v[14:15], v[26:27], v[126:127] op_sel_hi:[0,1,1] neg_lo:[1,0,0] neg_hi:[1,0,0]
    v_pk_mul_f32 v[116:117], v[28:29], v[116:117]
    v_pk_mul_f32 v[118:119], v[30:31], v[118:119]
    v_pk_mul_f32 v[124:125], v[28:29], v[124:125]
    v_pk_mul_f32 v[126:127], v[30:31], v[126:127]
    v_cvt_pk_bf16_f32 v90, v116, v117
    v_cvt_pk_bf16_f32 v91, v118, v119
    v_cvt_pk_bf16_f32 v94, v124, v125
    v_cvt_pk_bf16_f32 v95, v126, v127
    v_cvt_pk_bf16_f32 v116, v116, v117
    v_cvt_pk_bf16_f32 v117, v118, v119
    v_cvt_pk_bf16_f32 v118, v124, v125
    v_cvt_pk_bf16_f32 v119, v126, v127
    ds_write_b128 v7, v[116:119] offset:7168
    s_cmp_lg_u32 s16, 3
    s_cbranch_scc1 a_nh
    buffer_store_dwordx4 v[68:71], v1, s[4:7], s60 offen offset:0 sc1
    buffer_store_dwordx4 v[84:87], v1, s[4:7], s60 offen offset:1024 sc1
    buffer_store_dwordx4 v[100:103], v1, s[4:7], s60 offen offset:2048 sc1
    buffer_store_dwordx4 v[116:119], v1, s[4:7], s60 offen offset:3072 sc1
a_nh:
    v_pk_fma_f32 v[96:97], v[8:9], v[16:17], v[96:97] op_sel_hi:[0,1,1] neg_lo:[1,0,0] neg_hi:[1,0,0]
    v_pk_fma_f32 v[98:99], v[8:9], v[18:19], v[98:99] op_sel_hi:[0,1,1] neg_lo:[1,0,0] neg_hi:[1,0,0]
    v_pk_fma_f32 v[104:105], v[10:11], v[16:17], v[104:105] op_sel_hi:[0,1,1] neg_lo:[1,0,0] neg_hi:[1,0,0]
    v_pk_fma_f32 v[106:107], v[10:11], v[18:19], v[106:107] op_sel_hi:[0,1,1] neg_lo:[1,0,0] neg_hi:[1,0,0]
    v_pk_mul_f32 v[96:97], v[20:21], v[96:97]
    v_pk_mul_f32 v[98:99], v[22:23], v[98:99]
    v_pk_mul_f32 v[104:105], v[20:21], v[104:105]
    v_pk_mul_f32 v[106:107], v[22:23], v[106:107]
    v_cvt_pk_bf16_f32 v72, v96, v97
    v_cvt_pk_bf16_f32 v73, v98, v99
    v_cvt_pk_bf16_f32 v76, v104, v105
    v_cvt_pk_bf16_f32 v77, v106, v107
    v_pk_fma_f32 v[112:113], v[12:13], v[16:17], v[112:113] op_sel_hi:[0,1,1] neg_lo:[1,0,0] neg_hi:[1,0,0]
    v_pk_fma_f32 v[114:115], v[12:13], v[18:19], v[114:115] op_sel_hi:[0,1,1] neg_lo:[1,0,0] neg_hi:[1,0,0]
    v_pk_fma_f32 v[120:121], v[14:15], v[16:17], v[120:121] op_sel_hi:[0,1,1] neg_lo:[1,0,0] neg_hi:[1,0,0]
    v_pk_fma_f32 v[122:123], v[14:15], v[18:19], v[122:123] op_sel_hi:[0,1,1] neg_lo:[1,0,0] neg_hi:[1,0,0]
    v_pk_mul_f32 v[112:113], v[20:21], v[112:113]
    v_pk_mul_f32 v[114:115], v[22:23], v[114:115]
    v_pk_mul_f32 v[120:121], v[20:21], v[120:121]
    v_pk_mul_f32 v[122:123], v[22:23], v[122:123]
    v_cvt_pk_bf16_f32 v88, v112, v113
    v_cvt_pk_bf16_f32 v89, v114, v115
    v_cvt_pk_bf16_f32 v92, v120, v121
    v_cvt_pk_bf16_f32 v93, v122, v123
    v_mfma_f32_16x16x32_bf16 v[128:131], v[32:35], v[224:227], v[128:131]
    ds_read_b64_tr_b16 v[60:61], v6 offset:20480
    v_mfma_f32_16x16x32_bf16 v[132:135], v[32:35], v[228:231], v[132:135]
    ds_read_b64_tr_b16 v[62:63], v6 offset:21504
    v_mfma_f32_16x16x32_bf16 v[136:139], v[36:39], v[224:227], v[136:139]
    ds_read_b64_tr_b16 v[32:33], v3 offset:24576
    v_mfma_f32_16x16x32_bf16 v[140:143], v[36:39], v[228:231], v[140:143]
    ds_read_b64_tr_b16 v[34:35], v3 offset:25600
    v_mfma_f32_16x16x32_bf16 v[144:147], v[40:43], v[224:227], v[144:147]
    ds_read_b64_tr_b16 v[36:37], v4 offset:24576
    v_mfma_f32_16x16x32_bf16 v[148:151], v[40:43], v[228:231], v[148:151]
    ds_read_b64_tr_b16 v[38:39], v4 offset:25600
    v_mfma_f32_16x16x32_bf16 v[152:155], v[44:47], v[224:227], v[152:155]
    ds_read_b64_tr_b16 v[40:41], v5 offset:24576
    v_mfma_f32_16x16x32_bf16 v[156:159], v[44:47], v[228:231], v[156:159]
    ds_read_b64_tr_b16 v[42:43], v5 offset:25600
    s_waitcnt lgkmcnt(12)
    v_mfma_f32_16x16x32_bf16 v[128:131], v[48:51], v[232:235], v[128:131]
    ds_read_b64_tr_b16 v[44:45], v6 offset:24576
    v_mfma_f32_16x16x32_bf16 v[132:135], v[48:51], v[236:239], v[132:135]
    ds_read_b64_tr_b16 v[46:47], v6 offset:25600
    v_mfma_f32_16x16x32_bf16 v[136:139], v[52:55], v[232:235], v[136:139]
    ds_read_b64_tr_b16 v[48:49], v3 offset:28672
    v_mfma_f32_16x16x32_bf16 v[140:143], v[52:55], v[236:239], v[140:143]
    ds_read_b64_tr_b16 v[50:51], v3 offset:29696
    s_waitcnt lgkmcnt(10)
    v_mfma_f32_16x16x32_bf16 v[144:147], v[56:59], v[232:235], v[144:147]
    ds_read_b64_tr_b16 v[52:53], v4 offset:28672
    v_mfma_f32_16x16x32_bf16 v[148:151], v[56:59], v[236:239], v[148:151]
    ds_read_b64_tr_b16 v[54:55], v4 offset:29696
    v_mfma_f32_16x16x32_bf16 v[152:155], v[60:63], v[232:235], v[152:155]
    ds_read_b64_tr_b16 v[56:57], v5 offset:28672
    v_mfma_f32_16x16x32_bf16 v[156:159], v[60:63], v[236:239], v[156:159]
    ds_read_b64_tr_b16 v[58:59], v5 offset:29696
    s_waitcnt lgkmcnt(10)
    v_mfma_f32_16x16x32_bf16 v[128:131], v[32:35], v[240:243], v[128:131]
    ds_read_b64_tr_b16 v[60:61], v6 offset:28672
    v_mfma_f32_16x16x32_bf16 v[132:135], v[32:35], v[244:247], v[132:135]
    ds_read_b64_tr_b16 v[62:63], v6 offset:29696
    s_barrier
    v_mfma_f32_16x16x32_bf16 v[136:139], v[36:39], v[240:243], v[136:139]
    ds_read_b64_tr_b16 v[32:33], v3 offset:32768
    v_mfma_f32_16x16x32_bf16 v[140:143], v[36:39], v[244:247], v[140:143]
    ds_read_b64_tr_b16 v[34:35], v3 offset:33792
    s_waitcnt lgkmcnt(10)
    v_mfma_f32_16x16x32_bf16 v[144:147], v[40:43], v[240:243], v[144:147]
    ds_read_b64_tr_b16 v[36:37], v4 offset:32768
    v_mfma_f32_16x16x32_bf16 v[148:151], v[40:43], v[244:247], v[148:151]
    ds_read_b64_tr_b16 v[38:39], v4 offset:33792
    v_mfma_f32_16x16x32_bf16 v[152:155], v[44:47], v[240:243], v[152:155]
    ds_read_b64_tr_b16 v[40:41], v5 offset:32768
    v_mfma_f32_16x16x32_bf16 v[156:159], v[44:47], v[244:247], v[156:159]
    ds_read_b64_tr_b16 v[42:43], v5 offset:33792
    s_waitcnt lgkmcnt(10)
    v_mfma_f32_16x16x32_bf16 v[128:131], v[48:51], v[248:251], v[128:131]
    ds_read_b64_tr_b16 v[44:45], v6 offset:32768
    v_mfma_f32_16x16x32_bf16 v[132:135], v[48:51], v[252:255], v[132:135]
    ds_read_b64_tr_b16 v[46:47], v6 offset:33792
    v_mfma_f32_16x16x32_bf16 v[136:139], v[52:55], v[248:251], v[136:139]
    ds_read_b64_tr_b16 v[48:49], v3 offset:36864
    v_mfma_f32_16x16x32_bf16 v[140:143], v[52:55], v[252:255], v[140:143]
    ds_read_b64_tr_b16 v[50:51], v3 offset:37888
    s_waitcnt lgkmcnt(10)
    v_mfma_f32_16x16x32_bf16 v[144:147], v[56:59], v[248:251], v[144:147]
    ds_read_b64_tr_b16 v[52:53], v4 offset:36864
    v_mfma_f32_16x16x32_bf16 v[148:151], v[56:59], v[252:255], v[148:151]
    ds_read_b64_tr_b16 v[54:55], v4 offset:37888
    v_mfma_f32_16x16x32_bf16 v[152:155], v[60:63], v[248:251], v[152:155]
    ds_read_b64_tr_b16 v[56:57], v5 offset:36864
    v_mfma_f32_16x16x32_bf16 v[156:159], v[60:63], v[252:255], v[156:159]
    ds_read_b64_tr_b16 v[58:59], v5 offset:37888
    s_waitcnt lgkmcnt(10)
    v_mfma_f32_16x16x32_bf16 v[128:131], v[32:35], v[160:163], v[128:131]
    ds_read_b64_tr_b16 v[60:61], v6 offset:36864
    v_mfma_f32_16x16x32_bf16 v[132:135], v[32:35], v[164:167], v[132:135]
    ds_read_b64_tr_b16 v[62:63], v6 offset:37888
    v_mfma_f32_16x16x32_bf16 v[136:139], v[36:39], v[160:163], v[136:139]
    ds_read_b64_tr_b16 v[32:33], v3 offset:40960
    v_mfma_f32_16x16x32_bf16 v[140:143], v[36:39], v[164:167], v[140:143]
    ds_read_b64_tr_b16 v[34:35], v3 offset:41984
    s_waitcnt lgkmcnt(10)
    v_mfma_f32_16x16x32_bf16 v[144:147], v[40:43], v[160:163], v[144:147]
    ds_read_b64_tr_b16 v[36:37], v4 offset:40960
    v_mfma_f32_16x16x32_bf16 v[148:151], v[40:43], v[164:167], v[148:151]
    ds_read_b64_tr_b16 v[38:39], v4 offset:41984
    v_mfma_f32_16x16x32_bf16 v[152:155], v[44:47], v[160:163], v[152:155]
    ds_read_b64_tr_b16 v[40:41], v5 offset:40960
    v_mfma_f32_16x16x32_bf16 v[156:159], v[44:47], v[164:167], v[156:159]
    ds_read_b64_tr_b16 v[42:43], v5 offset:41984
    s_waitcnt lgkmcnt(10)
    v_mfma_f32_16x16x32_bf16 v[128:131], v[48:51], v[168:171], v[128:131]
    ds_read_b64_tr_b16 v[44:45], v6 offset:40960
    s_cmp_lg_u32 s16, 3
    s_cbranch_scc1 a_nopub
    s_waitcnt vmcnt(0)
    s_atomic_add s40, s[22:23], s61
a_nopub:
    v_mfma_f32_16x16x32_bf16 v[132:135], v[48:51], v[172:175], v[132:135]
    ds_read_b64_tr_b16 v[46:47], v6 offset:41984
    v_mfma_f32_16x16x32_bf16 v[136:139], v[52:55], v[168:171], v[136:139]
    ds_read_b64_tr_b16 v[48:49], v3 offset:45056
    v_mfma_f32_16x16x32_bf16 v[140:143], v[52:55], v[172:175], v[140:143]
    ds_read_b64_tr_b16 v[50:51], v3 offset:46080
    s_waitcnt lgkmcnt(10)
    v_mfma_f32_16x16x32_bf16 v[144:147], v[56:59], v[168:171], v[144:147]
    ds_read_b64_tr_b16 v[52:53], v4 offset:45056
    v_mfma_f32_16x16x32_bf16 v[148:151], v[56:59], v[172:175], v[148:151]
    ds_read_b64_tr_b16 v[54:55], v4 offset:46080
    v_mfma_f32_16x16x32_bf16 v[152:155], v[60:63], v[168:171], v[152:155]
    ds_read_b64_tr_b16 v[56:57], v5 offset:45056
    v_mfma_f32_16x16x32_bf16 v[156:159], v[60:63], v[172:175], v[156:159]
    ds_read_b64_tr_b16 v[58:59], v5 offset:46080
    s_waitcnt lgkmcnt(10)
    v_mfma_f32_16x16x32_bf16 v[128:131], v[32:35], v[176:179], v[128:131]
    ds_read_b64_tr_b16 v[60:61], v6 offset:45056
    v_mfma_f32_16x16x32_bf16 v[132:135], v[32:35], v[180:183], v[132:135]
    ds_read_b64_tr_b16 v[62:63], v6 offset:46080
    v_mfma_f32_16x16x32_bf16 v[136:139], v[36:39], v[176:179], v[136:139]
    ds_read_b64_tr_b16 v[32:33], v3 offset:49152
    v_mfma_f32_16x16x32_bf16 v[140:143], v[36:39], v[180:183], v[140:143]
    ds_read_b64_tr_b16 v[34:35], v3 offset:50176
    s_waitcnt lgkmcnt(10)
    v_mfma_f32_16x16x32_bf16 v[144:147], v[40:43], v[176:179], v[144:147]
    ds_read_b64_tr_b16 v[36:37], v4 offset:49152
    v_mfma_f32_16x16x32_bf16 v[148:151], v[40:43], v[180:183], v[148:151]
    ds_read_b64_tr_b16 v[38:39], v4 offset:50176
    v_mfma_f32_16x16x32_bf16 v[152:155], v[44:47], v[176:179], v[152:155]
    ds_read_b64_tr_b16 v[40:41], v5 offset:49152
    v_mfma_f32_16x16x32_bf16 v[156:159], v[44:47], v[180:183], v[156:159]
    ds_read_b64_tr_b16 v[42:43], v5 offset:50176
    s_waitcnt lgkmcnt(10)
    v_mfma_f32_16x16x32_bf16 v[128:131], v[48:51], v[184:187], v[128:131]
    ds_read_b64_tr_b16 v[44:45], v6 offset:49152
    ds_read_b32 v8, v9 offset:4096
    v_mfma_f32_16x16x32_bf16 v[132:135], v[48:51], v[188:191], v[132:135]
    ds_read_b64_tr_b16 v[46:47], v6 offset:50176
    ds_read_b32 v10, v9 offset:4608
    v_mfma_f32_16x16x32_bf16 v[136:139], v[52:55], v[184:187], v[136:139]
    ds_read_b64_tr_b16 v[48:49], v3 offset:53248
    ds_read_b32 v12, v9 offset:4160
    v_mfma_f32_16x16x32_bf16 v[140:143], v[52:55], v[188:191], v[140:143]
    ds_read_b64_tr_b16 v[50:51], v3 offset:54272
    ds_read_b32 v14, v9 offset:4672
    s_waitcnt lgkmcnt(14)
    v_mfma_f32_16x16x32_bf16 v[144:147], v[56:59], v[184:187], v[144:147]
    ds_read_b64_tr_b16 v[52:53], v4 offset:53248
    ds_read_b128 v[16:19], v11 offset:0
    v_mfma_f32_16x16x32_bf16 v[148:151], v[56:59], v[188:191], v[148:151]
    ds_read_b64_tr_b16 v[54:55], v4 offset:54272
    ds_read_b128 v[20:23], v11 offset:64
    v_mfma_f32_16x16x32_bf16 v[152:155], v[60:63], v[184:187], v[152:155]
    ds_read_b64_tr_b16 v[56:57], v5 offset:53248
    ds_read_b128 v[24:27], v11 offset:128
    v_mfma_f32_16x16x32_bf16 v[156:159], v[60:63], v[188:191], v[156:159]
    ds_read_b64_tr_b16 v[58:59], v5 offset:54272
    ds_read_b128 v[28:31], v11 offset:192
    s_waitcnt lgkmcnt(14)
    v_mfma_f32_16x16x32_bf16 v[128:131], v[32:35], v[192:195], v[128:131]
    ds_read_b64_tr_b16 v[60:61], v6 offset:53248
    v_add_u32 v13, 153600, v1
    v_mfma_f32_16x16x32_bf16 v[132:135], v[32:35], v[196:199], v[132:135]
    ds_read_b64_tr_b16 v[62:63], v6 offset:54272
    v_mfma_f32_16x16x32_bf16 v[136:139], v[36:39], v[192:195], v[136:139]
    ds_read_b64_tr_b16 v[32:33], v3 offset:57344
    v_mfma_f32_16x16x32_bf16 v[140:143], v[36:39], v[196:199], v[140:143]
    ds_read_b64_tr_b16 v[34:35], v3 offset:58368
    s_waitcnt lgkmcnt(14)
    v_mfma_f32_16x16x32_bf16 v[144:147], v[40:43], v[192:195], v[144:147]
    ds_read_b64_tr_b16 v[36:37], v4 offset:57344
    v_mfma_f32_16x16x32_bf16 v[148:151], v[40:43], v[196:199], v[148:151]
    ds_read_b64_tr_b16 v[38:39], v4 offset:58368
    v_mfma_f32_16x16x32_bf16 v[152:155], v[44:47], v[192:195], v[152:155]
    ds_read_b64_tr_b16 v[40:41], v5 offset:57344
    v_mfma_f32_16x16x32_bf16 v[156:159], v[44:47], v[196:199], v[156:159]
    ds_read_b64_tr_b16 v[42:43], v5 offset:58368
    s_waitcnt lgkmcnt(13)
    v_mfma_f32_16x16x32_bf16 v[128:131], v[48:51], v[200:203], v[128:131]
    ds_read_b64_tr_b16 v[44:45], v6 offset:57344
    s_waitcnt lgkmcnt(9)
    v_mfma_f32_16x16x32_bf16 v[132:135], v[48:51], v[204:207], v[132:135]
    ds_read_b64_tr_b16 v[46:47], v6 offset:58368
    v_mul_f32 v10, 0x3e8293ee, v10
    v_mfma_f32_16x16x32_bf16 v[136:139], v[52:55], v[200:203], v[136:139]
    ds_read_b64_tr_b16 v[48:49], v3 offset:61440
    v_mul_f32 v14, 0x3e8293ee, v14
    v_mfma_f32_16x16x32_bf16 v[140:143], v[52:55], v[204:207], v[140:143]
    ds_read_b64_tr_b16 v[50:51], v3 offset:62464
    ds_read_b128 v[120:123], v13 offset:0
    s_waitcnt lgkmcnt(11)
    v_mfma_f32_16x16x32_bf16 v[144:147], v[56:59], v[200:203], v[144:147]
    ds_read_b64_tr_b16 v[52:53], v4 offset:61440
    ds_read_b128 v[124:127], v13 offset:1024
    v_mfma_f32_16x16x32_bf16 v[148:151], v[56:59], v[204:207], v[148:151]
    ds_read_b64_tr_b16 v[54:55], v4 offset:62464
    v_mfma_f32_16x16x32_bf16 v[152:155], v[60:63], v[200:203], v[152:155]
    ds_read_b64_tr_b16 v[56:57], v5 offset:61440
    v_mfma_f32_16x16x32_bf16 v[156:159], v[60:63], v[204:207], v[156:159]
    ds_read_b64_tr_b16 v[58:59], v5 offset:62464
    s_waitcnt lgkmcnt(12)
    v_mfma_f32_16x16x32_bf16 v[128:131], v[32:35], v[208:211], v[128:131]
    ds_read_b64_tr_b16 v[60:61], v6 offset:61440
    v_mfma_f32_16x16x32_bf16 v[132:135], v[32:35], v[212:215], v[132:135]
    ds_read_b64_tr_b16 v[62:63], v6 offset:62464
    v_xor_b32 v3, 0x10000, v3
    v_xor_b32 v4, 0x10000, v4
    v_xor_b32 v5, 0x10000, v5
    v_xor_b32 v6, 0x10000, v6
    v_mfma_f32_16x16x32_bf16 v[136:139], v[36:39], v[208:211], v[136:139]
    v_mfma_f32_16x16x32_bf16 v[140:143], v[36:39], v[212:215], v[140:143]
    s_waitcnt lgkmcnt(10)
    v_mfma_f32_16x16x32_bf16 v[144:147], v[40:43], v[208:211], v[144:147]
    v_mfma_f32_16x16x32_bf16 v[148:151], v[40:43], v[212:215], v[148:151]
    v_mfma_f32_16x16x32_bf16 v[152:155], v[44:47], v[208:211], v[152:155]
    v_mfma_f32_16x16x32_bf16 v[156:159], v[44:47], v[212:215], v[156:159]
    s_waitcnt lgkmcnt(4)
    v_mfma_f32_16x16x32_bf16 v[128:131], v[48:51], v[216:219], v[128:131]
    v_mfma_f32_16x16x32_bf16 v[132:135], v[48:51], v[220:223], v[132:135]
    v_mfma_f32_16x16x32_bf16 v[136:139], v[52:55], v[216:219], v[136:139]
    v_mfma_f32_16x16x32_bf16 v[140:143], v[52:55], v[220:223], v[140:143]
    s_waitcnt lgkmcnt(0)
    v_mfma_f32_16x16x32_bf16 v[144:147], v[56:59], v[216:219], v[144:147]
    v_mfma_f32_16x16x32_bf16 v[148:151], v[56:59], v[220:223], v[148:151]
    v_mfma_f32_16x16x32_bf16 v[152:155], v[60:63], v[216:219], v[152:155]
    v_mfma_f32_16x16x32_bf16 v[156:159], v[60:63], v[220:223], v[156:159]
    s_lshl_b32 s44, s21, 22
    s_lshl_b32 s45, s38, 16
    s_add_u32 s44, s44, s45
    s_lshl_b32 s45, s18, 12
    s_add_u32 s44, s44, s45
    s_add_u32 s52, s44, 16777216
    v_pk_fma_f32 v[132:133], v[12:13], v[16:17], v[132:133] op_sel_hi:[0,1,1] neg_lo:[1,0,0] neg_hi:[1,0,0]
    v_pk_fma_f32 v[134:135], v[12:13], v[18:19], v[134:135] op_sel_hi:[0,1,1] neg_lo:[1,0,0] neg_hi:[1,0,0]
    v_pk_fma_f32 v[140:141], v[12:13], v[20:21], v[140:141] op_sel_hi:[0,1,1] neg_lo:[1,0,0] neg_hi:[1,0,0]
    v_pk_fma_f32 v[142:143], v[12:13], v[22:23], v[142:143] op_sel_hi:[0,1,1] neg_lo:[1,0,0] neg_hi:[1,0,0]
    v_pk_fma_f32 v[148:149], v[12:13], v[24:25], v[148:149] op_sel_hi:[0,1,1] neg_lo:[1,0,0] neg_hi:[1,0,0]
    v_pk_fma_f32 v[150:151], v[12:13], v[26:27], v[150:151] op_sel_hi:[0,1,1] neg_lo:[1,0,0] neg_hi:[1,0,0]
    v_pk_fma_f32 v[156:157], v[12:13], v[28:29], v[156:157] op_sel_hi:[0,1,1] neg_lo:[1,0,0] neg_hi:[1,0,0]
    v_pk_fma_f32 v[158:159], v[12:13], v[30:31], v[158:159] op_sel_hi:[0,1,1] neg_lo:[1,0,0] neg_hi:[1,0,0]
    v_pk_mul_f32 v[132:133], v[14:15], v[132:133] op_sel_hi:[0,1]
    v_pk_mul_f32 v[134:135], v[14:15], v[134:135] op_sel_hi:[0,1]
    v_pk_mul_f32 v[140:141], v[14:15], v[140:141] op_sel_hi:[0,1]
    v_pk_mul_f32 v[142:143], v[14:15], v[142:143] op_sel_hi:[0,1]
    v_pk_mul_f32 v[148:149], v[14:15], v[148:149] op_sel_hi:[0,1]
    v_pk_mul_f32 v[150:151], v[14:15], v[150:151] op_sel_hi:[0,1]
    v_pk_mul_f32 v[156:157], v[14:15], v[156:157] op_sel_hi:[0,1]
    v_pk_mul_f32 v[158:159], v[14:15], v[158:159] op_sel_hi:[0,1]
    v_cvt_pk_bf16_f32 v132, v132, v133
    v_cvt_pk_bf16_f32 v133, v134, v135
    v_cvt_pk_bf16_f32 v134, v140, v141
    v_cvt_pk_bf16_f32 v135, v142, v143
    v_cvt_pk_bf16_f32 v148, v148, v149
    v_cvt_pk_bf16_f32 v149, v150, v151
    v_cvt_pk_bf16_f32 v150, v156, v157
    v_cvt_pk_bf16_f32 v151, v158, v159
    v_mfma_f32_16x16x32_bf16 v[172:175], v[68:71], v[132:135], v[120:123]
    v_mfma_f32_16x16x32_bf16 v[168:171], v[64:67], v[132:135], v[124:127]
    v_mfma_f32_16x16x32_bf16 v[188:191], v[84:87], v[148:151], v[120:123]
    v_mfma_f32_16x16x32_bf16 v[184:187], v[80:83], v[148:151], v[124:127]
    v_pk_fma_f32 v[128:129], v[8:9], v[16:17], v[128:129] op_sel_hi:[0,1,1] neg_lo:[1,0,0] neg_hi:[1,0,0]
    v_pk_fma_f32 v[130:131], v[8:9], v[18:19], v[130:131] op_sel_hi:[0,1,1] neg_lo:[1,0,0] neg_hi:[1,0,0]
    v_pk_fma_f32 v[136:137], v[8:9], v[20:21], v[136:137] op_sel_hi:[0,1,1] neg_lo:[1,0,0] neg_hi:[1,0,0]
    v_pk_fma_f32 v[138:139], v[8:9], v[22:23], v[138:139] op_sel_hi:[0,1,1] neg_lo:[1,0,0] neg_hi:[1,0,0]
    v_pk_fma_f32 v[144:145], v[8:9], v[24:25], v[144:145] op_sel_hi:[0,1,1] neg_lo:[1,0,0] neg_hi:[1,0,0]
    v_pk_fma_f32 v[146:147], v[8:9], v[26:27], v[146:147] op_sel_hi:[0,1,1] neg_lo:[1,0,0] neg_hi:[1,0,0]
    v_pk_fma_f32 v[152:153], v[8:9], v[28:29], v[152:153] op_sel_hi:[0,1,1] neg_lo:[1,0,0] neg_hi:[1,0,0]
    v_pk_fma_f32 v[154:155], v[8:9], v[30:31], v[154:155] op_sel_hi:[0,1,1] neg_lo:[1,0,0] neg_hi:[1,0,0]
    v_pk_mul_f32 v[128:129], v[10:11], v[128:129] op_sel_hi:[0,1]
    v_pk_mul_f32 v[130:131], v[10:11], v[130:131] op_sel_hi:[0,1]
    v_pk_mul_f32 v[136:137], v[10:11], v[136:137] op_sel_hi:[0,1]
    v_pk_mul_f32 v[138:139], v[10:11], v[138:139] op_sel_hi:[0,1]
    v_pk_mul_f32 v[144:145], v[10:11], v[144:145] op_sel_hi:[0,1]
    v_pk_mul_f32 v[146:147], v[10:11], v[146:147] op_sel_hi:[0,1]
    v_pk_mul_f32 v[152:153], v[10:11], v[152:153] op_sel_hi:[0,1]
    v_pk_mul_f32 v[154:155], v[10:11], v[154:155] op_sel_hi:[0,1]
    v_cvt_pk_bf16_f32 v128, v128, v129
    v_cvt_pk_bf16_f32 v129, v130, v131
    v_cvt_pk_bf16_f32 v130, v136, v137
    v_cvt_pk_bf16_f32 v131, v138, v139
    v_cvt_pk_bf16_f32 v144, v144, v145
    v_cvt_pk_bf16_f32 v145, v146, v147
    v_cvt_pk_bf16_f32 v146, v152, v153
    v_cvt_pk_bf16_f32 v147, v154, v155
    v_mfma_f32_16x16x32_bf16 v[164:167], v[64:67], v[128:131], v[120:123]
    s_nop 0
    v_mfma_f32_16x16x32_bf16 v[180:183], v[80:83], v[144:147], v[120:123]
    v_mov_b32 v232, 0x3f803f80
    v_mov_b32 v233, 0x3f803f80
    v_mov_b32 v234, 0x3f803f80
    v_mov_b32 v235, 0x3f803f80
    v_exp_f32 v172, v172
    v_exp_f32 v173, v173
    v_exp_f32 v174, v174
    v_exp_f32 v175, v175
    v_exp_f32 v188, v188
    v_exp_f32 v189, v189
    v_exp_f32 v190, v190
    v_exp_f32 v191, v191
    s_mov_b32 s46, 1006632960
a_exp1:
    v_exp_f32 v168, v168
    v_exp_f32 v169, v169
    v_exp_f32 v170, v170
    v_exp_f32 v171, v171
    v_exp_f32 v184, v184
    v_exp_f32 v185, v185
    v_exp_f32 v186, v186
    v_exp_f32 v187, v187
    v_cvt_pk_bf16_f32 v200, v168, v169
    v_cvt_pk_bf16_f32 v201, v170, v171
    v_cvt_pk_bf16_f32 v202, v172, v173
    v_cvt_pk_bf16_f32 v203, v174, v175
    v_cvt_pk_bf16_f32 v204, v184, v185
    v_cvt_pk_bf16_f32 v205, v186, v187
    v_cvt_pk_bf16_f32 v206, v188, v189
    v_cvt_pk_bf16_f32 v207, v190, v191
    v_mfma_f32_16x16x32_bf16 v[16:19], v[232:235], v[200:203], 0
    s_nop 0
    v_mfma_f32_16x16x32_bf16 v[20:23], v[232:235], v[204:207], 0
    v_mfma_f32_16x16x32_bf16 v[40:43], v[72:75], v[200:203], 0
    v_mfma_f32_16x16x32_bf16 v[44:47], v[76:79], v[200:203], 0
    v_mfma_f32_16x16x32_bf16 v[56:59], v[88:91], v[204:207], 0
    v_mfma_f32_16x16x32_bf16 v[60:63], v[92:95], v[204:207], 0
    v_mov_b32 v218, v72
    v_mov_b32 v219, v73
    v_mov_b32 v222, v76
    v_mov_b32 v223, v77
    v_mov_b32 v226, v88
    v_mov_b32 v227, v89
    v_mov_b32 v230, v92
    v_mov_b32 v231, v93
    v_subrev_u32 v18, 0x21800000, v16
    v_subrev_u32 v22, 0x21800000, v20
    v_max_u32 v18, v18, v22
    v_cmp_le_u32 vcc, s46, v18
    v_rcp_f32 v16, v16
    v_rcp_f32 v20, v20
    s_cbranch_vccnz a_slow1
a_fin1:
    v_pk_mul_f32 v[40:41], v[16:17], v[40:41] op_sel_hi:[0,1]
    v_pk_mul_f32 v[42:43], v[16:17], v[42:43] op_sel_hi:[0,1]
    v_pk_mul_f32 v[44:45], v[16:17], v[44:45] op_sel_hi:[0,1]
    v_pk_mul_f32 v[46:47], v[16:17], v[46:47] op_sel_hi:[0,1]
    v_pk_mul_f32 v[56:57], v[20:21], v[56:57] op_sel_hi:[0,1]
    v_pk_mul_f32 v[58:59], v[20:21], v[58:59] op_sel_hi:[0,1]
    v_pk_mul_f32 v[60:61], v[20:21], v[60:61] op_sel_hi:[0,1]
    v_pk_mul_f32 v[62:63], v[20:21], v[62:63] op_sel_hi:[0,1]
    v_cvt_pk_bf16_f32 v40, v40, v41
    v_cvt_pk_bf16_f32 v41, v42, v43
    v_cvt_pk_bf16_f32 v42, v44, v45
    v_cvt_pk_bf16_f32 v43, v46, v47
    v_cvt_pk_bf16_f32 v56, v56, v57
    v_cvt_pk_bf16_f32 v57, v58, v59
    v_cvt_pk_bf16_f32 v58, v60, v61
    v_cvt_pk_bf16_f32 v59, v62, v63
    v_permlane32_swap_b32 v40, v42
    v_permlane32_swap_b32 v41, v43
    buffer_store_dwordx4 v[40:43], v2, s[4:7], s52 offen offset:256 sc1
    v_permlane32_swap_b32 v56, v58
    v_permlane32_swap_b32 v57, v59
    buffer_store_dwordx4 v[56:59], v2, s[4:7], s52 offen offset:2304 sc1
    s_cmp_lg_u32 s38, 0
    s_cbranch_scc1 a_hasprev
    v_mov_b32 v124, 0xf149f2ca
    v_mov_b32 v125, 0xf149f2ca
    v_mov_b32 v126, 0xf149f2ca
    v_mov_b32 v127, 0xf149f2ca
a_hasprev:
    s_waitcnt lgkmcnt(0)
    s_barrier
    ds_read_b128 v[192:195], v7 offset:0
    ds_read_b128 v[196:199], v7 offset:1024
    ds_read_b64 v[216:217], v7 offset:2048
    ds_read_b64 v[220:221], v7 offset:2056
    ds_read_b64 v[224:225], v7 offset:3072
    ds_read_b64 v[228:229], v7 offset:3080
    s_waitcnt lgkmcnt(4)
    v_mfma_f32_16x16x32_bf16 v[160:163], v[192:195], v[128:131], v[124:127]
    v_mfma_f32_16x16x32_bf16 v[176:179], v[196:199], v[144:147], v[124:127]
    v_exp_f32 v164, v164
    v_exp_f32 v165, v165
    v_exp_f32 v166, v166
    v_exp_f32 v167, v167
    v_exp_f32 v180, v180
    v_exp_f32 v181, v181
    v_exp_f32 v182, v182
    v_exp_f32 v183, v183
    s_waitcnt lgkmcnt(0)
    s_mov_b32 s46, 1006632960
a_exp0:
    v_exp_f32 v160, v160
    v_exp_f32 v161, v161
    v_exp_f32 v162, v162
    v_exp_f32 v163, v163
    v_exp_f32 v176, v176
    v_exp_f32 v177, v177
    v_exp_f32 v178, v178
    v_exp_f32 v179, v179
    v_cvt_pk_bf16_f32 v200, v160, v161
    v_cvt_pk_bf16_f32 v201, v162, v163
    v_cvt_pk_bf16_f32 v202, v164, v165
    v_cvt_pk_bf16_f32 v203, v166, v167
    v_cvt_pk_bf16_f32 v204, v176, v177
    v_cvt_pk_bf16_f32 v205, v178, v179
    v_cvt_pk_bf16_f32 v206, v180, v181
    v_cvt_pk_bf16_f32 v207, v182, v183
    v_mfma_f32_16x16x32_bf16 v[16:19], v[232:235], v[200:203], 0
    s_nop 0
    v_mfma_f32_16x16x32_bf16 v[20:23], v[232:235], v[204:207], 0
    v_mfma_f32_16x16x32_bf16 v[32:35], v[216:219], v[200:203], 0
    v_mfma_f32_16x16x32_bf16 v[36:39], v[220:223], v[200:203], 0
    v_mfma_f32_16x16x32_bf16 v[48:51], v[224:227], v[204:207], 0
    v_mfma_f32_16x16x32_bf16 v[52:55], v[228:231], v[204:207], 0
    s_nop 1
    v_subrev_u32 v18, 0x21800000, v16
    s_nop 0
    v_subrev_u32 v22, 0x21800000, v20
    v_max_u32 v18, v18, v22
    v_cmp_le_u32 vcc, s46, v18
    v_rcp_f32 v16, v16
    v_rcp_f32 v20, v20
    s_cbranch_vccnz a_slow0
a_fin0:
    v_pk_mul_f32 v[32:33], v[16:17], v[32:33] op_sel_hi:[0,1]
    v_pk_mul_f32 v[34:35], v[16:17], v[34:35] op_sel_hi:[0,1]
    v_pk_mul_f32 v[36:37], v[16:17], v[36:37] op_sel_hi:[0,1]
    v_pk_mul_f32 v[38:39], v[16:17], v[38:39] op_sel_hi:[0,1]
    v_pk_mul_f32 v[48:49], v[20:21], v[48:49] op_sel_hi:[0,1]
    v_pk_mul_f32 v[50:51], v[20:21], v[50:51] op_sel_hi:[0,1]
    v_pk_mul_f32 v[52:53], v[20:21], v[52:53] op_sel_hi:[0,1]
    v_pk_mul_f32 v[54:55], v[20:21], v[54:55] op_sel_hi:[0,1]
    v_cvt_pk_bf16_f32 v32, v32, v33
    v_cvt_pk_bf16_f32 v33, v34, v35
    v_cvt_pk_bf16_f32 v34, v36, v37
    v_cvt_pk_bf16_f32 v35, v38, v39
    v_cvt_pk_bf16_f32 v48, v48, v49
    v_cvt_pk_bf16_f32 v49, v50, v51
    v_cvt_pk_bf16_f32 v50, v52, v53
    v_cvt_pk_bf16_f32 v51, v54, v55
    v_permlane32_swap_b32 v32, v34
    v_permlane32_swap_b32 v33, v35
    buffer_store_dwordx4 v[32:35], v2, s[4:7], s52 offen offset:0 sc1
    v_permlane32_swap_b32 v48, v50
    v_permlane32_swap_b32 v49, v51
    buffer_store_dwordx4 v[48:51], v2, s[4:7], s52 offen offset:2048 sc1
    s_lshl_b32 s44, s21, 22
    s_lshl_b32 s45, s39, 16
    s_add_u32 s41, s44, s45
    s_lshl_b32 s45, s20, 12
    s_add_u32 s43, s41, s45
    s_and_b32 s45, s45, 0
    s_add_u32 s41, s41, s45
    s_add_u32 s41, s41, 16777216
    buffer_load_dwordx4 v[224:227], v2, s[4:7], s43 offen offset:0 sc1
    buffer_load_dwordx4 v[228:231], v2, s[4:7], s43 offen offset:256 sc1
    buffer_load_dwordx4 v[232:235], v2, s[4:7], s43 offen offset:2048 sc1
    buffer_load_dwordx4 v[236:239], v2, s[4:7], s43 offen offset:2304 sc1
    s_barrier
    s_lshl_b32 s46, s21, 14
    s_lshl_b32 s67, s38, 8
    s_add_u32 s46, s46, s67
    s_add_u32 s46, s46, 86144
    s_lshl_b32 s47, s21, 14
    s_lshl_b32 s67, s39, 8
    s_add_u32 s47, s47, s67
    s_add_u32 s47, s47, 86144
    s_waitcnt vmcnt(4)
    s_atomic_add s40, s[22:23], s46
    s_mov_b32 s66, 0x10000
c_o_poll:
    s_mov_b32 s68, 0
    s_atomic_add s68, s[22:23], s47 offset:0 glc
    s_sub_u32 s66, s66, 1
    s_cselect_b32 s67, 16, 0
    s_waitcnt lgkmcnt(0)
    s_max_u32 s68, s68, s67
    s_cmp_lt_u32 s68, 16
    s_cbranch_scc1 c_o_poll
c_o_ok:
    s_branch c_wo
a_slow1:
    s_cmp_eq_u32 s46, 0
    s_cbranch_scc1 a_fin1
    s_mov_b32 s46, 0
    v_mfma_f32_16x16x32_bf16 v[172:175], v[68:71], v[132:135], v[120:123]
    v_mfma_f32_16x16x32_bf16 v[168:171], v[64:67], v[132:135], v[124:127]
    v_mfma_f32_16x16x32_bf16 v[188:191], v[84:87], v[148:151], v[120:123]
    v_mfma_f32_16x16x32_bf16 v[184:187], v[80:83], v[148:151], v[124:127]
    s_nop 5
    v_max3_f32 v24, v168, v169, v170
    v_max3_f32 v24, v24, v171, v172
    v_max3_f32 v24, v24, v173, v174
    v_max_f32 v24, v24, v175
    v_max3_f32 v26, v184, v185, v186
    v_max3_f32 v26, v26, v187, v188
    v_max3_f32 v26, v26, v189, v190
    v_max_f32 v26, v26, v191
    v_mov_b32 v25, v24
    v_mov_b32 v27, v26
    s_nop 0
    v_permlane32_swap_b32 v24, v25
    v_permlane32_swap_b32 v26, v27
    v_max_f32 v24, v24, v25
    v_max_f32 v26, v26, v27
    v_mov_b32 v25, v24
    v_mov_b32 v27, v26
    s_nop 0
    v_permlane16_swap_b32 v24, v25
    v_permlane16_swap_b32 v26, v27
    v_max_f32 v24, v24, v25
    v_max_f32 v26, v26, v27
    v_sub_f32 v168, v168, v24
    v_sub_f32 v169, v169, v24
    v_sub_f32 v170, v170, v24
    v_sub_f32 v171, v171, v24
    v_sub_f32 v172, v172, v24
    v_sub_f32 v173, v173, v24
    v_sub_f32 v174, v174, v24
    v_sub_f32 v175, v175, v24
    v_sub_f32 v184, v184, v26
    v_sub_f32 v185, v185, v26
    v_sub_f32 v186, v186, v26
    v_sub_f32 v187, v187, v26
    v_sub_f32 v188, v188, v26
    v_sub_f32 v189, v189, v26
    v_sub_f32 v190, v190, v26
    v_sub_f32 v191, v191, v26
    v_exp_f32 v172, v172
    v_exp_f32 v173, v173
    v_exp_f32 v174, v174
    v_exp_f32 v175, v175
    v_exp_f32 v188, v188
    v_exp_f32 v189, v189
    v_exp_f32 v190, v190
    v_exp_f32 v191, v191
    s_branch a_exp1
a_slow0:
    s_cmp_eq_u32 s46, 0
    s_cbranch_scc1 a_fin0
    s_mov_b32 s46, 0
    v_mfma_f32_16x16x32_bf16 v[164:167], v[64:67], v[128:131], v[120:123]
    v_mfma_f32_16x16x32_bf16 v[160:163], v[192:195], v[128:131], v[124:127]
    v_mfma_f32_16x16x32_bf16 v[180:183], v[80:83], v[144:147], v[120:123]
    v_mfma_f32_16x16x32_bf16 v[176:179], v[196:199], v[144:147], v[124:127]
    s_nop 5
    v_max3_f32 v24, v160, v161, v162
    v_max3_f32 v24, v24, v163, v164
    v_max3_f32 v24, v24, v165, v166
    v_max_f32 v24, v24, v167
    v_max3_f32 v26, v176, v177, v178
    v_max3_f32 v26, v26, v179, v180
    v_max3_f32 v26, v26, v181, v182
    v_max_f32 v26, v26, v183
    v_mov_b32 v25, v24
    v_mov_b32 v27, v26
    s_nop 0
    v_permlane32_swap_b32 v24, v25
    v_permlane32_swap_b32 v26, v27
    v_max_f32 v24, v24, v25
    v_max_f32 v26, v26, v27
    v_mov_b32 v25, v24
    v_mov_b32 v27, v26
    s_nop 0
    v_permlane16_swap_b32 v24, v25
    v_permlane16_swap_b32 v26, v27
    v_max_f32 v24, v24, v25
    v_max_f32 v26, v26, v27
    v_sub_f32 v160, v160, v24
    v_sub_f32 v161, v161, v24
    v_sub_f32 v162, v162, v24
    v_sub_f32 v163, v163, v24
    v_sub_f32 v164, v164, v24
    v_sub_f32 v165, v165, v24
    v_sub_f32 v166, v166, v24
    v_sub_f32 v167, v167, v24
    v_sub_f32 v176, v176, v26
    v_sub_f32 v177, v177, v26
    v_sub_f32 v178, v178, v26
    v_sub_f32 v179, v179, v26
    v_sub_f32 v180, v180, v26
    v_sub_f32 v181, v181, v26
    v_sub_f32 v182, v182, v26
    v_sub_f32 v183, v183, v26
    v_exp_f32 v164, v164
    v_exp_f32 v165, v165
    v_exp_f32 v166, v166
    v_exp_f32 v167, v167
    v_exp_f32 v180, v180
    v_exp_f32 v181, v181
    v_exp_f32 v182, v182
    v_exp_f32 v183, v183
    s_branch a_exp0
c_B:
    s_waitcnt lgkmcnt(6)
    v_pk_fma_f32 v[64:65], v[8:9], v[16:17], v[64:65] op_sel_hi:[0,1,1] neg_lo:[1,0,0] neg_hi:[1,0,0]
    v_pk_fma_f32 v[66:67], v[8:9], v[18:19], v[66:67] op_sel_hi:[0,1,1] neg_lo:[1,0,0] neg_hi:[1,0,0]
    v_pk_fma_f32 v[72:73], v[8:9], v[20:21], v[72:73] op_sel_hi:[0,1,1] neg_lo:[1,0,0] neg_hi:[1,0,0]
    v_pk_fma_f32 v[74:75], v[8:9], v[22:23], v[74:75] op_sel_hi:[0,1,1] neg_lo:[1,0,0] neg_hi:[1,0,0]
    v_pk_mul_f32 v[64:65], v[10:11], v[64:65] op_sel_hi:[0,1]
    v_pk_mul_f32 v[66:67], v[10:11], v[66:67] op_sel_hi:[0,1]
    v_pk_mul_f32 v[72:73], v[10:11], v[72:73] op_sel_hi:[0,1]
    v_pk_mul_f32 v[74:75], v[10:11], v[74:75] op_sel_hi:[0,1]
    v_cvt_pk_bf16_f32 v64, v64, v65
    v_cvt_pk_bf16_f32 v65, v66, v67
    v_cvt_pk_bf16_f32 v66, v72, v73
    v_cvt_pk_bf16_f32 v67, v74, v75
    s_add_u32 s55, s52, 0
    buffer_store_dwordx4 v[64:67], v2, s[4:7], s55 offen offset:0 sc1
    v_pk_fma_f32 v[68:69], v[12:13], v[16:17], v[68:69] op_sel_hi:[0,1,1] neg_lo:[1,0,0] neg_hi:[1,0,0]
    v_pk_fma_f32 v[70:71], v[12:13], v[18:19], v[70:71] op_sel_hi:[0,1,1] neg_lo:[1,0,0] neg_hi:[1,0,0]
    v_pk_fma_f32 v[76:77], v[12:13], v[20:21], v[76:77] op_sel_hi:[0,1,1] neg_lo:[1,0,0] neg_hi:[1,0,0]
    v_pk_fma_f32 v[78:79], v[12:13], v[22:23], v[78:79] op_sel_hi:[0,1,1] neg_lo:[1,0,0] neg_hi:[1,0,0]
    v_pk_mul_f32 v[68:69], v[14:15], v[68:69] op_sel_hi:[0,1]
    v_pk_mul_f32 v[70:71], v[14:15], v[70:71] op_sel_hi:[0,1]
    v_pk_mul_f32 v[76:77], v[14:15], v[76:77] op_sel_hi:[0,1]
    v_pk_mul_f32 v[78:79], v[14:15], v[78:79] op_sel_hi:[0,1]
    v_cvt_pk_bf16_f32 v68, v68, v69
    v_cvt_pk_bf16_f32 v69, v70, v71
    v_cvt_pk_bf16_f32 v70, v76, v77
    v_cvt_pk_bf16_f32 v71, v78, v79
    buffer_store_dwordx4 v[68:71], v2, s[4:7], s55 offen offset:256 sc1
    v_pk_fma_f32 v[80:81], v[8:9], v[24:25], v[80:81] op_sel_hi:[0,1,1] neg_lo:[1,0,0] neg_hi:[1,0,0]
    v_pk_fma_f32 v[82:83], v[8:9], v[26:27], v[82:83] op_sel_hi:[0,1,1] neg_lo:[1,0,0] neg_hi:[1,0,0]
    v_pk_fma_f32 v[88:89], v[8:9], v[28:29], v[88:89] op_sel_hi:[0,1,1] neg_lo:[1,0,0] neg_hi:[1,0,0]
    v_pk_fma_f32 v[90:91], v[8:9], v[30:31], v[90:91] op_sel_hi:[0,1,1] neg_lo:[1,0,0] neg_hi:[1,0,0]
    v_pk_mul_f32 v[80:81], v[10:11], v[80:81] op_sel_hi:[0,1]
    v_pk_mul_f32 v[82:83], v[10:11], v[82:83] op_sel_hi:[0,1]
    v_pk_mul_f32 v[88:89], v[10:11], v[88:89] op_sel_hi:[0,1]
    v_pk_mul_f32 v[90:91], v[10:11], v[90:91] op_sel_hi:[0,1]
    v_cvt_pk_bf16_f32 v80, v80, v81
    v_cvt_pk_bf16_f32 v81, v82, v83
    v_cvt_pk_bf16_f32 v82, v88, v89
    v_cvt_pk_bf16_f32 v83, v90, v91
    s_add_u32 s55, s52, 131072
    buffer_store_dwordx4 v[80:83], v2, s[4:7], s55 offen offset:0 sc1
    v_pk_fma_f32 v[84:85], v[12:13], v[24:25], v[84:85] op_sel_hi:[0,1,1] neg_lo:[1,0,0] neg_hi:[1,0,0]
    v_pk_fma_f32 v[86:87], v[12:13], v[26:27], v[86:87] op_sel_hi:[0,1,1] neg_lo:[1,0,0] neg_hi:[1,0,0]
    v_pk_fma_f32 v[92:93], v[12:13], v[28:29], v[92:93] op_sel_hi:[0,1,1] neg_lo:[1,0,0] neg_hi:[1,0,0]
    v_pk_fma_f32 v[94:95], v[12:13], v[30:31], v[94:95] op_sel_hi:[0,1,1] neg_lo:[1,0,0] neg_hi:[1,0,0]
    v_pk_mul_f32 v[84:85], v[14:15], v[84:85] op_sel_hi:[0,1]
    v_pk_mul_f32 v[86:87], v[14:15], v[86:87] op_sel_hi:[0,1]
    v_pk_mul_f32 v[92:93], v[14:15], v[92:93] op_sel_hi:[0,1]
    v_pk_mul_f32 v[94:95], v[14:15], v[94:95] op_sel_hi:[0,1]
    v_cvt_pk_bf16_f32 v84, v84, v85
    v_cvt_pk_bf16_f32 v85, v86, v87
    v_cvt_pk_bf16_f32 v86, v92, v93
    v_cvt_pk_bf16_f32 v87, v94, v95
    buffer_store_dwordx4 v[84:87], v2, s[4:7], s55 offen offset:256 sc1
    v_mfma_f32_16x16x32_bf16 v[96:99], v[160:163], v[32:35], v[96:99]
    ds_read_b64_tr_b16 v[60:61], v6 offset:53248
    v_mfma_f32_16x16x32_bf16 v[100:103], v[164:167], v[32:35], v[100:103]
    ds_read_b64_tr_b16 v[62:63], v6 offset:54272
    v_mfma_f32_16x16x32_bf16 v[104:107], v[160:163], v[36:39], v[104:107]
    ds_read_b64_tr_b16 v[32:33], v3 offset:57344
    v_mfma_f32_16x16x32_bf16 v[108:111], v[164:167], v[36:39], v[108:111]
    ds_read_b64_tr_b16 v[34:35], v3 offset:58368
    v_mfma_f32_16x16x32_bf16 v[112:115], v[160:163], v[40:43], v[112:115]
    ds_read_b64_tr_b16 v[36:37], v4 offset:57344
    v_mfma_f32_16x16x32_bf16 v[116:119], v[164:167], v[40:43], v[116:119]
    ds_read_b64_tr_b16 v[38:39], v4 offset:58368
    v_mfma_f32_16x16x32_bf16 v[120:123], v[160:163], v[44:47], v[120:123]
    ds_read_b64_tr_b16 v[40:41], v5 offset:57344
    v_mfma_f32_16x16x32_bf16 v[124:127], v[164:167], v[44:47], v[124:127]
    ds_read_b64_tr_b16 v[42:43], v5 offset:58368
    s_waitcnt lgkmcnt(10)
    v_mfma_f32_16x16x32_bf16 v[96:99], v[168:171], v[48:51], v[96:99]
    ds_read_b64_tr_b16 v[44:45], v6 offset:57344
    v_mfma_f32_16x16x32_bf16 v[100:103], v[172:175], v[48:51], v[100:103]
    ds_read_b64_tr_b16 v[46:47], v6 offset:58368
    v_mfma_f32_16x16x32_bf16 v[104:107], v[168:171], v[52:55], v[104:107]
    ds_read_b64_tr_b16 v[48:49], v3 offset:61440
    v_mfma_f32_16x16x32_bf16 v[108:111], v[172:175], v[52:55], v[108:111]
    ds_read_b64_tr_b16 v[50:51], v3 offset:62464
    s_waitcnt lgkmcnt(10)
    v_mfma_f32_16x16x32_bf16 v[112:115], v[168:171], v[56:59], v[112:115]
    ds_read_b64_tr_b16 v[52:53], v4 offset:61440
    v_mfma_f32_16x16x32_bf16 v[116:119], v[172:175], v[56:59], v[116:119]
    ds_read_b64_tr_b16 v[54:55], v4 offset:62464
    v_mfma_f32_16x16x32_bf16 v[120:123], v[168:171], v[60:63], v[120:123]
    ds_read_b64_tr_b16 v[56:57], v5 offset:61440
    v_mfma_f32_16x16x32_bf16 v[124:127], v[172:175], v[60:63], v[124:127]
    ds_read_b64_tr_b16 v[58:59], v5 offset:62464
    s_waitcnt lgkmcnt(10)
    v_mfma_f32_16x16x32_bf16 v[96:99], v[176:179], v[32:35], v[96:99]
    ds_read_b64_tr_b16 v[60:61], v6 offset:61440
    v_mfma_f32_16x16x32_bf16 v[100:103], v[180:183], v[32:35], v[100:103]
    ds_read_b64_tr_b16 v[62:63], v6 offset:62464
    s_barrier
    v_xor_b32 v3, 0x10000, v3
    v_xor_b32 v4, 0x10000, v4
    v_xor_b32 v5, 0x10000, v5
    v_xor_b32 v6, 0x10000, v6
    v_mfma_f32_16x16x32_bf16 v[104:107], v[176:179], v[36:39], v[104:107]
    ds_read_b64_tr_b16 v[32:33], v3 offset:0
    v_mfma_f32_16x16x32_bf16 v[108:111], v[180:183], v[36:39], v[108:111]
    ds_read_b64_tr_b16 v[34:35], v3 offset:1024
    s_waitcnt lgkmcnt(10)
    v_mfma_f32_16x16x32_bf16 v[112:115], v[176:179], v[40:43], v[112:115]
    ds_read_b64_tr_b16 v[36:37], v4 offset:0
    v_mfma_f32_16x16x32_bf16 v[116:119], v[180:183], v[40:43], v[116:119]
    ds_read_b64_tr_b16 v[38:39], v4 offset:1024
    v_mfma_f32_16x16x32_bf16 v[120:123], v[176:179], v[44:47], v[120:123]
    ds_read_b64_tr_b16 v[40:41], v5 offset:0
    v_mfma_f32_16x16x32_bf16 v[124:127], v[180:183], v[44:47], v[124:127]
    ds_read_b64_tr_b16 v[42:43], v5 offset:1024
    s_waitcnt lgkmcnt(10)
    v_mfma_f32_16x16x32_bf16 v[96:99], v[184:187], v[48:51], v[96:99]
    ds_read_b64_tr_b16 v[44:45], v6 offset:0
    v_mfma_f32_16x16x32_bf16 v[100:103], v[188:191], v[48:51], v[100:103]
    ds_read_b64_tr_b16 v[46:47], v6 offset:1024
    v_mfma_f32_16x16x32_bf16 v[104:107], v[184:187], v[52:55], v[104:107]
    ds_read_b64_tr_b16 v[48:49], v3 offset:4096
    v_mfma_f32_16x16x32_bf16 v[108:111], v[188:191], v[52:55], v[108:111]
    ds_read_b64_tr_b16 v[50:51], v3 offset:5120
    s_waitcnt lgkmcnt(10)
    v_mfma_f32_16x16x32_bf16 v[112:115], v[184:187], v[56:59], v[112:115]
    ds_read_b64_tr_b16 v[52:53], v4 offset:4096
    v_mfma_f32_16x16x32_bf16 v[116:119], v[188:191], v[56:59], v[116:119]
    ds_read_b64_tr_b16 v[54:55], v4 offset:5120
    v_mfma_f32_16x16x32_bf16 v[120:123], v[184:187], v[60:63], v[120:123]
    ds_read_b64_tr_b16 v[56:57], v5 offset:4096
    v_mfma_f32_16x16x32_bf16 v[124:127], v[188:191], v[60:63], v[124:127]
    ds_read_b64_tr_b16 v[58:59], v5 offset:5120
    s_waitcnt lgkmcnt(10)
    v_mfma_f32_16x16x32_bf16 v[96:99], v[192:195], v[32:35], v[96:99]
    ds_read_b64_tr_b16 v[60:61], v6 offset:4096
    v_mfma_f32_16x16x32_bf16 v[100:103], v[196:199], v[32:35], v[100:103]
    ds_read_b64_tr_b16 v[62:63], v6 offset:5120
    v_mfma_f32_16x16x32_bf16 v[104:107], v[192:195], v[36:39], v[104:107]
    ds_read_b64_tr_b16 v[32:33], v3 offset:8192
    v_mfma_f32_16x16x32_bf16 v[108:111], v[196:199], v[36:39], v[108:111]
    ds_read_b64_tr_b16 v[34:35], v3 offset:9216
    s_waitcnt lgkmcnt(10)
    v_mfma_f32_16x16x32_bf16 v[112:115], v[192:195], v[40:43], v[112:115]
    ds_read_b64_tr_b16 v[36:37], v4 offset:8192
    v_mfma_f32_16x16x32_bf16 v[116:119], v[196:199], v[40:43], v[116:119]
    ds_read_b64_tr_b16 v[38:39], v4 offset:9216
    v_mfma_f32_16x16x32_bf16 v[120:123], v[192:195], v[44:47], v[120:123]
    ds_read_b64_tr_b16 v[40:41], v5 offset:8192
    v_mfma_f32_16x16x32_bf16 v[124:127], v[196:199], v[44:47], v[124:127]
    ds_read_b64_tr_b16 v[42:43], v5 offset:9216
    s_waitcnt lgkmcnt(10)
    v_mfma_f32_16x16x32_bf16 v[96:99], v[200:203], v[48:51], v[96:99]
    ds_read_b64_tr_b16 v[44:45], v6 offset:8192
    v_mfma_f32_16x16x32_bf16 v[100:103], v[204:207], v[48:51], v[100:103]
    ds_read_b64_tr_b16 v[46:47], v6 offset:9216
    v_mfma_f32_16x16x32_bf16 v[104:107], v[200:203], v[52:55], v[104:107]
    ds_read_b64_tr_b16 v[48:49], v3 offset:12288
    v_mfma_f32_16x16x32_bf16 v[108:111], v[204:207], v[52:55], v[108:111]
    ds_read_b64_tr_b16 v[50:51], v3 offset:13312
    s_waitcnt lgkmcnt(10)
    v_mfma_f32_16x16x32_bf16 v[112:115], v[200:203], v[56:59], v[112:115]
    ds_read_b64_tr_b16 v[52:53], v4 offset:12288
    v_mfma_f32_16x16x32_bf16 v[116:119], v[204:207], v[56:59], v[116:119]
    ds_read_b64_tr_b16 v[54:55], v4 offset:13312
    v_mfma_f32_16x16x32_bf16 v[120:123], v[200:203], v[60:63], v[120:123]
    ds_read_b64_tr_b16 v[56:57], v5 offset:12288
    v_mfma_f32_16x16x32_bf16 v[124:127], v[204:207], v[60:63], v[124:127]
    ds_read_b64_tr_b16 v[58:59], v5 offset:13312
    s_waitcnt lgkmcnt(10)
    v_mfma_f32_16x16x32_bf16 v[96:99], v[208:211], v[32:35], v[96:99]
    ds_read_b64_tr_b16 v[60:61], v6 offset:12288
    v_mfma_f32_16x16x32_bf16 v[100:103], v[212:215], v[32:35], v[100:103]
    ds_read_b64_tr_b16 v[62:63], v6 offset:13312
    v_mfma_f32_16x16x32_bf16 v[104:107], v[208:211], v[36:39], v[104:107]
    ds_read_b64_tr_b16 v[32:33], v3 offset:16384
    ds_read_b128 v[16:19], v13 offset:4096
    v_mfma_f32_16x16x32_bf16 v[108:111], v[212:215], v[36:39], v[108:111]
    ds_read_b64_tr_b16 v[34:35], v3 offset:17408
    ds_read_b128 v[20:23], v13 offset:4608
    s_waitcnt lgkmcnt(12)
    v_mfma_f32_16x16x32_bf16 v[112:115], v[208:211], v[40:43], v[112:115]
    ds_read_b64_tr_b16 v[36:37], v4 offset:16384
    ds_read_b128 v[24:27], v13 offset:4160
    v_mfma_f32_16x16x32_bf16 v[116:119], v[212:215], v[40:43], v[116:119]
    ds_read_b64_tr_b16 v[38:39], v4 offset:17408
    ds_read_b128 v[28:31], v13 offset:4672
    v_mfma_f32_16x16x32_bf16 v[120:123], v[208:211], v[44:47], v[120:123]
    ds_read_b64_tr_b16 v[40:41], v5 offset:16384
    ds_read_b32 v8, v15 offset:512
    v_mfma_f32_16x16x32_bf16 v[124:127], v[212:215], v[44:47], v[124:127]
    ds_read_b64_tr_b16 v[42:43], v5 offset:17408
    ds_read_b32 v10, v15 offset:576
    s_waitcnt lgkmcnt(14)
    v_mfma_f32_16x16x32_bf16 v[96:99], v[216:219], v[48:51], v[96:99]
    ds_read_b64_tr_b16 v[44:45], v6 offset:16384
    ds_read_b32 v12, v15 offset:640
    v_mfma_f32_16x16x32_bf16 v[100:103], v[220:223], v[48:51], v[100:103]
    ds_read_b64_tr_b16 v[46:47], v6 offset:17408
    ds_read_b32 v14, v15 offset:704
    v_mfma_f32_16x16x32_bf16 v[104:107], v[216:219], v[52:55], v[104:107]
    ds_read_b64_tr_b16 v[48:49], v3 offset:20480
    v_mfma_f32_16x16x32_bf16 v[108:111], v[220:223], v[52:55], v[108:111]
    ds_read_b64_tr_b16 v[50:51], v3 offset:21504
    s_waitcnt lgkmcnt(14)
    v_mfma_f32_16x16x32_bf16 v[112:115], v[216:219], v[56:59], v[112:115]
    ds_read_b64_tr_b16 v[52:53], v4 offset:20480
    v_mfma_f32_16x16x32_bf16 v[116:119], v[220:223], v[56:59], v[116:119]
    ds_read_b64_tr_b16 v[54:55], v4 offset:21504
    v_mfma_f32_16x16x32_bf16 v[120:123], v[216:219], v[60:63], v[120:123]
    ds_read_b64_tr_b16 v[56:57], v5 offset:20480
    v_mfma_f32_16x16x32_bf16 v[124:127], v[220:223], v[60:63], v[124:127]
    ds_read_b64_tr_b16 v[58:59], v5 offset:21504
    s_waitcnt lgkmcnt(6)
    v_pk_fma_f32 v[96:97], v[8:9], v[16:17], v[96:97] op_sel_hi:[0,1,1] neg_lo:[1,0,0] neg_hi:[1,0,0]
    v_pk_fma_f32 v[98:99], v[8:9], v[18:19], v[98:99] op_sel_hi:[0,1,1] neg_lo:[1,0,0] neg_hi:[1,0,0]
    v_pk_fma_f32 v[104:105], v[10:11], v[16:17], v[104:105] op_sel_hi:[0,1,1] neg_lo:[1,0,0] neg_hi:[1,0,0]
    v_pk_fma_f32 v[106:107], v[10:11], v[18:19], v[106:107] op_sel_hi:[0,1,1] neg_lo:[1,0,0] neg_hi:[1,0,0]
    v_pk_mul_f32 v[96:97], v[20:21], v[96:97]
    v_pk_mul_f32 v[98:99], v[22:23], v[98:99]
    v_pk_mul_f32 v[104:105], v[20:21], v[104:105]
    v_pk_mul_f32 v[106:107], v[22:23], v[106:107]
    v_cvt_pk_bf16_f32 v72, v96, v97
    v_cvt_pk_bf16_f32 v73, v98, v99
    v_cvt_pk_bf16_f32 v74, v104, v105
    v_cvt_pk_bf16_f32 v75, v106, v107
    s_add_u32 s56, s52, 4194304
    v_permlane16_swap_b32 v72, v74
    v_permlane16_swap_b32 v73, v75
    buffer_store_dwordx4 v[72:75], v1, s[4:7], s56 offen offset:0 sc1
    v_pk_fma_f32 v[112:113], v[12:13], v[16:17], v[112:113] op_sel_hi:[0,1,1] neg_lo:[1,0,0] neg_hi:[1,0,0]
    v_pk_fma_f32 v[114:115], v[12:13], v[18:19], v[114:115] op_sel_hi:[0,1,1] neg_lo:[1,0,0] neg_hi:[1,0,0]
    v_pk_fma_f32 v[120:121], v[14:15], v[16:17], v[120:121] op_sel_hi:[0,1,1] neg_lo:[1,0,0] neg_hi:[1,0,0]
    v_pk_fma_f32 v[122:123], v[14:15], v[18:19], v[122:123] op_sel_hi:[0,1,1] neg_lo:[1,0,0] neg_hi:[1,0,0]
    v_pk_mul_f32 v[112:113], v[20:21], v[112:113]
    v_pk_mul_f32 v[114:115], v[22:23], v[114:115]
    v_pk_mul_f32 v[120:121], v[20:21], v[120:121]
    v_pk_mul_f32 v[122:123], v[22:23], v[122:123]
    v_cvt_pk_bf16_f32 v88, v112, v113
    v_cvt_pk_bf16_f32 v89, v114, v115
    v_cvt_pk_bf16_f32 v90, v120, v121
    v_cvt_pk_bf16_f32 v91, v122, v123
    s_add_u32 s56, s52, 4325376
    v_permlane16_swap_b32 v88, v90
    v_permlane16_swap_b32 v89, v91
    buffer_store_dwordx4 v[88:91], v1, s[4:7], s56 offen offset:0 sc1
    v_pk_fma_f32 v[100:101], v[8:9], v[24:25], v[100:101] op_sel_hi:[0,1,1] neg_lo:[1,0,0] neg_hi:[1,0,0]
    v_pk_fma_f32 v[102:103], v[8:9], v[26:27], v[102:103] op_sel_hi:[0,1,1] neg_lo:[1,0,0] neg_hi:[1,0,0]
    v_pk_fma_f32 v[108:109], v[10:11], v[24:25], v[108:109] op_sel_hi:[0,1,1] neg_lo:[1,0,0] neg_hi:[1,0,0]
    v_pk_fma_f32 v[110:111], v[10:11], v[26:27], v[110:111] op_sel_hi:[0,1,1] neg_lo:[1,0,0] neg_hi:[1,0,0]
    v_pk_mul_f32 v[100:101], v[28:29], v[100:101]
    v_pk_mul_f32 v[102:103], v[30:31], v[102:103]
    v_pk_mul_f32 v[108:109], v[28:29], v[108:109]
    v_pk_mul_f32 v[110:111], v[30:31], v[110:111]
    v_cvt_pk_bf16_f32 v76, v100, v101
    v_cvt_pk_bf16_f32 v77, v102, v103
    v_cvt_pk_bf16_f32 v78, v108, v109
    v_cvt_pk_bf16_f32 v79, v110, v111
    s_add_u32 s56, s52, 4194304
    v_permlane16_swap_b32 v76, v78
    v_permlane16_swap_b32 v77, v79
    buffer_store_dwordx4 v[76:79], v1, s[4:7], s56 offen offset:1024 sc1
    v_pk_fma_f32 v[116:117], v[12:13], v[24:25], v[116:117] op_sel_hi:[0,1,1] neg_lo:[1,0,0] neg_hi:[1,0,0]
    v_pk_fma_f32 v[118:119], v[12:13], v[26:27], v[118:119] op_sel_hi:[0,1,1] neg_lo:[1,0,0] neg_hi:[1,0,0]
    v_pk_fma_f32 v[124:125], v[14:15], v[24:25], v[124:125] op_sel_hi:[0,1,1] neg_lo:[1,0,0] neg_hi:[1,0,0]
    v_pk_fma_f32 v[126:127], v[14:15], v[26:27], v[126:127] op_sel_hi:[0,1,1] neg_lo:[1,0,0] neg_hi:[1,0,0]
    v_pk_mul_f32 v[116:117], v[28:29], v[116:117]
    v_pk_mul_f32 v[118:119], v[30:31], v[118:119]
    v_pk_mul_f32 v[124:125], v[28:29], v[124:125]
    v_pk_mul_f32 v[126:127], v[30:31], v[126:127]
    v_cvt_pk_bf16_f32 v92, v116, v117
    v_cvt_pk_bf16_f32 v93, v118, v119
    v_cvt_pk_bf16_f32 v94, v124, v125
    v_cvt_pk_bf16_f32 v95, v126, v127
    s_add_u32 s56, s52, 4325376
    v_permlane16_swap_b32 v92, v94
    v_permlane16_swap_b32 v93, v95
    buffer_store_dwordx4 v[92:95], v1, s[4:7], s56 offen offset:1024 sc1
    v_mfma_f32_16x16x32_bf16 v[128:131], v[32:35], v[224:227], v[128:131]
    ds_read_b64_tr_b16 v[60:61], v6 offset:20480
    v_mfma_f32_16x16x32_bf16 v[132:135], v[32:35], v[228:231], v[132:135]
    ds_read_b64_tr_b16 v[62:63], v6 offset:21504
    v_mfma_f32_16x16x32_bf16 v[136:139], v[36:39], v[224:227], v[136:139]
    ds_read_b64_tr_b16 v[32:33], v3 offset:24576
    v_mfma_f32_16x16x32_bf16 v[140:143], v[36:39], v[228:231], v[140:143]
    ds_read_b64_tr_b16 v[34:35], v3 offset:25600
    v_mfma_f32_16x16x32_bf16 v[144:147], v[40:43], v[224:227], v[144:147]
    ds_read_b64_tr_b16 v[36:37], v4 offset:24576
    v_mfma_f32_16x16x32_bf16 v[148:151], v[40:43], v[228:231], v[148:151]
    ds_read_b64_tr_b16 v[38:39], v4 offset:25600
    v_mfma_f32_16x16x32_bf16 v[152:155], v[44:47], v[224:227], v[152:155]
    ds_read_b64_tr_b16 v[40:41], v5 offset:24576
    v_mfma_f32_16x16x32_bf16 v[156:159], v[44:47], v[228:231], v[156:159]
    ds_read_b64_tr_b16 v[42:43], v5 offset:25600
    s_waitcnt lgkmcnt(10)
    v_mfma_f32_16x16x32_bf16 v[128:131], v[48:51], v[232:235], v[128:131]
    ds_read_b64_tr_b16 v[44:45], v6 offset:24576
    v_mfma_f32_16x16x32_bf16 v[132:135], v[48:51], v[236:239], v[132:135]
    ds_read_b64_tr_b16 v[46:47], v6 offset:25600
    v_mfma_f32_16x16x32_bf16 v[136:139], v[52:55], v[232:235], v[136:139]
    ds_read_b64_tr_b16 v[48:49], v3 offset:28672
    v_mfma_f32_16x16x32_bf16 v[140:143], v[52:55], v[236:239], v[140:143]
    ds_read_b64_tr_b16 v[50:51], v3 offset:29696
    s_waitcnt lgkmcnt(10)
    v_mfma_f32_16x16x32_bf16 v[144:147], v[56:59], v[232:235], v[144:147]
    ds_read_b64_tr_b16 v[52:53], v4 offset:28672
    v_mfma_f32_16x16x32_bf16 v[148:151], v[56:59], v[236:239], v[148:151]
    ds_read_b64_tr_b16 v[54:55], v4 offset:29696
    v_mfma_f32_16x16x32_bf16 v[152:155], v[60:63], v[232:235], v[152:155]
    ds_read_b64_tr_b16 v[56:57], v5 offset:28672
    v_mfma_f32_16x16x32_bf16 v[156:159], v[60:63], v[236:239], v[156:159]
    ds_read_b64_tr_b16 v[58:59], v5 offset:29696
    s_waitcnt lgkmcnt(10)
    v_mfma_f32_16x16x32_bf16 v[128:131], v[32:35], v[240:243], v[128:131]
    ds_read_b64_tr_b16 v[60:61], v6 offset:28672
    v_mfma_f32_16x16x32_bf16 v[132:135], v[32:35], v[244:247], v[132:135]
    ds_read_b64_tr_b16 v[62:63], v6 offset:29696
    s_barrier
    v_mfma_f32_16x16x32_bf16 v[136:139], v[36:39], v[240:243], v[136:139]
    ds_read_b64_tr_b16 v[32:33], v3 offset:32768
    v_mfma_f32_16x16x32_bf16 v[140:143], v[36:39], v[244:247], v[140:143]
    ds_read_b64_tr_b16 v[34:35], v3 offset:33792
    s_waitcnt lgkmcnt(10)
    v_mfma_f32_16x16x32_bf16 v[144:147], v[40:43], v[240:243], v[144:147]
    ds_read_b64_tr_b16 v[36:37], v4 offset:32768
    v_mfma_f32_16x16x32_bf16 v[148:151], v[40:43], v[244:247], v[148:151]
    ds_read_b64_tr_b16 v[38:39], v4 offset:33792
    v_mfma_f32_16x16x32_bf16 v[152:155], v[44:47], v[240:243], v[152:155]
    ds_read_b64_tr_b16 v[40:41], v5 offset:32768
    v_mfma_f32_16x16x32_bf16 v[156:159], v[44:47], v[244:247], v[156:159]
    ds_read_b64_tr_b16 v[42:43], v5 offset:33792
    s_waitcnt lgkmcnt(10)
    v_mfma_f32_16x16x32_bf16 v[128:131], v[48:51], v[248:251], v[128:131]
    ds_read_b64_tr_b16 v[44:45], v6 offset:32768
    v_mfma_f32_16x16x32_bf16 v[132:135], v[48:51], v[252:255], v[132:135]
    ds_read_b64_tr_b16 v[46:47], v6 offset:33792
    v_mfma_f32_16x16x32_bf16 v[136:139], v[52:55], v[248:251], v[136:139]
    ds_read_b64_tr_b16 v[48:49], v3 offset:36864
    v_mfma_f32_16x16x32_bf16 v[140:143], v[52:55], v[252:255], v[140:143]
    ds_read_b64_tr_b16 v[50:51], v3 offset:37888
    s_waitcnt lgkmcnt(10)
    v_mfma_f32_16x16x32_bf16 v[144:147], v[56:59], v[248:251], v[144:147]
    ds_read_b64_tr_b16 v[52:53], v4 offset:36864
    v_mfma_f32_16x16x32_bf16 v[148:151], v[56:59], v[252:255], v[148:151]
    ds_read_b64_tr_b16 v[54:55], v4 offset:37888
    v_mfma_f32_16x16x32_bf16 v[152:155], v[60:63], v[248:251], v[152:155]
    ds_read_b64_tr_b16 v[56:57], v5 offset:36864
    v_mfma_f32_16x16x32_bf16 v[156:159], v[60:63], v[252:255], v[156:159]
    ds_read_b64_tr_b16 v[58:59], v5 offset:37888
    s_waitcnt lgkmcnt(10)
    v_mfma_f32_16x16x32_bf16 v[128:131], v[32:35], v[160:163], v[128:131]
    ds_read_b64_tr_b16 v[60:61], v6 offset:36864
    v_mfma_f32_16x16x32_bf16 v[132:135], v[32:35], v[164:167], v[132:135]
    ds_read_b64_tr_b16 v[62:63], v6 offset:37888
    v_mfma_f32_16x16x32_bf16 v[136:139], v[36:39], v[160:163], v[136:139]
    ds_read_b64_tr_b16 v[32:33], v3 offset:40960
    v_mfma_f32_16x16x32_bf16 v[140:143], v[36:39], v[164:167], v[140:143]
    ds_read_b64_tr_b16 v[34:35], v3 offset:41984
    s_waitcnt lgkmcnt(10)
    v_mfma_f32_16x16x32_bf16 v[144:147], v[40:43], v[160:163], v[144:147]
    ds_read_b64_tr_b16 v[36:37], v4 offset:40960
    v_mfma_f32_16x16x32_bf16 v[148:151], v[40:43], v[164:167], v[148:151]
    ds_read_b64_tr_b16 v[38:39], v4 offset:41984
    v_mfma_f32_16x16x32_bf16 v[152:155], v[44:47], v[160:163], v[152:155]
    ds_read_b64_tr_b16 v[40:41], v5 offset:40960
    v_mfma_f32_16x16x32_bf16 v[156:159], v[44:47], v[164:167], v[156:159]
    ds_read_b64_tr_b16 v[42:43], v5 offset:41984
    s_waitcnt lgkmcnt(10)
    v_mfma_f32_16x16x32_bf16 v[128:131], v[48:51], v[168:171], v[128:131]
    ds_read_b64_tr_b16 v[44:45], v6 offset:40960
    v_mfma_f32_16x16x32_bf16 v[132:135], v[48:51], v[172:175], v[132:135]
    ds_read_b64_tr_b16 v[46:47], v6 offset:41984
    v_mfma_f32_16x16x32_bf16 v[136:139], v[52:55], v[168:171], v[136:139]
    ds_read_b64_tr_b16 v[48:49], v3 offset:45056
    v_mfma_f32_16x16x32_bf16 v[140:143], v[52:55], v[172:175], v[140:143]
    ds_read_b64_tr_b16 v[50:51], v3 offset:46080
    s_waitcnt lgkmcnt(10)
    v_mfma_f32_16x16x32_bf16 v[144:147], v[56:59], v[168:171], v[144:147]
    ds_read_b64_tr_b16 v[52:53], v4 offset:45056
    v_mfma_f32_16x16x32_bf16 v[148:151], v[56:59], v[172:175], v[148:151]
    ds_read_b64_tr_b16 v[54:55], v4 offset:46080
    v_mfma_f32_16x16x32_bf16 v[152:155], v[60:63], v[168:171], v[152:155]
    ds_read_b64_tr_b16 v[56:57], v5 offset:45056
    v_mfma_f32_16x16x32_bf16 v[156:159], v[60:63], v[172:175], v[156:159]
    ds_read_b64_tr_b16 v[58:59], v5 offset:46080
    s_waitcnt lgkmcnt(10)
    v_mfma_f32_16x16x32_bf16 v[128:131], v[32:35], v[176:179], v[128:131]
    ds_read_b64_tr_b16 v[60:61], v6 offset:45056
    v_mfma_f32_16x16x32_bf16 v[132:135], v[32:35], v[180:183], v[132:135]
    ds_read_b64_tr_b16 v[62:63], v6 offset:46080
    v_mfma_f32_16x16x32_bf16 v[136:139], v[36:39], v[176:179], v[136:139]
    ds_read_b64_tr_b16 v[32:33], v3 offset:49152
    v_mfma_f32_16x16x32_bf16 v[140:143], v[36:39], v[180:183], v[140:143]
    ds_read_b64_tr_b16 v[34:35], v3 offset:50176
    s_waitcnt lgkmcnt(10)
    v_mfma_f32_16x16x32_bf16 v[144:147], v[40:43], v[176:179], v[144:147]
    ds_read_b64_tr_b16 v[36:37], v4 offset:49152
    v_mfma_f32_16x16x32_bf16 v[148:151], v[40:43], v[180:183], v[148:151]
    ds_read_b64_tr_b16 v[38:39], v4 offset:50176
    v_mfma_f32_16x16x32_bf16 v[152:155], v[44:47], v[176:179], v[152:155]
    ds_read_b64_tr_b16 v[40:41], v5 offset:49152
    v_mfma_f32_16x16x32_bf16 v[156:159], v[44:47], v[180:183], v[156:159]
    ds_read_b64_tr_b16 v[42:43], v5 offset:50176
    s_waitcnt lgkmcnt(10)
    v_mfma_f32_16x16x32_bf16 v[128:131], v[48:51], v[184:187], v[128:131]
    ds_read_b64_tr_b16 v[44:45], v6 offset:49152
    s_waitcnt vmcnt(0)
    s_atomic_add s40, s[22:23], s59
    s_mov_b32 s68, 0
    s_atomic_add s68, s[22:23], s59 glc
    s_mov_b32 s55, s52
    s_add_u32 s56, s52, 4194304
    ds_read_b32 v8, v9 offset:4096
    v_mfma_f32_16x16x32_bf16 v[132:135], v[48:51], v[188:191], v[132:135]
    ds_read_b64_tr_b16 v[46:47], v6 offset:50176
    buffer_load_dwordx4 v[64:67], v1, s[4:7], s55 offen offset:0 sc1
    ds_read_b32 v10, v9 offset:4608
    v_mfma_f32_16x16x32_bf16 v[136:139], v[52:55], v[184:187], v[136:139]
    ds_read_b64_tr_b16 v[48:49], v3 offset:53248
    buffer_load_dwordx4 v[68:71], v1, s[4:7], s55 offen offset:1024 sc1
    ds_read_b32 v12, v9 offset:4160
    v_mfma_f32_16x16x32_bf16 v[140:143], v[52:55], v[188:191], v[140:143]
    ds_read_b64_tr_b16 v[50:51], v3 offset:54272
    buffer_load_dwordx4 v[72:75], v1, s[4:7], s56 offen offset:0 sc1
    ds_read_b32 v14, v9 offset:4672
    s_waitcnt lgkmcnt(14)
    v_mfma_f32_16x16x32_bf16 v[144:147], v[56:59], v[184:187], v[144:147]
    ds_read_b64_tr_b16 v[52:53], v4 offset:53248
    buffer_load_dwordx4 v[76:79], v1, s[4:7], s56 offen offset:1024 sc1
    ds_read_b128 v[16:19], v11 offset:0
    v_mfma_f32_16x16x32_bf16 v[148:151], v[56:59], v[188:191], v[148:151]
    ds_read_b64_tr_b16 v[54:55], v4 offset:54272
    ds_read_b128 v[20:23], v11 offset:64
    v_mfma_f32_16x16x32_bf16 v[152:155], v[60:63], v[184:187], v[152:155]
    ds_read_b64_tr_b16 v[56:57], v5 offset:53248
    ds_read_b128 v[24:27], v11 offset:128
    v_mfma_f32_16x16x32_bf16 v[156:159], v[60:63], v[188:191], v[156:159]
    ds_read_b64_tr_b16 v[58:59], v5 offset:54272
    ds_read_b128 v[28:31], v11 offset:192
    s_waitcnt lgkmcnt(14)
    v_mfma_f32_16x16x32_bf16 v[128:131], v[32:35], v[192:195], v[128:131]
    ds_read_b64_tr_b16 v[60:61], v6 offset:53248
    v_mfma_f32_16x16x32_bf16 v[132:135], v[32:35], v[196:199], v[132:135]
    ds_read_b64_tr_b16 v[62:63], v6 offset:54272
    v_mfma_f32_16x16x32_bf16 v[136:139], v[36:39], v[192:195], v[136:139]
    ds_read_b64_tr_b16 v[32:33], v3 offset:57344
    v_mfma_f32_16x16x32_bf16 v[140:143], v[36:39], v[196:199], v[140:143]
    ds_read_b64_tr_b16 v[34:35], v3 offset:58368
    s_waitcnt lgkmcnt(14)
    v_mfma_f32_16x16x32_bf16 v[144:147], v[40:43], v[192:195], v[144:147]
    ds_read_b64_tr_b16 v[36:37], v4 offset:57344
    v_mfma_f32_16x16x32_bf16 v[148:151], v[40:43], v[196:199], v[148:151]
    ds_read_b64_tr_b16 v[38:39], v4 offset:58368
    v_mfma_f32_16x16x32_bf16 v[152:155], v[44:47], v[192:195], v[152:155]
    ds_read_b64_tr_b16 v[40:41], v5 offset:57344
    v_mfma_f32_16x16x32_bf16 v[156:159], v[44:47], v[196:199], v[156:159]
    ds_read_b64_tr_b16 v[42:43], v5 offset:58368
    s_waitcnt lgkmcnt(13)
    v_mfma_f32_16x16x32_bf16 v[128:131], v[48:51], v[200:203], v[128:131]
    ds_read_b64_tr_b16 v[44:45], v6 offset:57344
    s_waitcnt lgkmcnt(9)
    v_mfma_f32_16x16x32_bf16 v[132:135], v[48:51], v[204:207], v[132:135]
    ds_read_b64_tr_b16 v[46:47], v6 offset:58368
    v_mul_f32 v10, 0x3e8293ee, v10
    v_mfma_f32_16x16x32_bf16 v[136:139], v[52:55], v[200:203], v[136:139]
    ds_read_b64_tr_b16 v[48:49], v3 offset:61440
    v_mul_f32 v14, 0x3e8293ee, v14
    v_mfma_f32_16x16x32_bf16 v[140:143], v[52:55], v[204:207], v[140:143]
    ds_read_b64_tr_b16 v[50:51], v3 offset:62464
    s_lshl_b32 s44, s16, 11
    s_waitcnt lgkmcnt(10)
    v_mfma_f32_16x16x32_bf16 v[144:147], v[56:59], v[200:203], v[144:147]
    ds_read_b64_tr_b16 v[52:53], v4 offset:61440
    s_add_u32 s44, s44, 131072
    v_mfma_f32_16x16x32_bf16 v[148:151], v[56:59], v[204:207], v[148:151]
    ds_read_b64_tr_b16 v[54:55], v4 offset:62464
    v_add_u32 v13, s44, v2
    v_mfma_f32_16x16x32_bf16 v[152:155], v[60:63], v[200:203], v[152:155]
    ds_read_b64_tr_b16 v[56:57], v5 offset:61440
    v_mfma_f32_16x16x32_bf16 v[156:159], v[60:63], v[204:207], v[156:159]
    ds_read_b64_tr_b16 v[58:59], v5 offset:62464
    s_waitcnt lgkmcnt(10)
    v_mfma_f32_16x16x32_bf16 v[128:131], v[32:35], v[208:211], v[128:131]
    ds_read_b64_tr_b16 v[60:61], v6 offset:61440
    v_mfma_f32_16x16x32_bf16 v[132:135], v[32:35], v[212:215], v[132:135]
    ds_read_b64_tr_b16 v[62:63], v6 offset:62464
    v_xor_b32 v3, 0x10000, v3
    v_xor_b32 v4, 0x10000, v4
    v_xor_b32 v5, 0x10000, v5
    v_xor_b32 v6, 0x10000, v6
    v_mfma_f32_16x16x32_bf16 v[136:139], v[36:39], v[208:211], v[136:139]
    v_mfma_f32_16x16x32_bf16 v[140:143], v[36:39], v[212:215], v[140:143]
    s_waitcnt lgkmcnt(8)
    v_mfma_f32_16x16x32_bf16 v[144:147], v[40:43], v[208:211], v[144:147]
    v_mfma_f32_16x16x32_bf16 v[148:151], v[40:43], v[212:215], v[148:151]
    v_mfma_f32_16x16x32_bf16 v[152:155], v[44:47], v[208:211], v[152:155]
    v_mfma_f32_16x16x32_bf16 v[156:159], v[44:47], v[212:215], v[156:159]
    s_waitcnt lgkmcnt(4)
    v_mfma_f32_16x16x32_bf16 v[128:131], v[48:51], v[216:219], v[128:131]
    v_mfma_f32_16x16x32_bf16 v[132:135], v[48:51], v[220:223], v[132:135]
    v_mfma_f32_16x16x32_bf16 v[136:139], v[52:55], v[216:219], v[136:139]
    v_mfma_f32_16x16x32_bf16 v[140:143], v[52:55], v[220:223], v[140:143]
    s_waitcnt lgkmcnt(0)
    v_mfma_f32_16x16x32_bf16 v[144:147], v[56:59], v[216:219], v[144:147]
    v_mfma_f32_16x16x32_bf16 v[148:151], v[56:59], v[220:223], v[148:151]
    v_mfma_f32_16x16x32_bf16 v[152:155], v[60:63], v[216:219], v[152:155]
    v_mfma_f32_16x16x32_bf16 v[156:159], v[60:63], v[220:223], v[156:159]
    v_pk_fma_f32 v[128:129], v[8:9], v[16:17], v[128:129] op_sel_hi:[0,1,1] neg_lo:[1,0,0] neg_hi:[1,0,0]
    v_pk_fma_f32 v[130:131], v[8:9], v[18:19], v[130:131] op_sel_hi:[0,1,1] neg_lo:[1,0,0] neg_hi:[1,0,0]
    v_pk_fma_f32 v[136:137], v[8:9], v[20:21], v[136:137] op_sel_hi:[0,1,1] neg_lo:[1,0,0] neg_hi:[1,0,0]
    v_pk_fma_f32 v[138:139], v[8:9], v[22:23], v[138:139] op_sel_hi:[0,1,1] neg_lo:[1,0,0] neg_hi:[1,0,0]
    v_pk_mul_f32 v[128:129], v[10:11], v[128:129] op_sel_hi:[0,1]
    v_pk_mul_f32 v[130:131], v[10:11], v[130:131] op_sel_hi:[0,1]
    v_pk_mul_f32 v[136:137], v[10:11], v[136:137] op_sel_hi:[0,1]
    v_pk_mul_f32 v[138:139], v[10:11], v[138:139] op_sel_hi:[0,1]
    v_cvt_pk_bf16_f32 v128, v128, v129
    v_cvt_pk_bf16_f32 v129, v130, v131
    v_cvt_pk_bf16_f32 v130, v136, v137
    v_cvt_pk_bf16_f32 v131, v138, v139
    ds_write_b128 v13, v[128:131] offset:0
    v_pk_fma_f32 v[132:133], v[12:13], v[16:17], v[132:133] op_sel_hi:[0,1,1] neg_lo:[1,0,0] neg_hi:[1,0,0]
    v_pk_fma_f32 v[134:135], v[12:13], v[18:19], v[134:135] op_sel_hi:[0,1,1] neg_lo:[1,0,0] neg_hi:[1,0,0]
    v_pk_fma_f32 v[140:141], v[12:13], v[20:21], v[140:141] op_sel_hi:[0,1,1] neg_lo:[1,0,0] neg_hi:[1,0,0]
    v_pk_fma_f32 v[142:143], v[12:13], v[22:23], v[142:143] op_sel_hi:[0,1,1] neg_lo:[1,0,0] neg_hi:[1,0,0]
    v_pk_mul_f32 v[132:133], v[14:15], v[132:133] op_sel_hi:[0,1]
    v_pk_mul_f32 v[134:135], v[14:15], v[134:135] op_sel_hi:[0,1]
    v_pk_mul_f32 v[140:141], v[14:15], v[140:141] op_sel_hi:[0,1]
    v_pk_mul_f32 v[142:143], v[14:15], v[142:143] op_sel_hi:[0,1]
    v_cvt_pk_bf16_f32 v132, v132, v133
    v_cvt_pk_bf16_f32 v133, v134, v135
    v_cvt_pk_bf16_f32 v134, v140, v141
    v_cvt_pk_bf16_f32 v135, v142, v143
    ds_write_b128 v13, v[132:135] offset:256
    v_add_u32 v4, 131072, v1
    s_waitcnt lgkmcnt(0)
    s_barrier
    ds_read_b128 v[32:35], v4 offset:0
    ds_read_b128 v[36:39], v4 offset:1024
    ds_read_b128 v[40:43], v4 offset:2048
    ds_read_b128 v[44:47], v4 offset:3072
    ds_read_b128 v[48:51], v4 offset:4096
    ds_read_b128 v[52:55], v4 offset:5120
    ds_read_b128 v[56:59], v4 offset:6144
    ds_read_b128 v[60:63], v4 offset:7168
    v_pk_fma_f32 v[144:145], v[8:9], v[24:25], v[144:145] op_sel_hi:[0,1,1] neg_lo:[1,0,0] neg_hi:[1,0,0]
    v_pk_fma_f32 v[146:147], v[8:9], v[26:27], v[146:147] op_sel_hi:[0,1,1] neg_lo:[1,0,0] neg_hi:[1,0,0]
    v_pk_fma_f32 v[152:153], v[8:9], v[28:29], v[152:153] op_sel_hi:[0,1,1] neg_lo:[1,0,0] neg_hi:[1,0,0]
    v_pk_fma_f32 v[154:155], v[8:9], v[30:31], v[154:155] op_sel_hi:[0,1,1] neg_lo:[1,0,0] neg_hi:[1,0,0]
    v_pk_mul_f32 v[144:145], v[10:11], v[144:145] op_sel_hi:[0,1]
    v_pk_mul_f32 v[146:147], v[10:11], v[146:147] op_sel_hi:[0,1]
    v_pk_mul_f32 v[152:153], v[10:11], v[152:153] op_sel_hi:[0,1]
    v_pk_mul_f32 v[154:155], v[10:11], v[154:155] op_sel_hi:[0,1]
    v_cvt_pk_bf16_f32 v144, v144, v145
    v_cvt_pk_bf16_f32 v145, v146, v147
    v_cvt_pk_bf16_f32 v146, v152, v153
    v_cvt_pk_bf16_f32 v147, v154, v155
    ds_write_b128 v13, v[144:147] offset:8192
    s_waitcnt vmcnt(0) lgkmcnt(7)
    v_mfma_f32_32x32x16_bf16 v[192:207], v[64:67], v[32:35], 0
    v_mfma_f32_32x32x16_bf16 v[192:207], v[68:71], v[36:39], v[192:207]
    v_pk_fma_f32 v[148:149], v[12:13], v[24:25], v[148:149] op_sel_hi:[0,1,1] neg_lo:[1,0,0] neg_hi:[1,0,0]
    v_pk_fma_f32 v[150:151], v[12:13], v[26:27], v[150:151] op_sel_hi:[0,1,1] neg_lo:[1,0,0] neg_hi:[1,0,0]
    v_pk_fma_f32 v[156:157], v[12:13], v[28:29], v[156:157] op_sel_hi:[0,1,1] neg_lo:[1,0,0] neg_hi:[1,0,0]
    v_pk_fma_f32 v[158:159], v[12:13], v[30:31], v[158:159] op_sel_hi:[0,1,1] neg_lo:[1,0,0] neg_hi:[1,0,0]
    v_pk_mul_f32 v[148:149], v[14:15], v[148:149] op_sel_hi:[0,1]
    v_pk_mul_f32 v[150:151], v[14:15], v[150:151] op_sel_hi:[0,1]
    v_pk_mul_f32 v[156:157], v[14:15], v[156:157] op_sel_hi:[0,1]
    v_pk_mul_f32 v[158:159], v[14:15], v[158:159] op_sel_hi:[0,1]
    v_cvt_pk_bf16_f32 v148, v148, v149
    v_cvt_pk_bf16_f32 v149, v150, v151
    v_cvt_pk_bf16_f32 v150, v156, v157
    v_cvt_pk_bf16_f32 v151, v158, v159
    ds_write_b128 v13, v[148:151] offset:8448
    v_mov_b32 v9, 0xdddddddd
    v_bfe_u32 v10, v1, 4, 3
    v_mov_b32 v11, 0x3f803f80
    v_cmp_eq_u32 vcc, 0, v10
    v_cmp_eq_u32 s[44:45], 4, v10
    s_mov_b32 s57, 0
    v_cndmask_b32 v28, 0, v11, vcc
    v_cndmask_b32 v29, 0, v11, vcc
    v_cndmask_b32 v30, 0, v11, s[44:45]
    v_cndmask_b32 v31, 0, v11, s[44:45]
    v_mov_b32 v10, 0
    v_mov_b32 v11, 0
    s_mov_b32 s66, 0x10000
    s_waitcnt lgkmcnt(0)
    s_cmp_eq_u32 s68, 16
    s_cbranch_scc1 c_k_ok
c_k_poll:
    s_mov_b32 s68, 0
    s_atomic_add s68, s[22:23], s59 offset:0 glc
    s_sub_u32 s66, s66, 1
    s_cselect_b32 s67, 16, 0
    s_waitcnt lgkmcnt(0)
    s_max_u32 s68, s68, s67
    s_cmp_lt_u32 s68, 16
    s_cbranch_scc1 c_k_poll
c_k_ok:
    s_add_u32 s54, s54, 8192
    s_and_b32 s54, s54, 0x1ffff
    s_add_u32 s55, s53, s54
    s_add_u32 s56, s55, 4194304
    buffer_load_dwordx4 v[80:83], v1, s[4:7], s55 offen offset:0 sc1
    buffer_load_dwordx4 v[84:87], v1, s[4:7], s55 offen offset:1024 sc1
    buffer_load_dwordx4 v[88:91], v1, s[4:7], s56 offen offset:0 sc1
    buffer_load_dwordx4 v[92:95], v1, s[4:7], s56 offen offset:1024 sc1
    s_add_u32 s54, s54, 8192
    s_and_b32 s54, s54, 0x1ffff
    s_add_u32 s55, s53, s54
    s_add_u32 s56, s55, 4194304
    buffer_load_dwordx4 v[96:99], v1, s[4:7], s55 offen offset:0 sc1
    buffer_load_dwordx4 v[100:103], v1, s[4:7], s55 offen offset:1024 sc1
    buffer_load_dwordx4 v[104:107], v1, s[4:7], s56 offen offset:0 sc1
    buffer_load_dwordx4 v[108:111], v1, s[4:7], s56 offen offset:1024 sc1
    v_mfma_f32_32x32x16_bf16 v[208:223], v[64:67], v[40:43], 0
    s_add_u32 s54, s54, 8192
    s_and_b32 s54, s54, 0x1ffff
    s_add_u32 s55, s53, s54
    s_add_u32 s56, s55, 4194304
    v_exp_f32 v192, v192
    v_exp_f32 v193, v193
    v_exp_f32 v194, v194
    v_mfma_f32_32x32x8_bf16 v[128:143], v[10:11], v[10:11], 0
    v_mov_b32 v12, 0
    buffer_load_dwordx4 v[112:115], v1, s[4:7], s55 offen offset:0 sc1
    v_exp_f32 v195, v195
    v_exp_f32 v196, v196
    v_exp_f32 v197, v197
    v_mfma_f32_32x32x16_bf16 v[208:223], v[68:71], v[44:47], v[208:223]
    v_exp_f32 v198, v198
    v_exp_f32 v199, v199
    v_exp_f32 v200, v200
    v_mfma_f32_32x32x8_bf16 v[144:159], v[10:11], v[10:11], 0
    v_mov_b32 v16, 0
    v_exp_f32 v201, v201
    v_exp_f32 v202, v202
    v_mfma_f32_32x32x8_bf16 v[160:175], v[10:11], v[10:11], 0
    v_mov_b32 v20, 0
    s_lshl_b32 s44, s16, 12
    s_add_u32 s44, s44, 65536
    v_add_u32 v5, s44, v1
    s_lshl_b32 s44, s16, 8
    s_add_u32 s44, s44, 147456
    v_lshrrev_b32 v6, 2, v1
    v_add_u32 v6, s44, v6
    s_lshl_b32 s44, s21, 22
    s_lshl_b32 s45, s39, 16
    s_add_u32 s41, s44, s45
    s_lshl_b32 s45, s20, 12
    s_add_u32 s43, s41, s45
    s_and_b32 s45, s45, 0
    s_add_u32 s41, s41, s45
    s_add_u32 s41, s41, 16777216
    v_exp_f32 v203, v203
    v_exp_f32 v204, v204
    v_exp_f32 v205, v205
    v_mfma_f32_32x32x8_bf16 v[176:191], v[10:11], v[10:11], 0
    v_mov_b32 v24, 0
    v_exp_f32 v206, v206
    v_exp_f32 v207, v207
    v_mfma_f32_32x32x16_bf16 v[224:239], v[64:67], v[48:51], 0
    v_exp_f32 v208, v208
    v_exp_f32 v209, v209
    v_exp_f32 v210, v210
    v_smfmac_f32_32x32x32_bf16 v[128:143], v[72:75], v[192:199], v9
    buffer_load_dwordx4 v[116:119], v1, s[4:7], s55 offen offset:1024 sc1
    v_exp_f32 v211, v211
    v_exp_f32 v212, v212
    v_exp_f32 v213, v213
    v_mfma_f32_32x32x16_bf16 v[224:239], v[68:71], v[52:55], v[224:239]
    v_exp_f32 v214, v214
    v_exp_f32 v215, v215
    v_exp_f32 v216, v216
    v_smfmac_f32_16x16x64_bf16 v[12:15], v[28:31], v[192:199], v9
    v_exp_f32 v217, v217
    v_smfmac_f32_32x32x32_bf16 v[128:143], v[76:79], v[200:207], v9
    v_exp_f32 v218, v218
    v_exp_f32 v219, v219
    v_exp_f32 v220, v220
    v_smfmac_f32_16x16x64_bf16 v[12:15], v[28:31], v[200:207], v9
    v_exp_f32 v221, v221
    v_exp_f32 v222, v222
    v_exp_f32 v223, v223
b_head:
    s_mov_b32 s58, 3
b_loop:
    v_mfma_f32_32x32x16_bf16 v[240:255], v[64:67], v[56:59], 0
    v_exp_f32 v224, v224
    v_exp_f32 v225, v225
    v_exp_f32 v226, v226
    v_smfmac_f32_32x32x32_bf16 v[144:159], v[72:75], v[208:215], v9
    buffer_load_dwordx4 v[120:123], v1, s[4:7], s56 offen offset:0 sc1
    v_exp_f32 v227, v227
    v_exp_f32 v228, v228
    v_exp_f32 v229, v229
    v_mfma_f32_32x32x16_bf16 v[240:255], v[68:71], v[60:63], v[240:255]
    v_exp_f32 v230, v230
    v_exp_f32 v231, v231
    v_exp_f32 v232, v232
    v_smfmac_f32_16x16x64_bf16 v[16:19], v[28:31], v[208:215], v9
    v_exp_f32 v233, v233
    v_smfmac_f32_32x32x32_bf16 v[144:159], v[76:79], v[216:223], v9
    v_exp_f32 v234, v234
    v_exp_f32 v235, v235
    v_exp_f32 v236, v236
    v_smfmac_f32_16x16x64_bf16 v[16:19], v[28:31], v[216:223], v9
    v_exp_f32 v237, v237
    v_exp_f32 v238, v238
    v_exp_f32 v239, v239
    s_waitcnt vmcnt(7)
    v_mfma_f32_32x32x16_bf16 v[192:207], v[80:83], v[32:35], 0
    v_exp_f32 v240, v240
    v_exp_f32 v241, v241
    v_exp_f32 v242, v242
    v_smfmac_f32_32x32x32_bf16 v[160:175], v[72:75], v[224:231], v9
    buffer_load_dwordx4 v[124:127], v1, s[4:7], s56 offen offset:1024 sc1
    v_exp_f32 v243, v243
    v_exp_f32 v244, v244
    v_exp_f32 v245, v245
    v_mfma_f32_32x32x16_bf16 v[192:207], v[84:87], v[36:39], v[192:207]
    v_exp_f32 v246, v246
    v_exp_f32 v247, v247
    v_exp_f32 v248, v248
    v_smfmac_f32_16x16x64_bf16 v[20:23], v[28:31], v[224:231], v9
    v_exp_f32 v249, v249
    v_smfmac_f32_32x32x32_bf16 v[160:175], v[76:79], v[232:239], v9
    v_exp_f32 v250, v250
    v_exp_f32 v251, v251
    v_exp_f32 v252, v252
    v_smfmac_f32_16x16x64_bf16 v[20:23], v[28:31], v[232:239], v9
    v_exp_f32 v253, v253
    v_exp_f32 v254, v254
    v_exp_f32 v255, v255
    v_mfma_f32_32x32x16_bf16 v[208:223], v[80:83], v[40:43], 0
    s_add_u32 s54, s54, 8192
    s_and_b32 s54, s54, 0x1ffff
    s_add_u32 s55, s53, s54
    s_add_u32 s56, s55, 4194304
    v_exp_f32 v192, v192
    v_exp_f32 v193, v193
    v_exp_f32 v194, v194
    v_smfmac_f32_32x32x32_bf16 v[176:191], v[72:75], v[240:247], v9
    buffer_load_dwordx4 v[64:67], v1, s[4:7], s55 offen offset:0 sc1
    v_exp_f32 v195, v195
    v_exp_f32 v196, v196
    v_exp_f32 v197, v197
    v_mfma_f32_32x32x16_bf16 v[208:223], v[84:87], v[44:47], v[208:223]
    v_exp_f32 v198, v198
    v_exp_f32 v199, v199
    v_exp_f32 v200, v200
    v_smfmac_f32_16x16x64_bf16 v[24:27], v[28:31], v[240:247], v9
    v_exp_f32 v201, v201
    v_smfmac_f32_32x32x32_bf16 v[176:191], v[76:79], v[248:255], v9
    v_exp_f32 v202, v202
    v_exp_f32 v203, v203
    v_exp_f32 v204, v204
    v_smfmac_f32_16x16x64_bf16 v[24:27], v[28:31], v[248:255], v9
    v_exp_f32 v205, v205
    v_exp_f32 v206, v206
    v_exp_f32 v207, v207
    v_mfma_f32_32x32x16_bf16 v[224:239], v[80:83], v[48:51], 0
    v_exp_f32 v208, v208
    v_exp_f32 v209, v209
    v_exp_f32 v210, v210
    v_smfmac_f32_32x32x32_bf16 v[128:143], v[88:91], v[192:199], v9
    buffer_load_dwordx4 v[68:71], v1, s[4:7], s55 offen offset:1024 sc1
    v_exp_f32 v211, v211
    v_exp_f32 v212, v212
    v_exp_f32 v213, v213
    v_mfma_f32_32x32x16_bf16 v[224:239], v[84:87], v[52:55], v[224:239]
    v_exp_f32 v214, v214
    v_exp_f32 v215, v215
    v_exp_f32 v216, v216
    v_smfmac_f32_16x16x64_bf16 v[12:15], v[28:31], v[192:199], v9
    v_exp_f32 v217, v217
    v_smfmac_f32_32x32x32_bf16 v[128:143], v[92:95], v[200:207], v9
    v_exp_f32 v218, v218
    v_exp_f32 v219, v219
    v_exp_f32 v220, v220
    v_smfmac_f32_16x16x64_bf16 v[12:15], v[28:31], v[200:207], v9
    v_exp_f32 v221, v221
    v_exp_f32 v222, v222
    v_exp_f32 v223, v223
    v_mfma_f32_32x32x16_bf16 v[240:255], v[80:83], v[56:59], 0
    v_exp_f32 v224, v224
    v_exp_f32 v225, v225
    v_exp_f32 v226, v226
    v_smfmac_f32_32x32x32_bf16 v[144:159], v[88:91], v[208:215], v9
    buffer_load_dwordx4 v[72:75], v1, s[4:7], s56 offen offset:0 sc1
    v_exp_f32 v227, v227
    v_exp_f32 v228, v228
    v_exp_f32 v229, v229
    v_mfma_f32_32x32x16_bf16 v[240:255], v[84:87], v[60:63], v[240:255]
    v_exp_f32 v230, v230
    v_exp_f32 v231, v231
    v_exp_f32 v232, v232
    v_smfmac_f32_16x16x64_bf16 v[16:19], v[28:31], v[208:215], v9
    v_exp_f32 v233, v233
    v_smfmac_f32_32x32x32_bf16 v[144:159], v[92:95], v[216:223], v9
    v_exp_f32 v234, v234
    v_exp_f32 v235, v235
    v_exp_f32 v236, v236
    v_smfmac_f32_16x16x64_bf16 v[16:19], v[28:31], v[216:223], v9
    v_exp_f32 v237, v237
    v_exp_f32 v238, v238
    v_exp_f32 v239, v239
    s_waitcnt vmcnt(7)
    v_mfma_f32_32x32x16_bf16 v[192:207], v[96:99], v[32:35], 0
    v_exp_f32 v240, v240
    v_exp_f32 v241, v241
    v_exp_f32 v242, v242
    v_smfmac_f32_32x32x32_bf16 v[160:175], v[88:91], v[224:231], v9
    buffer_load_dwordx4 v[76:79], v1, s[4:7], s56 offen offset:1024 sc1
    v_exp_f32 v243, v243
    v_exp_f32 v244, v244
    v_exp_f32 v245, v245
    v_mfma_f32_32x32x16_bf16 v[192:207], v[100:103], v[36:39], v[192:207]
    v_exp_f32 v246, v246
    v_exp_f32 v247, v247
    v_exp_f32 v248, v248
    v_smfmac_f32_16x16x64_bf16 v[20:23], v[28:31], v[224:231], v9
    v_exp_f32 v249, v249
    v_smfmac_f32_32x32x32_bf16 v[160:175], v[92:95], v[232:239], v9
    v_exp_f32 v250, v250
    v_exp_f32 v251, v251
    v_exp_f32 v252, v252
    v_smfmac_f32_16x16x64_bf16 v[20:23], v[28:31], v[232:239], v9
    v_exp_f32 v253, v253
    v_exp_f32 v254, v254
    v_exp_f32 v255, v255
    v_mfma_f32_32x32x16_bf16 v[208:223], v[96:99], v[40:43], 0
    s_add_u32 s54, s54, 8192
    s_and_b32 s54, s54, 0x1ffff
    s_add_u32 s55, s53, s54
    s_add_u32 s56, s55, 4194304
    v_exp_f32 v192, v192
    v_exp_f32 v193, v193
    v_exp_f32 v194, v194
    v_smfmac_f32_32x32x32_bf16 v[176:191], v[88:91], v[240:247], v9
    buffer_load_dwordx4 v[80:83], v1, s[4:7], s55 offen offset:0 sc1
    v_exp_f32 v195, v195
    v_exp_f32 v196, v196
    v_exp_f32 v197, v197
    v_mfma_f32_32x32x16_bf16 v[208:223], v[100:103], v[44:47], v[208:223]
    v_exp_f32 v198, v198
    v_exp_f32 v199, v199
    v_exp_f32 v200, v200
    v_smfmac_f32_16x16x64_bf16 v[24:27], v[28:31], v[240:247], v9
    v_exp_f32 v201, v201
    v_smfmac_f32_32x32x32_bf16 v[176:191], v[92:95], v[248:255], v9
    v_exp_f32 v202, v202
    v_exp_f32 v203, v203
    v_exp_f32 v204, v204
    v_smfmac_f32_16x16x64_bf16 v[24:27], v[28:31], v[248:255], v9
    v_exp_f32 v205, v205
    v_exp_f32 v206, v206
    v_exp_f32 v207, v207
    v_mfma_f32_32x32x16_bf16 v[224:239], v[96:99], v[48:51], 0
    v_exp_f32 v208, v208
    v_exp_f32 v209, v209
    v_exp_f32 v210, v210
    v_smfmac_f32_32x32x32_bf16 v[128:143], v[104:107], v[192:199], v9
    buffer_load_dwordx4 v[84:87], v1, s[4:7], s55 offen offset:1024 sc1
    v_exp_f32 v211, v211
    v_exp_f32 v212, v212
    v_exp_f32 v213, v213
    v_mfma_f32_32x32x16_bf16 v[224:239], v[100:103], v[52:55], v[224:239]
    v_exp_f32 v214, v214
    v_exp_f32 v215, v215
    v_exp_f32 v216, v216
    v_smfmac_f32_16x16x64_bf16 v[12:15], v[28:31], v[192:199], v9
    v_exp_f32 v217, v217
    v_smfmac_f32_32x32x32_bf16 v[128:143], v[108:111], v[200:207], v9
    v_exp_f32 v218, v218
    v_exp_f32 v219, v219
    v_exp_f32 v220, v220
    v_smfmac_f32_16x16x64_bf16 v[12:15], v[28:31], v[200:207], v9
    v_exp_f32 v221, v221
    v_exp_f32 v222, v222
    v_exp_f32 v223, v223
    v_mfma_f32_32x32x16_bf16 v[240:255], v[96:99], v[56:59], 0
    v_exp_f32 v224, v224
    v_exp_f32 v225, v225
    v_exp_f32 v226, v226
    v_smfmac_f32_32x32x32_bf16 v[144:159], v[104:107], v[208:215], v9
    buffer_load_dwordx4 v[88:91], v1, s[4:7], s56 offen offset:0 sc1
    v_exp_f32 v227, v227
    v_exp_f32 v228, v228
    v_exp_f32 v229, v229
    v_mfma_f32_32x32x16_bf16 v[240:255], v[100:103], v[60:63], v[240:255]
    v_exp_f32 v230, v230
    v_exp_f32 v231, v231
    v_exp_f32 v232, v232
    v_smfmac_f32_16x16x64_bf16 v[16:19], v[28:31], v[208:215], v9
    v_exp_f32 v233, v233
    v_smfmac_f32_32x32x32_bf16 v[144:159], v[108:111], v[216:223], v9
    v_exp_f32 v234, v234
    v_exp_f32 v235, v235
    v_exp_f32 v236, v236
    v_smfmac_f32_16x16x64_bf16 v[16:19], v[28:31], v[216:223], v9
    v_exp_f32 v237, v237
    v_exp_f32 v238, v238
    v_exp_f32 v239, v239
    s_waitcnt vmcnt(7)
    v_mfma_f32_32x32x16_bf16 v[192:207], v[112:115], v[32:35], 0
    v_exp_f32 v240, v240
    v_exp_f32 v241, v241
    v_exp_f32 v242, v242
    v_smfmac_f32_32x32x32_bf16 v[160:175], v[104:107], v[224:231], v9
    buffer_load_dwordx4 v[92:95], v1, s[4:7], s56 offen offset:1024 sc1
    v_exp_f32 v243, v243
    v_exp_f32 v244, v244
    v_exp_f32 v245, v245
    v_mfma_f32_32x32x16_bf16 v[192:207], v[116:119], v[36:39], v[192:207]
    v_exp_f32 v246, v246
    v_exp_f32 v247, v247
    v_exp_f32 v248, v248
    v_smfmac_f32_16x16x64_bf16 v[20:23], v[28:31], v[224:231], v9
    v_exp_f32 v249, v249
    v_smfmac_f32_32x32x32_bf16 v[160:175], v[108:111], v[232:239], v9
    v_exp_f32 v250, v250
    v_exp_f32 v251, v251
    v_exp_f32 v252, v252
    v_smfmac_f32_16x16x64_bf16 v[20:23], v[28:31], v[232:239], v9
    v_exp_f32 v253, v253
    v_exp_f32 v254, v254
    v_exp_f32 v255, v255
    v_mfma_f32_32x32x16_bf16 v[208:223], v[112:115], v[40:43], 0
    s_add_u32 s54, s54, 8192
    s_and_b32 s54, s54, 0x1ffff
    s_add_u32 s55, s53, s54
    s_add_u32 s56, s55, 4194304
    v_exp_f32 v192, v192
    v_exp_f32 v193, v193
    v_exp_f32 v194, v194
    v_smfmac_f32_32x32x32_bf16 v[176:191], v[104:107], v[240:247], v9
    buffer_load_dwordx4 v[96:99], v1, s[4:7], s55 offen offset:0 sc1
    v_exp_f32 v195, v195
    v_exp_f32 v196, v196
    v_exp_f32 v197, v197
    v_mfma_f32_32x32x16_bf16 v[208:223], v[116:119], v[44:47], v[208:223]
    v_exp_f32 v198, v198
    v_exp_f32 v199, v199
    v_exp_f32 v200, v200
    v_smfmac_f32_16x16x64_bf16 v[24:27], v[28:31], v[240:247], v9
    v_exp_f32 v201, v201
    v_smfmac_f32_32x32x32_bf16 v[176:191], v[108:111], v[248:255], v9
    v_exp_f32 v202, v202
    v_exp_f32 v203, v203
    v_exp_f32 v204, v204
    v_smfmac_f32_16x16x64_bf16 v[24:27], v[28:31], v[248:255], v9
    v_exp_f32 v205, v205
    v_exp_f32 v206, v206
    v_exp_f32 v207, v207
    v_mfma_f32_32x32x16_bf16 v[224:239], v[112:115], v[48:51], 0
    v_exp_f32 v208, v208
    v_exp_f32 v209, v209
    v_exp_f32 v210, v210
    v_smfmac_f32_32x32x32_bf16 v[128:143], v[120:123], v[192:199], v9
    buffer_load_dwordx4 v[100:103], v1, s[4:7], s55 offen offset:1024 sc1
    v_exp_f32 v211, v211
    v_exp_f32 v212, v212
    v_exp_f32 v213, v213
    v_mfma_f32_32x32x16_bf16 v[224:239], v[116:119], v[52:55], v[224:239]
    v_exp_f32 v214, v214
    v_exp_f32 v215, v215
    v_exp_f32 v216, v216
    v_smfmac_f32_16x16x64_bf16 v[12:15], v[28:31], v[192:199], v9
    v_exp_f32 v217, v217
    v_smfmac_f32_32x32x32_bf16 v[128:143], v[124:127], v[200:207], v9
    v_exp_f32 v218, v218
    v_exp_f32 v219, v219
    v_exp_f32 v220, v220
    v_smfmac_f32_16x16x64_bf16 v[12:15], v[28:31], v[200:207], v9
    v_exp_f32 v221, v221
    v_exp_f32 v222, v222
    v_exp_f32 v223, v223
    v_mfma_f32_32x32x16_bf16 v[240:255], v[112:115], v[56:59], 0
    v_exp_f32 v224, v224
    v_exp_f32 v225, v225
    v_exp_f32 v226, v226
    v_smfmac_f32_32x32x32_bf16 v[144:159], v[120:123], v[208:215], v9
    buffer_load_dwordx4 v[104:107], v1, s[4:7], s56 offen offset:0 sc1
    v_exp_f32 v227, v227
    v_exp_f32 v228, v228
    v_exp_f32 v229, v229
    v_mfma_f32_32x32x16_bf16 v[240:255], v[116:119], v[60:63], v[240:255]
    v_exp_f32 v230, v230
    v_exp_f32 v231, v231
    v_exp_f32 v232, v232
    v_smfmac_f32_16x16x64_bf16 v[16:19], v[28:31], v[208:215], v9
    v_exp_f32 v233, v233
    v_smfmac_f32_32x32x32_bf16 v[144:159], v[124:127], v[216:223], v9
    v_exp_f32 v234, v234
    v_exp_f32 v235, v235
    v_exp_f32 v236, v236
    v_smfmac_f32_16x16x64_bf16 v[16:19], v[28:31], v[216:223], v9
    v_exp_f32 v237, v237
    v_exp_f32 v238, v238
    v_exp_f32 v239, v239
    s_waitcnt vmcnt(7)
    v_mfma_f32_32x32x16_bf16 v[192:207], v[64:67], v[32:35], 0
    v_exp_f32 v240, v240
    v_exp_f32 v241, v241
    v_exp_f32 v242, v242
    v_smfmac_f32_32x32x32_bf16 v[160:175], v[120:123], v[224:231], v9
    buffer_load_dwordx4 v[108:111], v1, s[4:7], s56 offen offset:1024 sc1
    v_exp_f32 v243, v243
    v_exp_f32 v244, v244
    v_exp_f32 v245, v245
    v_mfma_f32_32x32x16_bf16 v[192:207], v[68:71], v[36:39], v[192:207]
    v_exp_f32 v246, v246
    v_exp_f32 v247, v247
    v_exp_f32 v248, v248
    v_smfmac_f32_16x16x64_bf16 v[20:23], v[28:31], v[224:231], v9
    v_exp_f32 v249, v249
    v_smfmac_f32_32x32x32_bf16 v[160:175], v[124:127], v[232:239], v9
    v_exp_f32 v250, v250
    v_exp_f32 v251, v251
    v_exp_f32 v252, v252
    v_smfmac_f32_16x16x64_bf16 v[20:23], v[28:31], v[232:239], v9
    v_exp_f32 v253, v253
    v_exp_f32 v254, v254
    v_exp_f32 v255, v255
    v_mfma_f32_32x32x16_bf16 v[208:223], v[64:67], v[40:43], 0
    s_add_u32 s54, s54, 8192
    s_and_b32 s54, s54, 0x1ffff
    s_add_u32 s55, s53, s54
    s_add_u32 s56, s55, 4194304
    v_exp_f32 v192, v192
    v_exp_f32 v193, v193
    v_exp_f32 v194, v194
    v_smfmac_f32_32x32x32_bf16 v[176:191], v[120:123], v[240:247], v9
    buffer_load_dwordx4 v[112:115], v1, s[4:7], s55 offen offset:0 sc1
    v_exp_f32 v195, v195
    v_exp_f32 v196, v196
    v_exp_f32 v197, v197
    v_mfma_f32_32x32x16_bf16 v[208:223], v[68:71], v[44:47], v[208:223]
    v_exp_f32 v198, v198
    v_exp_f32 v199, v199
    v_exp_f32 v200, v200
    v_smfmac_f32_16x16x64_bf16 v[24:27], v[28:31], v[240:247], v9
    v_exp_f32 v201, v201
    v_smfmac_f32_32x32x32_bf16 v[176:191], v[124:127], v[248:255], v9
    v_exp_f32 v202, v202
    v_exp_f32 v203, v203
    v_exp_f32 v204, v204
    v_smfmac_f32_16x16x64_bf16 v[24:27], v[28:31], v[248:255], v9
    v_exp_f32 v205, v205
    v_exp_f32 v206, v206
    v_exp_f32 v207, v207
    v_mfma_f32_32x32x16_bf16 v[224:239], v[64:67], v[48:51], 0
    v_exp_f32 v208, v208
    v_exp_f32 v209, v209
    v_exp_f32 v210, v210
    v_smfmac_f32_32x32x32_bf16 v[128:143], v[72:75], v[192:199], v9
    buffer_load_dwordx4 v[116:119], v1, s[4:7], s55 offen offset:1024 sc1
    v_exp_f32 v211, v211
    v_exp_f32 v212, v212
    v_exp_f32 v213, v213
    v_mfma_f32_32x32x16_bf16 v[224:239], v[68:71], v[52:55], v[224:239]
    v_exp_f32 v214, v214
    v_exp_f32 v215, v215
    v_exp_f32 v216, v216
    v_smfmac_f32_16x16x64_bf16 v[12:15], v[28:31], v[192:199], v9
    v_exp_f32 v217, v217
    v_smfmac_f32_32x32x32_bf16 v[128:143], v[76:79], v[200:207], v9
    v_exp_f32 v218, v218
    v_exp_f32 v219, v219
    v_exp_f32 v220, v220
    v_smfmac_f32_16x16x64_bf16 v[12:15], v[28:31], v[200:207], v9
    v_exp_f32 v221, v221
    v_exp_f32 v222, v222
    v_exp_f32 v223, v223
    s_sub_u32 s58, s58, 1
    s_cmp_lg_u32 s58, 0
    s_cbranch_scc1 b_loop
    v_mfma_f32_32x32x16_bf16 v[240:255], v[64:67], v[56:59], 0
    v_exp_f32 v224, v224
    v_exp_f32 v225, v225
    v_exp_f32 v226, v226
    v_smfmac_f32_32x32x32_bf16 v[144:159], v[72:75], v[208:215], v9
    buffer_load_dwordx4 v[120:123], v1, s[4:7], s56 offen offset:0 sc1
    v_exp_f32 v227, v227
    v_exp_f32 v228, v228
    v_exp_f32 v229, v229
    v_mfma_f32_32x32x16_bf16 v[240:255], v[68:71], v[60:63], v[240:255]
    v_exp_f32 v230, v230
    v_exp_f32 v231, v231
    v_exp_f32 v232, v232
    v_smfmac_f32_16x16x64_bf16 v[16:19], v[28:31], v[208:215], v9
    v_exp_f32 v233, v233
    v_smfmac_f32_32x32x32_bf16 v[144:159], v[76:79], v[216:223], v9
    v_exp_f32 v234, v234
    v_exp_f32 v235, v235
    v_exp_f32 v236, v236
    v_smfmac_f32_16x16x64_bf16 v[16:19], v[28:31], v[216:223], v9
    v_exp_f32 v237, v237
    v_exp_f32 v238, v238
    v_exp_f32 v239, v239
    s_waitcnt vmcnt(7)
    v_mfma_f32_32x32x16_bf16 v[192:207], v[80:83], v[32:35], 0
    v_exp_f32 v240, v240
    v_exp_f32 v241, v241
    v_exp_f32 v242, v242
    v_smfmac_f32_32x32x32_bf16 v[160:175], v[72:75], v[224:231], v9
    buffer_load_dwordx4 v[124:127], v1, s[4:7], s56 offen offset:1024 sc1
    v_exp_f32 v243, v243
    v_exp_f32 v244, v244
    v_exp_f32 v245, v245
    v_mfma_f32_32x32x16_bf16 v[192:207], v[84:87], v[36:39], v[192:207]
    v_exp_f32 v246, v246
    v_exp_f32 v247, v247
    v_exp_f32 v248, v248
    v_smfmac_f32_16x16x64_bf16 v[20:23], v[28:31], v[224:231], v9
    v_exp_f32 v249, v249
    v_smfmac_f32_32x32x32_bf16 v[160:175], v[76:79], v[232:239], v9
    v_exp_f32 v250, v250
    v_exp_f32 v251, v251
    v_exp_f32 v252, v252
    v_smfmac_f32_16x16x64_bf16 v[20:23], v[28:31], v[232:239], v9
    v_exp_f32 v253, v253
    v_exp_f32 v254, v254
    v_exp_f32 v255, v255
    s_add_u32 s53, s53, 131072
    s_cmp_eq_u32 s57, 0
    s_cselect_b32 s53, s53, 2146435072
    v_mfma_f32_32x32x16_bf16 v[208:223], v[80:83], v[40:43], 0
    s_add_u32 s54, s54, 8192
    s_and_b32 s54, s54, 0x1ffff
    s_add_u32 s55, s53, s54
    s_add_u32 s56, s55, 4194304
    v_exp_f32 v192, v192
    v_exp_f32 v193, v193
    v_exp_f32 v194, v194
    v_smfmac_f32_32x32x32_bf16 v[176:191], v[72:75], v[240:247], v9
    buffer_load_dwordx4 v[64:67], v1, s[4:7], s55 offen offset:0 sc1
    v_exp_f32 v195, v195
    v_exp_f32 v196, v196
    v_exp_f32 v197, v197
    v_mfma_f32_32x32x16_bf16 v[208:223], v[84:87], v[44:47], v[208:223]
    v_exp_f32 v198, v198
    v_exp_f32 v199, v199
    v_exp_f32 v200, v200
    v_smfmac_f32_16x16x64_bf16 v[24:27], v[28:31], v[240:247], v9
    v_exp_f32 v201, v201
    v_smfmac_f32_32x32x32_bf16 v[176:191], v[76:79], v[248:255], v9
    v_exp_f32 v202, v202
    v_exp_f32 v203, v203
    v_exp_f32 v204, v204
    v_smfmac_f32_16x16x64_bf16 v[24:27], v[28:31], v[248:255], v9
    v_exp_f32 v205, v205
    v_exp_f32 v206, v206
    v_exp_f32 v207, v207
    v_mfma_f32_32x32x16_bf16 v[224:239], v[80:83], v[48:51], 0
    v_exp_f32 v208, v208
    v_exp_f32 v209, v209
    v_exp_f32 v210, v210
    v_smfmac_f32_32x32x32_bf16 v[128:143], v[88:91], v[192:199], v9
    buffer_load_dwordx4 v[68:71], v1, s[4:7], s55 offen offset:1024 sc1
    v_exp_f32 v211, v211
    v_exp_f32 v212, v212
    v_exp_f32 v213, v213
    v_mfma_f32_32x32x16_bf16 v[224:239], v[84:87], v[52:55], v[224:239]
    v_exp_f32 v214, v214
    v_exp_f32 v215, v215
    v_exp_f32 v216, v216
    v_smfmac_f32_16x16x64_bf16 v[12:15], v[28:31], v[192:199], v9
    v_exp_f32 v217, v217
    v_smfmac_f32_32x32x32_bf16 v[128:143], v[92:95], v[200:207], v9
    v_exp_f32 v218, v218
    v_exp_f32 v219, v219
    v_exp_f32 v220, v220
    v_smfmac_f32_16x16x64_bf16 v[12:15], v[28:31], v[200:207], v9
    v_exp_f32 v221, v221
    v_exp_f32 v222, v222
    v_exp_f32 v223, v223
    v_mfma_f32_32x32x16_bf16 v[240:255], v[80:83], v[56:59], 0
    v_exp_f32 v224, v224
    v_exp_f32 v225, v225
    v_exp_f32 v226, v226
    v_smfmac_f32_32x32x32_bf16 v[144:159], v[88:91], v[208:215], v9
    buffer_load_dwordx4 v[72:75], v1, s[4:7], s56 offen offset:0 sc1
    v_exp_f32 v227, v227
    v_exp_f32 v228, v228
    v_exp_f32 v229, v229
    v_mfma_f32_32x32x16_bf16 v[240:255], v[84:87], v[60:63], v[240:255]
    v_exp_f32 v230, v230
    v_exp_f32 v231, v231
    v_exp_f32 v232, v232
    v_smfmac_f32_16x16x64_bf16 v[16:19], v[28:31], v[208:215], v9
    v_exp_f32 v233, v233
    v_smfmac_f32_32x32x32_bf16 v[144:159], v[92:95], v[216:223], v9
    v_exp_f32 v234, v234
    v_exp_f32 v235, v235
    v_exp_f32 v236, v236
    v_smfmac_f32_16x16x64_bf16 v[16:19], v[28:31], v[216:223], v9
    v_exp_f32 v237, v237
    v_exp_f32 v238, v238
    v_exp_f32 v239, v239
    s_waitcnt vmcnt(7)
    v_mfma_f32_32x32x16_bf16 v[192:207], v[96:99], v[32:35], 0
    v_exp_f32 v240, v240
    v_exp_f32 v241, v241
    v_exp_f32 v242, v242
    v_smfmac_f32_32x32x32_bf16 v[160:175], v[88:91], v[224:231], v9
    buffer_load_dwordx4 v[76:79], v1, s[4:7], s56 offen offset:1024 sc1
    v_exp_f32 v243, v243
    v_exp_f32 v244, v244
    v_exp_f32 v245, v245
    v_mfma_f32_32x32x16_bf16 v[192:207], v[100:103], v[36:39], v[192:207]
    v_exp_f32 v246, v246
    v_exp_f32 v247, v247
    v_exp_f32 v248, v248
    v_smfmac_f32_16x16x64_bf16 v[20:23], v[28:31], v[224:231], v9
    v_exp_f32 v249, v249
    v_smfmac_f32_32x32x32_bf16 v[160:175], v[92:95], v[232:239], v9
    v_exp_f32 v250, v250
    v_exp_f32 v251, v251
    v_exp_f32 v252, v252
    v_smfmac_f32_16x16x64_bf16 v[20:23], v[28:31], v[232:239], v9
    v_exp_f32 v253, v253
    v_exp_f32 v254, v254
    v_exp_f32 v255, v255
    v_mfma_f32_32x32x16_bf16 v[208:223], v[96:99], v[40:43], 0
    s_add_u32 s54, s54, 8192
    s_and_b32 s54, s54, 0x1ffff
    s_add_u32 s55, s53, s54
    s_add_u32 s56, s55, 4194304
    v_exp_f32 v192, v192
    v_exp_f32 v193, v193
    v_exp_f32 v194, v194
    v_smfmac_f32_32x32x32_bf16 v[176:191], v[88:91], v[240:247], v9
    buffer_load_dwordx4 v[80:83], v1, s[4:7], s55 offen offset:0 sc1
    v_exp_f32 v195, v195
    v_exp_f32 v196, v196
    v_exp_f32 v197, v197
    v_mfma_f32_32x32x16_bf16 v[208:223], v[100:103], v[44:47], v[208:223]
    v_exp_f32 v198, v198
    v_exp_f32 v199, v199
    v_exp_f32 v200, v200
    v_smfmac_f32_16x16x64_bf16 v[24:27], v[28:31], v[240:247], v9
    v_exp_f32 v201, v201
    v_smfmac_f32_32x32x32_bf16 v[176:191], v[92:95], v[248:255], v9
    v_exp_f32 v202, v202
    v_exp_f32 v203, v203
    v_exp_f32 v204, v204
    v_smfmac_f32_16x16x64_bf16 v[24:27], v[28:31], v[248:255], v9
    v_exp_f32 v205, v205
    v_exp_f32 v206, v206
    v_exp_f32 v207, v207
    v_mfma_f32_32x32x16_bf16 v[224:239], v[96:99], v[48:51], 0
    v_exp_f32 v208, v208
    v_exp_f32 v209, v209
    v_exp_f32 v210, v210
    v_smfmac_f32_32x32x32_bf16 v[128:143], v[104:107], v[192:199], v9
    buffer_load_dwordx4 v[84:87], v1, s[4:7], s55 offen offset:1024 sc1
    v_exp_f32 v211, v211
    v_exp_f32 v212, v212
    v_exp_f32 v213, v213
    v_mfma_f32_32x32x16_bf16 v[224:239], v[100:103], v[52:55], v[224:239]
    v_exp_f32 v214, v214
    v_exp_f32 v215, v215
    v_exp_f32 v216, v216
    v_smfmac_f32_16x16x64_bf16 v[12:15], v[28:31], v[192:199], v9
    v_exp_f32 v217, v217
    v_smfmac_f32_32x32x32_bf16 v[128:143], v[108:111], v[200:207], v9
    v_exp_f32 v218, v218
    v_exp_f32 v219, v219
    v_exp_f32 v220, v220
    v_smfmac_f32_16x16x64_bf16 v[12:15], v[28:31], v[200:207], v9
    v_exp_f32 v221, v221
    v_exp_f32 v222, v222
    v_exp_f32 v223, v223
    v_mfma_f32_32x32x16_bf16 v[240:255], v[96:99], v[56:59], 0
    v_exp_f32 v224, v224
    v_exp_f32 v225, v225
    v_exp_f32 v226, v226
    v_smfmac_f32_32x32x32_bf16 v[144:159], v[104:107], v[208:215], v9
    buffer_load_dwordx4 v[88:91], v1, s[4:7], s56 offen offset:0 sc1
    v_exp_f32 v227, v227
    v_exp_f32 v228, v228
    v_exp_f32 v229, v229
    v_mfma_f32_32x32x16_bf16 v[240:255], v[100:103], v[60:63], v[240:255]
    v_exp_f32 v230, v230
    v_exp_f32 v231, v231
    v_exp_f32 v232, v232
    v_smfmac_f32_16x16x64_bf16 v[16:19], v[28:31], v[208:215], v9
    v_exp_f32 v233, v233
    v_smfmac_f32_32x32x32_bf16 v[144:159], v[108:111], v[216:223], v9
    v_exp_f32 v234, v234
    v_exp_f32 v235, v235
    v_exp_f32 v236, v236
    v_smfmac_f32_16x16x64_bf16 v[16:19], v[28:31], v[216:223], v9
    v_exp_f32 v237, v237
    v_exp_f32 v238, v238
    v_exp_f32 v239, v239
    s_waitcnt vmcnt(7)
    v_mfma_f32_32x32x16_bf16 v[192:207], v[112:115], v[32:35], 0
    v_exp_f32 v240, v240
    v_exp_f32 v241, v241
    v_exp_f32 v242, v242
    v_smfmac_f32_32x32x32_bf16 v[160:175], v[104:107], v[224:231], v9
    buffer_load_dwordx4 v[92:95], v1, s[4:7], s56 offen offset:1024 sc1
    v_exp_f32 v243, v243
    v_exp_f32 v244, v244
    v_exp_f32 v245, v245
    v_mfma_f32_32x32x16_bf16 v[192:207], v[116:119], v[36:39], v[192:207]
    v_exp_f32 v246, v246
    v_exp_f32 v247, v247
    v_exp_f32 v248, v248
    v_smfmac_f32_16x16x64_bf16 v[20:23], v[28:31], v[224:231], v9
    v_exp_f32 v249, v249
    v_smfmac_f32_32x32x32_bf16 v[160:175], v[108:111], v[232:239], v9
    v_exp_f32 v250, v250
    v_exp_f32 v251, v251
    v_exp_f32 v252, v252
    v_smfmac_f32_16x16x64_bf16 v[20:23], v[28:31], v[232:239], v9
    v_exp_f32 v253, v253
    v_exp_f32 v254, v254
    v_exp_f32 v255, v255
    s_barrier
    v_mfma_f32_32x32x16_bf16 v[208:223], v[112:115], v[40:43], 0
    s_add_u32 s54, s54, 8192
    s_and_b32 s54, s54, 0x1ffff
    s_add_u32 s55, s53, s54
    s_add_u32 s56, s55, 4194304
    ds_read_b128 v[32:35], v4 offset:8192
    ds_read_b128 v[36:39], v4 offset:9216
    v_exp_f32 v192, v192
    v_exp_f32 v193, v193
    v_exp_f32 v194, v194
    v_smfmac_f32_32x32x32_bf16 v[176:191], v[104:107], v[240:247], v9
    buffer_load_dwordx4 v[96:99], v1, s[4:7], s55 offen offset:0 sc1
    v_exp_f32 v195, v195
    v_exp_f32 v196, v196
    v_exp_f32 v197, v197
    v_mfma_f32_32x32x16_bf16 v[208:223], v[116:119], v[44:47], v[208:223]
    v_exp_f32 v198, v198
    v_exp_f32 v199, v199
    v_exp_f32 v200, v200
    v_smfmac_f32_16x16x64_bf16 v[24:27], v[28:31], v[240:247], v9
    v_exp_f32 v201, v201
    v_smfmac_f32_32x32x32_bf16 v[176:191], v[108:111], v[248:255], v9
    v_exp_f32 v202, v202
    v_exp_f32 v203, v203
    v_exp_f32 v204, v204
    v_smfmac_f32_16x16x64_bf16 v[24:27], v[28:31], v[248:255], v9
    v_exp_f32 v205, v205
    v_exp_f32 v206, v206
    v_exp_f32 v207, v207
    v_mfma_f32_32x32x16_bf16 v[224:239], v[112:115], v[48:51], 0
    ds_read_b128 v[40:43], v4 offset:10240
    ds_read_b128 v[44:47], v4 offset:11264
    v_exp_f32 v208, v208
    v_exp_f32 v209, v209
    v_exp_f32 v210, v210
    v_smfmac_f32_32x32x32_bf16 v[128:143], v[120:123], v[192:199], v9
    buffer_load_dwordx4 v[100:103], v1, s[4:7], s55 offen offset:1024 sc1
    v_exp_f32 v211, v211
    v_exp_f32 v212, v212
    v_exp_f32 v213, v213
    v_mfma_f32_32x32x16_bf16 v[224:239], v[116:119], v[52:55], v[224:239]
    v_exp_f32 v214, v214
    v_exp_f32 v215, v215
    v_exp_f32 v216, v216
    v_smfmac_f32_16x16x64_bf16 v[12:15], v[28:31], v[192:199], v9
    v_exp_f32 v217, v217
    v_smfmac_f32_32x32x32_bf16 v[128:143], v[124:127], v[200:207], v9
    v_exp_f32 v218, v218
    v_exp_f32 v219, v219
    v_exp_f32 v220, v220
    v_smfmac_f32_16x16x64_bf16 v[12:15], v[28:31], v[200:207], v9
    v_exp_f32 v221, v221
    v_exp_f32 v222, v222
    v_exp_f32 v223, v223
    v_mfma_f32_32x32x16_bf16 v[240:255], v[112:115], v[56:59], 0
    ds_read_b128 v[48:51], v4 offset:12288
    ds_read_b128 v[52:55], v4 offset:13312
    v_exp_f32 v224, v224
    v_exp_f32 v225, v225
    v_exp_f32 v226, v226
    v_smfmac_f32_32x32x32_bf16 v[144:159], v[120:123], v[208:215], v9
    buffer_load_dwordx4 v[104:107], v1, s[4:7], s56 offen offset:0 sc1
    v_exp_f32 v227, v227
    ds_write_b128 v5, v[128:131] offset:0
    v_exp_f32 v228, v228
    v_exp_f32 v229, v229
    v_mfma_f32_32x32x16_bf16 v[240:255], v[116:119], v[60:63], v[240:255]
    ds_write_b128 v5, v[132:135] offset:1024
    v_exp_f32 v230, v230
    v_exp_f32 v231, v231
    v_exp_f32 v232, v232
    v_smfmac_f32_16x16x64_bf16 v[16:19], v[28:31], v[208:215], v9
    ds_write_b32 v6, v12 offset:0
    v_exp_f32 v233, v233
    v_smfmac_f32_32x32x32_bf16 v[144:159], v[124:127], v[216:223], v9
    ds_write_b128 v5, v[136:139] offset:2048
    v_exp_f32 v234, v234
    v_exp_f32 v235, v235
    v_exp_f32 v236, v236
    v_smfmac_f32_16x16x64_bf16 v[16:19], v[28:31], v[216:223], v9
    ds_write_b128 v5, v[140:143] offset:3072
    v_exp_f32 v237, v237
    v_exp_f32 v238, v238
    v_exp_f32 v239, v239
    s_waitcnt vmcnt(7)
    s_waitcnt lgkmcnt(9)
    v_mfma_f32_32x32x16_bf16 v[192:207], v[64:67], v[32:35], 0
    ds_read_b128 v[56:59], v4 offset:14336
    ds_read_b128 v[60:63], v4 offset:15360
    v_exp_f32 v240, v240
    v_exp_f32 v241, v241
    v_exp_f32 v242, v242
    v_smfmac_f32_32x32x32_bf16 v[160:175], v[120:123], v[224:231], v9
    buffer_load_dwordx4 v[108:111], v1, s[4:7], s56 offen offset:1024 sc1
    v_exp_f32 v243, v243
    ds_write_b128 v5, v[144:147] offset:16384
    v_exp_f32 v244, v244
    v_exp_f32 v245, v245
    v_mfma_f32_32x32x16_bf16 v[192:207], v[68:71], v[36:39], v[192:207]
    ds_write_b128 v5, v[148:151] offset:17408
    v_exp_f32 v246, v246
    v_exp_f32 v247, v247
    v_exp_f32 v248, v248
    s_waitcnt lgkmcnt(4)
    v_mfma_f32_32x32x8_bf16 v[128:143], v[10:11], v[10:11], 0
    v_mov_b32 v12, 0
    v_smfmac_f32_16x16x64_bf16 v[20:23], v[28:31], v[224:231], v9
    ds_write_b32 v6, v16 offset:1024
    v_exp_f32 v249, v249
    v_smfmac_f32_32x32x32_bf16 v[160:175], v[124:127], v[232:239], v9
    ds_write_b128 v5, v[152:155] offset:18432
    v_exp_f32 v250, v250
    v_exp_f32 v251, v251
    v_exp_f32 v252, v252
    v_smfmac_f32_16x16x64_bf16 v[20:23], v[28:31], v[232:239], v9
    ds_write_b128 v5, v[156:159] offset:19456
    v_exp_f32 v253, v253
    v_exp_f32 v254, v254
    v_exp_f32 v255, v255
    s_cmp_lg_u32 s57, 0
    s_cbranch_scc1 b_tail
    v_mfma_f32_32x32x16_bf16 v[208:223], v[64:67], v[40:43], 0
    s_add_u32 s54, s54, 8192
    s_and_b32 s54, s54, 0x1ffff
    s_add_u32 s55, s53, s54
    s_add_u32 s56, s55, 4194304
    v_exp_f32 v192, v192
    v_exp_f32 v193, v193
    v_exp_f32 v194, v194
    v_smfmac_f32_32x32x32_bf16 v[176:191], v[120:123], v[240:247], v9
    buffer_load_dwordx4 v[112:115], v1, s[4:7], s55 offen offset:0 sc1
    v_exp_f32 v195, v195
    ds_write_b128 v5, v[160:163] offset:32768
    v_exp_f32 v196, v196
    v_exp_f32 v197, v197
    v_mfma_f32_32x32x16_bf16 v[208:223], v[68:71], v[44:47], v[208:223]
    ds_write_b128 v5, v[164:167] offset:33792
    v_exp_f32 v198, v198
    v_exp_f32 v199, v199
    v_exp_f32 v200, v200
    s_waitcnt lgkmcnt(2)
    v_mfma_f32_32x32x8_bf16 v[144:159], v[10:11], v[10:11], 0
    v_mov_b32 v16, 0
    v_smfmac_f32_16x16x64_bf16 v[24:27], v[28:31], v[240:247], v9
    ds_write_b32 v6, v20 offset:2048
    v_exp_f32 v201, v201
    v_smfmac_f32_32x32x32_bf16 v[176:191], v[124:127], v[248:255], v9
    ds_write_b128 v5, v[168:171] offset:34816
    v_exp_f32 v202, v202
    v_exp_f32 v203, v203
    v_exp_f32 v204, v204
    v_smfmac_f32_16x16x64_bf16 v[24:27], v[28:31], v[248:255], v9
    ds_write_b128 v5, v[172:175] offset:35840
    v_exp_f32 v205, v205
    v_exp_f32 v206, v206
    v_exp_f32 v207, v207
    v_mfma_f32_32x32x16_bf16 v[224:239], v[64:67], v[48:51], 0
    v_exp_f32 v208, v208
    v_exp_f32 v209, v209
    v_exp_f32 v210, v210
    v_smfmac_f32_32x32x32_bf16 v[128:143], v[72:75], v[192:199], v9
    buffer_load_dwordx4 v[116:119], v1, s[4:7], s55 offen offset:1024 sc1
    v_exp_f32 v211, v211
    ds_write_b128 v5, v[176:179] offset:49152
    v_exp_f32 v212, v212
    v_exp_f32 v213, v213
    v_mfma_f32_32x32x16_bf16 v[224:239], v[68:71], v[52:55], v[224:239]
    ds_write_b128 v5, v[180:183] offset:50176
    v_exp_f32 v214, v214
    v_exp_f32 v215, v215
    v_exp_f32 v216, v216
    s_waitcnt lgkmcnt(2)
    v_mfma_f32_32x32x8_bf16 v[160:175], v[10:11], v[10:11], 0
    v_mov_b32 v20, 0
    v_smfmac_f32_16x16x64_bf16 v[12:15], v[28:31], v[192:199], v9
    ds_write_b32 v6, v24 offset:3072
    v_exp_f32 v217, v217
    v_smfmac_f32_32x32x32_bf16 v[128:143], v[76:79], v[200:207], v9
    ds_write_b128 v5, v[184:187] offset:51200
    v_exp_f32 v218, v218
    v_exp_f32 v219, v219
    v_exp_f32 v220, v220
    v_smfmac_f32_16x16x64_bf16 v[12:15], v[28:31], v[200:207], v9
    ds_write_b128 v5, v[188:191] offset:52224
    v_exp_f32 v221, v221
    v_exp_f32 v222, v222
    v_exp_f32 v223, v223
    s_waitcnt lgkmcnt(0)
    v_mfma_f32_32x32x8_bf16 v[176:191], v[10:11], v[10:11], 0
    v_mov_b32 v24, 0
    s_barrier
    s_mov_b32 s57, 1
    s_branch b_head
b_tail:
    v_smfmac_f32_32x32x32_bf16 v[176:191], v[120:123], v[240:247], v9
    v_smfmac_f32_32x32x32_bf16 v[176:191], v[124:127], v[248:255], v9
    ds_write_b128 v5, v[160:163] offset:32768
    ds_write_b128 v5, v[164:167] offset:33792
    v_smfmac_f32_16x16x64_bf16 v[24:27], v[28:31], v[240:247], v9
    ds_write_b128 v5, v[168:171] offset:34816
    v_smfmac_f32_16x16x64_bf16 v[24:27], v[28:31], v[248:255], v9
    ds_write_b128 v5, v[172:175] offset:35840
    ds_write_b32 v6, v20 offset:2048
    s_nop 4
    ds_write_b128 v5, v[176:179] offset:49152
    ds_write_b128 v5, v[180:183] offset:50176
    ds_write_b128 v5, v[184:187] offset:51200
    ds_write_b128 v5, v[188:191] offset:52224
    s_nop 0
    ds_write_b32 v6, v24 offset:3072
    buffer_load_dwordx4 v[224:227], v2, s[4:7], s43 offen offset:0 sc1
    buffer_load_dwordx4 v[228:231], v2, s[4:7], s43 offen offset:256 sc1
    buffer_load_dwordx4 v[232:235], v2, s[4:7], s43 offen offset:2048 sc1
    buffer_load_dwordx4 v[236:239], v2, s[4:7], s43 offen offset:2304 sc1
    s_waitcnt lgkmcnt(0)
    s_barrier
    v_xor_b32 v4, 32, v3
    v_xor_b32 v5, 64, v3
    v_xor_b32 v6, 96, v3
c_wo:
    s_xor_b32 s42, s41, 0
    buffer_load_dwordx4 v[64:67], v2, s[4:7], s42 offen offset:0 sc1
    buffer_load_dwordx4 v[68:71], v2, s[4:7], s42 offen offset:256 sc1
    s_xor_b32 s42, s41, 4096
    buffer_load_dwordx4 v[72:75], v2, s[4:7], s42 offen offset:0 sc1
    buffer_load_dwordx4 v[76:79], v2, s[4:7], s42 offen offset:256 sc1
    s_xor_b32 s42, s41, 8192
    buffer_load_dwordx4 v[80:83], v2, s[4:7], s42 offen offset:0 sc1
    buffer_load_dwordx4 v[84:87], v2, s[4:7], s42 offen offset:256 sc1
    s_xor_b32 s42, s41, 12288
    buffer_load_dwordx4 v[88:91], v2, s[4:7], s42 offen offset:0 sc1
    buffer_load_dwordx4 v[92:95], v2, s[4:7], s42 offen offset:256 sc1
    s_xor_b32 s42, s41, 16384
    buffer_load_dwordx4 v[96:99], v2, s[4:7], s42 offen offset:0 sc1
    buffer_load_dwordx4 v[100:103], v2, s[4:7], s42 offen offset:256 sc1
    ds_read_b64_tr_b16 v[32:33], v3 offset:0
    ds_read_b64_tr_b16 v[34:35], v3 offset:1024
    ds_read_b64_tr_b16 v[36:37], v4 offset:0
    ds_read_b64_tr_b16 v[38:39], v4 offset:1024
    ds_read_b64_tr_b16 v[40:41], v5 offset:0
    ds_read_b64_tr_b16 v[42:43], v5 offset:1024
    ds_read_b64_tr_b16 v[44:45], v6 offset:0
    ds_read_b64_tr_b16 v[46:47], v6 offset:1024
    ds_read_b64_tr_b16 v[48:49], v3 offset:4096
    ds_read_b64_tr_b16 v[50:51], v3 offset:5120
    ds_read_b64_tr_b16 v[52:53], v4 offset:4096
    ds_read_b64_tr_b16 v[54:55], v4 offset:5120
    ds_read_b64_tr_b16 v[56:57], v5 offset:4096
    ds_read_b64_tr_b16 v[58:59], v5 offset:5120
    v_lshrrev_b32 v12, 4, v1
    v_and_b32 v13, 1, v12
    v_lshlrev_b32 v13, 4, v13
    v_mov_b32 v14, 0x3f80
    v_lshlrev_b32 v13, v13, v14
    v_lshrrev_b32 v14, 2, v12
    v_lshrrev_b32 v15, 4, v12
    v_xor_b32 v14, v14, v15
    v_and_b32 v14, 1, v14
    v_bfe_u32 v15, v12, 3, 1
    v_bfe_u32 v16, v12, 1, 1
    v_lshl_add_u32 v15, v15, 1, v16
    v_lshrrev_b32 v16, 5, v12
    v_lshl_add_u32 v15, v16, 2, v15
    v_lshl_add_u32 v15, v14, 3, v15
    v_cmp_eq_u32 vcc, 0, v15
    s_nop 1
    v_cndmask_b32 v240, 0, v13, vcc
    v_cmp_eq_u32 vcc, 1, v15
    s_nop 1
    v_cndmask_b32 v241, 0, v13, vcc
    v_cmp_eq_u32 vcc, 2, v15
    s_nop 1
    v_cndmask_b32 v242, 0, v13, vcc
    v_cmp_eq_u32 vcc, 3, v15
    s_nop 1
    v_cndmask_b32 v243, 0, v13, vcc
    v_cmp_eq_u32 vcc, 4, v15
    s_nop 1
    v_cndmask_b32 v244, 0, v13, vcc
    v_cmp_eq_u32 vcc, 5, v15
    s_nop 1
    v_cndmask_b32 v245, 0, v13, vcc
    v_cmp_eq_u32 vcc, 6, v15
    s_nop 1
    v_cndmask_b32 v246, 0, v13, vcc
    v_cmp_eq_u32 vcc, 7, v15
    s_nop 1
    v_cndmask_b32 v247, 0, v13, vcc
    s_waitcnt vmcnt(10)
    v_mfma_f32_16x16x32_bf16 v[128:131], v[240:243], v[224:227], 0
    v_mfma_f32_16x16x32_bf16 v[132:135], v[240:243], v[228:231], 0
    v_mfma_f32_16x16x32_bf16 v[136:139], v[244:247], v[224:227], 0
    v_mfma_f32_16x16x32_bf16 v[140:143], v[244:247], v[228:231], 0
    v_mfma_f32_16x16x32_bf16 v[144:147], v[240:243], v[232:235], 0
    v_mfma_f32_16x16x32_bf16 v[148:151], v[240:243], v[236:239], 0
    v_mfma_f32_16x16x32_bf16 v[152:155], v[244:247], v[232:235], 0
    v_mfma_f32_16x16x32_bf16 v[156:159], v[244:247], v[236:239], 0
    s_waitcnt vmcnt(8) lgkmcnt(10)
    v_mfma_f32_16x16x32_bf16 v[128:131], v[32:35], v[64:67], v[128:131]
    ds_read_b64_tr_b16 v[60:61], v6 offset:4096
    s_xor_b32 s42, s41, 20480
    buffer_load_dwordx4 v[104:107], v2, s[4:7], s42 offen offset:0 sc1
    v_mfma_f32_16x16x32_bf16 v[132:135], v[32:35], v[68:71], v[132:135]
    ds_read_b64_tr_b16 v[62:63], v6 offset:5120
    v_mfma_f32_16x16x32_bf16 v[136:139], v[36:39], v[64:67], v[136:139]
    ds_read_b64_tr_b16 v[32:33], v3 offset:8192
    v_mfma_f32_16x16x32_bf16 v[140:143], v[36:39], v[68:71], v[140:143]
    ds_read_b64_tr_b16 v[34:35], v3 offset:9216
    s_waitcnt lgkmcnt(10)
    v_mfma_f32_16x16x32_bf16 v[144:147], v[40:43], v[64:67], v[144:147]
    ds_read_b64_tr_b16 v[36:37], v4 offset:8192
    buffer_load_dwordx4 v[108:111], v2, s[4:7], s42 offen offset:256 sc1
    v_mfma_f32_16x16x32_bf16 v[148:151], v[40:43], v[68:71], v[148:151]
    ds_read_b64_tr_b16 v[38:39], v4 offset:9216
    v_mfma_f32_16x16x32_bf16 v[152:155], v[44:47], v[64:67], v[152:155]
    ds_read_b64_tr_b16 v[40:41], v5 offset:8192
    v_mfma_f32_16x16x32_bf16 v[156:159], v[44:47], v[68:71], v[156:159]
    ds_read_b64_tr_b16 v[42:43], v5 offset:9216
    s_waitcnt vmcnt(8) lgkmcnt(10)
    v_mfma_f32_16x16x32_bf16 v[128:131], v[48:51], v[72:75], v[128:131]
    ds_read_b64_tr_b16 v[44:45], v6 offset:8192
    s_xor_b32 s42, s41, 24576
    buffer_load_dwordx4 v[112:115], v2, s[4:7], s42 offen offset:0 sc1
    v_mfma_f32_16x16x32_bf16 v[132:135], v[48:51], v[76:79], v[132:135]
    ds_read_b64_tr_b16 v[46:47], v6 offset:9216
    v_mfma_f32_16x16x32_bf16 v[136:139], v[52:55], v[72:75], v[136:139]
    ds_read_b64_tr_b16 v[48:49], v3 offset:12288
    v_mfma_f32_16x16x32_bf16 v[140:143], v[52:55], v[76:79], v[140:143]
    ds_read_b64_tr_b16 v[50:51], v3 offset:13312
    s_waitcnt lgkmcnt(10)
    v_mfma_f32_16x16x32_bf16 v[144:147], v[56:59], v[72:75], v[144:147]
    ds_read_b64_tr_b16 v[52:53], v4 offset:12288
    buffer_load_dwordx4 v[116:119], v2, s[4:7], s42 offen offset:256 sc1
    v_mfma_f32_16x16x32_bf16 v[148:151], v[56:59], v[76:79], v[148:151]
    ds_read_b64_tr_b16 v[54:55], v4 offset:13312
    v_mfma_f32_16x16x32_bf16 v[152:155], v[60:63], v[72:75], v[152:155]
    ds_read_b64_tr_b16 v[56:57], v5 offset:12288
    v_mfma_f32_16x16x32_bf16 v[156:159], v[60:63], v[76:79], v[156:159]
    ds_read_b64_tr_b16 v[58:59], v5 offset:13312
    s_waitcnt vmcnt(8) lgkmcnt(10)
    v_mfma_f32_16x16x32_bf16 v[128:131], v[32:35], v[80:83], v[128:131]
    ds_read_b64_tr_b16 v[60:61], v6 offset:12288
    s_xor_b32 s42, s41, 28672
    buffer_load_dwordx4 v[120:123], v2, s[4:7], s42 offen offset:0 sc1
    v_mfma_f32_16x16x32_bf16 v[132:135], v[32:35], v[84:87], v[132:135]
    ds_read_b64_tr_b16 v[62:63], v6 offset:13312
    v_mfma_f32_16x16x32_bf16 v[136:139], v[36:39], v[80:83], v[136:139]
    ds_read_b64_tr_b16 v[32:33], v3 offset:16384
    v_mfma_f32_16x16x32_bf16 v[140:143], v[36:39], v[84:87], v[140:143]
    ds_read_b64_tr_b16 v[34:35], v3 offset:17408
    s_waitcnt lgkmcnt(10)
    v_mfma_f32_16x16x32_bf16 v[144:147], v[40:43], v[80:83], v[144:147]
    ds_read_b64_tr_b16 v[36:37], v4 offset:16384
    buffer_load_dwordx4 v[124:127], v2, s[4:7], s42 offen offset:256 sc1
    v_mfma_f32_16x16x32_bf16 v[148:151], v[40:43], v[84:87], v[148:151]
    ds_read_b64_tr_b16 v[38:39], v4 offset:17408
    v_mfma_f32_16x16x32_bf16 v[152:155], v[44:47], v[80:83], v[152:155]
    ds_read_b64_tr_b16 v[40:41], v5 offset:16384
    v_mfma_f32_16x16x32_bf16 v[156:159], v[44:47], v[84:87], v[156:159]
    ds_read_b64_tr_b16 v[42:43], v5 offset:17408
    s_waitcnt vmcnt(8) lgkmcnt(10)
    v_mfma_f32_16x16x32_bf16 v[128:131], v[48:51], v[88:91], v[128:131]
    ds_read_b64_tr_b16 v[44:45], v6 offset:16384
    s_xor_b32 s42, s41, 32768
    buffer_load_dwordx4 v[160:163], v2, s[4:7], s42 offen offset:0 sc1
    v_mfma_f32_16x16x32_bf16 v[132:135], v[48:51], v[92:95], v[132:135]
    ds_read_b64_tr_b16 v[46:47], v6 offset:17408
    v_mfma_f32_16x16x32_bf16 v[136:139], v[52:55], v[88:91], v[136:139]
    ds_read_b64_tr_b16 v[48:49], v3 offset:20480
    v_mfma_f32_16x16x32_bf16 v[140:143], v[52:55], v[92:95], v[140:143]
    ds_read_b64_tr_b16 v[50:51], v3 offset:21504
    s_waitcnt lgkmcnt(10)
    v_mfma_f32_16x16x32_bf16 v[144:147], v[56:59], v[88:91], v[144:147]
    ds_read_b64_tr_b16 v[52:53], v4 offset:20480
    buffer_load_dwordx4 v[164:167], v2, s[4:7], s42 offen offset:256 sc1
    v_mfma_f32_16x16x32_bf16 v[148:151], v[56:59], v[92:95], v[148:151]
    ds_read_b64_tr_b16 v[54:55], v4 offset:21504
    v_mfma_f32_16x16x32_bf16 v[152:155], v[60:63], v[88:91], v[152:155]
    ds_read_b64_tr_b16 v[56:57], v5 offset:20480
    v_mfma_f32_16x16x32_bf16 v[156:159], v[60:63], v[92:95], v[156:159]
    ds_read_b64_tr_b16 v[58:59], v5 offset:21504
    s_waitcnt vmcnt(8) lgkmcnt(10)
    v_mfma_f32_16x16x32_bf16 v[128:131], v[32:35], v[96:99], v[128:131]
    ds_read_b64_tr_b16 v[60:61], v6 offset:20480
    s_xor_b32 s42, s41, 36864
    buffer_load_dwordx4 v[168:171], v2, s[4:7], s42 offen offset:0 sc1
    v_mfma_f32_16x16x32_bf16 v[132:135], v[32:35], v[100:103], v[132:135]
    ds_read_b64_tr_b16 v[62:63], v6 offset:21504
    v_mfma_f32_16x16x32_bf16 v[136:139], v[36:39], v[96:99], v[136:139]
    ds_read_b64_tr_b16 v[32:33], v3 offset:24576
    v_mfma_f32_16x16x32_bf16 v[140:143], v[36:39], v[100:103], v[140:143]
    ds_read_b64_tr_b16 v[34:35], v3 offset:25600
    s_waitcnt lgkmcnt(10)
    v_mfma_f32_16x16x32_bf16 v[144:147], v[40:43], v[96:99], v[144:147]
    ds_read_b64_tr_b16 v[36:37], v4 offset:24576
    buffer_load_dwordx4 v[172:175], v2, s[4:7], s42 offen offset:256 sc1
    v_mfma_f32_16x16x32_bf16 v[148:151], v[40:43], v[100:103], v[148:151]
    ds_read_b64_tr_b16 v[38:39], v4 offset:25600
    v_mfma_f32_16x16x32_bf16 v[152:155], v[44:47], v[96:99], v[152:155]
    ds_read_b64_tr_b16 v[40:41], v5 offset:24576
    v_mfma_f32_16x16x32_bf16 v[156:159], v[44:47], v[100:103], v[156:159]
    ds_read_b64_tr_b16 v[42:43], v5 offset:25600
    s_waitcnt vmcnt(8) lgkmcnt(10)
    v_mfma_f32_16x16x32_bf16 v[128:131], v[48:51], v[104:107], v[128:131]
    ds_read_b64_tr_b16 v[44:45], v6 offset:24576
    s_xor_b32 s42, s41, 40960
    buffer_load_dwordx4 v[176:179], v2, s[4:7], s42 offen offset:0 sc1
    v_mfma_f32_16x16x32_bf16 v[132:135], v[48:51], v[108:111], v[132:135]
    ds_read_b64_tr_b16 v[46:47], v6 offset:25600
    v_mfma_f32_16x16x32_bf16 v[136:139], v[52:55], v[104:107], v[136:139]
    ds_read_b64_tr_b16 v[48:49], v3 offset:28672
    v_mfma_f32_16x16x32_bf16 v[140:143], v[52:55], v[108:111], v[140:143]
    ds_read_b64_tr_b16 v[50:51], v3 offset:29696
    s_waitcnt lgkmcnt(10)
    v_mfma_f32_16x16x32_bf16 v[144:147], v[56:59], v[104:107], v[144:147]
    ds_read_b64_tr_b16 v[52:53], v4 offset:28672
    buffer_load_dwordx4 v[180:183], v2, s[4:7], s42 offen offset:256 sc1
    v_mfma_f32_16x16x32_bf16 v[148:151], v[56:59], v[108:111], v[148:151]
    ds_read_b64_tr_b16 v[54:55], v4 offset:29696
    v_mfma_f32_16x16x32_bf16 v[152:155], v[60:63], v[104:107], v[152:155]
    ds_read_b64_tr_b16 v[56:57], v5 offset:28672
    v_mfma_f32_16x16x32_bf16 v[156:159], v[60:63], v[108:111], v[156:159]
    ds_read_b64_tr_b16 v[58:59], v5 offset:29696
    s_waitcnt vmcnt(8) lgkmcnt(10)
    v_mfma_f32_16x16x32_bf16 v[128:131], v[32:35], v[112:115], v[128:131]
    ds_read_b64_tr_b16 v[60:61], v6 offset:28672
    s_xor_b32 s42, s41, 45056
    buffer_load_dwordx4 v[184:187], v2, s[4:7], s42 offen offset:0 sc1
    v_mfma_f32_16x16x32_bf16 v[132:135], v[32:35], v[116:119], v[132:135]
    ds_read_b64_tr_b16 v[62:63], v6 offset:29696
    v_mfma_f32_16x16x32_bf16 v[136:139], v[36:39], v[112:115], v[136:139]
    ds_read_b64_tr_b16 v[32:33], v3 offset:32768
    v_mfma_f32_16x16x32_bf16 v[140:143], v[36:39], v[116:119], v[140:143]
    ds_read_b64_tr_b16 v[34:35], v3 offset:33792
    s_waitcnt lgkmcnt(10)
    v_mfma_f32_16x16x32_bf16 v[144:147], v[40:43], v[112:115], v[144:147]
    ds_read_b64_tr_b16 v[36:37], v4 offset:32768
    buffer_load_dwordx4 v[188:191], v2, s[4:7], s42 offen offset:256 sc1
    v_mfma_f32_16x16x32_bf16 v[148:151], v[40:43], v[116:119], v[148:151]
    ds_read_b64_tr_b16 v[38:39], v4 offset:33792
    v_mfma_f32_16x16x32_bf16 v[152:155], v[44:47], v[112:115], v[152:155]
    ds_read_b64_tr_b16 v[40:41], v5 offset:32768
    v_mfma_f32_16x16x32_bf16 v[156:159], v[44:47], v[116:119], v[156:159]
    ds_read_b64_tr_b16 v[42:43], v5 offset:33792
    s_waitcnt vmcnt(8) lgkmcnt(10)
    v_mfma_f32_16x16x32_bf16 v[128:131], v[48:51], v[120:123], v[128:131]
    ds_read_b64_tr_b16 v[44:45], v6 offset:32768
    s_xor_b32 s42, s41, 49152
    buffer_load_dwordx4 v[64:67], v2, s[4:7], s42 offen offset:0 sc1
    v_mfma_f32_16x16x32_bf16 v[132:135], v[48:51], v[124:127], v[132:135]
    ds_read_b64_tr_b16 v[46:47], v6 offset:33792
    v_mfma_f32_16x16x32_bf16 v[136:139], v[52:55], v[120:123], v[136:139]
    ds_read_b64_tr_b16 v[48:49], v3 offset:36864
    v_mfma_f32_16x16x32_bf16 v[140:143], v[52:55], v[124:127], v[140:143]
    ds_read_b64_tr_b16 v[50:51], v3 offset:37888
    s_waitcnt lgkmcnt(10)
    v_mfma_f32_16x16x32_bf16 v[144:147], v[56:59], v[120:123], v[144:147]
    ds_read_b64_tr_b16 v[52:53], v4 offset:36864
    buffer_load_dwordx4 v[68:71], v2, s[4:7], s42 offen offset:256 sc1
    v_mfma_f32_16x16x32_bf16 v[148:151], v[56:59], v[124:127], v[148:151]
    ds_read_b64_tr_b16 v[54:55], v4 offset:37888
    v_mfma_f32_16x16x32_bf16 v[152:155], v[60:63], v[120:123], v[152:155]
    ds_read_b64_tr_b16 v[56:57], v5 offset:36864
    v_mfma_f32_16x16x32_bf16 v[156:159], v[60:63], v[124:127], v[156:159]
    ds_read_b64_tr_b16 v[58:59], v5 offset:37888
    s_waitcnt vmcnt(8) lgkmcnt(10)
    v_mfma_f32_16x16x32_bf16 v[128:131], v[32:35], v[160:163], v[128:131]
    ds_read_b64_tr_b16 v[60:61], v6 offset:36864
    s_xor_b32 s42, s41, 53248
    buffer_load_dwordx4 v[72:75], v2, s[4:7], s42 offen offset:0 sc1
    v_mfma_f32_16x16x32_bf16 v[132:135], v[32:35], v[164:167], v[132:135]
    ds_read_b64_tr_b16 v[62:63], v6 offset:37888
    v_mfma_f32_16x16x32_bf16 v[136:139], v[36:39], v[160:163], v[136:139]
    ds_read_b64_tr_b16 v[32:33], v3 offset:40960
    v_mfma_f32_16x16x32_bf16 v[140:143], v[36:39], v[164:167], v[140:143]
    ds_read_b64_tr_b16 v[34:35], v3 offset:41984
    s_waitcnt lgkmcnt(10)
    v_mfma_f32_16x16x32_bf16 v[144:147], v[40:43], v[160:163], v[144:147]
    ds_read_b64_tr_b16 v[36:37], v4 offset:40960
    buffer_load_dwordx4 v[76:79], v2, s[4:7], s42 offen offset:256 sc1
    v_mfma_f32_16x16x32_bf16 v[148:151], v[40:43], v[164:167], v[148:151]
    ds_read_b64_tr_b16 v[38:39], v4 offset:41984
    v_mfma_f32_16x16x32_bf16 v[152:155], v[44:47], v[160:163], v[152:155]
    ds_read_b64_tr_b16 v[40:41], v5 offset:40960
    v_mfma_f32_16x16x32_bf16 v[156:159], v[44:47], v[164:167], v[156:159]
    ds_read_b64_tr_b16 v[42:43], v5 offset:41984
    s_waitcnt vmcnt(8) lgkmcnt(10)
    v_mfma_f32_16x16x32_bf16 v[128:131], v[48:51], v[168:171], v[128:131]
    ds_read_b64_tr_b16 v[44:45], v6 offset:40960
    s_xor_b32 s42, s41, 57344
    buffer_load_dwordx4 v[80:83], v2, s[4:7], s42 offen offset:0 sc1
    v_mfma_f32_16x16x32_bf16 v[132:135], v[48:51], v[172:175], v[132:135]
    ds_read_b64_tr_b16 v[46:47], v6 offset:41984
    v_mfma_f32_16x16x32_bf16 v[136:139], v[52:55], v[168:171], v[136:139]
    ds_read_b64_tr_b16 v[48:49], v3 offset:45056
    v_mfma_f32_16x16x32_bf16 v[140:143], v[52:55], v[172:175], v[140:143]
    ds_read_b64_tr_b16 v[50:51], v3 offset:46080
    s_waitcnt lgkmcnt(10)
    v_mfma_f32_16x16x32_bf16 v[144:147], v[56:59], v[168:171], v[144:147]
    ds_read_b64_tr_b16 v[52:53], v4 offset:45056
    buffer_load_dwordx4 v[84:87], v2, s[4:7], s42 offen offset:256 sc1
    v_mfma_f32_16x16x32_bf16 v[148:151], v[56:59], v[172:175], v[148:151]
    ds_read_b64_tr_b16 v[54:55], v4 offset:46080
    v_mfma_f32_16x16x32_bf16 v[152:155], v[60:63], v[168:171], v[152:155]
    ds_read_b64_tr_b16 v[56:57], v5 offset:45056
    v_mfma_f32_16x16x32_bf16 v[156:159], v[60:63], v[172:175], v[156:159]
    ds_read_b64_tr_b16 v[58:59], v5 offset:46080
    s_waitcnt vmcnt(8) lgkmcnt(10)
    v_mfma_f32_16x16x32_bf16 v[128:131], v[32:35], v[176:179], v[128:131]
    ds_read_b64_tr_b16 v[60:61], v6 offset:45056
    s_xor_b32 s42, s41, 61440
    buffer_load_dwordx4 v[88:91], v2, s[4:7], s42 offen offset:0 sc1
    v_mfma_f32_16x16x32_bf16 v[132:135], v[32:35], v[180:183], v[132:135]
    ds_read_b64_tr_b16 v[62:63], v6 offset:46080
    s_barrier
    v_mfma_f32_16x16x32_bf16 v[136:139], v[36:39], v[176:179], v[136:139]
    ds_read_b64_tr_b16 v[32:33], v3 offset:49152
    v_mfma_f32_16x16x32_bf16 v[140:143], v[36:39], v[180:183], v[140:143]
    ds_read_b64_tr_b16 v[34:35], v3 offset:50176
    s_waitcnt lgkmcnt(10)
    v_mfma_f32_16x16x32_bf16 v[144:147], v[40:43], v[176:179], v[144:147]
    ds_read_b64_tr_b16 v[36:37], v4 offset:49152
    buffer_load_dwordx4 v[92:95], v2, s[4:7], s42 offen offset:256 sc1
    v_mfma_f32_16x16x32_bf16 v[148:151], v[40:43], v[180:183], v[148:151]
    ds_read_b64_tr_b16 v[38:39], v4 offset:50176
    v_mfma_f32_16x16x32_bf16 v[152:155], v[44:47], v[176:179], v[152:155]
    ds_read_b64_tr_b16 v[40:41], v5 offset:49152
    v_mfma_f32_16x16x32_bf16 v[156:159], v[44:47], v[180:183], v[156:159]
    ds_read_b64_tr_b16 v[42:43], v5 offset:50176
    s_waitcnt vmcnt(8) lgkmcnt(10)
    v_mfma_f32_16x16x32_bf16 v[128:131], v[48:51], v[184:187], v[128:131]
    ds_read_b64_tr_b16 v[44:45], v6 offset:49152
    s_xor_b32 s42, s41, 0
    buffer_load_dwordx4 v[96:99], v2, s[4:7], s42 offen offset:2048 sc1
    v_mfma_f32_16x16x32_bf16 v[132:135], v[48:51], v[188:191], v[132:135]
    ds_read_b64_tr_b16 v[46:47], v6 offset:50176
    v_mfma_f32_16x16x32_bf16 v[136:139], v[52:55], v[184:187], v[136:139]
    ds_read_b64_tr_b16 v[48:49], v3 offset:53248
    v_mfma_f32_16x16x32_bf16 v[140:143], v[52:55], v[188:191], v[140:143]
    ds_read_b64_tr_b16 v[50:51], v3 offset:54272
    s_waitcnt lgkmcnt(10)
    v_mfma_f32_16x16x32_bf16 v[144:147], v[56:59], v[184:187], v[144:147]
    ds_read_b64_tr_b16 v[52:53], v4 offset:53248
    buffer_load_dwordx4 v[100:103], v2, s[4:7], s42 offen offset:2304 sc1
    v_mfma_f32_16x16x32_bf16 v[148:151], v[56:59], v[188:191], v[148:151]
    ds_read_b64_tr_b16 v[54:55], v4 offset:54272
    v_mfma_f32_16x16x32_bf16 v[152:155], v[60:63], v[184:187], v[152:155]
    ds_read_b64_tr_b16 v[56:57], v5 offset:53248
    v_mfma_f32_16x16x32_bf16 v[156:159], v[60:63], v[188:191], v[156:159]
    ds_read_b64_tr_b16 v[58:59], v5 offset:54272
    s_waitcnt vmcnt(8) lgkmcnt(10)
    v_mfma_f32_16x16x32_bf16 v[128:131], v[32:35], v[64:67], v[128:131]
    ds_read_b64_tr_b16 v[60:61], v6 offset:53248
    s_xor_b32 s42, s41, 4096
    buffer_load_dwordx4 v[104:107], v2, s[4:7], s42 offen offset:2048 sc1
    v_mfma_f32_16x16x32_bf16 v[132:135], v[32:35], v[68:71], v[132:135]
    ds_read_b64_tr_b16 v[62:63], v6 offset:54272
    v_mfma_f32_16x16x32_bf16 v[136:139], v[36:39], v[64:67], v[136:139]
    ds_read_b64_tr_b16 v[32:33], v3 offset:57344
    v_mfma_f32_16x16x32_bf16 v[140:143], v[36:39], v[68:71], v[140:143]
    ds_read_b64_tr_b16 v[34:35], v3 offset:58368
    s_waitcnt lgkmcnt(10)
    v_mfma_f32_16x16x32_bf16 v[144:147], v[40:43], v[64:67], v[144:147]
    ds_read_b64_tr_b16 v[36:37], v4 offset:57344
    buffer_load_dwordx4 v[108:111], v2, s[4:7], s42 offen offset:2304 sc1
    v_mfma_f32_16x16x32_bf16 v[148:151], v[40:43], v[68:71], v[148:151]
    ds_read_b64_tr_b16 v[38:39], v4 offset:58368
    v_mfma_f32_16x16x32_bf16 v[152:155], v[44:47], v[64:67], v[152:155]
    ds_read_b64_tr_b16 v[40:41], v5 offset:57344
    v_mfma_f32_16x16x32_bf16 v[156:159], v[44:47], v[68:71], v[156:159]
    ds_read_b64_tr_b16 v[42:43], v5 offset:58368
    s_waitcnt vmcnt(8) lgkmcnt(10)
    v_mfma_f32_16x16x32_bf16 v[128:131], v[48:51], v[72:75], v[128:131]
    ds_read_b64_tr_b16 v[44:45], v6 offset:57344
    s_xor_b32 s42, s41, 8192
    buffer_load_dwordx4 v[112:115], v2, s[4:7], s42 offen offset:2048 sc1
    v_mfma_f32_16x16x32_bf16 v[132:135], v[48:51], v[76:79], v[132:135]
    ds_read_b64_tr_b16 v[46:47], v6 offset:58368
    v_mfma_f32_16x16x32_bf16 v[136:139], v[52:55], v[72:75], v[136:139]
    ds_read_b64_tr_b16 v[48:49], v3 offset:61440
    v_mfma_f32_16x16x32_bf16 v[140:143], v[52:55], v[76:79], v[140:143]
    ds_read_b64_tr_b16 v[50:51], v3 offset:62464
    s_waitcnt lgkmcnt(10)
    v_mfma_f32_16x16x32_bf16 v[144:147], v[56:59], v[72:75], v[144:147]
    ds_read_b64_tr_b16 v[52:53], v4 offset:61440
    buffer_load_dwordx4 v[116:119], v2, s[4:7], s42 offen offset:2304 sc1
    v_mfma_f32_16x16x32_bf16 v[148:151], v[56:59], v[76:79], v[148:151]
    ds_read_b64_tr_b16 v[54:55], v4 offset:62464
    v_mfma_f32_16x16x32_bf16 v[152:155], v[60:63], v[72:75], v[152:155]
    ds_read_b64_tr_b16 v[56:57], v5 offset:61440
    v_mfma_f32_16x16x32_bf16 v[156:159], v[60:63], v[76:79], v[156:159]
    ds_read_b64_tr_b16 v[58:59], v5 offset:62464
    s_waitcnt vmcnt(8) lgkmcnt(10)
    v_mfma_f32_16x16x32_bf16 v[128:131], v[32:35], v[80:83], v[128:131]
    ds_read_b64_tr_b16 v[60:61], v6 offset:61440
    s_xor_b32 s42, s41, 12288
    buffer_load_dwordx4 v[120:123], v2, s[4:7], s42 offen offset:2048 sc1
    v_mfma_f32_16x16x32_bf16 v[132:135], v[32:35], v[84:87], v[132:135]
    ds_read_b64_tr_b16 v[62:63], v6 offset:62464
    v_xor_b32 v3, 0x10000, v3
    v_xor_b32 v4, 0x10000, v4
    v_xor_b32 v5, 0x10000, v5
    v_xor_b32 v6, 0x10000, v6
    v_mfma_f32_16x16x32_bf16 v[136:139], v[36:39], v[80:83], v[136:139]
    ds_read_b64_tr_b16 v[32:33], v3 offset:0
    v_mfma_f32_16x16x32_bf16 v[140:143], v[36:39], v[84:87], v[140:143]
    ds_read_b64_tr_b16 v[34:35], v3 offset:1024
    s_waitcnt lgkmcnt(10)
    v_mfma_f32_16x16x32_bf16 v[144:147], v[40:43], v[80:83], v[144:147]
    ds_read_b64_tr_b16 v[36:37], v4 offset:0
    buffer_load_dwordx4 v[124:127], v2, s[4:7], s42 offen offset:2304 sc1
    v_mfma_f32_16x16x32_bf16 v[148:151], v[40:43], v[84:87], v[148:151]
    ds_read_b64_tr_b16 v[38:39], v4 offset:1024
    v_mfma_f32_16x16x32_bf16 v[152:155], v[44:47], v[80:83], v[152:155]
    ds_read_b64_tr_b16 v[40:41], v5 offset:0
    v_mfma_f32_16x16x32_bf16 v[156:159], v[44:47], v[84:87], v[156:159]
    ds_read_b64_tr_b16 v[42:43], v5 offset:1024
    s_waitcnt vmcnt(8) lgkmcnt(10)
    v_mfma_f32_16x16x32_bf16 v[128:131], v[48:51], v[88:91], v[128:131]
    ds_read_b64_tr_b16 v[44:45], v6 offset:0
    s_xor_b32 s42, s41, 16384
    buffer_load_dwordx4 v[160:163], v2, s[4:7], s42 offen offset:2048 sc1
    v_mfma_f32_16x16x32_bf16 v[132:135], v[48:51], v[92:95], v[132:135]
    ds_read_b64_tr_b16 v[46:47], v6 offset:1024
    v_mfma_f32_16x16x32_bf16 v[136:139], v[52:55], v[88:91], v[136:139]
    ds_read_b64_tr_b16 v[48:49], v3 offset:4096
    v_mfma_f32_16x16x32_bf16 v[140:143], v[52:55], v[92:95], v[140:143]
    ds_read_b64_tr_b16 v[50:51], v3 offset:5120
    s_waitcnt lgkmcnt(10)
    v_mfma_f32_16x16x32_bf16 v[144:147], v[56:59], v[88:91], v[144:147]
    ds_read_b64_tr_b16 v[52:53], v4 offset:4096
    buffer_load_dwordx4 v[164:167], v2, s[4:7], s42 offen offset:2304 sc1
    v_mfma_f32_16x16x32_bf16 v[148:151], v[56:59], v[92:95], v[148:151]
    ds_read_b64_tr_b16 v[54:55], v4 offset:5120
    v_mfma_f32_16x16x32_bf16 v[152:155], v[60:63], v[88:91], v[152:155]
    ds_read_b64_tr_b16 v[56:57], v5 offset:4096
    v_mfma_f32_16x16x32_bf16 v[156:159], v[60:63], v[92:95], v[156:159]
    ds_read_b64_tr_b16 v[58:59], v5 offset:5120
    s_waitcnt vmcnt(8) lgkmcnt(10)
    v_mfma_f32_16x16x32_bf16 v[128:131], v[32:35], v[96:99], v[128:131]
    ds_read_b64_tr_b16 v[60:61], v6 offset:4096
    s_xor_b32 s42, s41, 20480
    buffer_load_dwordx4 v[168:171], v2, s[4:7], s42 offen offset:2048 sc1
    v_mfma_f32_16x16x32_bf16 v[132:135], v[32:35], v[100:103], v[132:135]
    ds_read_b64_tr_b16 v[62:63], v6 offset:5120
    v_mfma_f32_16x16x32_bf16 v[136:139], v[36:39], v[96:99], v[136:139]
    ds_read_b64_tr_b16 v[32:33], v3 offset:8192
    v_mfma_f32_16x16x32_bf16 v[140:143], v[36:39], v[100:103], v[140:143]
    ds_read_b64_tr_b16 v[34:35], v3 offset:9216
    s_waitcnt lgkmcnt(10)
    v_mfma_f32_16x16x32_bf16 v[144:147], v[40:43], v[96:99], v[144:147]
    ds_read_b64_tr_b16 v[36:37], v4 offset:8192
    buffer_load_dwordx4 v[172:175], v2, s[4:7], s42 offen offset:2304 sc1
    v_mfma_f32_16x16x32_bf16 v[148:151], v[40:43], v[100:103], v[148:151]
    ds_read_b64_tr_b16 v[38:39], v4 offset:9216
    v_mfma_f32_16x16x32_bf16 v[152:155], v[44:47], v[96:99], v[152:155]
    ds_read_b64_tr_b16 v[40:41], v5 offset:8192
    v_mfma_f32_16x16x32_bf16 v[156:159], v[44:47], v[100:103], v[156:159]
    ds_read_b64_tr_b16 v[42:43], v5 offset:9216
    s_waitcnt vmcnt(8) lgkmcnt(10)
    v_mfma_f32_16x16x32_bf16 v[128:131], v[48:51], v[104:107], v[128:131]
    ds_read_b64_tr_b16 v[44:45], v6 offset:8192
    s_xor_b32 s42, s41, 24576
    buffer_load_dwordx4 v[176:179], v2, s[4:7], s42 offen offset:2048 sc1
    v_mfma_f32_16x16x32_bf16 v[132:135], v[48:51], v[108:111], v[132:135]
    ds_read_b64_tr_b16 v[46:47], v6 offset:9216
    v_mfma_f32_16x16x32_bf16 v[136:139], v[52:55], v[104:107], v[136:139]
    ds_read_b64_tr_b16 v[48:49], v3 offset:12288
    v_mfma_f32_16x16x32_bf16 v[140:143], v[52:55], v[108:111], v[140:143]
    ds_read_b64_tr_b16 v[50:51], v3 offset:13312
    s_waitcnt lgkmcnt(10)
    v_mfma_f32_16x16x32_bf16 v[144:147], v[56:59], v[104:107], v[144:147]
    ds_read_b64_tr_b16 v[52:53], v4 offset:12288
    buffer_load_dwordx4 v[180:183], v2, s[4:7], s42 offen offset:2304 sc1
    v_mfma_f32_16x16x32_bf16 v[148:151], v[56:59], v[108:111], v[148:151]
    ds_read_b64_tr_b16 v[54:55], v4 offset:13312
    v_mfma_f32_16x16x32_bf16 v[152:155], v[60:63], v[104:107], v[152:155]
    ds_read_b64_tr_b16 v[56:57], v5 offset:12288
    v_mfma_f32_16x16x32_bf16 v[156:159], v[60:63], v[108:111], v[156:159]
    ds_read_b64_tr_b16 v[58:59], v5 offset:13312
    s_waitcnt vmcnt(8) lgkmcnt(10)
    v_mfma_f32_16x16x32_bf16 v[128:131], v[32:35], v[112:115], v[128:131]
    ds_read_b64_tr_b16 v[60:61], v6 offset:12288
    s_xor_b32 s42, s41, 28672
    buffer_load_dwordx4 v[184:187], v2, s[4:7], s42 offen offset:2048 sc1
    v_mfma_f32_16x16x32_bf16 v[132:135], v[32:35], v[116:119], v[132:135]
    ds_read_b64_tr_b16 v[62:63], v6 offset:13312
    v_mfma_f32_16x16x32_bf16 v[136:139], v[36:39], v[112:115], v[136:139]
    ds_read_b64_tr_b16 v[32:33], v3 offset:16384
    v_mfma_f32_16x16x32_bf16 v[140:143], v[36:39], v[116:119], v[140:143]
    ds_read_b64_tr_b16 v[34:35], v3 offset:17408
    s_waitcnt lgkmcnt(10)
    v_mfma_f32_16x16x32_bf16 v[144:147], v[40:43], v[112:115], v[144:147]
    ds_read_b64_tr_b16 v[36:37], v4 offset:16384
    buffer_load_dwordx4 v[188:191], v2, s[4:7], s42 offen offset:2304 sc1
    v_mfma_f32_16x16x32_bf16 v[148:151], v[40:43], v[116:119], v[148:151]
    ds_read_b64_tr_b16 v[38:39], v4 offset:17408
    v_mfma_f32_16x16x32_bf16 v[152:155], v[44:47], v[112:115], v[152:155]
    ds_read_b64_tr_b16 v[40:41], v5 offset:16384
    v_mfma_f32_16x16x32_bf16 v[156:159], v[44:47], v[116:119], v[156:159]
    ds_read_b64_tr_b16 v[42:43], v5 offset:17408
    s_waitcnt vmcnt(8) lgkmcnt(10)
    v_mfma_f32_16x16x32_bf16 v[128:131], v[48:51], v[120:123], v[128:131]
    ds_read_b64_tr_b16 v[44:45], v6 offset:16384
    s_xor_b32 s42, s41, 32768
    buffer_load_dwordx4 v[64:67], v2, s[4:7], s42 offen offset:2048 sc1
    v_mfma_f32_16x16x32_bf16 v[132:135], v[48:51], v[124:127], v[132:135]
    ds_read_b64_tr_b16 v[46:47], v6 offset:17408
    v_mfma_f32_16x16x32_bf16 v[136:139], v[52:55], v[120:123], v[136:139]
    ds_read_b64_tr_b16 v[48:49], v3 offset:20480
    v_mfma_f32_16x16x32_bf16 v[140:143], v[52:55], v[124:127], v[140:143]
    ds_read_b64_tr_b16 v[50:51], v3 offset:21504
    s_waitcnt lgkmcnt(10)
    v_mfma_f32_16x16x32_bf16 v[144:147], v[56:59], v[120:123], v[144:147]
    ds_read_b64_tr_b16 v[52:53], v4 offset:20480
    buffer_load_dwordx4 v[68:71], v2, s[4:7], s42 offen offset:2304 sc1
    v_mfma_f32_16x16x32_bf16 v[148:151], v[56:59], v[124:127], v[148:151]
    ds_read_b64_tr_b16 v[54:55], v4 offset:21504
    v_mfma_f32_16x16x32_bf16 v[152:155], v[60:63], v[120:123], v[152:155]
    ds_read_b64_tr_b16 v[56:57], v5 offset:20480
    v_mfma_f32_16x16x32_bf16 v[156:159], v[60:63], v[124:127], v[156:159]
    ds_read_b64_tr_b16 v[58:59], v5 offset:21504
    s_waitcnt vmcnt(8) lgkmcnt(10)
    v_mfma_f32_16x16x32_bf16 v[128:131], v[32:35], v[160:163], v[128:131]
    ds_read_b64_tr_b16 v[60:61], v6 offset:20480
    s_xor_b32 s42, s41, 36864
    buffer_load_dwordx4 v[72:75], v2, s[4:7], s42 offen offset:2048 sc1
    v_mfma_f32_16x16x32_bf16 v[132:135], v[32:35], v[164:167], v[132:135]
    ds_read_b64_tr_b16 v[62:63], v6 offset:21504
    v_mfma_f32_16x16x32_bf16 v[136:139], v[36:39], v[160:163], v[136:139]
    ds_read_b64_tr_b16 v[32:33], v3 offset:24576
    v_mfma_f32_16x16x32_bf16 v[140:143], v[36:39], v[164:167], v[140:143]
    ds_read_b64_tr_b16 v[34:35], v3 offset:25600
    s_waitcnt lgkmcnt(10)
    v_mfma_f32_16x16x32_bf16 v[144:147], v[40:43], v[160:163], v[144:147]
    ds_read_b64_tr_b16 v[36:37], v4 offset:24576
    buffer_load_dwordx4 v[76:79], v2, s[4:7], s42 offen offset:2304 sc1
    v_mfma_f32_16x16x32_bf16 v[148:151], v[40:43], v[164:167], v[148:151]
    ds_read_b64_tr_b16 v[38:39], v4 offset:25600
    v_mfma_f32_16x16x32_bf16 v[152:155], v[44:47], v[160:163], v[152:155]
    ds_read_b64_tr_b16 v[40:41], v5 offset:24576
    v_mfma_f32_16x16x32_bf16 v[156:159], v[44:47], v[164:167], v[156:159]
    ds_read_b64_tr_b16 v[42:43], v5 offset:25600
    s_waitcnt vmcnt(8) lgkmcnt(10)
    v_mfma_f32_16x16x32_bf16 v[128:131], v[48:51], v[168:171], v[128:131]
    ds_read_b64_tr_b16 v[44:45], v6 offset:24576
    s_xor_b32 s42, s41, 40960
    buffer_load_dwordx4 v[80:83], v2, s[4:7], s42 offen offset:2048 sc1
    v_mfma_f32_16x16x32_bf16 v[132:135], v[48:51], v[172:175], v[132:135]
    ds_read_b64_tr_b16 v[46:47], v6 offset:25600
    v_mfma_f32_16x16x32_bf16 v[136:139], v[52:55], v[168:171], v[136:139]
    ds_read_b64_tr_b16 v[48:49], v3 offset:28672
    v_mfma_f32_16x16x32_bf16 v[140:143], v[52:55], v[172:175], v[140:143]
    ds_read_b64_tr_b16 v[50:51], v3 offset:29696
    s_waitcnt lgkmcnt(10)
    v_mfma_f32_16x16x32_bf16 v[144:147], v[56:59], v[168:171], v[144:147]
    ds_read_b64_tr_b16 v[52:53], v4 offset:28672
    buffer_load_dwordx4 v[84:87], v2, s[4:7], s42 offen offset:2304 sc1
    v_mfma_f32_16x16x32_bf16 v[148:151], v[56:59], v[172:175], v[148:151]
    ds_read_b64_tr_b16 v[54:55], v4 offset:29696
    v_mfma_f32_16x16x32_bf16 v[152:155], v[60:63], v[168:171], v[152:155]
    ds_read_b64_tr_b16 v[56:57], v5 offset:28672
    v_mfma_f32_16x16x32_bf16 v[156:159], v[60:63], v[172:175], v[156:159]
    ds_read_b64_tr_b16 v[58:59], v5 offset:29696
    s_waitcnt vmcnt(8) lgkmcnt(10)
    v_mfma_f32_16x16x32_bf16 v[128:131], v[32:35], v[176:179], v[128:131]
    ds_read_b64_tr_b16 v[60:61], v6 offset:28672
    s_xor_b32 s42, s41, 45056
    buffer_load_dwordx4 v[88:91], v2, s[4:7], s42 offen offset:2048 sc1
    v_mfma_f32_16x16x32_bf16 v[132:135], v[32:35], v[180:183], v[132:135]
    ds_read_b64_tr_b16 v[62:63], v6 offset:29696
    v_mfma_f32_16x16x32_bf16 v[136:139], v[36:39], v[176:179], v[136:139]
    ds_read_b64_tr_b16 v[32:33], v3 offset:32768
    v_mfma_f32_16x16x32_bf16 v[140:143], v[36:39], v[180:183], v[140:143]
    ds_read_b64_tr_b16 v[34:35], v3 offset:33792
    s_waitcnt lgkmcnt(10)
    v_mfma_f32_16x16x32_bf16 v[144:147], v[40:43], v[176:179], v[144:147]
    ds_read_b64_tr_b16 v[36:37], v4 offset:32768
    buffer_load_dwordx4 v[92:95], v2, s[4:7], s42 offen offset:2304 sc1
    v_mfma_f32_16x16x32_bf16 v[148:151], v[40:43], v[180:183], v[148:151]
    ds_read_b64_tr_b16 v[38:39], v4 offset:33792
    v_mfma_f32_16x16x32_bf16 v[152:155], v[44:47], v[176:179], v[152:155]
    ds_read_b64_tr_b16 v[40:41], v5 offset:32768
    v_mfma_f32_16x16x32_bf16 v[156:159], v[44:47], v[180:183], v[156:159]
    ds_read_b64_tr_b16 v[42:43], v5 offset:33792
    s_waitcnt vmcnt(8) lgkmcnt(10)
    v_mfma_f32_16x16x32_bf16 v[128:131], v[48:51], v[184:187], v[128:131]
    ds_read_b64_tr_b16 v[44:45], v6 offset:32768
    s_xor_b32 s42, s41, 49152
    buffer_load_dwordx4 v[96:99], v2, s[4:7], s42 offen offset:2048 sc1
    v_mfma_f32_16x16x32_bf16 v[132:135], v[48:51], v[188:191], v[132:135]
    ds_read_b64_tr_b16 v[46:47], v6 offset:33792
    v_mfma_f32_16x16x32_bf16 v[136:139], v[52:55], v[184:187], v[136:139]
    ds_read_b64_tr_b16 v[48:49], v3 offset:36864
    v_mfma_f32_16x16x32_bf16 v[140:143], v[52:55], v[188:191], v[140:143]
    ds_read_b64_tr_b16 v[50:51], v3 offset:37888
    s_waitcnt lgkmcnt(10)
    v_mfma_f32_16x16x32_bf16 v[144:147], v[56:59], v[184:187], v[144:147]
    ds_read_b64_tr_b16 v[52:53], v4 offset:36864
    buffer_load_dwordx4 v[100:103], v2, s[4:7], s42 offen offset:2304 sc1
    v_mfma_f32_16x16x32_bf16 v[148:151], v[56:59], v[188:191], v[148:151]
    ds_read_b64_tr_b16 v[54:55], v4 offset:37888
    v_mfma_f32_16x16x32_bf16 v[152:155], v[60:63], v[184:187], v[152:155]
    ds_read_b64_tr_b16 v[56:57], v5 offset:36864
    v_mfma_f32_16x16x32_bf16 v[156:159], v[60:63], v[188:191], v[156:159]
    ds_read_b64_tr_b16 v[58:59], v5 offset:37888
    s_waitcnt vmcnt(8) lgkmcnt(10)
    v_mfma_f32_16x16x32_bf16 v[128:131], v[32:35], v[64:67], v[128:131]
    ds_read_b64_tr_b16 v[60:61], v6 offset:36864
    s_xor_b32 s42, s41, 53248
    buffer_load_dwordx4 v[104:107], v2, s[4:7], s42 offen offset:2048 sc1
    v_mfma_f32_16x16x32_bf16 v[132:135], v[32:35], v[68:71], v[132:135]
    ds_read_b64_tr_b16 v[62:63], v6 offset:37888
    v_mfma_f32_16x16x32_bf16 v[136:139], v[36:39], v[64:67], v[136:139]
    ds_read_b64_tr_b16 v[32:33], v3 offset:40960
    v_mfma_f32_16x16x32_bf16 v[140:143], v[36:39], v[68:71], v[140:143]
    ds_read_b64_tr_b16 v[34:35], v3 offset:41984
    s_waitcnt lgkmcnt(10)
    v_mfma_f32_16x16x32_bf16 v[144:147], v[40:43], v[64:67], v[144:147]
    ds_read_b64_tr_b16 v[36:37], v4 offset:40960
    buffer_load_dwordx4 v[108:111], v2, s[4:7], s42 offen offset:2304 sc1
    v_mfma_f32_16x16x32_bf16 v[148:151], v[40:43], v[68:71], v[148:151]
    ds_read_b64_tr_b16 v[38:39], v4 offset:41984
    v_mfma_f32_16x16x32_bf16 v[152:155], v[44:47], v[64:67], v[152:155]
    ds_read_b64_tr_b16 v[40:41], v5 offset:40960
    v_mfma_f32_16x16x32_bf16 v[156:159], v[44:47], v[68:71], v[156:159]
    ds_read_b64_tr_b16 v[42:43], v5 offset:41984
    s_waitcnt vmcnt(8) lgkmcnt(10)
    v_mfma_f32_16x16x32_bf16 v[128:131], v[48:51], v[72:75], v[128:131]
    ds_read_b64_tr_b16 v[44:45], v6 offset:40960
    s_xor_b32 s42, s41, 57344
    buffer_load_dwordx4 v[112:115], v2, s[4:7], s42 offen offset:2048 sc1
    v_mfma_f32_16x16x32_bf16 v[132:135], v[48:51], v[76:79], v[132:135]
    ds_read_b64_tr_b16 v[46:47], v6 offset:41984
    v_mfma_f32_16x16x32_bf16 v[136:139], v[52:55], v[72:75], v[136:139]
    ds_read_b64_tr_b16 v[48:49], v3 offset:45056
    v_mfma_f32_16x16x32_bf16 v[140:143], v[52:55], v[76:79], v[140:143]
    ds_read_b64_tr_b16 v[50:51], v3 offset:46080
    s_waitcnt lgkmcnt(10)
    v_mfma_f32_16x16x32_bf16 v[144:147], v[56:59], v[72:75], v[144:147]
    ds_read_b64_tr_b16 v[52:53], v4 offset:45056
    buffer_load_dwordx4 v[116:119], v2, s[4:7], s42 offen offset:2304 sc1
    v_mfma_f32_16x16x32_bf16 v[148:151], v[56:59], v[76:79], v[148:151]
    ds_read_b64_tr_b16 v[54:55], v4 offset:46080
    v_mfma_f32_16x16x32_bf16 v[152:155], v[60:63], v[72:75], v[152:155]
    ds_read_b64_tr_b16 v[56:57], v5 offset:45056
    v_mfma_f32_16x16x32_bf16 v[156:159], v[60:63], v[76:79], v[156:159]
    ds_read_b64_tr_b16 v[58:59], v5 offset:46080
    s_waitcnt vmcnt(8) lgkmcnt(10)
    v_mfma_f32_16x16x32_bf16 v[128:131], v[32:35], v[80:83], v[128:131]
    ds_read_b64_tr_b16 v[60:61], v6 offset:45056
    s_xor_b32 s42, s41, 61440
    buffer_load_dwordx4 v[120:123], v2, s[4:7], s42 offen offset:2048 sc1
    v_mfma_f32_16x16x32_bf16 v[132:135], v[32:35], v[84:87], v[132:135]
    ds_read_b64_tr_b16 v[62:63], v6 offset:46080
    v_mfma_f32_16x16x32_bf16 v[136:139], v[36:39], v[80:83], v[136:139]
    ds_read_b64_tr_b16 v[32:33], v3 offset:49152
    v_mfma_f32_16x16x32_bf16 v[140:143], v[36:39], v[84:87], v[140:143]
    ds_read_b64_tr_b16 v[34:35], v3 offset:50176
    s_waitcnt lgkmcnt(10)
    v_mfma_f32_16x16x32_bf16 v[144:147], v[40:43], v[80:83], v[144:147]
    ds_read_b64_tr_b16 v[36:37], v4 offset:49152
    buffer_load_dwordx4 v[124:127], v2, s[4:7], s42 offen offset:2304 sc1
    v_mfma_f32_16x16x32_bf16 v[148:151], v[40:43], v[84:87], v[148:151]
    ds_read_b64_tr_b16 v[38:39], v4 offset:50176
    v_mfma_f32_16x16x32_bf16 v[152:155], v[44:47], v[80:83], v[152:155]
    ds_read_b64_tr_b16 v[40:41], v5 offset:49152
    v_mfma_f32_16x16x32_bf16 v[156:159], v[44:47], v[84:87], v[156:159]
    ds_read_b64_tr_b16 v[42:43], v5 offset:50176
    s_waitcnt vmcnt(8) lgkmcnt(10)
    v_mfma_f32_16x16x32_bf16 v[128:131], v[48:51], v[88:91], v[128:131]
    ds_read_b64_tr_b16 v[44:45], v6 offset:49152
    v_mfma_f32_16x16x32_bf16 v[132:135], v[48:51], v[92:95], v[132:135]
    ds_read_b64_tr_b16 v[46:47], v6 offset:50176
    v_mfma_f32_16x16x32_bf16 v[136:139], v[52:55], v[88:91], v[136:139]
    ds_read_b64_tr_b16 v[48:49], v3 offset:53248
    v_mfma_f32_16x16x32_bf16 v[140:143], v[52:55], v[92:95], v[140:143]
    ds_read_b64_tr_b16 v[50:51], v3 offset:54272
    s_waitcnt lgkmcnt(10)
    v_mfma_f32_16x16x32_bf16 v[144:147], v[56:59], v[88:91], v[144:147]
    ds_read_b64_tr_b16 v[52:53], v4 offset:53248
    v_mfma_f32_16x16x32_bf16 v[148:151], v[56:59], v[92:95], v[148:151]
    ds_read_b64_tr_b16 v[54:55], v4 offset:54272
    v_mfma_f32_16x16x32_bf16 v[152:155], v[60:63], v[88:91], v[152:155]
    ds_read_b64_tr_b16 v[56:57], v5 offset:53248
    v_mfma_f32_16x16x32_bf16 v[156:159], v[60:63], v[92:95], v[156:159]
    ds_read_b64_tr_b16 v[58:59], v5 offset:54272
    s_waitcnt vmcnt(6) lgkmcnt(10)
    v_mfma_f32_16x16x32_bf16 v[128:131], v[32:35], v[96:99], v[128:131]
    ds_read_b64_tr_b16 v[60:61], v6 offset:53248
    v_mfma_f32_16x16x32_bf16 v[132:135], v[32:35], v[100:103], v[132:135]
    ds_read_b64_tr_b16 v[62:63], v6 offset:54272
    v_mfma_f32_16x16x32_bf16 v[136:139], v[36:39], v[96:99], v[136:139]
    ds_read_b64_tr_b16 v[32:33], v3 offset:57344
    v_mfma_f32_16x16x32_bf16 v[140:143], v[36:39], v[100:103], v[140:143]
    ds_read_b64_tr_b16 v[34:35], v3 offset:58368
    s_waitcnt lgkmcnt(10)
    v_mfma_f32_16x16x32_bf16 v[144:147], v[40:43], v[96:99], v[144:147]
    ds_read_b64_tr_b16 v[36:37], v4 offset:57344
    v_mfma_f32_16x16x32_bf16 v[148:151], v[40:43], v[100:103], v[148:151]
    ds_read_b64_tr_b16 v[38:39], v4 offset:58368
    v_mfma_f32_16x16x32_bf16 v[152:155], v[44:47], v[96:99], v[152:155]
    ds_read_b64_tr_b16 v[40:41], v5 offset:57344
    v_mfma_f32_16x16x32_bf16 v[156:159], v[44:47], v[100:103], v[156:159]
    ds_read_b64_tr_b16 v[42:43], v5 offset:58368
    s_waitcnt vmcnt(4) lgkmcnt(10)
    v_mfma_f32_16x16x32_bf16 v[128:131], v[48:51], v[104:107], v[128:131]
    ds_read_b64_tr_b16 v[44:45], v6 offset:57344
    v_mfma_f32_16x16x32_bf16 v[132:135], v[48:51], v[108:111], v[132:135]
    ds_read_b64_tr_b16 v[46:47], v6 offset:58368
    v_mfma_f32_16x16x32_bf16 v[136:139], v[52:55], v[104:107], v[136:139]
    ds_read_b64_tr_b16 v[48:49], v3 offset:61440
    v_mfma_f32_16x16x32_bf16 v[140:143], v[52:55], v[108:111], v[140:143]
    ds_read_b64_tr_b16 v[50:51], v3 offset:62464
    s_waitcnt lgkmcnt(10)
    v_mfma_f32_16x16x32_bf16 v[144:147], v[56:59], v[104:107], v[144:147]
    ds_read_b64_tr_b16 v[52:53], v4 offset:61440
    v_mfma_f32_16x16x32_bf16 v[148:151], v[56:59], v[108:111], v[148:151]
    ds_read_b64_tr_b16 v[54:55], v4 offset:62464
    v_mfma_f32_16x16x32_bf16 v[152:155], v[60:63], v[104:107], v[152:155]
    ds_read_b64_tr_b16 v[56:57], v5 offset:61440
    v_mfma_f32_16x16x32_bf16 v[156:159], v[60:63], v[108:111], v[156:159]
    ds_read_b64_tr_b16 v[58:59], v5 offset:62464
    s_waitcnt vmcnt(2) lgkmcnt(10)
    v_mfma_f32_16x16x32_bf16 v[128:131], v[32:35], v[112:115], v[128:131]
    ds_read_b64_tr_b16 v[60:61], v6 offset:61440
    v_mfma_f32_16x16x32_bf16 v[132:135], v[32:35], v[116:119], v[132:135]
    ds_read_b64_tr_b16 v[62:63], v6 offset:62464
    v_xor_b32 v3, 0x10000, v3
    v_xor_b32 v4, 0x10000, v4
    v_xor_b32 v5, 0x10000, v5
    v_xor_b32 v6, 0x10000, v6
    v_mfma_f32_16x16x32_bf16 v[136:139], v[36:39], v[112:115], v[136:139]
    v_mfma_f32_16x16x32_bf16 v[140:143], v[36:39], v[116:119], v[140:143]
    s_waitcnt lgkmcnt(8)
    v_mfma_f32_16x16x32_bf16 v[144:147], v[40:43], v[112:115], v[144:147]
    v_mfma_f32_16x16x32_bf16 v[148:151], v[40:43], v[116:119], v[148:151]
    v_mfma_f32_16x16x32_bf16 v[152:155], v[44:47], v[112:115], v[152:155]
    v_mfma_f32_16x16x32_bf16 v[156:159], v[44:47], v[116:119], v[156:159]
    s_waitcnt vmcnt(0) lgkmcnt(4)
    v_mfma_f32_16x16x32_bf16 v[128:131], v[48:51], v[120:123], v[128:131]
    v_mfma_f32_16x16x32_bf16 v[132:135], v[48:51], v[124:127], v[132:135]
    v_mfma_f32_16x16x32_bf16 v[136:139], v[52:55], v[120:123], v[136:139]
    v_mfma_f32_16x16x32_bf16 v[140:143], v[52:55], v[124:127], v[140:143]
    s_waitcnt lgkmcnt(0)
    v_mfma_f32_16x16x32_bf16 v[144:147], v[56:59], v[120:123], v[144:147]
    v_mfma_f32_16x16x32_bf16 v[148:151], v[56:59], v[124:127], v[148:151]
    v_mfma_f32_16x16x32_bf16 v[152:155], v[60:63], v[120:123], v[152:155]
    v_mfma_f32_16x16x32_bf16 v[156:159], v[60:63], v[124:127], v[156:159]
    s_cmp_eq_u32 s21, 3
    s_cbranch_scc1 c_final
    s_add_u32 s43, s43, 4194304
    v_cvt_pk_bf16_f32 v160, v128, v129
    v_cvt_pk_bf16_f32 v161, v130, v131
    v_cvt_pk_bf16_f32 v162, v136, v137
    v_cvt_pk_bf16_f32 v163, v138, v139
    v_cvt_pk_bf16_f32 v168, v144, v145
    v_cvt_pk_bf16_f32 v169, v146, v147
    v_cvt_pk_bf16_f32 v170, v152, v153
    v_cvt_pk_bf16_f32 v171, v154, v155
    v_permlane32_swap_b32 v160, v162
    v_permlane32_swap_b32 v161, v163
    buffer_store_dwordx4 v[160:163], v2, s[4:7], s43 offen offset:0 sc1
    v_permlane32_swap_b32 v168, v170
    v_permlane32_swap_b32 v169, v171
    buffer_store_dwordx4 v[168:171], v2, s[4:7], s43 offen offset:2048 sc1
    v_cvt_pk_bf16_f32 v164, v132, v133
    v_cvt_pk_bf16_f32 v165, v134, v135
    v_cvt_pk_bf16_f32 v166, v140, v141
    v_cvt_pk_bf16_f32 v167, v142, v143
    v_cvt_pk_bf16_f32 v172, v148, v149
    v_cvt_pk_bf16_f32 v173, v150, v151
    v_cvt_pk_bf16_f32 v174, v156, v157
    v_cvt_pk_bf16_f32 v175, v158, v159
    v_permlane32_swap_b32 v164, v166
    v_permlane32_swap_b32 v165, v167
    buffer_store_dwordx4 v[164:167], v2, s[4:7], s43 offen offset:256 sc1
    v_permlane32_swap_b32 v172, v174
    v_permlane32_swap_b32 v173, v175
    buffer_store_dwordx4 v[172:175], v2, s[4:7], s43 offen offset:2304 sc1
    s_barrier
    v_mov_b32 v12, 0x3f803f80
    v_mov_b32 v14, 0
    v_mov_b32 v15, 0
    v_mov_b32 v16, 0
    v_mov_b32 v17, 0
    v_dot2_f32_bf16 v14, v160, v12, v14
    v_dot2_f32_bf16 v15, v160, v160, v15
    v_dot2_f32_bf16 v16, v164, v12, v16
    v_dot2_f32_bf16 v17, v164, v164, v17
    v_dot2_f32_bf16 v14, v161, v12, v14
    v_dot2_f32_bf16 v15, v161, v161, v15
    v_dot2_f32_bf16 v16, v165, v12, v16
    v_dot2_f32_bf16 v17, v165, v165, v17
    v_dot2_f32_bf16 v14, v162, v12, v14
    v_dot2_f32_bf16 v15, v162, v162, v15
    v_dot2_f32_bf16 v16, v166, v12, v16
    v_dot2_f32_bf16 v17, v166, v166, v17
    v_dot2_f32_bf16 v14, v163, v12, v14
    v_dot2_f32_bf16 v15, v163, v163, v15
    v_dot2_f32_bf16 v16, v167, v12, v16
    v_dot2_f32_bf16 v17, v167, v167, v17
    v_dot2_f32_bf16 v14, v168, v12, v14
    v_dot2_f32_bf16 v15, v168, v168, v15
    v_dot2_f32_bf16 v16, v172, v12, v16
    v_dot2_f32_bf16 v17, v172, v172, v17
    v_dot2_f32_bf16 v14, v169, v12, v14
    v_dot2_f32_bf16 v15, v169, v169, v15
    v_dot2_f32_bf16 v16, v173, v12, v16
    v_dot2_f32_bf16 v17, v173, v173, v17
    v_dot2_f32_bf16 v14, v170, v12, v14
    v_dot2_f32_bf16 v15, v170, v170, v15
    v_dot2_f32_bf16 v16, v174, v12, v16
    v_dot2_f32_bf16 v17, v174, v174, v17
    v_dot2_f32_bf16 v14, v171, v12, v14
    v_dot2_f32_bf16 v15, v171, v171, v15
    v_dot2_f32_bf16 v16, v175, v12, v16
    v_dot2_f32_bf16 v17, v175, v175, v17
    s_nop 2
    v_permlane16_swap_b32 v14, v16
    v_permlane16_swap_b32 v15, v17
    v_pk_add_f32 v[14:15], v[14:15], v[16:17]
    v_mov_b32 v16, v14
    v_mov_b32 v17, v15
    s_nop 0
    v_permlane32_swap_b32 v14, v16
    v_permlane32_swap_b32 v15, v17
    v_pk_add_f32 v[14:15], v[14:15], v[16:17]
    v_lshrrev_b32 v13, 1, v1
    v_and_b32 v13, 0xf8, v13
    s_add_u32 s21, s21, 1
    s_lshl_b32 s44, s21, 18
    s_lshl_b32 s45, s39, 12
    s_add_u32 s44, s44, s45
    s_lshl_b32 s45, s20, 8
    s_add_u32 s44, s44, s45
    s_add_u32 s44, s44, 50331648
    buffer_store_dwordx2 v[14:15], v13, s[4:7], s44 offen sc1
    s_lshl_b32 s46, s21, 14
    s_lshl_b32 s67, s39, 7
    s_add_u32 s46, s46, s67
    s_add_u32 s46, s46, 4096
    s_add_u32 s47, s46, 8192
    s_waitcnt vmcnt(1)
    s_atomic_add s40, s[22:23], s46
    s_branch c_layer
c_final:
    s_mov_b32 s8, s32
    s_mov_b32 s9, s33
    s_mov_b32 s10, 4194304
    s_mov_b32 s11, 0x00020000
    v_lshrrev_b32 v12, 4, v1
    s_mul_i32 s44, s16, 4608
    s_add_u32 s44, s44, 131072
    v_and_b32 v13, 15, v12
    v_mul_u32_u24 v13, 144, v13
    v_lshrrev_b32 v14, 4, v12
    v_lshl_add_u32 v13, v14, 3, v13
    v_add_u32 v13, s44, v13
    v_cvt_pk_bf16_f32 v128, v128, v129
    v_cvt_pk_bf16_f32 v129, v130, v131
    ds_write_b64 v13, v[128:129] offset:0
    v_cvt_pk_bf16_f32 v136, v136, v137
    v_cvt_pk_bf16_f32 v137, v138, v139
    ds_write_b64 v13, v[136:137] offset:32
    v_cvt_pk_bf16_f32 v144, v144, v145
    v_cvt_pk_bf16_f32 v145, v146, v147
    ds_write_b64 v13, v[144:145] offset:64
    v_cvt_pk_bf16_f32 v152, v152, v153
    v_cvt_pk_bf16_f32 v153, v154, v155
    ds_write_b64 v13, v[152:153] offset:96
    v_cvt_pk_bf16_f32 v132, v132, v133
    v_cvt_pk_bf16_f32 v133, v134, v135
    ds_write_b64 v13, v[132:133] offset:2304
    v_cvt_pk_bf16_f32 v140, v140, v141
    v_cvt_pk_bf16_f32 v141, v142, v143
    ds_write_b64 v13, v[140:141] offset:2336
    v_cvt_pk_bf16_f32 v148, v148, v149
    v_cvt_pk_bf16_f32 v149, v150, v151
    ds_write_b64 v13, v[148:149] offset:2368
    v_cvt_pk_bf16_f32 v156, v156, v157
    v_cvt_pk_bf16_f32 v157, v158, v159
    ds_write_b64 v13, v[156:157] offset:2400
    v_lshrrev_b32 v14, 3, v12
    v_and_b32 v15, 7, v12
    v_mul_u32_u24 v16, 144, v14
    v_lshl_add_u32 v16, v15, 4, v16
    v_add_u32 v16, s44, v16
    v_lshlrev_b32 v17, 11, v14
    v_lshl_add_u32 v17, v15, 4, v17
    ds_read_b128 v[32:35], v16 offset:0
    ds_read_b128 v[36:39], v16 offset:1152
    ds_read_b128 v[40:43], v16 offset:2304
    ds_read_b128 v[44:47], v16 offset:3456
    s_lshl_b32 s44, s39, 16
    s_lshl_b32 s45, s20, 7
    s_add_u32 s44, s44, s45
    s_waitcnt lgkmcnt(3)
    buffer_store_dwordx4 v[32:35], v17, s[8:11], s44 offen sc1
    s_add_u32 s44, s44, 16384
    s_waitcnt lgkmcnt(2)
    buffer_store_dwordx4 v[36:39], v17, s[8:11], s44 offen sc1
    s_add_u32 s44, s44, 16384
    s_waitcnt lgkmcnt(1)
    buffer_store_dwordx4 v[40:43], v17, s[8:11], s44 offen sc1
    s_add_u32 s44, s44, 16384
    s_waitcnt lgkmcnt(0)
    buffer_store_dwordx4 v[44:47], v17, s[8:11], s44 offen sc1
    s_endpgm
h_start:
    v_mov_b32 v20, 0
    v_mov_b32 v21, 0
    v_mov_b32 v22, 0
    v_mov_b32 v23, 0
    s_cmp_lt_u32 s2, 6
    s_cbranch_scc0 h_z0
    s_load_dword s101, s[34:35], 192
    s_lshl_b32 s44, s2, 11
    s_cmp_ge_u32 s2, 2
    s_cselect_b32 s3, 8192, 0
    s_add_u32 s44, s44, s3
    s_mov_b32 s45, 0
    s_atomic_swap s45, s[22:23], s44 offset:0
    s_atomic_swap s45, s[22:23], s44 offset:128
    s_atomic_swap s45, s[22:23], s44 offset:256
    s_atomic_swap s45, s[22:23], s44 offset:384
    s_atomic_swap s45, s[22:23], s44 offset:512
    s_atomic_swap s45, s[22:23], s44 offset:640
    s_atomic_swap s45, s[22:23], s44 offset:768
    s_atomic_swap s45, s[22:23], s44 offset:896
    s_atomic_swap s45, s[22:23], s44 offset:1024
    s_atomic_swap s45, s[22:23], s44 offset:1152
    s_atomic_swap s45, s[22:23], s44 offset:1280
    s_atomic_swap s45, s[22:23], s44 offset:1408
    s_atomic_swap s45, s[22:23], s44 offset:1536
    s_atomic_swap s45, s[22:23], s44 offset:1664
    s_atomic_swap s45, s[22:23], s44 offset:1792
    s_atomic_swap s45, s[22:23], s44 offset:1920
    s_waitcnt lgkmcnt(0)
    s_atomic_add s40, s[34:35], 0
h_z0:
    v_lshrrev_b32 v24, 4, v1
    v_lshrrev_b32 v25, 3, v24
    v_mul_u32_u24 v12, 6144, v25
    v_and_b32 v26, 2, v25
    v_lshrrev_b32 v25, 2, v25
    v_or_b32 v26, v26, v25
    v_bfe_u32 v25, v24, 1, 2
    v_xor_b32 v26, v26, v25
    v_lshl_add_u32 v12, v26, 5, v12
    v_and_b32 v26, 1, v24
    v_lshl_add_u32 v12, v26, 4, v12
    s_lshl_b32 s3, s18, 7
    v_add_u32 v12, s3, v12
    v_add_u32 v13, 48128, v12
    v_add_u32 v14, 96256, v12
    v_add_u32 v15, 144384, v12
    v_lshrrev_b32 v24, 4, v1
    v_lshrrev_b32 v25, 3, v24
    v_mul_u32_u24 v16, 2048, v25
    v_and_b32 v26, 2, v25
    v_lshrrev_b32 v25, 2, v25
    v_or_b32 v26, v26, v25
    v_bfe_u32 v25, v24, 1, 2
    v_xor_b32 v26, v26, v25
    v_lshl_add_u32 v16, v26, 5, v16
    v_and_b32 v26, 1, v24
    v_lshl_add_u32 v16, v26, 4, v16
    s_lshl_b32 s3, s20, 7
    v_add_u32 v16, s3, v16
    v_add_u32 v17, 15360, v16
    v_add_u32 v18, 30720, v16
    v_add_u32 v19, 46080, v16
    s_mul_i32 s84, s18, 393216
    s_cmp_eq_u32 s18, 1
    s_cselect_b32 s85, 0, 393216
    s_cmp_eq_u32 s18, 2
    s_cselect_b32 s86, 0, 786432
    s_cmp_eq_u32 s18, 3
    s_cselect_b32 s87, 0, 1179648
    s_cmp_eq_u32 s18, 4
    s_cselect_b32 s88, 0, 1572864
    s_cmp_eq_u32 s18, 5
    s_cselect_b32 s89, 0, 1966080
    s_cmp_eq_u32 s18, 6
    s_cselect_b32 s90, 0, 2359296
    s_cmp_eq_u32 s18, 7
    s_cselect_b32 s91, 0, 2752512
    s_cmp_eq_u32 s18, 8
    s_cselect_b32 s92, 0, 3145728
    s_cmp_eq_u32 s18, 9
    s_cselect_b32 s93, 0, 3538944
    s_cmp_eq_u32 s18, 10
    s_cselect_b32 s94, 0, 3932160
    s_cmp_eq_u32 s18, 11
    s_cselect_b32 s95, 0, 4325376
    s_cmp_eq_u32 s18, 12
    s_cselect_b32 s96, 0, 4718592
    s_cmp_eq_u32 s18, 13
    s_cselect_b32 s97, 0, 5111808
    s_cmp_eq_u32 s18, 14
    s_cselect_b32 s98, 0, 5505024
    s_cmp_eq_u32 s18, 15
    s_cselect_b32 s99, 0, 5898240
    s_and_b32 s3, s16, 3
    s_mul_i32 s3, s3, 49152
    v_add_u32 v11, s3, v12
    s_and_b32 s3, s16, 3
    s_lshl_b32 s3, s3, 10
    v_add_u32 v9, s3, v1
    v_add_u32 v10, 0x10000, v9
    v_lshrrev_b32 v24, 4, v1
    v_and_b32 v25, 15, v24
    v_lshrrev_b32 v24, 4, v24
    v_lshlrev_b32 v24, 2, v24
    v_sub_u32 v24, v25, v24
    v_mov_b32 v25, 0xf149f2ca
    v_add_u32 v26, 0x0, v24
    v_and_b32 v26, 0xfffffff1, v26
    v_cmp_eq_u32 vcc, 0, v26
    s_nop 1
    v_cndmask_b32 v32, v25, 0, vcc
    v_add_u32 v26, 0xffffffff, v24
    v_and_b32 v26, 0xfffffff1, v26
    v_cmp_eq_u32 vcc, 0, v26
    s_nop 1
    v_cndmask_b32 v33, v25, 0, vcc
    v_add_u32 v26, 0xfffffffe, v24
    v_and_b32 v26, 0xfffffff1, v26
    v_cmp_eq_u32 vcc, 0, v26
    s_nop 1
    v_cndmask_b32 v34, v25, 0, vcc
    v_add_u32 v26, 0xfffffffd, v24
    v_and_b32 v26, 0xfffffff1, v26
    v_cmp_eq_u32 vcc, 0, v26
    s_nop 1
    v_cndmask_b32 v35, v25, 0, vcc
    v_add_u32 v26, 0x10, v24
    v_and_b32 v26, 0xfffffff1, v26
    v_cmp_eq_u32 vcc, 0, v26
    s_nop 1
    v_cndmask_b32 v36, v25, 0, vcc
    v_add_u32 v26, 0xf, v24
    v_and_b32 v26, 0xfffffff1, v26
    v_cmp_eq_u32 vcc, 0, v26
    s_nop 1
    v_cndmask_b32 v37, v25, 0, vcc
    v_add_u32 v26, 0xe, v24
    v_and_b32 v26, 0xfffffff1, v26
    v_cmp_eq_u32 vcc, 0, v26
    s_nop 1
    v_cndmask_b32 v38, v25, 0, vcc
    v_add_u32 v26, 0xd, v24
    v_and_b32 v26, 0xfffffff1, v26
    v_cmp_eq_u32 vcc, 0, v26
    s_nop 1
    v_cndmask_b32 v39, v25, 0, vcc
    v_add_u32 v24, 153600, v1
    ds_write_b128 v24, v[32:35] offset:0
    ds_write_b128 v24, v[36:39] offset:1024
    s_barrier
    s_waitcnt lgkmcnt(0)
    s_lshl_b32 s44, s21, 14
    s_lshl_b32 s67, s17, 9
    s_add_u32 s44, s44, s67
    s_add_u32 s44, s44, 12288
    s_barrier
    s_mov_b32 s66, 0x10000
h_s0_poll:
    s_mov_b32 s68, 0
    s_mov_b32 s69, 0
    s_mov_b32 s70, 0
    s_mov_b32 s71, 0
    s_atomic_add s68, s[22:23], s44 offset:0 glc
    s_atomic_add s69, s[22:23], s44 offset:128 glc
    s_atomic_add s70, s[22:23], s44 offset:256 glc
    s_atomic_add s71, s[22:23], s44 offset:384 glc
    s_sub_u32 s66, s66, 1
    s_cselect_b32 s67, 16, 0
    s_waitcnt lgkmcnt(0)
    s_and_b32 s68, s68, s69
    s_and_b32 s68, s68, s70
    s_and_b32 s68, s68, s71
    s_max_u32 s68, s68, s67
    s_cmp_lt_u32 s68, 16
    s_cbranch_scc1 h_s0_poll
h_s0_ok:
    s_barrier
    s_barrier
    s_lshr_b32 s3, s2, 3
    s_cmp_eq_u32 s3, 1
    s_cbranch_scc0 h_s_ok
    s_mul_i32 s44, s2, 24576
    s_add_u32 s44, s44, 58544128
    s_mov_b32 s45, 24
h_zloop:
    buffer_store_dwordx4 v[20:23], v1, s[4:7], s44 offen sc1
    s_add_u32 s44, s44, 1024
    s_sub_u32 s45, s45, 1
    s_cmp_lg_u32 s45, 0
    s_cbranch_scc1 h_zloop
    s_branch h_s_ok
h_layer:
    s_waitcnt lgkmcnt(0)
    s_barrier
    s_barrier
    s_lshl_b32 s44, s21, 14
    s_lshl_b32 s67, s17, 9
    s_add_u32 s44, s44, s67
    s_add_u32 s44, s44, 12288
    s_mov_b32 s66, 0x10000
h_s_poll:
    s_mov_b32 s68, 0
    s_mov_b32 s69, 0
    s_mov_b32 s70, 0
    s_mov_b32 s71, 0
    s_atomic_add s68, s[22:23], s44 offset:0 glc
    s_atomic_add s69, s[22:23], s44 offset:128 glc
    s_atomic_add s70, s[22:23], s44 offset:256 glc
    s_atomic_add s71, s[22:23], s44 offset:384 glc
    s_sub_u32 s66, s66, 1
    s_cselect_b32 s67, 16, 0
    s_waitcnt lgkmcnt(0)
    s_and_b32 s68, s68, s69
    s_and_b32 s68, s68, s70
    s_and_b32 s68, s68, s71
    s_max_u32 s68, s68, s67
    s_cmp_lt_u32 s68, 16
    s_cbranch_scc1 h_s_poll
h_s_ok:
    s_barrier
    s_lshl_b32 s44, s21, 18
    s_lshl_b32 s45, s17, 14
    s_add_u32 s44, s44, s45
    s_add_u32 s44, s44, 50331648
    buffer_load_dwordx4 v[32:35], v1, s[4:7], s44 offen offset:0 sc1
    buffer_load_dwordx4 v[36:39], v1, s[4:7], s44 offen offset:1024 sc1
    buffer_load_dwordx4 v[40:43], v1, s[4:7], s44 offen offset:2048 sc1
    buffer_load_dwordx4 v[44:47], v1, s[4:7], s44 offen offset:3072 sc1
    s_add_u32 s44, s44, 4096
    buffer_load_dwordx4 v[48:51], v1, s[4:7], s44 offen offset:0 sc1
    buffer_load_dwordx4 v[52:55], v1, s[4:7], s44 offen offset:1024 sc1
    buffer_load_dwordx4 v[56:59], v1, s[4:7], s44 offen offset:2048 sc1
    buffer_load_dwordx4 v[60:63], v1, s[4:7], s44 offen offset:3072 sc1
    s_add_u32 s44, s44, 4096
    buffer_load_dwordx4 v[64:67], v1, s[4:7], s44 offen offset:0 sc1
    buffer_load_dwordx4 v[68:71], v1, s[4:7], s44 offen offset:1024 sc1
    buffer_load_dwordx4 v[72:75], v1, s[4:7], s44 offen offset:2048 sc1
    buffer_load_dwordx4 v[76:79], v1, s[4:7], s44 offen offset:3072 sc1
    s_add_u32 s44, s44, 4096
    buffer_load_dwordx4 v[80:83], v1, s[4:7], s44 offen offset:0 sc1
    buffer_load_dwordx4 v[84:87], v1, s[4:7], s44 offen offset:1024 sc1
    buffer_load_dwordx4 v[88:91], v1, s[4:7], s44 offen offset:2048 sc1
    buffer_load_dwordx4 v[92:95], v1, s[4:7], s44 offen offset:3072 sc1
    s_barrier
    s_cmp_ge_u32 s21, 2
    s_cbranch_scc1 h_c_ok
    s_lshl_b32 s44, s21, 11
    s_lshl_b32 s67, s18, 7
    s_add_u32 s44, s44, s67
    s_add_u32 s44, s44, 0
    s_mov_b32 s66, 0x10000
h_c_poll:
    s_mov_b32 s68, 0
    s_atomic_add s68, s[22:23], s44 offset:0 glc
    s_sub_u32 s66, s66, 1
    s_cselect_b32 s67, 48, 0
    s_waitcnt lgkmcnt(0)
    s_max_u32 s68, s68, s67
    s_cmp_lt_u32 s68, 48
    s_cbranch_scc1 h_c_poll
h_c_ok:
    s_waitcnt vmcnt(0)
    s_lshl_b32 s3, s21, 8
    s_add_u32 s3, s3, s2
    s_lshr_b32 s3, s3, 3
    s_cmp_eq_u32 s3, 1
    s_cbranch_scc0 h_nf1
    s_atomic_add s40, s[34:35], 128
h_nf1:
    s_barrier
    s_cmp_ge_u32 s21, 2
    s_cbranch_scc1 h_cs1
    s_lshl_b32 s44, s21, 18
    s_lshl_b32 s45, s18, 14
    s_add_u32 s44, s44, s45
    s_add_u32 s44, s44, 52428800
    buffer_load_dwordx4 v[96:99], v1, s[4:7], s44 offen offset:0 sc1
    buffer_load_dwordx4 v[100:103], v1, s[4:7], s44 offen offset:1024 sc1
    buffer_load_dwordx4 v[104:107], v1, s[4:7], s44 offen offset:2048 sc1
    buffer_load_dwordx4 v[108:111], v1, s[4:7], s44 offen offset:3072 sc1
    s_add_u32 s44, s44, 4096
    buffer_load_dwordx4 v[112:115], v1, s[4:7], s44 offen offset:0 sc1
    buffer_load_dwordx4 v[116:119], v1, s[4:7], s44 offen offset:1024 sc1
    buffer_load_dwordx4 v[120:123], v1, s[4:7], s44 offen offset:2048 sc1
    buffer_load_dwordx4 v[124:127], v1, s[4:7], s44 offen offset:3072 sc1
    s_add_u32 s44, s44, 4096
    buffer_load_dwordx4 v[128:131], v1, s[4:7], s44 offen offset:0 sc1
    buffer_load_dwordx4 v[132:135], v1, s[4:7], s44 offen offset:1024 sc1
    buffer_load_dwordx4 v[136:139], v1, s[4:7], s44 offen offset:2048 sc1
    buffer_load_dwordx4 v[140:143], v1, s[4:7], s44 offen offset:3072 sc1
    s_add_u32 s44, s44, 4096
    buffer_load_dwordx4 v[144:147], v1, s[4:7], s44 offen offset:0 sc1
    buffer_load_dwordx4 v[148:151], v1, s[4:7], s44 offen offset:1024 sc1
    buffer_load_dwordx4 v[152:155], v1, s[4:7], s44 offen offset:2048 sc1
    buffer_load_dwordx4 v[156:159], v1, s[4:7], s44 offen offset:3072 sc1
h_cs1:
    v_add_f32 v32, v32, v36
    v_add_f32 v33, v33, v37
    v_add_f32 v34, v34, v38
    v_add_f32 v35, v35, v39
    v_add_f32 v48, v48, v52
    v_add_f32 v49, v49, v53
    v_add_f32 v50, v50, v54
    v_add_f32 v51, v51, v55
    v_add_f32 v64, v64, v68
    v_add_f32 v65, v65, v69
    v_add_f32 v66, v66, v70
    v_add_f32 v67, v67, v71
    v_add_f32 v80, v80, v84
    v_add_f32 v81, v81, v85
    v_add_f32 v82, v82, v86
    v_add_f32 v83, v83, v87
    v_add_f32 v32, v32, v40
    v_add_f32 v33, v33, v41
    v_add_f32 v34, v34, v42
    v_add_f32 v35, v35, v43
    v_add_f32 v48, v48, v56
    v_add_f32 v49, v49, v57
    v_add_f32 v50, v50, v58
    v_add_f32 v51, v51, v59
    v_add_f32 v64, v64, v72
    v_add_f32 v65, v65, v73
    v_add_f32 v66, v66, v74
    v_add_f32 v67, v67, v75
    v_add_f32 v80, v80, v88
    v_add_f32 v81, v81, v89
    v_add_f32 v82, v82, v90
    v_add_f32 v83, v83, v91
    s_barrier
    v_add_f32 v32, v32, v44
    v_add_f32 v33, v33, v45
    v_add_f32 v34, v34, v46
    v_add_f32 v35, v35, v47
    v_add_f32 v48, v48, v60
    v_add_f32 v49, v49, v61
    v_add_f32 v50, v50, v62
    v_add_f32 v51, v51, v63
    v_add_f32 v64, v64, v76
    v_add_f32 v65, v65, v77
    v_add_f32 v66, v66, v78
    v_add_f32 v67, v67, v79
    v_add_f32 v80, v80, v92
    v_add_f32 v81, v81, v93
    v_add_f32 v82, v82, v94
    v_add_f32 v83, v83, v95
    v_permlane32_swap_b32 v32, v64
    v_permlane32_swap_b32 v33, v65
    v_permlane32_swap_b32 v34, v66
    v_permlane32_swap_b32 v35, v67
    v_add_f32 v32, v32, v64
    v_add_f32 v33, v33, v65
    v_add_f32 v34, v34, v66
    v_add_f32 v35, v35, v67
    v_permlane32_swap_b32 v48, v80
    v_permlane32_swap_b32 v49, v81
    v_permlane32_swap_b32 v50, v82
    v_permlane32_swap_b32 v51, v83
    v_add_f32 v48, v48, v80
    v_add_f32 v49, v49, v81
    v_add_f32 v50, v50, v82
    v_add_f32 v51, v51, v83
    v_permlane16_swap_b32 v32, v48
    v_permlane16_swap_b32 v33, v49
    v_permlane16_swap_b32 v34, v50
    v_permlane16_swap_b32 v35, v51
    v_add_f32 v32, v32, v48
    v_add_f32 v33, v33, v49
    v_add_f32 v34, v34, v50
    v_add_f32 v35, v35, v51
    s_barrier
    v_mul_f32 v32, 0x3a800000, v32
    v_mul_f32 v33, 0x3a800000, v33
    v_mul_f32 v34, 0x3a800000, v34
    v_mul_f32 v35, 0x3a800000, v35
    v_fma_f32 v33, -v32, v32, v33
    v_fma_f32 v35, -v34, v34, v35
    v_max_f32 v33, 0, v33
    v_max_f32 v35, 0, v35
    v_add_f32 v33, 0x3727c5ac, v33
    v_add_f32 v35, 0x3727c5ac, v35
    v_rsq_f32 v33, v33
    v_rsq_f32 v35, v35
    v_lshrrev_b32 v26, 1, v1
    v_add_u32 v26, 155648, v26
    ds_write2_b32 v26, v32, v34 offset0:0 offset1:1
    ds_write2_b32 v26, v33, v35 offset0:128 offset1:129
    s_barrier
    s_cmp_ge_u32 s21, 2
    s_cbranch_scc1 h_cs_done
    s_waitcnt vmcnt(0)
    v_add_f32 v96, v96, v100
    v_add_f32 v97, v97, v101
    v_add_f32 v98, v98, v102
    v_add_f32 v99, v99, v103
    v_add_f32 v96, v96, v104
    v_add_f32 v97, v97, v105
    v_add_f32 v98, v98, v106
    v_add_f32 v99, v99, v107
    v_add_f32 v96, v96, v108
    v_add_f32 v97, v97, v109
    v_add_f32 v98, v98, v110
    v_add_f32 v99, v99, v111
    v_add_f32 v96, v96, v112
    v_add_f32 v97, v97, v113
    v_add_f32 v98, v98, v114
    v_add_f32 v99, v99, v115
    v_add_f32 v96, v96, v116
    v_add_f32 v97, v97, v117
    v_add_f32 v98, v98, v118
    v_add_f32 v99, v99, v119
    v_add_f32 v96, v96, v120
    v_add_f32 v97, v97, v121
    v_add_f32 v98, v98, v122
    v_add_f32 v99, v99, v123
    v_add_f32 v96, v96, v124
    v_add_f32 v97, v97, v125
    v_add_f32 v98, v98, v126
    v_add_f32 v99, v99, v127
    v_add_f32 v96, v96, v128
    v_add_f32 v97, v97, v129
    v_add_f32 v98, v98, v130
    v_add_f32 v99, v99, v131
    v_add_f32 v96, v96, v132
    v_add_f32 v97, v97, v133
    v_add_f32 v98, v98, v134
    v_add_f32 v99, v99, v135
    v_add_f32 v96, v96, v136
    v_add_f32 v97, v97, v137
    v_add_f32 v98, v98, v138
    v_add_f32 v99, v99, v139
    v_add_f32 v96, v96, v140
    v_add_f32 v97, v97, v141
    v_add_f32 v98, v98, v142
    v_add_f32 v99, v99, v143
    v_add_f32 v96, v96, v144
    v_add_f32 v97, v97, v145
    v_add_f32 v98, v98, v146
    v_add_f32 v99, v99, v147
    v_add_f32 v96, v96, v148
    v_add_f32 v97, v97, v149
    v_add_f32 v98, v98, v150
    v_add_f32 v99, v99, v151
    v_add_f32 v96, v96, v152
    v_add_f32 v97, v97, v153
    v_add_f32 v98, v98, v154
    v_add_f32 v99, v99, v155
    v_add_f32 v96, v96, v156
    v_add_f32 v97, v97, v157
    v_add_f32 v98, v98, v158
    v_add_f32 v99, v99, v159
    s_lshl_b32 s44, s21, 10
    s_add_u32 s44, s44, 151552
    v_add_u32 v24, s44, v1
    ds_write_b128 v24, v[96:99]
h_cs_done:
    s_waitcnt lgkmcnt(0)
    s_barrier
    s_cmp_lg_u32 s21, 0
    s_cbranch_scc1 h_f1_ok
    s_load_dword s68, s[34:35], 128
    s_mov_b32 s8, s34
    s_mov_b32 s9, s35
    s_mov_b32 s10, 256
    s_mov_b32 s11, 0x00020000
    s_mov_b32 s66, 0x10000
    v_mov_b32 v24, 0
    s_waitcnt lgkmcnt(0)
h_f1:
    s_cmp_eq_u32 s68, 8
    s_cbranch_scc1 h_f1_ok
    buffer_load_dword v25, v24, s[8:11], 0 offen offset:128 sc1
    s_waitcnt vmcnt(0)
    v_readfirstlane_b32 s68, v25
    s_sub_u32 s66, s66, 1
    s_cmp_lg_u32 s66, 0
    s_cbranch_scc1 h_f1
h_f1_ok:
    s_barrier
    s_bitcmp1_b32 s21, 0
    s_cselect_b32 s8, s28, s24
    s_cselect_b32 s9, s29, s25
    s_cselect_b32 s12, s30, s26
    s_cselect_b32 s13, s31, s27
    s_mov_b32 s10, 6291456
    s_mov_b32 s11, 0x00020000
    s_mov_b32 s14, 2097152
    s_mov_b32 s15, 0x00020000
    v_lshrrev_b32 v28, 4, v1
    v_and_b32 v29, 7, v28
    v_lshrrev_b32 v28, 3, v28
    v_mul_u32_u24 v28, 2048, v28
    v_lshl_add_u32 v28, v29, 4, v28
    s_and_b32 s3, s20, 12
    s_or_b32 s3, s3, 3
    s_lshl_b32 s3, s3, 7
    v_add_u32 v28, s3, v28
    s_lshr_b32 s3, s2, 3
    s_lshl_b32 s3, s3, 2
    s_and_b32 s60, s16, 3
    s_add_u32 s60, s60, s3
    s_lshl_b32 s61, s60, 14
    buffer_load_dwordx4 v[144:147], v28, s[12:15], s61 offen
    s_bitcmp0_b32 s21, 0
    s_cselect_b32 s56, s28, s24
    s_cselect_b32 s57, s29, s25
    s_mov_b32 s58, 6291456
    s_mov_b32 s59, 0x00020000
    v_lshrrev_b32 v28, 4, v1
    v_and_b32 v29, 7, v28
    v_lshrrev_b32 v28, 3, v28
    v_mul_u32_u24 v28, 6144, v28
    v_lshl_add_u32 v28, v29, 4, v28
    s_and_b32 s3, s18, 12
    s_or_b32 s3, s3, 3
    s_lshl_b32 s3, s3, 7
    v_add_u32 v28, s3, v28
    s_lshr_b32 s3, s2, 3
    s_lshl_b32 s3, s3, 2
    s_and_b32 s60, s16, 3
    s_add_u32 s60, s60, s3
    s_and_b32 s3, s60, 31
    s_mul_i32 s3, s3, 49152
    s_lshr_b32 s61, s60, 5
    s_min_u32 s61, s61, 2
    s_lshl_b32 s61, s61, 11
    s_add_u32 s61, s61, s3
    s_and_b32 s3, s18, 0
    s_mul_i32 s3, s3, 393216
    s_add_u32 s61, s61, s3
    buffer_load_dwordx4 v[148:151], v28, s[56:59], s61 offen
    s_cmp_lg_u32 s21, 2
    s_cbranch_scc1 h_pe
    s_bitcmp0_b32 s21, 0
    s_cselect_b32 s56, s28, s24
    s_cselect_b32 s57, s29, s25
    s_mov_b32 s58, 6291456
    s_mov_b32 s59, 0x00020000
    s_add_u32 s61, s84, 2048
    buffer_load_dwordx4 v[160:163], v11, s[56:59], s61 offen
    s_add_u32 s61, s84, 4096
    buffer_load_dwordx4 v[164:167], v11, s[56:59], s61 offen
    s_add_u32 s61, s84, 0
    buffer_load_dwordx4 v[168:171], v11, s[56:59], s61 offen
    s_add_u32 s61, s84, 198656
    buffer_load_dwordx4 v[172:175], v11, s[56:59], s61 offen
    s_add_u32 s61, s84, 200704
    buffer_load_dwordx4 v[176:179], v11, s[56:59], s61 offen
    s_add_u32 s61, s84, 196608
    buffer_load_dwordx4 v[180:183], v11, s[56:59], s61 offen
    s_add_u32 s61, s85, 2048
    buffer_load_dwordx4 v[184:187], v11, s[56:59], s61 offen
    s_add_u32 s61, s85, 4096
    buffer_load_dwordx4 v[188:191], v11, s[56:59], s61 offen
    s_add_u32 s61, s85, 0
    buffer_load_dwordx4 v[192:195], v11, s[56:59], s61 offen
    s_add_u32 s61, s85, 198656
    buffer_load_dwordx4 v[196:199], v11, s[56:59], s61 offen
h_pe:
    s_barrier
    s_branch s_tail
l_start:
    s_getpc_b64 s[76:77]
l_pc:
    s_sub_u32 s76, s76, l_pc - interleave_layers__sliding_local_dilated__softmax_full_mha__prompt_kernel
    s_subb_u32 s77, s77, 0
    s_lshr_b32 s3, s2, 3
    s_lshl_b32 s3, s3, 1
    s_and_b32 s78, s16, 1
    s_add_u32 s3, s3, s78
    s_lshl_b32 s3, s3, 6
    s_add_u32 s76, s76, s3
    s_addc_u32 s77, s77, 0
    s_load_dword s80, s[76:77], 0
    s_load_dword s81, s[76:77], 4096
    s_load_dword s82, s[76:77], 8192
    s_load_dword s83, s[76:77], 12288
    s_load_dword s80, s[76:77], 16384
    s_load_dword s81, s[76:77], 20480
    s_load_dword s82, s[76:77], 24576
    s_load_dword s83, s[76:77], 28672
    s_load_dword s80, s[76:77], 32768
    s_load_dword s81, s[76:77], 36864
    s_load_dword s82, s[76:77], 40960
    s_load_dword s83, s[76:77], 45056
    v_lshrrev_b32 v24, 4, v1
    v_lshrrev_b32 v25, 3, v24
    v_mul_u32_u24 v12, 6144, v25
    v_and_b32 v26, 2, v25
    v_lshrrev_b32 v25, 2, v25
    v_or_b32 v26, v26, v25
    v_bfe_u32 v25, v24, 1, 2
    v_xor_b32 v26, v26, v25
    v_lshl_add_u32 v12, v26, 5, v12
    v_and_b32 v26, 1, v24
    v_lshl_add_u32 v12, v26, 4, v12
    s_lshl_b32 s3, s18, 7
    v_add_u32 v12, s3, v12
    v_add_u32 v13, 48128, v12
    v_add_u32 v14, 96256, v12
    v_add_u32 v15, 144384, v12
    v_lshrrev_b32 v24, 4, v1
    v_lshrrev_b32 v25, 3, v24
    v_mul_u32_u24 v16, 2048, v25
    v_and_b32 v26, 2, v25
    v_lshrrev_b32 v25, 2, v25
    v_or_b32 v26, v26, v25
    v_bfe_u32 v25, v24, 1, 2
    v_xor_b32 v26, v26, v25
    v_lshl_add_u32 v16, v26, 5, v16
    v_and_b32 v26, 1, v24
    v_lshl_add_u32 v16, v26, 4, v16
    s_lshl_b32 s3, s20, 7
    v_add_u32 v16, s3, v16
    v_add_u32 v17, 15360, v16
    v_add_u32 v18, 30720, v16
    v_add_u32 v19, 46080, v16
    s_mul_i32 s84, s18, 393216
    s_cmp_eq_u32 s18, 1
    s_cselect_b32 s85, 0, 393216
    s_cmp_eq_u32 s18, 2
    s_cselect_b32 s86, 0, 786432
    s_cmp_eq_u32 s18, 3
    s_cselect_b32 s87, 0, 1179648
    s_cmp_eq_u32 s18, 4
    s_cselect_b32 s88, 0, 1572864
    s_cmp_eq_u32 s18, 5
    s_cselect_b32 s89, 0, 1966080
    s_cmp_eq_u32 s18, 6
    s_cselect_b32 s90, 0, 2359296
    s_cmp_eq_u32 s18, 7
    s_cselect_b32 s91, 0, 2752512
    s_cmp_eq_u32 s18, 8
    s_cselect_b32 s92, 0, 3145728
    s_cmp_eq_u32 s18, 9
    s_cselect_b32 s93, 0, 3538944
    s_cmp_eq_u32 s18, 10
    s_cselect_b32 s94, 0, 3932160
    s_cmp_eq_u32 s18, 11
    s_cselect_b32 s95, 0, 4325376
    s_cmp_eq_u32 s18, 12
    s_cselect_b32 s96, 0, 4718592
    s_cmp_eq_u32 s18, 13
    s_cselect_b32 s97, 0, 5111808
    s_cmp_eq_u32 s18, 14
    s_cselect_b32 s98, 0, 5505024
    s_cmp_eq_u32 s18, 15
    s_cselect_b32 s99, 0, 5898240
    s_and_b32 s3, s16, 3
    s_mul_i32 s3, s3, 49152
    v_add_u32 v11, s3, v12
    s_and_b32 s3, s16, 3
    s_lshl_b32 s3, s3, 10
    v_add_u32 v9, s3, v1
    v_add_u32 v10, 0x10000, v9
    s_sub_u32 s3, s16, 5
    s_lshl_b32 s41, s3, 11
    s_mul_i32 s42, s3, 98304
    s_lshl_b32 s62, s3, 15
    v_add_u32 v14, s42, v12
    v_add_u32 v15, s42, v13
    s_and_b32 s3, s20, 0
    s_lshl_b32 s3, s3, 17
    s_add_u32 s62, s62, s3
    s_barrier
    s_bitcmp1_b32 s21, 0
    s_cselect_b32 s8, s28, s24
    s_cselect_b32 s9, s29, s25
    s_cselect_b32 s12, s30, s26
    s_cselect_b32 s13, s31, s27
    s_mov_b32 s10, 6291456
    s_mov_b32 s11, 0x00020000
    s_mov_b32 s14, 2097152
    s_mov_b32 s15, 0x00020000
    s_add_u32 m0, s41, 0
    s_add_u32 s44, s84, 2048
    buffer_load_dwordx4 v14, s[8:11], s44 offen offset:0 lds
    buffer_load_dwordx4 v15, s[8:11], s44 offen offset:1024 lds
    s_add_u32 m0, s41, 4096
    s_add_u32 s44, s84, 4096
    buffer_load_dwordx4 v14, s[8:11], s44 offen offset:0 lds
    buffer_load_dwordx4 v15, s[8:11], s44 offen offset:1024 lds
    s_add_u32 m0, s41, 8192
    s_add_u32 s44, s84, 0
    buffer_load_dwordx4 v14, s[8:11], s44 offen offset:0 lds
    buffer_load_dwordx4 v15, s[8:11], s44 offen offset:1024 lds
    s_add_u32 m0, s41, 12288
    s_add_u32 s44, s84, 198656
    buffer_load_dwordx4 v14, s[8:11], s44 offen offset:0 lds
    buffer_load_dwordx4 v15, s[8:11], s44 offen offset:1024 lds
    s_add_u32 m0, s41, 16384
    s_add_u32 s44, s84, 200704
    buffer_load_dwordx4 v14, s[8:11], s44 offen offset:0 lds
    buffer_load_dwordx4 v15, s[8:11], s44 offen offset:1024 lds
    s_add_u32 m0, s41, 20480
    s_add_u32 s44, s84, 196608
    buffer_load_dwordx4 v14, s[8:11], s44 offen offset:0 lds
    buffer_load_dwordx4 v15, s[8:11], s44 offen offset:1024 lds
    s_add_u32 m0, s41, 24576
    s_add_u32 s44, s85, 2048
    buffer_load_dwordx4 v14, s[8:11], s44 offen offset:0 lds
    buffer_load_dwordx4 v15, s[8:11], s44 offen offset:1024 lds
    s_add_u32 m0, s41, 28672
    s_add_u32 s44, s85, 4096
    buffer_load_dwordx4 v14, s[8:11], s44 offen offset:0 lds
    buffer_load_dwordx4 v15, s[8:11], s44 offen offset:1024 lds
    s_add_u32 m0, s41, 32768
    s_add_u32 s44, s85, 0
    buffer_load_dwordx4 v14, s[8:11], s44 offen offset:0 lds
    buffer_load_dwordx4 v15, s[8:11], s44 offen offset:1024 lds
    s_add_u32 m0, s41, 36864
    s_add_u32 s44, s85, 198656
    buffer_load_dwordx4 v14, s[8:11], s44 offen offset:0 lds
    buffer_load_dwordx4 v15, s[8:11], s44 offen offset:1024 lds
    s_add_u32 m0, s41, 40960
    s_add_u32 s44, s85, 200704
    buffer_load_dwordx4 v14, s[8:11], s44 offen offset:0 lds
    buffer_load_dwordx4 v15, s[8:11], s44 offen offset:1024 lds
    s_add_u32 m0, s41, 45056
    s_add_u32 s44, s85, 196608
    buffer_load_dwordx4 v14, s[8:11], s44 offen offset:0 lds
    buffer_load_dwordx4 v15, s[8:11], s44 offen offset:1024 lds
    s_waitcnt vmcnt(8)
    s_barrier
    s_add_u32 m0, s41, 49152
    s_add_u32 s44, s86, 2048
    buffer_load_dwordx4 v14, s[8:11], s44 offen offset:0 lds
    buffer_load_dwordx4 v15, s[8:11], s44 offen offset:1024 lds
    s_add_u32 m0, s41, 53248
    s_add_u32 s44, s86, 4096
    buffer_load_dwordx4 v14, s[8:11], s44 offen offset:0 lds
    buffer_load_dwordx4 v15, s[8:11], s44 offen offset:1024 lds
    s_add_u32 m0, s41, 57344
    s_add_u32 s44, s86, 0
    buffer_load_dwordx4 v14, s[8:11], s44 offen offset:0 lds
    buffer_load_dwordx4 v15, s[8:11], s44 offen offset:1024 lds
    s_add_u32 m0, s41, 61440
    s_add_u32 s44, s86, 198656
    buffer_load_dwordx4 v14, s[8:11], s44 offen offset:0 lds
    buffer_load_dwordx4 v15, s[8:11], s44 offen offset:1024 lds
    s_add_u32 m0, s41, 65536
    s_add_u32 s44, s86, 200704
    buffer_load_dwordx4 v14, s[8:11], s44 offen offset:0 lds
    buffer_load_dwordx4 v15, s[8:11], s44 offen offset:1024 lds
    s_add_u32 m0, s41, 69632
    s_add_u32 s44, s86, 196608
    buffer_load_dwordx4 v14, s[8:11], s44 offen offset:0 lds
    buffer_load_dwordx4 v15, s[8:11], s44 offen offset:1024 lds
    s_add_u32 m0, s41, 73728
    s_add_u32 s44, s87, 2048
    buffer_load_dwordx4 v14, s[8:11], s44 offen offset:0 lds
    buffer_load_dwordx4 v15, s[8:11], s44 offen offset:1024 lds
    s_add_u32 m0, s41, 77824
    s_add_u32 s44, s87, 4096
    buffer_load_dwordx4 v14, s[8:11], s44 offen offset:0 lds
    buffer_load_dwordx4 v15, s[8:11], s44 offen offset:1024 lds
    s_add_u32 m0, s41, 81920
    s_add_u32 s44, s87, 0
    buffer_load_dwordx4 v14, s[8:11], s44 offen offset:0 lds
    buffer_load_dwordx4 v15, s[8:11], s44 offen offset:1024 lds
    s_add_u32 m0, s41, 86016
    s_add_u32 s44, s87, 198656
    buffer_load_dwordx4 v14, s[8:11], s44 offen offset:0 lds
    buffer_load_dwordx4 v15, s[8:11], s44 offen offset:1024 lds
    s_add_u32 m0, s41, 90112
    s_add_u32 s44, s87, 200704
    buffer_load_dwordx4 v14, s[8:11], s44 offen offset:0 lds
    buffer_load_dwordx4 v15, s[8:11], s44 offen offset:1024 lds
    s_add_u32 m0, s41, 94208
    s_add_u32 s44, s87, 196608
    buffer_load_dwordx4 v14, s[8:11], s44 offen offset:0 lds
    buffer_load_dwordx4 v15, s[8:11], s44 offen offset:1024 lds
    s_waitcnt vmcnt(16)
    s_barrier
    s_add_u32 m0, s41, 98304
    s_add_u32 s44, s88, 2048
    buffer_load_dwordx4 v14, s[8:11], s44 offen offset:0 lds
    buffer_load_dwordx4 v15, s[8:11], s44 offen offset:1024 lds
    s_add_u32 m0, s41, 102400
    s_add_u32 s44, s88, 4096
    buffer_load_dwordx4 v14, s[8:11], s44 offen offset:0 lds
    buffer_load_dwordx4 v15, s[8:11], s44 offen offset:1024 lds
    s_add_u32 m0, s41, 106496
    s_add_u32 s44, s88, 0
    buffer_load_dwordx4 v14, s[8:11], s44 offen offset:0 lds
    buffer_load_dwordx4 v15, s[8:11], s44 offen offset:1024 lds
    s_add_u32 m0, s41, 110592
    s_add_u32 s44, s88, 198656
    buffer_load_dwordx4 v14, s[8:11], s44 offen offset:0 lds
    buffer_load_dwordx4 v15, s[8:11], s44 offen offset:1024 lds
    s_add_u32 m0, s41, 114688
    s_add_u32 s44, s88, 200704
    buffer_load_dwordx4 v14, s[8:11], s44 offen offset:0 lds
    buffer_load_dwordx4 v15, s[8:11], s44 offen offset:1024 lds
    s_add_u32 m0, s41, 118784
    s_add_u32 s44, s88, 196608
    buffer_load_dwordx4 v14, s[8:11], s44 offen offset:0 lds
    buffer_load_dwordx4 v15, s[8:11], s44 offen offset:1024 lds
    s_add_u32 m0, s41, 122880
    s_add_u32 s44, s89, 2048
    buffer_load_dwordx4 v14, s[8:11], s44 offen offset:0 lds
    buffer_load_dwordx4 v15, s[8:11], s44 offen offset:1024 lds
    s_add_u32 m0, s41, 126976
    s_add_u32 s44, s89, 4096
    buffer_load_dwordx4 v14, s[8:11], s44 offen offset:0 lds
    buffer_load_dwordx4 v15, s[8:11], s44 offen offset:1024 lds
    s_add_u32 m0, s41, 0
    s_add_u32 s44, s89, 0
    buffer_load_dwordx4 v14, s[8:11], s44 offen offset:0 lds
    buffer_load_dwordx4 v15, s[8:11], s44 offen offset:1024 lds
    s_add_u32 m0, s41, 4096
    s_add_u32 s44, s89, 198656
    buffer_load_dwordx4 v14, s[8:11], s44 offen offset:0 lds
    buffer_load_dwordx4 v15, s[8:11], s44 offen offset:1024 lds
    s_add_u32 m0, s41, 8192
    s_add_u32 s44, s89, 200704
    buffer_load_dwordx4 v14, s[8:11], s44 offen offset:0 lds
    buffer_load_dwordx4 v15, s[8:11], s44 offen offset:1024 lds
    s_add_u32 m0, s41, 12288
    s_add_u32 s44, s89, 196608
    buffer_load_dwordx4 v14, s[8:11], s44 offen offset:0 lds
    buffer_load_dwordx4 v15, s[8:11], s44 offen offset:1024 lds
    s_waitcnt vmcnt(24)
    s_branch l_join
l_layer:
    s_waitcnt lgkmcnt(0)
    s_barrier
    s_add_u32 m0, s41, 0
    s_add_u32 s44, s89, 0
    buffer_load_dwordx4 v14, s[8:11], s44 offen offset:0 lds
    buffer_load_dwordx4 v15, s[8:11], s44 offen offset:1024 lds
    s_add_u32 m0, s41, 4096
    s_add_u32 s44, s89, 198656
    buffer_load_dwordx4 v14, s[8:11], s44 offen offset:0 lds
    buffer_load_dwordx4 v15, s[8:11], s44 offen offset:1024 lds
    s_add_u32 m0, s41, 8192
    s_add_u32 s44, s89, 200704
    buffer_load_dwordx4 v14, s[8:11], s44 offen offset:0 lds
    buffer_load_dwordx4 v15, s[8:11], s44 offen offset:1024 lds
    s_add_u32 m0, s41, 12288
    s_add_u32 s44, s89, 196608
    buffer_load_dwordx4 v14, s[8:11], s44 offen offset:0 lds
    buffer_load_dwordx4 v15, s[8:11], s44 offen offset:1024 lds
l_join:
    s_barrier
    s_add_u32 m0, s41, 16384
    s_add_u32 s44, s90, 2048
    buffer_load_dwordx4 v14, s[8:11], s44 offen offset:0 lds
    buffer_load_dwordx4 v15, s[8:11], s44 offen offset:1024 lds
    s_add_u32 m0, s41, 20480
    s_add_u32 s44, s90, 4096
    buffer_load_dwordx4 v14, s[8:11], s44 offen offset:0 lds
    buffer_load_dwordx4 v15, s[8:11], s44 offen offset:1024 lds
    s_add_u32 m0, s41, 24576
    s_add_u32 s44, s90, 0
    buffer_load_dwordx4 v14, s[8:11], s44 offen offset:0 lds
    buffer_load_dwordx4 v15, s[8:11], s44 offen offset:1024 lds
    s_add_u32 m0, s41, 28672
    s_add_u32 s44, s90, 198656
    buffer_load_dwordx4 v14, s[8:11], s44 offen offset:0 lds
    buffer_load_dwordx4 v15, s[8:11], s44 offen offset:1024 lds
    s_add_u32 m0, s41, 32768
    s_add_u32 s44, s90, 200704
    buffer_load_dwordx4 v14, s[8:11], s44 offen offset:0 lds
    buffer_load_dwordx4 v15, s[8:11], s44 offen offset:1024 lds
    s_add_u32 m0, s41, 36864
    s_add_u32 s44, s90, 196608
    buffer_load_dwordx4 v14, s[8:11], s44 offen offset:0 lds
    buffer_load_dwordx4 v15, s[8:11], s44 offen offset:1024 lds
    s_add_u32 m0, s41, 40960
    s_add_u32 s44, s91, 2048
    buffer_load_dwordx4 v14, s[8:11], s44 offen offset:0 lds
    buffer_load_dwordx4 v15, s[8:11], s44 offen offset:1024 lds
    s_add_u32 m0, s41, 45056
    s_add_u32 s44, s91, 4096
    buffer_load_dwordx4 v14, s[8:11], s44 offen offset:0 lds
    buffer_load_dwordx4 v15, s[8:11], s44 offen offset:1024 lds
    s_waitcnt vmcnt(24)
    s_barrier
    s_add_u32 m0, s41, 49152
    s_add_u32 s44, s91, 0
    buffer_load_dwordx4 v14, s[8:11], s44 offen offset:0 lds
    buffer_load_dwordx4 v15, s[8:11], s44 offen offset:1024 lds
    s_add_u32 m0, s41, 53248
    s_add_u32 s44, s91, 198656
    buffer_load_dwordx4 v14, s[8:11], s44 offen offset:0 lds
    buffer_load_dwordx4 v15, s[8:11], s44 offen offset:1024 lds
    s_add_u32 m0, s41, 57344
    s_add_u32 s44, s91, 200704
    buffer_load_dwordx4 v14, s[8:11], s44 offen offset:0 lds
    buffer_load_dwordx4 v15, s[8:11], s44 offen offset:1024 lds
    s_add_u32 m0, s41, 61440
    s_add_u32 s44, s91, 196608
    buffer_load_dwordx4 v14, s[8:11], s44 offen offset:0 lds
    buffer_load_dwordx4 v15, s[8:11], s44 offen offset:1024 lds
    s_waitcnt vmcnt(16)
    s_barrier
    s_add_u32 m0, s41, 65536
    s_add_u32 s44, s92, 2048
    buffer_load_dwordx4 v14, s[8:11], s44 offen offset:0 lds
    buffer_load_dwordx4 v15, s[8:11], s44 offen offset:1024 lds
    s_add_u32 m0, s41, 69632
    s_add_u32 s44, s92, 4096
    buffer_load_dwordx4 v14, s[8:11], s44 offen offset:0 lds
    buffer_load_dwordx4 v15, s[8:11], s44 offen offset:1024 lds
    s_add_u32 m0, s41, 73728
    s_add_u32 s44, s92, 0
    buffer_load_dwordx4 v14, s[8:11], s44 offen offset:0 lds
    buffer_load_dwordx4 v15, s[8:11], s44 offen offset:1024 lds
    s_add_u32 m0, s41, 77824
    s_add_u32 s44, s92, 198656
    buffer_load_dwordx4 v14, s[8:11], s44 offen offset:0 lds
    buffer_load_dwordx4 v15, s[8:11], s44 offen offset:1024 lds
    s_add_u32 m0, s41, 81920
    s_add_u32 s44, s92, 200704
    buffer_load_dwordx4 v14, s[8:11], s44 offen offset:0 lds
    buffer_load_dwordx4 v15, s[8:11], s44 offen offset:1024 lds
    s_add_u32 m0, s41, 86016
    s_add_u32 s44, s92, 196608
    buffer_load_dwordx4 v14, s[8:11], s44 offen offset:0 lds
    buffer_load_dwordx4 v15, s[8:11], s44 offen offset:1024 lds
    s_add_u32 m0, s41, 90112
    s_add_u32 s44, s93, 2048
    buffer_load_dwordx4 v14, s[8:11], s44 offen offset:0 lds
    buffer_load_dwordx4 v15, s[8:11], s44 offen offset:1024 lds
    s_add_u32 m0, s41, 94208
    s_add_u32 s44, s93, 4096
    buffer_load_dwordx4 v14, s[8:11], s44 offen offset:0 lds
    buffer_load_dwordx4 v15, s[8:11], s44 offen offset:1024 lds
    s_waitcnt vmcnt(16)
    s_barrier
    s_add_u32 m0, s41, 98304
    s_add_u32 s44, s93, 0
    buffer_load_dwordx4 v14, s[8:11], s44 offen offset:0 lds
    buffer_load_dwordx4 v15, s[8:11], s44 offen offset:1024 lds
    s_add_u32 m0, s41, 102400
    s_add_u32 s44, s93, 198656
    buffer_load_dwordx4 v14, s[8:11], s44 offen offset:0 lds
    buffer_load_dwordx4 v15, s[8:11], s44 offen offset:1024 lds
    s_add_u32 m0, s41, 106496
    s_add_u32 s44, s93, 200704
    buffer_load_dwordx4 v14, s[8:11], s44 offen offset:0 lds
    buffer_load_dwordx4 v15, s[8:11], s44 offen offset:1024 lds
    s_add_u32 m0, s41, 110592
    s_add_u32 s44, s93, 196608
    buffer_load_dwordx4 v14, s[8:11], s44 offen offset:0 lds
    buffer_load_dwordx4 v15, s[8:11], s44 offen offset:1024 lds
    s_add_u32 m0, s41, 114688
    s_add_u32 s44, s94, 2048
    buffer_load_dwordx4 v14, s[8:11], s44 offen offset:0 lds
    buffer_load_dwordx4 v15, s[8:11], s44 offen offset:1024 lds
    s_add_u32 m0, s41, 118784
    s_add_u32 s44, s94, 4096
    buffer_load_dwordx4 v14, s[8:11], s44 offen offset:0 lds
    buffer_load_dwordx4 v15, s[8:11], s44 offen offset:1024 lds
    s_add_u32 m0, s41, 122880
    s_add_u32 s44, s94, 198656
    buffer_load_dwordx4 v14, s[8:11], s44 offen offset:0 lds
    buffer_load_dwordx4 v15, s[8:11], s44 offen offset:1024 lds
    s_add_u32 m0, s41, 126976
    s_add_u32 s44, s94, 200704
    buffer_load_dwordx4 v14, s[8:11], s44 offen offset:0 lds
    buffer_load_dwordx4 v15, s[8:11], s44 offen offset:1024 lds
    s_waitcnt vmcnt(16)
    s_barrier
    s_add_u32 m0, s41, 0
    s_add_u32 s44, s95, 2048
    buffer_load_dwordx4 v14, s[8:11], s44 offen offset:0 lds
    buffer_load_dwordx4 v15, s[8:11], s44 offen offset:1024 lds
    s_add_u32 m0, s41, 4096
    s_add_u32 s44, s95, 4096
    buffer_load_dwordx4 v14, s[8:11], s44 offen offset:0 lds
    buffer_load_dwordx4 v15, s[8:11], s44 offen offset:1024 lds
    s_add_u32 m0, s41, 8192
    s_add_u32 s44, s95, 198656
    buffer_load_dwordx4 v14, s[8:11], s44 offen offset:0 lds
    buffer_load_dwordx4 v15, s[8:11], s44 offen offset:1024 lds
    s_add_u32 m0, s41, 12288
    s_add_u32 s44, s95, 200704
    buffer_load_dwordx4 v14, s[8:11], s44 offen offset:0 lds
    buffer_load_dwordx4 v15, s[8:11], s44 offen offset:1024 lds
    s_add_u32 m0, s41, 16384
    s_add_u32 s44, s96, 2048
    buffer_load_dwordx4 v14, s[8:11], s44 offen offset:0 lds
    buffer_load_dwordx4 v15, s[8:11], s44 offen offset:1024 lds
    s_add_u32 m0, s41, 20480
    s_add_u32 s44, s96, 198656
    buffer_load_dwordx4 v14, s[8:11], s44 offen offset:0 lds
    buffer_load_dwordx4 v15, s[8:11], s44 offen offset:1024 lds
    s_add_u32 m0, s41, 24576
    s_add_u32 s44, s97, 2048
    buffer_load_dwordx4 v14, s[8:11], s44 offen offset:0 lds
    buffer_load_dwordx4 v15, s[8:11], s44 offen offset:1024 lds
    s_add_u32 m0, s41, 28672
    s_add_u32 s44, s97, 198656
    buffer_load_dwordx4 v14, s[8:11], s44 offen offset:0 lds
    buffer_load_dwordx4 v15, s[8:11], s44 offen offset:1024 lds
    s_waitcnt vmcnt(16)
    s_barrier
    s_add_u32 m0, s41, 32768
    s_add_u32 s44, s98, 2048
    buffer_load_dwordx4 v14, s[8:11], s44 offen offset:0 lds
    buffer_load_dwordx4 v15, s[8:11], s44 offen offset:1024 lds
    s_add_u32 m0, s41, 36864
    s_add_u32 s44, s98, 198656
    buffer_load_dwordx4 v14, s[8:11], s44 offen offset:0 lds
    buffer_load_dwordx4 v15, s[8:11], s44 offen offset:1024 lds
    s_add_u32 m0, s41, 40960
    s_add_u32 s44, s99, 2048
    buffer_load_dwordx4 v14, s[8:11], s44 offen offset:0 lds
    buffer_load_dwordx4 v15, s[8:11], s44 offen offset:1024 lds
    s_add_u32 m0, s41, 45056
    s_add_u32 s44, s99, 198656
    buffer_load_dwordx4 v14, s[8:11], s44 offen offset:0 lds
    buffer_load_dwordx4 v15, s[8:11], s44 offen offset:1024 lds
    s_add_u32 m0, s41, 49152
    s_add_u32 s44, s96, 4096
    buffer_load_dwordx4 v14, s[8:11], s44 offen offset:0 lds
    buffer_load_dwordx4 v15, s[8:11], s44 offen offset:1024 lds
    s_add_u32 m0, s41, 53248
    s_add_u32 s44, s96, 200704
    buffer_load_dwordx4 v14, s[8:11], s44 offen offset:0 lds
    buffer_load_dwordx4 v15, s[8:11], s44 offen offset:1024 lds
    s_add_u32 m0, s41, 57344
    s_add_u32 s44, s97, 4096
    buffer_load_dwordx4 v14, s[8:11], s44 offen offset:0 lds
    buffer_load_dwordx4 v15, s[8:11], s44 offen offset:1024 lds
    s_add_u32 m0, s41, 61440
    s_add_u32 s44, s97, 200704
    buffer_load_dwordx4 v14, s[8:11], s44 offen offset:0 lds
    buffer_load_dwordx4 v15, s[8:11], s44 offen offset:1024 lds
    s_waitcnt vmcnt(16)
    s_barrier
    s_add_u32 m0, s41, 65536
    s_add_u32 s44, s98, 4096
    buffer_load_dwordx4 v14, s[8:11], s44 offen offset:0 lds
    buffer_load_dwordx4 v15, s[8:11], s44 offen offset:1024 lds
    s_add_u32 m0, s41, 69632
    s_add_u32 s44, s98, 200704
    buffer_load_dwordx4 v14, s[8:11], s44 offen offset:0 lds
    buffer_load_dwordx4 v15, s[8:11], s44 offen offset:1024 lds
    s_add_u32 m0, s41, 73728
    s_add_u32 s44, s99, 4096
    buffer_load_dwordx4 v14, s[8:11], s44 offen offset:0 lds
    buffer_load_dwordx4 v15, s[8:11], s44 offen offset:1024 lds
    s_add_u32 m0, s41, 77824
    s_add_u32 s44, s99, 200704
    buffer_load_dwordx4 v14, s[8:11], s44 offen offset:0 lds
    buffer_load_dwordx4 v15, s[8:11], s44 offen offset:1024 lds
    s_add_u32 m0, s41, 81920
    s_add_u32 s44, s94, 0
    buffer_load_dwordx4 v14, s[8:11], s44 offen offset:0 lds
    buffer_load_dwordx4 v15, s[8:11], s44 offen offset:1024 lds
    s_add_u32 m0, s41, 86016
    s_add_u32 s44, s94, 196608
    buffer_load_dwordx4 v14, s[8:11], s44 offen offset:0 lds
    buffer_load_dwordx4 v15, s[8:11], s44 offen offset:1024 lds
    s_add_u32 m0, s41, 90112
    s_add_u32 s44, s95, 0
    buffer_load_dwordx4 v14, s[8:11], s44 offen offset:0 lds
    buffer_load_dwordx4 v15, s[8:11], s44 offen offset:1024 lds
    s_add_u32 m0, s41, 94208
    s_add_u32 s44, s95, 196608
    buffer_load_dwordx4 v14, s[8:11], s44 offen offset:0 lds
    buffer_load_dwordx4 v15, s[8:11], s44 offen offset:1024 lds
    s_waitcnt vmcnt(16)
    s_barrier
    s_add_u32 m0, s41, 98304
    s_add_u32 s44, s96, 0
    buffer_load_dwordx4 v14, s[8:11], s44 offen offset:0 lds
    buffer_load_dwordx4 v15, s[8:11], s44 offen offset:1024 lds
    s_add_u32 m0, s41, 102400
    s_add_u32 s44, s96, 196608
    buffer_load_dwordx4 v14, s[8:11], s44 offen offset:0 lds
    buffer_load_dwordx4 v15, s[8:11], s44 offen offset:1024 lds
    s_add_u32 m0, s41, 106496
    s_add_u32 s44, s97, 0
    buffer_load_dwordx4 v14, s[8:11], s44 offen offset:0 lds
    buffer_load_dwordx4 v15, s[8:11], s44 offen offset:1024 lds
    s_add_u32 m0, s41, 110592
    s_add_u32 s44, s97, 196608
    buffer_load_dwordx4 v14, s[8:11], s44 offen offset:0 lds
    buffer_load_dwordx4 v15, s[8:11], s44 offen offset:1024 lds
    s_add_u32 m0, s41, 114688
    s_add_u32 s44, s98, 0
    buffer_load_dwordx4 v14, s[8:11], s44 offen offset:0 lds
    buffer_load_dwordx4 v15, s[8:11], s44 offen offset:1024 lds
    s_add_u32 m0, s41, 118784
    s_add_u32 s44, s98, 196608
    buffer_load_dwordx4 v14, s[8:11], s44 offen offset:0 lds
    buffer_load_dwordx4 v15, s[8:11], s44 offen offset:1024 lds
    s_add_u32 m0, s41, 122880
    s_add_u32 s44, s99, 0
    buffer_load_dwordx4 v14, s[8:11], s44 offen offset:0 lds
    buffer_load_dwordx4 v15, s[8:11], s44 offen offset:1024 lds
    s_add_u32 m0, s41, 126976
    s_add_u32 s44, s99, 196608
    buffer_load_dwordx4 v14, s[8:11], s44 offen offset:0 lds
    buffer_load_dwordx4 v15, s[8:11], s44 offen offset:1024 lds
    s_waitcnt vmcnt(16)
    s_barrier
    v_lshrrev_b32 v28, 4, v1
    v_and_b32 v29, 7, v28
    v_lshrrev_b32 v28, 3, v28
    v_mul_u32_u24 v28, 2048, v28
    v_lshl_add_u32 v28, v29, 4, v28
    s_and_b32 s3, s20, 12
    s_or_b32 s3, s3, 3
    s_lshl_b32 s3, s3, 7
    v_add_u32 v28, s3, v28
    s_lshr_b32 s3, s2, 3
    s_lshl_b32 s3, s3, 2
    s_and_b32 s60, s16, 3
    s_add_u32 s60, s60, s3
    s_lshl_b32 s61, s60, 14
    buffer_load_dwordx4 v[144:147], v28, s[12:15], s61 offen
    s_bitcmp0_b32 s21, 0
    s_cselect_b32 s56, s28, s24
    s_cselect_b32 s57, s29, s25
    s_mov_b32 s58, 6291456
    s_mov_b32 s59, 0x00020000
    v_lshrrev_b32 v28, 4, v1
    v_and_b32 v29, 7, v28
    v_lshrrev_b32 v28, 3, v28
    v_mul_u32_u24 v28, 6144, v28
    v_lshl_add_u32 v28, v29, 4, v28
    s_and_b32 s3, s18, 12
    s_or_b32 s3, s3, 3
    s_lshl_b32 s3, s3, 7
    v_add_u32 v28, s3, v28
    s_lshr_b32 s3, s2, 3
    s_lshl_b32 s3, s3, 2
    s_and_b32 s60, s16, 3
    s_add_u32 s60, s60, s3
    s_and_b32 s3, s60, 31
    s_mul_i32 s3, s3, 49152
    s_lshr_b32 s61, s60, 5
    s_min_u32 s61, s61, 2
    s_lshl_b32 s61, s61, 11
    s_add_u32 s61, s61, s3
    s_and_b32 s3, s18, 0
    s_mul_i32 s3, s3, 393216
    s_add_u32 s61, s61, s3
    buffer_load_dwordx4 v[148:151], v28, s[56:59], s61 offen
    s_waitcnt vmcnt(2)
    s_cmp_lg_u32 s21, 2
    s_cbranch_scc1 l_pe
    s_bitcmp0_b32 s21, 0
    s_cselect_b32 s56, s28, s24
    s_cselect_b32 s57, s29, s25
    s_mov_b32 s58, 6291456
    s_mov_b32 s59, 0x00020000
    s_add_u32 s61, s84, 2048
    buffer_load_dwordx4 v[160:163], v11, s[56:59], s61 offen
    s_add_u32 s61, s84, 4096
    buffer_load_dwordx4 v[164:167], v11, s[56:59], s61 offen
    s_add_u32 s61, s84, 0
    buffer_load_dwordx4 v[168:171], v11, s[56:59], s61 offen
    s_add_u32 s61, s84, 198656
    buffer_load_dwordx4 v[172:175], v11, s[56:59], s61 offen
    s_add_u32 s61, s84, 200704
    buffer_load_dwordx4 v[176:179], v11, s[56:59], s61 offen
    s_add_u32 s61, s84, 196608
    buffer_load_dwordx4 v[180:183], v11, s[56:59], s61 offen
    s_add_u32 s61, s85, 2048
    buffer_load_dwordx4 v[184:187], v11, s[56:59], s61 offen
    s_add_u32 s61, s85, 4096
    buffer_load_dwordx4 v[188:191], v11, s[56:59], s61 offen
    s_add_u32 s61, s85, 0
    buffer_load_dwordx4 v[192:195], v11, s[56:59], s61 offen
    s_add_u32 s61, s85, 198656
    buffer_load_dwordx4 v[196:199], v11, s[56:59], s61 offen
l_pe:
    s_barrier
    s_bitcmp1_b32 s21, 0
    s_cbranch_scc1 s_B
    s_add_u32 m0, s41, 0
    s_xor_b32 s44, s62, 0
    buffer_load_dwordx4 v16, s[12:15], s44 offen offset:0 lds
    buffer_load_dwordx4 v17, s[12:15], s44 offen offset:1024 lds
    s_add_u32 m0, s41, 4096
    s_xor_b32 s44, s62, 131072
    buffer_load_dwordx4 v16, s[12:15], s44 offen offset:0 lds
    buffer_load_dwordx4 v17, s[12:15], s44 offen offset:1024 lds
    s_add_u32 m0, s41, 8192
    s_xor_b32 s44, s62, 262144
    buffer_load_dwordx4 v16, s[12:15], s44 offen offset:0 lds
    buffer_load_dwordx4 v17, s[12:15], s44 offen offset:1024 lds
    s_add_u32 m0, s41, 12288
    s_xor_b32 s44, s62, 393216
    buffer_load_dwordx4 v16, s[12:15], s44 offen offset:0 lds
    buffer_load_dwordx4 v17, s[12:15], s44 offen offset:1024 lds
    s_add_u32 m0, s41, 16384
    s_xor_b32 s44, s62, 524288
    buffer_load_dwordx4 v16, s[12:15], s44 offen offset:0 lds
    buffer_load_dwordx4 v17, s[12:15], s44 offen offset:1024 lds
    s_add_u32 m0, s41, 20480
    s_xor_b32 s44, s62, 655360
    buffer_load_dwordx4 v16, s[12:15], s44 offen offset:0 lds
    buffer_load_dwordx4 v17, s[12:15], s44 offen offset:1024 lds
    s_add_u32 m0, s41, 24576
    s_xor_b32 s44, s62, 786432
    buffer_load_dwordx4 v16, s[12:15], s44 offen offset:0 lds
    buffer_load_dwordx4 v17, s[12:15], s44 offen offset:1024 lds
    s_add_u32 m0, s41, 28672
    s_xor_b32 s44, s62, 917504
    buffer_load_dwordx4 v16, s[12:15], s44 offen offset:0 lds
    buffer_load_dwordx4 v17, s[12:15], s44 offen offset:1024 lds
    s_add_u32 m0, s41, 32768
    s_xor_b32 s44, s62, 1048576
    buffer_load_dwordx4 v16, s[12:15], s44 offen offset:0 lds
    buffer_load_dwordx4 v17, s[12:15], s44 offen offset:1024 lds
    s_add_u32 m0, s41, 36864
    s_xor_b32 s44, s62, 1179648
    buffer_load_dwordx4 v16, s[12:15], s44 offen offset:0 lds
    buffer_load_dwordx4 v17, s[12:15], s44 offen offset:1024 lds
    s_add_u32 m0, s41, 40960
    s_xor_b32 s44, s62, 1310720
    buffer_load_dwordx4 v16, s[12:15], s44 offen offset:0 lds
    buffer_load_dwordx4 v17, s[12:15], s44 offen offset:1024 lds
    s_add_u32 m0, s41, 45056
    s_xor_b32 s44, s62, 1441792
    buffer_load_dwordx4 v16, s[12:15], s44 offen offset:0 lds
    buffer_load_dwordx4 v17, s[12:15], s44 offen offset:1024 lds
    s_add_u32 m0, s41, 49152
    s_xor_b32 s44, s62, 1572864
    buffer_load_dwordx4 v16, s[12:15], s44 offen offset:0 lds
    buffer_load_dwordx4 v17, s[12:15], s44 offen offset:1024 lds
    s_add_u32 m0, s41, 53248
    s_xor_b32 s44, s62, 1703936
    buffer_load_dwordx4 v16, s[12:15], s44 offen offset:0 lds
    buffer_load_dwordx4 v17, s[12:15], s44 offen offset:1024 lds
    s_add_u32 m0, s41, 57344
    s_xor_b32 s44, s62, 1835008
    buffer_load_dwordx4 v16, s[12:15], s44 offen offset:0 lds
    buffer_load_dwordx4 v17, s[12:15], s44 offen offset:1024 lds
    s_add_u32 m0, s41, 61440
    s_xor_b32 s44, s62, 1966080
    buffer_load_dwordx4 v16, s[12:15], s44 offen offset:0 lds
    buffer_load_dwordx4 v17, s[12:15], s44 offen offset:1024 lds
    s_branch s_tail
z_start:
    v_lshrrev_b32 v24, 4, v1
    v_lshrrev_b32 v25, 3, v24
    v_mul_u32_u24 v20, 6144, v25
    v_and_b32 v25, 7, v24
    v_lshl_add_u32 v20, v25, 4, v20
    s_add_u32 s3, s18, 2
    s_and_b32 s3, s3, 15
    s_lshl_b32 s3, s3, 7
    s_add_u32 s3, s3, 4096
    v_add_u32 v22, s3, v20
    s_add_u32 s3, s18, 1
    s_and_b32 s3, s3, 15
    s_lshl_b32 s3, s3, 7
    s_add_u32 s3, s3, 2048
    v_add_u32 v21, s3, v20
    s_add_u32 s3, s18, 0
    s_and_b32 s3, s3, 15
    s_lshl_b32 s3, s3, 7
    s_add_u32 s3, s3, 0
    v_add_u32 v20, s3, v20
    s_waitcnt lgkmcnt(0)
    s_mov_b32 s8, s24
    s_mov_b32 s9, s25
    s_mov_b32 s10, 6291456
    s_mov_b32 s11, 0x00020000
    s_mul_i32 s44, s17, 393216
    buffer_load_dwordx4 v[32:35], v20, s[8:11], s44 offen
    buffer_load_dwordx4 v[64:67], v21, s[8:11], s44 offen
    buffer_load_dwordx4 v[96:99], v22, s[8:11], s44 offen
    s_add_u32 s44, s44, 49152
    buffer_load_dwordx4 v[36:39], v20, s[8:11], s44 offen
    buffer_load_dwordx4 v[68:71], v21, s[8:11], s44 offen
    buffer_load_dwordx4 v[100:103], v22, s[8:11], s44 offen
    s_add_u32 s44, s44, 49152
    buffer_load_dwordx4 v[40:43], v20, s[8:11], s44 offen
    buffer_load_dwordx4 v[72:75], v21, s[8:11], s44 offen
    buffer_load_dwordx4 v[104:107], v22, s[8:11], s44 offen
    s_add_u32 s44, s44, 49152
    buffer_load_dwordx4 v[44:47], v20, s[8:11], s44 offen
    buffer_load_dwordx4 v[76:79], v21, s[8:11], s44 offen
    buffer_load_dwordx4 v[108:111], v22, s[8:11], s44 offen
    s_add_u32 s44, s44, 49152
    buffer_load_dwordx4 v[48:51], v20, s[8:11], s44 offen
    buffer_load_dwordx4 v[80:83], v21, s[8:11], s44 offen
    buffer_load_dwordx4 v[112:115], v22, s[8:11], s44 offen
    s_add_u32 s44, s44, 49152
    buffer_load_dwordx4 v[52:55], v20, s[8:11], s44 offen
    buffer_load_dwordx4 v[84:87], v21, s[8:11], s44 offen
    buffer_load_dwordx4 v[116:119], v22, s[8:11], s44 offen
    s_add_u32 s44, s44, 49152
    buffer_load_dwordx4 v[56:59], v20, s[8:11], s44 offen
    buffer_load_dwordx4 v[88:91], v21, s[8:11], s44 offen
    buffer_load_dwordx4 v[120:123], v22, s[8:11], s44 offen
    s_add_u32 s44, s44, 49152
    buffer_load_dwordx4 v[60:63], v20, s[8:11], s44 offen
    buffer_load_dwordx4 v[92:95], v21, s[8:11], s44 offen
    buffer_load_dwordx4 v[124:127], v22, s[8:11], s44 offen
    v_lshrrev_b32 v24, 4, v1
    v_lshrrev_b32 v25, 3, v24
    v_mul_u32_u24 v12, 6144, v25
    v_and_b32 v26, 2, v25
    v_lshrrev_b32 v25, 2, v25
    v_or_b32 v26, v26, v25
    v_bfe_u32 v25, v24, 1, 2
    v_xor_b32 v26, v26, v25
    v_lshl_add_u32 v12, v26, 5, v12
    v_and_b32 v26, 1, v24
    v_lshl_add_u32 v12, v26, 4, v12
    s_lshl_b32 s3, s18, 7
    v_add_u32 v12, s3, v12
    v_add_u32 v13, 48128, v12
    v_add_u32 v14, 96256, v12
    v_add_u32 v15, 144384, v12
    v_lshrrev_b32 v24, 4, v1
    v_lshrrev_b32 v25, 3, v24
    v_mul_u32_u24 v16, 2048, v25
    v_and_b32 v26, 2, v25
    v_lshrrev_b32 v25, 2, v25
    v_or_b32 v26, v26, v25
    v_bfe_u32 v25, v24, 1, 2
    v_xor_b32 v26, v26, v25
    v_lshl_add_u32 v16, v26, 5, v16
    v_and_b32 v26, 1, v24
    v_lshl_add_u32 v16, v26, 4, v16
    s_lshl_b32 s3, s20, 7
    v_add_u32 v16, s3, v16
    v_add_u32 v17, 15360, v16
    v_add_u32 v18, 30720, v16
    v_add_u32 v19, 46080, v16
    s_mul_i32 s84, s18, 393216
    s_cmp_eq_u32 s18, 1
    s_cselect_b32 s85, 0, 393216
    s_cmp_eq_u32 s18, 2
    s_cselect_b32 s86, 0, 786432
    s_cmp_eq_u32 s18, 3
    s_cselect_b32 s87, 0, 1179648
    s_cmp_eq_u32 s18, 4
    s_cselect_b32 s88, 0, 1572864
    s_cmp_eq_u32 s18, 5
    s_cselect_b32 s89, 0, 1966080
    s_cmp_eq_u32 s18, 6
    s_cselect_b32 s90, 0, 2359296
    s_cmp_eq_u32 s18, 7
    s_cselect_b32 s91, 0, 2752512
    s_cmp_eq_u32 s18, 8
    s_cselect_b32 s92, 0, 3145728
    s_cmp_eq_u32 s18, 9
    s_cselect_b32 s93, 0, 3538944
    s_cmp_eq_u32 s18, 10
    s_cselect_b32 s94, 0, 3932160
    s_cmp_eq_u32 s18, 11
    s_cselect_b32 s95, 0, 4325376
    s_cmp_eq_u32 s18, 12
    s_cselect_b32 s96, 0, 4718592
    s_cmp_eq_u32 s18, 13
    s_cselect_b32 s97, 0, 5111808
    s_cmp_eq_u32 s18, 14
    s_cselect_b32 s98, 0, 5505024
    s_cmp_eq_u32 s18, 15
    s_cselect_b32 s99, 0, 5898240
    s_and_b32 s3, s16, 3
    s_mul_i32 s3, s3, 49152
    v_add_u32 v11, s3, v12
    s_and_b32 s3, s16, 3
    s_lshl_b32 s3, s3, 10
    v_add_u32 v9, s3, v1
    v_add_u32 v10, 0x10000, v9
    s_barrier
    s_setprio 3
    v_lshrrev_b32 v28, 4, v1
    v_and_b32 v29, 7, v28
    v_lshrrev_b32 v28, 3, v28
    v_mul_u32_u24 v28, 6144, v28
    v_lshl_add_u32 v28, v29, 4, v28
    s_and_b32 s3, s18, 12
    s_or_b32 s3, s3, 3
    s_lshl_b32 s3, s3, 7
    v_add_u32 v28, s3, v28
    s_lshr_b32 s3, s2, 3
    s_lshl_b32 s3, s3, 2
    s_and_b32 s60, s16, 3
    s_add_u32 s60, s60, s3
    s_lshr_b32 s60, s60, 2
    s_mul_i32 s60, s60, 49152
    s_and_b32 s3, s18, 0
    s_xor_b32 s3, s3, 0
    s_mul_i32 s3, s3, 393216
    s_add_u32 s3, s3, s60
    s_add_u32 s61, s3, 0
    buffer_load_dwordx4 v[160:163], v28, s[8:11], s61 offen
    s_add_u32 s61, s3, 2048
    buffer_load_dwordx4 v[164:167], v28, s[8:11], s61 offen
    s_add_u32 s61, s3, 4096
    buffer_load_dwordx4 v[168:171], v28, s[8:11], s61 offen
    s_setprio 0
    s_waitcnt vmcnt(3)
    v_lshrrev_b32 v24, 4, v1
    v_and_b32 v25, 1, v24
    v_lshlrev_b32 v25, 4, v25
    v_mov_b32 v26, 0x3f80
    v_lshlrev_b32 v25, v25, v26
    v_bfe_u32 v26, v24, 1, 2
    v_cmp_eq_u32 vcc, 0, v26
    s_nop 1
    v_cndmask_b32 v140, 0, v25, vcc
    v_cmp_eq_u32 vcc, 1, v26
    s_nop 1
    v_cndmask_b32 v141, 0, v25, vcc
    v_cmp_eq_u32 vcc, 2, v26
    s_nop 1
    v_cndmask_b32 v142, 0, v25, vcc
    v_cmp_eq_u32 vcc, 3, v26
    s_nop 1
    v_cndmask_b32 v143, 0, v25, vcc
    s_nop 1
    v_mfma_f32_16x16x32_bf16 v[128:131], v[140:143], v[32:35], 0
    v_mfma_f32_16x16x32_bf16 v[132:135], v[140:143], v[64:67], 0
    v_mfma_f32_16x16x32_bf16 v[136:139], v[140:143], v[96:99], 0
    v_mfma_f32_16x16x32_bf16 v[128:131], v[140:143], v[36:39], v[128:131]
    v_mfma_f32_16x16x32_bf16 v[132:135], v[140:143], v[68:71], v[132:135]
    v_mfma_f32_16x16x32_bf16 v[136:139], v[140:143], v[100:103], v[136:139]
    v_mfma_f32_16x16x32_bf16 v[128:131], v[140:143], v[40:43], v[128:131]
    v_mfma_f32_16x16x32_bf16 v[132:135], v[140:143], v[72:75], v[132:135]
    v_mfma_f32_16x16x32_bf16 v[136:139], v[140:143], v[104:107], v[136:139]
    v_mfma_f32_16x16x32_bf16 v[128:131], v[140:143], v[44:47], v[128:131]
    v_mfma_f32_16x16x32_bf16 v[132:135], v[140:143], v[76:79], v[132:135]
    v_mfma_f32_16x16x32_bf16 v[136:139], v[140:143], v[108:111], v[136:139]
    v_mfma_f32_16x16x32_bf16 v[128:131], v[140:143], v[48:51], v[128:131]
    v_mfma_f32_16x16x32_bf16 v[132:135], v[140:143], v[80:83], v[132:135]
    v_mfma_f32_16x16x32_bf16 v[136:139], v[140:143], v[112:115], v[136:139]
    v_mfma_f32_16x16x32_bf16 v[128:131], v[140:143], v[52:55], v[128:131]
    v_mfma_f32_16x16x32_bf16 v[132:135], v[140:143], v[84:87], v[132:135]
    v_mfma_f32_16x16x32_bf16 v[136:139], v[140:143], v[116:119], v[136:139]
    v_mfma_f32_16x16x32_bf16 v[128:131], v[140:143], v[56:59], v[128:131]
    v_mfma_f32_16x16x32_bf16 v[132:135], v[140:143], v[88:91], v[132:135]
    v_mfma_f32_16x16x32_bf16 v[136:139], v[140:143], v[120:123], v[136:139]
    v_mfma_f32_16x16x32_bf16 v[128:131], v[140:143], v[60:63], v[128:131]
    v_mfma_f32_16x16x32_bf16 v[132:135], v[140:143], v[92:95], v[132:135]
    v_mfma_f32_16x16x32_bf16 v[136:139], v[140:143], v[124:127], v[136:139]
    v_bfe_u32 v25, v24, 3, 1
    v_lshrrev_b32 v26, 5, v24
    v_lshl_add_u32 v26, v26, 1, v25
    v_lshlrev_b32 v25, 8, v26
    v_and_b32 v27, 7, v24
    v_lshl_add_u32 v25, v27, 5, v25
    v_bfe_u32 v27, v24, 4, 1
    v_lshl_add_u32 v25, v27, 4, v25
    v_add_f32_dpp v128, v128, v128 row_ror:8 row_mask:0xf bank_mask:0xf
    v_add_f32_dpp v129, v129, v129 row_ror:8 row_mask:0xf bank_mask:0xf
    v_add_f32_dpp v130, v130, v130 row_ror:8 row_mask:0xf bank_mask:0xf
    v_add_f32_dpp v131, v131, v131 row_ror:8 row_mask:0xf bank_mask:0xf
    v_add_f32_dpp v132, v132, v132 row_ror:8 row_mask:0xf bank_mask:0xf
    v_add_f32_dpp v133, v133, v133 row_ror:8 row_mask:0xf bank_mask:0xf
    v_add_f32_dpp v134, v134, v134 row_ror:8 row_mask:0xf bank_mask:0xf
    v_add_f32_dpp v135, v135, v135 row_ror:8 row_mask:0xf bank_mask:0xf
    v_add_f32_dpp v136, v136, v136 row_ror:8 row_mask:0xf bank_mask:0xf
    v_add_f32_dpp v137, v137, v137 row_ror:8 row_mask:0xf bank_mask:0xf
    v_add_f32_dpp v138, v138, v138 row_ror:8 row_mask:0xf bank_mask:0xf
    v_add_f32_dpp v139, v139, v139 row_ror:8 row_mask:0xf bank_mask:0xf
    v_cmp_le_u32 vcc, 1, v26
    s_nop 1
    v_cndmask_b32 v128, v128, v132, vcc
    v_cndmask_b32 v129, v129, v133, vcc
    v_cndmask_b32 v130, v130, v134, vcc
    v_cndmask_b32 v131, v131, v135, vcc
    v_cmp_le_u32 vcc, 2, v26
    s_nop 1
    v_cndmask_b32 v128, v128, v136, vcc
    v_cndmask_b32 v129, v129, v137, vcc
    v_cndmask_b32 v130, v130, v138, vcc
    v_cndmask_b32 v131, v131, v139, vcc
    v_add_u32 v27, s18, v26
    v_and_b32 v27, 15, v27
    v_lshl_add_u32 v25, v27, 14, v25
    s_lshl_b32 s44, s17, 10
    s_add_u32 s44, s44, 52428800
    buffer_store_dwordx4 v[128:131], v25, s[4:7], s44 offen sc1
    s_barrier
    v_lshrrev_b32 v28, 4, v1
    v_and_b32 v29, 7, v28
    v_lshrrev_b32 v28, 3, v28
    v_mul_u32_u24 v28, 6144, v28
    v_lshl_add_u32 v28, v29, 4, v28
    s_and_b32 s3, s18, 12
    s_or_b32 s3, s3, 3
    s_lshl_b32 s3, s3, 7
    v_add_u32 v28, s3, v28
    s_lshr_b32 s3, s2, 3
    s_lshl_b32 s3, s3, 2
    s_and_b32 s60, s16, 3
    s_add_u32 s60, s60, s3
    s_lshr_b32 s60, s60, 2
    s_mul_i32 s60, s60, 49152
    s_and_b32 s3, s18, 0
    s_xor_b32 s3, s3, 4
    s_mul_i32 s3, s3, 393216
    s_add_u32 s3, s3, s60
    s_add_u32 s61, s3, 0
    buffer_load_dwordx4 v[160:163], v28, s[8:11], s61 offen
    s_add_u32 s61, s3, 2048
    buffer_load_dwordx4 v[164:167], v28, s[8:11], s61 offen
    s_add_u32 s61, s3, 4096
    buffer_load_dwordx4 v[168:171], v28, s[8:11], s61 offen
    s_and_b32 s3, s18, 0
    s_xor_b32 s3, s3, 8
    s_mul_i32 s3, s3, 393216
    s_add_u32 s3, s3, s60
    s_add_u32 s61, s3, 0
    buffer_load_dwordx4 v[172:175], v28, s[8:11], s61 offen
    s_add_u32 s61, s3, 2048
    buffer_load_dwordx4 v[176:179], v28, s[8:11], s61 offen
    s_add_u32 s61, s3, 4096
    buffer_load_dwordx4 v[180:183], v28, s[8:11], s61 offen
    s_and_b32 s3, s18, 0
    s_xor_b32 s3, s3, 12
    s_mul_i32 s3, s3, 393216
    s_add_u32 s3, s3, s60
    s_add_u32 s61, s3, 0
    buffer_load_dwordx4 v[184:187], v28, s[8:11], s61 offen
    s_add_u32 s61, s3, 2048
    buffer_load_dwordx4 v[188:191], v28, s[8:11], s61 offen
    s_add_u32 s61, s3, 4096
    buffer_load_dwordx4 v[192:195], v28, s[8:11], s61 offen
    s_barrier
    s_barrier
    s_waitcnt vmcnt(0)
    s_add_u32 s44, s18, 0
    s_and_b32 s44, s44, 15
    s_lshl_b32 s44, s44, 7
    s_add_u32 s44, s44, 0
    s_atomic_add s40, s[22:23], s44
    s_add_u32 s45, s18, 1
    s_and_b32 s45, s45, 15
    s_lshl_b32 s45, s45, 7
    s_add_u32 s45, s45, 0
    s_atomic_add s40, s[22:23], s45
    s_add_u32 s46, s18, 2
    s_and_b32 s46, s46, 15
    s_lshl_b32 s46, s46, 7
    s_add_u32 s46, s46, 0
    s_atomic_add s40, s[22:23], s46
    s_barrier
    s_barrier
    s_barrier
    s_bfe_u32 s48, s2, 0x20003
    s_min_u32 s48, s48, 4
    s_max_u32 s48, s48, 4
    s_sub_u32 s49, 5, s48
z_n3:
    s_cmp_eq_u32 s48, 0
    s_cbranch_scc1 z_n3e
    s_barrier
    s_sub_u32 s48, s48, 1
    s_branch z_n3
z_n3e:
    s_mov_b32 s12, s26
    s_mov_b32 s13, s27
    s_mov_b32 s14, 2097152
    s_mov_b32 s15, 0x00020000
    s_lshl_b32 s44, s2, 13
    buffer_load_dwordx4 v[160:163], v1, s[12:15], s44 offen offset:0
    buffer_load_dwordx4 v[164:167], v1, s[12:15], s44 offen offset:1024
    buffer_load_dwordx4 v[168:171], v1, s[12:15], s44 offen offset:2048
    buffer_load_dwordx4 v[172:175], v1, s[12:15], s44 offen offset:3072
    s_add_u32 s44, s44, 4096
    buffer_load_dwordx4 v[176:179], v1, s[12:15], s44 offen offset:0
    buffer_load_dwordx4 v[180:183], v1, s[12:15], s44 offen offset:1024
    buffer_load_dwordx4 v[184:187], v1, s[12:15], s44 offen offset:2048
    buffer_load_dwordx4 v[188:191], v1, s[12:15], s44 offen offset:3072
    s_mov_b32 s8, s28
    s_mov_b32 s9, s29
    s_mov_b32 s10, 6291456
    s_mov_b32 s11, 0x00020000
    s_mul_i32 s44, s17, 393216
    buffer_load_dwordx4 v[32:35], v20, s[8:11], s44 offen
    buffer_load_dwordx4 v[64:67], v21, s[8:11], s44 offen
    buffer_load_dwordx4 v[96:99], v22, s[8:11], s44 offen
    s_add_u32 s44, s44, 49152
    buffer_load_dwordx4 v[36:39], v20, s[8:11], s44 offen
    buffer_load_dwordx4 v[68:71], v21, s[8:11], s44 offen
    buffer_load_dwordx4 v[100:103], v22, s[8:11], s44 offen
    s_add_u32 s44, s44, 49152
    buffer_load_dwordx4 v[40:43], v20, s[8:11], s44 offen
    buffer_load_dwordx4 v[72:75], v21, s[8:11], s44 offen
    buffer_load_dwordx4 v[104:107], v22, s[8:11], s44 offen
    s_add_u32 s44, s44, 49152
    s_barrier
    buffer_load_dwordx4 v[44:47], v20, s[8:11], s44 offen
    buffer_load_dwordx4 v[76:79], v21, s[8:11], s44 offen
    buffer_load_dwordx4 v[108:111], v22, s[8:11], s44 offen
    s_add_u32 s44, s44, 49152
    buffer_load_dwordx4 v[48:51], v20, s[8:11], s44 offen
    buffer_load_dwordx4 v[80:83], v21, s[8:11], s44 offen
    buffer_load_dwordx4 v[112:115], v22, s[8:11], s44 offen
    s_add_u32 s44, s44, 49152
    buffer_load_dwordx4 v[52:55], v20, s[8:11], s44 offen
    buffer_load_dwordx4 v[84:87], v21, s[8:11], s44 offen
    buffer_load_dwordx4 v[116:119], v22, s[8:11], s44 offen
    s_add_u32 s44, s44, 49152
    buffer_load_dwordx4 v[56:59], v20, s[8:11], s44 offen
    buffer_load_dwordx4 v[88:91], v21, s[8:11], s44 offen
    buffer_load_dwordx4 v[120:123], v22, s[8:11], s44 offen
    s_add_u32 s44, s44, 49152
    buffer_load_dwordx4 v[60:63], v20, s[8:11], s44 offen
    buffer_load_dwordx4 v[92:95], v21, s[8:11], s44 offen
    buffer_load_dwordx4 v[124:127], v22, s[8:11], s44 offen
z_n4:
    s_cmp_eq_u32 s49, 0
    s_cbranch_scc1 z_n4e
    s_barrier
    s_sub_u32 s49, s49, 1
    s_branch z_n4
z_n4e:
    s_bitcmp1_b32 s21, 0
    s_cselect_b32 s8, s28, s24
    s_cselect_b32 s9, s29, s25
    s_cselect_b32 s12, s30, s26
    s_cselect_b32 s13, s31, s27
    s_mov_b32 s10, 6291456
    s_mov_b32 s11, 0x00020000
    s_mov_b32 s14, 2097152
    s_mov_b32 s15, 0x00020000
    s_branch s_tail
z_layer:
    s_waitcnt lgkmcnt(0)
    v_lshrrev_b32 v28, 4, v1
    v_and_b32 v29, 7, v28
    v_lshrrev_b32 v28, 3, v28
    v_mul_u32_u24 v28, 6144, v28
    v_lshl_add_u32 v28, v29, 4, v28
    s_and_b32 s3, s18, 12
    s_or_b32 s3, s3, 3
    s_lshl_b32 s3, s3, 7
    v_add_u32 v28, s3, v28
    s_lshr_b32 s3, s2, 3
    s_lshl_b32 s3, s3, 2
    s_and_b32 s60, s16, 3
    s_add_u32 s60, s60, s3
    s_lshr_b32 s60, s60, 2
    s_mul_i32 s60, s60, 49152
    s_and_b32 s3, s18, 0
    s_xor_b32 s3, s3, 4
    s_mul_i32 s3, s3, 393216
    s_add_u32 s3, s3, s60
    s_add_u32 s61, s3, 0
    buffer_load_dwordx4 v[160:163], v28, s[8:11], s61 offen
    s_add_u32 s61, s3, 2048
    buffer_load_dwordx4 v[164:167], v28, s[8:11], s61 offen
    s_add_u32 s61, s3, 4096
    buffer_load_dwordx4 v[168:171], v28, s[8:11], s61 offen
    s_and_b32 s3, s18, 0
    s_xor_b32 s3, s3, 8
    s_mul_i32 s3, s3, 393216
    s_add_u32 s3, s3, s60
    s_add_u32 s61, s3, 0
    buffer_load_dwordx4 v[172:175], v28, s[8:11], s61 offen
    s_add_u32 s61, s3, 2048
    buffer_load_dwordx4 v[176:179], v28, s[8:11], s61 offen
    s_add_u32 s61, s3, 4096
    buffer_load_dwordx4 v[180:183], v28, s[8:11], s61 offen
    s_and_b32 s3, s18, 0
    s_xor_b32 s3, s3, 12
    s_mul_i32 s3, s3, 393216
    s_add_u32 s3, s3, s60
    s_add_u32 s61, s3, 0
    buffer_load_dwordx4 v[184:187], v28, s[8:11], s61 offen
    s_add_u32 s61, s3, 2048
    buffer_load_dwordx4 v[188:191], v28, s[8:11], s61 offen
    s_add_u32 s61, s3, 4096
    buffer_load_dwordx4 v[192:195], v28, s[8:11], s61 offen
    s_barrier
    s_barrier
    s_barrier
    s_barrier
    s_barrier
    s_barrier
    s_barrier
    s_barrier
    s_barrier
    s_barrier
    v_lshrrev_b32 v28, 4, v1
    v_and_b32 v29, 7, v28
    v_lshrrev_b32 v28, 3, v28
    v_mul_u32_u24 v28, 2048, v28
    v_lshl_add_u32 v28, v29, 4, v28
    s_and_b32 s3, s20, 12
    s_or_b32 s3, s3, 3
    s_lshl_b32 s3, s3, 7
    v_add_u32 v28, s3, v28
    s_lshr_b32 s3, s2, 3
    s_lshl_b32 s3, s3, 2
    s_and_b32 s60, s16, 3
    s_add_u32 s60, s60, s3
    s_lshl_b32 s61, s60, 14
    buffer_load_dwordx4 v[144:147], v28, s[12:15], s61 offen
    s_bitcmp0_b32 s21, 0
    s_cselect_b32 s56, s28, s24
    s_cselect_b32 s57, s29, s25
    s_mov_b32 s58, 6291456
    s_mov_b32 s59, 0x00020000
    v_lshrrev_b32 v28, 4, v1
    v_and_b32 v29, 7, v28
    v_lshrrev_b32 v28, 3, v28
    v_mul_u32_u24 v28, 6144, v28
    v_lshl_add_u32 v28, v29, 4, v28
    s_and_b32 s3, s18, 12
    s_or_b32 s3, s3, 3
    s_lshl_b32 s3, s3, 7
    v_add_u32 v28, s3, v28
    s_lshr_b32 s3, s2, 3
    s_lshl_b32 s3, s3, 2
    s_and_b32 s60, s16, 3
    s_add_u32 s60, s60, s3
    s_and_b32 s3, s60, 31
    s_mul_i32 s3, s3, 49152
    s_lshr_b32 s61, s60, 5
    s_min_u32 s61, s61, 2
    s_lshl_b32 s61, s61, 11
    s_add_u32 s61, s61, s3
    s_and_b32 s3, s18, 0
    s_mul_i32 s3, s3, 393216
    s_add_u32 s61, s61, s3
    buffer_load_dwordx4 v[148:151], v28, s[56:59], s61 offen
    s_cmp_lg_u32 s21, 2
    s_cbranch_scc1 z_pe
    s_bitcmp0_b32 s21, 0
    s_cselect_b32 s56, s28, s24
    s_cselect_b32 s57, s29, s25
    s_mov_b32 s58, 6291456
    s_mov_b32 s59, 0x00020000
    s_add_u32 s61, s84, 2048
    buffer_load_dwordx4 v[160:163], v11, s[56:59], s61 offen
    s_add_u32 s61, s84, 4096
    buffer_load_dwordx4 v[164:167], v11, s[56:59], s61 offen
    s_add_u32 s61, s84, 0
    buffer_load_dwordx4 v[168:171], v11, s[56:59], s61 offen
    s_add_u32 s61, s84, 198656
    buffer_load_dwordx4 v[172:175], v11, s[56:59], s61 offen
    s_add_u32 s61, s84, 200704
    buffer_load_dwordx4 v[176:179], v11, s[56:59], s61 offen
    s_add_u32 s61, s84, 196608
    buffer_load_dwordx4 v[180:183], v11, s[56:59], s61 offen
    s_add_u32 s61, s85, 2048
    buffer_load_dwordx4 v[184:187], v11, s[56:59], s61 offen
    s_add_u32 s61, s85, 4096
    buffer_load_dwordx4 v[188:191], v11, s[56:59], s61 offen
    s_add_u32 s61, s85, 0
    buffer_load_dwordx4 v[192:195], v11, s[56:59], s61 offen
    s_add_u32 s61, s85, 198656
    buffer_load_dwordx4 v[196:199], v11, s[56:59], s61 offen
z_pe:
    s_barrier
    s_branch s_tail
s_tail:
    s_bitcmp1_b32 s21, 0
    s_cbranch_scc1 s_B
    s_cmp_lg_u32 s16, 4
    s_cbranch_scc1 s_a1
    s_mov_b32 s45, 2146435072
    s_cmp_eq_u32 s17, 0
    s_cbranch_scc1 s_a0
    s_lshr_b32 s46, s21, 1
    s_lshl_b32 s44, s46, 15
    s_lshl_b32 s67, s17, 11
    s_add_u32 s44, s44, s67
    s_lshl_b32 s67, s18, 7
    s_add_u32 s44, s44, s67
    s_add_u32 s44, s44, 149504
    s_sub_u32 s45, s44, 151552
    s_lshl_b32 s45, s45, 5
    s_add_u32 s45, s45, 54525952
    s_mov_b32 s66, 0x10000
s_h_poll:
    s_mov_b32 s68, 0
    s_atomic_add s68, s[22:23], s44 offset:0 glc
    s_sub_u32 s66, s66, 1
    s_cselect_b32 s67, 1, 0
    s_waitcnt lgkmcnt(0)
    s_max_u32 s68, s68, s67
    s_cmp_lt_u32 s68, 1
    s_cbranch_scc1 s_h_poll
s_h_ok:
s_a0:
    s_mov_b32 m0, 131072
    s_nop 0
    buffer_load_dwordx4 v1, s[4:7], s45 offen offset:0 sc1 lds
    buffer_load_dwordx4 v1, s[4:7], s45 offen offset:1024 sc1 lds
    buffer_load_dwordx4 v1, s[4:7], s45 offen offset:2048 sc1 lds
    buffer_load_dwordx4 v1, s[4:7], s45 offen offset:3072 sc1 lds
    s_waitcnt vmcnt(0)
s_a1:
    s_barrier
    s_waitcnt vmcnt(0)
    s_barrier
    s_sub_u32 s3, s16, 5
    s_cmp_gt_u32 s3, 1
    s_cbranch_scc1 s_a2
    s_add_u32 m0, s41, 65536
    s_xor_b32 s44, s62, 65536
    buffer_load_dwordx4 v16, s[12:15], s44 offen offset:0 lds
    buffer_load_dwordx4 v17, s[12:15], s44 offen offset:1024 lds
    s_add_u32 m0, s41, 69632
    s_xor_b32 s44, s62, 196608
    buffer_load_dwordx4 v16, s[12:15], s44 offen offset:0 lds
    buffer_load_dwordx4 v17, s[12:15], s44 offen offset:1024 lds
    s_add_u32 m0, s41, 73728
    s_xor_b32 s44, s62, 327680
    buffer_load_dwordx4 v16, s[12:15], s44 offen offset:0 lds
    buffer_load_dwordx4 v17, s[12:15], s44 offen offset:1024 lds
    s_add_u32 m0, s41, 77824
    s_xor_b32 s44, s62, 458752
    buffer_load_dwordx4 v16, s[12:15], s44 offen offset:0 lds
    buffer_load_dwordx4 v17, s[12:15], s44 offen offset:1024 lds
    s_add_u32 m0, s41, 81920
    s_xor_b32 s44, s62, 589824
    buffer_load_dwordx4 v16, s[12:15], s44 offen offset:0 lds
    buffer_load_dwordx4 v17, s[12:15], s44 offen offset:1024 lds
    s_add_u32 m0, s41, 86016
    s_xor_b32 s44, s62, 720896
    buffer_load_dwordx4 v16, s[12:15], s44 offen offset:0 lds
    buffer_load_dwordx4 v17, s[12:15], s44 offen offset:1024 lds
    s_add_u32 m0, s41, 90112
    s_xor_b32 s44, s62, 851968
    buffer_load_dwordx4 v16, s[12:15], s44 offen offset:0 lds
    buffer_load_dwordx4 v17, s[12:15], s44 offen offset:1024 lds
    s_add_u32 m0, s41, 94208
    s_xor_b32 s44, s62, 983040
    buffer_load_dwordx4 v16, s[12:15], s44 offen offset:0 lds
    buffer_load_dwordx4 v17, s[12:15], s44 offen offset:1024 lds
    s_add_u32 m0, s41, 98304
    s_xor_b32 s44, s62, 1114112
    buffer_load_dwordx4 v16, s[12:15], s44 offen offset:0 lds
    buffer_load_dwordx4 v17, s[12:15], s44 offen offset:1024 lds
    s_add_u32 m0, s41, 102400
    s_xor_b32 s44, s62, 1245184
    buffer_load_dwordx4 v16, s[12:15], s44 offen offset:0 lds
    buffer_load_dwordx4 v17, s[12:15], s44 offen offset:1024 lds
    s_add_u32 m0, s41, 106496
    s_xor_b32 s44, s62, 1376256
    buffer_load_dwordx4 v16, s[12:15], s44 offen offset:0 lds
    buffer_load_dwordx4 v17, s[12:15], s44 offen offset:1024 lds
    s_add_u32 m0, s41, 110592
    s_xor_b32 s44, s62, 1507328
    buffer_load_dwordx4 v16, s[12:15], s44 offen offset:0 lds
    buffer_load_dwordx4 v17, s[12:15], s44 offen offset:1024 lds
    s_add_u32 m0, s41, 114688
    s_xor_b32 s44, s62, 1638400
    buffer_load_dwordx4 v16, s[12:15], s44 offen offset:0 lds
    buffer_load_dwordx4 v17, s[12:15], s44 offen offset:1024 lds
    s_add_u32 m0, s41, 118784
    s_xor_b32 s44, s62, 1769472
    buffer_load_dwordx4 v16, s[12:15], s44 offen offset:0 lds
    buffer_load_dwordx4 v17, s[12:15], s44 offen offset:1024 lds
    s_add_u32 m0, s41, 122880
    s_xor_b32 s44, s62, 1900544
    buffer_load_dwordx4 v16, s[12:15], s44 offen offset:0 lds
    buffer_load_dwordx4 v17, s[12:15], s44 offen offset:1024 lds
    s_add_u32 m0, s41, 126976
    s_xor_b32 s44, s62, 2031616
    buffer_load_dwordx4 v16, s[12:15], s44 offen offset:0 lds
    buffer_load_dwordx4 v17, s[12:15], s44 offen offset:1024 lds
s_a2:
    s_cmp_eq_u32 s21, 2
    s_cbranch_scc1 s_a3
    s_bitcmp0_b32 s21, 0
    s_cselect_b32 s56, s28, s24
    s_cselect_b32 s57, s29, s25
    s_mov_b32 s58, 6291456
    s_mov_b32 s59, 0x00020000
    s_add_u32 s61, s84, 2048
    buffer_load_dwordx4 v[160:163], v11, s[56:59], s61 offen
    s_add_u32 s61, s84, 4096
    buffer_load_dwordx4 v[164:167], v11, s[56:59], s61 offen
    s_add_u32 s61, s84, 0
    buffer_load_dwordx4 v[168:171], v11, s[56:59], s61 offen
    s_add_u32 s61, s84, 198656
    buffer_load_dwordx4 v[172:175], v11, s[56:59], s61 offen
    s_add_u32 s61, s84, 200704
    buffer_load_dwordx4 v[176:179], v11, s[56:59], s61 offen
    s_add_u32 s61, s84, 196608
    buffer_load_dwordx4 v[180:183], v11, s[56:59], s61 offen
    s_add_u32 s61, s85, 2048
    buffer_load_dwordx4 v[184:187], v11, s[56:59], s61 offen
    s_add_u32 s61, s85, 4096
    buffer_load_dwordx4 v[188:191], v11, s[56:59], s61 offen
    s_add_u32 s61, s85, 0
    buffer_load_dwordx4 v[192:195], v11, s[56:59], s61 offen
    s_add_u32 s61, s85, 198656
    buffer_load_dwordx4 v[196:199], v11, s[56:59], s61 offen
s_a3:
    s_bitcmp0_b32 s21, 0
    s_cselect_b32 s56, s28, s24
    s_cselect_b32 s57, s29, s25
    s_mov_b32 s58, 6291456
    s_mov_b32 s59, 0x00020000
    s_add_u32 s61, s85, 200704
    buffer_load_dwordx4 v[200:203], v11, s[56:59], s61 offen
    s_add_u32 s61, s85, 196608
    buffer_load_dwordx4 v[204:207], v11, s[56:59], s61 offen
    s_add_u32 s61, s86, 2048
    buffer_load_dwordx4 v[208:211], v11, s[56:59], s61 offen
    s_add_u32 s61, s86, 4096
    buffer_load_dwordx4 v[212:215], v11, s[56:59], s61 offen
    s_add_u32 s61, s86, 0
    buffer_load_dwordx4 v[216:219], v11, s[56:59], s61 offen
    s_add_u32 s61, s86, 198656
    buffer_load_dwordx4 v[220:223], v11, s[56:59], s61 offen
    s_add_u32 s61, s86, 200704
    buffer_load_dwordx4 v[224:227], v11, s[56:59], s61 offen
    s_add_u32 s61, s86, 196608
    buffer_load_dwordx4 v[228:231], v11, s[56:59], s61 offen
    s_add_u32 s61, s87, 2048
    buffer_load_dwordx4 v[232:235], v11, s[56:59], s61 offen
    s_add_u32 s61, s87, 4096
    buffer_load_dwordx4 v[236:239], v11, s[56:59], s61 offen
    s_add_u32 s61, s87, 0
    buffer_load_dwordx4 v[240:243], v11, s[56:59], s61 offen
    s_add_u32 s61, s87, 198656
    buffer_load_dwordx4 v[244:247], v11, s[56:59], s61 offen
    s_add_u32 s61, s87, 200704
    buffer_load_dwordx4 v[248:251], v11, s[56:59], s61 offen
    s_add_u32 s61, s87, 196608
    buffer_load_dwordx4 v[252:255], v11, s[56:59], s61 offen
    s_waitcnt vmcnt(0)
    s_lshl_b32 s3, s21, 3
    s_add_u32 s3, s3, s16
    s_cmp_lg_u32 s3, 7
    s_cbranch_scc1 s_g3
    v_lshrrev_b32 v24, 4, v1
    v_and_b32 v25, 1, v24
    v_lshlrev_b32 v25, 4, v25
    v_mov_b32 v26, 0x3f80
    v_lshlrev_b32 v25, v25, v26
    v_bfe_u32 v26, v24, 1, 2
    v_cmp_eq_u32 vcc, 0, v26
    s_nop 1
    v_cndmask_b32 v140, 0, v25, vcc
    v_cmp_eq_u32 vcc, 1, v26
    s_nop 1
    v_cndmask_b32 v141, 0, v25, vcc
    v_cmp_eq_u32 vcc, 2, v26
    s_nop 1
    v_cndmask_b32 v142, 0, v25, vcc
    v_cmp_eq_u32 vcc, 3, v26
    s_nop 1
    v_cndmask_b32 v143, 0, v25, vcc
    s_nop 1
    v_mfma_f32_16x16x32_bf16 v[128:131], v[140:143], v[32:35], 0
    v_mfma_f32_16x16x32_bf16 v[132:135], v[140:143], v[64:67], 0
    v_mfma_f32_16x16x32_bf16 v[136:139], v[140:143], v[96:99], 0
    v_mfma_f32_16x16x32_bf16 v[128:131], v[140:143], v[36:39], v[128:131]
    v_mfma_f32_16x16x32_bf16 v[132:135], v[140:143], v[68:71], v[132:135]
    v_mfma_f32_16x16x32_bf16 v[136:139], v[140:143], v[100:103], v[136:139]
    v_mfma_f32_16x16x32_bf16 v[128:131], v[140:143], v[40:43], v[128:131]
    v_mfma_f32_16x16x32_bf16 v[132:135], v[140:143], v[72:75], v[132:135]
    v_mfma_f32_16x16x32_bf16 v[136:139], v[140:143], v[104:107], v[136:139]
    v_mfma_f32_16x16x32_bf16 v[128:131], v[140:143], v[44:47], v[128:131]
    v_mfma_f32_16x16x32_bf16 v[132:135], v[140:143], v[76:79], v[132:135]
    v_mfma_f32_16x16x32_bf16 v[136:139], v[140:143], v[108:111], v[136:139]
    v_mfma_f32_16x16x32_bf16 v[128:131], v[140:143], v[48:51], v[128:131]
    v_mfma_f32_16x16x32_bf16 v[132:135], v[140:143], v[80:83], v[132:135]
    v_mfma_f32_16x16x32_bf16 v[136:139], v[140:143], v[112:115], v[136:139]
    v_mfma_f32_16x16x32_bf16 v[128:131], v[140:143], v[52:55], v[128:131]
    v_mfma_f32_16x16x32_bf16 v[132:135], v[140:143], v[84:87], v[132:135]
    v_mfma_f32_16x16x32_bf16 v[136:139], v[140:143], v[116:119], v[136:139]
    v_mfma_f32_16x16x32_bf16 v[128:131], v[140:143], v[56:59], v[128:131]
    v_mfma_f32_16x16x32_bf16 v[132:135], v[140:143], v[88:91], v[132:135]
    v_mfma_f32_16x16x32_bf16 v[136:139], v[140:143], v[120:123], v[136:139]
    v_mfma_f32_16x16x32_bf16 v[128:131], v[140:143], v[60:63], v[128:131]
    v_mfma_f32_16x16x32_bf16 v[132:135], v[140:143], v[92:95], v[132:135]
    v_mfma_f32_16x16x32_bf16 v[136:139], v[140:143], v[124:127], v[136:139]
    v_bfe_u32 v25, v24, 3, 1
    v_lshrrev_b32 v26, 5, v24
    v_lshl_add_u32 v26, v26, 1, v25
    v_lshlrev_b32 v25, 8, v26
    v_and_b32 v27, 7, v24
    v_lshl_add_u32 v25, v27, 5, v25
    v_bfe_u32 v27, v24, 4, 1
    v_lshl_add_u32 v25, v27, 4, v25
    v_add_f32_dpp v128, v128, v128 row_ror:8 row_mask:0xf bank_mask:0xf
    v_add_f32_dpp v129, v129, v129 row_ror:8 row_mask:0xf bank_mask:0xf
    v_add_f32_dpp v130, v130, v130 row_ror:8 row_mask:0xf bank_mask:0xf
    v_add_f32_dpp v131, v131, v131 row_ror:8 row_mask:0xf bank_mask:0xf
    v_add_f32_dpp v132, v132, v132 row_ror:8 row_mask:0xf bank_mask:0xf
    v_add_f32_dpp v133, v133, v133 row_ror:8 row_mask:0xf bank_mask:0xf
    v_add_f32_dpp v134, v134, v134 row_ror:8 row_mask:0xf bank_mask:0xf
    v_add_f32_dpp v135, v135, v135 row_ror:8 row_mask:0xf bank_mask:0xf
    v_add_f32_dpp v136, v136, v136 row_ror:8 row_mask:0xf bank_mask:0xf
    v_add_f32_dpp v137, v137, v137 row_ror:8 row_mask:0xf bank_mask:0xf
    v_add_f32_dpp v138, v138, v138 row_ror:8 row_mask:0xf bank_mask:0xf
    v_add_f32_dpp v139, v139, v139 row_ror:8 row_mask:0xf bank_mask:0xf
    v_cmp_le_u32 vcc, 1, v26
    s_nop 1
    v_cndmask_b32 v128, v128, v132, vcc
    v_cndmask_b32 v129, v129, v133, vcc
    v_cndmask_b32 v130, v130, v134, vcc
    v_cndmask_b32 v131, v131, v135, vcc
    v_cmp_le_u32 vcc, 2, v26
    s_nop 1
    v_cndmask_b32 v128, v128, v136, vcc
    v_cndmask_b32 v129, v129, v137, vcc
    v_cndmask_b32 v130, v130, v138, vcc
    v_cndmask_b32 v131, v131, v139, vcc
    v_add_u32 v27, s18, v26
    v_and_b32 v27, 15, v27
    v_lshl_add_u32 v25, v27, 14, v25
    s_lshl_b32 s44, s17, 10
    s_add_u32 s44, s44, 52690944
    buffer_store_dwordx4 v[128:131], v25, s[4:7], s44 offen sc1
    s_waitcnt vmcnt(0)
    s_add_u32 s44, s18, 0
    s_and_b32 s44, s44, 15
    s_lshl_b32 s44, s44, 7
    s_add_u32 s44, s44, 2048
    s_atomic_add s40, s[22:23], s44
    s_add_u32 s45, s18, 1
    s_and_b32 s45, s45, 15
    s_lshl_b32 s45, s45, 7
    s_add_u32 s45, s45, 2048
    s_atomic_add s40, s[22:23], s45
    s_add_u32 s46, s18, 2
    s_and_b32 s46, s46, 15
    s_lshl_b32 s46, s46, 7
    s_add_u32 s46, s46, 2048
    s_atomic_add s40, s[22:23], s46
    s_branch s_g3
s_B:
    s_barrier
    s_cmp_eq_u32 s21, 3
    s_cbranch_scc1 s_nopf
    s_bitcmp0_b32 s21, 0
    s_cselect_b32 s56, s28, s24
    s_cselect_b32 s57, s29, s25
    s_mov_b32 s58, 6291456
    s_mov_b32 s59, 0x00020000
    s_add_u32 s61, s84, 2048
    buffer_load_dwordx4 v[160:163], v11, s[56:59], s61 offen
    s_add_u32 s61, s84, 4096
    buffer_load_dwordx4 v[164:167], v11, s[56:59], s61 offen
    s_add_u32 s61, s84, 0
    buffer_load_dwordx4 v[168:171], v11, s[56:59], s61 offen
    s_add_u32 s61, s84, 198656
    buffer_load_dwordx4 v[172:175], v11, s[56:59], s61 offen
    s_waitcnt vmcnt(2)
    s_add_u32 s61, s84, 200704
    buffer_load_dwordx4 v[176:179], v11, s[56:59], s61 offen
    s_add_u32 s61, s84, 196608
    buffer_load_dwordx4 v[180:183], v11, s[56:59], s61 offen
    s_add_u32 s61, s85, 2048
    buffer_load_dwordx4 v[184:187], v11, s[56:59], s61 offen
    s_add_u32 s61, s85, 4096
    buffer_load_dwordx4 v[188:191], v11, s[56:59], s61 offen
    s_waitcnt vmcnt(2)
    s_add_u32 s61, s85, 0
    buffer_load_dwordx4 v[192:195], v11, s[56:59], s61 offen
    s_add_u32 s61, s85, 198656
    buffer_load_dwordx4 v[196:199], v11, s[56:59], s61 offen
    s_add_u32 s61, s85, 200704
    buffer_load_dwordx4 v[200:203], v11, s[56:59], s61 offen
    s_add_u32 s61, s85, 196608
    buffer_load_dwordx4 v[204:207], v11, s[56:59], s61 offen
    s_waitcnt vmcnt(2)
    s_add_u32 s61, s86, 2048
    buffer_load_dwordx4 v[208:211], v11, s[56:59], s61 offen
    s_add_u32 s61, s86, 4096
    buffer_load_dwordx4 v[212:215], v11, s[56:59], s61 offen
    s_add_u32 s61, s86, 0
    buffer_load_dwordx4 v[216:219], v11, s[56:59], s61 offen
    s_add_u32 s61, s86, 198656
    buffer_load_dwordx4 v[220:223], v11, s[56:59], s61 offen
    s_waitcnt vmcnt(2)
    s_add_u32 s61, s86, 200704
    buffer_load_dwordx4 v[224:227], v11, s[56:59], s61 offen
    s_add_u32 s61, s86, 196608
    buffer_load_dwordx4 v[228:231], v11, s[56:59], s61 offen
    s_add_u32 s61, s87, 2048
    buffer_load_dwordx4 v[232:235], v11, s[56:59], s61 offen
    s_add_u32 s61, s87, 4096
    buffer_load_dwordx4 v[236:239], v11, s[56:59], s61 offen
    s_waitcnt vmcnt(2)
    s_add_u32 s61, s87, 0
    buffer_load_dwordx4 v[240:243], v11, s[56:59], s61 offen
    s_add_u32 s61, s87, 198656
    buffer_load_dwordx4 v[244:247], v11, s[56:59], s61 offen
    s_add_u32 s61, s87, 200704
    buffer_load_dwordx4 v[248:251], v11, s[56:59], s61 offen
    s_add_u32 s61, s87, 196608
    buffer_load_dwordx4 v[252:255], v11, s[56:59], s61 offen
    s_waitcnt vmcnt(2)
    s_lshl_b32 s3, s2, 2
    s_and_b32 s60, s16, 3
    s_add_u32 s60, s60, s3
    s_lshl_b32 s60, s60, 11
    buffer_load_dwordx4 v[96:99], v1, s[12:15], s60 offen offset:0
    buffer_load_dwordx4 v[100:103], v1, s[12:15], s60 offen offset:1024
s_nopf:
    s_setprio 3
    s_mov_b32 s52, 0
    s_lshl_b32 s44, s16, 14
    v_add_u32 v24, s44, v1
    s_and_b32 s3, s16, 3
    s_lshl_b32 s44, s3, 10
    s_add_u32 s44, s44, 147456
    v_lshrrev_b32 v25, 2, v1
    v_add_u32 v25, s44, v25
    s_lshl_b32 s53, s21, 22
    s_lshl_b32 s44, s38, 16
    s_add_u32 s53, s53, s44
    s_lshl_b32 s44, s18, 12
    s_add_u32 s53, s53, s44
    s_add_u32 s53, s53, 16777216
    s_lshl_b32 s54, s21, 14
    s_lshl_b32 s67, s38, 8
    s_add_u32 s54, s54, s67
    s_add_u32 s54, s54, 86016
s_bhead:
    s_barrier
    s_waitcnt vmcnt(0) lgkmcnt(0)
    s_barrier
    ds_read_b32 v28, v25 offset:0
    ds_read_b32 v29, v25 offset:256
    ds_read_b32 v30, v25 offset:512
    ds_read_b32 v31, v25 offset:768
    ds_read_b128 v[32:35], v24 offset:0
    ds_read_b128 v[36:39], v24 offset:1024
    ds_read_b128 v[40:43], v24 offset:2048
    ds_read_b128 v[44:47], v24 offset:3072
    ds_read_b128 v[48:51], v24 offset:4096
    ds_read_b128 v[52:55], v24 offset:5120
    ds_read_b128 v[56:59], v24 offset:6144
    ds_read_b128 v[60:63], v24 offset:7168
    ds_read_b128 v[64:67], v24 offset:8192
    ds_read_b128 v[68:71], v24 offset:9216
    ds_read_b128 v[72:75], v24 offset:10240
    ds_read_b128 v[76:79], v24 offset:11264
    ds_read_b128 v[80:83], v24 offset:12288
    ds_read_b128 v[84:87], v24 offset:13312
    ds_read_b128 v[88:91], v24 offset:14336
    ds_read_b128 v[92:95], v24 offset:15360
    s_waitcnt lgkmcnt(14)
    v_add_f32 v28, v28, v29
    v_add_f32 v30, v30, v31
    v_add_f32 v28, v28, v30
    v_mov_b32 v29, 0x5d800000
    v_mov_b32 v30, 0x21800000
    v_cmp_nlt_f32 s[44:45], v28, v29
    v_cmp_ngt_f32 vcc, v28, v30
    v_rcp_f32 v28, v28
    s_or_b64 vcc, vcc, s[44:45]
    s_waitcnt lgkmcnt(8)
    v_pk_add_f32 v[32:33], v[32:33], v[48:49]
    v_pk_add_f32 v[34:35], v[34:35], v[50:51]
    v_pk_add_f32 v[36:37], v[36:37], v[52:53]
    v_pk_add_f32 v[38:39], v[38:39], v[54:55]
    v_pk_add_f32 v[40:41], v[40:41], v[56:57]
    v_pk_add_f32 v[42:43], v[42:43], v[58:59]
    v_pk_add_f32 v[44:45], v[44:45], v[60:61]
    v_pk_add_f32 v[46:47], v[46:47], v[62:63]
    s_waitcnt lgkmcnt(4)
    v_pk_add_f32 v[32:33], v[32:33], v[64:65]
    v_pk_add_f32 v[34:35], v[34:35], v[66:67]
    v_pk_add_f32 v[36:37], v[36:37], v[68:69]
    v_pk_add_f32 v[38:39], v[38:39], v[70:71]
    v_pk_add_f32 v[40:41], v[40:41], v[72:73]
    v_pk_add_f32 v[42:43], v[42:43], v[74:75]
    v_pk_add_f32 v[44:45], v[44:45], v[76:77]
    v_pk_add_f32 v[46:47], v[46:47], v[78:79]
    s_waitcnt lgkmcnt(0)
    v_pk_add_f32 v[32:33], v[32:33], v[80:81]
    v_pk_add_f32 v[34:35], v[34:35], v[82:83]
    v_pk_add_f32 v[36:37], v[36:37], v[84:85]
    v_pk_add_f32 v[38:39], v[38:39], v[86:87]
    v_pk_add_f32 v[40:41], v[40:41], v[88:89]
    v_pk_add_f32 v[42:43], v[42:43], v[90:91]
    v_pk_add_f32 v[44:45], v[44:45], v[92:93]
    v_pk_add_f32 v[46:47], v[46:47], v[94:95]
    s_cbranch_vccnz s_slow
s_fin:
    v_pk_mul_f32 v[32:33], v[28:29], v[32:33] op_sel_hi:[0,1]
    v_pk_mul_f32 v[34:35], v[28:29], v[34:35] op_sel_hi:[0,1]
    v_pk_mul_f32 v[36:37], v[28:29], v[36:37] op_sel_hi:[0,1]
    v_pk_mul_f32 v[38:39], v[28:29], v[38:39] op_sel_hi:[0,1]
    v_pk_mul_f32 v[40:41], v[28:29], v[40:41] op_sel_hi:[0,1]
    v_pk_mul_f32 v[42:43], v[28:29], v[42:43] op_sel_hi:[0,1]
    v_pk_mul_f32 v[44:45], v[28:29], v[44:45] op_sel_hi:[0,1]
    v_pk_mul_f32 v[46:47], v[28:29], v[46:47] op_sel_hi:[0,1]
    v_cvt_pk_bf16_f32 v32, v32, v33
    v_cvt_pk_bf16_f32 v33, v34, v35
    v_cvt_pk_bf16_f32 v34, v36, v37
    v_cvt_pk_bf16_f32 v35, v38, v39
    v_cvt_pk_bf16_f32 v36, v40, v41
    v_cvt_pk_bf16_f32 v37, v42, v43
    v_cvt_pk_bf16_f32 v38, v44, v45
    v_cvt_pk_bf16_f32 v39, v46, v47
    buffer_store_dwordx4 v[32:35], v1, s[4:7], s53 offen offset:0 sc1
    buffer_store_dwordx4 v[36:39], v1, s[4:7], s53 offen offset:1024 sc1
    s_cmp_lg_u32 s52, 0
    s_cbranch_scc1 s_b2
    s_waitcnt vmcnt(0)
    s_atomic_add s40, s[22:23], s54
    s_mov_b32 s52, 1
    s_add_u32 s53, s53, 2048
    s_waitcnt lgkmcnt(0)
    s_add_u32 s54, s54, 128
    s_setprio 0
    s_and_b32 s3, s16, 3
    s_lshl_b32 s46, s3, 19
    s_lshl_b32 s45, s3, 14
    s_and_b32 s3, s20, 0
    s_lshl_b32 s3, s3, 17
    s_xor_b32 s46, s46, s3
    s_add_u32 m0, s45, 0
    s_xor_b32 s44, s46, 0
    buffer_load_dwordx4 v16, s[12:15], s44 offen offset:0 lds
    buffer_load_dwordx4 v17, s[12:15], s44 offen offset:1024 lds
    buffer_load_dwordx4 v18, s[12:15], s44 offen offset:2048 lds
    buffer_load_dwordx4 v19, s[12:15], s44 offen offset:3072 lds
    s_add_u32 s44, s44, 65536
    s_waitcnt vmcnt(2)
    buffer_load_dwordx4 v[96:99], v16, s[12:15], s44 offen offset:0
    buffer_load_dwordx4 v[100:103], v17, s[12:15], s44 offen offset:1024
    buffer_load_dwordx4 v[104:107], v18, s[12:15], s44 offen offset:2048
    buffer_load_dwordx4 v[108:111], v19, s[12:15], s44 offen offset:3072
    s_waitcnt vmcnt(2)
    s_add_u32 m0, s45, 4096
    s_xor_b32 s44, s46, 131072
    buffer_load_dwordx4 v16, s[12:15], s44 offen offset:0 lds
    buffer_load_dwordx4 v17, s[12:15], s44 offen offset:1024 lds
    buffer_load_dwordx4 v18, s[12:15], s44 offen offset:2048 lds
    buffer_load_dwordx4 v19, s[12:15], s44 offen offset:3072 lds
    s_add_u32 s44, s44, 65536
    s_waitcnt vmcnt(2)
    buffer_load_dwordx4 v[112:115], v16, s[12:15], s44 offen offset:0
    buffer_load_dwordx4 v[116:119], v17, s[12:15], s44 offen offset:1024
    buffer_load_dwordx4 v[120:123], v18, s[12:15], s44 offen offset:2048
    buffer_load_dwordx4 v[124:127], v19, s[12:15], s44 offen offset:3072
    s_waitcnt vmcnt(2)
    s_add_u32 m0, s45, 8192
    s_xor_b32 s44, s46, 262144
    buffer_load_dwordx4 v16, s[12:15], s44 offen offset:0 lds
    buffer_load_dwordx4 v17, s[12:15], s44 offen offset:1024 lds
    buffer_load_dwordx4 v18, s[12:15], s44 offen offset:2048 lds
    buffer_load_dwordx4 v19, s[12:15], s44 offen offset:3072 lds
    s_add_u32 s44, s44, 65536
    s_waitcnt vmcnt(2)
    buffer_load_dwordx4 v[128:131], v16, s[12:15], s44 offen offset:0
    buffer_load_dwordx4 v[132:135], v17, s[12:15], s44 offen offset:1024
    buffer_load_dwordx4 v[136:139], v18, s[12:15], s44 offen offset:2048
    buffer_load_dwordx4 v[140:143], v19, s[12:15], s44 offen offset:3072
    s_waitcnt vmcnt(2)
    s_add_u32 m0, s45, 12288
    s_xor_b32 s44, s46, 393216
    buffer_load_dwordx4 v16, s[12:15], s44 offen offset:0 lds
    buffer_load_dwordx4 v17, s[12:15], s44 offen offset:1024 lds
    buffer_load_dwordx4 v18, s[12:15], s44 offen offset:2048 lds
    buffer_load_dwordx4 v19, s[12:15], s44 offen offset:3072 lds
    s_add_u32 s44, s44, 65536
    s_waitcnt vmcnt(2)
    buffer_load_dwordx4 v[144:147], v16, s[12:15], s44 offen offset:0
    buffer_load_dwordx4 v[148:151], v17, s[12:15], s44 offen offset:1024
    buffer_load_dwordx4 v[152:155], v18, s[12:15], s44 offen offset:2048
    buffer_load_dwordx4 v[156:159], v19, s[12:15], s44 offen offset:3072
    s_waitcnt vmcnt(2)
    s_setprio 3
    s_sub_u32 s44, s54, 128
    s_mov_b32 s66, 0x10000
s_o0_poll:
    s_mov_b32 s68, 0
    s_atomic_add s68, s[22:23], s44 offset:0 glc
    s_sub_u32 s66, s66, 1
    s_cselect_b32 s67, 16, 0
    s_waitcnt lgkmcnt(0)
    s_max_u32 s68, s68, s67
    s_cmp_lt_u32 s68, 16
    s_cbranch_scc1 s_o0_poll
s_o0_ok:
    s_branch s_bhead
s_b2:
    ds_write_b128 v24, v[96:99] offset:0
    ds_write_b128 v24, v[100:103] offset:1024
    ds_write_b128 v24, v[104:107] offset:2048
    ds_write_b128 v24, v[108:111] offset:3072
    ds_write_b128 v24, v[112:115] offset:4096
    ds_write_b128 v24, v[116:119] offset:5120
    ds_write_b128 v24, v[120:123] offset:6144
    ds_write_b128 v24, v[124:127] offset:7168
    ds_write_b128 v24, v[128:131] offset:8192
    ds_write_b128 v24, v[132:135] offset:9216
    ds_write_b128 v24, v[136:139] offset:10240
    ds_write_b128 v24, v[140:143] offset:11264
    ds_write_b128 v24, v[144:147] offset:12288
    ds_write_b128 v24, v[148:151] offset:13312
    ds_write_b128 v24, v[152:155] offset:14336
    ds_write_b128 v24, v[156:159] offset:15360
    s_waitcnt vmcnt(0)
    s_atomic_add s40, s[22:23], s54
    s_mov_b32 s66, 0x10000
s_o1_poll:
    s_mov_b32 s68, 0
    s_atomic_add s68, s[22:23], s54 offset:0 glc
    s_sub_u32 s66, s66, 1
    s_cselect_b32 s67, 16, 0
    s_waitcnt lgkmcnt(0)
    s_max_u32 s68, s68, s67
    s_cmp_lt_u32 s68, 16
    s_cbranch_scc1 s_o1_poll
s_o1_ok:
s_b3:
    s_setprio 0
    s_waitcnt lgkmcnt(0)
s_g3:
    s_barrier
    s_cmp_eq_u32 s21, 3
    s_cbranch_scc1 s_end
    s_barrier
    ds_write_b128 v9, v[160:163] offset:0
    ds_write_b128 v9, v[164:167] offset:4096
    ds_write_b128 v9, v[168:171] offset:8192
    ds_write_b128 v9, v[172:175] offset:12288
    ds_write_b128 v9, v[176:179] offset:16384
    ds_write_b128 v9, v[180:183] offset:20480
    ds_write_b128 v9, v[184:187] offset:24576
    ds_write_b128 v9, v[188:191] offset:28672
    s_add_u32 s21, s21, 1
    s_bitcmp1_b32 s21, 0
    s_cselect_b32 s8, s28, s24
    s_cselect_b32 s9, s29, s25
    s_cselect_b32 s12, s30, s26
    s_cselect_b32 s13, s31, s27
    s_mov_b32 s10, 6291456
    s_mov_b32 s11, 0x00020000
    s_mov_b32 s14, 2097152
    s_mov_b32 s15, 0x00020000
    s_sub_u32 s3, s16, 5
    s_cmp_gt_u32 s3, 1
    s_cbranch_scc1 s_n67
    s_add_u32 m0, s41, 98304
    s_add_u32 s44, s88, 2048
    buffer_load_dwordx4 v14, s[8:11], s44 offen offset:0 lds
    buffer_load_dwordx4 v15, s[8:11], s44 offen offset:1024 lds
    s_add_u32 m0, s41, 102400
    s_add_u32 s44, s88, 4096
    buffer_load_dwordx4 v14, s[8:11], s44 offen offset:0 lds
    buffer_load_dwordx4 v15, s[8:11], s44 offen offset:1024 lds
    s_add_u32 m0, s41, 106496
    s_add_u32 s44, s88, 0
    buffer_load_dwordx4 v14, s[8:11], s44 offen offset:0 lds
    buffer_load_dwordx4 v15, s[8:11], s44 offen offset:1024 lds
    s_add_u32 m0, s41, 110592
    s_add_u32 s44, s88, 198656
    buffer_load_dwordx4 v14, s[8:11], s44 offen offset:0 lds
    buffer_load_dwordx4 v15, s[8:11], s44 offen offset:1024 lds
    s_add_u32 m0, s41, 114688
    s_add_u32 s44, s88, 200704
    buffer_load_dwordx4 v14, s[8:11], s44 offen offset:0 lds
    buffer_load_dwordx4 v15, s[8:11], s44 offen offset:1024 lds
    s_add_u32 m0, s41, 118784
    s_add_u32 s44, s88, 196608
    buffer_load_dwordx4 v14, s[8:11], s44 offen offset:0 lds
    buffer_load_dwordx4 v15, s[8:11], s44 offen offset:1024 lds
    s_add_u32 m0, s41, 122880
    s_add_u32 s44, s89, 2048
    buffer_load_dwordx4 v14, s[8:11], s44 offen offset:0 lds
    buffer_load_dwordx4 v15, s[8:11], s44 offen offset:1024 lds
    s_add_u32 m0, s41, 126976
    s_add_u32 s44, s89, 4096
    buffer_load_dwordx4 v14, s[8:11], s44 offen offset:0 lds
    buffer_load_dwordx4 v15, s[8:11], s44 offen offset:1024 lds
s_n67:
    s_waitcnt lgkmcnt(0)
    s_barrier
    ds_write_b128 v9, v[192:195] offset:32768
    ds_write_b128 v9, v[196:199] offset:36864
    ds_write_b128 v9, v[200:203] offset:40960
    ds_write_b128 v9, v[204:207] offset:45056
    ds_write_b128 v9, v[208:211] offset:49152
    ds_write_b128 v9, v[212:215] offset:53248
    ds_write_b128 v9, v[216:219] offset:57344
    ds_write_b128 v9, v[220:223] offset:61440
    ds_write_b128 v10, v[224:227] offset:0
    ds_write_b128 v10, v[228:231] offset:4096
    ds_write_b128 v10, v[232:235] offset:8192
    ds_write_b128 v10, v[236:239] offset:12288
    ds_write_b128 v10, v[240:243] offset:16384
    ds_write_b128 v10, v[244:247] offset:20480
    ds_write_b128 v10, v[248:251] offset:24576
    ds_write_b128 v10, v[252:255] offset:28672
    s_cmp_eq_u32 s16, 4
    s_cbranch_scc1 h_layer
    s_cmp_eq_u32 s16, 7
    s_cbranch_scc1 z_layer
    s_branch l_layer
s_end:
    s_lshl_b32 s3, s2, 3
    s_add_u32 s3, s3, s16
    s_cmp_lg_u32 s3, 7
    s_cbranch_scc1 k_exit
    s_mov_b32 s8, s34
    s_mov_b32 s9, s35
    s_mov_b32 s10, 256
    s_mov_b32 s11, 0x00020000
    v_lshrrev_b32 v24, 2, v1
    v_mov_b32 v25, 0
    buffer_store_dword v25, v24, s[8:11], 0 offen sc1
    s_branch k_exit
s_slow:
    s_and_b32 s3, s16, 3
    s_lshl_b32 s44, s3, 11
    s_lshl_b32 s45, s52, 13
    s_add_u32 s44, s44, s45
    s_add_u32 s44, s44, 131072
    v_add_u32 v26, s44, v1
    ds_read_b128 v[48:51], v26 offset:0
    ds_read_b128 v[52:55], v26 offset:1024
    s_lshr_b32 s55, s21, 1
    s_lshl_b32 s55, s55, 23
    s_lshl_b32 s44, s18, 18
    s_add_u32 s55, s55, s44
    s_lshl_b32 s44, s52, 17
    s_add_u32 s55, s55, s44
    s_add_u32 s55, s55, 33554432
    s_waitcnt lgkmcnt(0)
    v_mov_b32 v26, 0xff800000
    s_mov_b32 s61, 0
s_slow1:
    s_add_u32 s44, s55, s61
    buffer_load_dwordx4 v[56:59], v1, s[4:7], s44 offen offset:0 sc1
    buffer_load_dwordx4 v[60:63], v1, s[4:7], s44 offen offset:1024 sc1
    s_waitcnt vmcnt(0)
    v_mfma_f32_32x32x16_bf16 v[72:87], v[56:59], v[48:51], 0
    v_mfma_f32_32x32x16_bf16 v[72:87], v[60:63], v[52:55], v[72:87]
    s_nop 11
    v_max3_f32 v26, v26, v72, v73
    v_max3_f32 v26, v26, v74, v75
    v_max3_f32 v26, v26, v76, v77
    v_max3_f32 v26, v26, v78, v79
    v_max3_f32 v26, v26, v80, v81
    v_max3_f32 v26, v26, v82, v83
    v_max3_f32 v26, v26, v84, v85
    v_max3_f32 v26, v26, v86, v87
    s_add_u32 s61, s61, 2048
    s_cmp_lt_u32 s61, 131072
    s_cbranch_scc1 s_slow1
    v_mov_b32 v27, v26
    s_nop 1
    v_permlane32_swap_b32 v26, v27
    v_max_f32 v26, v26, v27
    v_mov_b32 v32, 0
    v_mov_b32 v33, 0
    v_mov_b32 v34, 0
    v_mov_b32 v35, 0
    v_mov_b32 v36, 0
    v_mov_b32 v37, 0
    v_mov_b32 v38, 0
    v_mov_b32 v39, 0
    v_mov_b32 v40, 0
    v_mov_b32 v41, 0
    v_mov_b32 v42, 0
    v_mov_b32 v43, 0
    v_mov_b32 v44, 0
    v_mov_b32 v45, 0
    v_mov_b32 v46, 0
    v_mov_b32 v47, 0
    v_mov_b32 v28, 0
    v_mov_b32 v29, 0xdddddddd
    s_mov_b32 s3, 0xffff0000
    s_mov_b32 s61, 0
s_slow2:
    s_add_u32 s44, s55, s61
    buffer_load_dwordx4 v[56:59], v1, s[4:7], s44 offen offset:0 sc1
    buffer_load_dwordx4 v[60:63], v1, s[4:7], s44 offen offset:1024 sc1
    s_add_u32 s44, s44, 4194304
    buffer_load_dwordx4 v[64:67], v1, s[4:7], s44 offen offset:0 sc1
    buffer_load_dwordx4 v[68:71], v1, s[4:7], s44 offen offset:1024 sc1
    s_waitcnt vmcnt(0)
    v_mfma_f32_32x32x16_bf16 v[72:87], v[56:59], v[48:51], 0
    v_mfma_f32_32x32x16_bf16 v[72:87], v[60:63], v[52:55], v[72:87]
    s_nop 11
    v_sub_f32 v72, v72, v26
    v_sub_f32 v73, v73, v26
    v_sub_f32 v74, v74, v26
    v_sub_f32 v75, v75, v26
    v_sub_f32 v76, v76, v26
    v_sub_f32 v77, v77, v26
    v_sub_f32 v78, v78, v26
    v_sub_f32 v79, v79, v26
    v_sub_f32 v80, v80, v26
    v_sub_f32 v81, v81, v26
    v_sub_f32 v82, v82, v26
    v_sub_f32 v83, v83, v26
    v_sub_f32 v84, v84, v26
    v_sub_f32 v85, v85, v26
    v_sub_f32 v86, v86, v26
    v_sub_f32 v87, v87, v26
    v_exp_f32 v72, v72
    v_exp_f32 v73, v73
    v_exp_f32 v74, v74
    v_exp_f32 v75, v75
    v_exp_f32 v76, v76
    v_exp_f32 v77, v77
    v_exp_f32 v78, v78
    v_exp_f32 v79, v79
    v_exp_f32 v80, v80
    v_exp_f32 v81, v81
    v_exp_f32 v82, v82
    v_exp_f32 v83, v83
    v_exp_f32 v84, v84
    v_exp_f32 v85, v85
    v_exp_f32 v86, v86
    v_exp_f32 v87, v87
    v_and_b32 v72, s3, v72
    v_and_b32 v73, s3, v73
    v_and_b32 v74, s3, v74
    v_and_b32 v75, s3, v75
    v_and_b32 v76, s3, v76
    v_and_b32 v77, s3, v77
    v_and_b32 v78, s3, v78
    v_and_b32 v79, s3, v79
    v_and_b32 v80, s3, v80
    v_and_b32 v81, s3, v81
    v_and_b32 v82, s3, v82
    v_and_b32 v83, s3, v83
    v_and_b32 v84, s3, v84
    v_and_b32 v85, s3, v85
    v_and_b32 v86, s3, v86
    v_and_b32 v87, s3, v87
    v_add_f32 v28, v28, v72
    v_add_f32 v28, v28, v73
    v_add_f32 v28, v28, v74
    v_add_f32 v28, v28, v75
    v_add_f32 v28, v28, v76
    v_add_f32 v28, v28, v77
    v_add_f32 v28, v28, v78
    v_add_f32 v28, v28, v79
    v_add_f32 v28, v28, v80
    v_add_f32 v28, v28, v81
    v_add_f32 v28, v28, v82
    v_add_f32 v28, v28, v83
    v_add_f32 v28, v28, v84
    v_add_f32 v28, v28, v85
    v_add_f32 v28, v28, v86
    v_add_f32 v28, v28, v87
    v_smfmac_f32_32x32x32_bf16 v[32:47], v[64:67], v[72:79], v29
    v_smfmac_f32_32x32x32_bf16 v[32:47], v[68:71], v[80:87], v29
    s_add_u32 s61, s61, 2048
    s_cmp_lt_u32 s61, 131072
    s_cbranch_scc1 s_slow2
    v_mov_b32 v29, v28
    s_nop 1
    v_permlane32_swap_b32 v28, v29
    v_add_f32 v28, v28, v29
    v_rcp_f32 v28, v28
    s_nop 7
    s_branch s_fin
k_exit:
    s_endpgm
.if k_exit - interleave_layers__sliding_local_dilated__softmax_full_mha__prompt_kernel < 49152
.error "code prefetch reads past the end of the code"
.endif
.section .rodata,"a"
.p2align 6
.amdhsa_kernel interleave_layers__sliding_local_dilated__softmax_full_mha__prompt_kernel
  .amdhsa_next_free_vgpr 256
  .amdhsa_next_free_sgpr 102
  .amdhsa_accum_offset 256
  .amdhsa_group_segment_fixed_size 0
  .amdhsa_kernarg_size 72
  .amdhsa_user_sgpr_count 2
  .amdhsa_user_sgpr_kernarg_segment_ptr 1
  .amdhsa_system_sgpr_workgroup_id_x 1
.end_amdhsa_kernel
```

```asm
; @launch grid=(256,1,1) block=(512,1,1) lds=156736
.amdgcn_target "amdgcn-amd-amdhsa--gfx950"
.text
.globl interleave_layers__sliding_local_dilated__softmax_full_mha__prompt_kernel
.type interleave_layers__sliding_local_dilated__softmax_full_mha__prompt_kernel,@function
.p2align 8
interleave_layers__sliding_local_dilated__softmax_full_mha__prompt_kernel:
    s_cmp_ge_u32 s2, 256
    s_cbranch_scc1 k_exit
    s_load_dwordx2 s[36:37], s[0:1], 0
    s_load_dwordx4 s[24:27], s[0:1], 8
    s_load_dwordx8 s[28:35], s[0:1], 32
    s_load_dwordx2 s[44:45], s[0:1], 64
    v_lshrrev_b32 v2, 6, v0
    v_and_b32 v0, 63, v0
    v_readfirstlane_b32 s16, v2
    v_lshlrev_b32 v1, 4, v0
    s_mov_b32 s21, 0
    s_mov_b32 s40, 1
    s_and_b32 s3, s2, 1
    s_lshl_b32 s3, s3, 3
    s_bfe_u32 s17, s2, 0x30003
    s_add_u32 s17, s17, s3
    s_bfe_u32 s3, s2, 0x20001
    s_lshl_b32 s3, s3, 2
    s_lshr_b32 s18, s2, 6
    s_add_u32 s18, s18, s3
    s_and_b32 s3, s2, 3
    s_lshl_b32 s3, s3, 2
    s_bfe_u32 s19, s2, 0x20003
    s_add_u32 s19, s19, s3
    s_bfe_u32 s3, s2, 0x10002
    s_lshl_b32 s3, s3, 3
    s_lshr_b32 s20, s2, 5
    s_add_u32 s20, s20, s3
    s_mov_b32 s19, s17
    s_mov_b32 s20, s18
    s_and_b32 s3, s16, 3
    s_lshl_b32 s38, s17, 2
    s_add_u32 s38, s38, s3
    s_lshl_b32 s39, s19, 2
    s_add_u32 s39, s39, s3
    v_mov_b32 v12, 0
    v_mov_b32 v13, 0
    v_mov_b32 v14, 0
    v_mov_b32 v15, 0
    s_mov_b32 s41, 0
    s_mov_b32 s42, 0
    s_mov_b32 s43, 0
    s_mov_b32 s62, 0
    s_getpc_b64 s[76:77]
e_pc:
    s_sub_u32 s76, s76, e_pc - interleave_layers__sliding_local_dilated__softmax_full_mha__prompt_kernel
    s_subb_u32 s77, s77, 0
    s_and_b32 s3, s2, 0xf8
    s_add_u32 s3, s3, s16
    s_lshl_b32 s3, s3, 6
    s_add_u32 s78, s3, 49152
    s_min_u32 s78, s78, k_exit - interleave_layers__sliding_local_dilated__softmax_full_mha__prompt_kernel
    s_waitcnt lgkmcnt(0)
    s_load_dword s80, s[76:77], s3 offset:0
    s_load_dword s81, s[76:77], s3 offset:16384
    s_load_dword s82, s[76:77], s3 offset:32768
    s_load_dword s83, s[76:77], s78
    s_mov_b32 s4, s44
    s_mov_b32 s5, s45
    s_mov_b32 s6, 67108864
    s_mov_b32 s7, 0x00020000
    s_add_u32 s22, s44, 58720256
    s_addc_u32 s23, s45, 0
    s_load_dword s100, s[22:23], 217088
    s_cmp_eq_u32 s16, 4
    s_cbranch_scc1 h_start
    s_cmp_eq_u32 s16, 7
    s_cbranch_scc1 z_start
    s_cmp_gt_u32 s16, 4
    s_cbranch_scc1 l_start
    s_mov_b32 s8, s36
    s_mov_b32 s9, s37
    s_mov_b32 s10, 4194304
    s_mov_b32 s11, 0x00020000
    v_lshrrev_b32 v8, 4, v1
    v_lshrrev_b32 v32, 3, v8
    v_and_b32 v33, 7, v8
    v_lshlrev_b32 v34, 11, v32
    v_lshl_add_u32 v34, v33, 4, v34
    s_lshl_b32 s44, s39, 16
    s_lshl_b32 s45, s20, 7
    s_add_u32 s46, s44, s45
    buffer_load_dwordx4 v[40:43], v34, s[8:11], s46 offen
    s_add_u32 s46, s46, 16384
    buffer_load_dwordx4 v[44:47], v34, s[8:11], s46 offen
    s_add_u32 s46, s46, 16384
    buffer_load_dwordx4 v[48:51], v34, s[8:11], s46 offen
    s_add_u32 s46, s46, 16384
    buffer_load_dwordx4 v[52:55], v34, s[8:11], s46 offen
    v_xor_b32 v88, v33, v32
    v_lshlrev_b32 v88, 4, v88
    v_lshl_add_u32 v88, v32, 11, v88
    v_xor_b32 v89, 16, v88
    v_add_u32 v89, 15360, v89
    v_add_u32 v90, 30720, v88
    v_add_u32 v91, 30720, v89
    s_mul_i32 s76, s16, 16384
    s_add_u32 s76, s76, 65536
    s_lshl_b32 s77, s38, 16
    s_mul_i32 s84, s18, 4096
    s_cmp_eq_u32 s18, 1
    s_cselect_b32 s85, 0, 4096
    s_cmp_eq_u32 s18, 2
    s_cselect_b32 s86, 0, 8192
    s_cmp_eq_u32 s18, 3
    s_cselect_b32 s87, 0, 12288
    s_cmp_eq_u32 s18, 4
    s_cselect_b32 s88, 0, 16384
    s_cmp_eq_u32 s18, 5
    s_cselect_b32 s89, 0, 20480
    s_cmp_eq_u32 s18, 6
    s_cselect_b32 s90, 0, 24576
    s_cmp_eq_u32 s18, 7
    s_cselect_b32 s91, 0, 28672
    s_cmp_eq_u32 s18, 8
    s_cselect_b32 s92, 0, 32768
    s_cmp_eq_u32 s18, 9
    s_cselect_b32 s93, 0, 36864
    s_cmp_eq_u32 s18, 10
    s_cselect_b32 s94, 0, 40960
    s_cmp_eq_u32 s18, 11
    s_cselect_b32 s95, 0, 45056
    s_cmp_eq_u32 s18, 12
    s_cselect_b32 s96, 0, 49152
    s_cmp_eq_u32 s18, 13
    s_cselect_b32 s97, 0, 53248
    s_cmp_eq_u32 s18, 14
    s_cselect_b32 s98, 0, 57344
    s_cmp_eq_u32 s18, 15
    s_cselect_b32 s99, 0, 61440
    v_lshrrev_b32 v12, 4, v1
    v_and_b32 v13, 15, v12
    v_bfe_u32 v14, v12, 4, 1
    v_lshrrev_b32 v12, 5, v12
    v_lshl_add_u32 v2, v14, 5, v13
    v_lshlrev_b32 v2, 4, v2
    v_lshl_add_u32 v2, v12, 10, v2
    v_lshrrev_b32 v15, 2, v13
    v_lshl_add_u32 v15, v14, 2, v15
    v_lshlrev_b32 v3, 7, v15
    v_lshl_add_u32 v3, v12, 11, v3
    v_and_b32 v15, 3, v13
    v_lshl_add_u32 v3, v15, 3, v3
    v_lshrrev_b32 v15, 3, v13
    v_lshl_add_u32 v15, v15, 1, v14
    v_lshl_add_u32 v3, v15, 5, v3
    v_xor_b32 v4, 32, v3
    v_xor_b32 v5, 64, v3
    v_xor_b32 v6, 96, v3
    s_lshl_b32 s45, s16, 12
    s_add_u32 s45, s45, 131072
    v_lshrrev_b32 v35, 1, v33
    v_lshlrev_b32 v35, 10, v35
    v_lshl_add_u32 v35, v32, 4, v35
    v_and_b32 v36, 1, v33
    v_lshl_add_u32 v35, v36, 3, v35
    v_add_u32 v35, s45, v35
    v_add_u32 v36, s45, v1
    v_mov_b32 v37, 0x3f803f80
    v_and_b32 v38, 3, v8
    v_lshl_add_u32 v39, v38, 3, v32
    v_lshlrev_b32 v39, 3, v39
    v_mov_b32 v56, 0
    v_mov_b32 v57, 0
    v_mov_b32 v58, 0
    v_mov_b32 v59, 0
    v_mov_b32 v60, 0
    v_mov_b32 v61, 0
    v_mov_b32 v62, 0
    v_mov_b32 v63, 0
    s_waitcnt vmcnt(3)
    ds_write_b64 v35, v[40:41] offset:0
    ds_write_b64 v35, v[42:43] offset:512
    s_waitcnt vmcnt(2)
    ds_write_b64 v35, v[44:45] offset:128
    ds_write_b64 v35, v[46:47] offset:640
    s_waitcnt vmcnt(1)
    ds_write_b64 v35, v[48:49] offset:256
    ds_write_b64 v35, v[50:51] offset:768
    s_waitcnt vmcnt(0)
    ds_write_b64 v35, v[52:53] offset:384
    ds_write_b64 v35, v[54:55] offset:896
    ds_read_b128 v[64:67], v36 offset:0
    ds_read_b128 v[68:71], v36 offset:1024
    ds_read_b128 v[72:75], v36 offset:2048
    ds_read_b128 v[76:79], v36 offset:3072
    s_lshl_b32 s45, s20, 12
    s_add_u32 s46, s44, s45
    s_waitcnt lgkmcnt(3)
    buffer_store_dwordx4 v[64:67], v1, s[4:7], s46 offen offset:0 sc1
    s_waitcnt lgkmcnt(2)
    buffer_store_dwordx4 v[68:71], v1, s[4:7], s46 offen offset:1024 sc1
    s_waitcnt lgkmcnt(1)
    buffer_store_dwordx4 v[72:75], v1, s[4:7], s46 offen offset:2048 sc1
    s_waitcnt lgkmcnt(0)
    buffer_store_dwordx4 v[76:79], v1, s[4:7], s46 offen offset:3072 sc1
    s_add_u32 m0, s76, 4096
    s_lshr_b32 s78, s85, 5
    s_add_u32 s78, s78, s77
    buffer_load_dwordx4 v88, s[8:11], s78 offen offset:0 lds
    buffer_load_dwordx4 v89, s[8:11], s78 offen offset:1024 lds
    buffer_load_dwordx4 v90, s[8:11], s78 offen offset:2048 lds
    buffer_load_dwordx4 v91, s[8:11], s78 offen offset:3072 lds
    s_add_u32 m0, s76, 8192
    s_lshr_b32 s78, s86, 5
    s_add_u32 s78, s78, s77
    buffer_load_dwordx4 v88, s[8:11], s78 offen offset:0 lds
    buffer_load_dwordx4 v89, s[8:11], s78 offen offset:1024 lds
    buffer_load_dwordx4 v90, s[8:11], s78 offen offset:2048 lds
    buffer_load_dwordx4 v91, s[8:11], s78 offen offset:3072 lds
    s_add_u32 m0, s76, 12288
    s_lshr_b32 s78, s87, 5
    s_add_u32 s78, s78, s77
    buffer_load_dwordx4 v88, s[8:11], s78 offen offset:0 lds
    buffer_load_dwordx4 v89, s[8:11], s78 offen offset:1024 lds
    buffer_load_dwordx4 v90, s[8:11], s78 offen offset:2048 lds
    buffer_load_dwordx4 v91, s[8:11], s78 offen offset:3072 lds
    s_barrier
    v_dot2_f32_bf16 v56, v40, v37, v56
    v_dot2_f32_bf16 v57, v40, v40, v57
    v_dot2_f32_bf16 v58, v44, v37, v58
    v_dot2_f32_bf16 v59, v44, v44, v59
    v_dot2_f32_bf16 v60, v48, v37, v60
    v_dot2_f32_bf16 v61, v48, v48, v61
    v_dot2_f32_bf16 v62, v52, v37, v62
    v_dot2_f32_bf16 v63, v52, v52, v63
    v_dot2_f32_bf16 v56, v41, v37, v56
    v_dot2_f32_bf16 v57, v41, v41, v57
    v_dot2_f32_bf16 v58, v45, v37, v58
    v_dot2_f32_bf16 v59, v45, v45, v59
    v_dot2_f32_bf16 v60, v49, v37, v60
    v_dot2_f32_bf16 v61, v49, v49, v61
    v_dot2_f32_bf16 v62, v53, v37, v62
    v_dot2_f32_bf16 v63, v53, v53, v63
    v_dot2_f32_bf16 v56, v42, v37, v56
    v_dot2_f32_bf16 v57, v42, v42, v57
    v_dot2_f32_bf16 v58, v46, v37, v58
    v_dot2_f32_bf16 v59, v46, v46, v59
    v_dot2_f32_bf16 v60, v50, v37, v60
    v_dot2_f32_bf16 v61, v50, v50, v61
    v_dot2_f32_bf16 v62, v54, v37, v62
    v_dot2_f32_bf16 v63, v54, v54, v63
    v_dot2_f32_bf16 v56, v43, v37, v56
    v_dot2_f32_bf16 v57, v43, v43, v57
    v_dot2_f32_bf16 v58, v47, v37, v58
    v_dot2_f32_bf16 v59, v47, v47, v59
    v_dot2_f32_bf16 v60, v51, v37, v60
    v_dot2_f32_bf16 v61, v51, v51, v61
    v_dot2_f32_bf16 v62, v55, v37, v62
    v_dot2_f32_bf16 v63, v55, v55, v63
    s_nop 2
    v_add_f32_dpp v56, v56, v56 quad_perm:[1,0,3,2] row_mask:0xf bank_mask:0xf
    v_add_f32_dpp v57, v57, v57 quad_perm:[1,0,3,2] row_mask:0xf bank_mask:0xf
    v_add_f32_dpp v58, v58, v58 quad_perm:[1,0,3,2] row_mask:0xf bank_mask:0xf
    v_add_f32_dpp v59, v59, v59 quad_perm:[1,0,3,2] row_mask:0xf bank_mask:0xf
    v_add_f32_dpp v60, v60, v60 quad_perm:[1,0,3,2] row_mask:0xf bank_mask:0xf
    v_add_f32_dpp v61, v61, v61 quad_perm:[1,0,3,2] row_mask:0xf bank_mask:0xf
    v_add_f32_dpp v62, v62, v62 quad_perm:[1,0,3,2] row_mask:0xf bank_mask:0xf
    v_add_f32_dpp v63, v63, v63 quad_perm:[1,0,3,2] row_mask:0xf bank_mask:0xf
    v_add_f32_dpp v56, v56, v56 quad_perm:[2,3,0,1] row_mask:0xf bank_mask:0xf
    v_add_f32_dpp v57, v57, v57 quad_perm:[2,3,0,1] row_mask:0xf bank_mask:0xf
    v_add_f32_dpp v58, v58, v58 quad_perm:[2,3,0,1] row_mask:0xf bank_mask:0xf
    v_add_f32_dpp v59, v59, v59 quad_perm:[2,3,0,1] row_mask:0xf bank_mask:0xf
    v_add_f32_dpp v60, v60, v60 quad_perm:[2,3,0,1] row_mask:0xf bank_mask:0xf
    v_add_f32_dpp v61, v61, v61 quad_perm:[2,3,0,1] row_mask:0xf bank_mask:0xf
    v_add_f32_dpp v62, v62, v62 quad_perm:[2,3,0,1] row_mask:0xf bank_mask:0xf
    v_add_f32_dpp v63, v63, v63 quad_perm:[2,3,0,1] row_mask:0xf bank_mask:0xf
    v_add_f32_dpp v56, v56, v56 row_half_mirror row_mask:0xf bank_mask:0xf
    v_add_f32_dpp v57, v57, v57 row_half_mirror row_mask:0xf bank_mask:0xf
    v_add_f32_dpp v58, v58, v58 row_half_mirror row_mask:0xf bank_mask:0xf
    v_add_f32_dpp v59, v59, v59 row_half_mirror row_mask:0xf bank_mask:0xf
    v_add_f32_dpp v60, v60, v60 row_half_mirror row_mask:0xf bank_mask:0xf
    v_add_f32_dpp v61, v61, v61 row_half_mirror row_mask:0xf bank_mask:0xf
    v_add_f32_dpp v62, v62, v62 row_half_mirror row_mask:0xf bank_mask:0xf
    v_add_f32_dpp v63, v63, v63 row_half_mirror row_mask:0xf bank_mask:0xf
    v_cmp_eq_u32 vcc, 1, v38
    s_nop 1
    v_cndmask_b32 v56, v56, v58, vcc
    v_cndmask_b32 v57, v57, v59, vcc
    v_cmp_eq_u32 vcc, 2, v38
    s_nop 1
    v_cndmask_b32 v56, v56, v60, vcc
    v_cndmask_b32 v57, v57, v61, vcc
    v_cmp_eq_u32 vcc, 3, v38
    s_nop 1
    v_cndmask_b32 v56, v56, v62, vcc
    v_cndmask_b32 v57, v57, v63, vcc
    s_lshl_b32 s44, s21, 18
    s_lshl_b32 s45, s39, 12
    s_add_u32 s44, s44, s45
    s_lshl_b32 s45, s20, 8
    s_add_u32 s44, s44, s45
    s_add_u32 s44, s44, 50331648
    buffer_store_dwordx2 v[56:57], v39, s[4:7], s44 offen sc1
    s_lshl_b32 s46, s21, 14
    s_lshl_b32 s67, s39, 7
    s_add_u32 s46, s46, s67
    s_add_u32 s46, s46, 4096
    s_add_u32 s47, s46, 8192
    s_lshl_b32 s48, s21, 22
    s_lshl_b32 s49, s38, 16
    s_add_u32 s41, s48, s49
    s_lshl_b32 s48, s21, 14
    s_lshl_b32 s67, s38, 7
    s_add_u32 s48, s48, s67
    s_add_u32 s48, s48, 4096
    v_lshrrev_b32 v16, 4, v1
    v_and_b32 v17, 15, v16
    v_lshrrev_b32 v16, 4, v16
    s_lshl_b32 s49, s16, 7
    s_add_u32 s50, s49, 151552
    s_and_b32 s49, s21, 1
    s_lshl_b32 s49, s49, 10
    s_add_u32 s49, s49, 151552
    v_lshlrev_b32 v11, 4, v16
    v_add_u32 v13, s50, v11
    v_add_u32 v11, s49, v11
    v_lshlrev_b32 v15, 2, v17
    v_add_u32 v9, s50, v15
    v_add_u32 v15, s49, v15
    s_lshr_b32 s49, s21, 1
    s_lshl_b32 s53, s49, 23
    s_lshl_b32 s50, s18, 18
    s_add_u32 s53, s53, s50
    s_add_u32 s53, s53, 33554432
    s_lshl_b32 s54, s38, 11
    s_add_u32 s52, s53, s54
    s_lshl_b32 s59, s49, 13
    s_lshl_b32 s67, s18, 9
    s_add_u32 s59, s59, s67
    s_lshl_b32 s67, s16, 7
    s_add_u32 s59, s59, s67
    s_add_u32 s59, s59, 69632
    s_lshl_b32 s61, s49, 15
    s_lshl_b32 s67, s17, 11
    s_add_u32 s61, s61, s67
    s_lshl_b32 s67, s18, 7
    s_add_u32 s61, s61, s67
    s_add_u32 s61, s61, 151552
    s_sub_u32 s60, s61, 151552
    s_lshl_b32 s60, s60, 5
    s_add_u32 s60, s60, 54525952
    s_lshl_b32 s62, s16, 12
    s_add_u32 s62, s62, 131072
    v_bfe_u32 v80, v8, 3, 1
    v_and_b32 v81, 7, v8
    v_lshrrev_b32 v82, 5, v8
    v_lshlrev_b32 v82, 1, v82
    v_xor_b32 v82, v82, v81
    v_xor_b32 v82, v82, v80
    v_lshlrev_b32 v82, 4, v82
    v_lshl_add_u32 v82, v81, 7, v82
    v_lshl_add_u32 v82, v80, 10, v82
    v_bfe_u32 v80, v8, 4, 1
    v_lshl_add_u32 v82, v80, 3, v82
    v_add_u32 v84, s76, v82
    v_xor_b32 v85, 16, v84
    v_xor_b32 v86, 64, v84
    v_xor_b32 v87, 80, v84
    v_add_u32 v80, s62, v2
    ds_read_b128 v[160:163], v80 offset:0
    ds_read_b128 v[164:167], v80 offset:256
    ds_read_b128 v[168:171], v80 offset:2048
    ds_read_b128 v[172:175], v80 offset:2304
    s_waitcnt vmcnt(1)
    ds_read_b64 v[176:177], v84 offset:4096
    ds_read_b64 v[178:179], v85 offset:4096
    ds_read_b64 v[180:181], v84 offset:6144
    ds_read_b64 v[182:183], v85 offset:6144
    ds_read_b64 v[184:185], v86 offset:4096
    ds_read_b64 v[186:187], v87 offset:4096
    ds_read_b64 v[188:189], v86 offset:6144
    ds_read_b64 v[190:191], v87 offset:6144
    ds_read_b64 v[192:193], v84 offset:8192
    ds_read_b64 v[194:195], v85 offset:8192
    ds_read_b64 v[196:197], v84 offset:10240
    ds_read_b64 v[198:199], v85 offset:10240
    ds_read_b64 v[200:201], v86 offset:8192
    ds_read_b64 v[202:203], v87 offset:8192
    ds_read_b64 v[204:205], v86 offset:10240
    ds_read_b64 v[206:207], v87 offset:10240
    ds_read_b64 v[208:209], v84 offset:12288
    ds_read_b64 v[210:211], v85 offset:12288
    ds_read_b64 v[212:213], v84 offset:14336
    ds_read_b64 v[214:215], v85 offset:14336
    ds_read_b64 v[216:217], v86 offset:12288
    ds_read_b64 v[218:219], v87 offset:12288
    ds_read_b64 v[220:221], v86 offset:14336
    ds_read_b64 v[222:223], v87 offset:14336
    s_load_dword s68, s[34:35], 0
    s_mov_b32 s8, s34
    s_mov_b32 s9, s35
    s_mov_b32 s10, 256
    s_mov_b32 s11, 0x00020000
    s_mov_b32 s66, 0x10000
    v_mov_b32 v16, 0
    s_waitcnt lgkmcnt(0)
c_f0:
    s_cmp_eq_u32 s68, 10
    s_cbranch_scc1 c_f0_ok
    buffer_load_dword v17, v16, s[8:11], 0 offen offset:0 sc1
    s_waitcnt vmcnt(0)
    v_readfirstlane_b32 s68, v17
    s_sub_u32 s66, s66, 1
    s_cmp_lg_u32 s66, 0
    s_cbranch_scc1 c_f0
c_f0_ok:
    s_atomic_add s40, s[22:23], s46
    s_mov_b64 vcc, -1
    s_barrier
    ds_read_b64_tr_b16 v[32:33], v3 offset:0
    ds_read_b64_tr_b16 v[34:35], v3 offset:1024
    ds_read_b64_tr_b16 v[36:37], v4 offset:0
    ds_read_b64_tr_b16 v[38:39], v4 offset:1024
    ds_read_b64_tr_b16 v[40:41], v5 offset:0
    ds_read_b64_tr_b16 v[42:43], v5 offset:1024
    ds_read_b64_tr_b16 v[44:45], v6 offset:0
    ds_read_b64_tr_b16 v[46:47], v6 offset:1024
    ds_read_b64_tr_b16 v[48:49], v3 offset:4096
    ds_read_b64_tr_b16 v[50:51], v3 offset:5120
    ds_read_b64_tr_b16 v[52:53], v4 offset:4096
    ds_read_b64_tr_b16 v[54:55], v4 offset:5120
    ds_read_b64_tr_b16 v[56:57], v5 offset:4096
    ds_read_b64_tr_b16 v[58:59], v5 offset:5120
    s_branch c_g0
c_cs1:
    s_waitcnt vmcnt(0)
    s_atomic_add s40, s[22:23], s47
    s_branch c_cs2
c_layer:
    s_lshl_b32 s48, s21, 22
    s_lshl_b32 s49, s38, 16
    s_add_u32 s41, s48, s49
    s_lshl_b32 s48, s21, 14
    s_lshl_b32 s67, s38, 7
    s_add_u32 s48, s48, s67
    s_add_u32 s48, s48, 4096
    v_lshrrev_b32 v16, 4, v1
    v_and_b32 v17, 15, v16
    v_lshrrev_b32 v16, 4, v16
    s_lshl_b32 s49, s16, 7
    s_add_u32 s50, s49, 151552
    s_and_b32 s49, s21, 1
    s_lshl_b32 s49, s49, 10
    s_add_u32 s49, s49, 151552
    v_lshlrev_b32 v11, 4, v16
    v_add_u32 v13, s50, v11
    v_add_u32 v11, s49, v11
    v_lshlrev_b32 v15, 2, v17
    v_add_u32 v9, s50, v15
    v_add_u32 v15, s49, v15
    s_lshr_b32 s49, s21, 1
    s_lshl_b32 s53, s49, 23
    s_lshl_b32 s50, s18, 18
    s_add_u32 s53, s53, s50
    s_add_u32 s53, s53, 33554432
    s_lshl_b32 s54, s38, 11
    s_add_u32 s52, s53, s54
    s_lshl_b32 s59, s49, 13
    s_lshl_b32 s67, s18, 9
    s_add_u32 s59, s59, s67
    s_lshl_b32 s67, s16, 7
    s_add_u32 s59, s59, s67
    s_add_u32 s59, s59, 69632
    s_lshl_b32 s61, s49, 15
    s_lshl_b32 s67, s17, 11
    s_add_u32 s61, s61, s67
    s_lshl_b32 s67, s18, 7
    s_add_u32 s61, s61, s67
    s_add_u32 s61, s61, 151552
    s_sub_u32 s60, s61, 151552
    s_lshl_b32 s60, s60, 5
    s_add_u32 s60, s60, 54525952
    s_lshl_b32 s62, s16, 12
    s_add_u32 s62, s62, 131072
    s_mov_b32 s68, 0
    s_atomic_add s68, s[22:23], s48 glc
    s_mov_b64 vcc, 0
    s_barrier
    ds_read_b64_tr_b16 v[32:33], v3 offset:0
    ds_read_b64_tr_b16 v[34:35], v3 offset:1024
    ds_read_b64_tr_b16 v[36:37], v4 offset:0
    ds_read_b64_tr_b16 v[38:39], v4 offset:1024
    ds_read_b64_tr_b16 v[40:41], v5 offset:0
    ds_read_b64_tr_b16 v[42:43], v5 offset:1024
    ds_read_b64_tr_b16 v[44:45], v6 offset:0
    ds_read_b64_tr_b16 v[46:47], v6 offset:1024
    ds_read_b64_tr_b16 v[48:49], v3 offset:4096
    ds_read_b64_tr_b16 v[50:51], v3 offset:5120
    ds_read_b64_tr_b16 v[52:53], v4 offset:4096
    ds_read_b64_tr_b16 v[54:55], v4 offset:5120
    ds_read_b64_tr_b16 v[56:57], v5 offset:4096
    ds_read_b64_tr_b16 v[58:59], v5 offset:5120
c_g0:
    s_waitcnt lgkmcnt(10)
    v_mfma_f32_16x16x32_bf16 v[64:67], v[32:35], v[160:163], 0
    ds_read_b64_tr_b16 v[60:61], v6 offset:4096
    v_mfma_f32_16x16x32_bf16 v[68:71], v[32:35], v[164:167], 0
    ds_read_b64_tr_b16 v[62:63], v6 offset:5120
    v_mfma_f32_16x16x32_bf16 v[72:75], v[36:39], v[160:163], 0
    ds_read_b64_tr_b16 v[32:33], v3 offset:8192
    v_mfma_f32_16x16x32_bf16 v[76:79], v[36:39], v[164:167], 0
    ds_read_b64_tr_b16 v[34:35], v3 offset:9216
    s_waitcnt lgkmcnt(10)
    v_mfma_f32_16x16x32_bf16 v[80:83], v[40:43], v[160:163], 0
    ds_read_b64_tr_b16 v[36:37], v4 offset:8192
    v_mfma_f32_16x16x32_bf16 v[84:87], v[40:43], v[164:167], 0
    ds_read_b64_tr_b16 v[38:39], v4 offset:9216
    v_mfma_f32_16x16x32_bf16 v[88:91], v[44:47], v[160:163], 0
    ds_read_b64_tr_b16 v[40:41], v5 offset:8192
    v_mfma_f32_16x16x32_bf16 v[92:95], v[44:47], v[164:167], 0
    ds_read_b64_tr_b16 v[42:43], v5 offset:9216
    s_waitcnt lgkmcnt(10)
    v_mfma_f32_16x16x32_bf16 v[96:99], v[160:163], v[48:51], 0
    ds_read_b64_tr_b16 v[44:45], v6 offset:8192
    v_mfma_f32_16x16x32_bf16 v[100:103], v[164:167], v[48:51], 0
    ds_read_b64_tr_b16 v[46:47], v6 offset:9216
    v_mfma_f32_16x16x32_bf16 v[104:107], v[160:163], v[52:55], 0
    ds_read_b64_tr_b16 v[48:49], v3 offset:12288
    v_mfma_f32_16x16x32_bf16 v[108:111], v[164:167], v[52:55], 0
    ds_read_b64_tr_b16 v[50:51], v3 offset:13312
    s_waitcnt lgkmcnt(10)
    v_mfma_f32_16x16x32_bf16 v[112:115], v[160:163], v[56:59], 0
    ds_read_b64_tr_b16 v[52:53], v4 offset:12288
    v_mfma_f32_16x16x32_bf16 v[116:119], v[164:167], v[56:59], 0
    ds_read_b64_tr_b16 v[54:55], v4 offset:13312
    v_mfma_f32_16x16x32_bf16 v[120:123], v[160:163], v[60:63], 0
    ds_read_b64_tr_b16 v[56:57], v5 offset:12288
    v_mfma_f32_16x16x32_bf16 v[124:127], v[164:167], v[60:63], 0
    ds_read_b64_tr_b16 v[58:59], v5 offset:13312
    s_cbranch_vccnz c_gate
    s_mov_b32 s66, 0x10000
    s_waitcnt lgkmcnt(0)
    s_cmp_eq_u32 s68, 16
    s_cbranch_scc1 c_x_ok
c_x_poll:
    s_mov_b32 s68, 0
    s_atomic_add s68, s[22:23], s48 offset:0 glc
    s_sub_u32 s66, s66, 1
    s_cselect_b32 s67, 16, 0
    s_waitcnt lgkmcnt(0)
    s_max_u32 s68, s68, s67
    s_cmp_lt_u32 s68, 16
    s_cbranch_scc1 c_x_poll
c_x_ok:
    s_add_u32 s42, s41, s85
    buffer_load_dwordx4 v[176:179], v2, s[4:7], s42 offen offset:0 sc1
    buffer_load_dwordx4 v[180:183], v2, s[4:7], s42 offen offset:256 sc1
    buffer_load_dwordx4 v[184:187], v2, s[4:7], s42 offen offset:2048 sc1
    buffer_load_dwordx4 v[188:191], v2, s[4:7], s42 offen offset:2304 sc1
    s_add_u32 s42, s41, s86
    buffer_load_dwordx4 v[192:195], v2, s[4:7], s42 offen offset:0 sc1
    buffer_load_dwordx4 v[196:199], v2, s[4:7], s42 offen offset:256 sc1
    buffer_load_dwordx4 v[200:203], v2, s[4:7], s42 offen offset:2048 sc1
    buffer_load_dwordx4 v[204:207], v2, s[4:7], s42 offen offset:2304 sc1
    s_add_u32 s42, s41, s87
    buffer_load_dwordx4 v[208:211], v2, s[4:7], s42 offen offset:0 sc1
    buffer_load_dwordx4 v[212:215], v2, s[4:7], s42 offen offset:256 sc1
    s_waitcnt vmcnt(10)
    s_atomic_add s40, s[22:23], s47
c_gate:
    s_waitcnt lgkmcnt(10)
    v_mfma_f32_16x16x32_bf16 v[128:131], v[32:35], v[160:163], 0
    ds_read_b64_tr_b16 v[60:61], v6 offset:12288
    v_mfma_f32_16x16x32_bf16 v[132:135], v[32:35], v[164:167], 0
    ds_read_b64_tr_b16 v[62:63], v6 offset:13312
    v_mfma_f32_16x16x32_bf16 v[136:139], v[36:39], v[160:163], 0
    ds_read_b64_tr_b16 v[32:33], v3 offset:16384
    v_mfma_f32_16x16x32_bf16 v[140:143], v[36:39], v[164:167], 0
    ds_read_b64_tr_b16 v[34:35], v3 offset:17408
    s_waitcnt lgkmcnt(10)
    v_mfma_f32_16x16x32_bf16 v[144:147], v[40:43], v[160:163], 0
    ds_read_b64_tr_b16 v[36:37], v4 offset:16384
    v_mfma_f32_16x16x32_bf16 v[148:151], v[40:43], v[164:167], 0
    ds_read_b64_tr_b16 v[38:39], v4 offset:17408
    v_mfma_f32_16x16x32_bf16 v[152:155], v[44:47], v[160:163], 0
    ds_read_b64_tr_b16 v[40:41], v5 offset:16384
    v_mfma_f32_16x16x32_bf16 v[156:159], v[44:47], v[164:167], 0
    ds_read_b64_tr_b16 v[42:43], v5 offset:17408
    s_waitcnt lgkmcnt(10)
    v_mfma_f32_16x16x32_bf16 v[64:67], v[48:51], v[168:171], v[64:67]
    ds_read_b64_tr_b16 v[44:45], v6 offset:16384
    v_mfma_f32_16x16x32_bf16 v[68:71], v[48:51], v[172:175], v[68:71]
    ds_read_b64_tr_b16 v[46:47], v6 offset:17408
    v_mfma_f32_16x16x32_bf16 v[72:75], v[52:55], v[168:171], v[72:75]
    ds_read_b64_tr_b16 v[48:49], v3 offset:20480
    v_mfma_f32_16x16x32_bf16 v[76:79], v[52:55], v[172:175], v[76:79]
    ds_read_b64_tr_b16 v[50:51], v3 offset:21504
    s_waitcnt lgkmcnt(10)
    v_mfma_f32_16x16x32_bf16 v[80:83], v[56:59], v[168:171], v[80:83]
    ds_read_b64_tr_b16 v[52:53], v4 offset:20480
    v_mfma_f32_16x16x32_bf16 v[84:87], v[56:59], v[172:175], v[84:87]
    ds_read_b64_tr_b16 v[54:55], v4 offset:21504
    v_mfma_f32_16x16x32_bf16 v[88:91], v[60:63], v[168:171], v[88:91]
    ds_read_b64_tr_b16 v[56:57], v5 offset:20480
    v_mfma_f32_16x16x32_bf16 v[92:95], v[60:63], v[172:175], v[92:95]
    ds_read_b64_tr_b16 v[58:59], v5 offset:21504
    s_waitcnt lgkmcnt(10)
    v_mfma_f32_16x16x32_bf16 v[96:99], v[168:171], v[32:35], v[96:99]
    ds_read_b64_tr_b16 v[60:61], v6 offset:20480
    v_mfma_f32_16x16x32_bf16 v[100:103], v[172:175], v[32:35], v[100:103]
    ds_read_b64_tr_b16 v[62:63], v6 offset:21504
    v_mfma_f32_16x16x32_bf16 v[104:107], v[168:171], v[36:39], v[104:107]
    ds_read_b64_tr_b16 v[32:33], v3 offset:24576
    v_mfma_f32_16x16x32_bf16 v[108:111], v[172:175], v[36:39], v[108:111]
    ds_read_b64_tr_b16 v[34:35], v3 offset:25600
    s_waitcnt lgkmcnt(10)
    v_mfma_f32_16x16x32_bf16 v[112:115], v[168:171], v[40:43], v[112:115]
    ds_read_b64_tr_b16 v[36:37], v4 offset:24576
    v_mfma_f32_16x16x32_bf16 v[116:119], v[172:175], v[40:43], v[116:119]
    ds_read_b64_tr_b16 v[38:39], v4 offset:25600
    v_mfma_f32_16x16x32_bf16 v[120:123], v[168:171], v[44:47], v[120:123]
    ds_read_b64_tr_b16 v[40:41], v5 offset:24576
    v_mfma_f32_16x16x32_bf16 v[124:127], v[172:175], v[44:47], v[124:127]
    ds_read_b64_tr_b16 v[42:43], v5 offset:25600
    s_waitcnt lgkmcnt(10)
    v_mfma_f32_16x16x32_bf16 v[128:131], v[48:51], v[168:171], v[128:131]
    ds_read_b64_tr_b16 v[44:45], v6 offset:24576
    v_mfma_f32_16x16x32_bf16 v[132:135], v[48:51], v[172:175], v[132:135]
    ds_read_b64_tr_b16 v[46:47], v6 offset:25600
    v_mfma_f32_16x16x32_bf16 v[136:139], v[52:55], v[168:171], v[136:139]
    ds_read_b64_tr_b16 v[48:49], v3 offset:28672
    v_mfma_f32_16x16x32_bf16 v[140:143], v[52:55], v[172:175], v[140:143]
    ds_read_b64_tr_b16 v[50:51], v3 offset:29696
    s_waitcnt lgkmcnt(10)
    v_mfma_f32_16x16x32_bf16 v[144:147], v[56:59], v[168:171], v[144:147]
    ds_read_b64_tr_b16 v[52:53], v4 offset:28672
    v_mfma_f32_16x16x32_bf16 v[148:151], v[56:59], v[172:175], v[148:151]
    ds_read_b64_tr_b16 v[54:55], v4 offset:29696
    v_mfma_f32_16x16x32_bf16 v[152:155], v[60:63], v[168:171], v[152:155]
    ds_read_b64_tr_b16 v[56:57], v5 offset:28672
    v_mfma_f32_16x16x32_bf16 v[156:159], v[60:63], v[172:175], v[156:159]
    ds_read_b64_tr_b16 v[58:59], v5 offset:29696
    s_waitcnt vmcnt(8) lgkmcnt(10)
    v_mfma_f32_16x16x32_bf16 v[64:67], v[32:35], v[176:179], v[64:67]
    ds_read_b64_tr_b16 v[60:61], v6 offset:28672
    v_mfma_f32_16x16x32_bf16 v[68:71], v[32:35], v[180:183], v[68:71]
    ds_read_b64_tr_b16 v[62:63], v6 offset:29696
    s_barrier
    v_mfma_f32_16x16x32_bf16 v[72:75], v[36:39], v[176:179], v[72:75]
    ds_read_b64_tr_b16 v[32:33], v3 offset:32768
    v_mfma_f32_16x16x32_bf16 v[76:79], v[36:39], v[180:183], v[76:79]
    ds_read_b64_tr_b16 v[34:35], v3 offset:33792
    s_waitcnt lgkmcnt(10)
    v_mfma_f32_16x16x32_bf16 v[80:83], v[40:43], v[176:179], v[80:83]
    ds_read_b64_tr_b16 v[36:37], v4 offset:32768
    s_cbranch_vccnz c_cs1
c_cs2:
    v_mfma_f32_16x16x32_bf16 v[84:87], v[40:43], v[180:183], v[84:87]
    ds_read_b64_tr_b16 v[38:39], v4 offset:33792
    v_mfma_f32_16x16x32_bf16 v[88:91], v[44:47], v[176:179], v[88:91]
    ds_read_b64_tr_b16 v[40:41], v5 offset:32768
    v_mfma_f32_16x16x32_bf16 v[92:95], v[44:47], v[180:183], v[92:95]
    ds_read_b64_tr_b16 v[42:43], v5 offset:33792
    s_waitcnt lgkmcnt(10)
    v_mfma_f32_16x16x32_bf16 v[96:99], v[176:179], v[48:51], v[96:99]
    ds_read_b64_tr_b16 v[44:45], v6 offset:32768
    v_mfma_f32_16x16x32_bf16 v[100:103], v[180:183], v[48:51], v[100:103]
    ds_read_b64_tr_b16 v[46:47], v6 offset:33792
    v_mfma_f32_16x16x32_bf16 v[104:107], v[176:179], v[52:55], v[104:107]
    ds_read_b64_tr_b16 v[48:49], v3 offset:36864
    v_mfma_f32_16x16x32_bf16 v[108:111], v[180:183], v[52:55], v[108:111]
    ds_read_b64_tr_b16 v[50:51], v3 offset:37888
    s_waitcnt lgkmcnt(10)
    v_mfma_f32_16x16x32_bf16 v[112:115], v[176:179], v[56:59], v[112:115]
    ds_read_b64_tr_b16 v[52:53], v4 offset:36864
    v_mfma_f32_16x16x32_bf16 v[116:119], v[180:183], v[56:59], v[116:119]
    ds_read_b64_tr_b16 v[54:55], v4 offset:37888
    v_mfma_f32_16x16x32_bf16 v[120:123], v[176:179], v[60:63], v[120:123]
    ds_read_b64_tr_b16 v[56:57], v5 offset:36864
    v_mfma_f32_16x16x32_bf16 v[124:127], v[180:183], v[60:63], v[124:127]
    ds_read_b64_tr_b16 v[58:59], v5 offset:37888
    s_waitcnt lgkmcnt(10)
    v_mfma_f32_16x16x32_bf16 v[128:131], v[32:35], v[176:179], v[128:131]
    ds_read_b64_tr_b16 v[60:61], v6 offset:36864
    v_mfma_f32_16x16x32_bf16 v[132:135], v[32:35], v[180:183], v[132:135]
    ds_read_b64_tr_b16 v[62:63], v6 offset:37888
    v_mfma_f32_16x16x32_bf16 v[136:139], v[36:39], v[176:179], v[136:139]
    ds_read_b64_tr_b16 v[32:33], v3 offset:40960
    v_mfma_f32_16x16x32_bf16 v[140:143], v[36:39], v[180:183], v[140:143]
    ds_read_b64_tr_b16 v[34:35], v3 offset:41984
    s_waitcnt lgkmcnt(10)
    v_mfma_f32_16x16x32_bf16 v[144:147], v[40:43], v[176:179], v[144:147]
    ds_read_b64_tr_b16 v[36:37], v4 offset:40960
    v_mfma_f32_16x16x32_bf16 v[148:151], v[40:43], v[180:183], v[148:151]
    ds_read_b64_tr_b16 v[38:39], v4 offset:41984
    v_mfma_f32_16x16x32_bf16 v[152:155], v[44:47], v[176:179], v[152:155]
    ds_read_b64_tr_b16 v[40:41], v5 offset:40960
    v_mfma_f32_16x16x32_bf16 v[156:159], v[44:47], v[180:183], v[156:159]
    ds_read_b64_tr_b16 v[42:43], v5 offset:41984
    s_waitcnt vmcnt(6) lgkmcnt(10)
    v_mfma_f32_16x16x32_bf16 v[64:67], v[48:51], v[184:187], v[64:67]
    ds_read_b64_tr_b16 v[44:45], v6 offset:40960
    s_add_u32 s42, s41, s87
    s_cbranch_vccnz xs1
    buffer_load_dwordx4 v[216:219], v2, s[4:7], s42 offen offset:2048 sc1
xs1:
    v_mfma_f32_16x16x32_bf16 v[68:71], v[48:51], v[188:191], v[68:71]
    ds_read_b64_tr_b16 v[46:47], v6 offset:41984
    v_mfma_f32_16x16x32_bf16 v[72:75], v[52:55], v[184:187], v[72:75]
    ds_read_b64_tr_b16 v[48:49], v3 offset:45056
    s_cbranch_vccnz xs2
    buffer_load_dwordx4 v[220:223], v2, s[4:7], s42 offen offset:2304 sc1
xs2:
    v_mfma_f32_16x16x32_bf16 v[76:79], v[52:55], v[188:191], v[76:79]
    ds_read_b64_tr_b16 v[50:51], v3 offset:46080
    s_waitcnt lgkmcnt(10)
    v_mfma_f32_16x16x32_bf16 v[80:83], v[56:59], v[184:187], v[80:83]
    ds_read_b64_tr_b16 v[52:53], v4 offset:45056
    s_add_u32 s42, s41, s88
    buffer_load_dwordx4 v[224:227], v2, s[4:7], s42 offen offset:0 sc1
    v_mfma_f32_16x16x32_bf16 v[84:87], v[56:59], v[188:191], v[84:87]
    ds_read_b64_tr_b16 v[54:55], v4 offset:46080
    v_mfma_f32_16x16x32_bf16 v[88:91], v[60:63], v[184:187], v[88:91]
    ds_read_b64_tr_b16 v[56:57], v5 offset:45056
    buffer_load_dwordx4 v[228:231], v2, s[4:7], s42 offen offset:256 sc1
    v_mfma_f32_16x16x32_bf16 v[92:95], v[60:63], v[188:191], v[92:95]
    ds_read_b64_tr_b16 v[58:59], v5 offset:46080
    s_waitcnt lgkmcnt(10)
    v_mfma_f32_16x16x32_bf16 v[96:99], v[184:187], v[32:35], v[96:99]
    ds_read_b64_tr_b16 v[60:61], v6 offset:45056
    buffer_load_dwordx4 v[232:235], v2, s[4:7], s42 offen offset:2048 sc1
    v_mfma_f32_16x16x32_bf16 v[100:103], v[188:191], v[32:35], v[100:103]
    ds_read_b64_tr_b16 v[62:63], v6 offset:46080
    v_mfma_f32_16x16x32_bf16 v[104:107], v[184:187], v[36:39], v[104:107]
    ds_read_b64_tr_b16 v[32:33], v3 offset:49152
    buffer_load_dwordx4 v[236:239], v2, s[4:7], s42 offen offset:2304 sc1
    v_mfma_f32_16x16x32_bf16 v[108:111], v[188:191], v[36:39], v[108:111]
    ds_read_b64_tr_b16 v[34:35], v3 offset:50176
    s_waitcnt lgkmcnt(10)
    v_mfma_f32_16x16x32_bf16 v[112:115], v[184:187], v[40:43], v[112:115]
    ds_read_b64_tr_b16 v[36:37], v4 offset:49152
    s_add_u32 s42, s41, s89
    buffer_load_dwordx4 v[240:243], v2, s[4:7], s42 offen offset:0 sc1
    v_mfma_f32_16x16x32_bf16 v[116:119], v[188:191], v[40:43], v[116:119]
    ds_read_b64_tr_b16 v[38:39], v4 offset:50176
    v_mfma_f32_16x16x32_bf16 v[120:123], v[184:187], v[44:47], v[120:123]
    ds_read_b64_tr_b16 v[40:41], v5 offset:49152
    buffer_load_dwordx4 v[244:247], v2, s[4:7], s42 offen offset:256 sc1
    v_mfma_f32_16x16x32_bf16 v[124:127], v[188:191], v[44:47], v[124:127]
    ds_read_b64_tr_b16 v[42:43], v5 offset:50176
    s_waitcnt lgkmcnt(10)
    v_mfma_f32_16x16x32_bf16 v[128:131], v[48:51], v[184:187], v[128:131]
    ds_read_b64_tr_b16 v[44:45], v6 offset:49152
    buffer_load_dwordx4 v[248:251], v2, s[4:7], s42 offen offset:2048 sc1
    v_mfma_f32_16x16x32_bf16 v[132:135], v[48:51], v[188:191], v[132:135]
    ds_read_b64_tr_b16 v[46:47], v6 offset:50176
    v_mfma_f32_16x16x32_bf16 v[136:139], v[52:55], v[184:187], v[136:139]
    ds_read_b64_tr_b16 v[48:49], v3 offset:53248
    v_mfma_f32_16x16x32_bf16 v[140:143], v[52:55], v[188:191], v[140:143]
    ds_read_b64_tr_b16 v[50:51], v3 offset:54272
    s_waitcnt lgkmcnt(10)
    v_mfma_f32_16x16x32_bf16 v[144:147], v[56:59], v[184:187], v[144:147]
    ds_read_b64_tr_b16 v[52:53], v4 offset:53248
    v_mfma_f32_16x16x32_bf16 v[148:151], v[56:59], v[188:191], v[148:151]
    ds_read_b64_tr_b16 v[54:55], v4 offset:54272
    v_mfma_f32_16x16x32_bf16 v[152:155], v[60:63], v[184:187], v[152:155]
    ds_read_b64_tr_b16 v[56:57], v5 offset:53248
    v_mfma_f32_16x16x32_bf16 v[156:159], v[60:63], v[188:191], v[156:159]
    ds_read_b64_tr_b16 v[58:59], v5 offset:54272
    s_waitcnt vmcnt(13) lgkmcnt(10)
    v_mfma_f32_16x16x32_bf16 v[64:67], v[32:35], v[192:195], v[64:67]
    ds_read_b64_tr_b16 v[60:61], v6 offset:53248
    buffer_load_dwordx4 v[252:255], v2, s[4:7], s42 offen offset:2304 sc1
    v_mfma_f32_16x16x32_bf16 v[68:71], v[32:35], v[196:199], v[68:71]
    ds_read_b64_tr_b16 v[62:63], v6 offset:54272
    v_mfma_f32_16x16x32_bf16 v[72:75], v[36:39], v[192:195], v[72:75]
    ds_read_b64_tr_b16 v[32:33], v3 offset:57344
    v_mfma_f32_16x16x32_bf16 v[76:79], v[36:39], v[196:199], v[76:79]
    ds_read_b64_tr_b16 v[34:35], v3 offset:58368
    s_waitcnt lgkmcnt(10)
    v_mfma_f32_16x16x32_bf16 v[80:83], v[40:43], v[192:195], v[80:83]
    ds_read_b64_tr_b16 v[36:37], v4 offset:57344
    v_mfma_f32_16x16x32_bf16 v[84:87], v[40:43], v[196:199], v[84:87]
    ds_read_b64_tr_b16 v[38:39], v4 offset:58368
    v_mfma_f32_16x16x32_bf16 v[88:91], v[44:47], v[192:195], v[88:91]
    ds_read_b64_tr_b16 v[40:41], v5 offset:57344
    v_mfma_f32_16x16x32_bf16 v[92:95], v[44:47], v[196:199], v[92:95]
    ds_read_b64_tr_b16 v[42:43], v5 offset:58368
    s_waitcnt lgkmcnt(10)
    v_mfma_f32_16x16x32_bf16 v[96:99], v[192:195], v[48:51], v[96:99]
    ds_read_b64_tr_b16 v[44:45], v6 offset:57344
    s_add_u32 s42, s41, s90
    buffer_load_dwordx4 v[160:163], v2, s[4:7], s42 offen offset:0 sc1
    v_mfma_f32_16x16x32_bf16 v[100:103], v[196:199], v[48:51], v[100:103]
    ds_read_b64_tr_b16 v[46:47], v6 offset:58368
    v_mfma_f32_16x16x32_bf16 v[104:107], v[192:195], v[52:55], v[104:107]
    ds_read_b64_tr_b16 v[48:49], v3 offset:61440
    v_mfma_f32_16x16x32_bf16 v[108:111], v[196:199], v[52:55], v[108:111]
    ds_read_b64_tr_b16 v[50:51], v3 offset:62464
    s_waitcnt lgkmcnt(10)
    v_mfma_f32_16x16x32_bf16 v[112:115], v[192:195], v[56:59], v[112:115]
    ds_read_b64_tr_b16 v[52:53], v4 offset:61440
    v_mfma_f32_16x16x32_bf16 v[116:119], v[196:199], v[56:59], v[116:119]
    ds_read_b64_tr_b16 v[54:55], v4 offset:62464
    v_mfma_f32_16x16x32_bf16 v[120:123], v[192:195], v[60:63], v[120:123]
    ds_read_b64_tr_b16 v[56:57], v5 offset:61440
    v_mfma_f32_16x16x32_bf16 v[124:127], v[196:199], v[60:63], v[124:127]
    ds_read_b64_tr_b16 v[58:59], v5 offset:62464
    s_waitcnt lgkmcnt(10)
    v_mfma_f32_16x16x32_bf16 v[128:131], v[32:35], v[192:195], v[128:131]
    ds_read_b64_tr_b16 v[60:61], v6 offset:61440
    v_mfma_f32_16x16x32_bf16 v[132:135], v[32:35], v[196:199], v[132:135]
    ds_read_b64_tr_b16 v[62:63], v6 offset:62464
    s_barrier
    v_xor_b32 v3, 0x10000, v3
    v_xor_b32 v4, 0x10000, v4
    v_xor_b32 v5, 0x10000, v5
    v_xor_b32 v6, 0x10000, v6
    v_mfma_f32_16x16x32_bf16 v[136:139], v[36:39], v[192:195], v[136:139]
    ds_read_b64_tr_b16 v[32:33], v3 offset:0
    v_mfma_f32_16x16x32_bf16 v[140:143], v[36:39], v[196:199], v[140:143]
    ds_read_b64_tr_b16 v[34:35], v3 offset:1024
    s_waitcnt lgkmcnt(10)
    v_mfma_f32_16x16x32_bf16 v[144:147], v[40:43], v[192:195], v[144:147]
    ds_read_b64_tr_b16 v[36:37], v4 offset:0
    v_mfma_f32_16x16x32_bf16 v[148:151], v[40:43], v[196:199], v[148:151]
    ds_read_b64_tr_b16 v[38:39], v4 offset:1024
    v_mfma_f32_16x16x32_bf16 v[152:155], v[44:47], v[192:195], v[152:155]
    ds_read_b64_tr_b16 v[40:41], v5 offset:0
    v_mfma_f32_16x16x32_bf16 v[156:159], v[44:47], v[196:199], v[156:159]
    ds_read_b64_tr_b16 v[42:43], v5 offset:1024
    s_waitcnt vmcnt(13) lgkmcnt(10)
    v_mfma_f32_16x16x32_bf16 v[64:67], v[48:51], v[200:203], v[64:67]
    ds_read_b64_tr_b16 v[44:45], v6 offset:0
    v_mfma_f32_16x16x32_bf16 v[68:71], v[48:51], v[204:207], v[68:71]
    ds_read_b64_tr_b16 v[46:47], v6 offset:1024
    v_mfma_f32_16x16x32_bf16 v[72:75], v[52:55], v[200:203], v[72:75]
    ds_read_b64_tr_b16 v[48:49], v3 offset:4096
    v_mfma_f32_16x16x32_bf16 v[76:79], v[52:55], v[204:207], v[76:79]
    ds_read_b64_tr_b16 v[50:51], v3 offset:5120
    s_waitcnt lgkmcnt(10)
    v_mfma_f32_16x16x32_bf16 v[80:83], v[56:59], v[200:203], v[80:83]
    ds_read_b64_tr_b16 v[52:53], v4 offset:4096
    v_mfma_f32_16x16x32_bf16 v[84:87], v[56:59], v[204:207], v[84:87]
    ds_read_b64_tr_b16 v[54:55], v4 offset:5120
    v_mfma_f32_16x16x32_bf16 v[88:91], v[60:63], v[200:203], v[88:91]
    ds_read_b64_tr_b16 v[56:57], v5 offset:4096
    v_mfma_f32_16x16x32_bf16 v[92:95], v[60:63], v[204:207], v[92:95]
    ds_read_b64_tr_b16 v[58:59], v5 offset:5120
    s_waitcnt lgkmcnt(10)
    v_mfma_f32_16x16x32_bf16 v[96:99], v[200:203], v[32:35], v[96:99]
    ds_read_b64_tr_b16 v[60:61], v6 offset:4096
    v_mfma_f32_16x16x32_bf16 v[100:103], v[204:207], v[32:35], v[100:103]
    ds_read_b64_tr_b16 v[62:63], v6 offset:5120
    v_mfma_f32_16x16x32_bf16 v[104:107], v[200:203], v[36:39], v[104:107]
    ds_read_b64_tr_b16 v[32:33], v3 offset:8192
    v_mfma_f32_16x16x32_bf16 v[108:111], v[204:207], v[36:39], v[108:111]
    ds_read_b64_tr_b16 v[34:35], v3 offset:9216
    s_waitcnt lgkmcnt(10)
    v_mfma_f32_16x16x32_bf16 v[112:115], v[200:203], v[40:43], v[112:115]
    ds_read_b64_tr_b16 v[36:37], v4 offset:8192
    v_mfma_f32_16x16x32_bf16 v[116:119], v[204:207], v[40:43], v[116:119]
    ds_read_b64_tr_b16 v[38:39], v4 offset:9216
    v_mfma_f32_16x16x32_bf16 v[120:123], v[200:203], v[44:47], v[120:123]
    ds_read_b64_tr_b16 v[40:41], v5 offset:8192
    v_mfma_f32_16x16x32_bf16 v[124:127], v[204:207], v[44:47], v[124:127]
    ds_read_b64_tr_b16 v[42:43], v5 offset:9216
    s_waitcnt lgkmcnt(10)
    v_mfma_f32_16x16x32_bf16 v[128:131], v[48:51], v[200:203], v[128:131]
    ds_read_b64_tr_b16 v[44:45], v6 offset:8192
    v_mfma_f32_16x16x32_bf16 v[132:135], v[48:51], v[204:207], v[132:135]
    ds_read_b64_tr_b16 v[46:47], v6 offset:9216
    v_mfma_f32_16x16x32_bf16 v[136:139], v[52:55], v[200:203], v[136:139]
    ds_read_b64_tr_b16 v[48:49], v3 offset:12288
    v_mfma_f32_16x16x32_bf16 v[140:143], v[52:55], v[204:207], v[140:143]
    ds_read_b64_tr_b16 v[50:51], v3 offset:13312
    s_waitcnt lgkmcnt(10)
    v_mfma_f32_16x16x32_bf16 v[144:147], v[56:59], v[200:203], v[144:147]
    ds_read_b64_tr_b16 v[52:53], v4 offset:12288
    v_mfma_f32_16x16x32_bf16 v[148:151], v[56:59], v[204:207], v[148:151]
    ds_read_b64_tr_b16 v[54:55], v4 offset:13312
    v_mfma_f32_16x16x32_bf16 v[152:155], v[60:63], v[200:203], v[152:155]
    ds_read_b64_tr_b16 v[56:57], v5 offset:12288
    v_mfma_f32_16x16x32_bf16 v[156:159], v[60:63], v[204:207], v[156:159]
    ds_read_b64_tr_b16 v[58:59], v5 offset:13312
    s_waitcnt vmcnt(11) lgkmcnt(10)
    v_mfma_f32_16x16x32_bf16 v[64:67], v[32:35], v[208:211], v[64:67]
    ds_read_b64_tr_b16 v[60:61], v6 offset:12288
    v_mfma_f32_16x16x32_bf16 v[68:71], v[32:35], v[212:215], v[68:71]
    ds_read_b64_tr_b16 v[62:63], v6 offset:13312
    v_mfma_f32_16x16x32_bf16 v[72:75], v[36:39], v[208:211], v[72:75]
    ds_read_b64_tr_b16 v[32:33], v3 offset:16384
    v_mfma_f32_16x16x32_bf16 v[76:79], v[36:39], v[212:215], v[76:79]
    ds_read_b64_tr_b16 v[34:35], v3 offset:17408
    s_waitcnt lgkmcnt(10)
    v_mfma_f32_16x16x32_bf16 v[80:83], v[40:43], v[208:211], v[80:83]
    ds_read_b64_tr_b16 v[36:37], v4 offset:16384
    v_mfma_f32_16x16x32_bf16 v[84:87], v[40:43], v[212:215], v[84:87]
    ds_read_b64_tr_b16 v[38:39], v4 offset:17408
    v_mfma_f32_16x16x32_bf16 v[88:91], v[44:47], v[208:211], v[88:91]
    ds_read_b64_tr_b16 v[40:41], v5 offset:16384
    v_mfma_f32_16x16x32_bf16 v[92:95], v[44:47], v[212:215], v[92:95]
    ds_read_b64_tr_b16 v[42:43], v5 offset:17408
    s_waitcnt lgkmcnt(10)
    v_mfma_f32_16x16x32_bf16 v[96:99], v[208:211], v[48:51], v[96:99]
    ds_read_b64_tr_b16 v[44:45], v6 offset:16384
    buffer_load_dwordx4 v[164:167], v2, s[4:7], s42 offen offset:256 sc1
    v_mfma_f32_16x16x32_bf16 v[100:103], v[212:215], v[48:51], v[100:103]
    ds_read_b64_tr_b16 v[46:47], v6 offset:17408
    v_mfma_f32_16x16x32_bf16 v[104:107], v[208:211], v[52:55], v[104:107]
    ds_read_b64_tr_b16 v[48:49], v3 offset:20480
    buffer_load_dwordx4 v[168:171], v2, s[4:7], s42 offen offset:2048 sc1
    v_mfma_f32_16x16x32_bf16 v[108:111], v[212:215], v[52:55], v[108:111]
    ds_read_b64_tr_b16 v[50:51], v3 offset:21504
    s_waitcnt lgkmcnt(10)
    v_mfma_f32_16x16x32_bf16 v[112:115], v[208:211], v[56:59], v[112:115]
    ds_read_b64_tr_b16 v[52:53], v4 offset:20480
    buffer_load_dwordx4 v[172:175], v2, s[4:7], s42 offen offset:2304 sc1
    v_mfma_f32_16x16x32_bf16 v[116:119], v[212:215], v[56:59], v[116:119]
    ds_read_b64_tr_b16 v[54:55], v4 offset:21504
    v_mfma_f32_16x16x32_bf16 v[120:123], v[208:211], v[60:63], v[120:123]
    ds_read_b64_tr_b16 v[56:57], v5 offset:20480
    s_add_u32 s42, s41, s91
    buffer_load_dwordx4 v[176:179], v2, s[4:7], s42 offen offset:0 sc1
    v_mfma_f32_16x16x32_bf16 v[124:127], v[212:215], v[60:63], v[124:127]
    ds_read_b64_tr_b16 v[58:59], v5 offset:21504
    s_waitcnt lgkmcnt(10)
    v_mfma_f32_16x16x32_bf16 v[128:131], v[32:35], v[208:211], v[128:131]
    ds_read_b64_tr_b16 v[60:61], v6 offset:20480
    buffer_load_dwordx4 v[180:183], v2, s[4:7], s42 offen offset:256 sc1
    v_mfma_f32_16x16x32_bf16 v[132:135], v[32:35], v[212:215], v[132:135]
    ds_read_b64_tr_b16 v[62:63], v6 offset:21504
    v_mfma_f32_16x16x32_bf16 v[136:139], v[36:39], v[208:211], v[136:139]
    ds_read_b64_tr_b16 v[32:33], v3 offset:24576
    buffer_load_dwordx4 v[184:187], v2, s[4:7], s42 offen offset:2048 sc1
    v_mfma_f32_16x16x32_bf16 v[140:143], v[36:39], v[212:215], v[140:143]
    ds_read_b64_tr_b16 v[34:35], v3 offset:25600
    s_waitcnt lgkmcnt(10)
    v_mfma_f32_16x16x32_bf16 v[144:147], v[40:43], v[208:211], v[144:147]
    ds_read_b64_tr_b16 v[36:37], v4 offset:24576
    v_mfma_f32_16x16x32_bf16 v[148:151], v[40:43], v[212:215], v[148:151]
    ds_read_b64_tr_b16 v[38:39], v4 offset:25600
    v_mfma_f32_16x16x32_bf16 v[152:155], v[44:47], v[208:211], v[152:155]
    ds_read_b64_tr_b16 v[40:41], v5 offset:24576
    v_mfma_f32_16x16x32_bf16 v[156:159], v[44:47], v[212:215], v[156:159]
    ds_read_b64_tr_b16 v[42:43], v5 offset:25600
    s_waitcnt vmcnt(15) lgkmcnt(10)
    v_mfma_f32_16x16x32_bf16 v[64:67], v[48:51], v[216:219], v[64:67]
    ds_read_b64_tr_b16 v[44:45], v6 offset:24576
    v_mfma_f32_16x16x32_bf16 v[68:71], v[48:51], v[220:223], v[68:71]
    ds_read_b64_tr_b16 v[46:47], v6 offset:25600
    v_mfma_f32_16x16x32_bf16 v[72:75], v[52:55], v[216:219], v[72:75]
    ds_read_b64_tr_b16 v[48:49], v3 offset:28672
    v_mfma_f32_16x16x32_bf16 v[76:79], v[52:55], v[220:223], v[76:79]
    ds_read_b64_tr_b16 v[50:51], v3 offset:29696
    s_waitcnt lgkmcnt(10)
    v_mfma_f32_16x16x32_bf16 v[80:83], v[56:59], v[216:219], v[80:83]
    ds_read_b64_tr_b16 v[52:53], v4 offset:28672
    buffer_load_dwordx4 v[188:191], v2, s[4:7], s42 offen offset:2304 sc1
    v_mfma_f32_16x16x32_bf16 v[84:87], v[56:59], v[220:223], v[84:87]
    ds_read_b64_tr_b16 v[54:55], v4 offset:29696
    v_mfma_f32_16x16x32_bf16 v[88:91], v[60:63], v[216:219], v[88:91]
    ds_read_b64_tr_b16 v[56:57], v5 offset:28672
    v_mfma_f32_16x16x32_bf16 v[92:95], v[60:63], v[220:223], v[92:95]
    ds_read_b64_tr_b16 v[58:59], v5 offset:29696
    s_waitcnt lgkmcnt(10)
    v_mfma_f32_16x16x32_bf16 v[96:99], v[216:219], v[32:35], v[96:99]
    ds_read_b64_tr_b16 v[60:61], v6 offset:28672
    v_mfma_f32_16x16x32_bf16 v[100:103], v[220:223], v[32:35], v[100:103]
    ds_read_b64_tr_b16 v[62:63], v6 offset:29696
    s_barrier
    v_mfma_f32_16x16x32_bf16 v[104:107], v[216:219], v[36:39], v[104:107]
    ds_read_b64_tr_b16 v[32:33], v3 offset:32768
    v_mfma_f32_16x16x32_bf16 v[108:111], v[220:223], v[36:39], v[108:111]
    ds_read_b64_tr_b16 v[34:35], v3 offset:33792
    s_waitcnt lgkmcnt(10)
    v_mfma_f32_16x16x32_bf16 v[112:115], v[216:219], v[40:43], v[112:115]
    ds_read_b64_tr_b16 v[36:37], v4 offset:32768
    v_mfma_f32_16x16x32_bf16 v[116:119], v[220:223], v[40:43], v[116:119]
    ds_read_b64_tr_b16 v[38:39], v4 offset:33792
    v_mfma_f32_16x16x32_bf16 v[120:123], v[216:219], v[44:47], v[120:123]
    ds_read_b64_tr_b16 v[40:41], v5 offset:32768
    v_mfma_f32_16x16x32_bf16 v[124:127], v[220:223], v[44:47], v[124:127]
    ds_read_b64_tr_b16 v[42:43], v5 offset:33792
    s_waitcnt lgkmcnt(10)
    v_mfma_f32_16x16x32_bf16 v[128:131], v[48:51], v[216:219], v[128:131]
    ds_read_b64_tr_b16 v[44:45], v6 offset:32768
    v_mfma_f32_16x16x32_bf16 v[132:135], v[48:51], v[220:223], v[132:135]
    ds_read_b64_tr_b16 v[46:47], v6 offset:33792
    v_mfma_f32_16x16x32_bf16 v[136:139], v[52:55], v[216:219], v[136:139]
    ds_read_b64_tr_b16 v[48:49], v3 offset:36864
    v_mfma_f32_16x16x32_bf16 v[140:143], v[52:55], v[220:223], v[140:143]
    ds_read_b64_tr_b16 v[50:51], v3 offset:37888
    s_waitcnt lgkmcnt(10)
    v_mfma_f32_16x16x32_bf16 v[144:147], v[56:59], v[216:219], v[144:147]
    ds_read_b64_tr_b16 v[52:53], v4 offset:36864
    v_mfma_f32_16x16x32_bf16 v[148:151], v[56:59], v[220:223], v[148:151]
    ds_read_b64_tr_b16 v[54:55], v4 offset:37888
    v_mfma_f32_16x16x32_bf16 v[152:155], v[60:63], v[216:219], v[152:155]
    ds_read_b64_tr_b16 v[56:57], v5 offset:36864
    v_mfma_f32_16x16x32_bf16 v[156:159], v[60:63], v[220:223], v[156:159]
    ds_read_b64_tr_b16 v[58:59], v5 offset:37888
    s_waitcnt vmcnt(14) lgkmcnt(10)
    v_mfma_f32_16x16x32_bf16 v[64:67], v[32:35], v[224:227], v[64:67]
    ds_read_b64_tr_b16 v[60:61], v6 offset:36864
    v_mfma_f32_16x16x32_bf16 v[68:71], v[32:35], v[228:231], v[68:71]
    ds_read_b64_tr_b16 v[62:63], v6 offset:37888
    v_mfma_f32_16x16x32_bf16 v[72:75], v[36:39], v[224:227], v[72:75]
    ds_read_b64_tr_b16 v[32:33], v3 offset:40960
    v_mfma_f32_16x16x32_bf16 v[76:79], v[36:39], v[228:231], v[76:79]
    ds_read_b64_tr_b16 v[34:35], v3 offset:41984
    s_waitcnt lgkmcnt(10)
    v_mfma_f32_16x16x32_bf16 v[80:83], v[40:43], v[224:227], v[80:83]
    ds_read_b64_tr_b16 v[36:37], v4 offset:40960
    v_mfma_f32_16x16x32_bf16 v[84:87], v[40:43], v[228:231], v[84:87]
    ds_read_b64_tr_b16 v[38:39], v4 offset:41984
    v_mfma_f32_16x16x32_bf16 v[88:91], v[44:47], v[224:227], v[88:91]
    ds_read_b64_tr_b16 v[40:41], v5 offset:40960
    v_mfma_f32_16x16x32_bf16 v[92:95], v[44:47], v[228:231], v[92:95]
    ds_read_b64_tr_b16 v[42:43], v5 offset:41984
    s_waitcnt lgkmcnt(10)
    v_mfma_f32_16x16x32_bf16 v[96:99], v[224:227], v[48:51], v[96:99]
    ds_read_b64_tr_b16 v[44:45], v6 offset:40960
    v_mfma_f32_16x16x32_bf16 v[100:103], v[228:231], v[48:51], v[100:103]
    ds_read_b64_tr_b16 v[46:47], v6 offset:41984
    v_mfma_f32_16x16x32_bf16 v[104:107], v[224:227], v[52:55], v[104:107]
    ds_read_b64_tr_b16 v[48:49], v3 offset:45056
    v_mfma_f32_16x16x32_bf16 v[108:111], v[228:231], v[52:55], v[108:111]
    ds_read_b64_tr_b16 v[50:51], v3 offset:46080
    s_waitcnt lgkmcnt(10)
    v_mfma_f32_16x16x32_bf16 v[112:115], v[224:227], v[56:59], v[112:115]
    ds_read_b64_tr_b16 v[52:53], v4 offset:45056
    v_mfma_f32_16x16x32_bf16 v[116:119], v[228:231], v[56:59], v[116:119]
    ds_read_b64_tr_b16 v[54:55], v4 offset:46080
    v_mfma_f32_16x16x32_bf16 v[120:123], v[224:227], v[60:63], v[120:123]
    ds_read_b64_tr_b16 v[56:57], v5 offset:45056
    v_mfma_f32_16x16x32_bf16 v[124:127], v[228:231], v[60:63], v[124:127]
    ds_read_b64_tr_b16 v[58:59], v5 offset:46080
    s_waitcnt lgkmcnt(10)
    v_mfma_f32_16x16x32_bf16 v[128:131], v[32:35], v[224:227], v[128:131]
    ds_read_b64_tr_b16 v[60:61], v6 offset:45056
    v_mfma_f32_16x16x32_bf16 v[132:135], v[32:35], v[228:231], v[132:135]
    ds_read_b64_tr_b16 v[62:63], v6 offset:46080
    v_mfma_f32_16x16x32_bf16 v[136:139], v[36:39], v[224:227], v[136:139]
    ds_read_b64_tr_b16 v[32:33], v3 offset:49152
    v_mfma_f32_16x16x32_bf16 v[140:143], v[36:39], v[228:231], v[140:143]
    ds_read_b64_tr_b16 v[34:35], v3 offset:50176
    s_waitcnt lgkmcnt(10)
    v_mfma_f32_16x16x32_bf16 v[144:147], v[40:43], v[224:227], v[144:147]
    ds_read_b64_tr_b16 v[36:37], v4 offset:49152
    v_mfma_f32_16x16x32_bf16 v[148:151], v[40:43], v[228:231], v[148:151]
    ds_read_b64_tr_b16 v[38:39], v4 offset:50176
    v_mfma_f32_16x16x32_bf16 v[152:155], v[44:47], v[224:227], v[152:155]
    ds_read_b64_tr_b16 v[40:41], v5 offset:49152
    v_mfma_f32_16x16x32_bf16 v[156:159], v[44:47], v[228:231], v[156:159]
    ds_read_b64_tr_b16 v[42:43], v5 offset:50176
    s_waitcnt vmcnt(12) lgkmcnt(10)
    v_mfma_f32_16x16x32_bf16 v[64:67], v[48:51], v[232:235], v[64:67]
    ds_read_b64_tr_b16 v[44:45], v6 offset:49152
    s_add_u32 s42, s41, s92
    buffer_load_dwordx4 v[192:195], v2, s[4:7], s42 offen offset:0 sc1
    v_mfma_f32_16x16x32_bf16 v[68:71], v[48:51], v[236:239], v[68:71]
    ds_read_b64_tr_b16 v[46:47], v6 offset:50176
    v_mfma_f32_16x16x32_bf16 v[72:75], v[52:55], v[232:235], v[72:75]
    ds_read_b64_tr_b16 v[48:49], v3 offset:53248
    buffer_load_dwordx4 v[196:199], v2, s[4:7], s42 offen offset:256 sc1
    v_mfma_f32_16x16x32_bf16 v[76:79], v[52:55], v[236:239], v[76:79]
    ds_read_b64_tr_b16 v[50:51], v3 offset:54272
    s_waitcnt lgkmcnt(10)
    v_mfma_f32_16x16x32_bf16 v[80:83], v[56:59], v[232:235], v[80:83]
    ds_read_b64_tr_b16 v[52:53], v4 offset:53248
    buffer_load_dwordx4 v[200:203], v2, s[4:7], s42 offen offset:2048 sc1
    v_mfma_f32_16x16x32_bf16 v[84:87], v[56:59], v[236:239], v[84:87]
    ds_read_b64_tr_b16 v[54:55], v4 offset:54272
    v_mfma_f32_16x16x32_bf16 v[88:91], v[60:63], v[232:235], v[88:91]
    ds_read_b64_tr_b16 v[56:57], v5 offset:53248
    buffer_load_dwordx4 v[204:207], v2, s[4:7], s42 offen offset:2304 sc1
    v_mfma_f32_16x16x32_bf16 v[92:95], v[60:63], v[236:239], v[92:95]
    ds_read_b64_tr_b16 v[58:59], v5 offset:54272
    s_waitcnt lgkmcnt(10)
    v_mfma_f32_16x16x32_bf16 v[96:99], v[232:235], v[32:35], v[96:99]
    ds_read_b64_tr_b16 v[60:61], v6 offset:53248
    s_add_u32 s42, s41, s93
    buffer_load_dwordx4 v[208:211], v2, s[4:7], s42 offen offset:0 sc1
    v_mfma_f32_16x16x32_bf16 v[100:103], v[236:239], v[32:35], v[100:103]
    ds_read_b64_tr_b16 v[62:63], v6 offset:54272
    v_mfma_f32_16x16x32_bf16 v[104:107], v[232:235], v[36:39], v[104:107]
    ds_read_b64_tr_b16 v[32:33], v3 offset:57344
    v_mfma_f32_16x16x32_bf16 v[108:111], v[236:239], v[36:39], v[108:111]
    ds_read_b64_tr_b16 v[34:35], v3 offset:58368
    s_waitcnt lgkmcnt(10)
    v_mfma_f32_16x16x32_bf16 v[112:115], v[232:235], v[40:43], v[112:115]
    ds_read_b64_tr_b16 v[36:37], v4 offset:57344
    v_mfma_f32_16x16x32_bf16 v[116:119], v[236:239], v[40:43], v[116:119]
    ds_read_b64_tr_b16 v[38:39], v4 offset:58368
    v_mfma_f32_16x16x32_bf16 v[120:123], v[232:235], v[44:47], v[120:123]
    ds_read_b64_tr_b16 v[40:41], v5 offset:57344
    buffer_load_dwordx4 v[212:215], v2, s[4:7], s42 offen offset:256 sc1
    v_mfma_f32_16x16x32_bf16 v[124:127], v[236:239], v[44:47], v[124:127]
    ds_read_b64_tr_b16 v[42:43], v5 offset:58368
    s_waitcnt lgkmcnt(10)
    v_mfma_f32_16x16x32_bf16 v[128:131], v[48:51], v[232:235], v[128:131]
    ds_read_b64_tr_b16 v[44:45], v6 offset:57344
    v_mfma_f32_16x16x32_bf16 v[132:135], v[48:51], v[236:239], v[132:135]
    ds_read_b64_tr_b16 v[46:47], v6 offset:58368
    v_mfma_f32_16x16x32_bf16 v[136:139], v[52:55], v[232:235], v[136:139]
    ds_read_b64_tr_b16 v[48:49], v3 offset:61440
    v_mfma_f32_16x16x32_bf16 v[140:143], v[52:55], v[236:239], v[140:143]
    ds_read_b64_tr_b16 v[50:51], v3 offset:62464
    s_waitcnt lgkmcnt(10)
    v_mfma_f32_16x16x32_bf16 v[144:147], v[56:59], v[232:235], v[144:147]
    ds_read_b64_tr_b16 v[52:53], v4 offset:61440
    v_mfma_f32_16x16x32_bf16 v[148:151], v[56:59], v[236:239], v[148:151]
    ds_read_b64_tr_b16 v[54:55], v4 offset:62464
    v_mfma_f32_16x16x32_bf16 v[152:155], v[60:63], v[232:235], v[152:155]
    ds_read_b64_tr_b16 v[56:57], v5 offset:61440
    v_mfma_f32_16x16x32_bf16 v[156:159], v[60:63], v[236:239], v[156:159]
    ds_read_b64_tr_b16 v[58:59], v5 offset:62464
    s_waitcnt vmcnt(16) lgkmcnt(10)
    v_mfma_f32_16x16x32_bf16 v[64:67], v[32:35], v[240:243], v[64:67]
    ds_read_b64_tr_b16 v[60:61], v6 offset:61440
    v_mfma_f32_16x16x32_bf16 v[68:71], v[32:35], v[244:247], v[68:71]
    ds_read_b64_tr_b16 v[62:63], v6 offset:62464
    s_barrier
    v_xor_b32 v3, 0x10000, v3
    v_xor_b32 v4, 0x10000, v4
    v_xor_b32 v5, 0x10000, v5
    v_xor_b32 v6, 0x10000, v6
    v_mfma_f32_16x16x32_bf16 v[72:75], v[36:39], v[240:243], v[72:75]
    ds_read_b64_tr_b16 v[32:33], v3 offset:0
    v_mfma_f32_16x16x32_bf16 v[76:79], v[36:39], v[244:247], v[76:79]
    ds_read_b64_tr_b16 v[34:35], v3 offset:1024
    s_waitcnt lgkmcnt(10)
    v_mfma_f32_16x16x32_bf16 v[80:83], v[40:43], v[240:243], v[80:83]
    ds_read_b64_tr_b16 v[36:37], v4 offset:0
    v_mfma_f32_16x16x32_bf16 v[84:87], v[40:43], v[244:247], v[84:87]
    ds_read_b64_tr_b16 v[38:39], v4 offset:1024
    v_mfma_f32_16x16x32_bf16 v[88:91], v[44:47], v[240:243], v[88:91]
    ds_read_b64_tr_b16 v[40:41], v5 offset:0
    v_mfma_f32_16x16x32_bf16 v[92:95], v[44:47], v[244:247], v[92:95]
    ds_read_b64_tr_b16 v[42:43], v5 offset:1024
    s_waitcnt lgkmcnt(10)
    v_mfma_f32_16x16x32_bf16 v[96:99], v[240:243], v[48:51], v[96:99]
    ds_read_b64_tr_b16 v[44:45], v6 offset:0
    v_mfma_f32_16x16x32_bf16 v[100:103], v[244:247], v[48:51], v[100:103]
    ds_read_b64_tr_b16 v[46:47], v6 offset:1024
    v_mfma_f32_16x16x32_bf16 v[104:107], v[240:243], v[52:55], v[104:107]
    ds_read_b64_tr_b16 v[48:49], v3 offset:4096
    v_mfma_f32_16x16x32_bf16 v[108:111], v[244:247], v[52:55], v[108:111]
    ds_read_b64_tr_b16 v[50:51], v3 offset:5120
    s_waitcnt lgkmcnt(10)
    v_mfma_f32_16x16x32_bf16 v[112:115], v[240:243], v[56:59], v[112:115]
    ds_read_b64_tr_b16 v[52:53], v4 offset:4096
    v_mfma_f32_16x16x32_bf16 v[116:119], v[244:247], v[56:59], v[116:119]
    ds_read_b64_tr_b16 v[54:55], v4 offset:5120
    v_mfma_f32_16x16x32_bf16 v[120:123], v[240:243], v[60:63], v[120:123]
    ds_read_b64_tr_b16 v[56:57], v5 offset:4096
    v_mfma_f32_16x16x32_bf16 v[124:127], v[244:247], v[60:63], v[124:127]
    ds_read_b64_tr_b16 v[58:59], v5 offset:5120
    s_waitcnt lgkmcnt(10)
    v_mfma_f32_16x16x32_bf16 v[128:131], v[32:35], v[240:243], v[128:131]
    ds_read_b64_tr_b16 v[60:61], v6 offset:4096
    v_mfma_f32_16x16x32_bf16 v[132:135], v[32:35], v[244:247], v[132:135]
    ds_read_b64_tr_b16 v[62:63], v6 offset:5120
    v_mfma_f32_16x16x32_bf16 v[136:139], v[36:39], v[240:243], v[136:139]
    ds_read_b64_tr_b16 v[32:33], v3 offset:8192
    v_mfma_f32_16x16x32_bf16 v[140:143], v[36:39], v[244:247], v[140:143]
    ds_read_b64_tr_b16 v[34:35], v3 offset:9216
    s_waitcnt lgkmcnt(10)
    v_mfma_f32_16x16x32_bf16 v[144:147], v[40:43], v[240:243], v[144:147]
    ds_read_b64_tr_b16 v[36:37], v4 offset:8192
    v_mfma_f32_16x16x32_bf16 v[148:151], v[40:43], v[244:247], v[148:151]
    ds_read_b64_tr_b16 v[38:39], v4 offset:9216
    v_mfma_f32_16x16x32_bf16 v[152:155], v[44:47], v[240:243], v[152:155]
    ds_read_b64_tr_b16 v[40:41], v5 offset:8192
    v_mfma_f32_16x16x32_bf16 v[156:159], v[44:47], v[244:247], v[156:159]
    ds_read_b64_tr_b16 v[42:43], v5 offset:9216
    s_waitcnt vmcnt(14) lgkmcnt(10)
    v_mfma_f32_16x16x32_bf16 v[64:67], v[48:51], v[248:251], v[64:67]
    ds_read_b64_tr_b16 v[44:45], v6 offset:8192
    v_mfma_f32_16x16x32_bf16 v[68:71], v[48:51], v[252:255], v[68:71]
    ds_read_b64_tr_b16 v[46:47], v6 offset:9216
    v_mfma_f32_16x16x32_bf16 v[72:75], v[52:55], v[248:251], v[72:75]
    ds_read_b64_tr_b16 v[48:49], v3 offset:12288
    v_mfma_f32_16x16x32_bf16 v[76:79], v[52:55], v[252:255], v[76:79]
    ds_read_b64_tr_b16 v[50:51], v3 offset:13312
    s_waitcnt lgkmcnt(10)
    v_mfma_f32_16x16x32_bf16 v[80:83], v[56:59], v[248:251], v[80:83]
    ds_read_b64_tr_b16 v[52:53], v4 offset:12288
    v_mfma_f32_16x16x32_bf16 v[84:87], v[56:59], v[252:255], v[84:87]
    ds_read_b64_tr_b16 v[54:55], v4 offset:13312
    v_mfma_f32_16x16x32_bf16 v[88:91], v[60:63], v[248:251], v[88:91]
    ds_read_b64_tr_b16 v[56:57], v5 offset:12288
    v_mfma_f32_16x16x32_bf16 v[92:95], v[60:63], v[252:255], v[92:95]
    ds_read_b64_tr_b16 v[58:59], v5 offset:13312
    s_waitcnt lgkmcnt(10)
    v_mfma_f32_16x16x32_bf16 v[96:99], v[248:251], v[32:35], v[96:99]
    ds_read_b64_tr_b16 v[60:61], v6 offset:12288
    v_mfma_f32_16x16x32_bf16 v[100:103], v[252:255], v[32:35], v[100:103]
    ds_read_b64_tr_b16 v[62:63], v6 offset:13312
    v_mfma_f32_16x16x32_bf16 v[104:107], v[248:251], v[36:39], v[104:107]
    ds_read_b64_tr_b16 v[32:33], v3 offset:16384
    v_mfma_f32_16x16x32_bf16 v[108:111], v[252:255], v[36:39], v[108:111]
    ds_read_b64_tr_b16 v[34:35], v3 offset:17408
    s_waitcnt lgkmcnt(10)
    v_mfma_f32_16x16x32_bf16 v[112:115], v[248:251], v[40:43], v[112:115]
    ds_read_b64_tr_b16 v[36:37], v4 offset:16384
    v_mfma_f32_16x16x32_bf16 v[116:119], v[252:255], v[40:43], v[116:119]
    ds_read_b64_tr_b16 v[38:39], v4 offset:17408
    v_mfma_f32_16x16x32_bf16 v[120:123], v[248:251], v[44:47], v[120:123]
    ds_read_b64_tr_b16 v[40:41], v5 offset:16384
    v_mfma_f32_16x16x32_bf16 v[124:127], v[252:255], v[44:47], v[124:127]
    ds_read_b64_tr_b16 v[42:43], v5 offset:17408
    s_waitcnt lgkmcnt(10)
    v_mfma_f32_16x16x32_bf16 v[128:131], v[48:51], v[248:251], v[128:131]
    ds_read_b64_tr_b16 v[44:45], v6 offset:16384
    buffer_load_dwordx4 v[216:219], v2, s[4:7], s42 offen offset:2048 sc1
    v_mfma_f32_16x16x32_bf16 v[132:135], v[48:51], v[252:255], v[132:135]
    ds_read_b64_tr_b16 v[46:47], v6 offset:17408
    v_mfma_f32_16x16x32_bf16 v[136:139], v[52:55], v[248:251], v[136:139]
    ds_read_b64_tr_b16 v[48:49], v3 offset:20480
    buffer_load_dwordx4 v[220:223], v2, s[4:7], s42 offen offset:2304 sc1
    v_mfma_f32_16x16x32_bf16 v[140:143], v[52:55], v[252:255], v[140:143]
    ds_read_b64_tr_b16 v[50:51], v3 offset:21504
    s_waitcnt lgkmcnt(10)
    v_mfma_f32_16x16x32_bf16 v[144:147], v[56:59], v[248:251], v[144:147]
    ds_read_b64_tr_b16 v[52:53], v4 offset:20480
    s_add_u32 s42, s41, s94
    buffer_load_dwordx4 v[224:227], v2, s[4:7], s42 offen offset:0 sc1
    v_mfma_f32_16x16x32_bf16 v[148:151], v[56:59], v[252:255], v[148:151]
    ds_read_b64_tr_b16 v[54:55], v4 offset:21504
    v_mfma_f32_16x16x32_bf16 v[152:155], v[60:63], v[248:251], v[152:155]
    ds_read_b64_tr_b16 v[56:57], v5 offset:20480
    buffer_load_dwordx4 v[228:231], v2, s[4:7], s42 offen offset:256 sc1
    v_mfma_f32_16x16x32_bf16 v[156:159], v[60:63], v[252:255], v[156:159]
    ds_read_b64_tr_b16 v[58:59], v5 offset:21504
    s_waitcnt vmcnt(16) lgkmcnt(10)
    v_mfma_f32_16x16x32_bf16 v[64:67], v[32:35], v[160:163], v[64:67]
    ds_read_b64_tr_b16 v[60:61], v6 offset:20480
    buffer_load_dwordx4 v[232:235], v2, s[4:7], s42 offen offset:2048 sc1
    v_mfma_f32_16x16x32_bf16 v[68:71], v[32:35], v[164:167], v[68:71]
    ds_read_b64_tr_b16 v[62:63], v6 offset:21504
    v_mfma_f32_16x16x32_bf16 v[72:75], v[36:39], v[160:163], v[72:75]
    ds_read_b64_tr_b16 v[32:33], v3 offset:24576
    buffer_load_dwordx4 v[236:239], v2, s[4:7], s42 offen offset:2304 sc1
    v_mfma_f32_16x16x32_bf16 v[76:79], v[36:39], v[164:167], v[76:79]
    ds_read_b64_tr_b16 v[34:35], v3 offset:25600
    s_waitcnt lgkmcnt(10)
    v_mfma_f32_16x16x32_bf16 v[80:83], v[40:43], v[160:163], v[80:83]
    ds_read_b64_tr_b16 v[36:37], v4 offset:24576
    v_mfma_f32_16x16x32_bf16 v[84:87], v[40:43], v[164:167], v[84:87]
    ds_read_b64_tr_b16 v[38:39], v4 offset:25600
    v_mfma_f32_16x16x32_bf16 v[88:91], v[44:47], v[160:163], v[88:91]
    ds_read_b64_tr_b16 v[40:41], v5 offset:24576
    v_mfma_f32_16x16x32_bf16 v[92:95], v[44:47], v[164:167], v[92:95]
    ds_read_b64_tr_b16 v[42:43], v5 offset:25600
    s_waitcnt lgkmcnt(10)
    v_mfma_f32_16x16x32_bf16 v[96:99], v[160:163], v[48:51], v[96:99]
    ds_read_b64_tr_b16 v[44:45], v6 offset:24576
    s_add_u32 s42, s41, s95
    buffer_load_dwordx4 v[240:243], v2, s[4:7], s42 offen offset:0 sc1
    v_mfma_f32_16x16x32_bf16 v[100:103], v[164:167], v[48:51], v[100:103]
    ds_read_b64_tr_b16 v[46:47], v6 offset:25600
    v_mfma_f32_16x16x32_bf16 v[104:107], v[160:163], v[52:55], v[104:107]
    ds_read_b64_tr_b16 v[48:49], v3 offset:28672
    v_mfma_f32_16x16x32_bf16 v[108:111], v[164:167], v[52:55], v[108:111]
    ds_read_b64_tr_b16 v[50:51], v3 offset:29696
    s_waitcnt lgkmcnt(10)
    v_mfma_f32_16x16x32_bf16 v[112:115], v[160:163], v[56:59], v[112:115]
    ds_read_b64_tr_b16 v[52:53], v4 offset:28672
    v_mfma_f32_16x16x32_bf16 v[116:119], v[164:167], v[56:59], v[116:119]
    ds_read_b64_tr_b16 v[54:55], v4 offset:29696
    v_mfma_f32_16x16x32_bf16 v[120:123], v[160:163], v[60:63], v[120:123]
    ds_read_b64_tr_b16 v[56:57], v5 offset:28672
    v_mfma_f32_16x16x32_bf16 v[124:127], v[164:167], v[60:63], v[124:127]
    ds_read_b64_tr_b16 v[58:59], v5 offset:29696
    s_waitcnt lgkmcnt(10)
    v_mfma_f32_16x16x32_bf16 v[128:131], v[32:35], v[160:163], v[128:131]
    ds_read_b64_tr_b16 v[60:61], v6 offset:28672
    v_mfma_f32_16x16x32_bf16 v[132:135], v[32:35], v[164:167], v[132:135]
    ds_read_b64_tr_b16 v[62:63], v6 offset:29696
    s_barrier
    v_mfma_f32_16x16x32_bf16 v[136:139], v[36:39], v[160:163], v[136:139]
    ds_read_b64_tr_b16 v[32:33], v3 offset:32768
    v_mfma_f32_16x16x32_bf16 v[140:143], v[36:39], v[164:167], v[140:143]
    ds_read_b64_tr_b16 v[34:35], v3 offset:33792
    s_waitcnt lgkmcnt(10)
    v_mfma_f32_16x16x32_bf16 v[144:147], v[40:43], v[160:163], v[144:147]
    ds_read_b64_tr_b16 v[36:37], v4 offset:32768
    v_mfma_f32_16x16x32_bf16 v[148:151], v[40:43], v[164:167], v[148:151]
    ds_read_b64_tr_b16 v[38:39], v4 offset:33792
    v_mfma_f32_16x16x32_bf16 v[152:155], v[44:47], v[160:163], v[152:155]
    ds_read_b64_tr_b16 v[40:41], v5 offset:32768
    v_mfma_f32_16x16x32_bf16 v[156:159], v[44:47], v[164:167], v[156:159]
    ds_read_b64_tr_b16 v[42:43], v5 offset:33792
    s_waitcnt vmcnt(17) lgkmcnt(10)
    v_mfma_f32_16x16x32_bf16 v[64:67], v[48:51], v[168:171], v[64:67]
    ds_read_b64_tr_b16 v[44:45], v6 offset:32768
    v_mfma_f32_16x16x32_bf16 v[68:71], v[48:51], v[172:175], v[68:71]
    ds_read_b64_tr_b16 v[46:47], v6 offset:33792
    v_mfma_f32_16x16x32_bf16 v[72:75], v[52:55], v[168:171], v[72:75]
    ds_read_b64_tr_b16 v[48:49], v3 offset:36864
    v_mfma_f32_16x16x32_bf16 v[76:79], v[52:55], v[172:175], v[76:79]
    ds_read_b64_tr_b16 v[50:51], v3 offset:37888
    s_waitcnt lgkmcnt(10)
    v_mfma_f32_16x16x32_bf16 v[80:83], v[56:59], v[168:171], v[80:83]
    ds_read_b64_tr_b16 v[52:53], v4 offset:36864
    v_mfma_f32_16x16x32_bf16 v[84:87], v[56:59], v[172:175], v[84:87]
    ds_read_b64_tr_b16 v[54:55], v4 offset:37888
    v_mfma_f32_16x16x32_bf16 v[88:91], v[60:63], v[168:171], v[88:91]
    ds_read_b64_tr_b16 v[56:57], v5 offset:36864
    v_mfma_f32_16x16x32_bf16 v[92:95], v[60:63], v[172:175], v[92:95]
    ds_read_b64_tr_b16 v[58:59], v5 offset:37888
    s_waitcnt lgkmcnt(10)
    v_mfma_f32_16x16x32_bf16 v[96:99], v[168:171], v[32:35], v[96:99]
    ds_read_b64_tr_b16 v[60:61], v6 offset:36864
    v_mfma_f32_16x16x32_bf16 v[100:103], v[172:175], v[32:35], v[100:103]
    ds_read_b64_tr_b16 v[62:63], v6 offset:37888
    v_mfma_f32_16x16x32_bf16 v[104:107], v[168:171], v[36:39], v[104:107]
    ds_read_b64_tr_b16 v[32:33], v3 offset:40960
    v_mfma_f32_16x16x32_bf16 v[108:111], v[172:175], v[36:39], v[108:111]
    ds_read_b64_tr_b16 v[34:35], v3 offset:41984
    s_waitcnt lgkmcnt(10)
    v_mfma_f32_16x16x32_bf16 v[112:115], v[168:171], v[40:43], v[112:115]
    ds_read_b64_tr_b16 v[36:37], v4 offset:40960
    v_mfma_f32_16x16x32_bf16 v[116:119], v[172:175], v[40:43], v[116:119]
    ds_read_b64_tr_b16 v[38:39], v4 offset:41984
    v_mfma_f32_16x16x32_bf16 v[120:123], v[168:171], v[44:47], v[120:123]
    ds_read_b64_tr_b16 v[40:41], v5 offset:40960
    v_mfma_f32_16x16x32_bf16 v[124:127], v[172:175], v[44:47], v[124:127]
    ds_read_b64_tr_b16 v[42:43], v5 offset:41984
    s_waitcnt lgkmcnt(10)
    v_mfma_f32_16x16x32_bf16 v[128:131], v[48:51], v[168:171], v[128:131]
    ds_read_b64_tr_b16 v[44:45], v6 offset:40960
    v_mfma_f32_16x16x32_bf16 v[132:135], v[48:51], v[172:175], v[132:135]
    ds_read_b64_tr_b16 v[46:47], v6 offset:41984
    v_mfma_f32_16x16x32_bf16 v[136:139], v[52:55], v[168:171], v[136:139]
    ds_read_b64_tr_b16 v[48:49], v3 offset:45056
    v_mfma_f32_16x16x32_bf16 v[140:143], v[52:55], v[172:175], v[140:143]
    ds_read_b64_tr_b16 v[50:51], v3 offset:46080
    s_waitcnt lgkmcnt(10)
    v_mfma_f32_16x16x32_bf16 v[144:147], v[56:59], v[168:171], v[144:147]
    ds_read_b64_tr_b16 v[52:53], v4 offset:45056
    v_mfma_f32_16x16x32_bf16 v[148:151], v[56:59], v[172:175], v[148:151]
    ds_read_b64_tr_b16 v[54:55], v4 offset:46080
    v_mfma_f32_16x16x32_bf16 v[152:155], v[60:63], v[168:171], v[152:155]
    ds_read_b64_tr_b16 v[56:57], v5 offset:45056
    v_mfma_f32_16x16x32_bf16 v[156:159], v[60:63], v[172:175], v[156:159]
    ds_read_b64_tr_b16 v[58:59], v5 offset:46080
    s_waitcnt vmcnt(15) lgkmcnt(10)
    v_mfma_f32_16x16x32_bf16 v[64:67], v[32:35], v[176:179], v[64:67]
    ds_read_b64_tr_b16 v[60:61], v6 offset:45056
    v_mfma_f32_16x16x32_bf16 v[68:71], v[32:35], v[180:183], v[68:71]
    ds_read_b64_tr_b16 v[62:63], v6 offset:46080
    v_mfma_f32_16x16x32_bf16 v[72:75], v[36:39], v[176:179], v[72:75]
    ds_read_b64_tr_b16 v[32:33], v3 offset:49152
    v_mfma_f32_16x16x32_bf16 v[76:79], v[36:39], v[180:183], v[76:79]
    ds_read_b64_tr_b16 v[34:35], v3 offset:50176
    s_waitcnt lgkmcnt(10)
    v_mfma_f32_16x16x32_bf16 v[80:83], v[40:43], v[176:179], v[80:83]
    ds_read_b64_tr_b16 v[36:37], v4 offset:49152
    v_mfma_f32_16x16x32_bf16 v[84:87], v[40:43], v[180:183], v[84:87]
    ds_read_b64_tr_b16 v[38:39], v4 offset:50176
    v_mfma_f32_16x16x32_bf16 v[88:91], v[44:47], v[176:179], v[88:91]
    ds_read_b64_tr_b16 v[40:41], v5 offset:49152
    v_mfma_f32_16x16x32_bf16 v[92:95], v[44:47], v[180:183], v[92:95]
    ds_read_b64_tr_b16 v[42:43], v5 offset:50176
    s_waitcnt lgkmcnt(10)
    v_mfma_f32_16x16x32_bf16 v[96:99], v[176:179], v[48:51], v[96:99]
    ds_read_b64_tr_b16 v[44:45], v6 offset:49152
    buffer_load_dwordx4 v[244:247], v2, s[4:7], s42 offen offset:256 sc1
    v_mfma_f32_16x16x32_bf16 v[100:103], v[180:183], v[48:51], v[100:103]
    ds_read_b64_tr_b16 v[46:47], v6 offset:50176
    v_mfma_f32_16x16x32_bf16 v[104:107], v[176:179], v[52:55], v[104:107]
    ds_read_b64_tr_b16 v[48:49], v3 offset:53248
    buffer_load_dwordx4 v[248:251], v2, s[4:7], s42 offen offset:2048 sc1
    v_mfma_f32_16x16x32_bf16 v[108:111], v[180:183], v[52:55], v[108:111]
    ds_read_b64_tr_b16 v[50:51], v3 offset:54272
    s_waitcnt lgkmcnt(10)
    v_mfma_f32_16x16x32_bf16 v[112:115], v[176:179], v[56:59], v[112:115]
    ds_read_b64_tr_b16 v[52:53], v4 offset:53248
    buffer_load_dwordx4 v[252:255], v2, s[4:7], s42 offen offset:2304 sc1
    v_mfma_f32_16x16x32_bf16 v[116:119], v[180:183], v[56:59], v[116:119]
    ds_read_b64_tr_b16 v[54:55], v4 offset:54272
    v_mfma_f32_16x16x32_bf16 v[120:123], v[176:179], v[60:63], v[120:123]
    ds_read_b64_tr_b16 v[56:57], v5 offset:53248
    s_add_u32 s42, s41, s96
    buffer_load_dwordx4 v[160:163], v2, s[4:7], s42 offen offset:0 sc1
    v_mfma_f32_16x16x32_bf16 v[124:127], v[180:183], v[60:63], v[124:127]
    ds_read_b64_tr_b16 v[58:59], v5 offset:54272
    s_waitcnt lgkmcnt(10)
    v_mfma_f32_16x16x32_bf16 v[128:131], v[32:35], v[176:179], v[128:131]
    ds_read_b64_tr_b16 v[60:61], v6 offset:53248
    buffer_load_dwordx4 v[164:167], v2, s[4:7], s42 offen offset:256 sc1
    v_mfma_f32_16x16x32_bf16 v[132:135], v[32:35], v[180:183], v[132:135]
    ds_read_b64_tr_b16 v[62:63], v6 offset:54272
    v_mfma_f32_16x16x32_bf16 v[136:139], v[36:39], v[176:179], v[136:139]
    ds_read_b64_tr_b16 v[32:33], v3 offset:57344
    buffer_load_dwordx4 v[168:171], v2, s[4:7], s42 offen offset:2048 sc1
    v_mfma_f32_16x16x32_bf16 v[140:143], v[36:39], v[180:183], v[140:143]
    ds_read_b64_tr_b16 v[34:35], v3 offset:58368
    s_waitcnt lgkmcnt(10)
    v_mfma_f32_16x16x32_bf16 v[144:147], v[40:43], v[176:179], v[144:147]
    ds_read_b64_tr_b16 v[36:37], v4 offset:57344
    v_mfma_f32_16x16x32_bf16 v[148:151], v[40:43], v[180:183], v[148:151]
    ds_read_b64_tr_b16 v[38:39], v4 offset:58368
    v_mfma_f32_16x16x32_bf16 v[152:155], v[44:47], v[176:179], v[152:155]
    ds_read_b64_tr_b16 v[40:41], v5 offset:57344
    v_mfma_f32_16x16x32_bf16 v[156:159], v[44:47], v[180:183], v[156:159]
    ds_read_b64_tr_b16 v[42:43], v5 offset:58368
    s_waitcnt vmcnt(19) lgkmcnt(10)
    v_mfma_f32_16x16x32_bf16 v[64:67], v[48:51], v[184:187], v[64:67]
    ds_read_b64_tr_b16 v[44:45], v6 offset:57344
    v_mfma_f32_16x16x32_bf16 v[68:71], v[48:51], v[188:191], v[68:71]
    ds_read_b64_tr_b16 v[46:47], v6 offset:58368
    v_mfma_f32_16x16x32_bf16 v[72:75], v[52:55], v[184:187], v[72:75]
    ds_read_b64_tr_b16 v[48:49], v3 offset:61440
    v_mfma_f32_16x16x32_bf16 v[76:79], v[52:55], v[188:191], v[76:79]
    ds_read_b64_tr_b16 v[50:51], v3 offset:62464
    s_waitcnt lgkmcnt(10)
    v_mfma_f32_16x16x32_bf16 v[80:83], v[56:59], v[184:187], v[80:83]
    ds_read_b64_tr_b16 v[52:53], v4 offset:61440
    buffer_load_dwordx4 v[172:175], v2, s[4:7], s42 offen offset:2304 sc1
    v_mfma_f32_16x16x32_bf16 v[84:87], v[56:59], v[188:191], v[84:87]
    ds_read_b64_tr_b16 v[54:55], v4 offset:62464
    v_mfma_f32_16x16x32_bf16 v[88:91], v[60:63], v[184:187], v[88:91]
    ds_read_b64_tr_b16 v[56:57], v5 offset:61440
    v_mfma_f32_16x16x32_bf16 v[92:95], v[60:63], v[188:191], v[92:95]
    ds_read_b64_tr_b16 v[58:59], v5 offset:62464
    s_waitcnt lgkmcnt(10)
    v_mfma_f32_16x16x32_bf16 v[96:99], v[184:187], v[32:35], v[96:99]
    ds_read_b64_tr_b16 v[60:61], v6 offset:61440
    v_mfma_f32_16x16x32_bf16 v[100:103], v[188:191], v[32:35], v[100:103]
    ds_read_b64_tr_b16 v[62:63], v6 offset:62464
    s_barrier
    v_xor_b32 v3, 0x10000, v3
    v_xor_b32 v4, 0x10000, v4
    v_xor_b32 v5, 0x10000, v5
    v_xor_b32 v6, 0x10000, v6
    v_mfma_f32_16x16x32_bf16 v[104:107], v[184:187], v[36:39], v[104:107]
    ds_read_b64_tr_b16 v[32:33], v3 offset:0
    v_mfma_f32_16x16x32_bf16 v[108:111], v[188:191], v[36:39], v[108:111]
    ds_read_b64_tr_b16 v[34:35], v3 offset:1024
    s_waitcnt lgkmcnt(10)
    v_mfma_f32_16x16x32_bf16 v[112:115], v[184:187], v[40:43], v[112:115]
    ds_read_b64_tr_b16 v[36:37], v4 offset:0
    v_mfma_f32_16x16x32_bf16 v[116:119], v[188:191], v[40:43], v[116:119]
    ds_read_b64_tr_b16 v[38:39], v4 offset:1024
    v_mfma_f32_16x16x32_bf16 v[120:123], v[184:187], v[44:47], v[120:123]
    ds_read_b64_tr_b16 v[40:41], v5 offset:0
    v_mfma_f32_16x16x32_bf16 v[124:127], v[188:191], v[44:47], v[124:127]
    ds_read_b64_tr_b16 v[42:43], v5 offset:1024
    s_waitcnt lgkmcnt(10)
    v_mfma_f32_16x16x32_bf16 v[128:131], v[48:51], v[184:187], v[128:131]
    ds_read_b64_tr_b16 v[44:45], v6 offset:0
    v_mfma_f32_16x16x32_bf16 v[132:135], v[48:51], v[188:191], v[132:135]
    ds_read_b64_tr_b16 v[46:47], v6 offset:1024
    v_mfma_f32_16x16x32_bf16 v[136:139], v[52:55], v[184:187], v[136:139]
    ds_read_b64_tr_b16 v[48:49], v3 offset:4096
    v_mfma_f32_16x16x32_bf16 v[140:143], v[52:55], v[188:191], v[140:143]
    ds_read_b64_tr_b16 v[50:51], v3 offset:5120
    s_waitcnt lgkmcnt(10)
    v_mfma_f32_16x16x32_bf16 v[144:147], v[56:59], v[184:187], v[144:147]
    ds_read_b64_tr_b16 v[52:53], v4 offset:4096
    v_mfma_f32_16x16x32_bf16 v[148:151], v[56:59], v[188:191], v[148:151]
    ds_read_b64_tr_b16 v[54:55], v4 offset:5120
    v_mfma_f32_16x16x32_bf16 v[152:155], v[60:63], v[184:187], v[152:155]
    ds_read_b64_tr_b16 v[56:57], v5 offset:4096
    v_mfma_f32_16x16x32_bf16 v[156:159], v[60:63], v[188:191], v[156:159]
    ds_read_b64_tr_b16 v[58:59], v5 offset:5120
    s_waitcnt vmcnt(18) lgkmcnt(10)
    v_mfma_f32_16x16x32_bf16 v[64:67], v[32:35], v[192:195], v[64:67]
    ds_read_b64_tr_b16 v[60:61], v6 offset:4096
    v_mfma_f32_16x16x32_bf16 v[68:71], v[32:35], v[196:199], v[68:71]
    ds_read_b64_tr_b16 v[62:63], v6 offset:5120
    v_mfma_f32_16x16x32_bf16 v[72:75], v[36:39], v[192:195], v[72:75]
    ds_read_b64_tr_b16 v[32:33], v3 offset:8192
    v_mfma_f32_16x16x32_bf16 v[76:79], v[36:39], v[196:199], v[76:79]
    ds_read_b64_tr_b16 v[34:35], v3 offset:9216
    s_waitcnt lgkmcnt(10)
    v_mfma_f32_16x16x32_bf16 v[80:83], v[40:43], v[192:195], v[80:83]
    ds_read_b64_tr_b16 v[36:37], v4 offset:8192
    v_mfma_f32_16x16x32_bf16 v[84:87], v[40:43], v[196:199], v[84:87]
    ds_read_b64_tr_b16 v[38:39], v4 offset:9216
    v_mfma_f32_16x16x32_bf16 v[88:91], v[44:47], v[192:195], v[88:91]
    ds_read_b64_tr_b16 v[40:41], v5 offset:8192
    v_mfma_f32_16x16x32_bf16 v[92:95], v[44:47], v[196:199], v[92:95]
    ds_read_b64_tr_b16 v[42:43], v5 offset:9216
    s_waitcnt lgkmcnt(10)
    v_mfma_f32_16x16x32_bf16 v[96:99], v[192:195], v[48:51], v[96:99]
    ds_read_b64_tr_b16 v[44:45], v6 offset:8192
    v_mfma_f32_16x16x32_bf16 v[100:103], v[196:199], v[48:51], v[100:103]
    ds_read_b64_tr_b16 v[46:47], v6 offset:9216
    v_mfma_f32_16x16x32_bf16 v[104:107], v[192:195], v[52:55], v[104:107]
    ds_read_b64_tr_b16 v[48:49], v3 offset:12288
    v_mfma_f32_16x16x32_bf16 v[108:111], v[196:199], v[52:55], v[108:111]
    ds_read_b64_tr_b16 v[50:51], v3 offset:13312
    s_waitcnt lgkmcnt(10)
    v_mfma_f32_16x16x32_bf16 v[112:115], v[192:195], v[56:59], v[112:115]
    ds_read_b64_tr_b16 v[52:53], v4 offset:12288
    v_mfma_f32_16x16x32_bf16 v[116:119], v[196:199], v[56:59], v[116:119]
    ds_read_b64_tr_b16 v[54:55], v4 offset:13312
    v_mfma_f32_16x16x32_bf16 v[120:123], v[192:195], v[60:63], v[120:123]
    ds_read_b64_tr_b16 v[56:57], v5 offset:12288
    v_mfma_f32_16x16x32_bf16 v[124:127], v[196:199], v[60:63], v[124:127]
    ds_read_b64_tr_b16 v[58:59], v5 offset:13312
    s_waitcnt lgkmcnt(10)
    v_mfma_f32_16x16x32_bf16 v[128:131], v[32:35], v[192:195], v[128:131]
    ds_read_b64_tr_b16 v[60:61], v6 offset:12288
    v_mfma_f32_16x16x32_bf16 v[132:135], v[32:35], v[196:199], v[132:135]
    ds_read_b64_tr_b16 v[62:63], v6 offset:13312
    v_mfma_f32_16x16x32_bf16 v[136:139], v[36:39], v[192:195], v[136:139]
    ds_read_b64_tr_b16 v[32:33], v3 offset:16384
    v_mfma_f32_16x16x32_bf16 v[140:143], v[36:39], v[196:199], v[140:143]
    ds_read_b64_tr_b16 v[34:35], v3 offset:17408
    s_waitcnt lgkmcnt(10)
    v_mfma_f32_16x16x32_bf16 v[144:147], v[40:43], v[192:195], v[144:147]
    ds_read_b64_tr_b16 v[36:37], v4 offset:16384
    v_mfma_f32_16x16x32_bf16 v[148:151], v[40:43], v[196:199], v[148:151]
    ds_read_b64_tr_b16 v[38:39], v4 offset:17408
    v_mfma_f32_16x16x32_bf16 v[152:155], v[44:47], v[192:195], v[152:155]
    ds_read_b64_tr_b16 v[40:41], v5 offset:16384
    v_mfma_f32_16x16x32_bf16 v[156:159], v[44:47], v[196:199], v[156:159]
    ds_read_b64_tr_b16 v[42:43], v5 offset:17408
    s_waitcnt vmcnt(16) lgkmcnt(10)
    v_mfma_f32_16x16x32_bf16 v[64:67], v[48:51], v[200:203], v[64:67]
    ds_read_b64_tr_b16 v[44:45], v6 offset:16384
    s_add_u32 s42, s41, s97
    buffer_load_dwordx4 v[176:179], v2, s[4:7], s42 offen offset:0 sc1
    v_mfma_f32_16x16x32_bf16 v[68:71], v[48:51], v[204:207], v[68:71]
    ds_read_b64_tr_b16 v[46:47], v6 offset:17408
    v_mfma_f32_16x16x32_bf16 v[72:75], v[52:55], v[200:203], v[72:75]
    ds_read_b64_tr_b16 v[48:49], v3 offset:20480
    buffer_load_dwordx4 v[180:183], v2, s[4:7], s42 offen offset:256 sc1
    v_mfma_f32_16x16x32_bf16 v[76:79], v[52:55], v[204:207], v[76:79]
    ds_read_b64_tr_b16 v[50:51], v3 offset:21504
    s_waitcnt lgkmcnt(10)
    v_mfma_f32_16x16x32_bf16 v[80:83], v[56:59], v[200:203], v[80:83]
    ds_read_b64_tr_b16 v[52:53], v4 offset:20480
    buffer_load_dwordx4 v[184:187], v2, s[4:7], s42 offen offset:2048 sc1
    v_mfma_f32_16x16x32_bf16 v[84:87], v[56:59], v[204:207], v[84:87]
    ds_read_b64_tr_b16 v[54:55], v4 offset:21504
    v_mfma_f32_16x16x32_bf16 v[88:91], v[60:63], v[200:203], v[88:91]
    ds_read_b64_tr_b16 v[56:57], v5 offset:20480
    buffer_load_dwordx4 v[188:191], v2, s[4:7], s42 offen offset:2304 sc1
    v_mfma_f32_16x16x32_bf16 v[92:95], v[60:63], v[204:207], v[92:95]
    ds_read_b64_tr_b16 v[58:59], v5 offset:21504
    s_waitcnt lgkmcnt(10)
    v_mfma_f32_16x16x32_bf16 v[96:99], v[200:203], v[32:35], v[96:99]
    ds_read_b64_tr_b16 v[60:61], v6 offset:20480
    s_add_u32 s42, s41, s98
    buffer_load_dwordx4 v[192:195], v2, s[4:7], s42 offen offset:0 sc1
    v_mfma_f32_16x16x32_bf16 v[100:103], v[204:207], v[32:35], v[100:103]
    ds_read_b64_tr_b16 v[62:63], v6 offset:21504
    v_mfma_f32_16x16x32_bf16 v[104:107], v[200:203], v[36:39], v[104:107]
    ds_read_b64_tr_b16 v[32:33], v3 offset:24576
    v_mfma_f32_16x16x32_bf16 v[108:111], v[204:207], v[36:39], v[108:111]
    ds_read_b64_tr_b16 v[34:35], v3 offset:25600
    s_waitcnt lgkmcnt(10)
    v_mfma_f32_16x16x32_bf16 v[112:115], v[200:203], v[40:43], v[112:115]
    ds_read_b64_tr_b16 v[36:37], v4 offset:24576
    v_mfma_f32_16x16x32_bf16 v[116:119], v[204:207], v[40:43], v[116:119]
    ds_read_b64_tr_b16 v[38:39], v4 offset:25600
    v_mfma_f32_16x16x32_bf16 v[120:123], v[200:203], v[44:47], v[120:123]
    ds_read_b64_tr_b16 v[40:41], v5 offset:24576
    buffer_load_dwordx4 v[196:199], v2, s[4:7], s42 offen offset:256 sc1
    v_mfma_f32_16x16x32_bf16 v[124:127], v[204:207], v[44:47], v[124:127]
    ds_read_b64_tr_b16 v[42:43], v5 offset:25600
    s_waitcnt lgkmcnt(10)
    v_mfma_f32_16x16x32_bf16 v[128:131], v[48:51], v[200:203], v[128:131]
    ds_read_b64_tr_b16 v[44:45], v6 offset:24576
    v_mfma_f32_16x16x32_bf16 v[132:135], v[48:51], v[204:207], v[132:135]
    ds_read_b64_tr_b16 v[46:47], v6 offset:25600
    v_mfma_f32_16x16x32_bf16 v[136:139], v[52:55], v[200:203], v[136:139]
    ds_read_b64_tr_b16 v[48:49], v3 offset:28672
    v_mfma_f32_16x16x32_bf16 v[140:143], v[52:55], v[204:207], v[140:143]
    ds_read_b64_tr_b16 v[50:51], v3 offset:29696
    s_waitcnt lgkmcnt(10)
    v_mfma_f32_16x16x32_bf16 v[144:147], v[56:59], v[200:203], v[144:147]
    ds_read_b64_tr_b16 v[52:53], v4 offset:28672
    v_mfma_f32_16x16x32_bf16 v[148:151], v[56:59], v[204:207], v[148:151]
    ds_read_b64_tr_b16 v[54:55], v4 offset:29696
    v_mfma_f32_16x16x32_bf16 v[152:155], v[60:63], v[200:203], v[152:155]
    ds_read_b64_tr_b16 v[56:57], v5 offset:28672
    v_mfma_f32_16x16x32_bf16 v[156:159], v[60:63], v[204:207], v[156:159]
    ds_read_b64_tr_b16 v[58:59], v5 offset:29696
    s_waitcnt vmcnt(20) lgkmcnt(10)
    v_mfma_f32_16x16x32_bf16 v[64:67], v[32:35], v[208:211], v[64:67]
    ds_read_b64_tr_b16 v[60:61], v6 offset:28672
    v_mfma_f32_16x16x32_bf16 v[68:71], v[32:35], v[212:215], v[68:71]
    ds_read_b64_tr_b16 v[62:63], v6 offset:29696
    s_barrier
    v_mfma_f32_16x16x32_bf16 v[72:75], v[36:39], v[208:211], v[72:75]
    ds_read_b64_tr_b16 v[32:33], v3 offset:32768
    v_mfma_f32_16x16x32_bf16 v[76:79], v[36:39], v[212:215], v[76:79]
    ds_read_b64_tr_b16 v[34:35], v3 offset:33792
    s_waitcnt lgkmcnt(10)
    v_mfma_f32_16x16x32_bf16 v[80:83], v[40:43], v[208:211], v[80:83]
    ds_read_b64_tr_b16 v[36:37], v4 offset:32768
    v_mfma_f32_16x16x32_bf16 v[84:87], v[40:43], v[212:215], v[84:87]
    ds_read_b64_tr_b16 v[38:39], v4 offset:33792
    v_mfma_f32_16x16x32_bf16 v[88:91], v[44:47], v[208:211], v[88:91]
    ds_read_b64_tr_b16 v[40:41], v5 offset:32768
    v_mfma_f32_16x16x32_bf16 v[92:95], v[44:47], v[212:215], v[92:95]
    ds_read_b64_tr_b16 v[42:43], v5 offset:33792
    s_waitcnt lgkmcnt(10)
    v_mfma_f32_16x16x32_bf16 v[96:99], v[208:211], v[48:51], v[96:99]
    ds_read_b64_tr_b16 v[44:45], v6 offset:32768
    v_mfma_f32_16x16x32_bf16 v[100:103], v[212:215], v[48:51], v[100:103]
    ds_read_b64_tr_b16 v[46:47], v6 offset:33792
    v_mfma_f32_16x16x32_bf16 v[104:107], v[208:211], v[52:55], v[104:107]
    ds_read_b64_tr_b16 v[48:49], v3 offset:36864
    v_mfma_f32_16x16x32_bf16 v[108:111], v[212:215], v[52:55], v[108:111]
    ds_read_b64_tr_b16 v[50:51], v3 offset:37888
    s_waitcnt lgkmcnt(10)
    v_mfma_f32_16x16x32_bf16 v[112:115], v[208:211], v[56:59], v[112:115]
    ds_read_b64_tr_b16 v[52:53], v4 offset:36864
    v_mfma_f32_16x16x32_bf16 v[116:119], v[212:215], v[56:59], v[116:119]
    ds_read_b64_tr_b16 v[54:55], v4 offset:37888
    v_mfma_f32_16x16x32_bf16 v[120:123], v[208:211], v[60:63], v[120:123]
    ds_read_b64_tr_b16 v[56:57], v5 offset:36864
    v_mfma_f32_16x16x32_bf16 v[124:127], v[212:215], v[60:63], v[124:127]
    ds_read_b64_tr_b16 v[58:59], v5 offset:37888
    s_waitcnt lgkmcnt(10)
    v_mfma_f32_16x16x32_bf16 v[128:131], v[32:35], v[208:211], v[128:131]
    ds_read_b64_tr_b16 v[60:61], v6 offset:36864
    v_mfma_f32_16x16x32_bf16 v[132:135], v[32:35], v[212:215], v[132:135]
    ds_read_b64_tr_b16 v[62:63], v6 offset:37888
    v_mfma_f32_16x16x32_bf16 v[136:139], v[36:39], v[208:211], v[136:139]
    ds_read_b64_tr_b16 v[32:33], v3 offset:40960
    v_mfma_f32_16x16x32_bf16 v[140:143], v[36:39], v[212:215], v[140:143]
    ds_read_b64_tr_b16 v[34:35], v3 offset:41984
    s_waitcnt lgkmcnt(10)
    v_mfma_f32_16x16x32_bf16 v[144:147], v[40:43], v[208:211], v[144:147]
    ds_read_b64_tr_b16 v[36:37], v4 offset:40960
    v_mfma_f32_16x16x32_bf16 v[148:151], v[40:43], v[212:215], v[148:151]
    ds_read_b64_tr_b16 v[38:39], v4 offset:41984
    v_mfma_f32_16x16x32_bf16 v[152:155], v[44:47], v[208:211], v[152:155]
    ds_read_b64_tr_b16 v[40:41], v5 offset:40960
    v_mfma_f32_16x16x32_bf16 v[156:159], v[44:47], v[212:215], v[156:159]
    ds_read_b64_tr_b16 v[42:43], v5 offset:41984
    s_waitcnt vmcnt(18) lgkmcnt(10)
    v_mfma_f32_16x16x32_bf16 v[64:67], v[48:51], v[216:219], v[64:67]
    ds_read_b64_tr_b16 v[44:45], v6 offset:40960
    v_mfma_f32_16x16x32_bf16 v[68:71], v[48:51], v[220:223], v[68:71]
    ds_read_b64_tr_b16 v[46:47], v6 offset:41984
    v_mfma_f32_16x16x32_bf16 v[72:75], v[52:55], v[216:219], v[72:75]
    ds_read_b64_tr_b16 v[48:49], v3 offset:45056
    v_mfma_f32_16x16x32_bf16 v[76:79], v[52:55], v[220:223], v[76:79]
    ds_read_b64_tr_b16 v[50:51], v3 offset:46080
    s_waitcnt lgkmcnt(10)
    v_mfma_f32_16x16x32_bf16 v[80:83], v[56:59], v[216:219], v[80:83]
    ds_read_b64_tr_b16 v[52:53], v4 offset:45056
    v_mfma_f32_16x16x32_bf16 v[84:87], v[56:59], v[220:223], v[84:87]
    ds_read_b64_tr_b16 v[54:55], v4 offset:46080
    v_mfma_f32_16x16x32_bf16 v[88:91], v[60:63], v[216:219], v[88:91]
    ds_read_b64_tr_b16 v[56:57], v5 offset:45056
    v_mfma_f32_16x16x32_bf16 v[92:95], v[60:63], v[220:223], v[92:95]
    ds_read_b64_tr_b16 v[58:59], v5 offset:46080
    s_waitcnt lgkmcnt(10)
    v_mfma_f32_16x16x32_bf16 v[96:99], v[216:219], v[32:35], v[96:99]
    ds_read_b64_tr_b16 v[60:61], v6 offset:45056
    v_mfma_f32_16x16x32_bf16 v[100:103], v[220:223], v[32:35], v[100:103]
    ds_read_b64_tr_b16 v[62:63], v6 offset:46080
    v_mfma_f32_16x16x32_bf16 v[104:107], v[216:219], v[36:39], v[104:107]
    ds_read_b64_tr_b16 v[32:33], v3 offset:49152
    v_mfma_f32_16x16x32_bf16 v[108:111], v[220:223], v[36:39], v[108:111]
    ds_read_b64_tr_b16 v[34:35], v3 offset:50176
    s_waitcnt lgkmcnt(10)
    v_mfma_f32_16x16x32_bf16 v[112:115], v[216:219], v[40:43], v[112:115]
    ds_read_b64_tr_b16 v[36:37], v4 offset:49152
    v_mfma_f32_16x16x32_bf16 v[116:119], v[220:223], v[40:43], v[116:119]
    ds_read_b64_tr_b16 v[38:39], v4 offset:50176
    v_mfma_f32_16x16x32_bf16 v[120:123], v[216:219], v[44:47], v[120:123]
    ds_read_b64_tr_b16 v[40:41], v5 offset:49152
    v_mfma_f32_16x16x32_bf16 v[124:127], v[220:223], v[44:47], v[124:127]
    ds_read_b64_tr_b16 v[42:43], v5 offset:50176
    s_waitcnt lgkmcnt(10)
    v_mfma_f32_16x16x32_bf16 v[128:131], v[48:51], v[216:219], v[128:131]
    ds_read_b64_tr_b16 v[44:45], v6 offset:49152
    buffer_load_dwordx4 v[200:203], v2, s[4:7], s42 offen offset:2048 sc1
    v_mfma_f32_16x16x32_bf16 v[132:135], v[48:51], v[220:223], v[132:135]
    ds_read_b64_tr_b16 v[46:47], v6 offset:50176
    v_mfma_f32_16x16x32_bf16 v[136:139], v[52:55], v[216:219], v[136:139]
    ds_read_b64_tr_b16 v[48:49], v3 offset:53248
    buffer_load_dwordx4 v[204:207], v2, s[4:7], s42 offen offset:2304 sc1
    v_mfma_f32_16x16x32_bf16 v[140:143], v[52:55], v[220:223], v[140:143]
    ds_read_b64_tr_b16 v[50:51], v3 offset:54272
    s_waitcnt lgkmcnt(10)
    v_mfma_f32_16x16x32_bf16 v[144:147], v[56:59], v[216:219], v[144:147]
    ds_read_b64_tr_b16 v[52:53], v4 offset:53248
    s_add_u32 s42, s41, s99
    buffer_load_dwordx4 v[208:211], v2, s[4:7], s42 offen offset:0 sc1
    v_mfma_f32_16x16x32_bf16 v[148:151], v[56:59], v[220:223], v[148:151]
    ds_read_b64_tr_b16 v[54:55], v4 offset:54272
    v_mfma_f32_16x16x32_bf16 v[152:155], v[60:63], v[216:219], v[152:155]
    ds_read_b64_tr_b16 v[56:57], v5 offset:53248
    buffer_load_dwordx4 v[212:215], v2, s[4:7], s42 offen offset:256 sc1
    v_mfma_f32_16x16x32_bf16 v[156:159], v[60:63], v[220:223], v[156:159]
    ds_read_b64_tr_b16 v[58:59], v5 offset:54272
    s_waitcnt vmcnt(20) lgkmcnt(10)
    v_mfma_f32_16x16x32_bf16 v[64:67], v[32:35], v[224:227], v[64:67]
    ds_read_b64_tr_b16 v[60:61], v6 offset:53248
    buffer_load_dwordx4 v[216:219], v2, s[4:7], s42 offen offset:2048 sc1
    v_mfma_f32_16x16x32_bf16 v[68:71], v[32:35], v[228:231], v[68:71]
    ds_read_b64_tr_b16 v[62:63], v6 offset:54272
    v_mfma_f32_16x16x32_bf16 v[72:75], v[36:39], v[224:227], v[72:75]
    ds_read_b64_tr_b16 v[32:33], v3 offset:57344
    buffer_load_dwordx4 v[220:223], v2, s[4:7], s42 offen offset:2304 sc1
    v_mfma_f32_16x16x32_bf16 v[76:79], v[36:39], v[228:231], v[76:79]
    ds_read_b64_tr_b16 v[34:35], v3 offset:58368
    s_waitcnt lgkmcnt(10)
    v_mfma_f32_16x16x32_bf16 v[80:83], v[40:43], v[224:227], v[80:83]
    ds_read_b64_tr_b16 v[36:37], v4 offset:57344
    v_mfma_f32_16x16x32_bf16 v[84:87], v[40:43], v[228:231], v[84:87]
    ds_read_b64_tr_b16 v[38:39], v4 offset:58368
    v_mfma_f32_16x16x32_bf16 v[88:91], v[44:47], v[224:227], v[88:91]
    ds_read_b64_tr_b16 v[40:41], v5 offset:57344
    v_mfma_f32_16x16x32_bf16 v[92:95], v[44:47], v[228:231], v[92:95]
    ds_read_b64_tr_b16 v[42:43], v5 offset:58368
    s_waitcnt lgkmcnt(10)
    v_mfma_f32_16x16x32_bf16 v[96:99], v[224:227], v[48:51], v[96:99]
    ds_read_b64_tr_b16 v[44:45], v6 offset:57344
    v_mfma_f32_16x16x32_bf16 v[100:103], v[228:231], v[48:51], v[100:103]
    ds_read_b64_tr_b16 v[46:47], v6 offset:58368
    v_mfma_f32_16x16x32_bf16 v[104:107], v[224:227], v[52:55], v[104:107]
    ds_read_b64_tr_b16 v[48:49], v3 offset:61440
    v_mfma_f32_16x16x32_bf16 v[108:111], v[228:231], v[52:55], v[108:111]
    ds_read_b64_tr_b16 v[50:51], v3 offset:62464
    s_waitcnt lgkmcnt(10)
    v_mfma_f32_16x16x32_bf16 v[112:115], v[224:227], v[56:59], v[112:115]
    ds_read_b64_tr_b16 v[52:53], v4 offset:61440
    v_mfma_f32_16x16x32_bf16 v[116:119], v[228:231], v[56:59], v[116:119]
    ds_read_b64_tr_b16 v[54:55], v4 offset:62464
    v_mfma_f32_16x16x32_bf16 v[120:123], v[224:227], v[60:63], v[120:123]
    ds_read_b64_tr_b16 v[56:57], v5 offset:61440
    v_mfma_f32_16x16x32_bf16 v[124:127], v[228:231], v[60:63], v[124:127]
    ds_read_b64_tr_b16 v[58:59], v5 offset:62464
    s_waitcnt vmcnt(20) lgkmcnt(10)
    v_mfma_f32_16x16x32_bf16 v[64:67], v[32:35], v[232:235], v[64:67]
    ds_read_b64_tr_b16 v[60:61], v6 offset:61440
    v_mfma_f32_16x16x32_bf16 v[68:71], v[32:35], v[236:239], v[68:71]
    ds_read_b64_tr_b16 v[62:63], v6 offset:62464
    s_barrier
    v_xor_b32 v3, 0x10000, v3
    v_xor_b32 v4, 0x10000, v4
    v_xor_b32 v5, 0x10000, v5
    v_xor_b32 v6, 0x10000, v6
    v_mfma_f32_16x16x32_bf16 v[72:75], v[36:39], v[232:235], v[72:75]
    ds_read_b64_tr_b16 v[32:33], v3 offset:0
    v_mfma_f32_16x16x32_bf16 v[76:79], v[36:39], v[236:239], v[76:79]
    ds_read_b64_tr_b16 v[34:35], v3 offset:1024
    s_waitcnt lgkmcnt(10)
    v_mfma_f32_16x16x32_bf16 v[80:83], v[40:43], v[232:235], v[80:83]
    ds_read_b64_tr_b16 v[36:37], v4 offset:0
    v_mfma_f32_16x16x32_bf16 v[84:87], v[40:43], v[236:239], v[84:87]
    ds_read_b64_tr_b16 v[38:39], v4 offset:1024
    v_mfma_f32_16x16x32_bf16 v[88:91], v[44:47], v[232:235], v[88:91]
    ds_read_b64_tr_b16 v[40:41], v5 offset:0
    v_mfma_f32_16x16x32_bf16 v[92:95], v[44:47], v[236:239], v[92:95]
    ds_read_b64_tr_b16 v[42:43], v5 offset:1024
    s_waitcnt lgkmcnt(10)
    v_mfma_f32_16x16x32_bf16 v[96:99], v[232:235], v[48:51], v[96:99]
    ds_read_b64_tr_b16 v[44:45], v6 offset:0
    v_mfma_f32_16x16x32_bf16 v[100:103], v[236:239], v[48:51], v[100:103]
    ds_read_b64_tr_b16 v[46:47], v6 offset:1024
    v_mfma_f32_16x16x32_bf16 v[104:107], v[232:235], v[52:55], v[104:107]
    ds_read_b64_tr_b16 v[48:49], v3 offset:4096
    v_mfma_f32_16x16x32_bf16 v[108:111], v[236:239], v[52:55], v[108:111]
    ds_read_b64_tr_b16 v[50:51], v3 offset:5120
    s_waitcnt lgkmcnt(10)
    v_mfma_f32_16x16x32_bf16 v[112:115], v[232:235], v[56:59], v[112:115]
    ds_read_b64_tr_b16 v[52:53], v4 offset:4096
    v_mfma_f32_16x16x32_bf16 v[116:119], v[236:239], v[56:59], v[116:119]
    ds_read_b64_tr_b16 v[54:55], v4 offset:5120
    v_mfma_f32_16x16x32_bf16 v[120:123], v[232:235], v[60:63], v[120:123]
    ds_read_b64_tr_b16 v[56:57], v5 offset:4096
    v_mfma_f32_16x16x32_bf16 v[124:127], v[236:239], v[60:63], v[124:127]
    ds_read_b64_tr_b16 v[58:59], v5 offset:5120
    s_waitcnt vmcnt(18) lgkmcnt(10)
    v_mfma_f32_16x16x32_bf16 v[64:67], v[32:35], v[240:243], v[64:67]
    ds_read_b64_tr_b16 v[60:61], v6 offset:4096
    v_mfma_f32_16x16x32_bf16 v[68:71], v[32:35], v[244:247], v[68:71]
    ds_read_b64_tr_b16 v[62:63], v6 offset:5120
    v_mfma_f32_16x16x32_bf16 v[72:75], v[36:39], v[240:243], v[72:75]
    ds_read_b64_tr_b16 v[32:33], v3 offset:8192
    v_mfma_f32_16x16x32_bf16 v[76:79], v[36:39], v[244:247], v[76:79]
    ds_read_b64_tr_b16 v[34:35], v3 offset:9216
    s_waitcnt lgkmcnt(10)
    v_mfma_f32_16x16x32_bf16 v[80:83], v[40:43], v[240:243], v[80:83]
    ds_read_b64_tr_b16 v[36:37], v4 offset:8192
    v_mfma_f32_16x16x32_bf16 v[84:87], v[40:43], v[244:247], v[84:87]
    ds_read_b64_tr_b16 v[38:39], v4 offset:9216
    v_mfma_f32_16x16x32_bf16 v[88:91], v[44:47], v[240:243], v[88:91]
    ds_read_b64_tr_b16 v[40:41], v5 offset:8192
    v_mfma_f32_16x16x32_bf16 v[92:95], v[44:47], v[244:247], v[92:95]
    ds_read_b64_tr_b16 v[42:43], v5 offset:9216
    s_waitcnt lgkmcnt(10)
    v_mfma_f32_16x16x32_bf16 v[96:99], v[240:243], v[48:51], v[96:99]
    ds_read_b64_tr_b16 v[44:45], v6 offset:8192
    v_mfma_f32_16x16x32_bf16 v[100:103], v[244:247], v[48:51], v[100:103]
    ds_read_b64_tr_b16 v[46:47], v6 offset:9216
    v_mfma_f32_16x16x32_bf16 v[104:107], v[240:243], v[52:55], v[104:107]
    ds_read_b64_tr_b16 v[48:49], v3 offset:12288
    v_mfma_f32_16x16x32_bf16 v[108:111], v[244:247], v[52:55], v[108:111]
    ds_read_b64_tr_b16 v[50:51], v3 offset:13312
    s_waitcnt lgkmcnt(10)
    v_mfma_f32_16x16x32_bf16 v[112:115], v[240:243], v[56:59], v[112:115]
    ds_read_b64_tr_b16 v[52:53], v4 offset:12288
    v_mfma_f32_16x16x32_bf16 v[116:119], v[244:247], v[56:59], v[116:119]
    ds_read_b64_tr_b16 v[54:55], v4 offset:13312
    v_mfma_f32_16x16x32_bf16 v[120:123], v[240:243], v[60:63], v[120:123]
    ds_read_b64_tr_b16 v[56:57], v5 offset:12288
    v_mfma_f32_16x16x32_bf16 v[124:127], v[244:247], v[60:63], v[124:127]
    ds_read_b64_tr_b16 v[58:59], v5 offset:13312
    s_waitcnt vmcnt(16) lgkmcnt(10)
    v_mfma_f32_16x16x32_bf16 v[64:67], v[32:35], v[248:251], v[64:67]
    ds_read_b64_tr_b16 v[60:61], v6 offset:12288
    v_mfma_f32_16x16x32_bf16 v[68:71], v[32:35], v[252:255], v[68:71]
    ds_read_b64_tr_b16 v[62:63], v6 offset:13312
    v_mfma_f32_16x16x32_bf16 v[72:75], v[36:39], v[248:251], v[72:75]
    ds_read_b64_tr_b16 v[32:33], v3 offset:16384
    v_mfma_f32_16x16x32_bf16 v[76:79], v[36:39], v[252:255], v[76:79]
    ds_read_b64_tr_b16 v[34:35], v3 offset:17408
    s_waitcnt lgkmcnt(10)
    v_mfma_f32_16x16x32_bf16 v[80:83], v[40:43], v[248:251], v[80:83]
    ds_read_b64_tr_b16 v[36:37], v4 offset:16384
    v_mfma_f32_16x16x32_bf16 v[84:87], v[40:43], v[252:255], v[84:87]
    ds_read_b64_tr_b16 v[38:39], v4 offset:17408
    v_mfma_f32_16x16x32_bf16 v[88:91], v[44:47], v[248:251], v[88:91]
    ds_read_b64_tr_b16 v[40:41], v5 offset:16384
    v_mfma_f32_16x16x32_bf16 v[92:95], v[44:47], v[252:255], v[92:95]
    ds_read_b64_tr_b16 v[42:43], v5 offset:17408
    s_waitcnt lgkmcnt(10)
    v_mfma_f32_16x16x32_bf16 v[96:99], v[248:251], v[48:51], v[96:99]
    ds_read_b64_tr_b16 v[44:45], v6 offset:16384
    v_mfma_f32_16x16x32_bf16 v[100:103], v[252:255], v[48:51], v[100:103]
    ds_read_b64_tr_b16 v[46:47], v6 offset:17408
    v_mfma_f32_16x16x32_bf16 v[104:107], v[248:251], v[52:55], v[104:107]
    ds_read_b64_tr_b16 v[48:49], v3 offset:20480
    v_mfma_f32_16x16x32_bf16 v[108:111], v[252:255], v[52:55], v[108:111]
    ds_read_b64_tr_b16 v[50:51], v3 offset:21504
    s_waitcnt lgkmcnt(10)
    v_mfma_f32_16x16x32_bf16 v[112:115], v[248:251], v[56:59], v[112:115]
    ds_read_b64_tr_b16 v[52:53], v4 offset:20480
    v_mfma_f32_16x16x32_bf16 v[116:119], v[252:255], v[56:59], v[116:119]
    ds_read_b64_tr_b16 v[54:55], v4 offset:21504
    v_mfma_f32_16x16x32_bf16 v[120:123], v[248:251], v[60:63], v[120:123]
    ds_read_b64_tr_b16 v[56:57], v5 offset:20480
    v_mfma_f32_16x16x32_bf16 v[124:127], v[252:255], v[60:63], v[124:127]
    ds_read_b64_tr_b16 v[58:59], v5 offset:21504
    s_waitcnt vmcnt(14) lgkmcnt(10)
    v_mfma_f32_16x16x32_bf16 v[64:67], v[32:35], v[160:163], v[64:67]
    ds_read_b64_tr_b16 v[60:61], v6 offset:20480
    v_mfma_f32_16x16x32_bf16 v[68:71], v[32:35], v[164:167], v[68:71]
    ds_read_b64_tr_b16 v[62:63], v6 offset:21504
    v_mfma_f32_16x16x32_bf16 v[72:75], v[36:39], v[160:163], v[72:75]
    ds_read_b64_tr_b16 v[32:33], v3 offset:24576
    v_mfma_f32_16x16x32_bf16 v[76:79], v[36:39], v[164:167], v[76:79]
    ds_read_b64_tr_b16 v[34:35], v3 offset:25600
    s_waitcnt lgkmcnt(10)
    v_mfma_f32_16x16x32_bf16 v[80:83], v[40:43], v[160:163], v[80:83]
    ds_read_b64_tr_b16 v[36:37], v4 offset:24576
    v_mfma_f32_16x16x32_bf16 v[84:87], v[40:43], v[164:167], v[84:87]
    ds_read_b64_tr_b16 v[38:39], v4 offset:25600
    v_mfma_f32_16x16x32_bf16 v[88:91], v[44:47], v[160:163], v[88:91]
    ds_read_b64_tr_b16 v[40:41], v5 offset:24576
    v_mfma_f32_16x16x32_bf16 v[92:95], v[44:47], v[164:167], v[92:95]
    ds_read_b64_tr_b16 v[42:43], v5 offset:25600
    s_waitcnt vmcnt(12) lgkmcnt(10)
    v_mfma_f32_16x16x32_bf16 v[64:67], v[48:51], v[168:171], v[64:67]
    ds_read_b64_tr_b16 v[44:45], v6 offset:24576
    v_mfma_f32_16x16x32_bf16 v[68:71], v[48:51], v[172:175], v[68:71]
    ds_read_b64_tr_b16 v[46:47], v6 offset:25600
    v_mfma_f32_16x16x32_bf16 v[72:75], v[52:55], v[168:171], v[72:75]
    ds_read_b64_tr_b16 v[48:49], v3 offset:28672
    v_mfma_f32_16x16x32_bf16 v[76:79], v[52:55], v[172:175], v[76:79]
    ds_read_b64_tr_b16 v[50:51], v3 offset:29696
    s_waitcnt lgkmcnt(10)
    v_mfma_f32_16x16x32_bf16 v[80:83], v[56:59], v[168:171], v[80:83]
    ds_read_b64_tr_b16 v[52:53], v4 offset:28672
    v_mfma_f32_16x16x32_bf16 v[84:87], v[56:59], v[172:175], v[84:87]
    ds_read_b64_tr_b16 v[54:55], v4 offset:29696
    v_mfma_f32_16x16x32_bf16 v[88:91], v[60:63], v[168:171], v[88:91]
    ds_read_b64_tr_b16 v[56:57], v5 offset:28672
    v_mfma_f32_16x16x32_bf16 v[92:95], v[60:63], v[172:175], v[92:95]
    ds_read_b64_tr_b16 v[58:59], v5 offset:29696
    s_waitcnt vmcnt(10) lgkmcnt(10)
    v_mfma_f32_16x16x32_bf16 v[64:67], v[32:35], v[176:179], v[64:67]
    ds_read_b64_tr_b16 v[60:61], v6 offset:28672
    v_mfma_f32_16x16x32_bf16 v[68:71], v[32:35], v[180:183], v[68:71]
    ds_read_b64_tr_b16 v[62:63], v6 offset:29696
    s_barrier
    v_mfma_f32_16x16x32_bf16 v[72:75], v[36:39], v[176:179], v[72:75]
    ds_read_b64_tr_b16 v[32:33], v3 offset:32768
    v_mfma_f32_16x16x32_bf16 v[76:79], v[36:39], v[180:183], v[76:79]
    ds_read_b64_tr_b16 v[34:35], v3 offset:33792
    s_waitcnt lgkmcnt(10)
    v_mfma_f32_16x16x32_bf16 v[80:83], v[40:43], v[176:179], v[80:83]
    ds_read_b64_tr_b16 v[36:37], v4 offset:32768
    v_mfma_f32_16x16x32_bf16 v[84:87], v[40:43], v[180:183], v[84:87]
    ds_read_b64_tr_b16 v[38:39], v4 offset:33792
    v_mfma_f32_16x16x32_bf16 v[88:91], v[44:47], v[176:179], v[88:91]
    ds_read_b64_tr_b16 v[40:41], v5 offset:32768
    v_mfma_f32_16x16x32_bf16 v[92:95], v[44:47], v[180:183], v[92:95]
    ds_read_b64_tr_b16 v[42:43], v5 offset:33792
    s_waitcnt vmcnt(8) lgkmcnt(10)
    v_mfma_f32_16x16x32_bf16 v[64:67], v[48:51], v[184:187], v[64:67]
    ds_read_b64_tr_b16 v[44:45], v6 offset:32768
    v_mfma_f32_16x16x32_bf16 v[68:71], v[48:51], v[188:191], v[68:71]
    ds_read_b64_tr_b16 v[46:47], v6 offset:33792
    v_mfma_f32_16x16x32_bf16 v[72:75], v[52:55], v[184:187], v[72:75]
    ds_read_b64_tr_b16 v[48:49], v3 offset:36864
    v_mfma_f32_16x16x32_bf16 v[76:79], v[52:55], v[188:191], v[76:79]
    ds_read_b64_tr_b16 v[50:51], v3 offset:37888
    s_waitcnt lgkmcnt(10)
    v_mfma_f32_16x16x32_bf16 v[80:83], v[56:59], v[184:187], v[80:83]
    ds_read_b64_tr_b16 v[52:53], v4 offset:36864
    v_mfma_f32_16x16x32_bf16 v[84:87], v[56:59], v[188:191], v[84:87]
    ds_read_b64_tr_b16 v[54:55], v4 offset:37888
    v_mfma_f32_16x16x32_bf16 v[88:91], v[60:63], v[184:187], v[88:91]
    ds_read_b64_tr_b16 v[56:57], v5 offset:36864
    v_mfma_f32_16x16x32_bf16 v[92:95], v[60:63], v[188:191], v[92:95]
    ds_read_b64_tr_b16 v[58:59], v5 offset:37888
    s_waitcnt vmcnt(6) lgkmcnt(10)
    v_mfma_f32_16x16x32_bf16 v[64:67], v[32:35], v[192:195], v[64:67]
    ds_read_b64_tr_b16 v[60:61], v6 offset:36864
    v_mfma_f32_16x16x32_bf16 v[68:71], v[32:35], v[196:199], v[68:71]
    ds_read_b64_tr_b16 v[62:63], v6 offset:37888
    v_mfma_f32_16x16x32_bf16 v[72:75], v[36:39], v[192:195], v[72:75]
    ds_read_b64_tr_b16 v[32:33], v3 offset:40960
    v_mfma_f32_16x16x32_bf16 v[76:79], v[36:39], v[196:199], v[76:79]
    ds_read_b64_tr_b16 v[34:35], v3 offset:41984
    s_waitcnt lgkmcnt(10)
    v_mfma_f32_16x16x32_bf16 v[80:83], v[40:43], v[192:195], v[80:83]
    ds_read_b64_tr_b16 v[36:37], v4 offset:40960
    v_mfma_f32_16x16x32_bf16 v[84:87], v[40:43], v[196:199], v[84:87]
    ds_read_b64_tr_b16 v[38:39], v4 offset:41984
    v_mfma_f32_16x16x32_bf16 v[88:91], v[44:47], v[192:195], v[88:91]
    ds_read_b64_tr_b16 v[40:41], v5 offset:40960
    v_mfma_f32_16x16x32_bf16 v[92:95], v[44:47], v[196:199], v[92:95]
    ds_read_b64_tr_b16 v[42:43], v5 offset:41984
    s_waitcnt vmcnt(4) lgkmcnt(10)
    v_mfma_f32_16x16x32_bf16 v[64:67], v[48:51], v[200:203], v[64:67]
    ds_read_b64_tr_b16 v[44:45], v6 offset:40960
    v_mfma_f32_16x16x32_bf16 v[68:71], v[48:51], v[204:207], v[68:71]
    ds_read_b64_tr_b16 v[46:47], v6 offset:41984
    v_mfma_f32_16x16x32_bf16 v[72:75], v[52:55], v[200:203], v[72:75]
    ds_read_b64_tr_b16 v[48:49], v3 offset:45056
    v_mfma_f32_16x16x32_bf16 v[76:79], v[52:55], v[204:207], v[76:79]
    ds_read_b64_tr_b16 v[50:51], v3 offset:46080
    s_waitcnt lgkmcnt(10)
    v_mfma_f32_16x16x32_bf16 v[80:83], v[56:59], v[200:203], v[80:83]
    ds_read_b64_tr_b16 v[52:53], v4 offset:45056
    v_mfma_f32_16x16x32_bf16 v[84:87], v[56:59], v[204:207], v[84:87]
    ds_read_b64_tr_b16 v[54:55], v4 offset:46080
    v_mfma_f32_16x16x32_bf16 v[88:91], v[60:63], v[200:203], v[88:91]
    ds_read_b64_tr_b16 v[56:57], v5 offset:45056
    v_mfma_f32_16x16x32_bf16 v[92:95], v[60:63], v[204:207], v[92:95]
    ds_read_b64_tr_b16 v[58:59], v5 offset:46080
    s_waitcnt vmcnt(2) lgkmcnt(10)
    v_mfma_f32_16x16x32_bf16 v[64:67], v[32:35], v[208:211], v[64:67]
    ds_read_b64_tr_b16 v[60:61], v6 offset:45056
    v_mfma_f32_16x16x32_bf16 v[68:71], v[32:35], v[212:215], v[68:71]
    ds_read_b64_tr_b16 v[62:63], v6 offset:46080
    v_mfma_f32_16x16x32_bf16 v[72:75], v[36:39], v[208:211], v[72:75]
    ds_read_b64_tr_b16 v[32:33], v3 offset:49152
    ds_read_b32 v8, v9 offset:4096
    v_mfma_f32_16x16x32_bf16 v[76:79], v[36:39], v[212:215], v[76:79]
    ds_read_b64_tr_b16 v[34:35], v3 offset:50176
    ds_read_b32 v10, v9 offset:4608
    s_waitcnt lgkmcnt(12)
    v_mfma_f32_16x16x32_bf16 v[80:83], v[40:43], v[208:211], v[80:83]
    ds_read_b64_tr_b16 v[36:37], v4 offset:49152
    ds_read_b32 v12, v9 offset:4160
    v_mfma_f32_16x16x32_bf16 v[84:87], v[40:43], v[212:215], v[84:87]
    ds_read_b64_tr_b16 v[38:39], v4 offset:50176
    ds_read_b32 v14, v9 offset:4672
    v_mfma_f32_16x16x32_bf16 v[88:91], v[44:47], v[208:211], v[88:91]
    ds_read_b64_tr_b16 v[40:41], v5 offset:49152
    ds_read_b128 v[16:19], v11 offset:256
    v_mfma_f32_16x16x32_bf16 v[92:95], v[44:47], v[212:215], v[92:95]
    ds_read_b64_tr_b16 v[42:43], v5 offset:50176
    ds_read_b128 v[20:23], v11 offset:320
    s_waitcnt vmcnt(0) lgkmcnt(14)
    v_mfma_f32_16x16x32_bf16 v[64:67], v[48:51], v[216:219], v[64:67]
    ds_read_b64_tr_b16 v[44:45], v6 offset:49152
    ds_read_b128 v[24:27], v11 offset:384
    v_mfma_f32_16x16x32_bf16 v[68:71], v[48:51], v[220:223], v[68:71]
    ds_read_b64_tr_b16 v[46:47], v6 offset:50176
    ds_read_b128 v[28:31], v11 offset:448
    v_mfma_f32_16x16x32_bf16 v[72:75], v[52:55], v[216:219], v[72:75]
    ds_read_b64_tr_b16 v[48:49], v3 offset:53248
    v_mfma_f32_16x16x32_bf16 v[76:79], v[52:55], v[220:223], v[76:79]
    ds_read_b64_tr_b16 v[50:51], v3 offset:54272
    s_waitcnt lgkmcnt(14)
    v_mfma_f32_16x16x32_bf16 v[80:83], v[56:59], v[216:219], v[80:83]
    ds_read_b64_tr_b16 v[52:53], v4 offset:53248
    v_mfma_f32_16x16x32_bf16 v[84:87], v[56:59], v[220:223], v[84:87]
    ds_read_b64_tr_b16 v[54:55], v4 offset:54272
    v_mfma_f32_16x16x32_bf16 v[88:91], v[60:63], v[216:219], v[88:91]
    ds_read_b64_tr_b16 v[56:57], v5 offset:53248
    v_mfma_f32_16x16x32_bf16 v[92:95], v[60:63], v[220:223], v[92:95]
    ds_read_b64_tr_b16 v[58:59], v5 offset:54272
    s_bitcmp1_b32 s21, 0
    s_cbranch_scc1 c_B
    v_add_u32 v7, s62, v1
    s_waitcnt lgkmcnt(6)
    v_pk_fma_f32 v[68:69], v[12:13], v[16:17], v[68:69] op_sel_hi:[0,1,1] neg_lo:[1,0,0] neg_hi:[1,0,0]
    v_pk_fma_f32 v[70:71], v[12:13], v[18:19], v[70:71] op_sel_hi:[0,1,1] neg_lo:[1,0,0] neg_hi:[1,0,0]
    v_pk_fma_f32 v[76:77], v[12:13], v[20:21], v[76:77] op_sel_hi:[0,1,1] neg_lo:[1,0,0] neg_hi:[1,0,0]
    v_pk_fma_f32 v[78:79], v[12:13], v[22:23], v[78:79] op_sel_hi:[0,1,1] neg_lo:[1,0,0] neg_hi:[1,0,0]
    v_pk_mul_f32 v[68:69], v[14:15], v[68:69] op_sel_hi:[0,1]
    v_pk_mul_f32 v[70:71], v[14:15], v[70:71] op_sel_hi:[0,1]
    v_pk_mul_f32 v[76:77], v[14:15], v[76:77] op_sel_hi:[0,1]
    v_pk_mul_f32 v[78:79], v[14:15], v[78:79] op_sel_hi:[0,1]
    v_cvt_pk_bf16_f32 v68, v68, v69
    v_cvt_pk_bf16_f32 v69, v70, v71
    v_cvt_pk_bf16_f32 v70, v76, v77
    v_cvt_pk_bf16_f32 v71, v78, v79
    ds_write_b128 v7, v[68:71] offset:4096
    v_pk_fma_f32 v[64:65], v[8:9], v[16:17], v[64:65] op_sel_hi:[0,1,1] neg_lo:[1,0,0] neg_hi:[1,0,0]
    v_pk_fma_f32 v[66:67], v[8:9], v[18:19], v[66:67] op_sel_hi:[0,1,1] neg_lo:[1,0,0] neg_hi:[1,0,0]
    v_pk_fma_f32 v[72:73], v[8:9], v[20:21], v[72:73] op_sel_hi:[0,1,1] neg_lo:[1,0,0] neg_hi:[1,0,0]
    v_pk_fma_f32 v[74:75], v[8:9], v[22:23], v[74:75] op_sel_hi:[0,1,1] neg_lo:[1,0,0] neg_hi:[1,0,0]
    v_pk_mul_f32 v[64:65], v[10:11], v[64:65] op_sel_hi:[0,1]
    v_pk_mul_f32 v[66:67], v[10:11], v[66:67] op_sel_hi:[0,1]
    v_pk_mul_f32 v[72:73], v[10:11], v[72:73] op_sel_hi:[0,1]
    v_pk_mul_f32 v[74:75], v[10:11], v[74:75] op_sel_hi:[0,1]
    v_cvt_pk_bf16_f32 v64, v64, v65
    v_cvt_pk_bf16_f32 v65, v66, v67
    v_cvt_pk_bf16_f32 v66, v72, v73
    v_cvt_pk_bf16_f32 v67, v74, v75
    v_pk_fma_f32 v[84:85], v[12:13], v[24:25], v[84:85] op_sel_hi:[0,1,1] neg_lo:[1,0,0] neg_hi:[1,0,0]
    v_pk_fma_f32 v[86:87], v[12:13], v[26:27], v[86:87] op_sel_hi:[0,1,1] neg_lo:[1,0,0] neg_hi:[1,0,0]
    v_pk_fma_f32 v[92:93], v[12:13], v[28:29], v[92:93] op_sel_hi:[0,1,1] neg_lo:[1,0,0] neg_hi:[1,0,0]
    v_pk_fma_f32 v[94:95], v[12:13], v[30:31], v[94:95] op_sel_hi:[0,1,1] neg_lo:[1,0,0] neg_hi:[1,0,0]
    v_pk_mul_f32 v[84:85], v[14:15], v[84:85] op_sel_hi:[0,1]
    v_pk_mul_f32 v[86:87], v[14:15], v[86:87] op_sel_hi:[0,1]
    v_pk_mul_f32 v[92:93], v[14:15], v[92:93] op_sel_hi:[0,1]
    v_pk_mul_f32 v[94:95], v[14:15], v[94:95] op_sel_hi:[0,1]
    v_cvt_pk_bf16_f32 v84, v84, v85
    v_cvt_pk_bf16_f32 v85, v86, v87
    v_cvt_pk_bf16_f32 v86, v92, v93
    v_cvt_pk_bf16_f32 v87, v94, v95
    ds_write_b128 v7, v[84:87] offset:5120
    v_pk_fma_f32 v[80:81], v[8:9], v[24:25], v[80:81] op_sel_hi:[0,1,1] neg_lo:[1,0,0] neg_hi:[1,0,0]
    v_pk_fma_f32 v[82:83], v[8:9], v[26:27], v[82:83] op_sel_hi:[0,1,1] neg_lo:[1,0,0] neg_hi:[1,0,0]
    v_pk_fma_f32 v[88:89], v[8:9], v[28:29], v[88:89] op_sel_hi:[0,1,1] neg_lo:[1,0,0] neg_hi:[1,0,0]
    v_pk_fma_f32 v[90:91], v[8:9], v[30:31], v[90:91] op_sel_hi:[0,1,1] neg_lo:[1,0,0] neg_hi:[1,0,0]
    v_pk_mul_f32 v[80:81], v[10:11], v[80:81] op_sel_hi:[0,1]
    v_pk_mul_f32 v[82:83], v[10:11], v[82:83] op_sel_hi:[0,1]
    v_pk_mul_f32 v[88:89], v[10:11], v[88:89] op_sel_hi:[0,1]
    v_pk_mul_f32 v[90:91], v[10:11], v[90:91] op_sel_hi:[0,1]
    v_cvt_pk_bf16_f32 v80, v80, v81
    v_cvt_pk_bf16_f32 v81, v82, v83
    v_cvt_pk_bf16_f32 v82, v88, v89
    v_cvt_pk_bf16_f32 v83, v90, v91
    v_mfma_f32_16x16x32_bf16 v[96:99], v[160:163], v[32:35], v[96:99]
    ds_read_b64_tr_b16 v[60:61], v6 offset:53248
    v_mfma_f32_16x16x32_bf16 v[100:103], v[164:167], v[32:35], v[100:103]
    ds_read_b64_tr_b16 v[62:63], v6 offset:54272
    v_mfma_f32_16x16x32_bf16 v[104:107], v[160:163], v[36:39], v[104:107]
    ds_read_b64_tr_b16 v[32:33], v3 offset:57344
    v_mfma_f32_16x16x32_bf16 v[108:111], v[164:167], v[36:39], v[108:111]
    ds_read_b64_tr_b16 v[34:35], v3 offset:58368
    v_mfma_f32_16x16x32_bf16 v[112:115], v[160:163], v[40:43], v[112:115]
    ds_read_b64_tr_b16 v[36:37], v4 offset:57344
    v_mfma_f32_16x16x32_bf16 v[116:119], v[164:167], v[40:43], v[116:119]
    ds_read_b64_tr_b16 v[38:39], v4 offset:58368
    v_mfma_f32_16x16x32_bf16 v[120:123], v[160:163], v[44:47], v[120:123]
    ds_read_b64_tr_b16 v[40:41], v5 offset:57344
    v_mfma_f32_16x16x32_bf16 v[124:127], v[164:167], v[44:47], v[124:127]
    ds_read_b64_tr_b16 v[42:43], v5 offset:58368
    s_waitcnt lgkmcnt(12)
    v_mfma_f32_16x16x32_bf16 v[96:99], v[168:171], v[48:51], v[96:99]
    ds_read_b64_tr_b16 v[44:45], v6 offset:57344
    v_mfma_f32_16x16x32_bf16 v[100:103], v[172:175], v[48:51], v[100:103]
    ds_read_b64_tr_b16 v[46:47], v6 offset:58368
    v_mfma_f32_16x16x32_bf16 v[104:107], v[168:171], v[52:55], v[104:107]
    ds_read_b64_tr_b16 v[48:49], v3 offset:61440
    v_mfma_f32_16x16x32_bf16 v[108:111], v[172:175], v[52:55], v[108:111]
    ds_read_b64_tr_b16 v[50:51], v3 offset:62464
    s_waitcnt lgkmcnt(10)
    v_mfma_f32_16x16x32_bf16 v[112:115], v[168:171], v[56:59], v[112:115]
    ds_read_b64_tr_b16 v[52:53], v4 offset:61440
    v_mfma_f32_16x16x32_bf16 v[116:119], v[172:175], v[56:59], v[116:119]
    ds_read_b64_tr_b16 v[54:55], v4 offset:62464
    v_mfma_f32_16x16x32_bf16 v[120:123], v[168:171], v[60:63], v[120:123]
    ds_read_b64_tr_b16 v[56:57], v5 offset:61440
    v_mfma_f32_16x16x32_bf16 v[124:127], v[172:175], v[60:63], v[124:127]
    ds_read_b64_tr_b16 v[58:59], v5 offset:62464
    s_waitcnt lgkmcnt(10)
    v_mfma_f32_16x16x32_bf16 v[96:99], v[176:179], v[32:35], v[96:99]
    ds_read_b64_tr_b16 v[60:61], v6 offset:61440
    v_mfma_f32_16x16x32_bf16 v[100:103], v[180:183], v[32:35], v[100:103]
    ds_read_b64_tr_b16 v[62:63], v6 offset:62464
    s_barrier
    v_xor_b32 v3, 0x10000, v3
    v_xor_b32 v4, 0x10000, v4
    v_xor_b32 v5, 0x10000, v5
    v_xor_b32 v6, 0x10000, v6
    v_mfma_f32_16x16x32_bf16 v[104:107], v[176:179], v[36:39], v[104:107]
    ds_read_b64_tr_b16 v[32:33], v3 offset:0
    v_mfma_f32_16x16x32_bf16 v[108:111], v[180:183], v[36:39], v[108:111]
    ds_read_b64_tr_b16 v[34:35], v3 offset:1024
    s_waitcnt lgkmcnt(10)
    v_mfma_f32_16x16x32_bf16 v[112:115], v[176:179], v[40:43], v[112:115]
    ds_read_b64_tr_b16 v[36:37], v4 offset:0
    v_mfma_f32_16x16x32_bf16 v[116:119], v[180:183], v[40:43], v[116:119]
    ds_read_b64_tr_b16 v[38:39], v4 offset:1024
    v_mfma_f32_16x16x32_bf16 v[120:123], v[176:179], v[44:47], v[120:123]
    ds_read_b64_tr_b16 v[40:41], v5 offset:0
    v_mfma_f32_16x16x32_bf16 v[124:127], v[180:183], v[44:47], v[124:127]
    ds_read_b64_tr_b16 v[42:43], v5 offset:1024
    s_waitcnt lgkmcnt(10)
    v_mfma_f32_16x16x32_bf16 v[96:99], v[184:187], v[48:51], v[96:99]
    ds_read_b64_tr_b16 v[44:45], v6 offset:0
    v_mfma_f32_16x16x32_bf16 v[100:103], v[188:191], v[48:51], v[100:103]
    ds_read_b64_tr_b16 v[46:47], v6 offset:1024
    v_mfma_f32_16x16x32_bf16 v[104:107], v[184:187], v[52:55], v[104:107]
    ds_read_b64_tr_b16 v[48:49], v3 offset:4096
    v_mfma_f32_16x16x32_bf16 v[108:111], v[188:191], v[52:55], v[108:111]
    ds_read_b64_tr_b16 v[50:51], v3 offset:5120
    s_waitcnt lgkmcnt(10)
    v_mfma_f32_16x16x32_bf16 v[112:115], v[184:187], v[56:59], v[112:115]
    ds_read_b64_tr_b16 v[52:53], v4 offset:4096
    v_mfma_f32_16x16x32_bf16 v[116:119], v[188:191], v[56:59], v[116:119]
    ds_read_b64_tr_b16 v[54:55], v4 offset:5120
    v_mfma_f32_16x16x32_bf16 v[120:123], v[184:187], v[60:63], v[120:123]
    ds_read_b64_tr_b16 v[56:57], v5 offset:4096
    v_mfma_f32_16x16x32_bf16 v[124:127], v[188:191], v[60:63], v[124:127]
    ds_read_b64_tr_b16 v[58:59], v5 offset:5120
    s_waitcnt lgkmcnt(10)
    v_mfma_f32_16x16x32_bf16 v[96:99], v[192:195], v[32:35], v[96:99]
    ds_read_b64_tr_b16 v[60:61], v6 offset:4096
    v_mfma_f32_16x16x32_bf16 v[100:103], v[196:199], v[32:35], v[100:103]
    ds_read_b64_tr_b16 v[62:63], v6 offset:5120
    v_mfma_f32_16x16x32_bf16 v[104:107], v[192:195], v[36:39], v[104:107]
    ds_read_b64_tr_b16 v[32:33], v3 offset:8192
    v_mfma_f32_16x16x32_bf16 v[108:111], v[196:199], v[36:39], v[108:111]
    ds_read_b64_tr_b16 v[34:35], v3 offset:9216
    s_waitcnt lgkmcnt(10)
    v_mfma_f32_16x16x32_bf16 v[112:115], v[192:195], v[40:43], v[112:115]
    ds_read_b64_tr_b16 v[36:37], v4 offset:8192
    v_mfma_f32_16x16x32_bf16 v[116:119], v[196:199], v[40:43], v[116:119]
    ds_read_b64_tr_b16 v[38:39], v4 offset:9216
    v_mfma_f32_16x16x32_bf16 v[120:123], v[192:195], v[44:47], v[120:123]
    ds_read_b64_tr_b16 v[40:41], v5 offset:8192
    v_mfma_f32_16x16x32_bf16 v[124:127], v[196:199], v[44:47], v[124:127]
    ds_read_b64_tr_b16 v[42:43], v5 offset:9216
    s_waitcnt lgkmcnt(10)
    v_mfma_f32_16x16x32_bf16 v[96:99], v[200:203], v[48:51], v[96:99]
    ds_read_b64_tr_b16 v[44:45], v6 offset:8192
    v_mfma_f32_16x16x32_bf16 v[100:103], v[204:207], v[48:51], v[100:103]
    ds_read_b64_tr_b16 v[46:47], v6 offset:9216
    v_mfma_f32_16x16x32_bf16 v[104:107], v[200:203], v[52:55], v[104:107]
    ds_read_b64_tr_b16 v[48:49], v3 offset:12288
    v_mfma_f32_16x16x32_bf16 v[108:111], v[204:207], v[52:55], v[108:111]
    ds_read_b64_tr_b16 v[50:51], v3 offset:13312
    s_waitcnt lgkmcnt(10)
    v_mfma_f32_16x16x32_bf16 v[112:115], v[200:203], v[56:59], v[112:115]
    ds_read_b64_tr_b16 v[52:53], v4 offset:12288
    v_mfma_f32_16x16x32_bf16 v[116:119], v[204:207], v[56:59], v[116:119]
    ds_read_b64_tr_b16 v[54:55], v4 offset:13312
    v_mfma_f32_16x16x32_bf16 v[120:123], v[200:203], v[60:63], v[120:123]
    ds_read_b64_tr_b16 v[56:57], v5 offset:12288
    v_mfma_f32_16x16x32_bf16 v[124:127], v[204:207], v[60:63], v[124:127]
    ds_read_b64_tr_b16 v[58:59], v5 offset:13312
    s_waitcnt lgkmcnt(10)
    v_mfma_f32_16x16x32_bf16 v[96:99], v[208:211], v[32:35], v[96:99]
    ds_read_b64_tr_b16 v[60:61], v6 offset:12288
    v_mfma_f32_16x16x32_bf16 v[100:103], v[212:215], v[32:35], v[100:103]
    ds_read_b64_tr_b16 v[62:63], v6 offset:13312
    v_mfma_f32_16x16x32_bf16 v[104:107], v[208:211], v[36:39], v[104:107]
    ds_read_b64_tr_b16 v[32:33], v3 offset:16384
    ds_read_b128 v[16:19], v13 offset:4096
    v_mfma_f32_16x16x32_bf16 v[108:111], v[212:215], v[36:39], v[108:111]
    ds_read_b64_tr_b16 v[34:35], v3 offset:17408
    ds_read_b128 v[20:23], v13 offset:4608
    s_waitcnt lgkmcnt(12)
    v_mfma_f32_16x16x32_bf16 v[112:115], v[208:211], v[40:43], v[112:115]
    ds_read_b64_tr_b16 v[36:37], v4 offset:16384
    ds_read_b128 v[24:27], v13 offset:4160
    v_mfma_f32_16x16x32_bf16 v[116:119], v[212:215], v[40:43], v[116:119]
    ds_read_b64_tr_b16 v[38:39], v4 offset:17408
    ds_read_b128 v[28:31], v13 offset:4672
    v_mfma_f32_16x16x32_bf16 v[120:123], v[208:211], v[44:47], v[120:123]
    ds_read_b64_tr_b16 v[40:41], v5 offset:16384
    ds_read_b32 v8, v15 offset:512
    v_mfma_f32_16x16x32_bf16 v[124:127], v[212:215], v[44:47], v[124:127]
    ds_read_b64_tr_b16 v[42:43], v5 offset:17408
    ds_read_b32 v10, v15 offset:576
    s_waitcnt lgkmcnt(14)
    v_mfma_f32_16x16x32_bf16 v[96:99], v[216:219], v[48:51], v[96:99]
    ds_read_b64_tr_b16 v[44:45], v6 offset:16384
    ds_read_b32 v12, v15 offset:640
    v_mfma_f32_16x16x32_bf16 v[100:103], v[220:223], v[48:51], v[100:103]
    ds_read_b64_tr_b16 v[46:47], v6 offset:17408
    ds_read_b32 v14, v15 offset:704
    v_mfma_f32_16x16x32_bf16 v[104:107], v[216:219], v[52:55], v[104:107]
    ds_read_b64_tr_b16 v[48:49], v3 offset:20480
    v_mfma_f32_16x16x32_bf16 v[108:111], v[220:223], v[52:55], v[108:111]
    ds_read_b64_tr_b16 v[50:51], v3 offset:21504
    s_waitcnt lgkmcnt(14)
    v_mfma_f32_16x16x32_bf16 v[112:115], v[216:219], v[56:59], v[112:115]
    ds_read_b64_tr_b16 v[52:53], v4 offset:20480
    v_mfma_f32_16x16x32_bf16 v[116:119], v[220:223], v[56:59], v[116:119]
    ds_read_b64_tr_b16 v[54:55], v4 offset:21504
    v_mfma_f32_16x16x32_bf16 v[120:123], v[216:219], v[60:63], v[120:123]
    ds_read_b64_tr_b16 v[56:57], v5 offset:20480
    v_mfma_f32_16x16x32_bf16 v[124:127], v[220:223], v[60:63], v[124:127]
    ds_read_b64_tr_b16 v[58:59], v5 offset:21504
    s_waitcnt lgkmcnt(6)
    v_pk_fma_f32 v[100:101], v[8:9], v[24:25], v[100:101] op_sel_hi:[0,1,1] neg_lo:[1,0,0] neg_hi:[1,0,0]
    v_pk_fma_f32 v[102:103], v[8:9], v[26:27], v[102:103] op_sel_hi:[0,1,1] neg_lo:[1,0,0] neg_hi:[1,0,0]
    v_pk_fma_f32 v[108:109], v[10:11], v[24:25], v[108:109] op_sel_hi:[0,1,1] neg_lo:[1,0,0] neg_hi:[1,0,0]
    v_pk_fma_f32 v[110:111], v[10:11], v[26:27], v[110:111] op_sel_hi:[0,1,1] neg_lo:[1,0,0] neg_hi:[1,0,0]
    v_pk_mul_f32 v[100:101], v[28:29], v[100:101]
    v_pk_mul_f32 v[102:103], v[30:31], v[102:103]
    v_pk_mul_f32 v[108:109], v[28:29], v[108:109]
    v_pk_mul_f32 v[110:111], v[30:31], v[110:111]
    v_cvt_pk_bf16_f32 v74, v100, v101
    v_cvt_pk_bf16_f32 v75, v102, v103
    v_cvt_pk_bf16_f32 v78, v108, v109
    v_cvt_pk_bf16_f32 v79, v110, v111
    v_cvt_pk_bf16_f32 v100, v100, v101
    v_cvt_pk_bf16_f32 v101, v102, v103
    v_cvt_pk_bf16_f32 v102, v108, v109
    v_cvt_pk_bf16_f32 v103, v110, v111
    ds_write_b128 v7, v[100:103] offset:6144
    v_pk_fma_f32 v[116:117], v[12:13], v[24:25], v[116:117] op_sel_hi:[0,1,1] neg_lo:[1,0,0] neg_hi:[1,0,0]
    v_pk_fma_f32 v[118:119], v[12:13], v[26:27], v[118:119] op_sel_hi:[0,1,1] neg_lo:[1,0,0] neg_hi:[1,0,0]
    v_pk_fma_f32 v[124:125], v[14:15], v[24:25], v[124:125] op_sel_hi:[0,1,1] neg_lo:[1,0,0] neg_hi:[1,0,0]
    v_pk_fma_f32 v[126:127], v[14:15], v[26:27], v[126:127] op_sel_hi:[0,1,1] neg_lo:[1,0,0] neg_hi:[1,0,0]
    v_pk_mul_f32 v[116:117], v[28:29], v[116:117]
    v_pk_mul_f32 v[118:119], v[30:31], v[118:119]
    v_pk_mul_f32 v[124:125], v[28:29], v[124:125]
    v_pk_mul_f32 v[126:127], v[30:31], v[126:127]
    v_cvt_pk_bf16_f32 v90, v116, v117
    v_cvt_pk_bf16_f32 v91, v118, v119
    v_cvt_pk_bf16_f32 v94, v124, v125
    v_cvt_pk_bf16_f32 v95, v126, v127
    v_cvt_pk_bf16_f32 v116, v116, v117
    v_cvt_pk_bf16_f32 v117, v118, v119
    v_cvt_pk_bf16_f32 v118, v124, v125
    v_cvt_pk_bf16_f32 v119, v126, v127
    ds_write_b128 v7, v[116:119] offset:7168
    s_cmp_lg_u32 s16, 3
    s_cbranch_scc1 a_nh
    buffer_store_dwordx4 v[68:71], v1, s[4:7], s60 offen offset:0 sc1
    buffer_store_dwordx4 v[84:87], v1, s[4:7], s60 offen offset:1024 sc1
    buffer_store_dwordx4 v[100:103], v1, s[4:7], s60 offen offset:2048 sc1
    buffer_store_dwordx4 v[116:119], v1, s[4:7], s60 offen offset:3072 sc1
a_nh:
    v_pk_fma_f32 v[96:97], v[8:9], v[16:17], v[96:97] op_sel_hi:[0,1,1] neg_lo:[1,0,0] neg_hi:[1,0,0]
    v_pk_fma_f32 v[98:99], v[8:9], v[18:19], v[98:99] op_sel_hi:[0,1,1] neg_lo:[1,0,0] neg_hi:[1,0,0]
    v_pk_fma_f32 v[104:105], v[10:11], v[16:17], v[104:105] op_sel_hi:[0,1,1] neg_lo:[1,0,0] neg_hi:[1,0,0]
    v_pk_fma_f32 v[106:107], v[10:11], v[18:19], v[106:107] op_sel_hi:[0,1,1] neg_lo:[1,0,0] neg_hi:[1,0,0]
    v_pk_mul_f32 v[96:97], v[20:21], v[96:97]
    v_pk_mul_f32 v[98:99], v[22:23], v[98:99]
    v_pk_mul_f32 v[104:105], v[20:21], v[104:105]
    v_pk_mul_f32 v[106:107], v[22:23], v[106:107]
    v_cvt_pk_bf16_f32 v72, v96, v97
    v_cvt_pk_bf16_f32 v73, v98, v99
    v_cvt_pk_bf16_f32 v76, v104, v105
    v_cvt_pk_bf16_f32 v77, v106, v107
    v_pk_fma_f32 v[112:113], v[12:13], v[16:17], v[112:113] op_sel_hi:[0,1,1] neg_lo:[1,0,0] neg_hi:[1,0,0]
    v_pk_fma_f32 v[114:115], v[12:13], v[18:19], v[114:115] op_sel_hi:[0,1,1] neg_lo:[1,0,0] neg_hi:[1,0,0]
    v_pk_fma_f32 v[120:121], v[14:15], v[16:17], v[120:121] op_sel_hi:[0,1,1] neg_lo:[1,0,0] neg_hi:[1,0,0]
    v_pk_fma_f32 v[122:123], v[14:15], v[18:19], v[122:123] op_sel_hi:[0,1,1] neg_lo:[1,0,0] neg_hi:[1,0,0]
    v_pk_mul_f32 v[112:113], v[20:21], v[112:113]
    v_pk_mul_f32 v[114:115], v[22:23], v[114:115]
    v_pk_mul_f32 v[120:121], v[20:21], v[120:121]
    v_pk_mul_f32 v[122:123], v[22:23], v[122:123]
    v_cvt_pk_bf16_f32 v88, v112, v113
    v_cvt_pk_bf16_f32 v89, v114, v115
    v_cvt_pk_bf16_f32 v92, v120, v121
    v_cvt_pk_bf16_f32 v93, v122, v123
    v_mfma_f32_16x16x32_bf16 v[128:131], v[32:35], v[224:227], v[128:131]
    ds_read_b64_tr_b16 v[60:61], v6 offset:20480
    v_mfma_f32_16x16x32_bf16 v[132:135], v[32:35], v[228:231], v[132:135]
    ds_read_b64_tr_b16 v[62:63], v6 offset:21504
    v_mfma_f32_16x16x32_bf16 v[136:139], v[36:39], v[224:227], v[136:139]
    ds_read_b64_tr_b16 v[32:33], v3 offset:24576
    v_mfma_f32_16x16x32_bf16 v[140:143], v[36:39], v[228:231], v[140:143]
    ds_read_b64_tr_b16 v[34:35], v3 offset:25600
    v_mfma_f32_16x16x32_bf16 v[144:147], v[40:43], v[224:227], v[144:147]
    ds_read_b64_tr_b16 v[36:37], v4 offset:24576
    v_mfma_f32_16x16x32_bf16 v[148:151], v[40:43], v[228:231], v[148:151]
    ds_read_b64_tr_b16 v[38:39], v4 offset:25600
    v_mfma_f32_16x16x32_bf16 v[152:155], v[44:47], v[224:227], v[152:155]
    ds_read_b64_tr_b16 v[40:41], v5 offset:24576
    v_mfma_f32_16x16x32_bf16 v[156:159], v[44:47], v[228:231], v[156:159]
    ds_read_b64_tr_b16 v[42:43], v5 offset:25600
    s_waitcnt lgkmcnt(12)
    v_mfma_f32_16x16x32_bf16 v[128:131], v[48:51], v[232:235], v[128:131]
    ds_read_b64_tr_b16 v[44:45], v6 offset:24576
    v_mfma_f32_16x16x32_bf16 v[132:135], v[48:51], v[236:239], v[132:135]
    ds_read_b64_tr_b16 v[46:47], v6 offset:25600
    v_mfma_f32_16x16x32_bf16 v[136:139], v[52:55], v[232:235], v[136:139]
    ds_read_b64_tr_b16 v[48:49], v3 offset:28672
    v_mfma_f32_16x16x32_bf16 v[140:143], v[52:55], v[236:239], v[140:143]
    ds_read_b64_tr_b16 v[50:51], v3 offset:29696
    s_waitcnt lgkmcnt(10)
    v_mfma_f32_16x16x32_bf16 v[144:147], v[56:59], v[232:235], v[144:147]
    ds_read_b64_tr_b16 v[52:53], v4 offset:28672
    v_mfma_f32_16x16x32_bf16 v[148:151], v[56:59], v[236:239], v[148:151]
    ds_read_b64_tr_b16 v[54:55], v4 offset:29696
    v_mfma_f32_16x16x32_bf16 v[152:155], v[60:63], v[232:235], v[152:155]
    ds_read_b64_tr_b16 v[56:57], v5 offset:28672
    v_mfma_f32_16x16x32_bf16 v[156:159], v[60:63], v[236:239], v[156:159]
    ds_read_b64_tr_b16 v[58:59], v5 offset:29696
    s_waitcnt lgkmcnt(10)
    v_mfma_f32_16x16x32_bf16 v[128:131], v[32:35], v[240:243], v[128:131]
    ds_read_b64_tr_b16 v[60:61], v6 offset:28672
    v_mfma_f32_16x16x32_bf16 v[132:135], v[32:35], v[244:247], v[132:135]
    ds_read_b64_tr_b16 v[62:63], v6 offset:29696
    s_barrier
    v_mfma_f32_16x16x32_bf16 v[136:139], v[36:39], v[240:243], v[136:139]
    ds_read_b64_tr_b16 v[32:33], v3 offset:32768
    v_mfma_f32_16x16x32_bf16 v[140:143], v[36:39], v[244:247], v[140:143]
    ds_read_b64_tr_b16 v[34:35], v3 offset:33792
    s_waitcnt lgkmcnt(10)
    v_mfma_f32_16x16x32_bf16 v[144:147], v[40:43], v[240:243], v[144:147]
    ds_read_b64_tr_b16 v[36:37], v4 offset:32768
    v_mfma_f32_16x16x32_bf16 v[148:151], v[40:43], v[244:247], v[148:151]
    ds_read_b64_tr_b16 v[38:39], v4 offset:33792
    v_mfma_f32_16x16x32_bf16 v[152:155], v[44:47], v[240:243], v[152:155]
    ds_read_b64_tr_b16 v[40:41], v5 offset:32768
    v_mfma_f32_16x16x32_bf16 v[156:159], v[44:47], v[244:247], v[156:159]
    ds_read_b64_tr_b16 v[42:43], v5 offset:33792
    s_waitcnt lgkmcnt(10)
    v_mfma_f32_16x16x32_bf16 v[128:131], v[48:51], v[248:251], v[128:131]
    ds_read_b64_tr_b16 v[44:45], v6 offset:32768
    v_mfma_f32_16x16x32_bf16 v[132:135], v[48:51], v[252:255], v[132:135]
    ds_read_b64_tr_b16 v[46:47], v6 offset:33792
    v_mfma_f32_16x16x32_bf16 v[136:139], v[52:55], v[248:251], v[136:139]
    ds_read_b64_tr_b16 v[48:49], v3 offset:36864
    v_mfma_f32_16x16x32_bf16 v[140:143], v[52:55], v[252:255], v[140:143]
    ds_read_b64_tr_b16 v[50:51], v3 offset:37888
    s_waitcnt lgkmcnt(10)
    v_mfma_f32_16x16x32_bf16 v[144:147], v[56:59], v[248:251], v[144:147]
    ds_read_b64_tr_b16 v[52:53], v4 offset:36864
    v_mfma_f32_16x16x32_bf16 v[148:151], v[56:59], v[252:255], v[148:151]
    ds_read_b64_tr_b16 v[54:55], v4 offset:37888
    v_mfma_f32_16x16x32_bf16 v[152:155], v[60:63], v[248:251], v[152:155]
    ds_read_b64_tr_b16 v[56:57], v5 offset:36864
    v_mfma_f32_16x16x32_bf16 v[156:159], v[60:63], v[252:255], v[156:159]
    ds_read_b64_tr_b16 v[58:59], v5 offset:37888
    s_waitcnt lgkmcnt(10)
    v_mfma_f32_16x16x32_bf16 v[128:131], v[32:35], v[160:163], v[128:131]
    ds_read_b64_tr_b16 v[60:61], v6 offset:36864
    v_mfma_f32_16x16x32_bf16 v[132:135], v[32:35], v[164:167], v[132:135]
    ds_read_b64_tr_b16 v[62:63], v6 offset:37888
    v_mfma_f32_16x16x32_bf16 v[136:139], v[36:39], v[160:163], v[136:139]
    ds_read_b64_tr_b16 v[32:33], v3 offset:40960
    v_mfma_f32_16x16x32_bf16 v[140:143], v[36:39], v[164:167], v[140:143]
    ds_read_b64_tr_b16 v[34:35], v3 offset:41984
    s_waitcnt lgkmcnt(10)
    v_mfma_f32_16x16x32_bf16 v[144:147], v[40:43], v[160:163], v[144:147]
    ds_read_b64_tr_b16 v[36:37], v4 offset:40960
    v_mfma_f32_16x16x32_bf16 v[148:151], v[40:43], v[164:167], v[148:151]
    ds_read_b64_tr_b16 v[38:39], v4 offset:41984
    v_mfma_f32_16x16x32_bf16 v[152:155], v[44:47], v[160:163], v[152:155]
    ds_read_b64_tr_b16 v[40:41], v5 offset:40960
    v_mfma_f32_16x16x32_bf16 v[156:159], v[44:47], v[164:167], v[156:159]
    ds_read_b64_tr_b16 v[42:43], v5 offset:41984
    s_waitcnt lgkmcnt(10)
    v_mfma_f32_16x16x32_bf16 v[128:131], v[48:51], v[168:171], v[128:131]
    ds_read_b64_tr_b16 v[44:45], v6 offset:40960
    s_cmp_lg_u32 s16, 3
    s_cbranch_scc1 a_nopub
    s_waitcnt vmcnt(0)
    s_atomic_add s40, s[22:23], s61
a_nopub:
    v_mfma_f32_16x16x32_bf16 v[132:135], v[48:51], v[172:175], v[132:135]
    ds_read_b64_tr_b16 v[46:47], v6 offset:41984
    v_mfma_f32_16x16x32_bf16 v[136:139], v[52:55], v[168:171], v[136:139]
    ds_read_b64_tr_b16 v[48:49], v3 offset:45056
    v_mfma_f32_16x16x32_bf16 v[140:143], v[52:55], v[172:175], v[140:143]
    ds_read_b64_tr_b16 v[50:51], v3 offset:46080
    s_waitcnt lgkmcnt(10)
    v_mfma_f32_16x16x32_bf16 v[144:147], v[56:59], v[168:171], v[144:147]
    ds_read_b64_tr_b16 v[52:53], v4 offset:45056
    v_mfma_f32_16x16x32_bf16 v[148:151], v[56:59], v[172:175], v[148:151]
    ds_read_b64_tr_b16 v[54:55], v4 offset:46080
    v_mfma_f32_16x16x32_bf16 v[152:155], v[60:63], v[168:171], v[152:155]
    ds_read_b64_tr_b16 v[56:57], v5 offset:45056
    v_mfma_f32_16x16x32_bf16 v[156:159], v[60:63], v[172:175], v[156:159]
    ds_read_b64_tr_b16 v[58:59], v5 offset:46080
    s_waitcnt lgkmcnt(10)
    v_mfma_f32_16x16x32_bf16 v[128:131], v[32:35], v[176:179], v[128:131]
    ds_read_b64_tr_b16 v[60:61], v6 offset:45056
    v_mfma_f32_16x16x32_bf16 v[132:135], v[32:35], v[180:183], v[132:135]
    ds_read_b64_tr_b16 v[62:63], v6 offset:46080
    v_mfma_f32_16x16x32_bf16 v[136:139], v[36:39], v[176:179], v[136:139]
    ds_read_b64_tr_b16 v[32:33], v3 offset:49152
    v_mfma_f32_16x16x32_bf16 v[140:143], v[36:39], v[180:183], v[140:143]
    ds_read_b64_tr_b16 v[34:35], v3 offset:50176
    s_waitcnt lgkmcnt(10)
    v_mfma_f32_16x16x32_bf16 v[144:147], v[40:43], v[176:179], v[144:147]
    ds_read_b64_tr_b16 v[36:37], v4 offset:49152
    v_mfma_f32_16x16x32_bf16 v[148:151], v[40:43], v[180:183], v[148:151]
    ds_read_b64_tr_b16 v[38:39], v4 offset:50176
    v_mfma_f32_16x16x32_bf16 v[152:155], v[44:47], v[176:179], v[152:155]
    ds_read_b64_tr_b16 v[40:41], v5 offset:49152
    v_mfma_f32_16x16x32_bf16 v[156:159], v[44:47], v[180:183], v[156:159]
    ds_read_b64_tr_b16 v[42:43], v5 offset:50176
    s_waitcnt lgkmcnt(10)
    v_mfma_f32_16x16x32_bf16 v[128:131], v[48:51], v[184:187], v[128:131]
    ds_read_b64_tr_b16 v[44:45], v6 offset:49152
    ds_read_b32 v8, v9 offset:4096
    v_mfma_f32_16x16x32_bf16 v[132:135], v[48:51], v[188:191], v[132:135]
    ds_read_b64_tr_b16 v[46:47], v6 offset:50176
    ds_read_b32 v10, v9 offset:4608
    v_mfma_f32_16x16x32_bf16 v[136:139], v[52:55], v[184:187], v[136:139]
    ds_read_b64_tr_b16 v[48:49], v3 offset:53248
    ds_read_b32 v12, v9 offset:4160
    v_mfma_f32_16x16x32_bf16 v[140:143], v[52:55], v[188:191], v[140:143]
    ds_read_b64_tr_b16 v[50:51], v3 offset:54272
    ds_read_b32 v14, v9 offset:4672
    s_waitcnt lgkmcnt(14)
    v_mfma_f32_16x16x32_bf16 v[144:147], v[56:59], v[184:187], v[144:147]
    ds_read_b64_tr_b16 v[52:53], v4 offset:53248
    ds_read_b128 v[16:19], v11 offset:0
    v_mfma_f32_16x16x32_bf16 v[148:151], v[56:59], v[188:191], v[148:151]
    ds_read_b64_tr_b16 v[54:55], v4 offset:54272
    ds_read_b128 v[20:23], v11 offset:64
    v_mfma_f32_16x16x32_bf16 v[152:155], v[60:63], v[184:187], v[152:155]
    ds_read_b64_tr_b16 v[56:57], v5 offset:53248
    ds_read_b128 v[24:27], v11 offset:128
    v_mfma_f32_16x16x32_bf16 v[156:159], v[60:63], v[188:191], v[156:159]
    ds_read_b64_tr_b16 v[58:59], v5 offset:54272
    ds_read_b128 v[28:31], v11 offset:192
    s_waitcnt lgkmcnt(14)
    v_mfma_f32_16x16x32_bf16 v[128:131], v[32:35], v[192:195], v[128:131]
    ds_read_b64_tr_b16 v[60:61], v6 offset:53248
    v_add_u32 v13, 153600, v1
    v_mfma_f32_16x16x32_bf16 v[132:135], v[32:35], v[196:199], v[132:135]
    ds_read_b64_tr_b16 v[62:63], v6 offset:54272
    v_mfma_f32_16x16x32_bf16 v[136:139], v[36:39], v[192:195], v[136:139]
    ds_read_b64_tr_b16 v[32:33], v3 offset:57344
    v_mfma_f32_16x16x32_bf16 v[140:143], v[36:39], v[196:199], v[140:143]
    ds_read_b64_tr_b16 v[34:35], v3 offset:58368
    s_waitcnt lgkmcnt(14)
    v_mfma_f32_16x16x32_bf16 v[144:147], v[40:43], v[192:195], v[144:147]
    ds_read_b64_tr_b16 v[36:37], v4 offset:57344
    v_mfma_f32_16x16x32_bf16 v[148:151], v[40:43], v[196:199], v[148:151]
    ds_read_b64_tr_b16 v[38:39], v4 offset:58368
    v_mfma_f32_16x16x32_bf16 v[152:155], v[44:47], v[192:195], v[152:155]
    ds_read_b64_tr_b16 v[40:41], v5 offset:57344
    v_mfma_f32_16x16x32_bf16 v[156:159], v[44:47], v[196:199], v[156:159]
    ds_read_b64_tr_b16 v[42:43], v5 offset:58368
    s_waitcnt lgkmcnt(13)
    v_mfma_f32_16x16x32_bf16 v[128:131], v[48:51], v[200:203], v[128:131]
    ds_read_b64_tr_b16 v[44:45], v6 offset:57344
    s_waitcnt lgkmcnt(9)
    v_mfma_f32_16x16x32_bf16 v[132:135], v[48:51], v[204:207], v[132:135]
    ds_read_b64_tr_b16 v[46:47], v6 offset:58368
    v_mul_f32 v10, 0x3e8293ee, v10
    v_mfma_f32_16x16x32_bf16 v[136:139], v[52:55], v[200:203], v[136:139]
    ds_read_b64_tr_b16 v[48:49], v3 offset:61440
    v_mul_f32 v14, 0x3e8293ee, v14
    v_mfma_f32_16x16x32_bf16 v[140:143], v[52:55], v[204:207], v[140:143]
    ds_read_b64_tr_b16 v[50:51], v3 offset:62464
    ds_read_b128 v[120:123], v13 offset:0
    s_waitcnt lgkmcnt(11)
    v_mfma_f32_16x16x32_bf16 v[144:147], v[56:59], v[200:203], v[144:147]
    ds_read_b64_tr_b16 v[52:53], v4 offset:61440
    ds_read_b128 v[124:127], v13 offset:1024
    v_mfma_f32_16x16x32_bf16 v[148:151], v[56:59], v[204:207], v[148:151]
    ds_read_b64_tr_b16 v[54:55], v4 offset:62464
    v_mfma_f32_16x16x32_bf16 v[152:155], v[60:63], v[200:203], v[152:155]
    ds_read_b64_tr_b16 v[56:57], v5 offset:61440
    v_mfma_f32_16x16x32_bf16 v[156:159], v[60:63], v[204:207], v[156:159]
    ds_read_b64_tr_b16 v[58:59], v5 offset:62464
    s_waitcnt lgkmcnt(12)
    v_mfma_f32_16x16x32_bf16 v[128:131], v[32:35], v[208:211], v[128:131]
    ds_read_b64_tr_b16 v[60:61], v6 offset:61440
    v_mfma_f32_16x16x32_bf16 v[132:135], v[32:35], v[212:215], v[132:135]
    ds_read_b64_tr_b16 v[62:63], v6 offset:62464
    v_xor_b32 v3, 0x10000, v3
    v_xor_b32 v4, 0x10000, v4
    v_xor_b32 v5, 0x10000, v5
    v_xor_b32 v6, 0x10000, v6
    v_mfma_f32_16x16x32_bf16 v[136:139], v[36:39], v[208:211], v[136:139]
    v_mfma_f32_16x16x32_bf16 v[140:143], v[36:39], v[212:215], v[140:143]
    s_waitcnt lgkmcnt(10)
    v_mfma_f32_16x16x32_bf16 v[144:147], v[40:43], v[208:211], v[144:147]
    v_mfma_f32_16x16x32_bf16 v[148:151], v[40:43], v[212:215], v[148:151]
    v_mfma_f32_16x16x32_bf16 v[152:155], v[44:47], v[208:211], v[152:155]
    v_mfma_f32_16x16x32_bf16 v[156:159], v[44:47], v[212:215], v[156:159]
    s_waitcnt lgkmcnt(4)
    v_mfma_f32_16x16x32_bf16 v[128:131], v[48:51], v[216:219], v[128:131]
    v_mfma_f32_16x16x32_bf16 v[132:135], v[48:51], v[220:223], v[132:135]
    v_mfma_f32_16x16x32_bf16 v[136:139], v[52:55], v[216:219], v[136:139]
    v_mfma_f32_16x16x32_bf16 v[140:143], v[52:55], v[220:223], v[140:143]
    s_waitcnt lgkmcnt(0)
    v_mfma_f32_16x16x32_bf16 v[144:147], v[56:59], v[216:219], v[144:147]
    v_mfma_f32_16x16x32_bf16 v[148:151], v[56:59], v[220:223], v[148:151]
    v_mfma_f32_16x16x32_bf16 v[152:155], v[60:63], v[216:219], v[152:155]
    v_mfma_f32_16x16x32_bf16 v[156:159], v[60:63], v[220:223], v[156:159]
    s_lshl_b32 s44, s21, 22
    s_lshl_b32 s45, s38, 16
    s_add_u32 s44, s44, s45
    s_lshl_b32 s45, s18, 12
    s_add_u32 s44, s44, s45
    s_add_u32 s52, s44, 16777216
    v_pk_fma_f32 v[132:133], v[12:13], v[16:17], v[132:133] op_sel_hi:[0,1,1] neg_lo:[1,0,0] neg_hi:[1,0,0]
    v_pk_fma_f32 v[134:135], v[12:13], v[18:19], v[134:135] op_sel_hi:[0,1,1] neg_lo:[1,0,0] neg_hi:[1,0,0]
    v_pk_fma_f32 v[140:141], v[12:13], v[20:21], v[140:141] op_sel_hi:[0,1,1] neg_lo:[1,0,0] neg_hi:[1,0,0]
    v_pk_fma_f32 v[142:143], v[12:13], v[22:23], v[142:143] op_sel_hi:[0,1,1] neg_lo:[1,0,0] neg_hi:[1,0,0]
    v_pk_fma_f32 v[148:149], v[12:13], v[24:25], v[148:149] op_sel_hi:[0,1,1] neg_lo:[1,0,0] neg_hi:[1,0,0]
    v_pk_fma_f32 v[150:151], v[12:13], v[26:27], v[150:151] op_sel_hi:[0,1,1] neg_lo:[1,0,0] neg_hi:[1,0,0]
    v_pk_fma_f32 v[156:157], v[12:13], v[28:29], v[156:157] op_sel_hi:[0,1,1] neg_lo:[1,0,0] neg_hi:[1,0,0]
    v_pk_fma_f32 v[158:159], v[12:13], v[30:31], v[158:159] op_sel_hi:[0,1,1] neg_lo:[1,0,0] neg_hi:[1,0,0]
    v_pk_mul_f32 v[132:133], v[14:15], v[132:133] op_sel_hi:[0,1]
    v_pk_mul_f32 v[134:135], v[14:15], v[134:135] op_sel_hi:[0,1]
    v_pk_mul_f32 v[140:141], v[14:15], v[140:141] op_sel_hi:[0,1]
    v_pk_mul_f32 v[142:143], v[14:15], v[142:143] op_sel_hi:[0,1]
    v_pk_mul_f32 v[148:149], v[14:15], v[148:149] op_sel_hi:[0,1]
    v_pk_mul_f32 v[150:151], v[14:15], v[150:151] op_sel_hi:[0,1]
    v_pk_mul_f32 v[156:157], v[14:15], v[156:157] op_sel_hi:[0,1]
    v_pk_mul_f32 v[158:159], v[14:15], v[158:159] op_sel_hi:[0,1]
    v_cvt_pk_bf16_f32 v132, v132, v133
    v_cvt_pk_bf16_f32 v133, v134, v135
    v_cvt_pk_bf16_f32 v134, v140, v141
    v_cvt_pk_bf16_f32 v135, v142, v143
    v_cvt_pk_bf16_f32 v148, v148, v149
    v_cvt_pk_bf16_f32 v149, v150, v151
    v_cvt_pk_bf16_f32 v150, v156, v157
    v_cvt_pk_bf16_f32 v151, v158, v159
    v_mfma_f32_16x16x32_bf16 v[172:175], v[68:71], v[132:135], v[120:123]
    v_mfma_f32_16x16x32_bf16 v[168:171], v[64:67], v[132:135], v[124:127]
    v_mfma_f32_16x16x32_bf16 v[188:191], v[84:87], v[148:151], v[120:123]
    v_mfma_f32_16x16x32_bf16 v[184:187], v[80:83], v[148:151], v[124:127]
    v_pk_fma_f32 v[128:129], v[8:9], v[16:17], v[128:129] op_sel_hi:[0,1,1] neg_lo:[1,0,0] neg_hi:[1,0,0]
    v_pk_fma_f32 v[130:131], v[8:9], v[18:19], v[130:131] op_sel_hi:[0,1,1] neg_lo:[1,0,0] neg_hi:[1,0,0]
    v_pk_fma_f32 v[136:137], v[8:9], v[20:21], v[136:137] op_sel_hi:[0,1,1] neg_lo:[1,0,0] neg_hi:[1,0,0]
    v_pk_fma_f32 v[138:139], v[8:9], v[22:23], v[138:139] op_sel_hi:[0,1,1] neg_lo:[1,0,0] neg_hi:[1,0,0]
    v_pk_fma_f32 v[144:145], v[8:9], v[24:25], v[144:145] op_sel_hi:[0,1,1] neg_lo:[1,0,0] neg_hi:[1,0,0]
    v_pk_fma_f32 v[146:147], v[8:9], v[26:27], v[146:147] op_sel_hi:[0,1,1] neg_lo:[1,0,0] neg_hi:[1,0,0]
    v_pk_fma_f32 v[152:153], v[8:9], v[28:29], v[152:153] op_sel_hi:[0,1,1] neg_lo:[1,0,0] neg_hi:[1,0,0]
    v_pk_fma_f32 v[154:155], v[8:9], v[30:31], v[154:155] op_sel_hi:[0,1,1] neg_lo:[1,0,0] neg_hi:[1,0,0]
    v_pk_mul_f32 v[128:129], v[10:11], v[128:129] op_sel_hi:[0,1]
    v_pk_mul_f32 v[130:131], v[10:11], v[130:131] op_sel_hi:[0,1]
    v_pk_mul_f32 v[136:137], v[10:11], v[136:137] op_sel_hi:[0,1]
    v_pk_mul_f32 v[138:139], v[10:11], v[138:139] op_sel_hi:[0,1]
    v_pk_mul_f32 v[144:145], v[10:11], v[144:145] op_sel_hi:[0,1]
    v_pk_mul_f32 v[146:147], v[10:11], v[146:147] op_sel_hi:[0,1]
    v_pk_mul_f32 v[152:153], v[10:11], v[152:153] op_sel_hi:[0,1]
    v_pk_mul_f32 v[154:155], v[10:11], v[154:155] op_sel_hi:[0,1]
    v_cvt_pk_bf16_f32 v128, v128, v129
    v_cvt_pk_bf16_f32 v129, v130, v131
    v_cvt_pk_bf16_f32 v130, v136, v137
    v_cvt_pk_bf16_f32 v131, v138, v139
    v_cvt_pk_bf16_f32 v144, v144, v145
    v_cvt_pk_bf16_f32 v145, v146, v147
    v_cvt_pk_bf16_f32 v146, v152, v153
    v_cvt_pk_bf16_f32 v147, v154, v155
    v_mfma_f32_16x16x32_bf16 v[164:167], v[64:67], v[128:131], v[120:123]
    s_nop 0
    v_mfma_f32_16x16x32_bf16 v[180:183], v[80:83], v[144:147], v[120:123]
    v_mov_b32 v232, 0x3f803f80
    v_mov_b32 v233, 0x3f803f80
    v_mov_b32 v234, 0x3f803f80
    v_mov_b32 v235, 0x3f803f80
    v_exp_f32 v172, v172
    v_exp_f32 v173, v173
    v_exp_f32 v174, v174
    v_exp_f32 v175, v175
    v_exp_f32 v188, v188
    v_exp_f32 v189, v189
    v_exp_f32 v190, v190
    v_exp_f32 v191, v191
    s_mov_b32 s46, 1006632960
a_exp1:
    v_exp_f32 v168, v168
    v_exp_f32 v169, v169
    v_exp_f32 v170, v170
    v_exp_f32 v171, v171
    v_exp_f32 v184, v184
    v_exp_f32 v185, v185
    v_exp_f32 v186, v186
    v_exp_f32 v187, v187
    v_cvt_pk_bf16_f32 v200, v168, v169
    v_cvt_pk_bf16_f32 v201, v170, v171
    v_cvt_pk_bf16_f32 v202, v172, v173
    v_cvt_pk_bf16_f32 v203, v174, v175
    v_cvt_pk_bf16_f32 v204, v184, v185
    v_cvt_pk_bf16_f32 v205, v186, v187
    v_cvt_pk_bf16_f32 v206, v188, v189
    v_cvt_pk_bf16_f32 v207, v190, v191
    v_mfma_f32_16x16x32_bf16 v[16:19], v[232:235], v[200:203], 0
    s_nop 0
    v_mfma_f32_16x16x32_bf16 v[20:23], v[232:235], v[204:207], 0
    v_mfma_f32_16x16x32_bf16 v[40:43], v[72:75], v[200:203], 0
    v_mfma_f32_16x16x32_bf16 v[44:47], v[76:79], v[200:203], 0
    v_mfma_f32_16x16x32_bf16 v[56:59], v[88:91], v[204:207], 0
    v_mfma_f32_16x16x32_bf16 v[60:63], v[92:95], v[204:207], 0
    v_mov_b32 v218, v72
    v_mov_b32 v219, v73
    v_mov_b32 v222, v76
    v_mov_b32 v223, v77
    v_mov_b32 v226, v88
    v_mov_b32 v227, v89
    v_mov_b32 v230, v92
    v_mov_b32 v231, v93
    v_subrev_u32 v18, 0x21800000, v16
    v_subrev_u32 v22, 0x21800000, v20
    v_max_u32 v18, v18, v22
    v_cmp_le_u32 vcc, s46, v18
    v_rcp_f32 v16, v16
    v_rcp_f32 v20, v20
    s_cbranch_vccnz a_slow1
a_fin1:
    v_pk_mul_f32 v[40:41], v[16:17], v[40:41] op_sel_hi:[0,1]
    v_pk_mul_f32 v[42:43], v[16:17], v[42:43] op_sel_hi:[0,1]
    v_pk_mul_f32 v[44:45], v[16:17], v[44:45] op_sel_hi:[0,1]
    v_pk_mul_f32 v[46:47], v[16:17], v[46:47] op_sel_hi:[0,1]
    v_pk_mul_f32 v[56:57], v[20:21], v[56:57] op_sel_hi:[0,1]
    v_pk_mul_f32 v[58:59], v[20:21], v[58:59] op_sel_hi:[0,1]
    v_pk_mul_f32 v[60:61], v[20:21], v[60:61] op_sel_hi:[0,1]
    v_pk_mul_f32 v[62:63], v[20:21], v[62:63] op_sel_hi:[0,1]
    v_cvt_pk_bf16_f32 v40, v40, v41
    v_cvt_pk_bf16_f32 v41, v42, v43
    v_cvt_pk_bf16_f32 v42, v44, v45
    v_cvt_pk_bf16_f32 v43, v46, v47
    v_cvt_pk_bf16_f32 v56, v56, v57
    v_cvt_pk_bf16_f32 v57, v58, v59
    v_cvt_pk_bf16_f32 v58, v60, v61
    v_cvt_pk_bf16_f32 v59, v62, v63
    v_permlane32_swap_b32 v40, v42
    v_permlane32_swap_b32 v41, v43
    buffer_store_dwordx4 v[40:43], v2, s[4:7], s52 offen offset:256 sc1
    v_permlane32_swap_b32 v56, v58
    v_permlane32_swap_b32 v57, v59
    buffer_store_dwordx4 v[56:59], v2, s[4:7], s52 offen offset:2304 sc1
    s_cmp_lg_u32 s38, 0
    s_cbranch_scc1 a_hasprev
    v_mov_b32 v124, 0xf149f2ca
    v_mov_b32 v125, 0xf149f2ca
    v_mov_b32 v126, 0xf149f2ca
    v_mov_b32 v127, 0xf149f2ca
a_hasprev:
    s_waitcnt lgkmcnt(0)
    s_barrier
    ds_read_b128 v[192:195], v7 offset:0
    ds_read_b128 v[196:199], v7 offset:1024
    ds_read_b64 v[216:217], v7 offset:2048
    ds_read_b64 v[220:221], v7 offset:2056
    ds_read_b64 v[224:225], v7 offset:3072
    ds_read_b64 v[228:229], v7 offset:3080
    s_waitcnt lgkmcnt(4)
    v_mfma_f32_16x16x32_bf16 v[160:163], v[192:195], v[128:131], v[124:127]
    v_mfma_f32_16x16x32_bf16 v[176:179], v[196:199], v[144:147], v[124:127]
    v_exp_f32 v164, v164
    v_exp_f32 v165, v165
    v_exp_f32 v166, v166
    v_exp_f32 v167, v167
    v_exp_f32 v180, v180
    v_exp_f32 v181, v181
    v_exp_f32 v182, v182
    v_exp_f32 v183, v183
    s_waitcnt lgkmcnt(0)
    s_mov_b32 s46, 1006632960
a_exp0:
    v_exp_f32 v160, v160
    v_exp_f32 v161, v161
    v_exp_f32 v162, v162
    v_exp_f32 v163, v163
    v_exp_f32 v176, v176
    v_exp_f32 v177, v177
    v_exp_f32 v178, v178
    v_exp_f32 v179, v179
    v_cvt_pk_bf16_f32 v200, v160, v161
    v_cvt_pk_bf16_f32 v201, v162, v163
    v_cvt_pk_bf16_f32 v202, v164, v165
    v_cvt_pk_bf16_f32 v203, v166, v167
    v_cvt_pk_bf16_f32 v204, v176, v177
    v_cvt_pk_bf16_f32 v205, v178, v179
    v_cvt_pk_bf16_f32 v206, v180, v181
    v_cvt_pk_bf16_f32 v207, v182, v183
    v_mfma_f32_16x16x32_bf16 v[16:19], v[232:235], v[200:203], 0
    s_nop 0
    v_mfma_f32_16x16x32_bf16 v[20:23], v[232:235], v[204:207], 0
    v_mfma_f32_16x16x32_bf16 v[32:35], v[216:219], v[200:203], 0
    v_mfma_f32_16x16x32_bf16 v[36:39], v[220:223], v[200:203], 0
    v_mfma_f32_16x16x32_bf16 v[48:51], v[224:227], v[204:207], 0
    v_mfma_f32_16x16x32_bf16 v[52:55], v[228:231], v[204:207], 0
    s_nop 1
    v_subrev_u32 v18, 0x21800000, v16
    s_nop 0
    v_subrev_u32 v22, 0x21800000, v20
    v_max_u32 v18, v18, v22
    v_cmp_le_u32 vcc, s46, v18
    v_rcp_f32 v16, v16
    v_rcp_f32 v20, v20
    s_cbranch_vccnz a_slow0
a_fin0:
    v_pk_mul_f32 v[32:33], v[16:17], v[32:33] op_sel_hi:[0,1]
    v_pk_mul_f32 v[34:35], v[16:17], v[34:35] op_sel_hi:[0,1]
    v_pk_mul_f32 v[36:37], v[16:17], v[36:37] op_sel_hi:[0,1]
    v_pk_mul_f32 v[38:39], v[16:17], v[38:39] op_sel_hi:[0,1]
    v_pk_mul_f32 v[48:49], v[20:21], v[48:49] op_sel_hi:[0,1]
    v_pk_mul_f32 v[50:51], v[20:21], v[50:51] op_sel_hi:[0,1]
    v_pk_mul_f32 v[52:53], v[20:21], v[52:53] op_sel_hi:[0,1]
    v_pk_mul_f32 v[54:55], v[20:21], v[54:55] op_sel_hi:[0,1]
    v_cvt_pk_bf16_f32 v32, v32, v33
    v_cvt_pk_bf16_f32 v33, v34, v35
    v_cvt_pk_bf16_f32 v34, v36, v37
    v_cvt_pk_bf16_f32 v35, v38, v39
    v_cvt_pk_bf16_f32 v48, v48, v49
    v_cvt_pk_bf16_f32 v49, v50, v51
    v_cvt_pk_bf16_f32 v50, v52, v53
    v_cvt_pk_bf16_f32 v51, v54, v55
    v_permlane32_swap_b32 v32, v34
    v_permlane32_swap_b32 v33, v35
    buffer_store_dwordx4 v[32:35], v2, s[4:7], s52 offen offset:0 sc1
    v_permlane32_swap_b32 v48, v50
    v_permlane32_swap_b32 v49, v51
    buffer_store_dwordx4 v[48:51], v2, s[4:7], s52 offen offset:2048 sc1
    s_lshl_b32 s44, s21, 22
    s_lshl_b32 s45, s39, 16
    s_add_u32 s41, s44, s45
    s_lshl_b32 s45, s20, 12
    s_add_u32 s43, s41, s45
    s_and_b32 s45, s45, 0
    s_add_u32 s41, s41, s45
    s_add_u32 s41, s41, 16777216
    buffer_load_dwordx4 v[224:227], v2, s[4:7], s43 offen offset:0 sc1
    buffer_load_dwordx4 v[228:231], v2, s[4:7], s43 offen offset:256 sc1
    buffer_load_dwordx4 v[232:235], v2, s[4:7], s43 offen offset:2048 sc1
    buffer_load_dwordx4 v[236:239], v2, s[4:7], s43 offen offset:2304 sc1
    s_barrier
    s_lshl_b32 s46, s21, 14
    s_lshl_b32 s67, s38, 8
    s_add_u32 s46, s46, s67
    s_add_u32 s46, s46, 86144
    s_lshl_b32 s47, s21, 14
    s_lshl_b32 s67, s39, 8
    s_add_u32 s47, s47, s67
    s_add_u32 s47, s47, 86144
    s_waitcnt vmcnt(4)
    s_atomic_add s40, s[22:23], s46
    s_mov_b32 s66, 0x10000
c_o_poll:
    s_mov_b32 s68, 0
    s_atomic_add s68, s[22:23], s47 offset:0 glc
    s_sub_u32 s66, s66, 1
    s_cselect_b32 s67, 16, 0
    s_waitcnt lgkmcnt(0)
    s_max_u32 s68, s68, s67
    s_cmp_lt_u32 s68, 16
    s_cbranch_scc1 c_o_poll
c_o_ok:
    s_branch c_wo
a_slow1:
    s_cmp_eq_u32 s46, 0
    s_cbranch_scc1 a_fin1
    s_mov_b32 s46, 0
    v_mfma_f32_16x16x32_bf16 v[172:175], v[68:71], v[132:135], v[120:123]
    v_mfma_f32_16x16x32_bf16 v[168:171], v[64:67], v[132:135], v[124:127]
    v_mfma_f32_16x16x32_bf16 v[188:191], v[84:87], v[148:151], v[120:123]
    v_mfma_f32_16x16x32_bf16 v[184:187], v[80:83], v[148:151], v[124:127]
    s_nop 5
    v_max3_f32 v24, v168, v169, v170
    v_max3_f32 v24, v24, v171, v172
    v_max3_f32 v24, v24, v173, v174
    v_max_f32 v24, v24, v175
    v_max3_f32 v26, v184, v185, v186
    v_max3_f32 v26, v26, v187, v188
    v_max3_f32 v26, v26, v189, v190
    v_max_f32 v26, v26, v191
    v_mov_b32 v25, v24
    v_mov_b32 v27, v26
    s_nop 0
    v_permlane32_swap_b32 v24, v25
    v_permlane32_swap_b32 v26, v27
    v_max_f32 v24, v24, v25
    v_max_f32 v26, v26, v27
    v_mov_b32 v25, v24
    v_mov_b32 v27, v26
    s_nop 0
    v_permlane16_swap_b32 v24, v25
    v_permlane16_swap_b32 v26, v27
    v_max_f32 v24, v24, v25
    v_max_f32 v26, v26, v27
    v_sub_f32 v168, v168, v24
    v_sub_f32 v169, v169, v24
    v_sub_f32 v170, v170, v24
    v_sub_f32 v171, v171, v24
    v_sub_f32 v172, v172, v24
    v_sub_f32 v173, v173, v24
    v_sub_f32 v174, v174, v24
    v_sub_f32 v175, v175, v24
    v_sub_f32 v184, v184, v26
    v_sub_f32 v185, v185, v26
    v_sub_f32 v186, v186, v26
    v_sub_f32 v187, v187, v26
    v_sub_f32 v188, v188, v26
    v_sub_f32 v189, v189, v26
    v_sub_f32 v190, v190, v26
    v_sub_f32 v191, v191, v26
    v_exp_f32 v172, v172
    v_exp_f32 v173, v173
    v_exp_f32 v174, v174
    v_exp_f32 v175, v175
    v_exp_f32 v188, v188
    v_exp_f32 v189, v189
    v_exp_f32 v190, v190
    v_exp_f32 v191, v191
    s_branch a_exp1
a_slow0:
    s_cmp_eq_u32 s46, 0
    s_cbranch_scc1 a_fin0
    s_mov_b32 s46, 0
    v_mfma_f32_16x16x32_bf16 v[164:167], v[64:67], v[128:131], v[120:123]
    v_mfma_f32_16x16x32_bf16 v[160:163], v[192:195], v[128:131], v[124:127]
    v_mfma_f32_16x16x32_bf16 v[180:183], v[80:83], v[144:147], v[120:123]
    v_mfma_f32_16x16x32_bf16 v[176:179], v[196:199], v[144:147], v[124:127]
    s_nop 5
    v_max3_f32 v24, v160, v161, v162
    v_max3_f32 v24, v24, v163, v164
    v_max3_f32 v24, v24, v165, v166
    v_max_f32 v24, v24, v167
    v_max3_f32 v26, v176, v177, v178
    v_max3_f32 v26, v26, v179, v180
    v_max3_f32 v26, v26, v181, v182
    v_max_f32 v26, v26, v183
    v_mov_b32 v25, v24
    v_mov_b32 v27, v26
    s_nop 0
    v_permlane32_swap_b32 v24, v25
    v_permlane32_swap_b32 v26, v27
    v_max_f32 v24, v24, v25
    v_max_f32 v26, v26, v27
    v_mov_b32 v25, v24
    v_mov_b32 v27, v26
    s_nop 0
    v_permlane16_swap_b32 v24, v25
    v_permlane16_swap_b32 v26, v27
    v_max_f32 v24, v24, v25
    v_max_f32 v26, v26, v27
    v_sub_f32 v160, v160, v24
    v_sub_f32 v161, v161, v24
    v_sub_f32 v162, v162, v24
    v_sub_f32 v163, v163, v24
    v_sub_f32 v164, v164, v24
    v_sub_f32 v165, v165, v24
    v_sub_f32 v166, v166, v24
    v_sub_f32 v167, v167, v24
    v_sub_f32 v176, v176, v26
    v_sub_f32 v177, v177, v26
    v_sub_f32 v178, v178, v26
    v_sub_f32 v179, v179, v26
    v_sub_f32 v180, v180, v26
    v_sub_f32 v181, v181, v26
    v_sub_f32 v182, v182, v26
    v_sub_f32 v183, v183, v26
    v_exp_f32 v164, v164
    v_exp_f32 v165, v165
    v_exp_f32 v166, v166
    v_exp_f32 v167, v167
    v_exp_f32 v180, v180
    v_exp_f32 v181, v181
    v_exp_f32 v182, v182
    v_exp_f32 v183, v183
    s_branch a_exp0
c_B:
    s_waitcnt lgkmcnt(6)
    v_pk_fma_f32 v[64:65], v[8:9], v[16:17], v[64:65] op_sel_hi:[0,1,1] neg_lo:[1,0,0] neg_hi:[1,0,0]
    v_pk_fma_f32 v[66:67], v[8:9], v[18:19], v[66:67] op_sel_hi:[0,1,1] neg_lo:[1,0,0] neg_hi:[1,0,0]
    v_pk_fma_f32 v[72:73], v[8:9], v[20:21], v[72:73] op_sel_hi:[0,1,1] neg_lo:[1,0,0] neg_hi:[1,0,0]
    v_pk_fma_f32 v[74:75], v[8:9], v[22:23], v[74:75] op_sel_hi:[0,1,1] neg_lo:[1,0,0] neg_hi:[1,0,0]
    v_pk_mul_f32 v[64:65], v[10:11], v[64:65] op_sel_hi:[0,1]
    v_pk_mul_f32 v[66:67], v[10:11], v[66:67] op_sel_hi:[0,1]
    v_pk_mul_f32 v[72:73], v[10:11], v[72:73] op_sel_hi:[0,1]
    v_pk_mul_f32 v[74:75], v[10:11], v[74:75] op_sel_hi:[0,1]
    v_cvt_pk_bf16_f32 v64, v64, v65
    v_cvt_pk_bf16_f32 v65, v66, v67
    v_cvt_pk_bf16_f32 v66, v72, v73
    v_cvt_pk_bf16_f32 v67, v74, v75
    s_add_u32 s55, s52, 0
    buffer_store_dwordx4 v[64:67], v2, s[4:7], s55 offen offset:0 sc1
    v_pk_fma_f32 v[68:69], v[12:13], v[16:17], v[68:69] op_sel_hi:[0,1,1] neg_lo:[1,0,0] neg_hi:[1,0,0]
    v_pk_fma_f32 v[70:71], v[12:13], v[18:19], v[70:71] op_sel_hi:[0,1,1] neg_lo:[1,0,0] neg_hi:[1,0,0]
    v_pk_fma_f32 v[76:77], v[12:13], v[20:21], v[76:77] op_sel_hi:[0,1,1] neg_lo:[1,0,0] neg_hi:[1,0,0]
    v_pk_fma_f32 v[78:79], v[12:13], v[22:23], v[78:79] op_sel_hi:[0,1,1] neg_lo:[1,0,0] neg_hi:[1,0,0]
    v_pk_mul_f32 v[68:69], v[14:15], v[68:69] op_sel_hi:[0,1]
    v_pk_mul_f32 v[70:71], v[14:15], v[70:71] op_sel_hi:[0,1]
    v_pk_mul_f32 v[76:77], v[14:15], v[76:77] op_sel_hi:[0,1]
    v_pk_mul_f32 v[78:79], v[14:15], v[78:79] op_sel_hi:[0,1]
    v_cvt_pk_bf16_f32 v68, v68, v69
    v_cvt_pk_bf16_f32 v69, v70, v71
    v_cvt_pk_bf16_f32 v70, v76, v77
    v_cvt_pk_bf16_f32 v71, v78, v79
    buffer_store_dwordx4 v[68:71], v2, s[4:7], s55 offen offset:256 sc1
    v_pk_fma_f32 v[80:81], v[8:9], v[24:25], v[80:81] op_sel_hi:[0,1,1] neg_lo:[1,0,0] neg_hi:[1,0,0]
    v_pk_fma_f32 v[82:83], v[8:9], v[26:27], v[82:83] op_sel_hi:[0,1,1] neg_lo:[1,0,0] neg_hi:[1,0,0]
    v_pk_fma_f32 v[88:89], v[8:9], v[28:29], v[88:89] op_sel_hi:[0,1,1] neg_lo:[1,0,0] neg_hi:[1,0,0]
    v_pk_fma_f32 v[90:91], v[8:9], v[30:31], v[90:91] op_sel_hi:[0,1,1] neg_lo:[1,0,0] neg_hi:[1,0,0]
    v_pk_mul_f32 v[80:81], v[10:11], v[80:81] op_sel_hi:[0,1]
    v_pk_mul_f32 v[82:83], v[10:11], v[82:83] op_sel_hi:[0,1]
    v_pk_mul_f32 v[88:89], v[10:11], v[88:89] op_sel_hi:[0,1]
    v_pk_mul_f32 v[90:91], v[10:11], v[90:91] op_sel_hi:[0,1]
    v_cvt_pk_bf16_f32 v80, v80, v81
    v_cvt_pk_bf16_f32 v81, v82, v83
    v_cvt_pk_bf16_f32 v82, v88, v89
    v_cvt_pk_bf16_f32 v83, v90, v91
    s_add_u32 s55, s52, 131072
    buffer_store_dwordx4 v[80:83], v2, s[4:7], s55 offen offset:0 sc1
    v_pk_fma_f32 v[84:85], v[12:13], v[24:25], v[84:85] op_sel_hi:[0,1,1] neg_lo:[1,0,0] neg_hi:[1,0,0]
    v_pk_fma_f32 v[86:87], v[12:13], v[26:27], v[86:87] op_sel_hi:[0,1,1] neg_lo:[1,0,0] neg_hi:[1,0,0]
    v_pk_fma_f32 v[92:93], v[12:13], v[28:29], v[92:93] op_sel_hi:[0,1,1] neg_lo:[1,0,0] neg_hi:[1,0,0]
    v_pk_fma_f32 v[94:95], v[12:13], v[30:31], v[94:95] op_sel_hi:[0,1,1] neg_lo:[1,0,0] neg_hi:[1,0,0]
    v_pk_mul_f32 v[84:85], v[14:15], v[84:85] op_sel_hi:[0,1]
    v_pk_mul_f32 v[86:87], v[14:15], v[86:87] op_sel_hi:[0,1]
    v_pk_mul_f32 v[92:93], v[14:15], v[92:93] op_sel_hi:[0,1]
    v_pk_mul_f32 v[94:95], v[14:15], v[94:95] op_sel_hi:[0,1]
    v_cvt_pk_bf16_f32 v84, v84, v85
    v_cvt_pk_bf16_f32 v85, v86, v87
    v_cvt_pk_bf16_f32 v86, v92, v93
    v_cvt_pk_bf16_f32 v87, v94, v95
    buffer_store_dwordx4 v[84:87], v2, s[4:7], s55 offen offset:256 sc1
    v_mfma_f32_16x16x32_bf16 v[96:99], v[160:163], v[32:35], v[96:99]
    ds_read_b64_tr_b16 v[60:61], v6 offset:53248
    v_mfma_f32_16x16x32_bf16 v[100:103], v[164:167], v[32:35], v[100:103]
    ds_read_b64_tr_b16 v[62:63], v6 offset:54272
    v_mfma_f32_16x16x32_bf16 v[104:107], v[160:163], v[36:39], v[104:107]
    ds_read_b64_tr_b16 v[32:33], v3 offset:57344
    v_mfma_f32_16x16x32_bf16 v[108:111], v[164:167], v[36:39], v[108:111]
    ds_read_b64_tr_b16 v[34:35], v3 offset:58368
    v_mfma_f32_16x16x32_bf16 v[112:115], v[160:163], v[40:43], v[112:115]
    ds_read_b64_tr_b16 v[36:37], v4 offset:57344
    v_mfma_f32_16x16x32_bf16 v[116:119], v[164:167], v[40:43], v[116:119]
    ds_read_b64_tr_b16 v[38:39], v4 offset:58368
    v_mfma_f32_16x16x32_bf16 v[120:123], v[160:163], v[44:47], v[120:123]
    ds_read_b64_tr_b16 v[40:41], v5 offset:57344
    v_mfma_f32_16x16x32_bf16 v[124:127], v[164:167], v[44:47], v[124:127]
    ds_read_b64_tr_b16 v[42:43], v5 offset:58368
    s_waitcnt lgkmcnt(10)
    v_mfma_f32_16x16x32_bf16 v[96:99], v[168:171], v[48:51], v[96:99]
    ds_read_b64_tr_b16 v[44:45], v6 offset:57344
    v_mfma_f32_16x16x32_bf16 v[100:103], v[172:175], v[48:51], v[100:103]
    ds_read_b64_tr_b16 v[46:47], v6 offset:58368
    v_mfma_f32_16x16x32_bf16 v[104:107], v[168:171], v[52:55], v[104:107]
    ds_read_b64_tr_b16 v[48:49], v3 offset:61440
    v_mfma_f32_16x16x32_bf16 v[108:111], v[172:175], v[52:55], v[108:111]
    ds_read_b64_tr_b16 v[50:51], v3 offset:62464
    s_waitcnt lgkmcnt(10)
    v_mfma_f32_16x16x32_bf16 v[112:115], v[168:171], v[56:59], v[112:115]
    ds_read_b64_tr_b16 v[52:53], v4 offset:61440
    v_mfma_f32_16x16x32_bf16 v[116:119], v[172:175], v[56:59], v[116:119]
    ds_read_b64_tr_b16 v[54:55], v4 offset:62464
    v_mfma_f32_16x16x32_bf16 v[120:123], v[168:171], v[60:63], v[120:123]
    ds_read_b64_tr_b16 v[56:57], v5 offset:61440
    v_mfma_f32_16x16x32_bf16 v[124:127], v[172:175], v[60:63], v[124:127]
    ds_read_b64_tr_b16 v[58:59], v5 offset:62464
    s_waitcnt lgkmcnt(10)
    v_mfma_f32_16x16x32_bf16 v[96:99], v[176:179], v[32:35], v[96:99]
    ds_read_b64_tr_b16 v[60:61], v6 offset:61440
    v_mfma_f32_16x16x32_bf16 v[100:103], v[180:183], v[32:35], v[100:103]
    ds_read_b64_tr_b16 v[62:63], v6 offset:62464
    s_barrier
    v_xor_b32 v3, 0x10000, v3
    v_xor_b32 v4, 0x10000, v4
    v_xor_b32 v5, 0x10000, v5
    v_xor_b32 v6, 0x10000, v6
    v_mfma_f32_16x16x32_bf16 v[104:107], v[176:179], v[36:39], v[104:107]
    ds_read_b64_tr_b16 v[32:33], v3 offset:0
    v_mfma_f32_16x16x32_bf16 v[108:111], v[180:183], v[36:39], v[108:111]
    ds_read_b64_tr_b16 v[34:35], v3 offset:1024
    s_waitcnt lgkmcnt(10)
    v_mfma_f32_16x16x32_bf16 v[112:115], v[176:179], v[40:43], v[112:115]
    ds_read_b64_tr_b16 v[36:37], v4 offset:0
    v_mfma_f32_16x16x32_bf16 v[116:119], v[180:183], v[40:43], v[116:119]
    ds_read_b64_tr_b16 v[38:39], v4 offset:1024
    v_mfma_f32_16x16x32_bf16 v[120:123], v[176:179], v[44:47], v[120:123]
    ds_read_b64_tr_b16 v[40:41], v5 offset:0
    v_mfma_f32_16x16x32_bf16 v[124:127], v[180:183], v[44:47], v[124:127]
    ds_read_b64_tr_b16 v[42:43], v5 offset:1024
    s_waitcnt lgkmcnt(10)
    v_mfma_f32_16x16x32_bf16 v[96:99], v[184:187], v[48:51], v[96:99]
    ds_read_b64_tr_b16 v[44:45], v6 offset:0
    v_mfma_f32_16x16x32_bf16 v[100:103], v[188:191], v[48:51], v[100:103]
    ds_read_b64_tr_b16 v[46:47], v6 offset:1024
    v_mfma_f32_16x16x32_bf16 v[104:107], v[184:187], v[52:55], v[104:107]
    ds_read_b64_tr_b16 v[48:49], v3 offset:4096
    v_mfma_f32_16x16x32_bf16 v[108:111], v[188:191], v[52:55], v[108:111]
    ds_read_b64_tr_b16 v[50:51], v3 offset:5120
    s_waitcnt lgkmcnt(10)
    v_mfma_f32_16x16x32_bf16 v[112:115], v[184:187], v[56:59], v[112:115]
    ds_read_b64_tr_b16 v[52:53], v4 offset:4096
    v_mfma_f32_16x16x32_bf16 v[116:119], v[188:191], v[56:59], v[116:119]
    ds_read_b64_tr_b16 v[54:55], v4 offset:5120
    v_mfma_f32_16x16x32_bf16 v[120:123], v[184:187], v[60:63], v[120:123]
    ds_read_b64_tr_b16 v[56:57], v5 offset:4096
    v_mfma_f32_16x16x32_bf16 v[124:127], v[188:191], v[60:63], v[124:127]
    ds_read_b64_tr_b16 v[58:59], v5 offset:5120
    s_waitcnt lgkmcnt(10)
    v_mfma_f32_16x16x32_bf16 v[96:99], v[192:195], v[32:35], v[96:99]
    ds_read_b64_tr_b16 v[60:61], v6 offset:4096
    v_mfma_f32_16x16x32_bf16 v[100:103], v[196:199], v[32:35], v[100:103]
    ds_read_b64_tr_b16 v[62:63], v6 offset:5120
    v_mfma_f32_16x16x32_bf16 v[104:107], v[192:195], v[36:39], v[104:107]
    ds_read_b64_tr_b16 v[32:33], v3 offset:8192
    v_mfma_f32_16x16x32_bf16 v[108:111], v[196:199], v[36:39], v[108:111]
    ds_read_b64_tr_b16 v[34:35], v3 offset:9216
    s_waitcnt lgkmcnt(10)
    v_mfma_f32_16x16x32_bf16 v[112:115], v[192:195], v[40:43], v[112:115]
    ds_read_b64_tr_b16 v[36:37], v4 offset:8192
    v_mfma_f32_16x16x32_bf16 v[116:119], v[196:199], v[40:43], v[116:119]
    ds_read_b64_tr_b16 v[38:39], v4 offset:9216
    v_mfma_f32_16x16x32_bf16 v[120:123], v[192:195], v[44:47], v[120:123]
    ds_read_b64_tr_b16 v[40:41], v5 offset:8192
    v_mfma_f32_16x16x32_bf16 v[124:127], v[196:199], v[44:47], v[124:127]
    ds_read_b64_tr_b16 v[42:43], v5 offset:9216
    s_waitcnt lgkmcnt(10)
    v_mfma_f32_16x16x32_bf16 v[96:99], v[200:203], v[48:51], v[96:99]
    ds_read_b64_tr_b16 v[44:45], v6 offset:8192
    v_mfma_f32_16x16x32_bf16 v[100:103], v[204:207], v[48:51], v[100:103]
    ds_read_b64_tr_b16 v[46:47], v6 offset:9216
    v_mfma_f32_16x16x32_bf16 v[104:107], v[200:203], v[52:55], v[104:107]
    ds_read_b64_tr_b16 v[48:49], v3 offset:12288
    v_mfma_f32_16x16x32_bf16 v[108:111], v[204:207], v[52:55], v[108:111]
    ds_read_b64_tr_b16 v[50:51], v3 offset:13312
    s_waitcnt lgkmcnt(10)
    v_mfma_f32_16x16x32_bf16 v[112:115], v[200:203], v[56:59], v[112:115]
    ds_read_b64_tr_b16 v[52:53], v4 offset:12288
    v_mfma_f32_16x16x32_bf16 v[116:119], v[204:207], v[56:59], v[116:119]
    ds_read_b64_tr_b16 v[54:55], v4 offset:13312
    v_mfma_f32_16x16x32_bf16 v[120:123], v[200:203], v[60:63], v[120:123]
    ds_read_b64_tr_b16 v[56:57], v5 offset:12288
    v_mfma_f32_16x16x32_bf16 v[124:127], v[204:207], v[60:63], v[124:127]
    ds_read_b64_tr_b16 v[58:59], v5 offset:13312
    s_waitcnt lgkmcnt(10)
    v_mfma_f32_16x16x32_bf16 v[96:99], v[208:211], v[32:35], v[96:99]
    ds_read_b64_tr_b16 v[60:61], v6 offset:12288
    v_mfma_f32_16x16x32_bf16 v[100:103], v[212:215], v[32:35], v[100:103]
    ds_read_b64_tr_b16 v[62:63], v6 offset:13312
    v_mfma_f32_16x16x32_bf16 v[104:107], v[208:211], v[36:39], v[104:107]
    ds_read_b64_tr_b16 v[32:33], v3 offset:16384
    ds_read_b128 v[16:19], v13 offset:4096
    v_mfma_f32_16x16x32_bf16 v[108:111], v[212:215], v[36:39], v[108:111]
    ds_read_b64_tr_b16 v[34:35], v3 offset:17408
    ds_read_b128 v[20:23], v13 offset:4608
    s_waitcnt lgkmcnt(12)
    v_mfma_f32_16x16x32_bf16 v[112:115], v[208:211], v[40:43], v[112:115]
    ds_read_b64_tr_b16 v[36:37], v4 offset:16384
    ds_read_b128 v[24:27], v13 offset:4160
    v_mfma_f32_16x16x32_bf16 v[116:119], v[212:215], v[40:43], v[116:119]
    ds_read_b64_tr_b16 v[38:39], v4 offset:17408
    ds_read_b128 v[28:31], v13 offset:4672
    v_mfma_f32_16x16x32_bf16 v[120:123], v[208:211], v[44:47], v[120:123]
    ds_read_b64_tr_b16 v[40:41], v5 offset:16384
    ds_read_b32 v8, v15 offset:512
    v_mfma_f32_16x16x32_bf16 v[124:127], v[212:215], v[44:47], v[124:127]
    ds_read_b64_tr_b16 v[42:43], v5 offset:17408
    ds_read_b32 v10, v15 offset:576
    s_waitcnt lgkmcnt(14)
    v_mfma_f32_16x16x32_bf16 v[96:99], v[216:219], v[48:51], v[96:99]
    ds_read_b64_tr_b16 v[44:45], v6 offset:16384
    ds_read_b32 v12, v15 offset:640
    v_mfma_f32_16x16x32_bf16 v[100:103], v[220:223], v[48:51], v[100:103]
    ds_read_b64_tr_b16 v[46:47], v6 offset:17408
    ds_read_b32 v14, v15 offset:704
    v_mfma_f32_16x16x32_bf16 v[104:107], v[216:219], v[52:55], v[104:107]
    ds_read_b64_tr_b16 v[48:49], v3 offset:20480
    v_mfma_f32_16x16x32_bf16 v[108:111], v[220:223], v[52:55], v[108:111]
    ds_read_b64_tr_b16 v[50:51], v3 offset:21504
    s_waitcnt lgkmcnt(14)
    v_mfma_f32_16x16x32_bf16 v[112:115], v[216:219], v[56:59], v[112:115]
    ds_read_b64_tr_b16 v[52:53], v4 offset:20480
    v_mfma_f32_16x16x32_bf16 v[116:119], v[220:223], v[56:59], v[116:119]
    ds_read_b64_tr_b16 v[54:55], v4 offset:21504
    v_mfma_f32_16x16x32_bf16 v[120:123], v[216:219], v[60:63], v[120:123]
    ds_read_b64_tr_b16 v[56:57], v5 offset:20480
    v_mfma_f32_16x16x32_bf16 v[124:127], v[220:223], v[60:63], v[124:127]
    ds_read_b64_tr_b16 v[58:59], v5 offset:21504
    s_waitcnt lgkmcnt(6)
    v_pk_fma_f32 v[96:97], v[8:9], v[16:17], v[96:97] op_sel_hi:[0,1,1] neg_lo:[1,0,0] neg_hi:[1,0,0]
    v_pk_fma_f32 v[98:99], v[8:9], v[18:19], v[98:99] op_sel_hi:[0,1,1] neg_lo:[1,0,0] neg_hi:[1,0,0]
    v_pk_fma_f32 v[104:105], v[10:11], v[16:17], v[104:105] op_sel_hi:[0,1,1] neg_lo:[1,0,0] neg_hi:[1,0,0]
    v_pk_fma_f32 v[106:107], v[10:11], v[18:19], v[106:107] op_sel_hi:[0,1,1] neg_lo:[1,0,0] neg_hi:[1,0,0]
    v_pk_mul_f32 v[96:97], v[20:21], v[96:97]
    v_pk_mul_f32 v[98:99], v[22:23], v[98:99]
    v_pk_mul_f32 v[104:105], v[20:21], v[104:105]
    v_pk_mul_f32 v[106:107], v[22:23], v[106:107]
    v_cvt_pk_bf16_f32 v72, v96, v97
    v_cvt_pk_bf16_f32 v73, v98, v99
    v_cvt_pk_bf16_f32 v74, v104, v105
    v_cvt_pk_bf16_f32 v75, v106, v107
    s_add_u32 s56, s52, 4194304
    v_permlane16_swap_b32 v72, v74
    v_permlane16_swap_b32 v73, v75
    buffer_store_dwordx4 v[72:75], v1, s[4:7], s56 offen offset:0 sc1
    v_pk_fma_f32 v[112:113], v[12:13], v[16:17], v[112:113] op_sel_hi:[0,1,1] neg_lo:[1,0,0] neg_hi:[1,0,0]
    v_pk_fma_f32 v[114:115], v[12:13], v[18:19], v[114:115] op_sel_hi:[0,1,1] neg_lo:[1,0,0] neg_hi:[1,0,0]
    v_pk_fma_f32 v[120:121], v[14:15], v[16:17], v[120:121] op_sel_hi:[0,1,1] neg_lo:[1,0,0] neg_hi:[1,0,0]
    v_pk_fma_f32 v[122:123], v[14:15], v[18:19], v[122:123] op_sel_hi:[0,1,1] neg_lo:[1,0,0] neg_hi:[1,0,0]
    v_pk_mul_f32 v[112:113], v[20:21], v[112:113]
    v_pk_mul_f32 v[114:115], v[22:23], v[114:115]
    v_pk_mul_f32 v[120:121], v[20:21], v[120:121]
    v_pk_mul_f32 v[122:123], v[22:23], v[122:123]
    v_cvt_pk_bf16_f32 v88, v112, v113
    v_cvt_pk_bf16_f32 v89, v114, v115
    v_cvt_pk_bf16_f32 v90, v120, v121
    v_cvt_pk_bf16_f32 v91, v122, v123
    s_add_u32 s56, s52, 4325376
    v_permlane16_swap_b32 v88, v90
    v_permlane16_swap_b32 v89, v91
    buffer_store_dwordx4 v[88:91], v1, s[4:7], s56 offen offset:0 sc1
    v_pk_fma_f32 v[100:101], v[8:9], v[24:25], v[100:101] op_sel_hi:[0,1,1] neg_lo:[1,0,0] neg_hi:[1,0,0]
    v_pk_fma_f32 v[102:103], v[8:9], v[26:27], v[102:103] op_sel_hi:[0,1,1] neg_lo:[1,0,0] neg_hi:[1,0,0]
    v_pk_fma_f32 v[108:109], v[10:11], v[24:25], v[108:109] op_sel_hi:[0,1,1] neg_lo:[1,0,0] neg_hi:[1,0,0]
    v_pk_fma_f32 v[110:111], v[10:11], v[26:27], v[110:111] op_sel_hi:[0,1,1] neg_lo:[1,0,0] neg_hi:[1,0,0]
    v_pk_mul_f32 v[100:101], v[28:29], v[100:101]
    v_pk_mul_f32 v[102:103], v[30:31], v[102:103]
    v_pk_mul_f32 v[108:109], v[28:29], v[108:109]
    v_pk_mul_f32 v[110:111], v[30:31], v[110:111]
    v_cvt_pk_bf16_f32 v76, v100, v101
    v_cvt_pk_bf16_f32 v77, v102, v103
    v_cvt_pk_bf16_f32 v78, v108, v109
    v_cvt_pk_bf16_f32 v79, v110, v111
    s_add_u32 s56, s52, 4194304
    v_permlane16_swap_b32 v76, v78
    v_permlane16_swap_b32 v77, v79
    buffer_store_dwordx4 v[76:79], v1, s[4:7], s56 offen offset:1024 sc1
    v_pk_fma_f32 v[116:117], v[12:13], v[24:25], v[116:117] op_sel_hi:[0,1,1] neg_lo:[1,0,0] neg_hi:[1,0,0]
    v_pk_fma_f32 v[118:119], v[12:13], v[26:27], v[118:119] op_sel_hi:[0,1,1] neg_lo:[1,0,0] neg_hi:[1,0,0]
    v_pk_fma_f32 v[124:125], v[14:15], v[24:25], v[124:125] op_sel_hi:[0,1,1] neg_lo:[1,0,0] neg_hi:[1,0,0]
    v_pk_fma_f32 v[126:127], v[14:15], v[26:27], v[126:127] op_sel_hi:[0,1,1] neg_lo:[1,0,0] neg_hi:[1,0,0]
    v_pk_mul_f32 v[116:117], v[28:29], v[116:117]
    v_pk_mul_f32 v[118:119], v[30:31], v[118:119]
    v_pk_mul_f32 v[124:125], v[28:29], v[124:125]
    v_pk_mul_f32 v[126:127], v[30:31], v[126:127]
    v_cvt_pk_bf16_f32 v92, v116, v117
    v_cvt_pk_bf16_f32 v93, v118, v119
    v_cvt_pk_bf16_f32 v94, v124, v125
    v_cvt_pk_bf16_f32 v95, v126, v127
    s_add_u32 s56, s52, 4325376
    v_permlane16_swap_b32 v92, v94
    v_permlane16_swap_b32 v93, v95
    buffer_store_dwordx4 v[92:95], v1, s[4:7], s56 offen offset:1024 sc1
    v_mfma_f32_16x16x32_bf16 v[128:131], v[32:35], v[224:227], v[128:131]
    ds_read_b64_tr_b16 v[60:61], v6 offset:20480
    v_mfma_f32_16x16x32_bf16 v[132:135], v[32:35], v[228:231], v[132:135]
    ds_read_b64_tr_b16 v[62:63], v6 offset:21504
    v_mfma_f32_16x16x32_bf16 v[136:139], v[36:39], v[224:227], v[136:139]
    ds_read_b64_tr_b16 v[32:33], v3 offset:24576
    v_mfma_f32_16x16x32_bf16 v[140:143], v[36:39], v[228:231], v[140:143]
    ds_read_b64_tr_b16 v[34:35], v3 offset:25600
    v_mfma_f32_16x16x32_bf16 v[144:147], v[40:43], v[224:227], v[144:147]
    ds_read_b64_tr_b16 v[36:37], v4 offset:24576
    v_mfma_f32_16x16x32_bf16 v[148:151], v[40:43], v[228:231], v[148:151]
    ds_read_b64_tr_b16 v[38:39], v4 offset:25600
    v_mfma_f32_16x16x32_bf16 v[152:155], v[44:47], v[224:227], v[152:155]
    ds_read_b64_tr_b16 v[40:41], v5 offset:24576
    v_mfma_f32_16x16x32_bf16 v[156:159], v[44:47], v[228:231], v[156:159]
    ds_read_b64_tr_b16 v[42:43], v5 offset:25600
    s_waitcnt lgkmcnt(10)
    v_mfma_f32_16x16x32_bf16 v[128:131], v[48:51], v[232:235], v[128:131]
    ds_read_b64_tr_b16 v[44:45], v6 offset:24576
    v_mfma_f32_16x16x32_bf16 v[132:135], v[48:51], v[236:239], v[132:135]
    ds_read_b64_tr_b16 v[46:47], v6 offset:25600
    v_mfma_f32_16x16x32_bf16 v[136:139], v[52:55], v[232:235], v[136:139]
    ds_read_b64_tr_b16 v[48:49], v3 offset:28672
    v_mfma_f32_16x16x32_bf16 v[140:143], v[52:55], v[236:239], v[140:143]
    ds_read_b64_tr_b16 v[50:51], v3 offset:29696
    s_waitcnt lgkmcnt(10)
    v_mfma_f32_16x16x32_bf16 v[144:147], v[56:59], v[232:235], v[144:147]
    ds_read_b64_tr_b16 v[52:53], v4 offset:28672
    v_mfma_f32_16x16x32_bf16 v[148:151], v[56:59], v[236:239], v[148:151]
    ds_read_b64_tr_b16 v[54:55], v4 offset:29696
    v_mfma_f32_16x16x32_bf16 v[152:155], v[60:63], v[232:235], v[152:155]
    ds_read_b64_tr_b16 v[56:57], v5 offset:28672
    v_mfma_f32_16x16x32_bf16 v[156:159], v[60:63], v[236:239], v[156:159]
    ds_read_b64_tr_b16 v[58:59], v5 offset:29696
    s_waitcnt lgkmcnt(10)
    v_mfma_f32_16x16x32_bf16 v[128:131], v[32:35], v[240:243], v[128:131]
    ds_read_b64_tr_b16 v[60:61], v6 offset:28672
    v_mfma_f32_16x16x32_bf16 v[132:135], v[32:35], v[244:247], v[132:135]
    ds_read_b64_tr_b16 v[62:63], v6 offset:29696
    s_barrier
    v_mfma_f32_16x16x32_bf16 v[136:139], v[36:39], v[240:243], v[136:139]
    ds_read_b64_tr_b16 v[32:33], v3 offset:32768
    v_mfma_f32_16x16x32_bf16 v[140:143], v[36:39], v[244:247], v[140:143]
    ds_read_b64_tr_b16 v[34:35], v3 offset:33792
    s_waitcnt lgkmcnt(10)
    v_mfma_f32_16x16x32_bf16 v[144:147], v[40:43], v[240:243], v[144:147]
    ds_read_b64_tr_b16 v[36:37], v4 offset:32768
    v_mfma_f32_16x16x32_bf16 v[148:151], v[40:43], v[244:247], v[148:151]
    ds_read_b64_tr_b16 v[38:39], v4 offset:33792
    v_mfma_f32_16x16x32_bf16 v[152:155], v[44:47], v[240:243], v[152:155]
    ds_read_b64_tr_b16 v[40:41], v5 offset:32768
    v_mfma_f32_16x16x32_bf16 v[156:159], v[44:47], v[244:247], v[156:159]
    ds_read_b64_tr_b16 v[42:43], v5 offset:33792
    s_waitcnt lgkmcnt(10)
    v_mfma_f32_16x16x32_bf16 v[128:131], v[48:51], v[248:251], v[128:131]
    ds_read_b64_tr_b16 v[44:45], v6 offset:32768
    v_mfma_f32_16x16x32_bf16 v[132:135], v[48:51], v[252:255], v[132:135]
    ds_read_b64_tr_b16 v[46:47], v6 offset:33792
    v_mfma_f32_16x16x32_bf16 v[136:139], v[52:55], v[248:251], v[136:139]
    ds_read_b64_tr_b16 v[48:49], v3 offset:36864
    v_mfma_f32_16x16x32_bf16 v[140:143], v[52:55], v[252:255], v[140:143]
    ds_read_b64_tr_b16 v[50:51], v3 offset:37888
    s_waitcnt lgkmcnt(10)
    v_mfma_f32_16x16x32_bf16 v[144:147], v[56:59], v[248:251], v[144:147]
    ds_read_b64_tr_b16 v[52:53], v4 offset:36864
    v_mfma_f32_16x16x32_bf16 v[148:151], v[56:59], v[252:255], v[148:151]
    ds_read_b64_tr_b16 v[54:55], v4 offset:37888
    v_mfma_f32_16x16x32_bf16 v[152:155], v[60:63], v[248:251], v[152:155]
    ds_read_b64_tr_b16 v[56:57], v5 offset:36864
    v_mfma_f32_16x16x32_bf16 v[156:159], v[60:63], v[252:255], v[156:159]
    ds_read_b64_tr_b16 v[58:59], v5 offset:37888
    s_waitcnt lgkmcnt(10)
    v_mfma_f32_16x16x32_bf16 v[128:131], v[32:35], v[160:163], v[128:131]
    ds_read_b64_tr_b16 v[60:61], v6 offset:36864
    v_mfma_f32_16x16x32_bf16 v[132:135], v[32:35], v[164:167], v[132:135]
    ds_read_b64_tr_b16 v[62:63], v6 offset:37888
    v_mfma_f32_16x16x32_bf16 v[136:139], v[36:39], v[160:163], v[136:139]
    ds_read_b64_tr_b16 v[32:33], v3 offset:40960
    v_mfma_f32_16x16x32_bf16 v[140:143], v[36:39], v[164:167], v[140:143]
    ds_read_b64_tr_b16 v[34:35], v3 offset:41984
    s_waitcnt lgkmcnt(10)
    v_mfma_f32_16x16x32_bf16 v[144:147], v[40:43], v[160:163], v[144:147]
    ds_read_b64_tr_b16 v[36:37], v4 offset:40960
    v_mfma_f32_16x16x32_bf16 v[148:151], v[40:43], v[164:167], v[148:151]
    ds_read_b64_tr_b16 v[38:39], v4 offset:41984
    v_mfma_f32_16x16x32_bf16 v[152:155], v[44:47], v[160:163], v[152:155]
    ds_read_b64_tr_b16 v[40:41], v5 offset:40960
    v_mfma_f32_16x16x32_bf16 v[156:159], v[44:47], v[164:167], v[156:159]
    ds_read_b64_tr_b16 v[42:43], v5 offset:41984
    s_waitcnt lgkmcnt(10)
    v_mfma_f32_16x16x32_bf16 v[128:131], v[48:51], v[168:171], v[128:131]
    ds_read_b64_tr_b16 v[44:45], v6 offset:40960
    v_mfma_f32_16x16x32_bf16 v[132:135], v[48:51], v[172:175], v[132:135]
    ds_read_b64_tr_b16 v[46:47], v6 offset:41984
    v_mfma_f32_16x16x32_bf16 v[136:139], v[52:55], v[168:171], v[136:139]
    ds_read_b64_tr_b16 v[48:49], v3 offset:45056
    v_mfma_f32_16x16x32_bf16 v[140:143], v[52:55], v[172:175], v[140:143]
    ds_read_b64_tr_b16 v[50:51], v3 offset:46080
    s_waitcnt lgkmcnt(10)
    v_mfma_f32_16x16x32_bf16 v[144:147], v[56:59], v[168:171], v[144:147]
    ds_read_b64_tr_b16 v[52:53], v4 offset:45056
    v_mfma_f32_16x16x32_bf16 v[148:151], v[56:59], v[172:175], v[148:151]
    ds_read_b64_tr_b16 v[54:55], v4 offset:46080
    v_mfma_f32_16x16x32_bf16 v[152:155], v[60:63], v[168:171], v[152:155]
    ds_read_b64_tr_b16 v[56:57], v5 offset:45056
    v_mfma_f32_16x16x32_bf16 v[156:159], v[60:63], v[172:175], v[156:159]
    ds_read_b64_tr_b16 v[58:59], v5 offset:46080
    s_waitcnt lgkmcnt(10)
    v_mfma_f32_16x16x32_bf16 v[128:131], v[32:35], v[176:179], v[128:131]
    ds_read_b64_tr_b16 v[60:61], v6 offset:45056
    v_mfma_f32_16x16x32_bf16 v[132:135], v[32:35], v[180:183], v[132:135]
    ds_read_b64_tr_b16 v[62:63], v6 offset:46080
    v_mfma_f32_16x16x32_bf16 v[136:139], v[36:39], v[176:179], v[136:139]
    ds_read_b64_tr_b16 v[32:33], v3 offset:49152
    v_mfma_f32_16x16x32_bf16 v[140:143], v[36:39], v[180:183], v[140:143]
    ds_read_b64_tr_b16 v[34:35], v3 offset:50176
    s_waitcnt lgkmcnt(10)
    v_mfma_f32_16x16x32_bf16 v[144:147], v[40:43], v[176:179], v[144:147]
    ds_read_b64_tr_b16 v[36:37], v4 offset:49152
    v_mfma_f32_16x16x32_bf16 v[148:151], v[40:43], v[180:183], v[148:151]
    ds_read_b64_tr_b16 v[38:39], v4 offset:50176
    v_mfma_f32_16x16x32_bf16 v[152:155], v[44:47], v[176:179], v[152:155]
    ds_read_b64_tr_b16 v[40:41], v5 offset:49152
    v_mfma_f32_16x16x32_bf16 v[156:159], v[44:47], v[180:183], v[156:159]
    ds_read_b64_tr_b16 v[42:43], v5 offset:50176
    s_waitcnt lgkmcnt(10)
    v_mfma_f32_16x16x32_bf16 v[128:131], v[48:51], v[184:187], v[128:131]
    ds_read_b64_tr_b16 v[44:45], v6 offset:49152
    s_waitcnt vmcnt(0)
    s_atomic_add s40, s[22:23], s59
    s_mov_b32 s68, 0
    s_atomic_add s68, s[22:23], s59 glc
    s_mov_b32 s55, s52
    s_add_u32 s56, s52, 4194304
    ds_read_b32 v8, v9 offset:4096
    v_mfma_f32_16x16x32_bf16 v[132:135], v[48:51], v[188:191], v[132:135]
    ds_read_b64_tr_b16 v[46:47], v6 offset:50176
    buffer_load_dwordx4 v[64:67], v1, s[4:7], s55 offen offset:0 sc1
    ds_read_b32 v10, v9 offset:4608
    v_mfma_f32_16x16x32_bf16 v[136:139], v[52:55], v[184:187], v[136:139]
    ds_read_b64_tr_b16 v[48:49], v3 offset:53248
    buffer_load_dwordx4 v[68:71], v1, s[4:7], s55 offen offset:1024 sc1
    ds_read_b32 v12, v9 offset:4160
    v_mfma_f32_16x16x32_bf16 v[140:143], v[52:55], v[188:191], v[140:143]
    ds_read_b64_tr_b16 v[50:51], v3 offset:54272
    buffer_load_dwordx4 v[72:75], v1, s[4:7], s56 offen offset:0 sc1
    ds_read_b32 v14, v9 offset:4672
    s_waitcnt lgkmcnt(14)
    v_mfma_f32_16x16x32_bf16 v[144:147], v[56:59], v[184:187], v[144:147]
    ds_read_b64_tr_b16 v[52:53], v4 offset:53248
    buffer_load_dwordx4 v[76:79], v1, s[4:7], s56 offen offset:1024 sc1
    ds_read_b128 v[16:19], v11 offset:0
    v_mfma_f32_16x16x32_bf16 v[148:151], v[56:59], v[188:191], v[148:151]
    ds_read_b64_tr_b16 v[54:55], v4 offset:54272
    ds_read_b128 v[20:23], v11 offset:64
    v_mfma_f32_16x16x32_bf16 v[152:155], v[60:63], v[184:187], v[152:155]
    ds_read_b64_tr_b16 v[56:57], v5 offset:53248
    ds_read_b128 v[24:27], v11 offset:128
    v_mfma_f32_16x16x32_bf16 v[156:159], v[60:63], v[188:191], v[156:159]
    ds_read_b64_tr_b16 v[58:59], v5 offset:54272
    ds_read_b128 v[28:31], v11 offset:192
    s_waitcnt lgkmcnt(14)
    v_mfma_f32_16x16x32_bf16 v[128:131], v[32:35], v[192:195], v[128:131]
    ds_read_b64_tr_b16 v[60:61], v6 offset:53248
    v_mfma_f32_16x16x32_bf16 v[132:135], v[32:35], v[196:199], v[132:135]
    ds_read_b64_tr_b16 v[62:63], v6 offset:54272
    v_mfma_f32_16x16x32_bf16 v[136:139], v[36:39], v[192:195], v[136:139]
    ds_read_b64_tr_b16 v[32:33], v3 offset:57344
    v_mfma_f32_16x16x32_bf16 v[140:143], v[36:39], v[196:199], v[140:143]
    ds_read_b64_tr_b16 v[34:35], v3 offset:58368
    s_waitcnt lgkmcnt(14)
    v_mfma_f32_16x16x32_bf16 v[144:147], v[40:43], v[192:195], v[144:147]
    ds_read_b64_tr_b16 v[36:37], v4 offset:57344
    v_mfma_f32_16x16x32_bf16 v[148:151], v[40:43], v[196:199], v[148:151]
    ds_read_b64_tr_b16 v[38:39], v4 offset:58368
    v_mfma_f32_16x16x32_bf16 v[152:155], v[44:47], v[192:195], v[152:155]
    ds_read_b64_tr_b16 v[40:41], v5 offset:57344
    v_mfma_f32_16x16x32_bf16 v[156:159], v[44:47], v[196:199], v[156:159]
    ds_read_b64_tr_b16 v[42:43], v5 offset:58368
    s_waitcnt lgkmcnt(13)
    v_mfma_f32_16x16x32_bf16 v[128:131], v[48:51], v[200:203], v[128:131]
    ds_read_b64_tr_b16 v[44:45], v6 offset:57344
    s_waitcnt lgkmcnt(9)
    v_mfma_f32_16x16x32_bf16 v[132:135], v[48:51], v[204:207], v[132:135]
    ds_read_b64_tr_b16 v[46:47], v6 offset:58368
    v_mul_f32 v10, 0x3e8293ee, v10
    v_mfma_f32_16x16x32_bf16 v[136:139], v[52:55], v[200:203], v[136:139]
    ds_read_b64_tr_b16 v[48:49], v3 offset:61440
    v_mul_f32 v14, 0x3e8293ee, v14
    v_mfma_f32_16x16x32_bf16 v[140:143], v[52:55], v[204:207], v[140:143]
    ds_read_b64_tr_b16 v[50:51], v3 offset:62464
    s_lshl_b32 s44, s16, 11
    s_waitcnt lgkmcnt(10)
    v_mfma_f32_16x16x32_bf16 v[144:147], v[56:59], v[200:203], v[144:147]
    ds_read_b64_tr_b16 v[52:53], v4 offset:61440
    s_add_u32 s44, s44, 131072
    v_mfma_f32_16x16x32_bf16 v[148:151], v[56:59], v[204:207], v[148:151]
    ds_read_b64_tr_b16 v[54:55], v4 offset:62464
    v_add_u32 v13, s44, v2
    v_mfma_f32_16x16x32_bf16 v[152:155], v[60:63], v[200:203], v[152:155]
    ds_read_b64_tr_b16 v[56:57], v5 offset:61440
    v_mfma_f32_16x16x32_bf16 v[156:159], v[60:63], v[204:207], v[156:159]
    ds_read_b64_tr_b16 v[58:59], v5 offset:62464
    s_waitcnt lgkmcnt(10)
    v_mfma_f32_16x16x32_bf16 v[128:131], v[32:35], v[208:211], v[128:131]
    ds_read_b64_tr_b16 v[60:61], v6 offset:61440
    v_mfma_f32_16x16x32_bf16 v[132:135], v[32:35], v[212:215], v[132:135]
    ds_read_b64_tr_b16 v[62:63], v6 offset:62464
    v_xor_b32 v3, 0x10000, v3
    v_xor_b32 v4, 0x10000, v4
    v_xor_b32 v5, 0x10000, v5
    v_xor_b32 v6, 0x10000, v6
    v_mfma_f32_16x16x32_bf16 v[136:139], v[36:39], v[208:211], v[136:139]
    v_mfma_f32_16x16x32_bf16 v[140:143], v[36:39], v[212:215], v[140:143]
    s_waitcnt lgkmcnt(8)
    v_mfma_f32_16x16x32_bf16 v[144:147], v[40:43], v[208:211], v[144:147]
    v_mfma_f32_16x16x32_bf16 v[148:151], v[40:43], v[212:215], v[148:151]
    v_mfma_f32_16x16x32_bf16 v[152:155], v[44:47], v[208:211], v[152:155]
    v_mfma_f32_16x16x32_bf16 v[156:159], v[44:47], v[212:215], v[156:159]
    s_waitcnt lgkmcnt(4)
    v_mfma_f32_16x16x32_bf16 v[128:131], v[48:51], v[216:219], v[128:131]
    v_mfma_f32_16x16x32_bf16 v[132:135], v[48:51], v[220:223], v[132:135]
    v_mfma_f32_16x16x32_bf16 v[136:139], v[52:55], v[216:219], v[136:139]
    v_mfma_f32_16x16x32_bf16 v[140:143], v[52:55], v[220:223], v[140:143]
    s_waitcnt lgkmcnt(0)
    v_mfma_f32_16x16x32_bf16 v[144:147], v[56:59], v[216:219], v[144:147]
    v_mfma_f32_16x16x32_bf16 v[148:151], v[56:59], v[220:223], v[148:151]
    v_mfma_f32_16x16x32_bf16 v[152:155], v[60:63], v[216:219], v[152:155]
    v_mfma_f32_16x16x32_bf16 v[156:159], v[60:63], v[220:223], v[156:159]
    v_pk_fma_f32 v[128:129], v[8:9], v[16:17], v[128:129] op_sel_hi:[0,1,1] neg_lo:[1,0,0] neg_hi:[1,0,0]
    v_pk_fma_f32 v[130:131], v[8:9], v[18:19], v[130:131] op_sel_hi:[0,1,1] neg_lo:[1,0,0] neg_hi:[1,0,0]
    v_pk_fma_f32 v[136:137], v[8:9], v[20:21], v[136:137] op_sel_hi:[0,1,1] neg_lo:[1,0,0] neg_hi:[1,0,0]
    v_pk_fma_f32 v[138:139], v[8:9], v[22:23], v[138:139] op_sel_hi:[0,1,1] neg_lo:[1,0,0] neg_hi:[1,0,0]
    v_pk_mul_f32 v[128:129], v[10:11], v[128:129] op_sel_hi:[0,1]
    v_pk_mul_f32 v[130:131], v[10:11], v[130:131] op_sel_hi:[0,1]
    v_pk_mul_f32 v[136:137], v[10:11], v[136:137] op_sel_hi:[0,1]
    v_pk_mul_f32 v[138:139], v[10:11], v[138:139] op_sel_hi:[0,1]
    v_cvt_pk_bf16_f32 v128, v128, v129
    v_cvt_pk_bf16_f32 v129, v130, v131
    v_cvt_pk_bf16_f32 v130, v136, v137
    v_cvt_pk_bf16_f32 v131, v138, v139
    ds_write_b128 v13, v[128:131] offset:0
    v_pk_fma_f32 v[132:133], v[12:13], v[16:17], v[132:133] op_sel_hi:[0,1,1] neg_lo:[1,0,0] neg_hi:[1,0,0]
    v_pk_fma_f32 v[134:135], v[12:13], v[18:19], v[134:135] op_sel_hi:[0,1,1] neg_lo:[1,0,0] neg_hi:[1,0,0]
    v_pk_fma_f32 v[140:141], v[12:13], v[20:21], v[140:141] op_sel_hi:[0,1,1] neg_lo:[1,0,0] neg_hi:[1,0,0]
    v_pk_fma_f32 v[142:143], v[12:13], v[22:23], v[142:143] op_sel_hi:[0,1,1] neg_lo:[1,0,0] neg_hi:[1,0,0]
    v_pk_mul_f32 v[132:133], v[14:15], v[132:133] op_sel_hi:[0,1]
    v_pk_mul_f32 v[134:135], v[14:15], v[134:135] op_sel_hi:[0,1]
    v_pk_mul_f32 v[140:141], v[14:15], v[140:141] op_sel_hi:[0,1]
    v_pk_mul_f32 v[142:143], v[14:15], v[142:143] op_sel_hi:[0,1]
    v_cvt_pk_bf16_f32 v132, v132, v133
    v_cvt_pk_bf16_f32 v133, v134, v135
    v_cvt_pk_bf16_f32 v134, v140, v141
    v_cvt_pk_bf16_f32 v135, v142, v143
    ds_write_b128 v13, v[132:135] offset:256
    v_add_u32 v4, 131072, v1
    s_waitcnt lgkmcnt(0)
    s_barrier
    ds_read_b128 v[32:35], v4 offset:0
    ds_read_b128 v[36:39], v4 offset:1024
    ds_read_b128 v[40:43], v4 offset:2048
    ds_read_b128 v[44:47], v4 offset:3072
    ds_read_b128 v[48:51], v4 offset:4096
    ds_read_b128 v[52:55], v4 offset:5120
    ds_read_b128 v[56:59], v4 offset:6144
    ds_read_b128 v[60:63], v4 offset:7168
    v_pk_fma_f32 v[144:145], v[8:9], v[24:25], v[144:145] op_sel_hi:[0,1,1] neg_lo:[1,0,0] neg_hi:[1,0,0]
    v_pk_fma_f32 v[146:147], v[8:9], v[26:27], v[146:147] op_sel_hi:[0,1,1] neg_lo:[1,0,0] neg_hi:[1,0,0]
    v_pk_fma_f32 v[152:153], v[8:9], v[28:29], v[152:153] op_sel_hi:[0,1,1] neg_lo:[1,0,0] neg_hi:[1,0,0]
    v_pk_fma_f32 v[154:155], v[8:9], v[30:31], v[154:155] op_sel_hi:[0,1,1] neg_lo:[1,0,0] neg_hi:[1,0,0]
    v_pk_mul_f32 v[144:145], v[10:11], v[144:145] op_sel_hi:[0,1]
    v_pk_mul_f32 v[146:147], v[10:11], v[146:147] op_sel_hi:[0,1]
    v_pk_mul_f32 v[152:153], v[10:11], v[152:153] op_sel_hi:[0,1]
    v_pk_mul_f32 v[154:155], v[10:11], v[154:155] op_sel_hi:[0,1]
    v_cvt_pk_bf16_f32 v144, v144, v145
    v_cvt_pk_bf16_f32 v145, v146, v147
    v_cvt_pk_bf16_f32 v146, v152, v153
    v_cvt_pk_bf16_f32 v147, v154, v155
    ds_write_b128 v13, v[144:147] offset:8192
    s_waitcnt vmcnt(0) lgkmcnt(7)
    v_mfma_f32_32x32x16_bf16 v[192:207], v[64:67], v[32:35], 0
    v_mfma_f32_32x32x16_bf16 v[192:207], v[68:71], v[36:39], v[192:207]
    v_pk_fma_f32 v[148:149], v[12:13], v[24:25], v[148:149] op_sel_hi:[0,1,1] neg_lo:[1,0,0] neg_hi:[1,0,0]
    v_pk_fma_f32 v[150:151], v[12:13], v[26:27], v[150:151] op_sel_hi:[0,1,1] neg_lo:[1,0,0] neg_hi:[1,0,0]
    v_pk_fma_f32 v[156:157], v[12:13], v[28:29], v[156:157] op_sel_hi:[0,1,1] neg_lo:[1,0,0] neg_hi:[1,0,0]
    v_pk_fma_f32 v[158:159], v[12:13], v[30:31], v[158:159] op_sel_hi:[0,1,1] neg_lo:[1,0,0] neg_hi:[1,0,0]
    v_pk_mul_f32 v[148:149], v[14:15], v[148:149] op_sel_hi:[0,1]
    v_pk_mul_f32 v[150:151], v[14:15], v[150:151] op_sel_hi:[0,1]
    v_pk_mul_f32 v[156:157], v[14:15], v[156:157] op_sel_hi:[0,1]
    v_pk_mul_f32 v[158:159], v[14:15], v[158:159] op_sel_hi:[0,1]
    v_cvt_pk_bf16_f32 v148, v148, v149
    v_cvt_pk_bf16_f32 v149, v150, v151
    v_cvt_pk_bf16_f32 v150, v156, v157
    v_cvt_pk_bf16_f32 v151, v158, v159
    ds_write_b128 v13, v[148:151] offset:8448
    v_mov_b32 v9, 0xdddddddd
    v_bfe_u32 v10, v1, 4, 3
    v_mov_b32 v11, 0x3f803f80
    v_cmp_eq_u32 vcc, 0, v10
    v_cmp_eq_u32 s[44:45], 4, v10
    s_mov_b32 s57, 0
    v_cndmask_b32 v28, 0, v11, vcc
    v_cndmask_b32 v29, 0, v11, vcc
    v_cndmask_b32 v30, 0, v11, s[44:45]
    v_cndmask_b32 v31, 0, v11, s[44:45]
    v_mov_b32 v10, 0
    v_mov_b32 v11, 0
    s_mov_b32 s66, 0x10000
    s_waitcnt lgkmcnt(0)
    s_cmp_eq_u32 s68, 16
    s_cbranch_scc1 c_k_ok
c_k_poll:
    s_mov_b32 s68, 0
    s_atomic_add s68, s[22:23], s59 offset:0 glc
    s_sub_u32 s66, s66, 1
    s_cselect_b32 s67, 16, 0
    s_waitcnt lgkmcnt(0)
    s_max_u32 s68, s68, s67
    s_cmp_lt_u32 s68, 16
    s_cbranch_scc1 c_k_poll
c_k_ok:
    s_add_u32 s54, s54, 8192
    s_and_b32 s54, s54, 0x1ffff
    s_add_u32 s55, s53, s54
    s_add_u32 s56, s55, 4194304
    buffer_load_dwordx4 v[80:83], v1, s[4:7], s55 offen offset:0 sc1
    buffer_load_dwordx4 v[84:87], v1, s[4:7], s55 offen offset:1024 sc1
    buffer_load_dwordx4 v[88:91], v1, s[4:7], s56 offen offset:0 sc1
    buffer_load_dwordx4 v[92:95], v1, s[4:7], s56 offen offset:1024 sc1
    s_add_u32 s54, s54, 8192
    s_and_b32 s54, s54, 0x1ffff
    s_add_u32 s55, s53, s54
    s_add_u32 s56, s55, 4194304
    buffer_load_dwordx4 v[96:99], v1, s[4:7], s55 offen offset:0 sc1
    buffer_load_dwordx4 v[100:103], v1, s[4:7], s55 offen offset:1024 sc1
    buffer_load_dwordx4 v[104:107], v1, s[4:7], s56 offen offset:0 sc1
    buffer_load_dwordx4 v[108:111], v1, s[4:7], s56 offen offset:1024 sc1
    v_mfma_f32_32x32x16_bf16 v[208:223], v[64:67], v[40:43], 0
    s_add_u32 s54, s54, 8192
    s_and_b32 s54, s54, 0x1ffff
    s_add_u32 s55, s53, s54
    s_add_u32 s56, s55, 4194304
    v_exp_f32 v192, v192
    v_exp_f32 v193, v193
    v_exp_f32 v194, v194
    v_mfma_f32_32x32x8_bf16 v[128:143], v[10:11], v[10:11], 0
    v_mov_b32 v12, 0
    buffer_load_dwordx4 v[112:115], v1, s[4:7], s55 offen offset:0 sc1
    v_exp_f32 v195, v195
    v_exp_f32 v196, v196
    v_exp_f32 v197, v197
    v_mfma_f32_32x32x16_bf16 v[208:223], v[68:71], v[44:47], v[208:223]
    v_exp_f32 v198, v198
    v_exp_f32 v199, v199
    v_exp_f32 v200, v200
    v_mfma_f32_32x32x8_bf16 v[144:159], v[10:11], v[10:11], 0
    v_mov_b32 v16, 0
    v_exp_f32 v201, v201
    v_exp_f32 v202, v202
    v_mfma_f32_32x32x8_bf16 v[160:175], v[10:11], v[10:11], 0
    v_mov_b32 v20, 0
    s_lshl_b32 s44, s16, 12
    s_add_u32 s44, s44, 65536
    v_add_u32 v5, s44, v1
    s_lshl_b32 s44, s16, 8
    s_add_u32 s44, s44, 147456
    v_lshrrev_b32 v6, 2, v1
    v_add_u32 v6, s44, v6
    s_lshl_b32 s44, s21, 22
    s_lshl_b32 s45, s39, 16
    s_add_u32 s41, s44, s45
    s_lshl_b32 s45, s20, 12
    s_add_u32 s43, s41, s45
    s_and_b32 s45, s45, 0
    s_add_u32 s41, s41, s45
    s_add_u32 s41, s41, 16777216
    v_exp_f32 v203, v203
    v_exp_f32 v204, v204
    v_exp_f32 v205, v205
    v_mfma_f32_32x32x8_bf16 v[176:191], v[10:11], v[10:11], 0
    v_mov_b32 v24, 0
    v_exp_f32 v206, v206
    v_exp_f32 v207, v207
    v_mfma_f32_32x32x16_bf16 v[224:239], v[64:67], v[48:51], 0
    v_exp_f32 v208, v208
    v_exp_f32 v209, v209
    v_exp_f32 v210, v210
    v_smfmac_f32_32x32x32_bf16 v[128:143], v[72:75], v[192:199], v9
    buffer_load_dwordx4 v[116:119], v1, s[4:7], s55 offen offset:1024 sc1
    v_exp_f32 v211, v211
    v_exp_f32 v212, v212
    v_exp_f32 v213, v213
    v_mfma_f32_32x32x16_bf16 v[224:239], v[68:71], v[52:55], v[224:239]
    v_exp_f32 v214, v214
    v_exp_f32 v215, v215
    v_exp_f32 v216, v216
    v_smfmac_f32_16x16x64_bf16 v[12:15], v[28:31], v[192:199], v9
    v_exp_f32 v217, v217
    v_smfmac_f32_32x32x32_bf16 v[128:143], v[76:79], v[200:207], v9
    v_exp_f32 v218, v218
    v_exp_f32 v219, v219
    v_exp_f32 v220, v220
    v_smfmac_f32_16x16x64_bf16 v[12:15], v[28:31], v[200:207], v9
    v_exp_f32 v221, v221
    v_exp_f32 v222, v222
    v_exp_f32 v223, v223
b_head:
    s_mov_b32 s58, 3
b_loop:
    v_mfma_f32_32x32x16_bf16 v[240:255], v[64:67], v[56:59], 0
    v_exp_f32 v224, v224
    v_exp_f32 v225, v225
    v_exp_f32 v226, v226
    v_smfmac_f32_32x32x32_bf16 v[144:159], v[72:75], v[208:215], v9
    buffer_load_dwordx4 v[120:123], v1, s[4:7], s56 offen offset:0 sc1
    v_exp_f32 v227, v227
    v_exp_f32 v228, v228
    v_exp_f32 v229, v229
    v_mfma_f32_32x32x16_bf16 v[240:255], v[68:71], v[60:63], v[240:255]
    v_exp_f32 v230, v230
    v_exp_f32 v231, v231
    v_exp_f32 v232, v232
    v_smfmac_f32_16x16x64_bf16 v[16:19], v[28:31], v[208:215], v9
    v_exp_f32 v233, v233
    v_smfmac_f32_32x32x32_bf16 v[144:159], v[76:79], v[216:223], v9
    v_exp_f32 v234, v234
    v_exp_f32 v235, v235
    v_exp_f32 v236, v236
    v_smfmac_f32_16x16x64_bf16 v[16:19], v[28:31], v[216:223], v9
    v_exp_f32 v237, v237
    v_exp_f32 v238, v238
    v_exp_f32 v239, v239
    s_waitcnt vmcnt(7)
    v_mfma_f32_32x32x16_bf16 v[192:207], v[80:83], v[32:35], 0
    v_exp_f32 v240, v240
    v_exp_f32 v241, v241
    v_exp_f32 v242, v242
    v_smfmac_f32_32x32x32_bf16 v[160:175], v[72:75], v[224:231], v9
    buffer_load_dwordx4 v[124:127], v1, s[4:7], s56 offen offset:1024 sc1
    v_exp_f32 v243, v243
    v_exp_f32 v244, v244
    v_exp_f32 v245, v245
    v_mfma_f32_32x32x16_bf16 v[192:207], v[84:87], v[36:39], v[192:207]
    v_exp_f32 v246, v246
    v_exp_f32 v247, v247
    v_exp_f32 v248, v248
    v_smfmac_f32_16x16x64_bf16 v[20:23], v[28:31], v[224:231], v9
    v_exp_f32 v249, v249
    v_smfmac_f32_32x32x32_bf16 v[160:175], v[76:79], v[232:239], v9
    v_exp_f32 v250, v250
    v_exp_f32 v251, v251
    v_exp_f32 v252, v252
    v_smfmac_f32_16x16x64_bf16 v[20:23], v[28:31], v[232:239], v9
    v_exp_f32 v253, v253
    v_exp_f32 v254, v254
    v_exp_f32 v255, v255
    v_mfma_f32_32x32x16_bf16 v[208:223], v[80:83], v[40:43], 0
    s_add_u32 s54, s54, 8192
    s_and_b32 s54, s54, 0x1ffff
    s_add_u32 s55, s53, s54
    s_add_u32 s56, s55, 4194304
    v_exp_f32 v192, v192
    v_exp_f32 v193, v193
    v_exp_f32 v194, v194
    v_smfmac_f32_32x32x32_bf16 v[176:191], v[72:75], v[240:247], v9
    buffer_load_dwordx4 v[64:67], v1, s[4:7], s55 offen offset:0 sc1
    v_exp_f32 v195, v195
    v_exp_f32 v196, v196
    v_exp_f32 v197, v197
    v_mfma_f32_32x32x16_bf16 v[208:223], v[84:87], v[44:47], v[208:223]
    v_exp_f32 v198, v198
    v_exp_f32 v199, v199
    v_exp_f32 v200, v200
    v_smfmac_f32_16x16x64_bf16 v[24:27], v[28:31], v[240:247], v9
    v_exp_f32 v201, v201
    v_smfmac_f32_32x32x32_bf16 v[176:191], v[76:79], v[248:255], v9
    v_exp_f32 v202, v202
    v_exp_f32 v203, v203
    v_exp_f32 v204, v204
    v_smfmac_f32_16x16x64_bf16 v[24:27], v[28:31], v[248:255], v9
    v_exp_f32 v205, v205
    v_exp_f32 v206, v206
    v_exp_f32 v207, v207
    v_mfma_f32_32x32x16_bf16 v[224:239], v[80:83], v[48:51], 0
    v_exp_f32 v208, v208
    v_exp_f32 v209, v209
    v_exp_f32 v210, v210
    v_smfmac_f32_32x32x32_bf16 v[128:143], v[88:91], v[192:199], v9
    buffer_load_dwordx4 v[68:71], v1, s[4:7], s55 offen offset:1024 sc1
    v_exp_f32 v211, v211
    v_exp_f32 v212, v212
    v_exp_f32 v213, v213
    v_mfma_f32_32x32x16_bf16 v[224:239], v[84:87], v[52:55], v[224:239]
    v_exp_f32 v214, v214
    v_exp_f32 v215, v215
    v_exp_f32 v216, v216
    v_smfmac_f32_16x16x64_bf16 v[12:15], v[28:31], v[192:199], v9
    v_exp_f32 v217, v217
    v_smfmac_f32_32x32x32_bf16 v[128:143], v[92:95], v[200:207], v9
    v_exp_f32 v218, v218
    v_exp_f32 v219, v219
    v_exp_f32 v220, v220
    v_smfmac_f32_16x16x64_bf16 v[12:15], v[28:31], v[200:207], v9
    v_exp_f32 v221, v221
    v_exp_f32 v222, v222
    v_exp_f32 v223, v223
    v_mfma_f32_32x32x16_bf16 v[240:255], v[80:83], v[56:59], 0
    v_exp_f32 v224, v224
    v_exp_f32 v225, v225
    v_exp_f32 v226, v226
    v_smfmac_f32_32x32x32_bf16 v[144:159], v[88:91], v[208:215], v9
    buffer_load_dwordx4 v[72:75], v1, s[4:7], s56 offen offset:0 sc1
    v_exp_f32 v227, v227
    v_exp_f32 v228, v228
    v_exp_f32 v229, v229
    v_mfma_f32_32x32x16_bf16 v[240:255], v[84:87], v[60:63], v[240:255]
    v_exp_f32 v230, v230
    v_exp_f32 v231, v231
    v_exp_f32 v232, v232
    v_smfmac_f32_16x16x64_bf16 v[16:19], v[28:31], v[208:215], v9
    v_exp_f32 v233, v233
    v_smfmac_f32_32x32x32_bf16 v[144:159], v[92:95], v[216:223], v9
    v_exp_f32 v234, v234
    v_exp_f32 v235, v235
    v_exp_f32 v236, v236
    v_smfmac_f32_16x16x64_bf16 v[16:19], v[28:31], v[216:223], v9
    v_exp_f32 v237, v237
    v_exp_f32 v238, v238
    v_exp_f32 v239, v239
    s_waitcnt vmcnt(7)
    v_mfma_f32_32x32x16_bf16 v[192:207], v[96:99], v[32:35], 0
    v_exp_f32 v240, v240
    v_exp_f32 v241, v241
    v_exp_f32 v242, v242
    v_smfmac_f32_32x32x32_bf16 v[160:175], v[88:91], v[224:231], v9
    buffer_load_dwordx4 v[76:79], v1, s[4:7], s56 offen offset:1024 sc1
    v_exp_f32 v243, v243
    v_exp_f32 v244, v244
    v_exp_f32 v245, v245
    v_mfma_f32_32x32x16_bf16 v[192:207], v[100:103], v[36:39], v[192:207]
    v_exp_f32 v246, v246
    v_exp_f32 v247, v247
    v_exp_f32 v248, v248
    v_smfmac_f32_16x16x64_bf16 v[20:23], v[28:31], v[224:231], v9
    v_exp_f32 v249, v249
    v_smfmac_f32_32x32x32_bf16 v[160:175], v[92:95], v[232:239], v9
    v_exp_f32 v250, v250
    v_exp_f32 v251, v251
    v_exp_f32 v252, v252
    v_smfmac_f32_16x16x64_bf16 v[20:23], v[28:31], v[232:239], v9
    v_exp_f32 v253, v253
    v_exp_f32 v254, v254
    v_exp_f32 v255, v255
    v_mfma_f32_32x32x16_bf16 v[208:223], v[96:99], v[40:43], 0
    s_add_u32 s54, s54, 8192
    s_and_b32 s54, s54, 0x1ffff
    s_add_u32 s55, s53, s54
    s_add_u32 s56, s55, 4194304
    v_exp_f32 v192, v192
    v_exp_f32 v193, v193
    v_exp_f32 v194, v194
    v_smfmac_f32_32x32x32_bf16 v[176:191], v[88:91], v[240:247], v9
    buffer_load_dwordx4 v[80:83], v1, s[4:7], s55 offen offset:0 sc1
    v_exp_f32 v195, v195
    v_exp_f32 v196, v196
    v_exp_f32 v197, v197
    v_mfma_f32_32x32x16_bf16 v[208:223], v[100:103], v[44:47], v[208:223]
    v_exp_f32 v198, v198
    v_exp_f32 v199, v199
    v_exp_f32 v200, v200
    v_smfmac_f32_16x16x64_bf16 v[24:27], v[28:31], v[240:247], v9
    v_exp_f32 v201, v201
    v_smfmac_f32_32x32x32_bf16 v[176:191], v[92:95], v[248:255], v9
    v_exp_f32 v202, v202
    v_exp_f32 v203, v203
    v_exp_f32 v204, v204
    v_smfmac_f32_16x16x64_bf16 v[24:27], v[28:31], v[248:255], v9
    v_exp_f32 v205, v205
    v_exp_f32 v206, v206
    v_exp_f32 v207, v207
    v_mfma_f32_32x32x16_bf16 v[224:239], v[96:99], v[48:51], 0
    v_exp_f32 v208, v208
    v_exp_f32 v209, v209
    v_exp_f32 v210, v210
    v_smfmac_f32_32x32x32_bf16 v[128:143], v[104:107], v[192:199], v9
    buffer_load_dwordx4 v[84:87], v1, s[4:7], s55 offen offset:1024 sc1
    v_exp_f32 v211, v211
    v_exp_f32 v212, v212
    v_exp_f32 v213, v213
    v_mfma_f32_32x32x16_bf16 v[224:239], v[100:103], v[52:55], v[224:239]
    v_exp_f32 v214, v214
    v_exp_f32 v215, v215
    v_exp_f32 v216, v216
    v_smfmac_f32_16x16x64_bf16 v[12:15], v[28:31], v[192:199], v9
    v_exp_f32 v217, v217
    v_smfmac_f32_32x32x32_bf16 v[128:143], v[108:111], v[200:207], v9
    v_exp_f32 v218, v218
    v_exp_f32 v219, v219
    v_exp_f32 v220, v220
    v_smfmac_f32_16x16x64_bf16 v[12:15], v[28:31], v[200:207], v9
    v_exp_f32 v221, v221
    v_exp_f32 v222, v222
    v_exp_f32 v223, v223
    v_mfma_f32_32x32x16_bf16 v[240:255], v[96:99], v[56:59], 0
    v_exp_f32 v224, v224
    v_exp_f32 v225, v225
    v_exp_f32 v226, v226
    v_smfmac_f32_32x32x32_bf16 v[144:159], v[104:107], v[208:215], v9
    buffer_load_dwordx4 v[88:91], v1, s[4:7], s56 offen offset:0 sc1
    v_exp_f32 v227, v227
    v_exp_f32 v228, v228
    v_exp_f32 v229, v229
    v_mfma_f32_32x32x16_bf16 v[240:255], v[100:103], v[60:63], v[240:255]
    v_exp_f32 v230, v230
    v_exp_f32 v231, v231
    v_exp_f32 v232, v232
    v_smfmac_f32_16x16x64_bf16 v[16:19], v[28:31], v[208:215], v9
    v_exp_f32 v233, v233
    v_smfmac_f32_32x32x32_bf16 v[144:159], v[108:111], v[216:223], v9
    v_exp_f32 v234, v234
    v_exp_f32 v235, v235
    v_exp_f32 v236, v236
    v_smfmac_f32_16x16x64_bf16 v[16:19], v[28:31], v[216:223], v9
    v_exp_f32 v237, v237
    v_exp_f32 v238, v238
    v_exp_f32 v239, v239
    s_waitcnt vmcnt(7)
    v_mfma_f32_32x32x16_bf16 v[192:207], v[112:115], v[32:35], 0
    v_exp_f32 v240, v240
    v_exp_f32 v241, v241
    v_exp_f32 v242, v242
    v_smfmac_f32_32x32x32_bf16 v[160:175], v[104:107], v[224:231], v9
    buffer_load_dwordx4 v[92:95], v1, s[4:7], s56 offen offset:1024 sc1
    v_exp_f32 v243, v243
    v_exp_f32 v244, v244
    v_exp_f32 v245, v245
    v_mfma_f32_32x32x16_bf16 v[192:207], v[116:119], v[36:39], v[192:207]
    v_exp_f32 v246, v246
    v_exp_f32 v247, v247
    v_exp_f32 v248, v248
    v_smfmac_f32_16x16x64_bf16 v[20:23], v[28:31], v[224:231], v9
    v_exp_f32 v249, v249
    v_smfmac_f32_32x32x32_bf16 v[160:175], v[108:111], v[232:239], v9
    v_exp_f32 v250, v250
    v_exp_f32 v251, v251
    v_exp_f32 v252, v252
    v_smfmac_f32_16x16x64_bf16 v[20:23], v[28:31], v[232:239], v9
    v_exp_f32 v253, v253
    v_exp_f32 v254, v254
    v_exp_f32 v255, v255
    v_mfma_f32_32x32x16_bf16 v[208:223], v[112:115], v[40:43], 0
    s_add_u32 s54, s54, 8192
    s_and_b32 s54, s54, 0x1ffff
    s_add_u32 s55, s53, s54
    s_add_u32 s56, s55, 4194304
    v_exp_f32 v192, v192
    v_exp_f32 v193, v193
    v_exp_f32 v194, v194
    v_smfmac_f32_32x32x32_bf16 v[176:191], v[104:107], v[240:247], v9
    buffer_load_dwordx4 v[96:99], v1, s[4:7], s55 offen offset:0 sc1
    v_exp_f32 v195, v195
    v_exp_f32 v196, v196
    v_exp_f32 v197, v197
    v_mfma_f32_32x32x16_bf16 v[208:223], v[116:119], v[44:47], v[208:223]
    v_exp_f32 v198, v198
    v_exp_f32 v199, v199
    v_exp_f32 v200, v200
    v_smfmac_f32_16x16x64_bf16 v[24:27], v[28:31], v[240:247], v9
    v_exp_f32 v201, v201
    v_smfmac_f32_32x32x32_bf16 v[176:191], v[108:111], v[248:255], v9
    v_exp_f32 v202, v202
    v_exp_f32 v203, v203
    v_exp_f32 v204, v204
    v_smfmac_f32_16x16x64_bf16 v[24:27], v[28:31], v[248:255], v9
    v_exp_f32 v205, v205
    v_exp_f32 v206, v206
    v_exp_f32 v207, v207
    v_mfma_f32_32x32x16_bf16 v[224:239], v[112:115], v[48:51], 0
    v_exp_f32 v208, v208
    v_exp_f32 v209, v209
    v_exp_f32 v210, v210
    v_smfmac_f32_32x32x32_bf16 v[128:143], v[120:123], v[192:199], v9
    buffer_load_dwordx4 v[100:103], v1, s[4:7], s55 offen offset:1024 sc1
    v_exp_f32 v211, v211
    v_exp_f32 v212, v212
    v_exp_f32 v213, v213
    v_mfma_f32_32x32x16_bf16 v[224:239], v[116:119], v[52:55], v[224:239]
    v_exp_f32 v214, v214
    v_exp_f32 v215, v215
    v_exp_f32 v216, v216
    v_smfmac_f32_16x16x64_bf16 v[12:15], v[28:31], v[192:199], v9
    v_exp_f32 v217, v217
    v_smfmac_f32_32x32x32_bf16 v[128:143], v[124:127], v[200:207], v9
    v_exp_f32 v218, v218
    v_exp_f32 v219, v219
    v_exp_f32 v220, v220
    v_smfmac_f32_16x16x64_bf16 v[12:15], v[28:31], v[200:207], v9
    v_exp_f32 v221, v221
    v_exp_f32 v222, v222
    v_exp_f32 v223, v223
    v_mfma_f32_32x32x16_bf16 v[240:255], v[112:115], v[56:59], 0
    v_exp_f32 v224, v224
    v_exp_f32 v225, v225
    v_exp_f32 v226, v226
    v_smfmac_f32_32x32x32_bf16 v[144:159], v[120:123], v[208:215], v9
    buffer_load_dwordx4 v[104:107], v1, s[4:7], s56 offen offset:0 sc1
    v_exp_f32 v227, v227
    v_exp_f32 v228, v228
    v_exp_f32 v229, v229
    v_mfma_f32_32x32x16_bf16 v[240:255], v[116:119], v[60:63], v[240:255]
    v_exp_f32 v230, v230
    v_exp_f32 v231, v231
    v_exp_f32 v232, v232
    v_smfmac_f32_16x16x64_bf16 v[16:19], v[28:31], v[208:215], v9
    v_exp_f32 v233, v233
    v_smfmac_f32_32x32x32_bf16 v[144:159], v[124:127], v[216:223], v9
    v_exp_f32 v234, v234
    v_exp_f32 v235, v235
    v_exp_f32 v236, v236
    v_smfmac_f32_16x16x64_bf16 v[16:19], v[28:31], v[216:223], v9
    v_exp_f32 v237, v237
    v_exp_f32 v238, v238
    v_exp_f32 v239, v239
    s_waitcnt vmcnt(7)
    v_mfma_f32_32x32x16_bf16 v[192:207], v[64:67], v[32:35], 0
    v_exp_f32 v240, v240
    v_exp_f32 v241, v241
    v_exp_f32 v242, v242
    v_smfmac_f32_32x32x32_bf16 v[160:175], v[120:123], v[224:231], v9
    buffer_load_dwordx4 v[108:111], v1, s[4:7], s56 offen offset:1024 sc1
    v_exp_f32 v243, v243
    v_exp_f32 v244, v244
    v_exp_f32 v245, v245
    v_mfma_f32_32x32x16_bf16 v[192:207], v[68:71], v[36:39], v[192:207]
    v_exp_f32 v246, v246
    v_exp_f32 v247, v247
    v_exp_f32 v248, v248
    v_smfmac_f32_16x16x64_bf16 v[20:23], v[28:31], v[224:231], v9
    v_exp_f32 v249, v249
    v_smfmac_f32_32x32x32_bf16 v[160:175], v[124:127], v[232:239], v9
    v_exp_f32 v250, v250
    v_exp_f32 v251, v251
    v_exp_f32 v252, v252
    v_smfmac_f32_16x16x64_bf16 v[20:23], v[28:31], v[232:239], v9
    v_exp_f32 v253, v253
    v_exp_f32 v254, v254
    v_exp_f32 v255, v255
    v_mfma_f32_32x32x16_bf16 v[208:223], v[64:67], v[40:43], 0
    s_add_u32 s54, s54, 8192
    s_and_b32 s54, s54, 0x1ffff
    s_add_u32 s55, s53, s54
    s_add_u32 s56, s55, 4194304
    v_exp_f32 v192, v192
    v_exp_f32 v193, v193
    v_exp_f32 v194, v194
    v_smfmac_f32_32x32x32_bf16 v[176:191], v[120:123], v[240:247], v9
    buffer_load_dwordx4 v[112:115], v1, s[4:7], s55 offen offset:0 sc1
    v_exp_f32 v195, v195
    v_exp_f32 v196, v196
    v_exp_f32 v197, v197
    v_mfma_f32_32x32x16_bf16 v[208:223], v[68:71], v[44:47], v[208:223]
    v_exp_f32 v198, v198
    v_exp_f32 v199, v199
    v_exp_f32 v200, v200
    v_smfmac_f32_16x16x64_bf16 v[24:27], v[28:31], v[240:247], v9
    v_exp_f32 v201, v201
    v_smfmac_f32_32x32x32_bf16 v[176:191], v[124:127], v[248:255], v9
    v_exp_f32 v202, v202
    v_exp_f32 v203, v203
    v_exp_f32 v204, v204
    v_smfmac_f32_16x16x64_bf16 v[24:27], v[28:31], v[248:255], v9
    v_exp_f32 v205, v205
    v_exp_f32 v206, v206
    v_exp_f32 v207, v207
    v_mfma_f32_32x32x16_bf16 v[224:239], v[64:67], v[48:51], 0
    v_exp_f32 v208, v208
    v_exp_f32 v209, v209
    v_exp_f32 v210, v210
    v_smfmac_f32_32x32x32_bf16 v[128:143], v[72:75], v[192:199], v9
    buffer_load_dwordx4 v[116:119], v1, s[4:7], s55 offen offset:1024 sc1
    v_exp_f32 v211, v211
    v_exp_f32 v212, v212
    v_exp_f32 v213, v213
    v_mfma_f32_32x32x16_bf16 v[224:239], v[68:71], v[52:55], v[224:239]
    v_exp_f32 v214, v214
    v_exp_f32 v215, v215
    v_exp_f32 v216, v216
    v_smfmac_f32_16x16x64_bf16 v[12:15], v[28:31], v[192:199], v9
    v_exp_f32 v217, v217
    v_smfmac_f32_32x32x32_bf16 v[128:143], v[76:79], v[200:207], v9
    v_exp_f32 v218, v218
    v_exp_f32 v219, v219
    v_exp_f32 v220, v220
    v_smfmac_f32_16x16x64_bf16 v[12:15], v[28:31], v[200:207], v9
    v_exp_f32 v221, v221
    v_exp_f32 v222, v222
    v_exp_f32 v223, v223
    s_sub_u32 s58, s58, 1
    s_cmp_lg_u32 s58, 0
    s_cbranch_scc1 b_loop
    v_mfma_f32_32x32x16_bf16 v[240:255], v[64:67], v[56:59], 0
    v_exp_f32 v224, v224
    v_exp_f32 v225, v225
    v_exp_f32 v226, v226
    v_smfmac_f32_32x32x32_bf16 v[144:159], v[72:75], v[208:215], v9
    buffer_load_dwordx4 v[120:123], v1, s[4:7], s56 offen offset:0 sc1
    v_exp_f32 v227, v227
    v_exp_f32 v228, v228
    v_exp_f32 v229, v229
    v_mfma_f32_32x32x16_bf16 v[240:255], v[68:71], v[60:63], v[240:255]
    v_exp_f32 v230, v230
    v_exp_f32 v231, v231
    v_exp_f32 v232, v232
    v_smfmac_f32_16x16x64_bf16 v[16:19], v[28:31], v[208:215], v9
    v_exp_f32 v233, v233
    v_smfmac_f32_32x32x32_bf16 v[144:159], v[76:79], v[216:223], v9
    v_exp_f32 v234, v234
    v_exp_f32 v235, v235
    v_exp_f32 v236, v236
    v_smfmac_f32_16x16x64_bf16 v[16:19], v[28:31], v[216:223], v9
    v_exp_f32 v237, v237
    v_exp_f32 v238, v238
    v_exp_f32 v239, v239
    s_waitcnt vmcnt(7)
    v_mfma_f32_32x32x16_bf16 v[192:207], v[80:83], v[32:35], 0
    v_exp_f32 v240, v240
    v_exp_f32 v241, v241
    v_exp_f32 v242, v242
    v_smfmac_f32_32x32x32_bf16 v[160:175], v[72:75], v[224:231], v9
    buffer_load_dwordx4 v[124:127], v1, s[4:7], s56 offen offset:1024 sc1
    v_exp_f32 v243, v243
    v_exp_f32 v244, v244
    v_exp_f32 v245, v245
    v_mfma_f32_32x32x16_bf16 v[192:207], v[84:87], v[36:39], v[192:207]
    v_exp_f32 v246, v246
    v_exp_f32 v247, v247
    v_exp_f32 v248, v248
    v_smfmac_f32_16x16x64_bf16 v[20:23], v[28:31], v[224:231], v9
    v_exp_f32 v249, v249
    v_smfmac_f32_32x32x32_bf16 v[160:175], v[76:79], v[232:239], v9
    v_exp_f32 v250, v250
    v_exp_f32 v251, v251
    v_exp_f32 v252, v252
    v_smfmac_f32_16x16x64_bf16 v[20:23], v[28:31], v[232:239], v9
    v_exp_f32 v253, v253
    v_exp_f32 v254, v254
    v_exp_f32 v255, v255
    s_add_u32 s53, s53, 131072
    s_cmp_eq_u32 s57, 0
    s_cselect_b32 s53, s53, 2146435072
    v_mfma_f32_32x32x16_bf16 v[208:223], v[80:83], v[40:43], 0
    s_add_u32 s54, s54, 8192
    s_and_b32 s54, s54, 0x1ffff
    s_add_u32 s55, s53, s54
    s_add_u32 s56, s55, 4194304
    v_exp_f32 v192, v192
    v_exp_f32 v193, v193
    v_exp_f32 v194, v194
    v_smfmac_f32_32x32x32_bf16 v[176:191], v[72:75], v[240:247], v9
    buffer_load_dwordx4 v[64:67], v1, s[4:7], s55 offen offset:0 sc1
    v_exp_f32 v195, v195
    v_exp_f32 v196, v196
    v_exp_f32 v197, v197
    v_mfma_f32_32x32x16_bf16 v[208:223], v[84:87], v[44:47], v[208:223]
    v_exp_f32 v198, v198
    v_exp_f32 v199, v199
    v_exp_f32 v200, v200
    v_smfmac_f32_16x16x64_bf16 v[24:27], v[28:31], v[240:247], v9
    v_exp_f32 v201, v201
    v_smfmac_f32_32x32x32_bf16 v[176:191], v[76:79], v[248:255], v9
    v_exp_f32 v202, v202
    v_exp_f32 v203, v203
    v_exp_f32 v204, v204
    v_smfmac_f32_16x16x64_bf16 v[24:27], v[28:31], v[248:255], v9
    v_exp_f32 v205, v205
    v_exp_f32 v206, v206
    v_exp_f32 v207, v207
    v_mfma_f32_32x32x16_bf16 v[224:239], v[80:83], v[48:51], 0
    v_exp_f32 v208, v208
    v_exp_f32 v209, v209
    v_exp_f32 v210, v210
    v_smfmac_f32_32x32x32_bf16 v[128:143], v[88:91], v[192:199], v9
    buffer_load_dwordx4 v[68:71], v1, s[4:7], s55 offen offset:1024 sc1
    v_exp_f32 v211, v211
    v_exp_f32 v212, v212
    v_exp_f32 v213, v213
    v_mfma_f32_32x32x16_bf16 v[224:239], v[84:87], v[52:55], v[224:239]
    v_exp_f32 v214, v214
    v_exp_f32 v215, v215
    v_exp_f32 v216, v216
    v_smfmac_f32_16x16x64_bf16 v[12:15], v[28:31], v[192:199], v9
    v_exp_f32 v217, v217
    v_smfmac_f32_32x32x32_bf16 v[128:143], v[92:95], v[200:207], v9
    v_exp_f32 v218, v218
    v_exp_f32 v219, v219
    v_exp_f32 v220, v220
    v_smfmac_f32_16x16x64_bf16 v[12:15], v[28:31], v[200:207], v9
    v_exp_f32 v221, v221
    v_exp_f32 v222, v222
    v_exp_f32 v223, v223
    v_mfma_f32_32x32x16_bf16 v[240:255], v[80:83], v[56:59], 0
    v_exp_f32 v224, v224
    v_exp_f32 v225, v225
    v_exp_f32 v226, v226
    v_smfmac_f32_32x32x32_bf16 v[144:159], v[88:91], v[208:215], v9
    buffer_load_dwordx4 v[72:75], v1, s[4:7], s56 offen offset:0 sc1
    v_exp_f32 v227, v227
    v_exp_f32 v228, v228
    v_exp_f32 v229, v229
    v_mfma_f32_32x32x16_bf16 v[240:255], v[84:87], v[60:63], v[240:255]
    v_exp_f32 v230, v230
    v_exp_f32 v231, v231
    v_exp_f32 v232, v232
    v_smfmac_f32_16x16x64_bf16 v[16:19], v[28:31], v[208:215], v9
    v_exp_f32 v233, v233
    v_smfmac_f32_32x32x32_bf16 v[144:159], v[92:95], v[216:223], v9
    v_exp_f32 v234, v234
    v_exp_f32 v235, v235
    v_exp_f32 v236, v236
    v_smfmac_f32_16x16x64_bf16 v[16:19], v[28:31], v[216:223], v9
    v_exp_f32 v237, v237
    v_exp_f32 v238, v238
    v_exp_f32 v239, v239
    s_waitcnt vmcnt(7)
    v_mfma_f32_32x32x16_bf16 v[192:207], v[96:99], v[32:35], 0
    v_exp_f32 v240, v240
    v_exp_f32 v241, v241
    v_exp_f32 v242, v242
    v_smfmac_f32_32x32x32_bf16 v[160:175], v[88:91], v[224:231], v9
    buffer_load_dwordx4 v[76:79], v1, s[4:7], s56 offen offset:1024 sc1
    v_exp_f32 v243, v243
    v_exp_f32 v244, v244
    v_exp_f32 v245, v245
    v_mfma_f32_32x32x16_bf16 v[192:207], v[100:103], v[36:39], v[192:207]
    v_exp_f32 v246, v246
    v_exp_f32 v247, v247
    v_exp_f32 v248, v248
    v_smfmac_f32_16x16x64_bf16 v[20:23], v[28:31], v[224:231], v9
    v_exp_f32 v249, v249
    v_smfmac_f32_32x32x32_bf16 v[160:175], v[92:95], v[232:239], v9
    v_exp_f32 v250, v250
    v_exp_f32 v251, v251
    v_exp_f32 v252, v252
    v_smfmac_f32_16x16x64_bf16 v[20:23], v[28:31], v[232:239], v9
    v_exp_f32 v253, v253
    v_exp_f32 v254, v254
    v_exp_f32 v255, v255
    v_mfma_f32_32x32x16_bf16 v[208:223], v[96:99], v[40:43], 0
    s_add_u32 s54, s54, 8192
    s_and_b32 s54, s54, 0x1ffff
    s_add_u32 s55, s53, s54
    s_add_u32 s56, s55, 4194304
    v_exp_f32 v192, v192
    v_exp_f32 v193, v193
    v_exp_f32 v194, v194
    v_smfmac_f32_32x32x32_bf16 v[176:191], v[88:91], v[240:247], v9
    buffer_load_dwordx4 v[80:83], v1, s[4:7], s55 offen offset:0 sc1
    v_exp_f32 v195, v195
    v_exp_f32 v196, v196
    v_exp_f32 v197, v197
    v_mfma_f32_32x32x16_bf16 v[208:223], v[100:103], v[44:47], v[208:223]
    v_exp_f32 v198, v198
    v_exp_f32 v199, v199
    v_exp_f32 v200, v200
    v_smfmac_f32_16x16x64_bf16 v[24:27], v[28:31], v[240:247], v9
    v_exp_f32 v201, v201
    v_smfmac_f32_32x32x32_bf16 v[176:191], v[92:95], v[248:255], v9
    v_exp_f32 v202, v202
    v_exp_f32 v203, v203
    v_exp_f32 v204, v204
    v_smfmac_f32_16x16x64_bf16 v[24:27], v[28:31], v[248:255], v9
    v_exp_f32 v205, v205
    v_exp_f32 v206, v206
    v_exp_f32 v207, v207
    v_mfma_f32_32x32x16_bf16 v[224:239], v[96:99], v[48:51], 0
    v_exp_f32 v208, v208
    v_exp_f32 v209, v209
    v_exp_f32 v210, v210
    v_smfmac_f32_32x32x32_bf16 v[128:143], v[104:107], v[192:199], v9
    buffer_load_dwordx4 v[84:87], v1, s[4:7], s55 offen offset:1024 sc1
    v_exp_f32 v211, v211
    v_exp_f32 v212, v212
    v_exp_f32 v213, v213
    v_mfma_f32_32x32x16_bf16 v[224:239], v[100:103], v[52:55], v[224:239]
    v_exp_f32 v214, v214
    v_exp_f32 v215, v215
    v_exp_f32 v216, v216
    v_smfmac_f32_16x16x64_bf16 v[12:15], v[28:31], v[192:199], v9
    v_exp_f32 v217, v217
    v_smfmac_f32_32x32x32_bf16 v[128:143], v[108:111], v[200:207], v9
    v_exp_f32 v218, v218
    v_exp_f32 v219, v219
    v_exp_f32 v220, v220
    v_smfmac_f32_16x16x64_bf16 v[12:15], v[28:31], v[200:207], v9
    v_exp_f32 v221, v221
    v_exp_f32 v222, v222
    v_exp_f32 v223, v223
    v_mfma_f32_32x32x16_bf16 v[240:255], v[96:99], v[56:59], 0
    v_exp_f32 v224, v224
    v_exp_f32 v225, v225
    v_exp_f32 v226, v226
    v_smfmac_f32_32x32x32_bf16 v[144:159], v[104:107], v[208:215], v9
    buffer_load_dwordx4 v[88:91], v1, s[4:7], s56 offen offset:0 sc1
    v_exp_f32 v227, v227
    v_exp_f32 v228, v228
    v_exp_f32 v229, v229
    v_mfma_f32_32x32x16_bf16 v[240:255], v[100:103], v[60:63], v[240:255]
    v_exp_f32 v230, v230
    v_exp_f32 v231, v231
    v_exp_f32 v232, v232
    v_smfmac_f32_16x16x64_bf16 v[16:19], v[28:31], v[208:215], v9
    v_exp_f32 v233, v233
    v_smfmac_f32_32x32x32_bf16 v[144:159], v[108:111], v[216:223], v9
    v_exp_f32 v234, v234
    v_exp_f32 v235, v235
    v_exp_f32 v236, v236
    v_smfmac_f32_16x16x64_bf16 v[16:19], v[28:31], v[216:223], v9
    v_exp_f32 v237, v237
    v_exp_f32 v238, v238
    v_exp_f32 v239, v239
    s_waitcnt vmcnt(7)
    v_mfma_f32_32x32x16_bf16 v[192:207], v[112:115], v[32:35], 0
    v_exp_f32 v240, v240
    v_exp_f32 v241, v241
    v_exp_f32 v242, v242
    v_smfmac_f32_32x32x32_bf16 v[160:175], v[104:107], v[224:231], v9
    buffer_load_dwordx4 v[92:95], v1, s[4:7], s56 offen offset:1024 sc1
    v_exp_f32 v243, v243
    v_exp_f32 v244, v244
    v_exp_f32 v245, v245
    v_mfma_f32_32x32x16_bf16 v[192:207], v[116:119], v[36:39], v[192:207]
    v_exp_f32 v246, v246
    v_exp_f32 v247, v247
    v_exp_f32 v248, v248
    v_smfmac_f32_16x16x64_bf16 v[20:23], v[28:31], v[224:231], v9
    v_exp_f32 v249, v249
    v_smfmac_f32_32x32x32_bf16 v[160:175], v[108:111], v[232:239], v9
    v_exp_f32 v250, v250
    v_exp_f32 v251, v251
    v_exp_f32 v252, v252
    v_smfmac_f32_16x16x64_bf16 v[20:23], v[28:31], v[232:239], v9
    v_exp_f32 v253, v253
    v_exp_f32 v254, v254
    v_exp_f32 v255, v255
    s_barrier
    v_mfma_f32_32x32x16_bf16 v[208:223], v[112:115], v[40:43], 0
    s_add_u32 s54, s54, 8192
    s_and_b32 s54, s54, 0x1ffff
    s_add_u32 s55, s53, s54
    s_add_u32 s56, s55, 4194304
    ds_read_b128 v[32:35], v4 offset:8192
    ds_read_b128 v[36:39], v4 offset:9216
    v_exp_f32 v192, v192
    v_exp_f32 v193, v193
    v_exp_f32 v194, v194
    v_smfmac_f32_32x32x32_bf16 v[176:191], v[104:107], v[240:247], v9
    buffer_load_dwordx4 v[96:99], v1, s[4:7], s55 offen offset:0 sc1
    v_exp_f32 v195, v195
    v_exp_f32 v196, v196
    v_exp_f32 v197, v197
    v_mfma_f32_32x32x16_bf16 v[208:223], v[116:119], v[44:47], v[208:223]
    v_exp_f32 v198, v198
    v_exp_f32 v199, v199
    v_exp_f32 v200, v200
    v_smfmac_f32_16x16x64_bf16 v[24:27], v[28:31], v[240:247], v9
    v_exp_f32 v201, v201
    v_smfmac_f32_32x32x32_bf16 v[176:191], v[108:111], v[248:255], v9
    v_exp_f32 v202, v202
    v_exp_f32 v203, v203
    v_exp_f32 v204, v204
    v_smfmac_f32_16x16x64_bf16 v[24:27], v[28:31], v[248:255], v9
    v_exp_f32 v205, v205
    v_exp_f32 v206, v206
    v_exp_f32 v207, v207
    v_mfma_f32_32x32x16_bf16 v[224:239], v[112:115], v[48:51], 0
    ds_read_b128 v[40:43], v4 offset:10240
    ds_read_b128 v[44:47], v4 offset:11264
    v_exp_f32 v208, v208
    v_exp_f32 v209, v209
    v_exp_f32 v210, v210
    v_smfmac_f32_32x32x32_bf16 v[128:143], v[120:123], v[192:199], v9
    buffer_load_dwordx4 v[100:103], v1, s[4:7], s55 offen offset:1024 sc1
    v_exp_f32 v211, v211
    v_exp_f32 v212, v212
    v_exp_f32 v213, v213
    v_mfma_f32_32x32x16_bf16 v[224:239], v[116:119], v[52:55], v[224:239]
    v_exp_f32 v214, v214
    v_exp_f32 v215, v215
    v_exp_f32 v216, v216
    v_smfmac_f32_16x16x64_bf16 v[12:15], v[28:31], v[192:199], v9
    v_exp_f32 v217, v217
    v_smfmac_f32_32x32x32_bf16 v[128:143], v[124:127], v[200:207], v9
    v_exp_f32 v218, v218
    v_exp_f32 v219, v219
    v_exp_f32 v220, v220
    v_smfmac_f32_16x16x64_bf16 v[12:15], v[28:31], v[200:207], v9
    v_exp_f32 v221, v221
    v_exp_f32 v222, v222
    v_exp_f32 v223, v223
    v_mfma_f32_32x32x16_bf16 v[240:255], v[112:115], v[56:59], 0
    ds_read_b128 v[48:51], v4 offset:12288
    ds_read_b128 v[52:55], v4 offset:13312
    v_exp_f32 v224, v224
    v_exp_f32 v225, v225
    v_exp_f32 v226, v226
    v_smfmac_f32_32x32x32_bf16 v[144:159], v[120:123], v[208:215], v9
    buffer_load_dwordx4 v[104:107], v1, s[4:7], s56 offen offset:0 sc1
    v_exp_f32 v227, v227
    ds_write_b128 v5, v[128:131] offset:0
    v_exp_f32 v228, v228
    v_exp_f32 v229, v229
    v_mfma_f32_32x32x16_bf16 v[240:255], v[116:119], v[60:63], v[240:255]
    ds_write_b128 v5, v[132:135] offset:1024
    v_exp_f32 v230, v230
    v_exp_f32 v231, v231
    v_exp_f32 v232, v232
    v_smfmac_f32_16x16x64_bf16 v[16:19], v[28:31], v[208:215], v9
    ds_write_b32 v6, v12 offset:0
    v_exp_f32 v233, v233
    v_smfmac_f32_32x32x32_bf16 v[144:159], v[124:127], v[216:223], v9
    ds_write_b128 v5, v[136:139] offset:2048
    v_exp_f32 v234, v234
    v_exp_f32 v235, v235
    v_exp_f32 v236, v236
    v_smfmac_f32_16x16x64_bf16 v[16:19], v[28:31], v[216:223], v9
    ds_write_b128 v5, v[140:143] offset:3072
    v_exp_f32 v237, v237
    v_exp_f32 v238, v238
    v_exp_f32 v239, v239
    s_waitcnt vmcnt(7)
    s_waitcnt lgkmcnt(9)
    v_mfma_f32_32x32x16_bf16 v[192:207], v[64:67], v[32:35], 0
    ds_read_b128 v[56:59], v4 offset:14336
    ds_read_b128 v[60:63], v4 offset:15360
    v_exp_f32 v240, v240
    v_exp_f32 v241, v241
    v_exp_f32 v242, v242
    v_smfmac_f32_32x32x32_bf16 v[160:175], v[120:123], v[224:231], v9
    buffer_load_dwordx4 v[108:111], v1, s[4:7], s56 offen offset:1024 sc1
    v_exp_f32 v243, v243
    ds_write_b128 v5, v[144:147] offset:16384
    v_exp_f32 v244, v244
    v_exp_f32 v245, v245
    v_mfma_f32_32x32x16_bf16 v[192:207], v[68:71], v[36:39], v[192:207]
    ds_write_b128 v5, v[148:151] offset:17408
    v_exp_f32 v246, v246
    v_exp_f32 v247, v247
    v_exp_f32 v248, v248
    s_waitcnt lgkmcnt(4)
    v_mfma_f32_32x32x8_bf16 v[128:143], v[10:11], v[10:11], 0
    v_mov_b32 v12, 0
    v_smfmac_f32_16x16x64_bf16 v[20:23], v[28:31], v[224:231], v9
    ds_write_b32 v6, v16 offset:1024
    v_exp_f32 v249, v249
    v_smfmac_f32_32x32x32_bf16 v[160:175], v[124:127], v[232:239], v9
    ds_write_b128 v5, v[152:155] offset:18432
    v_exp_f32 v250, v250
    v_exp_f32 v251, v251
    v_exp_f32 v252, v252
    v_smfmac_f32_16x16x64_bf16 v[20:23], v[28:31], v[232:239], v9
    ds_write_b128 v5, v[156:159] offset:19456
    v_exp_f32 v253, v253
    v_exp_f32 v254, v254
    v_exp_f32 v255, v255
    s_cmp_lg_u32 s57, 0
    s_cbranch_scc1 b_tail
    v_mfma_f32_32x32x16_bf16 v[208:223], v[64:67], v[40:43], 0
    s_add_u32 s54, s54, 8192
    s_and_b32 s54, s54, 0x1ffff
    s_add_u32 s55, s53, s54
    s_add_u32 s56, s55, 4194304
    v_exp_f32 v192, v192
    v_exp_f32 v193, v193
    v_exp_f32 v194, v194
    v_smfmac_f32_32x32x32_bf16 v[176:191], v[120:123], v[240:247], v9
    buffer_load_dwordx4 v[112:115], v1, s[4:7], s55 offen offset:0 sc1
    v_exp_f32 v195, v195
    ds_write_b128 v5, v[160:163] offset:32768
    v_exp_f32 v196, v196
    v_exp_f32 v197, v197
    v_mfma_f32_32x32x16_bf16 v[208:223], v[68:71], v[44:47], v[208:223]
    ds_write_b128 v5, v[164:167] offset:33792
    v_exp_f32 v198, v198
    v_exp_f32 v199, v199
    v_exp_f32 v200, v200
    s_waitcnt lgkmcnt(2)
    v_mfma_f32_32x32x8_bf16 v[144:159], v[10:11], v[10:11], 0
    v_mov_b32 v16, 0
    v_smfmac_f32_16x16x64_bf16 v[24:27], v[28:31], v[240:247], v9
    ds_write_b32 v6, v20 offset:2048
    v_exp_f32 v201, v201
    v_smfmac_f32_32x32x32_bf16 v[176:191], v[124:127], v[248:255], v9
    ds_write_b128 v5, v[168:171] offset:34816
    v_exp_f32 v202, v202
    v_exp_f32 v203, v203
    v_exp_f32 v204, v204
    v_smfmac_f32_16x16x64_bf16 v[24:27], v[28:31], v[248:255], v9
    ds_write_b128 v5, v[172:175] offset:35840
    v_exp_f32 v205, v205
    v_exp_f32 v206, v206
    v_exp_f32 v207, v207
    v_mfma_f32_32x32x16_bf16 v[224:239], v[64:67], v[48:51], 0
    v_exp_f32 v208, v208
    v_exp_f32 v209, v209
    v_exp_f32 v210, v210
    v_smfmac_f32_32x32x32_bf16 v[128:143], v[72:75], v[192:199], v9
    buffer_load_dwordx4 v[116:119], v1, s[4:7], s55 offen offset:1024 sc1
    v_exp_f32 v211, v211
    ds_write_b128 v5, v[176:179] offset:49152
    v_exp_f32 v212, v212
    v_exp_f32 v213, v213
    v_mfma_f32_32x32x16_bf16 v[224:239], v[68:71], v[52:55], v[224:239]
    ds_write_b128 v5, v[180:183] offset:50176
    v_exp_f32 v214, v214
    v_exp_f32 v215, v215
    v_exp_f32 v216, v216
    s_waitcnt lgkmcnt(2)
    v_mfma_f32_32x32x8_bf16 v[160:175], v[10:11], v[10:11], 0
    v_mov_b32 v20, 0
    v_smfmac_f32_16x16x64_bf16 v[12:15], v[28:31], v[192:199], v9
    ds_write_b32 v6, v24 offset:3072
    v_exp_f32 v217, v217
    v_smfmac_f32_32x32x32_bf16 v[128:143], v[76:79], v[200:207], v9
    ds_write_b128 v5, v[184:187] offset:51200
    v_exp_f32 v218, v218
    v_exp_f32 v219, v219
    v_exp_f32 v220, v220
    v_smfmac_f32_16x16x64_bf16 v[12:15], v[28:31], v[200:207], v9
    ds_write_b128 v5, v[188:191] offset:52224
    v_exp_f32 v221, v221
    v_exp_f32 v222, v222
    v_exp_f32 v223, v223
    s_waitcnt lgkmcnt(0)
    v_mfma_f32_32x32x8_bf16 v[176:191], v[10:11], v[10:11], 0
    v_mov_b32 v24, 0
    s_barrier
    s_mov_b32 s57, 1
    s_branch b_head
b_tail:
    v_smfmac_f32_32x32x32_bf16 v[176:191], v[120:123], v[240:247], v9
    v_smfmac_f32_32x32x32_bf16 v[176:191], v[124:127], v[248:255], v9
    ds_write_b128 v5, v[160:163] offset:32768
    ds_write_b128 v5, v[164:167] offset:33792
    v_smfmac_f32_16x16x64_bf16 v[24:27], v[28:31], v[240:247], v9
    ds_write_b128 v5, v[168:171] offset:34816
    v_smfmac_f32_16x16x64_bf16 v[24:27], v[28:31], v[248:255], v9
    ds_write_b128 v5, v[172:175] offset:35840
    ds_write_b32 v6, v20 offset:2048
    s_nop 4
    ds_write_b128 v5, v[176:179] offset:49152
    ds_write_b128 v5, v[180:183] offset:50176
    ds_write_b128 v5, v[184:187] offset:51200
    ds_write_b128 v5, v[188:191] offset:52224
    s_nop 0
    ds_write_b32 v6, v24 offset:3072
    buffer_load_dwordx4 v[224:227], v2, s[4:7], s43 offen offset:0 sc1
    buffer_load_dwordx4 v[228:231], v2, s[4:7], s43 offen offset:256 sc1
    buffer_load_dwordx4 v[232:235], v2, s[4:7], s43 offen offset:2048 sc1
    buffer_load_dwordx4 v[236:239], v2, s[4:7], s43 offen offset:2304 sc1
    s_waitcnt lgkmcnt(0)
    s_barrier
    v_xor_b32 v4, 32, v3
    v_xor_b32 v5, 64, v3
    v_xor_b32 v6, 96, v3
c_wo:
    s_xor_b32 s42, s41, 0
    buffer_load_dwordx4 v[64:67], v2, s[4:7], s42 offen offset:0 sc1
    buffer_load_dwordx4 v[68:71], v2, s[4:7], s42 offen offset:256 sc1
    s_xor_b32 s42, s41, 4096
    buffer_load_dwordx4 v[72:75], v2, s[4:7], s42 offen offset:0 sc1
    buffer_load_dwordx4 v[76:79], v2, s[4:7], s42 offen offset:256 sc1
    s_xor_b32 s42, s41, 8192
    buffer_load_dwordx4 v[80:83], v2, s[4:7], s42 offen offset:0 sc1
    buffer_load_dwordx4 v[84:87], v2, s[4:7], s42 offen offset:256 sc1
    s_xor_b32 s42, s41, 12288
    buffer_load_dwordx4 v[88:91], v2, s[4:7], s42 offen offset:0 sc1
    buffer_load_dwordx4 v[92:95], v2, s[4:7], s42 offen offset:256 sc1
    s_xor_b32 s42, s41, 16384
    buffer_load_dwordx4 v[96:99], v2, s[4:7], s42 offen offset:0 sc1
    buffer_load_dwordx4 v[100:103], v2, s[4:7], s42 offen offset:256 sc1
    ds_read_b64_tr_b16 v[32:33], v3 offset:0
    ds_read_b64_tr_b16 v[34:35], v3 offset:1024
    ds_read_b64_tr_b16 v[36:37], v4 offset:0
    ds_read_b64_tr_b16 v[38:39], v4 offset:1024
    ds_read_b64_tr_b16 v[40:41], v5 offset:0
    ds_read_b64_tr_b16 v[42:43], v5 offset:1024
    ds_read_b64_tr_b16 v[44:45], v6 offset:0
    ds_read_b64_tr_b16 v[46:47], v6 offset:1024
    ds_read_b64_tr_b16 v[48:49], v3 offset:4096
    ds_read_b64_tr_b16 v[50:51], v3 offset:5120
    ds_read_b64_tr_b16 v[52:53], v4 offset:4096
    ds_read_b64_tr_b16 v[54:55], v4 offset:5120
    ds_read_b64_tr_b16 v[56:57], v5 offset:4096
    ds_read_b64_tr_b16 v[58:59], v5 offset:5120
    v_lshrrev_b32 v12, 4, v1
    v_and_b32 v13, 1, v12
    v_lshlrev_b32 v13, 4, v13
    v_mov_b32 v14, 0x3f80
    v_lshlrev_b32 v13, v13, v14
    v_lshrrev_b32 v14, 2, v12
    v_lshrrev_b32 v15, 4, v12
    v_xor_b32 v14, v14, v15
    v_and_b32 v14, 1, v14
    v_bfe_u32 v15, v12, 3, 1
    v_bfe_u32 v16, v12, 1, 1
    v_lshl_add_u32 v15, v15, 1, v16
    v_lshrrev_b32 v16, 5, v12
    v_lshl_add_u32 v15, v16, 2, v15
    v_lshl_add_u32 v15, v14, 3, v15
    v_cmp_eq_u32 vcc, 0, v15
    s_nop 1
    v_cndmask_b32 v240, 0, v13, vcc
    v_cmp_eq_u32 vcc, 1, v15
    s_nop 1
    v_cndmask_b32 v241, 0, v13, vcc
    v_cmp_eq_u32 vcc, 2, v15
    s_nop 1
    v_cndmask_b32 v242, 0, v13, vcc
    v_cmp_eq_u32 vcc, 3, v15
    s_nop 1
    v_cndmask_b32 v243, 0, v13, vcc
    v_cmp_eq_u32 vcc, 4, v15
    s_nop 1
    v_cndmask_b32 v244, 0, v13, vcc
    v_cmp_eq_u32 vcc, 5, v15
    s_nop 1
    v_cndmask_b32 v245, 0, v13, vcc
    v_cmp_eq_u32 vcc, 6, v15
    s_nop 1
    v_cndmask_b32 v246, 0, v13, vcc
    v_cmp_eq_u32 vcc, 7, v15
    s_nop 1
    v_cndmask_b32 v247, 0, v13, vcc
    s_waitcnt vmcnt(10)
    v_mfma_f32_16x16x32_bf16 v[128:131], v[240:243], v[224:227], 0
    v_mfma_f32_16x16x32_bf16 v[132:135], v[240:243], v[228:231], 0
    v_mfma_f32_16x16x32_bf16 v[136:139], v[244:247], v[224:227], 0
    v_mfma_f32_16x16x32_bf16 v[140:143], v[244:247], v[228:231], 0
    v_mfma_f32_16x16x32_bf16 v[144:147], v[240:243], v[232:235], 0
    v_mfma_f32_16x16x32_bf16 v[148:151], v[240:243], v[236:239], 0
    v_mfma_f32_16x16x32_bf16 v[152:155], v[244:247], v[232:235], 0
    v_mfma_f32_16x16x32_bf16 v[156:159], v[244:247], v[236:239], 0
    s_waitcnt vmcnt(8) lgkmcnt(10)
    v_mfma_f32_16x16x32_bf16 v[128:131], v[32:35], v[64:67], v[128:131]
    ds_read_b64_tr_b16 v[60:61], v6 offset:4096
    s_xor_b32 s42, s41, 20480
    buffer_load_dwordx4 v[104:107], v2, s[4:7], s42 offen offset:0 sc1
    v_mfma_f32_16x16x32_bf16 v[132:135], v[32:35], v[68:71], v[132:135]
    ds_read_b64_tr_b16 v[62:63], v6 offset:5120
    v_mfma_f32_16x16x32_bf16 v[136:139], v[36:39], v[64:67], v[136:139]
    ds_read_b64_tr_b16 v[32:33], v3 offset:8192
    v_mfma_f32_16x16x32_bf16 v[140:143], v[36:39], v[68:71], v[140:143]
    ds_read_b64_tr_b16 v[34:35], v3 offset:9216
    s_waitcnt lgkmcnt(10)
    v_mfma_f32_16x16x32_bf16 v[144:147], v[40:43], v[64:67], v[144:147]
    ds_read_b64_tr_b16 v[36:37], v4 offset:8192
    buffer_load_dwordx4 v[108:111], v2, s[4:7], s42 offen offset:256 sc1
    v_mfma_f32_16x16x32_bf16 v[148:151], v[40:43], v[68:71], v[148:151]
    ds_read_b64_tr_b16 v[38:39], v4 offset:9216
    v_mfma_f32_16x16x32_bf16 v[152:155], v[44:47], v[64:67], v[152:155]
    ds_read_b64_tr_b16 v[40:41], v5 offset:8192
    v_mfma_f32_16x16x32_bf16 v[156:159], v[44:47], v[68:71], v[156:159]
    ds_read_b64_tr_b16 v[42:43], v5 offset:9216
    s_waitcnt vmcnt(8) lgkmcnt(10)
    v_mfma_f32_16x16x32_bf16 v[128:131], v[48:51], v[72:75], v[128:131]
    ds_read_b64_tr_b16 v[44:45], v6 offset:8192
    s_xor_b32 s42, s41, 24576
    buffer_load_dwordx4 v[112:115], v2, s[4:7], s42 offen offset:0 sc1
    v_mfma_f32_16x16x32_bf16 v[132:135], v[48:51], v[76:79], v[132:135]
    ds_read_b64_tr_b16 v[46:47], v6 offset:9216
    v_mfma_f32_16x16x32_bf16 v[136:139], v[52:55], v[72:75], v[136:139]
    ds_read_b64_tr_b16 v[48:49], v3 offset:12288
    v_mfma_f32_16x16x32_bf16 v[140:143], v[52:55], v[76:79], v[140:143]
    ds_read_b64_tr_b16 v[50:51], v3 offset:13312
    s_waitcnt lgkmcnt(10)
    v_mfma_f32_16x16x32_bf16 v[144:147], v[56:59], v[72:75], v[144:147]
    ds_read_b64_tr_b16 v[52:53], v4 offset:12288
    buffer_load_dwordx4 v[116:119], v2, s[4:7], s42 offen offset:256 sc1
    v_mfma_f32_16x16x32_bf16 v[148:151], v[56:59], v[76:79], v[148:151]
    ds_read_b64_tr_b16 v[54:55], v4 offset:13312
    v_mfma_f32_16x16x32_bf16 v[152:155], v[60:63], v[72:75], v[152:155]
    ds_read_b64_tr_b16 v[56:57], v5 offset:12288
    v_mfma_f32_16x16x32_bf16 v[156:159], v[60:63], v[76:79], v[156:159]
    ds_read_b64_tr_b16 v[58:59], v5 offset:13312
    s_waitcnt vmcnt(8) lgkmcnt(10)
    v_mfma_f32_16x16x32_bf16 v[128:131], v[32:35], v[80:83], v[128:131]
    ds_read_b64_tr_b16 v[60:61], v6 offset:12288
    s_xor_b32 s42, s41, 28672
    buffer_load_dwordx4 v[120:123], v2, s[4:7], s42 offen offset:0 sc1
    v_mfma_f32_16x16x32_bf16 v[132:135], v[32:35], v[84:87], v[132:135]
    ds_read_b64_tr_b16 v[62:63], v6 offset:13312
    v_mfma_f32_16x16x32_bf16 v[136:139], v[36:39], v[80:83], v[136:139]
    ds_read_b64_tr_b16 v[32:33], v3 offset:16384
    v_mfma_f32_16x16x32_bf16 v[140:143], v[36:39], v[84:87], v[140:143]
    ds_read_b64_tr_b16 v[34:35], v3 offset:17408
    s_waitcnt lgkmcnt(10)
    v_mfma_f32_16x16x32_bf16 v[144:147], v[40:43], v[80:83], v[144:147]
    ds_read_b64_tr_b16 v[36:37], v4 offset:16384
    buffer_load_dwordx4 v[124:127], v2, s[4:7], s42 offen offset:256 sc1
    v_mfma_f32_16x16x32_bf16 v[148:151], v[40:43], v[84:87], v[148:151]
    ds_read_b64_tr_b16 v[38:39], v4 offset:17408
    v_mfma_f32_16x16x32_bf16 v[152:155], v[44:47], v[80:83], v[152:155]
    ds_read_b64_tr_b16 v[40:41], v5 offset:16384
    v_mfma_f32_16x16x32_bf16 v[156:159], v[44:47], v[84:87], v[156:159]
    ds_read_b64_tr_b16 v[42:43], v5 offset:17408
    s_waitcnt vmcnt(8) lgkmcnt(10)
    v_mfma_f32_16x16x32_bf16 v[128:131], v[48:51], v[88:91], v[128:131]
    ds_read_b64_tr_b16 v[44:45], v6 offset:16384
    s_xor_b32 s42, s41, 32768
    buffer_load_dwordx4 v[160:163], v2, s[4:7], s42 offen offset:0 sc1
    v_mfma_f32_16x16x32_bf16 v[132:135], v[48:51], v[92:95], v[132:135]
    ds_read_b64_tr_b16 v[46:47], v6 offset:17408
    v_mfma_f32_16x16x32_bf16 v[136:139], v[52:55], v[88:91], v[136:139]
    ds_read_b64_tr_b16 v[48:49], v3 offset:20480
    v_mfma_f32_16x16x32_bf16 v[140:143], v[52:55], v[92:95], v[140:143]
    ds_read_b64_tr_b16 v[50:51], v3 offset:21504
    s_waitcnt lgkmcnt(10)
    v_mfma_f32_16x16x32_bf16 v[144:147], v[56:59], v[88:91], v[144:147]
    ds_read_b64_tr_b16 v[52:53], v4 offset:20480
    buffer_load_dwordx4 v[164:167], v2, s[4:7], s42 offen offset:256 sc1
    v_mfma_f32_16x16x32_bf16 v[148:151], v[56:59], v[92:95], v[148:151]
    ds_read_b64_tr_b16 v[54:55], v4 offset:21504
    v_mfma_f32_16x16x32_bf16 v[152:155], v[60:63], v[88:91], v[152:155]
    ds_read_b64_tr_b16 v[56:57], v5 offset:20480
    v_mfma_f32_16x16x32_bf16 v[156:159], v[60:63], v[92:95], v[156:159]
    ds_read_b64_tr_b16 v[58:59], v5 offset:21504
    s_waitcnt vmcnt(8) lgkmcnt(10)
    v_mfma_f32_16x16x32_bf16 v[128:131], v[32:35], v[96:99], v[128:131]
    ds_read_b64_tr_b16 v[60:61], v6 offset:20480
    s_xor_b32 s42, s41, 36864
    buffer_load_dwordx4 v[168:171], v2, s[4:7], s42 offen offset:0 sc1
    v_mfma_f32_16x16x32_bf16 v[132:135], v[32:35], v[100:103], v[132:135]
    ds_read_b64_tr_b16 v[62:63], v6 offset:21504
    v_mfma_f32_16x16x32_bf16 v[136:139], v[36:39], v[96:99], v[136:139]
    ds_read_b64_tr_b16 v[32:33], v3 offset:24576
    v_mfma_f32_16x16x32_bf16 v[140:143], v[36:39], v[100:103], v[140:143]
    ds_read_b64_tr_b16 v[34:35], v3 offset:25600
    s_waitcnt lgkmcnt(10)
    v_mfma_f32_16x16x32_bf16 v[144:147], v[40:43], v[96:99], v[144:147]
    ds_read_b64_tr_b16 v[36:37], v4 offset:24576
    buffer_load_dwordx4 v[172:175], v2, s[4:7], s42 offen offset:256 sc1
    v_mfma_f32_16x16x32_bf16 v[148:151], v[40:43], v[100:103], v[148:151]
    ds_read_b64_tr_b16 v[38:39], v4 offset:25600
    v_mfma_f32_16x16x32_bf16 v[152:155], v[44:47], v[96:99], v[152:155]
    ds_read_b64_tr_b16 v[40:41], v5 offset:24576
    v_mfma_f32_16x16x32_bf16 v[156:159], v[44:47], v[100:103], v[156:159]
    ds_read_b64_tr_b16 v[42:43], v5 offset:25600
    s_waitcnt vmcnt(8) lgkmcnt(10)
    v_mfma_f32_16x16x32_bf16 v[128:131], v[48:51], v[104:107], v[128:131]
    ds_read_b64_tr_b16 v[44:45], v6 offset:24576
    s_xor_b32 s42, s41, 40960
    buffer_load_dwordx4 v[176:179], v2, s[4:7], s42 offen offset:0 sc1
    v_mfma_f32_16x16x32_bf16 v[132:135], v[48:51], v[108:111], v[132:135]
    ds_read_b64_tr_b16 v[46:47], v6 offset:25600
    v_mfma_f32_16x16x32_bf16 v[136:139], v[52:55], v[104:107], v[136:139]
    ds_read_b64_tr_b16 v[48:49], v3 offset:28672
    v_mfma_f32_16x16x32_bf16 v[140:143], v[52:55], v[108:111], v[140:143]
    ds_read_b64_tr_b16 v[50:51], v3 offset:29696
    s_waitcnt lgkmcnt(10)
    v_mfma_f32_16x16x32_bf16 v[144:147], v[56:59], v[104:107], v[144:147]
    ds_read_b64_tr_b16 v[52:53], v4 offset:28672
    buffer_load_dwordx4 v[180:183], v2, s[4:7], s42 offen offset:256 sc1
    v_mfma_f32_16x16x32_bf16 v[148:151], v[56:59], v[108:111], v[148:151]
    ds_read_b64_tr_b16 v[54:55], v4 offset:29696
    v_mfma_f32_16x16x32_bf16 v[152:155], v[60:63], v[104:107], v[152:155]
    ds_read_b64_tr_b16 v[56:57], v5 offset:28672
    v_mfma_f32_16x16x32_bf16 v[156:159], v[60:63], v[108:111], v[156:159]
    ds_read_b64_tr_b16 v[58:59], v5 offset:29696
    s_waitcnt vmcnt(8) lgkmcnt(10)
    v_mfma_f32_16x16x32_bf16 v[128:131], v[32:35], v[112:115], v[128:131]
    ds_read_b64_tr_b16 v[60:61], v6 offset:28672
    s_xor_b32 s42, s41, 45056
    buffer_load_dwordx4 v[184:187], v2, s[4:7], s42 offen offset:0 sc1
    v_mfma_f32_16x16x32_bf16 v[132:135], v[32:35], v[116:119], v[132:135]
    ds_read_b64_tr_b16 v[62:63], v6 offset:29696
    v_mfma_f32_16x16x32_bf16 v[136:139], v[36:39], v[112:115], v[136:139]
    ds_read_b64_tr_b16 v[32:33], v3 offset:32768
    v_mfma_f32_16x16x32_bf16 v[140:143], v[36:39], v[116:119], v[140:143]
    ds_read_b64_tr_b16 v[34:35], v3 offset:33792
    s_waitcnt lgkmcnt(10)
    v_mfma_f32_16x16x32_bf16 v[144:147], v[40:43], v[112:115], v[144:147]
    ds_read_b64_tr_b16 v[36:37], v4 offset:32768
    buffer_load_dwordx4 v[188:191], v2, s[4:7], s42 offen offset:256 sc1
    v_mfma_f32_16x16x32_bf16 v[148:151], v[40:43], v[116:119], v[148:151]
    ds_read_b64_tr_b16 v[38:39], v4 offset:33792
    v_mfma_f32_16x16x32_bf16 v[152:155], v[44:47], v[112:115], v[152:155]
    ds_read_b64_tr_b16 v[40:41], v5 offset:32768
    v_mfma_f32_16x16x32_bf16 v[156:159], v[44:47], v[116:119], v[156:159]
    ds_read_b64_tr_b16 v[42:43], v5 offset:33792
    s_waitcnt vmcnt(8) lgkmcnt(10)
    v_mfma_f32_16x16x32_bf16 v[128:131], v[48:51], v[120:123], v[128:131]
    ds_read_b64_tr_b16 v[44:45], v6 offset:32768
    s_xor_b32 s42, s41, 49152
    buffer_load_dwordx4 v[64:67], v2, s[4:7], s42 offen offset:0 sc1
    v_mfma_f32_16x16x32_bf16 v[132:135], v[48:51], v[124:127], v[132:135]
    ds_read_b64_tr_b16 v[46:47], v6 offset:33792
    v_mfma_f32_16x16x32_bf16 v[136:139], v[52:55], v[120:123], v[136:139]
    ds_read_b64_tr_b16 v[48:49], v3 offset:36864
    v_mfma_f32_16x16x32_bf16 v[140:143], v[52:55], v[124:127], v[140:143]
    ds_read_b64_tr_b16 v[50:51], v3 offset:37888
    s_waitcnt lgkmcnt(10)
    v_mfma_f32_16x16x32_bf16 v[144:147], v[56:59], v[120:123], v[144:147]
    ds_read_b64_tr_b16 v[52:53], v4 offset:36864
    buffer_load_dwordx4 v[68:71], v2, s[4:7], s42 offen offset:256 sc1
    v_mfma_f32_16x16x32_bf16 v[148:151], v[56:59], v[124:127], v[148:151]
    ds_read_b64_tr_b16 v[54:55], v4 offset:37888
    v_mfma_f32_16x16x32_bf16 v[152:155], v[60:63], v[120:123], v[152:155]
    ds_read_b64_tr_b16 v[56:57], v5 offset:36864
    v_mfma_f32_16x16x32_bf16 v[156:159], v[60:63], v[124:127], v[156:159]
    ds_read_b64_tr_b16 v[58:59], v5 offset:37888
    s_waitcnt vmcnt(8) lgkmcnt(10)
    v_mfma_f32_16x16x32_bf16 v[128:131], v[32:35], v[160:163], v[128:131]
    ds_read_b64_tr_b16 v[60:61], v6 offset:36864
    s_xor_b32 s42, s41, 53248
    buffer_load_dwordx4 v[72:75], v2, s[4:7], s42 offen offset:0 sc1
    v_mfma_f32_16x16x32_bf16 v[132:135], v[32:35], v[164:167], v[132:135]
    ds_read_b64_tr_b16 v[62:63], v6 offset:37888
    v_mfma_f32_16x16x32_bf16 v[136:139], v[36:39], v[160:163], v[136:139]
    ds_read_b64_tr_b16 v[32:33], v3 offset:40960
    v_mfma_f32_16x16x32_bf16 v[140:143], v[36:39], v[164:167], v[140:143]
    ds_read_b64_tr_b16 v[34:35], v3 offset:41984
    s_waitcnt lgkmcnt(10)
    v_mfma_f32_16x16x32_bf16 v[144:147], v[40:43], v[160:163], v[144:147]
    ds_read_b64_tr_b16 v[36:37], v4 offset:40960
    buffer_load_dwordx4 v[76:79], v2, s[4:7], s42 offen offset:256 sc1
    v_mfma_f32_16x16x32_bf16 v[148:151], v[40:43], v[164:167], v[148:151]
    ds_read_b64_tr_b16 v[38:39], v4 offset:41984
    v_mfma_f32_16x16x32_bf16 v[152:155], v[44:47], v[160:163], v[152:155]
    ds_read_b64_tr_b16 v[40:41], v5 offset:40960
    v_mfma_f32_16x16x32_bf16 v[156:159], v[44:47], v[164:167], v[156:159]
    ds_read_b64_tr_b16 v[42:43], v5 offset:41984
    s_waitcnt vmcnt(8) lgkmcnt(10)
    v_mfma_f32_16x16x32_bf16 v[128:131], v[48:51], v[168:171], v[128:131]
    ds_read_b64_tr_b16 v[44:45], v6 offset:40960
    s_xor_b32 s42, s41, 57344
    buffer_load_dwordx4 v[80:83], v2, s[4:7], s42 offen offset:0 sc1
    v_mfma_f32_16x16x32_bf16 v[132:135], v[48:51], v[172:175], v[132:135]
    ds_read_b64_tr_b16 v[46:47], v6 offset:41984
    v_mfma_f32_16x16x32_bf16 v[136:139], v[52:55], v[168:171], v[136:139]
    ds_read_b64_tr_b16 v[48:49], v3 offset:45056
    v_mfma_f32_16x16x32_bf16 v[140:143], v[52:55], v[172:175], v[140:143]
    ds_read_b64_tr_b16 v[50:51], v3 offset:46080
    s_waitcnt lgkmcnt(10)
    v_mfma_f32_16x16x32_bf16 v[144:147], v[56:59], v[168:171], v[144:147]
    ds_read_b64_tr_b16 v[52:53], v4 offset:45056
    buffer_load_dwordx4 v[84:87], v2, s[4:7], s42 offen offset:256 sc1
    v_mfma_f32_16x16x32_bf16 v[148:151], v[56:59], v[172:175], v[148:151]
    ds_read_b64_tr_b16 v[54:55], v4 offset:46080
    v_mfma_f32_16x16x32_bf16 v[152:155], v[60:63], v[168:171], v[152:155]
    ds_read_b64_tr_b16 v[56:57], v5 offset:45056
    v_mfma_f32_16x16x32_bf16 v[156:159], v[60:63], v[172:175], v[156:159]
    ds_read_b64_tr_b16 v[58:59], v5 offset:46080
    s_waitcnt vmcnt(8) lgkmcnt(10)
    v_mfma_f32_16x16x32_bf16 v[128:131], v[32:35], v[176:179], v[128:131]
    ds_read_b64_tr_b16 v[60:61], v6 offset:45056
    s_xor_b32 s42, s41, 61440
    buffer_load_dwordx4 v[88:91], v2, s[4:7], s42 offen offset:0 sc1
    v_mfma_f32_16x16x32_bf16 v[132:135], v[32:35], v[180:183], v[132:135]
    ds_read_b64_tr_b16 v[62:63], v6 offset:46080
    s_barrier
    v_mfma_f32_16x16x32_bf16 v[136:139], v[36:39], v[176:179], v[136:139]
    ds_read_b64_tr_b16 v[32:33], v3 offset:49152
    v_mfma_f32_16x16x32_bf16 v[140:143], v[36:39], v[180:183], v[140:143]
    ds_read_b64_tr_b16 v[34:35], v3 offset:50176
    s_waitcnt lgkmcnt(10)
    v_mfma_f32_16x16x32_bf16 v[144:147], v[40:43], v[176:179], v[144:147]
    ds_read_b64_tr_b16 v[36:37], v4 offset:49152
    buffer_load_dwordx4 v[92:95], v2, s[4:7], s42 offen offset:256 sc1
    v_mfma_f32_16x16x32_bf16 v[148:151], v[40:43], v[180:183], v[148:151]
    ds_read_b64_tr_b16 v[38:39], v4 offset:50176
    v_mfma_f32_16x16x32_bf16 v[152:155], v[44:47], v[176:179], v[152:155]
    ds_read_b64_tr_b16 v[40:41], v5 offset:49152
    v_mfma_f32_16x16x32_bf16 v[156:159], v[44:47], v[180:183], v[156:159]
    ds_read_b64_tr_b16 v[42:43], v5 offset:50176
    s_waitcnt vmcnt(8) lgkmcnt(10)
    v_mfma_f32_16x16x32_bf16 v[128:131], v[48:51], v[184:187], v[128:131]
    ds_read_b64_tr_b16 v[44:45], v6 offset:49152
    s_xor_b32 s42, s41, 0
    buffer_load_dwordx4 v[96:99], v2, s[4:7], s42 offen offset:2048 sc1
    v_mfma_f32_16x16x32_bf16 v[132:135], v[48:51], v[188:191], v[132:135]
    ds_read_b64_tr_b16 v[46:47], v6 offset:50176
    v_mfma_f32_16x16x32_bf16 v[136:139], v[52:55], v[184:187], v[136:139]
    ds_read_b64_tr_b16 v[48:49], v3 offset:53248
    v_mfma_f32_16x16x32_bf16 v[140:143], v[52:55], v[188:191], v[140:143]
    ds_read_b64_tr_b16 v[50:51], v3 offset:54272
    s_waitcnt lgkmcnt(10)
    v_mfma_f32_16x16x32_bf16 v[144:147], v[56:59], v[184:187], v[144:147]
    ds_read_b64_tr_b16 v[52:53], v4 offset:53248
    buffer_load_dwordx4 v[100:103], v2, s[4:7], s42 offen offset:2304 sc1
    v_mfma_f32_16x16x32_bf16 v[148:151], v[56:59], v[188:191], v[148:151]
    ds_read_b64_tr_b16 v[54:55], v4 offset:54272
    v_mfma_f32_16x16x32_bf16 v[152:155], v[60:63], v[184:187], v[152:155]
    ds_read_b64_tr_b16 v[56:57], v5 offset:53248
    v_mfma_f32_16x16x32_bf16 v[156:159], v[60:63], v[188:191], v[156:159]
    ds_read_b64_tr_b16 v[58:59], v5 offset:54272
    s_waitcnt vmcnt(8) lgkmcnt(10)
    v_mfma_f32_16x16x32_bf16 v[128:131], v[32:35], v[64:67], v[128:131]
    ds_read_b64_tr_b16 v[60:61], v6 offset:53248
    s_xor_b32 s42, s41, 4096
    buffer_load_dwordx4 v[104:107], v2, s[4:7], s42 offen offset:2048 sc1
    v_mfma_f32_16x16x32_bf16 v[132:135], v[32:35], v[68:71], v[132:135]
    ds_read_b64_tr_b16 v[62:63], v6 offset:54272
    v_mfma_f32_16x16x32_bf16 v[136:139], v[36:39], v[64:67], v[136:139]
    ds_read_b64_tr_b16 v[32:33], v3 offset:57344
    v_mfma_f32_16x16x32_bf16 v[140:143], v[36:39], v[68:71], v[140:143]
    ds_read_b64_tr_b16 v[34:35], v3 offset:58368
    s_waitcnt lgkmcnt(10)
    v_mfma_f32_16x16x32_bf16 v[144:147], v[40:43], v[64:67], v[144:147]
    ds_read_b64_tr_b16 v[36:37], v4 offset:57344
    buffer_load_dwordx4 v[108:111], v2, s[4:7], s42 offen offset:2304 sc1
    v_mfma_f32_16x16x32_bf16 v[148:151], v[40:43], v[68:71], v[148:151]
    ds_read_b64_tr_b16 v[38:39], v4 offset:58368
    v_mfma_f32_16x16x32_bf16 v[152:155], v[44:47], v[64:67], v[152:155]
    ds_read_b64_tr_b16 v[40:41], v5 offset:57344
    v_mfma_f32_16x16x32_bf16 v[156:159], v[44:47], v[68:71], v[156:159]
    ds_read_b64_tr_b16 v[42:43], v5 offset:58368
    s_waitcnt vmcnt(8) lgkmcnt(10)
    v_mfma_f32_16x16x32_bf16 v[128:131], v[48:51], v[72:75], v[128:131]
    ds_read_b64_tr_b16 v[44:45], v6 offset:57344
    s_xor_b32 s42, s41, 8192
    buffer_load_dwordx4 v[112:115], v2, s[4:7], s42 offen offset:2048 sc1
    v_mfma_f32_16x16x32_bf16 v[132:135], v[48:51], v[76:79], v[132:135]
    ds_read_b64_tr_b16 v[46:47], v6 offset:58368
    v_mfma_f32_16x16x32_bf16 v[136:139], v[52:55], v[72:75], v[136:139]
    ds_read_b64_tr_b16 v[48:49], v3 offset:61440
    v_mfma_f32_16x16x32_bf16 v[140:143], v[52:55], v[76:79], v[140:143]
    ds_read_b64_tr_b16 v[50:51], v3 offset:62464
    s_waitcnt lgkmcnt(10)
    v_mfma_f32_16x16x32_bf16 v[144:147], v[56:59], v[72:75], v[144:147]
    ds_read_b64_tr_b16 v[52:53], v4 offset:61440
    buffer_load_dwordx4 v[116:119], v2, s[4:7], s42 offen offset:2304 sc1
    v_mfma_f32_16x16x32_bf16 v[148:151], v[56:59], v[76:79], v[148:151]
    ds_read_b64_tr_b16 v[54:55], v4 offset:62464
    v_mfma_f32_16x16x32_bf16 v[152:155], v[60:63], v[72:75], v[152:155]
    ds_read_b64_tr_b16 v[56:57], v5 offset:61440
    v_mfma_f32_16x16x32_bf16 v[156:159], v[60:63], v[76:79], v[156:159]
    ds_read_b64_tr_b16 v[58:59], v5 offset:62464
    s_waitcnt vmcnt(8) lgkmcnt(10)
    v_mfma_f32_16x16x32_bf16 v[128:131], v[32:35], v[80:83], v[128:131]
    ds_read_b64_tr_b16 v[60:61], v6 offset:61440
    s_xor_b32 s42, s41, 12288
    buffer_load_dwordx4 v[120:123], v2, s[4:7], s42 offen offset:2048 sc1
    v_mfma_f32_16x16x32_bf16 v[132:135], v[32:35], v[84:87], v[132:135]
    ds_read_b64_tr_b16 v[62:63], v6 offset:62464
    v_xor_b32 v3, 0x10000, v3
    v_xor_b32 v4, 0x10000, v4
    v_xor_b32 v5, 0x10000, v5
    v_xor_b32 v6, 0x10000, v6
    v_mfma_f32_16x16x32_bf16 v[136:139], v[36:39], v[80:83], v[136:139]
    ds_read_b64_tr_b16 v[32:33], v3 offset:0
    v_mfma_f32_16x16x32_bf16 v[140:143], v[36:39], v[84:87], v[140:143]
    ds_read_b64_tr_b16 v[34:35], v3 offset:1024
    s_waitcnt lgkmcnt(10)
    v_mfma_f32_16x16x32_bf16 v[144:147], v[40:43], v[80:83], v[144:147]
    ds_read_b64_tr_b16 v[36:37], v4 offset:0
    buffer_load_dwordx4 v[124:127], v2, s[4:7], s42 offen offset:2304 sc1
    v_mfma_f32_16x16x32_bf16 v[148:151], v[40:43], v[84:87], v[148:151]
    ds_read_b64_tr_b16 v[38:39], v4 offset:1024
    v_mfma_f32_16x16x32_bf16 v[152:155], v[44:47], v[80:83], v[152:155]
    ds_read_b64_tr_b16 v[40:41], v5 offset:0
    v_mfma_f32_16x16x32_bf16 v[156:159], v[44:47], v[84:87], v[156:159]
    ds_read_b64_tr_b16 v[42:43], v5 offset:1024
    s_waitcnt vmcnt(8) lgkmcnt(10)
    v_mfma_f32_16x16x32_bf16 v[128:131], v[48:51], v[88:91], v[128:131]
    ds_read_b64_tr_b16 v[44:45], v6 offset:0
    s_xor_b32 s42, s41, 16384
    buffer_load_dwordx4 v[160:163], v2, s[4:7], s42 offen offset:2048 sc1
    v_mfma_f32_16x16x32_bf16 v[132:135], v[48:51], v[92:95], v[132:135]
    ds_read_b64_tr_b16 v[46:47], v6 offset:1024
    v_mfma_f32_16x16x32_bf16 v[136:139], v[52:55], v[88:91], v[136:139]
    ds_read_b64_tr_b16 v[48:49], v3 offset:4096
    v_mfma_f32_16x16x32_bf16 v[140:143], v[52:55], v[92:95], v[140:143]
    ds_read_b64_tr_b16 v[50:51], v3 offset:5120
    s_waitcnt lgkmcnt(10)
    v_mfma_f32_16x16x32_bf16 v[144:147], v[56:59], v[88:91], v[144:147]
    ds_read_b64_tr_b16 v[52:53], v4 offset:4096
    buffer_load_dwordx4 v[164:167], v2, s[4:7], s42 offen offset:2304 sc1
    v_mfma_f32_16x16x32_bf16 v[148:151], v[56:59], v[92:95], v[148:151]
    ds_read_b64_tr_b16 v[54:55], v4 offset:5120
    v_mfma_f32_16x16x32_bf16 v[152:155], v[60:63], v[88:91], v[152:155]
    ds_read_b64_tr_b16 v[56:57], v5 offset:4096
    v_mfma_f32_16x16x32_bf16 v[156:159], v[60:63], v[92:95], v[156:159]
    ds_read_b64_tr_b16 v[58:59], v5 offset:5120
    s_waitcnt vmcnt(8) lgkmcnt(10)
    v_mfma_f32_16x16x32_bf16 v[128:131], v[32:35], v[96:99], v[128:131]
    ds_read_b64_tr_b16 v[60:61], v6 offset:4096
    s_xor_b32 s42, s41, 20480
    buffer_load_dwordx4 v[168:171], v2, s[4:7], s42 offen offset:2048 sc1
    v_mfma_f32_16x16x32_bf16 v[132:135], v[32:35], v[100:103], v[132:135]
    ds_read_b64_tr_b16 v[62:63], v6 offset:5120
    v_mfma_f32_16x16x32_bf16 v[136:139], v[36:39], v[96:99], v[136:139]
    ds_read_b64_tr_b16 v[32:33], v3 offset:8192
    v_mfma_f32_16x16x32_bf16 v[140:143], v[36:39], v[100:103], v[140:143]
    ds_read_b64_tr_b16 v[34:35], v3 offset:9216
    s_waitcnt lgkmcnt(10)
    v_mfma_f32_16x16x32_bf16 v[144:147], v[40:43], v[96:99], v[144:147]
    ds_read_b64_tr_b16 v[36:37], v4 offset:8192
    buffer_load_dwordx4 v[172:175], v2, s[4:7], s42 offen offset:2304 sc1
    v_mfma_f32_16x16x32_bf16 v[148:151], v[40:43], v[100:103], v[148:151]
    ds_read_b64_tr_b16 v[38:39], v4 offset:9216
    v_mfma_f32_16x16x32_bf16 v[152:155], v[44:47], v[96:99], v[152:155]
    ds_read_b64_tr_b16 v[40:41], v5 offset:8192
    v_mfma_f32_16x16x32_bf16 v[156:159], v[44:47], v[100:103], v[156:159]
    ds_read_b64_tr_b16 v[42:43], v5 offset:9216
    s_waitcnt vmcnt(8) lgkmcnt(10)
    v_mfma_f32_16x16x32_bf16 v[128:131], v[48:51], v[104:107], v[128:131]
    ds_read_b64_tr_b16 v[44:45], v6 offset:8192
    s_xor_b32 s42, s41, 24576
    buffer_load_dwordx4 v[176:179], v2, s[4:7], s42 offen offset:2048 sc1
    v_mfma_f32_16x16x32_bf16 v[132:135], v[48:51], v[108:111], v[132:135]
    ds_read_b64_tr_b16 v[46:47], v6 offset:9216
    v_mfma_f32_16x16x32_bf16 v[136:139], v[52:55], v[104:107], v[136:139]
    ds_read_b64_tr_b16 v[48:49], v3 offset:12288
    v_mfma_f32_16x16x32_bf16 v[140:143], v[52:55], v[108:111], v[140:143]
    ds_read_b64_tr_b16 v[50:51], v3 offset:13312
    s_waitcnt lgkmcnt(10)
    v_mfma_f32_16x16x32_bf16 v[144:147], v[56:59], v[104:107], v[144:147]
    ds_read_b64_tr_b16 v[52:53], v4 offset:12288
    buffer_load_dwordx4 v[180:183], v2, s[4:7], s42 offen offset:2304 sc1
    v_mfma_f32_16x16x32_bf16 v[148:151], v[56:59], v[108:111], v[148:151]
    ds_read_b64_tr_b16 v[54:55], v4 offset:13312
    v_mfma_f32_16x16x32_bf16 v[152:155], v[60:63], v[104:107], v[152:155]
    ds_read_b64_tr_b16 v[56:57], v5 offset:12288
    v_mfma_f32_16x16x32_bf16 v[156:159], v[60:63], v[108:111], v[156:159]
    ds_read_b64_tr_b16 v[58:59], v5 offset:13312
    s_waitcnt vmcnt(8) lgkmcnt(10)
    v_mfma_f32_16x16x32_bf16 v[128:131], v[32:35], v[112:115], v[128:131]
    ds_read_b64_tr_b16 v[60:61], v6 offset:12288
    s_xor_b32 s42, s41, 28672
    buffer_load_dwordx4 v[184:187], v2, s[4:7], s42 offen offset:2048 sc1
    v_mfma_f32_16x16x32_bf16 v[132:135], v[32:35], v[116:119], v[132:135]
    ds_read_b64_tr_b16 v[62:63], v6 offset:13312
    v_mfma_f32_16x16x32_bf16 v[136:139], v[36:39], v[112:115], v[136:139]
    ds_read_b64_tr_b16 v[32:33], v3 offset:16384
    v_mfma_f32_16x16x32_bf16 v[140:143], v[36:39], v[116:119], v[140:143]
    ds_read_b64_tr_b16 v[34:35], v3 offset:17408
    s_waitcnt lgkmcnt(10)
    v_mfma_f32_16x16x32_bf16 v[144:147], v[40:43], v[112:115], v[144:147]
    ds_read_b64_tr_b16 v[36:37], v4 offset:16384
    buffer_load_dwordx4 v[188:191], v2, s[4:7], s42 offen offset:2304 sc1
    v_mfma_f32_16x16x32_bf16 v[148:151], v[40:43], v[116:119], v[148:151]
    ds_read_b64_tr_b16 v[38:39], v4 offset:17408
    v_mfma_f32_16x16x32_bf16 v[152:155], v[44:47], v[112:115], v[152:155]
    ds_read_b64_tr_b16 v[40:41], v5 offset:16384
    v_mfma_f32_16x16x32_bf16 v[156:159], v[44:47], v[116:119], v[156:159]
    ds_read_b64_tr_b16 v[42:43], v5 offset:17408
    s_waitcnt vmcnt(8) lgkmcnt(10)
    v_mfma_f32_16x16x32_bf16 v[128:131], v[48:51], v[120:123], v[128:131]
    ds_read_b64_tr_b16 v[44:45], v6 offset:16384
    s_xor_b32 s42, s41, 32768
    buffer_load_dwordx4 v[64:67], v2, s[4:7], s42 offen offset:2048 sc1
    v_mfma_f32_16x16x32_bf16 v[132:135], v[48:51], v[124:127], v[132:135]
    ds_read_b64_tr_b16 v[46:47], v6 offset:17408
    v_mfma_f32_16x16x32_bf16 v[136:139], v[52:55], v[120:123], v[136:139]
    ds_read_b64_tr_b16 v[48:49], v3 offset:20480
    v_mfma_f32_16x16x32_bf16 v[140:143], v[52:55], v[124:127], v[140:143]
    ds_read_b64_tr_b16 v[50:51], v3 offset:21504
    s_waitcnt lgkmcnt(10)
    v_mfma_f32_16x16x32_bf16 v[144:147], v[56:59], v[120:123], v[144:147]
    ds_read_b64_tr_b16 v[52:53], v4 offset:20480
    buffer_load_dwordx4 v[68:71], v2, s[4:7], s42 offen offset:2304 sc1
    v_mfma_f32_16x16x32_bf16 v[148:151], v[56:59], v[124:127], v[148:151]
    ds_read_b64_tr_b16 v[54:55], v4 offset:21504
    v_mfma_f32_16x16x32_bf16 v[152:155], v[60:63], v[120:123], v[152:155]
    ds_read_b64_tr_b16 v[56:57], v5 offset:20480
    v_mfma_f32_16x16x32_bf16 v[156:159], v[60:63], v[124:127], v[156:159]
    ds_read_b64_tr_b16 v[58:59], v5 offset:21504
    s_waitcnt vmcnt(8) lgkmcnt(10)
    v_mfma_f32_16x16x32_bf16 v[128:131], v[32:35], v[160:163], v[128:131]
    ds_read_b64_tr_b16 v[60:61], v6 offset:20480
    s_xor_b32 s42, s41, 36864
    buffer_load_dwordx4 v[72:75], v2, s[4:7], s42 offen offset:2048 sc1
    v_mfma_f32_16x16x32_bf16 v[132:135], v[32:35], v[164:167], v[132:135]
    ds_read_b64_tr_b16 v[62:63], v6 offset:21504
    v_mfma_f32_16x16x32_bf16 v[136:139], v[36:39], v[160:163], v[136:139]
    ds_read_b64_tr_b16 v[32:33], v3 offset:24576
    v_mfma_f32_16x16x32_bf16 v[140:143], v[36:39], v[164:167], v[140:143]
    ds_read_b64_tr_b16 v[34:35], v3 offset:25600
    s_waitcnt lgkmcnt(10)
    v_mfma_f32_16x16x32_bf16 v[144:147], v[40:43], v[160:163], v[144:147]
    ds_read_b64_tr_b16 v[36:37], v4 offset:24576
    buffer_load_dwordx4 v[76:79], v2, s[4:7], s42 offen offset:2304 sc1
    v_mfma_f32_16x16x32_bf16 v[148:151], v[40:43], v[164:167], v[148:151]
    ds_read_b64_tr_b16 v[38:39], v4 offset:25600
    v_mfma_f32_16x16x32_bf16 v[152:155], v[44:47], v[160:163], v[152:155]
    ds_read_b64_tr_b16 v[40:41], v5 offset:24576
    v_mfma_f32_16x16x32_bf16 v[156:159], v[44:47], v[164:167], v[156:159]
    ds_read_b64_tr_b16 v[42:43], v5 offset:25600
    s_waitcnt vmcnt(8) lgkmcnt(10)
    v_mfma_f32_16x16x32_bf16 v[128:131], v[48:51], v[168:171], v[128:131]
    ds_read_b64_tr_b16 v[44:45], v6 offset:24576
    s_xor_b32 s42, s41, 40960
    buffer_load_dwordx4 v[80:83], v2, s[4:7], s42 offen offset:2048 sc1
    v_mfma_f32_16x16x32_bf16 v[132:135], v[48:51], v[172:175], v[132:135]
    ds_read_b64_tr_b16 v[46:47], v6 offset:25600
    v_mfma_f32_16x16x32_bf16 v[136:139], v[52:55], v[168:171], v[136:139]
    ds_read_b64_tr_b16 v[48:49], v3 offset:28672
    v_mfma_f32_16x16x32_bf16 v[140:143], v[52:55], v[172:175], v[140:143]
    ds_read_b64_tr_b16 v[50:51], v3 offset:29696
    s_waitcnt lgkmcnt(10)
    v_mfma_f32_16x16x32_bf16 v[144:147], v[56:59], v[168:171], v[144:147]
    ds_read_b64_tr_b16 v[52:53], v4 offset:28672
    buffer_load_dwordx4 v[84:87], v2, s[4:7], s42 offen offset:2304 sc1
    v_mfma_f32_16x16x32_bf16 v[148:151], v[56:59], v[172:175], v[148:151]
    ds_read_b64_tr_b16 v[54:55], v4 offset:29696
    v_mfma_f32_16x16x32_bf16 v[152:155], v[60:63], v[168:171], v[152:155]
    ds_read_b64_tr_b16 v[56:57], v5 offset:28672
    v_mfma_f32_16x16x32_bf16 v[156:159], v[60:63], v[172:175], v[156:159]
    ds_read_b64_tr_b16 v[58:59], v5 offset:29696
    s_waitcnt vmcnt(8) lgkmcnt(10)
    v_mfma_f32_16x16x32_bf16 v[128:131], v[32:35], v[176:179], v[128:131]
    ds_read_b64_tr_b16 v[60:61], v6 offset:28672
    s_xor_b32 s42, s41, 45056
    buffer_load_dwordx4 v[88:91], v2, s[4:7], s42 offen offset:2048 sc1
    v_mfma_f32_16x16x32_bf16 v[132:135], v[32:35], v[180:183], v[132:135]
    ds_read_b64_tr_b16 v[62:63], v6 offset:29696
    v_mfma_f32_16x16x32_bf16 v[136:139], v[36:39], v[176:179], v[136:139]
    ds_read_b64_tr_b16 v[32:33], v3 offset:32768
    v_mfma_f32_16x16x32_bf16 v[140:143], v[36:39], v[180:183], v[140:143]
    ds_read_b64_tr_b16 v[34:35], v3 offset:33792
    s_waitcnt lgkmcnt(10)
    v_mfma_f32_16x16x32_bf16 v[144:147], v[40:43], v[176:179], v[144:147]
    ds_read_b64_tr_b16 v[36:37], v4 offset:32768
    buffer_load_dwordx4 v[92:95], v2, s[4:7], s42 offen offset:2304 sc1
    v_mfma_f32_16x16x32_bf16 v[148:151], v[40:43], v[180:183], v[148:151]
    ds_read_b64_tr_b16 v[38:39], v4 offset:33792
    v_mfma_f32_16x16x32_bf16 v[152:155], v[44:47], v[176:179], v[152:155]
    ds_read_b64_tr_b16 v[40:41], v5 offset:32768
    v_mfma_f32_16x16x32_bf16 v[156:159], v[44:47], v[180:183], v[156:159]
    ds_read_b64_tr_b16 v[42:43], v5 offset:33792
    s_waitcnt vmcnt(8) lgkmcnt(10)
    v_mfma_f32_16x16x32_bf16 v[128:131], v[48:51], v[184:187], v[128:131]
    ds_read_b64_tr_b16 v[44:45], v6 offset:32768
    s_xor_b32 s42, s41, 49152
    buffer_load_dwordx4 v[96:99], v2, s[4:7], s42 offen offset:2048 sc1
    v_mfma_f32_16x16x32_bf16 v[132:135], v[48:51], v[188:191], v[132:135]
    ds_read_b64_tr_b16 v[46:47], v6 offset:33792
    v_mfma_f32_16x16x32_bf16 v[136:139], v[52:55], v[184:187], v[136:139]
    ds_read_b64_tr_b16 v[48:49], v3 offset:36864
    v_mfma_f32_16x16x32_bf16 v[140:143], v[52:55], v[188:191], v[140:143]
    ds_read_b64_tr_b16 v[50:51], v3 offset:37888
    s_waitcnt lgkmcnt(10)
    v_mfma_f32_16x16x32_bf16 v[144:147], v[56:59], v[184:187], v[144:147]
    ds_read_b64_tr_b16 v[52:53], v4 offset:36864
    buffer_load_dwordx4 v[100:103], v2, s[4:7], s42 offen offset:2304 sc1
    v_mfma_f32_16x16x32_bf16 v[148:151], v[56:59], v[188:191], v[148:151]
    ds_read_b64_tr_b16 v[54:55], v4 offset:37888
    v_mfma_f32_16x16x32_bf16 v[152:155], v[60:63], v[184:187], v[152:155]
    ds_read_b64_tr_b16 v[56:57], v5 offset:36864
    v_mfma_f32_16x16x32_bf16 v[156:159], v[60:63], v[188:191], v[156:159]
    ds_read_b64_tr_b16 v[58:59], v5 offset:37888
    s_waitcnt vmcnt(8) lgkmcnt(10)
    v_mfma_f32_16x16x32_bf16 v[128:131], v[32:35], v[64:67], v[128:131]
    ds_read_b64_tr_b16 v[60:61], v6 offset:36864
    s_xor_b32 s42, s41, 53248
    buffer_load_dwordx4 v[104:107], v2, s[4:7], s42 offen offset:2048 sc1
    v_mfma_f32_16x16x32_bf16 v[132:135], v[32:35], v[68:71], v[132:135]
    ds_read_b64_tr_b16 v[62:63], v6 offset:37888
    v_mfma_f32_16x16x32_bf16 v[136:139], v[36:39], v[64:67], v[136:139]
    ds_read_b64_tr_b16 v[32:33], v3 offset:40960
    v_mfma_f32_16x16x32_bf16 v[140:143], v[36:39], v[68:71], v[140:143]
    ds_read_b64_tr_b16 v[34:35], v3 offset:41984
    s_waitcnt lgkmcnt(10)
    v_mfma_f32_16x16x32_bf16 v[144:147], v[40:43], v[64:67], v[144:147]
    ds_read_b64_tr_b16 v[36:37], v4 offset:40960
    buffer_load_dwordx4 v[108:111], v2, s[4:7], s42 offen offset:2304 sc1
    v_mfma_f32_16x16x32_bf16 v[148:151], v[40:43], v[68:71], v[148:151]
    ds_read_b64_tr_b16 v[38:39], v4 offset:41984
    v_mfma_f32_16x16x32_bf16 v[152:155], v[44:47], v[64:67], v[152:155]
    ds_read_b64_tr_b16 v[40:41], v5 offset:40960
    v_mfma_f32_16x16x32_bf16 v[156:159], v[44:47], v[68:71], v[156:159]
    ds_read_b64_tr_b16 v[42:43], v5 offset:41984
    s_waitcnt vmcnt(8) lgkmcnt(10)
    v_mfma_f32_16x16x32_bf16 v[128:131], v[48:51], v[72:75], v[128:131]
    ds_read_b64_tr_b16 v[44:45], v6 offset:40960
    s_xor_b32 s42, s41, 57344
    buffer_load_dwordx4 v[112:115], v2, s[4:7], s42 offen offset:2048 sc1
    v_mfma_f32_16x16x32_bf16 v[132:135], v[48:51], v[76:79], v[132:135]
    ds_read_b64_tr_b16 v[46:47], v6 offset:41984
    v_mfma_f32_16x16x32_bf16 v[136:139], v[52:55], v[72:75], v[136:139]
    ds_read_b64_tr_b16 v[48:49], v3 offset:45056
    v_mfma_f32_16x16x32_bf16 v[140:143], v[52:55], v[76:79], v[140:143]
    ds_read_b64_tr_b16 v[50:51], v3 offset:46080
    s_waitcnt lgkmcnt(10)
    v_mfma_f32_16x16x32_bf16 v[144:147], v[56:59], v[72:75], v[144:147]
    ds_read_b64_tr_b16 v[52:53], v4 offset:45056
    buffer_load_dwordx4 v[116:119], v2, s[4:7], s42 offen offset:2304 sc1
    v_mfma_f32_16x16x32_bf16 v[148:151], v[56:59], v[76:79], v[148:151]
    ds_read_b64_tr_b16 v[54:55], v4 offset:46080
    v_mfma_f32_16x16x32_bf16 v[152:155], v[60:63], v[72:75], v[152:155]
    ds_read_b64_tr_b16 v[56:57], v5 offset:45056
    v_mfma_f32_16x16x32_bf16 v[156:159], v[60:63], v[76:79], v[156:159]
    ds_read_b64_tr_b16 v[58:59], v5 offset:46080
    s_waitcnt vmcnt(8) lgkmcnt(10)
    v_mfma_f32_16x16x32_bf16 v[128:131], v[32:35], v[80:83], v[128:131]
    ds_read_b64_tr_b16 v[60:61], v6 offset:45056
    s_xor_b32 s42, s41, 61440
    buffer_load_dwordx4 v[120:123], v2, s[4:7], s42 offen offset:2048 sc1
    v_mfma_f32_16x16x32_bf16 v[132:135], v[32:35], v[84:87], v[132:135]
    ds_read_b64_tr_b16 v[62:63], v6 offset:46080
    v_mfma_f32_16x16x32_bf16 v[136:139], v[36:39], v[80:83], v[136:139]
    ds_read_b64_tr_b16 v[32:33], v3 offset:49152
    v_mfma_f32_16x16x32_bf16 v[140:143], v[36:39], v[84:87], v[140:143]
    ds_read_b64_tr_b16 v[34:35], v3 offset:50176
    s_waitcnt lgkmcnt(10)
    v_mfma_f32_16x16x32_bf16 v[144:147], v[40:43], v[80:83], v[144:147]
    ds_read_b64_tr_b16 v[36:37], v4 offset:49152
    buffer_load_dwordx4 v[124:127], v2, s[4:7], s42 offen offset:2304 sc1
    v_mfma_f32_16x16x32_bf16 v[148:151], v[40:43], v[84:87], v[148:151]
    ds_read_b64_tr_b16 v[38:39], v4 offset:50176
    v_mfma_f32_16x16x32_bf16 v[152:155], v[44:47], v[80:83], v[152:155]
    ds_read_b64_tr_b16 v[40:41], v5 offset:49152
    v_mfma_f32_16x16x32_bf16 v[156:159], v[44:47], v[84:87], v[156:159]
    ds_read_b64_tr_b16 v[42:43], v5 offset:50176
    s_waitcnt vmcnt(8) lgkmcnt(10)
    v_mfma_f32_16x16x32_bf16 v[128:131], v[48:51], v[88:91], v[128:131]
    ds_read_b64_tr_b16 v[44:45], v6 offset:49152
    v_mfma_f32_16x16x32_bf16 v[132:135], v[48:51], v[92:95], v[132:135]
    ds_read_b64_tr_b16 v[46:47], v6 offset:50176
    v_mfma_f32_16x16x32_bf16 v[136:139], v[52:55], v[88:91], v[136:139]
    ds_read_b64_tr_b16 v[48:49], v3 offset:53248
    v_mfma_f32_16x16x32_bf16 v[140:143], v[52:55], v[92:95], v[140:143]
    ds_read_b64_tr_b16 v[50:51], v3 offset:54272
    s_waitcnt lgkmcnt(10)
    v_mfma_f32_16x16x32_bf16 v[144:147], v[56:59], v[88:91], v[144:147]
    ds_read_b64_tr_b16 v[52:53], v4 offset:53248
    v_mfma_f32_16x16x32_bf16 v[148:151], v[56:59], v[92:95], v[148:151]
    ds_read_b64_tr_b16 v[54:55], v4 offset:54272
    v_mfma_f32_16x16x32_bf16 v[152:155], v[60:63], v[88:91], v[152:155]
    ds_read_b64_tr_b16 v[56:57], v5 offset:53248
    v_mfma_f32_16x16x32_bf16 v[156:159], v[60:63], v[92:95], v[156:159]
    ds_read_b64_tr_b16 v[58:59], v5 offset:54272
    s_waitcnt vmcnt(6) lgkmcnt(10)
    v_mfma_f32_16x16x32_bf16 v[128:131], v[32:35], v[96:99], v[128:131]
    ds_read_b64_tr_b16 v[60:61], v6 offset:53248
    v_mfma_f32_16x16x32_bf16 v[132:135], v[32:35], v[100:103], v[132:135]
    ds_read_b64_tr_b16 v[62:63], v6 offset:54272
    v_mfma_f32_16x16x32_bf16 v[136:139], v[36:39], v[96:99], v[136:139]
    ds_read_b64_tr_b16 v[32:33], v3 offset:57344
    v_mfma_f32_16x16x32_bf16 v[140:143], v[36:39], v[100:103], v[140:143]
    ds_read_b64_tr_b16 v[34:35], v3 offset:58368
    s_waitcnt lgkmcnt(10)
    v_mfma_f32_16x16x32_bf16 v[144:147], v[40:43], v[96:99], v[144:147]
    ds_read_b64_tr_b16 v[36:37], v4 offset:57344
    v_mfma_f32_16x16x32_bf16 v[148:151], v[40:43], v[100:103], v[148:151]
    ds_read_b64_tr_b16 v[38:39], v4 offset:58368
    v_mfma_f32_16x16x32_bf16 v[152:155], v[44:47], v[96:99], v[152:155]
    ds_read_b64_tr_b16 v[40:41], v5 offset:57344
    v_mfma_f32_16x16x32_bf16 v[156:159], v[44:47], v[100:103], v[156:159]
    ds_read_b64_tr_b16 v[42:43], v5 offset:58368
    s_waitcnt vmcnt(4) lgkmcnt(10)
    v_mfma_f32_16x16x32_bf16 v[128:131], v[48:51], v[104:107], v[128:131]
    ds_read_b64_tr_b16 v[44:45], v6 offset:57344
    v_mfma_f32_16x16x32_bf16 v[132:135], v[48:51], v[108:111], v[132:135]
    ds_read_b64_tr_b16 v[46:47], v6 offset:58368
    v_mfma_f32_16x16x32_bf16 v[136:139], v[52:55], v[104:107], v[136:139]
    ds_read_b64_tr_b16 v[48:49], v3 offset:61440
    v_mfma_f32_16x16x32_bf16 v[140:143], v[52:55], v[108:111], v[140:143]
    ds_read_b64_tr_b16 v[50:51], v3 offset:62464
    s_waitcnt lgkmcnt(10)
    v_mfma_f32_16x16x32_bf16 v[144:147], v[56:59], v[104:107], v[144:147]
    ds_read_b64_tr_b16 v[52:53], v4 offset:61440
    v_mfma_f32_16x16x32_bf16 v[148:151], v[56:59], v[108:111], v[148:151]
    ds_read_b64_tr_b16 v[54:55], v4 offset:62464
    v_mfma_f32_16x16x32_bf16 v[152:155], v[60:63], v[104:107], v[152:155]
    ds_read_b64_tr_b16 v[56:57], v5 offset:61440
    v_mfma_f32_16x16x32_bf16 v[156:159], v[60:63], v[108:111], v[156:159]
    ds_read_b64_tr_b16 v[58:59], v5 offset:62464
    s_waitcnt vmcnt(2) lgkmcnt(10)
    v_mfma_f32_16x16x32_bf16 v[128:131], v[32:35], v[112:115], v[128:131]
    ds_read_b64_tr_b16 v[60:61], v6 offset:61440
    v_mfma_f32_16x16x32_bf16 v[132:135], v[32:35], v[116:119], v[132:135]
    ds_read_b64_tr_b16 v[62:63], v6 offset:62464
    v_xor_b32 v3, 0x10000, v3
    v_xor_b32 v4, 0x10000, v4
    v_xor_b32 v5, 0x10000, v5
    v_xor_b32 v6, 0x10000, v6
    v_mfma_f32_16x16x32_bf16 v[136:139], v[36:39], v[112:115], v[136:139]
    v_mfma_f32_16x16x32_bf16 v[140:143], v[36:39], v[116:119], v[140:143]
    s_waitcnt lgkmcnt(8)
    v_mfma_f32_16x16x32_bf16 v[144:147], v[40:43], v[112:115], v[144:147]
    v_mfma_f32_16x16x32_bf16 v[148:151], v[40:43], v[116:119], v[148:151]
    v_mfma_f32_16x16x32_bf16 v[152:155], v[44:47], v[112:115], v[152:155]
    v_mfma_f32_16x16x32_bf16 v[156:159], v[44:47], v[116:119], v[156:159]
    s_waitcnt vmcnt(0) lgkmcnt(4)
    v_mfma_f32_16x16x32_bf16 v[128:131], v[48:51], v[120:123], v[128:131]
    v_mfma_f32_16x16x32_bf16 v[132:135], v[48:51], v[124:127], v[132:135]
    v_mfma_f32_16x16x32_bf16 v[136:139], v[52:55], v[120:123], v[136:139]
    v_mfma_f32_16x16x32_bf16 v[140:143], v[52:55], v[124:127], v[140:143]
    s_waitcnt lgkmcnt(0)
    v_mfma_f32_16x16x32_bf16 v[144:147], v[56:59], v[120:123], v[144:147]
    v_mfma_f32_16x16x32_bf16 v[148:151], v[56:59], v[124:127], v[148:151]
    v_mfma_f32_16x16x32_bf16 v[152:155], v[60:63], v[120:123], v[152:155]
    v_mfma_f32_16x16x32_bf16 v[156:159], v[60:63], v[124:127], v[156:159]
    s_cmp_eq_u32 s21, 3
    s_cbranch_scc1 c_final
    s_add_u32 s43, s43, 4194304
    v_cvt_pk_bf16_f32 v160, v128, v129
    v_cvt_pk_bf16_f32 v161, v130, v131
    v_cvt_pk_bf16_f32 v162, v136, v137
    v_cvt_pk_bf16_f32 v163, v138, v139
    v_cvt_pk_bf16_f32 v168, v144, v145
    v_cvt_pk_bf16_f32 v169, v146, v147
    v_cvt_pk_bf16_f32 v170, v152, v153
    v_cvt_pk_bf16_f32 v171, v154, v155
    v_permlane32_swap_b32 v160, v162
    v_permlane32_swap_b32 v161, v163
    buffer_store_dwordx4 v[160:163], v2, s[4:7], s43 offen offset:0 sc1
    v_permlane32_swap_b32 v168, v170
    v_permlane32_swap_b32 v169, v171
    buffer_store_dwordx4 v[168:171], v2, s[4:7], s43 offen offset:2048 sc1
    v_cvt_pk_bf16_f32 v164, v132, v133
    v_cvt_pk_bf16_f32 v165, v134, v135
    v_cvt_pk_bf16_f32 v166, v140, v141
    v_cvt_pk_bf16_f32 v167, v142, v143
    v_cvt_pk_bf16_f32 v172, v148, v149
    v_cvt_pk_bf16_f32 v173, v150, v151
    v_cvt_pk_bf16_f32 v174, v156, v157
    v_cvt_pk_bf16_f32 v175, v158, v159
    v_permlane32_swap_b32 v164, v166
    v_permlane32_swap_b32 v165, v167
    buffer_store_dwordx4 v[164:167], v2, s[4:7], s43 offen offset:256 sc1
    v_permlane32_swap_b32 v172, v174
    v_permlane32_swap_b32 v173, v175
    buffer_store_dwordx4 v[172:175], v2, s[4:7], s43 offen offset:2304 sc1
    s_barrier
    v_mov_b32 v12, 0x3f803f80
    v_mov_b32 v14, 0
    v_mov_b32 v15, 0
    v_mov_b32 v16, 0
    v_mov_b32 v17, 0
    v_dot2_f32_bf16 v14, v160, v12, v14
    v_dot2_f32_bf16 v15, v160, v160, v15
    v_dot2_f32_bf16 v16, v164, v12, v16
    v_dot2_f32_bf16 v17, v164, v164, v17
    v_dot2_f32_bf16 v14, v161, v12, v14
    v_dot2_f32_bf16 v15, v161, v161, v15
    v_dot2_f32_bf16 v16, v165, v12, v16
    v_dot2_f32_bf16 v17, v165, v165, v17
    v_dot2_f32_bf16 v14, v162, v12, v14
    v_dot2_f32_bf16 v15, v162, v162, v15
    v_dot2_f32_bf16 v16, v166, v12, v16
    v_dot2_f32_bf16 v17, v166, v166, v17
    v_dot2_f32_bf16 v14, v163, v12, v14
    v_dot2_f32_bf16 v15, v163, v163, v15
    v_dot2_f32_bf16 v16, v167, v12, v16
    v_dot2_f32_bf16 v17, v167, v167, v17
    v_dot2_f32_bf16 v14, v168, v12, v14
    v_dot2_f32_bf16 v15, v168, v168, v15
    v_dot2_f32_bf16 v16, v172, v12, v16
    v_dot2_f32_bf16 v17, v172, v172, v17
    v_dot2_f32_bf16 v14, v169, v12, v14
    v_dot2_f32_bf16 v15, v169, v169, v15
    v_dot2_f32_bf16 v16, v173, v12, v16
    v_dot2_f32_bf16 v17, v173, v173, v17
    v_dot2_f32_bf16 v14, v170, v12, v14
    v_dot2_f32_bf16 v15, v170, v170, v15
    v_dot2_f32_bf16 v16, v174, v12, v16
    v_dot2_f32_bf16 v17, v174, v174, v17
    v_dot2_f32_bf16 v14, v171, v12, v14
    v_dot2_f32_bf16 v15, v171, v171, v15
    v_dot2_f32_bf16 v16, v175, v12, v16
    v_dot2_f32_bf16 v17, v175, v175, v17
    s_nop 2
    v_permlane16_swap_b32 v14, v16
    v_permlane16_swap_b32 v15, v17
    v_pk_add_f32 v[14:15], v[14:15], v[16:17]
    v_mov_b32 v16, v14
    v_mov_b32 v17, v15
    s_nop 0
    v_permlane32_swap_b32 v14, v16
    v_permlane32_swap_b32 v15, v17
    v_pk_add_f32 v[14:15], v[14:15], v[16:17]
    v_lshrrev_b32 v13, 1, v1
    v_and_b32 v13, 0xf8, v13
    s_add_u32 s21, s21, 1
    s_lshl_b32 s44, s21, 18
    s_lshl_b32 s45, s39, 12
    s_add_u32 s44, s44, s45
    s_lshl_b32 s45, s20, 8
    s_add_u32 s44, s44, s45
    s_add_u32 s44, s44, 50331648
    buffer_store_dwordx2 v[14:15], v13, s[4:7], s44 offen sc1
    s_lshl_b32 s46, s21, 14
    s_lshl_b32 s67, s39, 7
    s_add_u32 s46, s46, s67
    s_add_u32 s46, s46, 4096
    s_add_u32 s47, s46, 8192
    s_waitcnt vmcnt(1)
    s_atomic_add s40, s[22:23], s46
    s_branch c_layer
c_final:
    s_mov_b32 s8, s32
    s_mov_b32 s9, s33
    s_mov_b32 s10, 4194304
    s_mov_b32 s11, 0x00020000
    v_lshrrev_b32 v12, 4, v1
    s_mul_i32 s44, s16, 4608
    s_add_u32 s44, s44, 131072
    v_and_b32 v13, 15, v12
    v_mul_u32_u24 v13, 144, v13
    v_lshrrev_b32 v14, 4, v12
    v_lshl_add_u32 v13, v14, 3, v13
    v_add_u32 v13, s44, v13
    v_cvt_pk_bf16_f32 v128, v128, v129
    v_cvt_pk_bf16_f32 v129, v130, v131
    ds_write_b64 v13, v[128:129] offset:0
    v_cvt_pk_bf16_f32 v136, v136, v137
    v_cvt_pk_bf16_f32 v137, v138, v139
    ds_write_b64 v13, v[136:137] offset:32
    v_cvt_pk_bf16_f32 v144, v144, v145
    v_cvt_pk_bf16_f32 v145, v146, v147
    ds_write_b64 v13, v[144:145] offset:64
    v_cvt_pk_bf16_f32 v152, v152, v153
    v_cvt_pk_bf16_f32 v153, v154, v155
    ds_write_b64 v13, v[152:153] offset:96
    v_cvt_pk_bf16_f32 v132, v132, v133
    v_cvt_pk_bf16_f32 v133, v134, v135
    ds_write_b64 v13, v[132:133] offset:2304
    v_cvt_pk_bf16_f32 v140, v140, v141
    v_cvt_pk_bf16_f32 v141, v142, v143
    ds_write_b64 v13, v[140:141] offset:2336
    v_cvt_pk_bf16_f32 v148, v148, v149
    v_cvt_pk_bf16_f32 v149, v150, v151
    ds_write_b64 v13, v[148:149] offset:2368
    v_cvt_pk_bf16_f32 v156, v156, v157
    v_cvt_pk_bf16_f32 v157, v158, v159
    ds_write_b64 v13, v[156:157] offset:2400
    v_lshrrev_b32 v14, 3, v12
    v_and_b32 v15, 7, v12
    v_mul_u32_u24 v16, 144, v14
    v_lshl_add_u32 v16, v15, 4, v16
    v_add_u32 v16, s44, v16
    v_lshlrev_b32 v17, 11, v14
    v_lshl_add_u32 v17, v15, 4, v17
    ds_read_b128 v[32:35], v16 offset:0
    ds_read_b128 v[36:39], v16 offset:1152
    ds_read_b128 v[40:43], v16 offset:2304
    ds_read_b128 v[44:47], v16 offset:3456
    s_lshl_b32 s44, s39, 16
    s_lshl_b32 s45, s20, 7
    s_add_u32 s44, s44, s45
    s_waitcnt lgkmcnt(3)
    buffer_store_dwordx4 v[32:35], v17, s[8:11], s44 offen sc1
    s_add_u32 s44, s44, 16384
    s_waitcnt lgkmcnt(2)
    buffer_store_dwordx4 v[36:39], v17, s[8:11], s44 offen sc1
    s_add_u32 s44, s44, 16384
    s_waitcnt lgkmcnt(1)
    buffer_store_dwordx4 v[40:43], v17, s[8:11], s44 offen sc1
    s_add_u32 s44, s44, 16384
    s_waitcnt lgkmcnt(0)
    buffer_store_dwordx4 v[44:47], v17, s[8:11], s44 offen sc1
    s_endpgm
h_start:
    v_mov_b32 v20, 0
    v_mov_b32 v21, 0
    v_mov_b32 v22, 0
    v_mov_b32 v23, 0
    s_cmp_lt_u32 s2, 10
    s_cbranch_scc0 h_z0
    s_load_dword s101, s[34:35], 192
    s_lshl_b32 s44, s2, 11
    s_mov_b32 s45, 0
    s_atomic_swap s45, s[22:23], s44 offset:0
    s_atomic_swap s45, s[22:23], s44 offset:128
    s_atomic_swap s45, s[22:23], s44 offset:256
    s_atomic_swap s45, s[22:23], s44 offset:384
    s_atomic_swap s45, s[22:23], s44 offset:512
    s_atomic_swap s45, s[22:23], s44 offset:640
    s_atomic_swap s45, s[22:23], s44 offset:768
    s_atomic_swap s45, s[22:23], s44 offset:896
    s_atomic_swap s45, s[22:23], s44 offset:1024
    s_atomic_swap s45, s[22:23], s44 offset:1152
    s_atomic_swap s45, s[22:23], s44 offset:1280
    s_atomic_swap s45, s[22:23], s44 offset:1408
    s_atomic_swap s45, s[22:23], s44 offset:1536
    s_atomic_swap s45, s[22:23], s44 offset:1664
    s_atomic_swap s45, s[22:23], s44 offset:1792
    s_atomic_swap s45, s[22:23], s44 offset:1920
    s_waitcnt lgkmcnt(0)
    s_atomic_add s40, s[34:35], 0
h_z0:
    v_lshrrev_b32 v24, 4, v1
    v_lshrrev_b32 v25, 3, v24
    v_mul_u32_u24 v12, 6144, v25
    v_and_b32 v26, 2, v25
    v_lshrrev_b32 v25, 2, v25
    v_or_b32 v26, v26, v25
    v_bfe_u32 v25, v24, 1, 2
    v_xor_b32 v26, v26, v25
    v_lshl_add_u32 v12, v26, 5, v12
    v_and_b32 v26, 1, v24
    v_lshl_add_u32 v12, v26, 4, v12
    s_lshl_b32 s3, s18, 7
    v_add_u32 v12, s3, v12
    v_add_u32 v13, 48128, v12
    v_add_u32 v14, 96256, v12
    v_add_u32 v15, 144384, v12
    v_lshrrev_b32 v24, 4, v1
    v_lshrrev_b32 v25, 3, v24
    v_mul_u32_u24 v16, 2048, v25
    v_and_b32 v26, 2, v25
    v_lshrrev_b32 v25, 2, v25
    v_or_b32 v26, v26, v25
    v_bfe_u32 v25, v24, 1, 2
    v_xor_b32 v26, v26, v25
    v_lshl_add_u32 v16, v26, 5, v16
    v_and_b32 v26, 1, v24
    v_lshl_add_u32 v16, v26, 4, v16
    s_lshl_b32 s3, s20, 7
    v_add_u32 v16, s3, v16
    v_add_u32 v17, 15360, v16
    v_add_u32 v18, 30720, v16
    v_add_u32 v19, 46080, v16
    s_mul_i32 s84, s18, 393216
    s_cmp_eq_u32 s18, 1
    s_cselect_b32 s85, 0, 393216
    s_cmp_eq_u32 s18, 2
    s_cselect_b32 s86, 0, 786432
    s_cmp_eq_u32 s18, 3
    s_cselect_b32 s87, 0, 1179648
    s_cmp_eq_u32 s18, 4
    s_cselect_b32 s88, 0, 1572864
    s_cmp_eq_u32 s18, 5
    s_cselect_b32 s89, 0, 1966080
    s_cmp_eq_u32 s18, 6
    s_cselect_b32 s90, 0, 2359296
    s_cmp_eq_u32 s18, 7
    s_cselect_b32 s91, 0, 2752512
    s_cmp_eq_u32 s18, 8
    s_cselect_b32 s92, 0, 3145728
    s_cmp_eq_u32 s18, 9
    s_cselect_b32 s93, 0, 3538944
    s_cmp_eq_u32 s18, 10
    s_cselect_b32 s94, 0, 3932160
    s_cmp_eq_u32 s18, 11
    s_cselect_b32 s95, 0, 4325376
    s_cmp_eq_u32 s18, 12
    s_cselect_b32 s96, 0, 4718592
    s_cmp_eq_u32 s18, 13
    s_cselect_b32 s97, 0, 5111808
    s_cmp_eq_u32 s18, 14
    s_cselect_b32 s98, 0, 5505024
    s_cmp_eq_u32 s18, 15
    s_cselect_b32 s99, 0, 5898240
    s_and_b32 s3, s16, 3
    s_mul_i32 s3, s3, 49152
    v_add_u32 v11, s3, v12
    s_and_b32 s3, s16, 3
    s_lshl_b32 s3, s3, 10
    v_add_u32 v9, s3, v1
    v_add_u32 v10, 0x10000, v9
    v_lshrrev_b32 v24, 4, v1
    v_and_b32 v25, 15, v24
    v_lshrrev_b32 v24, 4, v24
    v_lshlrev_b32 v24, 2, v24
    v_sub_u32 v24, v25, v24
    v_mov_b32 v25, 0xf149f2ca
    v_add_u32 v26, 0x0, v24
    v_and_b32 v26, 0xfffffff1, v26
    v_cmp_eq_u32 vcc, 0, v26
    s_nop 1
    v_cndmask_b32 v32, v25, 0, vcc
    v_add_u32 v26, 0xffffffff, v24
    v_and_b32 v26, 0xfffffff1, v26
    v_cmp_eq_u32 vcc, 0, v26
    s_nop 1
    v_cndmask_b32 v33, v25, 0, vcc
    v_add_u32 v26, 0xfffffffe, v24
    v_and_b32 v26, 0xfffffff1, v26
    v_cmp_eq_u32 vcc, 0, v26
    s_nop 1
    v_cndmask_b32 v34, v25, 0, vcc
    v_add_u32 v26, 0xfffffffd, v24
    v_and_b32 v26, 0xfffffff1, v26
    v_cmp_eq_u32 vcc, 0, v26
    s_nop 1
    v_cndmask_b32 v35, v25, 0, vcc
    v_add_u32 v26, 0x10, v24
    v_and_b32 v26, 0xfffffff1, v26
    v_cmp_eq_u32 vcc, 0, v26
    s_nop 1
    v_cndmask_b32 v36, v25, 0, vcc
    v_add_u32 v26, 0xf, v24
    v_and_b32 v26, 0xfffffff1, v26
    v_cmp_eq_u32 vcc, 0, v26
    s_nop 1
    v_cndmask_b32 v37, v25, 0, vcc
    v_add_u32 v26, 0xe, v24
    v_and_b32 v26, 0xfffffff1, v26
    v_cmp_eq_u32 vcc, 0, v26
    s_nop 1
    v_cndmask_b32 v38, v25, 0, vcc
    v_add_u32 v26, 0xd, v24
    v_and_b32 v26, 0xfffffff1, v26
    v_cmp_eq_u32 vcc, 0, v26
    s_nop 1
    v_cndmask_b32 v39, v25, 0, vcc
    v_add_u32 v24, 153600, v1
    ds_write_b128 v24, v[32:35] offset:0
    ds_write_b128 v24, v[36:39] offset:1024
    s_barrier
    s_waitcnt lgkmcnt(0)
    s_lshl_b32 s44, s21, 14
    s_lshl_b32 s67, s17, 9
    s_add_u32 s44, s44, s67
    s_add_u32 s44, s44, 4096
    s_barrier
    s_mov_b32 s66, 0x10000
h_s0_poll:
    s_mov_b32 s68, 0
    s_mov_b32 s69, 0
    s_mov_b32 s70, 0
    s_mov_b32 s71, 0
    s_atomic_add s68, s[22:23], s44 offset:0 glc
    s_atomic_add s69, s[22:23], s44 offset:128 glc
    s_atomic_add s70, s[22:23], s44 offset:256 glc
    s_atomic_add s71, s[22:23], s44 offset:384 glc
    s_sub_u32 s66, s66, 1
    s_cselect_b32 s67, 16, 0
    s_waitcnt lgkmcnt(0)
    s_and_b32 s68, s68, s69
    s_and_b32 s68, s68, s70
    s_and_b32 s68, s68, s71
    s_max_u32 s68, s68, s67
    s_cmp_lt_u32 s68, 16
    s_cbranch_scc1 h_s0_poll
h_s0_ok:
    s_barrier
    s_lshr_b32 s3, s2, 3
    s_cmp_eq_u32 s3, 2
    s_cbranch_scc0 h_g4
    s_mul_i32 s44, s2, 24576
    s_add_u32 s44, s44, 58347520
    s_mov_b32 s45, 24
h_zloop:
    buffer_store_dwordx4 v[20:23], v1, s[4:7], s44 offen sc1
    s_add_u32 s44, s44, 1024
    s_sub_u32 s45, s45, 1
    s_cmp_lg_u32 s45, 0
    s_cbranch_scc1 h_zloop
    s_branch h_g4
h_layer:
    s_waitcnt lgkmcnt(0)
    s_barrier
h_g4:
    s_barrier
    s_lshl_b32 s44, s21, 14
    s_lshl_b32 s67, s17, 9
    s_add_u32 s44, s44, s67
    s_add_u32 s44, s44, 12288
    s_mov_b32 s66, 0x10000
h_s_poll:
    s_mov_b32 s68, 0
    s_mov_b32 s69, 0
    s_mov_b32 s70, 0
    s_mov_b32 s71, 0
    s_atomic_add s68, s[22:23], s44 offset:0 glc
    s_atomic_add s69, s[22:23], s44 offset:128 glc
    s_atomic_add s70, s[22:23], s44 offset:256 glc
    s_atomic_add s71, s[22:23], s44 offset:384 glc
    s_sub_u32 s66, s66, 1
    s_cselect_b32 s67, 16, 0
    s_waitcnt lgkmcnt(0)
    s_and_b32 s68, s68, s69
    s_and_b32 s68, s68, s70
    s_and_b32 s68, s68, s71
    s_max_u32 s68, s68, s67
    s_cmp_lt_u32 s68, 16
    s_cbranch_scc1 h_s_poll
h_s_ok:
    s_barrier
    s_lshl_b32 s44, s21, 18
    s_lshl_b32 s45, s17, 14
    s_add_u32 s44, s44, s45
    s_add_u32 s44, s44, 50331648
    buffer_load_dwordx4 v[32:35], v1, s[4:7], s44 offen offset:0 sc1
    buffer_load_dwordx4 v[36:39], v1, s[4:7], s44 offen offset:1024 sc1
    buffer_load_dwordx4 v[40:43], v1, s[4:7], s44 offen offset:2048 sc1
    buffer_load_dwordx4 v[44:47], v1, s[4:7], s44 offen offset:3072 sc1
    s_add_u32 s44, s44, 4096
    buffer_load_dwordx4 v[48:51], v1, s[4:7], s44 offen offset:0 sc1
    buffer_load_dwordx4 v[52:55], v1, s[4:7], s44 offen offset:1024 sc1
    buffer_load_dwordx4 v[56:59], v1, s[4:7], s44 offen offset:2048 sc1
    buffer_load_dwordx4 v[60:63], v1, s[4:7], s44 offen offset:3072 sc1
    s_add_u32 s44, s44, 4096
    buffer_load_dwordx4 v[64:67], v1, s[4:7], s44 offen offset:0 sc1
    buffer_load_dwordx4 v[68:71], v1, s[4:7], s44 offen offset:1024 sc1
    buffer_load_dwordx4 v[72:75], v1, s[4:7], s44 offen offset:2048 sc1
    buffer_load_dwordx4 v[76:79], v1, s[4:7], s44 offen offset:3072 sc1
    s_add_u32 s44, s44, 4096
    buffer_load_dwordx4 v[80:83], v1, s[4:7], s44 offen offset:0 sc1
    buffer_load_dwordx4 v[84:87], v1, s[4:7], s44 offen offset:1024 sc1
    buffer_load_dwordx4 v[88:91], v1, s[4:7], s44 offen offset:2048 sc1
    buffer_load_dwordx4 v[92:95], v1, s[4:7], s44 offen offset:3072 sc1
    s_barrier
    s_cmp_ge_u32 s21, 2
    s_cbranch_scc1 h_c_ok
    s_lshl_b32 s44, s21, 11
    s_lshl_b32 s67, s18, 7
    s_add_u32 s44, s44, s67
    s_add_u32 s44, s44, 0
    s_mov_b32 s66, 0x10000
h_c_poll:
    s_mov_b32 s68, 0
    s_atomic_add s68, s[22:23], s44 offset:0 glc
    s_sub_u32 s66, s66, 1
    s_cselect_b32 s67, 48, 0
    s_waitcnt lgkmcnt(0)
    s_max_u32 s68, s68, s67
    s_cmp_lt_u32 s68, 48
    s_cbranch_scc1 h_c_poll
h_c_ok:
    s_waitcnt vmcnt(0)
    s_lshl_b32 s3, s21, 8
    s_add_u32 s3, s3, s2
    s_lshr_b32 s3, s3, 3
    s_cmp_eq_u32 s3, 2
    s_cbranch_scc0 h_nf1
    s_atomic_add s40, s[34:35], 128
h_nf1:
    s_barrier
    s_cmp_ge_u32 s21, 2
    s_cbranch_scc1 h_cs1
    s_lshl_b32 s44, s21, 18
    s_lshl_b32 s45, s18, 14
    s_add_u32 s44, s44, s45
    s_add_u32 s44, s44, 52428800
    buffer_load_dwordx4 v[96:99], v1, s[4:7], s44 offen offset:0 sc1
    buffer_load_dwordx4 v[100:103], v1, s[4:7], s44 offen offset:1024 sc1
    buffer_load_dwordx4 v[104:107], v1, s[4:7], s44 offen offset:2048 sc1
    buffer_load_dwordx4 v[108:111], v1, s[4:7], s44 offen offset:3072 sc1
    s_add_u32 s44, s44, 4096
    buffer_load_dwordx4 v[112:115], v1, s[4:7], s44 offen offset:0 sc1
    buffer_load_dwordx4 v[116:119], v1, s[4:7], s44 offen offset:1024 sc1
    buffer_load_dwordx4 v[120:123], v1, s[4:7], s44 offen offset:2048 sc1
    buffer_load_dwordx4 v[124:127], v1, s[4:7], s44 offen offset:3072 sc1
    s_add_u32 s44, s44, 4096
    buffer_load_dwordx4 v[128:131], v1, s[4:7], s44 offen offset:0 sc1
    buffer_load_dwordx4 v[132:135], v1, s[4:7], s44 offen offset:1024 sc1
    buffer_load_dwordx4 v[136:139], v1, s[4:7], s44 offen offset:2048 sc1
    buffer_load_dwordx4 v[140:143], v1, s[4:7], s44 offen offset:3072 sc1
    s_add_u32 s44, s44, 4096
    buffer_load_dwordx4 v[144:147], v1, s[4:7], s44 offen offset:0 sc1
    buffer_load_dwordx4 v[148:151], v1, s[4:7], s44 offen offset:1024 sc1
    buffer_load_dwordx4 v[152:155], v1, s[4:7], s44 offen offset:2048 sc1
    buffer_load_dwordx4 v[156:159], v1, s[4:7], s44 offen offset:3072 sc1
h_cs1:
    v_add_f32 v32, v32, v36
    v_add_f32 v33, v33, v37
    v_add_f32 v34, v34, v38
    v_add_f32 v35, v35, v39
    v_add_f32 v48, v48, v52
    v_add_f32 v49, v49, v53
    v_add_f32 v50, v50, v54
    v_add_f32 v51, v51, v55
    v_add_f32 v64, v64, v68
    v_add_f32 v65, v65, v69
    v_add_f32 v66, v66, v70
    v_add_f32 v67, v67, v71
    v_add_f32 v80, v80, v84
    v_add_f32 v81, v81, v85
    v_add_f32 v82, v82, v86
    v_add_f32 v83, v83, v87
    v_add_f32 v32, v32, v40
    v_add_f32 v33, v33, v41
    v_add_f32 v34, v34, v42
    v_add_f32 v35, v35, v43
    v_add_f32 v48, v48, v56
    v_add_f32 v49, v49, v57
    v_add_f32 v50, v50, v58
    v_add_f32 v51, v51, v59
    v_add_f32 v64, v64, v72
    v_add_f32 v65, v65, v73
    v_add_f32 v66, v66, v74
    v_add_f32 v67, v67, v75
    v_add_f32 v80, v80, v88
    v_add_f32 v81, v81, v89
    v_add_f32 v82, v82, v90
    v_add_f32 v83, v83, v91
    s_barrier
    v_add_f32 v32, v32, v44
    v_add_f32 v33, v33, v45
    v_add_f32 v34, v34, v46
    v_add_f32 v35, v35, v47
    v_add_f32 v48, v48, v60
    v_add_f32 v49, v49, v61
    v_add_f32 v50, v50, v62
    v_add_f32 v51, v51, v63
    v_add_f32 v64, v64, v76
    v_add_f32 v65, v65, v77
    v_add_f32 v66, v66, v78
    v_add_f32 v67, v67, v79
    v_add_f32 v80, v80, v92
    v_add_f32 v81, v81, v93
    v_add_f32 v82, v82, v94
    v_add_f32 v83, v83, v95
    v_permlane32_swap_b32 v32, v64
    v_permlane32_swap_b32 v33, v65
    v_permlane32_swap_b32 v34, v66
    v_permlane32_swap_b32 v35, v67
    v_add_f32 v32, v32, v64
    v_add_f32 v33, v33, v65
    v_add_f32 v34, v34, v66
    v_add_f32 v35, v35, v67
    v_permlane32_swap_b32 v48, v80
    v_permlane32_swap_b32 v49, v81
    v_permlane32_swap_b32 v50, v82
    v_permlane32_swap_b32 v51, v83
    v_add_f32 v48, v48, v80
    v_add_f32 v49, v49, v81
    v_add_f32 v50, v50, v82
    v_add_f32 v51, v51, v83
    v_permlane16_swap_b32 v32, v48
    v_permlane16_swap_b32 v33, v49
    v_permlane16_swap_b32 v34, v50
    v_permlane16_swap_b32 v35, v51
    v_add_f32 v32, v32, v48
    v_add_f32 v33, v33, v49
    v_add_f32 v34, v34, v50
    v_add_f32 v35, v35, v51
    s_barrier
    v_mul_f32 v32, 0x3a800000, v32
    v_mul_f32 v33, 0x3a800000, v33
    v_mul_f32 v34, 0x3a800000, v34
    v_mul_f32 v35, 0x3a800000, v35
    v_fma_f32 v33, -v32, v32, v33
    v_fma_f32 v35, -v34, v34, v35
    v_max_f32 v33, 0, v33
    v_max_f32 v35, 0, v35
    v_add_f32 v33, 0x3727c5ac, v33
    v_add_f32 v35, 0x3727c5ac, v35
    v_rsq_f32 v33, v33
    v_rsq_f32 v35, v35
    v_lshrrev_b32 v26, 1, v1
    v_add_u32 v26, 155648, v26
    ds_write2_b32 v26, v32, v34 offset0:0 offset1:1
    ds_write2_b32 v26, v33, v35 offset0:128 offset1:129
    s_barrier
    s_cmp_ge_u32 s21, 2
    s_cbranch_scc1 h_cs_done
    s_waitcnt vmcnt(0)
    v_add_f32 v96, v96, v100
    v_add_f32 v97, v97, v101
    v_add_f32 v98, v98, v102
    v_add_f32 v99, v99, v103
    v_add_f32 v96, v96, v104
    v_add_f32 v97, v97, v105
    v_add_f32 v98, v98, v106
    v_add_f32 v99, v99, v107
    v_add_f32 v96, v96, v108
    v_add_f32 v97, v97, v109
    v_add_f32 v98, v98, v110
    v_add_f32 v99, v99, v111
    v_add_f32 v96, v96, v112
    v_add_f32 v97, v97, v113
    v_add_f32 v98, v98, v114
    v_add_f32 v99, v99, v115
    v_add_f32 v96, v96, v116
    v_add_f32 v97, v97, v117
    v_add_f32 v98, v98, v118
    v_add_f32 v99, v99, v119
    v_add_f32 v96, v96, v120
    v_add_f32 v97, v97, v121
    v_add_f32 v98, v98, v122
    v_add_f32 v99, v99, v123
    v_add_f32 v96, v96, v124
    v_add_f32 v97, v97, v125
    v_add_f32 v98, v98, v126
    v_add_f32 v99, v99, v127
    v_add_f32 v96, v96, v128
    v_add_f32 v97, v97, v129
    v_add_f32 v98, v98, v130
    v_add_f32 v99, v99, v131
    v_add_f32 v96, v96, v132
    v_add_f32 v97, v97, v133
    v_add_f32 v98, v98, v134
    v_add_f32 v99, v99, v135
    v_add_f32 v96, v96, v136
    v_add_f32 v97, v97, v137
    v_add_f32 v98, v98, v138
    v_add_f32 v99, v99, v139
    v_add_f32 v96, v96, v140
    v_add_f32 v97, v97, v141
    v_add_f32 v98, v98, v142
    v_add_f32 v99, v99, v143
    v_add_f32 v96, v96, v144
    v_add_f32 v97, v97, v145
    v_add_f32 v98, v98, v146
    v_add_f32 v99, v99, v147
    v_add_f32 v96, v96, v148
    v_add_f32 v97, v97, v149
    v_add_f32 v98, v98, v150
    v_add_f32 v99, v99, v151
    v_add_f32 v96, v96, v152
    v_add_f32 v97, v97, v153
    v_add_f32 v98, v98, v154
    v_add_f32 v99, v99, v155
    v_add_f32 v96, v96, v156
    v_add_f32 v97, v97, v157
    v_add_f32 v98, v98, v158
    v_add_f32 v99, v99, v159
    s_lshl_b32 s44, s21, 10
    s_add_u32 s44, s44, 151552
    v_add_u32 v24, s44, v1
    ds_write_b128 v24, v[96:99]
h_cs_done:
    s_waitcnt lgkmcnt(0)
    s_barrier
    s_cmp_lg_u32 s21, 0
    s_cbranch_scc1 h_f1_ok
    s_load_dword s68, s[34:35], 128
    s_mov_b32 s8, s34
    s_mov_b32 s9, s35
    s_mov_b32 s10, 256
    s_mov_b32 s11, 0x00020000
    s_mov_b32 s66, 0x10000
    v_mov_b32 v24, 0
    s_waitcnt lgkmcnt(0)
h_f1:
    s_cmp_eq_u32 s68, 8
    s_cbranch_scc1 h_f1_ok
    buffer_load_dword v25, v24, s[8:11], 0 offen offset:128 sc1
    s_waitcnt vmcnt(0)
    v_readfirstlane_b32 s68, v25
    s_sub_u32 s66, s66, 1
    s_cmp_lg_u32 s66, 0
    s_cbranch_scc1 h_f1
h_f1_ok:
    s_barrier
    s_bitcmp1_b32 s21, 0
    s_cselect_b32 s8, s28, s24
    s_cselect_b32 s9, s29, s25
    s_cselect_b32 s12, s30, s26
    s_cselect_b32 s13, s31, s27
    s_mov_b32 s10, 6291456
    s_mov_b32 s11, 0x00020000
    s_mov_b32 s14, 2097152
    s_mov_b32 s15, 0x00020000
    v_lshrrev_b32 v28, 4, v1
    v_and_b32 v29, 7, v28
    v_lshrrev_b32 v28, 3, v28
    v_mul_u32_u24 v28, 2048, v28
    v_lshl_add_u32 v28, v29, 4, v28
    s_and_b32 s3, s20, 12
    s_or_b32 s3, s3, 3
    s_lshl_b32 s3, s3, 7
    v_add_u32 v28, s3, v28
    s_lshr_b32 s3, s2, 3
    s_lshl_b32 s3, s3, 2
    s_and_b32 s60, s16, 3
    s_add_u32 s60, s60, s3
    s_lshl_b32 s61, s60, 14
    buffer_load_dwordx4 v[144:147], v28, s[12:15], s61 offen
    s_bitcmp0_b32 s21, 0
    s_cselect_b32 s56, s28, s24
    s_cselect_b32 s57, s29, s25
    s_mov_b32 s58, 6291456
    s_mov_b32 s59, 0x00020000
    v_lshrrev_b32 v28, 4, v1
    v_and_b32 v29, 7, v28
    v_lshrrev_b32 v28, 3, v28
    v_mul_u32_u24 v28, 6144, v28
    v_lshl_add_u32 v28, v29, 4, v28
    s_and_b32 s3, s18, 12
    s_or_b32 s3, s3, 3
    s_lshl_b32 s3, s3, 7
    v_add_u32 v28, s3, v28
    s_lshr_b32 s3, s2, 3
    s_lshl_b32 s3, s3, 2
    s_and_b32 s60, s16, 3
    s_add_u32 s60, s60, s3
    s_and_b32 s3, s60, 31
    s_mul_i32 s3, s3, 49152
    s_lshr_b32 s61, s60, 5
    s_min_u32 s61, s61, 2
    s_lshl_b32 s61, s61, 11
    s_add_u32 s61, s61, s3
    s_and_b32 s3, s18, 0
    s_mul_i32 s3, s3, 393216
    s_add_u32 s61, s61, s3
    buffer_load_dwordx4 v[148:151], v28, s[56:59], s61 offen
    s_cmp_lg_u32 s21, 2
    s_cbranch_scc1 h_pe
    s_bitcmp0_b32 s21, 0
    s_cselect_b32 s56, s28, s24
    s_cselect_b32 s57, s29, s25
    s_mov_b32 s58, 6291456
    s_mov_b32 s59, 0x00020000
    s_add_u32 s61, s84, 2048
    buffer_load_dwordx4 v[160:163], v11, s[56:59], s61 offen
    s_add_u32 s61, s84, 4096
    buffer_load_dwordx4 v[164:167], v11, s[56:59], s61 offen
    s_add_u32 s61, s84, 0
    buffer_load_dwordx4 v[168:171], v11, s[56:59], s61 offen
    s_add_u32 s61, s84, 198656
    buffer_load_dwordx4 v[172:175], v11, s[56:59], s61 offen
    s_add_u32 s61, s84, 200704
    buffer_load_dwordx4 v[176:179], v11, s[56:59], s61 offen
    s_add_u32 s61, s84, 196608
    buffer_load_dwordx4 v[180:183], v11, s[56:59], s61 offen
    s_add_u32 s61, s85, 2048
    buffer_load_dwordx4 v[184:187], v11, s[56:59], s61 offen
    s_add_u32 s61, s85, 4096
    buffer_load_dwordx4 v[188:191], v11, s[56:59], s61 offen
    s_add_u32 s61, s85, 0
    buffer_load_dwordx4 v[192:195], v11, s[56:59], s61 offen
    s_add_u32 s61, s85, 198656
    buffer_load_dwordx4 v[196:199], v11, s[56:59], s61 offen
h_pe:
    s_barrier
    s_branch s_tail
l_start:
    v_lshrrev_b32 v24, 4, v1
    v_lshrrev_b32 v25, 3, v24
    v_mul_u32_u24 v12, 6144, v25
    v_and_b32 v26, 2, v25
    v_lshrrev_b32 v25, 2, v25
    v_or_b32 v26, v26, v25
    v_bfe_u32 v25, v24, 1, 2
    v_xor_b32 v26, v26, v25
    v_lshl_add_u32 v12, v26, 5, v12
    v_and_b32 v26, 1, v24
    v_lshl_add_u32 v12, v26, 4, v12
    s_lshl_b32 s3, s18, 7
    v_add_u32 v12, s3, v12
    v_add_u32 v13, 48128, v12
    v_add_u32 v14, 96256, v12
    v_add_u32 v15, 144384, v12
    v_lshrrev_b32 v24, 4, v1
    v_lshrrev_b32 v25, 3, v24
    v_mul_u32_u24 v16, 2048, v25
    v_and_b32 v26, 2, v25
    v_lshrrev_b32 v25, 2, v25
    v_or_b32 v26, v26, v25
    v_bfe_u32 v25, v24, 1, 2
    v_xor_b32 v26, v26, v25
    v_lshl_add_u32 v16, v26, 5, v16
    v_and_b32 v26, 1, v24
    v_lshl_add_u32 v16, v26, 4, v16
    s_lshl_b32 s3, s20, 7
    v_add_u32 v16, s3, v16
    v_add_u32 v17, 15360, v16
    v_add_u32 v18, 30720, v16
    v_add_u32 v19, 46080, v16
    s_mul_i32 s84, s18, 393216
    s_cmp_eq_u32 s18, 1
    s_cselect_b32 s85, 0, 393216
    s_cmp_eq_u32 s18, 2
    s_cselect_b32 s86, 0, 786432
    s_cmp_eq_u32 s18, 3
    s_cselect_b32 s87, 0, 1179648
    s_cmp_eq_u32 s18, 4
    s_cselect_b32 s88, 0, 1572864
    s_cmp_eq_u32 s18, 5
    s_cselect_b32 s89, 0, 1966080
    s_cmp_eq_u32 s18, 6
    s_cselect_b32 s90, 0, 2359296
    s_cmp_eq_u32 s18, 7
    s_cselect_b32 s91, 0, 2752512
    s_cmp_eq_u32 s18, 8
    s_cselect_b32 s92, 0, 3145728
    s_cmp_eq_u32 s18, 9
    s_cselect_b32 s93, 0, 3538944
    s_cmp_eq_u32 s18, 10
    s_cselect_b32 s94, 0, 3932160
    s_cmp_eq_u32 s18, 11
    s_cselect_b32 s95, 0, 4325376
    s_cmp_eq_u32 s18, 12
    s_cselect_b32 s96, 0, 4718592
    s_cmp_eq_u32 s18, 13
    s_cselect_b32 s97, 0, 5111808
    s_cmp_eq_u32 s18, 14
    s_cselect_b32 s98, 0, 5505024
    s_cmp_eq_u32 s18, 15
    s_cselect_b32 s99, 0, 5898240
    s_and_b32 s3, s16, 3
    s_mul_i32 s3, s3, 49152
    v_add_u32 v11, s3, v12
    s_and_b32 s3, s16, 3
    s_lshl_b32 s3, s3, 10
    v_add_u32 v9, s3, v1
    v_add_u32 v10, 0x10000, v9
    s_sub_u32 s3, s16, 5
    s_lshl_b32 s41, s3, 11
    s_mul_i32 s42, s3, 98304
    s_lshl_b32 s62, s3, 15
    v_add_u32 v14, s42, v12
    v_add_u32 v15, s42, v13
    s_and_b32 s3, s20, 0
    s_lshl_b32 s3, s3, 17
    s_add_u32 s62, s62, s3
    s_bitcmp1_b32 s21, 0
    s_cselect_b32 s8, s28, s24
    s_cselect_b32 s9, s29, s25
    s_cselect_b32 s12, s30, s26
    s_cselect_b32 s13, s31, s27
    s_mov_b32 s10, 6291456
    s_mov_b32 s11, 0x00020000
    s_mov_b32 s14, 2097152
    s_mov_b32 s15, 0x00020000
    s_add_u32 m0, s41, 0
    s_add_u32 s44, s84, 2048
    buffer_load_dwordx4 v14, s[8:11], s44 offen offset:0 lds
    buffer_load_dwordx4 v15, s[8:11], s44 offen offset:1024 lds
    s_add_u32 m0, s41, 4096
    s_add_u32 s44, s84, 4096
    buffer_load_dwordx4 v14, s[8:11], s44 offen offset:0 lds
    buffer_load_dwordx4 v15, s[8:11], s44 offen offset:1024 lds
    s_add_u32 m0, s41, 8192
    s_add_u32 s44, s84, 0
    buffer_load_dwordx4 v14, s[8:11], s44 offen offset:0 lds
    buffer_load_dwordx4 v15, s[8:11], s44 offen offset:1024 lds
    s_add_u32 m0, s41, 12288
    s_add_u32 s44, s84, 198656
    buffer_load_dwordx4 v14, s[8:11], s44 offen offset:0 lds
    buffer_load_dwordx4 v15, s[8:11], s44 offen offset:1024 lds
    s_add_u32 m0, s41, 16384
    s_add_u32 s44, s84, 200704
    buffer_load_dwordx4 v14, s[8:11], s44 offen offset:0 lds
    buffer_load_dwordx4 v15, s[8:11], s44 offen offset:1024 lds
    s_add_u32 m0, s41, 20480
    s_add_u32 s44, s84, 196608
    buffer_load_dwordx4 v14, s[8:11], s44 offen offset:0 lds
    buffer_load_dwordx4 v15, s[8:11], s44 offen offset:1024 lds
    s_add_u32 m0, s41, 24576
    s_add_u32 s44, s85, 2048
    buffer_load_dwordx4 v14, s[8:11], s44 offen offset:0 lds
    buffer_load_dwordx4 v15, s[8:11], s44 offen offset:1024 lds
    s_add_u32 m0, s41, 28672
    s_add_u32 s44, s85, 4096
    buffer_load_dwordx4 v14, s[8:11], s44 offen offset:0 lds
    buffer_load_dwordx4 v15, s[8:11], s44 offen offset:1024 lds
    s_barrier
    s_waitcnt vmcnt(0)
    s_barrier
    s_add_u32 m0, s41, 32768
    s_add_u32 s44, s85, 0
    buffer_load_dwordx4 v14, s[8:11], s44 offen offset:0 lds
    buffer_load_dwordx4 v15, s[8:11], s44 offen offset:1024 lds
    s_add_u32 m0, s41, 36864
    s_add_u32 s44, s85, 198656
    buffer_load_dwordx4 v14, s[8:11], s44 offen offset:0 lds
    buffer_load_dwordx4 v15, s[8:11], s44 offen offset:1024 lds
    s_add_u32 m0, s41, 40960
    s_add_u32 s44, s85, 200704
    buffer_load_dwordx4 v14, s[8:11], s44 offen offset:0 lds
    buffer_load_dwordx4 v15, s[8:11], s44 offen offset:1024 lds
    s_add_u32 m0, s41, 45056
    s_add_u32 s44, s85, 196608
    buffer_load_dwordx4 v14, s[8:11], s44 offen offset:0 lds
    buffer_load_dwordx4 v15, s[8:11], s44 offen offset:1024 lds
    s_add_u32 m0, s41, 49152
    s_add_u32 s44, s86, 2048
    buffer_load_dwordx4 v14, s[8:11], s44 offen offset:0 lds
    buffer_load_dwordx4 v15, s[8:11], s44 offen offset:1024 lds
    s_add_u32 m0, s41, 53248
    s_add_u32 s44, s86, 4096
    buffer_load_dwordx4 v14, s[8:11], s44 offen offset:0 lds
    buffer_load_dwordx4 v15, s[8:11], s44 offen offset:1024 lds
    s_add_u32 m0, s41, 57344
    s_add_u32 s44, s86, 0
    buffer_load_dwordx4 v14, s[8:11], s44 offen offset:0 lds
    buffer_load_dwordx4 v15, s[8:11], s44 offen offset:1024 lds
    s_add_u32 m0, s41, 61440
    s_add_u32 s44, s86, 198656
    buffer_load_dwordx4 v14, s[8:11], s44 offen offset:0 lds
    buffer_load_dwordx4 v15, s[8:11], s44 offen offset:1024 lds
    s_waitcnt vmcnt(0)
    s_barrier
    s_add_u32 m0, s41, 65536
    s_add_u32 s44, s86, 200704
    buffer_load_dwordx4 v14, s[8:11], s44 offen offset:0 lds
    buffer_load_dwordx4 v15, s[8:11], s44 offen offset:1024 lds
    s_add_u32 m0, s41, 69632
    s_add_u32 s44, s86, 196608
    buffer_load_dwordx4 v14, s[8:11], s44 offen offset:0 lds
    buffer_load_dwordx4 v15, s[8:11], s44 offen offset:1024 lds
    s_add_u32 m0, s41, 73728
    s_add_u32 s44, s87, 2048
    buffer_load_dwordx4 v14, s[8:11], s44 offen offset:0 lds
    buffer_load_dwordx4 v15, s[8:11], s44 offen offset:1024 lds
    s_add_u32 m0, s41, 77824
    s_add_u32 s44, s87, 4096
    buffer_load_dwordx4 v14, s[8:11], s44 offen offset:0 lds
    buffer_load_dwordx4 v15, s[8:11], s44 offen offset:1024 lds
    s_add_u32 m0, s41, 81920
    s_add_u32 s44, s87, 0
    buffer_load_dwordx4 v14, s[8:11], s44 offen offset:0 lds
    buffer_load_dwordx4 v15, s[8:11], s44 offen offset:1024 lds
    s_add_u32 m0, s41, 86016
    s_add_u32 s44, s87, 198656
    buffer_load_dwordx4 v14, s[8:11], s44 offen offset:0 lds
    buffer_load_dwordx4 v15, s[8:11], s44 offen offset:1024 lds
    s_add_u32 m0, s41, 90112
    s_add_u32 s44, s87, 200704
    buffer_load_dwordx4 v14, s[8:11], s44 offen offset:0 lds
    buffer_load_dwordx4 v15, s[8:11], s44 offen offset:1024 lds
    s_add_u32 m0, s41, 94208
    s_add_u32 s44, s87, 196608
    buffer_load_dwordx4 v14, s[8:11], s44 offen offset:0 lds
    buffer_load_dwordx4 v15, s[8:11], s44 offen offset:1024 lds
    s_add_u32 m0, s41, 98304
    s_add_u32 s44, s88, 2048
    buffer_load_dwordx4 v14, s[8:11], s44 offen offset:0 lds
    buffer_load_dwordx4 v15, s[8:11], s44 offen offset:1024 lds
    s_add_u32 m0, s41, 102400
    s_add_u32 s44, s88, 4096
    buffer_load_dwordx4 v14, s[8:11], s44 offen offset:0 lds
    buffer_load_dwordx4 v15, s[8:11], s44 offen offset:1024 lds
    s_add_u32 m0, s41, 106496
    s_add_u32 s44, s88, 0
    buffer_load_dwordx4 v14, s[8:11], s44 offen offset:0 lds
    buffer_load_dwordx4 v15, s[8:11], s44 offen offset:1024 lds
    s_add_u32 m0, s41, 110592
    s_add_u32 s44, s88, 198656
    buffer_load_dwordx4 v14, s[8:11], s44 offen offset:0 lds
    buffer_load_dwordx4 v15, s[8:11], s44 offen offset:1024 lds
    s_add_u32 m0, s41, 114688
    s_add_u32 s44, s88, 200704
    buffer_load_dwordx4 v14, s[8:11], s44 offen offset:0 lds
    buffer_load_dwordx4 v15, s[8:11], s44 offen offset:1024 lds
    s_add_u32 m0, s41, 118784
    s_add_u32 s44, s88, 196608
    buffer_load_dwordx4 v14, s[8:11], s44 offen offset:0 lds
    buffer_load_dwordx4 v15, s[8:11], s44 offen offset:1024 lds
    s_add_u32 m0, s41, 122880
    s_add_u32 s44, s89, 2048
    buffer_load_dwordx4 v14, s[8:11], s44 offen offset:0 lds
    buffer_load_dwordx4 v15, s[8:11], s44 offen offset:1024 lds
    s_add_u32 m0, s41, 126976
    s_add_u32 s44, s89, 4096
    buffer_load_dwordx4 v14, s[8:11], s44 offen offset:0 lds
    buffer_load_dwordx4 v15, s[8:11], s44 offen offset:1024 lds
    s_add_u32 m0, s41, 0
    s_add_u32 s44, s89, 0
    buffer_load_dwordx4 v14, s[8:11], s44 offen offset:0 lds
    buffer_load_dwordx4 v15, s[8:11], s44 offen offset:1024 lds
    s_add_u32 m0, s41, 4096
    s_add_u32 s44, s89, 198656
    buffer_load_dwordx4 v14, s[8:11], s44 offen offset:0 lds
    buffer_load_dwordx4 v15, s[8:11], s44 offen offset:1024 lds
    s_add_u32 m0, s41, 8192
    s_add_u32 s44, s89, 200704
    buffer_load_dwordx4 v14, s[8:11], s44 offen offset:0 lds
    buffer_load_dwordx4 v15, s[8:11], s44 offen offset:1024 lds
    s_add_u32 m0, s41, 12288
    s_add_u32 s44, s89, 196608
    buffer_load_dwordx4 v14, s[8:11], s44 offen offset:0 lds
    buffer_load_dwordx4 v15, s[8:11], s44 offen offset:1024 lds
    s_waitcnt vmcnt(24)
    s_branch l_join
l_layer:
    s_waitcnt lgkmcnt(0)
    s_barrier
    s_add_u32 m0, s41, 0
    s_add_u32 s44, s89, 0
    buffer_load_dwordx4 v14, s[8:11], s44 offen offset:0 lds
    buffer_load_dwordx4 v15, s[8:11], s44 offen offset:1024 lds
    s_add_u32 m0, s41, 4096
    s_add_u32 s44, s89, 198656
    buffer_load_dwordx4 v14, s[8:11], s44 offen offset:0 lds
    buffer_load_dwordx4 v15, s[8:11], s44 offen offset:1024 lds
    s_add_u32 m0, s41, 8192
    s_add_u32 s44, s89, 200704
    buffer_load_dwordx4 v14, s[8:11], s44 offen offset:0 lds
    buffer_load_dwordx4 v15, s[8:11], s44 offen offset:1024 lds
    s_add_u32 m0, s41, 12288
    s_add_u32 s44, s89, 196608
    buffer_load_dwordx4 v14, s[8:11], s44 offen offset:0 lds
    buffer_load_dwordx4 v15, s[8:11], s44 offen offset:1024 lds
l_join:
    s_barrier
    s_add_u32 m0, s41, 16384
    s_add_u32 s44, s90, 2048
    buffer_load_dwordx4 v14, s[8:11], s44 offen offset:0 lds
    buffer_load_dwordx4 v15, s[8:11], s44 offen offset:1024 lds
    s_add_u32 m0, s41, 20480
    s_add_u32 s44, s90, 4096
    buffer_load_dwordx4 v14, s[8:11], s44 offen offset:0 lds
    buffer_load_dwordx4 v15, s[8:11], s44 offen offset:1024 lds
    s_add_u32 m0, s41, 24576
    s_add_u32 s44, s90, 0
    buffer_load_dwordx4 v14, s[8:11], s44 offen offset:0 lds
    buffer_load_dwordx4 v15, s[8:11], s44 offen offset:1024 lds
    s_add_u32 m0, s41, 28672
    s_add_u32 s44, s90, 198656
    buffer_load_dwordx4 v14, s[8:11], s44 offen offset:0 lds
    buffer_load_dwordx4 v15, s[8:11], s44 offen offset:1024 lds
    s_add_u32 m0, s41, 32768
    s_add_u32 s44, s90, 200704
    buffer_load_dwordx4 v14, s[8:11], s44 offen offset:0 lds
    buffer_load_dwordx4 v15, s[8:11], s44 offen offset:1024 lds
    s_add_u32 m0, s41, 36864
    s_add_u32 s44, s90, 196608
    buffer_load_dwordx4 v14, s[8:11], s44 offen offset:0 lds
    buffer_load_dwordx4 v15, s[8:11], s44 offen offset:1024 lds
    s_add_u32 m0, s41, 40960
    s_add_u32 s44, s91, 2048
    buffer_load_dwordx4 v14, s[8:11], s44 offen offset:0 lds
    buffer_load_dwordx4 v15, s[8:11], s44 offen offset:1024 lds
    s_add_u32 m0, s41, 45056
    s_add_u32 s44, s91, 4096
    buffer_load_dwordx4 v14, s[8:11], s44 offen offset:0 lds
    buffer_load_dwordx4 v15, s[8:11], s44 offen offset:1024 lds
    s_waitcnt vmcnt(24)
    s_barrier
    s_add_u32 m0, s41, 49152
    s_add_u32 s44, s91, 0
    buffer_load_dwordx4 v14, s[8:11], s44 offen offset:0 lds
    buffer_load_dwordx4 v15, s[8:11], s44 offen offset:1024 lds
    s_add_u32 m0, s41, 53248
    s_add_u32 s44, s91, 198656
    buffer_load_dwordx4 v14, s[8:11], s44 offen offset:0 lds
    buffer_load_dwordx4 v15, s[8:11], s44 offen offset:1024 lds
    s_add_u32 m0, s41, 57344
    s_add_u32 s44, s91, 200704
    buffer_load_dwordx4 v14, s[8:11], s44 offen offset:0 lds
    buffer_load_dwordx4 v15, s[8:11], s44 offen offset:1024 lds
    s_add_u32 m0, s41, 61440
    s_add_u32 s44, s91, 196608
    buffer_load_dwordx4 v14, s[8:11], s44 offen offset:0 lds
    buffer_load_dwordx4 v15, s[8:11], s44 offen offset:1024 lds
    s_waitcnt vmcnt(16)
    s_barrier
    s_add_u32 m0, s41, 65536
    s_add_u32 s44, s92, 2048
    buffer_load_dwordx4 v14, s[8:11], s44 offen offset:0 lds
    buffer_load_dwordx4 v15, s[8:11], s44 offen offset:1024 lds
    s_add_u32 m0, s41, 69632
    s_add_u32 s44, s92, 4096
    buffer_load_dwordx4 v14, s[8:11], s44 offen offset:0 lds
    buffer_load_dwordx4 v15, s[8:11], s44 offen offset:1024 lds
    s_add_u32 m0, s41, 73728
    s_add_u32 s44, s92, 0
    buffer_load_dwordx4 v14, s[8:11], s44 offen offset:0 lds
    buffer_load_dwordx4 v15, s[8:11], s44 offen offset:1024 lds
    s_add_u32 m0, s41, 77824
    s_add_u32 s44, s92, 198656
    buffer_load_dwordx4 v14, s[8:11], s44 offen offset:0 lds
    buffer_load_dwordx4 v15, s[8:11], s44 offen offset:1024 lds
    s_add_u32 m0, s41, 81920
    s_add_u32 s44, s92, 200704
    buffer_load_dwordx4 v14, s[8:11], s44 offen offset:0 lds
    buffer_load_dwordx4 v15, s[8:11], s44 offen offset:1024 lds
    s_add_u32 m0, s41, 86016
    s_add_u32 s44, s92, 196608
    buffer_load_dwordx4 v14, s[8:11], s44 offen offset:0 lds
    buffer_load_dwordx4 v15, s[8:11], s44 offen offset:1024 lds
    s_add_u32 m0, s41, 90112
    s_add_u32 s44, s93, 2048
    buffer_load_dwordx4 v14, s[8:11], s44 offen offset:0 lds
    buffer_load_dwordx4 v15, s[8:11], s44 offen offset:1024 lds
    s_add_u32 m0, s41, 94208
    s_add_u32 s44, s93, 4096
    buffer_load_dwordx4 v14, s[8:11], s44 offen offset:0 lds
    buffer_load_dwordx4 v15, s[8:11], s44 offen offset:1024 lds
    s_waitcnt vmcnt(16)
    s_barrier
    s_add_u32 m0, s41, 98304
    s_add_u32 s44, s93, 0
    buffer_load_dwordx4 v14, s[8:11], s44 offen offset:0 lds
    buffer_load_dwordx4 v15, s[8:11], s44 offen offset:1024 lds
    s_add_u32 m0, s41, 102400
    s_add_u32 s44, s93, 198656
    buffer_load_dwordx4 v14, s[8:11], s44 offen offset:0 lds
    buffer_load_dwordx4 v15, s[8:11], s44 offen offset:1024 lds
    s_add_u32 m0, s41, 106496
    s_add_u32 s44, s93, 200704
    buffer_load_dwordx4 v14, s[8:11], s44 offen offset:0 lds
    buffer_load_dwordx4 v15, s[8:11], s44 offen offset:1024 lds
    s_add_u32 m0, s41, 110592
    s_add_u32 s44, s93, 196608
    buffer_load_dwordx4 v14, s[8:11], s44 offen offset:0 lds
    buffer_load_dwordx4 v15, s[8:11], s44 offen offset:1024 lds
    s_add_u32 m0, s41, 114688
    s_add_u32 s44, s94, 2048
    buffer_load_dwordx4 v14, s[8:11], s44 offen offset:0 lds
    buffer_load_dwordx4 v15, s[8:11], s44 offen offset:1024 lds
    s_add_u32 m0, s41, 118784
    s_add_u32 s44, s94, 4096
    buffer_load_dwordx4 v14, s[8:11], s44 offen offset:0 lds
    buffer_load_dwordx4 v15, s[8:11], s44 offen offset:1024 lds
    s_add_u32 m0, s41, 122880
    s_add_u32 s44, s94, 198656
    buffer_load_dwordx4 v14, s[8:11], s44 offen offset:0 lds
    buffer_load_dwordx4 v15, s[8:11], s44 offen offset:1024 lds
    s_add_u32 m0, s41, 126976
    s_add_u32 s44, s94, 200704
    buffer_load_dwordx4 v14, s[8:11], s44 offen offset:0 lds
    buffer_load_dwordx4 v15, s[8:11], s44 offen offset:1024 lds
    s_waitcnt vmcnt(16)
    s_barrier
    s_add_u32 m0, s41, 0
    s_add_u32 s44, s95, 2048
    buffer_load_dwordx4 v14, s[8:11], s44 offen offset:0 lds
    buffer_load_dwordx4 v15, s[8:11], s44 offen offset:1024 lds
    s_add_u32 m0, s41, 4096
    s_add_u32 s44, s95, 4096
    buffer_load_dwordx4 v14, s[8:11], s44 offen offset:0 lds
    buffer_load_dwordx4 v15, s[8:11], s44 offen offset:1024 lds
    s_add_u32 m0, s41, 8192
    s_add_u32 s44, s95, 198656
    buffer_load_dwordx4 v14, s[8:11], s44 offen offset:0 lds
    buffer_load_dwordx4 v15, s[8:11], s44 offen offset:1024 lds
    s_add_u32 m0, s41, 12288
    s_add_u32 s44, s95, 200704
    buffer_load_dwordx4 v14, s[8:11], s44 offen offset:0 lds
    buffer_load_dwordx4 v15, s[8:11], s44 offen offset:1024 lds
    s_add_u32 m0, s41, 16384
    s_add_u32 s44, s96, 2048
    buffer_load_dwordx4 v14, s[8:11], s44 offen offset:0 lds
    buffer_load_dwordx4 v15, s[8:11], s44 offen offset:1024 lds
    s_add_u32 m0, s41, 20480
    s_add_u32 s44, s96, 198656
    buffer_load_dwordx4 v14, s[8:11], s44 offen offset:0 lds
    buffer_load_dwordx4 v15, s[8:11], s44 offen offset:1024 lds
    s_add_u32 m0, s41, 24576
    s_add_u32 s44, s97, 2048
    buffer_load_dwordx4 v14, s[8:11], s44 offen offset:0 lds
    buffer_load_dwordx4 v15, s[8:11], s44 offen offset:1024 lds
    s_add_u32 m0, s41, 28672
    s_add_u32 s44, s97, 198656
    buffer_load_dwordx4 v14, s[8:11], s44 offen offset:0 lds
    buffer_load_dwordx4 v15, s[8:11], s44 offen offset:1024 lds
    s_waitcnt vmcnt(16)
    s_barrier
    s_add_u32 m0, s41, 32768
    s_add_u32 s44, s98, 2048
    buffer_load_dwordx4 v14, s[8:11], s44 offen offset:0 lds
    buffer_load_dwordx4 v15, s[8:11], s44 offen offset:1024 lds
    s_add_u32 m0, s41, 36864
    s_add_u32 s44, s98, 198656
    buffer_load_dwordx4 v14, s[8:11], s44 offen offset:0 lds
    buffer_load_dwordx4 v15, s[8:11], s44 offen offset:1024 lds
    s_add_u32 m0, s41, 40960
    s_add_u32 s44, s99, 2048
    buffer_load_dwordx4 v14, s[8:11], s44 offen offset:0 lds
    buffer_load_dwordx4 v15, s[8:11], s44 offen offset:1024 lds
    s_add_u32 m0, s41, 45056
    s_add_u32 s44, s99, 198656
    buffer_load_dwordx4 v14, s[8:11], s44 offen offset:0 lds
    buffer_load_dwordx4 v15, s[8:11], s44 offen offset:1024 lds
    s_add_u32 m0, s41, 49152
    s_add_u32 s44, s96, 4096
    buffer_load_dwordx4 v14, s[8:11], s44 offen offset:0 lds
    buffer_load_dwordx4 v15, s[8:11], s44 offen offset:1024 lds
    s_add_u32 m0, s41, 53248
    s_add_u32 s44, s96, 200704
    buffer_load_dwordx4 v14, s[8:11], s44 offen offset:0 lds
    buffer_load_dwordx4 v15, s[8:11], s44 offen offset:1024 lds
    s_add_u32 m0, s41, 57344
    s_add_u32 s44, s97, 4096
    buffer_load_dwordx4 v14, s[8:11], s44 offen offset:0 lds
    buffer_load_dwordx4 v15, s[8:11], s44 offen offset:1024 lds
    s_add_u32 m0, s41, 61440
    s_add_u32 s44, s97, 200704
    buffer_load_dwordx4 v14, s[8:11], s44 offen offset:0 lds
    buffer_load_dwordx4 v15, s[8:11], s44 offen offset:1024 lds
    s_waitcnt vmcnt(16)
    s_barrier
    s_add_u32 m0, s41, 65536
    s_add_u32 s44, s98, 4096
    buffer_load_dwordx4 v14, s[8:11], s44 offen offset:0 lds
    buffer_load_dwordx4 v15, s[8:11], s44 offen offset:1024 lds
    s_add_u32 m0, s41, 69632
    s_add_u32 s44, s98, 200704
    buffer_load_dwordx4 v14, s[8:11], s44 offen offset:0 lds
    buffer_load_dwordx4 v15, s[8:11], s44 offen offset:1024 lds
    s_add_u32 m0, s41, 73728
    s_add_u32 s44, s99, 4096
    buffer_load_dwordx4 v14, s[8:11], s44 offen offset:0 lds
    buffer_load_dwordx4 v15, s[8:11], s44 offen offset:1024 lds
    s_add_u32 m0, s41, 77824
    s_add_u32 s44, s99, 200704
    buffer_load_dwordx4 v14, s[8:11], s44 offen offset:0 lds
    buffer_load_dwordx4 v15, s[8:11], s44 offen offset:1024 lds
    s_add_u32 m0, s41, 81920
    s_add_u32 s44, s94, 0
    buffer_load_dwordx4 v14, s[8:11], s44 offen offset:0 lds
    buffer_load_dwordx4 v15, s[8:11], s44 offen offset:1024 lds
    s_add_u32 m0, s41, 86016
    s_add_u32 s44, s94, 196608
    buffer_load_dwordx4 v14, s[8:11], s44 offen offset:0 lds
    buffer_load_dwordx4 v15, s[8:11], s44 offen offset:1024 lds
    s_add_u32 m0, s41, 90112
    s_add_u32 s44, s95, 0
    buffer_load_dwordx4 v14, s[8:11], s44 offen offset:0 lds
    buffer_load_dwordx4 v15, s[8:11], s44 offen offset:1024 lds
    s_add_u32 m0, s41, 94208
    s_add_u32 s44, s95, 196608
    buffer_load_dwordx4 v14, s[8:11], s44 offen offset:0 lds
    buffer_load_dwordx4 v15, s[8:11], s44 offen offset:1024 lds
    s_waitcnt vmcnt(16)
    s_barrier
    s_add_u32 m0, s41, 98304
    s_add_u32 s44, s96, 0
    buffer_load_dwordx4 v14, s[8:11], s44 offen offset:0 lds
    buffer_load_dwordx4 v15, s[8:11], s44 offen offset:1024 lds
    s_add_u32 m0, s41, 102400
    s_add_u32 s44, s96, 196608
    buffer_load_dwordx4 v14, s[8:11], s44 offen offset:0 lds
    buffer_load_dwordx4 v15, s[8:11], s44 offen offset:1024 lds
    s_add_u32 m0, s41, 106496
    s_add_u32 s44, s97, 0
    buffer_load_dwordx4 v14, s[8:11], s44 offen offset:0 lds
    buffer_load_dwordx4 v15, s[8:11], s44 offen offset:1024 lds
    s_add_u32 m0, s41, 110592
    s_add_u32 s44, s97, 196608
    buffer_load_dwordx4 v14, s[8:11], s44 offen offset:0 lds
    buffer_load_dwordx4 v15, s[8:11], s44 offen offset:1024 lds
    s_add_u32 m0, s41, 114688
    s_add_u32 s44, s98, 0
    buffer_load_dwordx4 v14, s[8:11], s44 offen offset:0 lds
    buffer_load_dwordx4 v15, s[8:11], s44 offen offset:1024 lds
    s_add_u32 m0, s41, 118784
    s_add_u32 s44, s98, 196608
    buffer_load_dwordx4 v14, s[8:11], s44 offen offset:0 lds
    buffer_load_dwordx4 v15, s[8:11], s44 offen offset:1024 lds
    s_add_u32 m0, s41, 122880
    s_add_u32 s44, s99, 0
    buffer_load_dwordx4 v14, s[8:11], s44 offen offset:0 lds
    buffer_load_dwordx4 v15, s[8:11], s44 offen offset:1024 lds
    s_add_u32 m0, s41, 126976
    s_add_u32 s44, s99, 196608
    buffer_load_dwordx4 v14, s[8:11], s44 offen offset:0 lds
    buffer_load_dwordx4 v15, s[8:11], s44 offen offset:1024 lds
    s_waitcnt vmcnt(16)
    s_barrier
    v_lshrrev_b32 v28, 4, v1
    v_and_b32 v29, 7, v28
    v_lshrrev_b32 v28, 3, v28
    v_mul_u32_u24 v28, 2048, v28
    v_lshl_add_u32 v28, v29, 4, v28
    s_and_b32 s3, s20, 12
    s_or_b32 s3, s3, 3
    s_lshl_b32 s3, s3, 7
    v_add_u32 v28, s3, v28
    s_lshr_b32 s3, s2, 3
    s_lshl_b32 s3, s3, 2
    s_and_b32 s60, s16, 3
    s_add_u32 s60, s60, s3
    s_lshl_b32 s61, s60, 14
    buffer_load_dwordx4 v[144:147], v28, s[12:15], s61 offen
    s_bitcmp0_b32 s21, 0
    s_cselect_b32 s56, s28, s24
    s_cselect_b32 s57, s29, s25
    s_mov_b32 s58, 6291456
    s_mov_b32 s59, 0x00020000
    v_lshrrev_b32 v28, 4, v1
    v_and_b32 v29, 7, v28
    v_lshrrev_b32 v28, 3, v28
    v_mul_u32_u24 v28, 6144, v28
    v_lshl_add_u32 v28, v29, 4, v28
    s_and_b32 s3, s18, 12
    s_or_b32 s3, s3, 3
    s_lshl_b32 s3, s3, 7
    v_add_u32 v28, s3, v28
    s_lshr_b32 s3, s2, 3
    s_lshl_b32 s3, s3, 2
    s_and_b32 s60, s16, 3
    s_add_u32 s60, s60, s3
    s_and_b32 s3, s60, 31
    s_mul_i32 s3, s3, 49152
    s_lshr_b32 s61, s60, 5
    s_min_u32 s61, s61, 2
    s_lshl_b32 s61, s61, 11
    s_add_u32 s61, s61, s3
    s_and_b32 s3, s18, 0
    s_mul_i32 s3, s3, 393216
    s_add_u32 s61, s61, s3
    buffer_load_dwordx4 v[148:151], v28, s[56:59], s61 offen
    s_waitcnt vmcnt(2)
    s_cmp_lg_u32 s21, 2
    s_cbranch_scc1 l_pe
    s_bitcmp0_b32 s21, 0
    s_cselect_b32 s56, s28, s24
    s_cselect_b32 s57, s29, s25
    s_mov_b32 s58, 6291456
    s_mov_b32 s59, 0x00020000
    s_add_u32 s61, s84, 2048
    buffer_load_dwordx4 v[160:163], v11, s[56:59], s61 offen
    s_add_u32 s61, s84, 4096
    buffer_load_dwordx4 v[164:167], v11, s[56:59], s61 offen
    s_add_u32 s61, s84, 0
    buffer_load_dwordx4 v[168:171], v11, s[56:59], s61 offen
    s_add_u32 s61, s84, 198656
    buffer_load_dwordx4 v[172:175], v11, s[56:59], s61 offen
    s_add_u32 s61, s84, 200704
    buffer_load_dwordx4 v[176:179], v11, s[56:59], s61 offen
    s_add_u32 s61, s84, 196608
    buffer_load_dwordx4 v[180:183], v11, s[56:59], s61 offen
    s_add_u32 s61, s85, 2048
    buffer_load_dwordx4 v[184:187], v11, s[56:59], s61 offen
    s_add_u32 s61, s85, 4096
    buffer_load_dwordx4 v[188:191], v11, s[56:59], s61 offen
    s_add_u32 s61, s85, 0
    buffer_load_dwordx4 v[192:195], v11, s[56:59], s61 offen
    s_add_u32 s61, s85, 198656
    buffer_load_dwordx4 v[196:199], v11, s[56:59], s61 offen
l_pe:
    s_barrier
    s_bitcmp1_b32 s21, 0
    s_cbranch_scc1 s_B
    s_add_u32 m0, s41, 0
    s_xor_b32 s44, s62, 0
    buffer_load_dwordx4 v16, s[12:15], s44 offen offset:0 lds
    buffer_load_dwordx4 v17, s[12:15], s44 offen offset:1024 lds
    s_add_u32 m0, s41, 4096
    s_xor_b32 s44, s62, 131072
    buffer_load_dwordx4 v16, s[12:15], s44 offen offset:0 lds
    buffer_load_dwordx4 v17, s[12:15], s44 offen offset:1024 lds
    s_add_u32 m0, s41, 8192
    s_xor_b32 s44, s62, 262144
    buffer_load_dwordx4 v16, s[12:15], s44 offen offset:0 lds
    buffer_load_dwordx4 v17, s[12:15], s44 offen offset:1024 lds
    s_add_u32 m0, s41, 12288
    s_xor_b32 s44, s62, 393216
    buffer_load_dwordx4 v16, s[12:15], s44 offen offset:0 lds
    buffer_load_dwordx4 v17, s[12:15], s44 offen offset:1024 lds
    s_add_u32 m0, s41, 16384
    s_xor_b32 s44, s62, 524288
    buffer_load_dwordx4 v16, s[12:15], s44 offen offset:0 lds
    buffer_load_dwordx4 v17, s[12:15], s44 offen offset:1024 lds
    s_add_u32 m0, s41, 20480
    s_xor_b32 s44, s62, 655360
    buffer_load_dwordx4 v16, s[12:15], s44 offen offset:0 lds
    buffer_load_dwordx4 v17, s[12:15], s44 offen offset:1024 lds
    s_add_u32 m0, s41, 24576
    s_xor_b32 s44, s62, 786432
    buffer_load_dwordx4 v16, s[12:15], s44 offen offset:0 lds
    buffer_load_dwordx4 v17, s[12:15], s44 offen offset:1024 lds
    s_add_u32 m0, s41, 28672
    s_xor_b32 s44, s62, 917504
    buffer_load_dwordx4 v16, s[12:15], s44 offen offset:0 lds
    buffer_load_dwordx4 v17, s[12:15], s44 offen offset:1024 lds
    s_add_u32 m0, s41, 32768
    s_xor_b32 s44, s62, 1048576
    buffer_load_dwordx4 v16, s[12:15], s44 offen offset:0 lds
    buffer_load_dwordx4 v17, s[12:15], s44 offen offset:1024 lds
    s_add_u32 m0, s41, 36864
    s_xor_b32 s44, s62, 1179648
    buffer_load_dwordx4 v16, s[12:15], s44 offen offset:0 lds
    buffer_load_dwordx4 v17, s[12:15], s44 offen offset:1024 lds
    s_add_u32 m0, s41, 40960
    s_xor_b32 s44, s62, 1310720
    buffer_load_dwordx4 v16, s[12:15], s44 offen offset:0 lds
    buffer_load_dwordx4 v17, s[12:15], s44 offen offset:1024 lds
    s_add_u32 m0, s41, 45056
    s_xor_b32 s44, s62, 1441792
    buffer_load_dwordx4 v16, s[12:15], s44 offen offset:0 lds
    buffer_load_dwordx4 v17, s[12:15], s44 offen offset:1024 lds
    s_add_u32 m0, s41, 49152
    s_xor_b32 s44, s62, 1572864
    buffer_load_dwordx4 v16, s[12:15], s44 offen offset:0 lds
    buffer_load_dwordx4 v17, s[12:15], s44 offen offset:1024 lds
    s_add_u32 m0, s41, 53248
    s_xor_b32 s44, s62, 1703936
    buffer_load_dwordx4 v16, s[12:15], s44 offen offset:0 lds
    buffer_load_dwordx4 v17, s[12:15], s44 offen offset:1024 lds
    s_add_u32 m0, s41, 57344
    s_xor_b32 s44, s62, 1835008
    buffer_load_dwordx4 v16, s[12:15], s44 offen offset:0 lds
    buffer_load_dwordx4 v17, s[12:15], s44 offen offset:1024 lds
    s_add_u32 m0, s41, 61440
    s_xor_b32 s44, s62, 1966080
    buffer_load_dwordx4 v16, s[12:15], s44 offen offset:0 lds
    buffer_load_dwordx4 v17, s[12:15], s44 offen offset:1024 lds
    s_branch s_tail
z_start:
    v_lshrrev_b32 v24, 4, v1
    v_lshrrev_b32 v25, 3, v24
    v_mul_u32_u24 v20, 6144, v25
    v_and_b32 v25, 7, v24
    v_lshl_add_u32 v20, v25, 4, v20
    s_add_u32 s3, s18, 2
    s_and_b32 s3, s3, 15
    s_lshl_b32 s3, s3, 7
    s_add_u32 s3, s3, 4096
    v_add_u32 v22, s3, v20
    s_add_u32 s3, s18, 1
    s_and_b32 s3, s3, 15
    s_lshl_b32 s3, s3, 7
    s_add_u32 s3, s3, 2048
    v_add_u32 v21, s3, v20
    s_add_u32 s3, s18, 0
    s_and_b32 s3, s3, 15
    s_lshl_b32 s3, s3, 7
    s_add_u32 s3, s3, 0
    v_add_u32 v20, s3, v20
    v_lshrrev_b32 v24, 4, v1
    v_lshrrev_b32 v25, 3, v24
    v_mul_u32_u24 v12, 6144, v25
    v_and_b32 v26, 2, v25
    v_lshrrev_b32 v25, 2, v25
    v_or_b32 v26, v26, v25
    v_bfe_u32 v25, v24, 1, 2
    v_xor_b32 v26, v26, v25
    v_lshl_add_u32 v12, v26, 5, v12
    v_and_b32 v26, 1, v24
    v_lshl_add_u32 v12, v26, 4, v12
    s_lshl_b32 s3, s18, 7
    v_add_u32 v12, s3, v12
    v_add_u32 v13, 48128, v12
    v_add_u32 v14, 96256, v12
    v_add_u32 v15, 144384, v12
    v_lshrrev_b32 v24, 4, v1
    v_lshrrev_b32 v25, 3, v24
    v_mul_u32_u24 v16, 2048, v25
    v_and_b32 v26, 2, v25
    v_lshrrev_b32 v25, 2, v25
    v_or_b32 v26, v26, v25
    v_bfe_u32 v25, v24, 1, 2
    v_xor_b32 v26, v26, v25
    v_lshl_add_u32 v16, v26, 5, v16
    v_and_b32 v26, 1, v24
    v_lshl_add_u32 v16, v26, 4, v16
    s_lshl_b32 s3, s20, 7
    v_add_u32 v16, s3, v16
    v_add_u32 v17, 15360, v16
    v_add_u32 v18, 30720, v16
    v_add_u32 v19, 46080, v16
    s_mul_i32 s84, s18, 393216
    s_cmp_eq_u32 s18, 1
    s_cselect_b32 s85, 0, 393216
    s_cmp_eq_u32 s18, 2
    s_cselect_b32 s86, 0, 786432
    s_cmp_eq_u32 s18, 3
    s_cselect_b32 s87, 0, 1179648
    s_cmp_eq_u32 s18, 4
    s_cselect_b32 s88, 0, 1572864
    s_cmp_eq_u32 s18, 5
    s_cselect_b32 s89, 0, 1966080
    s_cmp_eq_u32 s18, 6
    s_cselect_b32 s90, 0, 2359296
    s_cmp_eq_u32 s18, 7
    s_cselect_b32 s91, 0, 2752512
    s_cmp_eq_u32 s18, 8
    s_cselect_b32 s92, 0, 3145728
    s_cmp_eq_u32 s18, 9
    s_cselect_b32 s93, 0, 3538944
    s_cmp_eq_u32 s18, 10
    s_cselect_b32 s94, 0, 3932160
    s_cmp_eq_u32 s18, 11
    s_cselect_b32 s95, 0, 4325376
    s_cmp_eq_u32 s18, 12
    s_cselect_b32 s96, 0, 4718592
    s_cmp_eq_u32 s18, 13
    s_cselect_b32 s97, 0, 5111808
    s_cmp_eq_u32 s18, 14
    s_cselect_b32 s98, 0, 5505024
    s_cmp_eq_u32 s18, 15
    s_cselect_b32 s99, 0, 5898240
    s_and_b32 s3, s16, 3
    s_mul_i32 s3, s3, 49152
    v_add_u32 v11, s3, v12
    s_and_b32 s3, s16, 3
    s_lshl_b32 s3, s3, 10
    v_add_u32 v9, s3, v1
    v_add_u32 v10, 0x10000, v9
    s_barrier
    s_mov_b32 s8, s24
    s_mov_b32 s9, s25
    s_mov_b32 s10, 6291456
    s_mov_b32 s11, 0x00020000
    s_mul_i32 s44, s17, 393216
    buffer_load_dwordx4 v[32:35], v20, s[8:11], s44 offen
    buffer_load_dwordx4 v[64:67], v21, s[8:11], s44 offen
    buffer_load_dwordx4 v[96:99], v22, s[8:11], s44 offen
    s_add_u32 s44, s44, 49152
    buffer_load_dwordx4 v[36:39], v20, s[8:11], s44 offen
    buffer_load_dwordx4 v[68:71], v21, s[8:11], s44 offen
    buffer_load_dwordx4 v[100:103], v22, s[8:11], s44 offen
    s_add_u32 s44, s44, 49152
    buffer_load_dwordx4 v[40:43], v20, s[8:11], s44 offen
    buffer_load_dwordx4 v[72:75], v21, s[8:11], s44 offen
    buffer_load_dwordx4 v[104:107], v22, s[8:11], s44 offen
    s_add_u32 s44, s44, 49152
    buffer_load_dwordx4 v[44:47], v20, s[8:11], s44 offen
    buffer_load_dwordx4 v[76:79], v21, s[8:11], s44 offen
    buffer_load_dwordx4 v[108:111], v22, s[8:11], s44 offen
    s_add_u32 s44, s44, 49152
    buffer_load_dwordx4 v[48:51], v20, s[8:11], s44 offen
    buffer_load_dwordx4 v[80:83], v21, s[8:11], s44 offen
    buffer_load_dwordx4 v[112:115], v22, s[8:11], s44 offen
    s_add_u32 s44, s44, 49152
    buffer_load_dwordx4 v[52:55], v20, s[8:11], s44 offen
    buffer_load_dwordx4 v[84:87], v21, s[8:11], s44 offen
    buffer_load_dwordx4 v[116:119], v22, s[8:11], s44 offen
    s_add_u32 s44, s44, 49152
    buffer_load_dwordx4 v[56:59], v20, s[8:11], s44 offen
    buffer_load_dwordx4 v[88:91], v21, s[8:11], s44 offen
    buffer_load_dwordx4 v[120:123], v22, s[8:11], s44 offen
    s_add_u32 s44, s44, 49152
    buffer_load_dwordx4 v[60:63], v20, s[8:11], s44 offen
    buffer_load_dwordx4 v[92:95], v21, s[8:11], s44 offen
    buffer_load_dwordx4 v[124:127], v22, s[8:11], s44 offen
    s_barrier
    s_waitcnt vmcnt(0)
    v_lshrrev_b32 v28, 4, v1
    v_and_b32 v29, 7, v28
    v_lshrrev_b32 v28, 3, v28
    v_mul_u32_u24 v28, 6144, v28
    v_lshl_add_u32 v28, v29, 4, v28
    s_and_b32 s3, s18, 12
    s_or_b32 s3, s3, 3
    s_lshl_b32 s3, s3, 7
    v_add_u32 v28, s3, v28
    s_lshr_b32 s3, s2, 3
    s_lshl_b32 s3, s3, 2
    s_and_b32 s60, s16, 3
    s_add_u32 s60, s60, s3
    s_lshr_b32 s60, s60, 2
    s_mul_i32 s60, s60, 49152
    s_and_b32 s3, s18, 0
    s_xor_b32 s3, s3, 0
    s_mul_i32 s3, s3, 393216
    s_add_u32 s3, s3, s60
    s_add_u32 s61, s3, 0
    buffer_load_dwordx4 v[160:163], v28, s[8:11], s61 offen
    s_add_u32 s61, s3, 2048
    buffer_load_dwordx4 v[164:167], v28, s[8:11], s61 offen
    s_add_u32 s61, s3, 4096
    buffer_load_dwordx4 v[168:171], v28, s[8:11], s61 offen
    s_and_b32 s3, s18, 0
    s_xor_b32 s3, s3, 4
    s_mul_i32 s3, s3, 393216
    s_add_u32 s3, s3, s60
    s_add_u32 s61, s3, 0
    buffer_load_dwordx4 v[172:175], v28, s[8:11], s61 offen
    s_add_u32 s61, s3, 2048
    buffer_load_dwordx4 v[176:179], v28, s[8:11], s61 offen
    s_add_u32 s61, s3, 4096
    buffer_load_dwordx4 v[180:183], v28, s[8:11], s61 offen
    s_and_b32 s3, s18, 0
    s_xor_b32 s3, s3, 8
    s_mul_i32 s3, s3, 393216
    s_add_u32 s3, s3, s60
    s_add_u32 s61, s3, 0
    buffer_load_dwordx4 v[184:187], v28, s[8:11], s61 offen
    s_add_u32 s61, s3, 2048
    buffer_load_dwordx4 v[188:191], v28, s[8:11], s61 offen
    s_add_u32 s61, s3, 4096
    buffer_load_dwordx4 v[192:195], v28, s[8:11], s61 offen
    s_and_b32 s3, s18, 0
    s_xor_b32 s3, s3, 12
    s_mul_i32 s3, s3, 393216
    s_add_u32 s3, s3, s60
    s_add_u32 s61, s3, 0
    buffer_load_dwordx4 v[196:199], v28, s[8:11], s61 offen
    s_add_u32 s61, s3, 2048
    buffer_load_dwordx4 v[200:203], v28, s[8:11], s61 offen
    s_add_u32 s61, s3, 4096
    buffer_load_dwordx4 v[204:207], v28, s[8:11], s61 offen
    v_lshrrev_b32 v24, 4, v1
    v_and_b32 v25, 1, v24
    v_lshlrev_b32 v25, 4, v25
    v_mov_b32 v26, 0x3f80
    v_lshlrev_b32 v25, v25, v26
    v_bfe_u32 v26, v24, 1, 2
    v_cmp_eq_u32 vcc, 0, v26
    s_nop 1
    v_cndmask_b32 v140, 0, v25, vcc
    v_cmp_eq_u32 vcc, 1, v26
    s_nop 1
    v_cndmask_b32 v141, 0, v25, vcc
    v_cmp_eq_u32 vcc, 2, v26
    s_nop 1
    v_cndmask_b32 v142, 0, v25, vcc
    v_cmp_eq_u32 vcc, 3, v26
    s_nop 1
    v_cndmask_b32 v143, 0, v25, vcc
    s_nop 1
    v_mfma_f32_16x16x32_bf16 v[128:131], v[140:143], v[32:35], 0
    v_mfma_f32_16x16x32_bf16 v[132:135], v[140:143], v[64:67], 0
    v_mfma_f32_16x16x32_bf16 v[136:139], v[140:143], v[96:99], 0
    v_mfma_f32_16x16x32_bf16 v[128:131], v[140:143], v[36:39], v[128:131]
    v_mfma_f32_16x16x32_bf16 v[132:135], v[140:143], v[68:71], v[132:135]
    v_mfma_f32_16x16x32_bf16 v[136:139], v[140:143], v[100:103], v[136:139]
    v_mfma_f32_16x16x32_bf16 v[128:131], v[140:143], v[40:43], v[128:131]
    v_mfma_f32_16x16x32_bf16 v[132:135], v[140:143], v[72:75], v[132:135]
    v_mfma_f32_16x16x32_bf16 v[136:139], v[140:143], v[104:107], v[136:139]
    v_mfma_f32_16x16x32_bf16 v[128:131], v[140:143], v[44:47], v[128:131]
    v_mfma_f32_16x16x32_bf16 v[132:135], v[140:143], v[76:79], v[132:135]
    v_mfma_f32_16x16x32_bf16 v[136:139], v[140:143], v[108:111], v[136:139]
    v_mfma_f32_16x16x32_bf16 v[128:131], v[140:143], v[48:51], v[128:131]
    v_mfma_f32_16x16x32_bf16 v[132:135], v[140:143], v[80:83], v[132:135]
    v_mfma_f32_16x16x32_bf16 v[136:139], v[140:143], v[112:115], v[136:139]
    v_mfma_f32_16x16x32_bf16 v[128:131], v[140:143], v[52:55], v[128:131]
    v_mfma_f32_16x16x32_bf16 v[132:135], v[140:143], v[84:87], v[132:135]
    v_mfma_f32_16x16x32_bf16 v[136:139], v[140:143], v[116:119], v[136:139]
    v_mfma_f32_16x16x32_bf16 v[128:131], v[140:143], v[56:59], v[128:131]
    v_mfma_f32_16x16x32_bf16 v[132:135], v[140:143], v[88:91], v[132:135]
    v_mfma_f32_16x16x32_bf16 v[136:139], v[140:143], v[120:123], v[136:139]
    v_mfma_f32_16x16x32_bf16 v[128:131], v[140:143], v[60:63], v[128:131]
    v_mfma_f32_16x16x32_bf16 v[132:135], v[140:143], v[92:95], v[132:135]
    v_mfma_f32_16x16x32_bf16 v[136:139], v[140:143], v[124:127], v[136:139]
    v_bfe_u32 v25, v24, 3, 1
    v_lshrrev_b32 v26, 5, v24
    v_lshl_add_u32 v26, v26, 1, v25
    v_lshlrev_b32 v25, 8, v26
    v_and_b32 v27, 7, v24
    v_lshl_add_u32 v25, v27, 5, v25
    v_bfe_u32 v27, v24, 4, 1
    v_lshl_add_u32 v25, v27, 4, v25
    v_add_f32_dpp v128, v128, v128 row_ror:8 row_mask:0xf bank_mask:0xf
    v_add_f32_dpp v129, v129, v129 row_ror:8 row_mask:0xf bank_mask:0xf
    v_add_f32_dpp v130, v130, v130 row_ror:8 row_mask:0xf bank_mask:0xf
    v_add_f32_dpp v131, v131, v131 row_ror:8 row_mask:0xf bank_mask:0xf
    v_add_f32_dpp v132, v132, v132 row_ror:8 row_mask:0xf bank_mask:0xf
    v_add_f32_dpp v133, v133, v133 row_ror:8 row_mask:0xf bank_mask:0xf
    v_add_f32_dpp v134, v134, v134 row_ror:8 row_mask:0xf bank_mask:0xf
    v_add_f32_dpp v135, v135, v135 row_ror:8 row_mask:0xf bank_mask:0xf
    v_add_f32_dpp v136, v136, v136 row_ror:8 row_mask:0xf bank_mask:0xf
    v_add_f32_dpp v137, v137, v137 row_ror:8 row_mask:0xf bank_mask:0xf
    v_add_f32_dpp v138, v138, v138 row_ror:8 row_mask:0xf bank_mask:0xf
    v_add_f32_dpp v139, v139, v139 row_ror:8 row_mask:0xf bank_mask:0xf
    v_cmp_le_u32 vcc, 1, v26
    s_nop 1
    v_cndmask_b32 v128, v128, v132, vcc
    v_cndmask_b32 v129, v129, v133, vcc
    v_cndmask_b32 v130, v130, v134, vcc
    v_cndmask_b32 v131, v131, v135, vcc
    v_cmp_le_u32 vcc, 2, v26
    s_nop 1
    v_cndmask_b32 v128, v128, v136, vcc
    v_cndmask_b32 v129, v129, v137, vcc
    v_cndmask_b32 v130, v130, v138, vcc
    v_cndmask_b32 v131, v131, v139, vcc
    v_add_u32 v27, s18, v26
    v_and_b32 v27, 15, v27
    v_lshl_add_u32 v25, v27, 14, v25
    s_lshl_b32 s44, s17, 10
    s_add_u32 s44, s44, 52428800
    buffer_store_dwordx4 v[128:131], v25, s[4:7], s44 offen sc1
    s_barrier
    s_barrier
    s_waitcnt vmcnt(0)
    s_add_u32 s44, s18, 0
    s_and_b32 s44, s44, 15
    s_lshl_b32 s44, s44, 7
    s_add_u32 s44, s44, 0
    s_atomic_add s40, s[22:23], s44
    s_add_u32 s45, s18, 1
    s_and_b32 s45, s45, 15
    s_lshl_b32 s45, s45, 7
    s_add_u32 s45, s45, 0
    s_atomic_add s40, s[22:23], s45
    s_add_u32 s46, s18, 2
    s_and_b32 s46, s46, 15
    s_lshl_b32 s46, s46, 7
    s_add_u32 s46, s46, 0
    s_atomic_add s40, s[22:23], s46
    s_barrier
    s_barrier
    s_barrier
    s_barrier
    s_barrier
    s_barrier
    s_barrier
    s_mov_b32 s12, s26
    s_mov_b32 s13, s27
    s_mov_b32 s14, 2097152
    s_mov_b32 s15, 0x00020000
    s_lshl_b32 s44, s2, 13
    buffer_load_dwordx4 v[160:163], v1, s[12:15], s44 offen offset:0
    buffer_load_dwordx4 v[164:167], v1, s[12:15], s44 offen offset:1024
    buffer_load_dwordx4 v[168:171], v1, s[12:15], s44 offen offset:2048
    buffer_load_dwordx4 v[172:175], v1, s[12:15], s44 offen offset:3072
    s_add_u32 s44, s44, 4096
    buffer_load_dwordx4 v[176:179], v1, s[12:15], s44 offen offset:0
    buffer_load_dwordx4 v[180:183], v1, s[12:15], s44 offen offset:1024
    buffer_load_dwordx4 v[184:187], v1, s[12:15], s44 offen offset:2048
    buffer_load_dwordx4 v[188:191], v1, s[12:15], s44 offen offset:3072
    s_mov_b32 s8, s28
    s_mov_b32 s9, s29
    s_mov_b32 s10, 6291456
    s_mov_b32 s11, 0x00020000
    s_mul_i32 s44, s17, 393216
    buffer_load_dwordx4 v[32:35], v20, s[8:11], s44 offen
    buffer_load_dwordx4 v[64:67], v21, s[8:11], s44 offen
    buffer_load_dwordx4 v[96:99], v22, s[8:11], s44 offen
    s_add_u32 s44, s44, 49152
    buffer_load_dwordx4 v[36:39], v20, s[8:11], s44 offen
    buffer_load_dwordx4 v[68:71], v21, s[8:11], s44 offen
    buffer_load_dwordx4 v[100:103], v22, s[8:11], s44 offen
    s_add_u32 s44, s44, 49152
    buffer_load_dwordx4 v[40:43], v20, s[8:11], s44 offen
    buffer_load_dwordx4 v[72:75], v21, s[8:11], s44 offen
    buffer_load_dwordx4 v[104:107], v22, s[8:11], s44 offen
    s_add_u32 s44, s44, 49152
    s_barrier
    buffer_load_dwordx4 v[44:47], v20, s[8:11], s44 offen
    buffer_load_dwordx4 v[76:79], v21, s[8:11], s44 offen
    buffer_load_dwordx4 v[108:111], v22, s[8:11], s44 offen
    s_add_u32 s44, s44, 49152
    buffer_load_dwordx4 v[48:51], v20, s[8:11], s44 offen
    buffer_load_dwordx4 v[80:83], v21, s[8:11], s44 offen
    buffer_load_dwordx4 v[112:115], v22, s[8:11], s44 offen
    s_add_u32 s44, s44, 49152
    buffer_load_dwordx4 v[52:55], v20, s[8:11], s44 offen
    buffer_load_dwordx4 v[84:87], v21, s[8:11], s44 offen
    buffer_load_dwordx4 v[116:119], v22, s[8:11], s44 offen
    s_add_u32 s44, s44, 49152
    buffer_load_dwordx4 v[56:59], v20, s[8:11], s44 offen
    buffer_load_dwordx4 v[88:91], v21, s[8:11], s44 offen
    buffer_load_dwordx4 v[120:123], v22, s[8:11], s44 offen
    s_add_u32 s44, s44, 49152
    buffer_load_dwordx4 v[60:63], v20, s[8:11], s44 offen
    buffer_load_dwordx4 v[92:95], v21, s[8:11], s44 offen
    buffer_load_dwordx4 v[124:127], v22, s[8:11], s44 offen
    s_barrier
    s_bitcmp1_b32 s21, 0
    s_cselect_b32 s8, s28, s24
    s_cselect_b32 s9, s29, s25
    s_cselect_b32 s12, s30, s26
    s_cselect_b32 s13, s31, s27
    s_mov_b32 s10, 6291456
    s_mov_b32 s11, 0x00020000
    s_mov_b32 s14, 2097152
    s_mov_b32 s15, 0x00020000
    s_branch s_tail
z_layer:
    s_waitcnt lgkmcnt(0)
    v_lshrrev_b32 v28, 4, v1
    v_and_b32 v29, 7, v28
    v_lshrrev_b32 v28, 3, v28
    v_mul_u32_u24 v28, 6144, v28
    v_lshl_add_u32 v28, v29, 4, v28
    s_and_b32 s3, s18, 12
    s_or_b32 s3, s3, 3
    s_lshl_b32 s3, s3, 7
    v_add_u32 v28, s3, v28
    s_lshr_b32 s3, s2, 3
    s_lshl_b32 s3, s3, 2
    s_and_b32 s60, s16, 3
    s_add_u32 s60, s60, s3
    s_lshr_b32 s60, s60, 2
    s_mul_i32 s60, s60, 49152
    s_and_b32 s3, s18, 0
    s_xor_b32 s3, s3, 4
    s_mul_i32 s3, s3, 393216
    s_add_u32 s3, s3, s60
    s_add_u32 s61, s3, 0
    buffer_load_dwordx4 v[160:163], v28, s[8:11], s61 offen
    s_add_u32 s61, s3, 2048
    buffer_load_dwordx4 v[164:167], v28, s[8:11], s61 offen
    s_add_u32 s61, s3, 4096
    buffer_load_dwordx4 v[168:171], v28, s[8:11], s61 offen
    s_and_b32 s3, s18, 0
    s_xor_b32 s3, s3, 8
    s_mul_i32 s3, s3, 393216
    s_add_u32 s3, s3, s60
    s_add_u32 s61, s3, 0
    buffer_load_dwordx4 v[172:175], v28, s[8:11], s61 offen
    s_add_u32 s61, s3, 2048
    buffer_load_dwordx4 v[176:179], v28, s[8:11], s61 offen
    s_add_u32 s61, s3, 4096
    buffer_load_dwordx4 v[180:183], v28, s[8:11], s61 offen
    s_and_b32 s3, s18, 0
    s_xor_b32 s3, s3, 12
    s_mul_i32 s3, s3, 393216
    s_add_u32 s3, s3, s60
    s_add_u32 s61, s3, 0
    buffer_load_dwordx4 v[184:187], v28, s[8:11], s61 offen
    s_add_u32 s61, s3, 2048
    buffer_load_dwordx4 v[188:191], v28, s[8:11], s61 offen
    s_add_u32 s61, s3, 4096
    buffer_load_dwordx4 v[192:195], v28, s[8:11], s61 offen
    s_barrier
    s_barrier
    s_barrier
    s_barrier
    s_barrier
    s_barrier
    s_barrier
    s_barrier
    s_barrier
    s_barrier
    v_lshrrev_b32 v28, 4, v1
    v_and_b32 v29, 7, v28
    v_lshrrev_b32 v28, 3, v28
    v_mul_u32_u24 v28, 2048, v28
    v_lshl_add_u32 v28, v29, 4, v28
    s_and_b32 s3, s20, 12
    s_or_b32 s3, s3, 3
    s_lshl_b32 s3, s3, 7
    v_add_u32 v28, s3, v28
    s_lshr_b32 s3, s2, 3
    s_lshl_b32 s3, s3, 2
    s_and_b32 s60, s16, 3
    s_add_u32 s60, s60, s3
    s_lshl_b32 s61, s60, 14
    buffer_load_dwordx4 v[144:147], v28, s[12:15], s61 offen
    s_bitcmp0_b32 s21, 0
    s_cselect_b32 s56, s28, s24
    s_cselect_b32 s57, s29, s25
    s_mov_b32 s58, 6291456
    s_mov_b32 s59, 0x00020000
    v_lshrrev_b32 v28, 4, v1
    v_and_b32 v29, 7, v28
    v_lshrrev_b32 v28, 3, v28
    v_mul_u32_u24 v28, 6144, v28
    v_lshl_add_u32 v28, v29, 4, v28
    s_and_b32 s3, s18, 12
    s_or_b32 s3, s3, 3
    s_lshl_b32 s3, s3, 7
    v_add_u32 v28, s3, v28
    s_lshr_b32 s3, s2, 3
    s_lshl_b32 s3, s3, 2
    s_and_b32 s60, s16, 3
    s_add_u32 s60, s60, s3
    s_and_b32 s3, s60, 31
    s_mul_i32 s3, s3, 49152
    s_lshr_b32 s61, s60, 5
    s_min_u32 s61, s61, 2
    s_lshl_b32 s61, s61, 11
    s_add_u32 s61, s61, s3
    s_and_b32 s3, s18, 0
    s_mul_i32 s3, s3, 393216
    s_add_u32 s61, s61, s3
    buffer_load_dwordx4 v[148:151], v28, s[56:59], s61 offen
    s_cmp_lg_u32 s21, 2
    s_cbranch_scc1 z_pe
    s_bitcmp0_b32 s21, 0
    s_cselect_b32 s56, s28, s24
    s_cselect_b32 s57, s29, s25
    s_mov_b32 s58, 6291456
    s_mov_b32 s59, 0x00020000
    s_add_u32 s61, s84, 2048
    buffer_load_dwordx4 v[160:163], v11, s[56:59], s61 offen
    s_add_u32 s61, s84, 4096
    buffer_load_dwordx4 v[164:167], v11, s[56:59], s61 offen
    s_add_u32 s61, s84, 0
    buffer_load_dwordx4 v[168:171], v11, s[56:59], s61 offen
    s_add_u32 s61, s84, 198656
    buffer_load_dwordx4 v[172:175], v11, s[56:59], s61 offen
    s_add_u32 s61, s84, 200704
    buffer_load_dwordx4 v[176:179], v11, s[56:59], s61 offen
    s_add_u32 s61, s84, 196608
    buffer_load_dwordx4 v[180:183], v11, s[56:59], s61 offen
    s_add_u32 s61, s85, 2048
    buffer_load_dwordx4 v[184:187], v11, s[56:59], s61 offen
    s_add_u32 s61, s85, 4096
    buffer_load_dwordx4 v[188:191], v11, s[56:59], s61 offen
    s_add_u32 s61, s85, 0
    buffer_load_dwordx4 v[192:195], v11, s[56:59], s61 offen
    s_add_u32 s61, s85, 198656
    buffer_load_dwordx4 v[196:199], v11, s[56:59], s61 offen
z_pe:
    s_barrier
    s_branch s_tail
s_tail:
    s_bitcmp1_b32 s21, 0
    s_cbranch_scc1 s_B
    s_cmp_lg_u32 s16, 4
    s_cbranch_scc1 s_a1
    s_mov_b32 s45, 2146435072
    s_cmp_eq_u32 s17, 0
    s_cbranch_scc1 s_a0
    s_lshr_b32 s46, s21, 1
    s_lshl_b32 s44, s46, 15
    s_lshl_b32 s67, s17, 11
    s_add_u32 s44, s44, s67
    s_lshl_b32 s67, s18, 7
    s_add_u32 s44, s44, s67
    s_add_u32 s44, s44, 149504
    s_sub_u32 s45, s44, 151552
    s_lshl_b32 s45, s45, 5
    s_add_u32 s45, s45, 54525952
    s_mov_b32 s66, 0x10000
s_h_poll:
    s_mov_b32 s68, 0
    s_atomic_add s68, s[22:23], s44 offset:0 glc
    s_sub_u32 s66, s66, 1
    s_cselect_b32 s67, 1, 0
    s_waitcnt lgkmcnt(0)
    s_max_u32 s68, s68, s67
    s_cmp_lt_u32 s68, 1
    s_cbranch_scc1 s_h_poll
s_h_ok:
s_a0:
    s_mov_b32 m0, 131072
    s_nop 0
    buffer_load_dwordx4 v1, s[4:7], s45 offen offset:0 sc1 lds
    buffer_load_dwordx4 v1, s[4:7], s45 offen offset:1024 sc1 lds
    buffer_load_dwordx4 v1, s[4:7], s45 offen offset:2048 sc1 lds
    buffer_load_dwordx4 v1, s[4:7], s45 offen offset:3072 sc1 lds
    s_waitcnt vmcnt(0)
s_a1:
    s_barrier
    s_waitcnt vmcnt(0)
    s_barrier
    s_sub_u32 s3, s16, 5
    s_cmp_gt_u32 s3, 1
    s_cbranch_scc1 s_a2
    s_add_u32 m0, s41, 65536
    s_xor_b32 s44, s62, 65536
    buffer_load_dwordx4 v16, s[12:15], s44 offen offset:0 lds
    buffer_load_dwordx4 v17, s[12:15], s44 offen offset:1024 lds
    s_add_u32 m0, s41, 69632
    s_xor_b32 s44, s62, 196608
    buffer_load_dwordx4 v16, s[12:15], s44 offen offset:0 lds
    buffer_load_dwordx4 v17, s[12:15], s44 offen offset:1024 lds
    s_add_u32 m0, s41, 73728
    s_xor_b32 s44, s62, 327680
    buffer_load_dwordx4 v16, s[12:15], s44 offen offset:0 lds
    buffer_load_dwordx4 v17, s[12:15], s44 offen offset:1024 lds
    s_add_u32 m0, s41, 77824
    s_xor_b32 s44, s62, 458752
    buffer_load_dwordx4 v16, s[12:15], s44 offen offset:0 lds
    buffer_load_dwordx4 v17, s[12:15], s44 offen offset:1024 lds
    s_add_u32 m0, s41, 81920
    s_xor_b32 s44, s62, 589824
    buffer_load_dwordx4 v16, s[12:15], s44 offen offset:0 lds
    buffer_load_dwordx4 v17, s[12:15], s44 offen offset:1024 lds
    s_add_u32 m0, s41, 86016
    s_xor_b32 s44, s62, 720896
    buffer_load_dwordx4 v16, s[12:15], s44 offen offset:0 lds
    buffer_load_dwordx4 v17, s[12:15], s44 offen offset:1024 lds
    s_add_u32 m0, s41, 90112
    s_xor_b32 s44, s62, 851968
    buffer_load_dwordx4 v16, s[12:15], s44 offen offset:0 lds
    buffer_load_dwordx4 v17, s[12:15], s44 offen offset:1024 lds
    s_add_u32 m0, s41, 94208
    s_xor_b32 s44, s62, 983040
    buffer_load_dwordx4 v16, s[12:15], s44 offen offset:0 lds
    buffer_load_dwordx4 v17, s[12:15], s44 offen offset:1024 lds
    s_add_u32 m0, s41, 98304
    s_xor_b32 s44, s62, 1114112
    buffer_load_dwordx4 v16, s[12:15], s44 offen offset:0 lds
    buffer_load_dwordx4 v17, s[12:15], s44 offen offset:1024 lds
    s_add_u32 m0, s41, 102400
    s_xor_b32 s44, s62, 1245184
    buffer_load_dwordx4 v16, s[12:15], s44 offen offset:0 lds
    buffer_load_dwordx4 v17, s[12:15], s44 offen offset:1024 lds
    s_add_u32 m0, s41, 106496
    s_xor_b32 s44, s62, 1376256
    buffer_load_dwordx4 v16, s[12:15], s44 offen offset:0 lds
    buffer_load_dwordx4 v17, s[12:15], s44 offen offset:1024 lds
    s_add_u32 m0, s41, 110592
    s_xor_b32 s44, s62, 1507328
    buffer_load_dwordx4 v16, s[12:15], s44 offen offset:0 lds
    buffer_load_dwordx4 v17, s[12:15], s44 offen offset:1024 lds
    s_add_u32 m0, s41, 114688
    s_xor_b32 s44, s62, 1638400
    buffer_load_dwordx4 v16, s[12:15], s44 offen offset:0 lds
    buffer_load_dwordx4 v17, s[12:15], s44 offen offset:1024 lds
    s_add_u32 m0, s41, 118784
    s_xor_b32 s44, s62, 1769472
    buffer_load_dwordx4 v16, s[12:15], s44 offen offset:0 lds
    buffer_load_dwordx4 v17, s[12:15], s44 offen offset:1024 lds
    s_add_u32 m0, s41, 122880
    s_xor_b32 s44, s62, 1900544
    buffer_load_dwordx4 v16, s[12:15], s44 offen offset:0 lds
    buffer_load_dwordx4 v17, s[12:15], s44 offen offset:1024 lds
    s_add_u32 m0, s41, 126976
    s_xor_b32 s44, s62, 2031616
    buffer_load_dwordx4 v16, s[12:15], s44 offen offset:0 lds
    buffer_load_dwordx4 v17, s[12:15], s44 offen offset:1024 lds
s_a2:
    s_cmp_eq_u32 s21, 2
    s_cbranch_scc1 s_a3
    s_bitcmp0_b32 s21, 0
    s_cselect_b32 s56, s28, s24
    s_cselect_b32 s57, s29, s25
    s_mov_b32 s58, 6291456
    s_mov_b32 s59, 0x00020000
    s_add_u32 s61, s84, 2048
    buffer_load_dwordx4 v[160:163], v11, s[56:59], s61 offen
    s_add_u32 s61, s84, 4096
    buffer_load_dwordx4 v[164:167], v11, s[56:59], s61 offen
    s_add_u32 s61, s84, 0
    buffer_load_dwordx4 v[168:171], v11, s[56:59], s61 offen
    s_add_u32 s61, s84, 198656
    buffer_load_dwordx4 v[172:175], v11, s[56:59], s61 offen
    s_add_u32 s61, s84, 200704
    buffer_load_dwordx4 v[176:179], v11, s[56:59], s61 offen
    s_add_u32 s61, s84, 196608
    buffer_load_dwordx4 v[180:183], v11, s[56:59], s61 offen
    s_add_u32 s61, s85, 2048
    buffer_load_dwordx4 v[184:187], v11, s[56:59], s61 offen
    s_add_u32 s61, s85, 4096
    buffer_load_dwordx4 v[188:191], v11, s[56:59], s61 offen
    s_add_u32 s61, s85, 0
    buffer_load_dwordx4 v[192:195], v11, s[56:59], s61 offen
    s_add_u32 s61, s85, 198656
    buffer_load_dwordx4 v[196:199], v11, s[56:59], s61 offen
s_a3:
    s_bitcmp0_b32 s21, 0
    s_cselect_b32 s56, s28, s24
    s_cselect_b32 s57, s29, s25
    s_mov_b32 s58, 6291456
    s_mov_b32 s59, 0x00020000
    s_add_u32 s61, s85, 200704
    buffer_load_dwordx4 v[200:203], v11, s[56:59], s61 offen
    s_add_u32 s61, s85, 196608
    buffer_load_dwordx4 v[204:207], v11, s[56:59], s61 offen
    s_add_u32 s61, s86, 2048
    buffer_load_dwordx4 v[208:211], v11, s[56:59], s61 offen
    s_add_u32 s61, s86, 4096
    buffer_load_dwordx4 v[212:215], v11, s[56:59], s61 offen
    s_add_u32 s61, s86, 0
    buffer_load_dwordx4 v[216:219], v11, s[56:59], s61 offen
    s_add_u32 s61, s86, 198656
    buffer_load_dwordx4 v[220:223], v11, s[56:59], s61 offen
    s_add_u32 s61, s86, 200704
    buffer_load_dwordx4 v[224:227], v11, s[56:59], s61 offen
    s_add_u32 s61, s86, 196608
    buffer_load_dwordx4 v[228:231], v11, s[56:59], s61 offen
    s_add_u32 s61, s87, 2048
    buffer_load_dwordx4 v[232:235], v11, s[56:59], s61 offen
    s_add_u32 s61, s87, 4096
    buffer_load_dwordx4 v[236:239], v11, s[56:59], s61 offen
    s_add_u32 s61, s87, 0
    buffer_load_dwordx4 v[240:243], v11, s[56:59], s61 offen
    s_add_u32 s61, s87, 198656
    buffer_load_dwordx4 v[244:247], v11, s[56:59], s61 offen
    s_add_u32 s61, s87, 200704
    buffer_load_dwordx4 v[248:251], v11, s[56:59], s61 offen
    s_add_u32 s61, s87, 196608
    buffer_load_dwordx4 v[252:255], v11, s[56:59], s61 offen
    s_waitcnt vmcnt(0)
    s_lshl_b32 s3, s21, 3
    s_add_u32 s3, s3, s16
    s_cmp_lg_u32 s3, 7
    s_cbranch_scc1 s_g3
    v_lshrrev_b32 v24, 4, v1
    v_and_b32 v25, 1, v24
    v_lshlrev_b32 v25, 4, v25
    v_mov_b32 v26, 0x3f80
    v_lshlrev_b32 v25, v25, v26
    v_bfe_u32 v26, v24, 1, 2
    v_cmp_eq_u32 vcc, 0, v26
    s_nop 1
    v_cndmask_b32 v140, 0, v25, vcc
    v_cmp_eq_u32 vcc, 1, v26
    s_nop 1
    v_cndmask_b32 v141, 0, v25, vcc
    v_cmp_eq_u32 vcc, 2, v26
    s_nop 1
    v_cndmask_b32 v142, 0, v25, vcc
    v_cmp_eq_u32 vcc, 3, v26
    s_nop 1
    v_cndmask_b32 v143, 0, v25, vcc
    s_nop 1
    v_mfma_f32_16x16x32_bf16 v[128:131], v[140:143], v[32:35], 0
    v_mfma_f32_16x16x32_bf16 v[132:135], v[140:143], v[64:67], 0
    v_mfma_f32_16x16x32_bf16 v[136:139], v[140:143], v[96:99], 0
    v_mfma_f32_16x16x32_bf16 v[128:131], v[140:143], v[36:39], v[128:131]
    v_mfma_f32_16x16x32_bf16 v[132:135], v[140:143], v[68:71], v[132:135]
    v_mfma_f32_16x16x32_bf16 v[136:139], v[140:143], v[100:103], v[136:139]
    v_mfma_f32_16x16x32_bf16 v[128:131], v[140:143], v[40:43], v[128:131]
    v_mfma_f32_16x16x32_bf16 v[132:135], v[140:143], v[72:75], v[132:135]
    v_mfma_f32_16x16x32_bf16 v[136:139], v[140:143], v[104:107], v[136:139]
    v_mfma_f32_16x16x32_bf16 v[128:131], v[140:143], v[44:47], v[128:131]
    v_mfma_f32_16x16x32_bf16 v[132:135], v[140:143], v[76:79], v[132:135]
    v_mfma_f32_16x16x32_bf16 v[136:139], v[140:143], v[108:111], v[136:139]
    v_mfma_f32_16x16x32_bf16 v[128:131], v[140:143], v[48:51], v[128:131]
    v_mfma_f32_16x16x32_bf16 v[132:135], v[140:143], v[80:83], v[132:135]
    v_mfma_f32_16x16x32_bf16 v[136:139], v[140:143], v[112:115], v[136:139]
    v_mfma_f32_16x16x32_bf16 v[128:131], v[140:143], v[52:55], v[128:131]
    v_mfma_f32_16x16x32_bf16 v[132:135], v[140:143], v[84:87], v[132:135]
    v_mfma_f32_16x16x32_bf16 v[136:139], v[140:143], v[116:119], v[136:139]
    v_mfma_f32_16x16x32_bf16 v[128:131], v[140:143], v[56:59], v[128:131]
    v_mfma_f32_16x16x32_bf16 v[132:135], v[140:143], v[88:91], v[132:135]
    v_mfma_f32_16x16x32_bf16 v[136:139], v[140:143], v[120:123], v[136:139]
    v_mfma_f32_16x16x32_bf16 v[128:131], v[140:143], v[60:63], v[128:131]
    v_mfma_f32_16x16x32_bf16 v[132:135], v[140:143], v[92:95], v[132:135]
    v_mfma_f32_16x16x32_bf16 v[136:139], v[140:143], v[124:127], v[136:139]
    v_bfe_u32 v25, v24, 3, 1
    v_lshrrev_b32 v26, 5, v24
    v_lshl_add_u32 v26, v26, 1, v25
    v_lshlrev_b32 v25, 8, v26
    v_and_b32 v27, 7, v24
    v_lshl_add_u32 v25, v27, 5, v25
    v_bfe_u32 v27, v24, 4, 1
    v_lshl_add_u32 v25, v27, 4, v25
    v_add_f32_dpp v128, v128, v128 row_ror:8 row_mask:0xf bank_mask:0xf
    v_add_f32_dpp v129, v129, v129 row_ror:8 row_mask:0xf bank_mask:0xf
    v_add_f32_dpp v130, v130, v130 row_ror:8 row_mask:0xf bank_mask:0xf
    v_add_f32_dpp v131, v131, v131 row_ror:8 row_mask:0xf bank_mask:0xf
    v_add_f32_dpp v132, v132, v132 row_ror:8 row_mask:0xf bank_mask:0xf
    v_add_f32_dpp v133, v133, v133 row_ror:8 row_mask:0xf bank_mask:0xf
    v_add_f32_dpp v134, v134, v134 row_ror:8 row_mask:0xf bank_mask:0xf
    v_add_f32_dpp v135, v135, v135 row_ror:8 row_mask:0xf bank_mask:0xf
    v_add_f32_dpp v136, v136, v136 row_ror:8 row_mask:0xf bank_mask:0xf
    v_add_f32_dpp v137, v137, v137 row_ror:8 row_mask:0xf bank_mask:0xf
    v_add_f32_dpp v138, v138, v138 row_ror:8 row_mask:0xf bank_mask:0xf
    v_add_f32_dpp v139, v139, v139 row_ror:8 row_mask:0xf bank_mask:0xf
    v_cmp_le_u32 vcc, 1, v26
    s_nop 1
    v_cndmask_b32 v128, v128, v132, vcc
    v_cndmask_b32 v129, v129, v133, vcc
    v_cndmask_b32 v130, v130, v134, vcc
    v_cndmask_b32 v131, v131, v135, vcc
    v_cmp_le_u32 vcc, 2, v26
    s_nop 1
    v_cndmask_b32 v128, v128, v136, vcc
    v_cndmask_b32 v129, v129, v137, vcc
    v_cndmask_b32 v130, v130, v138, vcc
    v_cndmask_b32 v131, v131, v139, vcc
    v_add_u32 v27, s18, v26
    v_and_b32 v27, 15, v27
    v_lshl_add_u32 v25, v27, 14, v25
    s_lshl_b32 s44, s17, 10
    s_add_u32 s44, s44, 52690944
    buffer_store_dwordx4 v[128:131], v25, s[4:7], s44 offen sc1
    s_waitcnt vmcnt(0)
    s_add_u32 s44, s18, 0
    s_and_b32 s44, s44, 15
    s_lshl_b32 s44, s44, 7
    s_add_u32 s44, s44, 2048
    s_atomic_add s40, s[22:23], s44
    s_add_u32 s45, s18, 1
    s_and_b32 s45, s45, 15
    s_lshl_b32 s45, s45, 7
    s_add_u32 s45, s45, 2048
    s_atomic_add s40, s[22:23], s45
    s_add_u32 s46, s18, 2
    s_and_b32 s46, s46, 15
    s_lshl_b32 s46, s46, 7
    s_add_u32 s46, s46, 2048
    s_atomic_add s40, s[22:23], s46
    s_branch s_g3
s_B:
    s_barrier
    s_cmp_eq_u32 s21, 3
    s_cbranch_scc1 s_nopf
    s_bitcmp0_b32 s21, 0
    s_cselect_b32 s56, s28, s24
    s_cselect_b32 s57, s29, s25
    s_mov_b32 s58, 6291456
    s_mov_b32 s59, 0x00020000
    s_add_u32 s61, s84, 2048
    buffer_load_dwordx4 v[160:163], v11, s[56:59], s61 offen
    s_add_u32 s61, s84, 4096
    buffer_load_dwordx4 v[164:167], v11, s[56:59], s61 offen
    s_add_u32 s61, s84, 0
    buffer_load_dwordx4 v[168:171], v11, s[56:59], s61 offen
    s_add_u32 s61, s84, 198656
    buffer_load_dwordx4 v[172:175], v11, s[56:59], s61 offen
    s_waitcnt vmcnt(2)
    s_add_u32 s61, s84, 200704
    buffer_load_dwordx4 v[176:179], v11, s[56:59], s61 offen
    s_add_u32 s61, s84, 196608
    buffer_load_dwordx4 v[180:183], v11, s[56:59], s61 offen
    s_add_u32 s61, s85, 2048
    buffer_load_dwordx4 v[184:187], v11, s[56:59], s61 offen
    s_add_u32 s61, s85, 4096
    buffer_load_dwordx4 v[188:191], v11, s[56:59], s61 offen
    s_waitcnt vmcnt(2)
    s_add_u32 s61, s85, 0
    buffer_load_dwordx4 v[192:195], v11, s[56:59], s61 offen
    s_add_u32 s61, s85, 198656
    buffer_load_dwordx4 v[196:199], v11, s[56:59], s61 offen
    s_add_u32 s61, s85, 200704
    buffer_load_dwordx4 v[200:203], v11, s[56:59], s61 offen
    s_add_u32 s61, s85, 196608
    buffer_load_dwordx4 v[204:207], v11, s[56:59], s61 offen
    s_waitcnt vmcnt(2)
    s_add_u32 s61, s86, 2048
    buffer_load_dwordx4 v[208:211], v11, s[56:59], s61 offen
    s_add_u32 s61, s86, 4096
    buffer_load_dwordx4 v[212:215], v11, s[56:59], s61 offen
    s_add_u32 s61, s86, 0
    buffer_load_dwordx4 v[216:219], v11, s[56:59], s61 offen
    s_add_u32 s61, s86, 198656
    buffer_load_dwordx4 v[220:223], v11, s[56:59], s61 offen
    s_waitcnt vmcnt(2)
    s_add_u32 s61, s86, 200704
    buffer_load_dwordx4 v[224:227], v11, s[56:59], s61 offen
    s_add_u32 s61, s86, 196608
    buffer_load_dwordx4 v[228:231], v11, s[56:59], s61 offen
    s_add_u32 s61, s87, 2048
    buffer_load_dwordx4 v[232:235], v11, s[56:59], s61 offen
    s_add_u32 s61, s87, 4096
    buffer_load_dwordx4 v[236:239], v11, s[56:59], s61 offen
    s_waitcnt vmcnt(2)
    s_add_u32 s61, s87, 0
    buffer_load_dwordx4 v[240:243], v11, s[56:59], s61 offen
    s_add_u32 s61, s87, 198656
    buffer_load_dwordx4 v[244:247], v11, s[56:59], s61 offen
    s_add_u32 s61, s87, 200704
    buffer_load_dwordx4 v[248:251], v11, s[56:59], s61 offen
    s_add_u32 s61, s87, 196608
    buffer_load_dwordx4 v[252:255], v11, s[56:59], s61 offen
    s_waitcnt vmcnt(2)
    s_lshl_b32 s3, s2, 2
    s_and_b32 s60, s16, 3
    s_add_u32 s60, s60, s3
    s_lshl_b32 s60, s60, 11
    buffer_load_dwordx4 v[96:99], v1, s[12:15], s60 offen offset:0
    buffer_load_dwordx4 v[100:103], v1, s[12:15], s60 offen offset:1024
s_nopf:
    s_setprio 3
    s_mov_b32 s52, 0
    s_lshl_b32 s44, s16, 14
    v_add_u32 v24, s44, v1
    s_and_b32 s3, s16, 3
    s_lshl_b32 s44, s3, 10
    s_add_u32 s44, s44, 147456
    v_lshrrev_b32 v25, 2, v1
    v_add_u32 v25, s44, v25
    s_lshl_b32 s53, s21, 22
    s_lshl_b32 s44, s38, 16
    s_add_u32 s53, s53, s44
    s_lshl_b32 s44, s18, 12
    s_add_u32 s53, s53, s44
    s_add_u32 s53, s53, 16777216
    s_lshl_b32 s54, s21, 14
    s_lshl_b32 s67, s38, 8
    s_add_u32 s54, s54, s67
    s_add_u32 s54, s54, 86016
s_bhead:
    s_barrier
    s_waitcnt vmcnt(0) lgkmcnt(0)
    s_barrier
    ds_read_b32 v28, v25 offset:0
    ds_read_b32 v29, v25 offset:256
    ds_read_b32 v30, v25 offset:512
    ds_read_b32 v31, v25 offset:768
    ds_read_b128 v[32:35], v24 offset:0
    ds_read_b128 v[36:39], v24 offset:1024
    ds_read_b128 v[40:43], v24 offset:2048
    ds_read_b128 v[44:47], v24 offset:3072
    ds_read_b128 v[48:51], v24 offset:4096
    ds_read_b128 v[52:55], v24 offset:5120
    ds_read_b128 v[56:59], v24 offset:6144
    ds_read_b128 v[60:63], v24 offset:7168
    ds_read_b128 v[64:67], v24 offset:8192
    ds_read_b128 v[68:71], v24 offset:9216
    ds_read_b128 v[72:75], v24 offset:10240
    ds_read_b128 v[76:79], v24 offset:11264
    ds_read_b128 v[80:83], v24 offset:12288
    ds_read_b128 v[84:87], v24 offset:13312
    ds_read_b128 v[88:91], v24 offset:14336
    ds_read_b128 v[92:95], v24 offset:15360
    s_waitcnt lgkmcnt(14)
    v_add_f32 v28, v28, v29
    v_add_f32 v30, v30, v31
    v_add_f32 v28, v28, v30
    v_mov_b32 v29, 0x5d800000
    v_mov_b32 v30, 0x21800000
    v_cmp_nlt_f32 s[44:45], v28, v29
    v_cmp_ngt_f32 vcc, v28, v30
    v_rcp_f32 v28, v28
    s_or_b64 vcc, vcc, s[44:45]
    s_waitcnt lgkmcnt(8)
    v_pk_add_f32 v[32:33], v[32:33], v[48:49]
    v_pk_add_f32 v[34:35], v[34:35], v[50:51]
    v_pk_add_f32 v[36:37], v[36:37], v[52:53]
    v_pk_add_f32 v[38:39], v[38:39], v[54:55]
    v_pk_add_f32 v[40:41], v[40:41], v[56:57]
    v_pk_add_f32 v[42:43], v[42:43], v[58:59]
    v_pk_add_f32 v[44:45], v[44:45], v[60:61]
    v_pk_add_f32 v[46:47], v[46:47], v[62:63]
    s_waitcnt lgkmcnt(4)
    v_pk_add_f32 v[32:33], v[32:33], v[64:65]
    v_pk_add_f32 v[34:35], v[34:35], v[66:67]
    v_pk_add_f32 v[36:37], v[36:37], v[68:69]
    v_pk_add_f32 v[38:39], v[38:39], v[70:71]
    v_pk_add_f32 v[40:41], v[40:41], v[72:73]
    v_pk_add_f32 v[42:43], v[42:43], v[74:75]
    v_pk_add_f32 v[44:45], v[44:45], v[76:77]
    v_pk_add_f32 v[46:47], v[46:47], v[78:79]
    s_waitcnt lgkmcnt(0)
    v_pk_add_f32 v[32:33], v[32:33], v[80:81]
    v_pk_add_f32 v[34:35], v[34:35], v[82:83]
    v_pk_add_f32 v[36:37], v[36:37], v[84:85]
    v_pk_add_f32 v[38:39], v[38:39], v[86:87]
    v_pk_add_f32 v[40:41], v[40:41], v[88:89]
    v_pk_add_f32 v[42:43], v[42:43], v[90:91]
    v_pk_add_f32 v[44:45], v[44:45], v[92:93]
    v_pk_add_f32 v[46:47], v[46:47], v[94:95]
    s_cbranch_vccnz s_slow
s_fin:
    v_pk_mul_f32 v[32:33], v[28:29], v[32:33] op_sel_hi:[0,1]
    v_pk_mul_f32 v[34:35], v[28:29], v[34:35] op_sel_hi:[0,1]
    v_pk_mul_f32 v[36:37], v[28:29], v[36:37] op_sel_hi:[0,1]
    v_pk_mul_f32 v[38:39], v[28:29], v[38:39] op_sel_hi:[0,1]
    v_pk_mul_f32 v[40:41], v[28:29], v[40:41] op_sel_hi:[0,1]
    v_pk_mul_f32 v[42:43], v[28:29], v[42:43] op_sel_hi:[0,1]
    v_pk_mul_f32 v[44:45], v[28:29], v[44:45] op_sel_hi:[0,1]
    v_pk_mul_f32 v[46:47], v[28:29], v[46:47] op_sel_hi:[0,1]
    v_cvt_pk_bf16_f32 v32, v32, v33
    v_cvt_pk_bf16_f32 v33, v34, v35
    v_cvt_pk_bf16_f32 v34, v36, v37
    v_cvt_pk_bf16_f32 v35, v38, v39
    v_cvt_pk_bf16_f32 v36, v40, v41
    v_cvt_pk_bf16_f32 v37, v42, v43
    v_cvt_pk_bf16_f32 v38, v44, v45
    v_cvt_pk_bf16_f32 v39, v46, v47
    buffer_store_dwordx4 v[32:35], v1, s[4:7], s53 offen offset:0 sc1
    buffer_store_dwordx4 v[36:39], v1, s[4:7], s53 offen offset:1024 sc1
    s_cmp_lg_u32 s52, 0
    s_cbranch_scc1 s_b2
    s_waitcnt vmcnt(0)
    s_atomic_add s40, s[22:23], s54
    s_mov_b32 s52, 1
    s_add_u32 s53, s53, 2048
    s_waitcnt lgkmcnt(0)
    s_add_u32 s54, s54, 128
    s_setprio 0
    s_and_b32 s3, s16, 3
    s_lshl_b32 s46, s3, 19
    s_lshl_b32 s45, s3, 14
    s_and_b32 s3, s20, 0
    s_lshl_b32 s3, s3, 17
    s_xor_b32 s46, s46, s3
    s_add_u32 m0, s45, 0
    s_xor_b32 s44, s46, 0
    buffer_load_dwordx4 v16, s[12:15], s44 offen offset:0 lds
    buffer_load_dwordx4 v17, s[12:15], s44 offen offset:1024 lds
    buffer_load_dwordx4 v18, s[12:15], s44 offen offset:2048 lds
    buffer_load_dwordx4 v19, s[12:15], s44 offen offset:3072 lds
    s_add_u32 s44, s44, 65536
    s_waitcnt vmcnt(2)
    buffer_load_dwordx4 v[96:99], v16, s[12:15], s44 offen offset:0
    buffer_load_dwordx4 v[100:103], v17, s[12:15], s44 offen offset:1024
    buffer_load_dwordx4 v[104:107], v18, s[12:15], s44 offen offset:2048
    buffer_load_dwordx4 v[108:111], v19, s[12:15], s44 offen offset:3072
    s_waitcnt vmcnt(2)
    s_add_u32 m0, s45, 4096
    s_xor_b32 s44, s46, 131072
    buffer_load_dwordx4 v16, s[12:15], s44 offen offset:0 lds
    buffer_load_dwordx4 v17, s[12:15], s44 offen offset:1024 lds
    buffer_load_dwordx4 v18, s[12:15], s44 offen offset:2048 lds
    buffer_load_dwordx4 v19, s[12:15], s44 offen offset:3072 lds
    s_add_u32 s44, s44, 65536
    s_waitcnt vmcnt(2)
    buffer_load_dwordx4 v[112:115], v16, s[12:15], s44 offen offset:0
    buffer_load_dwordx4 v[116:119], v17, s[12:15], s44 offen offset:1024
    buffer_load_dwordx4 v[120:123], v18, s[12:15], s44 offen offset:2048
    buffer_load_dwordx4 v[124:127], v19, s[12:15], s44 offen offset:3072
    s_waitcnt vmcnt(2)
    s_add_u32 m0, s45, 8192
    s_xor_b32 s44, s46, 262144
    buffer_load_dwordx4 v16, s[12:15], s44 offen offset:0 lds
    buffer_load_dwordx4 v17, s[12:15], s44 offen offset:1024 lds
    buffer_load_dwordx4 v18, s[12:15], s44 offen offset:2048 lds
    buffer_load_dwordx4 v19, s[12:15], s44 offen offset:3072 lds
    s_add_u32 s44, s44, 65536
    s_waitcnt vmcnt(2)
    buffer_load_dwordx4 v[128:131], v16, s[12:15], s44 offen offset:0
    buffer_load_dwordx4 v[132:135], v17, s[12:15], s44 offen offset:1024
    buffer_load_dwordx4 v[136:139], v18, s[12:15], s44 offen offset:2048
    buffer_load_dwordx4 v[140:143], v19, s[12:15], s44 offen offset:3072
    s_waitcnt vmcnt(2)
    s_add_u32 m0, s45, 12288
    s_xor_b32 s44, s46, 393216
    buffer_load_dwordx4 v16, s[12:15], s44 offen offset:0 lds
    buffer_load_dwordx4 v17, s[12:15], s44 offen offset:1024 lds
    buffer_load_dwordx4 v18, s[12:15], s44 offen offset:2048 lds
    buffer_load_dwordx4 v19, s[12:15], s44 offen offset:3072 lds
    s_add_u32 s44, s44, 65536
    s_waitcnt vmcnt(2)
    buffer_load_dwordx4 v[144:147], v16, s[12:15], s44 offen offset:0
    buffer_load_dwordx4 v[148:151], v17, s[12:15], s44 offen offset:1024
    buffer_load_dwordx4 v[152:155], v18, s[12:15], s44 offen offset:2048
    buffer_load_dwordx4 v[156:159], v19, s[12:15], s44 offen offset:3072
    s_waitcnt vmcnt(2)
    s_setprio 3
    s_sub_u32 s44, s54, 128
    s_mov_b32 s66, 0x10000
s_o0_poll:
    s_mov_b32 s68, 0
    s_atomic_add s68, s[22:23], s44 offset:0 glc
    s_sub_u32 s66, s66, 1
    s_cselect_b32 s67, 16, 0
    s_waitcnt lgkmcnt(0)
    s_max_u32 s68, s68, s67
    s_cmp_lt_u32 s68, 16
    s_cbranch_scc1 s_o0_poll
s_o0_ok:
    s_branch s_bhead
s_b2:
    ds_write_b128 v24, v[96:99] offset:0
    ds_write_b128 v24, v[100:103] offset:1024
    ds_write_b128 v24, v[104:107] offset:2048
    ds_write_b128 v24, v[108:111] offset:3072
    ds_write_b128 v24, v[112:115] offset:4096
    ds_write_b128 v24, v[116:119] offset:5120
    ds_write_b128 v24, v[120:123] offset:6144
    ds_write_b128 v24, v[124:127] offset:7168
    ds_write_b128 v24, v[128:131] offset:8192
    ds_write_b128 v24, v[132:135] offset:9216
    ds_write_b128 v24, v[136:139] offset:10240
    ds_write_b128 v24, v[140:143] offset:11264
    ds_write_b128 v24, v[144:147] offset:12288
    ds_write_b128 v24, v[148:151] offset:13312
    ds_write_b128 v24, v[152:155] offset:14336
    ds_write_b128 v24, v[156:159] offset:15360
    s_waitcnt vmcnt(0)
    s_atomic_add s40, s[22:23], s54
    s_mov_b32 s66, 0x10000
s_o1_poll:
    s_mov_b32 s68, 0
    s_atomic_add s68, s[22:23], s54 offset:0 glc
    s_sub_u32 s66, s66, 1
    s_cselect_b32 s67, 16, 0
    s_waitcnt lgkmcnt(0)
    s_max_u32 s68, s68, s67
    s_cmp_lt_u32 s68, 16
    s_cbranch_scc1 s_o1_poll
s_o1_ok:
s_b3:
    s_setprio 0
    s_waitcnt lgkmcnt(0)
s_g3:
    s_barrier
    s_cmp_eq_u32 s21, 3
    s_cbranch_scc1 s_end
    s_barrier
    ds_write_b128 v9, v[160:163] offset:0
    ds_write_b128 v9, v[164:167] offset:4096
    ds_write_b128 v9, v[168:171] offset:8192
    ds_write_b128 v9, v[172:175] offset:12288
    ds_write_b128 v9, v[176:179] offset:16384
    ds_write_b128 v9, v[180:183] offset:20480
    ds_write_b128 v9, v[184:187] offset:24576
    ds_write_b128 v9, v[188:191] offset:28672
    s_add_u32 s21, s21, 1
    s_bitcmp1_b32 s21, 0
    s_cselect_b32 s8, s28, s24
    s_cselect_b32 s9, s29, s25
    s_cselect_b32 s12, s30, s26
    s_cselect_b32 s13, s31, s27
    s_mov_b32 s10, 6291456
    s_mov_b32 s11, 0x00020000
    s_mov_b32 s14, 2097152
    s_mov_b32 s15, 0x00020000
    s_sub_u32 s3, s16, 5
    s_cmp_gt_u32 s3, 1
    s_cbranch_scc1 s_n67
    s_add_u32 m0, s41, 98304
    s_add_u32 s44, s88, 2048
    buffer_load_dwordx4 v14, s[8:11], s44 offen offset:0 lds
    buffer_load_dwordx4 v15, s[8:11], s44 offen offset:1024 lds
    s_add_u32 m0, s41, 102400
    s_add_u32 s44, s88, 4096
    buffer_load_dwordx4 v14, s[8:11], s44 offen offset:0 lds
    buffer_load_dwordx4 v15, s[8:11], s44 offen offset:1024 lds
    s_add_u32 m0, s41, 106496
    s_add_u32 s44, s88, 0
    buffer_load_dwordx4 v14, s[8:11], s44 offen offset:0 lds
    buffer_load_dwordx4 v15, s[8:11], s44 offen offset:1024 lds
    s_add_u32 m0, s41, 110592
    s_add_u32 s44, s88, 198656
    buffer_load_dwordx4 v14, s[8:11], s44 offen offset:0 lds
    buffer_load_dwordx4 v15, s[8:11], s44 offen offset:1024 lds
    s_add_u32 m0, s41, 114688
    s_add_u32 s44, s88, 200704
    buffer_load_dwordx4 v14, s[8:11], s44 offen offset:0 lds
    buffer_load_dwordx4 v15, s[8:11], s44 offen offset:1024 lds
    s_add_u32 m0, s41, 118784
    s_add_u32 s44, s88, 196608
    buffer_load_dwordx4 v14, s[8:11], s44 offen offset:0 lds
    buffer_load_dwordx4 v15, s[8:11], s44 offen offset:1024 lds
    s_add_u32 m0, s41, 122880
    s_add_u32 s44, s89, 2048
    buffer_load_dwordx4 v14, s[8:11], s44 offen offset:0 lds
    buffer_load_dwordx4 v15, s[8:11], s44 offen offset:1024 lds
    s_add_u32 m0, s41, 126976
    s_add_u32 s44, s89, 4096
    buffer_load_dwordx4 v14, s[8:11], s44 offen offset:0 lds
    buffer_load_dwordx4 v15, s[8:11], s44 offen offset:1024 lds
s_n67:
    s_waitcnt lgkmcnt(0)
    s_barrier
    ds_write_b128 v9, v[192:195] offset:32768
    ds_write_b128 v9, v[196:199] offset:36864
    ds_write_b128 v9, v[200:203] offset:40960
    ds_write_b128 v9, v[204:207] offset:45056
    ds_write_b128 v9, v[208:211] offset:49152
    ds_write_b128 v9, v[212:215] offset:53248
    ds_write_b128 v9, v[216:219] offset:57344
    ds_write_b128 v9, v[220:223] offset:61440
    ds_write_b128 v10, v[224:227] offset:0
    ds_write_b128 v10, v[228:231] offset:4096
    ds_write_b128 v10, v[232:235] offset:8192
    ds_write_b128 v10, v[236:239] offset:12288
    ds_write_b128 v10, v[240:243] offset:16384
    ds_write_b128 v10, v[244:247] offset:20480
    ds_write_b128 v10, v[248:251] offset:24576
    ds_write_b128 v10, v[252:255] offset:28672
    s_cmp_eq_u32 s16, 4
    s_cbranch_scc1 h_layer
    s_cmp_eq_u32 s16, 7
    s_cbranch_scc1 z_layer
    s_branch l_layer
s_end:
    s_lshl_b32 s3, s2, 3
    s_add_u32 s3, s3, s16
    s_cmp_lg_u32 s3, 7
    s_cbranch_scc1 k_exit
    s_mov_b32 s8, s34
    s_mov_b32 s9, s35
    s_mov_b32 s10, 256
    s_mov_b32 s11, 0x00020000
    v_lshrrev_b32 v24, 2, v1
    v_mov_b32 v25, 0
    buffer_store_dword v25, v24, s[8:11], 0 offen sc1
    s_branch k_exit
s_slow:
    s_and_b32 s3, s16, 3
    s_lshl_b32 s44, s3, 11
    s_lshl_b32 s45, s52, 13
    s_add_u32 s44, s44, s45
    s_add_u32 s44, s44, 131072
    v_add_u32 v26, s44, v1
    ds_read_b128 v[48:51], v26 offset:0
    ds_read_b128 v[52:55], v26 offset:1024
    s_lshr_b32 s55, s21, 1
    s_lshl_b32 s55, s55, 23
    s_lshl_b32 s44, s18, 18
    s_add_u32 s55, s55, s44
    s_lshl_b32 s44, s52, 17
    s_add_u32 s55, s55, s44
    s_add_u32 s55, s55, 33554432
    s_waitcnt lgkmcnt(0)
    v_mov_b32 v26, 0xff800000
    s_mov_b32 s61, 0
s_slow1:
    s_add_u32 s44, s55, s61
    buffer_load_dwordx4 v[56:59], v1, s[4:7], s44 offen offset:0 sc1
    buffer_load_dwordx4 v[60:63], v1, s[4:7], s44 offen offset:1024 sc1
    s_waitcnt vmcnt(0)
    v_mfma_f32_32x32x16_bf16 v[72:87], v[56:59], v[48:51], 0
    v_mfma_f32_32x32x16_bf16 v[72:87], v[60:63], v[52:55], v[72:87]
    s_nop 11
    v_max3_f32 v26, v26, v72, v73
    v_max3_f32 v26, v26, v74, v75
    v_max3_f32 v26, v26, v76, v77
    v_max3_f32 v26, v26, v78, v79
    v_max3_f32 v26, v26, v80, v81
    v_max3_f32 v26, v26, v82, v83
    v_max3_f32 v26, v26, v84, v85
    v_max3_f32 v26, v26, v86, v87
    s_add_u32 s61, s61, 2048
    s_cmp_lt_u32 s61, 131072
    s_cbranch_scc1 s_slow1
    v_mov_b32 v27, v26
    s_nop 1
    v_permlane32_swap_b32 v26, v27
    v_max_f32 v26, v26, v27
    v_mov_b32 v32, 0
    v_mov_b32 v33, 0
    v_mov_b32 v34, 0
    v_mov_b32 v35, 0
    v_mov_b32 v36, 0
    v_mov_b32 v37, 0
    v_mov_b32 v38, 0
    v_mov_b32 v39, 0
    v_mov_b32 v40, 0
    v_mov_b32 v41, 0
    v_mov_b32 v42, 0
    v_mov_b32 v43, 0
    v_mov_b32 v44, 0
    v_mov_b32 v45, 0
    v_mov_b32 v46, 0
    v_mov_b32 v47, 0
    v_mov_b32 v28, 0
    v_mov_b32 v29, 0xdddddddd
    s_mov_b32 s3, 0xffff0000
    s_mov_b32 s61, 0
s_slow2:
    s_add_u32 s44, s55, s61
    buffer_load_dwordx4 v[56:59], v1, s[4:7], s44 offen offset:0 sc1
    buffer_load_dwordx4 v[60:63], v1, s[4:7], s44 offen offset:1024 sc1
    s_add_u32 s44, s44, 4194304
    buffer_load_dwordx4 v[64:67], v1, s[4:7], s44 offen offset:0 sc1
    buffer_load_dwordx4 v[68:71], v1, s[4:7], s44 offen offset:1024 sc1
    s_waitcnt vmcnt(0)
    v_mfma_f32_32x32x16_bf16 v[72:87], v[56:59], v[48:51], 0
    v_mfma_f32_32x32x16_bf16 v[72:87], v[60:63], v[52:55], v[72:87]
    s_nop 11
    v_sub_f32 v72, v72, v26
    v_sub_f32 v73, v73, v26
    v_sub_f32 v74, v74, v26
    v_sub_f32 v75, v75, v26
    v_sub_f32 v76, v76, v26
    v_sub_f32 v77, v77, v26
    v_sub_f32 v78, v78, v26
    v_sub_f32 v79, v79, v26
    v_sub_f32 v80, v80, v26
    v_sub_f32 v81, v81, v26
    v_sub_f32 v82, v82, v26
    v_sub_f32 v83, v83, v26
    v_sub_f32 v84, v84, v26
    v_sub_f32 v85, v85, v26
    v_sub_f32 v86, v86, v26
    v_sub_f32 v87, v87, v26
    v_exp_f32 v72, v72
    v_exp_f32 v73, v73
    v_exp_f32 v74, v74
    v_exp_f32 v75, v75
    v_exp_f32 v76, v76
    v_exp_f32 v77, v77
    v_exp_f32 v78, v78
    v_exp_f32 v79, v79
    v_exp_f32 v80, v80
    v_exp_f32 v81, v81
    v_exp_f32 v82, v82
    v_exp_f32 v83, v83
    v_exp_f32 v84, v84
    v_exp_f32 v85, v85
    v_exp_f32 v86, v86
    v_exp_f32 v87, v87
    v_and_b32 v72, s3, v72
    v_and_b32 v73, s3, v73
    v_and_b32 v74, s3, v74
    v_and_b32 v75, s3, v75
    v_and_b32 v76, s3, v76
    v_and_b32 v77, s3, v77
    v_and_b32 v78, s3, v78
    v_and_b32 v79, s3, v79
    v_and_b32 v80, s3, v80
    v_and_b32 v81, s3, v81
    v_and_b32 v82, s3, v82
    v_and_b32 v83, s3, v83
    v_and_b32 v84, s3, v84
    v_and_b32 v85, s3, v85
    v_and_b32 v86, s3, v86
    v_and_b32 v87, s3, v87
    v_add_f32 v28, v28, v72
    v_add_f32 v28, v28, v73
    v_add_f32 v28, v28, v74
    v_add_f32 v28, v28, v75
    v_add_f32 v28, v28, v76
    v_add_f32 v28, v28, v77
    v_add_f32 v28, v28, v78
    v_add_f32 v28, v28, v79
    v_add_f32 v28, v28, v80
    v_add_f32 v28, v28, v81
    v_add_f32 v28, v28, v82
    v_add_f32 v28, v28, v83
    v_add_f32 v28, v28, v84
    v_add_f32 v28, v28, v85
    v_add_f32 v28, v28, v86
    v_add_f32 v28, v28, v87
    v_smfmac_f32_32x32x32_bf16 v[32:47], v[64:67], v[72:79], v29
    v_smfmac_f32_32x32x32_bf16 v[32:47], v[68:71], v[80:87], v29
    s_add_u32 s61, s61, 2048
    s_cmp_lt_u32 s61, 131072
    s_cbranch_scc1 s_slow2
    v_mov_b32 v29, v28
    s_nop 1
    v_permlane32_swap_b32 v28, v29
    v_add_f32 v28, v28, v29
    v_rcp_f32 v28, v28
    s_nop 7
    s_branch s_fin
k_exit:
    s_endpgm
.if k_exit - interleave_layers__sliding_local_dilated__softmax_full_mha__prompt_kernel < 49152
.error "code prefetch reads past the end of the code"
.endif
.section .rodata,"a"
.p2align 6
.amdhsa_kernel interleave_layers__sliding_local_dilated__softmax_full_mha__prompt_kernel
  .amdhsa_next_free_vgpr 256
  .amdhsa_next_free_sgpr 102
  .amdhsa_accum_offset 256
  .amdhsa_group_segment_fixed_size 0
  .amdhsa_kernarg_size 72
  .amdhsa_user_sgpr_count 2
  .amdhsa_user_sgpr_kernarg_segment_ptr 1
  .amdhsa_system_sgpr_workgroup_id_x 1
.end_amdhsa_kernel
```

```asm
; @launch grid=(256,1,1) block=(512,1,1) lds=156736
.amdgcn_target "amdgcn-amd-amdhsa--gfx950"
.text
.globl interleave_layers__sliding_local_dilated__softmax_full_mha__prompt_kernel
.type interleave_layers__sliding_local_dilated__softmax_full_mha__prompt_kernel,@function
.p2align 8
interleave_layers__sliding_local_dilated__softmax_full_mha__prompt_kernel:
    s_cmp_ge_u32 s2, 256
    s_cbranch_scc1 k_exit
    s_load_dwordx2 s[36:37], s[0:1], 0
    s_load_dwordx4 s[24:27], s[0:1], 8
    s_load_dwordx8 s[28:35], s[0:1], 32
    s_load_dwordx2 s[44:45], s[0:1], 64
    v_lshrrev_b32 v2, 6, v0
    v_and_b32 v0, 63, v0
    v_readfirstlane_b32 s16, v2
    v_lshlrev_b32 v1, 4, v0
    s_mov_b32 s21, 0
    s_mov_b32 s40, 1
    s_and_b32 s3, s2, 1
    s_lshl_b32 s3, s3, 3
    s_bfe_u32 s17, s2, 0x30003
    s_add_u32 s17, s17, s3
    s_bfe_u32 s3, s2, 0x20001
    s_lshl_b32 s3, s3, 2
    s_lshr_b32 s18, s2, 6
    s_add_u32 s18, s18, s3
    s_and_b32 s3, s2, 3
    s_lshl_b32 s3, s3, 2
    s_bfe_u32 s19, s2, 0x20003
    s_add_u32 s19, s19, s3
    s_bfe_u32 s3, s2, 0x10002
    s_lshl_b32 s3, s3, 3
    s_lshr_b32 s20, s2, 5
    s_add_u32 s20, s20, s3
    s_mov_b32 s19, s17
    s_mov_b32 s20, s18
    s_and_b32 s3, s16, 3
    s_lshl_b32 s38, s17, 2
    s_add_u32 s38, s38, s3
    s_lshl_b32 s39, s19, 2
    s_add_u32 s39, s39, s3
    v_mov_b32 v20, 0
    v_mov_b32 v21, 0
    v_mov_b32 v22, 0
    s_mov_b32 s41, 0
    s_mov_b32 s42, 0
    s_mov_b32 s43, 0
    s_mov_b32 s62, 0
    s_getpc_b64 s[76:77]
e_pc:
    s_sub_u32 s76, s76, e_pc - interleave_layers__sliding_local_dilated__softmax_full_mha__prompt_kernel
    s_subb_u32 s77, s77, 0
    s_and_b32 s3, s2, 0xf8
    s_add_u32 s3, s3, s16
    s_lshl_b32 s3, s3, 6
    s_add_u32 s78, s3, 49152
    s_min_u32 s78, s78, k_exit - interleave_layers__sliding_local_dilated__softmax_full_mha__prompt_kernel
    s_waitcnt lgkmcnt(0)
    s_load_dword s80, s[76:77], s3 offset:0
    s_load_dword s81, s[76:77], s3 offset:16384
    s_load_dword s82, s[76:77], s3 offset:32768
    s_load_dword s83, s[76:77], s78
    s_mov_b32 s4, s44
    s_mov_b32 s5, s45
    s_mov_b32 s6, 67108864
    s_mov_b32 s7, 0x00020000
    s_add_u32 s22, s44, 58720256
    s_addc_u32 s23, s45, 0
    s_load_dword s100, s[22:23], 217088
    s_cmp_eq_u32 s16, 4
    s_cbranch_scc1 h_start
    s_cmp_eq_u32 s16, 7
    s_cbranch_scc1 z_start
    s_cmp_gt_u32 s16, 4
    s_cbranch_scc1 l_start
    s_mov_b32 s8, s36
    s_mov_b32 s9, s37
    s_mov_b32 s10, 4194304
    s_mov_b32 s11, 0x00020000
    v_lshrrev_b32 v8, 4, v1
    v_lshrrev_b32 v32, 3, v8
    v_and_b32 v33, 7, v8
    v_lshlrev_b32 v34, 11, v32
    v_lshl_add_u32 v34, v33, 4, v34
    s_lshl_b32 s44, s39, 16
    s_lshl_b32 s45, s20, 7
    s_add_u32 s46, s44, s45
    buffer_load_dwordx4 v[40:43], v34, s[8:11], s46 offen
    s_add_u32 s46, s46, 16384
    buffer_load_dwordx4 v[44:47], v34, s[8:11], s46 offen
    s_add_u32 s46, s46, 16384
    buffer_load_dwordx4 v[48:51], v34, s[8:11], s46 offen
    s_add_u32 s46, s46, 16384
    buffer_load_dwordx4 v[52:55], v34, s[8:11], s46 offen
    v_xor_b32 v88, v33, v32
    v_lshlrev_b32 v88, 4, v88
    v_lshl_add_u32 v88, v32, 11, v88
    v_xor_b32 v89, 16, v88
    v_add_u32 v89, 15360, v89
    v_add_u32 v90, 30720, v88
    v_add_u32 v91, 30720, v89
    s_mul_i32 s76, s16, 16384
    s_add_u32 s76, s76, 65536
    s_lshl_b32 s77, s38, 16
    s_mul_i32 s84, s18, 4096
    s_cmp_eq_u32 s18, 1
    s_cselect_b32 s85, 0, 4096
    s_cmp_eq_u32 s18, 2
    s_cselect_b32 s86, 0, 8192
    s_cmp_eq_u32 s18, 3
    s_cselect_b32 s87, 0, 12288
    s_cmp_eq_u32 s18, 4
    s_cselect_b32 s88, 0, 16384
    s_cmp_eq_u32 s18, 5
    s_cselect_b32 s89, 0, 20480
    s_cmp_eq_u32 s18, 6
    s_cselect_b32 s90, 0, 24576
    s_cmp_eq_u32 s18, 7
    s_cselect_b32 s91, 0, 28672
    s_cmp_eq_u32 s18, 8
    s_cselect_b32 s92, 0, 32768
    s_cmp_eq_u32 s18, 9
    s_cselect_b32 s93, 0, 36864
    s_cmp_eq_u32 s18, 10
    s_cselect_b32 s94, 0, 40960
    s_cmp_eq_u32 s18, 11
    s_cselect_b32 s95, 0, 45056
    s_cmp_eq_u32 s18, 12
    s_cselect_b32 s96, 0, 49152
    s_cmp_eq_u32 s18, 13
    s_cselect_b32 s97, 0, 53248
    s_cmp_eq_u32 s18, 14
    s_cselect_b32 s98, 0, 57344
    s_cmp_eq_u32 s18, 15
    s_cselect_b32 s99, 0, 61440
    v_lshrrev_b32 v12, 4, v1
    v_and_b32 v13, 15, v12
    v_bfe_u32 v14, v12, 4, 1
    v_lshrrev_b32 v12, 5, v12
    v_lshl_add_u32 v2, v14, 5, v13
    v_lshlrev_b32 v2, 4, v2
    v_lshl_add_u32 v2, v12, 10, v2
    v_lshrrev_b32 v15, 2, v13
    v_lshl_add_u32 v15, v14, 2, v15
    v_lshlrev_b32 v3, 7, v15
    v_lshl_add_u32 v3, v12, 11, v3
    v_and_b32 v15, 3, v13
    v_lshl_add_u32 v3, v15, 3, v3
    v_lshrrev_b32 v15, 3, v13
    v_lshl_add_u32 v15, v15, 1, v14
    v_lshl_add_u32 v3, v15, 5, v3
    v_xor_b32 v4, 32, v3
    v_xor_b32 v5, 64, v3
    v_xor_b32 v6, 96, v3
    s_lshl_b32 s45, s16, 12
    s_add_u32 s45, s45, 131072
    v_lshrrev_b32 v35, 1, v33
    v_lshlrev_b32 v35, 10, v35
    v_lshl_add_u32 v35, v32, 4, v35
    v_and_b32 v36, 1, v33
    v_lshl_add_u32 v35, v36, 3, v35
    v_add_u32 v35, s45, v35
    v_add_u32 v36, s45, v1
    v_mov_b32 v37, 0x3f803f80
    v_and_b32 v38, 3, v8
    v_lshl_add_u32 v39, v38, 3, v32
    v_lshlrev_b32 v39, 3, v39
    v_mov_b32 v56, 0
    v_mov_b32 v57, 0
    v_mov_b32 v58, 0
    v_mov_b32 v59, 0
    v_mov_b32 v60, 0
    v_mov_b32 v61, 0
    v_mov_b32 v62, 0
    v_mov_b32 v63, 0
    s_waitcnt vmcnt(3)
    ds_write_b64 v35, v[40:41] offset:0
    ds_write_b64 v35, v[42:43] offset:512
    s_waitcnt vmcnt(2)
    ds_write_b64 v35, v[44:45] offset:128
    ds_write_b64 v35, v[46:47] offset:640
    s_waitcnt vmcnt(1)
    ds_write_b64 v35, v[48:49] offset:256
    ds_write_b64 v35, v[50:51] offset:768
    s_waitcnt vmcnt(0)
    ds_write_b64 v35, v[52:53] offset:384
    ds_write_b64 v35, v[54:55] offset:896
    ds_read_b128 v[64:67], v36 offset:0
    ds_read_b128 v[68:71], v36 offset:1024
    ds_read_b128 v[72:75], v36 offset:2048
    ds_read_b128 v[76:79], v36 offset:3072
    s_lshl_b32 s45, s20, 12
    s_add_u32 s46, s44, s45
    s_waitcnt lgkmcnt(3)
    buffer_store_dwordx4 v[64:67], v1, s[4:7], s46 offen offset:0 sc1
    s_waitcnt lgkmcnt(2)
    buffer_store_dwordx4 v[68:71], v1, s[4:7], s46 offen offset:1024 sc1
    s_waitcnt lgkmcnt(1)
    buffer_store_dwordx4 v[72:75], v1, s[4:7], s46 offen offset:2048 sc1
    s_waitcnt lgkmcnt(0)
    buffer_store_dwordx4 v[76:79], v1, s[4:7], s46 offen offset:3072 sc1
    s_add_u32 m0, s76, 4096
    s_lshr_b32 s78, s85, 5
    s_add_u32 s78, s78, s77
    buffer_load_dwordx4 v88, s[8:11], s78 offen offset:0 lds
    buffer_load_dwordx4 v89, s[8:11], s78 offen offset:1024 lds
    buffer_load_dwordx4 v90, s[8:11], s78 offen offset:2048 lds
    buffer_load_dwordx4 v91, s[8:11], s78 offen offset:3072 lds
    s_add_u32 m0, s76, 8192
    s_lshr_b32 s78, s86, 5
    s_add_u32 s78, s78, s77
    buffer_load_dwordx4 v88, s[8:11], s78 offen offset:0 lds
    buffer_load_dwordx4 v89, s[8:11], s78 offen offset:1024 lds
    buffer_load_dwordx4 v90, s[8:11], s78 offen offset:2048 lds
    buffer_load_dwordx4 v91, s[8:11], s78 offen offset:3072 lds
    s_add_u32 m0, s76, 12288
    s_lshr_b32 s78, s87, 5
    s_add_u32 s78, s78, s77
    buffer_load_dwordx4 v88, s[8:11], s78 offen offset:0 lds
    buffer_load_dwordx4 v89, s[8:11], s78 offen offset:1024 lds
    buffer_load_dwordx4 v90, s[8:11], s78 offen offset:2048 lds
    buffer_load_dwordx4 v91, s[8:11], s78 offen offset:3072 lds
    s_barrier
    v_dot2_f32_bf16 v56, v40, v37, v56
    v_dot2_f32_bf16 v57, v40, v40, v57
    v_dot2_f32_bf16 v58, v44, v37, v58
    v_dot2_f32_bf16 v59, v44, v44, v59
    v_dot2_f32_bf16 v60, v48, v37, v60
    v_dot2_f32_bf16 v61, v48, v48, v61
    v_dot2_f32_bf16 v62, v52, v37, v62
    v_dot2_f32_bf16 v63, v52, v52, v63
    v_dot2_f32_bf16 v56, v41, v37, v56
    v_dot2_f32_bf16 v57, v41, v41, v57
    v_dot2_f32_bf16 v58, v45, v37, v58
    v_dot2_f32_bf16 v59, v45, v45, v59
    v_dot2_f32_bf16 v60, v49, v37, v60
    v_dot2_f32_bf16 v61, v49, v49, v61
    v_dot2_f32_bf16 v62, v53, v37, v62
    v_dot2_f32_bf16 v63, v53, v53, v63
    v_dot2_f32_bf16 v56, v42, v37, v56
    v_dot2_f32_bf16 v57, v42, v42, v57
    v_dot2_f32_bf16 v58, v46, v37, v58
    v_dot2_f32_bf16 v59, v46, v46, v59
    v_dot2_f32_bf16 v60, v50, v37, v60
    v_dot2_f32_bf16 v61, v50, v50, v61
    v_dot2_f32_bf16 v62, v54, v37, v62
    v_dot2_f32_bf16 v63, v54, v54, v63
    v_dot2_f32_bf16 v56, v43, v37, v56
    v_dot2_f32_bf16 v57, v43, v43, v57
    v_dot2_f32_bf16 v58, v47, v37, v58
    v_dot2_f32_bf16 v59, v47, v47, v59
    v_dot2_f32_bf16 v60, v51, v37, v60
    v_dot2_f32_bf16 v61, v51, v51, v61
    v_dot2_f32_bf16 v62, v55, v37, v62
    v_dot2_f32_bf16 v63, v55, v55, v63
    s_nop 2
    v_add_f32_dpp v56, v56, v56 quad_perm:[1,0,3,2] row_mask:0xf bank_mask:0xf
    v_add_f32_dpp v57, v57, v57 quad_perm:[1,0,3,2] row_mask:0xf bank_mask:0xf
    v_add_f32_dpp v58, v58, v58 quad_perm:[1,0,3,2] row_mask:0xf bank_mask:0xf
    v_add_f32_dpp v59, v59, v59 quad_perm:[1,0,3,2] row_mask:0xf bank_mask:0xf
    v_add_f32_dpp v60, v60, v60 quad_perm:[1,0,3,2] row_mask:0xf bank_mask:0xf
    v_add_f32_dpp v61, v61, v61 quad_perm:[1,0,3,2] row_mask:0xf bank_mask:0xf
    v_add_f32_dpp v62, v62, v62 quad_perm:[1,0,3,2] row_mask:0xf bank_mask:0xf
    v_add_f32_dpp v63, v63, v63 quad_perm:[1,0,3,2] row_mask:0xf bank_mask:0xf
    v_add_f32_dpp v56, v56, v56 quad_perm:[2,3,0,1] row_mask:0xf bank_mask:0xf
    v_add_f32_dpp v57, v57, v57 quad_perm:[2,3,0,1] row_mask:0xf bank_mask:0xf
    v_add_f32_dpp v58, v58, v58 quad_perm:[2,3,0,1] row_mask:0xf bank_mask:0xf
    v_add_f32_dpp v59, v59, v59 quad_perm:[2,3,0,1] row_mask:0xf bank_mask:0xf
    v_add_f32_dpp v60, v60, v60 quad_perm:[2,3,0,1] row_mask:0xf bank_mask:0xf
    v_add_f32_dpp v61, v61, v61 quad_perm:[2,3,0,1] row_mask:0xf bank_mask:0xf
    v_add_f32_dpp v62, v62, v62 quad_perm:[2,3,0,1] row_mask:0xf bank_mask:0xf
    v_add_f32_dpp v63, v63, v63 quad_perm:[2,3,0,1] row_mask:0xf bank_mask:0xf
    v_add_f32_dpp v56, v56, v56 row_half_mirror row_mask:0xf bank_mask:0xf
    v_add_f32_dpp v57, v57, v57 row_half_mirror row_mask:0xf bank_mask:0xf
    v_add_f32_dpp v58, v58, v58 row_half_mirror row_mask:0xf bank_mask:0xf
    v_add_f32_dpp v59, v59, v59 row_half_mirror row_mask:0xf bank_mask:0xf
    v_add_f32_dpp v60, v60, v60 row_half_mirror row_mask:0xf bank_mask:0xf
    v_add_f32_dpp v61, v61, v61 row_half_mirror row_mask:0xf bank_mask:0xf
    v_add_f32_dpp v62, v62, v62 row_half_mirror row_mask:0xf bank_mask:0xf
    v_add_f32_dpp v63, v63, v63 row_half_mirror row_mask:0xf bank_mask:0xf
    v_cmp_eq_u32 vcc, 1, v38
    s_nop 1
    v_cndmask_b32 v56, v56, v58, vcc
    v_cndmask_b32 v57, v57, v59, vcc
    v_cmp_eq_u32 vcc, 2, v38
    s_nop 1
    v_cndmask_b32 v56, v56, v60, vcc
    v_cndmask_b32 v57, v57, v61, vcc
    v_cmp_eq_u32 vcc, 3, v38
    s_nop 1
    v_cndmask_b32 v56, v56, v62, vcc
    v_cndmask_b32 v57, v57, v63, vcc
    s_lshl_b32 s44, s21, 18
    s_lshl_b32 s45, s39, 12
    s_add_u32 s44, s44, s45
    s_lshl_b32 s45, s20, 8
    s_add_u32 s44, s44, s45
    s_add_u32 s44, s44, 50331648
    buffer_store_dwordx2 v[56:57], v39, s[4:7], s44 offen sc1
    s_lshl_b32 s46, s21, 14
    s_lshl_b32 s67, s39, 7
    s_add_u32 s46, s46, s67
    s_add_u32 s46, s46, 4096
    s_add_u32 s47, s46, 8192
    s_lshl_b32 s48, s21, 22
    s_lshl_b32 s49, s38, 16
    s_add_u32 s41, s48, s49
    s_lshl_b32 s48, s21, 14
    s_lshl_b32 s67, s38, 7
    s_add_u32 s48, s48, s67
    s_add_u32 s48, s48, 4096
    v_lshrrev_b32 v16, 4, v1
    v_and_b32 v17, 15, v16
    v_lshrrev_b32 v16, 4, v16
    s_lshl_b32 s49, s16, 7
    s_add_u32 s50, s49, 151552
    s_and_b32 s49, s21, 1
    s_lshl_b32 s49, s49, 10
    s_add_u32 s49, s49, 151552
    v_lshlrev_b32 v11, 4, v16
    v_add_u32 v13, s50, v11
    v_add_u32 v11, s49, v11
    v_lshlrev_b32 v15, 2, v17
    v_add_u32 v9, s50, v15
    v_add_u32 v15, s49, v15
    s_lshr_b32 s49, s21, 1
    s_lshl_b32 s53, s49, 23
    s_lshl_b32 s50, s18, 18
    s_add_u32 s53, s53, s50
    s_add_u32 s53, s53, 33554432
    s_lshl_b32 s54, s38, 11
    s_add_u32 s52, s53, s54
    s_lshl_b32 s59, s49, 13
    s_lshl_b32 s67, s18, 9
    s_add_u32 s59, s59, s67
    s_lshl_b32 s67, s16, 7
    s_add_u32 s59, s59, s67
    s_add_u32 s59, s59, 69632
    s_lshl_b32 s61, s49, 15
    s_lshl_b32 s67, s17, 11
    s_add_u32 s61, s61, s67
    s_lshl_b32 s67, s18, 7
    s_add_u32 s61, s61, s67
    s_add_u32 s61, s61, 151552
    s_sub_u32 s60, s61, 151552
    s_lshl_b32 s60, s60, 5
    s_add_u32 s60, s60, 54525952
    s_lshl_b32 s62, s16, 12
    s_add_u32 s62, s62, 131072
    v_bfe_u32 v80, v8, 3, 1
    v_and_b32 v81, 7, v8
    v_lshrrev_b32 v82, 5, v8
    v_lshlrev_b32 v82, 1, v82
    v_xor_b32 v82, v82, v81
    v_xor_b32 v82, v82, v80
    v_lshlrev_b32 v82, 4, v82
    v_lshl_add_u32 v82, v81, 7, v82
    v_lshl_add_u32 v82, v80, 10, v82
    v_bfe_u32 v80, v8, 4, 1
    v_lshl_add_u32 v82, v80, 3, v82
    v_add_u32 v84, s76, v82
    v_xor_b32 v85, 16, v84
    v_xor_b32 v86, 64, v84
    v_xor_b32 v87, 80, v84
    v_add_u32 v80, s62, v2
    ds_read_b128 v[160:163], v80 offset:0
    ds_read_b128 v[164:167], v80 offset:256
    ds_read_b128 v[168:171], v80 offset:2048
    ds_read_b128 v[172:175], v80 offset:2304
    s_waitcnt vmcnt(1)
    ds_read_b64 v[176:177], v84 offset:4096
    ds_read_b64 v[178:179], v85 offset:4096
    ds_read_b64 v[180:181], v84 offset:6144
    ds_read_b64 v[182:183], v85 offset:6144
    ds_read_b64 v[184:185], v86 offset:4096
    ds_read_b64 v[186:187], v87 offset:4096
    ds_read_b64 v[188:189], v86 offset:6144
    ds_read_b64 v[190:191], v87 offset:6144
    ds_read_b64 v[192:193], v84 offset:8192
    ds_read_b64 v[194:195], v85 offset:8192
    ds_read_b64 v[196:197], v84 offset:10240
    ds_read_b64 v[198:199], v85 offset:10240
    ds_read_b64 v[200:201], v86 offset:8192
    ds_read_b64 v[202:203], v87 offset:8192
    ds_read_b64 v[204:205], v86 offset:10240
    ds_read_b64 v[206:207], v87 offset:10240
    ds_read_b64 v[208:209], v84 offset:12288
    ds_read_b64 v[210:211], v85 offset:12288
    ds_read_b64 v[212:213], v84 offset:14336
    ds_read_b64 v[214:215], v85 offset:14336
    ds_read_b64 v[216:217], v86 offset:12288
    ds_read_b64 v[218:219], v87 offset:12288
    ds_read_b64 v[220:221], v86 offset:14336
    ds_read_b64 v[222:223], v87 offset:14336
    s_load_dword s68, s[34:35], 0
    s_mov_b32 s8, s34
    s_mov_b32 s9, s35
    s_mov_b32 s10, 256
    s_mov_b32 s11, 0x00020000
    s_mov_b32 s66, 0x10000
    v_mov_b32 v16, 0
    s_waitcnt lgkmcnt(0)
c_f0:
    s_cmp_eq_u32 s68, 10
    s_cbranch_scc1 c_f0_ok
    buffer_load_dword v17, v16, s[8:11], 0 offen offset:0 sc1
    s_waitcnt vmcnt(0)
    v_readfirstlane_b32 s68, v17
    s_sub_u32 s66, s66, 1
    s_cmp_lg_u32 s66, 0
    s_cbranch_scc1 c_f0
c_f0_ok:
    s_atomic_add s40, s[22:23], s46
    s_mov_b64 vcc, -1
    s_barrier
    ds_read_b64_tr_b16 v[32:33], v3 offset:0
    ds_read_b64_tr_b16 v[34:35], v3 offset:1024
    ds_read_b64_tr_b16 v[36:37], v4 offset:0
    ds_read_b64_tr_b16 v[38:39], v4 offset:1024
    ds_read_b64_tr_b16 v[40:41], v5 offset:0
    ds_read_b64_tr_b16 v[42:43], v5 offset:1024
    ds_read_b64_tr_b16 v[44:45], v6 offset:0
    ds_read_b64_tr_b16 v[46:47], v6 offset:1024
    ds_read_b64_tr_b16 v[48:49], v3 offset:4096
    ds_read_b64_tr_b16 v[50:51], v3 offset:5120
    ds_read_b64_tr_b16 v[52:53], v4 offset:4096
    ds_read_b64_tr_b16 v[54:55], v4 offset:5120
    ds_read_b64_tr_b16 v[56:57], v5 offset:4096
    ds_read_b64_tr_b16 v[58:59], v5 offset:5120
    s_branch c_g0
c_cs1:
    s_waitcnt vmcnt(0)
    s_atomic_add s40, s[22:23], s47
    s_branch c_cs2
c_layer:
    s_lshl_b32 s48, s21, 22
    s_lshl_b32 s49, s38, 16
    s_add_u32 s41, s48, s49
    s_lshl_b32 s48, s21, 14
    s_lshl_b32 s67, s38, 7
    s_add_u32 s48, s48, s67
    s_add_u32 s48, s48, 4096
    v_lshrrev_b32 v16, 4, v1
    v_and_b32 v17, 15, v16
    v_lshrrev_b32 v16, 4, v16
    s_lshl_b32 s49, s16, 7
    s_add_u32 s50, s49, 151552
    s_and_b32 s49, s21, 1
    s_lshl_b32 s49, s49, 10
    s_add_u32 s49, s49, 151552
    v_lshlrev_b32 v11, 4, v16
    v_add_u32 v13, s50, v11
    v_add_u32 v11, s49, v11
    v_lshlrev_b32 v15, 2, v17
    v_add_u32 v9, s50, v15
    v_add_u32 v15, s49, v15
    s_lshr_b32 s49, s21, 1
    s_lshl_b32 s53, s49, 23
    s_lshl_b32 s50, s18, 18
    s_add_u32 s53, s53, s50
    s_add_u32 s53, s53, 33554432
    s_lshl_b32 s54, s38, 11
    s_add_u32 s52, s53, s54
    s_lshl_b32 s59, s49, 13
    s_lshl_b32 s67, s18, 9
    s_add_u32 s59, s59, s67
    s_lshl_b32 s67, s16, 7
    s_add_u32 s59, s59, s67
    s_add_u32 s59, s59, 69632
    s_lshl_b32 s61, s49, 15
    s_lshl_b32 s67, s17, 11
    s_add_u32 s61, s61, s67
    s_lshl_b32 s67, s18, 7
    s_add_u32 s61, s61, s67
    s_add_u32 s61, s61, 151552
    s_sub_u32 s60, s61, 151552
    s_lshl_b32 s60, s60, 5
    s_add_u32 s60, s60, 54525952
    s_lshl_b32 s62, s16, 12
    s_add_u32 s62, s62, 131072
    s_mov_b32 s68, 0
    s_atomic_add s68, s[22:23], s48 glc
    s_mov_b64 vcc, 0
    s_barrier
    ds_read_b64_tr_b16 v[32:33], v3 offset:0
    ds_read_b64_tr_b16 v[34:35], v3 offset:1024
    ds_read_b64_tr_b16 v[36:37], v4 offset:0
    ds_read_b64_tr_b16 v[38:39], v4 offset:1024
    ds_read_b64_tr_b16 v[40:41], v5 offset:0
    ds_read_b64_tr_b16 v[42:43], v5 offset:1024
    ds_read_b64_tr_b16 v[44:45], v6 offset:0
    ds_read_b64_tr_b16 v[46:47], v6 offset:1024
    ds_read_b64_tr_b16 v[48:49], v3 offset:4096
    ds_read_b64_tr_b16 v[50:51], v3 offset:5120
    ds_read_b64_tr_b16 v[52:53], v4 offset:4096
    ds_read_b64_tr_b16 v[54:55], v4 offset:5120
    ds_read_b64_tr_b16 v[56:57], v5 offset:4096
    ds_read_b64_tr_b16 v[58:59], v5 offset:5120
c_g0:
    s_waitcnt lgkmcnt(10)
    v_mfma_f32_16x16x32_bf16 v[64:67], v[32:35], v[160:163], 0
    ds_read_b64_tr_b16 v[60:61], v6 offset:4096
    v_mfma_f32_16x16x32_bf16 v[68:71], v[32:35], v[164:167], 0
    ds_read_b64_tr_b16 v[62:63], v6 offset:5120
    v_mfma_f32_16x16x32_bf16 v[72:75], v[36:39], v[160:163], 0
    ds_read_b64_tr_b16 v[32:33], v3 offset:8192
    v_mfma_f32_16x16x32_bf16 v[76:79], v[36:39], v[164:167], 0
    ds_read_b64_tr_b16 v[34:35], v3 offset:9216
    s_waitcnt lgkmcnt(10)
    v_mfma_f32_16x16x32_bf16 v[80:83], v[40:43], v[160:163], 0
    ds_read_b64_tr_b16 v[36:37], v4 offset:8192
    v_mfma_f32_16x16x32_bf16 v[84:87], v[40:43], v[164:167], 0
    ds_read_b64_tr_b16 v[38:39], v4 offset:9216
    v_mfma_f32_16x16x32_bf16 v[88:91], v[44:47], v[160:163], 0
    ds_read_b64_tr_b16 v[40:41], v5 offset:8192
    v_mfma_f32_16x16x32_bf16 v[92:95], v[44:47], v[164:167], 0
    ds_read_b64_tr_b16 v[42:43], v5 offset:9216
    s_waitcnt lgkmcnt(10)
    v_mfma_f32_16x16x32_bf16 v[96:99], v[160:163], v[48:51], 0
    ds_read_b64_tr_b16 v[44:45], v6 offset:8192
    v_mfma_f32_16x16x32_bf16 v[100:103], v[164:167], v[48:51], 0
    ds_read_b64_tr_b16 v[46:47], v6 offset:9216
    v_mfma_f32_16x16x32_bf16 v[104:107], v[160:163], v[52:55], 0
    ds_read_b64_tr_b16 v[48:49], v3 offset:12288
    v_mfma_f32_16x16x32_bf16 v[108:111], v[164:167], v[52:55], 0
    ds_read_b64_tr_b16 v[50:51], v3 offset:13312
    s_waitcnt lgkmcnt(10)
    v_mfma_f32_16x16x32_bf16 v[112:115], v[160:163], v[56:59], 0
    ds_read_b64_tr_b16 v[52:53], v4 offset:12288
    v_mfma_f32_16x16x32_bf16 v[116:119], v[164:167], v[56:59], 0
    ds_read_b64_tr_b16 v[54:55], v4 offset:13312
    v_mfma_f32_16x16x32_bf16 v[120:123], v[160:163], v[60:63], 0
    ds_read_b64_tr_b16 v[56:57], v5 offset:12288
    v_mfma_f32_16x16x32_bf16 v[124:127], v[164:167], v[60:63], 0
    ds_read_b64_tr_b16 v[58:59], v5 offset:13312
    s_cbranch_vccnz c_gate
    s_mov_b32 s66, 0x10000
    s_waitcnt lgkmcnt(0)
    s_cmp_eq_u32 s68, 16
    s_cbranch_scc1 c_x_ok
c_x_poll:
    s_mov_b32 s68, 0
    s_atomic_add s68, s[22:23], s48 offset:0 glc
    s_sub_u32 s66, s66, 1
    s_cselect_b32 s67, 16, 0
    s_waitcnt lgkmcnt(0)
    s_max_u32 s68, s68, s67
    s_cmp_lt_u32 s68, 16
    s_cbranch_scc1 c_x_poll
c_x_ok:
    s_add_u32 s42, s41, s85
    buffer_load_dwordx4 v[176:179], v2, s[4:7], s42 offen offset:0 sc1
    buffer_load_dwordx4 v[180:183], v2, s[4:7], s42 offen offset:256 sc1
    buffer_load_dwordx4 v[184:187], v2, s[4:7], s42 offen offset:2048 sc1
    buffer_load_dwordx4 v[188:191], v2, s[4:7], s42 offen offset:2304 sc1
    s_add_u32 s42, s41, s86
    buffer_load_dwordx4 v[192:195], v2, s[4:7], s42 offen offset:0 sc1
    buffer_load_dwordx4 v[196:199], v2, s[4:7], s42 offen offset:256 sc1
    buffer_load_dwordx4 v[200:203], v2, s[4:7], s42 offen offset:2048 sc1
    buffer_load_dwordx4 v[204:207], v2, s[4:7], s42 offen offset:2304 sc1
    s_add_u32 s42, s41, s87
    buffer_load_dwordx4 v[208:211], v2, s[4:7], s42 offen offset:0 sc1
    buffer_load_dwordx4 v[212:215], v2, s[4:7], s42 offen offset:256 sc1
    s_waitcnt vmcnt(10)
    s_atomic_add s40, s[22:23], s47
c_gate:
    s_waitcnt lgkmcnt(10)
    v_mfma_f32_16x16x32_bf16 v[128:131], v[32:35], v[160:163], 0
    ds_read_b64_tr_b16 v[60:61], v6 offset:12288
    v_mfma_f32_16x16x32_bf16 v[132:135], v[32:35], v[164:167], 0
    ds_read_b64_tr_b16 v[62:63], v6 offset:13312
    v_mfma_f32_16x16x32_bf16 v[136:139], v[36:39], v[160:163], 0
    ds_read_b64_tr_b16 v[32:33], v3 offset:16384
    v_mfma_f32_16x16x32_bf16 v[140:143], v[36:39], v[164:167], 0
    ds_read_b64_tr_b16 v[34:35], v3 offset:17408
    s_waitcnt lgkmcnt(10)
    v_mfma_f32_16x16x32_bf16 v[144:147], v[40:43], v[160:163], 0
    ds_read_b64_tr_b16 v[36:37], v4 offset:16384
    v_mfma_f32_16x16x32_bf16 v[148:151], v[40:43], v[164:167], 0
    ds_read_b64_tr_b16 v[38:39], v4 offset:17408
    v_mfma_f32_16x16x32_bf16 v[152:155], v[44:47], v[160:163], 0
    ds_read_b64_tr_b16 v[40:41], v5 offset:16384
    v_mfma_f32_16x16x32_bf16 v[156:159], v[44:47], v[164:167], 0
    ds_read_b64_tr_b16 v[42:43], v5 offset:17408
    s_waitcnt lgkmcnt(10)
    v_mfma_f32_16x16x32_bf16 v[64:67], v[48:51], v[168:171], v[64:67]
    ds_read_b64_tr_b16 v[44:45], v6 offset:16384
    v_mfma_f32_16x16x32_bf16 v[68:71], v[48:51], v[172:175], v[68:71]
    ds_read_b64_tr_b16 v[46:47], v6 offset:17408
    v_mfma_f32_16x16x32_bf16 v[72:75], v[52:55], v[168:171], v[72:75]
    ds_read_b64_tr_b16 v[48:49], v3 offset:20480
    v_mfma_f32_16x16x32_bf16 v[76:79], v[52:55], v[172:175], v[76:79]
    ds_read_b64_tr_b16 v[50:51], v3 offset:21504
    s_waitcnt lgkmcnt(10)
    v_mfma_f32_16x16x32_bf16 v[80:83], v[56:59], v[168:171], v[80:83]
    ds_read_b64_tr_b16 v[52:53], v4 offset:20480
    v_mfma_f32_16x16x32_bf16 v[84:87], v[56:59], v[172:175], v[84:87]
    ds_read_b64_tr_b16 v[54:55], v4 offset:21504
    v_mfma_f32_16x16x32_bf16 v[88:91], v[60:63], v[168:171], v[88:91]
    ds_read_b64_tr_b16 v[56:57], v5 offset:20480
    v_mfma_f32_16x16x32_bf16 v[92:95], v[60:63], v[172:175], v[92:95]
    ds_read_b64_tr_b16 v[58:59], v5 offset:21504
    s_waitcnt lgkmcnt(10)
    v_mfma_f32_16x16x32_bf16 v[96:99], v[168:171], v[32:35], v[96:99]
    ds_read_b64_tr_b16 v[60:61], v6 offset:20480
    v_mfma_f32_16x16x32_bf16 v[100:103], v[172:175], v[32:35], v[100:103]
    ds_read_b64_tr_b16 v[62:63], v6 offset:21504
    v_mfma_f32_16x16x32_bf16 v[104:107], v[168:171], v[36:39], v[104:107]
    ds_read_b64_tr_b16 v[32:33], v3 offset:24576
    v_mfma_f32_16x16x32_bf16 v[108:111], v[172:175], v[36:39], v[108:111]
    ds_read_b64_tr_b16 v[34:35], v3 offset:25600
    s_waitcnt lgkmcnt(10)
    v_mfma_f32_16x16x32_bf16 v[112:115], v[168:171], v[40:43], v[112:115]
    ds_read_b64_tr_b16 v[36:37], v4 offset:24576
    v_mfma_f32_16x16x32_bf16 v[116:119], v[172:175], v[40:43], v[116:119]
    ds_read_b64_tr_b16 v[38:39], v4 offset:25600
    v_mfma_f32_16x16x32_bf16 v[120:123], v[168:171], v[44:47], v[120:123]
    ds_read_b64_tr_b16 v[40:41], v5 offset:24576
    v_mfma_f32_16x16x32_bf16 v[124:127], v[172:175], v[44:47], v[124:127]
    ds_read_b64_tr_b16 v[42:43], v5 offset:25600
    s_waitcnt lgkmcnt(10)
    v_mfma_f32_16x16x32_bf16 v[128:131], v[48:51], v[168:171], v[128:131]
    ds_read_b64_tr_b16 v[44:45], v6 offset:24576
    v_mfma_f32_16x16x32_bf16 v[132:135], v[48:51], v[172:175], v[132:135]
    ds_read_b64_tr_b16 v[46:47], v6 offset:25600
    v_mfma_f32_16x16x32_bf16 v[136:139], v[52:55], v[168:171], v[136:139]
    ds_read_b64_tr_b16 v[48:49], v3 offset:28672
    v_mfma_f32_16x16x32_bf16 v[140:143], v[52:55], v[172:175], v[140:143]
    ds_read_b64_tr_b16 v[50:51], v3 offset:29696
    s_waitcnt lgkmcnt(10)
    v_mfma_f32_16x16x32_bf16 v[144:147], v[56:59], v[168:171], v[144:147]
    ds_read_b64_tr_b16 v[52:53], v4 offset:28672
    v_mfma_f32_16x16x32_bf16 v[148:151], v[56:59], v[172:175], v[148:151]
    ds_read_b64_tr_b16 v[54:55], v4 offset:29696
    v_mfma_f32_16x16x32_bf16 v[152:155], v[60:63], v[168:171], v[152:155]
    ds_read_b64_tr_b16 v[56:57], v5 offset:28672
    v_mfma_f32_16x16x32_bf16 v[156:159], v[60:63], v[172:175], v[156:159]
    ds_read_b64_tr_b16 v[58:59], v5 offset:29696
    s_waitcnt vmcnt(8) lgkmcnt(10)
    v_mfma_f32_16x16x32_bf16 v[64:67], v[32:35], v[176:179], v[64:67]
    ds_read_b64_tr_b16 v[60:61], v6 offset:28672
    v_mfma_f32_16x16x32_bf16 v[68:71], v[32:35], v[180:183], v[68:71]
    ds_read_b64_tr_b16 v[62:63], v6 offset:29696
    s_barrier
    v_mfma_f32_16x16x32_bf16 v[72:75], v[36:39], v[176:179], v[72:75]
    ds_read_b64_tr_b16 v[32:33], v3 offset:32768
    v_mfma_f32_16x16x32_bf16 v[76:79], v[36:39], v[180:183], v[76:79]
    ds_read_b64_tr_b16 v[34:35], v3 offset:33792
    s_waitcnt lgkmcnt(10)
    v_mfma_f32_16x16x32_bf16 v[80:83], v[40:43], v[176:179], v[80:83]
    ds_read_b64_tr_b16 v[36:37], v4 offset:32768
    s_cbranch_vccnz c_cs1
c_cs2:
    v_mfma_f32_16x16x32_bf16 v[84:87], v[40:43], v[180:183], v[84:87]
    ds_read_b64_tr_b16 v[38:39], v4 offset:33792
    v_mfma_f32_16x16x32_bf16 v[88:91], v[44:47], v[176:179], v[88:91]
    ds_read_b64_tr_b16 v[40:41], v5 offset:32768
    v_mfma_f32_16x16x32_bf16 v[92:95], v[44:47], v[180:183], v[92:95]
    ds_read_b64_tr_b16 v[42:43], v5 offset:33792
    s_waitcnt lgkmcnt(10)
    v_mfma_f32_16x16x32_bf16 v[96:99], v[176:179], v[48:51], v[96:99]
    ds_read_b64_tr_b16 v[44:45], v6 offset:32768
    v_mfma_f32_16x16x32_bf16 v[100:103], v[180:183], v[48:51], v[100:103]
    ds_read_b64_tr_b16 v[46:47], v6 offset:33792
    v_mfma_f32_16x16x32_bf16 v[104:107], v[176:179], v[52:55], v[104:107]
    ds_read_b64_tr_b16 v[48:49], v3 offset:36864
    v_mfma_f32_16x16x32_bf16 v[108:111], v[180:183], v[52:55], v[108:111]
    ds_read_b64_tr_b16 v[50:51], v3 offset:37888
    s_waitcnt lgkmcnt(10)
    v_mfma_f32_16x16x32_bf16 v[112:115], v[176:179], v[56:59], v[112:115]
    ds_read_b64_tr_b16 v[52:53], v4 offset:36864
    v_mfma_f32_16x16x32_bf16 v[116:119], v[180:183], v[56:59], v[116:119]
    ds_read_b64_tr_b16 v[54:55], v4 offset:37888
    v_mfma_f32_16x16x32_bf16 v[120:123], v[176:179], v[60:63], v[120:123]
    ds_read_b64_tr_b16 v[56:57], v5 offset:36864
    v_mfma_f32_16x16x32_bf16 v[124:127], v[180:183], v[60:63], v[124:127]
    ds_read_b64_tr_b16 v[58:59], v5 offset:37888
    s_waitcnt lgkmcnt(10)
    v_mfma_f32_16x16x32_bf16 v[128:131], v[32:35], v[176:179], v[128:131]
    ds_read_b64_tr_b16 v[60:61], v6 offset:36864
    v_mfma_f32_16x16x32_bf16 v[132:135], v[32:35], v[180:183], v[132:135]
    ds_read_b64_tr_b16 v[62:63], v6 offset:37888
    v_mfma_f32_16x16x32_bf16 v[136:139], v[36:39], v[176:179], v[136:139]
    ds_read_b64_tr_b16 v[32:33], v3 offset:40960
    v_mfma_f32_16x16x32_bf16 v[140:143], v[36:39], v[180:183], v[140:143]
    ds_read_b64_tr_b16 v[34:35], v3 offset:41984
    s_waitcnt lgkmcnt(10)
    v_mfma_f32_16x16x32_bf16 v[144:147], v[40:43], v[176:179], v[144:147]
    ds_read_b64_tr_b16 v[36:37], v4 offset:40960
    v_mfma_f32_16x16x32_bf16 v[148:151], v[40:43], v[180:183], v[148:151]
    ds_read_b64_tr_b16 v[38:39], v4 offset:41984
    v_mfma_f32_16x16x32_bf16 v[152:155], v[44:47], v[176:179], v[152:155]
    ds_read_b64_tr_b16 v[40:41], v5 offset:40960
    v_mfma_f32_16x16x32_bf16 v[156:159], v[44:47], v[180:183], v[156:159]
    ds_read_b64_tr_b16 v[42:43], v5 offset:41984
    s_waitcnt vmcnt(6) lgkmcnt(10)
    v_mfma_f32_16x16x32_bf16 v[64:67], v[48:51], v[184:187], v[64:67]
    s_add_u32 s42, s41, s87
    s_cbranch_vccnz xs1
    buffer_load_dwordx4 v[216:219], v2, s[4:7], s42 offen offset:2048 sc1
xs1:
    ds_read_b64_tr_b16 v[44:45], v6 offset:40960
    v_mfma_f32_16x16x32_bf16 v[68:71], v[48:51], v[188:191], v[68:71]
    ds_read_b64_tr_b16 v[46:47], v6 offset:41984
    v_mfma_f32_16x16x32_bf16 v[72:75], v[52:55], v[184:187], v[72:75]
    s_cbranch_vccnz xs2
    buffer_load_dwordx4 v[220:223], v2, s[4:7], s42 offen offset:2304 sc1
xs2:
    ds_read_b64_tr_b16 v[48:49], v3 offset:45056
    s_add_u32 s42, s41, s88
    v_mfma_f32_16x16x32_bf16 v[76:79], v[52:55], v[188:191], v[76:79]
    ds_read_b64_tr_b16 v[50:51], v3 offset:46080
    s_waitcnt lgkmcnt(10)
    v_mfma_f32_16x16x32_bf16 v[80:83], v[56:59], v[184:187], v[80:83]
    buffer_load_dwordx4 v[224:227], v2, s[4:7], s42 offen offset:0 sc1
    ds_read_b64_tr_b16 v[52:53], v4 offset:45056
    v_mfma_f32_16x16x32_bf16 v[84:87], v[56:59], v[188:191], v[84:87]
    ds_read_b64_tr_b16 v[54:55], v4 offset:46080
    v_mfma_f32_16x16x32_bf16 v[88:91], v[60:63], v[184:187], v[88:91]
    buffer_load_dwordx4 v[228:231], v2, s[4:7], s42 offen offset:256 sc1
    ds_read_b64_tr_b16 v[56:57], v5 offset:45056
    v_mfma_f32_16x16x32_bf16 v[92:95], v[60:63], v[188:191], v[92:95]
    ds_read_b64_tr_b16 v[58:59], v5 offset:46080
    s_waitcnt lgkmcnt(10)
    v_mfma_f32_16x16x32_bf16 v[96:99], v[184:187], v[32:35], v[96:99]
    ds_read_b64_tr_b16 v[60:61], v6 offset:45056
    buffer_load_dwordx4 v[232:235], v2, s[4:7], s42 offen offset:2048 sc1
    v_mfma_f32_16x16x32_bf16 v[100:103], v[188:191], v[32:35], v[100:103]
    ds_read_b64_tr_b16 v[62:63], v6 offset:46080
    v_mfma_f32_16x16x32_bf16 v[104:107], v[184:187], v[36:39], v[104:107]
    buffer_load_dwordx4 v[236:239], v2, s[4:7], s42 offen offset:2304 sc1
    ds_read_b64_tr_b16 v[32:33], v3 offset:49152
    s_add_u32 s42, s41, s89
    v_mfma_f32_16x16x32_bf16 v[108:111], v[188:191], v[36:39], v[108:111]
    ds_read_b64_tr_b16 v[34:35], v3 offset:50176
    s_waitcnt lgkmcnt(10)
    v_mfma_f32_16x16x32_bf16 v[112:115], v[184:187], v[40:43], v[112:115]
    buffer_load_dwordx4 v[240:243], v2, s[4:7], s42 offen offset:0 sc1
    ds_read_b64_tr_b16 v[36:37], v4 offset:49152
    v_mfma_f32_16x16x32_bf16 v[116:119], v[188:191], v[40:43], v[116:119]
    ds_read_b64_tr_b16 v[38:39], v4 offset:50176
    v_mfma_f32_16x16x32_bf16 v[120:123], v[184:187], v[44:47], v[120:123]
    buffer_load_dwordx4 v[244:247], v2, s[4:7], s42 offen offset:256 sc1
    ds_read_b64_tr_b16 v[40:41], v5 offset:49152
    v_mfma_f32_16x16x32_bf16 v[124:127], v[188:191], v[44:47], v[124:127]
    ds_read_b64_tr_b16 v[42:43], v5 offset:50176
    s_waitcnt lgkmcnt(10)
    v_mfma_f32_16x16x32_bf16 v[128:131], v[48:51], v[184:187], v[128:131]
    buffer_load_dwordx4 v[248:251], v2, s[4:7], s42 offen offset:2048 sc1
    ds_read_b64_tr_b16 v[44:45], v6 offset:49152
    v_mfma_f32_16x16x32_bf16 v[132:135], v[48:51], v[188:191], v[132:135]
    ds_read_b64_tr_b16 v[46:47], v6 offset:50176
    v_mfma_f32_16x16x32_bf16 v[136:139], v[52:55], v[184:187], v[136:139]
    ds_read_b64_tr_b16 v[48:49], v3 offset:53248
    v_mfma_f32_16x16x32_bf16 v[140:143], v[52:55], v[188:191], v[140:143]
    ds_read_b64_tr_b16 v[50:51], v3 offset:54272
    s_waitcnt lgkmcnt(10)
    v_mfma_f32_16x16x32_bf16 v[144:147], v[56:59], v[184:187], v[144:147]
    ds_read_b64_tr_b16 v[52:53], v4 offset:53248
    v_mfma_f32_16x16x32_bf16 v[148:151], v[56:59], v[188:191], v[148:151]
    ds_read_b64_tr_b16 v[54:55], v4 offset:54272
    v_mfma_f32_16x16x32_bf16 v[152:155], v[60:63], v[184:187], v[152:155]
    ds_read_b64_tr_b16 v[56:57], v5 offset:53248
    v_mfma_f32_16x16x32_bf16 v[156:159], v[60:63], v[188:191], v[156:159]
    ds_read_b64_tr_b16 v[58:59], v5 offset:54272
    s_waitcnt vmcnt(13) lgkmcnt(10)
    v_mfma_f32_16x16x32_bf16 v[64:67], v[32:35], v[192:195], v[64:67]
    ds_read_b64_tr_b16 v[60:61], v6 offset:53248
    buffer_load_dwordx4 v[252:255], v2, s[4:7], s42 offen offset:2304 sc1
    s_add_u32 s42, s41, s90
    v_mfma_f32_16x16x32_bf16 v[68:71], v[32:35], v[196:199], v[68:71]
    ds_read_b64_tr_b16 v[62:63], v6 offset:54272
    v_mfma_f32_16x16x32_bf16 v[72:75], v[36:39], v[192:195], v[72:75]
    ds_read_b64_tr_b16 v[32:33], v3 offset:57344
    v_mfma_f32_16x16x32_bf16 v[76:79], v[36:39], v[196:199], v[76:79]
    ds_read_b64_tr_b16 v[34:35], v3 offset:58368
    s_waitcnt lgkmcnt(10)
    v_mfma_f32_16x16x32_bf16 v[80:83], v[40:43], v[192:195], v[80:83]
    ds_read_b64_tr_b16 v[36:37], v4 offset:57344
    v_mfma_f32_16x16x32_bf16 v[84:87], v[40:43], v[196:199], v[84:87]
    ds_read_b64_tr_b16 v[38:39], v4 offset:58368
    v_mfma_f32_16x16x32_bf16 v[88:91], v[44:47], v[192:195], v[88:91]
    ds_read_b64_tr_b16 v[40:41], v5 offset:57344
    v_mfma_f32_16x16x32_bf16 v[92:95], v[44:47], v[196:199], v[92:95]
    ds_read_b64_tr_b16 v[42:43], v5 offset:58368
    s_waitcnt lgkmcnt(10)
    v_mfma_f32_16x16x32_bf16 v[96:99], v[192:195], v[48:51], v[96:99]
    buffer_load_dwordx4 v[160:163], v2, s[4:7], s42 offen offset:0 sc1
    ds_read_b64_tr_b16 v[44:45], v6 offset:57344
    v_mfma_f32_16x16x32_bf16 v[100:103], v[196:199], v[48:51], v[100:103]
    ds_read_b64_tr_b16 v[46:47], v6 offset:58368
    v_mfma_f32_16x16x32_bf16 v[104:107], v[192:195], v[52:55], v[104:107]
    ds_read_b64_tr_b16 v[48:49], v3 offset:61440
    v_mfma_f32_16x16x32_bf16 v[108:111], v[196:199], v[52:55], v[108:111]
    ds_read_b64_tr_b16 v[50:51], v3 offset:62464
    s_waitcnt lgkmcnt(10)
    v_mfma_f32_16x16x32_bf16 v[112:115], v[192:195], v[56:59], v[112:115]
    ds_read_b64_tr_b16 v[52:53], v4 offset:61440
    v_mfma_f32_16x16x32_bf16 v[116:119], v[196:199], v[56:59], v[116:119]
    ds_read_b64_tr_b16 v[54:55], v4 offset:62464
    v_mfma_f32_16x16x32_bf16 v[120:123], v[192:195], v[60:63], v[120:123]
    ds_read_b64_tr_b16 v[56:57], v5 offset:61440
    v_mfma_f32_16x16x32_bf16 v[124:127], v[196:199], v[60:63], v[124:127]
    ds_read_b64_tr_b16 v[58:59], v5 offset:62464
    s_waitcnt lgkmcnt(10)
    v_mfma_f32_16x16x32_bf16 v[128:131], v[32:35], v[192:195], v[128:131]
    ds_read_b64_tr_b16 v[60:61], v6 offset:61440
    v_mfma_f32_16x16x32_bf16 v[132:135], v[32:35], v[196:199], v[132:135]
    ds_read_b64_tr_b16 v[62:63], v6 offset:62464
    s_barrier
    v_xor_b32 v3, 0x10000, v3
    v_xor_b32 v4, 0x10000, v4
    v_xor_b32 v5, 0x10000, v5
    v_xor_b32 v6, 0x10000, v6
    v_mfma_f32_16x16x32_bf16 v[136:139], v[36:39], v[192:195], v[136:139]
    ds_read_b64_tr_b16 v[32:33], v3 offset:0
    v_mfma_f32_16x16x32_bf16 v[140:143], v[36:39], v[196:199], v[140:143]
    ds_read_b64_tr_b16 v[34:35], v3 offset:1024
    s_waitcnt lgkmcnt(10)
    v_mfma_f32_16x16x32_bf16 v[144:147], v[40:43], v[192:195], v[144:147]
    ds_read_b64_tr_b16 v[36:37], v4 offset:0
    v_mfma_f32_16x16x32_bf16 v[148:151], v[40:43], v[196:199], v[148:151]
    ds_read_b64_tr_b16 v[38:39], v4 offset:1024
    v_mfma_f32_16x16x32_bf16 v[152:155], v[44:47], v[192:195], v[152:155]
    ds_read_b64_tr_b16 v[40:41], v5 offset:0
    v_mfma_f32_16x16x32_bf16 v[156:159], v[44:47], v[196:199], v[156:159]
    ds_read_b64_tr_b16 v[42:43], v5 offset:1024
    s_waitcnt vmcnt(13) lgkmcnt(10)
    v_mfma_f32_16x16x32_bf16 v[64:67], v[48:51], v[200:203], v[64:67]
    ds_read_b64_tr_b16 v[44:45], v6 offset:0
    v_mfma_f32_16x16x32_bf16 v[68:71], v[48:51], v[204:207], v[68:71]
    ds_read_b64_tr_b16 v[46:47], v6 offset:1024
    v_mfma_f32_16x16x32_bf16 v[72:75], v[52:55], v[200:203], v[72:75]
    ds_read_b64_tr_b16 v[48:49], v3 offset:4096
    v_mfma_f32_16x16x32_bf16 v[76:79], v[52:55], v[204:207], v[76:79]
    ds_read_b64_tr_b16 v[50:51], v3 offset:5120
    s_waitcnt lgkmcnt(10)
    v_mfma_f32_16x16x32_bf16 v[80:83], v[56:59], v[200:203], v[80:83]
    ds_read_b64_tr_b16 v[52:53], v4 offset:4096
    v_mfma_f32_16x16x32_bf16 v[84:87], v[56:59], v[204:207], v[84:87]
    ds_read_b64_tr_b16 v[54:55], v4 offset:5120
    v_mfma_f32_16x16x32_bf16 v[88:91], v[60:63], v[200:203], v[88:91]
    ds_read_b64_tr_b16 v[56:57], v5 offset:4096
    v_mfma_f32_16x16x32_bf16 v[92:95], v[60:63], v[204:207], v[92:95]
    ds_read_b64_tr_b16 v[58:59], v5 offset:5120
    s_waitcnt lgkmcnt(10)
    v_mfma_f32_16x16x32_bf16 v[96:99], v[200:203], v[32:35], v[96:99]
    ds_read_b64_tr_b16 v[60:61], v6 offset:4096
    v_mfma_f32_16x16x32_bf16 v[100:103], v[204:207], v[32:35], v[100:103]
    ds_read_b64_tr_b16 v[62:63], v6 offset:5120
    v_mfma_f32_16x16x32_bf16 v[104:107], v[200:203], v[36:39], v[104:107]
    ds_read_b64_tr_b16 v[32:33], v3 offset:8192
    v_mfma_f32_16x16x32_bf16 v[108:111], v[204:207], v[36:39], v[108:111]
    ds_read_b64_tr_b16 v[34:35], v3 offset:9216
    s_waitcnt lgkmcnt(10)
    v_mfma_f32_16x16x32_bf16 v[112:115], v[200:203], v[40:43], v[112:115]
    ds_read_b64_tr_b16 v[36:37], v4 offset:8192
    v_mfma_f32_16x16x32_bf16 v[116:119], v[204:207], v[40:43], v[116:119]
    ds_read_b64_tr_b16 v[38:39], v4 offset:9216
    v_mfma_f32_16x16x32_bf16 v[120:123], v[200:203], v[44:47], v[120:123]
    ds_read_b64_tr_b16 v[40:41], v5 offset:8192
    v_mfma_f32_16x16x32_bf16 v[124:127], v[204:207], v[44:47], v[124:127]
    ds_read_b64_tr_b16 v[42:43], v5 offset:9216
    s_waitcnt lgkmcnt(10)
    v_mfma_f32_16x16x32_bf16 v[128:131], v[48:51], v[200:203], v[128:131]
    ds_read_b64_tr_b16 v[44:45], v6 offset:8192
    v_mfma_f32_16x16x32_bf16 v[132:135], v[48:51], v[204:207], v[132:135]
    ds_read_b64_tr_b16 v[46:47], v6 offset:9216
    v_mfma_f32_16x16x32_bf16 v[136:139], v[52:55], v[200:203], v[136:139]
    ds_read_b64_tr_b16 v[48:49], v3 offset:12288
    v_mfma_f32_16x16x32_bf16 v[140:143], v[52:55], v[204:207], v[140:143]
    ds_read_b64_tr_b16 v[50:51], v3 offset:13312
    s_waitcnt lgkmcnt(10)
    v_mfma_f32_16x16x32_bf16 v[144:147], v[56:59], v[200:203], v[144:147]
    ds_read_b64_tr_b16 v[52:53], v4 offset:12288
    v_mfma_f32_16x16x32_bf16 v[148:151], v[56:59], v[204:207], v[148:151]
    ds_read_b64_tr_b16 v[54:55], v4 offset:13312
    v_mfma_f32_16x16x32_bf16 v[152:155], v[60:63], v[200:203], v[152:155]
    ds_read_b64_tr_b16 v[56:57], v5 offset:12288
    v_mfma_f32_16x16x32_bf16 v[156:159], v[60:63], v[204:207], v[156:159]
    ds_read_b64_tr_b16 v[58:59], v5 offset:13312
    s_waitcnt vmcnt(11) lgkmcnt(10)
    v_mfma_f32_16x16x32_bf16 v[64:67], v[32:35], v[208:211], v[64:67]
    ds_read_b64_tr_b16 v[60:61], v6 offset:12288
    v_mfma_f32_16x16x32_bf16 v[68:71], v[32:35], v[212:215], v[68:71]
    ds_read_b64_tr_b16 v[62:63], v6 offset:13312
    v_mfma_f32_16x16x32_bf16 v[72:75], v[36:39], v[208:211], v[72:75]
    ds_read_b64_tr_b16 v[32:33], v3 offset:16384
    v_mfma_f32_16x16x32_bf16 v[76:79], v[36:39], v[212:215], v[76:79]
    ds_read_b64_tr_b16 v[34:35], v3 offset:17408
    s_waitcnt lgkmcnt(10)
    v_mfma_f32_16x16x32_bf16 v[80:83], v[40:43], v[208:211], v[80:83]
    ds_read_b64_tr_b16 v[36:37], v4 offset:16384
    v_mfma_f32_16x16x32_bf16 v[84:87], v[40:43], v[212:215], v[84:87]
    ds_read_b64_tr_b16 v[38:39], v4 offset:17408
    v_mfma_f32_16x16x32_bf16 v[88:91], v[44:47], v[208:211], v[88:91]
    ds_read_b64_tr_b16 v[40:41], v5 offset:16384
    v_mfma_f32_16x16x32_bf16 v[92:95], v[44:47], v[212:215], v[92:95]
    ds_read_b64_tr_b16 v[42:43], v5 offset:17408
    s_waitcnt lgkmcnt(10)
    v_mfma_f32_16x16x32_bf16 v[96:99], v[208:211], v[48:51], v[96:99]
    buffer_load_dwordx4 v[164:167], v2, s[4:7], s42 offen offset:256 sc1
    ds_read_b64_tr_b16 v[44:45], v6 offset:16384
    v_mfma_f32_16x16x32_bf16 v[100:103], v[212:215], v[48:51], v[100:103]
    ds_read_b64_tr_b16 v[46:47], v6 offset:17408
    v_mfma_f32_16x16x32_bf16 v[104:107], v[208:211], v[52:55], v[104:107]
    buffer_load_dwordx4 v[168:171], v2, s[4:7], s42 offen offset:2048 sc1
    ds_read_b64_tr_b16 v[48:49], v3 offset:20480
    v_mfma_f32_16x16x32_bf16 v[108:111], v[212:215], v[52:55], v[108:111]
    ds_read_b64_tr_b16 v[50:51], v3 offset:21504
    s_waitcnt lgkmcnt(10)
    v_mfma_f32_16x16x32_bf16 v[112:115], v[208:211], v[56:59], v[112:115]
    buffer_load_dwordx4 v[172:175], v2, s[4:7], s42 offen offset:2304 sc1
    ds_read_b64_tr_b16 v[52:53], v4 offset:20480
    s_add_u32 s42, s41, s91
    v_mfma_f32_16x16x32_bf16 v[116:119], v[212:215], v[56:59], v[116:119]
    ds_read_b64_tr_b16 v[54:55], v4 offset:21504
    v_mfma_f32_16x16x32_bf16 v[120:123], v[208:211], v[60:63], v[120:123]
    buffer_load_dwordx4 v[176:179], v2, s[4:7], s42 offen offset:0 sc1
    ds_read_b64_tr_b16 v[56:57], v5 offset:20480
    v_mfma_f32_16x16x32_bf16 v[124:127], v[212:215], v[60:63], v[124:127]
    ds_read_b64_tr_b16 v[58:59], v5 offset:21504
    s_waitcnt lgkmcnt(10)
    v_mfma_f32_16x16x32_bf16 v[128:131], v[32:35], v[208:211], v[128:131]
    ds_read_b64_tr_b16 v[60:61], v6 offset:20480
    buffer_load_dwordx4 v[180:183], v2, s[4:7], s42 offen offset:256 sc1
    v_mfma_f32_16x16x32_bf16 v[132:135], v[32:35], v[212:215], v[132:135]
    ds_read_b64_tr_b16 v[62:63], v6 offset:21504
    v_mfma_f32_16x16x32_bf16 v[136:139], v[36:39], v[208:211], v[136:139]
    buffer_load_dwordx4 v[184:187], v2, s[4:7], s42 offen offset:2048 sc1
    ds_read_b64_tr_b16 v[32:33], v3 offset:24576
    v_mfma_f32_16x16x32_bf16 v[140:143], v[36:39], v[212:215], v[140:143]
    ds_read_b64_tr_b16 v[34:35], v3 offset:25600
    s_waitcnt lgkmcnt(10)
    v_mfma_f32_16x16x32_bf16 v[144:147], v[40:43], v[208:211], v[144:147]
    ds_read_b64_tr_b16 v[36:37], v4 offset:24576
    v_mfma_f32_16x16x32_bf16 v[148:151], v[40:43], v[212:215], v[148:151]
    ds_read_b64_tr_b16 v[38:39], v4 offset:25600
    v_mfma_f32_16x16x32_bf16 v[152:155], v[44:47], v[208:211], v[152:155]
    ds_read_b64_tr_b16 v[40:41], v5 offset:24576
    v_mfma_f32_16x16x32_bf16 v[156:159], v[44:47], v[212:215], v[156:159]
    ds_read_b64_tr_b16 v[42:43], v5 offset:25600
    s_waitcnt vmcnt(15) lgkmcnt(10)
    v_mfma_f32_16x16x32_bf16 v[64:67], v[48:51], v[216:219], v[64:67]
    ds_read_b64_tr_b16 v[44:45], v6 offset:24576
    v_mfma_f32_16x16x32_bf16 v[68:71], v[48:51], v[220:223], v[68:71]
    ds_read_b64_tr_b16 v[46:47], v6 offset:25600
    v_mfma_f32_16x16x32_bf16 v[72:75], v[52:55], v[216:219], v[72:75]
    ds_read_b64_tr_b16 v[48:49], v3 offset:28672
    v_mfma_f32_16x16x32_bf16 v[76:79], v[52:55], v[220:223], v[76:79]
    ds_read_b64_tr_b16 v[50:51], v3 offset:29696
    s_waitcnt lgkmcnt(10)
    v_mfma_f32_16x16x32_bf16 v[80:83], v[56:59], v[216:219], v[80:83]
    buffer_load_dwordx4 v[188:191], v2, s[4:7], s42 offen offset:2304 sc1
    ds_read_b64_tr_b16 v[52:53], v4 offset:28672
    s_add_u32 s42, s41, s92
    v_mfma_f32_16x16x32_bf16 v[84:87], v[56:59], v[220:223], v[84:87]
    ds_read_b64_tr_b16 v[54:55], v4 offset:29696
    v_mfma_f32_16x16x32_bf16 v[88:91], v[60:63], v[216:219], v[88:91]
    ds_read_b64_tr_b16 v[56:57], v5 offset:28672
    v_mfma_f32_16x16x32_bf16 v[92:95], v[60:63], v[220:223], v[92:95]
    ds_read_b64_tr_b16 v[58:59], v5 offset:29696
    s_waitcnt lgkmcnt(10)
    v_mfma_f32_16x16x32_bf16 v[96:99], v[216:219], v[32:35], v[96:99]
    ds_read_b64_tr_b16 v[60:61], v6 offset:28672
    v_mfma_f32_16x16x32_bf16 v[100:103], v[220:223], v[32:35], v[100:103]
    ds_read_b64_tr_b16 v[62:63], v6 offset:29696
    s_barrier
    v_mfma_f32_16x16x32_bf16 v[104:107], v[216:219], v[36:39], v[104:107]
    ds_read_b64_tr_b16 v[32:33], v3 offset:32768
    v_mfma_f32_16x16x32_bf16 v[108:111], v[220:223], v[36:39], v[108:111]
    ds_read_b64_tr_b16 v[34:35], v3 offset:33792
    s_waitcnt lgkmcnt(10)
    v_mfma_f32_16x16x32_bf16 v[112:115], v[216:219], v[40:43], v[112:115]
    ds_read_b64_tr_b16 v[36:37], v4 offset:32768
    v_mfma_f32_16x16x32_bf16 v[116:119], v[220:223], v[40:43], v[116:119]
    ds_read_b64_tr_b16 v[38:39], v4 offset:33792
    v_mfma_f32_16x16x32_bf16 v[120:123], v[216:219], v[44:47], v[120:123]
    ds_read_b64_tr_b16 v[40:41], v5 offset:32768
    v_mfma_f32_16x16x32_bf16 v[124:127], v[220:223], v[44:47], v[124:127]
    ds_read_b64_tr_b16 v[42:43], v5 offset:33792
    s_waitcnt lgkmcnt(10)
    v_mfma_f32_16x16x32_bf16 v[128:131], v[48:51], v[216:219], v[128:131]
    ds_read_b64_tr_b16 v[44:45], v6 offset:32768
    v_mfma_f32_16x16x32_bf16 v[132:135], v[48:51], v[220:223], v[132:135]
    ds_read_b64_tr_b16 v[46:47], v6 offset:33792
    v_mfma_f32_16x16x32_bf16 v[136:139], v[52:55], v[216:219], v[136:139]
    ds_read_b64_tr_b16 v[48:49], v3 offset:36864
    v_mfma_f32_16x16x32_bf16 v[140:143], v[52:55], v[220:223], v[140:143]
    ds_read_b64_tr_b16 v[50:51], v3 offset:37888
    s_waitcnt lgkmcnt(10)
    v_mfma_f32_16x16x32_bf16 v[144:147], v[56:59], v[216:219], v[144:147]
    ds_read_b64_tr_b16 v[52:53], v4 offset:36864
    v_mfma_f32_16x16x32_bf16 v[148:151], v[56:59], v[220:223], v[148:151]
    ds_read_b64_tr_b16 v[54:55], v4 offset:37888
    v_mfma_f32_16x16x32_bf16 v[152:155], v[60:63], v[216:219], v[152:155]
    ds_read_b64_tr_b16 v[56:57], v5 offset:36864
    v_mfma_f32_16x16x32_bf16 v[156:159], v[60:63], v[220:223], v[156:159]
    ds_read_b64_tr_b16 v[58:59], v5 offset:37888
    s_waitcnt vmcnt(14) lgkmcnt(10)
    v_mfma_f32_16x16x32_bf16 v[64:67], v[32:35], v[224:227], v[64:67]
    ds_read_b64_tr_b16 v[60:61], v6 offset:36864
    v_mfma_f32_16x16x32_bf16 v[68:71], v[32:35], v[228:231], v[68:71]
    ds_read_b64_tr_b16 v[62:63], v6 offset:37888
    v_mfma_f32_16x16x32_bf16 v[72:75], v[36:39], v[224:227], v[72:75]
    ds_read_b64_tr_b16 v[32:33], v3 offset:40960
    v_mfma_f32_16x16x32_bf16 v[76:79], v[36:39], v[228:231], v[76:79]
    ds_read_b64_tr_b16 v[34:35], v3 offset:41984
    s_waitcnt lgkmcnt(10)
    v_mfma_f32_16x16x32_bf16 v[80:83], v[40:43], v[224:227], v[80:83]
    ds_read_b64_tr_b16 v[36:37], v4 offset:40960
    v_mfma_f32_16x16x32_bf16 v[84:87], v[40:43], v[228:231], v[84:87]
    ds_read_b64_tr_b16 v[38:39], v4 offset:41984
    v_mfma_f32_16x16x32_bf16 v[88:91], v[44:47], v[224:227], v[88:91]
    ds_read_b64_tr_b16 v[40:41], v5 offset:40960
    v_mfma_f32_16x16x32_bf16 v[92:95], v[44:47], v[228:231], v[92:95]
    ds_read_b64_tr_b16 v[42:43], v5 offset:41984
    s_waitcnt lgkmcnt(10)
    v_mfma_f32_16x16x32_bf16 v[96:99], v[224:227], v[48:51], v[96:99]
    ds_read_b64_tr_b16 v[44:45], v6 offset:40960
    v_mfma_f32_16x16x32_bf16 v[100:103], v[228:231], v[48:51], v[100:103]
    ds_read_b64_tr_b16 v[46:47], v6 offset:41984
    v_mfma_f32_16x16x32_bf16 v[104:107], v[224:227], v[52:55], v[104:107]
    ds_read_b64_tr_b16 v[48:49], v3 offset:45056
    v_mfma_f32_16x16x32_bf16 v[108:111], v[228:231], v[52:55], v[108:111]
    ds_read_b64_tr_b16 v[50:51], v3 offset:46080
    s_waitcnt lgkmcnt(10)
    v_mfma_f32_16x16x32_bf16 v[112:115], v[224:227], v[56:59], v[112:115]
    ds_read_b64_tr_b16 v[52:53], v4 offset:45056
    v_mfma_f32_16x16x32_bf16 v[116:119], v[228:231], v[56:59], v[116:119]
    ds_read_b64_tr_b16 v[54:55], v4 offset:46080
    v_mfma_f32_16x16x32_bf16 v[120:123], v[224:227], v[60:63], v[120:123]
    ds_read_b64_tr_b16 v[56:57], v5 offset:45056
    v_mfma_f32_16x16x32_bf16 v[124:127], v[228:231], v[60:63], v[124:127]
    ds_read_b64_tr_b16 v[58:59], v5 offset:46080
    s_waitcnt lgkmcnt(10)
    v_mfma_f32_16x16x32_bf16 v[128:131], v[32:35], v[224:227], v[128:131]
    ds_read_b64_tr_b16 v[60:61], v6 offset:45056
    v_mfma_f32_16x16x32_bf16 v[132:135], v[32:35], v[228:231], v[132:135]
    ds_read_b64_tr_b16 v[62:63], v6 offset:46080
    v_mfma_f32_16x16x32_bf16 v[136:139], v[36:39], v[224:227], v[136:139]
    ds_read_b64_tr_b16 v[32:33], v3 offset:49152
    v_mfma_f32_16x16x32_bf16 v[140:143], v[36:39], v[228:231], v[140:143]
    ds_read_b64_tr_b16 v[34:35], v3 offset:50176
    s_waitcnt lgkmcnt(10)
    v_mfma_f32_16x16x32_bf16 v[144:147], v[40:43], v[224:227], v[144:147]
    ds_read_b64_tr_b16 v[36:37], v4 offset:49152
    v_mfma_f32_16x16x32_bf16 v[148:151], v[40:43], v[228:231], v[148:151]
    ds_read_b64_tr_b16 v[38:39], v4 offset:50176
    v_mfma_f32_16x16x32_bf16 v[152:155], v[44:47], v[224:227], v[152:155]
    ds_read_b64_tr_b16 v[40:41], v5 offset:49152
    v_mfma_f32_16x16x32_bf16 v[156:159], v[44:47], v[228:231], v[156:159]
    ds_read_b64_tr_b16 v[42:43], v5 offset:50176
    s_waitcnt vmcnt(12) lgkmcnt(10)
    v_mfma_f32_16x16x32_bf16 v[64:67], v[48:51], v[232:235], v[64:67]
    buffer_load_dwordx4 v[192:195], v2, s[4:7], s42 offen offset:0 sc1
    ds_read_b64_tr_b16 v[44:45], v6 offset:49152
    v_mfma_f32_16x16x32_bf16 v[68:71], v[48:51], v[236:239], v[68:71]
    ds_read_b64_tr_b16 v[46:47], v6 offset:50176
    v_mfma_f32_16x16x32_bf16 v[72:75], v[52:55], v[232:235], v[72:75]
    buffer_load_dwordx4 v[196:199], v2, s[4:7], s42 offen offset:256 sc1
    ds_read_b64_tr_b16 v[48:49], v3 offset:53248
    v_mfma_f32_16x16x32_bf16 v[76:79], v[52:55], v[236:239], v[76:79]
    ds_read_b64_tr_b16 v[50:51], v3 offset:54272
    s_waitcnt lgkmcnt(10)
    v_mfma_f32_16x16x32_bf16 v[80:83], v[56:59], v[232:235], v[80:83]
    buffer_load_dwordx4 v[200:203], v2, s[4:7], s42 offen offset:2048 sc1
    ds_read_b64_tr_b16 v[52:53], v4 offset:53248
    v_mfma_f32_16x16x32_bf16 v[84:87], v[56:59], v[236:239], v[84:87]
    ds_read_b64_tr_b16 v[54:55], v4 offset:54272
    v_mfma_f32_16x16x32_bf16 v[88:91], v[60:63], v[232:235], v[88:91]
    buffer_load_dwordx4 v[204:207], v2, s[4:7], s42 offen offset:2304 sc1
    ds_read_b64_tr_b16 v[56:57], v5 offset:53248
    s_add_u32 s42, s41, s93
    v_mfma_f32_16x16x32_bf16 v[92:95], v[60:63], v[236:239], v[92:95]
    ds_read_b64_tr_b16 v[58:59], v5 offset:54272
    s_waitcnt lgkmcnt(10)
    v_mfma_f32_16x16x32_bf16 v[96:99], v[232:235], v[32:35], v[96:99]
    ds_read_b64_tr_b16 v[60:61], v6 offset:53248
    buffer_load_dwordx4 v[208:211], v2, s[4:7], s42 offen offset:0 sc1
    v_mfma_f32_16x16x32_bf16 v[100:103], v[236:239], v[32:35], v[100:103]
    ds_read_b64_tr_b16 v[62:63], v6 offset:54272
    v_mfma_f32_16x16x32_bf16 v[104:107], v[232:235], v[36:39], v[104:107]
    ds_read_b64_tr_b16 v[32:33], v3 offset:57344
    v_mfma_f32_16x16x32_bf16 v[108:111], v[236:239], v[36:39], v[108:111]
    ds_read_b64_tr_b16 v[34:35], v3 offset:58368
    s_waitcnt lgkmcnt(10)
    v_mfma_f32_16x16x32_bf16 v[112:115], v[232:235], v[40:43], v[112:115]
    ds_read_b64_tr_b16 v[36:37], v4 offset:57344
    v_mfma_f32_16x16x32_bf16 v[116:119], v[236:239], v[40:43], v[116:119]
    ds_read_b64_tr_b16 v[38:39], v4 offset:58368
    v_mfma_f32_16x16x32_bf16 v[120:123], v[232:235], v[44:47], v[120:123]
    buffer_load_dwordx4 v[212:215], v2, s[4:7], s42 offen offset:256 sc1
    ds_read_b64_tr_b16 v[40:41], v5 offset:57344
    v_mfma_f32_16x16x32_bf16 v[124:127], v[236:239], v[44:47], v[124:127]
    ds_read_b64_tr_b16 v[42:43], v5 offset:58368
    s_waitcnt lgkmcnt(10)
    v_mfma_f32_16x16x32_bf16 v[128:131], v[48:51], v[232:235], v[128:131]
    ds_read_b64_tr_b16 v[44:45], v6 offset:57344
    v_mfma_f32_16x16x32_bf16 v[132:135], v[48:51], v[236:239], v[132:135]
    ds_read_b64_tr_b16 v[46:47], v6 offset:58368
    v_mfma_f32_16x16x32_bf16 v[136:139], v[52:55], v[232:235], v[136:139]
    ds_read_b64_tr_b16 v[48:49], v3 offset:61440
    v_mfma_f32_16x16x32_bf16 v[140:143], v[52:55], v[236:239], v[140:143]
    ds_read_b64_tr_b16 v[50:51], v3 offset:62464
    s_waitcnt lgkmcnt(10)
    v_mfma_f32_16x16x32_bf16 v[144:147], v[56:59], v[232:235], v[144:147]
    ds_read_b64_tr_b16 v[52:53], v4 offset:61440
    v_mfma_f32_16x16x32_bf16 v[148:151], v[56:59], v[236:239], v[148:151]
    ds_read_b64_tr_b16 v[54:55], v4 offset:62464
    v_mfma_f32_16x16x32_bf16 v[152:155], v[60:63], v[232:235], v[152:155]
    ds_read_b64_tr_b16 v[56:57], v5 offset:61440
    v_mfma_f32_16x16x32_bf16 v[156:159], v[60:63], v[236:239], v[156:159]
    ds_read_b64_tr_b16 v[58:59], v5 offset:62464
    s_waitcnt vmcnt(16) lgkmcnt(10)
    v_mfma_f32_16x16x32_bf16 v[64:67], v[32:35], v[240:243], v[64:67]
    ds_read_b64_tr_b16 v[60:61], v6 offset:61440
    v_mfma_f32_16x16x32_bf16 v[68:71], v[32:35], v[244:247], v[68:71]
    ds_read_b64_tr_b16 v[62:63], v6 offset:62464
    s_barrier
    v_xor_b32 v3, 0x10000, v3
    v_xor_b32 v4, 0x10000, v4
    v_xor_b32 v5, 0x10000, v5
    v_xor_b32 v6, 0x10000, v6
    v_mfma_f32_16x16x32_bf16 v[72:75], v[36:39], v[240:243], v[72:75]
    ds_read_b64_tr_b16 v[32:33], v3 offset:0
    v_mfma_f32_16x16x32_bf16 v[76:79], v[36:39], v[244:247], v[76:79]
    ds_read_b64_tr_b16 v[34:35], v3 offset:1024
    s_waitcnt lgkmcnt(10)
    v_mfma_f32_16x16x32_bf16 v[80:83], v[40:43], v[240:243], v[80:83]
    ds_read_b64_tr_b16 v[36:37], v4 offset:0
    v_mfma_f32_16x16x32_bf16 v[84:87], v[40:43], v[244:247], v[84:87]
    ds_read_b64_tr_b16 v[38:39], v4 offset:1024
    v_mfma_f32_16x16x32_bf16 v[88:91], v[44:47], v[240:243], v[88:91]
    ds_read_b64_tr_b16 v[40:41], v5 offset:0
    v_mfma_f32_16x16x32_bf16 v[92:95], v[44:47], v[244:247], v[92:95]
    ds_read_b64_tr_b16 v[42:43], v5 offset:1024
    s_waitcnt lgkmcnt(10)
    v_mfma_f32_16x16x32_bf16 v[96:99], v[240:243], v[48:51], v[96:99]
    ds_read_b64_tr_b16 v[44:45], v6 offset:0
    v_mfma_f32_16x16x32_bf16 v[100:103], v[244:247], v[48:51], v[100:103]
    ds_read_b64_tr_b16 v[46:47], v6 offset:1024
    v_mfma_f32_16x16x32_bf16 v[104:107], v[240:243], v[52:55], v[104:107]
    ds_read_b64_tr_b16 v[48:49], v3 offset:4096
    v_mfma_f32_16x16x32_bf16 v[108:111], v[244:247], v[52:55], v[108:111]
    ds_read_b64_tr_b16 v[50:51], v3 offset:5120
    s_waitcnt lgkmcnt(10)
    v_mfma_f32_16x16x32_bf16 v[112:115], v[240:243], v[56:59], v[112:115]
    ds_read_b64_tr_b16 v[52:53], v4 offset:4096
    v_mfma_f32_16x16x32_bf16 v[116:119], v[244:247], v[56:59], v[116:119]
    ds_read_b64_tr_b16 v[54:55], v4 offset:5120
    v_mfma_f32_16x16x32_bf16 v[120:123], v[240:243], v[60:63], v[120:123]
    ds_read_b64_tr_b16 v[56:57], v5 offset:4096
    v_mfma_f32_16x16x32_bf16 v[124:127], v[244:247], v[60:63], v[124:127]
    ds_read_b64_tr_b16 v[58:59], v5 offset:5120
    s_waitcnt lgkmcnt(10)
    v_mfma_f32_16x16x32_bf16 v[128:131], v[32:35], v[240:243], v[128:131]
    ds_read_b64_tr_b16 v[60:61], v6 offset:4096
    v_mfma_f32_16x16x32_bf16 v[132:135], v[32:35], v[244:247], v[132:135]
    ds_read_b64_tr_b16 v[62:63], v6 offset:5120
    v_mfma_f32_16x16x32_bf16 v[136:139], v[36:39], v[240:243], v[136:139]
    ds_read_b64_tr_b16 v[32:33], v3 offset:8192
    v_mfma_f32_16x16x32_bf16 v[140:143], v[36:39], v[244:247], v[140:143]
    ds_read_b64_tr_b16 v[34:35], v3 offset:9216
    s_waitcnt lgkmcnt(10)
    v_mfma_f32_16x16x32_bf16 v[144:147], v[40:43], v[240:243], v[144:147]
    ds_read_b64_tr_b16 v[36:37], v4 offset:8192
    v_mfma_f32_16x16x32_bf16 v[148:151], v[40:43], v[244:247], v[148:151]
    ds_read_b64_tr_b16 v[38:39], v4 offset:9216
    v_mfma_f32_16x16x32_bf16 v[152:155], v[44:47], v[240:243], v[152:155]
    ds_read_b64_tr_b16 v[40:41], v5 offset:8192
    v_mfma_f32_16x16x32_bf16 v[156:159], v[44:47], v[244:247], v[156:159]
    ds_read_b64_tr_b16 v[42:43], v5 offset:9216
    s_waitcnt vmcnt(14) lgkmcnt(10)
    v_mfma_f32_16x16x32_bf16 v[64:67], v[48:51], v[248:251], v[64:67]
    ds_read_b64_tr_b16 v[44:45], v6 offset:8192
    v_mfma_f32_16x16x32_bf16 v[68:71], v[48:51], v[252:255], v[68:71]
    ds_read_b64_tr_b16 v[46:47], v6 offset:9216
    v_mfma_f32_16x16x32_bf16 v[72:75], v[52:55], v[248:251], v[72:75]
    ds_read_b64_tr_b16 v[48:49], v3 offset:12288
    v_mfma_f32_16x16x32_bf16 v[76:79], v[52:55], v[252:255], v[76:79]
    ds_read_b64_tr_b16 v[50:51], v3 offset:13312
    s_waitcnt lgkmcnt(10)
    v_mfma_f32_16x16x32_bf16 v[80:83], v[56:59], v[248:251], v[80:83]
    ds_read_b64_tr_b16 v[52:53], v4 offset:12288
    v_mfma_f32_16x16x32_bf16 v[84:87], v[56:59], v[252:255], v[84:87]
    ds_read_b64_tr_b16 v[54:55], v4 offset:13312
    v_mfma_f32_16x16x32_bf16 v[88:91], v[60:63], v[248:251], v[88:91]
    ds_read_b64_tr_b16 v[56:57], v5 offset:12288
    v_mfma_f32_16x16x32_bf16 v[92:95], v[60:63], v[252:255], v[92:95]
    ds_read_b64_tr_b16 v[58:59], v5 offset:13312
    s_waitcnt lgkmcnt(10)
    v_mfma_f32_16x16x32_bf16 v[96:99], v[248:251], v[32:35], v[96:99]
    ds_read_b64_tr_b16 v[60:61], v6 offset:12288
    v_mfma_f32_16x16x32_bf16 v[100:103], v[252:255], v[32:35], v[100:103]
    ds_read_b64_tr_b16 v[62:63], v6 offset:13312
    v_mfma_f32_16x16x32_bf16 v[104:107], v[248:251], v[36:39], v[104:107]
    ds_read_b64_tr_b16 v[32:33], v3 offset:16384
    v_mfma_f32_16x16x32_bf16 v[108:111], v[252:255], v[36:39], v[108:111]
    ds_read_b64_tr_b16 v[34:35], v3 offset:17408
    s_waitcnt lgkmcnt(10)
    v_mfma_f32_16x16x32_bf16 v[112:115], v[248:251], v[40:43], v[112:115]
    ds_read_b64_tr_b16 v[36:37], v4 offset:16384
    v_mfma_f32_16x16x32_bf16 v[116:119], v[252:255], v[40:43], v[116:119]
    ds_read_b64_tr_b16 v[38:39], v4 offset:17408
    v_mfma_f32_16x16x32_bf16 v[120:123], v[248:251], v[44:47], v[120:123]
    ds_read_b64_tr_b16 v[40:41], v5 offset:16384
    v_mfma_f32_16x16x32_bf16 v[124:127], v[252:255], v[44:47], v[124:127]
    ds_read_b64_tr_b16 v[42:43], v5 offset:17408
    s_waitcnt lgkmcnt(10)
    v_mfma_f32_16x16x32_bf16 v[128:131], v[48:51], v[248:251], v[128:131]
    buffer_load_dwordx4 v[216:219], v2, s[4:7], s42 offen offset:2048 sc1
    ds_read_b64_tr_b16 v[44:45], v6 offset:16384
    v_mfma_f32_16x16x32_bf16 v[132:135], v[48:51], v[252:255], v[132:135]
    ds_read_b64_tr_b16 v[46:47], v6 offset:17408
    v_mfma_f32_16x16x32_bf16 v[136:139], v[52:55], v[248:251], v[136:139]
    buffer_load_dwordx4 v[220:223], v2, s[4:7], s42 offen offset:2304 sc1
    ds_read_b64_tr_b16 v[48:49], v3 offset:20480
    s_add_u32 s42, s41, s94
    v_mfma_f32_16x16x32_bf16 v[140:143], v[52:55], v[252:255], v[140:143]
    ds_read_b64_tr_b16 v[50:51], v3 offset:21504
    s_waitcnt lgkmcnt(10)
    v_mfma_f32_16x16x32_bf16 v[144:147], v[56:59], v[248:251], v[144:147]
    buffer_load_dwordx4 v[224:227], v2, s[4:7], s42 offen offset:0 sc1
    ds_read_b64_tr_b16 v[52:53], v4 offset:20480
    v_mfma_f32_16x16x32_bf16 v[148:151], v[56:59], v[252:255], v[148:151]
    ds_read_b64_tr_b16 v[54:55], v4 offset:21504
    v_mfma_f32_16x16x32_bf16 v[152:155], v[60:63], v[248:251], v[152:155]
    buffer_load_dwordx4 v[228:231], v2, s[4:7], s42 offen offset:256 sc1
    ds_read_b64_tr_b16 v[56:57], v5 offset:20480
    v_mfma_f32_16x16x32_bf16 v[156:159], v[60:63], v[252:255], v[156:159]
    ds_read_b64_tr_b16 v[58:59], v5 offset:21504
    s_waitcnt vmcnt(16) lgkmcnt(10)
    v_mfma_f32_16x16x32_bf16 v[64:67], v[32:35], v[160:163], v[64:67]
    ds_read_b64_tr_b16 v[60:61], v6 offset:20480
    buffer_load_dwordx4 v[232:235], v2, s[4:7], s42 offen offset:2048 sc1
    v_mfma_f32_16x16x32_bf16 v[68:71], v[32:35], v[164:167], v[68:71]
    ds_read_b64_tr_b16 v[62:63], v6 offset:21504
    v_mfma_f32_16x16x32_bf16 v[72:75], v[36:39], v[160:163], v[72:75]
    buffer_load_dwordx4 v[236:239], v2, s[4:7], s42 offen offset:2304 sc1
    ds_read_b64_tr_b16 v[32:33], v3 offset:24576
    s_add_u32 s42, s41, s95
    v_mfma_f32_16x16x32_bf16 v[76:79], v[36:39], v[164:167], v[76:79]
    ds_read_b64_tr_b16 v[34:35], v3 offset:25600
    s_waitcnt lgkmcnt(10)
    v_mfma_f32_16x16x32_bf16 v[80:83], v[40:43], v[160:163], v[80:83]
    ds_read_b64_tr_b16 v[36:37], v4 offset:24576
    v_mfma_f32_16x16x32_bf16 v[84:87], v[40:43], v[164:167], v[84:87]
    ds_read_b64_tr_b16 v[38:39], v4 offset:25600
    v_mfma_f32_16x16x32_bf16 v[88:91], v[44:47], v[160:163], v[88:91]
    ds_read_b64_tr_b16 v[40:41], v5 offset:24576
    v_mfma_f32_16x16x32_bf16 v[92:95], v[44:47], v[164:167], v[92:95]
    ds_read_b64_tr_b16 v[42:43], v5 offset:25600
    s_waitcnt lgkmcnt(10)
    v_mfma_f32_16x16x32_bf16 v[96:99], v[160:163], v[48:51], v[96:99]
    buffer_load_dwordx4 v[240:243], v2, s[4:7], s42 offen offset:0 sc1
    ds_read_b64_tr_b16 v[44:45], v6 offset:24576
    v_mfma_f32_16x16x32_bf16 v[100:103], v[164:167], v[48:51], v[100:103]
    ds_read_b64_tr_b16 v[46:47], v6 offset:25600
    v_mfma_f32_16x16x32_bf16 v[104:107], v[160:163], v[52:55], v[104:107]
    ds_read_b64_tr_b16 v[48:49], v3 offset:28672
    v_mfma_f32_16x16x32_bf16 v[108:111], v[164:167], v[52:55], v[108:111]
    ds_read_b64_tr_b16 v[50:51], v3 offset:29696
    s_waitcnt lgkmcnt(10)
    v_mfma_f32_16x16x32_bf16 v[112:115], v[160:163], v[56:59], v[112:115]
    ds_read_b64_tr_b16 v[52:53], v4 offset:28672
    v_mfma_f32_16x16x32_bf16 v[116:119], v[164:167], v[56:59], v[116:119]
    ds_read_b64_tr_b16 v[54:55], v4 offset:29696
    v_mfma_f32_16x16x32_bf16 v[120:123], v[160:163], v[60:63], v[120:123]
    ds_read_b64_tr_b16 v[56:57], v5 offset:28672
    v_mfma_f32_16x16x32_bf16 v[124:127], v[164:167], v[60:63], v[124:127]
    ds_read_b64_tr_b16 v[58:59], v5 offset:29696
    s_waitcnt lgkmcnt(10)
    v_mfma_f32_16x16x32_bf16 v[128:131], v[32:35], v[160:163], v[128:131]
    ds_read_b64_tr_b16 v[60:61], v6 offset:28672
    v_mfma_f32_16x16x32_bf16 v[132:135], v[32:35], v[164:167], v[132:135]
    ds_read_b64_tr_b16 v[62:63], v6 offset:29696
    s_barrier
    v_mfma_f32_16x16x32_bf16 v[136:139], v[36:39], v[160:163], v[136:139]
    ds_read_b64_tr_b16 v[32:33], v3 offset:32768
    v_mfma_f32_16x16x32_bf16 v[140:143], v[36:39], v[164:167], v[140:143]
    ds_read_b64_tr_b16 v[34:35], v3 offset:33792
    s_waitcnt lgkmcnt(10)
    v_mfma_f32_16x16x32_bf16 v[144:147], v[40:43], v[160:163], v[144:147]
    ds_read_b64_tr_b16 v[36:37], v4 offset:32768
    v_mfma_f32_16x16x32_bf16 v[148:151], v[40:43], v[164:167], v[148:151]
    ds_read_b64_tr_b16 v[38:39], v4 offset:33792
    v_mfma_f32_16x16x32_bf16 v[152:155], v[44:47], v[160:163], v[152:155]
    ds_read_b64_tr_b16 v[40:41], v5 offset:32768
    v_mfma_f32_16x16x32_bf16 v[156:159], v[44:47], v[164:167], v[156:159]
    ds_read_b64_tr_b16 v[42:43], v5 offset:33792
    s_waitcnt vmcnt(17) lgkmcnt(10)
    v_mfma_f32_16x16x32_bf16 v[64:67], v[48:51], v[168:171], v[64:67]
    ds_read_b64_tr_b16 v[44:45], v6 offset:32768
    v_mfma_f32_16x16x32_bf16 v[68:71], v[48:51], v[172:175], v[68:71]
    ds_read_b64_tr_b16 v[46:47], v6 offset:33792
    v_mfma_f32_16x16x32_bf16 v[72:75], v[52:55], v[168:171], v[72:75]
    ds_read_b64_tr_b16 v[48:49], v3 offset:36864
    v_mfma_f32_16x16x32_bf16 v[76:79], v[52:55], v[172:175], v[76:79]
    ds_read_b64_tr_b16 v[50:51], v3 offset:37888
    s_waitcnt lgkmcnt(10)
    v_mfma_f32_16x16x32_bf16 v[80:83], v[56:59], v[168:171], v[80:83]
    ds_read_b64_tr_b16 v[52:53], v4 offset:36864
    v_mfma_f32_16x16x32_bf16 v[84:87], v[56:59], v[172:175], v[84:87]
    ds_read_b64_tr_b16 v[54:55], v4 offset:37888
    v_mfma_f32_16x16x32_bf16 v[88:91], v[60:63], v[168:171], v[88:91]
    ds_read_b64_tr_b16 v[56:57], v5 offset:36864
    v_mfma_f32_16x16x32_bf16 v[92:95], v[60:63], v[172:175], v[92:95]
    ds_read_b64_tr_b16 v[58:59], v5 offset:37888
    s_waitcnt lgkmcnt(10)
    v_mfma_f32_16x16x32_bf16 v[96:99], v[168:171], v[32:35], v[96:99]
    ds_read_b64_tr_b16 v[60:61], v6 offset:36864
    v_mfma_f32_16x16x32_bf16 v[100:103], v[172:175], v[32:35], v[100:103]
    ds_read_b64_tr_b16 v[62:63], v6 offset:37888
    v_mfma_f32_16x16x32_bf16 v[104:107], v[168:171], v[36:39], v[104:107]
    ds_read_b64_tr_b16 v[32:33], v3 offset:40960
    v_mfma_f32_16x16x32_bf16 v[108:111], v[172:175], v[36:39], v[108:111]
    ds_read_b64_tr_b16 v[34:35], v3 offset:41984
    s_waitcnt lgkmcnt(10)
    v_mfma_f32_16x16x32_bf16 v[112:115], v[168:171], v[40:43], v[112:115]
    ds_read_b64_tr_b16 v[36:37], v4 offset:40960
    v_mfma_f32_16x16x32_bf16 v[116:119], v[172:175], v[40:43], v[116:119]
    ds_read_b64_tr_b16 v[38:39], v4 offset:41984
    v_mfma_f32_16x16x32_bf16 v[120:123], v[168:171], v[44:47], v[120:123]
    ds_read_b64_tr_b16 v[40:41], v5 offset:40960
    v_mfma_f32_16x16x32_bf16 v[124:127], v[172:175], v[44:47], v[124:127]
    ds_read_b64_tr_b16 v[42:43], v5 offset:41984
    s_waitcnt lgkmcnt(10)
    v_mfma_f32_16x16x32_bf16 v[128:131], v[48:51], v[168:171], v[128:131]
    ds_read_b64_tr_b16 v[44:45], v6 offset:40960
    v_mfma_f32_16x16x32_bf16 v[132:135], v[48:51], v[172:175], v[132:135]
    ds_read_b64_tr_b16 v[46:47], v6 offset:41984
    v_mfma_f32_16x16x32_bf16 v[136:139], v[52:55], v[168:171], v[136:139]
    ds_read_b64_tr_b16 v[48:49], v3 offset:45056
    v_mfma_f32_16x16x32_bf16 v[140:143], v[52:55], v[172:175], v[140:143]
    ds_read_b64_tr_b16 v[50:51], v3 offset:46080
    s_waitcnt lgkmcnt(10)
    v_mfma_f32_16x16x32_bf16 v[144:147], v[56:59], v[168:171], v[144:147]
    ds_read_b64_tr_b16 v[52:53], v4 offset:45056
    v_mfma_f32_16x16x32_bf16 v[148:151], v[56:59], v[172:175], v[148:151]
    ds_read_b64_tr_b16 v[54:55], v4 offset:46080
    v_mfma_f32_16x16x32_bf16 v[152:155], v[60:63], v[168:171], v[152:155]
    ds_read_b64_tr_b16 v[56:57], v5 offset:45056
    v_mfma_f32_16x16x32_bf16 v[156:159], v[60:63], v[172:175], v[156:159]
    ds_read_b64_tr_b16 v[58:59], v5 offset:46080
    s_waitcnt vmcnt(15) lgkmcnt(10)
    v_mfma_f32_16x16x32_bf16 v[64:67], v[32:35], v[176:179], v[64:67]
    ds_read_b64_tr_b16 v[60:61], v6 offset:45056
    v_mfma_f32_16x16x32_bf16 v[68:71], v[32:35], v[180:183], v[68:71]
    ds_read_b64_tr_b16 v[62:63], v6 offset:46080
    v_mfma_f32_16x16x32_bf16 v[72:75], v[36:39], v[176:179], v[72:75]
    ds_read_b64_tr_b16 v[32:33], v3 offset:49152
    v_mfma_f32_16x16x32_bf16 v[76:79], v[36:39], v[180:183], v[76:79]
    ds_read_b64_tr_b16 v[34:35], v3 offset:50176
    s_waitcnt lgkmcnt(10)
    v_mfma_f32_16x16x32_bf16 v[80:83], v[40:43], v[176:179], v[80:83]
    ds_read_b64_tr_b16 v[36:37], v4 offset:49152
    v_mfma_f32_16x16x32_bf16 v[84:87], v[40:43], v[180:183], v[84:87]
    ds_read_b64_tr_b16 v[38:39], v4 offset:50176
    v_mfma_f32_16x16x32_bf16 v[88:91], v[44:47], v[176:179], v[88:91]
    ds_read_b64_tr_b16 v[40:41], v5 offset:49152
    v_mfma_f32_16x16x32_bf16 v[92:95], v[44:47], v[180:183], v[92:95]
    ds_read_b64_tr_b16 v[42:43], v5 offset:50176
    s_waitcnt lgkmcnt(10)
    v_mfma_f32_16x16x32_bf16 v[96:99], v[176:179], v[48:51], v[96:99]
    buffer_load_dwordx4 v[244:247], v2, s[4:7], s42 offen offset:256 sc1
    ds_read_b64_tr_b16 v[44:45], v6 offset:49152
    v_mfma_f32_16x16x32_bf16 v[100:103], v[180:183], v[48:51], v[100:103]
    ds_read_b64_tr_b16 v[46:47], v6 offset:50176
    v_mfma_f32_16x16x32_bf16 v[104:107], v[176:179], v[52:55], v[104:107]
    buffer_load_dwordx4 v[248:251], v2, s[4:7], s42 offen offset:2048 sc1
    ds_read_b64_tr_b16 v[48:49], v3 offset:53248
    v_mfma_f32_16x16x32_bf16 v[108:111], v[180:183], v[52:55], v[108:111]
    ds_read_b64_tr_b16 v[50:51], v3 offset:54272
    s_waitcnt lgkmcnt(10)
    v_mfma_f32_16x16x32_bf16 v[112:115], v[176:179], v[56:59], v[112:115]
    buffer_load_dwordx4 v[252:255], v2, s[4:7], s42 offen offset:2304 sc1
    ds_read_b64_tr_b16 v[52:53], v4 offset:53248
    s_add_u32 s42, s41, s96
    v_mfma_f32_16x16x32_bf16 v[116:119], v[180:183], v[56:59], v[116:119]
    ds_read_b64_tr_b16 v[54:55], v4 offset:54272
    v_mfma_f32_16x16x32_bf16 v[120:123], v[176:179], v[60:63], v[120:123]
    buffer_load_dwordx4 v[160:163], v2, s[4:7], s42 offen offset:0 sc1
    ds_read_b64_tr_b16 v[56:57], v5 offset:53248
    v_mfma_f32_16x16x32_bf16 v[124:127], v[180:183], v[60:63], v[124:127]
    ds_read_b64_tr_b16 v[58:59], v5 offset:54272
    s_waitcnt lgkmcnt(10)
    v_mfma_f32_16x16x32_bf16 v[128:131], v[32:35], v[176:179], v[128:131]
    ds_read_b64_tr_b16 v[60:61], v6 offset:53248
    buffer_load_dwordx4 v[164:167], v2, s[4:7], s42 offen offset:256 sc1
    v_mfma_f32_16x16x32_bf16 v[132:135], v[32:35], v[180:183], v[132:135]
    ds_read_b64_tr_b16 v[62:63], v6 offset:54272
    v_mfma_f32_16x16x32_bf16 v[136:139], v[36:39], v[176:179], v[136:139]
    buffer_load_dwordx4 v[168:171], v2, s[4:7], s42 offen offset:2048 sc1
    ds_read_b64_tr_b16 v[32:33], v3 offset:57344
    v_mfma_f32_16x16x32_bf16 v[140:143], v[36:39], v[180:183], v[140:143]
    ds_read_b64_tr_b16 v[34:35], v3 offset:58368
    s_waitcnt lgkmcnt(10)
    v_mfma_f32_16x16x32_bf16 v[144:147], v[40:43], v[176:179], v[144:147]
    ds_read_b64_tr_b16 v[36:37], v4 offset:57344
    v_mfma_f32_16x16x32_bf16 v[148:151], v[40:43], v[180:183], v[148:151]
    ds_read_b64_tr_b16 v[38:39], v4 offset:58368
    v_mfma_f32_16x16x32_bf16 v[152:155], v[44:47], v[176:179], v[152:155]
    ds_read_b64_tr_b16 v[40:41], v5 offset:57344
    v_mfma_f32_16x16x32_bf16 v[156:159], v[44:47], v[180:183], v[156:159]
    ds_read_b64_tr_b16 v[42:43], v5 offset:58368
    s_waitcnt vmcnt(19) lgkmcnt(10)
    v_mfma_f32_16x16x32_bf16 v[64:67], v[48:51], v[184:187], v[64:67]
    ds_read_b64_tr_b16 v[44:45], v6 offset:57344
    v_mfma_f32_16x16x32_bf16 v[68:71], v[48:51], v[188:191], v[68:71]
    ds_read_b64_tr_b16 v[46:47], v6 offset:58368
    v_mfma_f32_16x16x32_bf16 v[72:75], v[52:55], v[184:187], v[72:75]
    ds_read_b64_tr_b16 v[48:49], v3 offset:61440
    v_mfma_f32_16x16x32_bf16 v[76:79], v[52:55], v[188:191], v[76:79]
    ds_read_b64_tr_b16 v[50:51], v3 offset:62464
    s_waitcnt lgkmcnt(10)
    v_mfma_f32_16x16x32_bf16 v[80:83], v[56:59], v[184:187], v[80:83]
    buffer_load_dwordx4 v[172:175], v2, s[4:7], s42 offen offset:2304 sc1
    ds_read_b64_tr_b16 v[52:53], v4 offset:61440
    s_add_u32 s42, s41, s97
    v_mfma_f32_16x16x32_bf16 v[84:87], v[56:59], v[188:191], v[84:87]
    ds_read_b64_tr_b16 v[54:55], v4 offset:62464
    v_mfma_f32_16x16x32_bf16 v[88:91], v[60:63], v[184:187], v[88:91]
    ds_read_b64_tr_b16 v[56:57], v5 offset:61440
    v_mfma_f32_16x16x32_bf16 v[92:95], v[60:63], v[188:191], v[92:95]
    ds_read_b64_tr_b16 v[58:59], v5 offset:62464
    s_waitcnt lgkmcnt(10)
    v_mfma_f32_16x16x32_bf16 v[96:99], v[184:187], v[32:35], v[96:99]
    ds_read_b64_tr_b16 v[60:61], v6 offset:61440
    v_mfma_f32_16x16x32_bf16 v[100:103], v[188:191], v[32:35], v[100:103]
    ds_read_b64_tr_b16 v[62:63], v6 offset:62464
    s_barrier
    v_xor_b32 v3, 0x10000, v3
    v_xor_b32 v4, 0x10000, v4
    v_xor_b32 v5, 0x10000, v5
    v_xor_b32 v6, 0x10000, v6
    v_mfma_f32_16x16x32_bf16 v[104:107], v[184:187], v[36:39], v[104:107]
    ds_read_b64_tr_b16 v[32:33], v3 offset:0
    v_mfma_f32_16x16x32_bf16 v[108:111], v[188:191], v[36:39], v[108:111]
    ds_read_b64_tr_b16 v[34:35], v3 offset:1024
    s_waitcnt lgkmcnt(10)
    v_mfma_f32_16x16x32_bf16 v[112:115], v[184:187], v[40:43], v[112:115]
    ds_read_b64_tr_b16 v[36:37], v4 offset:0
    v_mfma_f32_16x16x32_bf16 v[116:119], v[188:191], v[40:43], v[116:119]
    ds_read_b64_tr_b16 v[38:39], v4 offset:1024
    v_mfma_f32_16x16x32_bf16 v[120:123], v[184:187], v[44:47], v[120:123]
    ds_read_b64_tr_b16 v[40:41], v5 offset:0
    v_mfma_f32_16x16x32_bf16 v[124:127], v[188:191], v[44:47], v[124:127]
    ds_read_b64_tr_b16 v[42:43], v5 offset:1024
    s_waitcnt lgkmcnt(10)
    v_mfma_f32_16x16x32_bf16 v[128:131], v[48:51], v[184:187], v[128:131]
    ds_read_b64_tr_b16 v[44:45], v6 offset:0
    v_mfma_f32_16x16x32_bf16 v[132:135], v[48:51], v[188:191], v[132:135]
    ds_read_b64_tr_b16 v[46:47], v6 offset:1024
    v_mfma_f32_16x16x32_bf16 v[136:139], v[52:55], v[184:187], v[136:139]
    ds_read_b64_tr_b16 v[48:49], v3 offset:4096
    v_mfma_f32_16x16x32_bf16 v[140:143], v[52:55], v[188:191], v[140:143]
    ds_read_b64_tr_b16 v[50:51], v3 offset:5120
    s_waitcnt lgkmcnt(10)
    v_mfma_f32_16x16x32_bf16 v[144:147], v[56:59], v[184:187], v[144:147]
    ds_read_b64_tr_b16 v[52:53], v4 offset:4096
    v_mfma_f32_16x16x32_bf16 v[148:151], v[56:59], v[188:191], v[148:151]
    ds_read_b64_tr_b16 v[54:55], v4 offset:5120
    v_mfma_f32_16x16x32_bf16 v[152:155], v[60:63], v[184:187], v[152:155]
    ds_read_b64_tr_b16 v[56:57], v5 offset:4096
    v_mfma_f32_16x16x32_bf16 v[156:159], v[60:63], v[188:191], v[156:159]
    ds_read_b64_tr_b16 v[58:59], v5 offset:5120
    s_waitcnt vmcnt(18) lgkmcnt(10)
    v_mfma_f32_16x16x32_bf16 v[64:67], v[32:35], v[192:195], v[64:67]
    ds_read_b64_tr_b16 v[60:61], v6 offset:4096
    v_mfma_f32_16x16x32_bf16 v[68:71], v[32:35], v[196:199], v[68:71]
    ds_read_b64_tr_b16 v[62:63], v6 offset:5120
    v_mfma_f32_16x16x32_bf16 v[72:75], v[36:39], v[192:195], v[72:75]
    ds_read_b64_tr_b16 v[32:33], v3 offset:8192
    v_mfma_f32_16x16x32_bf16 v[76:79], v[36:39], v[196:199], v[76:79]
    ds_read_b64_tr_b16 v[34:35], v3 offset:9216
    s_waitcnt lgkmcnt(10)
    v_mfma_f32_16x16x32_bf16 v[80:83], v[40:43], v[192:195], v[80:83]
    ds_read_b64_tr_b16 v[36:37], v4 offset:8192
    v_mfma_f32_16x16x32_bf16 v[84:87], v[40:43], v[196:199], v[84:87]
    ds_read_b64_tr_b16 v[38:39], v4 offset:9216
    v_mfma_f32_16x16x32_bf16 v[88:91], v[44:47], v[192:195], v[88:91]
    ds_read_b64_tr_b16 v[40:41], v5 offset:8192
    v_mfma_f32_16x16x32_bf16 v[92:95], v[44:47], v[196:199], v[92:95]
    ds_read_b64_tr_b16 v[42:43], v5 offset:9216
    s_waitcnt lgkmcnt(10)
    v_mfma_f32_16x16x32_bf16 v[96:99], v[192:195], v[48:51], v[96:99]
    ds_read_b64_tr_b16 v[44:45], v6 offset:8192
    v_mfma_f32_16x16x32_bf16 v[100:103], v[196:199], v[48:51], v[100:103]
    ds_read_b64_tr_b16 v[46:47], v6 offset:9216
    v_mfma_f32_16x16x32_bf16 v[104:107], v[192:195], v[52:55], v[104:107]
    ds_read_b64_tr_b16 v[48:49], v3 offset:12288
    v_mfma_f32_16x16x32_bf16 v[108:111], v[196:199], v[52:55], v[108:111]
    ds_read_b64_tr_b16 v[50:51], v3 offset:13312
    s_waitcnt lgkmcnt(10)
    v_mfma_f32_16x16x32_bf16 v[112:115], v[192:195], v[56:59], v[112:115]
    ds_read_b64_tr_b16 v[52:53], v4 offset:12288
    v_mfma_f32_16x16x32_bf16 v[116:119], v[196:199], v[56:59], v[116:119]
    ds_read_b64_tr_b16 v[54:55], v4 offset:13312
    v_mfma_f32_16x16x32_bf16 v[120:123], v[192:195], v[60:63], v[120:123]
    ds_read_b64_tr_b16 v[56:57], v5 offset:12288
    v_mfma_f32_16x16x32_bf16 v[124:127], v[196:199], v[60:63], v[124:127]
    ds_read_b64_tr_b16 v[58:59], v5 offset:13312
    s_waitcnt lgkmcnt(10)
    v_mfma_f32_16x16x32_bf16 v[128:131], v[32:35], v[192:195], v[128:131]
    ds_read_b64_tr_b16 v[60:61], v6 offset:12288
    v_mfma_f32_16x16x32_bf16 v[132:135], v[32:35], v[196:199], v[132:135]
    ds_read_b64_tr_b16 v[62:63], v6 offset:13312
    v_mfma_f32_16x16x32_bf16 v[136:139], v[36:39], v[192:195], v[136:139]
    ds_read_b64_tr_b16 v[32:33], v3 offset:16384
    v_mfma_f32_16x16x32_bf16 v[140:143], v[36:39], v[196:199], v[140:143]
    ds_read_b64_tr_b16 v[34:35], v3 offset:17408
    s_waitcnt lgkmcnt(10)
    v_mfma_f32_16x16x32_bf16 v[144:147], v[40:43], v[192:195], v[144:147]
    ds_read_b64_tr_b16 v[36:37], v4 offset:16384
    v_mfma_f32_16x16x32_bf16 v[148:151], v[40:43], v[196:199], v[148:151]
    ds_read_b64_tr_b16 v[38:39], v4 offset:17408
    v_mfma_f32_16x16x32_bf16 v[152:155], v[44:47], v[192:195], v[152:155]
    ds_read_b64_tr_b16 v[40:41], v5 offset:16384
    v_mfma_f32_16x16x32_bf16 v[156:159], v[44:47], v[196:199], v[156:159]
    ds_read_b64_tr_b16 v[42:43], v5 offset:17408
    s_waitcnt vmcnt(16) lgkmcnt(10)
    v_mfma_f32_16x16x32_bf16 v[64:67], v[48:51], v[200:203], v[64:67]
    buffer_load_dwordx4 v[176:179], v2, s[4:7], s42 offen offset:0 sc1
    ds_read_b64_tr_b16 v[44:45], v6 offset:16384
    v_mfma_f32_16x16x32_bf16 v[68:71], v[48:51], v[204:207], v[68:71]
    ds_read_b64_tr_b16 v[46:47], v6 offset:17408
    v_mfma_f32_16x16x32_bf16 v[72:75], v[52:55], v[200:203], v[72:75]
    buffer_load_dwordx4 v[180:183], v2, s[4:7], s42 offen offset:256 sc1
    ds_read_b64_tr_b16 v[48:49], v3 offset:20480
    v_mfma_f32_16x16x32_bf16 v[76:79], v[52:55], v[204:207], v[76:79]
    ds_read_b64_tr_b16 v[50:51], v3 offset:21504
    s_waitcnt lgkmcnt(10)
    v_mfma_f32_16x16x32_bf16 v[80:83], v[56:59], v[200:203], v[80:83]
    buffer_load_dwordx4 v[184:187], v2, s[4:7], s42 offen offset:2048 sc1
    ds_read_b64_tr_b16 v[52:53], v4 offset:20480
    v_mfma_f32_16x16x32_bf16 v[84:87], v[56:59], v[204:207], v[84:87]
    ds_read_b64_tr_b16 v[54:55], v4 offset:21504
    v_mfma_f32_16x16x32_bf16 v[88:91], v[60:63], v[200:203], v[88:91]
    buffer_load_dwordx4 v[188:191], v2, s[4:7], s42 offen offset:2304 sc1
    ds_read_b64_tr_b16 v[56:57], v5 offset:20480
    s_add_u32 s42, s41, s98
    v_mfma_f32_16x16x32_bf16 v[92:95], v[60:63], v[204:207], v[92:95]
    ds_read_b64_tr_b16 v[58:59], v5 offset:21504
    s_waitcnt lgkmcnt(10)
    v_mfma_f32_16x16x32_bf16 v[96:99], v[200:203], v[32:35], v[96:99]
    ds_read_b64_tr_b16 v[60:61], v6 offset:20480
    buffer_load_dwordx4 v[192:195], v2, s[4:7], s42 offen offset:0 sc1
    v_mfma_f32_16x16x32_bf16 v[100:103], v[204:207], v[32:35], v[100:103]
    ds_read_b64_tr_b16 v[62:63], v6 offset:21504
    v_mfma_f32_16x16x32_bf16 v[104:107], v[200:203], v[36:39], v[104:107]
    ds_read_b64_tr_b16 v[32:33], v3 offset:24576
    v_mfma_f32_16x16x32_bf16 v[108:111], v[204:207], v[36:39], v[108:111]
    ds_read_b64_tr_b16 v[34:35], v3 offset:25600
    s_waitcnt lgkmcnt(10)
    v_mfma_f32_16x16x32_bf16 v[112:115], v[200:203], v[40:43], v[112:115]
    ds_read_b64_tr_b16 v[36:37], v4 offset:24576
    v_mfma_f32_16x16x32_bf16 v[116:119], v[204:207], v[40:43], v[116:119]
    ds_read_b64_tr_b16 v[38:39], v4 offset:25600
    v_mfma_f32_16x16x32_bf16 v[120:123], v[200:203], v[44:47], v[120:123]
    buffer_load_dwordx4 v[196:199], v2, s[4:7], s42 offen offset:256 sc1
    ds_read_b64_tr_b16 v[40:41], v5 offset:24576
    v_mfma_f32_16x16x32_bf16 v[124:127], v[204:207], v[44:47], v[124:127]
    ds_read_b64_tr_b16 v[42:43], v5 offset:25600
    s_waitcnt lgkmcnt(10)
    v_mfma_f32_16x16x32_bf16 v[128:131], v[48:51], v[200:203], v[128:131]
    ds_read_b64_tr_b16 v[44:45], v6 offset:24576
    v_mfma_f32_16x16x32_bf16 v[132:135], v[48:51], v[204:207], v[132:135]
    ds_read_b64_tr_b16 v[46:47], v6 offset:25600
    v_mfma_f32_16x16x32_bf16 v[136:139], v[52:55], v[200:203], v[136:139]
    ds_read_b64_tr_b16 v[48:49], v3 offset:28672
    v_mfma_f32_16x16x32_bf16 v[140:143], v[52:55], v[204:207], v[140:143]
    ds_read_b64_tr_b16 v[50:51], v3 offset:29696
    s_waitcnt lgkmcnt(10)
    v_mfma_f32_16x16x32_bf16 v[144:147], v[56:59], v[200:203], v[144:147]
    ds_read_b64_tr_b16 v[52:53], v4 offset:28672
    v_mfma_f32_16x16x32_bf16 v[148:151], v[56:59], v[204:207], v[148:151]
    ds_read_b64_tr_b16 v[54:55], v4 offset:29696
    v_mfma_f32_16x16x32_bf16 v[152:155], v[60:63], v[200:203], v[152:155]
    ds_read_b64_tr_b16 v[56:57], v5 offset:28672
    v_mfma_f32_16x16x32_bf16 v[156:159], v[60:63], v[204:207], v[156:159]
    ds_read_b64_tr_b16 v[58:59], v5 offset:29696
    s_waitcnt vmcnt(20) lgkmcnt(10)
    v_mfma_f32_16x16x32_bf16 v[64:67], v[32:35], v[208:211], v[64:67]
    ds_read_b64_tr_b16 v[60:61], v6 offset:28672
    v_mfma_f32_16x16x32_bf16 v[68:71], v[32:35], v[212:215], v[68:71]
    ds_read_b64_tr_b16 v[62:63], v6 offset:29696
    s_barrier
    v_mfma_f32_16x16x32_bf16 v[72:75], v[36:39], v[208:211], v[72:75]
    ds_read_b64_tr_b16 v[32:33], v3 offset:32768
    v_mfma_f32_16x16x32_bf16 v[76:79], v[36:39], v[212:215], v[76:79]
    ds_read_b64_tr_b16 v[34:35], v3 offset:33792
    s_waitcnt lgkmcnt(10)
    v_mfma_f32_16x16x32_bf16 v[80:83], v[40:43], v[208:211], v[80:83]
    ds_read_b64_tr_b16 v[36:37], v4 offset:32768
    v_mfma_f32_16x16x32_bf16 v[84:87], v[40:43], v[212:215], v[84:87]
    ds_read_b64_tr_b16 v[38:39], v4 offset:33792
    v_mfma_f32_16x16x32_bf16 v[88:91], v[44:47], v[208:211], v[88:91]
    ds_read_b64_tr_b16 v[40:41], v5 offset:32768
    v_mfma_f32_16x16x32_bf16 v[92:95], v[44:47], v[212:215], v[92:95]
    ds_read_b64_tr_b16 v[42:43], v5 offset:33792
    s_waitcnt lgkmcnt(10)
    v_mfma_f32_16x16x32_bf16 v[96:99], v[208:211], v[48:51], v[96:99]
    ds_read_b64_tr_b16 v[44:45], v6 offset:32768
    v_mfma_f32_16x16x32_bf16 v[100:103], v[212:215], v[48:51], v[100:103]
    ds_read_b64_tr_b16 v[46:47], v6 offset:33792
    v_mfma_f32_16x16x32_bf16 v[104:107], v[208:211], v[52:55], v[104:107]
    ds_read_b64_tr_b16 v[48:49], v3 offset:36864
    v_mfma_f32_16x16x32_bf16 v[108:111], v[212:215], v[52:55], v[108:111]
    ds_read_b64_tr_b16 v[50:51], v3 offset:37888
    s_waitcnt lgkmcnt(10)
    v_mfma_f32_16x16x32_bf16 v[112:115], v[208:211], v[56:59], v[112:115]
    ds_read_b64_tr_b16 v[52:53], v4 offset:36864
    v_mfma_f32_16x16x32_bf16 v[116:119], v[212:215], v[56:59], v[116:119]
    ds_read_b64_tr_b16 v[54:55], v4 offset:37888
    v_mfma_f32_16x16x32_bf16 v[120:123], v[208:211], v[60:63], v[120:123]
    ds_read_b64_tr_b16 v[56:57], v5 offset:36864
    v_mfma_f32_16x16x32_bf16 v[124:127], v[212:215], v[60:63], v[124:127]
    ds_read_b64_tr_b16 v[58:59], v5 offset:37888
    s_waitcnt lgkmcnt(10)
    v_mfma_f32_16x16x32_bf16 v[128:131], v[32:35], v[208:211], v[128:131]
    ds_read_b64_tr_b16 v[60:61], v6 offset:36864
    v_mfma_f32_16x16x32_bf16 v[132:135], v[32:35], v[212:215], v[132:135]
    ds_read_b64_tr_b16 v[62:63], v6 offset:37888
    v_mfma_f32_16x16x32_bf16 v[136:139], v[36:39], v[208:211], v[136:139]
    ds_read_b64_tr_b16 v[32:33], v3 offset:40960
    v_mfma_f32_16x16x32_bf16 v[140:143], v[36:39], v[212:215], v[140:143]
    ds_read_b64_tr_b16 v[34:35], v3 offset:41984
    s_waitcnt lgkmcnt(10)
    v_mfma_f32_16x16x32_bf16 v[144:147], v[40:43], v[208:211], v[144:147]
    ds_read_b64_tr_b16 v[36:37], v4 offset:40960
    v_mfma_f32_16x16x32_bf16 v[148:151], v[40:43], v[212:215], v[148:151]
    ds_read_b64_tr_b16 v[38:39], v4 offset:41984
    v_mfma_f32_16x16x32_bf16 v[152:155], v[44:47], v[208:211], v[152:155]
    ds_read_b64_tr_b16 v[40:41], v5 offset:40960
    v_mfma_f32_16x16x32_bf16 v[156:159], v[44:47], v[212:215], v[156:159]
    ds_read_b64_tr_b16 v[42:43], v5 offset:41984
    s_waitcnt vmcnt(18) lgkmcnt(10)
    v_mfma_f32_16x16x32_bf16 v[64:67], v[48:51], v[216:219], v[64:67]
    ds_read_b64_tr_b16 v[44:45], v6 offset:40960
    v_mfma_f32_16x16x32_bf16 v[68:71], v[48:51], v[220:223], v[68:71]
    ds_read_b64_tr_b16 v[46:47], v6 offset:41984
    v_mfma_f32_16x16x32_bf16 v[72:75], v[52:55], v[216:219], v[72:75]
    ds_read_b64_tr_b16 v[48:49], v3 offset:45056
    v_mfma_f32_16x16x32_bf16 v[76:79], v[52:55], v[220:223], v[76:79]
    ds_read_b64_tr_b16 v[50:51], v3 offset:46080
    s_waitcnt lgkmcnt(10)
    v_mfma_f32_16x16x32_bf16 v[80:83], v[56:59], v[216:219], v[80:83]
    ds_read_b64_tr_b16 v[52:53], v4 offset:45056
    v_mfma_f32_16x16x32_bf16 v[84:87], v[56:59], v[220:223], v[84:87]
    ds_read_b64_tr_b16 v[54:55], v4 offset:46080
    v_mfma_f32_16x16x32_bf16 v[88:91], v[60:63], v[216:219], v[88:91]
    ds_read_b64_tr_b16 v[56:57], v5 offset:45056
    v_mfma_f32_16x16x32_bf16 v[92:95], v[60:63], v[220:223], v[92:95]
    ds_read_b64_tr_b16 v[58:59], v5 offset:46080
    s_waitcnt lgkmcnt(10)
    v_mfma_f32_16x16x32_bf16 v[96:99], v[216:219], v[32:35], v[96:99]
    ds_read_b64_tr_b16 v[60:61], v6 offset:45056
    v_mfma_f32_16x16x32_bf16 v[100:103], v[220:223], v[32:35], v[100:103]
    ds_read_b64_tr_b16 v[62:63], v6 offset:46080
    v_mfma_f32_16x16x32_bf16 v[104:107], v[216:219], v[36:39], v[104:107]
    ds_read_b64_tr_b16 v[32:33], v3 offset:49152
    v_mfma_f32_16x16x32_bf16 v[108:111], v[220:223], v[36:39], v[108:111]
    ds_read_b64_tr_b16 v[34:35], v3 offset:50176
    s_waitcnt lgkmcnt(10)
    v_mfma_f32_16x16x32_bf16 v[112:115], v[216:219], v[40:43], v[112:115]
    ds_read_b64_tr_b16 v[36:37], v4 offset:49152
    v_mfma_f32_16x16x32_bf16 v[116:119], v[220:223], v[40:43], v[116:119]
    ds_read_b64_tr_b16 v[38:39], v4 offset:50176
    v_mfma_f32_16x16x32_bf16 v[120:123], v[216:219], v[44:47], v[120:123]
    ds_read_b64_tr_b16 v[40:41], v5 offset:49152
    v_mfma_f32_16x16x32_bf16 v[124:127], v[220:223], v[44:47], v[124:127]
    ds_read_b64_tr_b16 v[42:43], v5 offset:50176
    s_waitcnt lgkmcnt(10)
    v_mfma_f32_16x16x32_bf16 v[128:131], v[48:51], v[216:219], v[128:131]
    buffer_load_dwordx4 v[200:203], v2, s[4:7], s42 offen offset:2048 sc1
    ds_read_b64_tr_b16 v[44:45], v6 offset:49152
    v_mfma_f32_16x16x32_bf16 v[132:135], v[48:51], v[220:223], v[132:135]
    ds_read_b64_tr_b16 v[46:47], v6 offset:50176
    v_mfma_f32_16x16x32_bf16 v[136:139], v[52:55], v[216:219], v[136:139]
    buffer_load_dwordx4 v[204:207], v2, s[4:7], s42 offen offset:2304 sc1
    ds_read_b64_tr_b16 v[48:49], v3 offset:53248
    s_add_u32 s42, s41, s99
    v_mfma_f32_16x16x32_bf16 v[140:143], v[52:55], v[220:223], v[140:143]
    ds_read_b64_tr_b16 v[50:51], v3 offset:54272
    s_waitcnt lgkmcnt(10)
    v_mfma_f32_16x16x32_bf16 v[144:147], v[56:59], v[216:219], v[144:147]
    buffer_load_dwordx4 v[208:211], v2, s[4:7], s42 offen offset:0 sc1
    ds_read_b64_tr_b16 v[52:53], v4 offset:53248
    v_mfma_f32_16x16x32_bf16 v[148:151], v[56:59], v[220:223], v[148:151]
    ds_read_b64_tr_b16 v[54:55], v4 offset:54272
    v_mfma_f32_16x16x32_bf16 v[152:155], v[60:63], v[216:219], v[152:155]
    buffer_load_dwordx4 v[212:215], v2, s[4:7], s42 offen offset:256 sc1
    ds_read_b64_tr_b16 v[56:57], v5 offset:53248
    v_mfma_f32_16x16x32_bf16 v[156:159], v[60:63], v[220:223], v[156:159]
    ds_read_b64_tr_b16 v[58:59], v5 offset:54272
    s_waitcnt vmcnt(20) lgkmcnt(10)
    v_mfma_f32_16x16x32_bf16 v[64:67], v[32:35], v[224:227], v[64:67]
    ds_read_b64_tr_b16 v[60:61], v6 offset:53248
    buffer_load_dwordx4 v[216:219], v2, s[4:7], s42 offen offset:2048 sc1
    v_mfma_f32_16x16x32_bf16 v[68:71], v[32:35], v[228:231], v[68:71]
    ds_read_b64_tr_b16 v[62:63], v6 offset:54272
    v_mfma_f32_16x16x32_bf16 v[72:75], v[36:39], v[224:227], v[72:75]
    buffer_load_dwordx4 v[220:223], v2, s[4:7], s42 offen offset:2304 sc1
    ds_read_b64_tr_b16 v[32:33], v3 offset:57344
    v_mfma_f32_16x16x32_bf16 v[76:79], v[36:39], v[228:231], v[76:79]
    ds_read_b64_tr_b16 v[34:35], v3 offset:58368
    s_waitcnt lgkmcnt(10)
    v_mfma_f32_16x16x32_bf16 v[80:83], v[40:43], v[224:227], v[80:83]
    ds_read_b64_tr_b16 v[36:37], v4 offset:57344
    v_mfma_f32_16x16x32_bf16 v[84:87], v[40:43], v[228:231], v[84:87]
    ds_read_b64_tr_b16 v[38:39], v4 offset:58368
    v_mfma_f32_16x16x32_bf16 v[88:91], v[44:47], v[224:227], v[88:91]
    ds_read_b64_tr_b16 v[40:41], v5 offset:57344
    v_mfma_f32_16x16x32_bf16 v[92:95], v[44:47], v[228:231], v[92:95]
    ds_read_b64_tr_b16 v[42:43], v5 offset:58368
    s_waitcnt lgkmcnt(10)
    v_mfma_f32_16x16x32_bf16 v[96:99], v[224:227], v[48:51], v[96:99]
    ds_read_b64_tr_b16 v[44:45], v6 offset:57344
    v_mfma_f32_16x16x32_bf16 v[100:103], v[228:231], v[48:51], v[100:103]
    ds_read_b64_tr_b16 v[46:47], v6 offset:58368
    v_mfma_f32_16x16x32_bf16 v[104:107], v[224:227], v[52:55], v[104:107]
    ds_read_b64_tr_b16 v[48:49], v3 offset:61440
    v_mfma_f32_16x16x32_bf16 v[108:111], v[228:231], v[52:55], v[108:111]
    ds_read_b64_tr_b16 v[50:51], v3 offset:62464
    s_waitcnt lgkmcnt(10)
    v_mfma_f32_16x16x32_bf16 v[112:115], v[224:227], v[56:59], v[112:115]
    ds_read_b64_tr_b16 v[52:53], v4 offset:61440
    v_mfma_f32_16x16x32_bf16 v[116:119], v[228:231], v[56:59], v[116:119]
    ds_read_b64_tr_b16 v[54:55], v4 offset:62464
    v_mfma_f32_16x16x32_bf16 v[120:123], v[224:227], v[60:63], v[120:123]
    ds_read_b64_tr_b16 v[56:57], v5 offset:61440
    v_mfma_f32_16x16x32_bf16 v[124:127], v[228:231], v[60:63], v[124:127]
    ds_read_b64_tr_b16 v[58:59], v5 offset:62464
    s_waitcnt vmcnt(20) lgkmcnt(10)
    v_mfma_f32_16x16x32_bf16 v[64:67], v[32:35], v[232:235], v[64:67]
    ds_read_b64_tr_b16 v[60:61], v6 offset:61440
    v_mfma_f32_16x16x32_bf16 v[68:71], v[32:35], v[236:239], v[68:71]
    ds_read_b64_tr_b16 v[62:63], v6 offset:62464
    s_barrier
    v_xor_b32 v3, 0x10000, v3
    v_xor_b32 v4, 0x10000, v4
    v_xor_b32 v5, 0x10000, v5
    v_xor_b32 v6, 0x10000, v6
    v_mfma_f32_16x16x32_bf16 v[72:75], v[36:39], v[232:235], v[72:75]
    ds_read_b64_tr_b16 v[32:33], v3 offset:0
    v_mfma_f32_16x16x32_bf16 v[76:79], v[36:39], v[236:239], v[76:79]
    ds_read_b64_tr_b16 v[34:35], v3 offset:1024
    s_waitcnt lgkmcnt(10)
    v_mfma_f32_16x16x32_bf16 v[80:83], v[40:43], v[232:235], v[80:83]
    ds_read_b64_tr_b16 v[36:37], v4 offset:0
    v_mfma_f32_16x16x32_bf16 v[84:87], v[40:43], v[236:239], v[84:87]
    ds_read_b64_tr_b16 v[38:39], v4 offset:1024
    v_mfma_f32_16x16x32_bf16 v[88:91], v[44:47], v[232:235], v[88:91]
    ds_read_b64_tr_b16 v[40:41], v5 offset:0
    v_mfma_f32_16x16x32_bf16 v[92:95], v[44:47], v[236:239], v[92:95]
    ds_read_b64_tr_b16 v[42:43], v5 offset:1024
    s_waitcnt lgkmcnt(10)
    v_mfma_f32_16x16x32_bf16 v[96:99], v[232:235], v[48:51], v[96:99]
    ds_read_b64_tr_b16 v[44:45], v6 offset:0
    v_mfma_f32_16x16x32_bf16 v[100:103], v[236:239], v[48:51], v[100:103]
    ds_read_b64_tr_b16 v[46:47], v6 offset:1024
    v_mfma_f32_16x16x32_bf16 v[104:107], v[232:235], v[52:55], v[104:107]
    ds_read_b64_tr_b16 v[48:49], v3 offset:4096
    v_mfma_f32_16x16x32_bf16 v[108:111], v[236:239], v[52:55], v[108:111]
    ds_read_b64_tr_b16 v[50:51], v3 offset:5120
    s_waitcnt lgkmcnt(10)
    v_mfma_f32_16x16x32_bf16 v[112:115], v[232:235], v[56:59], v[112:115]
    ds_read_b64_tr_b16 v[52:53], v4 offset:4096
    v_mfma_f32_16x16x32_bf16 v[116:119], v[236:239], v[56:59], v[116:119]
    ds_read_b64_tr_b16 v[54:55], v4 offset:5120
    v_mfma_f32_16x16x32_bf16 v[120:123], v[232:235], v[60:63], v[120:123]
    ds_read_b64_tr_b16 v[56:57], v5 offset:4096
    v_mfma_f32_16x16x32_bf16 v[124:127], v[236:239], v[60:63], v[124:127]
    ds_read_b64_tr_b16 v[58:59], v5 offset:5120
    s_waitcnt vmcnt(18) lgkmcnt(10)
    v_mfma_f32_16x16x32_bf16 v[64:67], v[32:35], v[240:243], v[64:67]
    ds_read_b64_tr_b16 v[60:61], v6 offset:4096
    v_mfma_f32_16x16x32_bf16 v[68:71], v[32:35], v[244:247], v[68:71]
    ds_read_b64_tr_b16 v[62:63], v6 offset:5120
    v_mfma_f32_16x16x32_bf16 v[72:75], v[36:39], v[240:243], v[72:75]
    ds_read_b64_tr_b16 v[32:33], v3 offset:8192
    v_mfma_f32_16x16x32_bf16 v[76:79], v[36:39], v[244:247], v[76:79]
    ds_read_b64_tr_b16 v[34:35], v3 offset:9216
    s_waitcnt lgkmcnt(10)
    v_mfma_f32_16x16x32_bf16 v[80:83], v[40:43], v[240:243], v[80:83]
    ds_read_b64_tr_b16 v[36:37], v4 offset:8192
    v_mfma_f32_16x16x32_bf16 v[84:87], v[40:43], v[244:247], v[84:87]
    ds_read_b64_tr_b16 v[38:39], v4 offset:9216
    v_mfma_f32_16x16x32_bf16 v[88:91], v[44:47], v[240:243], v[88:91]
    ds_read_b64_tr_b16 v[40:41], v5 offset:8192
    v_mfma_f32_16x16x32_bf16 v[92:95], v[44:47], v[244:247], v[92:95]
    ds_read_b64_tr_b16 v[42:43], v5 offset:9216
    s_waitcnt lgkmcnt(10)
    v_mfma_f32_16x16x32_bf16 v[96:99], v[240:243], v[48:51], v[96:99]
    ds_read_b64_tr_b16 v[44:45], v6 offset:8192
    v_mfma_f32_16x16x32_bf16 v[100:103], v[244:247], v[48:51], v[100:103]
    ds_read_b64_tr_b16 v[46:47], v6 offset:9216
    v_mfma_f32_16x16x32_bf16 v[104:107], v[240:243], v[52:55], v[104:107]
    ds_read_b64_tr_b16 v[48:49], v3 offset:12288
    v_mfma_f32_16x16x32_bf16 v[108:111], v[244:247], v[52:55], v[108:111]
    ds_read_b64_tr_b16 v[50:51], v3 offset:13312
    s_waitcnt lgkmcnt(10)
    v_mfma_f32_16x16x32_bf16 v[112:115], v[240:243], v[56:59], v[112:115]
    ds_read_b64_tr_b16 v[52:53], v4 offset:12288
    v_mfma_f32_16x16x32_bf16 v[116:119], v[244:247], v[56:59], v[116:119]
    ds_read_b64_tr_b16 v[54:55], v4 offset:13312
    v_mfma_f32_16x16x32_bf16 v[120:123], v[240:243], v[60:63], v[120:123]
    ds_read_b64_tr_b16 v[56:57], v5 offset:12288
    v_mfma_f32_16x16x32_bf16 v[124:127], v[244:247], v[60:63], v[124:127]
    ds_read_b64_tr_b16 v[58:59], v5 offset:13312
    s_waitcnt vmcnt(16) lgkmcnt(10)
    v_mfma_f32_16x16x32_bf16 v[64:67], v[32:35], v[248:251], v[64:67]
    ds_read_b64_tr_b16 v[60:61], v6 offset:12288
    v_mfma_f32_16x16x32_bf16 v[68:71], v[32:35], v[252:255], v[68:71]
    ds_read_b64_tr_b16 v[62:63], v6 offset:13312
    v_mfma_f32_16x16x32_bf16 v[72:75], v[36:39], v[248:251], v[72:75]
    ds_read_b64_tr_b16 v[32:33], v3 offset:16384
    v_mfma_f32_16x16x32_bf16 v[76:79], v[36:39], v[252:255], v[76:79]
    ds_read_b64_tr_b16 v[34:35], v3 offset:17408
    s_waitcnt lgkmcnt(10)
    v_mfma_f32_16x16x32_bf16 v[80:83], v[40:43], v[248:251], v[80:83]
    ds_read_b64_tr_b16 v[36:37], v4 offset:16384
    v_mfma_f32_16x16x32_bf16 v[84:87], v[40:43], v[252:255], v[84:87]
    ds_read_b64_tr_b16 v[38:39], v4 offset:17408
    v_mfma_f32_16x16x32_bf16 v[88:91], v[44:47], v[248:251], v[88:91]
    ds_read_b64_tr_b16 v[40:41], v5 offset:16384
    v_mfma_f32_16x16x32_bf16 v[92:95], v[44:47], v[252:255], v[92:95]
    ds_read_b64_tr_b16 v[42:43], v5 offset:17408
    s_waitcnt lgkmcnt(10)
    v_mfma_f32_16x16x32_bf16 v[96:99], v[248:251], v[48:51], v[96:99]
    ds_read_b64_tr_b16 v[44:45], v6 offset:16384
    v_mfma_f32_16x16x32_bf16 v[100:103], v[252:255], v[48:51], v[100:103]
    ds_read_b64_tr_b16 v[46:47], v6 offset:17408
    v_mfma_f32_16x16x32_bf16 v[104:107], v[248:251], v[52:55], v[104:107]
    ds_read_b64_tr_b16 v[48:49], v3 offset:20480
    v_mfma_f32_16x16x32_bf16 v[108:111], v[252:255], v[52:55], v[108:111]
    ds_read_b64_tr_b16 v[50:51], v3 offset:21504
    s_waitcnt lgkmcnt(10)
    v_mfma_f32_16x16x32_bf16 v[112:115], v[248:251], v[56:59], v[112:115]
    ds_read_b64_tr_b16 v[52:53], v4 offset:20480
    v_mfma_f32_16x16x32_bf16 v[116:119], v[252:255], v[56:59], v[116:119]
    ds_read_b64_tr_b16 v[54:55], v4 offset:21504
    v_mfma_f32_16x16x32_bf16 v[120:123], v[248:251], v[60:63], v[120:123]
    ds_read_b64_tr_b16 v[56:57], v5 offset:20480
    v_mfma_f32_16x16x32_bf16 v[124:127], v[252:255], v[60:63], v[124:127]
    ds_read_b64_tr_b16 v[58:59], v5 offset:21504
    s_waitcnt vmcnt(14) lgkmcnt(10)
    v_mfma_f32_16x16x32_bf16 v[64:67], v[32:35], v[160:163], v[64:67]
    ds_read_b64_tr_b16 v[60:61], v6 offset:20480
    v_mfma_f32_16x16x32_bf16 v[68:71], v[32:35], v[164:167], v[68:71]
    ds_read_b64_tr_b16 v[62:63], v6 offset:21504
    v_mfma_f32_16x16x32_bf16 v[72:75], v[36:39], v[160:163], v[72:75]
    ds_read_b64_tr_b16 v[32:33], v3 offset:24576
    v_mfma_f32_16x16x32_bf16 v[76:79], v[36:39], v[164:167], v[76:79]
    ds_read_b64_tr_b16 v[34:35], v3 offset:25600
    s_waitcnt lgkmcnt(10)
    v_mfma_f32_16x16x32_bf16 v[80:83], v[40:43], v[160:163], v[80:83]
    ds_read_b64_tr_b16 v[36:37], v4 offset:24576
    v_mfma_f32_16x16x32_bf16 v[84:87], v[40:43], v[164:167], v[84:87]
    ds_read_b64_tr_b16 v[38:39], v4 offset:25600
    v_mfma_f32_16x16x32_bf16 v[88:91], v[44:47], v[160:163], v[88:91]
    ds_read_b64_tr_b16 v[40:41], v5 offset:24576
    v_mfma_f32_16x16x32_bf16 v[92:95], v[44:47], v[164:167], v[92:95]
    ds_read_b64_tr_b16 v[42:43], v5 offset:25600
    s_waitcnt vmcnt(12) lgkmcnt(10)
    v_mfma_f32_16x16x32_bf16 v[64:67], v[48:51], v[168:171], v[64:67]
    ds_read_b64_tr_b16 v[44:45], v6 offset:24576
    v_mfma_f32_16x16x32_bf16 v[68:71], v[48:51], v[172:175], v[68:71]
    ds_read_b64_tr_b16 v[46:47], v6 offset:25600
    v_mfma_f32_16x16x32_bf16 v[72:75], v[52:55], v[168:171], v[72:75]
    ds_read_b64_tr_b16 v[48:49], v3 offset:28672
    v_mfma_f32_16x16x32_bf16 v[76:79], v[52:55], v[172:175], v[76:79]
    ds_read_b64_tr_b16 v[50:51], v3 offset:29696
    s_waitcnt lgkmcnt(10)
    v_mfma_f32_16x16x32_bf16 v[80:83], v[56:59], v[168:171], v[80:83]
    ds_read_b64_tr_b16 v[52:53], v4 offset:28672
    v_mfma_f32_16x16x32_bf16 v[84:87], v[56:59], v[172:175], v[84:87]
    ds_read_b64_tr_b16 v[54:55], v4 offset:29696
    v_mfma_f32_16x16x32_bf16 v[88:91], v[60:63], v[168:171], v[88:91]
    ds_read_b64_tr_b16 v[56:57], v5 offset:28672
    v_mfma_f32_16x16x32_bf16 v[92:95], v[60:63], v[172:175], v[92:95]
    ds_read_b64_tr_b16 v[58:59], v5 offset:29696
    s_waitcnt vmcnt(10) lgkmcnt(10)
    v_mfma_f32_16x16x32_bf16 v[64:67], v[32:35], v[176:179], v[64:67]
    ds_read_b64_tr_b16 v[60:61], v6 offset:28672
    v_mfma_f32_16x16x32_bf16 v[68:71], v[32:35], v[180:183], v[68:71]
    ds_read_b64_tr_b16 v[62:63], v6 offset:29696
    s_barrier
    v_mfma_f32_16x16x32_bf16 v[72:75], v[36:39], v[176:179], v[72:75]
    ds_read_b64_tr_b16 v[32:33], v3 offset:32768
    v_mfma_f32_16x16x32_bf16 v[76:79], v[36:39], v[180:183], v[76:79]
    ds_read_b64_tr_b16 v[34:35], v3 offset:33792
    s_waitcnt lgkmcnt(10)
    v_mfma_f32_16x16x32_bf16 v[80:83], v[40:43], v[176:179], v[80:83]
    ds_read_b64_tr_b16 v[36:37], v4 offset:32768
    v_mfma_f32_16x16x32_bf16 v[84:87], v[40:43], v[180:183], v[84:87]
    ds_read_b64_tr_b16 v[38:39], v4 offset:33792
    v_mfma_f32_16x16x32_bf16 v[88:91], v[44:47], v[176:179], v[88:91]
    ds_read_b64_tr_b16 v[40:41], v5 offset:32768
    v_mfma_f32_16x16x32_bf16 v[92:95], v[44:47], v[180:183], v[92:95]
    ds_read_b64_tr_b16 v[42:43], v5 offset:33792
    s_waitcnt vmcnt(8) lgkmcnt(10)
    v_mfma_f32_16x16x32_bf16 v[64:67], v[48:51], v[184:187], v[64:67]
    ds_read_b64_tr_b16 v[44:45], v6 offset:32768
    v_mfma_f32_16x16x32_bf16 v[68:71], v[48:51], v[188:191], v[68:71]
    ds_read_b64_tr_b16 v[46:47], v6 offset:33792
    v_mfma_f32_16x16x32_bf16 v[72:75], v[52:55], v[184:187], v[72:75]
    ds_read_b64_tr_b16 v[48:49], v3 offset:36864
    v_mfma_f32_16x16x32_bf16 v[76:79], v[52:55], v[188:191], v[76:79]
    ds_read_b64_tr_b16 v[50:51], v3 offset:37888
    s_waitcnt lgkmcnt(10)
    v_mfma_f32_16x16x32_bf16 v[80:83], v[56:59], v[184:187], v[80:83]
    ds_read_b64_tr_b16 v[52:53], v4 offset:36864
    v_mfma_f32_16x16x32_bf16 v[84:87], v[56:59], v[188:191], v[84:87]
    ds_read_b64_tr_b16 v[54:55], v4 offset:37888
    v_mfma_f32_16x16x32_bf16 v[88:91], v[60:63], v[184:187], v[88:91]
    ds_read_b64_tr_b16 v[56:57], v5 offset:36864
    v_mfma_f32_16x16x32_bf16 v[92:95], v[60:63], v[188:191], v[92:95]
    ds_read_b64_tr_b16 v[58:59], v5 offset:37888
    s_waitcnt vmcnt(6) lgkmcnt(10)
    v_mfma_f32_16x16x32_bf16 v[64:67], v[32:35], v[192:195], v[64:67]
    ds_read_b64_tr_b16 v[60:61], v6 offset:36864
    v_mfma_f32_16x16x32_bf16 v[68:71], v[32:35], v[196:199], v[68:71]
    ds_read_b64_tr_b16 v[62:63], v6 offset:37888
    v_mfma_f32_16x16x32_bf16 v[72:75], v[36:39], v[192:195], v[72:75]
    ds_read_b64_tr_b16 v[32:33], v3 offset:40960
    v_mfma_f32_16x16x32_bf16 v[76:79], v[36:39], v[196:199], v[76:79]
    ds_read_b64_tr_b16 v[34:35], v3 offset:41984
    s_waitcnt lgkmcnt(10)
    v_mfma_f32_16x16x32_bf16 v[80:83], v[40:43], v[192:195], v[80:83]
    ds_read_b64_tr_b16 v[36:37], v4 offset:40960
    v_mfma_f32_16x16x32_bf16 v[84:87], v[40:43], v[196:199], v[84:87]
    ds_read_b64_tr_b16 v[38:39], v4 offset:41984
    v_mfma_f32_16x16x32_bf16 v[88:91], v[44:47], v[192:195], v[88:91]
    ds_read_b64_tr_b16 v[40:41], v5 offset:40960
    v_mfma_f32_16x16x32_bf16 v[92:95], v[44:47], v[196:199], v[92:95]
    ds_read_b64_tr_b16 v[42:43], v5 offset:41984
    s_waitcnt vmcnt(4) lgkmcnt(10)
    v_mfma_f32_16x16x32_bf16 v[64:67], v[48:51], v[200:203], v[64:67]
    ds_read_b64_tr_b16 v[44:45], v6 offset:40960
    v_mfma_f32_16x16x32_bf16 v[68:71], v[48:51], v[204:207], v[68:71]
    ds_read_b64_tr_b16 v[46:47], v6 offset:41984
    v_mfma_f32_16x16x32_bf16 v[72:75], v[52:55], v[200:203], v[72:75]
    ds_read_b64_tr_b16 v[48:49], v3 offset:45056
    v_mfma_f32_16x16x32_bf16 v[76:79], v[52:55], v[204:207], v[76:79]
    ds_read_b64_tr_b16 v[50:51], v3 offset:46080
    s_waitcnt lgkmcnt(10)
    v_mfma_f32_16x16x32_bf16 v[80:83], v[56:59], v[200:203], v[80:83]
    ds_read_b64_tr_b16 v[52:53], v4 offset:45056
    v_mfma_f32_16x16x32_bf16 v[84:87], v[56:59], v[204:207], v[84:87]
    ds_read_b64_tr_b16 v[54:55], v4 offset:46080
    v_mfma_f32_16x16x32_bf16 v[88:91], v[60:63], v[200:203], v[88:91]
    ds_read_b64_tr_b16 v[56:57], v5 offset:45056
    v_mfma_f32_16x16x32_bf16 v[92:95], v[60:63], v[204:207], v[92:95]
    ds_read_b64_tr_b16 v[58:59], v5 offset:46080
    s_waitcnt vmcnt(2) lgkmcnt(10)
    v_mfma_f32_16x16x32_bf16 v[64:67], v[32:35], v[208:211], v[64:67]
    ds_read_b64_tr_b16 v[60:61], v6 offset:45056
    v_mfma_f32_16x16x32_bf16 v[68:71], v[32:35], v[212:215], v[68:71]
    ds_read_b64_tr_b16 v[62:63], v6 offset:46080
    v_mfma_f32_16x16x32_bf16 v[72:75], v[36:39], v[208:211], v[72:75]
    ds_read_b64_tr_b16 v[32:33], v3 offset:49152
    ds_read_b32 v8, v9 offset:4096
    v_mfma_f32_16x16x32_bf16 v[76:79], v[36:39], v[212:215], v[76:79]
    ds_read_b64_tr_b16 v[34:35], v3 offset:50176
    ds_read_b32 v10, v9 offset:4608
    s_waitcnt lgkmcnt(12)
    v_mfma_f32_16x16x32_bf16 v[80:83], v[40:43], v[208:211], v[80:83]
    ds_read_b64_tr_b16 v[36:37], v4 offset:49152
    ds_read_b32 v12, v9 offset:4160
    v_mfma_f32_16x16x32_bf16 v[84:87], v[40:43], v[212:215], v[84:87]
    ds_read_b64_tr_b16 v[38:39], v4 offset:50176
    ds_read_b32 v14, v9 offset:4672
    v_mfma_f32_16x16x32_bf16 v[88:91], v[44:47], v[208:211], v[88:91]
    ds_read_b64_tr_b16 v[40:41], v5 offset:49152
    ds_read_b128 v[16:19], v11 offset:256
    v_mfma_f32_16x16x32_bf16 v[92:95], v[44:47], v[212:215], v[92:95]
    ds_read_b64_tr_b16 v[42:43], v5 offset:50176
    ds_read_b128 v[20:23], v11 offset:320
    s_waitcnt vmcnt(0) lgkmcnt(14)
    v_mfma_f32_16x16x32_bf16 v[64:67], v[48:51], v[216:219], v[64:67]
    ds_read_b64_tr_b16 v[44:45], v6 offset:49152
    ds_read_b128 v[24:27], v11 offset:384
    v_mfma_f32_16x16x32_bf16 v[68:71], v[48:51], v[220:223], v[68:71]
    ds_read_b64_tr_b16 v[46:47], v6 offset:50176
    ds_read_b128 v[28:31], v11 offset:448
    v_mfma_f32_16x16x32_bf16 v[72:75], v[52:55], v[216:219], v[72:75]
    ds_read_b64_tr_b16 v[48:49], v3 offset:53248
    v_mfma_f32_16x16x32_bf16 v[76:79], v[52:55], v[220:223], v[76:79]
    ds_read_b64_tr_b16 v[50:51], v3 offset:54272
    s_waitcnt lgkmcnt(14)
    v_mfma_f32_16x16x32_bf16 v[80:83], v[56:59], v[216:219], v[80:83]
    ds_read_b64_tr_b16 v[52:53], v4 offset:53248
    v_mfma_f32_16x16x32_bf16 v[84:87], v[56:59], v[220:223], v[84:87]
    ds_read_b64_tr_b16 v[54:55], v4 offset:54272
    v_mfma_f32_16x16x32_bf16 v[88:91], v[60:63], v[216:219], v[88:91]
    ds_read_b64_tr_b16 v[56:57], v5 offset:53248
    v_mfma_f32_16x16x32_bf16 v[92:95], v[60:63], v[220:223], v[92:95]
    ds_read_b64_tr_b16 v[58:59], v5 offset:54272
    s_bitcmp1_b32 s21, 0
    s_cbranch_scc1 c_B
    v_add_u32 v7, s62, v1
    s_waitcnt lgkmcnt(6)
    v_pk_fma_f32 v[68:69], v[12:13], v[16:17], v[68:69] op_sel_hi:[0,1,1] neg_lo:[1,0,0] neg_hi:[1,0,0]
    v_pk_fma_f32 v[70:71], v[12:13], v[18:19], v[70:71] op_sel_hi:[0,1,1] neg_lo:[1,0,0] neg_hi:[1,0,0]
    v_pk_fma_f32 v[76:77], v[12:13], v[20:21], v[76:77] op_sel_hi:[0,1,1] neg_lo:[1,0,0] neg_hi:[1,0,0]
    v_pk_fma_f32 v[78:79], v[12:13], v[22:23], v[78:79] op_sel_hi:[0,1,1] neg_lo:[1,0,0] neg_hi:[1,0,0]
    v_pk_mul_f32 v[68:69], v[14:15], v[68:69] op_sel_hi:[0,1]
    v_pk_mul_f32 v[70:71], v[14:15], v[70:71] op_sel_hi:[0,1]
    v_pk_mul_f32 v[76:77], v[14:15], v[76:77] op_sel_hi:[0,1]
    v_pk_mul_f32 v[78:79], v[14:15], v[78:79] op_sel_hi:[0,1]
    v_cvt_pk_bf16_f32 v68, v68, v69
    v_cvt_pk_bf16_f32 v69, v70, v71
    v_cvt_pk_bf16_f32 v70, v76, v77
    v_cvt_pk_bf16_f32 v71, v78, v79
    ds_write_b128 v7, v[68:71] offset:4096
    v_pk_fma_f32 v[64:65], v[8:9], v[16:17], v[64:65] op_sel_hi:[0,1,1] neg_lo:[1,0,0] neg_hi:[1,0,0]
    v_pk_fma_f32 v[66:67], v[8:9], v[18:19], v[66:67] op_sel_hi:[0,1,1] neg_lo:[1,0,0] neg_hi:[1,0,0]
    v_pk_fma_f32 v[72:73], v[8:9], v[20:21], v[72:73] op_sel_hi:[0,1,1] neg_lo:[1,0,0] neg_hi:[1,0,0]
    v_pk_fma_f32 v[74:75], v[8:9], v[22:23], v[74:75] op_sel_hi:[0,1,1] neg_lo:[1,0,0] neg_hi:[1,0,0]
    v_pk_mul_f32 v[64:65], v[10:11], v[64:65] op_sel_hi:[0,1]
    v_pk_mul_f32 v[66:67], v[10:11], v[66:67] op_sel_hi:[0,1]
    v_pk_mul_f32 v[72:73], v[10:11], v[72:73] op_sel_hi:[0,1]
    v_pk_mul_f32 v[74:75], v[10:11], v[74:75] op_sel_hi:[0,1]
    v_cvt_pk_bf16_f32 v64, v64, v65
    v_cvt_pk_bf16_f32 v65, v66, v67
    v_cvt_pk_bf16_f32 v66, v72, v73
    v_cvt_pk_bf16_f32 v67, v74, v75
    v_pk_fma_f32 v[84:85], v[12:13], v[24:25], v[84:85] op_sel_hi:[0,1,1] neg_lo:[1,0,0] neg_hi:[1,0,0]
    v_pk_fma_f32 v[86:87], v[12:13], v[26:27], v[86:87] op_sel_hi:[0,1,1] neg_lo:[1,0,0] neg_hi:[1,0,0]
    v_pk_fma_f32 v[92:93], v[12:13], v[28:29], v[92:93] op_sel_hi:[0,1,1] neg_lo:[1,0,0] neg_hi:[1,0,0]
    v_pk_fma_f32 v[94:95], v[12:13], v[30:31], v[94:95] op_sel_hi:[0,1,1] neg_lo:[1,0,0] neg_hi:[1,0,0]
    v_pk_mul_f32 v[84:85], v[14:15], v[84:85] op_sel_hi:[0,1]
    v_pk_mul_f32 v[86:87], v[14:15], v[86:87] op_sel_hi:[0,1]
    v_pk_mul_f32 v[92:93], v[14:15], v[92:93] op_sel_hi:[0,1]
    v_pk_mul_f32 v[94:95], v[14:15], v[94:95] op_sel_hi:[0,1]
    v_cvt_pk_bf16_f32 v84, v84, v85
    v_cvt_pk_bf16_f32 v85, v86, v87
    v_cvt_pk_bf16_f32 v86, v92, v93
    v_cvt_pk_bf16_f32 v87, v94, v95
    ds_write_b128 v7, v[84:87] offset:5120
    v_pk_fma_f32 v[80:81], v[8:9], v[24:25], v[80:81] op_sel_hi:[0,1,1] neg_lo:[1,0,0] neg_hi:[1,0,0]
    v_pk_fma_f32 v[82:83], v[8:9], v[26:27], v[82:83] op_sel_hi:[0,1,1] neg_lo:[1,0,0] neg_hi:[1,0,0]
    v_pk_fma_f32 v[88:89], v[8:9], v[28:29], v[88:89] op_sel_hi:[0,1,1] neg_lo:[1,0,0] neg_hi:[1,0,0]
    v_pk_fma_f32 v[90:91], v[8:9], v[30:31], v[90:91] op_sel_hi:[0,1,1] neg_lo:[1,0,0] neg_hi:[1,0,0]
    v_pk_mul_f32 v[80:81], v[10:11], v[80:81] op_sel_hi:[0,1]
    v_pk_mul_f32 v[82:83], v[10:11], v[82:83] op_sel_hi:[0,1]
    v_pk_mul_f32 v[88:89], v[10:11], v[88:89] op_sel_hi:[0,1]
    v_pk_mul_f32 v[90:91], v[10:11], v[90:91] op_sel_hi:[0,1]
    v_cvt_pk_bf16_f32 v80, v80, v81
    v_cvt_pk_bf16_f32 v81, v82, v83
    v_cvt_pk_bf16_f32 v82, v88, v89
    v_cvt_pk_bf16_f32 v83, v90, v91
    v_mfma_f32_16x16x32_bf16 v[96:99], v[160:163], v[32:35], v[96:99]
    ds_read_b64_tr_b16 v[60:61], v6 offset:53248
    v_mfma_f32_16x16x32_bf16 v[100:103], v[164:167], v[32:35], v[100:103]
    ds_read_b64_tr_b16 v[62:63], v6 offset:54272
    v_mfma_f32_16x16x32_bf16 v[104:107], v[160:163], v[36:39], v[104:107]
    ds_read_b64_tr_b16 v[32:33], v3 offset:57344
    v_mfma_f32_16x16x32_bf16 v[108:111], v[164:167], v[36:39], v[108:111]
    ds_read_b64_tr_b16 v[34:35], v3 offset:58368
    v_mfma_f32_16x16x32_bf16 v[112:115], v[160:163], v[40:43], v[112:115]
    ds_read_b64_tr_b16 v[36:37], v4 offset:57344
    v_mfma_f32_16x16x32_bf16 v[116:119], v[164:167], v[40:43], v[116:119]
    ds_read_b64_tr_b16 v[38:39], v4 offset:58368
    v_mfma_f32_16x16x32_bf16 v[120:123], v[160:163], v[44:47], v[120:123]
    ds_read_b64_tr_b16 v[40:41], v5 offset:57344
    v_mfma_f32_16x16x32_bf16 v[124:127], v[164:167], v[44:47], v[124:127]
    ds_read_b64_tr_b16 v[42:43], v5 offset:58368
    s_waitcnt lgkmcnt(12)
    v_mfma_f32_16x16x32_bf16 v[96:99], v[168:171], v[48:51], v[96:99]
    ds_read_b64_tr_b16 v[44:45], v6 offset:57344
    v_mfma_f32_16x16x32_bf16 v[100:103], v[172:175], v[48:51], v[100:103]
    ds_read_b64_tr_b16 v[46:47], v6 offset:58368
    v_mfma_f32_16x16x32_bf16 v[104:107], v[168:171], v[52:55], v[104:107]
    ds_read_b64_tr_b16 v[48:49], v3 offset:61440
    v_mfma_f32_16x16x32_bf16 v[108:111], v[172:175], v[52:55], v[108:111]
    ds_read_b64_tr_b16 v[50:51], v3 offset:62464
    s_waitcnt lgkmcnt(10)
    v_mfma_f32_16x16x32_bf16 v[112:115], v[168:171], v[56:59], v[112:115]
    ds_read_b64_tr_b16 v[52:53], v4 offset:61440
    v_mfma_f32_16x16x32_bf16 v[116:119], v[172:175], v[56:59], v[116:119]
    ds_read_b64_tr_b16 v[54:55], v4 offset:62464
    v_mfma_f32_16x16x32_bf16 v[120:123], v[168:171], v[60:63], v[120:123]
    ds_read_b64_tr_b16 v[56:57], v5 offset:61440
    v_mfma_f32_16x16x32_bf16 v[124:127], v[172:175], v[60:63], v[124:127]
    ds_read_b64_tr_b16 v[58:59], v5 offset:62464
    s_waitcnt lgkmcnt(10)
    v_mfma_f32_16x16x32_bf16 v[96:99], v[176:179], v[32:35], v[96:99]
    ds_read_b64_tr_b16 v[60:61], v6 offset:61440
    v_mfma_f32_16x16x32_bf16 v[100:103], v[180:183], v[32:35], v[100:103]
    ds_read_b64_tr_b16 v[62:63], v6 offset:62464
    s_barrier
    v_xor_b32 v3, 0x10000, v3
    v_xor_b32 v4, 0x10000, v4
    v_xor_b32 v5, 0x10000, v5
    v_xor_b32 v6, 0x10000, v6
    v_mfma_f32_16x16x32_bf16 v[104:107], v[176:179], v[36:39], v[104:107]
    ds_read_b64_tr_b16 v[32:33], v3 offset:0
    v_mfma_f32_16x16x32_bf16 v[108:111], v[180:183], v[36:39], v[108:111]
    ds_read_b64_tr_b16 v[34:35], v3 offset:1024
    s_waitcnt lgkmcnt(10)
    v_mfma_f32_16x16x32_bf16 v[112:115], v[176:179], v[40:43], v[112:115]
    ds_read_b64_tr_b16 v[36:37], v4 offset:0
    v_mfma_f32_16x16x32_bf16 v[116:119], v[180:183], v[40:43], v[116:119]
    ds_read_b64_tr_b16 v[38:39], v4 offset:1024
    v_mfma_f32_16x16x32_bf16 v[120:123], v[176:179], v[44:47], v[120:123]
    ds_read_b64_tr_b16 v[40:41], v5 offset:0
    v_mfma_f32_16x16x32_bf16 v[124:127], v[180:183], v[44:47], v[124:127]
    ds_read_b64_tr_b16 v[42:43], v5 offset:1024
    s_waitcnt lgkmcnt(10)
    v_mfma_f32_16x16x32_bf16 v[96:99], v[184:187], v[48:51], v[96:99]
    ds_read_b64_tr_b16 v[44:45], v6 offset:0
    v_mfma_f32_16x16x32_bf16 v[100:103], v[188:191], v[48:51], v[100:103]
    ds_read_b64_tr_b16 v[46:47], v6 offset:1024
    v_mfma_f32_16x16x32_bf16 v[104:107], v[184:187], v[52:55], v[104:107]
    ds_read_b64_tr_b16 v[48:49], v3 offset:4096
    v_mfma_f32_16x16x32_bf16 v[108:111], v[188:191], v[52:55], v[108:111]
    ds_read_b64_tr_b16 v[50:51], v3 offset:5120
    s_waitcnt lgkmcnt(10)
    v_mfma_f32_16x16x32_bf16 v[112:115], v[184:187], v[56:59], v[112:115]
    ds_read_b64_tr_b16 v[52:53], v4 offset:4096
    v_mfma_f32_16x16x32_bf16 v[116:119], v[188:191], v[56:59], v[116:119]
    ds_read_b64_tr_b16 v[54:55], v4 offset:5120
    v_mfma_f32_16x16x32_bf16 v[120:123], v[184:187], v[60:63], v[120:123]
    ds_read_b64_tr_b16 v[56:57], v5 offset:4096
    v_mfma_f32_16x16x32_bf16 v[124:127], v[188:191], v[60:63], v[124:127]
    ds_read_b64_tr_b16 v[58:59], v5 offset:5120
    s_waitcnt lgkmcnt(10)
    v_mfma_f32_16x16x32_bf16 v[96:99], v[192:195], v[32:35], v[96:99]
    ds_read_b64_tr_b16 v[60:61], v6 offset:4096
    v_mfma_f32_16x16x32_bf16 v[100:103], v[196:199], v[32:35], v[100:103]
    ds_read_b64_tr_b16 v[62:63], v6 offset:5120
    v_mfma_f32_16x16x32_bf16 v[104:107], v[192:195], v[36:39], v[104:107]
    ds_read_b64_tr_b16 v[32:33], v3 offset:8192
    v_mfma_f32_16x16x32_bf16 v[108:111], v[196:199], v[36:39], v[108:111]
    ds_read_b64_tr_b16 v[34:35], v3 offset:9216
    s_waitcnt lgkmcnt(10)
    v_mfma_f32_16x16x32_bf16 v[112:115], v[192:195], v[40:43], v[112:115]
    ds_read_b64_tr_b16 v[36:37], v4 offset:8192
    v_mfma_f32_16x16x32_bf16 v[116:119], v[196:199], v[40:43], v[116:119]
    ds_read_b64_tr_b16 v[38:39], v4 offset:9216
    v_mfma_f32_16x16x32_bf16 v[120:123], v[192:195], v[44:47], v[120:123]
    ds_read_b64_tr_b16 v[40:41], v5 offset:8192
    v_mfma_f32_16x16x32_bf16 v[124:127], v[196:199], v[44:47], v[124:127]
    ds_read_b64_tr_b16 v[42:43], v5 offset:9216
    s_waitcnt lgkmcnt(10)
    v_mfma_f32_16x16x32_bf16 v[96:99], v[200:203], v[48:51], v[96:99]
    ds_read_b64_tr_b16 v[44:45], v6 offset:8192
    v_mfma_f32_16x16x32_bf16 v[100:103], v[204:207], v[48:51], v[100:103]
    ds_read_b64_tr_b16 v[46:47], v6 offset:9216
    v_mfma_f32_16x16x32_bf16 v[104:107], v[200:203], v[52:55], v[104:107]
    ds_read_b64_tr_b16 v[48:49], v3 offset:12288
    v_mfma_f32_16x16x32_bf16 v[108:111], v[204:207], v[52:55], v[108:111]
    ds_read_b64_tr_b16 v[50:51], v3 offset:13312
    s_waitcnt lgkmcnt(10)
    v_mfma_f32_16x16x32_bf16 v[112:115], v[200:203], v[56:59], v[112:115]
    ds_read_b64_tr_b16 v[52:53], v4 offset:12288
    v_mfma_f32_16x16x32_bf16 v[116:119], v[204:207], v[56:59], v[116:119]
    ds_read_b64_tr_b16 v[54:55], v4 offset:13312
    v_mfma_f32_16x16x32_bf16 v[120:123], v[200:203], v[60:63], v[120:123]
    ds_read_b64_tr_b16 v[56:57], v5 offset:12288
    v_mfma_f32_16x16x32_bf16 v[124:127], v[204:207], v[60:63], v[124:127]
    ds_read_b64_tr_b16 v[58:59], v5 offset:13312
    s_waitcnt lgkmcnt(10)
    v_mfma_f32_16x16x32_bf16 v[96:99], v[208:211], v[32:35], v[96:99]
    ds_read_b64_tr_b16 v[60:61], v6 offset:12288
    v_mfma_f32_16x16x32_bf16 v[100:103], v[212:215], v[32:35], v[100:103]
    ds_read_b64_tr_b16 v[62:63], v6 offset:13312
    v_mfma_f32_16x16x32_bf16 v[104:107], v[208:211], v[36:39], v[104:107]
    ds_read_b64_tr_b16 v[32:33], v3 offset:16384
    ds_read_b128 v[16:19], v13 offset:4096
    v_mfma_f32_16x16x32_bf16 v[108:111], v[212:215], v[36:39], v[108:111]
    ds_read_b64_tr_b16 v[34:35], v3 offset:17408
    ds_read_b128 v[20:23], v13 offset:4608
    s_waitcnt lgkmcnt(12)
    v_mfma_f32_16x16x32_bf16 v[112:115], v[208:211], v[40:43], v[112:115]
    ds_read_b64_tr_b16 v[36:37], v4 offset:16384
    ds_read_b128 v[24:27], v13 offset:4160
    v_mfma_f32_16x16x32_bf16 v[116:119], v[212:215], v[40:43], v[116:119]
    ds_read_b64_tr_b16 v[38:39], v4 offset:17408
    ds_read_b128 v[28:31], v13 offset:4672
    v_mfma_f32_16x16x32_bf16 v[120:123], v[208:211], v[44:47], v[120:123]
    ds_read_b64_tr_b16 v[40:41], v5 offset:16384
    ds_read_b32 v8, v15 offset:512
    v_mfma_f32_16x16x32_bf16 v[124:127], v[212:215], v[44:47], v[124:127]
    ds_read_b64_tr_b16 v[42:43], v5 offset:17408
    ds_read_b32 v10, v15 offset:576
    s_waitcnt lgkmcnt(14)
    v_mfma_f32_16x16x32_bf16 v[96:99], v[216:219], v[48:51], v[96:99]
    ds_read_b64_tr_b16 v[44:45], v6 offset:16384
    ds_read_b32 v12, v15 offset:640
    v_mfma_f32_16x16x32_bf16 v[100:103], v[220:223], v[48:51], v[100:103]
    ds_read_b64_tr_b16 v[46:47], v6 offset:17408
    ds_read_b32 v14, v15 offset:704
    v_mfma_f32_16x16x32_bf16 v[104:107], v[216:219], v[52:55], v[104:107]
    ds_read_b64_tr_b16 v[48:49], v3 offset:20480
    v_mfma_f32_16x16x32_bf16 v[108:111], v[220:223], v[52:55], v[108:111]
    ds_read_b64_tr_b16 v[50:51], v3 offset:21504
    s_waitcnt lgkmcnt(14)
    v_mfma_f32_16x16x32_bf16 v[112:115], v[216:219], v[56:59], v[112:115]
    ds_read_b64_tr_b16 v[52:53], v4 offset:20480
    v_mfma_f32_16x16x32_bf16 v[116:119], v[220:223], v[56:59], v[116:119]
    ds_read_b64_tr_b16 v[54:55], v4 offset:21504
    v_mfma_f32_16x16x32_bf16 v[120:123], v[216:219], v[60:63], v[120:123]
    ds_read_b64_tr_b16 v[56:57], v5 offset:20480
    v_mfma_f32_16x16x32_bf16 v[124:127], v[220:223], v[60:63], v[124:127]
    ds_read_b64_tr_b16 v[58:59], v5 offset:21504
    s_waitcnt lgkmcnt(6)
    v_pk_fma_f32 v[100:101], v[8:9], v[24:25], v[100:101] op_sel_hi:[0,1,1] neg_lo:[1,0,0] neg_hi:[1,0,0]
    v_pk_fma_f32 v[102:103], v[8:9], v[26:27], v[102:103] op_sel_hi:[0,1,1] neg_lo:[1,0,0] neg_hi:[1,0,0]
    v_pk_fma_f32 v[108:109], v[10:11], v[24:25], v[108:109] op_sel_hi:[0,1,1] neg_lo:[1,0,0] neg_hi:[1,0,0]
    v_pk_fma_f32 v[110:111], v[10:11], v[26:27], v[110:111] op_sel_hi:[0,1,1] neg_lo:[1,0,0] neg_hi:[1,0,0]
    v_pk_mul_f32 v[100:101], v[28:29], v[100:101]
    v_pk_mul_f32 v[102:103], v[30:31], v[102:103]
    v_pk_mul_f32 v[108:109], v[28:29], v[108:109]
    v_pk_mul_f32 v[110:111], v[30:31], v[110:111]
    v_cvt_pk_bf16_f32 v74, v100, v101
    v_cvt_pk_bf16_f32 v75, v102, v103
    v_cvt_pk_bf16_f32 v78, v108, v109
    v_cvt_pk_bf16_f32 v79, v110, v111
    v_cvt_pk_bf16_f32 v100, v100, v101
    v_cvt_pk_bf16_f32 v101, v102, v103
    v_cvt_pk_bf16_f32 v102, v108, v109
    v_cvt_pk_bf16_f32 v103, v110, v111
    ds_write_b128 v7, v[100:103] offset:6144
    v_pk_fma_f32 v[116:117], v[12:13], v[24:25], v[116:117] op_sel_hi:[0,1,1] neg_lo:[1,0,0] neg_hi:[1,0,0]
    v_pk_fma_f32 v[118:119], v[12:13], v[26:27], v[118:119] op_sel_hi:[0,1,1] neg_lo:[1,0,0] neg_hi:[1,0,0]
    v_pk_fma_f32 v[124:125], v[14:15], v[24:25], v[124:125] op_sel_hi:[0,1,1] neg_lo:[1,0,0] neg_hi:[1,0,0]
    v_pk_fma_f32 v[126:127], v[14:15], v[26:27], v[126:127] op_sel_hi:[0,1,1] neg_lo:[1,0,0] neg_hi:[1,0,0]
    v_pk_mul_f32 v[116:117], v[28:29], v[116:117]
    v_pk_mul_f32 v[118:119], v[30:31], v[118:119]
    v_pk_mul_f32 v[124:125], v[28:29], v[124:125]
    v_pk_mul_f32 v[126:127], v[30:31], v[126:127]
    v_cvt_pk_bf16_f32 v90, v116, v117
    v_cvt_pk_bf16_f32 v91, v118, v119
    v_cvt_pk_bf16_f32 v94, v124, v125
    v_cvt_pk_bf16_f32 v95, v126, v127
    v_cvt_pk_bf16_f32 v116, v116, v117
    v_cvt_pk_bf16_f32 v117, v118, v119
    v_cvt_pk_bf16_f32 v118, v124, v125
    v_cvt_pk_bf16_f32 v119, v126, v127
    ds_write_b128 v7, v[116:119] offset:7168
    s_cmp_lg_u32 s16, 3
    s_cbranch_scc1 a_nh
    buffer_store_dwordx4 v[68:71], v1, s[4:7], s60 offen offset:0 sc1
    buffer_store_dwordx4 v[84:87], v1, s[4:7], s60 offen offset:1024 sc1
    buffer_store_dwordx4 v[100:103], v1, s[4:7], s60 offen offset:2048 sc1
    buffer_store_dwordx4 v[116:119], v1, s[4:7], s60 offen offset:3072 sc1
a_nh:
    v_pk_fma_f32 v[96:97], v[8:9], v[16:17], v[96:97] op_sel_hi:[0,1,1] neg_lo:[1,0,0] neg_hi:[1,0,0]
    v_pk_fma_f32 v[98:99], v[8:9], v[18:19], v[98:99] op_sel_hi:[0,1,1] neg_lo:[1,0,0] neg_hi:[1,0,0]
    v_pk_fma_f32 v[104:105], v[10:11], v[16:17], v[104:105] op_sel_hi:[0,1,1] neg_lo:[1,0,0] neg_hi:[1,0,0]
    v_pk_fma_f32 v[106:107], v[10:11], v[18:19], v[106:107] op_sel_hi:[0,1,1] neg_lo:[1,0,0] neg_hi:[1,0,0]
    v_pk_mul_f32 v[96:97], v[20:21], v[96:97]
    v_pk_mul_f32 v[98:99], v[22:23], v[98:99]
    v_pk_mul_f32 v[104:105], v[20:21], v[104:105]
    v_pk_mul_f32 v[106:107], v[22:23], v[106:107]
    v_cvt_pk_bf16_f32 v72, v96, v97
    v_cvt_pk_bf16_f32 v73, v98, v99
    v_cvt_pk_bf16_f32 v76, v104, v105
    v_cvt_pk_bf16_f32 v77, v106, v107
    v_pk_fma_f32 v[112:113], v[12:13], v[16:17], v[112:113] op_sel_hi:[0,1,1] neg_lo:[1,0,0] neg_hi:[1,0,0]
    v_pk_fma_f32 v[114:115], v[12:13], v[18:19], v[114:115] op_sel_hi:[0,1,1] neg_lo:[1,0,0] neg_hi:[1,0,0]
    v_pk_fma_f32 v[120:121], v[14:15], v[16:17], v[120:121] op_sel_hi:[0,1,1] neg_lo:[1,0,0] neg_hi:[1,0,0]
    v_pk_fma_f32 v[122:123], v[14:15], v[18:19], v[122:123] op_sel_hi:[0,1,1] neg_lo:[1,0,0] neg_hi:[1,0,0]
    v_pk_mul_f32 v[112:113], v[20:21], v[112:113]
    v_pk_mul_f32 v[114:115], v[22:23], v[114:115]
    v_pk_mul_f32 v[120:121], v[20:21], v[120:121]
    v_pk_mul_f32 v[122:123], v[22:23], v[122:123]
    v_cvt_pk_bf16_f32 v88, v112, v113
    v_cvt_pk_bf16_f32 v89, v114, v115
    v_cvt_pk_bf16_f32 v92, v120, v121
    v_cvt_pk_bf16_f32 v93, v122, v123
    v_mfma_f32_16x16x32_bf16 v[128:131], v[32:35], v[224:227], v[128:131]
    ds_read_b64_tr_b16 v[60:61], v6 offset:20480
    v_mfma_f32_16x16x32_bf16 v[132:135], v[32:35], v[228:231], v[132:135]
    ds_read_b64_tr_b16 v[62:63], v6 offset:21504
    v_mfma_f32_16x16x32_bf16 v[136:139], v[36:39], v[224:227], v[136:139]
    ds_read_b64_tr_b16 v[32:33], v3 offset:24576
    v_mfma_f32_16x16x32_bf16 v[140:143], v[36:39], v[228:231], v[140:143]
    ds_read_b64_tr_b16 v[34:35], v3 offset:25600
    v_mfma_f32_16x16x32_bf16 v[144:147], v[40:43], v[224:227], v[144:147]
    ds_read_b64_tr_b16 v[36:37], v4 offset:24576
    v_mfma_f32_16x16x32_bf16 v[148:151], v[40:43], v[228:231], v[148:151]
    ds_read_b64_tr_b16 v[38:39], v4 offset:25600
    v_mfma_f32_16x16x32_bf16 v[152:155], v[44:47], v[224:227], v[152:155]
    ds_read_b64_tr_b16 v[40:41], v5 offset:24576
    v_mfma_f32_16x16x32_bf16 v[156:159], v[44:47], v[228:231], v[156:159]
    ds_read_b64_tr_b16 v[42:43], v5 offset:25600
    s_waitcnt lgkmcnt(12)
    v_mfma_f32_16x16x32_bf16 v[128:131], v[48:51], v[232:235], v[128:131]
    ds_read_b64_tr_b16 v[44:45], v6 offset:24576
    v_mfma_f32_16x16x32_bf16 v[132:135], v[48:51], v[236:239], v[132:135]
    ds_read_b64_tr_b16 v[46:47], v6 offset:25600
    v_mfma_f32_16x16x32_bf16 v[136:139], v[52:55], v[232:235], v[136:139]
    ds_read_b64_tr_b16 v[48:49], v3 offset:28672
    v_mfma_f32_16x16x32_bf16 v[140:143], v[52:55], v[236:239], v[140:143]
    ds_read_b64_tr_b16 v[50:51], v3 offset:29696
    s_waitcnt lgkmcnt(10)
    v_mfma_f32_16x16x32_bf16 v[144:147], v[56:59], v[232:235], v[144:147]
    ds_read_b64_tr_b16 v[52:53], v4 offset:28672
    v_mfma_f32_16x16x32_bf16 v[148:151], v[56:59], v[236:239], v[148:151]
    ds_read_b64_tr_b16 v[54:55], v4 offset:29696
    v_mfma_f32_16x16x32_bf16 v[152:155], v[60:63], v[232:235], v[152:155]
    ds_read_b64_tr_b16 v[56:57], v5 offset:28672
    v_mfma_f32_16x16x32_bf16 v[156:159], v[60:63], v[236:239], v[156:159]
    ds_read_b64_tr_b16 v[58:59], v5 offset:29696
    s_waitcnt lgkmcnt(10)
    v_mfma_f32_16x16x32_bf16 v[128:131], v[32:35], v[240:243], v[128:131]
    ds_read_b64_tr_b16 v[60:61], v6 offset:28672
    v_mfma_f32_16x16x32_bf16 v[132:135], v[32:35], v[244:247], v[132:135]
    ds_read_b64_tr_b16 v[62:63], v6 offset:29696
    s_barrier
    v_mfma_f32_16x16x32_bf16 v[136:139], v[36:39], v[240:243], v[136:139]
    ds_read_b64_tr_b16 v[32:33], v3 offset:32768
    v_mfma_f32_16x16x32_bf16 v[140:143], v[36:39], v[244:247], v[140:143]
    ds_read_b64_tr_b16 v[34:35], v3 offset:33792
    s_waitcnt lgkmcnt(10)
    v_mfma_f32_16x16x32_bf16 v[144:147], v[40:43], v[240:243], v[144:147]
    ds_read_b64_tr_b16 v[36:37], v4 offset:32768
    v_mfma_f32_16x16x32_bf16 v[148:151], v[40:43], v[244:247], v[148:151]
    ds_read_b64_tr_b16 v[38:39], v4 offset:33792
    v_mfma_f32_16x16x32_bf16 v[152:155], v[44:47], v[240:243], v[152:155]
    ds_read_b64_tr_b16 v[40:41], v5 offset:32768
    v_mfma_f32_16x16x32_bf16 v[156:159], v[44:47], v[244:247], v[156:159]
    ds_read_b64_tr_b16 v[42:43], v5 offset:33792
    s_waitcnt lgkmcnt(10)
    v_mfma_f32_16x16x32_bf16 v[128:131], v[48:51], v[248:251], v[128:131]
    ds_read_b64_tr_b16 v[44:45], v6 offset:32768
    v_mfma_f32_16x16x32_bf16 v[132:135], v[48:51], v[252:255], v[132:135]
    ds_read_b64_tr_b16 v[46:47], v6 offset:33792
    v_mfma_f32_16x16x32_bf16 v[136:139], v[52:55], v[248:251], v[136:139]
    ds_read_b64_tr_b16 v[48:49], v3 offset:36864
    v_mfma_f32_16x16x32_bf16 v[140:143], v[52:55], v[252:255], v[140:143]
    ds_read_b64_tr_b16 v[50:51], v3 offset:37888
    s_waitcnt lgkmcnt(10)
    v_mfma_f32_16x16x32_bf16 v[144:147], v[56:59], v[248:251], v[144:147]
    ds_read_b64_tr_b16 v[52:53], v4 offset:36864
    v_mfma_f32_16x16x32_bf16 v[148:151], v[56:59], v[252:255], v[148:151]
    ds_read_b64_tr_b16 v[54:55], v4 offset:37888
    v_mfma_f32_16x16x32_bf16 v[152:155], v[60:63], v[248:251], v[152:155]
    ds_read_b64_tr_b16 v[56:57], v5 offset:36864
    v_mfma_f32_16x16x32_bf16 v[156:159], v[60:63], v[252:255], v[156:159]
    ds_read_b64_tr_b16 v[58:59], v5 offset:37888
    s_waitcnt lgkmcnt(10)
    v_mfma_f32_16x16x32_bf16 v[128:131], v[32:35], v[160:163], v[128:131]
    ds_read_b64_tr_b16 v[60:61], v6 offset:36864
    v_mfma_f32_16x16x32_bf16 v[132:135], v[32:35], v[164:167], v[132:135]
    ds_read_b64_tr_b16 v[62:63], v6 offset:37888
    v_mfma_f32_16x16x32_bf16 v[136:139], v[36:39], v[160:163], v[136:139]
    ds_read_b64_tr_b16 v[32:33], v3 offset:40960
    v_mfma_f32_16x16x32_bf16 v[140:143], v[36:39], v[164:167], v[140:143]
    ds_read_b64_tr_b16 v[34:35], v3 offset:41984
    s_waitcnt lgkmcnt(10)
    v_mfma_f32_16x16x32_bf16 v[144:147], v[40:43], v[160:163], v[144:147]
    ds_read_b64_tr_b16 v[36:37], v4 offset:40960
    v_mfma_f32_16x16x32_bf16 v[148:151], v[40:43], v[164:167], v[148:151]
    ds_read_b64_tr_b16 v[38:39], v4 offset:41984
    v_mfma_f32_16x16x32_bf16 v[152:155], v[44:47], v[160:163], v[152:155]
    ds_read_b64_tr_b16 v[40:41], v5 offset:40960
    v_mfma_f32_16x16x32_bf16 v[156:159], v[44:47], v[164:167], v[156:159]
    ds_read_b64_tr_b16 v[42:43], v5 offset:41984
    s_waitcnt lgkmcnt(10)
    v_mfma_f32_16x16x32_bf16 v[128:131], v[48:51], v[168:171], v[128:131]
    ds_read_b64_tr_b16 v[44:45], v6 offset:40960
    s_cmp_lg_u32 s16, 3
    s_cbranch_scc1 a_nopub
    s_waitcnt vmcnt(0)
    s_atomic_add s40, s[22:23], s61
a_nopub:
    v_mfma_f32_16x16x32_bf16 v[132:135], v[48:51], v[172:175], v[132:135]
    ds_read_b64_tr_b16 v[46:47], v6 offset:41984
    v_mfma_f32_16x16x32_bf16 v[136:139], v[52:55], v[168:171], v[136:139]
    ds_read_b64_tr_b16 v[48:49], v3 offset:45056
    v_mfma_f32_16x16x32_bf16 v[140:143], v[52:55], v[172:175], v[140:143]
    ds_read_b64_tr_b16 v[50:51], v3 offset:46080
    s_waitcnt lgkmcnt(10)
    v_mfma_f32_16x16x32_bf16 v[144:147], v[56:59], v[168:171], v[144:147]
    ds_read_b64_tr_b16 v[52:53], v4 offset:45056
    v_mfma_f32_16x16x32_bf16 v[148:151], v[56:59], v[172:175], v[148:151]
    ds_read_b64_tr_b16 v[54:55], v4 offset:46080
    v_mfma_f32_16x16x32_bf16 v[152:155], v[60:63], v[168:171], v[152:155]
    ds_read_b64_tr_b16 v[56:57], v5 offset:45056
    v_mfma_f32_16x16x32_bf16 v[156:159], v[60:63], v[172:175], v[156:159]
    ds_read_b64_tr_b16 v[58:59], v5 offset:46080
    s_waitcnt lgkmcnt(10)
    v_mfma_f32_16x16x32_bf16 v[128:131], v[32:35], v[176:179], v[128:131]
    ds_read_b64_tr_b16 v[60:61], v6 offset:45056
    v_mfma_f32_16x16x32_bf16 v[132:135], v[32:35], v[180:183], v[132:135]
    ds_read_b64_tr_b16 v[62:63], v6 offset:46080
    v_mfma_f32_16x16x32_bf16 v[136:139], v[36:39], v[176:179], v[136:139]
    ds_read_b64_tr_b16 v[32:33], v3 offset:49152
    v_mfma_f32_16x16x32_bf16 v[140:143], v[36:39], v[180:183], v[140:143]
    ds_read_b64_tr_b16 v[34:35], v3 offset:50176
    s_waitcnt lgkmcnt(10)
    v_mfma_f32_16x16x32_bf16 v[144:147], v[40:43], v[176:179], v[144:147]
    ds_read_b64_tr_b16 v[36:37], v4 offset:49152
    v_mfma_f32_16x16x32_bf16 v[148:151], v[40:43], v[180:183], v[148:151]
    ds_read_b64_tr_b16 v[38:39], v4 offset:50176
    v_mfma_f32_16x16x32_bf16 v[152:155], v[44:47], v[176:179], v[152:155]
    ds_read_b64_tr_b16 v[40:41], v5 offset:49152
    v_mfma_f32_16x16x32_bf16 v[156:159], v[44:47], v[180:183], v[156:159]
    ds_read_b64_tr_b16 v[42:43], v5 offset:50176
    s_waitcnt lgkmcnt(10)
    v_mfma_f32_16x16x32_bf16 v[128:131], v[48:51], v[184:187], v[128:131]
    ds_read_b64_tr_b16 v[44:45], v6 offset:49152
    ds_read_b32 v8, v9 offset:4096
    v_mfma_f32_16x16x32_bf16 v[132:135], v[48:51], v[188:191], v[132:135]
    ds_read_b64_tr_b16 v[46:47], v6 offset:50176
    ds_read_b32 v10, v9 offset:4608
    v_mfma_f32_16x16x32_bf16 v[136:139], v[52:55], v[184:187], v[136:139]
    ds_read_b64_tr_b16 v[48:49], v3 offset:53248
    ds_read_b32 v12, v9 offset:4160
    v_mfma_f32_16x16x32_bf16 v[140:143], v[52:55], v[188:191], v[140:143]
    ds_read_b64_tr_b16 v[50:51], v3 offset:54272
    ds_read_b32 v14, v9 offset:4672
    s_waitcnt lgkmcnt(14)
    v_mfma_f32_16x16x32_bf16 v[144:147], v[56:59], v[184:187], v[144:147]
    ds_read_b64_tr_b16 v[52:53], v4 offset:53248
    ds_read_b128 v[16:19], v11 offset:0
    v_mfma_f32_16x16x32_bf16 v[148:151], v[56:59], v[188:191], v[148:151]
    ds_read_b64_tr_b16 v[54:55], v4 offset:54272
    ds_read_b128 v[20:23], v11 offset:64
    v_mfma_f32_16x16x32_bf16 v[152:155], v[60:63], v[184:187], v[152:155]
    ds_read_b64_tr_b16 v[56:57], v5 offset:53248
    ds_read_b128 v[24:27], v11 offset:128
    v_mfma_f32_16x16x32_bf16 v[156:159], v[60:63], v[188:191], v[156:159]
    ds_read_b64_tr_b16 v[58:59], v5 offset:54272
    ds_read_b128 v[28:31], v11 offset:192
    s_waitcnt lgkmcnt(14)
    v_mfma_f32_16x16x32_bf16 v[128:131], v[32:35], v[192:195], v[128:131]
    ds_read_b64_tr_b16 v[60:61], v6 offset:53248
    v_add_u32 v13, 153600, v1
    v_mfma_f32_16x16x32_bf16 v[132:135], v[32:35], v[196:199], v[132:135]
    ds_read_b64_tr_b16 v[62:63], v6 offset:54272
    v_mfma_f32_16x16x32_bf16 v[136:139], v[36:39], v[192:195], v[136:139]
    ds_read_b64_tr_b16 v[32:33], v3 offset:57344
    v_mfma_f32_16x16x32_bf16 v[140:143], v[36:39], v[196:199], v[140:143]
    ds_read_b64_tr_b16 v[34:35], v3 offset:58368
    s_waitcnt lgkmcnt(14)
    v_mfma_f32_16x16x32_bf16 v[144:147], v[40:43], v[192:195], v[144:147]
    ds_read_b64_tr_b16 v[36:37], v4 offset:57344
    v_mfma_f32_16x16x32_bf16 v[148:151], v[40:43], v[196:199], v[148:151]
    ds_read_b64_tr_b16 v[38:39], v4 offset:58368
    v_mfma_f32_16x16x32_bf16 v[152:155], v[44:47], v[192:195], v[152:155]
    ds_read_b64_tr_b16 v[40:41], v5 offset:57344
    v_mfma_f32_16x16x32_bf16 v[156:159], v[44:47], v[196:199], v[156:159]
    ds_read_b64_tr_b16 v[42:43], v5 offset:58368
    s_waitcnt lgkmcnt(13)
    v_mfma_f32_16x16x32_bf16 v[128:131], v[48:51], v[200:203], v[128:131]
    ds_read_b64_tr_b16 v[44:45], v6 offset:57344
    s_waitcnt lgkmcnt(9)
    v_mfma_f32_16x16x32_bf16 v[132:135], v[48:51], v[204:207], v[132:135]
    ds_read_b64_tr_b16 v[46:47], v6 offset:58368
    v_mul_f32 v10, 0x3e8293ee, v10
    v_mfma_f32_16x16x32_bf16 v[136:139], v[52:55], v[200:203], v[136:139]
    ds_read_b64_tr_b16 v[48:49], v3 offset:61440
    v_mul_f32 v14, 0x3e8293ee, v14
    v_mfma_f32_16x16x32_bf16 v[140:143], v[52:55], v[204:207], v[140:143]
    ds_read_b64_tr_b16 v[50:51], v3 offset:62464
    ds_read_b128 v[120:123], v13 offset:0
    s_waitcnt lgkmcnt(11)
    v_mfma_f32_16x16x32_bf16 v[144:147], v[56:59], v[200:203], v[144:147]
    ds_read_b64_tr_b16 v[52:53], v4 offset:61440
    ds_read_b128 v[124:127], v13 offset:1024
    v_mfma_f32_16x16x32_bf16 v[148:151], v[56:59], v[204:207], v[148:151]
    ds_read_b64_tr_b16 v[54:55], v4 offset:62464
    v_mfma_f32_16x16x32_bf16 v[152:155], v[60:63], v[200:203], v[152:155]
    ds_read_b64_tr_b16 v[56:57], v5 offset:61440
    v_mfma_f32_16x16x32_bf16 v[156:159], v[60:63], v[204:207], v[156:159]
    ds_read_b64_tr_b16 v[58:59], v5 offset:62464
    s_waitcnt lgkmcnt(12)
    v_mfma_f32_16x16x32_bf16 v[128:131], v[32:35], v[208:211], v[128:131]
    ds_read_b64_tr_b16 v[60:61], v6 offset:61440
    v_mfma_f32_16x16x32_bf16 v[132:135], v[32:35], v[212:215], v[132:135]
    ds_read_b64_tr_b16 v[62:63], v6 offset:62464
    v_xor_b32 v3, 0x10000, v3
    v_xor_b32 v4, 0x10000, v4
    v_xor_b32 v5, 0x10000, v5
    v_xor_b32 v6, 0x10000, v6
    v_mfma_f32_16x16x32_bf16 v[136:139], v[36:39], v[208:211], v[136:139]
    v_mfma_f32_16x16x32_bf16 v[140:143], v[36:39], v[212:215], v[140:143]
    s_waitcnt lgkmcnt(10)
    v_mfma_f32_16x16x32_bf16 v[144:147], v[40:43], v[208:211], v[144:147]
    v_mfma_f32_16x16x32_bf16 v[148:151], v[40:43], v[212:215], v[148:151]
    v_mfma_f32_16x16x32_bf16 v[152:155], v[44:47], v[208:211], v[152:155]
    v_mfma_f32_16x16x32_bf16 v[156:159], v[44:47], v[212:215], v[156:159]
    s_waitcnt lgkmcnt(4)
    v_mfma_f32_16x16x32_bf16 v[128:131], v[48:51], v[216:219], v[128:131]
    v_mfma_f32_16x16x32_bf16 v[132:135], v[48:51], v[220:223], v[132:135]
    v_mfma_f32_16x16x32_bf16 v[136:139], v[52:55], v[216:219], v[136:139]
    v_mfma_f32_16x16x32_bf16 v[140:143], v[52:55], v[220:223], v[140:143]
    s_waitcnt lgkmcnt(0)
    v_mfma_f32_16x16x32_bf16 v[144:147], v[56:59], v[216:219], v[144:147]
    v_mfma_f32_16x16x32_bf16 v[148:151], v[56:59], v[220:223], v[148:151]
    v_mfma_f32_16x16x32_bf16 v[152:155], v[60:63], v[216:219], v[152:155]
    v_mfma_f32_16x16x32_bf16 v[156:159], v[60:63], v[220:223], v[156:159]
    s_lshl_b32 s44, s21, 22
    s_lshl_b32 s45, s38, 16
    s_add_u32 s44, s44, s45
    s_lshl_b32 s45, s18, 12
    s_add_u32 s44, s44, s45
    s_add_u32 s52, s44, 16777216
    v_pk_fma_f32 v[132:133], v[12:13], v[16:17], v[132:133] op_sel_hi:[0,1,1] neg_lo:[1,0,0] neg_hi:[1,0,0]
    v_pk_fma_f32 v[134:135], v[12:13], v[18:19], v[134:135] op_sel_hi:[0,1,1] neg_lo:[1,0,0] neg_hi:[1,0,0]
    v_pk_fma_f32 v[140:141], v[12:13], v[20:21], v[140:141] op_sel_hi:[0,1,1] neg_lo:[1,0,0] neg_hi:[1,0,0]
    v_pk_fma_f32 v[142:143], v[12:13], v[22:23], v[142:143] op_sel_hi:[0,1,1] neg_lo:[1,0,0] neg_hi:[1,0,0]
    v_pk_fma_f32 v[148:149], v[12:13], v[24:25], v[148:149] op_sel_hi:[0,1,1] neg_lo:[1,0,0] neg_hi:[1,0,0]
    v_pk_fma_f32 v[150:151], v[12:13], v[26:27], v[150:151] op_sel_hi:[0,1,1] neg_lo:[1,0,0] neg_hi:[1,0,0]
    v_pk_fma_f32 v[156:157], v[12:13], v[28:29], v[156:157] op_sel_hi:[0,1,1] neg_lo:[1,0,0] neg_hi:[1,0,0]
    v_pk_fma_f32 v[158:159], v[12:13], v[30:31], v[158:159] op_sel_hi:[0,1,1] neg_lo:[1,0,0] neg_hi:[1,0,0]
    v_pk_mul_f32 v[132:133], v[14:15], v[132:133] op_sel_hi:[0,1]
    v_pk_mul_f32 v[134:135], v[14:15], v[134:135] op_sel_hi:[0,1]
    v_pk_mul_f32 v[140:141], v[14:15], v[140:141] op_sel_hi:[0,1]
    v_pk_mul_f32 v[142:143], v[14:15], v[142:143] op_sel_hi:[0,1]
    v_pk_mul_f32 v[148:149], v[14:15], v[148:149] op_sel_hi:[0,1]
    v_pk_mul_f32 v[150:151], v[14:15], v[150:151] op_sel_hi:[0,1]
    v_pk_mul_f32 v[156:157], v[14:15], v[156:157] op_sel_hi:[0,1]
    v_pk_mul_f32 v[158:159], v[14:15], v[158:159] op_sel_hi:[0,1]
    v_cvt_pk_bf16_f32 v132, v132, v133
    v_cvt_pk_bf16_f32 v133, v134, v135
    v_cvt_pk_bf16_f32 v134, v140, v141
    v_cvt_pk_bf16_f32 v135, v142, v143
    v_cvt_pk_bf16_f32 v148, v148, v149
    v_cvt_pk_bf16_f32 v149, v150, v151
    v_cvt_pk_bf16_f32 v150, v156, v157
    v_cvt_pk_bf16_f32 v151, v158, v159
    v_mfma_f32_16x16x32_bf16 v[172:175], v[68:71], v[132:135], v[120:123]
    v_mfma_f32_16x16x32_bf16 v[168:171], v[64:67], v[132:135], v[124:127]
    v_mfma_f32_16x16x32_bf16 v[188:191], v[84:87], v[148:151], v[120:123]
    v_mfma_f32_16x16x32_bf16 v[184:187], v[80:83], v[148:151], v[124:127]
    v_pk_fma_f32 v[128:129], v[8:9], v[16:17], v[128:129] op_sel_hi:[0,1,1] neg_lo:[1,0,0] neg_hi:[1,0,0]
    v_pk_fma_f32 v[130:131], v[8:9], v[18:19], v[130:131] op_sel_hi:[0,1,1] neg_lo:[1,0,0] neg_hi:[1,0,0]
    v_pk_fma_f32 v[136:137], v[8:9], v[20:21], v[136:137] op_sel_hi:[0,1,1] neg_lo:[1,0,0] neg_hi:[1,0,0]
    v_pk_fma_f32 v[138:139], v[8:9], v[22:23], v[138:139] op_sel_hi:[0,1,1] neg_lo:[1,0,0] neg_hi:[1,0,0]
    v_pk_fma_f32 v[144:145], v[8:9], v[24:25], v[144:145] op_sel_hi:[0,1,1] neg_lo:[1,0,0] neg_hi:[1,0,0]
    v_pk_fma_f32 v[146:147], v[8:9], v[26:27], v[146:147] op_sel_hi:[0,1,1] neg_lo:[1,0,0] neg_hi:[1,0,0]
    v_pk_fma_f32 v[152:153], v[8:9], v[28:29], v[152:153] op_sel_hi:[0,1,1] neg_lo:[1,0,0] neg_hi:[1,0,0]
    v_pk_fma_f32 v[154:155], v[8:9], v[30:31], v[154:155] op_sel_hi:[0,1,1] neg_lo:[1,0,0] neg_hi:[1,0,0]
    v_pk_mul_f32 v[128:129], v[10:11], v[128:129] op_sel_hi:[0,1]
    v_pk_mul_f32 v[130:131], v[10:11], v[130:131] op_sel_hi:[0,1]
    v_pk_mul_f32 v[136:137], v[10:11], v[136:137] op_sel_hi:[0,1]
    v_pk_mul_f32 v[138:139], v[10:11], v[138:139] op_sel_hi:[0,1]
    v_pk_mul_f32 v[144:145], v[10:11], v[144:145] op_sel_hi:[0,1]
    v_pk_mul_f32 v[146:147], v[10:11], v[146:147] op_sel_hi:[0,1]
    v_pk_mul_f32 v[152:153], v[10:11], v[152:153] op_sel_hi:[0,1]
    v_pk_mul_f32 v[154:155], v[10:11], v[154:155] op_sel_hi:[0,1]
    v_cvt_pk_bf16_f32 v128, v128, v129
    v_cvt_pk_bf16_f32 v129, v130, v131
    v_cvt_pk_bf16_f32 v130, v136, v137
    v_cvt_pk_bf16_f32 v131, v138, v139
    v_cvt_pk_bf16_f32 v144, v144, v145
    v_cvt_pk_bf16_f32 v145, v146, v147
    v_cvt_pk_bf16_f32 v146, v152, v153
    v_cvt_pk_bf16_f32 v147, v154, v155
    v_mfma_f32_16x16x32_bf16 v[164:167], v[64:67], v[128:131], v[120:123]
    s_nop 0
    v_mfma_f32_16x16x32_bf16 v[180:183], v[80:83], v[144:147], v[120:123]
    v_mov_b32 v232, 0x3f803f80
    v_mov_b32 v233, 0x3f803f80
    v_mov_b32 v234, 0x3f803f80
    v_mov_b32 v235, 0x3f803f80
    v_exp_f32 v172, v172
    v_exp_f32 v173, v173
    v_exp_f32 v174, v174
    v_exp_f32 v175, v175
    v_exp_f32 v188, v188
    v_exp_f32 v189, v189
    v_exp_f32 v190, v190
    v_exp_f32 v191, v191
    s_mov_b32 s46, 1006632960
a_exp1:
    v_exp_f32 v168, v168
    v_exp_f32 v169, v169
    v_exp_f32 v170, v170
    v_exp_f32 v171, v171
    v_exp_f32 v184, v184
    v_exp_f32 v185, v185
    v_exp_f32 v186, v186
    v_exp_f32 v187, v187
    v_cvt_pk_bf16_f32 v200, v168, v169
    v_cvt_pk_bf16_f32 v201, v170, v171
    v_cvt_pk_bf16_f32 v202, v172, v173
    v_cvt_pk_bf16_f32 v203, v174, v175
    v_cvt_pk_bf16_f32 v204, v184, v185
    v_cvt_pk_bf16_f32 v205, v186, v187
    v_cvt_pk_bf16_f32 v206, v188, v189
    v_cvt_pk_bf16_f32 v207, v190, v191
    v_mfma_f32_16x16x32_bf16 v[16:19], v[232:235], v[200:203], 0
    s_nop 0
    v_mfma_f32_16x16x32_bf16 v[20:23], v[232:235], v[204:207], 0
    v_mfma_f32_16x16x32_bf16 v[40:43], v[72:75], v[200:203], 0
    v_mfma_f32_16x16x32_bf16 v[44:47], v[76:79], v[200:203], 0
    v_mfma_f32_16x16x32_bf16 v[56:59], v[88:91], v[204:207], 0
    v_mfma_f32_16x16x32_bf16 v[60:63], v[92:95], v[204:207], 0
    v_mov_b32 v218, v72
    v_mov_b32 v219, v73
    v_mov_b32 v222, v76
    v_mov_b32 v223, v77
    v_mov_b32 v226, v88
    v_mov_b32 v227, v89
    v_mov_b32 v230, v92
    v_mov_b32 v231, v93
    v_subrev_u32 v18, 0x21800000, v16
    v_subrev_u32 v22, 0x21800000, v20
    v_max_u32 v18, v18, v22
    v_cmp_le_u32 vcc, s46, v18
    v_rcp_f32 v16, v16
    v_rcp_f32 v20, v20
    s_cbranch_vccnz a_slow1
a_fin1:
    v_pk_mul_f32 v[40:41], v[16:17], v[40:41] op_sel_hi:[0,1]
    v_pk_mul_f32 v[42:43], v[16:17], v[42:43] op_sel_hi:[0,1]
    v_pk_mul_f32 v[44:45], v[16:17], v[44:45] op_sel_hi:[0,1]
    v_pk_mul_f32 v[46:47], v[16:17], v[46:47] op_sel_hi:[0,1]
    v_pk_mul_f32 v[56:57], v[20:21], v[56:57] op_sel_hi:[0,1]
    v_pk_mul_f32 v[58:59], v[20:21], v[58:59] op_sel_hi:[0,1]
    v_pk_mul_f32 v[60:61], v[20:21], v[60:61] op_sel_hi:[0,1]
    v_pk_mul_f32 v[62:63], v[20:21], v[62:63] op_sel_hi:[0,1]
    v_cvt_pk_bf16_f32 v40, v40, v41
    v_cvt_pk_bf16_f32 v41, v42, v43
    v_cvt_pk_bf16_f32 v42, v44, v45
    v_cvt_pk_bf16_f32 v43, v46, v47
    v_cvt_pk_bf16_f32 v56, v56, v57
    v_cvt_pk_bf16_f32 v57, v58, v59
    v_cvt_pk_bf16_f32 v58, v60, v61
    v_cvt_pk_bf16_f32 v59, v62, v63
    v_permlane32_swap_b32 v40, v42
    v_permlane32_swap_b32 v41, v43
    buffer_store_dwordx4 v[40:43], v2, s[4:7], s52 offen offset:256 sc1
    v_permlane32_swap_b32 v56, v58
    v_permlane32_swap_b32 v57, v59
    buffer_store_dwordx4 v[56:59], v2, s[4:7], s52 offen offset:2304 sc1
    s_cmp_lg_u32 s38, 0
    s_cbranch_scc1 a_hasprev
    v_mov_b32 v124, 0xf149f2ca
    v_mov_b32 v125, 0xf149f2ca
    v_mov_b32 v126, 0xf149f2ca
    v_mov_b32 v127, 0xf149f2ca
a_hasprev:
    s_waitcnt lgkmcnt(0)
    s_barrier
    ds_read_b128 v[192:195], v7 offset:0
    ds_read_b128 v[196:199], v7 offset:1024
    ds_read_b64 v[216:217], v7 offset:2048
    ds_read_b64 v[220:221], v7 offset:2056
    ds_read_b64 v[224:225], v7 offset:3072
    ds_read_b64 v[228:229], v7 offset:3080
    s_waitcnt lgkmcnt(4)
    v_mfma_f32_16x16x32_bf16 v[160:163], v[192:195], v[128:131], v[124:127]
    v_mfma_f32_16x16x32_bf16 v[176:179], v[196:199], v[144:147], v[124:127]
    v_exp_f32 v164, v164
    v_exp_f32 v165, v165
    v_exp_f32 v166, v166
    v_exp_f32 v167, v167
    v_exp_f32 v180, v180
    v_exp_f32 v181, v181
    v_exp_f32 v182, v182
    v_exp_f32 v183, v183
    s_waitcnt lgkmcnt(0)
    s_mov_b32 s46, 1006632960
a_exp0:
    v_exp_f32 v160, v160
    v_exp_f32 v161, v161
    v_exp_f32 v162, v162
    v_exp_f32 v163, v163
    v_exp_f32 v176, v176
    v_exp_f32 v177, v177
    v_exp_f32 v178, v178
    v_exp_f32 v179, v179
    v_cvt_pk_bf16_f32 v200, v160, v161
    v_cvt_pk_bf16_f32 v201, v162, v163
    v_cvt_pk_bf16_f32 v202, v164, v165
    v_cvt_pk_bf16_f32 v203, v166, v167
    v_cvt_pk_bf16_f32 v204, v176, v177
    v_cvt_pk_bf16_f32 v205, v178, v179
    v_cvt_pk_bf16_f32 v206, v180, v181
    v_cvt_pk_bf16_f32 v207, v182, v183
    v_mfma_f32_16x16x32_bf16 v[16:19], v[232:235], v[200:203], 0
    s_nop 0
    v_mfma_f32_16x16x32_bf16 v[20:23], v[232:235], v[204:207], 0
    v_mfma_f32_16x16x32_bf16 v[32:35], v[216:219], v[200:203], 0
    v_mfma_f32_16x16x32_bf16 v[36:39], v[220:223], v[200:203], 0
    v_mfma_f32_16x16x32_bf16 v[48:51], v[224:227], v[204:207], 0
    v_mfma_f32_16x16x32_bf16 v[52:55], v[228:231], v[204:207], 0
    s_nop 1
    v_subrev_u32 v18, 0x21800000, v16
    s_nop 0
    v_subrev_u32 v22, 0x21800000, v20
    v_max_u32 v18, v18, v22
    v_cmp_le_u32 vcc, s46, v18
    v_rcp_f32 v16, v16
    v_rcp_f32 v20, v20
    s_cbranch_vccnz a_slow0
a_fin0:
    v_pk_mul_f32 v[32:33], v[16:17], v[32:33] op_sel_hi:[0,1]
    v_pk_mul_f32 v[34:35], v[16:17], v[34:35] op_sel_hi:[0,1]
    v_pk_mul_f32 v[36:37], v[16:17], v[36:37] op_sel_hi:[0,1]
    v_pk_mul_f32 v[38:39], v[16:17], v[38:39] op_sel_hi:[0,1]
    v_pk_mul_f32 v[48:49], v[20:21], v[48:49] op_sel_hi:[0,1]
    v_pk_mul_f32 v[50:51], v[20:21], v[50:51] op_sel_hi:[0,1]
    v_pk_mul_f32 v[52:53], v[20:21], v[52:53] op_sel_hi:[0,1]
    v_pk_mul_f32 v[54:55], v[20:21], v[54:55] op_sel_hi:[0,1]
    v_cvt_pk_bf16_f32 v32, v32, v33
    v_cvt_pk_bf16_f32 v33, v34, v35
    v_cvt_pk_bf16_f32 v34, v36, v37
    v_cvt_pk_bf16_f32 v35, v38, v39
    v_cvt_pk_bf16_f32 v48, v48, v49
    v_cvt_pk_bf16_f32 v49, v50, v51
    v_cvt_pk_bf16_f32 v50, v52, v53
    v_cvt_pk_bf16_f32 v51, v54, v55
    v_permlane32_swap_b32 v32, v34
    v_permlane32_swap_b32 v33, v35
    buffer_store_dwordx4 v[32:35], v2, s[4:7], s52 offen offset:0 sc1
    v_permlane32_swap_b32 v48, v50
    v_permlane32_swap_b32 v49, v51
    buffer_store_dwordx4 v[48:51], v2, s[4:7], s52 offen offset:2048 sc1
    s_lshl_b32 s44, s21, 22
    s_lshl_b32 s45, s39, 16
    s_add_u32 s41, s44, s45
    s_lshl_b32 s45, s20, 12
    s_add_u32 s43, s41, s45
    s_and_b32 s45, s45, 0
    s_add_u32 s41, s41, s45
    s_add_u32 s41, s41, 16777216
    buffer_load_dwordx4 v[224:227], v2, s[4:7], s43 offen offset:0 sc1
    buffer_load_dwordx4 v[228:231], v2, s[4:7], s43 offen offset:256 sc1
    buffer_load_dwordx4 v[232:235], v2, s[4:7], s43 offen offset:2048 sc1
    buffer_load_dwordx4 v[236:239], v2, s[4:7], s43 offen offset:2304 sc1
    s_barrier
    s_lshl_b32 s46, s21, 14
    s_lshl_b32 s67, s38, 8
    s_add_u32 s46, s46, s67
    s_add_u32 s46, s46, 86144
    s_lshl_b32 s47, s21, 14
    s_lshl_b32 s67, s39, 8
    s_add_u32 s47, s47, s67
    s_add_u32 s47, s47, 86144
    s_waitcnt vmcnt(4)
    s_atomic_add s40, s[22:23], s46
    s_mov_b32 s66, 0x10000
c_o_poll:
    s_mov_b32 s68, 0
    s_atomic_add s68, s[22:23], s47 offset:0 glc
    s_sub_u32 s66, s66, 1
    s_cselect_b32 s67, 16, 0
    s_waitcnt lgkmcnt(0)
    s_max_u32 s68, s68, s67
    s_cmp_lt_u32 s68, 16
    s_cbranch_scc1 c_o_poll
c_o_ok:
    s_branch c_wo
a_slow1:
    s_cmp_eq_u32 s46, 0
    s_cbranch_scc1 a_fin1
    s_mov_b32 s46, 0
    v_mfma_f32_16x16x32_bf16 v[172:175], v[68:71], v[132:135], v[120:123]
    v_mfma_f32_16x16x32_bf16 v[168:171], v[64:67], v[132:135], v[124:127]
    v_mfma_f32_16x16x32_bf16 v[188:191], v[84:87], v[148:151], v[120:123]
    v_mfma_f32_16x16x32_bf16 v[184:187], v[80:83], v[148:151], v[124:127]
    s_nop 5
    v_max3_f32 v24, v168, v169, v170
    v_max3_f32 v24, v24, v171, v172
    v_max3_f32 v24, v24, v173, v174
    v_max_f32 v24, v24, v175
    v_max3_f32 v26, v184, v185, v186
    v_max3_f32 v26, v26, v187, v188
    v_max3_f32 v26, v26, v189, v190
    v_max_f32 v26, v26, v191
    v_mov_b32 v25, v24
    v_mov_b32 v27, v26
    s_nop 0
    v_permlane32_swap_b32 v24, v25
    v_permlane32_swap_b32 v26, v27
    v_max_f32 v24, v24, v25
    v_max_f32 v26, v26, v27
    v_mov_b32 v25, v24
    v_mov_b32 v27, v26
    s_nop 0
    v_permlane16_swap_b32 v24, v25
    v_permlane16_swap_b32 v26, v27
    v_max_f32 v24, v24, v25
    v_max_f32 v26, v26, v27
    v_sub_f32 v168, v168, v24
    v_sub_f32 v169, v169, v24
    v_sub_f32 v170, v170, v24
    v_sub_f32 v171, v171, v24
    v_sub_f32 v172, v172, v24
    v_sub_f32 v173, v173, v24
    v_sub_f32 v174, v174, v24
    v_sub_f32 v175, v175, v24
    v_sub_f32 v184, v184, v26
    v_sub_f32 v185, v185, v26
    v_sub_f32 v186, v186, v26
    v_sub_f32 v187, v187, v26
    v_sub_f32 v188, v188, v26
    v_sub_f32 v189, v189, v26
    v_sub_f32 v190, v190, v26
    v_sub_f32 v191, v191, v26
    v_exp_f32 v172, v172
    v_exp_f32 v173, v173
    v_exp_f32 v174, v174
    v_exp_f32 v175, v175
    v_exp_f32 v188, v188
    v_exp_f32 v189, v189
    v_exp_f32 v190, v190
    v_exp_f32 v191, v191
    s_branch a_exp1
a_slow0:
    s_cmp_eq_u32 s46, 0
    s_cbranch_scc1 a_fin0
    s_mov_b32 s46, 0
    v_mfma_f32_16x16x32_bf16 v[164:167], v[64:67], v[128:131], v[120:123]
    v_mfma_f32_16x16x32_bf16 v[160:163], v[192:195], v[128:131], v[124:127]
    v_mfma_f32_16x16x32_bf16 v[180:183], v[80:83], v[144:147], v[120:123]
    v_mfma_f32_16x16x32_bf16 v[176:179], v[196:199], v[144:147], v[124:127]
    s_nop 5
    v_max3_f32 v24, v160, v161, v162
    v_max3_f32 v24, v24, v163, v164
    v_max3_f32 v24, v24, v165, v166
    v_max_f32 v24, v24, v167
    v_max3_f32 v26, v176, v177, v178
    v_max3_f32 v26, v26, v179, v180
    v_max3_f32 v26, v26, v181, v182
    v_max_f32 v26, v26, v183
    v_mov_b32 v25, v24
    v_mov_b32 v27, v26
    s_nop 0
    v_permlane32_swap_b32 v24, v25
    v_permlane32_swap_b32 v26, v27
    v_max_f32 v24, v24, v25
    v_max_f32 v26, v26, v27
    v_mov_b32 v25, v24
    v_mov_b32 v27, v26
    s_nop 0
    v_permlane16_swap_b32 v24, v25
    v_permlane16_swap_b32 v26, v27
    v_max_f32 v24, v24, v25
    v_max_f32 v26, v26, v27
    v_sub_f32 v160, v160, v24
    v_sub_f32 v161, v161, v24
    v_sub_f32 v162, v162, v24
    v_sub_f32 v163, v163, v24
    v_sub_f32 v164, v164, v24
    v_sub_f32 v165, v165, v24
    v_sub_f32 v166, v166, v24
    v_sub_f32 v167, v167, v24
    v_sub_f32 v176, v176, v26
    v_sub_f32 v177, v177, v26
    v_sub_f32 v178, v178, v26
    v_sub_f32 v179, v179, v26
    v_sub_f32 v180, v180, v26
    v_sub_f32 v181, v181, v26
    v_sub_f32 v182, v182, v26
    v_sub_f32 v183, v183, v26
    v_exp_f32 v164, v164
    v_exp_f32 v165, v165
    v_exp_f32 v166, v166
    v_exp_f32 v167, v167
    v_exp_f32 v180, v180
    v_exp_f32 v181, v181
    v_exp_f32 v182, v182
    v_exp_f32 v183, v183
    s_branch a_exp0
c_B:
    s_waitcnt lgkmcnt(6)
    v_pk_fma_f32 v[64:65], v[8:9], v[16:17], v[64:65] op_sel_hi:[0,1,1] neg_lo:[1,0,0] neg_hi:[1,0,0]
    v_pk_fma_f32 v[66:67], v[8:9], v[18:19], v[66:67] op_sel_hi:[0,1,1] neg_lo:[1,0,0] neg_hi:[1,0,0]
    v_pk_fma_f32 v[72:73], v[8:9], v[20:21], v[72:73] op_sel_hi:[0,1,1] neg_lo:[1,0,0] neg_hi:[1,0,0]
    v_pk_fma_f32 v[74:75], v[8:9], v[22:23], v[74:75] op_sel_hi:[0,1,1] neg_lo:[1,0,0] neg_hi:[1,0,0]
    v_pk_mul_f32 v[64:65], v[10:11], v[64:65] op_sel_hi:[0,1]
    v_pk_mul_f32 v[66:67], v[10:11], v[66:67] op_sel_hi:[0,1]
    v_pk_mul_f32 v[72:73], v[10:11], v[72:73] op_sel_hi:[0,1]
    v_pk_mul_f32 v[74:75], v[10:11], v[74:75] op_sel_hi:[0,1]
    v_cvt_pk_bf16_f32 v64, v64, v65
    v_cvt_pk_bf16_f32 v65, v66, v67
    v_cvt_pk_bf16_f32 v66, v72, v73
    v_cvt_pk_bf16_f32 v67, v74, v75
    s_add_u32 s55, s52, 0
    buffer_store_dwordx4 v[64:67], v2, s[4:7], s55 offen offset:0 sc1
    v_pk_fma_f32 v[68:69], v[12:13], v[16:17], v[68:69] op_sel_hi:[0,1,1] neg_lo:[1,0,0] neg_hi:[1,0,0]
    v_pk_fma_f32 v[70:71], v[12:13], v[18:19], v[70:71] op_sel_hi:[0,1,1] neg_lo:[1,0,0] neg_hi:[1,0,0]
    v_pk_fma_f32 v[76:77], v[12:13], v[20:21], v[76:77] op_sel_hi:[0,1,1] neg_lo:[1,0,0] neg_hi:[1,0,0]
    v_pk_fma_f32 v[78:79], v[12:13], v[22:23], v[78:79] op_sel_hi:[0,1,1] neg_lo:[1,0,0] neg_hi:[1,0,0]
    v_pk_mul_f32 v[68:69], v[14:15], v[68:69] op_sel_hi:[0,1]
    v_pk_mul_f32 v[70:71], v[14:15], v[70:71] op_sel_hi:[0,1]
    v_pk_mul_f32 v[76:77], v[14:15], v[76:77] op_sel_hi:[0,1]
    v_pk_mul_f32 v[78:79], v[14:15], v[78:79] op_sel_hi:[0,1]
    v_cvt_pk_bf16_f32 v68, v68, v69
    v_cvt_pk_bf16_f32 v69, v70, v71
    v_cvt_pk_bf16_f32 v70, v76, v77
    v_cvt_pk_bf16_f32 v71, v78, v79
    buffer_store_dwordx4 v[68:71], v2, s[4:7], s55 offen offset:256 sc1
    v_pk_fma_f32 v[80:81], v[8:9], v[24:25], v[80:81] op_sel_hi:[0,1,1] neg_lo:[1,0,0] neg_hi:[1,0,0]
    v_pk_fma_f32 v[82:83], v[8:9], v[26:27], v[82:83] op_sel_hi:[0,1,1] neg_lo:[1,0,0] neg_hi:[1,0,0]
    v_pk_fma_f32 v[88:89], v[8:9], v[28:29], v[88:89] op_sel_hi:[0,1,1] neg_lo:[1,0,0] neg_hi:[1,0,0]
    v_pk_fma_f32 v[90:91], v[8:9], v[30:31], v[90:91] op_sel_hi:[0,1,1] neg_lo:[1,0,0] neg_hi:[1,0,0]
    v_pk_mul_f32 v[80:81], v[10:11], v[80:81] op_sel_hi:[0,1]
    v_pk_mul_f32 v[82:83], v[10:11], v[82:83] op_sel_hi:[0,1]
    v_pk_mul_f32 v[88:89], v[10:11], v[88:89] op_sel_hi:[0,1]
    v_pk_mul_f32 v[90:91], v[10:11], v[90:91] op_sel_hi:[0,1]
    v_cvt_pk_bf16_f32 v80, v80, v81
    v_cvt_pk_bf16_f32 v81, v82, v83
    v_cvt_pk_bf16_f32 v82, v88, v89
    v_cvt_pk_bf16_f32 v83, v90, v91
    s_add_u32 s55, s52, 131072
    buffer_store_dwordx4 v[80:83], v2, s[4:7], s55 offen offset:0 sc1
    v_pk_fma_f32 v[84:85], v[12:13], v[24:25], v[84:85] op_sel_hi:[0,1,1] neg_lo:[1,0,0] neg_hi:[1,0,0]
    v_pk_fma_f32 v[86:87], v[12:13], v[26:27], v[86:87] op_sel_hi:[0,1,1] neg_lo:[1,0,0] neg_hi:[1,0,0]
    v_pk_fma_f32 v[92:93], v[12:13], v[28:29], v[92:93] op_sel_hi:[0,1,1] neg_lo:[1,0,0] neg_hi:[1,0,0]
    v_pk_fma_f32 v[94:95], v[12:13], v[30:31], v[94:95] op_sel_hi:[0,1,1] neg_lo:[1,0,0] neg_hi:[1,0,0]
    v_pk_mul_f32 v[84:85], v[14:15], v[84:85] op_sel_hi:[0,1]
    v_pk_mul_f32 v[86:87], v[14:15], v[86:87] op_sel_hi:[0,1]
    v_pk_mul_f32 v[92:93], v[14:15], v[92:93] op_sel_hi:[0,1]
    v_pk_mul_f32 v[94:95], v[14:15], v[94:95] op_sel_hi:[0,1]
    v_cvt_pk_bf16_f32 v84, v84, v85
    v_cvt_pk_bf16_f32 v85, v86, v87
    v_cvt_pk_bf16_f32 v86, v92, v93
    v_cvt_pk_bf16_f32 v87, v94, v95
    buffer_store_dwordx4 v[84:87], v2, s[4:7], s55 offen offset:256 sc1
    v_mfma_f32_16x16x32_bf16 v[96:99], v[160:163], v[32:35], v[96:99]
    ds_read_b64_tr_b16 v[60:61], v6 offset:53248
    v_mfma_f32_16x16x32_bf16 v[100:103], v[164:167], v[32:35], v[100:103]
    ds_read_b64_tr_b16 v[62:63], v6 offset:54272
    v_mfma_f32_16x16x32_bf16 v[104:107], v[160:163], v[36:39], v[104:107]
    ds_read_b64_tr_b16 v[32:33], v3 offset:57344
    v_mfma_f32_16x16x32_bf16 v[108:111], v[164:167], v[36:39], v[108:111]
    ds_read_b64_tr_b16 v[34:35], v3 offset:58368
    v_mfma_f32_16x16x32_bf16 v[112:115], v[160:163], v[40:43], v[112:115]
    ds_read_b64_tr_b16 v[36:37], v4 offset:57344
    v_mfma_f32_16x16x32_bf16 v[116:119], v[164:167], v[40:43], v[116:119]
    ds_read_b64_tr_b16 v[38:39], v4 offset:58368
    v_mfma_f32_16x16x32_bf16 v[120:123], v[160:163], v[44:47], v[120:123]
    ds_read_b64_tr_b16 v[40:41], v5 offset:57344
    v_mfma_f32_16x16x32_bf16 v[124:127], v[164:167], v[44:47], v[124:127]
    ds_read_b64_tr_b16 v[42:43], v5 offset:58368
    s_waitcnt lgkmcnt(10)
    v_mfma_f32_16x16x32_bf16 v[96:99], v[168:171], v[48:51], v[96:99]
    ds_read_b64_tr_b16 v[44:45], v6 offset:57344
    v_mfma_f32_16x16x32_bf16 v[100:103], v[172:175], v[48:51], v[100:103]
    ds_read_b64_tr_b16 v[46:47], v6 offset:58368
    v_mfma_f32_16x16x32_bf16 v[104:107], v[168:171], v[52:55], v[104:107]
    ds_read_b64_tr_b16 v[48:49], v3 offset:61440
    v_mfma_f32_16x16x32_bf16 v[108:111], v[172:175], v[52:55], v[108:111]
    ds_read_b64_tr_b16 v[50:51], v3 offset:62464
    s_waitcnt lgkmcnt(10)
    v_mfma_f32_16x16x32_bf16 v[112:115], v[168:171], v[56:59], v[112:115]
    ds_read_b64_tr_b16 v[52:53], v4 offset:61440
    v_mfma_f32_16x16x32_bf16 v[116:119], v[172:175], v[56:59], v[116:119]
    ds_read_b64_tr_b16 v[54:55], v4 offset:62464
    v_mfma_f32_16x16x32_bf16 v[120:123], v[168:171], v[60:63], v[120:123]
    ds_read_b64_tr_b16 v[56:57], v5 offset:61440
    v_mfma_f32_16x16x32_bf16 v[124:127], v[172:175], v[60:63], v[124:127]
    ds_read_b64_tr_b16 v[58:59], v5 offset:62464
    s_waitcnt lgkmcnt(10)
    v_mfma_f32_16x16x32_bf16 v[96:99], v[176:179], v[32:35], v[96:99]
    ds_read_b64_tr_b16 v[60:61], v6 offset:61440
    v_mfma_f32_16x16x32_bf16 v[100:103], v[180:183], v[32:35], v[100:103]
    ds_read_b64_tr_b16 v[62:63], v6 offset:62464
    s_barrier
    v_xor_b32 v3, 0x10000, v3
    v_xor_b32 v4, 0x10000, v4
    v_xor_b32 v5, 0x10000, v5
    v_xor_b32 v6, 0x10000, v6
    v_mfma_f32_16x16x32_bf16 v[104:107], v[176:179], v[36:39], v[104:107]
    ds_read_b64_tr_b16 v[32:33], v3 offset:0
    v_mfma_f32_16x16x32_bf16 v[108:111], v[180:183], v[36:39], v[108:111]
    ds_read_b64_tr_b16 v[34:35], v3 offset:1024
    s_waitcnt lgkmcnt(10)
    v_mfma_f32_16x16x32_bf16 v[112:115], v[176:179], v[40:43], v[112:115]
    ds_read_b64_tr_b16 v[36:37], v4 offset:0
    v_mfma_f32_16x16x32_bf16 v[116:119], v[180:183], v[40:43], v[116:119]
    ds_read_b64_tr_b16 v[38:39], v4 offset:1024
    v_mfma_f32_16x16x32_bf16 v[120:123], v[176:179], v[44:47], v[120:123]
    ds_read_b64_tr_b16 v[40:41], v5 offset:0
    v_mfma_f32_16x16x32_bf16 v[124:127], v[180:183], v[44:47], v[124:127]
    ds_read_b64_tr_b16 v[42:43], v5 offset:1024
    s_waitcnt lgkmcnt(10)
    v_mfma_f32_16x16x32_bf16 v[96:99], v[184:187], v[48:51], v[96:99]
    ds_read_b64_tr_b16 v[44:45], v6 offset:0
    v_mfma_f32_16x16x32_bf16 v[100:103], v[188:191], v[48:51], v[100:103]
    ds_read_b64_tr_b16 v[46:47], v6 offset:1024
    v_mfma_f32_16x16x32_bf16 v[104:107], v[184:187], v[52:55], v[104:107]
    ds_read_b64_tr_b16 v[48:49], v3 offset:4096
    v_mfma_f32_16x16x32_bf16 v[108:111], v[188:191], v[52:55], v[108:111]
    ds_read_b64_tr_b16 v[50:51], v3 offset:5120
    s_waitcnt lgkmcnt(10)
    v_mfma_f32_16x16x32_bf16 v[112:115], v[184:187], v[56:59], v[112:115]
    ds_read_b64_tr_b16 v[52:53], v4 offset:4096
    v_mfma_f32_16x16x32_bf16 v[116:119], v[188:191], v[56:59], v[116:119]
    ds_read_b64_tr_b16 v[54:55], v4 offset:5120
    v_mfma_f32_16x16x32_bf16 v[120:123], v[184:187], v[60:63], v[120:123]
    ds_read_b64_tr_b16 v[56:57], v5 offset:4096
    v_mfma_f32_16x16x32_bf16 v[124:127], v[188:191], v[60:63], v[124:127]
    ds_read_b64_tr_b16 v[58:59], v5 offset:5120
    s_waitcnt lgkmcnt(10)
    v_mfma_f32_16x16x32_bf16 v[96:99], v[192:195], v[32:35], v[96:99]
    ds_read_b64_tr_b16 v[60:61], v6 offset:4096
    v_mfma_f32_16x16x32_bf16 v[100:103], v[196:199], v[32:35], v[100:103]
    ds_read_b64_tr_b16 v[62:63], v6 offset:5120
    v_mfma_f32_16x16x32_bf16 v[104:107], v[192:195], v[36:39], v[104:107]
    ds_read_b64_tr_b16 v[32:33], v3 offset:8192
    v_mfma_f32_16x16x32_bf16 v[108:111], v[196:199], v[36:39], v[108:111]
    ds_read_b64_tr_b16 v[34:35], v3 offset:9216
    s_waitcnt lgkmcnt(10)
    v_mfma_f32_16x16x32_bf16 v[112:115], v[192:195], v[40:43], v[112:115]
    ds_read_b64_tr_b16 v[36:37], v4 offset:8192
    v_mfma_f32_16x16x32_bf16 v[116:119], v[196:199], v[40:43], v[116:119]
    ds_read_b64_tr_b16 v[38:39], v4 offset:9216
    v_mfma_f32_16x16x32_bf16 v[120:123], v[192:195], v[44:47], v[120:123]
    ds_read_b64_tr_b16 v[40:41], v5 offset:8192
    v_mfma_f32_16x16x32_bf16 v[124:127], v[196:199], v[44:47], v[124:127]
    ds_read_b64_tr_b16 v[42:43], v5 offset:9216
    s_waitcnt lgkmcnt(10)
    v_mfma_f32_16x16x32_bf16 v[96:99], v[200:203], v[48:51], v[96:99]
    ds_read_b64_tr_b16 v[44:45], v6 offset:8192
    v_mfma_f32_16x16x32_bf16 v[100:103], v[204:207], v[48:51], v[100:103]
    ds_read_b64_tr_b16 v[46:47], v6 offset:9216
    v_mfma_f32_16x16x32_bf16 v[104:107], v[200:203], v[52:55], v[104:107]
    ds_read_b64_tr_b16 v[48:49], v3 offset:12288
    v_mfma_f32_16x16x32_bf16 v[108:111], v[204:207], v[52:55], v[108:111]
    ds_read_b64_tr_b16 v[50:51], v3 offset:13312
    s_waitcnt lgkmcnt(10)
    v_mfma_f32_16x16x32_bf16 v[112:115], v[200:203], v[56:59], v[112:115]
    ds_read_b64_tr_b16 v[52:53], v4 offset:12288
    v_mfma_f32_16x16x32_bf16 v[116:119], v[204:207], v[56:59], v[116:119]
    ds_read_b64_tr_b16 v[54:55], v4 offset:13312
    v_mfma_f32_16x16x32_bf16 v[120:123], v[200:203], v[60:63], v[120:123]
    ds_read_b64_tr_b16 v[56:57], v5 offset:12288
    v_mfma_f32_16x16x32_bf16 v[124:127], v[204:207], v[60:63], v[124:127]
    ds_read_b64_tr_b16 v[58:59], v5 offset:13312
    s_waitcnt lgkmcnt(10)
    v_mfma_f32_16x16x32_bf16 v[96:99], v[208:211], v[32:35], v[96:99]
    ds_read_b64_tr_b16 v[60:61], v6 offset:12288
    v_mfma_f32_16x16x32_bf16 v[100:103], v[212:215], v[32:35], v[100:103]
    ds_read_b64_tr_b16 v[62:63], v6 offset:13312
    v_mfma_f32_16x16x32_bf16 v[104:107], v[208:211], v[36:39], v[104:107]
    ds_read_b64_tr_b16 v[32:33], v3 offset:16384
    ds_read_b128 v[16:19], v13 offset:4096
    v_mfma_f32_16x16x32_bf16 v[108:111], v[212:215], v[36:39], v[108:111]
    ds_read_b64_tr_b16 v[34:35], v3 offset:17408
    ds_read_b128 v[20:23], v13 offset:4608
    s_waitcnt lgkmcnt(12)
    v_mfma_f32_16x16x32_bf16 v[112:115], v[208:211], v[40:43], v[112:115]
    ds_read_b64_tr_b16 v[36:37], v4 offset:16384
    ds_read_b128 v[24:27], v13 offset:4160
    v_mfma_f32_16x16x32_bf16 v[116:119], v[212:215], v[40:43], v[116:119]
    ds_read_b64_tr_b16 v[38:39], v4 offset:17408
    ds_read_b128 v[28:31], v13 offset:4672
    v_mfma_f32_16x16x32_bf16 v[120:123], v[208:211], v[44:47], v[120:123]
    ds_read_b64_tr_b16 v[40:41], v5 offset:16384
    ds_read_b32 v8, v15 offset:512
    v_mfma_f32_16x16x32_bf16 v[124:127], v[212:215], v[44:47], v[124:127]
    ds_read_b64_tr_b16 v[42:43], v5 offset:17408
    ds_read_b32 v10, v15 offset:576
    s_waitcnt lgkmcnt(14)
    v_mfma_f32_16x16x32_bf16 v[96:99], v[216:219], v[48:51], v[96:99]
    ds_read_b64_tr_b16 v[44:45], v6 offset:16384
    ds_read_b32 v12, v15 offset:640
    v_mfma_f32_16x16x32_bf16 v[100:103], v[220:223], v[48:51], v[100:103]
    ds_read_b64_tr_b16 v[46:47], v6 offset:17408
    ds_read_b32 v14, v15 offset:704
    v_mfma_f32_16x16x32_bf16 v[104:107], v[216:219], v[52:55], v[104:107]
    ds_read_b64_tr_b16 v[48:49], v3 offset:20480
    v_mfma_f32_16x16x32_bf16 v[108:111], v[220:223], v[52:55], v[108:111]
    ds_read_b64_tr_b16 v[50:51], v3 offset:21504
    s_waitcnt lgkmcnt(14)
    v_mfma_f32_16x16x32_bf16 v[112:115], v[216:219], v[56:59], v[112:115]
    ds_read_b64_tr_b16 v[52:53], v4 offset:20480
    v_mfma_f32_16x16x32_bf16 v[116:119], v[220:223], v[56:59], v[116:119]
    ds_read_b64_tr_b16 v[54:55], v4 offset:21504
    v_mfma_f32_16x16x32_bf16 v[120:123], v[216:219], v[60:63], v[120:123]
    ds_read_b64_tr_b16 v[56:57], v5 offset:20480
    v_mfma_f32_16x16x32_bf16 v[124:127], v[220:223], v[60:63], v[124:127]
    ds_read_b64_tr_b16 v[58:59], v5 offset:21504
    s_waitcnt lgkmcnt(6)
    v_pk_fma_f32 v[96:97], v[8:9], v[16:17], v[96:97] op_sel_hi:[0,1,1] neg_lo:[1,0,0] neg_hi:[1,0,0]
    v_pk_fma_f32 v[98:99], v[8:9], v[18:19], v[98:99] op_sel_hi:[0,1,1] neg_lo:[1,0,0] neg_hi:[1,0,0]
    v_pk_fma_f32 v[104:105], v[10:11], v[16:17], v[104:105] op_sel_hi:[0,1,1] neg_lo:[1,0,0] neg_hi:[1,0,0]
    v_pk_fma_f32 v[106:107], v[10:11], v[18:19], v[106:107] op_sel_hi:[0,1,1] neg_lo:[1,0,0] neg_hi:[1,0,0]
    v_pk_mul_f32 v[96:97], v[20:21], v[96:97]
    v_pk_mul_f32 v[98:99], v[22:23], v[98:99]
    v_pk_mul_f32 v[104:105], v[20:21], v[104:105]
    v_pk_mul_f32 v[106:107], v[22:23], v[106:107]
    v_cvt_pk_bf16_f32 v72, v96, v97
    v_cvt_pk_bf16_f32 v73, v98, v99
    v_cvt_pk_bf16_f32 v74, v104, v105
    v_cvt_pk_bf16_f32 v75, v106, v107
    s_add_u32 s56, s52, 4194304
    v_permlane16_swap_b32 v72, v74
    v_permlane16_swap_b32 v73, v75
    buffer_store_dwordx4 v[72:75], v1, s[4:7], s56 offen offset:0 sc1
    v_pk_fma_f32 v[112:113], v[12:13], v[16:17], v[112:113] op_sel_hi:[0,1,1] neg_lo:[1,0,0] neg_hi:[1,0,0]
    v_pk_fma_f32 v[114:115], v[12:13], v[18:19], v[114:115] op_sel_hi:[0,1,1] neg_lo:[1,0,0] neg_hi:[1,0,0]
    v_pk_fma_f32 v[120:121], v[14:15], v[16:17], v[120:121] op_sel_hi:[0,1,1] neg_lo:[1,0,0] neg_hi:[1,0,0]
    v_pk_fma_f32 v[122:123], v[14:15], v[18:19], v[122:123] op_sel_hi:[0,1,1] neg_lo:[1,0,0] neg_hi:[1,0,0]
    v_pk_mul_f32 v[112:113], v[20:21], v[112:113]
    v_pk_mul_f32 v[114:115], v[22:23], v[114:115]
    v_pk_mul_f32 v[120:121], v[20:21], v[120:121]
    v_pk_mul_f32 v[122:123], v[22:23], v[122:123]
    v_cvt_pk_bf16_f32 v88, v112, v113
    v_cvt_pk_bf16_f32 v89, v114, v115
    v_cvt_pk_bf16_f32 v90, v120, v121
    v_cvt_pk_bf16_f32 v91, v122, v123
    s_add_u32 s56, s52, 4325376
    v_permlane16_swap_b32 v88, v90
    v_permlane16_swap_b32 v89, v91
    buffer_store_dwordx4 v[88:91], v1, s[4:7], s56 offen offset:0 sc1
    v_pk_fma_f32 v[100:101], v[8:9], v[24:25], v[100:101] op_sel_hi:[0,1,1] neg_lo:[1,0,0] neg_hi:[1,0,0]
    v_pk_fma_f32 v[102:103], v[8:9], v[26:27], v[102:103] op_sel_hi:[0,1,1] neg_lo:[1,0,0] neg_hi:[1,0,0]
    v_pk_fma_f32 v[108:109], v[10:11], v[24:25], v[108:109] op_sel_hi:[0,1,1] neg_lo:[1,0,0] neg_hi:[1,0,0]
    v_pk_fma_f32 v[110:111], v[10:11], v[26:27], v[110:111] op_sel_hi:[0,1,1] neg_lo:[1,0,0] neg_hi:[1,0,0]
    v_pk_mul_f32 v[100:101], v[28:29], v[100:101]
    v_pk_mul_f32 v[102:103], v[30:31], v[102:103]
    v_pk_mul_f32 v[108:109], v[28:29], v[108:109]
    v_pk_mul_f32 v[110:111], v[30:31], v[110:111]
    v_cvt_pk_bf16_f32 v76, v100, v101
    v_cvt_pk_bf16_f32 v77, v102, v103
    v_cvt_pk_bf16_f32 v78, v108, v109
    v_cvt_pk_bf16_f32 v79, v110, v111
    s_add_u32 s56, s52, 4194304
    v_permlane16_swap_b32 v76, v78
    v_permlane16_swap_b32 v77, v79
    buffer_store_dwordx4 v[76:79], v1, s[4:7], s56 offen offset:1024 sc1
    v_pk_fma_f32 v[116:117], v[12:13], v[24:25], v[116:117] op_sel_hi:[0,1,1] neg_lo:[1,0,0] neg_hi:[1,0,0]
    v_pk_fma_f32 v[118:119], v[12:13], v[26:27], v[118:119] op_sel_hi:[0,1,1] neg_lo:[1,0,0] neg_hi:[1,0,0]
    v_pk_fma_f32 v[124:125], v[14:15], v[24:25], v[124:125] op_sel_hi:[0,1,1] neg_lo:[1,0,0] neg_hi:[1,0,0]
    v_pk_fma_f32 v[126:127], v[14:15], v[26:27], v[126:127] op_sel_hi:[0,1,1] neg_lo:[1,0,0] neg_hi:[1,0,0]
    v_pk_mul_f32 v[116:117], v[28:29], v[116:117]
    v_pk_mul_f32 v[118:119], v[30:31], v[118:119]
    v_pk_mul_f32 v[124:125], v[28:29], v[124:125]
    v_pk_mul_f32 v[126:127], v[30:31], v[126:127]
    v_cvt_pk_bf16_f32 v92, v116, v117
    v_cvt_pk_bf16_f32 v93, v118, v119
    v_cvt_pk_bf16_f32 v94, v124, v125
    v_cvt_pk_bf16_f32 v95, v126, v127
    s_add_u32 s56, s52, 4325376
    v_permlane16_swap_b32 v92, v94
    v_permlane16_swap_b32 v93, v95
    buffer_store_dwordx4 v[92:95], v1, s[4:7], s56 offen offset:1024 sc1
    v_mfma_f32_16x16x32_bf16 v[128:131], v[32:35], v[224:227], v[128:131]
    ds_read_b64_tr_b16 v[60:61], v6 offset:20480
    v_mfma_f32_16x16x32_bf16 v[132:135], v[32:35], v[228:231], v[132:135]
    ds_read_b64_tr_b16 v[62:63], v6 offset:21504
    v_mfma_f32_16x16x32_bf16 v[136:139], v[36:39], v[224:227], v[136:139]
    ds_read_b64_tr_b16 v[32:33], v3 offset:24576
    v_mfma_f32_16x16x32_bf16 v[140:143], v[36:39], v[228:231], v[140:143]
    ds_read_b64_tr_b16 v[34:35], v3 offset:25600
    v_mfma_f32_16x16x32_bf16 v[144:147], v[40:43], v[224:227], v[144:147]
    ds_read_b64_tr_b16 v[36:37], v4 offset:24576
    v_mfma_f32_16x16x32_bf16 v[148:151], v[40:43], v[228:231], v[148:151]
    ds_read_b64_tr_b16 v[38:39], v4 offset:25600
    v_mfma_f32_16x16x32_bf16 v[152:155], v[44:47], v[224:227], v[152:155]
    ds_read_b64_tr_b16 v[40:41], v5 offset:24576
    v_mfma_f32_16x16x32_bf16 v[156:159], v[44:47], v[228:231], v[156:159]
    ds_read_b64_tr_b16 v[42:43], v5 offset:25600
    s_waitcnt lgkmcnt(10)
    v_mfma_f32_16x16x32_bf16 v[128:131], v[48:51], v[232:235], v[128:131]
    ds_read_b64_tr_b16 v[44:45], v6 offset:24576
    v_mfma_f32_16x16x32_bf16 v[132:135], v[48:51], v[236:239], v[132:135]
    ds_read_b64_tr_b16 v[46:47], v6 offset:25600
    v_mfma_f32_16x16x32_bf16 v[136:139], v[52:55], v[232:235], v[136:139]
    ds_read_b64_tr_b16 v[48:49], v3 offset:28672
    v_mfma_f32_16x16x32_bf16 v[140:143], v[52:55], v[236:239], v[140:143]
    ds_read_b64_tr_b16 v[50:51], v3 offset:29696
    s_waitcnt lgkmcnt(10)
    v_mfma_f32_16x16x32_bf16 v[144:147], v[56:59], v[232:235], v[144:147]
    ds_read_b64_tr_b16 v[52:53], v4 offset:28672
    v_mfma_f32_16x16x32_bf16 v[148:151], v[56:59], v[236:239], v[148:151]
    ds_read_b64_tr_b16 v[54:55], v4 offset:29696
    v_mfma_f32_16x16x32_bf16 v[152:155], v[60:63], v[232:235], v[152:155]
    ds_read_b64_tr_b16 v[56:57], v5 offset:28672
    v_mfma_f32_16x16x32_bf16 v[156:159], v[60:63], v[236:239], v[156:159]
    ds_read_b64_tr_b16 v[58:59], v5 offset:29696
    s_waitcnt lgkmcnt(10)
    v_mfma_f32_16x16x32_bf16 v[128:131], v[32:35], v[240:243], v[128:131]
    ds_read_b64_tr_b16 v[60:61], v6 offset:28672
    v_mfma_f32_16x16x32_bf16 v[132:135], v[32:35], v[244:247], v[132:135]
    ds_read_b64_tr_b16 v[62:63], v6 offset:29696
    s_barrier
    v_mfma_f32_16x16x32_bf16 v[136:139], v[36:39], v[240:243], v[136:139]
    ds_read_b64_tr_b16 v[32:33], v3 offset:32768
    v_mfma_f32_16x16x32_bf16 v[140:143], v[36:39], v[244:247], v[140:143]
    ds_read_b64_tr_b16 v[34:35], v3 offset:33792
    s_waitcnt lgkmcnt(10)
    v_mfma_f32_16x16x32_bf16 v[144:147], v[40:43], v[240:243], v[144:147]
    ds_read_b64_tr_b16 v[36:37], v4 offset:32768
    v_mfma_f32_16x16x32_bf16 v[148:151], v[40:43], v[244:247], v[148:151]
    ds_read_b64_tr_b16 v[38:39], v4 offset:33792
    v_mfma_f32_16x16x32_bf16 v[152:155], v[44:47], v[240:243], v[152:155]
    ds_read_b64_tr_b16 v[40:41], v5 offset:32768
    v_mfma_f32_16x16x32_bf16 v[156:159], v[44:47], v[244:247], v[156:159]
    ds_read_b64_tr_b16 v[42:43], v5 offset:33792
    s_waitcnt lgkmcnt(10)
    v_mfma_f32_16x16x32_bf16 v[128:131], v[48:51], v[248:251], v[128:131]
    ds_read_b64_tr_b16 v[44:45], v6 offset:32768
    v_mfma_f32_16x16x32_bf16 v[132:135], v[48:51], v[252:255], v[132:135]
    ds_read_b64_tr_b16 v[46:47], v6 offset:33792
    v_mfma_f32_16x16x32_bf16 v[136:139], v[52:55], v[248:251], v[136:139]
    ds_read_b64_tr_b16 v[48:49], v3 offset:36864
    v_mfma_f32_16x16x32_bf16 v[140:143], v[52:55], v[252:255], v[140:143]
    ds_read_b64_tr_b16 v[50:51], v3 offset:37888
    s_waitcnt lgkmcnt(10)
    v_mfma_f32_16x16x32_bf16 v[144:147], v[56:59], v[248:251], v[144:147]
    ds_read_b64_tr_b16 v[52:53], v4 offset:36864
    v_mfma_f32_16x16x32_bf16 v[148:151], v[56:59], v[252:255], v[148:151]
    ds_read_b64_tr_b16 v[54:55], v4 offset:37888
    v_mfma_f32_16x16x32_bf16 v[152:155], v[60:63], v[248:251], v[152:155]
    ds_read_b64_tr_b16 v[56:57], v5 offset:36864
    v_mfma_f32_16x16x32_bf16 v[156:159], v[60:63], v[252:255], v[156:159]
    ds_read_b64_tr_b16 v[58:59], v5 offset:37888
    s_waitcnt lgkmcnt(10)
    v_mfma_f32_16x16x32_bf16 v[128:131], v[32:35], v[160:163], v[128:131]
    ds_read_b64_tr_b16 v[60:61], v6 offset:36864
    v_mfma_f32_16x16x32_bf16 v[132:135], v[32:35], v[164:167], v[132:135]
    ds_read_b64_tr_b16 v[62:63], v6 offset:37888
    v_mfma_f32_16x16x32_bf16 v[136:139], v[36:39], v[160:163], v[136:139]
    ds_read_b64_tr_b16 v[32:33], v3 offset:40960
    v_mfma_f32_16x16x32_bf16 v[140:143], v[36:39], v[164:167], v[140:143]
    ds_read_b64_tr_b16 v[34:35], v3 offset:41984
    s_waitcnt lgkmcnt(10)
    v_mfma_f32_16x16x32_bf16 v[144:147], v[40:43], v[160:163], v[144:147]
    ds_read_b64_tr_b16 v[36:37], v4 offset:40960
    v_mfma_f32_16x16x32_bf16 v[148:151], v[40:43], v[164:167], v[148:151]
    ds_read_b64_tr_b16 v[38:39], v4 offset:41984
    v_mfma_f32_16x16x32_bf16 v[152:155], v[44:47], v[160:163], v[152:155]
    ds_read_b64_tr_b16 v[40:41], v5 offset:40960
    v_mfma_f32_16x16x32_bf16 v[156:159], v[44:47], v[164:167], v[156:159]
    ds_read_b64_tr_b16 v[42:43], v5 offset:41984
    s_waitcnt lgkmcnt(10)
    v_mfma_f32_16x16x32_bf16 v[128:131], v[48:51], v[168:171], v[128:131]
    ds_read_b64_tr_b16 v[44:45], v6 offset:40960
    v_mfma_f32_16x16x32_bf16 v[132:135], v[48:51], v[172:175], v[132:135]
    ds_read_b64_tr_b16 v[46:47], v6 offset:41984
    v_mfma_f32_16x16x32_bf16 v[136:139], v[52:55], v[168:171], v[136:139]
    ds_read_b64_tr_b16 v[48:49], v3 offset:45056
    v_mfma_f32_16x16x32_bf16 v[140:143], v[52:55], v[172:175], v[140:143]
    ds_read_b64_tr_b16 v[50:51], v3 offset:46080
    s_waitcnt lgkmcnt(10)
    v_mfma_f32_16x16x32_bf16 v[144:147], v[56:59], v[168:171], v[144:147]
    ds_read_b64_tr_b16 v[52:53], v4 offset:45056
    v_mfma_f32_16x16x32_bf16 v[148:151], v[56:59], v[172:175], v[148:151]
    ds_read_b64_tr_b16 v[54:55], v4 offset:46080
    v_mfma_f32_16x16x32_bf16 v[152:155], v[60:63], v[168:171], v[152:155]
    ds_read_b64_tr_b16 v[56:57], v5 offset:45056
    v_mfma_f32_16x16x32_bf16 v[156:159], v[60:63], v[172:175], v[156:159]
    ds_read_b64_tr_b16 v[58:59], v5 offset:46080
    s_waitcnt lgkmcnt(10)
    v_mfma_f32_16x16x32_bf16 v[128:131], v[32:35], v[176:179], v[128:131]
    ds_read_b64_tr_b16 v[60:61], v6 offset:45056
    v_mfma_f32_16x16x32_bf16 v[132:135], v[32:35], v[180:183], v[132:135]
    ds_read_b64_tr_b16 v[62:63], v6 offset:46080
    v_mfma_f32_16x16x32_bf16 v[136:139], v[36:39], v[176:179], v[136:139]
    ds_read_b64_tr_b16 v[32:33], v3 offset:49152
    v_mfma_f32_16x16x32_bf16 v[140:143], v[36:39], v[180:183], v[140:143]
    ds_read_b64_tr_b16 v[34:35], v3 offset:50176
    s_waitcnt lgkmcnt(10)
    v_mfma_f32_16x16x32_bf16 v[144:147], v[40:43], v[176:179], v[144:147]
    ds_read_b64_tr_b16 v[36:37], v4 offset:49152
    v_mfma_f32_16x16x32_bf16 v[148:151], v[40:43], v[180:183], v[148:151]
    ds_read_b64_tr_b16 v[38:39], v4 offset:50176
    v_mfma_f32_16x16x32_bf16 v[152:155], v[44:47], v[176:179], v[152:155]
    ds_read_b64_tr_b16 v[40:41], v5 offset:49152
    v_mfma_f32_16x16x32_bf16 v[156:159], v[44:47], v[180:183], v[156:159]
    ds_read_b64_tr_b16 v[42:43], v5 offset:50176
    s_waitcnt lgkmcnt(10)
    v_mfma_f32_16x16x32_bf16 v[128:131], v[48:51], v[184:187], v[128:131]
    ds_read_b64_tr_b16 v[44:45], v6 offset:49152
    s_waitcnt vmcnt(0)
    s_atomic_add s40, s[22:23], s59
    s_mov_b32 s68, 0
    s_atomic_add s68, s[22:23], s59 glc
    s_mov_b32 s55, s52
    s_add_u32 s56, s52, 4194304
    ds_read_b32 v8, v9 offset:4096
    v_mfma_f32_16x16x32_bf16 v[132:135], v[48:51], v[188:191], v[132:135]
    ds_read_b64_tr_b16 v[46:47], v6 offset:50176
    buffer_load_dwordx4 v[64:67], v1, s[4:7], s55 offen offset:0 sc1
    ds_read_b32 v10, v9 offset:4608
    v_mfma_f32_16x16x32_bf16 v[136:139], v[52:55], v[184:187], v[136:139]
    ds_read_b64_tr_b16 v[48:49], v3 offset:53248
    buffer_load_dwordx4 v[68:71], v1, s[4:7], s55 offen offset:1024 sc1
    ds_read_b32 v12, v9 offset:4160
    v_mfma_f32_16x16x32_bf16 v[140:143], v[52:55], v[188:191], v[140:143]
    ds_read_b64_tr_b16 v[50:51], v3 offset:54272
    buffer_load_dwordx4 v[72:75], v1, s[4:7], s56 offen offset:0 sc1
    ds_read_b32 v14, v9 offset:4672
    s_waitcnt lgkmcnt(14)
    v_mfma_f32_16x16x32_bf16 v[144:147], v[56:59], v[184:187], v[144:147]
    ds_read_b64_tr_b16 v[52:53], v4 offset:53248
    buffer_load_dwordx4 v[76:79], v1, s[4:7], s56 offen offset:1024 sc1
    ds_read_b128 v[16:19], v11 offset:0
    v_mfma_f32_16x16x32_bf16 v[148:151], v[56:59], v[188:191], v[148:151]
    ds_read_b64_tr_b16 v[54:55], v4 offset:54272
    ds_read_b128 v[20:23], v11 offset:64
    v_mfma_f32_16x16x32_bf16 v[152:155], v[60:63], v[184:187], v[152:155]
    ds_read_b64_tr_b16 v[56:57], v5 offset:53248
    ds_read_b128 v[24:27], v11 offset:128
    v_mfma_f32_16x16x32_bf16 v[156:159], v[60:63], v[188:191], v[156:159]
    ds_read_b64_tr_b16 v[58:59], v5 offset:54272
    ds_read_b128 v[28:31], v11 offset:192
    s_waitcnt lgkmcnt(14)
    v_mfma_f32_16x16x32_bf16 v[128:131], v[32:35], v[192:195], v[128:131]
    ds_read_b64_tr_b16 v[60:61], v6 offset:53248
    v_mfma_f32_16x16x32_bf16 v[132:135], v[32:35], v[196:199], v[132:135]
    ds_read_b64_tr_b16 v[62:63], v6 offset:54272
    v_mfma_f32_16x16x32_bf16 v[136:139], v[36:39], v[192:195], v[136:139]
    ds_read_b64_tr_b16 v[32:33], v3 offset:57344
    v_mfma_f32_16x16x32_bf16 v[140:143], v[36:39], v[196:199], v[140:143]
    ds_read_b64_tr_b16 v[34:35], v3 offset:58368
    s_waitcnt lgkmcnt(14)
    v_mfma_f32_16x16x32_bf16 v[144:147], v[40:43], v[192:195], v[144:147]
    ds_read_b64_tr_b16 v[36:37], v4 offset:57344
    v_mfma_f32_16x16x32_bf16 v[148:151], v[40:43], v[196:199], v[148:151]
    ds_read_b64_tr_b16 v[38:39], v4 offset:58368
    v_mfma_f32_16x16x32_bf16 v[152:155], v[44:47], v[192:195], v[152:155]
    ds_read_b64_tr_b16 v[40:41], v5 offset:57344
    v_mfma_f32_16x16x32_bf16 v[156:159], v[44:47], v[196:199], v[156:159]
    ds_read_b64_tr_b16 v[42:43], v5 offset:58368
    s_waitcnt lgkmcnt(13)
    v_mfma_f32_16x16x32_bf16 v[128:131], v[48:51], v[200:203], v[128:131]
    ds_read_b64_tr_b16 v[44:45], v6 offset:57344
    s_waitcnt lgkmcnt(9)
    v_mfma_f32_16x16x32_bf16 v[132:135], v[48:51], v[204:207], v[132:135]
    ds_read_b64_tr_b16 v[46:47], v6 offset:58368
    v_mul_f32 v10, 0x3e8293ee, v10
    v_mfma_f32_16x16x32_bf16 v[136:139], v[52:55], v[200:203], v[136:139]
    ds_read_b64_tr_b16 v[48:49], v3 offset:61440
    v_mul_f32 v14, 0x3e8293ee, v14
    v_mfma_f32_16x16x32_bf16 v[140:143], v[52:55], v[204:207], v[140:143]
    ds_read_b64_tr_b16 v[50:51], v3 offset:62464
    s_lshl_b32 s44, s16, 11
    s_waitcnt lgkmcnt(10)
    v_mfma_f32_16x16x32_bf16 v[144:147], v[56:59], v[200:203], v[144:147]
    ds_read_b64_tr_b16 v[52:53], v4 offset:61440
    s_add_u32 s44, s44, 131072
    v_mfma_f32_16x16x32_bf16 v[148:151], v[56:59], v[204:207], v[148:151]
    ds_read_b64_tr_b16 v[54:55], v4 offset:62464
    v_add_u32 v13, s44, v2
    v_mfma_f32_16x16x32_bf16 v[152:155], v[60:63], v[200:203], v[152:155]
    ds_read_b64_tr_b16 v[56:57], v5 offset:61440
    v_mfma_f32_16x16x32_bf16 v[156:159], v[60:63], v[204:207], v[156:159]
    ds_read_b64_tr_b16 v[58:59], v5 offset:62464
    s_waitcnt lgkmcnt(10)
    v_mfma_f32_16x16x32_bf16 v[128:131], v[32:35], v[208:211], v[128:131]
    ds_read_b64_tr_b16 v[60:61], v6 offset:61440
    v_mfma_f32_16x16x32_bf16 v[132:135], v[32:35], v[212:215], v[132:135]
    ds_read_b64_tr_b16 v[62:63], v6 offset:62464
    v_xor_b32 v3, 0x10000, v3
    v_xor_b32 v4, 0x10000, v4
    v_xor_b32 v5, 0x10000, v5
    v_xor_b32 v6, 0x10000, v6
    v_mfma_f32_16x16x32_bf16 v[136:139], v[36:39], v[208:211], v[136:139]
    v_mfma_f32_16x16x32_bf16 v[140:143], v[36:39], v[212:215], v[140:143]
    s_waitcnt lgkmcnt(8)
    v_mfma_f32_16x16x32_bf16 v[144:147], v[40:43], v[208:211], v[144:147]
    v_mfma_f32_16x16x32_bf16 v[148:151], v[40:43], v[212:215], v[148:151]
    v_mfma_f32_16x16x32_bf16 v[152:155], v[44:47], v[208:211], v[152:155]
    v_mfma_f32_16x16x32_bf16 v[156:159], v[44:47], v[212:215], v[156:159]
    s_waitcnt lgkmcnt(4)
    v_mfma_f32_16x16x32_bf16 v[128:131], v[48:51], v[216:219], v[128:131]
    v_mfma_f32_16x16x32_bf16 v[132:135], v[48:51], v[220:223], v[132:135]
    v_mfma_f32_16x16x32_bf16 v[136:139], v[52:55], v[216:219], v[136:139]
    v_mfma_f32_16x16x32_bf16 v[140:143], v[52:55], v[220:223], v[140:143]
    s_waitcnt lgkmcnt(0)
    v_mfma_f32_16x16x32_bf16 v[144:147], v[56:59], v[216:219], v[144:147]
    v_mfma_f32_16x16x32_bf16 v[148:151], v[56:59], v[220:223], v[148:151]
    v_mfma_f32_16x16x32_bf16 v[152:155], v[60:63], v[216:219], v[152:155]
    v_mfma_f32_16x16x32_bf16 v[156:159], v[60:63], v[220:223], v[156:159]
    v_pk_fma_f32 v[128:129], v[8:9], v[16:17], v[128:129] op_sel_hi:[0,1,1] neg_lo:[1,0,0] neg_hi:[1,0,0]
    v_pk_fma_f32 v[130:131], v[8:9], v[18:19], v[130:131] op_sel_hi:[0,1,1] neg_lo:[1,0,0] neg_hi:[1,0,0]
    v_pk_fma_f32 v[136:137], v[8:9], v[20:21], v[136:137] op_sel_hi:[0,1,1] neg_lo:[1,0,0] neg_hi:[1,0,0]
    v_pk_fma_f32 v[138:139], v[8:9], v[22:23], v[138:139] op_sel_hi:[0,1,1] neg_lo:[1,0,0] neg_hi:[1,0,0]
    v_pk_mul_f32 v[128:129], v[10:11], v[128:129] op_sel_hi:[0,1]
    v_pk_mul_f32 v[130:131], v[10:11], v[130:131] op_sel_hi:[0,1]
    v_pk_mul_f32 v[136:137], v[10:11], v[136:137] op_sel_hi:[0,1]
    v_pk_mul_f32 v[138:139], v[10:11], v[138:139] op_sel_hi:[0,1]
    v_cvt_pk_bf16_f32 v128, v128, v129
    v_cvt_pk_bf16_f32 v129, v130, v131
    v_cvt_pk_bf16_f32 v130, v136, v137
    v_cvt_pk_bf16_f32 v131, v138, v139
    ds_write_b128 v13, v[128:131] offset:0
    v_pk_fma_f32 v[132:133], v[12:13], v[16:17], v[132:133] op_sel_hi:[0,1,1] neg_lo:[1,0,0] neg_hi:[1,0,0]
    v_pk_fma_f32 v[134:135], v[12:13], v[18:19], v[134:135] op_sel_hi:[0,1,1] neg_lo:[1,0,0] neg_hi:[1,0,0]
    v_pk_fma_f32 v[140:141], v[12:13], v[20:21], v[140:141] op_sel_hi:[0,1,1] neg_lo:[1,0,0] neg_hi:[1,0,0]
    v_pk_fma_f32 v[142:143], v[12:13], v[22:23], v[142:143] op_sel_hi:[0,1,1] neg_lo:[1,0,0] neg_hi:[1,0,0]
    v_pk_mul_f32 v[132:133], v[14:15], v[132:133] op_sel_hi:[0,1]
    v_pk_mul_f32 v[134:135], v[14:15], v[134:135] op_sel_hi:[0,1]
    v_pk_mul_f32 v[140:141], v[14:15], v[140:141] op_sel_hi:[0,1]
    v_pk_mul_f32 v[142:143], v[14:15], v[142:143] op_sel_hi:[0,1]
    v_cvt_pk_bf16_f32 v132, v132, v133
    v_cvt_pk_bf16_f32 v133, v134, v135
    v_cvt_pk_bf16_f32 v134, v140, v141
    v_cvt_pk_bf16_f32 v135, v142, v143
    ds_write_b128 v13, v[132:135] offset:256
    v_add_u32 v4, 131072, v1
    s_waitcnt lgkmcnt(0)
    s_barrier
    ds_read_b128 v[32:35], v4 offset:0
    ds_read_b128 v[36:39], v4 offset:1024
    ds_read_b128 v[40:43], v4 offset:2048
    ds_read_b128 v[44:47], v4 offset:3072
    ds_read_b128 v[48:51], v4 offset:4096
    ds_read_b128 v[52:55], v4 offset:5120
    ds_read_b128 v[56:59], v4 offset:6144
    ds_read_b128 v[60:63], v4 offset:7168
    v_pk_fma_f32 v[144:145], v[8:9], v[24:25], v[144:145] op_sel_hi:[0,1,1] neg_lo:[1,0,0] neg_hi:[1,0,0]
    v_pk_fma_f32 v[146:147], v[8:9], v[26:27], v[146:147] op_sel_hi:[0,1,1] neg_lo:[1,0,0] neg_hi:[1,0,0]
    v_pk_fma_f32 v[152:153], v[8:9], v[28:29], v[152:153] op_sel_hi:[0,1,1] neg_lo:[1,0,0] neg_hi:[1,0,0]
    v_pk_fma_f32 v[154:155], v[8:9], v[30:31], v[154:155] op_sel_hi:[0,1,1] neg_lo:[1,0,0] neg_hi:[1,0,0]
    v_pk_mul_f32 v[144:145], v[10:11], v[144:145] op_sel_hi:[0,1]
    v_pk_mul_f32 v[146:147], v[10:11], v[146:147] op_sel_hi:[0,1]
    v_pk_mul_f32 v[152:153], v[10:11], v[152:153] op_sel_hi:[0,1]
    v_pk_mul_f32 v[154:155], v[10:11], v[154:155] op_sel_hi:[0,1]
    v_cvt_pk_bf16_f32 v144, v144, v145
    v_cvt_pk_bf16_f32 v145, v146, v147
    v_cvt_pk_bf16_f32 v146, v152, v153
    v_cvt_pk_bf16_f32 v147, v154, v155
    ds_write_b128 v13, v[144:147] offset:8192
    s_waitcnt vmcnt(0) lgkmcnt(7)
    v_mfma_f32_32x32x16_bf16 v[192:207], v[64:67], v[32:35], 0
    v_mfma_f32_32x32x16_bf16 v[192:207], v[68:71], v[36:39], v[192:207]
    v_pk_fma_f32 v[148:149], v[12:13], v[24:25], v[148:149] op_sel_hi:[0,1,1] neg_lo:[1,0,0] neg_hi:[1,0,0]
    v_pk_fma_f32 v[150:151], v[12:13], v[26:27], v[150:151] op_sel_hi:[0,1,1] neg_lo:[1,0,0] neg_hi:[1,0,0]
    v_pk_fma_f32 v[156:157], v[12:13], v[28:29], v[156:157] op_sel_hi:[0,1,1] neg_lo:[1,0,0] neg_hi:[1,0,0]
    v_pk_fma_f32 v[158:159], v[12:13], v[30:31], v[158:159] op_sel_hi:[0,1,1] neg_lo:[1,0,0] neg_hi:[1,0,0]
    v_pk_mul_f32 v[148:149], v[14:15], v[148:149] op_sel_hi:[0,1]
    v_pk_mul_f32 v[150:151], v[14:15], v[150:151] op_sel_hi:[0,1]
    v_pk_mul_f32 v[156:157], v[14:15], v[156:157] op_sel_hi:[0,1]
    v_pk_mul_f32 v[158:159], v[14:15], v[158:159] op_sel_hi:[0,1]
    v_cvt_pk_bf16_f32 v148, v148, v149
    v_cvt_pk_bf16_f32 v149, v150, v151
    v_cvt_pk_bf16_f32 v150, v156, v157
    v_cvt_pk_bf16_f32 v151, v158, v159
    ds_write_b128 v13, v[148:151] offset:8448
    v_mov_b32 v9, 0xdddddddd
    v_bfe_u32 v10, v1, 4, 3
    v_mov_b32 v11, 0x3f803f80
    v_cmp_eq_u32 vcc, 0, v10
    v_cmp_eq_u32 s[44:45], 4, v10
    s_mov_b32 s57, 0
    v_cndmask_b32 v28, 0, v11, vcc
    v_cndmask_b32 v29, 0, v11, vcc
    v_cndmask_b32 v30, 0, v11, s[44:45]
    v_cndmask_b32 v31, 0, v11, s[44:45]
    v_mov_b32 v10, 0
    v_mov_b32 v11, 0
    s_mov_b32 s66, 0x10000
    s_waitcnt lgkmcnt(0)
    s_cmp_eq_u32 s68, 16
    s_cbranch_scc1 c_k_ok
c_k_poll:
    s_mov_b32 s68, 0
    s_atomic_add s68, s[22:23], s59 offset:0 glc
    s_sub_u32 s66, s66, 1
    s_cselect_b32 s67, 16, 0
    s_waitcnt lgkmcnt(0)
    s_max_u32 s68, s68, s67
    s_cmp_lt_u32 s68, 16
    s_cbranch_scc1 c_k_poll
c_k_ok:
    s_add_u32 s54, s54, 8192
    s_and_b32 s54, s54, 0x1ffff
    s_add_u32 s55, s53, s54
    s_add_u32 s56, s55, 4194304
    buffer_load_dwordx4 v[80:83], v1, s[4:7], s55 offen offset:0 sc1
    buffer_load_dwordx4 v[84:87], v1, s[4:7], s55 offen offset:1024 sc1
    buffer_load_dwordx4 v[88:91], v1, s[4:7], s56 offen offset:0 sc1
    buffer_load_dwordx4 v[92:95], v1, s[4:7], s56 offen offset:1024 sc1
    s_add_u32 s54, s54, 8192
    s_and_b32 s54, s54, 0x1ffff
    s_add_u32 s55, s53, s54
    s_add_u32 s56, s55, 4194304
    buffer_load_dwordx4 v[96:99], v1, s[4:7], s55 offen offset:0 sc1
    buffer_load_dwordx4 v[100:103], v1, s[4:7], s55 offen offset:1024 sc1
    buffer_load_dwordx4 v[104:107], v1, s[4:7], s56 offen offset:0 sc1
    buffer_load_dwordx4 v[108:111], v1, s[4:7], s56 offen offset:1024 sc1
    v_mfma_f32_32x32x16_bf16 v[208:223], v[64:67], v[40:43], 0
    s_add_u32 s54, s54, 8192
    s_and_b32 s54, s54, 0x1ffff
    s_add_u32 s55, s53, s54
    s_add_u32 s56, s55, 4194304
    v_exp_f32 v192, v192
    v_exp_f32 v193, v193
    v_exp_f32 v194, v194
    v_mfma_f32_32x32x8_bf16 v[128:143], v[10:11], v[10:11], 0
    v_mov_b32 v12, 0
    v_exp_f32 v195, v195
    v_exp_f32 v196, v196
    v_exp_f32 v197, v197
    v_mfma_f32_32x32x16_bf16 v[208:223], v[68:71], v[44:47], v[208:223]
    v_exp_f32 v198, v198
    v_exp_f32 v199, v199
    v_exp_f32 v200, v200
    v_mfma_f32_32x32x8_bf16 v[144:159], v[10:11], v[10:11], 0
    v_mov_b32 v16, 0
    v_exp_f32 v201, v201
    v_exp_f32 v202, v202
    v_mfma_f32_32x32x8_bf16 v[160:175], v[10:11], v[10:11], 0
    v_mov_b32 v20, 0
    s_lshl_b32 s44, s16, 12
    s_add_u32 s44, s44, 65536
    v_add_u32 v5, s44, v1
    s_lshl_b32 s44, s16, 8
    s_add_u32 s44, s44, 147456
    v_lshrrev_b32 v6, 2, v1
    v_add_u32 v6, s44, v6
    s_lshl_b32 s44, s21, 22
    s_lshl_b32 s45, s39, 16
    s_add_u32 s41, s44, s45
    s_lshl_b32 s45, s20, 12
    s_add_u32 s43, s41, s45
    s_and_b32 s45, s45, 0
    s_add_u32 s41, s41, s45
    s_add_u32 s41, s41, 16777216
    v_exp_f32 v203, v203
    v_exp_f32 v204, v204
    buffer_load_dwordx4 v[112:115], v1, s[4:7], s55 offen offset:0 sc1
    v_exp_f32 v205, v205
    v_mfma_f32_32x32x8_bf16 v[176:191], v[10:11], v[10:11], 0
    v_mov_b32 v24, 0
    v_exp_f32 v206, v206
    v_exp_f32 v207, v207
    v_mfma_f32_32x32x16_bf16 v[224:239], v[64:67], v[48:51], 0
    v_exp_f32 v208, v208
    v_exp_f32 v209, v209
    v_exp_f32 v210, v210
    v_smfmac_f32_32x32x32_bf16 v[128:143], v[72:75], v[192:199], v9
    v_exp_f32 v211, v211
    v_exp_f32 v212, v212
    v_exp_f32 v213, v213
    v_mfma_f32_32x32x16_bf16 v[224:239], v[68:71], v[52:55], v[224:239]
    v_exp_f32 v214, v214
    v_exp_f32 v215, v215
    v_exp_f32 v216, v216
    v_smfmac_f32_16x16x64_bf16 v[12:15], v[28:31], v[192:199], v9
    v_exp_f32 v217, v217
    v_smfmac_f32_32x32x32_bf16 v[128:143], v[76:79], v[200:207], v9
    v_exp_f32 v218, v218
    v_exp_f32 v219, v219
    v_exp_f32 v220, v220
    v_smfmac_f32_16x16x64_bf16 v[12:15], v[28:31], v[200:207], v9
    buffer_load_dwordx4 v[116:119], v1, s[4:7], s55 offen offset:1024 sc1
    v_exp_f32 v221, v221
    v_exp_f32 v222, v222
    v_exp_f32 v223, v223
b_head:
    s_mov_b32 s58, 3
b_loop:
    v_mfma_f32_32x32x16_bf16 v[240:255], v[64:67], v[56:59], 0
    v_exp_f32 v224, v224
    v_exp_f32 v225, v225
    v_exp_f32 v226, v226
    v_smfmac_f32_32x32x32_bf16 v[144:159], v[72:75], v[208:215], v9
    v_exp_f32 v227, v227
    v_exp_f32 v228, v228
    v_exp_f32 v229, v229
    v_mfma_f32_32x32x16_bf16 v[240:255], v[68:71], v[60:63], v[240:255]
    v_exp_f32 v230, v230
    v_exp_f32 v231, v231
    v_exp_f32 v232, v232
    v_smfmac_f32_16x16x64_bf16 v[16:19], v[28:31], v[208:215], v9
    v_exp_f32 v233, v233
    v_smfmac_f32_32x32x32_bf16 v[144:159], v[76:79], v[216:223], v9
    v_exp_f32 v234, v234
    v_exp_f32 v235, v235
    v_exp_f32 v236, v236
    v_smfmac_f32_16x16x64_bf16 v[16:19], v[28:31], v[216:223], v9
    buffer_load_dwordx4 v[120:123], v1, s[4:7], s56 offen offset:0 sc1
    v_exp_f32 v237, v237
    v_exp_f32 v238, v238
    v_exp_f32 v239, v239
    s_waitcnt vmcnt(7)
    v_mfma_f32_32x32x16_bf16 v[192:207], v[80:83], v[32:35], 0
    v_exp_f32 v240, v240
    v_exp_f32 v241, v241
    v_exp_f32 v242, v242
    v_smfmac_f32_32x32x32_bf16 v[160:175], v[72:75], v[224:231], v9
    v_exp_f32 v243, v243
    v_exp_f32 v244, v244
    v_exp_f32 v245, v245
    v_mfma_f32_32x32x16_bf16 v[192:207], v[84:87], v[36:39], v[192:207]
    v_exp_f32 v246, v246
    v_exp_f32 v247, v247
    v_exp_f32 v248, v248
    v_smfmac_f32_16x16x64_bf16 v[20:23], v[28:31], v[224:231], v9
    v_exp_f32 v249, v249
    v_smfmac_f32_32x32x32_bf16 v[160:175], v[76:79], v[232:239], v9
    v_exp_f32 v250, v250
    v_exp_f32 v251, v251
    v_exp_f32 v252, v252
    v_smfmac_f32_16x16x64_bf16 v[20:23], v[28:31], v[232:239], v9
    buffer_load_dwordx4 v[124:127], v1, s[4:7], s56 offen offset:1024 sc1
    v_exp_f32 v253, v253
    v_exp_f32 v254, v254
    v_exp_f32 v255, v255
    v_mfma_f32_32x32x16_bf16 v[208:223], v[80:83], v[40:43], 0
    s_add_u32 s54, s54, 8192
    s_and_b32 s54, s54, 0x1ffff
    s_add_u32 s55, s53, s54
    s_add_u32 s56, s55, 4194304
    v_exp_f32 v192, v192
    v_exp_f32 v193, v193
    v_exp_f32 v194, v194
    v_smfmac_f32_32x32x32_bf16 v[176:191], v[72:75], v[240:247], v9
    v_exp_f32 v195, v195
    v_exp_f32 v196, v196
    v_exp_f32 v197, v197
    v_mfma_f32_32x32x16_bf16 v[208:223], v[84:87], v[44:47], v[208:223]
    v_exp_f32 v198, v198
    v_exp_f32 v199, v199
    v_exp_f32 v200, v200
    v_smfmac_f32_16x16x64_bf16 v[24:27], v[28:31], v[240:247], v9
    v_exp_f32 v201, v201
    v_smfmac_f32_32x32x32_bf16 v[176:191], v[76:79], v[248:255], v9
    v_exp_f32 v202, v202
    v_exp_f32 v203, v203
    v_exp_f32 v204, v204
    v_smfmac_f32_16x16x64_bf16 v[24:27], v[28:31], v[248:255], v9
    buffer_load_dwordx4 v[64:67], v1, s[4:7], s55 offen offset:0 sc1
    v_exp_f32 v205, v205
    v_exp_f32 v206, v206
    v_exp_f32 v207, v207
    v_mfma_f32_32x32x16_bf16 v[224:239], v[80:83], v[48:51], 0
    v_exp_f32 v208, v208
    v_exp_f32 v209, v209
    v_exp_f32 v210, v210
    v_smfmac_f32_32x32x32_bf16 v[128:143], v[88:91], v[192:199], v9
    v_exp_f32 v211, v211
    v_exp_f32 v212, v212
    v_exp_f32 v213, v213
    v_mfma_f32_32x32x16_bf16 v[224:239], v[84:87], v[52:55], v[224:239]
    v_exp_f32 v214, v214
    v_exp_f32 v215, v215
    v_exp_f32 v216, v216
    v_smfmac_f32_16x16x64_bf16 v[12:15], v[28:31], v[192:199], v9
    v_exp_f32 v217, v217
    v_smfmac_f32_32x32x32_bf16 v[128:143], v[92:95], v[200:207], v9
    v_exp_f32 v218, v218
    v_exp_f32 v219, v219
    v_exp_f32 v220, v220
    v_smfmac_f32_16x16x64_bf16 v[12:15], v[28:31], v[200:207], v9
    buffer_load_dwordx4 v[68:71], v1, s[4:7], s55 offen offset:1024 sc1
    v_exp_f32 v221, v221
    v_exp_f32 v222, v222
    v_exp_f32 v223, v223
    v_mfma_f32_32x32x16_bf16 v[240:255], v[80:83], v[56:59], 0
    v_exp_f32 v224, v224
    v_exp_f32 v225, v225
    v_exp_f32 v226, v226
    v_smfmac_f32_32x32x32_bf16 v[144:159], v[88:91], v[208:215], v9
    v_exp_f32 v227, v227
    v_exp_f32 v228, v228
    v_exp_f32 v229, v229
    v_mfma_f32_32x32x16_bf16 v[240:255], v[84:87], v[60:63], v[240:255]
    v_exp_f32 v230, v230
    v_exp_f32 v231, v231
    v_exp_f32 v232, v232
    v_smfmac_f32_16x16x64_bf16 v[16:19], v[28:31], v[208:215], v9
    v_exp_f32 v233, v233
    v_smfmac_f32_32x32x32_bf16 v[144:159], v[92:95], v[216:223], v9
    v_exp_f32 v234, v234
    v_exp_f32 v235, v235
    v_exp_f32 v236, v236
    v_smfmac_f32_16x16x64_bf16 v[16:19], v[28:31], v[216:223], v9
    buffer_load_dwordx4 v[72:75], v1, s[4:7], s56 offen offset:0 sc1
    v_exp_f32 v237, v237
    v_exp_f32 v238, v238
    v_exp_f32 v239, v239
    s_waitcnt vmcnt(7)
    v_mfma_f32_32x32x16_bf16 v[192:207], v[96:99], v[32:35], 0
    v_exp_f32 v240, v240
    v_exp_f32 v241, v241
    v_exp_f32 v242, v242
    v_smfmac_f32_32x32x32_bf16 v[160:175], v[88:91], v[224:231], v9
    v_exp_f32 v243, v243
    v_exp_f32 v244, v244
    v_exp_f32 v245, v245
    v_mfma_f32_32x32x16_bf16 v[192:207], v[100:103], v[36:39], v[192:207]
    v_exp_f32 v246, v246
    v_exp_f32 v247, v247
    v_exp_f32 v248, v248
    v_smfmac_f32_16x16x64_bf16 v[20:23], v[28:31], v[224:231], v9
    v_exp_f32 v249, v249
    v_smfmac_f32_32x32x32_bf16 v[160:175], v[92:95], v[232:239], v9
    v_exp_f32 v250, v250
    v_exp_f32 v251, v251
    v_exp_f32 v252, v252
    v_smfmac_f32_16x16x64_bf16 v[20:23], v[28:31], v[232:239], v9
    buffer_load_dwordx4 v[76:79], v1, s[4:7], s56 offen offset:1024 sc1
    v_exp_f32 v253, v253
    v_exp_f32 v254, v254
    v_exp_f32 v255, v255
    v_mfma_f32_32x32x16_bf16 v[208:223], v[96:99], v[40:43], 0
    s_add_u32 s54, s54, 8192
    s_and_b32 s54, s54, 0x1ffff
    s_add_u32 s55, s53, s54
    s_add_u32 s56, s55, 4194304
    v_exp_f32 v192, v192
    v_exp_f32 v193, v193
    v_exp_f32 v194, v194
    v_smfmac_f32_32x32x32_bf16 v[176:191], v[88:91], v[240:247], v9
    v_exp_f32 v195, v195
    v_exp_f32 v196, v196
    v_exp_f32 v197, v197
    v_mfma_f32_32x32x16_bf16 v[208:223], v[100:103], v[44:47], v[208:223]
    v_exp_f32 v198, v198
    v_exp_f32 v199, v199
    v_exp_f32 v200, v200
    v_smfmac_f32_16x16x64_bf16 v[24:27], v[28:31], v[240:247], v9
    v_exp_f32 v201, v201
    v_smfmac_f32_32x32x32_bf16 v[176:191], v[92:95], v[248:255], v9
    v_exp_f32 v202, v202
    v_exp_f32 v203, v203
    v_exp_f32 v204, v204
    v_smfmac_f32_16x16x64_bf16 v[24:27], v[28:31], v[248:255], v9
    buffer_load_dwordx4 v[80:83], v1, s[4:7], s55 offen offset:0 sc1
    v_exp_f32 v205, v205
    v_exp_f32 v206, v206
    v_exp_f32 v207, v207
    v_mfma_f32_32x32x16_bf16 v[224:239], v[96:99], v[48:51], 0
    v_exp_f32 v208, v208
    v_exp_f32 v209, v209
    v_exp_f32 v210, v210
    v_smfmac_f32_32x32x32_bf16 v[128:143], v[104:107], v[192:199], v9
    v_exp_f32 v211, v211
    v_exp_f32 v212, v212
    v_exp_f32 v213, v213
    v_mfma_f32_32x32x16_bf16 v[224:239], v[100:103], v[52:55], v[224:239]
    v_exp_f32 v214, v214
    v_exp_f32 v215, v215
    v_exp_f32 v216, v216
    v_smfmac_f32_16x16x64_bf16 v[12:15], v[28:31], v[192:199], v9
    v_exp_f32 v217, v217
    v_smfmac_f32_32x32x32_bf16 v[128:143], v[108:111], v[200:207], v9
    v_exp_f32 v218, v218
    v_exp_f32 v219, v219
    v_exp_f32 v220, v220
    v_smfmac_f32_16x16x64_bf16 v[12:15], v[28:31], v[200:207], v9
    buffer_load_dwordx4 v[84:87], v1, s[4:7], s55 offen offset:1024 sc1
    v_exp_f32 v221, v221
    v_exp_f32 v222, v222
    v_exp_f32 v223, v223
    v_mfma_f32_32x32x16_bf16 v[240:255], v[96:99], v[56:59], 0
    v_exp_f32 v224, v224
    v_exp_f32 v225, v225
    v_exp_f32 v226, v226
    v_smfmac_f32_32x32x32_bf16 v[144:159], v[104:107], v[208:215], v9
    v_exp_f32 v227, v227
    v_exp_f32 v228, v228
    v_exp_f32 v229, v229
    v_mfma_f32_32x32x16_bf16 v[240:255], v[100:103], v[60:63], v[240:255]
    v_exp_f32 v230, v230
    v_exp_f32 v231, v231
    v_exp_f32 v232, v232
    v_smfmac_f32_16x16x64_bf16 v[16:19], v[28:31], v[208:215], v9
    v_exp_f32 v233, v233
    v_smfmac_f32_32x32x32_bf16 v[144:159], v[108:111], v[216:223], v9
    v_exp_f32 v234, v234
    v_exp_f32 v235, v235
    v_exp_f32 v236, v236
    v_smfmac_f32_16x16x64_bf16 v[16:19], v[28:31], v[216:223], v9
    buffer_load_dwordx4 v[88:91], v1, s[4:7], s56 offen offset:0 sc1
    v_exp_f32 v237, v237
    v_exp_f32 v238, v238
    v_exp_f32 v239, v239
    s_waitcnt vmcnt(7)
    v_mfma_f32_32x32x16_bf16 v[192:207], v[112:115], v[32:35], 0
    v_exp_f32 v240, v240
    v_exp_f32 v241, v241
    v_exp_f32 v242, v242
    v_smfmac_f32_32x32x32_bf16 v[160:175], v[104:107], v[224:231], v9
    v_exp_f32 v243, v243
    v_exp_f32 v244, v244
    v_exp_f32 v245, v245
    v_mfma_f32_32x32x16_bf16 v[192:207], v[116:119], v[36:39], v[192:207]
    v_exp_f32 v246, v246
    v_exp_f32 v247, v247
    v_exp_f32 v248, v248
    v_smfmac_f32_16x16x64_bf16 v[20:23], v[28:31], v[224:231], v9
    v_exp_f32 v249, v249
    v_smfmac_f32_32x32x32_bf16 v[160:175], v[108:111], v[232:239], v9
    v_exp_f32 v250, v250
    v_exp_f32 v251, v251
    v_exp_f32 v252, v252
    v_smfmac_f32_16x16x64_bf16 v[20:23], v[28:31], v[232:239], v9
    buffer_load_dwordx4 v[92:95], v1, s[4:7], s56 offen offset:1024 sc1
    v_exp_f32 v253, v253
    v_exp_f32 v254, v254
    v_exp_f32 v255, v255
    v_mfma_f32_32x32x16_bf16 v[208:223], v[112:115], v[40:43], 0
    s_add_u32 s54, s54, 8192
    s_and_b32 s54, s54, 0x1ffff
    s_add_u32 s55, s53, s54
    s_add_u32 s56, s55, 4194304
    v_exp_f32 v192, v192
    v_exp_f32 v193, v193
    v_exp_f32 v194, v194
    v_smfmac_f32_32x32x32_bf16 v[176:191], v[104:107], v[240:247], v9
    v_exp_f32 v195, v195
    v_exp_f32 v196, v196
    v_exp_f32 v197, v197
    v_mfma_f32_32x32x16_bf16 v[208:223], v[116:119], v[44:47], v[208:223]
    v_exp_f32 v198, v198
    v_exp_f32 v199, v199
    v_exp_f32 v200, v200
    v_smfmac_f32_16x16x64_bf16 v[24:27], v[28:31], v[240:247], v9
    v_exp_f32 v201, v201
    v_smfmac_f32_32x32x32_bf16 v[176:191], v[108:111], v[248:255], v9
    v_exp_f32 v202, v202
    v_exp_f32 v203, v203
    v_exp_f32 v204, v204
    v_smfmac_f32_16x16x64_bf16 v[24:27], v[28:31], v[248:255], v9
    buffer_load_dwordx4 v[96:99], v1, s[4:7], s55 offen offset:0 sc1
    v_exp_f32 v205, v205
    v_exp_f32 v206, v206
    v_exp_f32 v207, v207
    v_mfma_f32_32x32x16_bf16 v[224:239], v[112:115], v[48:51], 0
    v_exp_f32 v208, v208
    v_exp_f32 v209, v209
    v_exp_f32 v210, v210
    v_smfmac_f32_32x32x32_bf16 v[128:143], v[120:123], v[192:199], v9
    v_exp_f32 v211, v211
    v_exp_f32 v212, v212
    v_exp_f32 v213, v213
    v_mfma_f32_32x32x16_bf16 v[224:239], v[116:119], v[52:55], v[224:239]
    v_exp_f32 v214, v214
    v_exp_f32 v215, v215
    v_exp_f32 v216, v216
    v_smfmac_f32_16x16x64_bf16 v[12:15], v[28:31], v[192:199], v9
    v_exp_f32 v217, v217
    v_smfmac_f32_32x32x32_bf16 v[128:143], v[124:127], v[200:207], v9
    v_exp_f32 v218, v218
    v_exp_f32 v219, v219
    v_exp_f32 v220, v220
    v_smfmac_f32_16x16x64_bf16 v[12:15], v[28:31], v[200:207], v9
    buffer_load_dwordx4 v[100:103], v1, s[4:7], s55 offen offset:1024 sc1
    v_exp_f32 v221, v221
    v_exp_f32 v222, v222
    v_exp_f32 v223, v223
    v_mfma_f32_32x32x16_bf16 v[240:255], v[112:115], v[56:59], 0
    v_exp_f32 v224, v224
    v_exp_f32 v225, v225
    v_exp_f32 v226, v226
    v_smfmac_f32_32x32x32_bf16 v[144:159], v[120:123], v[208:215], v9
    v_exp_f32 v227, v227
    v_exp_f32 v228, v228
    v_exp_f32 v229, v229
    v_mfma_f32_32x32x16_bf16 v[240:255], v[116:119], v[60:63], v[240:255]
    v_exp_f32 v230, v230
    v_exp_f32 v231, v231
    v_exp_f32 v232, v232
    v_smfmac_f32_16x16x64_bf16 v[16:19], v[28:31], v[208:215], v9
    v_exp_f32 v233, v233
    v_smfmac_f32_32x32x32_bf16 v[144:159], v[124:127], v[216:223], v9
    v_exp_f32 v234, v234
    v_exp_f32 v235, v235
    v_exp_f32 v236, v236
    v_smfmac_f32_16x16x64_bf16 v[16:19], v[28:31], v[216:223], v9
    buffer_load_dwordx4 v[104:107], v1, s[4:7], s56 offen offset:0 sc1
    v_exp_f32 v237, v237
    v_exp_f32 v238, v238
    v_exp_f32 v239, v239
    s_waitcnt vmcnt(7)
    v_mfma_f32_32x32x16_bf16 v[192:207], v[64:67], v[32:35], 0
    v_exp_f32 v240, v240
    v_exp_f32 v241, v241
    v_exp_f32 v242, v242
    v_smfmac_f32_32x32x32_bf16 v[160:175], v[120:123], v[224:231], v9
    v_exp_f32 v243, v243
    v_exp_f32 v244, v244
    v_exp_f32 v245, v245
    v_mfma_f32_32x32x16_bf16 v[192:207], v[68:71], v[36:39], v[192:207]
    v_exp_f32 v246, v246
    v_exp_f32 v247, v247
    v_exp_f32 v248, v248
    v_smfmac_f32_16x16x64_bf16 v[20:23], v[28:31], v[224:231], v9
    v_exp_f32 v249, v249
    v_smfmac_f32_32x32x32_bf16 v[160:175], v[124:127], v[232:239], v9
    v_exp_f32 v250, v250
    v_exp_f32 v251, v251
    v_exp_f32 v252, v252
    v_smfmac_f32_16x16x64_bf16 v[20:23], v[28:31], v[232:239], v9
    buffer_load_dwordx4 v[108:111], v1, s[4:7], s56 offen offset:1024 sc1
    v_exp_f32 v253, v253
    v_exp_f32 v254, v254
    v_exp_f32 v255, v255
    v_mfma_f32_32x32x16_bf16 v[208:223], v[64:67], v[40:43], 0
    s_add_u32 s54, s54, 8192
    s_and_b32 s54, s54, 0x1ffff
    s_add_u32 s55, s53, s54
    s_add_u32 s56, s55, 4194304
    v_exp_f32 v192, v192
    v_exp_f32 v193, v193
    v_exp_f32 v194, v194
    v_smfmac_f32_32x32x32_bf16 v[176:191], v[120:123], v[240:247], v9
    v_exp_f32 v195, v195
    v_exp_f32 v196, v196
    v_exp_f32 v197, v197
    v_mfma_f32_32x32x16_bf16 v[208:223], v[68:71], v[44:47], v[208:223]
    v_exp_f32 v198, v198
    v_exp_f32 v199, v199
    v_exp_f32 v200, v200
    v_smfmac_f32_16x16x64_bf16 v[24:27], v[28:31], v[240:247], v9
    v_exp_f32 v201, v201
    v_smfmac_f32_32x32x32_bf16 v[176:191], v[124:127], v[248:255], v9
    v_exp_f32 v202, v202
    v_exp_f32 v203, v203
    v_exp_f32 v204, v204
    v_smfmac_f32_16x16x64_bf16 v[24:27], v[28:31], v[248:255], v9
    buffer_load_dwordx4 v[112:115], v1, s[4:7], s55 offen offset:0 sc1
    v_exp_f32 v205, v205
    v_exp_f32 v206, v206
    v_exp_f32 v207, v207
    v_mfma_f32_32x32x16_bf16 v[224:239], v[64:67], v[48:51], 0
    v_exp_f32 v208, v208
    v_exp_f32 v209, v209
    v_exp_f32 v210, v210
    v_smfmac_f32_32x32x32_bf16 v[128:143], v[72:75], v[192:199], v9
    v_exp_f32 v211, v211
    v_exp_f32 v212, v212
    v_exp_f32 v213, v213
    v_mfma_f32_32x32x16_bf16 v[224:239], v[68:71], v[52:55], v[224:239]
    v_exp_f32 v214, v214
    v_exp_f32 v215, v215
    v_exp_f32 v216, v216
    v_smfmac_f32_16x16x64_bf16 v[12:15], v[28:31], v[192:199], v9
    v_exp_f32 v217, v217
    v_smfmac_f32_32x32x32_bf16 v[128:143], v[76:79], v[200:207], v9
    v_exp_f32 v218, v218
    v_exp_f32 v219, v219
    v_exp_f32 v220, v220
    v_smfmac_f32_16x16x64_bf16 v[12:15], v[28:31], v[200:207], v9
    buffer_load_dwordx4 v[116:119], v1, s[4:7], s55 offen offset:1024 sc1
    v_exp_f32 v221, v221
    v_exp_f32 v222, v222
    v_exp_f32 v223, v223
    s_sub_u32 s58, s58, 1
    s_cmp_lg_u32 s58, 0
    s_cbranch_scc1 b_loop
    v_mfma_f32_32x32x16_bf16 v[240:255], v[64:67], v[56:59], 0
    v_exp_f32 v224, v224
    v_exp_f32 v225, v225
    v_exp_f32 v226, v226
    v_smfmac_f32_32x32x32_bf16 v[144:159], v[72:75], v[208:215], v9
    v_exp_f32 v227, v227
    v_exp_f32 v228, v228
    v_exp_f32 v229, v229
    v_mfma_f32_32x32x16_bf16 v[240:255], v[68:71], v[60:63], v[240:255]
    v_exp_f32 v230, v230
    v_exp_f32 v231, v231
    v_exp_f32 v232, v232
    v_smfmac_f32_16x16x64_bf16 v[16:19], v[28:31], v[208:215], v9
    v_exp_f32 v233, v233
    v_smfmac_f32_32x32x32_bf16 v[144:159], v[76:79], v[216:223], v9
    v_exp_f32 v234, v234
    v_exp_f32 v235, v235
    v_exp_f32 v236, v236
    v_smfmac_f32_16x16x64_bf16 v[16:19], v[28:31], v[216:223], v9
    buffer_load_dwordx4 v[120:123], v1, s[4:7], s56 offen offset:0 sc1
    v_exp_f32 v237, v237
    v_exp_f32 v238, v238
    v_exp_f32 v239, v239
    s_waitcnt vmcnt(7)
    v_mfma_f32_32x32x16_bf16 v[192:207], v[80:83], v[32:35], 0
    v_exp_f32 v240, v240
    v_exp_f32 v241, v241
    v_exp_f32 v242, v242
    v_smfmac_f32_32x32x32_bf16 v[160:175], v[72:75], v[224:231], v9
    v_exp_f32 v243, v243
    v_exp_f32 v244, v244
    v_exp_f32 v245, v245
    v_mfma_f32_32x32x16_bf16 v[192:207], v[84:87], v[36:39], v[192:207]
    v_exp_f32 v246, v246
    v_exp_f32 v247, v247
    v_exp_f32 v248, v248
    v_smfmac_f32_16x16x64_bf16 v[20:23], v[28:31], v[224:231], v9
    v_exp_f32 v249, v249
    v_smfmac_f32_32x32x32_bf16 v[160:175], v[76:79], v[232:239], v9
    v_exp_f32 v250, v250
    v_exp_f32 v251, v251
    v_exp_f32 v252, v252
    v_smfmac_f32_16x16x64_bf16 v[20:23], v[28:31], v[232:239], v9
    buffer_load_dwordx4 v[124:127], v1, s[4:7], s56 offen offset:1024 sc1
    v_exp_f32 v253, v253
    v_exp_f32 v254, v254
    v_exp_f32 v255, v255
    s_add_u32 s53, s53, 131072
    s_cmp_eq_u32 s57, 0
    s_cselect_b32 s53, s53, 2146435072
    v_mfma_f32_32x32x16_bf16 v[208:223], v[80:83], v[40:43], 0
    s_add_u32 s54, s54, 8192
    s_and_b32 s54, s54, 0x1ffff
    s_add_u32 s55, s53, s54
    s_add_u32 s56, s55, 4194304
    v_exp_f32 v192, v192
    v_exp_f32 v193, v193
    v_exp_f32 v194, v194
    v_smfmac_f32_32x32x32_bf16 v[176:191], v[72:75], v[240:247], v9
    v_exp_f32 v195, v195
    v_exp_f32 v196, v196
    v_exp_f32 v197, v197
    v_mfma_f32_32x32x16_bf16 v[208:223], v[84:87], v[44:47], v[208:223]
    v_exp_f32 v198, v198
    v_exp_f32 v199, v199
    v_exp_f32 v200, v200
    v_smfmac_f32_16x16x64_bf16 v[24:27], v[28:31], v[240:247], v9
    v_exp_f32 v201, v201
    v_smfmac_f32_32x32x32_bf16 v[176:191], v[76:79], v[248:255], v9
    v_exp_f32 v202, v202
    v_exp_f32 v203, v203
    v_exp_f32 v204, v204
    v_smfmac_f32_16x16x64_bf16 v[24:27], v[28:31], v[248:255], v9
    buffer_load_dwordx4 v[64:67], v1, s[4:7], s55 offen offset:0 sc1
    v_exp_f32 v205, v205
    v_exp_f32 v206, v206
    v_exp_f32 v207, v207
    v_mfma_f32_32x32x16_bf16 v[224:239], v[80:83], v[48:51], 0
    v_exp_f32 v208, v208
    v_exp_f32 v209, v209
    v_exp_f32 v210, v210
    v_smfmac_f32_32x32x32_bf16 v[128:143], v[88:91], v[192:199], v9
    v_exp_f32 v211, v211
    v_exp_f32 v212, v212
    v_exp_f32 v213, v213
    v_mfma_f32_32x32x16_bf16 v[224:239], v[84:87], v[52:55], v[224:239]
    v_exp_f32 v214, v214
    v_exp_f32 v215, v215
    v_exp_f32 v216, v216
    v_smfmac_f32_16x16x64_bf16 v[12:15], v[28:31], v[192:199], v9
    v_exp_f32 v217, v217
    v_smfmac_f32_32x32x32_bf16 v[128:143], v[92:95], v[200:207], v9
    v_exp_f32 v218, v218
    v_exp_f32 v219, v219
    v_exp_f32 v220, v220
    v_smfmac_f32_16x16x64_bf16 v[12:15], v[28:31], v[200:207], v9
    buffer_load_dwordx4 v[68:71], v1, s[4:7], s55 offen offset:1024 sc1
    v_exp_f32 v221, v221
    v_exp_f32 v222, v222
    v_exp_f32 v223, v223
    v_mfma_f32_32x32x16_bf16 v[240:255], v[80:83], v[56:59], 0
    v_exp_f32 v224, v224
    v_exp_f32 v225, v225
    v_exp_f32 v226, v226
    v_smfmac_f32_32x32x32_bf16 v[144:159], v[88:91], v[208:215], v9
    v_exp_f32 v227, v227
    v_exp_f32 v228, v228
    v_exp_f32 v229, v229
    v_mfma_f32_32x32x16_bf16 v[240:255], v[84:87], v[60:63], v[240:255]
    v_exp_f32 v230, v230
    v_exp_f32 v231, v231
    v_exp_f32 v232, v232
    v_smfmac_f32_16x16x64_bf16 v[16:19], v[28:31], v[208:215], v9
    v_exp_f32 v233, v233
    v_smfmac_f32_32x32x32_bf16 v[144:159], v[92:95], v[216:223], v9
    v_exp_f32 v234, v234
    v_exp_f32 v235, v235
    v_exp_f32 v236, v236
    v_smfmac_f32_16x16x64_bf16 v[16:19], v[28:31], v[216:223], v9
    buffer_load_dwordx4 v[72:75], v1, s[4:7], s56 offen offset:0 sc1
    v_exp_f32 v237, v237
    v_exp_f32 v238, v238
    v_exp_f32 v239, v239
    s_waitcnt vmcnt(7)
    v_mfma_f32_32x32x16_bf16 v[192:207], v[96:99], v[32:35], 0
    v_exp_f32 v240, v240
    v_exp_f32 v241, v241
    v_exp_f32 v242, v242
    v_smfmac_f32_32x32x32_bf16 v[160:175], v[88:91], v[224:231], v9
    v_exp_f32 v243, v243
    v_exp_f32 v244, v244
    v_exp_f32 v245, v245
    v_mfma_f32_32x32x16_bf16 v[192:207], v[100:103], v[36:39], v[192:207]
    v_exp_f32 v246, v246
    v_exp_f32 v247, v247
    v_exp_f32 v248, v248
    v_smfmac_f32_16x16x64_bf16 v[20:23], v[28:31], v[224:231], v9
    v_exp_f32 v249, v249
    v_smfmac_f32_32x32x32_bf16 v[160:175], v[92:95], v[232:239], v9
    v_exp_f32 v250, v250
    v_exp_f32 v251, v251
    v_exp_f32 v252, v252
    v_smfmac_f32_16x16x64_bf16 v[20:23], v[28:31], v[232:239], v9
    buffer_load_dwordx4 v[76:79], v1, s[4:7], s56 offen offset:1024 sc1
    v_exp_f32 v253, v253
    v_exp_f32 v254, v254
    v_exp_f32 v255, v255
    v_mfma_f32_32x32x16_bf16 v[208:223], v[96:99], v[40:43], 0
    s_add_u32 s54, s54, 8192
    s_and_b32 s54, s54, 0x1ffff
    s_add_u32 s55, s53, s54
    s_add_u32 s56, s55, 4194304
    v_exp_f32 v192, v192
    v_exp_f32 v193, v193
    v_exp_f32 v194, v194
    v_smfmac_f32_32x32x32_bf16 v[176:191], v[88:91], v[240:247], v9
    v_exp_f32 v195, v195
    v_exp_f32 v196, v196
    v_exp_f32 v197, v197
    v_mfma_f32_32x32x16_bf16 v[208:223], v[100:103], v[44:47], v[208:223]
    v_exp_f32 v198, v198
    v_exp_f32 v199, v199
    v_exp_f32 v200, v200
    v_smfmac_f32_16x16x64_bf16 v[24:27], v[28:31], v[240:247], v9
    v_exp_f32 v201, v201
    v_smfmac_f32_32x32x32_bf16 v[176:191], v[92:95], v[248:255], v9
    v_exp_f32 v202, v202
    v_exp_f32 v203, v203
    v_exp_f32 v204, v204
    v_smfmac_f32_16x16x64_bf16 v[24:27], v[28:31], v[248:255], v9
    buffer_load_dwordx4 v[80:83], v1, s[4:7], s55 offen offset:0 sc1
    v_exp_f32 v205, v205
    v_exp_f32 v206, v206
    v_exp_f32 v207, v207
    v_mfma_f32_32x32x16_bf16 v[224:239], v[96:99], v[48:51], 0
    v_exp_f32 v208, v208
    v_exp_f32 v209, v209
    v_exp_f32 v210, v210
    v_smfmac_f32_32x32x32_bf16 v[128:143], v[104:107], v[192:199], v9
    v_exp_f32 v211, v211
    v_exp_f32 v212, v212
    v_exp_f32 v213, v213
    v_mfma_f32_32x32x16_bf16 v[224:239], v[100:103], v[52:55], v[224:239]
    v_exp_f32 v214, v214
    v_exp_f32 v215, v215
    v_exp_f32 v216, v216
    v_smfmac_f32_16x16x64_bf16 v[12:15], v[28:31], v[192:199], v9
    v_exp_f32 v217, v217
    v_smfmac_f32_32x32x32_bf16 v[128:143], v[108:111], v[200:207], v9
    v_exp_f32 v218, v218
    v_exp_f32 v219, v219
    v_exp_f32 v220, v220
    v_smfmac_f32_16x16x64_bf16 v[12:15], v[28:31], v[200:207], v9
    buffer_load_dwordx4 v[84:87], v1, s[4:7], s55 offen offset:1024 sc1
    v_exp_f32 v221, v221
    v_exp_f32 v222, v222
    v_exp_f32 v223, v223
    v_mfma_f32_32x32x16_bf16 v[240:255], v[96:99], v[56:59], 0
    v_exp_f32 v224, v224
    v_exp_f32 v225, v225
    v_exp_f32 v226, v226
    v_smfmac_f32_32x32x32_bf16 v[144:159], v[104:107], v[208:215], v9
    v_exp_f32 v227, v227
    v_exp_f32 v228, v228
    v_exp_f32 v229, v229
    v_mfma_f32_32x32x16_bf16 v[240:255], v[100:103], v[60:63], v[240:255]
    v_exp_f32 v230, v230
    v_exp_f32 v231, v231
    v_exp_f32 v232, v232
    v_smfmac_f32_16x16x64_bf16 v[16:19], v[28:31], v[208:215], v9
    v_exp_f32 v233, v233
    v_smfmac_f32_32x32x32_bf16 v[144:159], v[108:111], v[216:223], v9
    v_exp_f32 v234, v234
    v_exp_f32 v235, v235
    v_exp_f32 v236, v236
    v_smfmac_f32_16x16x64_bf16 v[16:19], v[28:31], v[216:223], v9
    buffer_load_dwordx4 v[88:91], v1, s[4:7], s56 offen offset:0 sc1
    v_exp_f32 v237, v237
    v_exp_f32 v238, v238
    v_exp_f32 v239, v239
    s_waitcnt vmcnt(7)
    v_mfma_f32_32x32x16_bf16 v[192:207], v[112:115], v[32:35], 0
    v_exp_f32 v240, v240
    v_exp_f32 v241, v241
    v_exp_f32 v242, v242
    v_smfmac_f32_32x32x32_bf16 v[160:175], v[104:107], v[224:231], v9
    v_exp_f32 v243, v243
    v_exp_f32 v244, v244
    v_exp_f32 v245, v245
    v_mfma_f32_32x32x16_bf16 v[192:207], v[116:119], v[36:39], v[192:207]
    v_exp_f32 v246, v246
    v_exp_f32 v247, v247
    v_exp_f32 v248, v248
    v_smfmac_f32_16x16x64_bf16 v[20:23], v[28:31], v[224:231], v9
    v_exp_f32 v249, v249
    v_smfmac_f32_32x32x32_bf16 v[160:175], v[108:111], v[232:239], v9
    v_exp_f32 v250, v250
    v_exp_f32 v251, v251
    v_exp_f32 v252, v252
    v_smfmac_f32_16x16x64_bf16 v[20:23], v[28:31], v[232:239], v9
    buffer_load_dwordx4 v[92:95], v1, s[4:7], s56 offen offset:1024 sc1
    v_exp_f32 v253, v253
    v_exp_f32 v254, v254
    v_exp_f32 v255, v255
    s_barrier
    v_mfma_f32_32x32x16_bf16 v[208:223], v[112:115], v[40:43], 0
    s_add_u32 s54, s54, 8192
    s_and_b32 s54, s54, 0x1ffff
    s_add_u32 s55, s53, s54
    s_add_u32 s56, s55, 4194304
    ds_read_b128 v[32:35], v4 offset:8192
    ds_read_b128 v[36:39], v4 offset:9216
    v_exp_f32 v192, v192
    v_exp_f32 v193, v193
    v_exp_f32 v194, v194
    v_smfmac_f32_32x32x32_bf16 v[176:191], v[104:107], v[240:247], v9
    v_exp_f32 v195, v195
    v_exp_f32 v196, v196
    v_exp_f32 v197, v197
    v_mfma_f32_32x32x16_bf16 v[208:223], v[116:119], v[44:47], v[208:223]
    v_exp_f32 v198, v198
    v_exp_f32 v199, v199
    v_exp_f32 v200, v200
    v_smfmac_f32_16x16x64_bf16 v[24:27], v[28:31], v[240:247], v9
    v_exp_f32 v201, v201
    v_smfmac_f32_32x32x32_bf16 v[176:191], v[108:111], v[248:255], v9
    v_exp_f32 v202, v202
    v_exp_f32 v203, v203
    v_exp_f32 v204, v204
    v_smfmac_f32_16x16x64_bf16 v[24:27], v[28:31], v[248:255], v9
    buffer_load_dwordx4 v[96:99], v1, s[4:7], s55 offen offset:0 sc1
    v_exp_f32 v205, v205
    v_exp_f32 v206, v206
    v_exp_f32 v207, v207
    v_mfma_f32_32x32x16_bf16 v[224:239], v[112:115], v[48:51], 0
    ds_read_b128 v[40:43], v4 offset:10240
    ds_read_b128 v[44:47], v4 offset:11264
    v_exp_f32 v208, v208
    v_exp_f32 v209, v209
    v_exp_f32 v210, v210
    v_smfmac_f32_32x32x32_bf16 v[128:143], v[120:123], v[192:199], v9
    v_exp_f32 v211, v211
    v_exp_f32 v212, v212
    v_exp_f32 v213, v213
    v_mfma_f32_32x32x16_bf16 v[224:239], v[116:119], v[52:55], v[224:239]
    v_exp_f32 v214, v214
    v_exp_f32 v215, v215
    v_exp_f32 v216, v216
    v_smfmac_f32_16x16x64_bf16 v[12:15], v[28:31], v[192:199], v9
    v_exp_f32 v217, v217
    v_smfmac_f32_32x32x32_bf16 v[128:143], v[124:127], v[200:207], v9
    v_exp_f32 v218, v218
    v_exp_f32 v219, v219
    v_exp_f32 v220, v220
    v_smfmac_f32_16x16x64_bf16 v[12:15], v[28:31], v[200:207], v9
    buffer_load_dwordx4 v[100:103], v1, s[4:7], s55 offen offset:1024 sc1
    v_exp_f32 v221, v221
    v_exp_f32 v222, v222
    v_exp_f32 v223, v223
    v_mfma_f32_32x32x16_bf16 v[240:255], v[112:115], v[56:59], 0
    ds_read_b128 v[48:51], v4 offset:12288
    ds_read_b128 v[52:55], v4 offset:13312
    v_exp_f32 v224, v224
    v_exp_f32 v225, v225
    v_exp_f32 v226, v226
    v_smfmac_f32_32x32x32_bf16 v[144:159], v[120:123], v[208:215], v9
    v_exp_f32 v227, v227
    ds_write_b128 v5, v[128:131] offset:0
    v_exp_f32 v228, v228
    v_exp_f32 v229, v229
    v_mfma_f32_32x32x16_bf16 v[240:255], v[116:119], v[60:63], v[240:255]
    ds_write_b128 v5, v[132:135] offset:1024
    v_exp_f32 v230, v230
    v_exp_f32 v231, v231
    v_exp_f32 v232, v232
    v_smfmac_f32_16x16x64_bf16 v[16:19], v[28:31], v[208:215], v9
    ds_write_b32 v6, v12 offset:0
    v_exp_f32 v233, v233
    v_smfmac_f32_32x32x32_bf16 v[144:159], v[124:127], v[216:223], v9
    ds_write_b128 v5, v[136:139] offset:2048
    v_exp_f32 v234, v234
    v_exp_f32 v235, v235
    v_exp_f32 v236, v236
    v_smfmac_f32_16x16x64_bf16 v[16:19], v[28:31], v[216:223], v9
    buffer_load_dwordx4 v[104:107], v1, s[4:7], s56 offen offset:0 sc1
    ds_write_b128 v5, v[140:143] offset:3072
    v_exp_f32 v237, v237
    v_exp_f32 v238, v238
    v_exp_f32 v239, v239
    s_waitcnt vmcnt(7)
    s_waitcnt lgkmcnt(9)
    v_mfma_f32_32x32x16_bf16 v[192:207], v[64:67], v[32:35], 0
    ds_read_b128 v[56:59], v4 offset:14336
    ds_read_b128 v[60:63], v4 offset:15360
    v_exp_f32 v240, v240
    v_exp_f32 v241, v241
    v_exp_f32 v242, v242
    v_smfmac_f32_32x32x32_bf16 v[160:175], v[120:123], v[224:231], v9
    v_exp_f32 v243, v243
    ds_write_b128 v5, v[144:147] offset:16384
    v_exp_f32 v244, v244
    v_exp_f32 v245, v245
    v_mfma_f32_32x32x16_bf16 v[192:207], v[68:71], v[36:39], v[192:207]
    ds_write_b128 v5, v[148:151] offset:17408
    v_exp_f32 v246, v246
    v_exp_f32 v247, v247
    v_exp_f32 v248, v248
    s_waitcnt lgkmcnt(4)
    v_mfma_f32_32x32x8_bf16 v[128:143], v[10:11], v[10:11], 0
    v_mov_b32 v12, 0
    v_smfmac_f32_16x16x64_bf16 v[20:23], v[28:31], v[224:231], v9
    ds_write_b32 v6, v16 offset:1024
    v_exp_f32 v249, v249
    v_smfmac_f32_32x32x32_bf16 v[160:175], v[124:127], v[232:239], v9
    ds_write_b128 v5, v[152:155] offset:18432
    v_exp_f32 v250, v250
    v_exp_f32 v251, v251
    v_exp_f32 v252, v252
    v_smfmac_f32_16x16x64_bf16 v[20:23], v[28:31], v[232:239], v9
    buffer_load_dwordx4 v[108:111], v1, s[4:7], s56 offen offset:1024 sc1
    ds_write_b128 v5, v[156:159] offset:19456
    v_exp_f32 v253, v253
    v_exp_f32 v254, v254
    v_exp_f32 v255, v255
    s_cmp_lg_u32 s57, 0
    s_cbranch_scc1 b_tail
    v_mfma_f32_32x32x16_bf16 v[208:223], v[64:67], v[40:43], 0
    s_add_u32 s54, s54, 8192
    s_and_b32 s54, s54, 0x1ffff
    s_add_u32 s55, s53, s54
    s_add_u32 s56, s55, 4194304
    v_exp_f32 v192, v192
    v_exp_f32 v193, v193
    v_exp_f32 v194, v194
    v_smfmac_f32_32x32x32_bf16 v[176:191], v[120:123], v[240:247], v9
    v_exp_f32 v195, v195
    ds_write_b128 v5, v[160:163] offset:32768
    v_exp_f32 v196, v196
    v_exp_f32 v197, v197
    v_mfma_f32_32x32x16_bf16 v[208:223], v[68:71], v[44:47], v[208:223]
    ds_write_b128 v5, v[164:167] offset:33792
    v_exp_f32 v198, v198
    v_exp_f32 v199, v199
    v_exp_f32 v200, v200
    s_waitcnt lgkmcnt(2)
    v_mfma_f32_32x32x8_bf16 v[144:159], v[10:11], v[10:11], 0
    v_mov_b32 v16, 0
    v_smfmac_f32_16x16x64_bf16 v[24:27], v[28:31], v[240:247], v9
    ds_write_b32 v6, v20 offset:2048
    v_exp_f32 v201, v201
    v_smfmac_f32_32x32x32_bf16 v[176:191], v[124:127], v[248:255], v9
    ds_write_b128 v5, v[168:171] offset:34816
    v_exp_f32 v202, v202
    v_exp_f32 v203, v203
    v_exp_f32 v204, v204
    v_smfmac_f32_16x16x64_bf16 v[24:27], v[28:31], v[248:255], v9
    buffer_load_dwordx4 v[112:115], v1, s[4:7], s55 offen offset:0 sc1
    ds_write_b128 v5, v[172:175] offset:35840
    v_exp_f32 v205, v205
    v_exp_f32 v206, v206
    v_exp_f32 v207, v207
    v_mfma_f32_32x32x16_bf16 v[224:239], v[64:67], v[48:51], 0
    v_exp_f32 v208, v208
    v_exp_f32 v209, v209
    v_exp_f32 v210, v210
    v_smfmac_f32_32x32x32_bf16 v[128:143], v[72:75], v[192:199], v9
    v_exp_f32 v211, v211
    ds_write_b128 v5, v[176:179] offset:49152
    v_exp_f32 v212, v212
    v_exp_f32 v213, v213
    v_mfma_f32_32x32x16_bf16 v[224:239], v[68:71], v[52:55], v[224:239]
    ds_write_b128 v5, v[180:183] offset:50176
    v_exp_f32 v214, v214
    v_exp_f32 v215, v215
    v_exp_f32 v216, v216
    s_waitcnt lgkmcnt(2)
    v_mfma_f32_32x32x8_bf16 v[160:175], v[10:11], v[10:11], 0
    v_mov_b32 v20, 0
    v_smfmac_f32_16x16x64_bf16 v[12:15], v[28:31], v[192:199], v9
    ds_write_b32 v6, v24 offset:3072
    v_exp_f32 v217, v217
    v_smfmac_f32_32x32x32_bf16 v[128:143], v[76:79], v[200:207], v9
    ds_write_b128 v5, v[184:187] offset:51200
    v_exp_f32 v218, v218
    v_exp_f32 v219, v219
    v_exp_f32 v220, v220
    v_smfmac_f32_16x16x64_bf16 v[12:15], v[28:31], v[200:207], v9
    buffer_load_dwordx4 v[116:119], v1, s[4:7], s55 offen offset:1024 sc1
    ds_write_b128 v5, v[188:191] offset:52224
    v_exp_f32 v221, v221
    v_exp_f32 v222, v222
    v_exp_f32 v223, v223
    s_waitcnt lgkmcnt(0)
    v_mfma_f32_32x32x8_bf16 v[176:191], v[10:11], v[10:11], 0
    v_mov_b32 v24, 0
    s_barrier
    s_mov_b32 s57, 1
    s_branch b_head
b_tail:
    v_smfmac_f32_32x32x32_bf16 v[176:191], v[120:123], v[240:247], v9
    v_smfmac_f32_32x32x32_bf16 v[176:191], v[124:127], v[248:255], v9
    ds_write_b128 v5, v[160:163] offset:32768
    ds_write_b128 v5, v[164:167] offset:33792
    v_smfmac_f32_16x16x64_bf16 v[24:27], v[28:31], v[240:247], v9
    ds_write_b128 v5, v[168:171] offset:34816
    v_smfmac_f32_16x16x64_bf16 v[24:27], v[28:31], v[248:255], v9
    ds_write_b128 v5, v[172:175] offset:35840
    ds_write_b32 v6, v20 offset:2048
    s_nop 4
    ds_write_b128 v5, v[176:179] offset:49152
    ds_write_b128 v5, v[180:183] offset:50176
    ds_write_b128 v5, v[184:187] offset:51200
    ds_write_b128 v5, v[188:191] offset:52224
    s_nop 0
    ds_write_b32 v6, v24 offset:3072
    buffer_load_dwordx4 v[224:227], v2, s[4:7], s43 offen offset:0 sc1
    buffer_load_dwordx4 v[228:231], v2, s[4:7], s43 offen offset:256 sc1
    buffer_load_dwordx4 v[232:235], v2, s[4:7], s43 offen offset:2048 sc1
    buffer_load_dwordx4 v[236:239], v2, s[4:7], s43 offen offset:2304 sc1
    s_waitcnt lgkmcnt(0)
    s_barrier
    v_xor_b32 v4, 32, v3
    v_xor_b32 v5, 64, v3
    v_xor_b32 v6, 96, v3
c_wo:
    s_xor_b32 s42, s41, 0
    buffer_load_dwordx4 v[64:67], v2, s[4:7], s42 offen offset:0 sc1
    buffer_load_dwordx4 v[68:71], v2, s[4:7], s42 offen offset:256 sc1
    s_xor_b32 s42, s41, 4096
    buffer_load_dwordx4 v[72:75], v2, s[4:7], s42 offen offset:0 sc1
    buffer_load_dwordx4 v[76:79], v2, s[4:7], s42 offen offset:256 sc1
    s_xor_b32 s42, s41, 8192
    buffer_load_dwordx4 v[80:83], v2, s[4:7], s42 offen offset:0 sc1
    buffer_load_dwordx4 v[84:87], v2, s[4:7], s42 offen offset:256 sc1
    s_xor_b32 s42, s41, 12288
    buffer_load_dwordx4 v[88:91], v2, s[4:7], s42 offen offset:0 sc1
    buffer_load_dwordx4 v[92:95], v2, s[4:7], s42 offen offset:256 sc1
    s_xor_b32 s42, s41, 16384
    buffer_load_dwordx4 v[96:99], v2, s[4:7], s42 offen offset:0 sc1
    buffer_load_dwordx4 v[100:103], v2, s[4:7], s42 offen offset:256 sc1
    ds_read_b64_tr_b16 v[32:33], v3 offset:0
    ds_read_b64_tr_b16 v[34:35], v3 offset:1024
    ds_read_b64_tr_b16 v[36:37], v4 offset:0
    ds_read_b64_tr_b16 v[38:39], v4 offset:1024
    ds_read_b64_tr_b16 v[40:41], v5 offset:0
    ds_read_b64_tr_b16 v[42:43], v5 offset:1024
    ds_read_b64_tr_b16 v[44:45], v6 offset:0
    ds_read_b64_tr_b16 v[46:47], v6 offset:1024
    ds_read_b64_tr_b16 v[48:49], v3 offset:4096
    ds_read_b64_tr_b16 v[50:51], v3 offset:5120
    ds_read_b64_tr_b16 v[52:53], v4 offset:4096
    ds_read_b64_tr_b16 v[54:55], v4 offset:5120
    ds_read_b64_tr_b16 v[56:57], v5 offset:4096
    ds_read_b64_tr_b16 v[58:59], v5 offset:5120
    v_lshrrev_b32 v12, 4, v1
    v_and_b32 v13, 1, v12
    v_lshlrev_b32 v13, 4, v13
    v_mov_b32 v14, 0x3f80
    v_lshlrev_b32 v13, v13, v14
    v_lshrrev_b32 v14, 2, v12
    v_lshrrev_b32 v15, 4, v12
    v_xor_b32 v14, v14, v15
    v_and_b32 v14, 1, v14
    v_bfe_u32 v15, v12, 3, 1
    v_bfe_u32 v16, v12, 1, 1
    v_lshl_add_u32 v15, v15, 1, v16
    v_lshrrev_b32 v16, 5, v12
    v_lshl_add_u32 v15, v16, 2, v15
    v_lshl_add_u32 v15, v14, 3, v15
    v_cmp_eq_u32 vcc, 0, v15
    s_nop 1
    v_cndmask_b32 v240, 0, v13, vcc
    v_cmp_eq_u32 vcc, 1, v15
    s_nop 1
    v_cndmask_b32 v241, 0, v13, vcc
    v_cmp_eq_u32 vcc, 2, v15
    s_nop 1
    v_cndmask_b32 v242, 0, v13, vcc
    v_cmp_eq_u32 vcc, 3, v15
    s_nop 1
    v_cndmask_b32 v243, 0, v13, vcc
    v_cmp_eq_u32 vcc, 4, v15
    s_nop 1
    v_cndmask_b32 v244, 0, v13, vcc
    v_cmp_eq_u32 vcc, 5, v15
    s_nop 1
    v_cndmask_b32 v245, 0, v13, vcc
    v_cmp_eq_u32 vcc, 6, v15
    s_nop 1
    v_cndmask_b32 v246, 0, v13, vcc
    v_cmp_eq_u32 vcc, 7, v15
    s_nop 1
    v_cndmask_b32 v247, 0, v13, vcc
    s_waitcnt vmcnt(10)
    v_mfma_f32_16x16x32_bf16 v[128:131], v[240:243], v[224:227], 0
    v_mfma_f32_16x16x32_bf16 v[132:135], v[240:243], v[228:231], 0
    v_mfma_f32_16x16x32_bf16 v[136:139], v[244:247], v[224:227], 0
    v_mfma_f32_16x16x32_bf16 v[140:143], v[244:247], v[228:231], 0
    v_mfma_f32_16x16x32_bf16 v[144:147], v[240:243], v[232:235], 0
    v_mfma_f32_16x16x32_bf16 v[148:151], v[240:243], v[236:239], 0
    v_mfma_f32_16x16x32_bf16 v[152:155], v[244:247], v[232:235], 0
    v_mfma_f32_16x16x32_bf16 v[156:159], v[244:247], v[236:239], 0
    s_waitcnt vmcnt(8) lgkmcnt(10)
    v_mfma_f32_16x16x32_bf16 v[128:131], v[32:35], v[64:67], v[128:131]
    ds_read_b64_tr_b16 v[60:61], v6 offset:4096
    s_xor_b32 s42, s41, 20480
    buffer_load_dwordx4 v[104:107], v2, s[4:7], s42 offen offset:0 sc1
    v_mfma_f32_16x16x32_bf16 v[132:135], v[32:35], v[68:71], v[132:135]
    ds_read_b64_tr_b16 v[62:63], v6 offset:5120
    v_mfma_f32_16x16x32_bf16 v[136:139], v[36:39], v[64:67], v[136:139]
    ds_read_b64_tr_b16 v[32:33], v3 offset:8192
    v_mfma_f32_16x16x32_bf16 v[140:143], v[36:39], v[68:71], v[140:143]
    ds_read_b64_tr_b16 v[34:35], v3 offset:9216
    s_waitcnt lgkmcnt(10)
    v_mfma_f32_16x16x32_bf16 v[144:147], v[40:43], v[64:67], v[144:147]
    buffer_load_dwordx4 v[108:111], v2, s[4:7], s42 offen offset:256 sc1
    ds_read_b64_tr_b16 v[36:37], v4 offset:8192
    s_xor_b32 s42, s41, 24576
    v_mfma_f32_16x16x32_bf16 v[148:151], v[40:43], v[68:71], v[148:151]
    ds_read_b64_tr_b16 v[38:39], v4 offset:9216
    v_mfma_f32_16x16x32_bf16 v[152:155], v[44:47], v[64:67], v[152:155]
    ds_read_b64_tr_b16 v[40:41], v5 offset:8192
    v_mfma_f32_16x16x32_bf16 v[156:159], v[44:47], v[68:71], v[156:159]
    ds_read_b64_tr_b16 v[42:43], v5 offset:9216
    s_waitcnt vmcnt(8) lgkmcnt(10)
    v_mfma_f32_16x16x32_bf16 v[128:131], v[48:51], v[72:75], v[128:131]
    buffer_load_dwordx4 v[112:115], v2, s[4:7], s42 offen offset:0 sc1
    ds_read_b64_tr_b16 v[44:45], v6 offset:8192
    v_mfma_f32_16x16x32_bf16 v[132:135], v[48:51], v[76:79], v[132:135]
    ds_read_b64_tr_b16 v[46:47], v6 offset:9216
    v_mfma_f32_16x16x32_bf16 v[136:139], v[52:55], v[72:75], v[136:139]
    ds_read_b64_tr_b16 v[48:49], v3 offset:12288
    v_mfma_f32_16x16x32_bf16 v[140:143], v[52:55], v[76:79], v[140:143]
    ds_read_b64_tr_b16 v[50:51], v3 offset:13312
    s_waitcnt lgkmcnt(10)
    v_mfma_f32_16x16x32_bf16 v[144:147], v[56:59], v[72:75], v[144:147]
    buffer_load_dwordx4 v[116:119], v2, s[4:7], s42 offen offset:256 sc1
    ds_read_b64_tr_b16 v[52:53], v4 offset:12288
    s_xor_b32 s42, s41, 28672
    v_mfma_f32_16x16x32_bf16 v[148:151], v[56:59], v[76:79], v[148:151]
    ds_read_b64_tr_b16 v[54:55], v4 offset:13312
    v_mfma_f32_16x16x32_bf16 v[152:155], v[60:63], v[72:75], v[152:155]
    ds_read_b64_tr_b16 v[56:57], v5 offset:12288
    v_mfma_f32_16x16x32_bf16 v[156:159], v[60:63], v[76:79], v[156:159]
    ds_read_b64_tr_b16 v[58:59], v5 offset:13312
    s_waitcnt vmcnt(8) lgkmcnt(10)
    v_mfma_f32_16x16x32_bf16 v[128:131], v[32:35], v[80:83], v[128:131]
    ds_read_b64_tr_b16 v[60:61], v6 offset:12288
    buffer_load_dwordx4 v[120:123], v2, s[4:7], s42 offen offset:0 sc1
    v_mfma_f32_16x16x32_bf16 v[132:135], v[32:35], v[84:87], v[132:135]
    ds_read_b64_tr_b16 v[62:63], v6 offset:13312
    v_mfma_f32_16x16x32_bf16 v[136:139], v[36:39], v[80:83], v[136:139]
    ds_read_b64_tr_b16 v[32:33], v3 offset:16384
    v_mfma_f32_16x16x32_bf16 v[140:143], v[36:39], v[84:87], v[140:143]
    ds_read_b64_tr_b16 v[34:35], v3 offset:17408
    s_waitcnt lgkmcnt(10)
    v_mfma_f32_16x16x32_bf16 v[144:147], v[40:43], v[80:83], v[144:147]
    buffer_load_dwordx4 v[124:127], v2, s[4:7], s42 offen offset:256 sc1
    ds_read_b64_tr_b16 v[36:37], v4 offset:16384
    s_xor_b32 s42, s41, 32768
    v_mfma_f32_16x16x32_bf16 v[148:151], v[40:43], v[84:87], v[148:151]
    ds_read_b64_tr_b16 v[38:39], v4 offset:17408
    v_mfma_f32_16x16x32_bf16 v[152:155], v[44:47], v[80:83], v[152:155]
    ds_read_b64_tr_b16 v[40:41], v5 offset:16384
    v_mfma_f32_16x16x32_bf16 v[156:159], v[44:47], v[84:87], v[156:159]
    ds_read_b64_tr_b16 v[42:43], v5 offset:17408
    s_waitcnt vmcnt(8) lgkmcnt(10)
    v_mfma_f32_16x16x32_bf16 v[128:131], v[48:51], v[88:91], v[128:131]
    buffer_load_dwordx4 v[160:163], v2, s[4:7], s42 offen offset:0 sc1
    ds_read_b64_tr_b16 v[44:45], v6 offset:16384
    v_mfma_f32_16x16x32_bf16 v[132:135], v[48:51], v[92:95], v[132:135]
    ds_read_b64_tr_b16 v[46:47], v6 offset:17408
    v_mfma_f32_16x16x32_bf16 v[136:139], v[52:55], v[88:91], v[136:139]
    ds_read_b64_tr_b16 v[48:49], v3 offset:20480
    v_mfma_f32_16x16x32_bf16 v[140:143], v[52:55], v[92:95], v[140:143]
    ds_read_b64_tr_b16 v[50:51], v3 offset:21504
    s_waitcnt lgkmcnt(10)
    v_mfma_f32_16x16x32_bf16 v[144:147], v[56:59], v[88:91], v[144:147]
    buffer_load_dwordx4 v[164:167], v2, s[4:7], s42 offen offset:256 sc1
    ds_read_b64_tr_b16 v[52:53], v4 offset:20480
    s_xor_b32 s42, s41, 36864
    v_mfma_f32_16x16x32_bf16 v[148:151], v[56:59], v[92:95], v[148:151]
    ds_read_b64_tr_b16 v[54:55], v4 offset:21504
    v_mfma_f32_16x16x32_bf16 v[152:155], v[60:63], v[88:91], v[152:155]
    ds_read_b64_tr_b16 v[56:57], v5 offset:20480
    v_mfma_f32_16x16x32_bf16 v[156:159], v[60:63], v[92:95], v[156:159]
    ds_read_b64_tr_b16 v[58:59], v5 offset:21504
    s_waitcnt vmcnt(8) lgkmcnt(10)
    v_mfma_f32_16x16x32_bf16 v[128:131], v[32:35], v[96:99], v[128:131]
    ds_read_b64_tr_b16 v[60:61], v6 offset:20480
    buffer_load_dwordx4 v[168:171], v2, s[4:7], s42 offen offset:0 sc1
    v_mfma_f32_16x16x32_bf16 v[132:135], v[32:35], v[100:103], v[132:135]
    ds_read_b64_tr_b16 v[62:63], v6 offset:21504
    v_mfma_f32_16x16x32_bf16 v[136:139], v[36:39], v[96:99], v[136:139]
    ds_read_b64_tr_b16 v[32:33], v3 offset:24576
    v_mfma_f32_16x16x32_bf16 v[140:143], v[36:39], v[100:103], v[140:143]
    ds_read_b64_tr_b16 v[34:35], v3 offset:25600
    s_waitcnt lgkmcnt(10)
    v_mfma_f32_16x16x32_bf16 v[144:147], v[40:43], v[96:99], v[144:147]
    buffer_load_dwordx4 v[172:175], v2, s[4:7], s42 offen offset:256 sc1
    ds_read_b64_tr_b16 v[36:37], v4 offset:24576
    s_xor_b32 s42, s41, 40960
    v_mfma_f32_16x16x32_bf16 v[148:151], v[40:43], v[100:103], v[148:151]
    ds_read_b64_tr_b16 v[38:39], v4 offset:25600
    v_mfma_f32_16x16x32_bf16 v[152:155], v[44:47], v[96:99], v[152:155]
    ds_read_b64_tr_b16 v[40:41], v5 offset:24576
    v_mfma_f32_16x16x32_bf16 v[156:159], v[44:47], v[100:103], v[156:159]
    ds_read_b64_tr_b16 v[42:43], v5 offset:25600
    s_waitcnt vmcnt(8) lgkmcnt(10)
    v_mfma_f32_16x16x32_bf16 v[128:131], v[48:51], v[104:107], v[128:131]
    buffer_load_dwordx4 v[176:179], v2, s[4:7], s42 offen offset:0 sc1
    ds_read_b64_tr_b16 v[44:45], v6 offset:24576
    v_mfma_f32_16x16x32_bf16 v[132:135], v[48:51], v[108:111], v[132:135]
    ds_read_b64_tr_b16 v[46:47], v6 offset:25600
    v_mfma_f32_16x16x32_bf16 v[136:139], v[52:55], v[104:107], v[136:139]
    ds_read_b64_tr_b16 v[48:49], v3 offset:28672
    v_mfma_f32_16x16x32_bf16 v[140:143], v[52:55], v[108:111], v[140:143]
    ds_read_b64_tr_b16 v[50:51], v3 offset:29696
    s_waitcnt lgkmcnt(10)
    v_mfma_f32_16x16x32_bf16 v[144:147], v[56:59], v[104:107], v[144:147]
    buffer_load_dwordx4 v[180:183], v2, s[4:7], s42 offen offset:256 sc1
    ds_read_b64_tr_b16 v[52:53], v4 offset:28672
    s_xor_b32 s42, s41, 45056
    v_mfma_f32_16x16x32_bf16 v[148:151], v[56:59], v[108:111], v[148:151]
    ds_read_b64_tr_b16 v[54:55], v4 offset:29696
    v_mfma_f32_16x16x32_bf16 v[152:155], v[60:63], v[104:107], v[152:155]
    ds_read_b64_tr_b16 v[56:57], v5 offset:28672
    v_mfma_f32_16x16x32_bf16 v[156:159], v[60:63], v[108:111], v[156:159]
    ds_read_b64_tr_b16 v[58:59], v5 offset:29696
    s_waitcnt vmcnt(8) lgkmcnt(10)
    v_mfma_f32_16x16x32_bf16 v[128:131], v[32:35], v[112:115], v[128:131]
    ds_read_b64_tr_b16 v[60:61], v6 offset:28672
    buffer_load_dwordx4 v[184:187], v2, s[4:7], s42 offen offset:0 sc1
    v_mfma_f32_16x16x32_bf16 v[132:135], v[32:35], v[116:119], v[132:135]
    ds_read_b64_tr_b16 v[62:63], v6 offset:29696
    v_mfma_f32_16x16x32_bf16 v[136:139], v[36:39], v[112:115], v[136:139]
    ds_read_b64_tr_b16 v[32:33], v3 offset:32768
    v_mfma_f32_16x16x32_bf16 v[140:143], v[36:39], v[116:119], v[140:143]
    ds_read_b64_tr_b16 v[34:35], v3 offset:33792
    s_waitcnt lgkmcnt(10)
    v_mfma_f32_16x16x32_bf16 v[144:147], v[40:43], v[112:115], v[144:147]
    buffer_load_dwordx4 v[188:191], v2, s[4:7], s42 offen offset:256 sc1
    ds_read_b64_tr_b16 v[36:37], v4 offset:32768
    s_xor_b32 s42, s41, 49152
    v_mfma_f32_16x16x32_bf16 v[148:151], v[40:43], v[116:119], v[148:151]
    ds_read_b64_tr_b16 v[38:39], v4 offset:33792
    v_mfma_f32_16x16x32_bf16 v[152:155], v[44:47], v[112:115], v[152:155]
    ds_read_b64_tr_b16 v[40:41], v5 offset:32768
    v_mfma_f32_16x16x32_bf16 v[156:159], v[44:47], v[116:119], v[156:159]
    ds_read_b64_tr_b16 v[42:43], v5 offset:33792
    s_waitcnt vmcnt(8) lgkmcnt(10)
    v_mfma_f32_16x16x32_bf16 v[128:131], v[48:51], v[120:123], v[128:131]
    buffer_load_dwordx4 v[64:67], v2, s[4:7], s42 offen offset:0 sc1
    ds_read_b64_tr_b16 v[44:45], v6 offset:32768
    v_mfma_f32_16x16x32_bf16 v[132:135], v[48:51], v[124:127], v[132:135]
    ds_read_b64_tr_b16 v[46:47], v6 offset:33792
    v_mfma_f32_16x16x32_bf16 v[136:139], v[52:55], v[120:123], v[136:139]
    ds_read_b64_tr_b16 v[48:49], v3 offset:36864
    v_mfma_f32_16x16x32_bf16 v[140:143], v[52:55], v[124:127], v[140:143]
    ds_read_b64_tr_b16 v[50:51], v3 offset:37888
    s_waitcnt lgkmcnt(10)
    v_mfma_f32_16x16x32_bf16 v[144:147], v[56:59], v[120:123], v[144:147]
    buffer_load_dwordx4 v[68:71], v2, s[4:7], s42 offen offset:256 sc1
    ds_read_b64_tr_b16 v[52:53], v4 offset:36864
    s_xor_b32 s42, s41, 53248
    v_mfma_f32_16x16x32_bf16 v[148:151], v[56:59], v[124:127], v[148:151]
    ds_read_b64_tr_b16 v[54:55], v4 offset:37888
    v_mfma_f32_16x16x32_bf16 v[152:155], v[60:63], v[120:123], v[152:155]
    ds_read_b64_tr_b16 v[56:57], v5 offset:36864
    v_mfma_f32_16x16x32_bf16 v[156:159], v[60:63], v[124:127], v[156:159]
    ds_read_b64_tr_b16 v[58:59], v5 offset:37888
    s_waitcnt vmcnt(8) lgkmcnt(10)
    v_mfma_f32_16x16x32_bf16 v[128:131], v[32:35], v[160:163], v[128:131]
    ds_read_b64_tr_b16 v[60:61], v6 offset:36864
    buffer_load_dwordx4 v[72:75], v2, s[4:7], s42 offen offset:0 sc1
    v_mfma_f32_16x16x32_bf16 v[132:135], v[32:35], v[164:167], v[132:135]
    ds_read_b64_tr_b16 v[62:63], v6 offset:37888
    v_mfma_f32_16x16x32_bf16 v[136:139], v[36:39], v[160:163], v[136:139]
    ds_read_b64_tr_b16 v[32:33], v3 offset:40960
    v_mfma_f32_16x16x32_bf16 v[140:143], v[36:39], v[164:167], v[140:143]
    ds_read_b64_tr_b16 v[34:35], v3 offset:41984
    s_waitcnt lgkmcnt(10)
    v_mfma_f32_16x16x32_bf16 v[144:147], v[40:43], v[160:163], v[144:147]
    buffer_load_dwordx4 v[76:79], v2, s[4:7], s42 offen offset:256 sc1
    ds_read_b64_tr_b16 v[36:37], v4 offset:40960
    s_xor_b32 s42, s41, 57344
    v_mfma_f32_16x16x32_bf16 v[148:151], v[40:43], v[164:167], v[148:151]
    ds_read_b64_tr_b16 v[38:39], v4 offset:41984
    v_mfma_f32_16x16x32_bf16 v[152:155], v[44:47], v[160:163], v[152:155]
    ds_read_b64_tr_b16 v[40:41], v5 offset:40960
    v_mfma_f32_16x16x32_bf16 v[156:159], v[44:47], v[164:167], v[156:159]
    ds_read_b64_tr_b16 v[42:43], v5 offset:41984
    s_waitcnt vmcnt(8) lgkmcnt(10)
    v_mfma_f32_16x16x32_bf16 v[128:131], v[48:51], v[168:171], v[128:131]
    buffer_load_dwordx4 v[80:83], v2, s[4:7], s42 offen offset:0 sc1
    ds_read_b64_tr_b16 v[44:45], v6 offset:40960
    v_mfma_f32_16x16x32_bf16 v[132:135], v[48:51], v[172:175], v[132:135]
    ds_read_b64_tr_b16 v[46:47], v6 offset:41984
    v_mfma_f32_16x16x32_bf16 v[136:139], v[52:55], v[168:171], v[136:139]
    ds_read_b64_tr_b16 v[48:49], v3 offset:45056
    v_mfma_f32_16x16x32_bf16 v[140:143], v[52:55], v[172:175], v[140:143]
    ds_read_b64_tr_b16 v[50:51], v3 offset:46080
    s_waitcnt lgkmcnt(10)
    v_mfma_f32_16x16x32_bf16 v[144:147], v[56:59], v[168:171], v[144:147]
    buffer_load_dwordx4 v[84:87], v2, s[4:7], s42 offen offset:256 sc1
    ds_read_b64_tr_b16 v[52:53], v4 offset:45056
    s_xor_b32 s42, s41, 61440
    v_mfma_f32_16x16x32_bf16 v[148:151], v[56:59], v[172:175], v[148:151]
    ds_read_b64_tr_b16 v[54:55], v4 offset:46080
    v_mfma_f32_16x16x32_bf16 v[152:155], v[60:63], v[168:171], v[152:155]
    ds_read_b64_tr_b16 v[56:57], v5 offset:45056
    v_mfma_f32_16x16x32_bf16 v[156:159], v[60:63], v[172:175], v[156:159]
    ds_read_b64_tr_b16 v[58:59], v5 offset:46080
    s_waitcnt vmcnt(8) lgkmcnt(10)
    v_mfma_f32_16x16x32_bf16 v[128:131], v[32:35], v[176:179], v[128:131]
    ds_read_b64_tr_b16 v[60:61], v6 offset:45056
    buffer_load_dwordx4 v[88:91], v2, s[4:7], s42 offen offset:0 sc1
    v_mfma_f32_16x16x32_bf16 v[132:135], v[32:35], v[180:183], v[132:135]
    ds_read_b64_tr_b16 v[62:63], v6 offset:46080
    s_barrier
    v_mfma_f32_16x16x32_bf16 v[136:139], v[36:39], v[176:179], v[136:139]
    ds_read_b64_tr_b16 v[32:33], v3 offset:49152
    v_mfma_f32_16x16x32_bf16 v[140:143], v[36:39], v[180:183], v[140:143]
    ds_read_b64_tr_b16 v[34:35], v3 offset:50176
    s_waitcnt lgkmcnt(10)
    v_mfma_f32_16x16x32_bf16 v[144:147], v[40:43], v[176:179], v[144:147]
    buffer_load_dwordx4 v[92:95], v2, s[4:7], s42 offen offset:256 sc1
    ds_read_b64_tr_b16 v[36:37], v4 offset:49152
    s_xor_b32 s42, s41, 0
    v_mfma_f32_16x16x32_bf16 v[148:151], v[40:43], v[180:183], v[148:151]
    ds_read_b64_tr_b16 v[38:39], v4 offset:50176
    v_mfma_f32_16x16x32_bf16 v[152:155], v[44:47], v[176:179], v[152:155]
    ds_read_b64_tr_b16 v[40:41], v5 offset:49152
    v_mfma_f32_16x16x32_bf16 v[156:159], v[44:47], v[180:183], v[156:159]
    ds_read_b64_tr_b16 v[42:43], v5 offset:50176
    s_waitcnt vmcnt(8) lgkmcnt(10)
    v_mfma_f32_16x16x32_bf16 v[128:131], v[48:51], v[184:187], v[128:131]
    buffer_load_dwordx4 v[96:99], v2, s[4:7], s42 offen offset:2048 sc1
    ds_read_b64_tr_b16 v[44:45], v6 offset:49152
    v_mfma_f32_16x16x32_bf16 v[132:135], v[48:51], v[188:191], v[132:135]
    ds_read_b64_tr_b16 v[46:47], v6 offset:50176
    v_mfma_f32_16x16x32_bf16 v[136:139], v[52:55], v[184:187], v[136:139]
    ds_read_b64_tr_b16 v[48:49], v3 offset:53248
    v_mfma_f32_16x16x32_bf16 v[140:143], v[52:55], v[188:191], v[140:143]
    ds_read_b64_tr_b16 v[50:51], v3 offset:54272
    s_waitcnt lgkmcnt(10)
    v_mfma_f32_16x16x32_bf16 v[144:147], v[56:59], v[184:187], v[144:147]
    buffer_load_dwordx4 v[100:103], v2, s[4:7], s42 offen offset:2304 sc1
    ds_read_b64_tr_b16 v[52:53], v4 offset:53248
    s_xor_b32 s42, s41, 4096
    v_mfma_f32_16x16x32_bf16 v[148:151], v[56:59], v[188:191], v[148:151]
    ds_read_b64_tr_b16 v[54:55], v4 offset:54272
    v_mfma_f32_16x16x32_bf16 v[152:155], v[60:63], v[184:187], v[152:155]
    ds_read_b64_tr_b16 v[56:57], v5 offset:53248
    v_mfma_f32_16x16x32_bf16 v[156:159], v[60:63], v[188:191], v[156:159]
    ds_read_b64_tr_b16 v[58:59], v5 offset:54272
    s_waitcnt vmcnt(8) lgkmcnt(10)
    v_mfma_f32_16x16x32_bf16 v[128:131], v[32:35], v[64:67], v[128:131]
    ds_read_b64_tr_b16 v[60:61], v6 offset:53248
    buffer_load_dwordx4 v[104:107], v2, s[4:7], s42 offen offset:2048 sc1
    v_mfma_f32_16x16x32_bf16 v[132:135], v[32:35], v[68:71], v[132:135]
    ds_read_b64_tr_b16 v[62:63], v6 offset:54272
    v_mfma_f32_16x16x32_bf16 v[136:139], v[36:39], v[64:67], v[136:139]
    ds_read_b64_tr_b16 v[32:33], v3 offset:57344
    v_mfma_f32_16x16x32_bf16 v[140:143], v[36:39], v[68:71], v[140:143]
    ds_read_b64_tr_b16 v[34:35], v3 offset:58368
    s_waitcnt lgkmcnt(10)
    v_mfma_f32_16x16x32_bf16 v[144:147], v[40:43], v[64:67], v[144:147]
    buffer_load_dwordx4 v[108:111], v2, s[4:7], s42 offen offset:2304 sc1
    ds_read_b64_tr_b16 v[36:37], v4 offset:57344
    s_xor_b32 s42, s41, 8192
    v_mfma_f32_16x16x32_bf16 v[148:151], v[40:43], v[68:71], v[148:151]
    ds_read_b64_tr_b16 v[38:39], v4 offset:58368
    v_mfma_f32_16x16x32_bf16 v[152:155], v[44:47], v[64:67], v[152:155]
    ds_read_b64_tr_b16 v[40:41], v5 offset:57344
    v_mfma_f32_16x16x32_bf16 v[156:159], v[44:47], v[68:71], v[156:159]
    ds_read_b64_tr_b16 v[42:43], v5 offset:58368
    s_waitcnt vmcnt(8) lgkmcnt(10)
    v_mfma_f32_16x16x32_bf16 v[128:131], v[48:51], v[72:75], v[128:131]
    buffer_load_dwordx4 v[112:115], v2, s[4:7], s42 offen offset:2048 sc1
    ds_read_b64_tr_b16 v[44:45], v6 offset:57344
    v_mfma_f32_16x16x32_bf16 v[132:135], v[48:51], v[76:79], v[132:135]
    ds_read_b64_tr_b16 v[46:47], v6 offset:58368
    v_mfma_f32_16x16x32_bf16 v[136:139], v[52:55], v[72:75], v[136:139]
    ds_read_b64_tr_b16 v[48:49], v3 offset:61440
    v_mfma_f32_16x16x32_bf16 v[140:143], v[52:55], v[76:79], v[140:143]
    ds_read_b64_tr_b16 v[50:51], v3 offset:62464
    s_waitcnt lgkmcnt(10)
    v_mfma_f32_16x16x32_bf16 v[144:147], v[56:59], v[72:75], v[144:147]
    buffer_load_dwordx4 v[116:119], v2, s[4:7], s42 offen offset:2304 sc1
    ds_read_b64_tr_b16 v[52:53], v4 offset:61440
    s_xor_b32 s42, s41, 12288
    v_mfma_f32_16x16x32_bf16 v[148:151], v[56:59], v[76:79], v[148:151]
    ds_read_b64_tr_b16 v[54:55], v4 offset:62464
    v_mfma_f32_16x16x32_bf16 v[152:155], v[60:63], v[72:75], v[152:155]
    ds_read_b64_tr_b16 v[56:57], v5 offset:61440
    v_mfma_f32_16x16x32_bf16 v[156:159], v[60:63], v[76:79], v[156:159]
    ds_read_b64_tr_b16 v[58:59], v5 offset:62464
    s_waitcnt vmcnt(8) lgkmcnt(10)
    v_mfma_f32_16x16x32_bf16 v[128:131], v[32:35], v[80:83], v[128:131]
    ds_read_b64_tr_b16 v[60:61], v6 offset:61440
    buffer_load_dwordx4 v[120:123], v2, s[4:7], s42 offen offset:2048 sc1
    v_mfma_f32_16x16x32_bf16 v[132:135], v[32:35], v[84:87], v[132:135]
    ds_read_b64_tr_b16 v[62:63], v6 offset:62464
    v_xor_b32 v3, 0x10000, v3
    v_xor_b32 v4, 0x10000, v4
    v_xor_b32 v5, 0x10000, v5
    v_xor_b32 v6, 0x10000, v6
    v_mfma_f32_16x16x32_bf16 v[136:139], v[36:39], v[80:83], v[136:139]
    ds_read_b64_tr_b16 v[32:33], v3 offset:0
    v_mfma_f32_16x16x32_bf16 v[140:143], v[36:39], v[84:87], v[140:143]
    ds_read_b64_tr_b16 v[34:35], v3 offset:1024
    s_waitcnt lgkmcnt(10)
    v_mfma_f32_16x16x32_bf16 v[144:147], v[40:43], v[80:83], v[144:147]
    buffer_load_dwordx4 v[124:127], v2, s[4:7], s42 offen offset:2304 sc1
    ds_read_b64_tr_b16 v[36:37], v4 offset:0
    s_xor_b32 s42, s41, 16384
    v_mfma_f32_16x16x32_bf16 v[148:151], v[40:43], v[84:87], v[148:151]
    ds_read_b64_tr_b16 v[38:39], v4 offset:1024
    v_mfma_f32_16x16x32_bf16 v[152:155], v[44:47], v[80:83], v[152:155]
    ds_read_b64_tr_b16 v[40:41], v5 offset:0
    v_mfma_f32_16x16x32_bf16 v[156:159], v[44:47], v[84:87], v[156:159]
    ds_read_b64_tr_b16 v[42:43], v5 offset:1024
    s_waitcnt vmcnt(8) lgkmcnt(10)
    v_mfma_f32_16x16x32_bf16 v[128:131], v[48:51], v[88:91], v[128:131]
    buffer_load_dwordx4 v[160:163], v2, s[4:7], s42 offen offset:2048 sc1
    ds_read_b64_tr_b16 v[44:45], v6 offset:0
    v_mfma_f32_16x16x32_bf16 v[132:135], v[48:51], v[92:95], v[132:135]
    ds_read_b64_tr_b16 v[46:47], v6 offset:1024
    v_mfma_f32_16x16x32_bf16 v[136:139], v[52:55], v[88:91], v[136:139]
    ds_read_b64_tr_b16 v[48:49], v3 offset:4096
    v_mfma_f32_16x16x32_bf16 v[140:143], v[52:55], v[92:95], v[140:143]
    ds_read_b64_tr_b16 v[50:51], v3 offset:5120
    s_waitcnt lgkmcnt(10)
    v_mfma_f32_16x16x32_bf16 v[144:147], v[56:59], v[88:91], v[144:147]
    buffer_load_dwordx4 v[164:167], v2, s[4:7], s42 offen offset:2304 sc1
    ds_read_b64_tr_b16 v[52:53], v4 offset:4096
    s_xor_b32 s42, s41, 20480
    v_mfma_f32_16x16x32_bf16 v[148:151], v[56:59], v[92:95], v[148:151]
    ds_read_b64_tr_b16 v[54:55], v4 offset:5120
    v_mfma_f32_16x16x32_bf16 v[152:155], v[60:63], v[88:91], v[152:155]
    ds_read_b64_tr_b16 v[56:57], v5 offset:4096
    v_mfma_f32_16x16x32_bf16 v[156:159], v[60:63], v[92:95], v[156:159]
    ds_read_b64_tr_b16 v[58:59], v5 offset:5120
    s_waitcnt vmcnt(8) lgkmcnt(10)
    v_mfma_f32_16x16x32_bf16 v[128:131], v[32:35], v[96:99], v[128:131]
    ds_read_b64_tr_b16 v[60:61], v6 offset:4096
    buffer_load_dwordx4 v[168:171], v2, s[4:7], s42 offen offset:2048 sc1
    v_mfma_f32_16x16x32_bf16 v[132:135], v[32:35], v[100:103], v[132:135]
    ds_read_b64_tr_b16 v[62:63], v6 offset:5120
    v_mfma_f32_16x16x32_bf16 v[136:139], v[36:39], v[96:99], v[136:139]
    ds_read_b64_tr_b16 v[32:33], v3 offset:8192
    v_mfma_f32_16x16x32_bf16 v[140:143], v[36:39], v[100:103], v[140:143]
    ds_read_b64_tr_b16 v[34:35], v3 offset:9216
    s_waitcnt lgkmcnt(10)
    v_mfma_f32_16x16x32_bf16 v[144:147], v[40:43], v[96:99], v[144:147]
    buffer_load_dwordx4 v[172:175], v2, s[4:7], s42 offen offset:2304 sc1
    ds_read_b64_tr_b16 v[36:37], v4 offset:8192
    s_xor_b32 s42, s41, 24576
    v_mfma_f32_16x16x32_bf16 v[148:151], v[40:43], v[100:103], v[148:151]
    ds_read_b64_tr_b16 v[38:39], v4 offset:9216
    v_mfma_f32_16x16x32_bf16 v[152:155], v[44:47], v[96:99], v[152:155]
    ds_read_b64_tr_b16 v[40:41], v5 offset:8192
    v_mfma_f32_16x16x32_bf16 v[156:159], v[44:47], v[100:103], v[156:159]
    ds_read_b64_tr_b16 v[42:43], v5 offset:9216
    s_waitcnt vmcnt(8) lgkmcnt(10)
    v_mfma_f32_16x16x32_bf16 v[128:131], v[48:51], v[104:107], v[128:131]
    buffer_load_dwordx4 v[176:179], v2, s[4:7], s42 offen offset:2048 sc1
    ds_read_b64_tr_b16 v[44:45], v6 offset:8192
    v_mfma_f32_16x16x32_bf16 v[132:135], v[48:51], v[108:111], v[132:135]
    ds_read_b64_tr_b16 v[46:47], v6 offset:9216
    v_mfma_f32_16x16x32_bf16 v[136:139], v[52:55], v[104:107], v[136:139]
    ds_read_b64_tr_b16 v[48:49], v3 offset:12288
    v_mfma_f32_16x16x32_bf16 v[140:143], v[52:55], v[108:111], v[140:143]
    ds_read_b64_tr_b16 v[50:51], v3 offset:13312
    s_waitcnt lgkmcnt(10)
    v_mfma_f32_16x16x32_bf16 v[144:147], v[56:59], v[104:107], v[144:147]
    buffer_load_dwordx4 v[180:183], v2, s[4:7], s42 offen offset:2304 sc1
    ds_read_b64_tr_b16 v[52:53], v4 offset:12288
    s_xor_b32 s42, s41, 28672
    v_mfma_f32_16x16x32_bf16 v[148:151], v[56:59], v[108:111], v[148:151]
    ds_read_b64_tr_b16 v[54:55], v4 offset:13312
    v_mfma_f32_16x16x32_bf16 v[152:155], v[60:63], v[104:107], v[152:155]
    ds_read_b64_tr_b16 v[56:57], v5 offset:12288
    v_mfma_f32_16x16x32_bf16 v[156:159], v[60:63], v[108:111], v[156:159]
    ds_read_b64_tr_b16 v[58:59], v5 offset:13312
    s_waitcnt vmcnt(8) lgkmcnt(10)
    v_mfma_f32_16x16x32_bf16 v[128:131], v[32:35], v[112:115], v[128:131]
    ds_read_b64_tr_b16 v[60:61], v6 offset:12288
    buffer_load_dwordx4 v[184:187], v2, s[4:7], s42 offen offset:2048 sc1
    v_mfma_f32_16x16x32_bf16 v[132:135], v[32:35], v[116:119], v[132:135]
    ds_read_b64_tr_b16 v[62:63], v6 offset:13312
    v_mfma_f32_16x16x32_bf16 v[136:139], v[36:39], v[112:115], v[136:139]
    ds_read_b64_tr_b16 v[32:33], v3 offset:16384
    v_mfma_f32_16x16x32_bf16 v[140:143], v[36:39], v[116:119], v[140:143]
    ds_read_b64_tr_b16 v[34:35], v3 offset:17408
    s_waitcnt lgkmcnt(10)
    v_mfma_f32_16x16x32_bf16 v[144:147], v[40:43], v[112:115], v[144:147]
    buffer_load_dwordx4 v[188:191], v2, s[4:7], s42 offen offset:2304 sc1
    ds_read_b64_tr_b16 v[36:37], v4 offset:16384
    s_xor_b32 s42, s41, 32768
    v_mfma_f32_16x16x32_bf16 v[148:151], v[40:43], v[116:119], v[148:151]
    ds_read_b64_tr_b16 v[38:39], v4 offset:17408
    v_mfma_f32_16x16x32_bf16 v[152:155], v[44:47], v[112:115], v[152:155]
    ds_read_b64_tr_b16 v[40:41], v5 offset:16384
    v_mfma_f32_16x16x32_bf16 v[156:159], v[44:47], v[116:119], v[156:159]
    ds_read_b64_tr_b16 v[42:43], v5 offset:17408
    s_waitcnt vmcnt(8) lgkmcnt(10)
    v_mfma_f32_16x16x32_bf16 v[128:131], v[48:51], v[120:123], v[128:131]
    buffer_load_dwordx4 v[64:67], v2, s[4:7], s42 offen offset:2048 sc1
    ds_read_b64_tr_b16 v[44:45], v6 offset:16384
    v_mfma_f32_16x16x32_bf16 v[132:135], v[48:51], v[124:127], v[132:135]
    ds_read_b64_tr_b16 v[46:47], v6 offset:17408
    v_mfma_f32_16x16x32_bf16 v[136:139], v[52:55], v[120:123], v[136:139]
    ds_read_b64_tr_b16 v[48:49], v3 offset:20480
    v_mfma_f32_16x16x32_bf16 v[140:143], v[52:55], v[124:127], v[140:143]
    ds_read_b64_tr_b16 v[50:51], v3 offset:21504
    s_waitcnt lgkmcnt(10)
    v_mfma_f32_16x16x32_bf16 v[144:147], v[56:59], v[120:123], v[144:147]
    buffer_load_dwordx4 v[68:71], v2, s[4:7], s42 offen offset:2304 sc1
    ds_read_b64_tr_b16 v[52:53], v4 offset:20480
    s_xor_b32 s42, s41, 36864
    v_mfma_f32_16x16x32_bf16 v[148:151], v[56:59], v[124:127], v[148:151]
    ds_read_b64_tr_b16 v[54:55], v4 offset:21504
    v_mfma_f32_16x16x32_bf16 v[152:155], v[60:63], v[120:123], v[152:155]
    ds_read_b64_tr_b16 v[56:57], v5 offset:20480
    v_mfma_f32_16x16x32_bf16 v[156:159], v[60:63], v[124:127], v[156:159]
    ds_read_b64_tr_b16 v[58:59], v5 offset:21504
    s_waitcnt vmcnt(8) lgkmcnt(10)
    v_mfma_f32_16x16x32_bf16 v[128:131], v[32:35], v[160:163], v[128:131]
    ds_read_b64_tr_b16 v[60:61], v6 offset:20480
    buffer_load_dwordx4 v[72:75], v2, s[4:7], s42 offen offset:2048 sc1
    v_mfma_f32_16x16x32_bf16 v[132:135], v[32:35], v[164:167], v[132:135]
    ds_read_b64_tr_b16 v[62:63], v6 offset:21504
    v_mfma_f32_16x16x32_bf16 v[136:139], v[36:39], v[160:163], v[136:139]
    ds_read_b64_tr_b16 v[32:33], v3 offset:24576
    v_mfma_f32_16x16x32_bf16 v[140:143], v[36:39], v[164:167], v[140:143]
    ds_read_b64_tr_b16 v[34:35], v3 offset:25600
    s_waitcnt lgkmcnt(10)
    v_mfma_f32_16x16x32_bf16 v[144:147], v[40:43], v[160:163], v[144:147]
    buffer_load_dwordx4 v[76:79], v2, s[4:7], s42 offen offset:2304 sc1
    ds_read_b64_tr_b16 v[36:37], v4 offset:24576
    s_xor_b32 s42, s41, 40960
    v_mfma_f32_16x16x32_bf16 v[148:151], v[40:43], v[164:167], v[148:151]
    ds_read_b64_tr_b16 v[38:39], v4 offset:25600
    v_mfma_f32_16x16x32_bf16 v[152:155], v[44:47], v[160:163], v[152:155]
    ds_read_b64_tr_b16 v[40:41], v5 offset:24576
    v_mfma_f32_16x16x32_bf16 v[156:159], v[44:47], v[164:167], v[156:159]
    ds_read_b64_tr_b16 v[42:43], v5 offset:25600
    s_waitcnt vmcnt(8) lgkmcnt(10)
    v_mfma_f32_16x16x32_bf16 v[128:131], v[48:51], v[168:171], v[128:131]
    buffer_load_dwordx4 v[80:83], v2, s[4:7], s42 offen offset:2048 sc1
    ds_read_b64_tr_b16 v[44:45], v6 offset:24576
    v_mfma_f32_16x16x32_bf16 v[132:135], v[48:51], v[172:175], v[132:135]
    ds_read_b64_tr_b16 v[46:47], v6 offset:25600
    v_mfma_f32_16x16x32_bf16 v[136:139], v[52:55], v[168:171], v[136:139]
    ds_read_b64_tr_b16 v[48:49], v3 offset:28672
    v_mfma_f32_16x16x32_bf16 v[140:143], v[52:55], v[172:175], v[140:143]
    ds_read_b64_tr_b16 v[50:51], v3 offset:29696
    s_waitcnt lgkmcnt(10)
    v_mfma_f32_16x16x32_bf16 v[144:147], v[56:59], v[168:171], v[144:147]
    buffer_load_dwordx4 v[84:87], v2, s[4:7], s42 offen offset:2304 sc1
    ds_read_b64_tr_b16 v[52:53], v4 offset:28672
    s_xor_b32 s42, s41, 45056
    v_mfma_f32_16x16x32_bf16 v[148:151], v[56:59], v[172:175], v[148:151]
    ds_read_b64_tr_b16 v[54:55], v4 offset:29696
    v_mfma_f32_16x16x32_bf16 v[152:155], v[60:63], v[168:171], v[152:155]
    ds_read_b64_tr_b16 v[56:57], v5 offset:28672
    v_mfma_f32_16x16x32_bf16 v[156:159], v[60:63], v[172:175], v[156:159]
    ds_read_b64_tr_b16 v[58:59], v5 offset:29696
    s_waitcnt vmcnt(8) lgkmcnt(10)
    v_mfma_f32_16x16x32_bf16 v[128:131], v[32:35], v[176:179], v[128:131]
    ds_read_b64_tr_b16 v[60:61], v6 offset:28672
    buffer_load_dwordx4 v[88:91], v2, s[4:7], s42 offen offset:2048 sc1
    v_mfma_f32_16x16x32_bf16 v[132:135], v[32:35], v[180:183], v[132:135]
    ds_read_b64_tr_b16 v[62:63], v6 offset:29696
    v_mfma_f32_16x16x32_bf16 v[136:139], v[36:39], v[176:179], v[136:139]
    ds_read_b64_tr_b16 v[32:33], v3 offset:32768
    v_mfma_f32_16x16x32_bf16 v[140:143], v[36:39], v[180:183], v[140:143]
    ds_read_b64_tr_b16 v[34:35], v3 offset:33792
    s_waitcnt lgkmcnt(10)
    v_mfma_f32_16x16x32_bf16 v[144:147], v[40:43], v[176:179], v[144:147]
    buffer_load_dwordx4 v[92:95], v2, s[4:7], s42 offen offset:2304 sc1
    ds_read_b64_tr_b16 v[36:37], v4 offset:32768
    s_xor_b32 s42, s41, 49152
    v_mfma_f32_16x16x32_bf16 v[148:151], v[40:43], v[180:183], v[148:151]
    ds_read_b64_tr_b16 v[38:39], v4 offset:33792
    v_mfma_f32_16x16x32_bf16 v[152:155], v[44:47], v[176:179], v[152:155]
    ds_read_b64_tr_b16 v[40:41], v5 offset:32768
    v_mfma_f32_16x16x32_bf16 v[156:159], v[44:47], v[180:183], v[156:159]
    ds_read_b64_tr_b16 v[42:43], v5 offset:33792
    s_waitcnt vmcnt(8) lgkmcnt(10)
    v_mfma_f32_16x16x32_bf16 v[128:131], v[48:51], v[184:187], v[128:131]
    buffer_load_dwordx4 v[96:99], v2, s[4:7], s42 offen offset:2048 sc1
    ds_read_b64_tr_b16 v[44:45], v6 offset:32768
    v_mfma_f32_16x16x32_bf16 v[132:135], v[48:51], v[188:191], v[132:135]
    ds_read_b64_tr_b16 v[46:47], v6 offset:33792
    v_mfma_f32_16x16x32_bf16 v[136:139], v[52:55], v[184:187], v[136:139]
    ds_read_b64_tr_b16 v[48:49], v3 offset:36864
    v_mfma_f32_16x16x32_bf16 v[140:143], v[52:55], v[188:191], v[140:143]
    ds_read_b64_tr_b16 v[50:51], v3 offset:37888
    s_waitcnt lgkmcnt(10)
    v_mfma_f32_16x16x32_bf16 v[144:147], v[56:59], v[184:187], v[144:147]
    buffer_load_dwordx4 v[100:103], v2, s[4:7], s42 offen offset:2304 sc1
    ds_read_b64_tr_b16 v[52:53], v4 offset:36864
    s_xor_b32 s42, s41, 53248
    v_mfma_f32_16x16x32_bf16 v[148:151], v[56:59], v[188:191], v[148:151]
    ds_read_b64_tr_b16 v[54:55], v4 offset:37888
    v_mfma_f32_16x16x32_bf16 v[152:155], v[60:63], v[184:187], v[152:155]
    ds_read_b64_tr_b16 v[56:57], v5 offset:36864
    v_mfma_f32_16x16x32_bf16 v[156:159], v[60:63], v[188:191], v[156:159]
    ds_read_b64_tr_b16 v[58:59], v5 offset:37888
    s_waitcnt vmcnt(8) lgkmcnt(10)
    v_mfma_f32_16x16x32_bf16 v[128:131], v[32:35], v[64:67], v[128:131]
    ds_read_b64_tr_b16 v[60:61], v6 offset:36864
    buffer_load_dwordx4 v[104:107], v2, s[4:7], s42 offen offset:2048 sc1
    v_mfma_f32_16x16x32_bf16 v[132:135], v[32:35], v[68:71], v[132:135]
    ds_read_b64_tr_b16 v[62:63], v6 offset:37888
    v_mfma_f32_16x16x32_bf16 v[136:139], v[36:39], v[64:67], v[136:139]
    ds_read_b64_tr_b16 v[32:33], v3 offset:40960
    v_mfma_f32_16x16x32_bf16 v[140:143], v[36:39], v[68:71], v[140:143]
    ds_read_b64_tr_b16 v[34:35], v3 offset:41984
    s_waitcnt lgkmcnt(10)
    v_mfma_f32_16x16x32_bf16 v[144:147], v[40:43], v[64:67], v[144:147]
    buffer_load_dwordx4 v[108:111], v2, s[4:7], s42 offen offset:2304 sc1
    ds_read_b64_tr_b16 v[36:37], v4 offset:40960
    s_xor_b32 s42, s41, 57344
    v_mfma_f32_16x16x32_bf16 v[148:151], v[40:43], v[68:71], v[148:151]
    ds_read_b64_tr_b16 v[38:39], v4 offset:41984
    v_mfma_f32_16x16x32_bf16 v[152:155], v[44:47], v[64:67], v[152:155]
    ds_read_b64_tr_b16 v[40:41], v5 offset:40960
    v_mfma_f32_16x16x32_bf16 v[156:159], v[44:47], v[68:71], v[156:159]
    ds_read_b64_tr_b16 v[42:43], v5 offset:41984
    s_waitcnt vmcnt(8) lgkmcnt(10)
    v_mfma_f32_16x16x32_bf16 v[128:131], v[48:51], v[72:75], v[128:131]
    buffer_load_dwordx4 v[112:115], v2, s[4:7], s42 offen offset:2048 sc1
    ds_read_b64_tr_b16 v[44:45], v6 offset:40960
    v_mfma_f32_16x16x32_bf16 v[132:135], v[48:51], v[76:79], v[132:135]
    ds_read_b64_tr_b16 v[46:47], v6 offset:41984
    v_mfma_f32_16x16x32_bf16 v[136:139], v[52:55], v[72:75], v[136:139]
    ds_read_b64_tr_b16 v[48:49], v3 offset:45056
    v_mfma_f32_16x16x32_bf16 v[140:143], v[52:55], v[76:79], v[140:143]
    ds_read_b64_tr_b16 v[50:51], v3 offset:46080
    s_waitcnt lgkmcnt(10)
    v_mfma_f32_16x16x32_bf16 v[144:147], v[56:59], v[72:75], v[144:147]
    buffer_load_dwordx4 v[116:119], v2, s[4:7], s42 offen offset:2304 sc1
    ds_read_b64_tr_b16 v[52:53], v4 offset:45056
    s_xor_b32 s42, s41, 61440
    v_mfma_f32_16x16x32_bf16 v[148:151], v[56:59], v[76:79], v[148:151]
    ds_read_b64_tr_b16 v[54:55], v4 offset:46080
    v_mfma_f32_16x16x32_bf16 v[152:155], v[60:63], v[72:75], v[152:155]
    ds_read_b64_tr_b16 v[56:57], v5 offset:45056
    v_mfma_f32_16x16x32_bf16 v[156:159], v[60:63], v[76:79], v[156:159]
    ds_read_b64_tr_b16 v[58:59], v5 offset:46080
    s_waitcnt vmcnt(8) lgkmcnt(10)
    v_mfma_f32_16x16x32_bf16 v[128:131], v[32:35], v[80:83], v[128:131]
    ds_read_b64_tr_b16 v[60:61], v6 offset:45056
    buffer_load_dwordx4 v[120:123], v2, s[4:7], s42 offen offset:2048 sc1
    v_mfma_f32_16x16x32_bf16 v[132:135], v[32:35], v[84:87], v[132:135]
    ds_read_b64_tr_b16 v[62:63], v6 offset:46080
    v_mfma_f32_16x16x32_bf16 v[136:139], v[36:39], v[80:83], v[136:139]
    ds_read_b64_tr_b16 v[32:33], v3 offset:49152
    v_mfma_f32_16x16x32_bf16 v[140:143], v[36:39], v[84:87], v[140:143]
    ds_read_b64_tr_b16 v[34:35], v3 offset:50176
    s_waitcnt lgkmcnt(10)
    v_mfma_f32_16x16x32_bf16 v[144:147], v[40:43], v[80:83], v[144:147]
    buffer_load_dwordx4 v[124:127], v2, s[4:7], s42 offen offset:2304 sc1
    ds_read_b64_tr_b16 v[36:37], v4 offset:49152
    v_mfma_f32_16x16x32_bf16 v[148:151], v[40:43], v[84:87], v[148:151]
    ds_read_b64_tr_b16 v[38:39], v4 offset:50176
    v_mfma_f32_16x16x32_bf16 v[152:155], v[44:47], v[80:83], v[152:155]
    ds_read_b64_tr_b16 v[40:41], v5 offset:49152
    v_mfma_f32_16x16x32_bf16 v[156:159], v[44:47], v[84:87], v[156:159]
    ds_read_b64_tr_b16 v[42:43], v5 offset:50176
    s_waitcnt vmcnt(8) lgkmcnt(10)
    v_mfma_f32_16x16x32_bf16 v[128:131], v[48:51], v[88:91], v[128:131]
    ds_read_b64_tr_b16 v[44:45], v6 offset:49152
    v_mfma_f32_16x16x32_bf16 v[132:135], v[48:51], v[92:95], v[132:135]
    ds_read_b64_tr_b16 v[46:47], v6 offset:50176
    v_mfma_f32_16x16x32_bf16 v[136:139], v[52:55], v[88:91], v[136:139]
    ds_read_b64_tr_b16 v[48:49], v3 offset:53248
    v_mfma_f32_16x16x32_bf16 v[140:143], v[52:55], v[92:95], v[140:143]
    ds_read_b64_tr_b16 v[50:51], v3 offset:54272
    s_waitcnt lgkmcnt(10)
    v_mfma_f32_16x16x32_bf16 v[144:147], v[56:59], v[88:91], v[144:147]
    ds_read_b64_tr_b16 v[52:53], v4 offset:53248
    v_mfma_f32_16x16x32_bf16 v[148:151], v[56:59], v[92:95], v[148:151]
    ds_read_b64_tr_b16 v[54:55], v4 offset:54272
    v_mfma_f32_16x16x32_bf16 v[152:155], v[60:63], v[88:91], v[152:155]
    ds_read_b64_tr_b16 v[56:57], v5 offset:53248
    v_mfma_f32_16x16x32_bf16 v[156:159], v[60:63], v[92:95], v[156:159]
    ds_read_b64_tr_b16 v[58:59], v5 offset:54272
    s_waitcnt vmcnt(6) lgkmcnt(10)
    v_mfma_f32_16x16x32_bf16 v[128:131], v[32:35], v[96:99], v[128:131]
    ds_read_b64_tr_b16 v[60:61], v6 offset:53248
    v_mfma_f32_16x16x32_bf16 v[132:135], v[32:35], v[100:103], v[132:135]
    ds_read_b64_tr_b16 v[62:63], v6 offset:54272
    v_mfma_f32_16x16x32_bf16 v[136:139], v[36:39], v[96:99], v[136:139]
    ds_read_b64_tr_b16 v[32:33], v3 offset:57344
    v_mfma_f32_16x16x32_bf16 v[140:143], v[36:39], v[100:103], v[140:143]
    ds_read_b64_tr_b16 v[34:35], v3 offset:58368
    s_waitcnt lgkmcnt(10)
    v_mfma_f32_16x16x32_bf16 v[144:147], v[40:43], v[96:99], v[144:147]
    ds_read_b64_tr_b16 v[36:37], v4 offset:57344
    v_mfma_f32_16x16x32_bf16 v[148:151], v[40:43], v[100:103], v[148:151]
    ds_read_b64_tr_b16 v[38:39], v4 offset:58368
    v_mfma_f32_16x16x32_bf16 v[152:155], v[44:47], v[96:99], v[152:155]
    ds_read_b64_tr_b16 v[40:41], v5 offset:57344
    v_mfma_f32_16x16x32_bf16 v[156:159], v[44:47], v[100:103], v[156:159]
    ds_read_b64_tr_b16 v[42:43], v5 offset:58368
    s_waitcnt vmcnt(4) lgkmcnt(10)
    v_mfma_f32_16x16x32_bf16 v[128:131], v[48:51], v[104:107], v[128:131]
    ds_read_b64_tr_b16 v[44:45], v6 offset:57344
    v_mfma_f32_16x16x32_bf16 v[132:135], v[48:51], v[108:111], v[132:135]
    ds_read_b64_tr_b16 v[46:47], v6 offset:58368
    v_mfma_f32_16x16x32_bf16 v[136:139], v[52:55], v[104:107], v[136:139]
    ds_read_b64_tr_b16 v[48:49], v3 offset:61440
    v_mfma_f32_16x16x32_bf16 v[140:143], v[52:55], v[108:111], v[140:143]
    ds_read_b64_tr_b16 v[50:51], v3 offset:62464
    s_waitcnt lgkmcnt(10)
    v_mfma_f32_16x16x32_bf16 v[144:147], v[56:59], v[104:107], v[144:147]
    ds_read_b64_tr_b16 v[52:53], v4 offset:61440
    v_mfma_f32_16x16x32_bf16 v[148:151], v[56:59], v[108:111], v[148:151]
    ds_read_b64_tr_b16 v[54:55], v4 offset:62464
    v_mfma_f32_16x16x32_bf16 v[152:155], v[60:63], v[104:107], v[152:155]
    ds_read_b64_tr_b16 v[56:57], v5 offset:61440
    v_mfma_f32_16x16x32_bf16 v[156:159], v[60:63], v[108:111], v[156:159]
    ds_read_b64_tr_b16 v[58:59], v5 offset:62464
    s_waitcnt vmcnt(2) lgkmcnt(10)
    v_mfma_f32_16x16x32_bf16 v[128:131], v[32:35], v[112:115], v[128:131]
    ds_read_b64_tr_b16 v[60:61], v6 offset:61440
    v_mfma_f32_16x16x32_bf16 v[132:135], v[32:35], v[116:119], v[132:135]
    ds_read_b64_tr_b16 v[62:63], v6 offset:62464
    v_xor_b32 v3, 0x10000, v3
    v_xor_b32 v4, 0x10000, v4
    v_xor_b32 v5, 0x10000, v5
    v_xor_b32 v6, 0x10000, v6
    v_mfma_f32_16x16x32_bf16 v[136:139], v[36:39], v[112:115], v[136:139]
    v_mfma_f32_16x16x32_bf16 v[140:143], v[36:39], v[116:119], v[140:143]
    s_waitcnt lgkmcnt(8)
    v_mfma_f32_16x16x32_bf16 v[144:147], v[40:43], v[112:115], v[144:147]
    v_mfma_f32_16x16x32_bf16 v[148:151], v[40:43], v[116:119], v[148:151]
    v_mfma_f32_16x16x32_bf16 v[152:155], v[44:47], v[112:115], v[152:155]
    v_mfma_f32_16x16x32_bf16 v[156:159], v[44:47], v[116:119], v[156:159]
    s_waitcnt vmcnt(0) lgkmcnt(4)
    v_mfma_f32_16x16x32_bf16 v[128:131], v[48:51], v[120:123], v[128:131]
    v_mfma_f32_16x16x32_bf16 v[132:135], v[48:51], v[124:127], v[132:135]
    v_mfma_f32_16x16x32_bf16 v[136:139], v[52:55], v[120:123], v[136:139]
    v_mfma_f32_16x16x32_bf16 v[140:143], v[52:55], v[124:127], v[140:143]
    s_waitcnt lgkmcnt(0)
    v_mfma_f32_16x16x32_bf16 v[144:147], v[56:59], v[120:123], v[144:147]
    v_mfma_f32_16x16x32_bf16 v[148:151], v[56:59], v[124:127], v[148:151]
    v_mfma_f32_16x16x32_bf16 v[152:155], v[60:63], v[120:123], v[152:155]
    v_mfma_f32_16x16x32_bf16 v[156:159], v[60:63], v[124:127], v[156:159]
    s_cmp_eq_u32 s21, 3
    s_cbranch_scc1 c_final
    s_add_u32 s43, s43, 4194304
    v_cvt_pk_bf16_f32 v160, v128, v129
    v_cvt_pk_bf16_f32 v161, v130, v131
    v_cvt_pk_bf16_f32 v162, v136, v137
    v_cvt_pk_bf16_f32 v163, v138, v139
    v_cvt_pk_bf16_f32 v168, v144, v145
    v_cvt_pk_bf16_f32 v169, v146, v147
    v_cvt_pk_bf16_f32 v170, v152, v153
    v_cvt_pk_bf16_f32 v171, v154, v155
    v_permlane32_swap_b32 v160, v162
    v_permlane32_swap_b32 v161, v163
    buffer_store_dwordx4 v[160:163], v2, s[4:7], s43 offen offset:0 sc1
    v_permlane32_swap_b32 v168, v170
    v_permlane32_swap_b32 v169, v171
    buffer_store_dwordx4 v[168:171], v2, s[4:7], s43 offen offset:2048 sc1
    v_cvt_pk_bf16_f32 v164, v132, v133
    v_cvt_pk_bf16_f32 v165, v134, v135
    v_cvt_pk_bf16_f32 v166, v140, v141
    v_cvt_pk_bf16_f32 v167, v142, v143
    v_cvt_pk_bf16_f32 v172, v148, v149
    v_cvt_pk_bf16_f32 v173, v150, v151
    v_cvt_pk_bf16_f32 v174, v156, v157
    v_cvt_pk_bf16_f32 v175, v158, v159
    v_permlane32_swap_b32 v164, v166
    v_permlane32_swap_b32 v165, v167
    buffer_store_dwordx4 v[164:167], v2, s[4:7], s43 offen offset:256 sc1
    v_permlane32_swap_b32 v172, v174
    v_permlane32_swap_b32 v173, v175
    buffer_store_dwordx4 v[172:175], v2, s[4:7], s43 offen offset:2304 sc1
    s_barrier
    v_mov_b32 v12, 0x3f803f80
    v_mov_b32 v14, 0
    v_mov_b32 v15, 0
    v_mov_b32 v16, 0
    v_mov_b32 v17, 0
    v_dot2_f32_bf16 v14, v160, v12, v14
    v_dot2_f32_bf16 v15, v160, v160, v15
    v_dot2_f32_bf16 v16, v164, v12, v16
    v_dot2_f32_bf16 v17, v164, v164, v17
    v_dot2_f32_bf16 v14, v161, v12, v14
    v_dot2_f32_bf16 v15, v161, v161, v15
    v_dot2_f32_bf16 v16, v165, v12, v16
    v_dot2_f32_bf16 v17, v165, v165, v17
    v_dot2_f32_bf16 v14, v162, v12, v14
    v_dot2_f32_bf16 v15, v162, v162, v15
    v_dot2_f32_bf16 v16, v166, v12, v16
    v_dot2_f32_bf16 v17, v166, v166, v17
    v_dot2_f32_bf16 v14, v163, v12, v14
    v_dot2_f32_bf16 v15, v163, v163, v15
    v_dot2_f32_bf16 v16, v167, v12, v16
    v_dot2_f32_bf16 v17, v167, v167, v17
    v_dot2_f32_bf16 v14, v168, v12, v14
    v_dot2_f32_bf16 v15, v168, v168, v15
    v_dot2_f32_bf16 v16, v172, v12, v16
    v_dot2_f32_bf16 v17, v172, v172, v17
    v_dot2_f32_bf16 v14, v169, v12, v14
    v_dot2_f32_bf16 v15, v169, v169, v15
    v_dot2_f32_bf16 v16, v173, v12, v16
    v_dot2_f32_bf16 v17, v173, v173, v17
    v_dot2_f32_bf16 v14, v170, v12, v14
    v_dot2_f32_bf16 v15, v170, v170, v15
    v_dot2_f32_bf16 v16, v174, v12, v16
    v_dot2_f32_bf16 v17, v174, v174, v17
    v_dot2_f32_bf16 v14, v171, v12, v14
    v_dot2_f32_bf16 v15, v171, v171, v15
    v_dot2_f32_bf16 v16, v175, v12, v16
    v_dot2_f32_bf16 v17, v175, v175, v17
    s_nop 2
    v_permlane16_swap_b32 v14, v16
    v_permlane16_swap_b32 v15, v17
    v_pk_add_f32 v[14:15], v[14:15], v[16:17]
    v_mov_b32 v16, v14
    v_mov_b32 v17, v15
    s_nop 0
    v_permlane32_swap_b32 v14, v16
    v_permlane32_swap_b32 v15, v17
    v_pk_add_f32 v[14:15], v[14:15], v[16:17]
    v_lshrrev_b32 v13, 1, v1
    v_and_b32 v13, 0xf8, v13
    s_add_u32 s21, s21, 1
    s_lshl_b32 s44, s21, 18
    s_lshl_b32 s45, s39, 12
    s_add_u32 s44, s44, s45
    s_lshl_b32 s45, s20, 8
    s_add_u32 s44, s44, s45
    s_add_u32 s44, s44, 50331648
    buffer_store_dwordx2 v[14:15], v13, s[4:7], s44 offen sc1
    s_lshl_b32 s46, s21, 14
    s_lshl_b32 s67, s39, 7
    s_add_u32 s46, s46, s67
    s_add_u32 s46, s46, 4096
    s_add_u32 s47, s46, 8192
    s_waitcnt vmcnt(1)
    s_atomic_add s40, s[22:23], s46
    s_branch c_layer
c_final:
    s_mov_b32 s8, s32
    s_mov_b32 s9, s33
    s_mov_b32 s10, 4194304
    s_mov_b32 s11, 0x00020000
    v_lshrrev_b32 v12, 4, v1
    s_mul_i32 s44, s16, 4608
    s_add_u32 s44, s44, 131072
    v_and_b32 v13, 15, v12
    v_mul_u32_u24 v13, 144, v13
    v_lshrrev_b32 v14, 4, v12
    v_lshl_add_u32 v13, v14, 3, v13
    v_add_u32 v13, s44, v13
    v_cvt_pk_bf16_f32 v128, v128, v129
    v_cvt_pk_bf16_f32 v129, v130, v131
    ds_write_b64 v13, v[128:129] offset:0
    v_cvt_pk_bf16_f32 v136, v136, v137
    v_cvt_pk_bf16_f32 v137, v138, v139
    ds_write_b64 v13, v[136:137] offset:32
    v_cvt_pk_bf16_f32 v144, v144, v145
    v_cvt_pk_bf16_f32 v145, v146, v147
    ds_write_b64 v13, v[144:145] offset:64
    v_cvt_pk_bf16_f32 v152, v152, v153
    v_cvt_pk_bf16_f32 v153, v154, v155
    ds_write_b64 v13, v[152:153] offset:96
    v_cvt_pk_bf16_f32 v132, v132, v133
    v_cvt_pk_bf16_f32 v133, v134, v135
    ds_write_b64 v13, v[132:133] offset:2304
    v_cvt_pk_bf16_f32 v140, v140, v141
    v_cvt_pk_bf16_f32 v141, v142, v143
    ds_write_b64 v13, v[140:141] offset:2336
    v_cvt_pk_bf16_f32 v148, v148, v149
    v_cvt_pk_bf16_f32 v149, v150, v151
    ds_write_b64 v13, v[148:149] offset:2368
    v_cvt_pk_bf16_f32 v156, v156, v157
    v_cvt_pk_bf16_f32 v157, v158, v159
    ds_write_b64 v13, v[156:157] offset:2400
    v_lshrrev_b32 v14, 3, v12
    v_and_b32 v15, 7, v12
    v_mul_u32_u24 v16, 144, v14
    v_lshl_add_u32 v16, v15, 4, v16
    v_add_u32 v16, s44, v16
    v_lshlrev_b32 v17, 11, v14
    v_lshl_add_u32 v17, v15, 4, v17
    ds_read_b128 v[32:35], v16 offset:0
    ds_read_b128 v[36:39], v16 offset:1152
    ds_read_b128 v[40:43], v16 offset:2304
    ds_read_b128 v[44:47], v16 offset:3456
    s_lshl_b32 s44, s39, 16
    s_lshl_b32 s45, s20, 7
    s_add_u32 s44, s44, s45
    s_waitcnt lgkmcnt(3)
    buffer_store_dwordx4 v[32:35], v17, s[8:11], s44 offen sc1
    s_add_u32 s44, s44, 16384
    s_waitcnt lgkmcnt(2)
    buffer_store_dwordx4 v[36:39], v17, s[8:11], s44 offen sc1
    s_add_u32 s44, s44, 16384
    s_waitcnt lgkmcnt(1)
    buffer_store_dwordx4 v[40:43], v17, s[8:11], s44 offen sc1
    s_add_u32 s44, s44, 16384
    s_waitcnt lgkmcnt(0)
    buffer_store_dwordx4 v[44:47], v17, s[8:11], s44 offen sc1
    s_endpgm
h_start:
    v_mov_b32 v20, 0
    v_mov_b32 v21, 0
    v_mov_b32 v22, 0
    v_mov_b32 v23, 0
    s_cmp_lt_u32 s2, 10
    s_cbranch_scc0 h_z0
    s_load_dword s101, s[34:35], 192
    s_lshl_b32 s44, s2, 11
    s_mov_b32 s45, 0
    s_mov_b32 s46, 0
    s_mov_b32 s47, 0
    s_mov_b32 s48, 0
    s_mov_b32 s49, 0
    s_mov_b32 s50, 0
    s_mov_b32 s51, 0
    s_mov_b32 s52, 0
    s_mov_b32 s53, 0
    s_mov_b32 s54, 0
    s_mov_b32 s55, 0
    s_mov_b32 s56, 0
    s_mov_b32 s57, 0
    s_mov_b32 s58, 0
    s_mov_b32 s59, 0
    s_mov_b32 s60, 0
    s_atomic_swap s45, s[22:23], s44 offset:0 glc
    s_atomic_swap s46, s[22:23], s44 offset:128 glc
    s_atomic_swap s47, s[22:23], s44 offset:256 glc
    s_atomic_swap s48, s[22:23], s44 offset:384 glc
    s_atomic_swap s49, s[22:23], s44 offset:512 glc
    s_atomic_swap s50, s[22:23], s44 offset:640 glc
    s_atomic_swap s51, s[22:23], s44 offset:768 glc
    s_atomic_swap s52, s[22:23], s44 offset:896 glc
    s_atomic_swap s53, s[22:23], s44 offset:1024 glc
    s_atomic_swap s54, s[22:23], s44 offset:1152 glc
    s_atomic_swap s55, s[22:23], s44 offset:1280 glc
    s_atomic_swap s56, s[22:23], s44 offset:1408 glc
    s_atomic_swap s57, s[22:23], s44 offset:1536 glc
    s_atomic_swap s58, s[22:23], s44 offset:1664 glc
    s_atomic_swap s59, s[22:23], s44 offset:1792 glc
    s_atomic_swap s60, s[22:23], s44 offset:1920 glc
    s_waitcnt lgkmcnt(0)
    s_atomic_add s40, s[34:35], 0
h_z0:
    v_lshrrev_b32 v24, 4, v1
    v_lshrrev_b32 v25, 3, v24
    v_mul_u32_u24 v12, 6144, v25
    v_and_b32 v26, 2, v25
    v_lshrrev_b32 v25, 2, v25
    v_or_b32 v26, v26, v25
    v_bfe_u32 v25, v24, 1, 2
    v_xor_b32 v26, v26, v25
    v_lshl_add_u32 v12, v26, 5, v12
    v_and_b32 v26, 1, v24
    v_lshl_add_u32 v12, v26, 4, v12
    s_lshl_b32 s3, s18, 7
    v_add_u32 v12, s3, v12
    v_add_u32 v13, 48128, v12
    v_add_u32 v14, 96256, v12
    v_add_u32 v15, 144384, v12
    v_lshrrev_b32 v24, 4, v1
    v_lshrrev_b32 v25, 3, v24
    v_mul_u32_u24 v16, 2048, v25
    v_and_b32 v26, 2, v25
    v_lshrrev_b32 v25, 2, v25
    v_or_b32 v26, v26, v25
    v_bfe_u32 v25, v24, 1, 2
    v_xor_b32 v26, v26, v25
    v_lshl_add_u32 v16, v26, 5, v16
    v_and_b32 v26, 1, v24
    v_lshl_add_u32 v16, v26, 4, v16
    s_lshl_b32 s3, s20, 7
    v_add_u32 v16, s3, v16
    v_add_u32 v17, 15360, v16
    v_add_u32 v18, 30720, v16
    v_add_u32 v19, 46080, v16
    s_mul_i32 s84, s18, 393216
    s_cmp_eq_u32 s18, 1
    s_cselect_b32 s85, 0, 393216
    s_cmp_eq_u32 s18, 2
    s_cselect_b32 s86, 0, 786432
    s_cmp_eq_u32 s18, 3
    s_cselect_b32 s87, 0, 1179648
    s_cmp_eq_u32 s18, 4
    s_cselect_b32 s88, 0, 1572864
    s_cmp_eq_u32 s18, 5
    s_cselect_b32 s89, 0, 1966080
    s_cmp_eq_u32 s18, 6
    s_cselect_b32 s90, 0, 2359296
    s_cmp_eq_u32 s18, 7
    s_cselect_b32 s91, 0, 2752512
    s_cmp_eq_u32 s18, 8
    s_cselect_b32 s92, 0, 3145728
    s_cmp_eq_u32 s18, 9
    s_cselect_b32 s93, 0, 3538944
    s_cmp_eq_u32 s18, 10
    s_cselect_b32 s94, 0, 3932160
    s_cmp_eq_u32 s18, 11
    s_cselect_b32 s95, 0, 4325376
    s_cmp_eq_u32 s18, 12
    s_cselect_b32 s96, 0, 4718592
    s_cmp_eq_u32 s18, 13
    s_cselect_b32 s97, 0, 5111808
    s_cmp_eq_u32 s18, 14
    s_cselect_b32 s98, 0, 5505024
    s_cmp_eq_u32 s18, 15
    s_cselect_b32 s99, 0, 5898240
    s_and_b32 s3, s16, 3
    s_mul_i32 s3, s3, 49152
    v_add_u32 v11, s3, v12
    s_and_b32 s3, s16, 3
    s_lshl_b32 s3, s3, 10
    v_add_u32 v9, s3, v1
    v_add_u32 v10, 0x10000, v9
    v_lshrrev_b32 v24, 4, v1
    v_and_b32 v25, 15, v24
    v_lshrrev_b32 v24, 4, v24
    v_lshlrev_b32 v24, 2, v24
    v_sub_u32 v24, v25, v24
    v_mov_b32 v25, 0xf149f2ca
    v_add_u32 v26, 0x0, v24
    v_and_b32 v26, 0xfffffff1, v26
    v_cmp_eq_u32 vcc, 0, v26
    s_nop 1
    v_cndmask_b32 v32, v25, 0, vcc
    v_add_u32 v26, 0xffffffff, v24
    v_and_b32 v26, 0xfffffff1, v26
    v_cmp_eq_u32 vcc, 0, v26
    s_nop 1
    v_cndmask_b32 v33, v25, 0, vcc
    v_add_u32 v26, 0xfffffffe, v24
    v_and_b32 v26, 0xfffffff1, v26
    v_cmp_eq_u32 vcc, 0, v26
    s_nop 1
    v_cndmask_b32 v34, v25, 0, vcc
    v_add_u32 v26, 0xfffffffd, v24
    v_and_b32 v26, 0xfffffff1, v26
    v_cmp_eq_u32 vcc, 0, v26
    s_nop 1
    v_cndmask_b32 v35, v25, 0, vcc
    v_add_u32 v26, 0x10, v24
    v_and_b32 v26, 0xfffffff1, v26
    v_cmp_eq_u32 vcc, 0, v26
    s_nop 1
    v_cndmask_b32 v36, v25, 0, vcc
    v_add_u32 v26, 0xf, v24
    v_and_b32 v26, 0xfffffff1, v26
    v_cmp_eq_u32 vcc, 0, v26
    s_nop 1
    v_cndmask_b32 v37, v25, 0, vcc
    v_add_u32 v26, 0xe, v24
    v_and_b32 v26, 0xfffffff1, v26
    v_cmp_eq_u32 vcc, 0, v26
    s_nop 1
    v_cndmask_b32 v38, v25, 0, vcc
    v_add_u32 v26, 0xd, v24
    v_and_b32 v26, 0xfffffff1, v26
    v_cmp_eq_u32 vcc, 0, v26
    s_nop 1
    v_cndmask_b32 v39, v25, 0, vcc
    v_add_u32 v24, 153600, v1
    ds_write_b128 v24, v[32:35] offset:0
    ds_write_b128 v24, v[36:39] offset:1024
    s_barrier
    s_waitcnt lgkmcnt(0)
    s_lshl_b32 s44, s21, 14
    s_lshl_b32 s67, s17, 9
    s_add_u32 s44, s44, s67
    s_add_u32 s44, s44, 4096
    s_barrier
    s_mov_b32 s66, 0x10000
h_s0_poll:
    s_mov_b32 s68, 0
    s_mov_b32 s69, 0
    s_mov_b32 s70, 0
    s_mov_b32 s71, 0
    s_atomic_add s68, s[22:23], s44 offset:0 glc
    s_atomic_add s69, s[22:23], s44 offset:128 glc
    s_atomic_add s70, s[22:23], s44 offset:256 glc
    s_atomic_add s71, s[22:23], s44 offset:384 glc
    s_sub_u32 s66, s66, 1
    s_cselect_b32 s67, 16, 0
    s_waitcnt lgkmcnt(0)
    s_and_b32 s68, s68, s69
    s_and_b32 s68, s68, s70
    s_and_b32 s68, s68, s71
    s_max_u32 s68, s68, s67
    s_cmp_lt_u32 s68, 16
    s_cbranch_scc1 h_s0_poll
h_s0_ok:
    s_barrier
    s_lshr_b32 s3, s2, 3
    s_cmp_eq_u32 s3, 2
    s_cbranch_scc0 h_g4
    s_mul_i32 s44, s2, 24576
    s_add_u32 s44, s44, 58347520
    s_mov_b32 s45, 24
h_zloop:
    buffer_store_dwordx4 v[20:23], v1, s[4:7], s44 offen sc1
    s_add_u32 s44, s44, 1024
    s_sub_u32 s45, s45, 1
    s_cmp_lg_u32 s45, 0
    s_cbranch_scc1 h_zloop
    s_branch h_g4
h_layer:
    s_waitcnt lgkmcnt(0)
    s_barrier
h_g4:
    s_barrier
    s_lshl_b32 s44, s21, 14
    s_lshl_b32 s67, s17, 9
    s_add_u32 s44, s44, s67
    s_add_u32 s44, s44, 12288
    s_mov_b32 s66, 0x10000
h_s_poll:
    s_mov_b32 s68, 0
    s_mov_b32 s69, 0
    s_mov_b32 s70, 0
    s_mov_b32 s71, 0
    s_atomic_add s68, s[22:23], s44 offset:0 glc
    s_atomic_add s69, s[22:23], s44 offset:128 glc
    s_atomic_add s70, s[22:23], s44 offset:256 glc
    s_atomic_add s71, s[22:23], s44 offset:384 glc
    s_sub_u32 s66, s66, 1
    s_cselect_b32 s67, 16, 0
    s_waitcnt lgkmcnt(0)
    s_and_b32 s68, s68, s69
    s_and_b32 s68, s68, s70
    s_and_b32 s68, s68, s71
    s_max_u32 s68, s68, s67
    s_cmp_lt_u32 s68, 16
    s_cbranch_scc1 h_s_poll
h_s_ok:
    s_barrier
    s_lshl_b32 s44, s21, 18
    s_lshl_b32 s45, s17, 14
    s_add_u32 s44, s44, s45
    s_add_u32 s44, s44, 50331648
    buffer_load_dwordx4 v[32:35], v1, s[4:7], s44 offen offset:0 sc1
    buffer_load_dwordx4 v[36:39], v1, s[4:7], s44 offen offset:1024 sc1
    buffer_load_dwordx4 v[40:43], v1, s[4:7], s44 offen offset:2048 sc1
    buffer_load_dwordx4 v[44:47], v1, s[4:7], s44 offen offset:3072 sc1
    s_add_u32 s44, s44, 4096
    buffer_load_dwordx4 v[48:51], v1, s[4:7], s44 offen offset:0 sc1
    buffer_load_dwordx4 v[52:55], v1, s[4:7], s44 offen offset:1024 sc1
    buffer_load_dwordx4 v[56:59], v1, s[4:7], s44 offen offset:2048 sc1
    buffer_load_dwordx4 v[60:63], v1, s[4:7], s44 offen offset:3072 sc1
    s_add_u32 s44, s44, 4096
    buffer_load_dwordx4 v[64:67], v1, s[4:7], s44 offen offset:0 sc1
    buffer_load_dwordx4 v[68:71], v1, s[4:7], s44 offen offset:1024 sc1
    buffer_load_dwordx4 v[72:75], v1, s[4:7], s44 offen offset:2048 sc1
    buffer_load_dwordx4 v[76:79], v1, s[4:7], s44 offen offset:3072 sc1
    s_add_u32 s44, s44, 4096
    buffer_load_dwordx4 v[80:83], v1, s[4:7], s44 offen offset:0 sc1
    buffer_load_dwordx4 v[84:87], v1, s[4:7], s44 offen offset:1024 sc1
    buffer_load_dwordx4 v[88:91], v1, s[4:7], s44 offen offset:2048 sc1
    buffer_load_dwordx4 v[92:95], v1, s[4:7], s44 offen offset:3072 sc1
    s_barrier
    s_cmp_ge_u32 s21, 2
    s_cbranch_scc1 h_c_ok
    s_lshl_b32 s44, s21, 11
    s_lshl_b32 s67, s18, 7
    s_add_u32 s44, s44, s67
    s_add_u32 s44, s44, 0
    s_mov_b32 s66, 0x10000
h_c_poll:
    s_mov_b32 s68, 0
    s_atomic_add s68, s[22:23], s44 offset:0 glc
    s_sub_u32 s66, s66, 1
    s_cselect_b32 s67, 48, 0
    s_waitcnt lgkmcnt(0)
    s_max_u32 s68, s68, s67
    s_cmp_lt_u32 s68, 48
    s_cbranch_scc1 h_c_poll
h_c_ok:
    s_waitcnt vmcnt(0)
    s_lshl_b32 s3, s21, 8
    s_add_u32 s3, s3, s2
    s_lshr_b32 s3, s3, 3
    s_cmp_eq_u32 s3, 2
    s_cbranch_scc0 h_nf1
    s_atomic_add s40, s[34:35], 128
h_nf1:
    s_barrier
    s_cmp_ge_u32 s21, 2
    s_cbranch_scc1 h_cs1
    s_lshl_b32 s44, s21, 18
    s_lshl_b32 s45, s18, 14
    s_add_u32 s44, s44, s45
    s_add_u32 s44, s44, 52428800
    buffer_load_dwordx4 v[96:99], v1, s[4:7], s44 offen offset:0 sc1
    buffer_load_dwordx4 v[100:103], v1, s[4:7], s44 offen offset:1024 sc1
    buffer_load_dwordx4 v[104:107], v1, s[4:7], s44 offen offset:2048 sc1
    buffer_load_dwordx4 v[108:111], v1, s[4:7], s44 offen offset:3072 sc1
    s_add_u32 s44, s44, 4096
    buffer_load_dwordx4 v[112:115], v1, s[4:7], s44 offen offset:0 sc1
    buffer_load_dwordx4 v[116:119], v1, s[4:7], s44 offen offset:1024 sc1
    buffer_load_dwordx4 v[120:123], v1, s[4:7], s44 offen offset:2048 sc1
    buffer_load_dwordx4 v[124:127], v1, s[4:7], s44 offen offset:3072 sc1
    s_add_u32 s44, s44, 4096
    buffer_load_dwordx4 v[128:131], v1, s[4:7], s44 offen offset:0 sc1
    buffer_load_dwordx4 v[132:135], v1, s[4:7], s44 offen offset:1024 sc1
    buffer_load_dwordx4 v[136:139], v1, s[4:7], s44 offen offset:2048 sc1
    buffer_load_dwordx4 v[140:143], v1, s[4:7], s44 offen offset:3072 sc1
    s_add_u32 s44, s44, 4096
    buffer_load_dwordx4 v[144:147], v1, s[4:7], s44 offen offset:0 sc1
    buffer_load_dwordx4 v[148:151], v1, s[4:7], s44 offen offset:1024 sc1
    buffer_load_dwordx4 v[152:155], v1, s[4:7], s44 offen offset:2048 sc1
    buffer_load_dwordx4 v[156:159], v1, s[4:7], s44 offen offset:3072 sc1
h_cs1:
    v_add_f32 v32, v32, v36
    v_add_f32 v33, v33, v37
    v_add_f32 v34, v34, v38
    v_add_f32 v35, v35, v39
    v_add_f32 v48, v48, v52
    v_add_f32 v49, v49, v53
    v_add_f32 v50, v50, v54
    v_add_f32 v51, v51, v55
    v_add_f32 v64, v64, v68
    v_add_f32 v65, v65, v69
    v_add_f32 v66, v66, v70
    v_add_f32 v67, v67, v71
    v_add_f32 v80, v80, v84
    v_add_f32 v81, v81, v85
    v_add_f32 v82, v82, v86
    v_add_f32 v83, v83, v87
    v_add_f32 v32, v32, v40
    v_add_f32 v33, v33, v41
    v_add_f32 v34, v34, v42
    v_add_f32 v35, v35, v43
    v_add_f32 v48, v48, v56
    v_add_f32 v49, v49, v57
    v_add_f32 v50, v50, v58
    v_add_f32 v51, v51, v59
    v_add_f32 v64, v64, v72
    v_add_f32 v65, v65, v73
    v_add_f32 v66, v66, v74
    v_add_f32 v67, v67, v75
    v_add_f32 v80, v80, v88
    v_add_f32 v81, v81, v89
    v_add_f32 v82, v82, v90
    v_add_f32 v83, v83, v91
    s_barrier
    v_add_f32 v32, v32, v44
    v_add_f32 v33, v33, v45
    v_add_f32 v34, v34, v46
    v_add_f32 v35, v35, v47
    v_add_f32 v48, v48, v60
    v_add_f32 v49, v49, v61
    v_add_f32 v50, v50, v62
    v_add_f32 v51, v51, v63
    v_add_f32 v64, v64, v76
    v_add_f32 v65, v65, v77
    v_add_f32 v66, v66, v78
    v_add_f32 v67, v67, v79
    v_add_f32 v80, v80, v92
    v_add_f32 v81, v81, v93
    v_add_f32 v82, v82, v94
    v_add_f32 v83, v83, v95
    v_permlane32_swap_b32 v32, v64
    v_permlane32_swap_b32 v33, v65
    v_permlane32_swap_b32 v34, v66
    v_permlane32_swap_b32 v35, v67
    v_add_f32 v32, v32, v64
    v_add_f32 v33, v33, v65
    v_add_f32 v34, v34, v66
    v_add_f32 v35, v35, v67
    v_permlane32_swap_b32 v48, v80
    v_permlane32_swap_b32 v49, v81
    v_permlane32_swap_b32 v50, v82
    v_permlane32_swap_b32 v51, v83
    v_add_f32 v48, v48, v80
    v_add_f32 v49, v49, v81
    v_add_f32 v50, v50, v82
    v_add_f32 v51, v51, v83
    v_permlane16_swap_b32 v32, v48
    v_permlane16_swap_b32 v33, v49
    v_permlane16_swap_b32 v34, v50
    v_permlane16_swap_b32 v35, v51
    v_add_f32 v32, v32, v48
    v_add_f32 v33, v33, v49
    v_add_f32 v34, v34, v50
    v_add_f32 v35, v35, v51
    s_barrier
    v_mul_f32 v32, 0x3a800000, v32
    v_mul_f32 v33, 0x3a800000, v33
    v_mul_f32 v34, 0x3a800000, v34
    v_mul_f32 v35, 0x3a800000, v35
    v_fma_f32 v33, -v32, v32, v33
    v_fma_f32 v35, -v34, v34, v35
    v_max_f32 v33, 0, v33
    v_max_f32 v35, 0, v35
    v_add_f32 v33, 0x3727c5ac, v33
    v_add_f32 v35, 0x3727c5ac, v35
    v_rsq_f32 v33, v33
    v_rsq_f32 v35, v35
    v_lshrrev_b32 v26, 1, v1
    v_add_u32 v26, 155648, v26
    ds_write2_b32 v26, v32, v34 offset0:0 offset1:1
    ds_write2_b32 v26, v33, v35 offset0:128 offset1:129
    s_barrier
    s_cmp_ge_u32 s21, 2
    s_cbranch_scc1 h_cs_done
    s_waitcnt vmcnt(0)
    v_add_f32 v96, v96, v100
    v_add_f32 v97, v97, v101
    v_add_f32 v98, v98, v102
    v_add_f32 v99, v99, v103
    v_add_f32 v96, v96, v104
    v_add_f32 v97, v97, v105
    v_add_f32 v98, v98, v106
    v_add_f32 v99, v99, v107
    v_add_f32 v96, v96, v108
    v_add_f32 v97, v97, v109
    v_add_f32 v98, v98, v110
    v_add_f32 v99, v99, v111
    v_add_f32 v96, v96, v112
    v_add_f32 v97, v97, v113
    v_add_f32 v98, v98, v114
    v_add_f32 v99, v99, v115
    v_add_f32 v96, v96, v116
    v_add_f32 v97, v97, v117
    v_add_f32 v98, v98, v118
    v_add_f32 v99, v99, v119
    v_add_f32 v96, v96, v120
    v_add_f32 v97, v97, v121
    v_add_f32 v98, v98, v122
    v_add_f32 v99, v99, v123
    v_add_f32 v96, v96, v124
    v_add_f32 v97, v97, v125
    v_add_f32 v98, v98, v126
    v_add_f32 v99, v99, v127
    v_add_f32 v96, v96, v128
    v_add_f32 v97, v97, v129
    v_add_f32 v98, v98, v130
    v_add_f32 v99, v99, v131
    v_add_f32 v96, v96, v132
    v_add_f32 v97, v97, v133
    v_add_f32 v98, v98, v134
    v_add_f32 v99, v99, v135
    v_add_f32 v96, v96, v136
    v_add_f32 v97, v97, v137
    v_add_f32 v98, v98, v138
    v_add_f32 v99, v99, v139
    v_add_f32 v96, v96, v140
    v_add_f32 v97, v97, v141
    v_add_f32 v98, v98, v142
    v_add_f32 v99, v99, v143
    v_add_f32 v96, v96, v144
    v_add_f32 v97, v97, v145
    v_add_f32 v98, v98, v146
    v_add_f32 v99, v99, v147
    v_add_f32 v96, v96, v148
    v_add_f32 v97, v97, v149
    v_add_f32 v98, v98, v150
    v_add_f32 v99, v99, v151
    v_add_f32 v96, v96, v152
    v_add_f32 v97, v97, v153
    v_add_f32 v98, v98, v154
    v_add_f32 v99, v99, v155
    v_add_f32 v96, v96, v156
    v_add_f32 v97, v97, v157
    v_add_f32 v98, v98, v158
    v_add_f32 v99, v99, v159
    s_lshl_b32 s44, s21, 10
    s_add_u32 s44, s44, 151552
    v_add_u32 v24, s44, v1
    ds_write_b128 v24, v[96:99]
h_cs_done:
    s_waitcnt lgkmcnt(0)
    s_barrier
    s_cmp_lg_u32 s21, 0
    s_cbranch_scc1 h_f1_ok
    s_load_dword s68, s[34:35], 128
    s_mov_b32 s8, s34
    s_mov_b32 s9, s35
    s_mov_b32 s10, 256
    s_mov_b32 s11, 0x00020000
    s_mov_b32 s66, 0x10000
    v_mov_b32 v24, 0
    s_waitcnt lgkmcnt(0)
h_f1:
    s_cmp_eq_u32 s68, 8
    s_cbranch_scc1 h_f1_ok
    buffer_load_dword v25, v24, s[8:11], 0 offen offset:128 sc1
    s_waitcnt vmcnt(0)
    v_readfirstlane_b32 s68, v25
    s_sub_u32 s66, s66, 1
    s_cmp_lg_u32 s66, 0
    s_cbranch_scc1 h_f1
h_f1_ok:
    s_barrier
    s_bitcmp1_b32 s21, 0
    s_cselect_b32 s8, s28, s24
    s_cselect_b32 s9, s29, s25
    s_cselect_b32 s12, s30, s26
    s_cselect_b32 s13, s31, s27
    s_mov_b32 s10, 6291456
    s_mov_b32 s11, 0x00020000
    s_mov_b32 s14, 2097152
    s_mov_b32 s15, 0x00020000
    v_lshrrev_b32 v28, 4, v1
    v_and_b32 v29, 7, v28
    v_lshrrev_b32 v28, 3, v28
    v_mul_u32_u24 v28, 2048, v28
    v_lshl_add_u32 v28, v29, 4, v28
    s_and_b32 s3, s20, 12
    s_or_b32 s3, s3, 3
    s_lshl_b32 s3, s3, 7
    v_add_u32 v28, s3, v28
    s_lshr_b32 s3, s2, 3
    s_lshl_b32 s3, s3, 2
    s_and_b32 s60, s16, 3
    s_add_u32 s60, s60, s3
    s_lshl_b32 s61, s60, 14
    buffer_load_dwordx4 v[144:147], v28, s[12:15], s61 offen
    s_bitcmp0_b32 s21, 0
    s_cselect_b32 s56, s28, s24
    s_cselect_b32 s57, s29, s25
    s_mov_b32 s58, 6291456
    s_mov_b32 s59, 0x00020000
    v_lshrrev_b32 v28, 4, v1
    v_and_b32 v29, 7, v28
    v_lshrrev_b32 v28, 3, v28
    v_mul_u32_u24 v28, 6144, v28
    v_lshl_add_u32 v28, v29, 4, v28
    s_and_b32 s3, s18, 12
    s_or_b32 s3, s3, 3
    s_lshl_b32 s3, s3, 7
    v_add_u32 v28, s3, v28
    s_lshr_b32 s3, s2, 3
    s_lshl_b32 s3, s3, 2
    s_and_b32 s60, s16, 3
    s_add_u32 s60, s60, s3
    s_and_b32 s3, s60, 31
    s_mul_i32 s3, s3, 49152
    s_lshr_b32 s61, s60, 5
    s_min_u32 s61, s61, 2
    s_lshl_b32 s61, s61, 11
    s_add_u32 s61, s61, s3
    s_and_b32 s3, s18, 0
    s_mul_i32 s3, s3, 393216
    s_add_u32 s61, s61, s3
    buffer_load_dwordx4 v[148:151], v28, s[56:59], s61 offen
    s_cmp_lg_u32 s21, 2
    s_cbranch_scc1 h_pe
    s_bitcmp0_b32 s21, 0
    s_cselect_b32 s56, s28, s24
    s_cselect_b32 s57, s29, s25
    s_mov_b32 s58, 6291456
    s_mov_b32 s59, 0x00020000
    s_add_u32 s61, s84, 2048
    buffer_load_dwordx4 v[160:163], v11, s[56:59], s61 offen
    s_add_u32 s61, s84, 4096
    buffer_load_dwordx4 v[164:167], v11, s[56:59], s61 offen
    s_add_u32 s61, s84, 0
    buffer_load_dwordx4 v[168:171], v11, s[56:59], s61 offen
    s_add_u32 s61, s84, 198656
    buffer_load_dwordx4 v[172:175], v11, s[56:59], s61 offen
    s_add_u32 s61, s84, 200704
    buffer_load_dwordx4 v[176:179], v11, s[56:59], s61 offen
    s_add_u32 s61, s84, 196608
    buffer_load_dwordx4 v[180:183], v11, s[56:59], s61 offen
    s_add_u32 s61, s85, 2048
    buffer_load_dwordx4 v[184:187], v11, s[56:59], s61 offen
    s_add_u32 s61, s85, 4096
    buffer_load_dwordx4 v[188:191], v11, s[56:59], s61 offen
    s_add_u32 s61, s85, 0
    buffer_load_dwordx4 v[192:195], v11, s[56:59], s61 offen
    s_add_u32 s61, s85, 198656
    buffer_load_dwordx4 v[196:199], v11, s[56:59], s61 offen
h_pe:
    s_barrier
    s_branch s_tail
l_start:
    v_lshrrev_b32 v24, 4, v1
    v_lshrrev_b32 v25, 3, v24
    v_mul_u32_u24 v12, 6144, v25
    v_and_b32 v26, 2, v25
    v_lshrrev_b32 v25, 2, v25
    v_or_b32 v26, v26, v25
    v_bfe_u32 v25, v24, 1, 2
    v_xor_b32 v26, v26, v25
    v_lshl_add_u32 v12, v26, 5, v12
    v_and_b32 v26, 1, v24
    v_lshl_add_u32 v12, v26, 4, v12
    s_lshl_b32 s3, s18, 7
    v_add_u32 v12, s3, v12
    v_add_u32 v13, 48128, v12
    v_add_u32 v14, 96256, v12
    v_add_u32 v15, 144384, v12
    v_lshrrev_b32 v24, 4, v1
    v_lshrrev_b32 v25, 3, v24
    v_mul_u32_u24 v16, 2048, v25
    v_and_b32 v26, 2, v25
    v_lshrrev_b32 v25, 2, v25
    v_or_b32 v26, v26, v25
    v_bfe_u32 v25, v24, 1, 2
    v_xor_b32 v26, v26, v25
    v_lshl_add_u32 v16, v26, 5, v16
    v_and_b32 v26, 1, v24
    v_lshl_add_u32 v16, v26, 4, v16
    s_lshl_b32 s3, s20, 7
    v_add_u32 v16, s3, v16
    v_add_u32 v17, 15360, v16
    v_add_u32 v18, 30720, v16
    v_add_u32 v19, 46080, v16
    s_mul_i32 s84, s18, 393216
    s_cmp_eq_u32 s18, 1
    s_cselect_b32 s85, 0, 393216
    s_cmp_eq_u32 s18, 2
    s_cselect_b32 s86, 0, 786432
    s_cmp_eq_u32 s18, 3
    s_cselect_b32 s87, 0, 1179648
    s_cmp_eq_u32 s18, 4
    s_cselect_b32 s88, 0, 1572864
    s_cmp_eq_u32 s18, 5
    s_cselect_b32 s89, 0, 1966080
    s_cmp_eq_u32 s18, 6
    s_cselect_b32 s90, 0, 2359296
    s_cmp_eq_u32 s18, 7
    s_cselect_b32 s91, 0, 2752512
    s_cmp_eq_u32 s18, 8
    s_cselect_b32 s92, 0, 3145728
    s_cmp_eq_u32 s18, 9
    s_cselect_b32 s93, 0, 3538944
    s_cmp_eq_u32 s18, 10
    s_cselect_b32 s94, 0, 3932160
    s_cmp_eq_u32 s18, 11
    s_cselect_b32 s95, 0, 4325376
    s_cmp_eq_u32 s18, 12
    s_cselect_b32 s96, 0, 4718592
    s_cmp_eq_u32 s18, 13
    s_cselect_b32 s97, 0, 5111808
    s_cmp_eq_u32 s18, 14
    s_cselect_b32 s98, 0, 5505024
    s_cmp_eq_u32 s18, 15
    s_cselect_b32 s99, 0, 5898240
    s_and_b32 s3, s16, 3
    s_mul_i32 s3, s3, 49152
    v_add_u32 v11, s3, v12
    s_and_b32 s3, s16, 3
    s_lshl_b32 s3, s3, 10
    v_add_u32 v9, s3, v1
    v_add_u32 v10, 0x10000, v9
    s_sub_u32 s3, s16, 5
    s_lshl_b32 s41, s3, 11
    s_mul_i32 s42, s3, 98304
    s_lshl_b32 s62, s3, 15
    v_add_u32 v14, s42, v12
    v_add_u32 v15, s42, v13
    s_and_b32 s3, s20, 0
    s_lshl_b32 s3, s3, 17
    s_add_u32 s62, s62, s3
    s_bitcmp1_b32 s21, 0
    s_cselect_b32 s8, s28, s24
    s_cselect_b32 s9, s29, s25
    s_cselect_b32 s12, s30, s26
    s_cselect_b32 s13, s31, s27
    s_mov_b32 s10, 6291456
    s_mov_b32 s11, 0x00020000
    s_mov_b32 s14, 2097152
    s_mov_b32 s15, 0x00020000
    s_add_u32 m0, s41, 0
    s_add_u32 s44, s84, 2048
    buffer_load_dwordx4 v14, s[8:11], s44 offen offset:0 lds
    buffer_load_dwordx4 v15, s[8:11], s44 offen offset:1024 lds
    s_add_u32 m0, s41, 4096
    s_add_u32 s44, s84, 4096
    buffer_load_dwordx4 v14, s[8:11], s44 offen offset:0 lds
    buffer_load_dwordx4 v15, s[8:11], s44 offen offset:1024 lds
    s_add_u32 m0, s41, 8192
    s_add_u32 s44, s84, 0
    buffer_load_dwordx4 v14, s[8:11], s44 offen offset:0 lds
    buffer_load_dwordx4 v15, s[8:11], s44 offen offset:1024 lds
    s_add_u32 m0, s41, 12288
    s_add_u32 s44, s84, 198656
    buffer_load_dwordx4 v14, s[8:11], s44 offen offset:0 lds
    buffer_load_dwordx4 v15, s[8:11], s44 offen offset:1024 lds
    s_add_u32 m0, s41, 16384
    s_add_u32 s44, s84, 200704
    buffer_load_dwordx4 v14, s[8:11], s44 offen offset:0 lds
    buffer_load_dwordx4 v15, s[8:11], s44 offen offset:1024 lds
    s_add_u32 m0, s41, 20480
    s_add_u32 s44, s84, 196608
    buffer_load_dwordx4 v14, s[8:11], s44 offen offset:0 lds
    buffer_load_dwordx4 v15, s[8:11], s44 offen offset:1024 lds
    s_add_u32 m0, s41, 24576
    s_add_u32 s44, s85, 2048
    buffer_load_dwordx4 v14, s[8:11], s44 offen offset:0 lds
    buffer_load_dwordx4 v15, s[8:11], s44 offen offset:1024 lds
    s_add_u32 m0, s41, 28672
    s_add_u32 s44, s85, 4096
    buffer_load_dwordx4 v14, s[8:11], s44 offen offset:0 lds
    buffer_load_dwordx4 v15, s[8:11], s44 offen offset:1024 lds
    s_barrier
    s_waitcnt vmcnt(0)
    s_barrier
    s_add_u32 m0, s41, 32768
    s_add_u32 s44, s85, 0
    buffer_load_dwordx4 v14, s[8:11], s44 offen offset:0 lds
    buffer_load_dwordx4 v15, s[8:11], s44 offen offset:1024 lds
    s_add_u32 m0, s41, 36864
    s_add_u32 s44, s85, 198656
    buffer_load_dwordx4 v14, s[8:11], s44 offen offset:0 lds
    buffer_load_dwordx4 v15, s[8:11], s44 offen offset:1024 lds
    s_add_u32 m0, s41, 40960
    s_add_u32 s44, s85, 200704
    buffer_load_dwordx4 v14, s[8:11], s44 offen offset:0 lds
    buffer_load_dwordx4 v15, s[8:11], s44 offen offset:1024 lds
    s_add_u32 m0, s41, 45056
    s_add_u32 s44, s85, 196608
    buffer_load_dwordx4 v14, s[8:11], s44 offen offset:0 lds
    buffer_load_dwordx4 v15, s[8:11], s44 offen offset:1024 lds
    s_add_u32 m0, s41, 49152
    s_add_u32 s44, s86, 2048
    buffer_load_dwordx4 v14, s[8:11], s44 offen offset:0 lds
    buffer_load_dwordx4 v15, s[8:11], s44 offen offset:1024 lds
    s_add_u32 m0, s41, 53248
    s_add_u32 s44, s86, 4096
    buffer_load_dwordx4 v14, s[8:11], s44 offen offset:0 lds
    buffer_load_dwordx4 v15, s[8:11], s44 offen offset:1024 lds
    s_add_u32 m0, s41, 57344
    s_add_u32 s44, s86, 0
    buffer_load_dwordx4 v14, s[8:11], s44 offen offset:0 lds
    buffer_load_dwordx4 v15, s[8:11], s44 offen offset:1024 lds
    s_add_u32 m0, s41, 61440
    s_add_u32 s44, s86, 198656
    buffer_load_dwordx4 v14, s[8:11], s44 offen offset:0 lds
    buffer_load_dwordx4 v15, s[8:11], s44 offen offset:1024 lds
    s_waitcnt vmcnt(0)
    s_barrier
    s_add_u32 m0, s41, 65536
    s_add_u32 s44, s86, 200704
    buffer_load_dwordx4 v14, s[8:11], s44 offen offset:0 lds
    buffer_load_dwordx4 v15, s[8:11], s44 offen offset:1024 lds
    s_add_u32 m0, s41, 69632
    s_add_u32 s44, s86, 196608
    buffer_load_dwordx4 v14, s[8:11], s44 offen offset:0 lds
    buffer_load_dwordx4 v15, s[8:11], s44 offen offset:1024 lds
    s_add_u32 m0, s41, 73728
    s_add_u32 s44, s87, 2048
    buffer_load_dwordx4 v14, s[8:11], s44 offen offset:0 lds
    buffer_load_dwordx4 v15, s[8:11], s44 offen offset:1024 lds
    s_add_u32 m0, s41, 77824
    s_add_u32 s44, s87, 4096
    buffer_load_dwordx4 v14, s[8:11], s44 offen offset:0 lds
    buffer_load_dwordx4 v15, s[8:11], s44 offen offset:1024 lds
    s_add_u32 m0, s41, 81920
    s_add_u32 s44, s87, 0
    buffer_load_dwordx4 v14, s[8:11], s44 offen offset:0 lds
    buffer_load_dwordx4 v15, s[8:11], s44 offen offset:1024 lds
    s_add_u32 m0, s41, 86016
    s_add_u32 s44, s87, 198656
    buffer_load_dwordx4 v14, s[8:11], s44 offen offset:0 lds
    buffer_load_dwordx4 v15, s[8:11], s44 offen offset:1024 lds
    s_add_u32 m0, s41, 90112
    s_add_u32 s44, s87, 200704
    buffer_load_dwordx4 v14, s[8:11], s44 offen offset:0 lds
    buffer_load_dwordx4 v15, s[8:11], s44 offen offset:1024 lds
    s_add_u32 m0, s41, 94208
    s_add_u32 s44, s87, 196608
    buffer_load_dwordx4 v14, s[8:11], s44 offen offset:0 lds
    buffer_load_dwordx4 v15, s[8:11], s44 offen offset:1024 lds
    s_add_u32 m0, s41, 98304
    s_add_u32 s44, s88, 2048
    buffer_load_dwordx4 v14, s[8:11], s44 offen offset:0 lds
    buffer_load_dwordx4 v15, s[8:11], s44 offen offset:1024 lds
    s_add_u32 m0, s41, 102400
    s_add_u32 s44, s88, 4096
    buffer_load_dwordx4 v14, s[8:11], s44 offen offset:0 lds
    buffer_load_dwordx4 v15, s[8:11], s44 offen offset:1024 lds
    s_add_u32 m0, s41, 106496
    s_add_u32 s44, s88, 0
    buffer_load_dwordx4 v14, s[8:11], s44 offen offset:0 lds
    buffer_load_dwordx4 v15, s[8:11], s44 offen offset:1024 lds
    s_add_u32 m0, s41, 110592
    s_add_u32 s44, s88, 198656
    buffer_load_dwordx4 v14, s[8:11], s44 offen offset:0 lds
    buffer_load_dwordx4 v15, s[8:11], s44 offen offset:1024 lds
    s_add_u32 m0, s41, 114688
    s_add_u32 s44, s88, 200704
    buffer_load_dwordx4 v14, s[8:11], s44 offen offset:0 lds
    buffer_load_dwordx4 v15, s[8:11], s44 offen offset:1024 lds
    s_add_u32 m0, s41, 118784
    s_add_u32 s44, s88, 196608
    buffer_load_dwordx4 v14, s[8:11], s44 offen offset:0 lds
    buffer_load_dwordx4 v15, s[8:11], s44 offen offset:1024 lds
    s_add_u32 m0, s41, 122880
    s_add_u32 s44, s89, 2048
    buffer_load_dwordx4 v14, s[8:11], s44 offen offset:0 lds
    buffer_load_dwordx4 v15, s[8:11], s44 offen offset:1024 lds
    s_add_u32 m0, s41, 126976
    s_add_u32 s44, s89, 4096
    buffer_load_dwordx4 v14, s[8:11], s44 offen offset:0 lds
    buffer_load_dwordx4 v15, s[8:11], s44 offen offset:1024 lds
    s_add_u32 m0, s41, 0
    s_add_u32 s44, s89, 0
    buffer_load_dwordx4 v14, s[8:11], s44 offen offset:0 lds
    buffer_load_dwordx4 v15, s[8:11], s44 offen offset:1024 lds
    s_add_u32 m0, s41, 4096
    s_add_u32 s44, s89, 198656
    buffer_load_dwordx4 v14, s[8:11], s44 offen offset:0 lds
    buffer_load_dwordx4 v15, s[8:11], s44 offen offset:1024 lds
    s_add_u32 m0, s41, 8192
    s_add_u32 s44, s89, 200704
    buffer_load_dwordx4 v14, s[8:11], s44 offen offset:0 lds
    buffer_load_dwordx4 v15, s[8:11], s44 offen offset:1024 lds
    s_add_u32 m0, s41, 12288
    s_add_u32 s44, s89, 196608
    buffer_load_dwordx4 v14, s[8:11], s44 offen offset:0 lds
    buffer_load_dwordx4 v15, s[8:11], s44 offen offset:1024 lds
    s_waitcnt vmcnt(24)
    s_branch l_join
l_layer:
    s_waitcnt lgkmcnt(0)
    s_barrier
    s_add_u32 m0, s41, 0
    s_add_u32 s44, s89, 0
    buffer_load_dwordx4 v14, s[8:11], s44 offen offset:0 lds
    buffer_load_dwordx4 v15, s[8:11], s44 offen offset:1024 lds
    s_add_u32 m0, s41, 4096
    s_add_u32 s44, s89, 198656
    buffer_load_dwordx4 v14, s[8:11], s44 offen offset:0 lds
    buffer_load_dwordx4 v15, s[8:11], s44 offen offset:1024 lds
    s_add_u32 m0, s41, 8192
    s_add_u32 s44, s89, 200704
    buffer_load_dwordx4 v14, s[8:11], s44 offen offset:0 lds
    buffer_load_dwordx4 v15, s[8:11], s44 offen offset:1024 lds
    s_add_u32 m0, s41, 12288
    s_add_u32 s44, s89, 196608
    buffer_load_dwordx4 v14, s[8:11], s44 offen offset:0 lds
    buffer_load_dwordx4 v15, s[8:11], s44 offen offset:1024 lds
l_join:
    s_barrier
    s_add_u32 m0, s41, 16384
    s_add_u32 s44, s90, 2048
    buffer_load_dwordx4 v14, s[8:11], s44 offen offset:0 lds
    buffer_load_dwordx4 v15, s[8:11], s44 offen offset:1024 lds
    s_add_u32 m0, s41, 20480
    s_add_u32 s44, s90, 4096
    buffer_load_dwordx4 v14, s[8:11], s44 offen offset:0 lds
    buffer_load_dwordx4 v15, s[8:11], s44 offen offset:1024 lds
    s_add_u32 m0, s41, 24576
    s_add_u32 s44, s90, 0
    buffer_load_dwordx4 v14, s[8:11], s44 offen offset:0 lds
    buffer_load_dwordx4 v15, s[8:11], s44 offen offset:1024 lds
    s_add_u32 m0, s41, 28672
    s_add_u32 s44, s90, 198656
    buffer_load_dwordx4 v14, s[8:11], s44 offen offset:0 lds
    buffer_load_dwordx4 v15, s[8:11], s44 offen offset:1024 lds
    s_add_u32 m0, s41, 32768
    s_add_u32 s44, s90, 200704
    buffer_load_dwordx4 v14, s[8:11], s44 offen offset:0 lds
    buffer_load_dwordx4 v15, s[8:11], s44 offen offset:1024 lds
    s_add_u32 m0, s41, 36864
    s_add_u32 s44, s90, 196608
    buffer_load_dwordx4 v14, s[8:11], s44 offen offset:0 lds
    buffer_load_dwordx4 v15, s[8:11], s44 offen offset:1024 lds
    s_add_u32 m0, s41, 40960
    s_add_u32 s44, s91, 2048
    buffer_load_dwordx4 v14, s[8:11], s44 offen offset:0 lds
    buffer_load_dwordx4 v15, s[8:11], s44 offen offset:1024 lds
    s_add_u32 m0, s41, 45056
    s_add_u32 s44, s91, 4096
    buffer_load_dwordx4 v14, s[8:11], s44 offen offset:0 lds
    buffer_load_dwordx4 v15, s[8:11], s44 offen offset:1024 lds
    s_waitcnt vmcnt(24)
    s_barrier
    s_add_u32 m0, s41, 49152
    s_add_u32 s44, s91, 0
    buffer_load_dwordx4 v14, s[8:11], s44 offen offset:0 lds
    buffer_load_dwordx4 v15, s[8:11], s44 offen offset:1024 lds
    s_add_u32 m0, s41, 53248
    s_add_u32 s44, s91, 198656
    buffer_load_dwordx4 v14, s[8:11], s44 offen offset:0 lds
    buffer_load_dwordx4 v15, s[8:11], s44 offen offset:1024 lds
    s_add_u32 m0, s41, 57344
    s_add_u32 s44, s91, 200704
    buffer_load_dwordx4 v14, s[8:11], s44 offen offset:0 lds
    buffer_load_dwordx4 v15, s[8:11], s44 offen offset:1024 lds
    s_add_u32 m0, s41, 61440
    s_add_u32 s44, s91, 196608
    buffer_load_dwordx4 v14, s[8:11], s44 offen offset:0 lds
    buffer_load_dwordx4 v15, s[8:11], s44 offen offset:1024 lds
    s_waitcnt vmcnt(16)
    s_barrier
    s_add_u32 m0, s41, 65536
    s_add_u32 s44, s92, 2048
    buffer_load_dwordx4 v14, s[8:11], s44 offen offset:0 lds
    buffer_load_dwordx4 v15, s[8:11], s44 offen offset:1024 lds
    s_add_u32 m0, s41, 69632
    s_add_u32 s44, s92, 4096
    buffer_load_dwordx4 v14, s[8:11], s44 offen offset:0 lds
    buffer_load_dwordx4 v15, s[8:11], s44 offen offset:1024 lds
    s_add_u32 m0, s41, 73728
    s_add_u32 s44, s92, 0
    buffer_load_dwordx4 v14, s[8:11], s44 offen offset:0 lds
    buffer_load_dwordx4 v15, s[8:11], s44 offen offset:1024 lds
    s_add_u32 m0, s41, 77824
    s_add_u32 s44, s92, 198656
    buffer_load_dwordx4 v14, s[8:11], s44 offen offset:0 lds
    buffer_load_dwordx4 v15, s[8:11], s44 offen offset:1024 lds
    s_add_u32 m0, s41, 81920
    s_add_u32 s44, s92, 200704
    buffer_load_dwordx4 v14, s[8:11], s44 offen offset:0 lds
    buffer_load_dwordx4 v15, s[8:11], s44 offen offset:1024 lds
    s_add_u32 m0, s41, 86016
    s_add_u32 s44, s92, 196608
    buffer_load_dwordx4 v14, s[8:11], s44 offen offset:0 lds
    buffer_load_dwordx4 v15, s[8:11], s44 offen offset:1024 lds
    s_add_u32 m0, s41, 90112
    s_add_u32 s44, s93, 2048
    buffer_load_dwordx4 v14, s[8:11], s44 offen offset:0 lds
    buffer_load_dwordx4 v15, s[8:11], s44 offen offset:1024 lds
    s_add_u32 m0, s41, 94208
    s_add_u32 s44, s93, 4096
    buffer_load_dwordx4 v14, s[8:11], s44 offen offset:0 lds
    buffer_load_dwordx4 v15, s[8:11], s44 offen offset:1024 lds
    s_waitcnt vmcnt(16)
    s_barrier
    s_add_u32 m0, s41, 98304
    s_add_u32 s44, s93, 0
    buffer_load_dwordx4 v14, s[8:11], s44 offen offset:0 lds
    buffer_load_dwordx4 v15, s[8:11], s44 offen offset:1024 lds
    s_add_u32 m0, s41, 102400
    s_add_u32 s44, s93, 198656
    buffer_load_dwordx4 v14, s[8:11], s44 offen offset:0 lds
    buffer_load_dwordx4 v15, s[8:11], s44 offen offset:1024 lds
    s_add_u32 m0, s41, 106496
    s_add_u32 s44, s93, 200704
    buffer_load_dwordx4 v14, s[8:11], s44 offen offset:0 lds
    buffer_load_dwordx4 v15, s[8:11], s44 offen offset:1024 lds
    s_add_u32 m0, s41, 110592
    s_add_u32 s44, s93, 196608
    buffer_load_dwordx4 v14, s[8:11], s44 offen offset:0 lds
    buffer_load_dwordx4 v15, s[8:11], s44 offen offset:1024 lds
    s_add_u32 m0, s41, 114688
    s_add_u32 s44, s94, 2048
    buffer_load_dwordx4 v14, s[8:11], s44 offen offset:0 lds
    buffer_load_dwordx4 v15, s[8:11], s44 offen offset:1024 lds
    s_add_u32 m0, s41, 118784
    s_add_u32 s44, s94, 4096
    buffer_load_dwordx4 v14, s[8:11], s44 offen offset:0 lds
    buffer_load_dwordx4 v15, s[8:11], s44 offen offset:1024 lds
    s_add_u32 m0, s41, 122880
    s_add_u32 s44, s94, 198656
    buffer_load_dwordx4 v14, s[8:11], s44 offen offset:0 lds
    buffer_load_dwordx4 v15, s[8:11], s44 offen offset:1024 lds
    s_add_u32 m0, s41, 126976
    s_add_u32 s44, s94, 200704
    buffer_load_dwordx4 v14, s[8:11], s44 offen offset:0 lds
    buffer_load_dwordx4 v15, s[8:11], s44 offen offset:1024 lds
    s_waitcnt vmcnt(16)
    s_barrier
    s_add_u32 m0, s41, 0
    s_add_u32 s44, s95, 2048
    buffer_load_dwordx4 v14, s[8:11], s44 offen offset:0 lds
    buffer_load_dwordx4 v15, s[8:11], s44 offen offset:1024 lds
    s_add_u32 m0, s41, 4096
    s_add_u32 s44, s95, 4096
    buffer_load_dwordx4 v14, s[8:11], s44 offen offset:0 lds
    buffer_load_dwordx4 v15, s[8:11], s44 offen offset:1024 lds
    s_add_u32 m0, s41, 8192
    s_add_u32 s44, s95, 198656
    buffer_load_dwordx4 v14, s[8:11], s44 offen offset:0 lds
    buffer_load_dwordx4 v15, s[8:11], s44 offen offset:1024 lds
    s_add_u32 m0, s41, 12288
    s_add_u32 s44, s95, 200704
    buffer_load_dwordx4 v14, s[8:11], s44 offen offset:0 lds
    buffer_load_dwordx4 v15, s[8:11], s44 offen offset:1024 lds
    s_add_u32 m0, s41, 16384
    s_add_u32 s44, s96, 2048
    buffer_load_dwordx4 v14, s[8:11], s44 offen offset:0 lds
    buffer_load_dwordx4 v15, s[8:11], s44 offen offset:1024 lds
    s_add_u32 m0, s41, 20480
    s_add_u32 s44, s96, 198656
    buffer_load_dwordx4 v14, s[8:11], s44 offen offset:0 lds
    buffer_load_dwordx4 v15, s[8:11], s44 offen offset:1024 lds
    s_add_u32 m0, s41, 24576
    s_add_u32 s44, s97, 2048
    buffer_load_dwordx4 v14, s[8:11], s44 offen offset:0 lds
    buffer_load_dwordx4 v15, s[8:11], s44 offen offset:1024 lds
    s_add_u32 m0, s41, 28672
    s_add_u32 s44, s97, 198656
    buffer_load_dwordx4 v14, s[8:11], s44 offen offset:0 lds
    buffer_load_dwordx4 v15, s[8:11], s44 offen offset:1024 lds
    s_waitcnt vmcnt(16)
    s_barrier
    s_add_u32 m0, s41, 32768
    s_add_u32 s44, s98, 2048
    buffer_load_dwordx4 v14, s[8:11], s44 offen offset:0 lds
    buffer_load_dwordx4 v15, s[8:11], s44 offen offset:1024 lds
    s_add_u32 m0, s41, 36864
    s_add_u32 s44, s98, 198656
    buffer_load_dwordx4 v14, s[8:11], s44 offen offset:0 lds
    buffer_load_dwordx4 v15, s[8:11], s44 offen offset:1024 lds
    s_add_u32 m0, s41, 40960
    s_add_u32 s44, s99, 2048
    buffer_load_dwordx4 v14, s[8:11], s44 offen offset:0 lds
    buffer_load_dwordx4 v15, s[8:11], s44 offen offset:1024 lds
    s_add_u32 m0, s41, 45056
    s_add_u32 s44, s99, 198656
    buffer_load_dwordx4 v14, s[8:11], s44 offen offset:0 lds
    buffer_load_dwordx4 v15, s[8:11], s44 offen offset:1024 lds
    s_add_u32 m0, s41, 49152
    s_add_u32 s44, s96, 4096
    buffer_load_dwordx4 v14, s[8:11], s44 offen offset:0 lds
    buffer_load_dwordx4 v15, s[8:11], s44 offen offset:1024 lds
    s_add_u32 m0, s41, 53248
    s_add_u32 s44, s96, 200704
    buffer_load_dwordx4 v14, s[8:11], s44 offen offset:0 lds
    buffer_load_dwordx4 v15, s[8:11], s44 offen offset:1024 lds
    s_add_u32 m0, s41, 57344
    s_add_u32 s44, s97, 4096
    buffer_load_dwordx4 v14, s[8:11], s44 offen offset:0 lds
    buffer_load_dwordx4 v15, s[8:11], s44 offen offset:1024 lds
    s_add_u32 m0, s41, 61440
    s_add_u32 s44, s97, 200704
    buffer_load_dwordx4 v14, s[8:11], s44 offen offset:0 lds
    buffer_load_dwordx4 v15, s[8:11], s44 offen offset:1024 lds
    s_waitcnt vmcnt(16)
    s_barrier
    s_add_u32 m0, s41, 65536
    s_add_u32 s44, s98, 4096
    buffer_load_dwordx4 v14, s[8:11], s44 offen offset:0 lds
    buffer_load_dwordx4 v15, s[8:11], s44 offen offset:1024 lds
    s_add_u32 m0, s41, 69632
    s_add_u32 s44, s98, 200704
    buffer_load_dwordx4 v14, s[8:11], s44 offen offset:0 lds
    buffer_load_dwordx4 v15, s[8:11], s44 offen offset:1024 lds
    s_add_u32 m0, s41, 73728
    s_add_u32 s44, s99, 4096
    buffer_load_dwordx4 v14, s[8:11], s44 offen offset:0 lds
    buffer_load_dwordx4 v15, s[8:11], s44 offen offset:1024 lds
    s_add_u32 m0, s41, 77824
    s_add_u32 s44, s99, 200704
    buffer_load_dwordx4 v14, s[8:11], s44 offen offset:0 lds
    buffer_load_dwordx4 v15, s[8:11], s44 offen offset:1024 lds
    s_add_u32 m0, s41, 81920
    s_add_u32 s44, s94, 0
    buffer_load_dwordx4 v14, s[8:11], s44 offen offset:0 lds
    buffer_load_dwordx4 v15, s[8:11], s44 offen offset:1024 lds
    s_add_u32 m0, s41, 86016
    s_add_u32 s44, s94, 196608
    buffer_load_dwordx4 v14, s[8:11], s44 offen offset:0 lds
    buffer_load_dwordx4 v15, s[8:11], s44 offen offset:1024 lds
    s_add_u32 m0, s41, 90112
    s_add_u32 s44, s95, 0
    buffer_load_dwordx4 v14, s[8:11], s44 offen offset:0 lds
    buffer_load_dwordx4 v15, s[8:11], s44 offen offset:1024 lds
    s_add_u32 m0, s41, 94208
    s_add_u32 s44, s95, 196608
    buffer_load_dwordx4 v14, s[8:11], s44 offen offset:0 lds
    buffer_load_dwordx4 v15, s[8:11], s44 offen offset:1024 lds
    s_waitcnt vmcnt(16)
    s_barrier
    s_add_u32 m0, s41, 98304
    s_add_u32 s44, s96, 0
    buffer_load_dwordx4 v14, s[8:11], s44 offen offset:0 lds
    buffer_load_dwordx4 v15, s[8:11], s44 offen offset:1024 lds
    s_add_u32 m0, s41, 102400
    s_add_u32 s44, s96, 196608
    buffer_load_dwordx4 v14, s[8:11], s44 offen offset:0 lds
    buffer_load_dwordx4 v15, s[8:11], s44 offen offset:1024 lds
    s_add_u32 m0, s41, 106496
    s_add_u32 s44, s97, 0
    buffer_load_dwordx4 v14, s[8:11], s44 offen offset:0 lds
    buffer_load_dwordx4 v15, s[8:11], s44 offen offset:1024 lds
    s_add_u32 m0, s41, 110592
    s_add_u32 s44, s97, 196608
    buffer_load_dwordx4 v14, s[8:11], s44 offen offset:0 lds
    buffer_load_dwordx4 v15, s[8:11], s44 offen offset:1024 lds
    s_add_u32 m0, s41, 114688
    s_add_u32 s44, s98, 0
    buffer_load_dwordx4 v14, s[8:11], s44 offen offset:0 lds
    buffer_load_dwordx4 v15, s[8:11], s44 offen offset:1024 lds
    s_add_u32 m0, s41, 118784
    s_add_u32 s44, s98, 196608
    buffer_load_dwordx4 v14, s[8:11], s44 offen offset:0 lds
    buffer_load_dwordx4 v15, s[8:11], s44 offen offset:1024 lds
    s_add_u32 m0, s41, 122880
    s_add_u32 s44, s99, 0
    buffer_load_dwordx4 v14, s[8:11], s44 offen offset:0 lds
    buffer_load_dwordx4 v15, s[8:11], s44 offen offset:1024 lds
    s_add_u32 m0, s41, 126976
    s_add_u32 s44, s99, 196608
    buffer_load_dwordx4 v14, s[8:11], s44 offen offset:0 lds
    buffer_load_dwordx4 v15, s[8:11], s44 offen offset:1024 lds
    s_waitcnt vmcnt(16)
    s_barrier
    v_lshrrev_b32 v28, 4, v1
    v_and_b32 v29, 7, v28
    v_lshrrev_b32 v28, 3, v28
    v_mul_u32_u24 v28, 2048, v28
    v_lshl_add_u32 v28, v29, 4, v28
    s_and_b32 s3, s20, 12
    s_or_b32 s3, s3, 3
    s_lshl_b32 s3, s3, 7
    v_add_u32 v28, s3, v28
    s_lshr_b32 s3, s2, 3
    s_lshl_b32 s3, s3, 2
    s_and_b32 s60, s16, 3
    s_add_u32 s60, s60, s3
    s_lshl_b32 s61, s60, 14
    buffer_load_dwordx4 v[144:147], v28, s[12:15], s61 offen
    s_bitcmp0_b32 s21, 0
    s_cselect_b32 s56, s28, s24
    s_cselect_b32 s57, s29, s25
    s_mov_b32 s58, 6291456
    s_mov_b32 s59, 0x00020000
    v_lshrrev_b32 v28, 4, v1
    v_and_b32 v29, 7, v28
    v_lshrrev_b32 v28, 3, v28
    v_mul_u32_u24 v28, 6144, v28
    v_lshl_add_u32 v28, v29, 4, v28
    s_and_b32 s3, s18, 12
    s_or_b32 s3, s3, 3
    s_lshl_b32 s3, s3, 7
    v_add_u32 v28, s3, v28
    s_lshr_b32 s3, s2, 3
    s_lshl_b32 s3, s3, 2
    s_and_b32 s60, s16, 3
    s_add_u32 s60, s60, s3
    s_and_b32 s3, s60, 31
    s_mul_i32 s3, s3, 49152
    s_lshr_b32 s61, s60, 5
    s_min_u32 s61, s61, 2
    s_lshl_b32 s61, s61, 11
    s_add_u32 s61, s61, s3
    s_and_b32 s3, s18, 0
    s_mul_i32 s3, s3, 393216
    s_add_u32 s61, s61, s3
    buffer_load_dwordx4 v[148:151], v28, s[56:59], s61 offen
    s_waitcnt vmcnt(2)
    s_cmp_lg_u32 s21, 2
    s_cbranch_scc1 l_pe
    s_bitcmp0_b32 s21, 0
    s_cselect_b32 s56, s28, s24
    s_cselect_b32 s57, s29, s25
    s_mov_b32 s58, 6291456
    s_mov_b32 s59, 0x00020000
    s_add_u32 s61, s84, 2048
    buffer_load_dwordx4 v[160:163], v11, s[56:59], s61 offen
    s_add_u32 s61, s84, 4096
    buffer_load_dwordx4 v[164:167], v11, s[56:59], s61 offen
    s_add_u32 s61, s84, 0
    buffer_load_dwordx4 v[168:171], v11, s[56:59], s61 offen
    s_add_u32 s61, s84, 198656
    buffer_load_dwordx4 v[172:175], v11, s[56:59], s61 offen
    s_add_u32 s61, s84, 200704
    buffer_load_dwordx4 v[176:179], v11, s[56:59], s61 offen
    s_add_u32 s61, s84, 196608
    buffer_load_dwordx4 v[180:183], v11, s[56:59], s61 offen
    s_add_u32 s61, s85, 2048
    buffer_load_dwordx4 v[184:187], v11, s[56:59], s61 offen
    s_add_u32 s61, s85, 4096
    buffer_load_dwordx4 v[188:191], v11, s[56:59], s61 offen
    s_add_u32 s61, s85, 0
    buffer_load_dwordx4 v[192:195], v11, s[56:59], s61 offen
    s_add_u32 s61, s85, 198656
    buffer_load_dwordx4 v[196:199], v11, s[56:59], s61 offen
l_pe:
    s_barrier
    s_bitcmp1_b32 s21, 0
    s_cbranch_scc1 s_B
    s_add_u32 m0, s41, 0
    s_xor_b32 s44, s62, 0
    buffer_load_dwordx4 v16, s[12:15], s44 offen offset:0 lds
    buffer_load_dwordx4 v17, s[12:15], s44 offen offset:1024 lds
    s_add_u32 m0, s41, 4096
    s_xor_b32 s44, s62, 131072
    buffer_load_dwordx4 v16, s[12:15], s44 offen offset:0 lds
    buffer_load_dwordx4 v17, s[12:15], s44 offen offset:1024 lds
    s_add_u32 m0, s41, 8192
    s_xor_b32 s44, s62, 262144
    buffer_load_dwordx4 v16, s[12:15], s44 offen offset:0 lds
    buffer_load_dwordx4 v17, s[12:15], s44 offen offset:1024 lds
    s_add_u32 m0, s41, 12288
    s_xor_b32 s44, s62, 393216
    buffer_load_dwordx4 v16, s[12:15], s44 offen offset:0 lds
    buffer_load_dwordx4 v17, s[12:15], s44 offen offset:1024 lds
    s_add_u32 m0, s41, 16384
    s_xor_b32 s44, s62, 524288
    buffer_load_dwordx4 v16, s[12:15], s44 offen offset:0 lds
    buffer_load_dwordx4 v17, s[12:15], s44 offen offset:1024 lds
    s_add_u32 m0, s41, 20480
    s_xor_b32 s44, s62, 655360
    buffer_load_dwordx4 v16, s[12:15], s44 offen offset:0 lds
    buffer_load_dwordx4 v17, s[12:15], s44 offen offset:1024 lds
    s_add_u32 m0, s41, 24576
    s_xor_b32 s44, s62, 786432
    buffer_load_dwordx4 v16, s[12:15], s44 offen offset:0 lds
    buffer_load_dwordx4 v17, s[12:15], s44 offen offset:1024 lds
    s_add_u32 m0, s41, 28672
    s_xor_b32 s44, s62, 917504
    buffer_load_dwordx4 v16, s[12:15], s44 offen offset:0 lds
    buffer_load_dwordx4 v17, s[12:15], s44 offen offset:1024 lds
    s_add_u32 m0, s41, 32768
    s_xor_b32 s44, s62, 1048576
    buffer_load_dwordx4 v16, s[12:15], s44 offen offset:0 lds
    buffer_load_dwordx4 v17, s[12:15], s44 offen offset:1024 lds
    s_add_u32 m0, s41, 36864
    s_xor_b32 s44, s62, 1179648
    buffer_load_dwordx4 v16, s[12:15], s44 offen offset:0 lds
    buffer_load_dwordx4 v17, s[12:15], s44 offen offset:1024 lds
    s_add_u32 m0, s41, 40960
    s_xor_b32 s44, s62, 1310720
    buffer_load_dwordx4 v16, s[12:15], s44 offen offset:0 lds
    buffer_load_dwordx4 v17, s[12:15], s44 offen offset:1024 lds
    s_add_u32 m0, s41, 45056
    s_xor_b32 s44, s62, 1441792
    buffer_load_dwordx4 v16, s[12:15], s44 offen offset:0 lds
    buffer_load_dwordx4 v17, s[12:15], s44 offen offset:1024 lds
    s_add_u32 m0, s41, 49152
    s_xor_b32 s44, s62, 1572864
    buffer_load_dwordx4 v16, s[12:15], s44 offen offset:0 lds
    buffer_load_dwordx4 v17, s[12:15], s44 offen offset:1024 lds
    s_add_u32 m0, s41, 53248
    s_xor_b32 s44, s62, 1703936
    buffer_load_dwordx4 v16, s[12:15], s44 offen offset:0 lds
    buffer_load_dwordx4 v17, s[12:15], s44 offen offset:1024 lds
    s_add_u32 m0, s41, 57344
    s_xor_b32 s44, s62, 1835008
    buffer_load_dwordx4 v16, s[12:15], s44 offen offset:0 lds
    buffer_load_dwordx4 v17, s[12:15], s44 offen offset:1024 lds
    s_add_u32 m0, s41, 61440
    s_xor_b32 s44, s62, 1966080
    buffer_load_dwordx4 v16, s[12:15], s44 offen offset:0 lds
    buffer_load_dwordx4 v17, s[12:15], s44 offen offset:1024 lds
    s_branch s_tail
z_start:
    v_lshrrev_b32 v24, 4, v1
    v_lshrrev_b32 v25, 3, v24
    v_mul_u32_u24 v20, 6144, v25
    v_and_b32 v25, 7, v24
    v_lshl_add_u32 v20, v25, 4, v20
    s_add_u32 s3, s18, 2
    s_and_b32 s3, s3, 15
    s_lshl_b32 s3, s3, 7
    s_add_u32 s3, s3, 4096
    v_add_u32 v22, s3, v20
    s_add_u32 s3, s18, 1
    s_and_b32 s3, s3, 15
    s_lshl_b32 s3, s3, 7
    s_add_u32 s3, s3, 2048
    v_add_u32 v21, s3, v20
    s_add_u32 s3, s18, 0
    s_and_b32 s3, s3, 15
    s_lshl_b32 s3, s3, 7
    s_add_u32 s3, s3, 0
    v_add_u32 v20, s3, v20
    v_lshrrev_b32 v24, 4, v1
    v_lshrrev_b32 v25, 3, v24
    v_mul_u32_u24 v12, 6144, v25
    v_and_b32 v26, 2, v25
    v_lshrrev_b32 v25, 2, v25
    v_or_b32 v26, v26, v25
    v_bfe_u32 v25, v24, 1, 2
    v_xor_b32 v26, v26, v25
    v_lshl_add_u32 v12, v26, 5, v12
    v_and_b32 v26, 1, v24
    v_lshl_add_u32 v12, v26, 4, v12
    s_lshl_b32 s3, s18, 7
    v_add_u32 v12, s3, v12
    v_add_u32 v13, 48128, v12
    v_add_u32 v14, 96256, v12
    v_add_u32 v15, 144384, v12
    v_lshrrev_b32 v24, 4, v1
    v_lshrrev_b32 v25, 3, v24
    v_mul_u32_u24 v16, 2048, v25
    v_and_b32 v26, 2, v25
    v_lshrrev_b32 v25, 2, v25
    v_or_b32 v26, v26, v25
    v_bfe_u32 v25, v24, 1, 2
    v_xor_b32 v26, v26, v25
    v_lshl_add_u32 v16, v26, 5, v16
    v_and_b32 v26, 1, v24
    v_lshl_add_u32 v16, v26, 4, v16
    s_lshl_b32 s3, s20, 7
    v_add_u32 v16, s3, v16
    v_add_u32 v17, 15360, v16
    v_add_u32 v18, 30720, v16
    v_add_u32 v19, 46080, v16
    s_mul_i32 s84, s18, 393216
    s_cmp_eq_u32 s18, 1
    s_cselect_b32 s85, 0, 393216
    s_cmp_eq_u32 s18, 2
    s_cselect_b32 s86, 0, 786432
    s_cmp_eq_u32 s18, 3
    s_cselect_b32 s87, 0, 1179648
    s_cmp_eq_u32 s18, 4
    s_cselect_b32 s88, 0, 1572864
    s_cmp_eq_u32 s18, 5
    s_cselect_b32 s89, 0, 1966080
    s_cmp_eq_u32 s18, 6
    s_cselect_b32 s90, 0, 2359296
    s_cmp_eq_u32 s18, 7
    s_cselect_b32 s91, 0, 2752512
    s_cmp_eq_u32 s18, 8
    s_cselect_b32 s92, 0, 3145728
    s_cmp_eq_u32 s18, 9
    s_cselect_b32 s93, 0, 3538944
    s_cmp_eq_u32 s18, 10
    s_cselect_b32 s94, 0, 3932160
    s_cmp_eq_u32 s18, 11
    s_cselect_b32 s95, 0, 4325376
    s_cmp_eq_u32 s18, 12
    s_cselect_b32 s96, 0, 4718592
    s_cmp_eq_u32 s18, 13
    s_cselect_b32 s97, 0, 5111808
    s_cmp_eq_u32 s18, 14
    s_cselect_b32 s98, 0, 5505024
    s_cmp_eq_u32 s18, 15
    s_cselect_b32 s99, 0, 5898240
    s_and_b32 s3, s16, 3
    s_mul_i32 s3, s3, 49152
    v_add_u32 v11, s3, v12
    s_and_b32 s3, s16, 3
    s_lshl_b32 s3, s3, 10
    v_add_u32 v9, s3, v1
    v_add_u32 v10, 0x10000, v9
    s_barrier
    s_mov_b32 s8, s24
    s_mov_b32 s9, s25
    s_mov_b32 s10, 6291456
    s_mov_b32 s11, 0x00020000
    s_mul_i32 s44, s17, 393216
    buffer_load_dwordx4 v[32:35], v20, s[8:11], s44 offen
    buffer_load_dwordx4 v[64:67], v21, s[8:11], s44 offen
    buffer_load_dwordx4 v[96:99], v22, s[8:11], s44 offen
    s_add_u32 s44, s44, 49152
    buffer_load_dwordx4 v[36:39], v20, s[8:11], s44 offen
    buffer_load_dwordx4 v[68:71], v21, s[8:11], s44 offen
    buffer_load_dwordx4 v[100:103], v22, s[8:11], s44 offen
    s_add_u32 s44, s44, 49152
    buffer_load_dwordx4 v[40:43], v20, s[8:11], s44 offen
    buffer_load_dwordx4 v[72:75], v21, s[8:11], s44 offen
    buffer_load_dwordx4 v[104:107], v22, s[8:11], s44 offen
    s_add_u32 s44, s44, 49152
    buffer_load_dwordx4 v[44:47], v20, s[8:11], s44 offen
    buffer_load_dwordx4 v[76:79], v21, s[8:11], s44 offen
    buffer_load_dwordx4 v[108:111], v22, s[8:11], s44 offen
    s_add_u32 s44, s44, 49152
    buffer_load_dwordx4 v[48:51], v20, s[8:11], s44 offen
    buffer_load_dwordx4 v[80:83], v21, s[8:11], s44 offen
    buffer_load_dwordx4 v[112:115], v22, s[8:11], s44 offen
    s_add_u32 s44, s44, 49152
    buffer_load_dwordx4 v[52:55], v20, s[8:11], s44 offen
    buffer_load_dwordx4 v[84:87], v21, s[8:11], s44 offen
    buffer_load_dwordx4 v[116:119], v22, s[8:11], s44 offen
    s_add_u32 s44, s44, 49152
    buffer_load_dwordx4 v[56:59], v20, s[8:11], s44 offen
    buffer_load_dwordx4 v[88:91], v21, s[8:11], s44 offen
    buffer_load_dwordx4 v[120:123], v22, s[8:11], s44 offen
    s_add_u32 s44, s44, 49152
    buffer_load_dwordx4 v[60:63], v20, s[8:11], s44 offen
    buffer_load_dwordx4 v[92:95], v21, s[8:11], s44 offen
    buffer_load_dwordx4 v[124:127], v22, s[8:11], s44 offen
    s_barrier
    s_waitcnt vmcnt(0)
    v_lshrrev_b32 v28, 4, v1
    v_and_b32 v29, 7, v28
    v_lshrrev_b32 v28, 3, v28
    v_mul_u32_u24 v28, 6144, v28
    v_lshl_add_u32 v28, v29, 4, v28
    s_and_b32 s3, s18, 12
    s_or_b32 s3, s3, 3
    s_lshl_b32 s3, s3, 7
    v_add_u32 v28, s3, v28
    s_lshr_b32 s3, s2, 3
    s_lshl_b32 s3, s3, 2
    s_and_b32 s60, s16, 3
    s_add_u32 s60, s60, s3
    s_lshr_b32 s60, s60, 2
    s_mul_i32 s60, s60, 49152
    s_and_b32 s3, s18, 0
    s_xor_b32 s3, s3, 0
    s_mul_i32 s3, s3, 393216
    s_add_u32 s3, s3, s60
    s_add_u32 s61, s3, 0
    buffer_load_dwordx4 v[160:163], v28, s[8:11], s61 offen
    s_add_u32 s61, s3, 2048
    buffer_load_dwordx4 v[164:167], v28, s[8:11], s61 offen
    s_add_u32 s61, s3, 4096
    buffer_load_dwordx4 v[168:171], v28, s[8:11], s61 offen
    s_and_b32 s3, s18, 0
    s_xor_b32 s3, s3, 4
    s_mul_i32 s3, s3, 393216
    s_add_u32 s3, s3, s60
    s_add_u32 s61, s3, 0
    buffer_load_dwordx4 v[172:175], v28, s[8:11], s61 offen
    s_add_u32 s61, s3, 2048
    buffer_load_dwordx4 v[176:179], v28, s[8:11], s61 offen
    s_add_u32 s61, s3, 4096
    buffer_load_dwordx4 v[180:183], v28, s[8:11], s61 offen
    s_and_b32 s3, s18, 0
    s_xor_b32 s3, s3, 8
    s_mul_i32 s3, s3, 393216
    s_add_u32 s3, s3, s60
    s_add_u32 s61, s3, 0
    buffer_load_dwordx4 v[184:187], v28, s[8:11], s61 offen
    s_add_u32 s61, s3, 2048
    buffer_load_dwordx4 v[188:191], v28, s[8:11], s61 offen
    s_add_u32 s61, s3, 4096
    buffer_load_dwordx4 v[192:195], v28, s[8:11], s61 offen
    s_and_b32 s3, s18, 0
    s_xor_b32 s3, s3, 12
    s_mul_i32 s3, s3, 393216
    s_add_u32 s3, s3, s60
    s_add_u32 s61, s3, 0
    buffer_load_dwordx4 v[196:199], v28, s[8:11], s61 offen
    s_add_u32 s61, s3, 2048
    buffer_load_dwordx4 v[200:203], v28, s[8:11], s61 offen
    s_add_u32 s61, s3, 4096
    buffer_load_dwordx4 v[204:207], v28, s[8:11], s61 offen
    v_lshrrev_b32 v24, 4, v1
    v_and_b32 v25, 1, v24
    v_lshlrev_b32 v25, 4, v25
    v_mov_b32 v26, 0x3f80
    v_lshlrev_b32 v25, v25, v26
    v_bfe_u32 v26, v24, 1, 2
    v_cmp_eq_u32 vcc, 0, v26
    s_nop 1
    v_cndmask_b32 v140, 0, v25, vcc
    v_cmp_eq_u32 vcc, 1, v26
    s_nop 1
    v_cndmask_b32 v141, 0, v25, vcc
    v_cmp_eq_u32 vcc, 2, v26
    s_nop 1
    v_cndmask_b32 v142, 0, v25, vcc
    v_cmp_eq_u32 vcc, 3, v26
    s_nop 1
    v_cndmask_b32 v143, 0, v25, vcc
    s_nop 1
    v_mfma_f32_16x16x32_bf16 v[128:131], v[140:143], v[32:35], 0
    v_mfma_f32_16x16x32_bf16 v[132:135], v[140:143], v[64:67], 0
    v_mfma_f32_16x16x32_bf16 v[136:139], v[140:143], v[96:99], 0
    v_mfma_f32_16x16x32_bf16 v[128:131], v[140:143], v[36:39], v[128:131]
    v_mfma_f32_16x16x32_bf16 v[132:135], v[140:143], v[68:71], v[132:135]
    v_mfma_f32_16x16x32_bf16 v[136:139], v[140:143], v[100:103], v[136:139]
    v_mfma_f32_16x16x32_bf16 v[128:131], v[140:143], v[40:43], v[128:131]
    v_mfma_f32_16x16x32_bf16 v[132:135], v[140:143], v[72:75], v[132:135]
    v_mfma_f32_16x16x32_bf16 v[136:139], v[140:143], v[104:107], v[136:139]
    v_mfma_f32_16x16x32_bf16 v[128:131], v[140:143], v[44:47], v[128:131]
    v_mfma_f32_16x16x32_bf16 v[132:135], v[140:143], v[76:79], v[132:135]
    v_mfma_f32_16x16x32_bf16 v[136:139], v[140:143], v[108:111], v[136:139]
    v_mfma_f32_16x16x32_bf16 v[128:131], v[140:143], v[48:51], v[128:131]
    v_mfma_f32_16x16x32_bf16 v[132:135], v[140:143], v[80:83], v[132:135]
    v_mfma_f32_16x16x32_bf16 v[136:139], v[140:143], v[112:115], v[136:139]
    v_mfma_f32_16x16x32_bf16 v[128:131], v[140:143], v[52:55], v[128:131]
    v_mfma_f32_16x16x32_bf16 v[132:135], v[140:143], v[84:87], v[132:135]
    v_mfma_f32_16x16x32_bf16 v[136:139], v[140:143], v[116:119], v[136:139]
    v_mfma_f32_16x16x32_bf16 v[128:131], v[140:143], v[56:59], v[128:131]
    v_mfma_f32_16x16x32_bf16 v[132:135], v[140:143], v[88:91], v[132:135]
    v_mfma_f32_16x16x32_bf16 v[136:139], v[140:143], v[120:123], v[136:139]
    v_mfma_f32_16x16x32_bf16 v[128:131], v[140:143], v[60:63], v[128:131]
    v_mfma_f32_16x16x32_bf16 v[132:135], v[140:143], v[92:95], v[132:135]
    v_mfma_f32_16x16x32_bf16 v[136:139], v[140:143], v[124:127], v[136:139]
    v_bfe_u32 v25, v24, 3, 1
    v_lshrrev_b32 v26, 5, v24
    v_lshl_add_u32 v26, v26, 1, v25
    v_lshlrev_b32 v25, 8, v26
    v_and_b32 v27, 7, v24
    v_lshl_add_u32 v25, v27, 5, v25
    v_bfe_u32 v27, v24, 4, 1
    v_lshl_add_u32 v25, v27, 4, v25
    v_add_f32_dpp v128, v128, v128 row_ror:8 row_mask:0xf bank_mask:0xf
    v_add_f32_dpp v129, v129, v129 row_ror:8 row_mask:0xf bank_mask:0xf
    v_add_f32_dpp v130, v130, v130 row_ror:8 row_mask:0xf bank_mask:0xf
    v_add_f32_dpp v131, v131, v131 row_ror:8 row_mask:0xf bank_mask:0xf
    v_add_f32_dpp v132, v132, v132 row_ror:8 row_mask:0xf bank_mask:0xf
    v_add_f32_dpp v133, v133, v133 row_ror:8 row_mask:0xf bank_mask:0xf
    v_add_f32_dpp v134, v134, v134 row_ror:8 row_mask:0xf bank_mask:0xf
    v_add_f32_dpp v135, v135, v135 row_ror:8 row_mask:0xf bank_mask:0xf
    v_add_f32_dpp v136, v136, v136 row_ror:8 row_mask:0xf bank_mask:0xf
    v_add_f32_dpp v137, v137, v137 row_ror:8 row_mask:0xf bank_mask:0xf
    v_add_f32_dpp v138, v138, v138 row_ror:8 row_mask:0xf bank_mask:0xf
    v_add_f32_dpp v139, v139, v139 row_ror:8 row_mask:0xf bank_mask:0xf
    v_cmp_le_u32 vcc, 1, v26
    s_nop 1
    v_cndmask_b32 v128, v128, v132, vcc
    v_cndmask_b32 v129, v129, v133, vcc
    v_cndmask_b32 v130, v130, v134, vcc
    v_cndmask_b32 v131, v131, v135, vcc
    v_cmp_le_u32 vcc, 2, v26
    s_nop 1
    v_cndmask_b32 v128, v128, v136, vcc
    v_cndmask_b32 v129, v129, v137, vcc
    v_cndmask_b32 v130, v130, v138, vcc
    v_cndmask_b32 v131, v131, v139, vcc
    v_add_u32 v27, s18, v26
    v_and_b32 v27, 15, v27
    v_lshl_add_u32 v25, v27, 14, v25
    s_lshl_b32 s44, s17, 10
    s_add_u32 s44, s44, 52428800
    buffer_store_dwordx4 v[128:131], v25, s[4:7], s44 offen sc1
    s_barrier
    s_barrier
    s_waitcnt vmcnt(0)
    s_add_u32 s44, s18, 0
    s_and_b32 s44, s44, 15
    s_lshl_b32 s44, s44, 7
    s_add_u32 s44, s44, 0
    s_atomic_add s40, s[22:23], s44
    s_add_u32 s45, s18, 1
    s_and_b32 s45, s45, 15
    s_lshl_b32 s45, s45, 7
    s_add_u32 s45, s45, 0
    s_atomic_add s40, s[22:23], s45
    s_add_u32 s46, s18, 2
    s_and_b32 s46, s46, 15
    s_lshl_b32 s46, s46, 7
    s_add_u32 s46, s46, 0
    s_atomic_add s40, s[22:23], s46
    s_barrier
    s_barrier
    s_barrier
    s_barrier
    s_barrier
    s_barrier
    s_barrier
    s_mov_b32 s12, s26
    s_mov_b32 s13, s27
    s_mov_b32 s14, 2097152
    s_mov_b32 s15, 0x00020000
    s_lshl_b32 s44, s2, 13
    buffer_load_dwordx4 v[160:163], v1, s[12:15], s44 offen offset:0
    buffer_load_dwordx4 v[164:167], v1, s[12:15], s44 offen offset:1024
    buffer_load_dwordx4 v[168:171], v1, s[12:15], s44 offen offset:2048
    buffer_load_dwordx4 v[172:175], v1, s[12:15], s44 offen offset:3072
    s_add_u32 s44, s44, 4096
    buffer_load_dwordx4 v[176:179], v1, s[12:15], s44 offen offset:0
    buffer_load_dwordx4 v[180:183], v1, s[12:15], s44 offen offset:1024
    buffer_load_dwordx4 v[184:187], v1, s[12:15], s44 offen offset:2048
    buffer_load_dwordx4 v[188:191], v1, s[12:15], s44 offen offset:3072
    s_mov_b32 s8, s28
    s_mov_b32 s9, s29
    s_mov_b32 s10, 6291456
    s_mov_b32 s11, 0x00020000
    s_mul_i32 s44, s17, 393216
    buffer_load_dwordx4 v[32:35], v20, s[8:11], s44 offen
    buffer_load_dwordx4 v[64:67], v21, s[8:11], s44 offen
    buffer_load_dwordx4 v[96:99], v22, s[8:11], s44 offen
    s_add_u32 s44, s44, 49152
    buffer_load_dwordx4 v[36:39], v20, s[8:11], s44 offen
    buffer_load_dwordx4 v[68:71], v21, s[8:11], s44 offen
    buffer_load_dwordx4 v[100:103], v22, s[8:11], s44 offen
    s_add_u32 s44, s44, 49152
    buffer_load_dwordx4 v[40:43], v20, s[8:11], s44 offen
    buffer_load_dwordx4 v[72:75], v21, s[8:11], s44 offen
    buffer_load_dwordx4 v[104:107], v22, s[8:11], s44 offen
    s_add_u32 s44, s44, 49152
    s_barrier
    buffer_load_dwordx4 v[44:47], v20, s[8:11], s44 offen
    buffer_load_dwordx4 v[76:79], v21, s[8:11], s44 offen
    buffer_load_dwordx4 v[108:111], v22, s[8:11], s44 offen
    s_add_u32 s44, s44, 49152
    buffer_load_dwordx4 v[48:51], v20, s[8:11], s44 offen
    buffer_load_dwordx4 v[80:83], v21, s[8:11], s44 offen
    buffer_load_dwordx4 v[112:115], v22, s[8:11], s44 offen
    s_add_u32 s44, s44, 49152
    buffer_load_dwordx4 v[52:55], v20, s[8:11], s44 offen
    buffer_load_dwordx4 v[84:87], v21, s[8:11], s44 offen
    buffer_load_dwordx4 v[116:119], v22, s[8:11], s44 offen
    s_add_u32 s44, s44, 49152
    buffer_load_dwordx4 v[56:59], v20, s[8:11], s44 offen
    buffer_load_dwordx4 v[88:91], v21, s[8:11], s44 offen
    buffer_load_dwordx4 v[120:123], v22, s[8:11], s44 offen
    s_add_u32 s44, s44, 49152
    buffer_load_dwordx4 v[60:63], v20, s[8:11], s44 offen
    buffer_load_dwordx4 v[92:95], v21, s[8:11], s44 offen
    buffer_load_dwordx4 v[124:127], v22, s[8:11], s44 offen
    s_barrier
    s_bitcmp1_b32 s21, 0
    s_cselect_b32 s8, s28, s24
    s_cselect_b32 s9, s29, s25
    s_cselect_b32 s12, s30, s26
    s_cselect_b32 s13, s31, s27
    s_mov_b32 s10, 6291456
    s_mov_b32 s11, 0x00020000
    s_mov_b32 s14, 2097152
    s_mov_b32 s15, 0x00020000
    s_branch s_tail
z_layer:
    s_waitcnt lgkmcnt(0)
    v_lshrrev_b32 v28, 4, v1
    v_and_b32 v29, 7, v28
    v_lshrrev_b32 v28, 3, v28
    v_mul_u32_u24 v28, 6144, v28
    v_lshl_add_u32 v28, v29, 4, v28
    s_and_b32 s3, s18, 12
    s_or_b32 s3, s3, 3
    s_lshl_b32 s3, s3, 7
    v_add_u32 v28, s3, v28
    s_lshr_b32 s3, s2, 3
    s_lshl_b32 s3, s3, 2
    s_and_b32 s60, s16, 3
    s_add_u32 s60, s60, s3
    s_lshr_b32 s60, s60, 2
    s_mul_i32 s60, s60, 49152
    s_and_b32 s3, s18, 0
    s_xor_b32 s3, s3, 4
    s_mul_i32 s3, s3, 393216
    s_add_u32 s3, s3, s60
    s_add_u32 s61, s3, 0
    buffer_load_dwordx4 v[160:163], v28, s[8:11], s61 offen
    s_add_u32 s61, s3, 2048
    buffer_load_dwordx4 v[164:167], v28, s[8:11], s61 offen
    s_add_u32 s61, s3, 4096
    buffer_load_dwordx4 v[168:171], v28, s[8:11], s61 offen
    s_and_b32 s3, s18, 0
    s_xor_b32 s3, s3, 8
    s_mul_i32 s3, s3, 393216
    s_add_u32 s3, s3, s60
    s_add_u32 s61, s3, 0
    buffer_load_dwordx4 v[172:175], v28, s[8:11], s61 offen
    s_add_u32 s61, s3, 2048
    buffer_load_dwordx4 v[176:179], v28, s[8:11], s61 offen
    s_add_u32 s61, s3, 4096
    buffer_load_dwordx4 v[180:183], v28, s[8:11], s61 offen
    s_and_b32 s3, s18, 0
    s_xor_b32 s3, s3, 12
    s_mul_i32 s3, s3, 393216
    s_add_u32 s3, s3, s60
    s_add_u32 s61, s3, 0
    buffer_load_dwordx4 v[184:187], v28, s[8:11], s61 offen
    s_add_u32 s61, s3, 2048
    buffer_load_dwordx4 v[188:191], v28, s[8:11], s61 offen
    s_add_u32 s61, s3, 4096
    buffer_load_dwordx4 v[192:195], v28, s[8:11], s61 offen
    s_barrier
    s_barrier
    s_barrier
    s_barrier
    s_barrier
    s_barrier
    s_barrier
    s_barrier
    s_barrier
    s_barrier
    v_lshrrev_b32 v28, 4, v1
    v_and_b32 v29, 7, v28
    v_lshrrev_b32 v28, 3, v28
    v_mul_u32_u24 v28, 2048, v28
    v_lshl_add_u32 v28, v29, 4, v28
    s_and_b32 s3, s20, 12
    s_or_b32 s3, s3, 3
    s_lshl_b32 s3, s3, 7
    v_add_u32 v28, s3, v28
    s_lshr_b32 s3, s2, 3
    s_lshl_b32 s3, s3, 2
    s_and_b32 s60, s16, 3
    s_add_u32 s60, s60, s3
    s_lshl_b32 s61, s60, 14
    buffer_load_dwordx4 v[144:147], v28, s[12:15], s61 offen
    s_bitcmp0_b32 s21, 0
    s_cselect_b32 s56, s28, s24
    s_cselect_b32 s57, s29, s25
    s_mov_b32 s58, 6291456
    s_mov_b32 s59, 0x00020000
    v_lshrrev_b32 v28, 4, v1
    v_and_b32 v29, 7, v28
    v_lshrrev_b32 v28, 3, v28
    v_mul_u32_u24 v28, 6144, v28
    v_lshl_add_u32 v28, v29, 4, v28
    s_and_b32 s3, s18, 12
    s_or_b32 s3, s3, 3
    s_lshl_b32 s3, s3, 7
    v_add_u32 v28, s3, v28
    s_lshr_b32 s3, s2, 3
    s_lshl_b32 s3, s3, 2
    s_and_b32 s60, s16, 3
    s_add_u32 s60, s60, s3
    s_and_b32 s3, s60, 31
    s_mul_i32 s3, s3, 49152
    s_lshr_b32 s61, s60, 5
    s_min_u32 s61, s61, 2
    s_lshl_b32 s61, s61, 11
    s_add_u32 s61, s61, s3
    s_and_b32 s3, s18, 0
    s_mul_i32 s3, s3, 393216
    s_add_u32 s61, s61, s3
    buffer_load_dwordx4 v[148:151], v28, s[56:59], s61 offen
    s_cmp_lg_u32 s21, 2
    s_cbranch_scc1 z_pe
    s_bitcmp0_b32 s21, 0
    s_cselect_b32 s56, s28, s24
    s_cselect_b32 s57, s29, s25
    s_mov_b32 s58, 6291456
    s_mov_b32 s59, 0x00020000
    s_add_u32 s61, s84, 2048
    buffer_load_dwordx4 v[160:163], v11, s[56:59], s61 offen
    s_add_u32 s61, s84, 4096
    buffer_load_dwordx4 v[164:167], v11, s[56:59], s61 offen
    s_add_u32 s61, s84, 0
    buffer_load_dwordx4 v[168:171], v11, s[56:59], s61 offen
    s_add_u32 s61, s84, 198656
    buffer_load_dwordx4 v[172:175], v11, s[56:59], s61 offen
    s_add_u32 s61, s84, 200704
    buffer_load_dwordx4 v[176:179], v11, s[56:59], s61 offen
    s_add_u32 s61, s84, 196608
    buffer_load_dwordx4 v[180:183], v11, s[56:59], s61 offen
    s_add_u32 s61, s85, 2048
    buffer_load_dwordx4 v[184:187], v11, s[56:59], s61 offen
    s_add_u32 s61, s85, 4096
    buffer_load_dwordx4 v[188:191], v11, s[56:59], s61 offen
    s_add_u32 s61, s85, 0
    buffer_load_dwordx4 v[192:195], v11, s[56:59], s61 offen
    s_add_u32 s61, s85, 198656
    buffer_load_dwordx4 v[196:199], v11, s[56:59], s61 offen
z_pe:
    s_barrier
    s_branch s_tail
s_tail:
    s_bitcmp1_b32 s21, 0
    s_cbranch_scc1 s_B
    s_cmp_lg_u32 s16, 4
    s_cbranch_scc1 s_a1
    s_mov_b32 s45, 2146435072
    s_cmp_eq_u32 s17, 0
    s_cbranch_scc1 s_a0
    s_lshr_b32 s46, s21, 1
    s_lshl_b32 s44, s46, 15
    s_lshl_b32 s67, s17, 11
    s_add_u32 s44, s44, s67
    s_lshl_b32 s67, s18, 7
    s_add_u32 s44, s44, s67
    s_add_u32 s44, s44, 149504
    s_sub_u32 s45, s44, 151552
    s_lshl_b32 s45, s45, 5
    s_add_u32 s45, s45, 54525952
    s_mov_b32 s66, 0x10000
s_h_poll:
    s_mov_b32 s68, 0
    s_atomic_add s68, s[22:23], s44 offset:0 glc
    s_sub_u32 s66, s66, 1
    s_cselect_b32 s67, 1, 0
    s_waitcnt lgkmcnt(0)
    s_max_u32 s68, s68, s67
    s_cmp_lt_u32 s68, 1
    s_cbranch_scc1 s_h_poll
s_h_ok:
s_a0:
    s_mov_b32 m0, 131072
    s_nop 0
    buffer_load_dwordx4 v1, s[4:7], s45 offen offset:0 sc1 lds
    buffer_load_dwordx4 v1, s[4:7], s45 offen offset:1024 sc1 lds
    buffer_load_dwordx4 v1, s[4:7], s45 offen offset:2048 sc1 lds
    buffer_load_dwordx4 v1, s[4:7], s45 offen offset:3072 sc1 lds
    s_waitcnt vmcnt(0)
s_a1:
    s_barrier
    s_waitcnt vmcnt(0)
    s_barrier
    s_sub_u32 s3, s16, 5
    s_cmp_gt_u32 s3, 1
    s_cbranch_scc1 s_a2
    s_add_u32 m0, s41, 65536
    s_xor_b32 s44, s62, 65536
    buffer_load_dwordx4 v16, s[12:15], s44 offen offset:0 lds
    buffer_load_dwordx4 v17, s[12:15], s44 offen offset:1024 lds
    s_add_u32 m0, s41, 69632
    s_xor_b32 s44, s62, 196608
    buffer_load_dwordx4 v16, s[12:15], s44 offen offset:0 lds
    buffer_load_dwordx4 v17, s[12:15], s44 offen offset:1024 lds
    s_add_u32 m0, s41, 73728
    s_xor_b32 s44, s62, 327680
    buffer_load_dwordx4 v16, s[12:15], s44 offen offset:0 lds
    buffer_load_dwordx4 v17, s[12:15], s44 offen offset:1024 lds
    s_add_u32 m0, s41, 77824
    s_xor_b32 s44, s62, 458752
    buffer_load_dwordx4 v16, s[12:15], s44 offen offset:0 lds
    buffer_load_dwordx4 v17, s[12:15], s44 offen offset:1024 lds
    s_add_u32 m0, s41, 81920
    s_xor_b32 s44, s62, 589824
    buffer_load_dwordx4 v16, s[12:15], s44 offen offset:0 lds
    buffer_load_dwordx4 v17, s[12:15], s44 offen offset:1024 lds
    s_add_u32 m0, s41, 86016
    s_xor_b32 s44, s62, 720896
    buffer_load_dwordx4 v16, s[12:15], s44 offen offset:0 lds
    buffer_load_dwordx4 v17, s[12:15], s44 offen offset:1024 lds
    s_add_u32 m0, s41, 90112
    s_xor_b32 s44, s62, 851968
    buffer_load_dwordx4 v16, s[12:15], s44 offen offset:0 lds
    buffer_load_dwordx4 v17, s[12:15], s44 offen offset:1024 lds
    s_add_u32 m0, s41, 94208
    s_xor_b32 s44, s62, 983040
    buffer_load_dwordx4 v16, s[12:15], s44 offen offset:0 lds
    buffer_load_dwordx4 v17, s[12:15], s44 offen offset:1024 lds
    s_add_u32 m0, s41, 98304
    s_xor_b32 s44, s62, 1114112
    buffer_load_dwordx4 v16, s[12:15], s44 offen offset:0 lds
    buffer_load_dwordx4 v17, s[12:15], s44 offen offset:1024 lds
    s_add_u32 m0, s41, 102400
    s_xor_b32 s44, s62, 1245184
    buffer_load_dwordx4 v16, s[12:15], s44 offen offset:0 lds
    buffer_load_dwordx4 v17, s[12:15], s44 offen offset:1024 lds
    s_add_u32 m0, s41, 106496
    s_xor_b32 s44, s62, 1376256
    buffer_load_dwordx4 v16, s[12:15], s44 offen offset:0 lds
    buffer_load_dwordx4 v17, s[12:15], s44 offen offset:1024 lds
    s_add_u32 m0, s41, 110592
    s_xor_b32 s44, s62, 1507328
    buffer_load_dwordx4 v16, s[12:15], s44 offen offset:0 lds
    buffer_load_dwordx4 v17, s[12:15], s44 offen offset:1024 lds
    s_add_u32 m0, s41, 114688
    s_xor_b32 s44, s62, 1638400
    buffer_load_dwordx4 v16, s[12:15], s44 offen offset:0 lds
    buffer_load_dwordx4 v17, s[12:15], s44 offen offset:1024 lds
    s_add_u32 m0, s41, 118784
    s_xor_b32 s44, s62, 1769472
    buffer_load_dwordx4 v16, s[12:15], s44 offen offset:0 lds
    buffer_load_dwordx4 v17, s[12:15], s44 offen offset:1024 lds
    s_add_u32 m0, s41, 122880
    s_xor_b32 s44, s62, 1900544
    buffer_load_dwordx4 v16, s[12:15], s44 offen offset:0 lds
    buffer_load_dwordx4 v17, s[12:15], s44 offen offset:1024 lds
    s_add_u32 m0, s41, 126976
    s_xor_b32 s44, s62, 2031616
    buffer_load_dwordx4 v16, s[12:15], s44 offen offset:0 lds
    buffer_load_dwordx4 v17, s[12:15], s44 offen offset:1024 lds
s_a2:
    s_cmp_eq_u32 s21, 2
    s_cbranch_scc1 s_a3
    s_bitcmp0_b32 s21, 0
    s_cselect_b32 s56, s28, s24
    s_cselect_b32 s57, s29, s25
    s_mov_b32 s58, 6291456
    s_mov_b32 s59, 0x00020000
    s_add_u32 s61, s84, 2048
    buffer_load_dwordx4 v[160:163], v11, s[56:59], s61 offen
    s_add_u32 s61, s84, 4096
    buffer_load_dwordx4 v[164:167], v11, s[56:59], s61 offen
    s_add_u32 s61, s84, 0
    buffer_load_dwordx4 v[168:171], v11, s[56:59], s61 offen
    s_add_u32 s61, s84, 198656
    buffer_load_dwordx4 v[172:175], v11, s[56:59], s61 offen
    s_add_u32 s61, s84, 200704
    buffer_load_dwordx4 v[176:179], v11, s[56:59], s61 offen
    s_add_u32 s61, s84, 196608
    buffer_load_dwordx4 v[180:183], v11, s[56:59], s61 offen
    s_add_u32 s61, s85, 2048
    buffer_load_dwordx4 v[184:187], v11, s[56:59], s61 offen
    s_add_u32 s61, s85, 4096
    buffer_load_dwordx4 v[188:191], v11, s[56:59], s61 offen
    s_add_u32 s61, s85, 0
    buffer_load_dwordx4 v[192:195], v11, s[56:59], s61 offen
    s_add_u32 s61, s85, 198656
    buffer_load_dwordx4 v[196:199], v11, s[56:59], s61 offen
s_a3:
    s_bitcmp0_b32 s21, 0
    s_cselect_b32 s56, s28, s24
    s_cselect_b32 s57, s29, s25
    s_mov_b32 s58, 6291456
    s_mov_b32 s59, 0x00020000
    s_add_u32 s61, s85, 200704
    buffer_load_dwordx4 v[200:203], v11, s[56:59], s61 offen
    s_add_u32 s61, s85, 196608
    buffer_load_dwordx4 v[204:207], v11, s[56:59], s61 offen
    s_add_u32 s61, s86, 2048
    buffer_load_dwordx4 v[208:211], v11, s[56:59], s61 offen
    s_add_u32 s61, s86, 4096
    buffer_load_dwordx4 v[212:215], v11, s[56:59], s61 offen
    s_add_u32 s61, s86, 0
    buffer_load_dwordx4 v[216:219], v11, s[56:59], s61 offen
    s_add_u32 s61, s86, 198656
    buffer_load_dwordx4 v[220:223], v11, s[56:59], s61 offen
    s_add_u32 s61, s86, 200704
    buffer_load_dwordx4 v[224:227], v11, s[56:59], s61 offen
    s_add_u32 s61, s86, 196608
    buffer_load_dwordx4 v[228:231], v11, s[56:59], s61 offen
    s_add_u32 s61, s87, 2048
    buffer_load_dwordx4 v[232:235], v11, s[56:59], s61 offen
    s_add_u32 s61, s87, 4096
    buffer_load_dwordx4 v[236:239], v11, s[56:59], s61 offen
    s_add_u32 s61, s87, 0
    buffer_load_dwordx4 v[240:243], v11, s[56:59], s61 offen
    s_add_u32 s61, s87, 198656
    buffer_load_dwordx4 v[244:247], v11, s[56:59], s61 offen
    s_add_u32 s61, s87, 200704
    buffer_load_dwordx4 v[248:251], v11, s[56:59], s61 offen
    s_add_u32 s61, s87, 196608
    buffer_load_dwordx4 v[252:255], v11, s[56:59], s61 offen
    s_waitcnt vmcnt(0)
    s_lshl_b32 s3, s21, 3
    s_add_u32 s3, s3, s16
    s_cmp_lg_u32 s3, 7
    s_cbranch_scc1 s_g3
    v_lshrrev_b32 v24, 4, v1
    v_and_b32 v25, 1, v24
    v_lshlrev_b32 v25, 4, v25
    v_mov_b32 v26, 0x3f80
    v_lshlrev_b32 v25, v25, v26
    v_bfe_u32 v26, v24, 1, 2
    v_cmp_eq_u32 vcc, 0, v26
    s_nop 1
    v_cndmask_b32 v140, 0, v25, vcc
    v_cmp_eq_u32 vcc, 1, v26
    s_nop 1
    v_cndmask_b32 v141, 0, v25, vcc
    v_cmp_eq_u32 vcc, 2, v26
    s_nop 1
    v_cndmask_b32 v142, 0, v25, vcc
    v_cmp_eq_u32 vcc, 3, v26
    s_nop 1
    v_cndmask_b32 v143, 0, v25, vcc
    s_nop 1
    v_mfma_f32_16x16x32_bf16 v[128:131], v[140:143], v[32:35], 0
    v_mfma_f32_16x16x32_bf16 v[132:135], v[140:143], v[64:67], 0
    v_mfma_f32_16x16x32_bf16 v[136:139], v[140:143], v[96:99], 0
    v_mfma_f32_16x16x32_bf16 v[128:131], v[140:143], v[36:39], v[128:131]
    v_mfma_f32_16x16x32_bf16 v[132:135], v[140:143], v[68:71], v[132:135]
    v_mfma_f32_16x16x32_bf16 v[136:139], v[140:143], v[100:103], v[136:139]
    v_mfma_f32_16x16x32_bf16 v[128:131], v[140:143], v[40:43], v[128:131]
    v_mfma_f32_16x16x32_bf16 v[132:135], v[140:143], v[72:75], v[132:135]
    v_mfma_f32_16x16x32_bf16 v[136:139], v[140:143], v[104:107], v[136:139]
    v_mfma_f32_16x16x32_bf16 v[128:131], v[140:143], v[44:47], v[128:131]
    v_mfma_f32_16x16x32_bf16 v[132:135], v[140:143], v[76:79], v[132:135]
    v_mfma_f32_16x16x32_bf16 v[136:139], v[140:143], v[108:111], v[136:139]
    v_mfma_f32_16x16x32_bf16 v[128:131], v[140:143], v[48:51], v[128:131]
    v_mfma_f32_16x16x32_bf16 v[132:135], v[140:143], v[80:83], v[132:135]
    v_mfma_f32_16x16x32_bf16 v[136:139], v[140:143], v[112:115], v[136:139]
    v_mfma_f32_16x16x32_bf16 v[128:131], v[140:143], v[52:55], v[128:131]
    v_mfma_f32_16x16x32_bf16 v[132:135], v[140:143], v[84:87], v[132:135]
    v_mfma_f32_16x16x32_bf16 v[136:139], v[140:143], v[116:119], v[136:139]
    v_mfma_f32_16x16x32_bf16 v[128:131], v[140:143], v[56:59], v[128:131]
    v_mfma_f32_16x16x32_bf16 v[132:135], v[140:143], v[88:91], v[132:135]
    v_mfma_f32_16x16x32_bf16 v[136:139], v[140:143], v[120:123], v[136:139]
    v_mfma_f32_16x16x32_bf16 v[128:131], v[140:143], v[60:63], v[128:131]
    v_mfma_f32_16x16x32_bf16 v[132:135], v[140:143], v[92:95], v[132:135]
    v_mfma_f32_16x16x32_bf16 v[136:139], v[140:143], v[124:127], v[136:139]
    v_bfe_u32 v25, v24, 3, 1
    v_lshrrev_b32 v26, 5, v24
    v_lshl_add_u32 v26, v26, 1, v25
    v_lshlrev_b32 v25, 8, v26
    v_and_b32 v27, 7, v24
    v_lshl_add_u32 v25, v27, 5, v25
    v_bfe_u32 v27, v24, 4, 1
    v_lshl_add_u32 v25, v27, 4, v25
    v_add_f32_dpp v128, v128, v128 row_ror:8 row_mask:0xf bank_mask:0xf
    v_add_f32_dpp v129, v129, v129 row_ror:8 row_mask:0xf bank_mask:0xf
    v_add_f32_dpp v130, v130, v130 row_ror:8 row_mask:0xf bank_mask:0xf
    v_add_f32_dpp v131, v131, v131 row_ror:8 row_mask:0xf bank_mask:0xf
    v_add_f32_dpp v132, v132, v132 row_ror:8 row_mask:0xf bank_mask:0xf
    v_add_f32_dpp v133, v133, v133 row_ror:8 row_mask:0xf bank_mask:0xf
    v_add_f32_dpp v134, v134, v134 row_ror:8 row_mask:0xf bank_mask:0xf
    v_add_f32_dpp v135, v135, v135 row_ror:8 row_mask:0xf bank_mask:0xf
    v_add_f32_dpp v136, v136, v136 row_ror:8 row_mask:0xf bank_mask:0xf
    v_add_f32_dpp v137, v137, v137 row_ror:8 row_mask:0xf bank_mask:0xf
    v_add_f32_dpp v138, v138, v138 row_ror:8 row_mask:0xf bank_mask:0xf
    v_add_f32_dpp v139, v139, v139 row_ror:8 row_mask:0xf bank_mask:0xf
    v_cmp_le_u32 vcc, 1, v26
    s_nop 1
    v_cndmask_b32 v128, v128, v132, vcc
    v_cndmask_b32 v129, v129, v133, vcc
    v_cndmask_b32 v130, v130, v134, vcc
    v_cndmask_b32 v131, v131, v135, vcc
    v_cmp_le_u32 vcc, 2, v26
    s_nop 1
    v_cndmask_b32 v128, v128, v136, vcc
    v_cndmask_b32 v129, v129, v137, vcc
    v_cndmask_b32 v130, v130, v138, vcc
    v_cndmask_b32 v131, v131, v139, vcc
    v_add_u32 v27, s18, v26
    v_and_b32 v27, 15, v27
    v_lshl_add_u32 v25, v27, 14, v25
    s_lshl_b32 s44, s17, 10
    s_add_u32 s44, s44, 52690944
    buffer_store_dwordx4 v[128:131], v25, s[4:7], s44 offen sc1
    s_waitcnt vmcnt(0)
    s_add_u32 s44, s18, 0
    s_and_b32 s44, s44, 15
    s_lshl_b32 s44, s44, 7
    s_add_u32 s44, s44, 2048
    s_atomic_add s40, s[22:23], s44
    s_add_u32 s45, s18, 1
    s_and_b32 s45, s45, 15
    s_lshl_b32 s45, s45, 7
    s_add_u32 s45, s45, 2048
    s_atomic_add s40, s[22:23], s45
    s_add_u32 s46, s18, 2
    s_and_b32 s46, s46, 15
    s_lshl_b32 s46, s46, 7
    s_add_u32 s46, s46, 2048
    s_atomic_add s40, s[22:23], s46
    s_branch s_g3
s_B:
    s_barrier
    s_cmp_eq_u32 s21, 3
    s_cbranch_scc1 s_nopf
    s_bitcmp0_b32 s21, 0
    s_cselect_b32 s56, s28, s24
    s_cselect_b32 s57, s29, s25
    s_mov_b32 s58, 6291456
    s_mov_b32 s59, 0x00020000
    s_add_u32 s61, s84, 2048
    buffer_load_dwordx4 v[160:163], v11, s[56:59], s61 offen
    s_add_u32 s61, s84, 4096
    buffer_load_dwordx4 v[164:167], v11, s[56:59], s61 offen
    s_add_u32 s61, s84, 0
    buffer_load_dwordx4 v[168:171], v11, s[56:59], s61 offen
    s_add_u32 s61, s84, 198656
    buffer_load_dwordx4 v[172:175], v11, s[56:59], s61 offen
    s_waitcnt vmcnt(2)
    s_add_u32 s61, s84, 200704
    buffer_load_dwordx4 v[176:179], v11, s[56:59], s61 offen
    s_add_u32 s61, s84, 196608
    buffer_load_dwordx4 v[180:183], v11, s[56:59], s61 offen
    s_add_u32 s61, s85, 2048
    buffer_load_dwordx4 v[184:187], v11, s[56:59], s61 offen
    s_add_u32 s61, s85, 4096
    buffer_load_dwordx4 v[188:191], v11, s[56:59], s61 offen
    s_waitcnt vmcnt(2)
    s_add_u32 s61, s85, 0
    buffer_load_dwordx4 v[192:195], v11, s[56:59], s61 offen
    s_add_u32 s61, s85, 198656
    buffer_load_dwordx4 v[196:199], v11, s[56:59], s61 offen
    s_add_u32 s61, s85, 200704
    buffer_load_dwordx4 v[200:203], v11, s[56:59], s61 offen
    s_add_u32 s61, s85, 196608
    buffer_load_dwordx4 v[204:207], v11, s[56:59], s61 offen
    s_waitcnt vmcnt(2)
    s_add_u32 s61, s86, 2048
    buffer_load_dwordx4 v[208:211], v11, s[56:59], s61 offen
    s_add_u32 s61, s86, 4096
    buffer_load_dwordx4 v[212:215], v11, s[56:59], s61 offen
    s_add_u32 s61, s86, 0
    buffer_load_dwordx4 v[216:219], v11, s[56:59], s61 offen
    s_add_u32 s61, s86, 198656
    buffer_load_dwordx4 v[220:223], v11, s[56:59], s61 offen
    s_waitcnt vmcnt(2)
    s_add_u32 s61, s86, 200704
    buffer_load_dwordx4 v[224:227], v11, s[56:59], s61 offen
    s_add_u32 s61, s86, 196608
    buffer_load_dwordx4 v[228:231], v11, s[56:59], s61 offen
    s_add_u32 s61, s87, 2048
    buffer_load_dwordx4 v[232:235], v11, s[56:59], s61 offen
    s_add_u32 s61, s87, 4096
    buffer_load_dwordx4 v[236:239], v11, s[56:59], s61 offen
    s_waitcnt vmcnt(2)
    s_add_u32 s61, s87, 0
    buffer_load_dwordx4 v[240:243], v11, s[56:59], s61 offen
    s_add_u32 s61, s87, 198656
    buffer_load_dwordx4 v[244:247], v11, s[56:59], s61 offen
    s_add_u32 s61, s87, 200704
    buffer_load_dwordx4 v[248:251], v11, s[56:59], s61 offen
    s_add_u32 s61, s87, 196608
    buffer_load_dwordx4 v[252:255], v11, s[56:59], s61 offen
    s_waitcnt vmcnt(2)
    s_lshl_b32 s3, s2, 2
    s_and_b32 s60, s16, 3
    s_add_u32 s60, s60, s3
    s_lshl_b32 s60, s60, 11
    buffer_load_dwordx4 v[96:99], v1, s[12:15], s60 offen offset:0
    buffer_load_dwordx4 v[100:103], v1, s[12:15], s60 offen offset:1024
s_nopf:
    s_setprio 3
    s_mov_b32 s52, 0
    s_lshl_b32 s44, s16, 14
    v_add_u32 v24, s44, v1
    s_and_b32 s3, s16, 3
    s_lshl_b32 s44, s3, 10
    s_add_u32 s44, s44, 147456
    v_lshrrev_b32 v25, 2, v1
    v_add_u32 v25, s44, v25
    s_lshl_b32 s53, s21, 22
    s_lshl_b32 s44, s38, 16
    s_add_u32 s53, s53, s44
    s_lshl_b32 s44, s18, 12
    s_add_u32 s53, s53, s44
    s_add_u32 s53, s53, 16777216
    s_lshl_b32 s54, s21, 14
    s_lshl_b32 s67, s38, 8
    s_add_u32 s54, s54, s67
    s_add_u32 s54, s54, 86016
s_bhead:
    s_barrier
    s_waitcnt vmcnt(0) lgkmcnt(0)
    s_barrier
    ds_read_b32 v28, v25 offset:0
    ds_read_b32 v29, v25 offset:256
    ds_read_b32 v30, v25 offset:512
    ds_read_b32 v31, v25 offset:768
    ds_read_b128 v[32:35], v24 offset:0
    ds_read_b128 v[36:39], v24 offset:1024
    ds_read_b128 v[40:43], v24 offset:2048
    ds_read_b128 v[44:47], v24 offset:3072
    ds_read_b128 v[48:51], v24 offset:4096
    ds_read_b128 v[52:55], v24 offset:5120
    ds_read_b128 v[56:59], v24 offset:6144
    ds_read_b128 v[60:63], v24 offset:7168
    ds_read_b128 v[64:67], v24 offset:8192
    ds_read_b128 v[68:71], v24 offset:9216
    ds_read_b128 v[72:75], v24 offset:10240
    ds_read_b128 v[76:79], v24 offset:11264
    ds_read_b128 v[80:83], v24 offset:12288
    ds_read_b128 v[84:87], v24 offset:13312
    ds_read_b128 v[88:91], v24 offset:14336
    ds_read_b128 v[92:95], v24 offset:15360
    s_waitcnt lgkmcnt(14)
    v_add_f32 v28, v28, v29
    v_add_f32 v30, v30, v31
    v_add_f32 v28, v28, v30
    v_mov_b32 v29, 0x5d800000
    v_mov_b32 v30, 0x21800000
    v_cmp_nlt_f32 s[44:45], v28, v29
    v_cmp_ngt_f32 vcc, v28, v30
    v_rcp_f32 v28, v28
    s_or_b64 vcc, vcc, s[44:45]
    s_waitcnt lgkmcnt(8)
    v_pk_add_f32 v[32:33], v[32:33], v[48:49]
    v_pk_add_f32 v[34:35], v[34:35], v[50:51]
    v_pk_add_f32 v[36:37], v[36:37], v[52:53]
    v_pk_add_f32 v[38:39], v[38:39], v[54:55]
    v_pk_add_f32 v[40:41], v[40:41], v[56:57]
    v_pk_add_f32 v[42:43], v[42:43], v[58:59]
    v_pk_add_f32 v[44:45], v[44:45], v[60:61]
    v_pk_add_f32 v[46:47], v[46:47], v[62:63]
    s_waitcnt lgkmcnt(4)
    v_pk_add_f32 v[32:33], v[32:33], v[64:65]
    v_pk_add_f32 v[34:35], v[34:35], v[66:67]
    v_pk_add_f32 v[36:37], v[36:37], v[68:69]
    v_pk_add_f32 v[38:39], v[38:39], v[70:71]
    v_pk_add_f32 v[40:41], v[40:41], v[72:73]
    v_pk_add_f32 v[42:43], v[42:43], v[74:75]
    v_pk_add_f32 v[44:45], v[44:45], v[76:77]
    v_pk_add_f32 v[46:47], v[46:47], v[78:79]
    s_waitcnt lgkmcnt(0)
    v_pk_add_f32 v[32:33], v[32:33], v[80:81]
    v_pk_add_f32 v[34:35], v[34:35], v[82:83]
    v_pk_add_f32 v[36:37], v[36:37], v[84:85]
    v_pk_add_f32 v[38:39], v[38:39], v[86:87]
    v_pk_add_f32 v[40:41], v[40:41], v[88:89]
    v_pk_add_f32 v[42:43], v[42:43], v[90:91]
    v_pk_add_f32 v[44:45], v[44:45], v[92:93]
    v_pk_add_f32 v[46:47], v[46:47], v[94:95]
    s_cbranch_vccnz s_slow
s_fin:
    v_pk_mul_f32 v[32:33], v[28:29], v[32:33] op_sel_hi:[0,1]
    v_pk_mul_f32 v[34:35], v[28:29], v[34:35] op_sel_hi:[0,1]
    v_pk_mul_f32 v[36:37], v[28:29], v[36:37] op_sel_hi:[0,1]
    v_pk_mul_f32 v[38:39], v[28:29], v[38:39] op_sel_hi:[0,1]
    v_pk_mul_f32 v[40:41], v[28:29], v[40:41] op_sel_hi:[0,1]
    v_pk_mul_f32 v[42:43], v[28:29], v[42:43] op_sel_hi:[0,1]
    v_pk_mul_f32 v[44:45], v[28:29], v[44:45] op_sel_hi:[0,1]
    v_pk_mul_f32 v[46:47], v[28:29], v[46:47] op_sel_hi:[0,1]
    v_cvt_pk_bf16_f32 v32, v32, v33
    v_cvt_pk_bf16_f32 v33, v34, v35
    v_cvt_pk_bf16_f32 v34, v36, v37
    v_cvt_pk_bf16_f32 v35, v38, v39
    v_cvt_pk_bf16_f32 v36, v40, v41
    v_cvt_pk_bf16_f32 v37, v42, v43
    v_cvt_pk_bf16_f32 v38, v44, v45
    v_cvt_pk_bf16_f32 v39, v46, v47
    buffer_store_dwordx4 v[32:35], v1, s[4:7], s53 offen offset:0 sc1
    buffer_store_dwordx4 v[36:39], v1, s[4:7], s53 offen offset:1024 sc1
    s_cmp_lg_u32 s52, 0
    s_cbranch_scc1 s_b2
    s_waitcnt vmcnt(0)
    s_atomic_add s40, s[22:23], s54
    s_mov_b32 s52, 1
    s_add_u32 s53, s53, 2048
    s_waitcnt lgkmcnt(0)
    s_add_u32 s54, s54, 128
    s_setprio 0
    s_and_b32 s3, s16, 3
    s_lshl_b32 s46, s3, 19
    s_lshl_b32 s45, s3, 14
    s_and_b32 s3, s20, 0
    s_lshl_b32 s3, s3, 17
    s_xor_b32 s46, s46, s3
    s_add_u32 m0, s45, 0
    s_xor_b32 s44, s46, 0
    buffer_load_dwordx4 v16, s[12:15], s44 offen offset:0 lds
    buffer_load_dwordx4 v17, s[12:15], s44 offen offset:1024 lds
    buffer_load_dwordx4 v18, s[12:15], s44 offen offset:2048 lds
    buffer_load_dwordx4 v19, s[12:15], s44 offen offset:3072 lds
    s_add_u32 s44, s44, 65536
    s_waitcnt vmcnt(2)
    buffer_load_dwordx4 v[96:99], v16, s[12:15], s44 offen offset:0
    buffer_load_dwordx4 v[100:103], v17, s[12:15], s44 offen offset:1024
    buffer_load_dwordx4 v[104:107], v18, s[12:15], s44 offen offset:2048
    buffer_load_dwordx4 v[108:111], v19, s[12:15], s44 offen offset:3072
    s_waitcnt vmcnt(2)
    s_add_u32 m0, s45, 4096
    s_xor_b32 s44, s46, 131072
    buffer_load_dwordx4 v16, s[12:15], s44 offen offset:0 lds
    buffer_load_dwordx4 v17, s[12:15], s44 offen offset:1024 lds
    buffer_load_dwordx4 v18, s[12:15], s44 offen offset:2048 lds
    buffer_load_dwordx4 v19, s[12:15], s44 offen offset:3072 lds
    s_add_u32 s44, s44, 65536
    s_waitcnt vmcnt(2)
    buffer_load_dwordx4 v[112:115], v16, s[12:15], s44 offen offset:0
    buffer_load_dwordx4 v[116:119], v17, s[12:15], s44 offen offset:1024
    buffer_load_dwordx4 v[120:123], v18, s[12:15], s44 offen offset:2048
    buffer_load_dwordx4 v[124:127], v19, s[12:15], s44 offen offset:3072
    s_waitcnt vmcnt(2)
    s_add_u32 m0, s45, 8192
    s_xor_b32 s44, s46, 262144
    buffer_load_dwordx4 v16, s[12:15], s44 offen offset:0 lds
    buffer_load_dwordx4 v17, s[12:15], s44 offen offset:1024 lds
    buffer_load_dwordx4 v18, s[12:15], s44 offen offset:2048 lds
    buffer_load_dwordx4 v19, s[12:15], s44 offen offset:3072 lds
    s_add_u32 s44, s44, 65536
    s_waitcnt vmcnt(2)
    buffer_load_dwordx4 v[128:131], v16, s[12:15], s44 offen offset:0
    buffer_load_dwordx4 v[132:135], v17, s[12:15], s44 offen offset:1024
    buffer_load_dwordx4 v[136:139], v18, s[12:15], s44 offen offset:2048
    buffer_load_dwordx4 v[140:143], v19, s[12:15], s44 offen offset:3072
    s_waitcnt vmcnt(2)
    s_add_u32 m0, s45, 12288
    s_xor_b32 s44, s46, 393216
    buffer_load_dwordx4 v16, s[12:15], s44 offen offset:0 lds
    buffer_load_dwordx4 v17, s[12:15], s44 offen offset:1024 lds
    buffer_load_dwordx4 v18, s[12:15], s44 offen offset:2048 lds
    buffer_load_dwordx4 v19, s[12:15], s44 offen offset:3072 lds
    s_add_u32 s44, s44, 65536
    s_waitcnt vmcnt(2)
    buffer_load_dwordx4 v[144:147], v16, s[12:15], s44 offen offset:0
    buffer_load_dwordx4 v[148:151], v17, s[12:15], s44 offen offset:1024
    buffer_load_dwordx4 v[152:155], v18, s[12:15], s44 offen offset:2048
    buffer_load_dwordx4 v[156:159], v19, s[12:15], s44 offen offset:3072
    s_waitcnt vmcnt(2)
    s_setprio 3
    s_sub_u32 s44, s54, 128
    s_mov_b32 s66, 0x10000
s_o0_poll:
    s_mov_b32 s68, 0
    s_atomic_add s68, s[22:23], s44 offset:0 glc
    s_sub_u32 s66, s66, 1
    s_cselect_b32 s67, 16, 0
    s_waitcnt lgkmcnt(0)
    s_max_u32 s68, s68, s67
    s_cmp_lt_u32 s68, 16
    s_cbranch_scc1 s_o0_poll
s_o0_ok:
    s_branch s_bhead
s_b2:
    ds_write_b128 v24, v[96:99] offset:0
    ds_write_b128 v24, v[100:103] offset:1024
    ds_write_b128 v24, v[104:107] offset:2048
    ds_write_b128 v24, v[108:111] offset:3072
    ds_write_b128 v24, v[112:115] offset:4096
    ds_write_b128 v24, v[116:119] offset:5120
    ds_write_b128 v24, v[120:123] offset:6144
    ds_write_b128 v24, v[124:127] offset:7168
    ds_write_b128 v24, v[128:131] offset:8192
    ds_write_b128 v24, v[132:135] offset:9216
    ds_write_b128 v24, v[136:139] offset:10240
    ds_write_b128 v24, v[140:143] offset:11264
    ds_write_b128 v24, v[144:147] offset:12288
    ds_write_b128 v24, v[148:151] offset:13312
    ds_write_b128 v24, v[152:155] offset:14336
    ds_write_b128 v24, v[156:159] offset:15360
    s_waitcnt vmcnt(0)
    s_atomic_add s40, s[22:23], s54
    s_mov_b32 s66, 0x10000
s_o1_poll:
    s_mov_b32 s68, 0
    s_atomic_add s68, s[22:23], s54 offset:0 glc
    s_sub_u32 s66, s66, 1
    s_cselect_b32 s67, 16, 0
    s_waitcnt lgkmcnt(0)
    s_max_u32 s68, s68, s67
    s_cmp_lt_u32 s68, 16
    s_cbranch_scc1 s_o1_poll
s_o1_ok:
s_b3:
    s_setprio 0
    s_waitcnt lgkmcnt(0)
s_g3:
    s_barrier
    s_cmp_eq_u32 s21, 3
    s_cbranch_scc1 s_end
    s_barrier
    ds_write_b128 v9, v[160:163] offset:0
    ds_write_b128 v9, v[164:167] offset:4096
    ds_write_b128 v9, v[168:171] offset:8192
    ds_write_b128 v9, v[172:175] offset:12288
    ds_write_b128 v9, v[176:179] offset:16384
    ds_write_b128 v9, v[180:183] offset:20480
    ds_write_b128 v9, v[184:187] offset:24576
    ds_write_b128 v9, v[188:191] offset:28672
    s_add_u32 s21, s21, 1
    s_bitcmp1_b32 s21, 0
    s_cselect_b32 s8, s28, s24
    s_cselect_b32 s9, s29, s25
    s_cselect_b32 s12, s30, s26
    s_cselect_b32 s13, s31, s27
    s_mov_b32 s10, 6291456
    s_mov_b32 s11, 0x00020000
    s_mov_b32 s14, 2097152
    s_mov_b32 s15, 0x00020000
    s_sub_u32 s3, s16, 5
    s_cmp_gt_u32 s3, 1
    s_cbranch_scc1 s_n67
    s_add_u32 m0, s41, 98304
    s_add_u32 s44, s88, 2048
    buffer_load_dwordx4 v14, s[8:11], s44 offen offset:0 lds
    buffer_load_dwordx4 v15, s[8:11], s44 offen offset:1024 lds
    s_add_u32 m0, s41, 102400
    s_add_u32 s44, s88, 4096
    buffer_load_dwordx4 v14, s[8:11], s44 offen offset:0 lds
    buffer_load_dwordx4 v15, s[8:11], s44 offen offset:1024 lds
    s_add_u32 m0, s41, 106496
    s_add_u32 s44, s88, 0
    buffer_load_dwordx4 v14, s[8:11], s44 offen offset:0 lds
    buffer_load_dwordx4 v15, s[8:11], s44 offen offset:1024 lds
    s_add_u32 m0, s41, 110592
    s_add_u32 s44, s88, 198656
    buffer_load_dwordx4 v14, s[8:11], s44 offen offset:0 lds
    buffer_load_dwordx4 v15, s[8:11], s44 offen offset:1024 lds
    s_add_u32 m0, s41, 114688
    s_add_u32 s44, s88, 200704
    buffer_load_dwordx4 v14, s[8:11], s44 offen offset:0 lds
    buffer_load_dwordx4 v15, s[8:11], s44 offen offset:1024 lds
    s_add_u32 m0, s41, 118784
    s_add_u32 s44, s88, 196608
    buffer_load_dwordx4 v14, s[8:11], s44 offen offset:0 lds
    buffer_load_dwordx4 v15, s[8:11], s44 offen offset:1024 lds
    s_add_u32 m0, s41, 122880
    s_add_u32 s44, s89, 2048
    buffer_load_dwordx4 v14, s[8:11], s44 offen offset:0 lds
    buffer_load_dwordx4 v15, s[8:11], s44 offen offset:1024 lds
    s_add_u32 m0, s41, 126976
    s_add_u32 s44, s89, 4096
    buffer_load_dwordx4 v14, s[8:11], s44 offen offset:0 lds
    buffer_load_dwordx4 v15, s[8:11], s44 offen offset:1024 lds
s_n67:
    s_waitcnt lgkmcnt(0)
    s_barrier
    ds_write_b128 v9, v[192:195] offset:32768
    ds_write_b128 v9, v[196:199] offset:36864
    ds_write_b128 v9, v[200:203] offset:40960
    ds_write_b128 v9, v[204:207] offset:45056
    ds_write_b128 v9, v[208:211] offset:49152
    ds_write_b128 v9, v[212:215] offset:53248
    ds_write_b128 v9, v[216:219] offset:57344
    ds_write_b128 v9, v[220:223] offset:61440
    ds_write_b128 v10, v[224:227] offset:0
    ds_write_b128 v10, v[228:231] offset:4096
    ds_write_b128 v10, v[232:235] offset:8192
    ds_write_b128 v10, v[236:239] offset:12288
    ds_write_b128 v10, v[240:243] offset:16384
    ds_write_b128 v10, v[244:247] offset:20480
    ds_write_b128 v10, v[248:251] offset:24576
    ds_write_b128 v10, v[252:255] offset:28672
    s_cmp_eq_u32 s16, 4
    s_cbranch_scc1 h_layer
    s_cmp_eq_u32 s16, 7
    s_cbranch_scc1 z_layer
    s_branch l_layer
s_end:
    s_lshl_b32 s3, s2, 3
    s_add_u32 s3, s3, s16
    s_cmp_lg_u32 s3, 7
    s_cbranch_scc1 k_exit
    s_mov_b32 s8, s34
    s_mov_b32 s9, s35
    s_mov_b32 s10, 256
    s_mov_b32 s11, 0x00020000
    v_lshrrev_b32 v24, 2, v1
    v_mov_b32 v25, 0
    buffer_store_dword v25, v24, s[8:11], 0 offen sc1
    s_branch k_exit
s_slow:
    s_and_b32 s3, s16, 3
    s_lshl_b32 s44, s3, 11
    s_lshl_b32 s45, s52, 13
    s_add_u32 s44, s44, s45
    s_add_u32 s44, s44, 131072
    v_add_u32 v26, s44, v1
    ds_read_b128 v[48:51], v26 offset:0
    ds_read_b128 v[52:55], v26 offset:1024
    s_lshr_b32 s55, s21, 1
    s_lshl_b32 s55, s55, 23
    s_lshl_b32 s44, s18, 18
    s_add_u32 s55, s55, s44
    s_lshl_b32 s44, s52, 17
    s_add_u32 s55, s55, s44
    s_add_u32 s55, s55, 33554432
    s_waitcnt lgkmcnt(0)
    v_mov_b32 v26, 0xff800000
    s_mov_b32 s61, 0
s_slow1:
    s_add_u32 s44, s55, s61
    buffer_load_dwordx4 v[56:59], v1, s[4:7], s44 offen offset:0 sc1
    buffer_load_dwordx4 v[60:63], v1, s[4:7], s44 offen offset:1024 sc1
    s_waitcnt vmcnt(0)
    v_mfma_f32_32x32x16_bf16 v[72:87], v[56:59], v[48:51], 0
    v_mfma_f32_32x32x16_bf16 v[72:87], v[60:63], v[52:55], v[72:87]
    s_nop 11
    v_max3_f32 v26, v26, v72, v73
    v_max3_f32 v26, v26, v74, v75
    v_max3_f32 v26, v26, v76, v77
    v_max3_f32 v26, v26, v78, v79
    v_max3_f32 v26, v26, v80, v81
    v_max3_f32 v26, v26, v82, v83
    v_max3_f32 v26, v26, v84, v85
    v_max3_f32 v26, v26, v86, v87
    s_add_u32 s61, s61, 2048
    s_cmp_lt_u32 s61, 131072
    s_cbranch_scc1 s_slow1
    v_mov_b32 v27, v26
    s_nop 1
    v_permlane32_swap_b32 v26, v27
    v_max_f32 v26, v26, v27
    v_mov_b32 v32, 0
    v_mov_b32 v33, 0
    v_mov_b32 v34, 0
    v_mov_b32 v35, 0
    v_mov_b32 v36, 0
    v_mov_b32 v37, 0
    v_mov_b32 v38, 0
    v_mov_b32 v39, 0
    v_mov_b32 v40, 0
    v_mov_b32 v41, 0
    v_mov_b32 v42, 0
    v_mov_b32 v43, 0
    v_mov_b32 v44, 0
    v_mov_b32 v45, 0
    v_mov_b32 v46, 0
    v_mov_b32 v47, 0
    v_mov_b32 v28, 0
    v_mov_b32 v29, 0xdddddddd
    s_mov_b32 s3, 0xffff0000
    s_mov_b32 s61, 0
s_slow2:
    s_add_u32 s44, s55, s61
    buffer_load_dwordx4 v[56:59], v1, s[4:7], s44 offen offset:0 sc1
    buffer_load_dwordx4 v[60:63], v1, s[4:7], s44 offen offset:1024 sc1
    s_add_u32 s44, s44, 4194304
    buffer_load_dwordx4 v[64:67], v1, s[4:7], s44 offen offset:0 sc1
    buffer_load_dwordx4 v[68:71], v1, s[4:7], s44 offen offset:1024 sc1
    s_waitcnt vmcnt(0)
    v_mfma_f32_32x32x16_bf16 v[72:87], v[56:59], v[48:51], 0
    v_mfma_f32_32x32x16_bf16 v[72:87], v[60:63], v[52:55], v[72:87]
    s_nop 11
    v_sub_f32 v72, v72, v26
    v_sub_f32 v73, v73, v26
    v_sub_f32 v74, v74, v26
    v_sub_f32 v75, v75, v26
    v_sub_f32 v76, v76, v26
    v_sub_f32 v77, v77, v26
    v_sub_f32 v78, v78, v26
    v_sub_f32 v79, v79, v26
    v_sub_f32 v80, v80, v26
    v_sub_f32 v81, v81, v26
    v_sub_f32 v82, v82, v26
    v_sub_f32 v83, v83, v26
    v_sub_f32 v84, v84, v26
    v_sub_f32 v85, v85, v26
    v_sub_f32 v86, v86, v26
    v_sub_f32 v87, v87, v26
    v_exp_f32 v72, v72
    v_exp_f32 v73, v73
    v_exp_f32 v74, v74
    v_exp_f32 v75, v75
    v_exp_f32 v76, v76
    v_exp_f32 v77, v77
    v_exp_f32 v78, v78
    v_exp_f32 v79, v79
    v_exp_f32 v80, v80
    v_exp_f32 v81, v81
    v_exp_f32 v82, v82
    v_exp_f32 v83, v83
    v_exp_f32 v84, v84
    v_exp_f32 v85, v85
    v_exp_f32 v86, v86
    v_exp_f32 v87, v87
    v_and_b32 v72, s3, v72
    v_and_b32 v73, s3, v73
    v_and_b32 v74, s3, v74
    v_and_b32 v75, s3, v75
    v_and_b32 v76, s3, v76
    v_and_b32 v77, s3, v77
    v_and_b32 v78, s3, v78
    v_and_b32 v79, s3, v79
    v_and_b32 v80, s3, v80
    v_and_b32 v81, s3, v81
    v_and_b32 v82, s3, v82
    v_and_b32 v83, s3, v83
    v_and_b32 v84, s3, v84
    v_and_b32 v85, s3, v85
    v_and_b32 v86, s3, v86
    v_and_b32 v87, s3, v87
    v_add_f32 v28, v28, v72
    v_add_f32 v28, v28, v73
    v_add_f32 v28, v28, v74
    v_add_f32 v28, v28, v75
    v_add_f32 v28, v28, v76
    v_add_f32 v28, v28, v77
    v_add_f32 v28, v28, v78
    v_add_f32 v28, v28, v79
    v_add_f32 v28, v28, v80
    v_add_f32 v28, v28, v81
    v_add_f32 v28, v28, v82
    v_add_f32 v28, v28, v83
    v_add_f32 v28, v28, v84
    v_add_f32 v28, v28, v85
    v_add_f32 v28, v28, v86
    v_add_f32 v28, v28, v87
    v_smfmac_f32_32x32x32_bf16 v[32:47], v[64:67], v[72:79], v29
    v_smfmac_f32_32x32x32_bf16 v[32:47], v[68:71], v[80:87], v29
    s_add_u32 s61, s61, 2048
    s_cmp_lt_u32 s61, 131072
    s_cbranch_scc1 s_slow2
    v_mov_b32 v29, v28
    s_nop 1
    v_permlane32_swap_b32 v28, v29
    v_add_f32 v28, v28, v29
    v_rcp_f32 v28, v28
    s_nop 7
    s_branch s_fin
k_exit:
    s_endpgm
.if k_exit - interleave_layers__sliding_local_dilated__softmax_full_mha__prompt_kernel < 49152
.error "code prefetch reads past the end of the code"
.endif
.section .rodata,"a"
.p2align 6
.amdhsa_kernel interleave_layers__sliding_local_dilated__softmax_full_mha__prompt_kernel
  .amdhsa_next_free_vgpr 256
  .amdhsa_next_free_sgpr 102
  .amdhsa_accum_offset 256
  .amdhsa_group_segment_fixed_size 0
  .amdhsa_kernarg_size 72
  .amdhsa_user_sgpr_count 2
  .amdhsa_user_sgpr_kernarg_segment_ptr 1
  .amdhsa_system_sgpr_workgroup_id_x 1
.end_amdhsa_kernel
```

```asm
; @launch grid=(256,1,1) block=(512,1,1) lds=156736
.amdgcn_target "amdgcn-amd-amdhsa--gfx950"
.text
.globl interleave_layers__sliding_local_dilated__softmax_full_mha__prompt_kernel
.type interleave_layers__sliding_local_dilated__softmax_full_mha__prompt_kernel,@function
.p2align 8
interleave_layers__sliding_local_dilated__softmax_full_mha__prompt_kernel:
    s_cmp_ge_u32 s2, 256
    s_cbranch_scc1 k_exit
    s_load_dwordx2 s[36:37], s[0:1], 0
    s_load_dwordx4 s[24:27], s[0:1], 8
    s_load_dwordx8 s[28:35], s[0:1], 32
    s_load_dwordx2 s[44:45], s[0:1], 64
    v_lshrrev_b32 v2, 6, v0
    v_and_b32 v0, 63, v0
    v_readfirstlane_b32 s16, v2
    v_lshlrev_b32 v1, 4, v0
    s_mov_b32 s21, 0
    s_mov_b32 s40, 1
    s_and_b32 s3, s2, 1
    s_lshl_b32 s3, s3, 3
    s_bfe_u32 s17, s2, 0x30003
    s_add_u32 s17, s17, s3
    s_bfe_u32 s3, s2, 0x20001
    s_lshl_b32 s3, s3, 2
    s_lshr_b32 s18, s2, 6
    s_add_u32 s18, s18, s3
    s_and_b32 s3, s16, 3
    s_lshl_b32 s38, s17, 2
    s_add_u32 s38, s38, s3
    v_lshrrev_b32 v32, 3, v0
    v_and_b32 v33, 7, v0
    v_lshlrev_b32 v34, 11, v32
    v_lshl_add_u32 v34, v33, 4, v34
    s_lshl_b32 s46, s38, 16
    s_lshl_b32 s47, s18, 7
    s_add_u32 s46, s46, s47
    s_getpc_b64 s[76:77]
e_pc:
    s_sub_u32 s76, s76, e_pc - interleave_layers__sliding_local_dilated__softmax_full_mha__prompt_kernel
    s_subb_u32 s77, s77, 0
    s_and_b32 s3, s2, 0xf8
    s_add_u32 s3, s3, s16
    s_lshl_b32 s3, s3, 6
    s_add_u32 s78, s3, 49152
    s_min_u32 s78, s78, k_exit - interleave_layers__sliding_local_dilated__softmax_full_mha__prompt_kernel
    s_waitcnt lgkmcnt(0)
    s_mov_b32 s8, s36
    s_mov_b32 s9, s37
    s_mov_b32 s10, 4194304
    s_mov_b32 s11, 0x00020000
    s_cmp_gt_u32 s16, 3
    s_cbranch_scc1 e_side
    buffer_load_dwordx4 v[40:43], v34, s[8:11], s46 offen
    s_add_u32 s46, s46, 16384
    buffer_load_dwordx4 v[44:47], v34, s[8:11], s46 offen
    s_add_u32 s46, s46, 16384
    buffer_load_dwordx4 v[48:51], v34, s[8:11], s46 offen
    s_add_u32 s46, s46, 16384
    buffer_load_dwordx4 v[52:55], v34, s[8:11], s46 offen
e_side:
    s_load_dword s80, s[76:77], s3 offset:0
    s_load_dword s81, s[76:77], s3 offset:16384
    s_load_dword s82, s[76:77], s3 offset:32768
    s_load_dword s83, s[76:77], s78
    s_mov_b32 s4, s44
    s_mov_b32 s5, s45
    s_mov_b32 s6, 67108864
    s_mov_b32 s7, 0x00020000
    s_add_u32 s22, s44, 58720256
    s_addc_u32 s23, s45, 0
    s_load_dword s100, s[22:23], 217088
    s_cmp_gt_u32 s16, 3
    s_cbranch_scc1 s_start
    v_lshrrev_b32 v8, 4, v1
    s_lshl_b32 s44, s38, 16
    v_xor_b32 v88, v33, v32
    v_lshlrev_b32 v88, 4, v88
    v_lshl_add_u32 v88, v32, 11, v88
    v_xor_b32 v89, 16, v88
    v_add_u32 v89, 15360, v89
    v_add_u32 v90, 30720, v88
    v_add_u32 v91, 30720, v89
    s_mul_i32 s76, s16, 16384
    s_add_u32 s76, s76, 65536
    s_lshl_b32 s77, s38, 16
    s_mul_i32 s84, s18, 4096
    s_cmp_eq_u32 s18, 1
    s_cselect_b32 s85, 0, 4096
    s_cmp_eq_u32 s18, 2
    s_cselect_b32 s86, 0, 8192
    s_cmp_eq_u32 s18, 3
    s_cselect_b32 s87, 0, 12288
    s_cmp_eq_u32 s18, 4
    s_cselect_b32 s88, 0, 16384
    s_cmp_eq_u32 s18, 5
    s_cselect_b32 s89, 0, 20480
    s_cmp_eq_u32 s18, 6
    s_cselect_b32 s90, 0, 24576
    s_cmp_eq_u32 s18, 7
    s_cselect_b32 s91, 0, 28672
    s_cmp_eq_u32 s18, 8
    s_cselect_b32 s92, 0, 32768
    s_cmp_eq_u32 s18, 9
    s_cselect_b32 s93, 0, 36864
    s_cmp_eq_u32 s18, 10
    s_cselect_b32 s94, 0, 40960
    s_cmp_eq_u32 s18, 11
    s_cselect_b32 s95, 0, 45056
    s_cmp_eq_u32 s18, 12
    s_cselect_b32 s96, 0, 49152
    s_cmp_eq_u32 s18, 13
    s_cselect_b32 s97, 0, 53248
    s_cmp_eq_u32 s18, 14
    s_cselect_b32 s98, 0, 57344
    s_cmp_eq_u32 s18, 15
    s_cselect_b32 s99, 0, 61440
    v_lshrrev_b32 v12, 4, v1
    v_and_b32 v13, 15, v12
    v_bfe_u32 v14, v12, 4, 1
    v_lshrrev_b32 v12, 5, v12
    v_lshl_add_u32 v2, v14, 5, v13
    v_lshlrev_b32 v2, 4, v2
    v_lshl_add_u32 v2, v12, 10, v2
    v_lshrrev_b32 v15, 2, v13
    v_lshl_add_u32 v15, v14, 2, v15
    v_lshlrev_b32 v3, 7, v15
    v_lshl_add_u32 v3, v12, 11, v3
    v_and_b32 v15, 3, v13
    v_lshl_add_u32 v3, v15, 3, v3
    v_lshrrev_b32 v15, 3, v13
    v_lshl_add_u32 v15, v15, 1, v14
    v_lshl_add_u32 v3, v15, 5, v3
    v_xor_b32 v4, 32, v3
    v_xor_b32 v5, 64, v3
    v_xor_b32 v6, 96, v3
    s_lshl_b32 s45, s16, 12
    s_add_u32 s45, s45, 131072
    v_lshrrev_b32 v35, 1, v33
    v_lshlrev_b32 v35, 10, v35
    v_lshl_add_u32 v35, v32, 4, v35
    v_and_b32 v36, 1, v33
    v_lshl_add_u32 v35, v36, 3, v35
    v_add_u32 v35, s45, v35
    v_add_u32 v36, s45, v1
    v_mov_b32 v37, 0x3f803f80
    v_and_b32 v38, 3, v8
    v_lshl_add_u32 v39, v38, 3, v32
    v_lshlrev_b32 v39, 3, v39
    v_mov_b32 v56, 0
    v_mov_b32 v57, 0
    v_mov_b32 v58, 0
    v_mov_b32 v59, 0
    v_mov_b32 v60, 0
    v_mov_b32 v61, 0
    v_mov_b32 v62, 0
    v_mov_b32 v63, 0
    s_waitcnt vmcnt(3)
    ds_write_b64 v35, v[40:41] offset:0
    ds_write_b64 v35, v[42:43] offset:512
    s_waitcnt vmcnt(2)
    ds_write_b64 v35, v[44:45] offset:128
    ds_write_b64 v35, v[46:47] offset:640
    s_waitcnt vmcnt(1)
    ds_write_b64 v35, v[48:49] offset:256
    ds_write_b64 v35, v[50:51] offset:768
    s_waitcnt vmcnt(0)
    ds_write_b64 v35, v[52:53] offset:384
    ds_write_b64 v35, v[54:55] offset:896
    ds_read_b128 v[64:67], v36 offset:0
    ds_read_b128 v[68:71], v36 offset:1024
    ds_read_b128 v[72:75], v36 offset:2048
    ds_read_b128 v[76:79], v36 offset:3072
    s_lshl_b32 s45, s18, 12
    s_add_u32 s46, s44, s45
    s_waitcnt lgkmcnt(3)
    buffer_store_dwordx4 v[64:67], v1, s[4:7], s46 offen offset:0 sc1
    s_waitcnt lgkmcnt(2)
    buffer_store_dwordx4 v[68:71], v1, s[4:7], s46 offen offset:1024 sc1
    s_waitcnt lgkmcnt(1)
    buffer_store_dwordx4 v[72:75], v1, s[4:7], s46 offen offset:2048 sc1
    s_waitcnt lgkmcnt(0)
    buffer_store_dwordx4 v[76:79], v1, s[4:7], s46 offen offset:3072 sc1
    s_add_u32 m0, s76, 4096
    s_lshr_b32 s78, s85, 5
    s_add_u32 s78, s78, s77
    buffer_load_dwordx4 v88, s[8:11], s78 offen offset:0 lds
    buffer_load_dwordx4 v89, s[8:11], s78 offen offset:1024 lds
    buffer_load_dwordx4 v90, s[8:11], s78 offen offset:2048 lds
    buffer_load_dwordx4 v91, s[8:11], s78 offen offset:3072 lds
    s_add_u32 m0, s76, 8192
    s_lshr_b32 s78, s86, 5
    s_add_u32 s78, s78, s77
    buffer_load_dwordx4 v88, s[8:11], s78 offen offset:0 lds
    buffer_load_dwordx4 v89, s[8:11], s78 offen offset:1024 lds
    buffer_load_dwordx4 v90, s[8:11], s78 offen offset:2048 lds
    buffer_load_dwordx4 v91, s[8:11], s78 offen offset:3072 lds
    s_add_u32 m0, s76, 12288
    s_lshr_b32 s78, s87, 5
    s_add_u32 s78, s78, s77
    buffer_load_dwordx4 v88, s[8:11], s78 offen offset:0 lds
    buffer_load_dwordx4 v89, s[8:11], s78 offen offset:1024 lds
    buffer_load_dwordx4 v90, s[8:11], s78 offen offset:2048 lds
    buffer_load_dwordx4 v91, s[8:11], s78 offen offset:3072 lds
    s_barrier
    v_dot2_f32_bf16 v56, v40, v37, v56
    v_dot2_f32_bf16 v57, v40, v40, v57
    v_dot2_f32_bf16 v58, v44, v37, v58
    v_dot2_f32_bf16 v59, v44, v44, v59
    v_dot2_f32_bf16 v60, v48, v37, v60
    v_dot2_f32_bf16 v61, v48, v48, v61
    v_dot2_f32_bf16 v62, v52, v37, v62
    v_dot2_f32_bf16 v63, v52, v52, v63
    v_dot2_f32_bf16 v56, v41, v37, v56
    v_dot2_f32_bf16 v57, v41, v41, v57
    v_dot2_f32_bf16 v58, v45, v37, v58
    v_dot2_f32_bf16 v59, v45, v45, v59
    v_dot2_f32_bf16 v60, v49, v37, v60
    v_dot2_f32_bf16 v61, v49, v49, v61
    v_dot2_f32_bf16 v62, v53, v37, v62
    v_dot2_f32_bf16 v63, v53, v53, v63
    v_dot2_f32_bf16 v56, v42, v37, v56
    v_dot2_f32_bf16 v57, v42, v42, v57
    v_dot2_f32_bf16 v58, v46, v37, v58
    v_dot2_f32_bf16 v59, v46, v46, v59
    v_dot2_f32_bf16 v60, v50, v37, v60
    v_dot2_f32_bf16 v61, v50, v50, v61
    v_dot2_f32_bf16 v62, v54, v37, v62
    v_dot2_f32_bf16 v63, v54, v54, v63
    v_dot2_f32_bf16 v56, v43, v37, v56
    v_dot2_f32_bf16 v57, v43, v43, v57
    v_dot2_f32_bf16 v58, v47, v37, v58
    v_dot2_f32_bf16 v59, v47, v47, v59
    v_dot2_f32_bf16 v60, v51, v37, v60
    v_dot2_f32_bf16 v61, v51, v51, v61
    v_dot2_f32_bf16 v62, v55, v37, v62
    v_dot2_f32_bf16 v63, v55, v55, v63
    s_nop 2
    v_add_f32_dpp v56, v56, v56 quad_perm:[1,0,3,2] row_mask:0xf bank_mask:0xf
    v_add_f32_dpp v57, v57, v57 quad_perm:[1,0,3,2] row_mask:0xf bank_mask:0xf
    v_add_f32_dpp v58, v58, v58 quad_perm:[1,0,3,2] row_mask:0xf bank_mask:0xf
    v_add_f32_dpp v59, v59, v59 quad_perm:[1,0,3,2] row_mask:0xf bank_mask:0xf
    v_add_f32_dpp v60, v60, v60 quad_perm:[1,0,3,2] row_mask:0xf bank_mask:0xf
    v_add_f32_dpp v61, v61, v61 quad_perm:[1,0,3,2] row_mask:0xf bank_mask:0xf
    v_add_f32_dpp v62, v62, v62 quad_perm:[1,0,3,2] row_mask:0xf bank_mask:0xf
    v_add_f32_dpp v63, v63, v63 quad_perm:[1,0,3,2] row_mask:0xf bank_mask:0xf
    v_add_f32_dpp v56, v56, v56 quad_perm:[2,3,0,1] row_mask:0xf bank_mask:0xf
    v_add_f32_dpp v57, v57, v57 quad_perm:[2,3,0,1] row_mask:0xf bank_mask:0xf
    v_add_f32_dpp v58, v58, v58 quad_perm:[2,3,0,1] row_mask:0xf bank_mask:0xf
    v_add_f32_dpp v59, v59, v59 quad_perm:[2,3,0,1] row_mask:0xf bank_mask:0xf
    v_add_f32_dpp v60, v60, v60 quad_perm:[2,3,0,1] row_mask:0xf bank_mask:0xf
    v_add_f32_dpp v61, v61, v61 quad_perm:[2,3,0,1] row_mask:0xf bank_mask:0xf
    v_add_f32_dpp v62, v62, v62 quad_perm:[2,3,0,1] row_mask:0xf bank_mask:0xf
    v_add_f32_dpp v63, v63, v63 quad_perm:[2,3,0,1] row_mask:0xf bank_mask:0xf
    v_add_f32_dpp v56, v56, v56 row_half_mirror row_mask:0xf bank_mask:0xf
    v_add_f32_dpp v57, v57, v57 row_half_mirror row_mask:0xf bank_mask:0xf
    v_add_f32_dpp v58, v58, v58 row_half_mirror row_mask:0xf bank_mask:0xf
    v_add_f32_dpp v59, v59, v59 row_half_mirror row_mask:0xf bank_mask:0xf
    v_add_f32_dpp v60, v60, v60 row_half_mirror row_mask:0xf bank_mask:0xf
    v_add_f32_dpp v61, v61, v61 row_half_mirror row_mask:0xf bank_mask:0xf
    v_add_f32_dpp v62, v62, v62 row_half_mirror row_mask:0xf bank_mask:0xf
    v_add_f32_dpp v63, v63, v63 row_half_mirror row_mask:0xf bank_mask:0xf
    v_cmp_eq_u32 vcc, 1, v38
    s_nop 1
    v_cndmask_b32 v56, v56, v58, vcc
    v_cndmask_b32 v57, v57, v59, vcc
    v_cmp_eq_u32 vcc, 2, v38
    s_nop 1
    v_cndmask_b32 v56, v56, v60, vcc
    v_cndmask_b32 v57, v57, v61, vcc
    v_cmp_eq_u32 vcc, 3, v38
    s_nop 1
    v_cndmask_b32 v56, v56, v62, vcc
    v_cndmask_b32 v57, v57, v63, vcc
    s_lshl_b32 s44, s21, 18
    s_lshl_b32 s45, s38, 12
    s_add_u32 s44, s44, s45
    s_lshl_b32 s45, s18, 8
    s_add_u32 s44, s44, s45
    s_add_u32 s44, s44, 50331648
    buffer_store_dwordx2 v[56:57], v39, s[4:7], s44 offen sc1
    s_lshl_b32 s46, s21, 14
    s_lshl_b32 s67, s38, 7
    s_add_u32 s46, s46, s67
    s_add_u32 s46, s46, 4096
    s_add_u32 s47, s46, 8192
    s_lshl_b32 s48, s21, 22
    s_lshl_b32 s49, s38, 16
    s_add_u32 s41, s48, s49
    s_lshl_b32 s48, s21, 14
    s_lshl_b32 s67, s38, 7
    s_add_u32 s48, s48, s67
    s_add_u32 s48, s48, 4096
    v_lshrrev_b32 v16, 4, v1
    v_and_b32 v17, 15, v16
    v_lshrrev_b32 v16, 4, v16
    s_lshl_b32 s49, s16, 7
    s_add_u32 s50, s49, 151552
    s_and_b32 s49, s21, 1
    s_lshl_b32 s49, s49, 10
    s_add_u32 s49, s49, 151552
    v_lshlrev_b32 v11, 4, v16
    v_add_u32 v13, s50, v11
    v_add_u32 v11, s49, v11
    v_lshlrev_b32 v15, 2, v17
    v_add_u32 v9, s50, v15
    v_add_u32 v15, s49, v15
    s_lshr_b32 s49, s21, 1
    s_lshl_b32 s53, s49, 23
    s_lshl_b32 s50, s18, 18
    s_add_u32 s53, s53, s50
    s_add_u32 s53, s53, 33554432
    s_lshl_b32 s54, s38, 11
    s_add_u32 s52, s53, s54
    s_lshl_b32 s59, s49, 13
    s_lshl_b32 s67, s18, 9
    s_add_u32 s59, s59, s67
    s_lshl_b32 s67, s16, 7
    s_add_u32 s59, s59, s67
    s_add_u32 s59, s59, 69632
    s_lshl_b32 s61, s49, 15
    s_lshl_b32 s67, s17, 11
    s_add_u32 s61, s61, s67
    s_lshl_b32 s67, s18, 7
    s_add_u32 s61, s61, s67
    s_add_u32 s61, s61, 151552
    s_sub_u32 s60, s61, 151552
    s_lshl_b32 s60, s60, 5
    s_add_u32 s60, s60, 54525952
    s_lshl_b32 s62, s16, 12
    s_add_u32 s62, s62, 131072
    v_bfe_u32 v80, v8, 3, 1
    v_and_b32 v81, 7, v8
    v_lshrrev_b32 v82, 5, v8
    v_lshlrev_b32 v82, 1, v82
    v_xor_b32 v82, v82, v81
    v_xor_b32 v82, v82, v80
    v_lshlrev_b32 v82, 4, v82
    v_lshl_add_u32 v82, v81, 7, v82
    v_lshl_add_u32 v82, v80, 10, v82
    v_bfe_u32 v80, v8, 4, 1
    v_lshl_add_u32 v82, v80, 3, v82
    v_add_u32 v84, s76, v82
    v_xor_b32 v85, 16, v84
    v_xor_b32 v86, 64, v84
    v_xor_b32 v87, 80, v84
    v_add_u32 v80, s62, v2
    ds_read_b128 v[160:163], v80 offset:0
    ds_read_b128 v[164:167], v80 offset:256
    ds_read_b128 v[168:171], v80 offset:2048
    ds_read_b128 v[172:175], v80 offset:2304
    s_waitcnt vmcnt(1)
    ds_read_b64 v[176:177], v84 offset:4096
    ds_read_b64 v[178:179], v85 offset:4096
    ds_read_b64 v[180:181], v84 offset:6144
    ds_read_b64 v[182:183], v85 offset:6144
    ds_read_b64 v[184:185], v86 offset:4096
    ds_read_b64 v[186:187], v87 offset:4096
    ds_read_b64 v[188:189], v86 offset:6144
    ds_read_b64 v[190:191], v87 offset:6144
    ds_read_b64 v[192:193], v84 offset:8192
    ds_read_b64 v[194:195], v85 offset:8192
    ds_read_b64 v[196:197], v84 offset:10240
    ds_read_b64 v[198:199], v85 offset:10240
    ds_read_b64 v[200:201], v86 offset:8192
    ds_read_b64 v[202:203], v87 offset:8192
    ds_read_b64 v[204:205], v86 offset:10240
    ds_read_b64 v[206:207], v87 offset:10240
    ds_read_b64 v[208:209], v84 offset:12288
    ds_read_b64 v[210:211], v85 offset:12288
    ds_read_b64 v[212:213], v84 offset:14336
    ds_read_b64 v[214:215], v85 offset:14336
    ds_read_b64 v[216:217], v86 offset:12288
    ds_read_b64 v[218:219], v87 offset:12288
    ds_read_b64 v[220:221], v86 offset:14336
    ds_read_b64 v[222:223], v87 offset:14336
    s_load_dword s68, s[34:35], 0
    s_mov_b32 s8, s34
    s_mov_b32 s9, s35
    s_mov_b32 s10, 256
    s_mov_b32 s11, 0x00020000
    s_mov_b32 s66, 0x10000
    v_mov_b32 v16, 0
    s_waitcnt lgkmcnt(0)
c_f0:
    s_cmp_eq_u32 s68, 10
    s_cbranch_scc1 c_f0_ok
    buffer_load_dword v17, v16, s[8:11], 0 offen offset:0 sc1
    s_waitcnt vmcnt(0)
    v_readfirstlane_b32 s68, v17
    s_sub_u32 s66, s66, 1
    s_cmp_lg_u32 s66, 0
    s_cbranch_scc1 c_f0
c_f0_ok:
    s_atomic_add s40, s[22:23], s46
    s_mov_b64 vcc, -1
    s_barrier
    ds_read_b64_tr_b16 v[32:33], v3 offset:0
    ds_read_b64_tr_b16 v[34:35], v3 offset:1024
    ds_read_b64_tr_b16 v[36:37], v4 offset:0
    ds_read_b64_tr_b16 v[38:39], v4 offset:1024
    ds_read_b64_tr_b16 v[40:41], v5 offset:0
    ds_read_b64_tr_b16 v[42:43], v5 offset:1024
    ds_read_b64_tr_b16 v[44:45], v6 offset:0
    ds_read_b64_tr_b16 v[46:47], v6 offset:1024
    ds_read_b64_tr_b16 v[48:49], v3 offset:4096
    ds_read_b64_tr_b16 v[50:51], v3 offset:5120
    ds_read_b64_tr_b16 v[52:53], v4 offset:4096
    ds_read_b64_tr_b16 v[54:55], v4 offset:5120
    ds_read_b64_tr_b16 v[56:57], v5 offset:4096
    ds_read_b64_tr_b16 v[58:59], v5 offset:5120
    s_branch c_g0
c_cs1:
    s_waitcnt vmcnt(0)
    s_atomic_add s40, s[22:23], s47
    s_branch c_cs2
c_layer:
    s_lshl_b32 s48, s21, 22
    s_lshl_b32 s49, s38, 16
    s_add_u32 s41, s48, s49
    s_lshl_b32 s48, s21, 14
    s_lshl_b32 s67, s38, 7
    s_add_u32 s48, s48, s67
    s_add_u32 s48, s48, 4096
    v_lshrrev_b32 v16, 4, v1
    v_and_b32 v17, 15, v16
    v_lshrrev_b32 v16, 4, v16
    s_lshl_b32 s49, s16, 7
    s_add_u32 s50, s49, 151552
    s_and_b32 s49, s21, 1
    s_lshl_b32 s49, s49, 10
    s_add_u32 s49, s49, 151552
    v_lshlrev_b32 v11, 4, v16
    v_add_u32 v13, s50, v11
    v_add_u32 v11, s49, v11
    v_lshlrev_b32 v15, 2, v17
    v_add_u32 v9, s50, v15
    v_add_u32 v15, s49, v15
    s_lshr_b32 s49, s21, 1
    s_lshl_b32 s53, s49, 23
    s_lshl_b32 s50, s18, 18
    s_add_u32 s53, s53, s50
    s_add_u32 s53, s53, 33554432
    s_lshl_b32 s54, s38, 11
    s_add_u32 s52, s53, s54
    s_lshl_b32 s59, s49, 13
    s_lshl_b32 s67, s18, 9
    s_add_u32 s59, s59, s67
    s_lshl_b32 s67, s16, 7
    s_add_u32 s59, s59, s67
    s_add_u32 s59, s59, 69632
    s_lshl_b32 s61, s49, 15
    s_lshl_b32 s67, s17, 11
    s_add_u32 s61, s61, s67
    s_lshl_b32 s67, s18, 7
    s_add_u32 s61, s61, s67
    s_add_u32 s61, s61, 151552
    s_sub_u32 s60, s61, 151552
    s_lshl_b32 s60, s60, 5
    s_add_u32 s60, s60, 54525952
    s_lshl_b32 s62, s16, 12
    s_add_u32 s62, s62, 131072
    s_mov_b32 s68, 0
    s_atomic_add s68, s[22:23], s48 glc
    s_mov_b64 vcc, 0
    s_barrier
    ds_read_b64_tr_b16 v[32:33], v3 offset:0
    ds_read_b64_tr_b16 v[34:35], v3 offset:1024
    ds_read_b64_tr_b16 v[36:37], v4 offset:0
    ds_read_b64_tr_b16 v[38:39], v4 offset:1024
    ds_read_b64_tr_b16 v[40:41], v5 offset:0
    ds_read_b64_tr_b16 v[42:43], v5 offset:1024
    ds_read_b64_tr_b16 v[44:45], v6 offset:0
    ds_read_b64_tr_b16 v[46:47], v6 offset:1024
    ds_read_b64_tr_b16 v[48:49], v3 offset:4096
    ds_read_b64_tr_b16 v[50:51], v3 offset:5120
    ds_read_b64_tr_b16 v[52:53], v4 offset:4096
    ds_read_b64_tr_b16 v[54:55], v4 offset:5120
    ds_read_b64_tr_b16 v[56:57], v5 offset:4096
    ds_read_b64_tr_b16 v[58:59], v5 offset:5120
c_g0:
    s_waitcnt lgkmcnt(10)
    v_mfma_f32_16x16x32_bf16 v[64:67], v[32:35], v[160:163], 0
    ds_read_b64_tr_b16 v[60:61], v6 offset:4096
    v_mfma_f32_16x16x32_bf16 v[68:71], v[32:35], v[164:167], 0
    ds_read_b64_tr_b16 v[62:63], v6 offset:5120
    v_mfma_f32_16x16x32_bf16 v[72:75], v[36:39], v[160:163], 0
    ds_read_b64_tr_b16 v[32:33], v3 offset:8192
    v_mfma_f32_16x16x32_bf16 v[76:79], v[36:39], v[164:167], 0
    ds_read_b64_tr_b16 v[34:35], v3 offset:9216
    s_waitcnt lgkmcnt(10)
    v_mfma_f32_16x16x32_bf16 v[80:83], v[40:43], v[160:163], 0
    ds_read_b64_tr_b16 v[36:37], v4 offset:8192
    v_mfma_f32_16x16x32_bf16 v[84:87], v[40:43], v[164:167], 0
    ds_read_b64_tr_b16 v[38:39], v4 offset:9216
    v_mfma_f32_16x16x32_bf16 v[88:91], v[44:47], v[160:163], 0
    ds_read_b64_tr_b16 v[40:41], v5 offset:8192
    v_mfma_f32_16x16x32_bf16 v[92:95], v[44:47], v[164:167], 0
    ds_read_b64_tr_b16 v[42:43], v5 offset:9216
    s_waitcnt lgkmcnt(10)
    v_mfma_f32_16x16x32_bf16 v[96:99], v[160:163], v[48:51], 0
    ds_read_b64_tr_b16 v[44:45], v6 offset:8192
    v_mfma_f32_16x16x32_bf16 v[100:103], v[164:167], v[48:51], 0
    ds_read_b64_tr_b16 v[46:47], v6 offset:9216
    v_mfma_f32_16x16x32_bf16 v[104:107], v[160:163], v[52:55], 0
    ds_read_b64_tr_b16 v[48:49], v3 offset:12288
    v_mfma_f32_16x16x32_bf16 v[108:111], v[164:167], v[52:55], 0
    ds_read_b64_tr_b16 v[50:51], v3 offset:13312
    s_waitcnt lgkmcnt(10)
    v_mfma_f32_16x16x32_bf16 v[112:115], v[160:163], v[56:59], 0
    ds_read_b64_tr_b16 v[52:53], v4 offset:12288
    v_mfma_f32_16x16x32_bf16 v[116:119], v[164:167], v[56:59], 0
    ds_read_b64_tr_b16 v[54:55], v4 offset:13312
    v_mfma_f32_16x16x32_bf16 v[120:123], v[160:163], v[60:63], 0
    ds_read_b64_tr_b16 v[56:57], v5 offset:12288
    v_mfma_f32_16x16x32_bf16 v[124:127], v[164:167], v[60:63], 0
    ds_read_b64_tr_b16 v[58:59], v5 offset:13312
    s_cbranch_vccnz c_gate
    s_mov_b32 s66, 0x10000
    s_waitcnt lgkmcnt(0)
    s_cmp_eq_u32 s68, 16
    s_cbranch_scc1 c_x_ok
c_x_poll:
    s_mov_b32 s68, 0
    s_atomic_add s68, s[22:23], s48 offset:0 glc
    s_sub_u32 s66, s66, 1
    s_cselect_b32 s67, 16, 0
    s_waitcnt lgkmcnt(0)
    s_max_u32 s68, s68, s67
    s_cmp_lt_u32 s68, 16
    s_cbranch_scc1 c_x_poll
c_x_ok:
    s_add_u32 s42, s41, s85
    buffer_load_dwordx4 v[176:179], v2, s[4:7], s42 offen offset:0 sc1
    buffer_load_dwordx4 v[180:183], v2, s[4:7], s42 offen offset:256 sc1
    buffer_load_dwordx4 v[184:187], v2, s[4:7], s42 offen offset:2048 sc1
    buffer_load_dwordx4 v[188:191], v2, s[4:7], s42 offen offset:2304 sc1
    s_add_u32 s42, s41, s86
    buffer_load_dwordx4 v[192:195], v2, s[4:7], s42 offen offset:0 sc1
    buffer_load_dwordx4 v[196:199], v2, s[4:7], s42 offen offset:256 sc1
    buffer_load_dwordx4 v[200:203], v2, s[4:7], s42 offen offset:2048 sc1
    buffer_load_dwordx4 v[204:207], v2, s[4:7], s42 offen offset:2304 sc1
    s_add_u32 s42, s41, s87
    buffer_load_dwordx4 v[208:211], v2, s[4:7], s42 offen offset:0 sc1
    buffer_load_dwordx4 v[212:215], v2, s[4:7], s42 offen offset:256 sc1
    s_waitcnt vmcnt(10)
    s_atomic_add s40, s[22:23], s47
c_gate:
    s_waitcnt lgkmcnt(10)
    v_mfma_f32_16x16x32_bf16 v[128:131], v[32:35], v[160:163], 0
    ds_read_b64_tr_b16 v[60:61], v6 offset:12288
    v_mfma_f32_16x16x32_bf16 v[132:135], v[32:35], v[164:167], 0
    ds_read_b64_tr_b16 v[62:63], v6 offset:13312
    v_mfma_f32_16x16x32_bf16 v[136:139], v[36:39], v[160:163], 0
    ds_read_b64_tr_b16 v[32:33], v3 offset:16384
    v_mfma_f32_16x16x32_bf16 v[140:143], v[36:39], v[164:167], 0
    ds_read_b64_tr_b16 v[34:35], v3 offset:17408
    s_waitcnt lgkmcnt(10)
    v_mfma_f32_16x16x32_bf16 v[144:147], v[40:43], v[160:163], 0
    ds_read_b64_tr_b16 v[36:37], v4 offset:16384
    v_mfma_f32_16x16x32_bf16 v[148:151], v[40:43], v[164:167], 0
    ds_read_b64_tr_b16 v[38:39], v4 offset:17408
    v_mfma_f32_16x16x32_bf16 v[152:155], v[44:47], v[160:163], 0
    ds_read_b64_tr_b16 v[40:41], v5 offset:16384
    v_mfma_f32_16x16x32_bf16 v[156:159], v[44:47], v[164:167], 0
    ds_read_b64_tr_b16 v[42:43], v5 offset:17408
    s_waitcnt lgkmcnt(10)
    v_mfma_f32_16x16x32_bf16 v[64:67], v[48:51], v[168:171], v[64:67]
    ds_read_b64_tr_b16 v[44:45], v6 offset:16384
    v_mfma_f32_16x16x32_bf16 v[68:71], v[48:51], v[172:175], v[68:71]
    ds_read_b64_tr_b16 v[46:47], v6 offset:17408
    v_mfma_f32_16x16x32_bf16 v[72:75], v[52:55], v[168:171], v[72:75]
    ds_read_b64_tr_b16 v[48:49], v3 offset:20480
    v_mfma_f32_16x16x32_bf16 v[76:79], v[52:55], v[172:175], v[76:79]
    ds_read_b64_tr_b16 v[50:51], v3 offset:21504
    s_waitcnt lgkmcnt(10)
    v_mfma_f32_16x16x32_bf16 v[80:83], v[56:59], v[168:171], v[80:83]
    ds_read_b64_tr_b16 v[52:53], v4 offset:20480
    v_mfma_f32_16x16x32_bf16 v[84:87], v[56:59], v[172:175], v[84:87]
    ds_read_b64_tr_b16 v[54:55], v4 offset:21504
    v_mfma_f32_16x16x32_bf16 v[88:91], v[60:63], v[168:171], v[88:91]
    ds_read_b64_tr_b16 v[56:57], v5 offset:20480
    v_mfma_f32_16x16x32_bf16 v[92:95], v[60:63], v[172:175], v[92:95]
    ds_read_b64_tr_b16 v[58:59], v5 offset:21504
    s_waitcnt lgkmcnt(10)
    v_mfma_f32_16x16x32_bf16 v[96:99], v[168:171], v[32:35], v[96:99]
    ds_read_b64_tr_b16 v[60:61], v6 offset:20480
    v_mfma_f32_16x16x32_bf16 v[100:103], v[172:175], v[32:35], v[100:103]
    ds_read_b64_tr_b16 v[62:63], v6 offset:21504
    v_mfma_f32_16x16x32_bf16 v[104:107], v[168:171], v[36:39], v[104:107]
    ds_read_b64_tr_b16 v[32:33], v3 offset:24576
    v_mfma_f32_16x16x32_bf16 v[108:111], v[172:175], v[36:39], v[108:111]
    ds_read_b64_tr_b16 v[34:35], v3 offset:25600
    s_waitcnt lgkmcnt(10)
    v_mfma_f32_16x16x32_bf16 v[112:115], v[168:171], v[40:43], v[112:115]
    ds_read_b64_tr_b16 v[36:37], v4 offset:24576
    v_mfma_f32_16x16x32_bf16 v[116:119], v[172:175], v[40:43], v[116:119]
    ds_read_b64_tr_b16 v[38:39], v4 offset:25600
    v_mfma_f32_16x16x32_bf16 v[120:123], v[168:171], v[44:47], v[120:123]
    ds_read_b64_tr_b16 v[40:41], v5 offset:24576
    v_mfma_f32_16x16x32_bf16 v[124:127], v[172:175], v[44:47], v[124:127]
    ds_read_b64_tr_b16 v[42:43], v5 offset:25600
    s_waitcnt lgkmcnt(10)
    v_mfma_f32_16x16x32_bf16 v[128:131], v[48:51], v[168:171], v[128:131]
    ds_read_b64_tr_b16 v[44:45], v6 offset:24576
    v_mfma_f32_16x16x32_bf16 v[132:135], v[48:51], v[172:175], v[132:135]
    ds_read_b64_tr_b16 v[46:47], v6 offset:25600
    v_mfma_f32_16x16x32_bf16 v[136:139], v[52:55], v[168:171], v[136:139]
    ds_read_b64_tr_b16 v[48:49], v3 offset:28672
    v_mfma_f32_16x16x32_bf16 v[140:143], v[52:55], v[172:175], v[140:143]
    ds_read_b64_tr_b16 v[50:51], v3 offset:29696
    s_waitcnt lgkmcnt(10)
    v_mfma_f32_16x16x32_bf16 v[144:147], v[56:59], v[168:171], v[144:147]
    ds_read_b64_tr_b16 v[52:53], v4 offset:28672
    v_mfma_f32_16x16x32_bf16 v[148:151], v[56:59], v[172:175], v[148:151]
    ds_read_b64_tr_b16 v[54:55], v4 offset:29696
    v_mfma_f32_16x16x32_bf16 v[152:155], v[60:63], v[168:171], v[152:155]
    ds_read_b64_tr_b16 v[56:57], v5 offset:28672
    v_mfma_f32_16x16x32_bf16 v[156:159], v[60:63], v[172:175], v[156:159]
    ds_read_b64_tr_b16 v[58:59], v5 offset:29696
    s_waitcnt vmcnt(8) lgkmcnt(10)
    v_mfma_f32_16x16x32_bf16 v[64:67], v[32:35], v[176:179], v[64:67]
    ds_read_b64_tr_b16 v[60:61], v6 offset:28672
    v_mfma_f32_16x16x32_bf16 v[68:71], v[32:35], v[180:183], v[68:71]
    ds_read_b64_tr_b16 v[62:63], v6 offset:29696
    s_barrier
    v_mfma_f32_16x16x32_bf16 v[72:75], v[36:39], v[176:179], v[72:75]
    ds_read_b64_tr_b16 v[32:33], v3 offset:32768
    v_mfma_f32_16x16x32_bf16 v[76:79], v[36:39], v[180:183], v[76:79]
    ds_read_b64_tr_b16 v[34:35], v3 offset:33792
    s_waitcnt lgkmcnt(10)
    v_mfma_f32_16x16x32_bf16 v[80:83], v[40:43], v[176:179], v[80:83]
    ds_read_b64_tr_b16 v[36:37], v4 offset:32768
    s_cbranch_vccnz c_cs1
c_cs2:
    v_mfma_f32_16x16x32_bf16 v[84:87], v[40:43], v[180:183], v[84:87]
    ds_read_b64_tr_b16 v[38:39], v4 offset:33792
    v_mfma_f32_16x16x32_bf16 v[88:91], v[44:47], v[176:179], v[88:91]
    ds_read_b64_tr_b16 v[40:41], v5 offset:32768
    v_mfma_f32_16x16x32_bf16 v[92:95], v[44:47], v[180:183], v[92:95]
    ds_read_b64_tr_b16 v[42:43], v5 offset:33792
    s_waitcnt lgkmcnt(10)
    v_mfma_f32_16x16x32_bf16 v[96:99], v[176:179], v[48:51], v[96:99]
    ds_read_b64_tr_b16 v[44:45], v6 offset:32768
    v_mfma_f32_16x16x32_bf16 v[100:103], v[180:183], v[48:51], v[100:103]
    ds_read_b64_tr_b16 v[46:47], v6 offset:33792
    v_mfma_f32_16x16x32_bf16 v[104:107], v[176:179], v[52:55], v[104:107]
    ds_read_b64_tr_b16 v[48:49], v3 offset:36864
    v_mfma_f32_16x16x32_bf16 v[108:111], v[180:183], v[52:55], v[108:111]
    ds_read_b64_tr_b16 v[50:51], v3 offset:37888
    s_waitcnt lgkmcnt(10)
    v_mfma_f32_16x16x32_bf16 v[112:115], v[176:179], v[56:59], v[112:115]
    ds_read_b64_tr_b16 v[52:53], v4 offset:36864
    v_mfma_f32_16x16x32_bf16 v[116:119], v[180:183], v[56:59], v[116:119]
    ds_read_b64_tr_b16 v[54:55], v4 offset:37888
    v_mfma_f32_16x16x32_bf16 v[120:123], v[176:179], v[60:63], v[120:123]
    ds_read_b64_tr_b16 v[56:57], v5 offset:36864
    v_mfma_f32_16x16x32_bf16 v[124:127], v[180:183], v[60:63], v[124:127]
    ds_read_b64_tr_b16 v[58:59], v5 offset:37888
    s_waitcnt lgkmcnt(10)
    v_mfma_f32_16x16x32_bf16 v[128:131], v[32:35], v[176:179], v[128:131]
    ds_read_b64_tr_b16 v[60:61], v6 offset:36864
    v_mfma_f32_16x16x32_bf16 v[132:135], v[32:35], v[180:183], v[132:135]
    ds_read_b64_tr_b16 v[62:63], v6 offset:37888
    v_mfma_f32_16x16x32_bf16 v[136:139], v[36:39], v[176:179], v[136:139]
    ds_read_b64_tr_b16 v[32:33], v3 offset:40960
    v_mfma_f32_16x16x32_bf16 v[140:143], v[36:39], v[180:183], v[140:143]
    ds_read_b64_tr_b16 v[34:35], v3 offset:41984
    s_waitcnt lgkmcnt(10)
    v_mfma_f32_16x16x32_bf16 v[144:147], v[40:43], v[176:179], v[144:147]
    ds_read_b64_tr_b16 v[36:37], v4 offset:40960
    v_mfma_f32_16x16x32_bf16 v[148:151], v[40:43], v[180:183], v[148:151]
    ds_read_b64_tr_b16 v[38:39], v4 offset:41984
    v_mfma_f32_16x16x32_bf16 v[152:155], v[44:47], v[176:179], v[152:155]
    ds_read_b64_tr_b16 v[40:41], v5 offset:40960
    v_mfma_f32_16x16x32_bf16 v[156:159], v[44:47], v[180:183], v[156:159]
    ds_read_b64_tr_b16 v[42:43], v5 offset:41984
    s_waitcnt vmcnt(6) lgkmcnt(10)
    v_mfma_f32_16x16x32_bf16 v[64:67], v[48:51], v[184:187], v[64:67]
    s_add_u32 s42, s41, s87
    s_cbranch_vccnz xs1
    buffer_load_dwordx4 v[216:219], v2, s[4:7], s42 offen offset:2048 sc1
xs1:
    ds_read_b64_tr_b16 v[44:45], v6 offset:40960
    v_mfma_f32_16x16x32_bf16 v[68:71], v[48:51], v[188:191], v[68:71]
    ds_read_b64_tr_b16 v[46:47], v6 offset:41984
    v_mfma_f32_16x16x32_bf16 v[72:75], v[52:55], v[184:187], v[72:75]
    s_cbranch_vccnz xs2
    buffer_load_dwordx4 v[220:223], v2, s[4:7], s42 offen offset:2304 sc1
xs2:
    ds_read_b64_tr_b16 v[48:49], v3 offset:45056
    s_add_u32 s42, s41, s88
    v_mfma_f32_16x16x32_bf16 v[76:79], v[52:55], v[188:191], v[76:79]
    ds_read_b64_tr_b16 v[50:51], v3 offset:46080
    s_waitcnt lgkmcnt(10)
    v_mfma_f32_16x16x32_bf16 v[80:83], v[56:59], v[184:187], v[80:83]
    buffer_load_dwordx4 v[224:227], v2, s[4:7], s42 offen offset:0 sc1
    ds_read_b64_tr_b16 v[52:53], v4 offset:45056
    v_mfma_f32_16x16x32_bf16 v[84:87], v[56:59], v[188:191], v[84:87]
    ds_read_b64_tr_b16 v[54:55], v4 offset:46080
    v_mfma_f32_16x16x32_bf16 v[88:91], v[60:63], v[184:187], v[88:91]
    buffer_load_dwordx4 v[228:231], v2, s[4:7], s42 offen offset:256 sc1
    ds_read_b64_tr_b16 v[56:57], v5 offset:45056
    v_mfma_f32_16x16x32_bf16 v[92:95], v[60:63], v[188:191], v[92:95]
    ds_read_b64_tr_b16 v[58:59], v5 offset:46080
    s_waitcnt lgkmcnt(10)
    v_mfma_f32_16x16x32_bf16 v[96:99], v[184:187], v[32:35], v[96:99]
    ds_read_b64_tr_b16 v[60:61], v6 offset:45056
    buffer_load_dwordx4 v[232:235], v2, s[4:7], s42 offen offset:2048 sc1
    v_mfma_f32_16x16x32_bf16 v[100:103], v[188:191], v[32:35], v[100:103]
    ds_read_b64_tr_b16 v[62:63], v6 offset:46080
    v_mfma_f32_16x16x32_bf16 v[104:107], v[184:187], v[36:39], v[104:107]
    buffer_load_dwordx4 v[236:239], v2, s[4:7], s42 offen offset:2304 sc1
    ds_read_b64_tr_b16 v[32:33], v3 offset:49152
    s_add_u32 s42, s41, s89
    v_mfma_f32_16x16x32_bf16 v[108:111], v[188:191], v[36:39], v[108:111]
    ds_read_b64_tr_b16 v[34:35], v3 offset:50176
    s_waitcnt lgkmcnt(10)
    v_mfma_f32_16x16x32_bf16 v[112:115], v[184:187], v[40:43], v[112:115]
    buffer_load_dwordx4 v[240:243], v2, s[4:7], s42 offen offset:0 sc1
    ds_read_b64_tr_b16 v[36:37], v4 offset:49152
    v_mfma_f32_16x16x32_bf16 v[116:119], v[188:191], v[40:43], v[116:119]
    ds_read_b64_tr_b16 v[38:39], v4 offset:50176
    v_mfma_f32_16x16x32_bf16 v[120:123], v[184:187], v[44:47], v[120:123]
    buffer_load_dwordx4 v[244:247], v2, s[4:7], s42 offen offset:256 sc1
    ds_read_b64_tr_b16 v[40:41], v5 offset:49152
    v_mfma_f32_16x16x32_bf16 v[124:127], v[188:191], v[44:47], v[124:127]
    ds_read_b64_tr_b16 v[42:43], v5 offset:50176
    s_waitcnt lgkmcnt(10)
    v_mfma_f32_16x16x32_bf16 v[128:131], v[48:51], v[184:187], v[128:131]
    buffer_load_dwordx4 v[248:251], v2, s[4:7], s42 offen offset:2048 sc1
    ds_read_b64_tr_b16 v[44:45], v6 offset:49152
    v_mfma_f32_16x16x32_bf16 v[132:135], v[48:51], v[188:191], v[132:135]
    ds_read_b64_tr_b16 v[46:47], v6 offset:50176
    v_mfma_f32_16x16x32_bf16 v[136:139], v[52:55], v[184:187], v[136:139]
    ds_read_b64_tr_b16 v[48:49], v3 offset:53248
    v_mfma_f32_16x16x32_bf16 v[140:143], v[52:55], v[188:191], v[140:143]
    ds_read_b64_tr_b16 v[50:51], v3 offset:54272
    s_waitcnt lgkmcnt(10)
    v_mfma_f32_16x16x32_bf16 v[144:147], v[56:59], v[184:187], v[144:147]
    ds_read_b64_tr_b16 v[52:53], v4 offset:53248
    v_mfma_f32_16x16x32_bf16 v[148:151], v[56:59], v[188:191], v[148:151]
    ds_read_b64_tr_b16 v[54:55], v4 offset:54272
    v_mfma_f32_16x16x32_bf16 v[152:155], v[60:63], v[184:187], v[152:155]
    ds_read_b64_tr_b16 v[56:57], v5 offset:53248
    v_mfma_f32_16x16x32_bf16 v[156:159], v[60:63], v[188:191], v[156:159]
    ds_read_b64_tr_b16 v[58:59], v5 offset:54272
    s_waitcnt vmcnt(13) lgkmcnt(10)
    v_mfma_f32_16x16x32_bf16 v[64:67], v[32:35], v[192:195], v[64:67]
    ds_read_b64_tr_b16 v[60:61], v6 offset:53248
    buffer_load_dwordx4 v[252:255], v2, s[4:7], s42 offen offset:2304 sc1
    s_add_u32 s42, s41, s90
    v_mfma_f32_16x16x32_bf16 v[68:71], v[32:35], v[196:199], v[68:71]
    ds_read_b64_tr_b16 v[62:63], v6 offset:54272
    v_mfma_f32_16x16x32_bf16 v[72:75], v[36:39], v[192:195], v[72:75]
    ds_read_b64_tr_b16 v[32:33], v3 offset:57344
    v_mfma_f32_16x16x32_bf16 v[76:79], v[36:39], v[196:199], v[76:79]
    ds_read_b64_tr_b16 v[34:35], v3 offset:58368
    s_waitcnt lgkmcnt(10)
    v_mfma_f32_16x16x32_bf16 v[80:83], v[40:43], v[192:195], v[80:83]
    ds_read_b64_tr_b16 v[36:37], v4 offset:57344
    v_mfma_f32_16x16x32_bf16 v[84:87], v[40:43], v[196:199], v[84:87]
    ds_read_b64_tr_b16 v[38:39], v4 offset:58368
    v_mfma_f32_16x16x32_bf16 v[88:91], v[44:47], v[192:195], v[88:91]
    ds_read_b64_tr_b16 v[40:41], v5 offset:57344
    v_mfma_f32_16x16x32_bf16 v[92:95], v[44:47], v[196:199], v[92:95]
    ds_read_b64_tr_b16 v[42:43], v5 offset:58368
    s_waitcnt lgkmcnt(10)
    v_mfma_f32_16x16x32_bf16 v[96:99], v[192:195], v[48:51], v[96:99]
    buffer_load_dwordx4 v[160:163], v2, s[4:7], s42 offen offset:0 sc1
    ds_read_b64_tr_b16 v[44:45], v6 offset:57344
    v_mfma_f32_16x16x32_bf16 v[100:103], v[196:199], v[48:51], v[100:103]
    ds_read_b64_tr_b16 v[46:47], v6 offset:58368
    v_mfma_f32_16x16x32_bf16 v[104:107], v[192:195], v[52:55], v[104:107]
    ds_read_b64_tr_b16 v[48:49], v3 offset:61440
    v_mfma_f32_16x16x32_bf16 v[108:111], v[196:199], v[52:55], v[108:111]
    ds_read_b64_tr_b16 v[50:51], v3 offset:62464
    s_waitcnt lgkmcnt(10)
    v_mfma_f32_16x16x32_bf16 v[112:115], v[192:195], v[56:59], v[112:115]
    ds_read_b64_tr_b16 v[52:53], v4 offset:61440
    v_mfma_f32_16x16x32_bf16 v[116:119], v[196:199], v[56:59], v[116:119]
    ds_read_b64_tr_b16 v[54:55], v4 offset:62464
    v_mfma_f32_16x16x32_bf16 v[120:123], v[192:195], v[60:63], v[120:123]
    ds_read_b64_tr_b16 v[56:57], v5 offset:61440
    v_mfma_f32_16x16x32_bf16 v[124:127], v[196:199], v[60:63], v[124:127]
    ds_read_b64_tr_b16 v[58:59], v5 offset:62464
    s_waitcnt lgkmcnt(10)
    v_mfma_f32_16x16x32_bf16 v[128:131], v[32:35], v[192:195], v[128:131]
    ds_read_b64_tr_b16 v[60:61], v6 offset:61440
    v_mfma_f32_16x16x32_bf16 v[132:135], v[32:35], v[196:199], v[132:135]
    ds_read_b64_tr_b16 v[62:63], v6 offset:62464
    s_barrier
    v_xor_b32 v3, 0x10000, v3
    v_xor_b32 v4, 0x10000, v4
    v_xor_b32 v5, 0x10000, v5
    v_xor_b32 v6, 0x10000, v6
    v_mfma_f32_16x16x32_bf16 v[136:139], v[36:39], v[192:195], v[136:139]
    ds_read_b64_tr_b16 v[32:33], v3 offset:0
    v_mfma_f32_16x16x32_bf16 v[140:143], v[36:39], v[196:199], v[140:143]
    ds_read_b64_tr_b16 v[34:35], v3 offset:1024
    s_waitcnt lgkmcnt(10)
    v_mfma_f32_16x16x32_bf16 v[144:147], v[40:43], v[192:195], v[144:147]
    ds_read_b64_tr_b16 v[36:37], v4 offset:0
    v_mfma_f32_16x16x32_bf16 v[148:151], v[40:43], v[196:199], v[148:151]
    ds_read_b64_tr_b16 v[38:39], v4 offset:1024
    v_mfma_f32_16x16x32_bf16 v[152:155], v[44:47], v[192:195], v[152:155]
    ds_read_b64_tr_b16 v[40:41], v5 offset:0
    v_mfma_f32_16x16x32_bf16 v[156:159], v[44:47], v[196:199], v[156:159]
    ds_read_b64_tr_b16 v[42:43], v5 offset:1024
    s_waitcnt vmcnt(13) lgkmcnt(10)
    v_mfma_f32_16x16x32_bf16 v[64:67], v[48:51], v[200:203], v[64:67]
    ds_read_b64_tr_b16 v[44:45], v6 offset:0
    v_mfma_f32_16x16x32_bf16 v[68:71], v[48:51], v[204:207], v[68:71]
    ds_read_b64_tr_b16 v[46:47], v6 offset:1024
    v_mfma_f32_16x16x32_bf16 v[72:75], v[52:55], v[200:203], v[72:75]
    ds_read_b64_tr_b16 v[48:49], v3 offset:4096
    v_mfma_f32_16x16x32_bf16 v[76:79], v[52:55], v[204:207], v[76:79]
    ds_read_b64_tr_b16 v[50:51], v3 offset:5120
    s_waitcnt lgkmcnt(10)
    v_mfma_f32_16x16x32_bf16 v[80:83], v[56:59], v[200:203], v[80:83]
    ds_read_b64_tr_b16 v[52:53], v4 offset:4096
    v_mfma_f32_16x16x32_bf16 v[84:87], v[56:59], v[204:207], v[84:87]
    ds_read_b64_tr_b16 v[54:55], v4 offset:5120
    v_mfma_f32_16x16x32_bf16 v[88:91], v[60:63], v[200:203], v[88:91]
    ds_read_b64_tr_b16 v[56:57], v5 offset:4096
    v_mfma_f32_16x16x32_bf16 v[92:95], v[60:63], v[204:207], v[92:95]
    ds_read_b64_tr_b16 v[58:59], v5 offset:5120
    s_waitcnt lgkmcnt(10)
    v_mfma_f32_16x16x32_bf16 v[96:99], v[200:203], v[32:35], v[96:99]
    ds_read_b64_tr_b16 v[60:61], v6 offset:4096
    v_mfma_f32_16x16x32_bf16 v[100:103], v[204:207], v[32:35], v[100:103]
    ds_read_b64_tr_b16 v[62:63], v6 offset:5120
    v_mfma_f32_16x16x32_bf16 v[104:107], v[200:203], v[36:39], v[104:107]
    ds_read_b64_tr_b16 v[32:33], v3 offset:8192
    v_mfma_f32_16x16x32_bf16 v[108:111], v[204:207], v[36:39], v[108:111]
    ds_read_b64_tr_b16 v[34:35], v3 offset:9216
    s_waitcnt lgkmcnt(10)
    v_mfma_f32_16x16x32_bf16 v[112:115], v[200:203], v[40:43], v[112:115]
    ds_read_b64_tr_b16 v[36:37], v4 offset:8192
    v_mfma_f32_16x16x32_bf16 v[116:119], v[204:207], v[40:43], v[116:119]
    ds_read_b64_tr_b16 v[38:39], v4 offset:9216
    v_mfma_f32_16x16x32_bf16 v[120:123], v[200:203], v[44:47], v[120:123]
    ds_read_b64_tr_b16 v[40:41], v5 offset:8192
    v_mfma_f32_16x16x32_bf16 v[124:127], v[204:207], v[44:47], v[124:127]
    ds_read_b64_tr_b16 v[42:43], v5 offset:9216
    s_waitcnt lgkmcnt(10)
    v_mfma_f32_16x16x32_bf16 v[128:131], v[48:51], v[200:203], v[128:131]
    ds_read_b64_tr_b16 v[44:45], v6 offset:8192
    v_mfma_f32_16x16x32_bf16 v[132:135], v[48:51], v[204:207], v[132:135]
    ds_read_b64_tr_b16 v[46:47], v6 offset:9216
    v_mfma_f32_16x16x32_bf16 v[136:139], v[52:55], v[200:203], v[136:139]
    ds_read_b64_tr_b16 v[48:49], v3 offset:12288
    v_mfma_f32_16x16x32_bf16 v[140:143], v[52:55], v[204:207], v[140:143]
    ds_read_b64_tr_b16 v[50:51], v3 offset:13312
    s_waitcnt lgkmcnt(10)
    v_mfma_f32_16x16x32_bf16 v[144:147], v[56:59], v[200:203], v[144:147]
    ds_read_b64_tr_b16 v[52:53], v4 offset:12288
    v_mfma_f32_16x16x32_bf16 v[148:151], v[56:59], v[204:207], v[148:151]
    ds_read_b64_tr_b16 v[54:55], v4 offset:13312
    v_mfma_f32_16x16x32_bf16 v[152:155], v[60:63], v[200:203], v[152:155]
    ds_read_b64_tr_b16 v[56:57], v5 offset:12288
    v_mfma_f32_16x16x32_bf16 v[156:159], v[60:63], v[204:207], v[156:159]
    ds_read_b64_tr_b16 v[58:59], v5 offset:13312
    s_waitcnt vmcnt(11) lgkmcnt(10)
    v_mfma_f32_16x16x32_bf16 v[64:67], v[32:35], v[208:211], v[64:67]
    ds_read_b64_tr_b16 v[60:61], v6 offset:12288
    v_mfma_f32_16x16x32_bf16 v[68:71], v[32:35], v[212:215], v[68:71]
    ds_read_b64_tr_b16 v[62:63], v6 offset:13312
    v_mfma_f32_16x16x32_bf16 v[72:75], v[36:39], v[208:211], v[72:75]
    ds_read_b64_tr_b16 v[32:33], v3 offset:16384
    v_mfma_f32_16x16x32_bf16 v[76:79], v[36:39], v[212:215], v[76:79]
    ds_read_b64_tr_b16 v[34:35], v3 offset:17408
    s_waitcnt lgkmcnt(10)
    v_mfma_f32_16x16x32_bf16 v[80:83], v[40:43], v[208:211], v[80:83]
    ds_read_b64_tr_b16 v[36:37], v4 offset:16384
    v_mfma_f32_16x16x32_bf16 v[84:87], v[40:43], v[212:215], v[84:87]
    ds_read_b64_tr_b16 v[38:39], v4 offset:17408
    v_mfma_f32_16x16x32_bf16 v[88:91], v[44:47], v[208:211], v[88:91]
    ds_read_b64_tr_b16 v[40:41], v5 offset:16384
    v_mfma_f32_16x16x32_bf16 v[92:95], v[44:47], v[212:215], v[92:95]
    ds_read_b64_tr_b16 v[42:43], v5 offset:17408
    s_waitcnt lgkmcnt(10)
    v_mfma_f32_16x16x32_bf16 v[96:99], v[208:211], v[48:51], v[96:99]
    buffer_load_dwordx4 v[164:167], v2, s[4:7], s42 offen offset:256 sc1
    ds_read_b64_tr_b16 v[44:45], v6 offset:16384
    v_mfma_f32_16x16x32_bf16 v[100:103], v[212:215], v[48:51], v[100:103]
    ds_read_b64_tr_b16 v[46:47], v6 offset:17408
    v_mfma_f32_16x16x32_bf16 v[104:107], v[208:211], v[52:55], v[104:107]
    buffer_load_dwordx4 v[168:171], v2, s[4:7], s42 offen offset:2048 sc1
    ds_read_b64_tr_b16 v[48:49], v3 offset:20480
    v_mfma_f32_16x16x32_bf16 v[108:111], v[212:215], v[52:55], v[108:111]
    ds_read_b64_tr_b16 v[50:51], v3 offset:21504
    s_waitcnt lgkmcnt(10)
    v_mfma_f32_16x16x32_bf16 v[112:115], v[208:211], v[56:59], v[112:115]
    buffer_load_dwordx4 v[172:175], v2, s[4:7], s42 offen offset:2304 sc1
    ds_read_b64_tr_b16 v[52:53], v4 offset:20480
    s_add_u32 s42, s41, s91
    v_mfma_f32_16x16x32_bf16 v[116:119], v[212:215], v[56:59], v[116:119]
    ds_read_b64_tr_b16 v[54:55], v4 offset:21504
    v_mfma_f32_16x16x32_bf16 v[120:123], v[208:211], v[60:63], v[120:123]
    buffer_load_dwordx4 v[176:179], v2, s[4:7], s42 offen offset:0 sc1
    ds_read_b64_tr_b16 v[56:57], v5 offset:20480
    v_mfma_f32_16x16x32_bf16 v[124:127], v[212:215], v[60:63], v[124:127]
    ds_read_b64_tr_b16 v[58:59], v5 offset:21504
    s_waitcnt lgkmcnt(10)
    v_mfma_f32_16x16x32_bf16 v[128:131], v[32:35], v[208:211], v[128:131]
    ds_read_b64_tr_b16 v[60:61], v6 offset:20480
    buffer_load_dwordx4 v[180:183], v2, s[4:7], s42 offen offset:256 sc1
    v_mfma_f32_16x16x32_bf16 v[132:135], v[32:35], v[212:215], v[132:135]
    ds_read_b64_tr_b16 v[62:63], v6 offset:21504
    v_mfma_f32_16x16x32_bf16 v[136:139], v[36:39], v[208:211], v[136:139]
    buffer_load_dwordx4 v[184:187], v2, s[4:7], s42 offen offset:2048 sc1
    ds_read_b64_tr_b16 v[32:33], v3 offset:24576
    v_mfma_f32_16x16x32_bf16 v[140:143], v[36:39], v[212:215], v[140:143]
    ds_read_b64_tr_b16 v[34:35], v3 offset:25600
    s_waitcnt lgkmcnt(10)
    v_mfma_f32_16x16x32_bf16 v[144:147], v[40:43], v[208:211], v[144:147]
    ds_read_b64_tr_b16 v[36:37], v4 offset:24576
    v_mfma_f32_16x16x32_bf16 v[148:151], v[40:43], v[212:215], v[148:151]
    ds_read_b64_tr_b16 v[38:39], v4 offset:25600
    v_mfma_f32_16x16x32_bf16 v[152:155], v[44:47], v[208:211], v[152:155]
    ds_read_b64_tr_b16 v[40:41], v5 offset:24576
    v_mfma_f32_16x16x32_bf16 v[156:159], v[44:47], v[212:215], v[156:159]
    ds_read_b64_tr_b16 v[42:43], v5 offset:25600
    s_waitcnt vmcnt(15) lgkmcnt(10)
    v_mfma_f32_16x16x32_bf16 v[64:67], v[48:51], v[216:219], v[64:67]
    ds_read_b64_tr_b16 v[44:45], v6 offset:24576
    v_mfma_f32_16x16x32_bf16 v[68:71], v[48:51], v[220:223], v[68:71]
    ds_read_b64_tr_b16 v[46:47], v6 offset:25600
    v_mfma_f32_16x16x32_bf16 v[72:75], v[52:55], v[216:219], v[72:75]
    ds_read_b64_tr_b16 v[48:49], v3 offset:28672
    v_mfma_f32_16x16x32_bf16 v[76:79], v[52:55], v[220:223], v[76:79]
    ds_read_b64_tr_b16 v[50:51], v3 offset:29696
    s_waitcnt lgkmcnt(10)
    v_mfma_f32_16x16x32_bf16 v[80:83], v[56:59], v[216:219], v[80:83]
    buffer_load_dwordx4 v[188:191], v2, s[4:7], s42 offen offset:2304 sc1
    ds_read_b64_tr_b16 v[52:53], v4 offset:28672
    s_add_u32 s42, s41, s92
    v_mfma_f32_16x16x32_bf16 v[84:87], v[56:59], v[220:223], v[84:87]
    ds_read_b64_tr_b16 v[54:55], v4 offset:29696
    v_mfma_f32_16x16x32_bf16 v[88:91], v[60:63], v[216:219], v[88:91]
    ds_read_b64_tr_b16 v[56:57], v5 offset:28672
    v_mfma_f32_16x16x32_bf16 v[92:95], v[60:63], v[220:223], v[92:95]
    ds_read_b64_tr_b16 v[58:59], v5 offset:29696
    s_waitcnt lgkmcnt(10)
    v_mfma_f32_16x16x32_bf16 v[96:99], v[216:219], v[32:35], v[96:99]
    ds_read_b64_tr_b16 v[60:61], v6 offset:28672
    v_mfma_f32_16x16x32_bf16 v[100:103], v[220:223], v[32:35], v[100:103]
    ds_read_b64_tr_b16 v[62:63], v6 offset:29696
    s_barrier
    v_mfma_f32_16x16x32_bf16 v[104:107], v[216:219], v[36:39], v[104:107]
    ds_read_b64_tr_b16 v[32:33], v3 offset:32768
    v_mfma_f32_16x16x32_bf16 v[108:111], v[220:223], v[36:39], v[108:111]
    ds_read_b64_tr_b16 v[34:35], v3 offset:33792
    s_waitcnt lgkmcnt(10)
    v_mfma_f32_16x16x32_bf16 v[112:115], v[216:219], v[40:43], v[112:115]
    ds_read_b64_tr_b16 v[36:37], v4 offset:32768
    v_mfma_f32_16x16x32_bf16 v[116:119], v[220:223], v[40:43], v[116:119]
    ds_read_b64_tr_b16 v[38:39], v4 offset:33792
    v_mfma_f32_16x16x32_bf16 v[120:123], v[216:219], v[44:47], v[120:123]
    ds_read_b64_tr_b16 v[40:41], v5 offset:32768
    v_mfma_f32_16x16x32_bf16 v[124:127], v[220:223], v[44:47], v[124:127]
    ds_read_b64_tr_b16 v[42:43], v5 offset:33792
    s_waitcnt lgkmcnt(10)
    v_mfma_f32_16x16x32_bf16 v[128:131], v[48:51], v[216:219], v[128:131]
    ds_read_b64_tr_b16 v[44:45], v6 offset:32768
    v_mfma_f32_16x16x32_bf16 v[132:135], v[48:51], v[220:223], v[132:135]
    ds_read_b64_tr_b16 v[46:47], v6 offset:33792
    v_mfma_f32_16x16x32_bf16 v[136:139], v[52:55], v[216:219], v[136:139]
    ds_read_b64_tr_b16 v[48:49], v3 offset:36864
    v_mfma_f32_16x16x32_bf16 v[140:143], v[52:55], v[220:223], v[140:143]
    ds_read_b64_tr_b16 v[50:51], v3 offset:37888
    s_waitcnt lgkmcnt(10)
    v_mfma_f32_16x16x32_bf16 v[144:147], v[56:59], v[216:219], v[144:147]
    ds_read_b64_tr_b16 v[52:53], v4 offset:36864
    v_mfma_f32_16x16x32_bf16 v[148:151], v[56:59], v[220:223], v[148:151]
    ds_read_b64_tr_b16 v[54:55], v4 offset:37888
    v_mfma_f32_16x16x32_bf16 v[152:155], v[60:63], v[216:219], v[152:155]
    ds_read_b64_tr_b16 v[56:57], v5 offset:36864
    v_mfma_f32_16x16x32_bf16 v[156:159], v[60:63], v[220:223], v[156:159]
    ds_read_b64_tr_b16 v[58:59], v5 offset:37888
    s_waitcnt vmcnt(14) lgkmcnt(10)
    v_mfma_f32_16x16x32_bf16 v[64:67], v[32:35], v[224:227], v[64:67]
    ds_read_b64_tr_b16 v[60:61], v6 offset:36864
    v_mfma_f32_16x16x32_bf16 v[68:71], v[32:35], v[228:231], v[68:71]
    ds_read_b64_tr_b16 v[62:63], v6 offset:37888
    v_mfma_f32_16x16x32_bf16 v[72:75], v[36:39], v[224:227], v[72:75]
    ds_read_b64_tr_b16 v[32:33], v3 offset:40960
    v_mfma_f32_16x16x32_bf16 v[76:79], v[36:39], v[228:231], v[76:79]
    ds_read_b64_tr_b16 v[34:35], v3 offset:41984
    s_waitcnt lgkmcnt(10)
    v_mfma_f32_16x16x32_bf16 v[80:83], v[40:43], v[224:227], v[80:83]
    ds_read_b64_tr_b16 v[36:37], v4 offset:40960
    v_mfma_f32_16x16x32_bf16 v[84:87], v[40:43], v[228:231], v[84:87]
    ds_read_b64_tr_b16 v[38:39], v4 offset:41984
    v_mfma_f32_16x16x32_bf16 v[88:91], v[44:47], v[224:227], v[88:91]
    ds_read_b64_tr_b16 v[40:41], v5 offset:40960
    v_mfma_f32_16x16x32_bf16 v[92:95], v[44:47], v[228:231], v[92:95]
    ds_read_b64_tr_b16 v[42:43], v5 offset:41984
    s_waitcnt lgkmcnt(10)
    v_mfma_f32_16x16x32_bf16 v[96:99], v[224:227], v[48:51], v[96:99]
    ds_read_b64_tr_b16 v[44:45], v6 offset:40960
    v_mfma_f32_16x16x32_bf16 v[100:103], v[228:231], v[48:51], v[100:103]
    ds_read_b64_tr_b16 v[46:47], v6 offset:41984
    v_mfma_f32_16x16x32_bf16 v[104:107], v[224:227], v[52:55], v[104:107]
    ds_read_b64_tr_b16 v[48:49], v3 offset:45056
    v_mfma_f32_16x16x32_bf16 v[108:111], v[228:231], v[52:55], v[108:111]
    ds_read_b64_tr_b16 v[50:51], v3 offset:46080
    s_waitcnt lgkmcnt(10)
    v_mfma_f32_16x16x32_bf16 v[112:115], v[224:227], v[56:59], v[112:115]
    ds_read_b64_tr_b16 v[52:53], v4 offset:45056
    v_mfma_f32_16x16x32_bf16 v[116:119], v[228:231], v[56:59], v[116:119]
    ds_read_b64_tr_b16 v[54:55], v4 offset:46080
    v_mfma_f32_16x16x32_bf16 v[120:123], v[224:227], v[60:63], v[120:123]
    ds_read_b64_tr_b16 v[56:57], v5 offset:45056
    v_mfma_f32_16x16x32_bf16 v[124:127], v[228:231], v[60:63], v[124:127]
    ds_read_b64_tr_b16 v[58:59], v5 offset:46080
    s_waitcnt lgkmcnt(10)
    v_mfma_f32_16x16x32_bf16 v[128:131], v[32:35], v[224:227], v[128:131]
    ds_read_b64_tr_b16 v[60:61], v6 offset:45056
    v_mfma_f32_16x16x32_bf16 v[132:135], v[32:35], v[228:231], v[132:135]
    ds_read_b64_tr_b16 v[62:63], v6 offset:46080
    v_mfma_f32_16x16x32_bf16 v[136:139], v[36:39], v[224:227], v[136:139]
    ds_read_b64_tr_b16 v[32:33], v3 offset:49152
    v_mfma_f32_16x16x32_bf16 v[140:143], v[36:39], v[228:231], v[140:143]
    ds_read_b64_tr_b16 v[34:35], v3 offset:50176
    s_waitcnt lgkmcnt(10)
    v_mfma_f32_16x16x32_bf16 v[144:147], v[40:43], v[224:227], v[144:147]
    ds_read_b64_tr_b16 v[36:37], v4 offset:49152
    v_mfma_f32_16x16x32_bf16 v[148:151], v[40:43], v[228:231], v[148:151]
    ds_read_b64_tr_b16 v[38:39], v4 offset:50176
    v_mfma_f32_16x16x32_bf16 v[152:155], v[44:47], v[224:227], v[152:155]
    ds_read_b64_tr_b16 v[40:41], v5 offset:49152
    v_mfma_f32_16x16x32_bf16 v[156:159], v[44:47], v[228:231], v[156:159]
    ds_read_b64_tr_b16 v[42:43], v5 offset:50176
    s_waitcnt vmcnt(12) lgkmcnt(10)
    v_mfma_f32_16x16x32_bf16 v[64:67], v[48:51], v[232:235], v[64:67]
    buffer_load_dwordx4 v[192:195], v2, s[4:7], s42 offen offset:0 sc1
    ds_read_b64_tr_b16 v[44:45], v6 offset:49152
    v_mfma_f32_16x16x32_bf16 v[68:71], v[48:51], v[236:239], v[68:71]
    ds_read_b64_tr_b16 v[46:47], v6 offset:50176
    v_mfma_f32_16x16x32_bf16 v[72:75], v[52:55], v[232:235], v[72:75]
    buffer_load_dwordx4 v[196:199], v2, s[4:7], s42 offen offset:256 sc1
    ds_read_b64_tr_b16 v[48:49], v3 offset:53248
    v_mfma_f32_16x16x32_bf16 v[76:79], v[52:55], v[236:239], v[76:79]
    ds_read_b64_tr_b16 v[50:51], v3 offset:54272
    s_waitcnt lgkmcnt(10)
    v_mfma_f32_16x16x32_bf16 v[80:83], v[56:59], v[232:235], v[80:83]
    buffer_load_dwordx4 v[200:203], v2, s[4:7], s42 offen offset:2048 sc1
    ds_read_b64_tr_b16 v[52:53], v4 offset:53248
    v_mfma_f32_16x16x32_bf16 v[84:87], v[56:59], v[236:239], v[84:87]
    ds_read_b64_tr_b16 v[54:55], v4 offset:54272
    v_mfma_f32_16x16x32_bf16 v[88:91], v[60:63], v[232:235], v[88:91]
    buffer_load_dwordx4 v[204:207], v2, s[4:7], s42 offen offset:2304 sc1
    ds_read_b64_tr_b16 v[56:57], v5 offset:53248
    s_add_u32 s42, s41, s93
    v_mfma_f32_16x16x32_bf16 v[92:95], v[60:63], v[236:239], v[92:95]
    ds_read_b64_tr_b16 v[58:59], v5 offset:54272
    s_waitcnt lgkmcnt(10)
    v_mfma_f32_16x16x32_bf16 v[96:99], v[232:235], v[32:35], v[96:99]
    ds_read_b64_tr_b16 v[60:61], v6 offset:53248
    buffer_load_dwordx4 v[208:211], v2, s[4:7], s42 offen offset:0 sc1
    v_mfma_f32_16x16x32_bf16 v[100:103], v[236:239], v[32:35], v[100:103]
    ds_read_b64_tr_b16 v[62:63], v6 offset:54272
    v_mfma_f32_16x16x32_bf16 v[104:107], v[232:235], v[36:39], v[104:107]
    ds_read_b64_tr_b16 v[32:33], v3 offset:57344
    v_mfma_f32_16x16x32_bf16 v[108:111], v[236:239], v[36:39], v[108:111]
    ds_read_b64_tr_b16 v[34:35], v3 offset:58368
    s_waitcnt lgkmcnt(10)
    v_mfma_f32_16x16x32_bf16 v[112:115], v[232:235], v[40:43], v[112:115]
    ds_read_b64_tr_b16 v[36:37], v4 offset:57344
    v_mfma_f32_16x16x32_bf16 v[116:119], v[236:239], v[40:43], v[116:119]
    ds_read_b64_tr_b16 v[38:39], v4 offset:58368
    v_mfma_f32_16x16x32_bf16 v[120:123], v[232:235], v[44:47], v[120:123]
    buffer_load_dwordx4 v[212:215], v2, s[4:7], s42 offen offset:256 sc1
    ds_read_b64_tr_b16 v[40:41], v5 offset:57344
    v_mfma_f32_16x16x32_bf16 v[124:127], v[236:239], v[44:47], v[124:127]
    ds_read_b64_tr_b16 v[42:43], v5 offset:58368
    s_waitcnt lgkmcnt(10)
    v_mfma_f32_16x16x32_bf16 v[128:131], v[48:51], v[232:235], v[128:131]
    ds_read_b64_tr_b16 v[44:45], v6 offset:57344
    v_mfma_f32_16x16x32_bf16 v[132:135], v[48:51], v[236:239], v[132:135]
    ds_read_b64_tr_b16 v[46:47], v6 offset:58368
    v_mfma_f32_16x16x32_bf16 v[136:139], v[52:55], v[232:235], v[136:139]
    ds_read_b64_tr_b16 v[48:49], v3 offset:61440
    v_mfma_f32_16x16x32_bf16 v[140:143], v[52:55], v[236:239], v[140:143]
    ds_read_b64_tr_b16 v[50:51], v3 offset:62464
    s_waitcnt lgkmcnt(10)
    v_mfma_f32_16x16x32_bf16 v[144:147], v[56:59], v[232:235], v[144:147]
    ds_read_b64_tr_b16 v[52:53], v4 offset:61440
    v_mfma_f32_16x16x32_bf16 v[148:151], v[56:59], v[236:239], v[148:151]
    ds_read_b64_tr_b16 v[54:55], v4 offset:62464
    v_mfma_f32_16x16x32_bf16 v[152:155], v[60:63], v[232:235], v[152:155]
    ds_read_b64_tr_b16 v[56:57], v5 offset:61440
    v_mfma_f32_16x16x32_bf16 v[156:159], v[60:63], v[236:239], v[156:159]
    ds_read_b64_tr_b16 v[58:59], v5 offset:62464
    s_waitcnt vmcnt(16) lgkmcnt(10)
    v_mfma_f32_16x16x32_bf16 v[64:67], v[32:35], v[240:243], v[64:67]
    ds_read_b64_tr_b16 v[60:61], v6 offset:61440
    v_mfma_f32_16x16x32_bf16 v[68:71], v[32:35], v[244:247], v[68:71]
    ds_read_b64_tr_b16 v[62:63], v6 offset:62464
    s_barrier
    v_xor_b32 v3, 0x10000, v3
    v_xor_b32 v4, 0x10000, v4
    v_xor_b32 v5, 0x10000, v5
    v_xor_b32 v6, 0x10000, v6
    v_mfma_f32_16x16x32_bf16 v[72:75], v[36:39], v[240:243], v[72:75]
    ds_read_b64_tr_b16 v[32:33], v3 offset:0
    v_mfma_f32_16x16x32_bf16 v[76:79], v[36:39], v[244:247], v[76:79]
    ds_read_b64_tr_b16 v[34:35], v3 offset:1024
    s_waitcnt lgkmcnt(10)
    v_mfma_f32_16x16x32_bf16 v[80:83], v[40:43], v[240:243], v[80:83]
    ds_read_b64_tr_b16 v[36:37], v4 offset:0
    v_mfma_f32_16x16x32_bf16 v[84:87], v[40:43], v[244:247], v[84:87]
    ds_read_b64_tr_b16 v[38:39], v4 offset:1024
    v_mfma_f32_16x16x32_bf16 v[88:91], v[44:47], v[240:243], v[88:91]
    ds_read_b64_tr_b16 v[40:41], v5 offset:0
    v_mfma_f32_16x16x32_bf16 v[92:95], v[44:47], v[244:247], v[92:95]
    ds_read_b64_tr_b16 v[42:43], v5 offset:1024
    s_waitcnt lgkmcnt(10)
    v_mfma_f32_16x16x32_bf16 v[96:99], v[240:243], v[48:51], v[96:99]
    ds_read_b64_tr_b16 v[44:45], v6 offset:0
    v_mfma_f32_16x16x32_bf16 v[100:103], v[244:247], v[48:51], v[100:103]
    ds_read_b64_tr_b16 v[46:47], v6 offset:1024
    v_mfma_f32_16x16x32_bf16 v[104:107], v[240:243], v[52:55], v[104:107]
    ds_read_b64_tr_b16 v[48:49], v3 offset:4096
    v_mfma_f32_16x16x32_bf16 v[108:111], v[244:247], v[52:55], v[108:111]
    ds_read_b64_tr_b16 v[50:51], v3 offset:5120
    s_waitcnt lgkmcnt(10)
    v_mfma_f32_16x16x32_bf16 v[112:115], v[240:243], v[56:59], v[112:115]
    ds_read_b64_tr_b16 v[52:53], v4 offset:4096
    v_mfma_f32_16x16x32_bf16 v[116:119], v[244:247], v[56:59], v[116:119]
    ds_read_b64_tr_b16 v[54:55], v4 offset:5120
    v_mfma_f32_16x16x32_bf16 v[120:123], v[240:243], v[60:63], v[120:123]
    ds_read_b64_tr_b16 v[56:57], v5 offset:4096
    v_mfma_f32_16x16x32_bf16 v[124:127], v[244:247], v[60:63], v[124:127]
    ds_read_b64_tr_b16 v[58:59], v5 offset:5120
    s_waitcnt lgkmcnt(10)
    v_mfma_f32_16x16x32_bf16 v[128:131], v[32:35], v[240:243], v[128:131]
    ds_read_b64_tr_b16 v[60:61], v6 offset:4096
    v_mfma_f32_16x16x32_bf16 v[132:135], v[32:35], v[244:247], v[132:135]
    ds_read_b64_tr_b16 v[62:63], v6 offset:5120
    v_mfma_f32_16x16x32_bf16 v[136:139], v[36:39], v[240:243], v[136:139]
    ds_read_b64_tr_b16 v[32:33], v3 offset:8192
    v_mfma_f32_16x16x32_bf16 v[140:143], v[36:39], v[244:247], v[140:143]
    ds_read_b64_tr_b16 v[34:35], v3 offset:9216
    s_waitcnt lgkmcnt(10)
    v_mfma_f32_16x16x32_bf16 v[144:147], v[40:43], v[240:243], v[144:147]
    ds_read_b64_tr_b16 v[36:37], v4 offset:8192
    v_mfma_f32_16x16x32_bf16 v[148:151], v[40:43], v[244:247], v[148:151]
    ds_read_b64_tr_b16 v[38:39], v4 offset:9216
    v_mfma_f32_16x16x32_bf16 v[152:155], v[44:47], v[240:243], v[152:155]
    ds_read_b64_tr_b16 v[40:41], v5 offset:8192
    v_mfma_f32_16x16x32_bf16 v[156:159], v[44:47], v[244:247], v[156:159]
    ds_read_b64_tr_b16 v[42:43], v5 offset:9216
    s_waitcnt vmcnt(14) lgkmcnt(10)
    v_mfma_f32_16x16x32_bf16 v[64:67], v[48:51], v[248:251], v[64:67]
    ds_read_b64_tr_b16 v[44:45], v6 offset:8192
    v_mfma_f32_16x16x32_bf16 v[68:71], v[48:51], v[252:255], v[68:71]
    ds_read_b64_tr_b16 v[46:47], v6 offset:9216
    v_mfma_f32_16x16x32_bf16 v[72:75], v[52:55], v[248:251], v[72:75]
    ds_read_b64_tr_b16 v[48:49], v3 offset:12288
    v_mfma_f32_16x16x32_bf16 v[76:79], v[52:55], v[252:255], v[76:79]
    ds_read_b64_tr_b16 v[50:51], v3 offset:13312
    s_waitcnt lgkmcnt(10)
    v_mfma_f32_16x16x32_bf16 v[80:83], v[56:59], v[248:251], v[80:83]
    ds_read_b64_tr_b16 v[52:53], v4 offset:12288
    v_mfma_f32_16x16x32_bf16 v[84:87], v[56:59], v[252:255], v[84:87]
    ds_read_b64_tr_b16 v[54:55], v4 offset:13312
    v_mfma_f32_16x16x32_bf16 v[88:91], v[60:63], v[248:251], v[88:91]
    ds_read_b64_tr_b16 v[56:57], v5 offset:12288
    v_mfma_f32_16x16x32_bf16 v[92:95], v[60:63], v[252:255], v[92:95]
    ds_read_b64_tr_b16 v[58:59], v5 offset:13312
    s_waitcnt lgkmcnt(10)
    v_mfma_f32_16x16x32_bf16 v[96:99], v[248:251], v[32:35], v[96:99]
    ds_read_b64_tr_b16 v[60:61], v6 offset:12288
    v_mfma_f32_16x16x32_bf16 v[100:103], v[252:255], v[32:35], v[100:103]
    ds_read_b64_tr_b16 v[62:63], v6 offset:13312
    v_mfma_f32_16x16x32_bf16 v[104:107], v[248:251], v[36:39], v[104:107]
    ds_read_b64_tr_b16 v[32:33], v3 offset:16384
    v_mfma_f32_16x16x32_bf16 v[108:111], v[252:255], v[36:39], v[108:111]
    ds_read_b64_tr_b16 v[34:35], v3 offset:17408
    s_waitcnt lgkmcnt(10)
    v_mfma_f32_16x16x32_bf16 v[112:115], v[248:251], v[40:43], v[112:115]
    ds_read_b64_tr_b16 v[36:37], v4 offset:16384
    v_mfma_f32_16x16x32_bf16 v[116:119], v[252:255], v[40:43], v[116:119]
    ds_read_b64_tr_b16 v[38:39], v4 offset:17408
    v_mfma_f32_16x16x32_bf16 v[120:123], v[248:251], v[44:47], v[120:123]
    ds_read_b64_tr_b16 v[40:41], v5 offset:16384
    v_mfma_f32_16x16x32_bf16 v[124:127], v[252:255], v[44:47], v[124:127]
    ds_read_b64_tr_b16 v[42:43], v5 offset:17408
    s_waitcnt lgkmcnt(10)
    v_mfma_f32_16x16x32_bf16 v[128:131], v[48:51], v[248:251], v[128:131]
    buffer_load_dwordx4 v[216:219], v2, s[4:7], s42 offen offset:2048 sc1
    ds_read_b64_tr_b16 v[44:45], v6 offset:16384
    v_mfma_f32_16x16x32_bf16 v[132:135], v[48:51], v[252:255], v[132:135]
    ds_read_b64_tr_b16 v[46:47], v6 offset:17408
    v_mfma_f32_16x16x32_bf16 v[136:139], v[52:55], v[248:251], v[136:139]
    buffer_load_dwordx4 v[220:223], v2, s[4:7], s42 offen offset:2304 sc1
    ds_read_b64_tr_b16 v[48:49], v3 offset:20480
    s_add_u32 s42, s41, s94
    v_mfma_f32_16x16x32_bf16 v[140:143], v[52:55], v[252:255], v[140:143]
    ds_read_b64_tr_b16 v[50:51], v3 offset:21504
    s_waitcnt lgkmcnt(10)
    v_mfma_f32_16x16x32_bf16 v[144:147], v[56:59], v[248:251], v[144:147]
    buffer_load_dwordx4 v[224:227], v2, s[4:7], s42 offen offset:0 sc1
    ds_read_b64_tr_b16 v[52:53], v4 offset:20480
    v_mfma_f32_16x16x32_bf16 v[148:151], v[56:59], v[252:255], v[148:151]
    ds_read_b64_tr_b16 v[54:55], v4 offset:21504
    v_mfma_f32_16x16x32_bf16 v[152:155], v[60:63], v[248:251], v[152:155]
    buffer_load_dwordx4 v[228:231], v2, s[4:7], s42 offen offset:256 sc1
    ds_read_b64_tr_b16 v[56:57], v5 offset:20480
    v_mfma_f32_16x16x32_bf16 v[156:159], v[60:63], v[252:255], v[156:159]
    ds_read_b64_tr_b16 v[58:59], v5 offset:21504
    s_waitcnt vmcnt(16) lgkmcnt(10)
    v_mfma_f32_16x16x32_bf16 v[64:67], v[32:35], v[160:163], v[64:67]
    ds_read_b64_tr_b16 v[60:61], v6 offset:20480
    buffer_load_dwordx4 v[232:235], v2, s[4:7], s42 offen offset:2048 sc1
    v_mfma_f32_16x16x32_bf16 v[68:71], v[32:35], v[164:167], v[68:71]
    ds_read_b64_tr_b16 v[62:63], v6 offset:21504
    v_mfma_f32_16x16x32_bf16 v[72:75], v[36:39], v[160:163], v[72:75]
    buffer_load_dwordx4 v[236:239], v2, s[4:7], s42 offen offset:2304 sc1
    ds_read_b64_tr_b16 v[32:33], v3 offset:24576
    s_add_u32 s42, s41, s95
    v_mfma_f32_16x16x32_bf16 v[76:79], v[36:39], v[164:167], v[76:79]
    ds_read_b64_tr_b16 v[34:35], v3 offset:25600
    s_waitcnt lgkmcnt(10)
    v_mfma_f32_16x16x32_bf16 v[80:83], v[40:43], v[160:163], v[80:83]
    ds_read_b64_tr_b16 v[36:37], v4 offset:24576
    v_mfma_f32_16x16x32_bf16 v[84:87], v[40:43], v[164:167], v[84:87]
    ds_read_b64_tr_b16 v[38:39], v4 offset:25600
    v_mfma_f32_16x16x32_bf16 v[88:91], v[44:47], v[160:163], v[88:91]
    ds_read_b64_tr_b16 v[40:41], v5 offset:24576
    v_mfma_f32_16x16x32_bf16 v[92:95], v[44:47], v[164:167], v[92:95]
    ds_read_b64_tr_b16 v[42:43], v5 offset:25600
    s_waitcnt lgkmcnt(10)
    v_mfma_f32_16x16x32_bf16 v[96:99], v[160:163], v[48:51], v[96:99]
    buffer_load_dwordx4 v[240:243], v2, s[4:7], s42 offen offset:0 sc1
    ds_read_b64_tr_b16 v[44:45], v6 offset:24576
    v_mfma_f32_16x16x32_bf16 v[100:103], v[164:167], v[48:51], v[100:103]
    ds_read_b64_tr_b16 v[46:47], v6 offset:25600
    v_mfma_f32_16x16x32_bf16 v[104:107], v[160:163], v[52:55], v[104:107]
    ds_read_b64_tr_b16 v[48:49], v3 offset:28672
    v_mfma_f32_16x16x32_bf16 v[108:111], v[164:167], v[52:55], v[108:111]
    ds_read_b64_tr_b16 v[50:51], v3 offset:29696
    s_waitcnt lgkmcnt(10)
    v_mfma_f32_16x16x32_bf16 v[112:115], v[160:163], v[56:59], v[112:115]
    ds_read_b64_tr_b16 v[52:53], v4 offset:28672
    v_mfma_f32_16x16x32_bf16 v[116:119], v[164:167], v[56:59], v[116:119]
    ds_read_b64_tr_b16 v[54:55], v4 offset:29696
    v_mfma_f32_16x16x32_bf16 v[120:123], v[160:163], v[60:63], v[120:123]
    ds_read_b64_tr_b16 v[56:57], v5 offset:28672
    v_mfma_f32_16x16x32_bf16 v[124:127], v[164:167], v[60:63], v[124:127]
    ds_read_b64_tr_b16 v[58:59], v5 offset:29696
    s_waitcnt lgkmcnt(10)
    v_mfma_f32_16x16x32_bf16 v[128:131], v[32:35], v[160:163], v[128:131]
    ds_read_b64_tr_b16 v[60:61], v6 offset:28672
    v_mfma_f32_16x16x32_bf16 v[132:135], v[32:35], v[164:167], v[132:135]
    ds_read_b64_tr_b16 v[62:63], v6 offset:29696
    s_barrier
    v_mfma_f32_16x16x32_bf16 v[136:139], v[36:39], v[160:163], v[136:139]
    ds_read_b64_tr_b16 v[32:33], v3 offset:32768
    v_mfma_f32_16x16x32_bf16 v[140:143], v[36:39], v[164:167], v[140:143]
    ds_read_b64_tr_b16 v[34:35], v3 offset:33792
    s_waitcnt lgkmcnt(10)
    v_mfma_f32_16x16x32_bf16 v[144:147], v[40:43], v[160:163], v[144:147]
    ds_read_b64_tr_b16 v[36:37], v4 offset:32768
    v_mfma_f32_16x16x32_bf16 v[148:151], v[40:43], v[164:167], v[148:151]
    ds_read_b64_tr_b16 v[38:39], v4 offset:33792
    v_mfma_f32_16x16x32_bf16 v[152:155], v[44:47], v[160:163], v[152:155]
    ds_read_b64_tr_b16 v[40:41], v5 offset:32768
    v_mfma_f32_16x16x32_bf16 v[156:159], v[44:47], v[164:167], v[156:159]
    ds_read_b64_tr_b16 v[42:43], v5 offset:33792
    s_waitcnt vmcnt(17) lgkmcnt(10)
    v_mfma_f32_16x16x32_bf16 v[64:67], v[48:51], v[168:171], v[64:67]
    ds_read_b64_tr_b16 v[44:45], v6 offset:32768
    v_mfma_f32_16x16x32_bf16 v[68:71], v[48:51], v[172:175], v[68:71]
    ds_read_b64_tr_b16 v[46:47], v6 offset:33792
    v_mfma_f32_16x16x32_bf16 v[72:75], v[52:55], v[168:171], v[72:75]
    ds_read_b64_tr_b16 v[48:49], v3 offset:36864
    v_mfma_f32_16x16x32_bf16 v[76:79], v[52:55], v[172:175], v[76:79]
    ds_read_b64_tr_b16 v[50:51], v3 offset:37888
    s_waitcnt lgkmcnt(10)
    v_mfma_f32_16x16x32_bf16 v[80:83], v[56:59], v[168:171], v[80:83]
    ds_read_b64_tr_b16 v[52:53], v4 offset:36864
    v_mfma_f32_16x16x32_bf16 v[84:87], v[56:59], v[172:175], v[84:87]
    ds_read_b64_tr_b16 v[54:55], v4 offset:37888
    v_mfma_f32_16x16x32_bf16 v[88:91], v[60:63], v[168:171], v[88:91]
    ds_read_b64_tr_b16 v[56:57], v5 offset:36864
    v_mfma_f32_16x16x32_bf16 v[92:95], v[60:63], v[172:175], v[92:95]
    ds_read_b64_tr_b16 v[58:59], v5 offset:37888
    s_waitcnt lgkmcnt(10)
    v_mfma_f32_16x16x32_bf16 v[96:99], v[168:171], v[32:35], v[96:99]
    ds_read_b64_tr_b16 v[60:61], v6 offset:36864
    v_mfma_f32_16x16x32_bf16 v[100:103], v[172:175], v[32:35], v[100:103]
    ds_read_b64_tr_b16 v[62:63], v6 offset:37888
    v_mfma_f32_16x16x32_bf16 v[104:107], v[168:171], v[36:39], v[104:107]
    ds_read_b64_tr_b16 v[32:33], v3 offset:40960
    v_mfma_f32_16x16x32_bf16 v[108:111], v[172:175], v[36:39], v[108:111]
    ds_read_b64_tr_b16 v[34:35], v3 offset:41984
    s_waitcnt lgkmcnt(10)
    v_mfma_f32_16x16x32_bf16 v[112:115], v[168:171], v[40:43], v[112:115]
    ds_read_b64_tr_b16 v[36:37], v4 offset:40960
    v_mfma_f32_16x16x32_bf16 v[116:119], v[172:175], v[40:43], v[116:119]
    ds_read_b64_tr_b16 v[38:39], v4 offset:41984
    v_mfma_f32_16x16x32_bf16 v[120:123], v[168:171], v[44:47], v[120:123]
    ds_read_b64_tr_b16 v[40:41], v5 offset:40960
    v_mfma_f32_16x16x32_bf16 v[124:127], v[172:175], v[44:47], v[124:127]
    ds_read_b64_tr_b16 v[42:43], v5 offset:41984
    s_waitcnt lgkmcnt(10)
    v_mfma_f32_16x16x32_bf16 v[128:131], v[48:51], v[168:171], v[128:131]
    ds_read_b64_tr_b16 v[44:45], v6 offset:40960
    v_mfma_f32_16x16x32_bf16 v[132:135], v[48:51], v[172:175], v[132:135]
    ds_read_b64_tr_b16 v[46:47], v6 offset:41984
    v_mfma_f32_16x16x32_bf16 v[136:139], v[52:55], v[168:171], v[136:139]
    ds_read_b64_tr_b16 v[48:49], v3 offset:45056
    v_mfma_f32_16x16x32_bf16 v[140:143], v[52:55], v[172:175], v[140:143]
    ds_read_b64_tr_b16 v[50:51], v3 offset:46080
    s_waitcnt lgkmcnt(10)
    v_mfma_f32_16x16x32_bf16 v[144:147], v[56:59], v[168:171], v[144:147]
    ds_read_b64_tr_b16 v[52:53], v4 offset:45056
    v_mfma_f32_16x16x32_bf16 v[148:151], v[56:59], v[172:175], v[148:151]
    ds_read_b64_tr_b16 v[54:55], v4 offset:46080
    v_mfma_f32_16x16x32_bf16 v[152:155], v[60:63], v[168:171], v[152:155]
    ds_read_b64_tr_b16 v[56:57], v5 offset:45056
    v_mfma_f32_16x16x32_bf16 v[156:159], v[60:63], v[172:175], v[156:159]
    ds_read_b64_tr_b16 v[58:59], v5 offset:46080
    s_waitcnt vmcnt(15) lgkmcnt(10)
    v_mfma_f32_16x16x32_bf16 v[64:67], v[32:35], v[176:179], v[64:67]
    ds_read_b64_tr_b16 v[60:61], v6 offset:45056
    v_mfma_f32_16x16x32_bf16 v[68:71], v[32:35], v[180:183], v[68:71]
    ds_read_b64_tr_b16 v[62:63], v6 offset:46080
    v_mfma_f32_16x16x32_bf16 v[72:75], v[36:39], v[176:179], v[72:75]
    ds_read_b64_tr_b16 v[32:33], v3 offset:49152
    v_mfma_f32_16x16x32_bf16 v[76:79], v[36:39], v[180:183], v[76:79]
    ds_read_b64_tr_b16 v[34:35], v3 offset:50176
    s_waitcnt lgkmcnt(10)
    v_mfma_f32_16x16x32_bf16 v[80:83], v[40:43], v[176:179], v[80:83]
    ds_read_b64_tr_b16 v[36:37], v4 offset:49152
    v_mfma_f32_16x16x32_bf16 v[84:87], v[40:43], v[180:183], v[84:87]
    ds_read_b64_tr_b16 v[38:39], v4 offset:50176
    v_mfma_f32_16x16x32_bf16 v[88:91], v[44:47], v[176:179], v[88:91]
    ds_read_b64_tr_b16 v[40:41], v5 offset:49152
    v_mfma_f32_16x16x32_bf16 v[92:95], v[44:47], v[180:183], v[92:95]
    ds_read_b64_tr_b16 v[42:43], v5 offset:50176
    s_waitcnt lgkmcnt(10)
    v_mfma_f32_16x16x32_bf16 v[96:99], v[176:179], v[48:51], v[96:99]
    buffer_load_dwordx4 v[244:247], v2, s[4:7], s42 offen offset:256 sc1
    ds_read_b64_tr_b16 v[44:45], v6 offset:49152
    v_mfma_f32_16x16x32_bf16 v[100:103], v[180:183], v[48:51], v[100:103]
    ds_read_b64_tr_b16 v[46:47], v6 offset:50176
    v_mfma_f32_16x16x32_bf16 v[104:107], v[176:179], v[52:55], v[104:107]
    buffer_load_dwordx4 v[248:251], v2, s[4:7], s42 offen offset:2048 sc1
    ds_read_b64_tr_b16 v[48:49], v3 offset:53248
    v_mfma_f32_16x16x32_bf16 v[108:111], v[180:183], v[52:55], v[108:111]
    ds_read_b64_tr_b16 v[50:51], v3 offset:54272
    s_waitcnt lgkmcnt(10)
    v_mfma_f32_16x16x32_bf16 v[112:115], v[176:179], v[56:59], v[112:115]
    buffer_load_dwordx4 v[252:255], v2, s[4:7], s42 offen offset:2304 sc1
    ds_read_b64_tr_b16 v[52:53], v4 offset:53248
    s_add_u32 s42, s41, s96
    v_mfma_f32_16x16x32_bf16 v[116:119], v[180:183], v[56:59], v[116:119]
    ds_read_b64_tr_b16 v[54:55], v4 offset:54272
    v_mfma_f32_16x16x32_bf16 v[120:123], v[176:179], v[60:63], v[120:123]
    buffer_load_dwordx4 v[160:163], v2, s[4:7], s42 offen offset:0 sc1
    ds_read_b64_tr_b16 v[56:57], v5 offset:53248
    v_mfma_f32_16x16x32_bf16 v[124:127], v[180:183], v[60:63], v[124:127]
    ds_read_b64_tr_b16 v[58:59], v5 offset:54272
    s_waitcnt lgkmcnt(10)
    v_mfma_f32_16x16x32_bf16 v[128:131], v[32:35], v[176:179], v[128:131]
    ds_read_b64_tr_b16 v[60:61], v6 offset:53248
    buffer_load_dwordx4 v[164:167], v2, s[4:7], s42 offen offset:256 sc1
    v_mfma_f32_16x16x32_bf16 v[132:135], v[32:35], v[180:183], v[132:135]
    ds_read_b64_tr_b16 v[62:63], v6 offset:54272
    v_mfma_f32_16x16x32_bf16 v[136:139], v[36:39], v[176:179], v[136:139]
    buffer_load_dwordx4 v[168:171], v2, s[4:7], s42 offen offset:2048 sc1
    ds_read_b64_tr_b16 v[32:33], v3 offset:57344
    v_mfma_f32_16x16x32_bf16 v[140:143], v[36:39], v[180:183], v[140:143]
    ds_read_b64_tr_b16 v[34:35], v3 offset:58368
    s_waitcnt lgkmcnt(10)
    v_mfma_f32_16x16x32_bf16 v[144:147], v[40:43], v[176:179], v[144:147]
    ds_read_b64_tr_b16 v[36:37], v4 offset:57344
    v_mfma_f32_16x16x32_bf16 v[148:151], v[40:43], v[180:183], v[148:151]
    ds_read_b64_tr_b16 v[38:39], v4 offset:58368
    v_mfma_f32_16x16x32_bf16 v[152:155], v[44:47], v[176:179], v[152:155]
    ds_read_b64_tr_b16 v[40:41], v5 offset:57344
    v_mfma_f32_16x16x32_bf16 v[156:159], v[44:47], v[180:183], v[156:159]
    ds_read_b64_tr_b16 v[42:43], v5 offset:58368
    s_waitcnt vmcnt(19) lgkmcnt(10)
    v_mfma_f32_16x16x32_bf16 v[64:67], v[48:51], v[184:187], v[64:67]
    ds_read_b64_tr_b16 v[44:45], v6 offset:57344
    v_mfma_f32_16x16x32_bf16 v[68:71], v[48:51], v[188:191], v[68:71]
    ds_read_b64_tr_b16 v[46:47], v6 offset:58368
    v_mfma_f32_16x16x32_bf16 v[72:75], v[52:55], v[184:187], v[72:75]
    ds_read_b64_tr_b16 v[48:49], v3 offset:61440
    v_mfma_f32_16x16x32_bf16 v[76:79], v[52:55], v[188:191], v[76:79]
    ds_read_b64_tr_b16 v[50:51], v3 offset:62464
    s_waitcnt lgkmcnt(10)
    v_mfma_f32_16x16x32_bf16 v[80:83], v[56:59], v[184:187], v[80:83]
    buffer_load_dwordx4 v[172:175], v2, s[4:7], s42 offen offset:2304 sc1
    ds_read_b64_tr_b16 v[52:53], v4 offset:61440
    s_add_u32 s42, s41, s97
    v_mfma_f32_16x16x32_bf16 v[84:87], v[56:59], v[188:191], v[84:87]
    ds_read_b64_tr_b16 v[54:55], v4 offset:62464
    v_mfma_f32_16x16x32_bf16 v[88:91], v[60:63], v[184:187], v[88:91]
    ds_read_b64_tr_b16 v[56:57], v5 offset:61440
    v_mfma_f32_16x16x32_bf16 v[92:95], v[60:63], v[188:191], v[92:95]
    ds_read_b64_tr_b16 v[58:59], v5 offset:62464
    s_waitcnt lgkmcnt(10)
    v_mfma_f32_16x16x32_bf16 v[96:99], v[184:187], v[32:35], v[96:99]
    ds_read_b64_tr_b16 v[60:61], v6 offset:61440
    v_mfma_f32_16x16x32_bf16 v[100:103], v[188:191], v[32:35], v[100:103]
    ds_read_b64_tr_b16 v[62:63], v6 offset:62464
    s_barrier
    v_xor_b32 v3, 0x10000, v3
    v_xor_b32 v4, 0x10000, v4
    v_xor_b32 v5, 0x10000, v5
    v_xor_b32 v6, 0x10000, v6
    v_mfma_f32_16x16x32_bf16 v[104:107], v[184:187], v[36:39], v[104:107]
    ds_read_b64_tr_b16 v[32:33], v3 offset:0
    v_mfma_f32_16x16x32_bf16 v[108:111], v[188:191], v[36:39], v[108:111]
    ds_read_b64_tr_b16 v[34:35], v3 offset:1024
    s_waitcnt lgkmcnt(10)
    v_mfma_f32_16x16x32_bf16 v[112:115], v[184:187], v[40:43], v[112:115]
    ds_read_b64_tr_b16 v[36:37], v4 offset:0
    v_mfma_f32_16x16x32_bf16 v[116:119], v[188:191], v[40:43], v[116:119]
    ds_read_b64_tr_b16 v[38:39], v4 offset:1024
    v_mfma_f32_16x16x32_bf16 v[120:123], v[184:187], v[44:47], v[120:123]
    ds_read_b64_tr_b16 v[40:41], v5 offset:0
    v_mfma_f32_16x16x32_bf16 v[124:127], v[188:191], v[44:47], v[124:127]
    ds_read_b64_tr_b16 v[42:43], v5 offset:1024
    s_waitcnt lgkmcnt(10)
    v_mfma_f32_16x16x32_bf16 v[128:131], v[48:51], v[184:187], v[128:131]
    ds_read_b64_tr_b16 v[44:45], v6 offset:0
    v_mfma_f32_16x16x32_bf16 v[132:135], v[48:51], v[188:191], v[132:135]
    ds_read_b64_tr_b16 v[46:47], v6 offset:1024
    v_mfma_f32_16x16x32_bf16 v[136:139], v[52:55], v[184:187], v[136:139]
    ds_read_b64_tr_b16 v[48:49], v3 offset:4096
    v_mfma_f32_16x16x32_bf16 v[140:143], v[52:55], v[188:191], v[140:143]
    ds_read_b64_tr_b16 v[50:51], v3 offset:5120
    s_waitcnt lgkmcnt(10)
    v_mfma_f32_16x16x32_bf16 v[144:147], v[56:59], v[184:187], v[144:147]
    ds_read_b64_tr_b16 v[52:53], v4 offset:4096
    v_mfma_f32_16x16x32_bf16 v[148:151], v[56:59], v[188:191], v[148:151]
    ds_read_b64_tr_b16 v[54:55], v4 offset:5120
    v_mfma_f32_16x16x32_bf16 v[152:155], v[60:63], v[184:187], v[152:155]
    ds_read_b64_tr_b16 v[56:57], v5 offset:4096
    v_mfma_f32_16x16x32_bf16 v[156:159], v[60:63], v[188:191], v[156:159]
    ds_read_b64_tr_b16 v[58:59], v5 offset:5120
    s_waitcnt vmcnt(18) lgkmcnt(10)
    v_mfma_f32_16x16x32_bf16 v[64:67], v[32:35], v[192:195], v[64:67]
    ds_read_b64_tr_b16 v[60:61], v6 offset:4096
    v_mfma_f32_16x16x32_bf16 v[68:71], v[32:35], v[196:199], v[68:71]
    ds_read_b64_tr_b16 v[62:63], v6 offset:5120
    v_mfma_f32_16x16x32_bf16 v[72:75], v[36:39], v[192:195], v[72:75]
    ds_read_b64_tr_b16 v[32:33], v3 offset:8192
    v_mfma_f32_16x16x32_bf16 v[76:79], v[36:39], v[196:199], v[76:79]
    ds_read_b64_tr_b16 v[34:35], v3 offset:9216
    s_waitcnt lgkmcnt(10)
    v_mfma_f32_16x16x32_bf16 v[80:83], v[40:43], v[192:195], v[80:83]
    ds_read_b64_tr_b16 v[36:37], v4 offset:8192
    v_mfma_f32_16x16x32_bf16 v[84:87], v[40:43], v[196:199], v[84:87]
    ds_read_b64_tr_b16 v[38:39], v4 offset:9216
    v_mfma_f32_16x16x32_bf16 v[88:91], v[44:47], v[192:195], v[88:91]
    ds_read_b64_tr_b16 v[40:41], v5 offset:8192
    v_mfma_f32_16x16x32_bf16 v[92:95], v[44:47], v[196:199], v[92:95]
    ds_read_b64_tr_b16 v[42:43], v5 offset:9216
    s_waitcnt lgkmcnt(10)
    v_mfma_f32_16x16x32_bf16 v[96:99], v[192:195], v[48:51], v[96:99]
    ds_read_b64_tr_b16 v[44:45], v6 offset:8192
    v_mfma_f32_16x16x32_bf16 v[100:103], v[196:199], v[48:51], v[100:103]
    ds_read_b64_tr_b16 v[46:47], v6 offset:9216
    v_mfma_f32_16x16x32_bf16 v[104:107], v[192:195], v[52:55], v[104:107]
    ds_read_b64_tr_b16 v[48:49], v3 offset:12288
    v_mfma_f32_16x16x32_bf16 v[108:111], v[196:199], v[52:55], v[108:111]
    ds_read_b64_tr_b16 v[50:51], v3 offset:13312
    s_waitcnt lgkmcnt(10)
    v_mfma_f32_16x16x32_bf16 v[112:115], v[192:195], v[56:59], v[112:115]
    ds_read_b64_tr_b16 v[52:53], v4 offset:12288
    v_mfma_f32_16x16x32_bf16 v[116:119], v[196:199], v[56:59], v[116:119]
    ds_read_b64_tr_b16 v[54:55], v4 offset:13312
    v_mfma_f32_16x16x32_bf16 v[120:123], v[192:195], v[60:63], v[120:123]
    ds_read_b64_tr_b16 v[56:57], v5 offset:12288
    v_mfma_f32_16x16x32_bf16 v[124:127], v[196:199], v[60:63], v[124:127]
    ds_read_b64_tr_b16 v[58:59], v5 offset:13312
    s_waitcnt lgkmcnt(10)
    v_mfma_f32_16x16x32_bf16 v[128:131], v[32:35], v[192:195], v[128:131]
    ds_read_b64_tr_b16 v[60:61], v6 offset:12288
    v_mfma_f32_16x16x32_bf16 v[132:135], v[32:35], v[196:199], v[132:135]
    ds_read_b64_tr_b16 v[62:63], v6 offset:13312
    v_mfma_f32_16x16x32_bf16 v[136:139], v[36:39], v[192:195], v[136:139]
    ds_read_b64_tr_b16 v[32:33], v3 offset:16384
    v_mfma_f32_16x16x32_bf16 v[140:143], v[36:39], v[196:199], v[140:143]
    ds_read_b64_tr_b16 v[34:35], v3 offset:17408
    s_waitcnt lgkmcnt(10)
    v_mfma_f32_16x16x32_bf16 v[144:147], v[40:43], v[192:195], v[144:147]
    ds_read_b64_tr_b16 v[36:37], v4 offset:16384
    v_mfma_f32_16x16x32_bf16 v[148:151], v[40:43], v[196:199], v[148:151]
    ds_read_b64_tr_b16 v[38:39], v4 offset:17408
    v_mfma_f32_16x16x32_bf16 v[152:155], v[44:47], v[192:195], v[152:155]
    ds_read_b64_tr_b16 v[40:41], v5 offset:16384
    v_mfma_f32_16x16x32_bf16 v[156:159], v[44:47], v[196:199], v[156:159]
    ds_read_b64_tr_b16 v[42:43], v5 offset:17408
    s_waitcnt vmcnt(16) lgkmcnt(10)
    v_mfma_f32_16x16x32_bf16 v[64:67], v[48:51], v[200:203], v[64:67]
    buffer_load_dwordx4 v[176:179], v2, s[4:7], s42 offen offset:0 sc1
    ds_read_b64_tr_b16 v[44:45], v6 offset:16384
    v_mfma_f32_16x16x32_bf16 v[68:71], v[48:51], v[204:207], v[68:71]
    ds_read_b64_tr_b16 v[46:47], v6 offset:17408
    v_mfma_f32_16x16x32_bf16 v[72:75], v[52:55], v[200:203], v[72:75]
    buffer_load_dwordx4 v[180:183], v2, s[4:7], s42 offen offset:256 sc1
    ds_read_b64_tr_b16 v[48:49], v3 offset:20480
    v_mfma_f32_16x16x32_bf16 v[76:79], v[52:55], v[204:207], v[76:79]
    ds_read_b64_tr_b16 v[50:51], v3 offset:21504
    s_waitcnt lgkmcnt(10)
    v_mfma_f32_16x16x32_bf16 v[80:83], v[56:59], v[200:203], v[80:83]
    buffer_load_dwordx4 v[184:187], v2, s[4:7], s42 offen offset:2048 sc1
    ds_read_b64_tr_b16 v[52:53], v4 offset:20480
    v_mfma_f32_16x16x32_bf16 v[84:87], v[56:59], v[204:207], v[84:87]
    ds_read_b64_tr_b16 v[54:55], v4 offset:21504
    v_mfma_f32_16x16x32_bf16 v[88:91], v[60:63], v[200:203], v[88:91]
    buffer_load_dwordx4 v[188:191], v2, s[4:7], s42 offen offset:2304 sc1
    ds_read_b64_tr_b16 v[56:57], v5 offset:20480
    s_add_u32 s42, s41, s98
    v_mfma_f32_16x16x32_bf16 v[92:95], v[60:63], v[204:207], v[92:95]
    ds_read_b64_tr_b16 v[58:59], v5 offset:21504
    s_waitcnt lgkmcnt(10)
    v_mfma_f32_16x16x32_bf16 v[96:99], v[200:203], v[32:35], v[96:99]
    ds_read_b64_tr_b16 v[60:61], v6 offset:20480
    buffer_load_dwordx4 v[192:195], v2, s[4:7], s42 offen offset:0 sc1
    v_mfma_f32_16x16x32_bf16 v[100:103], v[204:207], v[32:35], v[100:103]
    ds_read_b64_tr_b16 v[62:63], v6 offset:21504
    v_mfma_f32_16x16x32_bf16 v[104:107], v[200:203], v[36:39], v[104:107]
    ds_read_b64_tr_b16 v[32:33], v3 offset:24576
    v_mfma_f32_16x16x32_bf16 v[108:111], v[204:207], v[36:39], v[108:111]
    ds_read_b64_tr_b16 v[34:35], v3 offset:25600
    s_waitcnt lgkmcnt(10)
    v_mfma_f32_16x16x32_bf16 v[112:115], v[200:203], v[40:43], v[112:115]
    ds_read_b64_tr_b16 v[36:37], v4 offset:24576
    v_mfma_f32_16x16x32_bf16 v[116:119], v[204:207], v[40:43], v[116:119]
    ds_read_b64_tr_b16 v[38:39], v4 offset:25600
    v_mfma_f32_16x16x32_bf16 v[120:123], v[200:203], v[44:47], v[120:123]
    buffer_load_dwordx4 v[196:199], v2, s[4:7], s42 offen offset:256 sc1
    ds_read_b64_tr_b16 v[40:41], v5 offset:24576
    v_mfma_f32_16x16x32_bf16 v[124:127], v[204:207], v[44:47], v[124:127]
    ds_read_b64_tr_b16 v[42:43], v5 offset:25600
    s_waitcnt lgkmcnt(10)
    v_mfma_f32_16x16x32_bf16 v[128:131], v[48:51], v[200:203], v[128:131]
    ds_read_b64_tr_b16 v[44:45], v6 offset:24576
    v_mfma_f32_16x16x32_bf16 v[132:135], v[48:51], v[204:207], v[132:135]
    ds_read_b64_tr_b16 v[46:47], v6 offset:25600
    v_mfma_f32_16x16x32_bf16 v[136:139], v[52:55], v[200:203], v[136:139]
    ds_read_b64_tr_b16 v[48:49], v3 offset:28672
    v_mfma_f32_16x16x32_bf16 v[140:143], v[52:55], v[204:207], v[140:143]
    ds_read_b64_tr_b16 v[50:51], v3 offset:29696
    s_waitcnt lgkmcnt(10)
    v_mfma_f32_16x16x32_bf16 v[144:147], v[56:59], v[200:203], v[144:147]
    ds_read_b64_tr_b16 v[52:53], v4 offset:28672
    v_mfma_f32_16x16x32_bf16 v[148:151], v[56:59], v[204:207], v[148:151]
    ds_read_b64_tr_b16 v[54:55], v4 offset:29696
    v_mfma_f32_16x16x32_bf16 v[152:155], v[60:63], v[200:203], v[152:155]
    ds_read_b64_tr_b16 v[56:57], v5 offset:28672
    v_mfma_f32_16x16x32_bf16 v[156:159], v[60:63], v[204:207], v[156:159]
    ds_read_b64_tr_b16 v[58:59], v5 offset:29696
    s_waitcnt vmcnt(20) lgkmcnt(10)
    v_mfma_f32_16x16x32_bf16 v[64:67], v[32:35], v[208:211], v[64:67]
    ds_read_b64_tr_b16 v[60:61], v6 offset:28672
    v_mfma_f32_16x16x32_bf16 v[68:71], v[32:35], v[212:215], v[68:71]
    ds_read_b64_tr_b16 v[62:63], v6 offset:29696
    s_barrier
    v_mfma_f32_16x16x32_bf16 v[72:75], v[36:39], v[208:211], v[72:75]
    ds_read_b64_tr_b16 v[32:33], v3 offset:32768
    v_mfma_f32_16x16x32_bf16 v[76:79], v[36:39], v[212:215], v[76:79]
    ds_read_b64_tr_b16 v[34:35], v3 offset:33792
    s_waitcnt lgkmcnt(10)
    v_mfma_f32_16x16x32_bf16 v[80:83], v[40:43], v[208:211], v[80:83]
    ds_read_b64_tr_b16 v[36:37], v4 offset:32768
    v_mfma_f32_16x16x32_bf16 v[84:87], v[40:43], v[212:215], v[84:87]
    ds_read_b64_tr_b16 v[38:39], v4 offset:33792
    v_mfma_f32_16x16x32_bf16 v[88:91], v[44:47], v[208:211], v[88:91]
    ds_read_b64_tr_b16 v[40:41], v5 offset:32768
    v_mfma_f32_16x16x32_bf16 v[92:95], v[44:47], v[212:215], v[92:95]
    ds_read_b64_tr_b16 v[42:43], v5 offset:33792
    s_waitcnt lgkmcnt(10)
    v_mfma_f32_16x16x32_bf16 v[96:99], v[208:211], v[48:51], v[96:99]
    ds_read_b64_tr_b16 v[44:45], v6 offset:32768
    v_mfma_f32_16x16x32_bf16 v[100:103], v[212:215], v[48:51], v[100:103]
    ds_read_b64_tr_b16 v[46:47], v6 offset:33792
    v_mfma_f32_16x16x32_bf16 v[104:107], v[208:211], v[52:55], v[104:107]
    ds_read_b64_tr_b16 v[48:49], v3 offset:36864
    v_mfma_f32_16x16x32_bf16 v[108:111], v[212:215], v[52:55], v[108:111]
    ds_read_b64_tr_b16 v[50:51], v3 offset:37888
    s_waitcnt lgkmcnt(10)
    v_mfma_f32_16x16x32_bf16 v[112:115], v[208:211], v[56:59], v[112:115]
    ds_read_b64_tr_b16 v[52:53], v4 offset:36864
    v_mfma_f32_16x16x32_bf16 v[116:119], v[212:215], v[56:59], v[116:119]
    ds_read_b64_tr_b16 v[54:55], v4 offset:37888
    v_mfma_f32_16x16x32_bf16 v[120:123], v[208:211], v[60:63], v[120:123]
    ds_read_b64_tr_b16 v[56:57], v5 offset:36864
    v_mfma_f32_16x16x32_bf16 v[124:127], v[212:215], v[60:63], v[124:127]
    ds_read_b64_tr_b16 v[58:59], v5 offset:37888
    s_waitcnt lgkmcnt(10)
    v_mfma_f32_16x16x32_bf16 v[128:131], v[32:35], v[208:211], v[128:131]
    ds_read_b64_tr_b16 v[60:61], v6 offset:36864
    v_mfma_f32_16x16x32_bf16 v[132:135], v[32:35], v[212:215], v[132:135]
    ds_read_b64_tr_b16 v[62:63], v6 offset:37888
    v_mfma_f32_16x16x32_bf16 v[136:139], v[36:39], v[208:211], v[136:139]
    ds_read_b64_tr_b16 v[32:33], v3 offset:40960
    v_mfma_f32_16x16x32_bf16 v[140:143], v[36:39], v[212:215], v[140:143]
    ds_read_b64_tr_b16 v[34:35], v3 offset:41984
    s_waitcnt lgkmcnt(10)
    v_mfma_f32_16x16x32_bf16 v[144:147], v[40:43], v[208:211], v[144:147]
    ds_read_b64_tr_b16 v[36:37], v4 offset:40960
    v_mfma_f32_16x16x32_bf16 v[148:151], v[40:43], v[212:215], v[148:151]
    ds_read_b64_tr_b16 v[38:39], v4 offset:41984
    v_mfma_f32_16x16x32_bf16 v[152:155], v[44:47], v[208:211], v[152:155]
    ds_read_b64_tr_b16 v[40:41], v5 offset:40960
    v_mfma_f32_16x16x32_bf16 v[156:159], v[44:47], v[212:215], v[156:159]
    ds_read_b64_tr_b16 v[42:43], v5 offset:41984
    s_waitcnt vmcnt(18) lgkmcnt(10)
    v_mfma_f32_16x16x32_bf16 v[64:67], v[48:51], v[216:219], v[64:67]
    ds_read_b64_tr_b16 v[44:45], v6 offset:40960
    v_mfma_f32_16x16x32_bf16 v[68:71], v[48:51], v[220:223], v[68:71]
    ds_read_b64_tr_b16 v[46:47], v6 offset:41984
    v_mfma_f32_16x16x32_bf16 v[72:75], v[52:55], v[216:219], v[72:75]
    ds_read_b64_tr_b16 v[48:49], v3 offset:45056
    v_mfma_f32_16x16x32_bf16 v[76:79], v[52:55], v[220:223], v[76:79]
    ds_read_b64_tr_b16 v[50:51], v3 offset:46080
    s_waitcnt lgkmcnt(10)
    v_mfma_f32_16x16x32_bf16 v[80:83], v[56:59], v[216:219], v[80:83]
    ds_read_b64_tr_b16 v[52:53], v4 offset:45056
    v_mfma_f32_16x16x32_bf16 v[84:87], v[56:59], v[220:223], v[84:87]
    ds_read_b64_tr_b16 v[54:55], v4 offset:46080
    v_mfma_f32_16x16x32_bf16 v[88:91], v[60:63], v[216:219], v[88:91]
    ds_read_b64_tr_b16 v[56:57], v5 offset:45056
    v_mfma_f32_16x16x32_bf16 v[92:95], v[60:63], v[220:223], v[92:95]
    ds_read_b64_tr_b16 v[58:59], v5 offset:46080
    s_waitcnt lgkmcnt(10)
    v_mfma_f32_16x16x32_bf16 v[96:99], v[216:219], v[32:35], v[96:99]
    ds_read_b64_tr_b16 v[60:61], v6 offset:45056
    v_mfma_f32_16x16x32_bf16 v[100:103], v[220:223], v[32:35], v[100:103]
    ds_read_b64_tr_b16 v[62:63], v6 offset:46080
    v_mfma_f32_16x16x32_bf16 v[104:107], v[216:219], v[36:39], v[104:107]
    ds_read_b64_tr_b16 v[32:33], v3 offset:49152
    v_mfma_f32_16x16x32_bf16 v[108:111], v[220:223], v[36:39], v[108:111]
    ds_read_b64_tr_b16 v[34:35], v3 offset:50176
    s_waitcnt lgkmcnt(10)
    v_mfma_f32_16x16x32_bf16 v[112:115], v[216:219], v[40:43], v[112:115]
    ds_read_b64_tr_b16 v[36:37], v4 offset:49152
    v_mfma_f32_16x16x32_bf16 v[116:119], v[220:223], v[40:43], v[116:119]
    ds_read_b64_tr_b16 v[38:39], v4 offset:50176
    v_mfma_f32_16x16x32_bf16 v[120:123], v[216:219], v[44:47], v[120:123]
    ds_read_b64_tr_b16 v[40:41], v5 offset:49152
    v_mfma_f32_16x16x32_bf16 v[124:127], v[220:223], v[44:47], v[124:127]
    ds_read_b64_tr_b16 v[42:43], v5 offset:50176
    s_waitcnt lgkmcnt(10)
    v_mfma_f32_16x16x32_bf16 v[128:131], v[48:51], v[216:219], v[128:131]
    buffer_load_dwordx4 v[200:203], v2, s[4:7], s42 offen offset:2048 sc1
    ds_read_b64_tr_b16 v[44:45], v6 offset:49152
    v_mfma_f32_16x16x32_bf16 v[132:135], v[48:51], v[220:223], v[132:135]
    ds_read_b64_tr_b16 v[46:47], v6 offset:50176
    v_mfma_f32_16x16x32_bf16 v[136:139], v[52:55], v[216:219], v[136:139]
    buffer_load_dwordx4 v[204:207], v2, s[4:7], s42 offen offset:2304 sc1
    ds_read_b64_tr_b16 v[48:49], v3 offset:53248
    s_add_u32 s42, s41, s99
    v_mfma_f32_16x16x32_bf16 v[140:143], v[52:55], v[220:223], v[140:143]
    ds_read_b64_tr_b16 v[50:51], v3 offset:54272
    s_waitcnt lgkmcnt(10)
    v_mfma_f32_16x16x32_bf16 v[144:147], v[56:59], v[216:219], v[144:147]
    buffer_load_dwordx4 v[208:211], v2, s[4:7], s42 offen offset:0 sc1
    ds_read_b64_tr_b16 v[52:53], v4 offset:53248
    v_mfma_f32_16x16x32_bf16 v[148:151], v[56:59], v[220:223], v[148:151]
    ds_read_b64_tr_b16 v[54:55], v4 offset:54272
    v_mfma_f32_16x16x32_bf16 v[152:155], v[60:63], v[216:219], v[152:155]
    buffer_load_dwordx4 v[212:215], v2, s[4:7], s42 offen offset:256 sc1
    ds_read_b64_tr_b16 v[56:57], v5 offset:53248
    v_mfma_f32_16x16x32_bf16 v[156:159], v[60:63], v[220:223], v[156:159]
    ds_read_b64_tr_b16 v[58:59], v5 offset:54272
    s_waitcnt vmcnt(20) lgkmcnt(10)
    v_mfma_f32_16x16x32_bf16 v[64:67], v[32:35], v[224:227], v[64:67]
    ds_read_b64_tr_b16 v[60:61], v6 offset:53248
    buffer_load_dwordx4 v[216:219], v2, s[4:7], s42 offen offset:2048 sc1
    v_mfma_f32_16x16x32_bf16 v[68:71], v[32:35], v[228:231], v[68:71]
    ds_read_b64_tr_b16 v[62:63], v6 offset:54272
    v_mfma_f32_16x16x32_bf16 v[72:75], v[36:39], v[224:227], v[72:75]
    buffer_load_dwordx4 v[220:223], v2, s[4:7], s42 offen offset:2304 sc1
    ds_read_b64_tr_b16 v[32:33], v3 offset:57344
    v_mfma_f32_16x16x32_bf16 v[76:79], v[36:39], v[228:231], v[76:79]
    ds_read_b64_tr_b16 v[34:35], v3 offset:58368
    s_waitcnt lgkmcnt(10)
    v_mfma_f32_16x16x32_bf16 v[80:83], v[40:43], v[224:227], v[80:83]
    ds_read_b64_tr_b16 v[36:37], v4 offset:57344
    v_mfma_f32_16x16x32_bf16 v[84:87], v[40:43], v[228:231], v[84:87]
    ds_read_b64_tr_b16 v[38:39], v4 offset:58368
    v_mfma_f32_16x16x32_bf16 v[88:91], v[44:47], v[224:227], v[88:91]
    ds_read_b64_tr_b16 v[40:41], v5 offset:57344
    v_mfma_f32_16x16x32_bf16 v[92:95], v[44:47], v[228:231], v[92:95]
    ds_read_b64_tr_b16 v[42:43], v5 offset:58368
    s_waitcnt lgkmcnt(10)
    v_mfma_f32_16x16x32_bf16 v[96:99], v[224:227], v[48:51], v[96:99]
    ds_read_b64_tr_b16 v[44:45], v6 offset:57344
    v_mfma_f32_16x16x32_bf16 v[100:103], v[228:231], v[48:51], v[100:103]
    ds_read_b64_tr_b16 v[46:47], v6 offset:58368
    v_mfma_f32_16x16x32_bf16 v[104:107], v[224:227], v[52:55], v[104:107]
    ds_read_b64_tr_b16 v[48:49], v3 offset:61440
    v_mfma_f32_16x16x32_bf16 v[108:111], v[228:231], v[52:55], v[108:111]
    ds_read_b64_tr_b16 v[50:51], v3 offset:62464
    s_waitcnt lgkmcnt(10)
    v_mfma_f32_16x16x32_bf16 v[112:115], v[224:227], v[56:59], v[112:115]
    ds_read_b64_tr_b16 v[52:53], v4 offset:61440
    v_mfma_f32_16x16x32_bf16 v[116:119], v[228:231], v[56:59], v[116:119]
    ds_read_b64_tr_b16 v[54:55], v4 offset:62464
    v_mfma_f32_16x16x32_bf16 v[120:123], v[224:227], v[60:63], v[120:123]
    ds_read_b64_tr_b16 v[56:57], v5 offset:61440
    v_mfma_f32_16x16x32_bf16 v[124:127], v[228:231], v[60:63], v[124:127]
    ds_read_b64_tr_b16 v[58:59], v5 offset:62464
    s_waitcnt vmcnt(20) lgkmcnt(10)
    v_mfma_f32_16x16x32_bf16 v[64:67], v[32:35], v[232:235], v[64:67]
    ds_read_b64_tr_b16 v[60:61], v6 offset:61440
    v_mfma_f32_16x16x32_bf16 v[68:71], v[32:35], v[236:239], v[68:71]
    ds_read_b64_tr_b16 v[62:63], v6 offset:62464
    s_barrier
    v_xor_b32 v3, 0x10000, v3
    v_xor_b32 v4, 0x10000, v4
    v_xor_b32 v5, 0x10000, v5
    v_xor_b32 v6, 0x10000, v6
    v_mfma_f32_16x16x32_bf16 v[72:75], v[36:39], v[232:235], v[72:75]
    ds_read_b64_tr_b16 v[32:33], v3 offset:0
    v_mfma_f32_16x16x32_bf16 v[76:79], v[36:39], v[236:239], v[76:79]
    ds_read_b64_tr_b16 v[34:35], v3 offset:1024
    s_waitcnt lgkmcnt(10)
    v_mfma_f32_16x16x32_bf16 v[80:83], v[40:43], v[232:235], v[80:83]
    ds_read_b64_tr_b16 v[36:37], v4 offset:0
    v_mfma_f32_16x16x32_bf16 v[84:87], v[40:43], v[236:239], v[84:87]
    ds_read_b64_tr_b16 v[38:39], v4 offset:1024
    v_mfma_f32_16x16x32_bf16 v[88:91], v[44:47], v[232:235], v[88:91]
    ds_read_b64_tr_b16 v[40:41], v5 offset:0
    v_mfma_f32_16x16x32_bf16 v[92:95], v[44:47], v[236:239], v[92:95]
    ds_read_b64_tr_b16 v[42:43], v5 offset:1024
    s_waitcnt lgkmcnt(10)
    v_mfma_f32_16x16x32_bf16 v[96:99], v[232:235], v[48:51], v[96:99]
    ds_read_b64_tr_b16 v[44:45], v6 offset:0
    v_mfma_f32_16x16x32_bf16 v[100:103], v[236:239], v[48:51], v[100:103]
    ds_read_b64_tr_b16 v[46:47], v6 offset:1024
    v_mfma_f32_16x16x32_bf16 v[104:107], v[232:235], v[52:55], v[104:107]
    ds_read_b64_tr_b16 v[48:49], v3 offset:4096
    v_mfma_f32_16x16x32_bf16 v[108:111], v[236:239], v[52:55], v[108:111]
    ds_read_b64_tr_b16 v[50:51], v3 offset:5120
    s_waitcnt lgkmcnt(10)
    v_mfma_f32_16x16x32_bf16 v[112:115], v[232:235], v[56:59], v[112:115]
    ds_read_b64_tr_b16 v[52:53], v4 offset:4096
    v_mfma_f32_16x16x32_bf16 v[116:119], v[236:239], v[56:59], v[116:119]
    ds_read_b64_tr_b16 v[54:55], v4 offset:5120
    v_mfma_f32_16x16x32_bf16 v[120:123], v[232:235], v[60:63], v[120:123]
    ds_read_b64_tr_b16 v[56:57], v5 offset:4096
    v_mfma_f32_16x16x32_bf16 v[124:127], v[236:239], v[60:63], v[124:127]
    ds_read_b64_tr_b16 v[58:59], v5 offset:5120
    s_waitcnt vmcnt(18) lgkmcnt(10)
    v_mfma_f32_16x16x32_bf16 v[64:67], v[32:35], v[240:243], v[64:67]
    ds_read_b64_tr_b16 v[60:61], v6 offset:4096
    v_mfma_f32_16x16x32_bf16 v[68:71], v[32:35], v[244:247], v[68:71]
    ds_read_b64_tr_b16 v[62:63], v6 offset:5120
    v_mfma_f32_16x16x32_bf16 v[72:75], v[36:39], v[240:243], v[72:75]
    ds_read_b64_tr_b16 v[32:33], v3 offset:8192
    v_mfma_f32_16x16x32_bf16 v[76:79], v[36:39], v[244:247], v[76:79]
    ds_read_b64_tr_b16 v[34:35], v3 offset:9216
    s_waitcnt lgkmcnt(10)
    v_mfma_f32_16x16x32_bf16 v[80:83], v[40:43], v[240:243], v[80:83]
    ds_read_b64_tr_b16 v[36:37], v4 offset:8192
    v_mfma_f32_16x16x32_bf16 v[84:87], v[40:43], v[244:247], v[84:87]
    ds_read_b64_tr_b16 v[38:39], v4 offset:9216
    v_mfma_f32_16x16x32_bf16 v[88:91], v[44:47], v[240:243], v[88:91]
    ds_read_b64_tr_b16 v[40:41], v5 offset:8192
    v_mfma_f32_16x16x32_bf16 v[92:95], v[44:47], v[244:247], v[92:95]
    ds_read_b64_tr_b16 v[42:43], v5 offset:9216
    s_waitcnt lgkmcnt(10)
    v_mfma_f32_16x16x32_bf16 v[96:99], v[240:243], v[48:51], v[96:99]
    ds_read_b64_tr_b16 v[44:45], v6 offset:8192
    v_mfma_f32_16x16x32_bf16 v[100:103], v[244:247], v[48:51], v[100:103]
    ds_read_b64_tr_b16 v[46:47], v6 offset:9216
    v_mfma_f32_16x16x32_bf16 v[104:107], v[240:243], v[52:55], v[104:107]
    ds_read_b64_tr_b16 v[48:49], v3 offset:12288
    v_mfma_f32_16x16x32_bf16 v[108:111], v[244:247], v[52:55], v[108:111]
    ds_read_b64_tr_b16 v[50:51], v3 offset:13312
    s_waitcnt lgkmcnt(10)
    v_mfma_f32_16x16x32_bf16 v[112:115], v[240:243], v[56:59], v[112:115]
    ds_read_b64_tr_b16 v[52:53], v4 offset:12288
    v_mfma_f32_16x16x32_bf16 v[116:119], v[244:247], v[56:59], v[116:119]
    ds_read_b64_tr_b16 v[54:55], v4 offset:13312
    v_mfma_f32_16x16x32_bf16 v[120:123], v[240:243], v[60:63], v[120:123]
    ds_read_b64_tr_b16 v[56:57], v5 offset:12288
    v_mfma_f32_16x16x32_bf16 v[124:127], v[244:247], v[60:63], v[124:127]
    ds_read_b64_tr_b16 v[58:59], v5 offset:13312
    s_waitcnt vmcnt(16) lgkmcnt(10)
    v_mfma_f32_16x16x32_bf16 v[64:67], v[32:35], v[248:251], v[64:67]
    ds_read_b64_tr_b16 v[60:61], v6 offset:12288
    v_mfma_f32_16x16x32_bf16 v[68:71], v[32:35], v[252:255], v[68:71]
    ds_read_b64_tr_b16 v[62:63], v6 offset:13312
    v_mfma_f32_16x16x32_bf16 v[72:75], v[36:39], v[248:251], v[72:75]
    ds_read_b64_tr_b16 v[32:33], v3 offset:16384
    v_mfma_f32_16x16x32_bf16 v[76:79], v[36:39], v[252:255], v[76:79]
    ds_read_b64_tr_b16 v[34:35], v3 offset:17408
    s_waitcnt lgkmcnt(10)
    v_mfma_f32_16x16x32_bf16 v[80:83], v[40:43], v[248:251], v[80:83]
    ds_read_b64_tr_b16 v[36:37], v4 offset:16384
    v_mfma_f32_16x16x32_bf16 v[84:87], v[40:43], v[252:255], v[84:87]
    ds_read_b64_tr_b16 v[38:39], v4 offset:17408
    v_mfma_f32_16x16x32_bf16 v[88:91], v[44:47], v[248:251], v[88:91]
    ds_read_b64_tr_b16 v[40:41], v5 offset:16384
    v_mfma_f32_16x16x32_bf16 v[92:95], v[44:47], v[252:255], v[92:95]
    ds_read_b64_tr_b16 v[42:43], v5 offset:17408
    s_waitcnt lgkmcnt(10)
    v_mfma_f32_16x16x32_bf16 v[96:99], v[248:251], v[48:51], v[96:99]
    ds_read_b64_tr_b16 v[44:45], v6 offset:16384
    v_mfma_f32_16x16x32_bf16 v[100:103], v[252:255], v[48:51], v[100:103]
    ds_read_b64_tr_b16 v[46:47], v6 offset:17408
    v_mfma_f32_16x16x32_bf16 v[104:107], v[248:251], v[52:55], v[104:107]
    ds_read_b64_tr_b16 v[48:49], v3 offset:20480
    v_mfma_f32_16x16x32_bf16 v[108:111], v[252:255], v[52:55], v[108:111]
    ds_read_b64_tr_b16 v[50:51], v3 offset:21504
    s_waitcnt lgkmcnt(10)
    v_mfma_f32_16x16x32_bf16 v[112:115], v[248:251], v[56:59], v[112:115]
    ds_read_b64_tr_b16 v[52:53], v4 offset:20480
    v_mfma_f32_16x16x32_bf16 v[116:119], v[252:255], v[56:59], v[116:119]
    ds_read_b64_tr_b16 v[54:55], v4 offset:21504
    v_mfma_f32_16x16x32_bf16 v[120:123], v[248:251], v[60:63], v[120:123]
    ds_read_b64_tr_b16 v[56:57], v5 offset:20480
    v_mfma_f32_16x16x32_bf16 v[124:127], v[252:255], v[60:63], v[124:127]
    ds_read_b64_tr_b16 v[58:59], v5 offset:21504
    s_waitcnt vmcnt(14) lgkmcnt(10)
    v_mfma_f32_16x16x32_bf16 v[64:67], v[32:35], v[160:163], v[64:67]
    ds_read_b64_tr_b16 v[60:61], v6 offset:20480
    v_mfma_f32_16x16x32_bf16 v[68:71], v[32:35], v[164:167], v[68:71]
    ds_read_b64_tr_b16 v[62:63], v6 offset:21504
    v_mfma_f32_16x16x32_bf16 v[72:75], v[36:39], v[160:163], v[72:75]
    ds_read_b64_tr_b16 v[32:33], v3 offset:24576
    v_mfma_f32_16x16x32_bf16 v[76:79], v[36:39], v[164:167], v[76:79]
    ds_read_b64_tr_b16 v[34:35], v3 offset:25600
    s_waitcnt lgkmcnt(10)
    v_mfma_f32_16x16x32_bf16 v[80:83], v[40:43], v[160:163], v[80:83]
    ds_read_b64_tr_b16 v[36:37], v4 offset:24576
    v_mfma_f32_16x16x32_bf16 v[84:87], v[40:43], v[164:167], v[84:87]
    ds_read_b64_tr_b16 v[38:39], v4 offset:25600
    v_mfma_f32_16x16x32_bf16 v[88:91], v[44:47], v[160:163], v[88:91]
    ds_read_b64_tr_b16 v[40:41], v5 offset:24576
    v_mfma_f32_16x16x32_bf16 v[92:95], v[44:47], v[164:167], v[92:95]
    ds_read_b64_tr_b16 v[42:43], v5 offset:25600
    s_waitcnt vmcnt(12) lgkmcnt(10)
    v_mfma_f32_16x16x32_bf16 v[64:67], v[48:51], v[168:171], v[64:67]
    ds_read_b64_tr_b16 v[44:45], v6 offset:24576
    v_mfma_f32_16x16x32_bf16 v[68:71], v[48:51], v[172:175], v[68:71]
    ds_read_b64_tr_b16 v[46:47], v6 offset:25600
    v_mfma_f32_16x16x32_bf16 v[72:75], v[52:55], v[168:171], v[72:75]
    ds_read_b64_tr_b16 v[48:49], v3 offset:28672
    v_mfma_f32_16x16x32_bf16 v[76:79], v[52:55], v[172:175], v[76:79]
    ds_read_b64_tr_b16 v[50:51], v3 offset:29696
    s_waitcnt lgkmcnt(10)
    v_mfma_f32_16x16x32_bf16 v[80:83], v[56:59], v[168:171], v[80:83]
    ds_read_b64_tr_b16 v[52:53], v4 offset:28672
    v_mfma_f32_16x16x32_bf16 v[84:87], v[56:59], v[172:175], v[84:87]
    ds_read_b64_tr_b16 v[54:55], v4 offset:29696
    v_mfma_f32_16x16x32_bf16 v[88:91], v[60:63], v[168:171], v[88:91]
    ds_read_b64_tr_b16 v[56:57], v5 offset:28672
    v_mfma_f32_16x16x32_bf16 v[92:95], v[60:63], v[172:175], v[92:95]
    ds_read_b64_tr_b16 v[58:59], v5 offset:29696
    s_waitcnt vmcnt(10) lgkmcnt(10)
    v_mfma_f32_16x16x32_bf16 v[64:67], v[32:35], v[176:179], v[64:67]
    ds_read_b64_tr_b16 v[60:61], v6 offset:28672
    v_mfma_f32_16x16x32_bf16 v[68:71], v[32:35], v[180:183], v[68:71]
    ds_read_b64_tr_b16 v[62:63], v6 offset:29696
    s_barrier
    v_mfma_f32_16x16x32_bf16 v[72:75], v[36:39], v[176:179], v[72:75]
    ds_read_b64_tr_b16 v[32:33], v3 offset:32768
    v_mfma_f32_16x16x32_bf16 v[76:79], v[36:39], v[180:183], v[76:79]
    ds_read_b64_tr_b16 v[34:35], v3 offset:33792
    s_waitcnt lgkmcnt(10)
    v_mfma_f32_16x16x32_bf16 v[80:83], v[40:43], v[176:179], v[80:83]
    ds_read_b64_tr_b16 v[36:37], v4 offset:32768
    v_mfma_f32_16x16x32_bf16 v[84:87], v[40:43], v[180:183], v[84:87]
    ds_read_b64_tr_b16 v[38:39], v4 offset:33792
    v_mfma_f32_16x16x32_bf16 v[88:91], v[44:47], v[176:179], v[88:91]
    ds_read_b64_tr_b16 v[40:41], v5 offset:32768
    v_mfma_f32_16x16x32_bf16 v[92:95], v[44:47], v[180:183], v[92:95]
    ds_read_b64_tr_b16 v[42:43], v5 offset:33792
    s_waitcnt vmcnt(8) lgkmcnt(10)
    v_mfma_f32_16x16x32_bf16 v[64:67], v[48:51], v[184:187], v[64:67]
    ds_read_b64_tr_b16 v[44:45], v6 offset:32768
    v_mfma_f32_16x16x32_bf16 v[68:71], v[48:51], v[188:191], v[68:71]
    ds_read_b64_tr_b16 v[46:47], v6 offset:33792
    v_mfma_f32_16x16x32_bf16 v[72:75], v[52:55], v[184:187], v[72:75]
    ds_read_b64_tr_b16 v[48:49], v3 offset:36864
    v_mfma_f32_16x16x32_bf16 v[76:79], v[52:55], v[188:191], v[76:79]
    ds_read_b64_tr_b16 v[50:51], v3 offset:37888
    s_waitcnt lgkmcnt(10)
    v_mfma_f32_16x16x32_bf16 v[80:83], v[56:59], v[184:187], v[80:83]
    ds_read_b64_tr_b16 v[52:53], v4 offset:36864
    v_mfma_f32_16x16x32_bf16 v[84:87], v[56:59], v[188:191], v[84:87]
    ds_read_b64_tr_b16 v[54:55], v4 offset:37888
    v_mfma_f32_16x16x32_bf16 v[88:91], v[60:63], v[184:187], v[88:91]
    ds_read_b64_tr_b16 v[56:57], v5 offset:36864
    v_mfma_f32_16x16x32_bf16 v[92:95], v[60:63], v[188:191], v[92:95]
    ds_read_b64_tr_b16 v[58:59], v5 offset:37888
    s_waitcnt vmcnt(6) lgkmcnt(10)
    v_mfma_f32_16x16x32_bf16 v[64:67], v[32:35], v[192:195], v[64:67]
    ds_read_b64_tr_b16 v[60:61], v6 offset:36864
    v_mfma_f32_16x16x32_bf16 v[68:71], v[32:35], v[196:199], v[68:71]
    ds_read_b64_tr_b16 v[62:63], v6 offset:37888
    v_mfma_f32_16x16x32_bf16 v[72:75], v[36:39], v[192:195], v[72:75]
    ds_read_b64_tr_b16 v[32:33], v3 offset:40960
    v_mfma_f32_16x16x32_bf16 v[76:79], v[36:39], v[196:199], v[76:79]
    ds_read_b64_tr_b16 v[34:35], v3 offset:41984
    s_waitcnt lgkmcnt(10)
    v_mfma_f32_16x16x32_bf16 v[80:83], v[40:43], v[192:195], v[80:83]
    ds_read_b64_tr_b16 v[36:37], v4 offset:40960
    v_mfma_f32_16x16x32_bf16 v[84:87], v[40:43], v[196:199], v[84:87]
    ds_read_b64_tr_b16 v[38:39], v4 offset:41984
    v_mfma_f32_16x16x32_bf16 v[88:91], v[44:47], v[192:195], v[88:91]
    ds_read_b64_tr_b16 v[40:41], v5 offset:40960
    v_mfma_f32_16x16x32_bf16 v[92:95], v[44:47], v[196:199], v[92:95]
    ds_read_b64_tr_b16 v[42:43], v5 offset:41984
    s_waitcnt vmcnt(4) lgkmcnt(10)
    v_mfma_f32_16x16x32_bf16 v[64:67], v[48:51], v[200:203], v[64:67]
    ds_read_b64_tr_b16 v[44:45], v6 offset:40960
    v_mfma_f32_16x16x32_bf16 v[68:71], v[48:51], v[204:207], v[68:71]
    ds_read_b64_tr_b16 v[46:47], v6 offset:41984
    v_mfma_f32_16x16x32_bf16 v[72:75], v[52:55], v[200:203], v[72:75]
    ds_read_b64_tr_b16 v[48:49], v3 offset:45056
    v_mfma_f32_16x16x32_bf16 v[76:79], v[52:55], v[204:207], v[76:79]
    ds_read_b64_tr_b16 v[50:51], v3 offset:46080
    s_waitcnt lgkmcnt(10)
    v_mfma_f32_16x16x32_bf16 v[80:83], v[56:59], v[200:203], v[80:83]
    ds_read_b64_tr_b16 v[52:53], v4 offset:45056
    v_mfma_f32_16x16x32_bf16 v[84:87], v[56:59], v[204:207], v[84:87]
    ds_read_b64_tr_b16 v[54:55], v4 offset:46080
    v_mfma_f32_16x16x32_bf16 v[88:91], v[60:63], v[200:203], v[88:91]
    ds_read_b64_tr_b16 v[56:57], v5 offset:45056
    v_mfma_f32_16x16x32_bf16 v[92:95], v[60:63], v[204:207], v[92:95]
    ds_read_b64_tr_b16 v[58:59], v5 offset:46080
    s_waitcnt vmcnt(2) lgkmcnt(10)
    v_mfma_f32_16x16x32_bf16 v[64:67], v[32:35], v[208:211], v[64:67]
    ds_read_b64_tr_b16 v[60:61], v6 offset:45056
    v_mfma_f32_16x16x32_bf16 v[68:71], v[32:35], v[212:215], v[68:71]
    ds_read_b64_tr_b16 v[62:63], v6 offset:46080
    v_mfma_f32_16x16x32_bf16 v[72:75], v[36:39], v[208:211], v[72:75]
    ds_read_b64_tr_b16 v[32:33], v3 offset:49152
    ds_read_b32 v8, v9 offset:4096
    v_mfma_f32_16x16x32_bf16 v[76:79], v[36:39], v[212:215], v[76:79]
    ds_read_b64_tr_b16 v[34:35], v3 offset:50176
    ds_read_b32 v10, v9 offset:4608
    s_waitcnt lgkmcnt(12)
    v_mfma_f32_16x16x32_bf16 v[80:83], v[40:43], v[208:211], v[80:83]
    ds_read_b64_tr_b16 v[36:37], v4 offset:49152
    ds_read_b32 v12, v9 offset:4160
    v_mfma_f32_16x16x32_bf16 v[84:87], v[40:43], v[212:215], v[84:87]
    ds_read_b64_tr_b16 v[38:39], v4 offset:50176
    ds_read_b32 v14, v9 offset:4672
    v_mfma_f32_16x16x32_bf16 v[88:91], v[44:47], v[208:211], v[88:91]
    ds_read_b64_tr_b16 v[40:41], v5 offset:49152
    ds_read_b128 v[16:19], v11 offset:256
    v_mfma_f32_16x16x32_bf16 v[92:95], v[44:47], v[212:215], v[92:95]
    ds_read_b64_tr_b16 v[42:43], v5 offset:50176
    ds_read_b128 v[20:23], v11 offset:320
    s_waitcnt vmcnt(0) lgkmcnt(14)
    v_mfma_f32_16x16x32_bf16 v[64:67], v[48:51], v[216:219], v[64:67]
    ds_read_b64_tr_b16 v[44:45], v6 offset:49152
    ds_read_b128 v[24:27], v11 offset:384
    v_mfma_f32_16x16x32_bf16 v[68:71], v[48:51], v[220:223], v[68:71]
    ds_read_b64_tr_b16 v[46:47], v6 offset:50176
    ds_read_b128 v[28:31], v11 offset:448
    v_mfma_f32_16x16x32_bf16 v[72:75], v[52:55], v[216:219], v[72:75]
    ds_read_b64_tr_b16 v[48:49], v3 offset:53248
    v_mfma_f32_16x16x32_bf16 v[76:79], v[52:55], v[220:223], v[76:79]
    ds_read_b64_tr_b16 v[50:51], v3 offset:54272
    s_waitcnt lgkmcnt(14)
    v_mfma_f32_16x16x32_bf16 v[80:83], v[56:59], v[216:219], v[80:83]
    ds_read_b64_tr_b16 v[52:53], v4 offset:53248
    v_mfma_f32_16x16x32_bf16 v[84:87], v[56:59], v[220:223], v[84:87]
    ds_read_b64_tr_b16 v[54:55], v4 offset:54272
    v_mfma_f32_16x16x32_bf16 v[88:91], v[60:63], v[216:219], v[88:91]
    ds_read_b64_tr_b16 v[56:57], v5 offset:53248
    v_mfma_f32_16x16x32_bf16 v[92:95], v[60:63], v[220:223], v[92:95]
    ds_read_b64_tr_b16 v[58:59], v5 offset:54272
    s_bitcmp1_b32 s21, 0
    s_cbranch_scc1 c_B
    v_add_u32 v7, s62, v1
    s_waitcnt lgkmcnt(6)
    v_pk_fma_f32 v[68:69], v[12:13], v[16:17], v[68:69] op_sel_hi:[0,1,1] neg_lo:[1,0,0] neg_hi:[1,0,0]
    v_pk_fma_f32 v[70:71], v[12:13], v[18:19], v[70:71] op_sel_hi:[0,1,1] neg_lo:[1,0,0] neg_hi:[1,0,0]
    v_pk_fma_f32 v[76:77], v[12:13], v[20:21], v[76:77] op_sel_hi:[0,1,1] neg_lo:[1,0,0] neg_hi:[1,0,0]
    v_pk_fma_f32 v[78:79], v[12:13], v[22:23], v[78:79] op_sel_hi:[0,1,1] neg_lo:[1,0,0] neg_hi:[1,0,0]
    v_pk_mul_f32 v[68:69], v[14:15], v[68:69] op_sel_hi:[0,1]
    v_pk_mul_f32 v[70:71], v[14:15], v[70:71] op_sel_hi:[0,1]
    v_pk_mul_f32 v[76:77], v[14:15], v[76:77] op_sel_hi:[0,1]
    v_pk_mul_f32 v[78:79], v[14:15], v[78:79] op_sel_hi:[0,1]
    v_cvt_pk_bf16_f32 v68, v68, v69
    v_cvt_pk_bf16_f32 v69, v70, v71
    v_cvt_pk_bf16_f32 v70, v76, v77
    v_cvt_pk_bf16_f32 v71, v78, v79
    ds_write_b128 v7, v[68:71] offset:4096
    v_pk_fma_f32 v[64:65], v[8:9], v[16:17], v[64:65] op_sel_hi:[0,1,1] neg_lo:[1,0,0] neg_hi:[1,0,0]
    v_pk_fma_f32 v[66:67], v[8:9], v[18:19], v[66:67] op_sel_hi:[0,1,1] neg_lo:[1,0,0] neg_hi:[1,0,0]
    v_pk_fma_f32 v[72:73], v[8:9], v[20:21], v[72:73] op_sel_hi:[0,1,1] neg_lo:[1,0,0] neg_hi:[1,0,0]
    v_pk_fma_f32 v[74:75], v[8:9], v[22:23], v[74:75] op_sel_hi:[0,1,1] neg_lo:[1,0,0] neg_hi:[1,0,0]
    v_pk_mul_f32 v[64:65], v[10:11], v[64:65] op_sel_hi:[0,1]
    v_pk_mul_f32 v[66:67], v[10:11], v[66:67] op_sel_hi:[0,1]
    v_pk_mul_f32 v[72:73], v[10:11], v[72:73] op_sel_hi:[0,1]
    v_pk_mul_f32 v[74:75], v[10:11], v[74:75] op_sel_hi:[0,1]
    v_cvt_pk_bf16_f32 v64, v64, v65
    v_cvt_pk_bf16_f32 v65, v66, v67
    v_cvt_pk_bf16_f32 v66, v72, v73
    v_cvt_pk_bf16_f32 v67, v74, v75
    v_pk_fma_f32 v[84:85], v[12:13], v[24:25], v[84:85] op_sel_hi:[0,1,1] neg_lo:[1,0,0] neg_hi:[1,0,0]
    v_pk_fma_f32 v[86:87], v[12:13], v[26:27], v[86:87] op_sel_hi:[0,1,1] neg_lo:[1,0,0] neg_hi:[1,0,0]
    v_pk_fma_f32 v[92:93], v[12:13], v[28:29], v[92:93] op_sel_hi:[0,1,1] neg_lo:[1,0,0] neg_hi:[1,0,0]
    v_pk_fma_f32 v[94:95], v[12:13], v[30:31], v[94:95] op_sel_hi:[0,1,1] neg_lo:[1,0,0] neg_hi:[1,0,0]
    v_pk_mul_f32 v[84:85], v[14:15], v[84:85] op_sel_hi:[0,1]
    v_pk_mul_f32 v[86:87], v[14:15], v[86:87] op_sel_hi:[0,1]
    v_pk_mul_f32 v[92:93], v[14:15], v[92:93] op_sel_hi:[0,1]
    v_pk_mul_f32 v[94:95], v[14:15], v[94:95] op_sel_hi:[0,1]
    v_cvt_pk_bf16_f32 v84, v84, v85
    v_cvt_pk_bf16_f32 v85, v86, v87
    v_cvt_pk_bf16_f32 v86, v92, v93
    v_cvt_pk_bf16_f32 v87, v94, v95
    ds_write_b128 v7, v[84:87] offset:5120
    v_pk_fma_f32 v[80:81], v[8:9], v[24:25], v[80:81] op_sel_hi:[0,1,1] neg_lo:[1,0,0] neg_hi:[1,0,0]
    v_pk_fma_f32 v[82:83], v[8:9], v[26:27], v[82:83] op_sel_hi:[0,1,1] neg_lo:[1,0,0] neg_hi:[1,0,0]
    v_pk_fma_f32 v[88:89], v[8:9], v[28:29], v[88:89] op_sel_hi:[0,1,1] neg_lo:[1,0,0] neg_hi:[1,0,0]
    v_pk_fma_f32 v[90:91], v[8:9], v[30:31], v[90:91] op_sel_hi:[0,1,1] neg_lo:[1,0,0] neg_hi:[1,0,0]
    v_pk_mul_f32 v[80:81], v[10:11], v[80:81] op_sel_hi:[0,1]
    v_pk_mul_f32 v[82:83], v[10:11], v[82:83] op_sel_hi:[0,1]
    v_pk_mul_f32 v[88:89], v[10:11], v[88:89] op_sel_hi:[0,1]
    v_pk_mul_f32 v[90:91], v[10:11], v[90:91] op_sel_hi:[0,1]
    v_cvt_pk_bf16_f32 v80, v80, v81
    v_cvt_pk_bf16_f32 v81, v82, v83
    v_cvt_pk_bf16_f32 v82, v88, v89
    v_cvt_pk_bf16_f32 v83, v90, v91
    v_mfma_f32_16x16x32_bf16 v[96:99], v[160:163], v[32:35], v[96:99]
    ds_read_b64_tr_b16 v[60:61], v6 offset:53248
    v_mfma_f32_16x16x32_bf16 v[100:103], v[164:167], v[32:35], v[100:103]
    ds_read_b64_tr_b16 v[62:63], v6 offset:54272
    v_mfma_f32_16x16x32_bf16 v[104:107], v[160:163], v[36:39], v[104:107]
    ds_read_b64_tr_b16 v[32:33], v3 offset:57344
    v_mfma_f32_16x16x32_bf16 v[108:111], v[164:167], v[36:39], v[108:111]
    ds_read_b64_tr_b16 v[34:35], v3 offset:58368
    v_mfma_f32_16x16x32_bf16 v[112:115], v[160:163], v[40:43], v[112:115]
    ds_read_b64_tr_b16 v[36:37], v4 offset:57344
    v_mfma_f32_16x16x32_bf16 v[116:119], v[164:167], v[40:43], v[116:119]
    ds_read_b64_tr_b16 v[38:39], v4 offset:58368
    v_mfma_f32_16x16x32_bf16 v[120:123], v[160:163], v[44:47], v[120:123]
    ds_read_b64_tr_b16 v[40:41], v5 offset:57344
    v_mfma_f32_16x16x32_bf16 v[124:127], v[164:167], v[44:47], v[124:127]
    ds_read_b64_tr_b16 v[42:43], v5 offset:58368
    s_waitcnt lgkmcnt(12)
    v_mfma_f32_16x16x32_bf16 v[96:99], v[168:171], v[48:51], v[96:99]
    ds_read_b64_tr_b16 v[44:45], v6 offset:57344
    v_mfma_f32_16x16x32_bf16 v[100:103], v[172:175], v[48:51], v[100:103]
    ds_read_b64_tr_b16 v[46:47], v6 offset:58368
    v_mfma_f32_16x16x32_bf16 v[104:107], v[168:171], v[52:55], v[104:107]
    ds_read_b64_tr_b16 v[48:49], v3 offset:61440
    v_mfma_f32_16x16x32_bf16 v[108:111], v[172:175], v[52:55], v[108:111]
    ds_read_b64_tr_b16 v[50:51], v3 offset:62464
    s_waitcnt lgkmcnt(10)
    v_mfma_f32_16x16x32_bf16 v[112:115], v[168:171], v[56:59], v[112:115]
    ds_read_b64_tr_b16 v[52:53], v4 offset:61440
    v_mfma_f32_16x16x32_bf16 v[116:119], v[172:175], v[56:59], v[116:119]
    ds_read_b64_tr_b16 v[54:55], v4 offset:62464
    v_mfma_f32_16x16x32_bf16 v[120:123], v[168:171], v[60:63], v[120:123]
    ds_read_b64_tr_b16 v[56:57], v5 offset:61440
    v_mfma_f32_16x16x32_bf16 v[124:127], v[172:175], v[60:63], v[124:127]
    ds_read_b64_tr_b16 v[58:59], v5 offset:62464
    s_waitcnt lgkmcnt(10)
    v_mfma_f32_16x16x32_bf16 v[96:99], v[176:179], v[32:35], v[96:99]
    ds_read_b64_tr_b16 v[60:61], v6 offset:61440
    v_mfma_f32_16x16x32_bf16 v[100:103], v[180:183], v[32:35], v[100:103]
    ds_read_b64_tr_b16 v[62:63], v6 offset:62464
    s_barrier
    v_xor_b32 v3, 0x10000, v3
    v_xor_b32 v4, 0x10000, v4
    v_xor_b32 v5, 0x10000, v5
    v_xor_b32 v6, 0x10000, v6
    v_mfma_f32_16x16x32_bf16 v[104:107], v[176:179], v[36:39], v[104:107]
    ds_read_b64_tr_b16 v[32:33], v3 offset:0
    v_mfma_f32_16x16x32_bf16 v[108:111], v[180:183], v[36:39], v[108:111]
    ds_read_b64_tr_b16 v[34:35], v3 offset:1024
    s_waitcnt lgkmcnt(10)
    v_mfma_f32_16x16x32_bf16 v[112:115], v[176:179], v[40:43], v[112:115]
    ds_read_b64_tr_b16 v[36:37], v4 offset:0
    v_mfma_f32_16x16x32_bf16 v[116:119], v[180:183], v[40:43], v[116:119]
    ds_read_b64_tr_b16 v[38:39], v4 offset:1024
    v_mfma_f32_16x16x32_bf16 v[120:123], v[176:179], v[44:47], v[120:123]
    ds_read_b64_tr_b16 v[40:41], v5 offset:0
    v_mfma_f32_16x16x32_bf16 v[124:127], v[180:183], v[44:47], v[124:127]
    ds_read_b64_tr_b16 v[42:43], v5 offset:1024
    s_waitcnt lgkmcnt(10)
    v_mfma_f32_16x16x32_bf16 v[96:99], v[184:187], v[48:51], v[96:99]
    ds_read_b64_tr_b16 v[44:45], v6 offset:0
    v_mfma_f32_16x16x32_bf16 v[100:103], v[188:191], v[48:51], v[100:103]
    ds_read_b64_tr_b16 v[46:47], v6 offset:1024
    v_mfma_f32_16x16x32_bf16 v[104:107], v[184:187], v[52:55], v[104:107]
    ds_read_b64_tr_b16 v[48:49], v3 offset:4096
    v_mfma_f32_16x16x32_bf16 v[108:111], v[188:191], v[52:55], v[108:111]
    ds_read_b64_tr_b16 v[50:51], v3 offset:5120
    s_waitcnt lgkmcnt(10)
    v_mfma_f32_16x16x32_bf16 v[112:115], v[184:187], v[56:59], v[112:115]
    ds_read_b64_tr_b16 v[52:53], v4 offset:4096
    v_mfma_f32_16x16x32_bf16 v[116:119], v[188:191], v[56:59], v[116:119]
    ds_read_b64_tr_b16 v[54:55], v4 offset:5120
    v_mfma_f32_16x16x32_bf16 v[120:123], v[184:187], v[60:63], v[120:123]
    ds_read_b64_tr_b16 v[56:57], v5 offset:4096
    v_mfma_f32_16x16x32_bf16 v[124:127], v[188:191], v[60:63], v[124:127]
    ds_read_b64_tr_b16 v[58:59], v5 offset:5120
    s_waitcnt lgkmcnt(10)
    v_mfma_f32_16x16x32_bf16 v[96:99], v[192:195], v[32:35], v[96:99]
    ds_read_b64_tr_b16 v[60:61], v6 offset:4096
    v_mfma_f32_16x16x32_bf16 v[100:103], v[196:199], v[32:35], v[100:103]
    ds_read_b64_tr_b16 v[62:63], v6 offset:5120
    v_mfma_f32_16x16x32_bf16 v[104:107], v[192:195], v[36:39], v[104:107]
    ds_read_b64_tr_b16 v[32:33], v3 offset:8192
    v_mfma_f32_16x16x32_bf16 v[108:111], v[196:199], v[36:39], v[108:111]
    ds_read_b64_tr_b16 v[34:35], v3 offset:9216
    s_waitcnt lgkmcnt(10)
    v_mfma_f32_16x16x32_bf16 v[112:115], v[192:195], v[40:43], v[112:115]
    ds_read_b64_tr_b16 v[36:37], v4 offset:8192
    v_mfma_f32_16x16x32_bf16 v[116:119], v[196:199], v[40:43], v[116:119]
    ds_read_b64_tr_b16 v[38:39], v4 offset:9216
    v_mfma_f32_16x16x32_bf16 v[120:123], v[192:195], v[44:47], v[120:123]
    ds_read_b64_tr_b16 v[40:41], v5 offset:8192
    v_mfma_f32_16x16x32_bf16 v[124:127], v[196:199], v[44:47], v[124:127]
    ds_read_b64_tr_b16 v[42:43], v5 offset:9216
    s_waitcnt lgkmcnt(10)
    v_mfma_f32_16x16x32_bf16 v[96:99], v[200:203], v[48:51], v[96:99]
    ds_read_b64_tr_b16 v[44:45], v6 offset:8192
    v_mfma_f32_16x16x32_bf16 v[100:103], v[204:207], v[48:51], v[100:103]
    ds_read_b64_tr_b16 v[46:47], v6 offset:9216
    v_mfma_f32_16x16x32_bf16 v[104:107], v[200:203], v[52:55], v[104:107]
    ds_read_b64_tr_b16 v[48:49], v3 offset:12288
    v_mfma_f32_16x16x32_bf16 v[108:111], v[204:207], v[52:55], v[108:111]
    ds_read_b64_tr_b16 v[50:51], v3 offset:13312
    s_waitcnt lgkmcnt(10)
    v_mfma_f32_16x16x32_bf16 v[112:115], v[200:203], v[56:59], v[112:115]
    ds_read_b64_tr_b16 v[52:53], v4 offset:12288
    v_mfma_f32_16x16x32_bf16 v[116:119], v[204:207], v[56:59], v[116:119]
    ds_read_b64_tr_b16 v[54:55], v4 offset:13312
    v_mfma_f32_16x16x32_bf16 v[120:123], v[200:203], v[60:63], v[120:123]
    ds_read_b64_tr_b16 v[56:57], v5 offset:12288
    v_mfma_f32_16x16x32_bf16 v[124:127], v[204:207], v[60:63], v[124:127]
    ds_read_b64_tr_b16 v[58:59], v5 offset:13312
    s_waitcnt lgkmcnt(10)
    v_mfma_f32_16x16x32_bf16 v[96:99], v[208:211], v[32:35], v[96:99]
    ds_read_b64_tr_b16 v[60:61], v6 offset:12288
    v_mfma_f32_16x16x32_bf16 v[100:103], v[212:215], v[32:35], v[100:103]
    ds_read_b64_tr_b16 v[62:63], v6 offset:13312
    v_mfma_f32_16x16x32_bf16 v[104:107], v[208:211], v[36:39], v[104:107]
    ds_read_b64_tr_b16 v[32:33], v3 offset:16384
    ds_read_b128 v[16:19], v13 offset:4096
    v_mfma_f32_16x16x32_bf16 v[108:111], v[212:215], v[36:39], v[108:111]
    ds_read_b64_tr_b16 v[34:35], v3 offset:17408
    ds_read_b128 v[20:23], v13 offset:4608
    s_waitcnt lgkmcnt(12)
    v_mfma_f32_16x16x32_bf16 v[112:115], v[208:211], v[40:43], v[112:115]
    ds_read_b64_tr_b16 v[36:37], v4 offset:16384
    ds_read_b128 v[24:27], v13 offset:4160
    v_mfma_f32_16x16x32_bf16 v[116:119], v[212:215], v[40:43], v[116:119]
    ds_read_b64_tr_b16 v[38:39], v4 offset:17408
    ds_read_b128 v[28:31], v13 offset:4672
    v_mfma_f32_16x16x32_bf16 v[120:123], v[208:211], v[44:47], v[120:123]
    ds_read_b64_tr_b16 v[40:41], v5 offset:16384
    ds_read_b32 v8, v15 offset:512
    v_mfma_f32_16x16x32_bf16 v[124:127], v[212:215], v[44:47], v[124:127]
    ds_read_b64_tr_b16 v[42:43], v5 offset:17408
    ds_read_b32 v10, v15 offset:576
    s_waitcnt lgkmcnt(14)
    v_mfma_f32_16x16x32_bf16 v[96:99], v[216:219], v[48:51], v[96:99]
    ds_read_b64_tr_b16 v[44:45], v6 offset:16384
    ds_read_b32 v12, v15 offset:640
    v_mfma_f32_16x16x32_bf16 v[100:103], v[220:223], v[48:51], v[100:103]
    ds_read_b64_tr_b16 v[46:47], v6 offset:17408
    ds_read_b32 v14, v15 offset:704
    v_mfma_f32_16x16x32_bf16 v[104:107], v[216:219], v[52:55], v[104:107]
    ds_read_b64_tr_b16 v[48:49], v3 offset:20480
    v_mfma_f32_16x16x32_bf16 v[108:111], v[220:223], v[52:55], v[108:111]
    ds_read_b64_tr_b16 v[50:51], v3 offset:21504
    s_waitcnt lgkmcnt(14)
    v_mfma_f32_16x16x32_bf16 v[112:115], v[216:219], v[56:59], v[112:115]
    ds_read_b64_tr_b16 v[52:53], v4 offset:20480
    v_mfma_f32_16x16x32_bf16 v[116:119], v[220:223], v[56:59], v[116:119]
    ds_read_b64_tr_b16 v[54:55], v4 offset:21504
    v_mfma_f32_16x16x32_bf16 v[120:123], v[216:219], v[60:63], v[120:123]
    ds_read_b64_tr_b16 v[56:57], v5 offset:20480
    v_mfma_f32_16x16x32_bf16 v[124:127], v[220:223], v[60:63], v[124:127]
    ds_read_b64_tr_b16 v[58:59], v5 offset:21504
    s_waitcnt lgkmcnt(6)
    v_pk_fma_f32 v[100:101], v[8:9], v[24:25], v[100:101] op_sel_hi:[0,1,1] neg_lo:[1,0,0] neg_hi:[1,0,0]
    v_pk_fma_f32 v[102:103], v[8:9], v[26:27], v[102:103] op_sel_hi:[0,1,1] neg_lo:[1,0,0] neg_hi:[1,0,0]
    v_pk_fma_f32 v[108:109], v[10:11], v[24:25], v[108:109] op_sel_hi:[0,1,1] neg_lo:[1,0,0] neg_hi:[1,0,0]
    v_pk_fma_f32 v[110:111], v[10:11], v[26:27], v[110:111] op_sel_hi:[0,1,1] neg_lo:[1,0,0] neg_hi:[1,0,0]
    v_pk_mul_f32 v[100:101], v[28:29], v[100:101]
    v_pk_mul_f32 v[102:103], v[30:31], v[102:103]
    v_pk_mul_f32 v[108:109], v[28:29], v[108:109]
    v_pk_mul_f32 v[110:111], v[30:31], v[110:111]
    v_cvt_pk_bf16_f32 v74, v100, v101
    v_cvt_pk_bf16_f32 v75, v102, v103
    v_cvt_pk_bf16_f32 v78, v108, v109
    v_cvt_pk_bf16_f32 v79, v110, v111
    v_cvt_pk_bf16_f32 v100, v100, v101
    v_cvt_pk_bf16_f32 v101, v102, v103
    v_cvt_pk_bf16_f32 v102, v108, v109
    v_cvt_pk_bf16_f32 v103, v110, v111
    ds_write_b128 v7, v[100:103] offset:6144
    v_pk_fma_f32 v[116:117], v[12:13], v[24:25], v[116:117] op_sel_hi:[0,1,1] neg_lo:[1,0,0] neg_hi:[1,0,0]
    v_pk_fma_f32 v[118:119], v[12:13], v[26:27], v[118:119] op_sel_hi:[0,1,1] neg_lo:[1,0,0] neg_hi:[1,0,0]
    v_pk_fma_f32 v[124:125], v[14:15], v[24:25], v[124:125] op_sel_hi:[0,1,1] neg_lo:[1,0,0] neg_hi:[1,0,0]
    v_pk_fma_f32 v[126:127], v[14:15], v[26:27], v[126:127] op_sel_hi:[0,1,1] neg_lo:[1,0,0] neg_hi:[1,0,0]
    v_pk_mul_f32 v[116:117], v[28:29], v[116:117]
    v_pk_mul_f32 v[118:119], v[30:31], v[118:119]
    v_pk_mul_f32 v[124:125], v[28:29], v[124:125]
    v_pk_mul_f32 v[126:127], v[30:31], v[126:127]
    v_cvt_pk_bf16_f32 v90, v116, v117
    v_cvt_pk_bf16_f32 v91, v118, v119
    v_cvt_pk_bf16_f32 v94, v124, v125
    v_cvt_pk_bf16_f32 v95, v126, v127
    v_cvt_pk_bf16_f32 v116, v116, v117
    v_cvt_pk_bf16_f32 v117, v118, v119
    v_cvt_pk_bf16_f32 v118, v124, v125
    v_cvt_pk_bf16_f32 v119, v126, v127
    ds_write_b128 v7, v[116:119] offset:7168
    s_cmp_lg_u32 s16, 3
    s_cbranch_scc1 a_nh
    buffer_store_dwordx4 v[68:71], v1, s[4:7], s60 offen offset:0 sc1
    buffer_store_dwordx4 v[84:87], v1, s[4:7], s60 offen offset:1024 sc1
    buffer_store_dwordx4 v[100:103], v1, s[4:7], s60 offen offset:2048 sc1
    buffer_store_dwordx4 v[116:119], v1, s[4:7], s60 offen offset:3072 sc1
a_nh:
    v_pk_fma_f32 v[96:97], v[8:9], v[16:17], v[96:97] op_sel_hi:[0,1,1] neg_lo:[1,0,0] neg_hi:[1,0,0]
    v_pk_fma_f32 v[98:99], v[8:9], v[18:19], v[98:99] op_sel_hi:[0,1,1] neg_lo:[1,0,0] neg_hi:[1,0,0]
    v_pk_fma_f32 v[104:105], v[10:11], v[16:17], v[104:105] op_sel_hi:[0,1,1] neg_lo:[1,0,0] neg_hi:[1,0,0]
    v_pk_fma_f32 v[106:107], v[10:11], v[18:19], v[106:107] op_sel_hi:[0,1,1] neg_lo:[1,0,0] neg_hi:[1,0,0]
    v_pk_mul_f32 v[96:97], v[20:21], v[96:97]
    v_pk_mul_f32 v[98:99], v[22:23], v[98:99]
    v_pk_mul_f32 v[104:105], v[20:21], v[104:105]
    v_pk_mul_f32 v[106:107], v[22:23], v[106:107]
    v_cvt_pk_bf16_f32 v72, v96, v97
    v_cvt_pk_bf16_f32 v73, v98, v99
    v_cvt_pk_bf16_f32 v76, v104, v105
    v_cvt_pk_bf16_f32 v77, v106, v107
    v_pk_fma_f32 v[112:113], v[12:13], v[16:17], v[112:113] op_sel_hi:[0,1,1] neg_lo:[1,0,0] neg_hi:[1,0,0]
    v_pk_fma_f32 v[114:115], v[12:13], v[18:19], v[114:115] op_sel_hi:[0,1,1] neg_lo:[1,0,0] neg_hi:[1,0,0]
    v_pk_fma_f32 v[120:121], v[14:15], v[16:17], v[120:121] op_sel_hi:[0,1,1] neg_lo:[1,0,0] neg_hi:[1,0,0]
    v_pk_fma_f32 v[122:123], v[14:15], v[18:19], v[122:123] op_sel_hi:[0,1,1] neg_lo:[1,0,0] neg_hi:[1,0,0]
    v_pk_mul_f32 v[112:113], v[20:21], v[112:113]
    v_pk_mul_f32 v[114:115], v[22:23], v[114:115]
    v_pk_mul_f32 v[120:121], v[20:21], v[120:121]
    v_pk_mul_f32 v[122:123], v[22:23], v[122:123]
    v_cvt_pk_bf16_f32 v88, v112, v113
    v_cvt_pk_bf16_f32 v89, v114, v115
    v_cvt_pk_bf16_f32 v92, v120, v121
    v_cvt_pk_bf16_f32 v93, v122, v123
    v_mfma_f32_16x16x32_bf16 v[128:131], v[32:35], v[224:227], v[128:131]
    ds_read_b64_tr_b16 v[60:61], v6 offset:20480
    v_mfma_f32_16x16x32_bf16 v[132:135], v[32:35], v[228:231], v[132:135]
    ds_read_b64_tr_b16 v[62:63], v6 offset:21504
    v_mfma_f32_16x16x32_bf16 v[136:139], v[36:39], v[224:227], v[136:139]
    ds_read_b64_tr_b16 v[32:33], v3 offset:24576
    v_mfma_f32_16x16x32_bf16 v[140:143], v[36:39], v[228:231], v[140:143]
    ds_read_b64_tr_b16 v[34:35], v3 offset:25600
    v_mfma_f32_16x16x32_bf16 v[144:147], v[40:43], v[224:227], v[144:147]
    ds_read_b64_tr_b16 v[36:37], v4 offset:24576
    v_mfma_f32_16x16x32_bf16 v[148:151], v[40:43], v[228:231], v[148:151]
    ds_read_b64_tr_b16 v[38:39], v4 offset:25600
    v_mfma_f32_16x16x32_bf16 v[152:155], v[44:47], v[224:227], v[152:155]
    ds_read_b64_tr_b16 v[40:41], v5 offset:24576
    v_mfma_f32_16x16x32_bf16 v[156:159], v[44:47], v[228:231], v[156:159]
    ds_read_b64_tr_b16 v[42:43], v5 offset:25600
    s_waitcnt lgkmcnt(12)
    v_mfma_f32_16x16x32_bf16 v[128:131], v[48:51], v[232:235], v[128:131]
    ds_read_b64_tr_b16 v[44:45], v6 offset:24576
    v_mfma_f32_16x16x32_bf16 v[132:135], v[48:51], v[236:239], v[132:135]
    ds_read_b64_tr_b16 v[46:47], v6 offset:25600
    v_mfma_f32_16x16x32_bf16 v[136:139], v[52:55], v[232:235], v[136:139]
    ds_read_b64_tr_b16 v[48:49], v3 offset:28672
    v_mfma_f32_16x16x32_bf16 v[140:143], v[52:55], v[236:239], v[140:143]
    ds_read_b64_tr_b16 v[50:51], v3 offset:29696
    s_waitcnt lgkmcnt(10)
    v_mfma_f32_16x16x32_bf16 v[144:147], v[56:59], v[232:235], v[144:147]
    ds_read_b64_tr_b16 v[52:53], v4 offset:28672
    v_mfma_f32_16x16x32_bf16 v[148:151], v[56:59], v[236:239], v[148:151]
    ds_read_b64_tr_b16 v[54:55], v4 offset:29696
    v_mfma_f32_16x16x32_bf16 v[152:155], v[60:63], v[232:235], v[152:155]
    ds_read_b64_tr_b16 v[56:57], v5 offset:28672
    v_mfma_f32_16x16x32_bf16 v[156:159], v[60:63], v[236:239], v[156:159]
    ds_read_b64_tr_b16 v[58:59], v5 offset:29696
    s_waitcnt lgkmcnt(10)
    v_mfma_f32_16x16x32_bf16 v[128:131], v[32:35], v[240:243], v[128:131]
    ds_read_b64_tr_b16 v[60:61], v6 offset:28672
    v_mfma_f32_16x16x32_bf16 v[132:135], v[32:35], v[244:247], v[132:135]
    ds_read_b64_tr_b16 v[62:63], v6 offset:29696
    s_barrier
    v_mfma_f32_16x16x32_bf16 v[136:139], v[36:39], v[240:243], v[136:139]
    ds_read_b64_tr_b16 v[32:33], v3 offset:32768
    v_mfma_f32_16x16x32_bf16 v[140:143], v[36:39], v[244:247], v[140:143]
    ds_read_b64_tr_b16 v[34:35], v3 offset:33792
    s_waitcnt lgkmcnt(10)
    v_mfma_f32_16x16x32_bf16 v[144:147], v[40:43], v[240:243], v[144:147]
    ds_read_b64_tr_b16 v[36:37], v4 offset:32768
    v_mfma_f32_16x16x32_bf16 v[148:151], v[40:43], v[244:247], v[148:151]
    ds_read_b64_tr_b16 v[38:39], v4 offset:33792
    v_mfma_f32_16x16x32_bf16 v[152:155], v[44:47], v[240:243], v[152:155]
    ds_read_b64_tr_b16 v[40:41], v5 offset:32768
    v_mfma_f32_16x16x32_bf16 v[156:159], v[44:47], v[244:247], v[156:159]
    ds_read_b64_tr_b16 v[42:43], v5 offset:33792
    s_waitcnt lgkmcnt(10)
    v_mfma_f32_16x16x32_bf16 v[128:131], v[48:51], v[248:251], v[128:131]
    ds_read_b64_tr_b16 v[44:45], v6 offset:32768
    v_mfma_f32_16x16x32_bf16 v[132:135], v[48:51], v[252:255], v[132:135]
    ds_read_b64_tr_b16 v[46:47], v6 offset:33792
    v_mfma_f32_16x16x32_bf16 v[136:139], v[52:55], v[248:251], v[136:139]
    ds_read_b64_tr_b16 v[48:49], v3 offset:36864
    v_mfma_f32_16x16x32_bf16 v[140:143], v[52:55], v[252:255], v[140:143]
    ds_read_b64_tr_b16 v[50:51], v3 offset:37888
    s_waitcnt lgkmcnt(10)
    v_mfma_f32_16x16x32_bf16 v[144:147], v[56:59], v[248:251], v[144:147]
    ds_read_b64_tr_b16 v[52:53], v4 offset:36864
    v_mfma_f32_16x16x32_bf16 v[148:151], v[56:59], v[252:255], v[148:151]
    ds_read_b64_tr_b16 v[54:55], v4 offset:37888
    v_mfma_f32_16x16x32_bf16 v[152:155], v[60:63], v[248:251], v[152:155]
    ds_read_b64_tr_b16 v[56:57], v5 offset:36864
    v_mfma_f32_16x16x32_bf16 v[156:159], v[60:63], v[252:255], v[156:159]
    ds_read_b64_tr_b16 v[58:59], v5 offset:37888
    s_waitcnt lgkmcnt(10)
    v_mfma_f32_16x16x32_bf16 v[128:131], v[32:35], v[160:163], v[128:131]
    ds_read_b64_tr_b16 v[60:61], v6 offset:36864
    v_mfma_f32_16x16x32_bf16 v[132:135], v[32:35], v[164:167], v[132:135]
    ds_read_b64_tr_b16 v[62:63], v6 offset:37888
    v_mfma_f32_16x16x32_bf16 v[136:139], v[36:39], v[160:163], v[136:139]
    ds_read_b64_tr_b16 v[32:33], v3 offset:40960
    v_mfma_f32_16x16x32_bf16 v[140:143], v[36:39], v[164:167], v[140:143]
    ds_read_b64_tr_b16 v[34:35], v3 offset:41984
    s_waitcnt lgkmcnt(10)
    v_mfma_f32_16x16x32_bf16 v[144:147], v[40:43], v[160:163], v[144:147]
    ds_read_b64_tr_b16 v[36:37], v4 offset:40960
    v_mfma_f32_16x16x32_bf16 v[148:151], v[40:43], v[164:167], v[148:151]
    ds_read_b64_tr_b16 v[38:39], v4 offset:41984
    v_mfma_f32_16x16x32_bf16 v[152:155], v[44:47], v[160:163], v[152:155]
    ds_read_b64_tr_b16 v[40:41], v5 offset:40960
    v_mfma_f32_16x16x32_bf16 v[156:159], v[44:47], v[164:167], v[156:159]
    ds_read_b64_tr_b16 v[42:43], v5 offset:41984
    s_waitcnt lgkmcnt(10)
    v_mfma_f32_16x16x32_bf16 v[128:131], v[48:51], v[168:171], v[128:131]
    ds_read_b64_tr_b16 v[44:45], v6 offset:40960
    s_cmp_lg_u32 s16, 3
    s_cbranch_scc1 a_nopub
    s_waitcnt vmcnt(0)
    s_atomic_add s40, s[22:23], s61
a_nopub:
    v_mfma_f32_16x16x32_bf16 v[132:135], v[48:51], v[172:175], v[132:135]
    ds_read_b64_tr_b16 v[46:47], v6 offset:41984
    v_mfma_f32_16x16x32_bf16 v[136:139], v[52:55], v[168:171], v[136:139]
    ds_read_b64_tr_b16 v[48:49], v3 offset:45056
    v_mfma_f32_16x16x32_bf16 v[140:143], v[52:55], v[172:175], v[140:143]
    ds_read_b64_tr_b16 v[50:51], v3 offset:46080
    s_waitcnt lgkmcnt(10)
    v_mfma_f32_16x16x32_bf16 v[144:147], v[56:59], v[168:171], v[144:147]
    ds_read_b64_tr_b16 v[52:53], v4 offset:45056
    v_mfma_f32_16x16x32_bf16 v[148:151], v[56:59], v[172:175], v[148:151]
    ds_read_b64_tr_b16 v[54:55], v4 offset:46080
    v_mfma_f32_16x16x32_bf16 v[152:155], v[60:63], v[168:171], v[152:155]
    ds_read_b64_tr_b16 v[56:57], v5 offset:45056
    v_mfma_f32_16x16x32_bf16 v[156:159], v[60:63], v[172:175], v[156:159]
    ds_read_b64_tr_b16 v[58:59], v5 offset:46080
    s_waitcnt lgkmcnt(10)
    v_mfma_f32_16x16x32_bf16 v[128:131], v[32:35], v[176:179], v[128:131]
    ds_read_b64_tr_b16 v[60:61], v6 offset:45056
    v_mfma_f32_16x16x32_bf16 v[132:135], v[32:35], v[180:183], v[132:135]
    ds_read_b64_tr_b16 v[62:63], v6 offset:46080
    v_mfma_f32_16x16x32_bf16 v[136:139], v[36:39], v[176:179], v[136:139]
    ds_read_b64_tr_b16 v[32:33], v3 offset:49152
    v_mfma_f32_16x16x32_bf16 v[140:143], v[36:39], v[180:183], v[140:143]
    ds_read_b64_tr_b16 v[34:35], v3 offset:50176
    s_waitcnt lgkmcnt(10)
    v_mfma_f32_16x16x32_bf16 v[144:147], v[40:43], v[176:179], v[144:147]
    ds_read_b64_tr_b16 v[36:37], v4 offset:49152
    v_mfma_f32_16x16x32_bf16 v[148:151], v[40:43], v[180:183], v[148:151]
    ds_read_b64_tr_b16 v[38:39], v4 offset:50176
    v_mfma_f32_16x16x32_bf16 v[152:155], v[44:47], v[176:179], v[152:155]
    ds_read_b64_tr_b16 v[40:41], v5 offset:49152
    v_mfma_f32_16x16x32_bf16 v[156:159], v[44:47], v[180:183], v[156:159]
    ds_read_b64_tr_b16 v[42:43], v5 offset:50176
    s_waitcnt lgkmcnt(10)
    v_mfma_f32_16x16x32_bf16 v[128:131], v[48:51], v[184:187], v[128:131]
    ds_read_b64_tr_b16 v[44:45], v6 offset:49152
    ds_read_b32 v8, v9 offset:4096
    v_mfma_f32_16x16x32_bf16 v[132:135], v[48:51], v[188:191], v[132:135]
    ds_read_b64_tr_b16 v[46:47], v6 offset:50176
    ds_read_b32 v10, v9 offset:4608
    v_mfma_f32_16x16x32_bf16 v[136:139], v[52:55], v[184:187], v[136:139]
    ds_read_b64_tr_b16 v[48:49], v3 offset:53248
    ds_read_b32 v12, v9 offset:4160
    v_mfma_f32_16x16x32_bf16 v[140:143], v[52:55], v[188:191], v[140:143]
    ds_read_b64_tr_b16 v[50:51], v3 offset:54272
    ds_read_b32 v14, v9 offset:4672
    s_waitcnt lgkmcnt(14)
    v_mfma_f32_16x16x32_bf16 v[144:147], v[56:59], v[184:187], v[144:147]
    ds_read_b64_tr_b16 v[52:53], v4 offset:53248
    ds_read_b128 v[16:19], v11 offset:0
    v_mfma_f32_16x16x32_bf16 v[148:151], v[56:59], v[188:191], v[148:151]
    ds_read_b64_tr_b16 v[54:55], v4 offset:54272
    ds_read_b128 v[20:23], v11 offset:64
    v_mfma_f32_16x16x32_bf16 v[152:155], v[60:63], v[184:187], v[152:155]
    ds_read_b64_tr_b16 v[56:57], v5 offset:53248
    ds_read_b128 v[24:27], v11 offset:128
    v_mfma_f32_16x16x32_bf16 v[156:159], v[60:63], v[188:191], v[156:159]
    ds_read_b64_tr_b16 v[58:59], v5 offset:54272
    ds_read_b128 v[28:31], v11 offset:192
    s_waitcnt lgkmcnt(14)
    v_mfma_f32_16x16x32_bf16 v[128:131], v[32:35], v[192:195], v[128:131]
    ds_read_b64_tr_b16 v[60:61], v6 offset:53248
    v_add_u32 v13, 153600, v1
    v_mfma_f32_16x16x32_bf16 v[132:135], v[32:35], v[196:199], v[132:135]
    ds_read_b64_tr_b16 v[62:63], v6 offset:54272
    v_mfma_f32_16x16x32_bf16 v[136:139], v[36:39], v[192:195], v[136:139]
    ds_read_b64_tr_b16 v[32:33], v3 offset:57344
    v_mfma_f32_16x16x32_bf16 v[140:143], v[36:39], v[196:199], v[140:143]
    ds_read_b64_tr_b16 v[34:35], v3 offset:58368
    s_waitcnt lgkmcnt(14)
    v_mfma_f32_16x16x32_bf16 v[144:147], v[40:43], v[192:195], v[144:147]
    ds_read_b64_tr_b16 v[36:37], v4 offset:57344
    v_mfma_f32_16x16x32_bf16 v[148:151], v[40:43], v[196:199], v[148:151]
    ds_read_b64_tr_b16 v[38:39], v4 offset:58368
    v_mfma_f32_16x16x32_bf16 v[152:155], v[44:47], v[192:195], v[152:155]
    ds_read_b64_tr_b16 v[40:41], v5 offset:57344
    v_mfma_f32_16x16x32_bf16 v[156:159], v[44:47], v[196:199], v[156:159]
    ds_read_b64_tr_b16 v[42:43], v5 offset:58368
    s_waitcnt lgkmcnt(13)
    v_mfma_f32_16x16x32_bf16 v[128:131], v[48:51], v[200:203], v[128:131]
    ds_read_b64_tr_b16 v[44:45], v6 offset:57344
    s_waitcnt lgkmcnt(9)
    v_mfma_f32_16x16x32_bf16 v[132:135], v[48:51], v[204:207], v[132:135]
    ds_read_b64_tr_b16 v[46:47], v6 offset:58368
    v_mul_f32 v10, 0x3e8293ee, v10
    v_mfma_f32_16x16x32_bf16 v[136:139], v[52:55], v[200:203], v[136:139]
    ds_read_b64_tr_b16 v[48:49], v3 offset:61440
    v_mul_f32 v14, 0x3e8293ee, v14
    v_mfma_f32_16x16x32_bf16 v[140:143], v[52:55], v[204:207], v[140:143]
    ds_read_b64_tr_b16 v[50:51], v3 offset:62464
    ds_read_b128 v[120:123], v13 offset:0
    s_waitcnt lgkmcnt(11)
    v_mfma_f32_16x16x32_bf16 v[144:147], v[56:59], v[200:203], v[144:147]
    ds_read_b64_tr_b16 v[52:53], v4 offset:61440
    ds_read_b128 v[124:127], v13 offset:1024
    v_mfma_f32_16x16x32_bf16 v[148:151], v[56:59], v[204:207], v[148:151]
    ds_read_b64_tr_b16 v[54:55], v4 offset:62464
    v_mfma_f32_16x16x32_bf16 v[152:155], v[60:63], v[200:203], v[152:155]
    ds_read_b64_tr_b16 v[56:57], v5 offset:61440
    v_mfma_f32_16x16x32_bf16 v[156:159], v[60:63], v[204:207], v[156:159]
    ds_read_b64_tr_b16 v[58:59], v5 offset:62464
    s_waitcnt lgkmcnt(12)
    v_mfma_f32_16x16x32_bf16 v[128:131], v[32:35], v[208:211], v[128:131]
    ds_read_b64_tr_b16 v[60:61], v6 offset:61440
    v_mfma_f32_16x16x32_bf16 v[132:135], v[32:35], v[212:215], v[132:135]
    ds_read_b64_tr_b16 v[62:63], v6 offset:62464
    v_xor_b32 v3, 0x10000, v3
    v_xor_b32 v4, 0x10000, v4
    v_xor_b32 v5, 0x10000, v5
    v_xor_b32 v6, 0x10000, v6
    v_mfma_f32_16x16x32_bf16 v[136:139], v[36:39], v[208:211], v[136:139]
    v_mfma_f32_16x16x32_bf16 v[140:143], v[36:39], v[212:215], v[140:143]
    s_waitcnt lgkmcnt(10)
    v_mfma_f32_16x16x32_bf16 v[144:147], v[40:43], v[208:211], v[144:147]
    v_mfma_f32_16x16x32_bf16 v[148:151], v[40:43], v[212:215], v[148:151]
    v_mfma_f32_16x16x32_bf16 v[152:155], v[44:47], v[208:211], v[152:155]
    v_mfma_f32_16x16x32_bf16 v[156:159], v[44:47], v[212:215], v[156:159]
    s_waitcnt lgkmcnt(4)
    v_mfma_f32_16x16x32_bf16 v[128:131], v[48:51], v[216:219], v[128:131]
    v_mfma_f32_16x16x32_bf16 v[132:135], v[48:51], v[220:223], v[132:135]
    v_mfma_f32_16x16x32_bf16 v[136:139], v[52:55], v[216:219], v[136:139]
    v_mfma_f32_16x16x32_bf16 v[140:143], v[52:55], v[220:223], v[140:143]
    s_waitcnt lgkmcnt(0)
    v_mfma_f32_16x16x32_bf16 v[144:147], v[56:59], v[216:219], v[144:147]
    v_mfma_f32_16x16x32_bf16 v[148:151], v[56:59], v[220:223], v[148:151]
    v_mfma_f32_16x16x32_bf16 v[152:155], v[60:63], v[216:219], v[152:155]
    v_mfma_f32_16x16x32_bf16 v[156:159], v[60:63], v[220:223], v[156:159]
    s_lshl_b32 s44, s21, 22
    s_lshl_b32 s45, s38, 16
    s_add_u32 s44, s44, s45
    s_lshl_b32 s45, s18, 12
    s_add_u32 s44, s44, s45
    s_add_u32 s52, s44, 16777216
    v_pk_fma_f32 v[132:133], v[12:13], v[16:17], v[132:133] op_sel_hi:[0,1,1] neg_lo:[1,0,0] neg_hi:[1,0,0]
    v_pk_fma_f32 v[134:135], v[12:13], v[18:19], v[134:135] op_sel_hi:[0,1,1] neg_lo:[1,0,0] neg_hi:[1,0,0]
    v_pk_fma_f32 v[140:141], v[12:13], v[20:21], v[140:141] op_sel_hi:[0,1,1] neg_lo:[1,0,0] neg_hi:[1,0,0]
    v_pk_fma_f32 v[142:143], v[12:13], v[22:23], v[142:143] op_sel_hi:[0,1,1] neg_lo:[1,0,0] neg_hi:[1,0,0]
    v_pk_fma_f32 v[148:149], v[12:13], v[24:25], v[148:149] op_sel_hi:[0,1,1] neg_lo:[1,0,0] neg_hi:[1,0,0]
    v_pk_fma_f32 v[150:151], v[12:13], v[26:27], v[150:151] op_sel_hi:[0,1,1] neg_lo:[1,0,0] neg_hi:[1,0,0]
    v_pk_fma_f32 v[156:157], v[12:13], v[28:29], v[156:157] op_sel_hi:[0,1,1] neg_lo:[1,0,0] neg_hi:[1,0,0]
    v_pk_fma_f32 v[158:159], v[12:13], v[30:31], v[158:159] op_sel_hi:[0,1,1] neg_lo:[1,0,0] neg_hi:[1,0,0]
    v_pk_mul_f32 v[132:133], v[14:15], v[132:133] op_sel_hi:[0,1]
    v_pk_mul_f32 v[134:135], v[14:15], v[134:135] op_sel_hi:[0,1]
    v_pk_mul_f32 v[140:141], v[14:15], v[140:141] op_sel_hi:[0,1]
    v_pk_mul_f32 v[142:143], v[14:15], v[142:143] op_sel_hi:[0,1]
    v_pk_mul_f32 v[148:149], v[14:15], v[148:149] op_sel_hi:[0,1]
    v_pk_mul_f32 v[150:151], v[14:15], v[150:151] op_sel_hi:[0,1]
    v_pk_mul_f32 v[156:157], v[14:15], v[156:157] op_sel_hi:[0,1]
    v_pk_mul_f32 v[158:159], v[14:15], v[158:159] op_sel_hi:[0,1]
    v_cvt_pk_bf16_f32 v132, v132, v133
    v_cvt_pk_bf16_f32 v133, v134, v135
    v_cvt_pk_bf16_f32 v134, v140, v141
    v_cvt_pk_bf16_f32 v135, v142, v143
    v_cvt_pk_bf16_f32 v148, v148, v149
    v_cvt_pk_bf16_f32 v149, v150, v151
    v_cvt_pk_bf16_f32 v150, v156, v157
    v_cvt_pk_bf16_f32 v151, v158, v159
    v_mfma_f32_16x16x32_bf16 v[172:175], v[68:71], v[132:135], v[120:123]
    v_mfma_f32_16x16x32_bf16 v[168:171], v[64:67], v[132:135], v[124:127]
    v_mfma_f32_16x16x32_bf16 v[188:191], v[84:87], v[148:151], v[120:123]
    v_mfma_f32_16x16x32_bf16 v[184:187], v[80:83], v[148:151], v[124:127]
    v_pk_fma_f32 v[128:129], v[8:9], v[16:17], v[128:129] op_sel_hi:[0,1,1] neg_lo:[1,0,0] neg_hi:[1,0,0]
    v_pk_fma_f32 v[130:131], v[8:9], v[18:19], v[130:131] op_sel_hi:[0,1,1] neg_lo:[1,0,0] neg_hi:[1,0,0]
    v_pk_fma_f32 v[136:137], v[8:9], v[20:21], v[136:137] op_sel_hi:[0,1,1] neg_lo:[1,0,0] neg_hi:[1,0,0]
    v_pk_fma_f32 v[138:139], v[8:9], v[22:23], v[138:139] op_sel_hi:[0,1,1] neg_lo:[1,0,0] neg_hi:[1,0,0]
    v_pk_fma_f32 v[144:145], v[8:9], v[24:25], v[144:145] op_sel_hi:[0,1,1] neg_lo:[1,0,0] neg_hi:[1,0,0]
    v_pk_fma_f32 v[146:147], v[8:9], v[26:27], v[146:147] op_sel_hi:[0,1,1] neg_lo:[1,0,0] neg_hi:[1,0,0]
    v_pk_fma_f32 v[152:153], v[8:9], v[28:29], v[152:153] op_sel_hi:[0,1,1] neg_lo:[1,0,0] neg_hi:[1,0,0]
    v_pk_fma_f32 v[154:155], v[8:9], v[30:31], v[154:155] op_sel_hi:[0,1,1] neg_lo:[1,0,0] neg_hi:[1,0,0]
    v_pk_mul_f32 v[128:129], v[10:11], v[128:129] op_sel_hi:[0,1]
    v_pk_mul_f32 v[130:131], v[10:11], v[130:131] op_sel_hi:[0,1]
    v_pk_mul_f32 v[136:137], v[10:11], v[136:137] op_sel_hi:[0,1]
    v_pk_mul_f32 v[138:139], v[10:11], v[138:139] op_sel_hi:[0,1]
    v_pk_mul_f32 v[144:145], v[10:11], v[144:145] op_sel_hi:[0,1]
    v_pk_mul_f32 v[146:147], v[10:11], v[146:147] op_sel_hi:[0,1]
    v_pk_mul_f32 v[152:153], v[10:11], v[152:153] op_sel_hi:[0,1]
    v_pk_mul_f32 v[154:155], v[10:11], v[154:155] op_sel_hi:[0,1]
    v_cvt_pk_bf16_f32 v128, v128, v129
    v_cvt_pk_bf16_f32 v129, v130, v131
    v_cvt_pk_bf16_f32 v130, v136, v137
    v_cvt_pk_bf16_f32 v131, v138, v139
    v_cvt_pk_bf16_f32 v144, v144, v145
    v_cvt_pk_bf16_f32 v145, v146, v147
    v_cvt_pk_bf16_f32 v146, v152, v153
    v_cvt_pk_bf16_f32 v147, v154, v155
    v_mfma_f32_16x16x32_bf16 v[164:167], v[64:67], v[128:131], v[120:123]
    s_nop 0
    v_mfma_f32_16x16x32_bf16 v[180:183], v[80:83], v[144:147], v[120:123]
    v_mov_b32 v232, 0x3f803f80
    v_mov_b32 v233, 0x3f803f80
    v_mov_b32 v234, 0x3f803f80
    v_mov_b32 v235, 0x3f803f80
    v_exp_f32 v172, v172
    v_exp_f32 v173, v173
    v_exp_f32 v174, v174
    v_exp_f32 v175, v175
    v_exp_f32 v188, v188
    v_exp_f32 v189, v189
    v_exp_f32 v190, v190
    v_exp_f32 v191, v191
    s_mov_b32 s46, 1006632960
a_exp1:
    v_exp_f32 v168, v168
    v_exp_f32 v169, v169
    v_exp_f32 v170, v170
    v_exp_f32 v171, v171
    v_exp_f32 v184, v184
    v_exp_f32 v185, v185
    v_exp_f32 v186, v186
    v_exp_f32 v187, v187
    v_cvt_pk_bf16_f32 v200, v168, v169
    v_cvt_pk_bf16_f32 v201, v170, v171
    v_cvt_pk_bf16_f32 v202, v172, v173
    v_cvt_pk_bf16_f32 v203, v174, v175
    v_cvt_pk_bf16_f32 v204, v184, v185
    v_cvt_pk_bf16_f32 v205, v186, v187
    v_cvt_pk_bf16_f32 v206, v188, v189
    v_cvt_pk_bf16_f32 v207, v190, v191
    v_mfma_f32_16x16x32_bf16 v[16:19], v[232:235], v[200:203], 0
    s_nop 0
    v_mfma_f32_16x16x32_bf16 v[20:23], v[232:235], v[204:207], 0
    v_mfma_f32_16x16x32_bf16 v[40:43], v[72:75], v[200:203], 0
    v_mfma_f32_16x16x32_bf16 v[44:47], v[76:79], v[200:203], 0
    v_mfma_f32_16x16x32_bf16 v[56:59], v[88:91], v[204:207], 0
    v_mfma_f32_16x16x32_bf16 v[60:63], v[92:95], v[204:207], 0
    v_mov_b32 v218, v72
    v_mov_b32 v219, v73
    v_mov_b32 v222, v76
    v_mov_b32 v223, v77
    v_mov_b32 v226, v88
    v_mov_b32 v227, v89
    v_mov_b32 v230, v92
    v_mov_b32 v231, v93
    v_subrev_u32 v18, 0x21800000, v16
    v_subrev_u32 v22, 0x21800000, v20
    v_max_u32 v18, v18, v22
    v_cmp_le_u32 vcc, s46, v18
    v_rcp_f32 v16, v16
    v_rcp_f32 v20, v20
    s_cbranch_vccnz a_slow1
a_fin1:
    v_pk_mul_f32 v[40:41], v[16:17], v[40:41] op_sel_hi:[0,1]
    v_pk_mul_f32 v[42:43], v[16:17], v[42:43] op_sel_hi:[0,1]
    v_pk_mul_f32 v[44:45], v[16:17], v[44:45] op_sel_hi:[0,1]
    v_pk_mul_f32 v[46:47], v[16:17], v[46:47] op_sel_hi:[0,1]
    v_pk_mul_f32 v[56:57], v[20:21], v[56:57] op_sel_hi:[0,1]
    v_pk_mul_f32 v[58:59], v[20:21], v[58:59] op_sel_hi:[0,1]
    v_pk_mul_f32 v[60:61], v[20:21], v[60:61] op_sel_hi:[0,1]
    v_pk_mul_f32 v[62:63], v[20:21], v[62:63] op_sel_hi:[0,1]
    v_cvt_pk_bf16_f32 v40, v40, v41
    v_cvt_pk_bf16_f32 v41, v42, v43
    v_cvt_pk_bf16_f32 v42, v44, v45
    v_cvt_pk_bf16_f32 v43, v46, v47
    v_cvt_pk_bf16_f32 v56, v56, v57
    v_cvt_pk_bf16_f32 v57, v58, v59
    v_cvt_pk_bf16_f32 v58, v60, v61
    v_cvt_pk_bf16_f32 v59, v62, v63
    v_permlane32_swap_b32 v40, v42
    v_permlane32_swap_b32 v41, v43
    buffer_store_dwordx4 v[40:43], v2, s[4:7], s52 offen offset:256 sc1
    v_permlane32_swap_b32 v56, v58
    v_permlane32_swap_b32 v57, v59
    buffer_store_dwordx4 v[56:59], v2, s[4:7], s52 offen offset:2304 sc1
    s_cmp_lg_u32 s38, 0
    s_cbranch_scc1 a_hasprev
    v_mov_b32 v124, 0xf149f2ca
    v_mov_b32 v125, 0xf149f2ca
    v_mov_b32 v126, 0xf149f2ca
    v_mov_b32 v127, 0xf149f2ca
a_hasprev:
    s_waitcnt lgkmcnt(0)
    s_barrier
    ds_read_b128 v[192:195], v7 offset:0
    ds_read_b128 v[196:199], v7 offset:1024
    ds_read_b64 v[216:217], v7 offset:2048
    ds_read_b64 v[220:221], v7 offset:2056
    ds_read_b64 v[224:225], v7 offset:3072
    ds_read_b64 v[228:229], v7 offset:3080
    s_waitcnt lgkmcnt(4)
    v_mfma_f32_16x16x32_bf16 v[160:163], v[192:195], v[128:131], v[124:127]
    v_mfma_f32_16x16x32_bf16 v[176:179], v[196:199], v[144:147], v[124:127]
    v_exp_f32 v164, v164
    v_exp_f32 v165, v165
    v_exp_f32 v166, v166
    v_exp_f32 v167, v167
    v_exp_f32 v180, v180
    v_exp_f32 v181, v181
    v_exp_f32 v182, v182
    v_exp_f32 v183, v183
    s_waitcnt lgkmcnt(0)
    s_mov_b32 s46, 1006632960
a_exp0:
    v_exp_f32 v160, v160
    v_exp_f32 v161, v161
    v_exp_f32 v162, v162
    v_exp_f32 v163, v163
    v_exp_f32 v176, v176
    v_exp_f32 v177, v177
    v_exp_f32 v178, v178
    v_exp_f32 v179, v179
    v_cvt_pk_bf16_f32 v200, v160, v161
    v_cvt_pk_bf16_f32 v201, v162, v163
    v_cvt_pk_bf16_f32 v202, v164, v165
    v_cvt_pk_bf16_f32 v203, v166, v167
    v_cvt_pk_bf16_f32 v204, v176, v177
    v_cvt_pk_bf16_f32 v205, v178, v179
    v_cvt_pk_bf16_f32 v206, v180, v181
    v_cvt_pk_bf16_f32 v207, v182, v183
    v_mfma_f32_16x16x32_bf16 v[16:19], v[232:235], v[200:203], 0
    s_nop 0
    v_mfma_f32_16x16x32_bf16 v[20:23], v[232:235], v[204:207], 0
    v_mfma_f32_16x16x32_bf16 v[32:35], v[216:219], v[200:203], 0
    v_mfma_f32_16x16x32_bf16 v[36:39], v[220:223], v[200:203], 0
    v_mfma_f32_16x16x32_bf16 v[48:51], v[224:227], v[204:207], 0
    v_mfma_f32_16x16x32_bf16 v[52:55], v[228:231], v[204:207], 0
    s_nop 1
    v_subrev_u32 v18, 0x21800000, v16
    s_nop 0
    v_subrev_u32 v22, 0x21800000, v20
    v_max_u32 v18, v18, v22
    v_cmp_le_u32 vcc, s46, v18
    v_rcp_f32 v16, v16
    v_rcp_f32 v20, v20
    s_cbranch_vccnz a_slow0
a_fin0:
    v_pk_mul_f32 v[32:33], v[16:17], v[32:33] op_sel_hi:[0,1]
    v_pk_mul_f32 v[34:35], v[16:17], v[34:35] op_sel_hi:[0,1]
    v_pk_mul_f32 v[36:37], v[16:17], v[36:37] op_sel_hi:[0,1]
    v_pk_mul_f32 v[38:39], v[16:17], v[38:39] op_sel_hi:[0,1]
    v_pk_mul_f32 v[48:49], v[20:21], v[48:49] op_sel_hi:[0,1]
    v_pk_mul_f32 v[50:51], v[20:21], v[50:51] op_sel_hi:[0,1]
    v_pk_mul_f32 v[52:53], v[20:21], v[52:53] op_sel_hi:[0,1]
    v_pk_mul_f32 v[54:55], v[20:21], v[54:55] op_sel_hi:[0,1]
    v_cvt_pk_bf16_f32 v32, v32, v33
    v_cvt_pk_bf16_f32 v33, v34, v35
    v_cvt_pk_bf16_f32 v34, v36, v37
    v_cvt_pk_bf16_f32 v35, v38, v39
    v_cvt_pk_bf16_f32 v48, v48, v49
    v_cvt_pk_bf16_f32 v49, v50, v51
    v_cvt_pk_bf16_f32 v50, v52, v53
    v_cvt_pk_bf16_f32 v51, v54, v55
    v_permlane32_swap_b32 v32, v34
    v_permlane32_swap_b32 v33, v35
    buffer_store_dwordx4 v[32:35], v2, s[4:7], s52 offen offset:0 sc1
    v_permlane32_swap_b32 v48, v50
    v_permlane32_swap_b32 v49, v51
    buffer_store_dwordx4 v[48:51], v2, s[4:7], s52 offen offset:2048 sc1
    s_lshl_b32 s44, s21, 22
    s_lshl_b32 s45, s38, 16
    s_add_u32 s41, s44, s45
    s_lshl_b32 s45, s18, 12
    s_add_u32 s43, s41, s45
    s_and_b32 s45, s45, 0
    s_add_u32 s41, s41, s45
    s_add_u32 s41, s41, 16777216
    buffer_load_dwordx4 v[224:227], v2, s[4:7], s43 offen offset:0 sc1
    buffer_load_dwordx4 v[228:231], v2, s[4:7], s43 offen offset:256 sc1
    buffer_load_dwordx4 v[232:235], v2, s[4:7], s43 offen offset:2048 sc1
    buffer_load_dwordx4 v[236:239], v2, s[4:7], s43 offen offset:2304 sc1
    s_barrier
    s_lshl_b32 s46, s21, 14
    s_lshl_b32 s67, s38, 8
    s_add_u32 s46, s46, s67
    s_add_u32 s46, s46, 86144
    s_lshl_b32 s47, s21, 14
    s_lshl_b32 s67, s38, 8
    s_add_u32 s47, s47, s67
    s_add_u32 s47, s47, 86144
    s_waitcnt vmcnt(4)
    s_atomic_add s40, s[22:23], s46
    s_mov_b32 s66, 0x10000
c_o_poll:
    s_mov_b32 s68, 0
    s_atomic_add s68, s[22:23], s47 offset:0 glc
    s_sub_u32 s66, s66, 1
    s_cselect_b32 s67, 16, 0
    s_waitcnt lgkmcnt(0)
    s_max_u32 s68, s68, s67
    s_cmp_lt_u32 s68, 16
    s_cbranch_scc1 c_o_poll
c_o_ok:
    s_branch c_wo
a_slow1:
    s_cmp_eq_u32 s46, 0
    s_cbranch_scc1 a_fin1
    s_mov_b32 s46, 0
    v_mfma_f32_16x16x32_bf16 v[172:175], v[68:71], v[132:135], v[120:123]
    v_mfma_f32_16x16x32_bf16 v[168:171], v[64:67], v[132:135], v[124:127]
    v_mfma_f32_16x16x32_bf16 v[188:191], v[84:87], v[148:151], v[120:123]
    v_mfma_f32_16x16x32_bf16 v[184:187], v[80:83], v[148:151], v[124:127]
    s_nop 5
    v_max3_f32 v24, v168, v169, v170
    v_max3_f32 v24, v24, v171, v172
    v_max3_f32 v24, v24, v173, v174
    v_max_f32 v24, v24, v175
    v_max3_f32 v26, v184, v185, v186
    v_max3_f32 v26, v26, v187, v188
    v_max3_f32 v26, v26, v189, v190
    v_max_f32 v26, v26, v191
    v_mov_b32 v25, v24
    v_mov_b32 v27, v26
    s_nop 0
    v_permlane32_swap_b32 v24, v25
    v_permlane32_swap_b32 v26, v27
    v_max_f32 v24, v24, v25
    v_max_f32 v26, v26, v27
    v_mov_b32 v25, v24
    v_mov_b32 v27, v26
    s_nop 0
    v_permlane16_swap_b32 v24, v25
    v_permlane16_swap_b32 v26, v27
    v_max_f32 v24, v24, v25
    v_max_f32 v26, v26, v27
    v_sub_f32 v168, v168, v24
    v_sub_f32 v169, v169, v24
    v_sub_f32 v170, v170, v24
    v_sub_f32 v171, v171, v24
    v_sub_f32 v172, v172, v24
    v_sub_f32 v173, v173, v24
    v_sub_f32 v174, v174, v24
    v_sub_f32 v175, v175, v24
    v_sub_f32 v184, v184, v26
    v_sub_f32 v185, v185, v26
    v_sub_f32 v186, v186, v26
    v_sub_f32 v187, v187, v26
    v_sub_f32 v188, v188, v26
    v_sub_f32 v189, v189, v26
    v_sub_f32 v190, v190, v26
    v_sub_f32 v191, v191, v26
    v_exp_f32 v172, v172
    v_exp_f32 v173, v173
    v_exp_f32 v174, v174
    v_exp_f32 v175, v175
    v_exp_f32 v188, v188
    v_exp_f32 v189, v189
    v_exp_f32 v190, v190
    v_exp_f32 v191, v191
    s_branch a_exp1
a_slow0:
    s_cmp_eq_u32 s46, 0
    s_cbranch_scc1 a_fin0
    s_mov_b32 s46, 0
    v_mfma_f32_16x16x32_bf16 v[164:167], v[64:67], v[128:131], v[120:123]
    v_mfma_f32_16x16x32_bf16 v[160:163], v[192:195], v[128:131], v[124:127]
    v_mfma_f32_16x16x32_bf16 v[180:183], v[80:83], v[144:147], v[120:123]
    v_mfma_f32_16x16x32_bf16 v[176:179], v[196:199], v[144:147], v[124:127]
    s_nop 5
    v_max3_f32 v24, v160, v161, v162
    v_max3_f32 v24, v24, v163, v164
    v_max3_f32 v24, v24, v165, v166
    v_max_f32 v24, v24, v167
    v_max3_f32 v26, v176, v177, v178
    v_max3_f32 v26, v26, v179, v180
    v_max3_f32 v26, v26, v181, v182
    v_max_f32 v26, v26, v183
    v_mov_b32 v25, v24
    v_mov_b32 v27, v26
    s_nop 0
    v_permlane32_swap_b32 v24, v25
    v_permlane32_swap_b32 v26, v27
    v_max_f32 v24, v24, v25
    v_max_f32 v26, v26, v27
    v_mov_b32 v25, v24
    v_mov_b32 v27, v26
    s_nop 0
    v_permlane16_swap_b32 v24, v25
    v_permlane16_swap_b32 v26, v27
    v_max_f32 v24, v24, v25
    v_max_f32 v26, v26, v27
    v_sub_f32 v160, v160, v24
    v_sub_f32 v161, v161, v24
    v_sub_f32 v162, v162, v24
    v_sub_f32 v163, v163, v24
    v_sub_f32 v164, v164, v24
    v_sub_f32 v165, v165, v24
    v_sub_f32 v166, v166, v24
    v_sub_f32 v167, v167, v24
    v_sub_f32 v176, v176, v26
    v_sub_f32 v177, v177, v26
    v_sub_f32 v178, v178, v26
    v_sub_f32 v179, v179, v26
    v_sub_f32 v180, v180, v26
    v_sub_f32 v181, v181, v26
    v_sub_f32 v182, v182, v26
    v_sub_f32 v183, v183, v26
    v_exp_f32 v164, v164
    v_exp_f32 v165, v165
    v_exp_f32 v166, v166
    v_exp_f32 v167, v167
    v_exp_f32 v180, v180
    v_exp_f32 v181, v181
    v_exp_f32 v182, v182
    v_exp_f32 v183, v183
    s_branch a_exp0
c_B:
    s_waitcnt lgkmcnt(6)
    v_pk_fma_f32 v[64:65], v[8:9], v[16:17], v[64:65] op_sel_hi:[0,1,1] neg_lo:[1,0,0] neg_hi:[1,0,0]
    v_pk_fma_f32 v[66:67], v[8:9], v[18:19], v[66:67] op_sel_hi:[0,1,1] neg_lo:[1,0,0] neg_hi:[1,0,0]
    v_pk_fma_f32 v[72:73], v[8:9], v[20:21], v[72:73] op_sel_hi:[0,1,1] neg_lo:[1,0,0] neg_hi:[1,0,0]
    v_pk_fma_f32 v[74:75], v[8:9], v[22:23], v[74:75] op_sel_hi:[0,1,1] neg_lo:[1,0,0] neg_hi:[1,0,0]
    v_pk_mul_f32 v[64:65], v[10:11], v[64:65] op_sel_hi:[0,1]
    v_pk_mul_f32 v[66:67], v[10:11], v[66:67] op_sel_hi:[0,1]
    v_pk_mul_f32 v[72:73], v[10:11], v[72:73] op_sel_hi:[0,1]
    v_pk_mul_f32 v[74:75], v[10:11], v[74:75] op_sel_hi:[0,1]
    v_cvt_pk_bf16_f32 v64, v64, v65
    v_cvt_pk_bf16_f32 v65, v66, v67
    v_cvt_pk_bf16_f32 v66, v72, v73
    v_cvt_pk_bf16_f32 v67, v74, v75
    s_add_u32 s55, s52, 0
    buffer_store_dwordx4 v[64:67], v2, s[4:7], s55 offen offset:0 sc1
    v_pk_fma_f32 v[68:69], v[12:13], v[16:17], v[68:69] op_sel_hi:[0,1,1] neg_lo:[1,0,0] neg_hi:[1,0,0]
    v_pk_fma_f32 v[70:71], v[12:13], v[18:19], v[70:71] op_sel_hi:[0,1,1] neg_lo:[1,0,0] neg_hi:[1,0,0]
    v_pk_fma_f32 v[76:77], v[12:13], v[20:21], v[76:77] op_sel_hi:[0,1,1] neg_lo:[1,0,0] neg_hi:[1,0,0]
    v_pk_fma_f32 v[78:79], v[12:13], v[22:23], v[78:79] op_sel_hi:[0,1,1] neg_lo:[1,0,0] neg_hi:[1,0,0]
    v_pk_mul_f32 v[68:69], v[14:15], v[68:69] op_sel_hi:[0,1]
    v_pk_mul_f32 v[70:71], v[14:15], v[70:71] op_sel_hi:[0,1]
    v_pk_mul_f32 v[76:77], v[14:15], v[76:77] op_sel_hi:[0,1]
    v_pk_mul_f32 v[78:79], v[14:15], v[78:79] op_sel_hi:[0,1]
    v_cvt_pk_bf16_f32 v68, v68, v69
    v_cvt_pk_bf16_f32 v69, v70, v71
    v_cvt_pk_bf16_f32 v70, v76, v77
    v_cvt_pk_bf16_f32 v71, v78, v79
    buffer_store_dwordx4 v[68:71], v2, s[4:7], s55 offen offset:256 sc1
    v_pk_fma_f32 v[80:81], v[8:9], v[24:25], v[80:81] op_sel_hi:[0,1,1] neg_lo:[1,0,0] neg_hi:[1,0,0]
    v_pk_fma_f32 v[82:83], v[8:9], v[26:27], v[82:83] op_sel_hi:[0,1,1] neg_lo:[1,0,0] neg_hi:[1,0,0]
    v_pk_fma_f32 v[88:89], v[8:9], v[28:29], v[88:89] op_sel_hi:[0,1,1] neg_lo:[1,0,0] neg_hi:[1,0,0]
    v_pk_fma_f32 v[90:91], v[8:9], v[30:31], v[90:91] op_sel_hi:[0,1,1] neg_lo:[1,0,0] neg_hi:[1,0,0]
    v_pk_mul_f32 v[80:81], v[10:11], v[80:81] op_sel_hi:[0,1]
    v_pk_mul_f32 v[82:83], v[10:11], v[82:83] op_sel_hi:[0,1]
    v_pk_mul_f32 v[88:89], v[10:11], v[88:89] op_sel_hi:[0,1]
    v_pk_mul_f32 v[90:91], v[10:11], v[90:91] op_sel_hi:[0,1]
    v_cvt_pk_bf16_f32 v80, v80, v81
    v_cvt_pk_bf16_f32 v81, v82, v83
    v_cvt_pk_bf16_f32 v82, v88, v89
    v_cvt_pk_bf16_f32 v83, v90, v91
    s_add_u32 s55, s52, 131072
    buffer_store_dwordx4 v[80:83], v2, s[4:7], s55 offen offset:0 sc1
    v_pk_fma_f32 v[84:85], v[12:13], v[24:25], v[84:85] op_sel_hi:[0,1,1] neg_lo:[1,0,0] neg_hi:[1,0,0]
    v_pk_fma_f32 v[86:87], v[12:13], v[26:27], v[86:87] op_sel_hi:[0,1,1] neg_lo:[1,0,0] neg_hi:[1,0,0]
    v_pk_fma_f32 v[92:93], v[12:13], v[28:29], v[92:93] op_sel_hi:[0,1,1] neg_lo:[1,0,0] neg_hi:[1,0,0]
    v_pk_fma_f32 v[94:95], v[12:13], v[30:31], v[94:95] op_sel_hi:[0,1,1] neg_lo:[1,0,0] neg_hi:[1,0,0]
    v_pk_mul_f32 v[84:85], v[14:15], v[84:85] op_sel_hi:[0,1]
    v_pk_mul_f32 v[86:87], v[14:15], v[86:87] op_sel_hi:[0,1]
    v_pk_mul_f32 v[92:93], v[14:15], v[92:93] op_sel_hi:[0,1]
    v_pk_mul_f32 v[94:95], v[14:15], v[94:95] op_sel_hi:[0,1]
    v_cvt_pk_bf16_f32 v84, v84, v85
    v_cvt_pk_bf16_f32 v85, v86, v87
    v_cvt_pk_bf16_f32 v86, v92, v93
    v_cvt_pk_bf16_f32 v87, v94, v95
    buffer_store_dwordx4 v[84:87], v2, s[4:7], s55 offen offset:256 sc1
    v_mfma_f32_16x16x32_bf16 v[96:99], v[160:163], v[32:35], v[96:99]
    ds_read_b64_tr_b16 v[60:61], v6 offset:53248
    v_mfma_f32_16x16x32_bf16 v[100:103], v[164:167], v[32:35], v[100:103]
    ds_read_b64_tr_b16 v[62:63], v6 offset:54272
    v_mfma_f32_16x16x32_bf16 v[104:107], v[160:163], v[36:39], v[104:107]
    ds_read_b64_tr_b16 v[32:33], v3 offset:57344
    v_mfma_f32_16x16x32_bf16 v[108:111], v[164:167], v[36:39], v[108:111]
    ds_read_b64_tr_b16 v[34:35], v3 offset:58368
    v_mfma_f32_16x16x32_bf16 v[112:115], v[160:163], v[40:43], v[112:115]
    ds_read_b64_tr_b16 v[36:37], v4 offset:57344
    v_mfma_f32_16x16x32_bf16 v[116:119], v[164:167], v[40:43], v[116:119]
    ds_read_b64_tr_b16 v[38:39], v4 offset:58368
    v_mfma_f32_16x16x32_bf16 v[120:123], v[160:163], v[44:47], v[120:123]
    ds_read_b64_tr_b16 v[40:41], v5 offset:57344
    v_mfma_f32_16x16x32_bf16 v[124:127], v[164:167], v[44:47], v[124:127]
    ds_read_b64_tr_b16 v[42:43], v5 offset:58368
    s_waitcnt lgkmcnt(10)
    v_mfma_f32_16x16x32_bf16 v[96:99], v[168:171], v[48:51], v[96:99]
    ds_read_b64_tr_b16 v[44:45], v6 offset:57344
    v_mfma_f32_16x16x32_bf16 v[100:103], v[172:175], v[48:51], v[100:103]
    ds_read_b64_tr_b16 v[46:47], v6 offset:58368
    v_mfma_f32_16x16x32_bf16 v[104:107], v[168:171], v[52:55], v[104:107]
    ds_read_b64_tr_b16 v[48:49], v3 offset:61440
    v_mfma_f32_16x16x32_bf16 v[108:111], v[172:175], v[52:55], v[108:111]
    ds_read_b64_tr_b16 v[50:51], v3 offset:62464
    s_waitcnt lgkmcnt(10)
    v_mfma_f32_16x16x32_bf16 v[112:115], v[168:171], v[56:59], v[112:115]
    ds_read_b64_tr_b16 v[52:53], v4 offset:61440
    v_mfma_f32_16x16x32_bf16 v[116:119], v[172:175], v[56:59], v[116:119]
    ds_read_b64_tr_b16 v[54:55], v4 offset:62464
    v_mfma_f32_16x16x32_bf16 v[120:123], v[168:171], v[60:63], v[120:123]
    ds_read_b64_tr_b16 v[56:57], v5 offset:61440
    v_mfma_f32_16x16x32_bf16 v[124:127], v[172:175], v[60:63], v[124:127]
    ds_read_b64_tr_b16 v[58:59], v5 offset:62464
    s_waitcnt lgkmcnt(10)
    v_mfma_f32_16x16x32_bf16 v[96:99], v[176:179], v[32:35], v[96:99]
    ds_read_b64_tr_b16 v[60:61], v6 offset:61440
    v_mfma_f32_16x16x32_bf16 v[100:103], v[180:183], v[32:35], v[100:103]
    ds_read_b64_tr_b16 v[62:63], v6 offset:62464
    s_barrier
    v_xor_b32 v3, 0x10000, v3
    v_xor_b32 v4, 0x10000, v4
    v_xor_b32 v5, 0x10000, v5
    v_xor_b32 v6, 0x10000, v6
    v_mfma_f32_16x16x32_bf16 v[104:107], v[176:179], v[36:39], v[104:107]
    ds_read_b64_tr_b16 v[32:33], v3 offset:0
    v_mfma_f32_16x16x32_bf16 v[108:111], v[180:183], v[36:39], v[108:111]
    ds_read_b64_tr_b16 v[34:35], v3 offset:1024
    s_waitcnt lgkmcnt(10)
    v_mfma_f32_16x16x32_bf16 v[112:115], v[176:179], v[40:43], v[112:115]
    ds_read_b64_tr_b16 v[36:37], v4 offset:0
    v_mfma_f32_16x16x32_bf16 v[116:119], v[180:183], v[40:43], v[116:119]
    ds_read_b64_tr_b16 v[38:39], v4 offset:1024
    v_mfma_f32_16x16x32_bf16 v[120:123], v[176:179], v[44:47], v[120:123]
    ds_read_b64_tr_b16 v[40:41], v5 offset:0
    v_mfma_f32_16x16x32_bf16 v[124:127], v[180:183], v[44:47], v[124:127]
    ds_read_b64_tr_b16 v[42:43], v5 offset:1024
    s_waitcnt lgkmcnt(10)
    v_mfma_f32_16x16x32_bf16 v[96:99], v[184:187], v[48:51], v[96:99]
    ds_read_b64_tr_b16 v[44:45], v6 offset:0
    v_mfma_f32_16x16x32_bf16 v[100:103], v[188:191], v[48:51], v[100:103]
    ds_read_b64_tr_b16 v[46:47], v6 offset:1024
    v_mfma_f32_16x16x32_bf16 v[104:107], v[184:187], v[52:55], v[104:107]
    ds_read_b64_tr_b16 v[48:49], v3 offset:4096
    v_mfma_f32_16x16x32_bf16 v[108:111], v[188:191], v[52:55], v[108:111]
    ds_read_b64_tr_b16 v[50:51], v3 offset:5120
    s_waitcnt lgkmcnt(10)
    v_mfma_f32_16x16x32_bf16 v[112:115], v[184:187], v[56:59], v[112:115]
    ds_read_b64_tr_b16 v[52:53], v4 offset:4096
    v_mfma_f32_16x16x32_bf16 v[116:119], v[188:191], v[56:59], v[116:119]
    ds_read_b64_tr_b16 v[54:55], v4 offset:5120
    v_mfma_f32_16x16x32_bf16 v[120:123], v[184:187], v[60:63], v[120:123]
    ds_read_b64_tr_b16 v[56:57], v5 offset:4096
    v_mfma_f32_16x16x32_bf16 v[124:127], v[188:191], v[60:63], v[124:127]
    ds_read_b64_tr_b16 v[58:59], v5 offset:5120
    s_waitcnt lgkmcnt(10)
    v_mfma_f32_16x16x32_bf16 v[96:99], v[192:195], v[32:35], v[96:99]
    ds_read_b64_tr_b16 v[60:61], v6 offset:4096
    v_mfma_f32_16x16x32_bf16 v[100:103], v[196:199], v[32:35], v[100:103]
    ds_read_b64_tr_b16 v[62:63], v6 offset:5120
    v_mfma_f32_16x16x32_bf16 v[104:107], v[192:195], v[36:39], v[104:107]
    ds_read_b64_tr_b16 v[32:33], v3 offset:8192
    v_mfma_f32_16x16x32_bf16 v[108:111], v[196:199], v[36:39], v[108:111]
    ds_read_b64_tr_b16 v[34:35], v3 offset:9216
    s_waitcnt lgkmcnt(10)
    v_mfma_f32_16x16x32_bf16 v[112:115], v[192:195], v[40:43], v[112:115]
    ds_read_b64_tr_b16 v[36:37], v4 offset:8192
    v_mfma_f32_16x16x32_bf16 v[116:119], v[196:199], v[40:43], v[116:119]
    ds_read_b64_tr_b16 v[38:39], v4 offset:9216
    v_mfma_f32_16x16x32_bf16 v[120:123], v[192:195], v[44:47], v[120:123]
    ds_read_b64_tr_b16 v[40:41], v5 offset:8192
    v_mfma_f32_16x16x32_bf16 v[124:127], v[196:199], v[44:47], v[124:127]
    ds_read_b64_tr_b16 v[42:43], v5 offset:9216
    s_waitcnt lgkmcnt(10)
    v_mfma_f32_16x16x32_bf16 v[96:99], v[200:203], v[48:51], v[96:99]
    ds_read_b64_tr_b16 v[44:45], v6 offset:8192
    v_mfma_f32_16x16x32_bf16 v[100:103], v[204:207], v[48:51], v[100:103]
    ds_read_b64_tr_b16 v[46:47], v6 offset:9216
    v_mfma_f32_16x16x32_bf16 v[104:107], v[200:203], v[52:55], v[104:107]
    ds_read_b64_tr_b16 v[48:49], v3 offset:12288
    v_mfma_f32_16x16x32_bf16 v[108:111], v[204:207], v[52:55], v[108:111]
    ds_read_b64_tr_b16 v[50:51], v3 offset:13312
    s_waitcnt lgkmcnt(10)
    v_mfma_f32_16x16x32_bf16 v[112:115], v[200:203], v[56:59], v[112:115]
    ds_read_b64_tr_b16 v[52:53], v4 offset:12288
    v_mfma_f32_16x16x32_bf16 v[116:119], v[204:207], v[56:59], v[116:119]
    ds_read_b64_tr_b16 v[54:55], v4 offset:13312
    v_mfma_f32_16x16x32_bf16 v[120:123], v[200:203], v[60:63], v[120:123]
    ds_read_b64_tr_b16 v[56:57], v5 offset:12288
    v_mfma_f32_16x16x32_bf16 v[124:127], v[204:207], v[60:63], v[124:127]
    ds_read_b64_tr_b16 v[58:59], v5 offset:13312
    s_waitcnt lgkmcnt(10)
    v_mfma_f32_16x16x32_bf16 v[96:99], v[208:211], v[32:35], v[96:99]
    ds_read_b64_tr_b16 v[60:61], v6 offset:12288
    v_mfma_f32_16x16x32_bf16 v[100:103], v[212:215], v[32:35], v[100:103]
    ds_read_b64_tr_b16 v[62:63], v6 offset:13312
    v_mfma_f32_16x16x32_bf16 v[104:107], v[208:211], v[36:39], v[104:107]
    ds_read_b64_tr_b16 v[32:33], v3 offset:16384
    ds_read_b128 v[16:19], v13 offset:4096
    v_mfma_f32_16x16x32_bf16 v[108:111], v[212:215], v[36:39], v[108:111]
    ds_read_b64_tr_b16 v[34:35], v3 offset:17408
    ds_read_b128 v[20:23], v13 offset:4608
    s_waitcnt lgkmcnt(12)
    v_mfma_f32_16x16x32_bf16 v[112:115], v[208:211], v[40:43], v[112:115]
    ds_read_b64_tr_b16 v[36:37], v4 offset:16384
    ds_read_b128 v[24:27], v13 offset:4160
    v_mfma_f32_16x16x32_bf16 v[116:119], v[212:215], v[40:43], v[116:119]
    ds_read_b64_tr_b16 v[38:39], v4 offset:17408
    ds_read_b128 v[28:31], v13 offset:4672
    v_mfma_f32_16x16x32_bf16 v[120:123], v[208:211], v[44:47], v[120:123]
    ds_read_b64_tr_b16 v[40:41], v5 offset:16384
    ds_read_b32 v8, v15 offset:512
    v_mfma_f32_16x16x32_bf16 v[124:127], v[212:215], v[44:47], v[124:127]
    ds_read_b64_tr_b16 v[42:43], v5 offset:17408
    ds_read_b32 v10, v15 offset:576
    s_waitcnt lgkmcnt(14)
    v_mfma_f32_16x16x32_bf16 v[96:99], v[216:219], v[48:51], v[96:99]
    ds_read_b64_tr_b16 v[44:45], v6 offset:16384
    ds_read_b32 v12, v15 offset:640
    v_mfma_f32_16x16x32_bf16 v[100:103], v[220:223], v[48:51], v[100:103]
    ds_read_b64_tr_b16 v[46:47], v6 offset:17408
    ds_read_b32 v14, v15 offset:704
    v_mfma_f32_16x16x32_bf16 v[104:107], v[216:219], v[52:55], v[104:107]
    ds_read_b64_tr_b16 v[48:49], v3 offset:20480
    v_mfma_f32_16x16x32_bf16 v[108:111], v[220:223], v[52:55], v[108:111]
    ds_read_b64_tr_b16 v[50:51], v3 offset:21504
    s_waitcnt lgkmcnt(14)
    v_mfma_f32_16x16x32_bf16 v[112:115], v[216:219], v[56:59], v[112:115]
    ds_read_b64_tr_b16 v[52:53], v4 offset:20480
    v_mfma_f32_16x16x32_bf16 v[116:119], v[220:223], v[56:59], v[116:119]
    ds_read_b64_tr_b16 v[54:55], v4 offset:21504
    v_mfma_f32_16x16x32_bf16 v[120:123], v[216:219], v[60:63], v[120:123]
    ds_read_b64_tr_b16 v[56:57], v5 offset:20480
    v_mfma_f32_16x16x32_bf16 v[124:127], v[220:223], v[60:63], v[124:127]
    ds_read_b64_tr_b16 v[58:59], v5 offset:21504
    s_waitcnt lgkmcnt(6)
    v_pk_fma_f32 v[96:97], v[8:9], v[16:17], v[96:97] op_sel_hi:[0,1,1] neg_lo:[1,0,0] neg_hi:[1,0,0]
    v_pk_fma_f32 v[98:99], v[8:9], v[18:19], v[98:99] op_sel_hi:[0,1,1] neg_lo:[1,0,0] neg_hi:[1,0,0]
    v_pk_fma_f32 v[104:105], v[10:11], v[16:17], v[104:105] op_sel_hi:[0,1,1] neg_lo:[1,0,0] neg_hi:[1,0,0]
    v_pk_fma_f32 v[106:107], v[10:11], v[18:19], v[106:107] op_sel_hi:[0,1,1] neg_lo:[1,0,0] neg_hi:[1,0,0]
    v_pk_mul_f32 v[96:97], v[20:21], v[96:97]
    v_pk_mul_f32 v[98:99], v[22:23], v[98:99]
    v_pk_mul_f32 v[104:105], v[20:21], v[104:105]
    v_pk_mul_f32 v[106:107], v[22:23], v[106:107]
    v_cvt_pk_bf16_f32 v72, v96, v97
    v_cvt_pk_bf16_f32 v73, v98, v99
    v_cvt_pk_bf16_f32 v74, v104, v105
    v_cvt_pk_bf16_f32 v75, v106, v107
    s_add_u32 s56, s52, 4194304
    v_permlane16_swap_b32 v72, v74
    v_permlane16_swap_b32 v73, v75
    buffer_store_dwordx4 v[72:75], v1, s[4:7], s56 offen offset:0 sc1
    v_pk_fma_f32 v[112:113], v[12:13], v[16:17], v[112:113] op_sel_hi:[0,1,1] neg_lo:[1,0,0] neg_hi:[1,0,0]
    v_pk_fma_f32 v[114:115], v[12:13], v[18:19], v[114:115] op_sel_hi:[0,1,1] neg_lo:[1,0,0] neg_hi:[1,0,0]
    v_pk_fma_f32 v[120:121], v[14:15], v[16:17], v[120:121] op_sel_hi:[0,1,1] neg_lo:[1,0,0] neg_hi:[1,0,0]
    v_pk_fma_f32 v[122:123], v[14:15], v[18:19], v[122:123] op_sel_hi:[0,1,1] neg_lo:[1,0,0] neg_hi:[1,0,0]
    v_pk_mul_f32 v[112:113], v[20:21], v[112:113]
    v_pk_mul_f32 v[114:115], v[22:23], v[114:115]
    v_pk_mul_f32 v[120:121], v[20:21], v[120:121]
    v_pk_mul_f32 v[122:123], v[22:23], v[122:123]
    v_cvt_pk_bf16_f32 v88, v112, v113
    v_cvt_pk_bf16_f32 v89, v114, v115
    v_cvt_pk_bf16_f32 v90, v120, v121
    v_cvt_pk_bf16_f32 v91, v122, v123
    s_add_u32 s56, s52, 4325376
    v_permlane16_swap_b32 v88, v90
    v_permlane16_swap_b32 v89, v91
    buffer_store_dwordx4 v[88:91], v1, s[4:7], s56 offen offset:0 sc1
    v_pk_fma_f32 v[100:101], v[8:9], v[24:25], v[100:101] op_sel_hi:[0,1,1] neg_lo:[1,0,0] neg_hi:[1,0,0]
    v_pk_fma_f32 v[102:103], v[8:9], v[26:27], v[102:103] op_sel_hi:[0,1,1] neg_lo:[1,0,0] neg_hi:[1,0,0]
    v_pk_fma_f32 v[108:109], v[10:11], v[24:25], v[108:109] op_sel_hi:[0,1,1] neg_lo:[1,0,0] neg_hi:[1,0,0]
    v_pk_fma_f32 v[110:111], v[10:11], v[26:27], v[110:111] op_sel_hi:[0,1,1] neg_lo:[1,0,0] neg_hi:[1,0,0]
    v_pk_mul_f32 v[100:101], v[28:29], v[100:101]
    v_pk_mul_f32 v[102:103], v[30:31], v[102:103]
    v_pk_mul_f32 v[108:109], v[28:29], v[108:109]
    v_pk_mul_f32 v[110:111], v[30:31], v[110:111]
    v_cvt_pk_bf16_f32 v76, v100, v101
    v_cvt_pk_bf16_f32 v77, v102, v103
    v_cvt_pk_bf16_f32 v78, v108, v109
    v_cvt_pk_bf16_f32 v79, v110, v111
    s_add_u32 s56, s52, 4194304
    v_permlane16_swap_b32 v76, v78
    v_permlane16_swap_b32 v77, v79
    buffer_store_dwordx4 v[76:79], v1, s[4:7], s56 offen offset:1024 sc1
    v_pk_fma_f32 v[116:117], v[12:13], v[24:25], v[116:117] op_sel_hi:[0,1,1] neg_lo:[1,0,0] neg_hi:[1,0,0]
    v_pk_fma_f32 v[118:119], v[12:13], v[26:27], v[118:119] op_sel_hi:[0,1,1] neg_lo:[1,0,0] neg_hi:[1,0,0]
    v_pk_fma_f32 v[124:125], v[14:15], v[24:25], v[124:125] op_sel_hi:[0,1,1] neg_lo:[1,0,0] neg_hi:[1,0,0]
    v_pk_fma_f32 v[126:127], v[14:15], v[26:27], v[126:127] op_sel_hi:[0,1,1] neg_lo:[1,0,0] neg_hi:[1,0,0]
    v_pk_mul_f32 v[116:117], v[28:29], v[116:117]
    v_pk_mul_f32 v[118:119], v[30:31], v[118:119]
    v_pk_mul_f32 v[124:125], v[28:29], v[124:125]
    v_pk_mul_f32 v[126:127], v[30:31], v[126:127]
    v_cvt_pk_bf16_f32 v92, v116, v117
    v_cvt_pk_bf16_f32 v93, v118, v119
    v_cvt_pk_bf16_f32 v94, v124, v125
    v_cvt_pk_bf16_f32 v95, v126, v127
    s_add_u32 s56, s52, 4325376
    v_permlane16_swap_b32 v92, v94
    v_permlane16_swap_b32 v93, v95
    buffer_store_dwordx4 v[92:95], v1, s[4:7], s56 offen offset:1024 sc1
    v_mfma_f32_16x16x32_bf16 v[128:131], v[32:35], v[224:227], v[128:131]
    ds_read_b64_tr_b16 v[60:61], v6 offset:20480
    v_mfma_f32_16x16x32_bf16 v[132:135], v[32:35], v[228:231], v[132:135]
    ds_read_b64_tr_b16 v[62:63], v6 offset:21504
    v_mfma_f32_16x16x32_bf16 v[136:139], v[36:39], v[224:227], v[136:139]
    ds_read_b64_tr_b16 v[32:33], v3 offset:24576
    v_mfma_f32_16x16x32_bf16 v[140:143], v[36:39], v[228:231], v[140:143]
    ds_read_b64_tr_b16 v[34:35], v3 offset:25600
    v_mfma_f32_16x16x32_bf16 v[144:147], v[40:43], v[224:227], v[144:147]
    ds_read_b64_tr_b16 v[36:37], v4 offset:24576
    v_mfma_f32_16x16x32_bf16 v[148:151], v[40:43], v[228:231], v[148:151]
    ds_read_b64_tr_b16 v[38:39], v4 offset:25600
    v_mfma_f32_16x16x32_bf16 v[152:155], v[44:47], v[224:227], v[152:155]
    ds_read_b64_tr_b16 v[40:41], v5 offset:24576
    v_mfma_f32_16x16x32_bf16 v[156:159], v[44:47], v[228:231], v[156:159]
    ds_read_b64_tr_b16 v[42:43], v5 offset:25600
    s_waitcnt lgkmcnt(10)
    v_mfma_f32_16x16x32_bf16 v[128:131], v[48:51], v[232:235], v[128:131]
    ds_read_b64_tr_b16 v[44:45], v6 offset:24576
    v_mfma_f32_16x16x32_bf16 v[132:135], v[48:51], v[236:239], v[132:135]
    ds_read_b64_tr_b16 v[46:47], v6 offset:25600
    v_mfma_f32_16x16x32_bf16 v[136:139], v[52:55], v[232:235], v[136:139]
    ds_read_b64_tr_b16 v[48:49], v3 offset:28672
    v_mfma_f32_16x16x32_bf16 v[140:143], v[52:55], v[236:239], v[140:143]
    ds_read_b64_tr_b16 v[50:51], v3 offset:29696
    s_waitcnt lgkmcnt(10)
    v_mfma_f32_16x16x32_bf16 v[144:147], v[56:59], v[232:235], v[144:147]
    ds_read_b64_tr_b16 v[52:53], v4 offset:28672
    v_mfma_f32_16x16x32_bf16 v[148:151], v[56:59], v[236:239], v[148:151]
    ds_read_b64_tr_b16 v[54:55], v4 offset:29696
    v_mfma_f32_16x16x32_bf16 v[152:155], v[60:63], v[232:235], v[152:155]
    ds_read_b64_tr_b16 v[56:57], v5 offset:28672
    v_mfma_f32_16x16x32_bf16 v[156:159], v[60:63], v[236:239], v[156:159]
    ds_read_b64_tr_b16 v[58:59], v5 offset:29696
    s_waitcnt lgkmcnt(10)
    v_mfma_f32_16x16x32_bf16 v[128:131], v[32:35], v[240:243], v[128:131]
    ds_read_b64_tr_b16 v[60:61], v6 offset:28672
    v_mfma_f32_16x16x32_bf16 v[132:135], v[32:35], v[244:247], v[132:135]
    ds_read_b64_tr_b16 v[62:63], v6 offset:29696
    s_barrier
    v_mfma_f32_16x16x32_bf16 v[136:139], v[36:39], v[240:243], v[136:139]
    ds_read_b64_tr_b16 v[32:33], v3 offset:32768
    v_mfma_f32_16x16x32_bf16 v[140:143], v[36:39], v[244:247], v[140:143]
    ds_read_b64_tr_b16 v[34:35], v3 offset:33792
    s_waitcnt lgkmcnt(10)
    v_mfma_f32_16x16x32_bf16 v[144:147], v[40:43], v[240:243], v[144:147]
    ds_read_b64_tr_b16 v[36:37], v4 offset:32768
    v_mfma_f32_16x16x32_bf16 v[148:151], v[40:43], v[244:247], v[148:151]
    ds_read_b64_tr_b16 v[38:39], v4 offset:33792
    v_mfma_f32_16x16x32_bf16 v[152:155], v[44:47], v[240:243], v[152:155]
    ds_read_b64_tr_b16 v[40:41], v5 offset:32768
    v_mfma_f32_16x16x32_bf16 v[156:159], v[44:47], v[244:247], v[156:159]
    ds_read_b64_tr_b16 v[42:43], v5 offset:33792
    s_waitcnt lgkmcnt(10)
    v_mfma_f32_16x16x32_bf16 v[128:131], v[48:51], v[248:251], v[128:131]
    ds_read_b64_tr_b16 v[44:45], v6 offset:32768
    v_mfma_f32_16x16x32_bf16 v[132:135], v[48:51], v[252:255], v[132:135]
    ds_read_b64_tr_b16 v[46:47], v6 offset:33792
    v_mfma_f32_16x16x32_bf16 v[136:139], v[52:55], v[248:251], v[136:139]
    ds_read_b64_tr_b16 v[48:49], v3 offset:36864
    v_mfma_f32_16x16x32_bf16 v[140:143], v[52:55], v[252:255], v[140:143]
    ds_read_b64_tr_b16 v[50:51], v3 offset:37888
    s_waitcnt lgkmcnt(10)
    v_mfma_f32_16x16x32_bf16 v[144:147], v[56:59], v[248:251], v[144:147]
    ds_read_b64_tr_b16 v[52:53], v4 offset:36864
    v_mfma_f32_16x16x32_bf16 v[148:151], v[56:59], v[252:255], v[148:151]
    ds_read_b64_tr_b16 v[54:55], v4 offset:37888
    v_mfma_f32_16x16x32_bf16 v[152:155], v[60:63], v[248:251], v[152:155]
    ds_read_b64_tr_b16 v[56:57], v5 offset:36864
    v_mfma_f32_16x16x32_bf16 v[156:159], v[60:63], v[252:255], v[156:159]
    ds_read_b64_tr_b16 v[58:59], v5 offset:37888
    s_waitcnt lgkmcnt(10)
    v_mfma_f32_16x16x32_bf16 v[128:131], v[32:35], v[160:163], v[128:131]
    ds_read_b64_tr_b16 v[60:61], v6 offset:36864
    v_mfma_f32_16x16x32_bf16 v[132:135], v[32:35], v[164:167], v[132:135]
    ds_read_b64_tr_b16 v[62:63], v6 offset:37888
    v_mfma_f32_16x16x32_bf16 v[136:139], v[36:39], v[160:163], v[136:139]
    ds_read_b64_tr_b16 v[32:33], v3 offset:40960
    v_mfma_f32_16x16x32_bf16 v[140:143], v[36:39], v[164:167], v[140:143]
    ds_read_b64_tr_b16 v[34:35], v3 offset:41984
    s_waitcnt lgkmcnt(10)
    v_mfma_f32_16x16x32_bf16 v[144:147], v[40:43], v[160:163], v[144:147]
    ds_read_b64_tr_b16 v[36:37], v4 offset:40960
    v_mfma_f32_16x16x32_bf16 v[148:151], v[40:43], v[164:167], v[148:151]
    ds_read_b64_tr_b16 v[38:39], v4 offset:41984
    v_mfma_f32_16x16x32_bf16 v[152:155], v[44:47], v[160:163], v[152:155]
    ds_read_b64_tr_b16 v[40:41], v5 offset:40960
    v_mfma_f32_16x16x32_bf16 v[156:159], v[44:47], v[164:167], v[156:159]
    ds_read_b64_tr_b16 v[42:43], v5 offset:41984
    s_waitcnt lgkmcnt(10)
    v_mfma_f32_16x16x32_bf16 v[128:131], v[48:51], v[168:171], v[128:131]
    ds_read_b64_tr_b16 v[44:45], v6 offset:40960
    v_mfma_f32_16x16x32_bf16 v[132:135], v[48:51], v[172:175], v[132:135]
    ds_read_b64_tr_b16 v[46:47], v6 offset:41984
    v_mfma_f32_16x16x32_bf16 v[136:139], v[52:55], v[168:171], v[136:139]
    ds_read_b64_tr_b16 v[48:49], v3 offset:45056
    v_mfma_f32_16x16x32_bf16 v[140:143], v[52:55], v[172:175], v[140:143]
    ds_read_b64_tr_b16 v[50:51], v3 offset:46080
    s_waitcnt lgkmcnt(10)
    v_mfma_f32_16x16x32_bf16 v[144:147], v[56:59], v[168:171], v[144:147]
    ds_read_b64_tr_b16 v[52:53], v4 offset:45056
    v_mfma_f32_16x16x32_bf16 v[148:151], v[56:59], v[172:175], v[148:151]
    ds_read_b64_tr_b16 v[54:55], v4 offset:46080
    v_mfma_f32_16x16x32_bf16 v[152:155], v[60:63], v[168:171], v[152:155]
    ds_read_b64_tr_b16 v[56:57], v5 offset:45056
    v_mfma_f32_16x16x32_bf16 v[156:159], v[60:63], v[172:175], v[156:159]
    ds_read_b64_tr_b16 v[58:59], v5 offset:46080
    s_waitcnt lgkmcnt(10)
    v_mfma_f32_16x16x32_bf16 v[128:131], v[32:35], v[176:179], v[128:131]
    ds_read_b64_tr_b16 v[60:61], v6 offset:45056
    v_mfma_f32_16x16x32_bf16 v[132:135], v[32:35], v[180:183], v[132:135]
    ds_read_b64_tr_b16 v[62:63], v6 offset:46080
    v_mfma_f32_16x16x32_bf16 v[136:139], v[36:39], v[176:179], v[136:139]
    ds_read_b64_tr_b16 v[32:33], v3 offset:49152
    v_mfma_f32_16x16x32_bf16 v[140:143], v[36:39], v[180:183], v[140:143]
    ds_read_b64_tr_b16 v[34:35], v3 offset:50176
    s_waitcnt lgkmcnt(10)
    v_mfma_f32_16x16x32_bf16 v[144:147], v[40:43], v[176:179], v[144:147]
    ds_read_b64_tr_b16 v[36:37], v4 offset:49152
    v_mfma_f32_16x16x32_bf16 v[148:151], v[40:43], v[180:183], v[148:151]
    ds_read_b64_tr_b16 v[38:39], v4 offset:50176
    v_mfma_f32_16x16x32_bf16 v[152:155], v[44:47], v[176:179], v[152:155]
    ds_read_b64_tr_b16 v[40:41], v5 offset:49152
    v_mfma_f32_16x16x32_bf16 v[156:159], v[44:47], v[180:183], v[156:159]
    ds_read_b64_tr_b16 v[42:43], v5 offset:50176
    s_waitcnt lgkmcnt(10)
    v_mfma_f32_16x16x32_bf16 v[128:131], v[48:51], v[184:187], v[128:131]
    ds_read_b64_tr_b16 v[44:45], v6 offset:49152
    s_waitcnt vmcnt(0)
    s_atomic_add s40, s[22:23], s59
    s_mov_b32 s68, 0
    s_atomic_add s68, s[22:23], s59 glc
    s_mov_b32 s55, s52
    s_add_u32 s56, s52, 4194304
    ds_read_b32 v8, v9 offset:4096
    v_mfma_f32_16x16x32_bf16 v[132:135], v[48:51], v[188:191], v[132:135]
    ds_read_b64_tr_b16 v[46:47], v6 offset:50176
    buffer_load_dwordx4 v[64:67], v1, s[4:7], s55 offen offset:0 sc1
    ds_read_b32 v10, v9 offset:4608
    v_mfma_f32_16x16x32_bf16 v[136:139], v[52:55], v[184:187], v[136:139]
    ds_read_b64_tr_b16 v[48:49], v3 offset:53248
    buffer_load_dwordx4 v[68:71], v1, s[4:7], s55 offen offset:1024 sc1
    ds_read_b32 v12, v9 offset:4160
    v_mfma_f32_16x16x32_bf16 v[140:143], v[52:55], v[188:191], v[140:143]
    ds_read_b64_tr_b16 v[50:51], v3 offset:54272
    buffer_load_dwordx4 v[72:75], v1, s[4:7], s56 offen offset:0 sc1
    ds_read_b32 v14, v9 offset:4672
    s_waitcnt lgkmcnt(14)
    v_mfma_f32_16x16x32_bf16 v[144:147], v[56:59], v[184:187], v[144:147]
    ds_read_b64_tr_b16 v[52:53], v4 offset:53248
    buffer_load_dwordx4 v[76:79], v1, s[4:7], s56 offen offset:1024 sc1
    ds_read_b128 v[16:19], v11 offset:0
    v_mfma_f32_16x16x32_bf16 v[148:151], v[56:59], v[188:191], v[148:151]
    ds_read_b64_tr_b16 v[54:55], v4 offset:54272
    ds_read_b128 v[20:23], v11 offset:64
    v_mfma_f32_16x16x32_bf16 v[152:155], v[60:63], v[184:187], v[152:155]
    ds_read_b64_tr_b16 v[56:57], v5 offset:53248
    ds_read_b128 v[24:27], v11 offset:128
    v_mfma_f32_16x16x32_bf16 v[156:159], v[60:63], v[188:191], v[156:159]
    ds_read_b64_tr_b16 v[58:59], v5 offset:54272
    ds_read_b128 v[28:31], v11 offset:192
    s_waitcnt lgkmcnt(14)
    v_mfma_f32_16x16x32_bf16 v[128:131], v[32:35], v[192:195], v[128:131]
    ds_read_b64_tr_b16 v[60:61], v6 offset:53248
    v_mfma_f32_16x16x32_bf16 v[132:135], v[32:35], v[196:199], v[132:135]
    ds_read_b64_tr_b16 v[62:63], v6 offset:54272
    v_mfma_f32_16x16x32_bf16 v[136:139], v[36:39], v[192:195], v[136:139]
    ds_read_b64_tr_b16 v[32:33], v3 offset:57344
    v_mfma_f32_16x16x32_bf16 v[140:143], v[36:39], v[196:199], v[140:143]
    ds_read_b64_tr_b16 v[34:35], v3 offset:58368
    s_waitcnt lgkmcnt(14)
    v_mfma_f32_16x16x32_bf16 v[144:147], v[40:43], v[192:195], v[144:147]
    ds_read_b64_tr_b16 v[36:37], v4 offset:57344
    v_mfma_f32_16x16x32_bf16 v[148:151], v[40:43], v[196:199], v[148:151]
    ds_read_b64_tr_b16 v[38:39], v4 offset:58368
    v_mfma_f32_16x16x32_bf16 v[152:155], v[44:47], v[192:195], v[152:155]
    ds_read_b64_tr_b16 v[40:41], v5 offset:57344
    v_mfma_f32_16x16x32_bf16 v[156:159], v[44:47], v[196:199], v[156:159]
    ds_read_b64_tr_b16 v[42:43], v5 offset:58368
    s_waitcnt lgkmcnt(13)
    v_mfma_f32_16x16x32_bf16 v[128:131], v[48:51], v[200:203], v[128:131]
    ds_read_b64_tr_b16 v[44:45], v6 offset:57344
    s_waitcnt lgkmcnt(9)
    v_mfma_f32_16x16x32_bf16 v[132:135], v[48:51], v[204:207], v[132:135]
    ds_read_b64_tr_b16 v[46:47], v6 offset:58368
    v_mul_f32 v10, 0x3e8293ee, v10
    v_mfma_f32_16x16x32_bf16 v[136:139], v[52:55], v[200:203], v[136:139]
    ds_read_b64_tr_b16 v[48:49], v3 offset:61440
    v_mul_f32 v14, 0x3e8293ee, v14
    v_mfma_f32_16x16x32_bf16 v[140:143], v[52:55], v[204:207], v[140:143]
    ds_read_b64_tr_b16 v[50:51], v3 offset:62464
    s_lshl_b32 s44, s16, 11
    s_waitcnt lgkmcnt(10)
    v_mfma_f32_16x16x32_bf16 v[144:147], v[56:59], v[200:203], v[144:147]
    ds_read_b64_tr_b16 v[52:53], v4 offset:61440
    s_add_u32 s44, s44, 131072
    v_mfma_f32_16x16x32_bf16 v[148:151], v[56:59], v[204:207], v[148:151]
    ds_read_b64_tr_b16 v[54:55], v4 offset:62464
    v_add_u32 v13, s44, v2
    v_mfma_f32_16x16x32_bf16 v[152:155], v[60:63], v[200:203], v[152:155]
    ds_read_b64_tr_b16 v[56:57], v5 offset:61440
    v_mfma_f32_16x16x32_bf16 v[156:159], v[60:63], v[204:207], v[156:159]
    ds_read_b64_tr_b16 v[58:59], v5 offset:62464
    s_waitcnt lgkmcnt(10)
    v_mfma_f32_16x16x32_bf16 v[128:131], v[32:35], v[208:211], v[128:131]
    ds_read_b64_tr_b16 v[60:61], v6 offset:61440
    v_mfma_f32_16x16x32_bf16 v[132:135], v[32:35], v[212:215], v[132:135]
    ds_read_b64_tr_b16 v[62:63], v6 offset:62464
    v_xor_b32 v3, 0x10000, v3
    v_xor_b32 v4, 0x10000, v4
    v_xor_b32 v5, 0x10000, v5
    v_xor_b32 v6, 0x10000, v6
    v_mfma_f32_16x16x32_bf16 v[136:139], v[36:39], v[208:211], v[136:139]
    v_mfma_f32_16x16x32_bf16 v[140:143], v[36:39], v[212:215], v[140:143]
    s_waitcnt lgkmcnt(8)
    v_mfma_f32_16x16x32_bf16 v[144:147], v[40:43], v[208:211], v[144:147]
    v_mfma_f32_16x16x32_bf16 v[148:151], v[40:43], v[212:215], v[148:151]
    v_mfma_f32_16x16x32_bf16 v[152:155], v[44:47], v[208:211], v[152:155]
    v_mfma_f32_16x16x32_bf16 v[156:159], v[44:47], v[212:215], v[156:159]
    s_waitcnt lgkmcnt(4)
    v_mfma_f32_16x16x32_bf16 v[128:131], v[48:51], v[216:219], v[128:131]
    v_mfma_f32_16x16x32_bf16 v[132:135], v[48:51], v[220:223], v[132:135]
    v_mfma_f32_16x16x32_bf16 v[136:139], v[52:55], v[216:219], v[136:139]
    v_mfma_f32_16x16x32_bf16 v[140:143], v[52:55], v[220:223], v[140:143]
    s_waitcnt lgkmcnt(0)
    v_mfma_f32_16x16x32_bf16 v[144:147], v[56:59], v[216:219], v[144:147]
    v_mfma_f32_16x16x32_bf16 v[148:151], v[56:59], v[220:223], v[148:151]
    v_mfma_f32_16x16x32_bf16 v[152:155], v[60:63], v[216:219], v[152:155]
    v_mfma_f32_16x16x32_bf16 v[156:159], v[60:63], v[220:223], v[156:159]
    v_pk_fma_f32 v[128:129], v[8:9], v[16:17], v[128:129] op_sel_hi:[0,1,1] neg_lo:[1,0,0] neg_hi:[1,0,0]
    v_pk_fma_f32 v[130:131], v[8:9], v[18:19], v[130:131] op_sel_hi:[0,1,1] neg_lo:[1,0,0] neg_hi:[1,0,0]
    v_pk_fma_f32 v[136:137], v[8:9], v[20:21], v[136:137] op_sel_hi:[0,1,1] neg_lo:[1,0,0] neg_hi:[1,0,0]
    v_pk_fma_f32 v[138:139], v[8:9], v[22:23], v[138:139] op_sel_hi:[0,1,1] neg_lo:[1,0,0] neg_hi:[1,0,0]
    v_pk_mul_f32 v[128:129], v[10:11], v[128:129] op_sel_hi:[0,1]
    v_pk_mul_f32 v[130:131], v[10:11], v[130:131] op_sel_hi:[0,1]
    v_pk_mul_f32 v[136:137], v[10:11], v[136:137] op_sel_hi:[0,1]
    v_pk_mul_f32 v[138:139], v[10:11], v[138:139] op_sel_hi:[0,1]
    v_cvt_pk_bf16_f32 v128, v128, v129
    v_cvt_pk_bf16_f32 v129, v130, v131
    v_cvt_pk_bf16_f32 v130, v136, v137
    v_cvt_pk_bf16_f32 v131, v138, v139
    ds_write_b128 v13, v[128:131] offset:0
    v_pk_fma_f32 v[132:133], v[12:13], v[16:17], v[132:133] op_sel_hi:[0,1,1] neg_lo:[1,0,0] neg_hi:[1,0,0]
    v_pk_fma_f32 v[134:135], v[12:13], v[18:19], v[134:135] op_sel_hi:[0,1,1] neg_lo:[1,0,0] neg_hi:[1,0,0]
    v_pk_fma_f32 v[140:141], v[12:13], v[20:21], v[140:141] op_sel_hi:[0,1,1] neg_lo:[1,0,0] neg_hi:[1,0,0]
    v_pk_fma_f32 v[142:143], v[12:13], v[22:23], v[142:143] op_sel_hi:[0,1,1] neg_lo:[1,0,0] neg_hi:[1,0,0]
    v_pk_mul_f32 v[132:133], v[14:15], v[132:133] op_sel_hi:[0,1]
    v_pk_mul_f32 v[134:135], v[14:15], v[134:135] op_sel_hi:[0,1]
    v_pk_mul_f32 v[140:141], v[14:15], v[140:141] op_sel_hi:[0,1]
    v_pk_mul_f32 v[142:143], v[14:15], v[142:143] op_sel_hi:[0,1]
    v_cvt_pk_bf16_f32 v132, v132, v133
    v_cvt_pk_bf16_f32 v133, v134, v135
    v_cvt_pk_bf16_f32 v134, v140, v141
    v_cvt_pk_bf16_f32 v135, v142, v143
    ds_write_b128 v13, v[132:135] offset:256
    v_add_u32 v4, 131072, v1
    s_waitcnt lgkmcnt(0)
    s_barrier
    ds_read_b128 v[32:35], v4 offset:0
    ds_read_b128 v[36:39], v4 offset:1024
    ds_read_b128 v[40:43], v4 offset:2048
    ds_read_b128 v[44:47], v4 offset:3072
    ds_read_b128 v[48:51], v4 offset:4096
    ds_read_b128 v[52:55], v4 offset:5120
    ds_read_b128 v[56:59], v4 offset:6144
    ds_read_b128 v[60:63], v4 offset:7168
    v_pk_fma_f32 v[144:145], v[8:9], v[24:25], v[144:145] op_sel_hi:[0,1,1] neg_lo:[1,0,0] neg_hi:[1,0,0]
    v_pk_fma_f32 v[146:147], v[8:9], v[26:27], v[146:147] op_sel_hi:[0,1,1] neg_lo:[1,0,0] neg_hi:[1,0,0]
    v_pk_fma_f32 v[152:153], v[8:9], v[28:29], v[152:153] op_sel_hi:[0,1,1] neg_lo:[1,0,0] neg_hi:[1,0,0]
    v_pk_fma_f32 v[154:155], v[8:9], v[30:31], v[154:155] op_sel_hi:[0,1,1] neg_lo:[1,0,0] neg_hi:[1,0,0]
    v_pk_mul_f32 v[144:145], v[10:11], v[144:145] op_sel_hi:[0,1]
    v_pk_mul_f32 v[146:147], v[10:11], v[146:147] op_sel_hi:[0,1]
    v_pk_mul_f32 v[152:153], v[10:11], v[152:153] op_sel_hi:[0,1]
    v_pk_mul_f32 v[154:155], v[10:11], v[154:155] op_sel_hi:[0,1]
    v_cvt_pk_bf16_f32 v144, v144, v145
    v_cvt_pk_bf16_f32 v145, v146, v147
    v_cvt_pk_bf16_f32 v146, v152, v153
    v_cvt_pk_bf16_f32 v147, v154, v155
    ds_write_b128 v13, v[144:147] offset:8192
    s_waitcnt vmcnt(0) lgkmcnt(7)
    v_mfma_f32_32x32x16_bf16 v[192:207], v[64:67], v[32:35], 0
    v_mfma_f32_32x32x16_bf16 v[192:207], v[68:71], v[36:39], v[192:207]
    v_pk_fma_f32 v[148:149], v[12:13], v[24:25], v[148:149] op_sel_hi:[0,1,1] neg_lo:[1,0,0] neg_hi:[1,0,0]
    v_pk_fma_f32 v[150:151], v[12:13], v[26:27], v[150:151] op_sel_hi:[0,1,1] neg_lo:[1,0,0] neg_hi:[1,0,0]
    v_pk_fma_f32 v[156:157], v[12:13], v[28:29], v[156:157] op_sel_hi:[0,1,1] neg_lo:[1,0,0] neg_hi:[1,0,0]
    v_pk_fma_f32 v[158:159], v[12:13], v[30:31], v[158:159] op_sel_hi:[0,1,1] neg_lo:[1,0,0] neg_hi:[1,0,0]
    v_pk_mul_f32 v[148:149], v[14:15], v[148:149] op_sel_hi:[0,1]
    v_pk_mul_f32 v[150:151], v[14:15], v[150:151] op_sel_hi:[0,1]
    v_pk_mul_f32 v[156:157], v[14:15], v[156:157] op_sel_hi:[0,1]
    v_pk_mul_f32 v[158:159], v[14:15], v[158:159] op_sel_hi:[0,1]
    v_cvt_pk_bf16_f32 v148, v148, v149
    v_cvt_pk_bf16_f32 v149, v150, v151
    v_cvt_pk_bf16_f32 v150, v156, v157
    v_cvt_pk_bf16_f32 v151, v158, v159
    ds_write_b128 v13, v[148:151] offset:8448
    v_mov_b32 v9, 0xdddddddd
    v_bfe_u32 v10, v1, 4, 3
    v_mov_b32 v11, 0x3f803f80
    v_cmp_eq_u32 vcc, 0, v10
    v_cmp_eq_u32 s[44:45], 4, v10
    s_mov_b32 s57, 0
    v_cndmask_b32 v28, 0, v11, vcc
    v_cndmask_b32 v29, 0, v11, vcc
    v_cndmask_b32 v30, 0, v11, s[44:45]
    v_cndmask_b32 v31, 0, v11, s[44:45]
    v_mov_b32 v10, 0
    v_mov_b32 v11, 0
    s_mov_b32 s66, 0x10000
    s_waitcnt lgkmcnt(0)
    s_cmp_eq_u32 s68, 16
    s_cbranch_scc1 c_k_ok
c_k_poll:
    s_mov_b32 s68, 0
    s_atomic_add s68, s[22:23], s59 offset:0 glc
    s_sub_u32 s66, s66, 1
    s_cselect_b32 s67, 16, 0
    s_waitcnt lgkmcnt(0)
    s_max_u32 s68, s68, s67
    s_cmp_lt_u32 s68, 16
    s_cbranch_scc1 c_k_poll
c_k_ok:
    s_add_u32 s54, s54, 8192
    s_and_b32 s54, s54, 0x1ffff
    s_add_u32 s55, s53, s54
    s_add_u32 s56, s55, 4194304
    buffer_load_dwordx4 v[80:83], v1, s[4:7], s55 offen offset:0 sc1
    buffer_load_dwordx4 v[84:87], v1, s[4:7], s55 offen offset:1024 sc1
    buffer_load_dwordx4 v[88:91], v1, s[4:7], s56 offen offset:0 sc1
    buffer_load_dwordx4 v[92:95], v1, s[4:7], s56 offen offset:1024 sc1
    s_add_u32 s54, s54, 8192
    s_and_b32 s54, s54, 0x1ffff
    s_add_u32 s55, s53, s54
    s_add_u32 s56, s55, 4194304
    buffer_load_dwordx4 v[96:99], v1, s[4:7], s55 offen offset:0 sc1
    buffer_load_dwordx4 v[100:103], v1, s[4:7], s55 offen offset:1024 sc1
    buffer_load_dwordx4 v[104:107], v1, s[4:7], s56 offen offset:0 sc1
    buffer_load_dwordx4 v[108:111], v1, s[4:7], s56 offen offset:1024 sc1
    v_mfma_f32_32x32x16_bf16 v[208:223], v[64:67], v[40:43], 0
    s_add_u32 s54, s54, 8192
    s_and_b32 s54, s54, 0x1ffff
    s_add_u32 s55, s53, s54
    s_add_u32 s56, s55, 4194304
    v_exp_f32 v192, v192
    v_exp_f32 v193, v193
    v_exp_f32 v194, v194
    v_mfma_f32_32x32x8_bf16 v[128:143], v[10:11], v[10:11], 0
    v_mov_b32 v12, 0
    v_exp_f32 v195, v195
    v_exp_f32 v196, v196
    v_exp_f32 v197, v197
    v_mfma_f32_32x32x16_bf16 v[208:223], v[68:71], v[44:47], v[208:223]
    v_exp_f32 v198, v198
    v_exp_f32 v199, v199
    v_exp_f32 v200, v200
    v_mfma_f32_32x32x8_bf16 v[144:159], v[10:11], v[10:11], 0
    v_mov_b32 v16, 0
    v_exp_f32 v201, v201
    v_exp_f32 v202, v202
    v_mfma_f32_32x32x8_bf16 v[160:175], v[10:11], v[10:11], 0
    v_mov_b32 v20, 0
    s_lshl_b32 s44, s16, 12
    s_add_u32 s44, s44, 65536
    v_add_u32 v5, s44, v1
    s_lshl_b32 s44, s16, 8
    s_add_u32 s44, s44, 147456
    v_lshrrev_b32 v6, 2, v1
    v_add_u32 v6, s44, v6
    s_lshl_b32 s44, s21, 22
    s_lshl_b32 s45, s38, 16
    s_add_u32 s41, s44, s45
    s_lshl_b32 s45, s18, 12
    s_add_u32 s43, s41, s45
    s_and_b32 s45, s45, 0
    s_add_u32 s41, s41, s45
    s_add_u32 s41, s41, 16777216
    v_exp_f32 v203, v203
    v_exp_f32 v204, v204
    buffer_load_dwordx4 v[112:115], v1, s[4:7], s55 offen offset:0 sc1
    v_exp_f32 v205, v205
    v_mfma_f32_32x32x8_bf16 v[176:191], v[10:11], v[10:11], 0
    v_mov_b32 v24, 0
    v_exp_f32 v206, v206
    v_exp_f32 v207, v207
    v_mfma_f32_32x32x16_bf16 v[224:239], v[64:67], v[48:51], 0
    v_exp_f32 v208, v208
    v_exp_f32 v209, v209
    v_exp_f32 v210, v210
    v_smfmac_f32_32x32x32_bf16 v[128:143], v[72:75], v[192:199], v9
    v_exp_f32 v211, v211
    v_exp_f32 v212, v212
    v_exp_f32 v213, v213
    v_mfma_f32_32x32x16_bf16 v[224:239], v[68:71], v[52:55], v[224:239]
    v_exp_f32 v214, v214
    v_exp_f32 v215, v215
    v_exp_f32 v216, v216
    v_smfmac_f32_16x16x64_bf16 v[12:15], v[28:31], v[192:199], v9
    v_exp_f32 v217, v217
    v_smfmac_f32_32x32x32_bf16 v[128:143], v[76:79], v[200:207], v9
    v_exp_f32 v218, v218
    v_exp_f32 v219, v219
    v_exp_f32 v220, v220
    v_smfmac_f32_16x16x64_bf16 v[12:15], v[28:31], v[200:207], v9
    buffer_load_dwordx4 v[116:119], v1, s[4:7], s55 offen offset:1024 sc1
    v_exp_f32 v221, v221
    v_exp_f32 v222, v222
    v_exp_f32 v223, v223
b_head:
    s_mov_b32 s58, 3
b_loop:
    v_mfma_f32_32x32x16_bf16 v[240:255], v[64:67], v[56:59], 0
    v_exp_f32 v224, v224
    v_exp_f32 v225, v225
    v_exp_f32 v226, v226
    v_smfmac_f32_32x32x32_bf16 v[144:159], v[72:75], v[208:215], v9
    v_exp_f32 v227, v227
    v_exp_f32 v228, v228
    v_exp_f32 v229, v229
    v_mfma_f32_32x32x16_bf16 v[240:255], v[68:71], v[60:63], v[240:255]
    v_exp_f32 v230, v230
    v_exp_f32 v231, v231
    v_exp_f32 v232, v232
    v_smfmac_f32_16x16x64_bf16 v[16:19], v[28:31], v[208:215], v9
    v_exp_f32 v233, v233
    v_smfmac_f32_32x32x32_bf16 v[144:159], v[76:79], v[216:223], v9
    v_exp_f32 v234, v234
    v_exp_f32 v235, v235
    v_exp_f32 v236, v236
    v_smfmac_f32_16x16x64_bf16 v[16:19], v[28:31], v[216:223], v9
    buffer_load_dwordx4 v[120:123], v1, s[4:7], s56 offen offset:0 sc1
    v_exp_f32 v237, v237
    v_exp_f32 v238, v238
    v_exp_f32 v239, v239
    s_waitcnt vmcnt(7)
    v_mfma_f32_32x32x16_bf16 v[192:207], v[80:83], v[32:35], 0
    v_exp_f32 v240, v240
    v_exp_f32 v241, v241
    v_exp_f32 v242, v242
    v_smfmac_f32_32x32x32_bf16 v[160:175], v[72:75], v[224:231], v9
    v_exp_f32 v243, v243
    v_exp_f32 v244, v244
    v_exp_f32 v245, v245
    v_mfma_f32_32x32x16_bf16 v[192:207], v[84:87], v[36:39], v[192:207]
    v_exp_f32 v246, v246
    v_exp_f32 v247, v247
    v_exp_f32 v248, v248
    v_smfmac_f32_16x16x64_bf16 v[20:23], v[28:31], v[224:231], v9
    v_exp_f32 v249, v249
    v_smfmac_f32_32x32x32_bf16 v[160:175], v[76:79], v[232:239], v9
    v_exp_f32 v250, v250
    v_exp_f32 v251, v251
    v_exp_f32 v252, v252
    v_smfmac_f32_16x16x64_bf16 v[20:23], v[28:31], v[232:239], v9
    buffer_load_dwordx4 v[124:127], v1, s[4:7], s56 offen offset:1024 sc1
    v_exp_f32 v253, v253
    v_exp_f32 v254, v254
    v_exp_f32 v255, v255
    v_mfma_f32_32x32x16_bf16 v[208:223], v[80:83], v[40:43], 0
    s_add_u32 s54, s54, 8192
    s_and_b32 s54, s54, 0x1ffff
    s_add_u32 s55, s53, s54
    s_add_u32 s56, s55, 4194304
    v_exp_f32 v192, v192
    v_exp_f32 v193, v193
    v_exp_f32 v194, v194
    v_smfmac_f32_32x32x32_bf16 v[176:191], v[72:75], v[240:247], v9
    v_exp_f32 v195, v195
    v_exp_f32 v196, v196
    v_exp_f32 v197, v197
    v_mfma_f32_32x32x16_bf16 v[208:223], v[84:87], v[44:47], v[208:223]
    v_exp_f32 v198, v198
    v_exp_f32 v199, v199
    v_exp_f32 v200, v200
    v_smfmac_f32_16x16x64_bf16 v[24:27], v[28:31], v[240:247], v9
    v_exp_f32 v201, v201
    v_smfmac_f32_32x32x32_bf16 v[176:191], v[76:79], v[248:255], v9
    v_exp_f32 v202, v202
    v_exp_f32 v203, v203
    v_exp_f32 v204, v204
    v_smfmac_f32_16x16x64_bf16 v[24:27], v[28:31], v[248:255], v9
    buffer_load_dwordx4 v[64:67], v1, s[4:7], s55 offen offset:0 sc1
    v_exp_f32 v205, v205
    v_exp_f32 v206, v206
    v_exp_f32 v207, v207
    v_mfma_f32_32x32x16_bf16 v[224:239], v[80:83], v[48:51], 0
    v_exp_f32 v208, v208
    v_exp_f32 v209, v209
    v_exp_f32 v210, v210
    v_smfmac_f32_32x32x32_bf16 v[128:143], v[88:91], v[192:199], v9
    v_exp_f32 v211, v211
    v_exp_f32 v212, v212
    v_exp_f32 v213, v213
    v_mfma_f32_32x32x16_bf16 v[224:239], v[84:87], v[52:55], v[224:239]
    v_exp_f32 v214, v214
    v_exp_f32 v215, v215
    v_exp_f32 v216, v216
    v_smfmac_f32_16x16x64_bf16 v[12:15], v[28:31], v[192:199], v9
    v_exp_f32 v217, v217
    v_smfmac_f32_32x32x32_bf16 v[128:143], v[92:95], v[200:207], v9
    v_exp_f32 v218, v218
    v_exp_f32 v219, v219
    v_exp_f32 v220, v220
    v_smfmac_f32_16x16x64_bf16 v[12:15], v[28:31], v[200:207], v9
    buffer_load_dwordx4 v[68:71], v1, s[4:7], s55 offen offset:1024 sc1
    v_exp_f32 v221, v221
    v_exp_f32 v222, v222
    v_exp_f32 v223, v223
    v_mfma_f32_32x32x16_bf16 v[240:255], v[80:83], v[56:59], 0
    v_exp_f32 v224, v224
    v_exp_f32 v225, v225
    v_exp_f32 v226, v226
    v_smfmac_f32_32x32x32_bf16 v[144:159], v[88:91], v[208:215], v9
    v_exp_f32 v227, v227
    v_exp_f32 v228, v228
    v_exp_f32 v229, v229
    v_mfma_f32_32x32x16_bf16 v[240:255], v[84:87], v[60:63], v[240:255]
    v_exp_f32 v230, v230
    v_exp_f32 v231, v231
    v_exp_f32 v232, v232
    v_smfmac_f32_16x16x64_bf16 v[16:19], v[28:31], v[208:215], v9
    v_exp_f32 v233, v233
    v_smfmac_f32_32x32x32_bf16 v[144:159], v[92:95], v[216:223], v9
    v_exp_f32 v234, v234
    v_exp_f32 v235, v235
    v_exp_f32 v236, v236
    v_smfmac_f32_16x16x64_bf16 v[16:19], v[28:31], v[216:223], v9
    buffer_load_dwordx4 v[72:75], v1, s[4:7], s56 offen offset:0 sc1
    v_exp_f32 v237, v237
    v_exp_f32 v238, v238
    v_exp_f32 v239, v239
    s_waitcnt vmcnt(7)
    v_mfma_f32_32x32x16_bf16 v[192:207], v[96:99], v[32:35], 0
    v_exp_f32 v240, v240
    v_exp_f32 v241, v241
    v_exp_f32 v242, v242
    v_smfmac_f32_32x32x32_bf16 v[160:175], v[88:91], v[224:231], v9
    v_exp_f32 v243, v243
    v_exp_f32 v244, v244
    v_exp_f32 v245, v245
    v_mfma_f32_32x32x16_bf16 v[192:207], v[100:103], v[36:39], v[192:207]
    v_exp_f32 v246, v246
    v_exp_f32 v247, v247
    v_exp_f32 v248, v248
    v_smfmac_f32_16x16x64_bf16 v[20:23], v[28:31], v[224:231], v9
    v_exp_f32 v249, v249
    v_smfmac_f32_32x32x32_bf16 v[160:175], v[92:95], v[232:239], v9
    v_exp_f32 v250, v250
    v_exp_f32 v251, v251
    v_exp_f32 v252, v252
    v_smfmac_f32_16x16x64_bf16 v[20:23], v[28:31], v[232:239], v9
    buffer_load_dwordx4 v[76:79], v1, s[4:7], s56 offen offset:1024 sc1
    v_exp_f32 v253, v253
    v_exp_f32 v254, v254
    v_exp_f32 v255, v255
    v_mfma_f32_32x32x16_bf16 v[208:223], v[96:99], v[40:43], 0
    s_add_u32 s54, s54, 8192
    s_and_b32 s54, s54, 0x1ffff
    s_add_u32 s55, s53, s54
    s_add_u32 s56, s55, 4194304
    v_exp_f32 v192, v192
    v_exp_f32 v193, v193
    v_exp_f32 v194, v194
    v_smfmac_f32_32x32x32_bf16 v[176:191], v[88:91], v[240:247], v9
    v_exp_f32 v195, v195
    v_exp_f32 v196, v196
    v_exp_f32 v197, v197
    v_mfma_f32_32x32x16_bf16 v[208:223], v[100:103], v[44:47], v[208:223]
    v_exp_f32 v198, v198
    v_exp_f32 v199, v199
    v_exp_f32 v200, v200
    v_smfmac_f32_16x16x64_bf16 v[24:27], v[28:31], v[240:247], v9
    v_exp_f32 v201, v201
    v_smfmac_f32_32x32x32_bf16 v[176:191], v[92:95], v[248:255], v9
    v_exp_f32 v202, v202
    v_exp_f32 v203, v203
    v_exp_f32 v204, v204
    v_smfmac_f32_16x16x64_bf16 v[24:27], v[28:31], v[248:255], v9
    buffer_load_dwordx4 v[80:83], v1, s[4:7], s55 offen offset:0 sc1
    v_exp_f32 v205, v205
    v_exp_f32 v206, v206
    v_exp_f32 v207, v207
    v_mfma_f32_32x32x16_bf16 v[224:239], v[96:99], v[48:51], 0
    v_exp_f32 v208, v208
    v_exp_f32 v209, v209
    v_exp_f32 v210, v210
    v_smfmac_f32_32x32x32_bf16 v[128:143], v[104:107], v[192:199], v9
    v_exp_f32 v211, v211
    v_exp_f32 v212, v212
    v_exp_f32 v213, v213
    v_mfma_f32_32x32x16_bf16 v[224:239], v[100:103], v[52:55], v[224:239]
    v_exp_f32 v214, v214
    v_exp_f32 v215, v215
    v_exp_f32 v216, v216
    v_smfmac_f32_16x16x64_bf16 v[12:15], v[28:31], v[192:199], v9
    v_exp_f32 v217, v217
    v_smfmac_f32_32x32x32_bf16 v[128:143], v[108:111], v[200:207], v9
    v_exp_f32 v218, v218
    v_exp_f32 v219, v219
    v_exp_f32 v220, v220
    v_smfmac_f32_16x16x64_bf16 v[12:15], v[28:31], v[200:207], v9
    buffer_load_dwordx4 v[84:87], v1, s[4:7], s55 offen offset:1024 sc1
    v_exp_f32 v221, v221
    v_exp_f32 v222, v222
    v_exp_f32 v223, v223
    v_mfma_f32_32x32x16_bf16 v[240:255], v[96:99], v[56:59], 0
    v_exp_f32 v224, v224
    v_exp_f32 v225, v225
    v_exp_f32 v226, v226
    v_smfmac_f32_32x32x32_bf16 v[144:159], v[104:107], v[208:215], v9
    v_exp_f32 v227, v227
    v_exp_f32 v228, v228
    v_exp_f32 v229, v229
    v_mfma_f32_32x32x16_bf16 v[240:255], v[100:103], v[60:63], v[240:255]
    v_exp_f32 v230, v230
    v_exp_f32 v231, v231
    v_exp_f32 v232, v232
    v_smfmac_f32_16x16x64_bf16 v[16:19], v[28:31], v[208:215], v9
    v_exp_f32 v233, v233
    v_smfmac_f32_32x32x32_bf16 v[144:159], v[108:111], v[216:223], v9
    v_exp_f32 v234, v234
    v_exp_f32 v235, v235
    v_exp_f32 v236, v236
    v_smfmac_f32_16x16x64_bf16 v[16:19], v[28:31], v[216:223], v9
    buffer_load_dwordx4 v[88:91], v1, s[4:7], s56 offen offset:0 sc1
    v_exp_f32 v237, v237
    v_exp_f32 v238, v238
    v_exp_f32 v239, v239
    s_waitcnt vmcnt(7)
    v_mfma_f32_32x32x16_bf16 v[192:207], v[112:115], v[32:35], 0
    v_exp_f32 v240, v240
    v_exp_f32 v241, v241
    v_exp_f32 v242, v242
    v_smfmac_f32_32x32x32_bf16 v[160:175], v[104:107], v[224:231], v9
    v_exp_f32 v243, v243
    v_exp_f32 v244, v244
    v_exp_f32 v245, v245
    v_mfma_f32_32x32x16_bf16 v[192:207], v[116:119], v[36:39], v[192:207]
    v_exp_f32 v246, v246
    v_exp_f32 v247, v247
    v_exp_f32 v248, v248
    v_smfmac_f32_16x16x64_bf16 v[20:23], v[28:31], v[224:231], v9
    v_exp_f32 v249, v249
    v_smfmac_f32_32x32x32_bf16 v[160:175], v[108:111], v[232:239], v9
    v_exp_f32 v250, v250
    v_exp_f32 v251, v251
    v_exp_f32 v252, v252
    v_smfmac_f32_16x16x64_bf16 v[20:23], v[28:31], v[232:239], v9
    buffer_load_dwordx4 v[92:95], v1, s[4:7], s56 offen offset:1024 sc1
    v_exp_f32 v253, v253
    v_exp_f32 v254, v254
    v_exp_f32 v255, v255
    v_mfma_f32_32x32x16_bf16 v[208:223], v[112:115], v[40:43], 0
    s_add_u32 s54, s54, 8192
    s_and_b32 s54, s54, 0x1ffff
    s_add_u32 s55, s53, s54
    s_add_u32 s56, s55, 4194304
    v_exp_f32 v192, v192
    v_exp_f32 v193, v193
    v_exp_f32 v194, v194
    v_smfmac_f32_32x32x32_bf16 v[176:191], v[104:107], v[240:247], v9
    v_exp_f32 v195, v195
    v_exp_f32 v196, v196
    v_exp_f32 v197, v197
    v_mfma_f32_32x32x16_bf16 v[208:223], v[116:119], v[44:47], v[208:223]
    v_exp_f32 v198, v198
    v_exp_f32 v199, v199
    v_exp_f32 v200, v200
    v_smfmac_f32_16x16x64_bf16 v[24:27], v[28:31], v[240:247], v9
    v_exp_f32 v201, v201
    v_smfmac_f32_32x32x32_bf16 v[176:191], v[108:111], v[248:255], v9
    v_exp_f32 v202, v202
    v_exp_f32 v203, v203
    v_exp_f32 v204, v204
    v_smfmac_f32_16x16x64_bf16 v[24:27], v[28:31], v[248:255], v9
    buffer_load_dwordx4 v[96:99], v1, s[4:7], s55 offen offset:0 sc1
    v_exp_f32 v205, v205
    v_exp_f32 v206, v206
    v_exp_f32 v207, v207
    v_mfma_f32_32x32x16_bf16 v[224:239], v[112:115], v[48:51], 0
    v_exp_f32 v208, v208
    v_exp_f32 v209, v209
    v_exp_f32 v210, v210
    v_smfmac_f32_32x32x32_bf16 v[128:143], v[120:123], v[192:199], v9
    v_exp_f32 v211, v211
    v_exp_f32 v212, v212
    v_exp_f32 v213, v213
    v_mfma_f32_32x32x16_bf16 v[224:239], v[116:119], v[52:55], v[224:239]
    v_exp_f32 v214, v214
    v_exp_f32 v215, v215
    v_exp_f32 v216, v216
    v_smfmac_f32_16x16x64_bf16 v[12:15], v[28:31], v[192:199], v9
    v_exp_f32 v217, v217
    v_smfmac_f32_32x32x32_bf16 v[128:143], v[124:127], v[200:207], v9
    v_exp_f32 v218, v218
    v_exp_f32 v219, v219
    v_exp_f32 v220, v220
    v_smfmac_f32_16x16x64_bf16 v[12:15], v[28:31], v[200:207], v9
    buffer_load_dwordx4 v[100:103], v1, s[4:7], s55 offen offset:1024 sc1
    v_exp_f32 v221, v221
    v_exp_f32 v222, v222
    v_exp_f32 v223, v223
    v_mfma_f32_32x32x16_bf16 v[240:255], v[112:115], v[56:59], 0
    v_exp_f32 v224, v224
    v_exp_f32 v225, v225
    v_exp_f32 v226, v226
    v_smfmac_f32_32x32x32_bf16 v[144:159], v[120:123], v[208:215], v9
    v_exp_f32 v227, v227
    v_exp_f32 v228, v228
    v_exp_f32 v229, v229
    v_mfma_f32_32x32x16_bf16 v[240:255], v[116:119], v[60:63], v[240:255]
    v_exp_f32 v230, v230
    v_exp_f32 v231, v231
    v_exp_f32 v232, v232
    v_smfmac_f32_16x16x64_bf16 v[16:19], v[28:31], v[208:215], v9
    v_exp_f32 v233, v233
    v_smfmac_f32_32x32x32_bf16 v[144:159], v[124:127], v[216:223], v9
    v_exp_f32 v234, v234
    v_exp_f32 v235, v235
    v_exp_f32 v236, v236
    v_smfmac_f32_16x16x64_bf16 v[16:19], v[28:31], v[216:223], v9
    buffer_load_dwordx4 v[104:107], v1, s[4:7], s56 offen offset:0 sc1
    v_exp_f32 v237, v237
    v_exp_f32 v238, v238
    v_exp_f32 v239, v239
    s_waitcnt vmcnt(7)
    v_mfma_f32_32x32x16_bf16 v[192:207], v[64:67], v[32:35], 0
    v_exp_f32 v240, v240
    v_exp_f32 v241, v241
    v_exp_f32 v242, v242
    v_smfmac_f32_32x32x32_bf16 v[160:175], v[120:123], v[224:231], v9
    v_exp_f32 v243, v243
    v_exp_f32 v244, v244
    v_exp_f32 v245, v245
    v_mfma_f32_32x32x16_bf16 v[192:207], v[68:71], v[36:39], v[192:207]
    v_exp_f32 v246, v246
    v_exp_f32 v247, v247
    v_exp_f32 v248, v248
    v_smfmac_f32_16x16x64_bf16 v[20:23], v[28:31], v[224:231], v9
    v_exp_f32 v249, v249
    v_smfmac_f32_32x32x32_bf16 v[160:175], v[124:127], v[232:239], v9
    v_exp_f32 v250, v250
    v_exp_f32 v251, v251
    v_exp_f32 v252, v252
    v_smfmac_f32_16x16x64_bf16 v[20:23], v[28:31], v[232:239], v9
    buffer_load_dwordx4 v[108:111], v1, s[4:7], s56 offen offset:1024 sc1
    v_exp_f32 v253, v253
    v_exp_f32 v254, v254
    v_exp_f32 v255, v255
    v_mfma_f32_32x32x16_bf16 v[208:223], v[64:67], v[40:43], 0
    s_add_u32 s54, s54, 8192
    s_and_b32 s54, s54, 0x1ffff
    s_add_u32 s55, s53, s54
    s_add_u32 s56, s55, 4194304
    v_exp_f32 v192, v192
    v_exp_f32 v193, v193
    v_exp_f32 v194, v194
    v_smfmac_f32_32x32x32_bf16 v[176:191], v[120:123], v[240:247], v9
    v_exp_f32 v195, v195
    v_exp_f32 v196, v196
    v_exp_f32 v197, v197
    v_mfma_f32_32x32x16_bf16 v[208:223], v[68:71], v[44:47], v[208:223]
    v_exp_f32 v198, v198
    v_exp_f32 v199, v199
    v_exp_f32 v200, v200
    v_smfmac_f32_16x16x64_bf16 v[24:27], v[28:31], v[240:247], v9
    v_exp_f32 v201, v201
    v_smfmac_f32_32x32x32_bf16 v[176:191], v[124:127], v[248:255], v9
    v_exp_f32 v202, v202
    v_exp_f32 v203, v203
    v_exp_f32 v204, v204
    v_smfmac_f32_16x16x64_bf16 v[24:27], v[28:31], v[248:255], v9
    buffer_load_dwordx4 v[112:115], v1, s[4:7], s55 offen offset:0 sc1
    v_exp_f32 v205, v205
    v_exp_f32 v206, v206
    v_exp_f32 v207, v207
    v_mfma_f32_32x32x16_bf16 v[224:239], v[64:67], v[48:51], 0
    v_exp_f32 v208, v208
    v_exp_f32 v209, v209
    v_exp_f32 v210, v210
    v_smfmac_f32_32x32x32_bf16 v[128:143], v[72:75], v[192:199], v9
    v_exp_f32 v211, v211
    v_exp_f32 v212, v212
    v_exp_f32 v213, v213
    v_mfma_f32_32x32x16_bf16 v[224:239], v[68:71], v[52:55], v[224:239]
    v_exp_f32 v214, v214
    v_exp_f32 v215, v215
    v_exp_f32 v216, v216
    v_smfmac_f32_16x16x64_bf16 v[12:15], v[28:31], v[192:199], v9
    v_exp_f32 v217, v217
    v_smfmac_f32_32x32x32_bf16 v[128:143], v[76:79], v[200:207], v9
    v_exp_f32 v218, v218
    v_exp_f32 v219, v219
    v_exp_f32 v220, v220
    v_smfmac_f32_16x16x64_bf16 v[12:15], v[28:31], v[200:207], v9
    buffer_load_dwordx4 v[116:119], v1, s[4:7], s55 offen offset:1024 sc1
    v_exp_f32 v221, v221
    v_exp_f32 v222, v222
    v_exp_f32 v223, v223
    s_sub_u32 s58, s58, 1
    s_cmp_lg_u32 s58, 0
    s_cbranch_scc1 b_loop
    v_mfma_f32_32x32x16_bf16 v[240:255], v[64:67], v[56:59], 0
    v_exp_f32 v224, v224
    v_exp_f32 v225, v225
    v_exp_f32 v226, v226
    v_smfmac_f32_32x32x32_bf16 v[144:159], v[72:75], v[208:215], v9
    v_exp_f32 v227, v227
    v_exp_f32 v228, v228
    v_exp_f32 v229, v229
    v_mfma_f32_32x32x16_bf16 v[240:255], v[68:71], v[60:63], v[240:255]
    v_exp_f32 v230, v230
    v_exp_f32 v231, v231
    v_exp_f32 v232, v232
    v_smfmac_f32_16x16x64_bf16 v[16:19], v[28:31], v[208:215], v9
    v_exp_f32 v233, v233
    v_smfmac_f32_32x32x32_bf16 v[144:159], v[76:79], v[216:223], v9
    v_exp_f32 v234, v234
    v_exp_f32 v235, v235
    v_exp_f32 v236, v236
    v_smfmac_f32_16x16x64_bf16 v[16:19], v[28:31], v[216:223], v9
    buffer_load_dwordx4 v[120:123], v1, s[4:7], s56 offen offset:0 sc1
    v_exp_f32 v237, v237
    v_exp_f32 v238, v238
    v_exp_f32 v239, v239
    s_waitcnt vmcnt(7)
    v_mfma_f32_32x32x16_bf16 v[192:207], v[80:83], v[32:35], 0
    v_exp_f32 v240, v240
    v_exp_f32 v241, v241
    v_exp_f32 v242, v242
    v_smfmac_f32_32x32x32_bf16 v[160:175], v[72:75], v[224:231], v9
    v_exp_f32 v243, v243
    v_exp_f32 v244, v244
    v_exp_f32 v245, v245
    v_mfma_f32_32x32x16_bf16 v[192:207], v[84:87], v[36:39], v[192:207]
    v_exp_f32 v246, v246
    v_exp_f32 v247, v247
    v_exp_f32 v248, v248
    v_smfmac_f32_16x16x64_bf16 v[20:23], v[28:31], v[224:231], v9
    v_exp_f32 v249, v249
    v_smfmac_f32_32x32x32_bf16 v[160:175], v[76:79], v[232:239], v9
    v_exp_f32 v250, v250
    v_exp_f32 v251, v251
    v_exp_f32 v252, v252
    v_smfmac_f32_16x16x64_bf16 v[20:23], v[28:31], v[232:239], v9
    buffer_load_dwordx4 v[124:127], v1, s[4:7], s56 offen offset:1024 sc1
    v_exp_f32 v253, v253
    v_exp_f32 v254, v254
    v_exp_f32 v255, v255
    s_add_u32 s53, s53, 131072
    s_cmp_eq_u32 s57, 0
    s_cselect_b32 s53, s53, 2146435072
    v_mfma_f32_32x32x16_bf16 v[208:223], v[80:83], v[40:43], 0
    s_add_u32 s54, s54, 8192
    s_and_b32 s54, s54, 0x1ffff
    s_add_u32 s55, s53, s54
    s_add_u32 s56, s55, 4194304
    v_exp_f32 v192, v192
    v_exp_f32 v193, v193
    v_exp_f32 v194, v194
    v_smfmac_f32_32x32x32_bf16 v[176:191], v[72:75], v[240:247], v9
    v_exp_f32 v195, v195
    v_exp_f32 v196, v196
    v_exp_f32 v197, v197
    v_mfma_f32_32x32x16_bf16 v[208:223], v[84:87], v[44:47], v[208:223]
    v_exp_f32 v198, v198
    v_exp_f32 v199, v199
    v_exp_f32 v200, v200
    v_smfmac_f32_16x16x64_bf16 v[24:27], v[28:31], v[240:247], v9
    v_exp_f32 v201, v201
    v_smfmac_f32_32x32x32_bf16 v[176:191], v[76:79], v[248:255], v9
    v_exp_f32 v202, v202
    v_exp_f32 v203, v203
    v_exp_f32 v204, v204
    v_smfmac_f32_16x16x64_bf16 v[24:27], v[28:31], v[248:255], v9
    buffer_load_dwordx4 v[64:67], v1, s[4:7], s55 offen offset:0 sc1
    v_exp_f32 v205, v205
    v_exp_f32 v206, v206
    v_exp_f32 v207, v207
    v_mfma_f32_32x32x16_bf16 v[224:239], v[80:83], v[48:51], 0
    v_exp_f32 v208, v208
    v_exp_f32 v209, v209
    v_exp_f32 v210, v210
    v_smfmac_f32_32x32x32_bf16 v[128:143], v[88:91], v[192:199], v9
    v_exp_f32 v211, v211
    v_exp_f32 v212, v212
    v_exp_f32 v213, v213
    v_mfma_f32_32x32x16_bf16 v[224:239], v[84:87], v[52:55], v[224:239]
    v_exp_f32 v214, v214
    v_exp_f32 v215, v215
    v_exp_f32 v216, v216
    v_smfmac_f32_16x16x64_bf16 v[12:15], v[28:31], v[192:199], v9
    v_exp_f32 v217, v217
    v_smfmac_f32_32x32x32_bf16 v[128:143], v[92:95], v[200:207], v9
    v_exp_f32 v218, v218
    v_exp_f32 v219, v219
    v_exp_f32 v220, v220
    v_smfmac_f32_16x16x64_bf16 v[12:15], v[28:31], v[200:207], v9
    buffer_load_dwordx4 v[68:71], v1, s[4:7], s55 offen offset:1024 sc1
    v_exp_f32 v221, v221
    v_exp_f32 v222, v222
    v_exp_f32 v223, v223
    v_mfma_f32_32x32x16_bf16 v[240:255], v[80:83], v[56:59], 0
    v_exp_f32 v224, v224
    v_exp_f32 v225, v225
    v_exp_f32 v226, v226
    v_smfmac_f32_32x32x32_bf16 v[144:159], v[88:91], v[208:215], v9
    v_exp_f32 v227, v227
    v_exp_f32 v228, v228
    v_exp_f32 v229, v229
    v_mfma_f32_32x32x16_bf16 v[240:255], v[84:87], v[60:63], v[240:255]
    v_exp_f32 v230, v230
    v_exp_f32 v231, v231
    v_exp_f32 v232, v232
    v_smfmac_f32_16x16x64_bf16 v[16:19], v[28:31], v[208:215], v9
    v_exp_f32 v233, v233
    v_smfmac_f32_32x32x32_bf16 v[144:159], v[92:95], v[216:223], v9
    v_exp_f32 v234, v234
    v_exp_f32 v235, v235
    v_exp_f32 v236, v236
    v_smfmac_f32_16x16x64_bf16 v[16:19], v[28:31], v[216:223], v9
    buffer_load_dwordx4 v[72:75], v1, s[4:7], s56 offen offset:0 sc1
    v_exp_f32 v237, v237
    v_exp_f32 v238, v238
    v_exp_f32 v239, v239
    s_waitcnt vmcnt(7)
    v_mfma_f32_32x32x16_bf16 v[192:207], v[96:99], v[32:35], 0
    v_exp_f32 v240, v240
    v_exp_f32 v241, v241
    v_exp_f32 v242, v242
    v_smfmac_f32_32x32x32_bf16 v[160:175], v[88:91], v[224:231], v9
    v_exp_f32 v243, v243
    v_exp_f32 v244, v244
    v_exp_f32 v245, v245
    v_mfma_f32_32x32x16_bf16 v[192:207], v[100:103], v[36:39], v[192:207]
    v_exp_f32 v246, v246
    v_exp_f32 v247, v247
    v_exp_f32 v248, v248
    v_smfmac_f32_16x16x64_bf16 v[20:23], v[28:31], v[224:231], v9
    v_exp_f32 v249, v249
    v_smfmac_f32_32x32x32_bf16 v[160:175], v[92:95], v[232:239], v9
    v_exp_f32 v250, v250
    v_exp_f32 v251, v251
    v_exp_f32 v252, v252
    v_smfmac_f32_16x16x64_bf16 v[20:23], v[28:31], v[232:239], v9
    buffer_load_dwordx4 v[76:79], v1, s[4:7], s56 offen offset:1024 sc1
    v_exp_f32 v253, v253
    v_exp_f32 v254, v254
    v_exp_f32 v255, v255
    v_mfma_f32_32x32x16_bf16 v[208:223], v[96:99], v[40:43], 0
    s_add_u32 s54, s54, 8192
    s_and_b32 s54, s54, 0x1ffff
    s_add_u32 s55, s53, s54
    s_add_u32 s56, s55, 4194304
    v_exp_f32 v192, v192
    v_exp_f32 v193, v193
    v_exp_f32 v194, v194
    v_smfmac_f32_32x32x32_bf16 v[176:191], v[88:91], v[240:247], v9
    v_exp_f32 v195, v195
    v_exp_f32 v196, v196
    v_exp_f32 v197, v197
    v_mfma_f32_32x32x16_bf16 v[208:223], v[100:103], v[44:47], v[208:223]
    v_exp_f32 v198, v198
    v_exp_f32 v199, v199
    v_exp_f32 v200, v200
    v_smfmac_f32_16x16x64_bf16 v[24:27], v[28:31], v[240:247], v9
    v_exp_f32 v201, v201
    v_smfmac_f32_32x32x32_bf16 v[176:191], v[92:95], v[248:255], v9
    v_exp_f32 v202, v202
    v_exp_f32 v203, v203
    v_exp_f32 v204, v204
    v_smfmac_f32_16x16x64_bf16 v[24:27], v[28:31], v[248:255], v9
    buffer_load_dwordx4 v[80:83], v1, s[4:7], s55 offen offset:0 sc1
    v_exp_f32 v205, v205
    v_exp_f32 v206, v206
    v_exp_f32 v207, v207
    v_mfma_f32_32x32x16_bf16 v[224:239], v[96:99], v[48:51], 0
    v_exp_f32 v208, v208
    v_exp_f32 v209, v209
    v_exp_f32 v210, v210
    v_smfmac_f32_32x32x32_bf16 v[128:143], v[104:107], v[192:199], v9
    v_exp_f32 v211, v211
    v_exp_f32 v212, v212
    v_exp_f32 v213, v213
    v_mfma_f32_32x32x16_bf16 v[224:239], v[100:103], v[52:55], v[224:239]
    v_exp_f32 v214, v214
    v_exp_f32 v215, v215
    v_exp_f32 v216, v216
    v_smfmac_f32_16x16x64_bf16 v[12:15], v[28:31], v[192:199], v9
    v_exp_f32 v217, v217
    v_smfmac_f32_32x32x32_bf16 v[128:143], v[108:111], v[200:207], v9
    v_exp_f32 v218, v218
    v_exp_f32 v219, v219
    v_exp_f32 v220, v220
    v_smfmac_f32_16x16x64_bf16 v[12:15], v[28:31], v[200:207], v9
    buffer_load_dwordx4 v[84:87], v1, s[4:7], s55 offen offset:1024 sc1
    v_exp_f32 v221, v221
    v_exp_f32 v222, v222
    v_exp_f32 v223, v223
    v_mfma_f32_32x32x16_bf16 v[240:255], v[96:99], v[56:59], 0
    v_exp_f32 v224, v224
    v_exp_f32 v225, v225
    v_exp_f32 v226, v226
    v_smfmac_f32_32x32x32_bf16 v[144:159], v[104:107], v[208:215], v9
    v_exp_f32 v227, v227
    v_exp_f32 v228, v228
    v_exp_f32 v229, v229
    v_mfma_f32_32x32x16_bf16 v[240:255], v[100:103], v[60:63], v[240:255]
    v_exp_f32 v230, v230
    v_exp_f32 v231, v231
    v_exp_f32 v232, v232
    v_smfmac_f32_16x16x64_bf16 v[16:19], v[28:31], v[208:215], v9
    v_exp_f32 v233, v233
    v_smfmac_f32_32x32x32_bf16 v[144:159], v[108:111], v[216:223], v9
    v_exp_f32 v234, v234
    v_exp_f32 v235, v235
    v_exp_f32 v236, v236
    v_smfmac_f32_16x16x64_bf16 v[16:19], v[28:31], v[216:223], v9
    buffer_load_dwordx4 v[88:91], v1, s[4:7], s56 offen offset:0 sc1
    v_exp_f32 v237, v237
    v_exp_f32 v238, v238
    v_exp_f32 v239, v239
    s_waitcnt vmcnt(7)
    v_mfma_f32_32x32x16_bf16 v[192:207], v[112:115], v[32:35], 0
    v_exp_f32 v240, v240
    v_exp_f32 v241, v241
    v_exp_f32 v242, v242
    v_smfmac_f32_32x32x32_bf16 v[160:175], v[104:107], v[224:231], v9
    v_exp_f32 v243, v243
    v_exp_f32 v244, v244
    v_exp_f32 v245, v245
    v_mfma_f32_32x32x16_bf16 v[192:207], v[116:119], v[36:39], v[192:207]
    v_exp_f32 v246, v246
    v_exp_f32 v247, v247
    v_exp_f32 v248, v248
    v_smfmac_f32_16x16x64_bf16 v[20:23], v[28:31], v[224:231], v9
    v_exp_f32 v249, v249
    v_smfmac_f32_32x32x32_bf16 v[160:175], v[108:111], v[232:239], v9
    v_exp_f32 v250, v250
    v_exp_f32 v251, v251
    v_exp_f32 v252, v252
    v_smfmac_f32_16x16x64_bf16 v[20:23], v[28:31], v[232:239], v9
    buffer_load_dwordx4 v[92:95], v1, s[4:7], s56 offen offset:1024 sc1
    v_exp_f32 v253, v253
    v_exp_f32 v254, v254
    v_exp_f32 v255, v255
    s_barrier
    v_mfma_f32_32x32x16_bf16 v[208:223], v[112:115], v[40:43], 0
    s_add_u32 s54, s54, 8192
    s_and_b32 s54, s54, 0x1ffff
    s_add_u32 s55, s53, s54
    s_add_u32 s56, s55, 4194304
    ds_read_b128 v[32:35], v4 offset:8192
    ds_read_b128 v[36:39], v4 offset:9216
    v_exp_f32 v192, v192
    v_exp_f32 v193, v193
    v_exp_f32 v194, v194
    v_smfmac_f32_32x32x32_bf16 v[176:191], v[104:107], v[240:247], v9
    v_exp_f32 v195, v195
    v_exp_f32 v196, v196
    v_exp_f32 v197, v197
    v_mfma_f32_32x32x16_bf16 v[208:223], v[116:119], v[44:47], v[208:223]
    v_exp_f32 v198, v198
    v_exp_f32 v199, v199
    v_exp_f32 v200, v200
    v_smfmac_f32_16x16x64_bf16 v[24:27], v[28:31], v[240:247], v9
    v_exp_f32 v201, v201
    v_smfmac_f32_32x32x32_bf16 v[176:191], v[108:111], v[248:255], v9
    v_exp_f32 v202, v202
    v_exp_f32 v203, v203
    v_exp_f32 v204, v204
    v_smfmac_f32_16x16x64_bf16 v[24:27], v[28:31], v[248:255], v9
    buffer_load_dwordx4 v[96:99], v1, s[4:7], s55 offen offset:0 sc1
    v_exp_f32 v205, v205
    v_exp_f32 v206, v206
    v_exp_f32 v207, v207
    v_mfma_f32_32x32x16_bf16 v[224:239], v[112:115], v[48:51], 0
    ds_read_b128 v[40:43], v4 offset:10240
    ds_read_b128 v[44:47], v4 offset:11264
    v_exp_f32 v208, v208
    v_exp_f32 v209, v209
    v_exp_f32 v210, v210
    v_smfmac_f32_32x32x32_bf16 v[128:143], v[120:123], v[192:199], v9
    v_exp_f32 v211, v211
    v_exp_f32 v212, v212
    v_exp_f32 v213, v213
    v_mfma_f32_32x32x16_bf16 v[224:239], v[116:119], v[52:55], v[224:239]
    v_exp_f32 v214, v214
    v_exp_f32 v215, v215
    v_exp_f32 v216, v216
    v_smfmac_f32_16x16x64_bf16 v[12:15], v[28:31], v[192:199], v9
    v_exp_f32 v217, v217
    v_smfmac_f32_32x32x32_bf16 v[128:143], v[124:127], v[200:207], v9
    v_exp_f32 v218, v218
    v_exp_f32 v219, v219
    v_exp_f32 v220, v220
    v_smfmac_f32_16x16x64_bf16 v[12:15], v[28:31], v[200:207], v9
    buffer_load_dwordx4 v[100:103], v1, s[4:7], s55 offen offset:1024 sc1
    v_exp_f32 v221, v221
    v_exp_f32 v222, v222
    v_exp_f32 v223, v223
    v_mfma_f32_32x32x16_bf16 v[240:255], v[112:115], v[56:59], 0
    ds_read_b128 v[48:51], v4 offset:12288
    ds_read_b128 v[52:55], v4 offset:13312
    v_exp_f32 v224, v224
    v_exp_f32 v225, v225
    v_exp_f32 v226, v226
    v_smfmac_f32_32x32x32_bf16 v[144:159], v[120:123], v[208:215], v9
    v_exp_f32 v227, v227
    ds_write_b128 v5, v[128:131] offset:0
    v_exp_f32 v228, v228
    v_exp_f32 v229, v229
    v_mfma_f32_32x32x16_bf16 v[240:255], v[116:119], v[60:63], v[240:255]
    ds_write_b128 v5, v[132:135] offset:1024
    v_exp_f32 v230, v230
    v_exp_f32 v231, v231
    v_exp_f32 v232, v232
    v_smfmac_f32_16x16x64_bf16 v[16:19], v[28:31], v[208:215], v9
    ds_write_b32 v6, v12 offset:0
    v_exp_f32 v233, v233
    v_smfmac_f32_32x32x32_bf16 v[144:159], v[124:127], v[216:223], v9
    ds_write_b128 v5, v[136:139] offset:2048
    v_exp_f32 v234, v234
    v_exp_f32 v235, v235
    v_exp_f32 v236, v236
    v_smfmac_f32_16x16x64_bf16 v[16:19], v[28:31], v[216:223], v9
    buffer_load_dwordx4 v[104:107], v1, s[4:7], s56 offen offset:0 sc1
    ds_write_b128 v5, v[140:143] offset:3072
    v_exp_f32 v237, v237
    v_exp_f32 v238, v238
    v_exp_f32 v239, v239
    s_waitcnt vmcnt(7)
    s_waitcnt lgkmcnt(9)
    v_mfma_f32_32x32x16_bf16 v[192:207], v[64:67], v[32:35], 0
    ds_read_b128 v[56:59], v4 offset:14336
    ds_read_b128 v[60:63], v4 offset:15360
    v_exp_f32 v240, v240
    v_exp_f32 v241, v241
    v_exp_f32 v242, v242
    v_smfmac_f32_32x32x32_bf16 v[160:175], v[120:123], v[224:231], v9
    v_exp_f32 v243, v243
    ds_write_b128 v5, v[144:147] offset:16384
    v_exp_f32 v244, v244
    v_exp_f32 v245, v245
    v_mfma_f32_32x32x16_bf16 v[192:207], v[68:71], v[36:39], v[192:207]
    ds_write_b128 v5, v[148:151] offset:17408
    v_exp_f32 v246, v246
    v_exp_f32 v247, v247
    v_exp_f32 v248, v248
    s_waitcnt lgkmcnt(4)
    v_mfma_f32_32x32x8_bf16 v[128:143], v[10:11], v[10:11], 0
    v_mov_b32 v12, 0
    v_smfmac_f32_16x16x64_bf16 v[20:23], v[28:31], v[224:231], v9
    ds_write_b32 v6, v16 offset:1024
    v_exp_f32 v249, v249
    v_smfmac_f32_32x32x32_bf16 v[160:175], v[124:127], v[232:239], v9
    ds_write_b128 v5, v[152:155] offset:18432
    v_exp_f32 v250, v250
    v_exp_f32 v251, v251
    v_exp_f32 v252, v252
    v_smfmac_f32_16x16x64_bf16 v[20:23], v[28:31], v[232:239], v9
    buffer_load_dwordx4 v[108:111], v1, s[4:7], s56 offen offset:1024 sc1
    ds_write_b128 v5, v[156:159] offset:19456
    v_exp_f32 v253, v253
    v_exp_f32 v254, v254
    v_exp_f32 v255, v255
    s_cmp_lg_u32 s57, 0
    s_cbranch_scc1 b_tail
    v_mfma_f32_32x32x16_bf16 v[208:223], v[64:67], v[40:43], 0
    s_add_u32 s54, s54, 8192
    s_and_b32 s54, s54, 0x1ffff
    s_add_u32 s55, s53, s54
    s_add_u32 s56, s55, 4194304
    v_exp_f32 v192, v192
    v_exp_f32 v193, v193
    v_exp_f32 v194, v194
    v_smfmac_f32_32x32x32_bf16 v[176:191], v[120:123], v[240:247], v9
    v_exp_f32 v195, v195
    ds_write_b128 v5, v[160:163] offset:32768
    v_exp_f32 v196, v196
    v_exp_f32 v197, v197
    v_mfma_f32_32x32x16_bf16 v[208:223], v[68:71], v[44:47], v[208:223]
    ds_write_b128 v5, v[164:167] offset:33792
    v_exp_f32 v198, v198
    v_exp_f32 v199, v199
    v_exp_f32 v200, v200
    s_waitcnt lgkmcnt(2)
    v_mfma_f32_32x32x8_bf16 v[144:159], v[10:11], v[10:11], 0
    v_mov_b32 v16, 0
    v_smfmac_f32_16x16x64_bf16 v[24:27], v[28:31], v[240:247], v9
    ds_write_b32 v6, v20 offset:2048
    v_exp_f32 v201, v201
    v_smfmac_f32_32x32x32_bf16 v[176:191], v[124:127], v[248:255], v9
    ds_write_b128 v5, v[168:171] offset:34816
    v_exp_f32 v202, v202
    v_exp_f32 v203, v203
    v_exp_f32 v204, v204
    v_smfmac_f32_16x16x64_bf16 v[24:27], v[28:31], v[248:255], v9
    buffer_load_dwordx4 v[112:115], v1, s[4:7], s55 offen offset:0 sc1
    ds_write_b128 v5, v[172:175] offset:35840
    v_exp_f32 v205, v205
    v_exp_f32 v206, v206
    v_exp_f32 v207, v207
    v_mfma_f32_32x32x16_bf16 v[224:239], v[64:67], v[48:51], 0
    v_exp_f32 v208, v208
    v_exp_f32 v209, v209
    v_exp_f32 v210, v210
    v_smfmac_f32_32x32x32_bf16 v[128:143], v[72:75], v[192:199], v9
    v_exp_f32 v211, v211
    ds_write_b128 v5, v[176:179] offset:49152
    v_exp_f32 v212, v212
    v_exp_f32 v213, v213
    v_mfma_f32_32x32x16_bf16 v[224:239], v[68:71], v[52:55], v[224:239]
    ds_write_b128 v5, v[180:183] offset:50176
    v_exp_f32 v214, v214
    v_exp_f32 v215, v215
    v_exp_f32 v216, v216
    s_waitcnt lgkmcnt(2)
    v_mfma_f32_32x32x8_bf16 v[160:175], v[10:11], v[10:11], 0
    v_mov_b32 v20, 0
    v_smfmac_f32_16x16x64_bf16 v[12:15], v[28:31], v[192:199], v9
    ds_write_b32 v6, v24 offset:3072
    v_exp_f32 v217, v217
    v_smfmac_f32_32x32x32_bf16 v[128:143], v[76:79], v[200:207], v9
    ds_write_b128 v5, v[184:187] offset:51200
    v_exp_f32 v218, v218
    v_exp_f32 v219, v219
    v_exp_f32 v220, v220
    v_smfmac_f32_16x16x64_bf16 v[12:15], v[28:31], v[200:207], v9
    buffer_load_dwordx4 v[116:119], v1, s[4:7], s55 offen offset:1024 sc1
    ds_write_b128 v5, v[188:191] offset:52224
    v_exp_f32 v221, v221
    v_exp_f32 v222, v222
    v_exp_f32 v223, v223
    s_waitcnt lgkmcnt(0)
    v_mfma_f32_32x32x8_bf16 v[176:191], v[10:11], v[10:11], 0
    v_mov_b32 v24, 0
    s_barrier
    s_mov_b32 s57, 1
    s_branch b_head
b_tail:
    v_smfmac_f32_32x32x32_bf16 v[176:191], v[120:123], v[240:247], v9
    v_smfmac_f32_32x32x32_bf16 v[176:191], v[124:127], v[248:255], v9
    ds_write_b128 v5, v[160:163] offset:32768
    ds_write_b128 v5, v[164:167] offset:33792
    v_smfmac_f32_16x16x64_bf16 v[24:27], v[28:31], v[240:247], v9
    ds_write_b128 v5, v[168:171] offset:34816
    v_smfmac_f32_16x16x64_bf16 v[24:27], v[28:31], v[248:255], v9
    ds_write_b128 v5, v[172:175] offset:35840
    ds_write_b32 v6, v20 offset:2048
    s_nop 4
    ds_write_b128 v5, v[176:179] offset:49152
    ds_write_b128 v5, v[180:183] offset:50176
    ds_write_b128 v5, v[184:187] offset:51200
    ds_write_b128 v5, v[188:191] offset:52224
    s_nop 0
    ds_write_b32 v6, v24 offset:3072
    buffer_load_dwordx4 v[224:227], v2, s[4:7], s43 offen offset:0 sc1
    buffer_load_dwordx4 v[228:231], v2, s[4:7], s43 offen offset:256 sc1
    buffer_load_dwordx4 v[232:235], v2, s[4:7], s43 offen offset:2048 sc1
    buffer_load_dwordx4 v[236:239], v2, s[4:7], s43 offen offset:2304 sc1
    s_waitcnt lgkmcnt(0)
    s_barrier
    v_xor_b32 v4, 32, v3
    v_xor_b32 v5, 64, v3
    v_xor_b32 v6, 96, v3
c_wo:
    s_xor_b32 s42, s41, 0
    buffer_load_dwordx4 v[64:67], v2, s[4:7], s42 offen offset:0 sc1
    buffer_load_dwordx4 v[68:71], v2, s[4:7], s42 offen offset:256 sc1
    s_xor_b32 s42, s41, 4096
    buffer_load_dwordx4 v[72:75], v2, s[4:7], s42 offen offset:0 sc1
    buffer_load_dwordx4 v[76:79], v2, s[4:7], s42 offen offset:256 sc1
    s_xor_b32 s42, s41, 8192
    buffer_load_dwordx4 v[80:83], v2, s[4:7], s42 offen offset:0 sc1
    buffer_load_dwordx4 v[84:87], v2, s[4:7], s42 offen offset:256 sc1
    s_xor_b32 s42, s41, 12288
    buffer_load_dwordx4 v[88:91], v2, s[4:7], s42 offen offset:0 sc1
    buffer_load_dwordx4 v[92:95], v2, s[4:7], s42 offen offset:256 sc1
    s_xor_b32 s42, s41, 16384
    buffer_load_dwordx4 v[96:99], v2, s[4:7], s42 offen offset:0 sc1
    buffer_load_dwordx4 v[100:103], v2, s[4:7], s42 offen offset:256 sc1
    ds_read_b64_tr_b16 v[32:33], v3 offset:0
    ds_read_b64_tr_b16 v[34:35], v3 offset:1024
    ds_read_b64_tr_b16 v[36:37], v4 offset:0
    ds_read_b64_tr_b16 v[38:39], v4 offset:1024
    ds_read_b64_tr_b16 v[40:41], v5 offset:0
    ds_read_b64_tr_b16 v[42:43], v5 offset:1024
    ds_read_b64_tr_b16 v[44:45], v6 offset:0
    ds_read_b64_tr_b16 v[46:47], v6 offset:1024
    ds_read_b64_tr_b16 v[48:49], v3 offset:4096
    ds_read_b64_tr_b16 v[50:51], v3 offset:5120
    ds_read_b64_tr_b16 v[52:53], v4 offset:4096
    ds_read_b64_tr_b16 v[54:55], v4 offset:5120
    ds_read_b64_tr_b16 v[56:57], v5 offset:4096
    ds_read_b64_tr_b16 v[58:59], v5 offset:5120
    v_lshrrev_b32 v12, 4, v1
    v_and_b32 v13, 1, v12
    v_lshlrev_b32 v13, 4, v13
    v_mov_b32 v14, 0x3f80
    v_lshlrev_b32 v13, v13, v14
    v_lshrrev_b32 v14, 2, v12
    v_lshrrev_b32 v15, 4, v12
    v_xor_b32 v14, v14, v15
    v_and_b32 v14, 1, v14
    v_bfe_u32 v15, v12, 3, 1
    v_bfe_u32 v16, v12, 1, 1
    v_lshl_add_u32 v15, v15, 1, v16
    v_lshrrev_b32 v16, 5, v12
    v_lshl_add_u32 v15, v16, 2, v15
    v_lshl_add_u32 v15, v14, 3, v15
    v_cmp_eq_u32 vcc, 0, v15
    s_nop 1
    v_cndmask_b32 v240, 0, v13, vcc
    v_cmp_eq_u32 vcc, 1, v15
    s_nop 1
    v_cndmask_b32 v241, 0, v13, vcc
    v_cmp_eq_u32 vcc, 2, v15
    s_nop 1
    v_cndmask_b32 v242, 0, v13, vcc
    v_cmp_eq_u32 vcc, 3, v15
    s_nop 1
    v_cndmask_b32 v243, 0, v13, vcc
    v_cmp_eq_u32 vcc, 4, v15
    s_nop 1
    v_cndmask_b32 v244, 0, v13, vcc
    v_cmp_eq_u32 vcc, 5, v15
    s_nop 1
    v_cndmask_b32 v245, 0, v13, vcc
    v_cmp_eq_u32 vcc, 6, v15
    s_nop 1
    v_cndmask_b32 v246, 0, v13, vcc
    v_cmp_eq_u32 vcc, 7, v15
    s_nop 1
    v_cndmask_b32 v247, 0, v13, vcc
    s_waitcnt vmcnt(10)
    v_mfma_f32_16x16x32_bf16 v[128:131], v[240:243], v[224:227], 0
    v_mfma_f32_16x16x32_bf16 v[132:135], v[240:243], v[228:231], 0
    v_mfma_f32_16x16x32_bf16 v[136:139], v[244:247], v[224:227], 0
    v_mfma_f32_16x16x32_bf16 v[140:143], v[244:247], v[228:231], 0
    v_mfma_f32_16x16x32_bf16 v[144:147], v[240:243], v[232:235], 0
    v_mfma_f32_16x16x32_bf16 v[148:151], v[240:243], v[236:239], 0
    v_mfma_f32_16x16x32_bf16 v[152:155], v[244:247], v[232:235], 0
    v_mfma_f32_16x16x32_bf16 v[156:159], v[244:247], v[236:239], 0
    s_waitcnt vmcnt(8) lgkmcnt(10)
    v_mfma_f32_16x16x32_bf16 v[128:131], v[32:35], v[64:67], v[128:131]
    ds_read_b64_tr_b16 v[60:61], v6 offset:4096
    s_xor_b32 s42, s41, 20480
    buffer_load_dwordx4 v[104:107], v2, s[4:7], s42 offen offset:0 sc1
    v_mfma_f32_16x16x32_bf16 v[132:135], v[32:35], v[68:71], v[132:135]
    ds_read_b64_tr_b16 v[62:63], v6 offset:5120
    v_mfma_f32_16x16x32_bf16 v[136:139], v[36:39], v[64:67], v[136:139]
    ds_read_b64_tr_b16 v[32:33], v3 offset:8192
    v_mfma_f32_16x16x32_bf16 v[140:143], v[36:39], v[68:71], v[140:143]
    ds_read_b64_tr_b16 v[34:35], v3 offset:9216
    s_waitcnt lgkmcnt(10)
    v_mfma_f32_16x16x32_bf16 v[144:147], v[40:43], v[64:67], v[144:147]
    buffer_load_dwordx4 v[108:111], v2, s[4:7], s42 offen offset:256 sc1
    ds_read_b64_tr_b16 v[36:37], v4 offset:8192
    s_xor_b32 s42, s41, 24576
    v_mfma_f32_16x16x32_bf16 v[148:151], v[40:43], v[68:71], v[148:151]
    ds_read_b64_tr_b16 v[38:39], v4 offset:9216
    v_mfma_f32_16x16x32_bf16 v[152:155], v[44:47], v[64:67], v[152:155]
    ds_read_b64_tr_b16 v[40:41], v5 offset:8192
    v_mfma_f32_16x16x32_bf16 v[156:159], v[44:47], v[68:71], v[156:159]
    ds_read_b64_tr_b16 v[42:43], v5 offset:9216
    s_waitcnt vmcnt(8) lgkmcnt(10)
    v_mfma_f32_16x16x32_bf16 v[128:131], v[48:51], v[72:75], v[128:131]
    buffer_load_dwordx4 v[112:115], v2, s[4:7], s42 offen offset:0 sc1
    ds_read_b64_tr_b16 v[44:45], v6 offset:8192
    v_mfma_f32_16x16x32_bf16 v[132:135], v[48:51], v[76:79], v[132:135]
    ds_read_b64_tr_b16 v[46:47], v6 offset:9216
    v_mfma_f32_16x16x32_bf16 v[136:139], v[52:55], v[72:75], v[136:139]
    ds_read_b64_tr_b16 v[48:49], v3 offset:12288
    v_mfma_f32_16x16x32_bf16 v[140:143], v[52:55], v[76:79], v[140:143]
    ds_read_b64_tr_b16 v[50:51], v3 offset:13312
    s_waitcnt lgkmcnt(10)
    v_mfma_f32_16x16x32_bf16 v[144:147], v[56:59], v[72:75], v[144:147]
    buffer_load_dwordx4 v[116:119], v2, s[4:7], s42 offen offset:256 sc1
    ds_read_b64_tr_b16 v[52:53], v4 offset:12288
    s_xor_b32 s42, s41, 28672
    v_mfma_f32_16x16x32_bf16 v[148:151], v[56:59], v[76:79], v[148:151]
    ds_read_b64_tr_b16 v[54:55], v4 offset:13312
    v_mfma_f32_16x16x32_bf16 v[152:155], v[60:63], v[72:75], v[152:155]
    ds_read_b64_tr_b16 v[56:57], v5 offset:12288
    v_mfma_f32_16x16x32_bf16 v[156:159], v[60:63], v[76:79], v[156:159]
    ds_read_b64_tr_b16 v[58:59], v5 offset:13312
    s_waitcnt vmcnt(8) lgkmcnt(10)
    v_mfma_f32_16x16x32_bf16 v[128:131], v[32:35], v[80:83], v[128:131]
    ds_read_b64_tr_b16 v[60:61], v6 offset:12288
    buffer_load_dwordx4 v[120:123], v2, s[4:7], s42 offen offset:0 sc1
    v_mfma_f32_16x16x32_bf16 v[132:135], v[32:35], v[84:87], v[132:135]
    ds_read_b64_tr_b16 v[62:63], v6 offset:13312
    v_mfma_f32_16x16x32_bf16 v[136:139], v[36:39], v[80:83], v[136:139]
    ds_read_b64_tr_b16 v[32:33], v3 offset:16384
    v_mfma_f32_16x16x32_bf16 v[140:143], v[36:39], v[84:87], v[140:143]
    ds_read_b64_tr_b16 v[34:35], v3 offset:17408
    s_waitcnt lgkmcnt(10)
    v_mfma_f32_16x16x32_bf16 v[144:147], v[40:43], v[80:83], v[144:147]
    buffer_load_dwordx4 v[124:127], v2, s[4:7], s42 offen offset:256 sc1
    ds_read_b64_tr_b16 v[36:37], v4 offset:16384
    s_xor_b32 s42, s41, 32768
    v_mfma_f32_16x16x32_bf16 v[148:151], v[40:43], v[84:87], v[148:151]
    ds_read_b64_tr_b16 v[38:39], v4 offset:17408
    v_mfma_f32_16x16x32_bf16 v[152:155], v[44:47], v[80:83], v[152:155]
    ds_read_b64_tr_b16 v[40:41], v5 offset:16384
    v_mfma_f32_16x16x32_bf16 v[156:159], v[44:47], v[84:87], v[156:159]
    ds_read_b64_tr_b16 v[42:43], v5 offset:17408
    s_waitcnt vmcnt(8) lgkmcnt(10)
    v_mfma_f32_16x16x32_bf16 v[128:131], v[48:51], v[88:91], v[128:131]
    buffer_load_dwordx4 v[160:163], v2, s[4:7], s42 offen offset:0 sc1
    ds_read_b64_tr_b16 v[44:45], v6 offset:16384
    v_mfma_f32_16x16x32_bf16 v[132:135], v[48:51], v[92:95], v[132:135]
    ds_read_b64_tr_b16 v[46:47], v6 offset:17408
    v_mfma_f32_16x16x32_bf16 v[136:139], v[52:55], v[88:91], v[136:139]
    ds_read_b64_tr_b16 v[48:49], v3 offset:20480
    v_mfma_f32_16x16x32_bf16 v[140:143], v[52:55], v[92:95], v[140:143]
    ds_read_b64_tr_b16 v[50:51], v3 offset:21504
    s_waitcnt lgkmcnt(10)
    v_mfma_f32_16x16x32_bf16 v[144:147], v[56:59], v[88:91], v[144:147]
    buffer_load_dwordx4 v[164:167], v2, s[4:7], s42 offen offset:256 sc1
    ds_read_b64_tr_b16 v[52:53], v4 offset:20480
    s_xor_b32 s42, s41, 36864
    v_mfma_f32_16x16x32_bf16 v[148:151], v[56:59], v[92:95], v[148:151]
    ds_read_b64_tr_b16 v[54:55], v4 offset:21504
    v_mfma_f32_16x16x32_bf16 v[152:155], v[60:63], v[88:91], v[152:155]
    ds_read_b64_tr_b16 v[56:57], v5 offset:20480
    v_mfma_f32_16x16x32_bf16 v[156:159], v[60:63], v[92:95], v[156:159]
    ds_read_b64_tr_b16 v[58:59], v5 offset:21504
    s_waitcnt vmcnt(8) lgkmcnt(10)
    v_mfma_f32_16x16x32_bf16 v[128:131], v[32:35], v[96:99], v[128:131]
    ds_read_b64_tr_b16 v[60:61], v6 offset:20480
    buffer_load_dwordx4 v[168:171], v2, s[4:7], s42 offen offset:0 sc1
    v_mfma_f32_16x16x32_bf16 v[132:135], v[32:35], v[100:103], v[132:135]
    ds_read_b64_tr_b16 v[62:63], v6 offset:21504
    v_mfma_f32_16x16x32_bf16 v[136:139], v[36:39], v[96:99], v[136:139]
    ds_read_b64_tr_b16 v[32:33], v3 offset:24576
    v_mfma_f32_16x16x32_bf16 v[140:143], v[36:39], v[100:103], v[140:143]
    ds_read_b64_tr_b16 v[34:35], v3 offset:25600
    s_waitcnt lgkmcnt(10)
    v_mfma_f32_16x16x32_bf16 v[144:147], v[40:43], v[96:99], v[144:147]
    buffer_load_dwordx4 v[172:175], v2, s[4:7], s42 offen offset:256 sc1
    ds_read_b64_tr_b16 v[36:37], v4 offset:24576
    s_xor_b32 s42, s41, 40960
    v_mfma_f32_16x16x32_bf16 v[148:151], v[40:43], v[100:103], v[148:151]
    ds_read_b64_tr_b16 v[38:39], v4 offset:25600
    v_mfma_f32_16x16x32_bf16 v[152:155], v[44:47], v[96:99], v[152:155]
    ds_read_b64_tr_b16 v[40:41], v5 offset:24576
    v_mfma_f32_16x16x32_bf16 v[156:159], v[44:47], v[100:103], v[156:159]
    ds_read_b64_tr_b16 v[42:43], v5 offset:25600
    s_waitcnt vmcnt(8) lgkmcnt(10)
    v_mfma_f32_16x16x32_bf16 v[128:131], v[48:51], v[104:107], v[128:131]
    buffer_load_dwordx4 v[176:179], v2, s[4:7], s42 offen offset:0 sc1
    ds_read_b64_tr_b16 v[44:45], v6 offset:24576
    v_mfma_f32_16x16x32_bf16 v[132:135], v[48:51], v[108:111], v[132:135]
    ds_read_b64_tr_b16 v[46:47], v6 offset:25600
    v_mfma_f32_16x16x32_bf16 v[136:139], v[52:55], v[104:107], v[136:139]
    ds_read_b64_tr_b16 v[48:49], v3 offset:28672
    v_mfma_f32_16x16x32_bf16 v[140:143], v[52:55], v[108:111], v[140:143]
    ds_read_b64_tr_b16 v[50:51], v3 offset:29696
    s_waitcnt lgkmcnt(10)
    v_mfma_f32_16x16x32_bf16 v[144:147], v[56:59], v[104:107], v[144:147]
    buffer_load_dwordx4 v[180:183], v2, s[4:7], s42 offen offset:256 sc1
    ds_read_b64_tr_b16 v[52:53], v4 offset:28672
    s_xor_b32 s42, s41, 45056
    v_mfma_f32_16x16x32_bf16 v[148:151], v[56:59], v[108:111], v[148:151]
    ds_read_b64_tr_b16 v[54:55], v4 offset:29696
    v_mfma_f32_16x16x32_bf16 v[152:155], v[60:63], v[104:107], v[152:155]
    ds_read_b64_tr_b16 v[56:57], v5 offset:28672
    v_mfma_f32_16x16x32_bf16 v[156:159], v[60:63], v[108:111], v[156:159]
    ds_read_b64_tr_b16 v[58:59], v5 offset:29696
    s_waitcnt vmcnt(8) lgkmcnt(10)
    v_mfma_f32_16x16x32_bf16 v[128:131], v[32:35], v[112:115], v[128:131]
    ds_read_b64_tr_b16 v[60:61], v6 offset:28672
    buffer_load_dwordx4 v[184:187], v2, s[4:7], s42 offen offset:0 sc1
    v_mfma_f32_16x16x32_bf16 v[132:135], v[32:35], v[116:119], v[132:135]
    ds_read_b64_tr_b16 v[62:63], v6 offset:29696
    v_mfma_f32_16x16x32_bf16 v[136:139], v[36:39], v[112:115], v[136:139]
    ds_read_b64_tr_b16 v[32:33], v3 offset:32768
    v_mfma_f32_16x16x32_bf16 v[140:143], v[36:39], v[116:119], v[140:143]
    ds_read_b64_tr_b16 v[34:35], v3 offset:33792
    s_waitcnt lgkmcnt(10)
    v_mfma_f32_16x16x32_bf16 v[144:147], v[40:43], v[112:115], v[144:147]
    buffer_load_dwordx4 v[188:191], v2, s[4:7], s42 offen offset:256 sc1
    ds_read_b64_tr_b16 v[36:37], v4 offset:32768
    s_xor_b32 s42, s41, 49152
    v_mfma_f32_16x16x32_bf16 v[148:151], v[40:43], v[116:119], v[148:151]
    ds_read_b64_tr_b16 v[38:39], v4 offset:33792
    v_mfma_f32_16x16x32_bf16 v[152:155], v[44:47], v[112:115], v[152:155]
    ds_read_b64_tr_b16 v[40:41], v5 offset:32768
    v_mfma_f32_16x16x32_bf16 v[156:159], v[44:47], v[116:119], v[156:159]
    ds_read_b64_tr_b16 v[42:43], v5 offset:33792
    s_waitcnt vmcnt(8) lgkmcnt(10)
    v_mfma_f32_16x16x32_bf16 v[128:131], v[48:51], v[120:123], v[128:131]
    buffer_load_dwordx4 v[64:67], v2, s[4:7], s42 offen offset:0 sc1
    ds_read_b64_tr_b16 v[44:45], v6 offset:32768
    v_mfma_f32_16x16x32_bf16 v[132:135], v[48:51], v[124:127], v[132:135]
    ds_read_b64_tr_b16 v[46:47], v6 offset:33792
    v_mfma_f32_16x16x32_bf16 v[136:139], v[52:55], v[120:123], v[136:139]
    ds_read_b64_tr_b16 v[48:49], v3 offset:36864
    v_mfma_f32_16x16x32_bf16 v[140:143], v[52:55], v[124:127], v[140:143]
    ds_read_b64_tr_b16 v[50:51], v3 offset:37888
    s_waitcnt lgkmcnt(10)
    v_mfma_f32_16x16x32_bf16 v[144:147], v[56:59], v[120:123], v[144:147]
    buffer_load_dwordx4 v[68:71], v2, s[4:7], s42 offen offset:256 sc1
    ds_read_b64_tr_b16 v[52:53], v4 offset:36864
    s_xor_b32 s42, s41, 53248
    v_mfma_f32_16x16x32_bf16 v[148:151], v[56:59], v[124:127], v[148:151]
    ds_read_b64_tr_b16 v[54:55], v4 offset:37888
    v_mfma_f32_16x16x32_bf16 v[152:155], v[60:63], v[120:123], v[152:155]
    ds_read_b64_tr_b16 v[56:57], v5 offset:36864
    v_mfma_f32_16x16x32_bf16 v[156:159], v[60:63], v[124:127], v[156:159]
    ds_read_b64_tr_b16 v[58:59], v5 offset:37888
    s_waitcnt vmcnt(8) lgkmcnt(10)
    v_mfma_f32_16x16x32_bf16 v[128:131], v[32:35], v[160:163], v[128:131]
    ds_read_b64_tr_b16 v[60:61], v6 offset:36864
    buffer_load_dwordx4 v[72:75], v2, s[4:7], s42 offen offset:0 sc1
    v_mfma_f32_16x16x32_bf16 v[132:135], v[32:35], v[164:167], v[132:135]
    ds_read_b64_tr_b16 v[62:63], v6 offset:37888
    v_mfma_f32_16x16x32_bf16 v[136:139], v[36:39], v[160:163], v[136:139]
    ds_read_b64_tr_b16 v[32:33], v3 offset:40960
    v_mfma_f32_16x16x32_bf16 v[140:143], v[36:39], v[164:167], v[140:143]
    ds_read_b64_tr_b16 v[34:35], v3 offset:41984
    s_waitcnt lgkmcnt(10)
    v_mfma_f32_16x16x32_bf16 v[144:147], v[40:43], v[160:163], v[144:147]
    buffer_load_dwordx4 v[76:79], v2, s[4:7], s42 offen offset:256 sc1
    ds_read_b64_tr_b16 v[36:37], v4 offset:40960
    s_xor_b32 s42, s41, 57344
    v_mfma_f32_16x16x32_bf16 v[148:151], v[40:43], v[164:167], v[148:151]
    ds_read_b64_tr_b16 v[38:39], v4 offset:41984
    v_mfma_f32_16x16x32_bf16 v[152:155], v[44:47], v[160:163], v[152:155]
    ds_read_b64_tr_b16 v[40:41], v5 offset:40960
    v_mfma_f32_16x16x32_bf16 v[156:159], v[44:47], v[164:167], v[156:159]
    ds_read_b64_tr_b16 v[42:43], v5 offset:41984
    s_waitcnt vmcnt(8) lgkmcnt(10)
    v_mfma_f32_16x16x32_bf16 v[128:131], v[48:51], v[168:171], v[128:131]
    buffer_load_dwordx4 v[80:83], v2, s[4:7], s42 offen offset:0 sc1
    ds_read_b64_tr_b16 v[44:45], v6 offset:40960
    v_mfma_f32_16x16x32_bf16 v[132:135], v[48:51], v[172:175], v[132:135]
    ds_read_b64_tr_b16 v[46:47], v6 offset:41984
    v_mfma_f32_16x16x32_bf16 v[136:139], v[52:55], v[168:171], v[136:139]
    ds_read_b64_tr_b16 v[48:49], v3 offset:45056
    v_mfma_f32_16x16x32_bf16 v[140:143], v[52:55], v[172:175], v[140:143]
    ds_read_b64_tr_b16 v[50:51], v3 offset:46080
    s_waitcnt lgkmcnt(10)
    v_mfma_f32_16x16x32_bf16 v[144:147], v[56:59], v[168:171], v[144:147]
    buffer_load_dwordx4 v[84:87], v2, s[4:7], s42 offen offset:256 sc1
    ds_read_b64_tr_b16 v[52:53], v4 offset:45056
    s_xor_b32 s42, s41, 61440
    v_mfma_f32_16x16x32_bf16 v[148:151], v[56:59], v[172:175], v[148:151]
    ds_read_b64_tr_b16 v[54:55], v4 offset:46080
    v_mfma_f32_16x16x32_bf16 v[152:155], v[60:63], v[168:171], v[152:155]
    ds_read_b64_tr_b16 v[56:57], v5 offset:45056
    v_mfma_f32_16x16x32_bf16 v[156:159], v[60:63], v[172:175], v[156:159]
    ds_read_b64_tr_b16 v[58:59], v5 offset:46080
    s_waitcnt vmcnt(8) lgkmcnt(10)
    v_mfma_f32_16x16x32_bf16 v[128:131], v[32:35], v[176:179], v[128:131]
    ds_read_b64_tr_b16 v[60:61], v6 offset:45056
    buffer_load_dwordx4 v[88:91], v2, s[4:7], s42 offen offset:0 sc1
    v_mfma_f32_16x16x32_bf16 v[132:135], v[32:35], v[180:183], v[132:135]
    ds_read_b64_tr_b16 v[62:63], v6 offset:46080
    s_barrier
    v_mfma_f32_16x16x32_bf16 v[136:139], v[36:39], v[176:179], v[136:139]
    ds_read_b64_tr_b16 v[32:33], v3 offset:49152
    v_mfma_f32_16x16x32_bf16 v[140:143], v[36:39], v[180:183], v[140:143]
    ds_read_b64_tr_b16 v[34:35], v3 offset:50176
    s_waitcnt lgkmcnt(10)
    v_mfma_f32_16x16x32_bf16 v[144:147], v[40:43], v[176:179], v[144:147]
    buffer_load_dwordx4 v[92:95], v2, s[4:7], s42 offen offset:256 sc1
    ds_read_b64_tr_b16 v[36:37], v4 offset:49152
    s_xor_b32 s42, s41, 0
    v_mfma_f32_16x16x32_bf16 v[148:151], v[40:43], v[180:183], v[148:151]
    ds_read_b64_tr_b16 v[38:39], v4 offset:50176
    v_mfma_f32_16x16x32_bf16 v[152:155], v[44:47], v[176:179], v[152:155]
    ds_read_b64_tr_b16 v[40:41], v5 offset:49152
    v_mfma_f32_16x16x32_bf16 v[156:159], v[44:47], v[180:183], v[156:159]
    ds_read_b64_tr_b16 v[42:43], v5 offset:50176
    s_waitcnt vmcnt(8) lgkmcnt(10)
    v_mfma_f32_16x16x32_bf16 v[128:131], v[48:51], v[184:187], v[128:131]
    buffer_load_dwordx4 v[96:99], v2, s[4:7], s42 offen offset:2048 sc1
    ds_read_b64_tr_b16 v[44:45], v6 offset:49152
    v_mfma_f32_16x16x32_bf16 v[132:135], v[48:51], v[188:191], v[132:135]
    ds_read_b64_tr_b16 v[46:47], v6 offset:50176
    v_mfma_f32_16x16x32_bf16 v[136:139], v[52:55], v[184:187], v[136:139]
    ds_read_b64_tr_b16 v[48:49], v3 offset:53248
    v_mfma_f32_16x16x32_bf16 v[140:143], v[52:55], v[188:191], v[140:143]
    ds_read_b64_tr_b16 v[50:51], v3 offset:54272
    s_waitcnt lgkmcnt(10)
    v_mfma_f32_16x16x32_bf16 v[144:147], v[56:59], v[184:187], v[144:147]
    buffer_load_dwordx4 v[100:103], v2, s[4:7], s42 offen offset:2304 sc1
    ds_read_b64_tr_b16 v[52:53], v4 offset:53248
    s_xor_b32 s42, s41, 4096
    v_mfma_f32_16x16x32_bf16 v[148:151], v[56:59], v[188:191], v[148:151]
    ds_read_b64_tr_b16 v[54:55], v4 offset:54272
    v_mfma_f32_16x16x32_bf16 v[152:155], v[60:63], v[184:187], v[152:155]
    ds_read_b64_tr_b16 v[56:57], v5 offset:53248
    v_mfma_f32_16x16x32_bf16 v[156:159], v[60:63], v[188:191], v[156:159]
    ds_read_b64_tr_b16 v[58:59], v5 offset:54272
    s_waitcnt vmcnt(8) lgkmcnt(10)
    v_mfma_f32_16x16x32_bf16 v[128:131], v[32:35], v[64:67], v[128:131]
    ds_read_b64_tr_b16 v[60:61], v6 offset:53248
    buffer_load_dwordx4 v[104:107], v2, s[4:7], s42 offen offset:2048 sc1
    v_mfma_f32_16x16x32_bf16 v[132:135], v[32:35], v[68:71], v[132:135]
    ds_read_b64_tr_b16 v[62:63], v6 offset:54272
    v_mfma_f32_16x16x32_bf16 v[136:139], v[36:39], v[64:67], v[136:139]
    ds_read_b64_tr_b16 v[32:33], v3 offset:57344
    v_mfma_f32_16x16x32_bf16 v[140:143], v[36:39], v[68:71], v[140:143]
    ds_read_b64_tr_b16 v[34:35], v3 offset:58368
    s_waitcnt lgkmcnt(10)
    v_mfma_f32_16x16x32_bf16 v[144:147], v[40:43], v[64:67], v[144:147]
    buffer_load_dwordx4 v[108:111], v2, s[4:7], s42 offen offset:2304 sc1
    ds_read_b64_tr_b16 v[36:37], v4 offset:57344
    s_xor_b32 s42, s41, 8192
    v_mfma_f32_16x16x32_bf16 v[148:151], v[40:43], v[68:71], v[148:151]
    ds_read_b64_tr_b16 v[38:39], v4 offset:58368
    v_mfma_f32_16x16x32_bf16 v[152:155], v[44:47], v[64:67], v[152:155]
    ds_read_b64_tr_b16 v[40:41], v5 offset:57344
    v_mfma_f32_16x16x32_bf16 v[156:159], v[44:47], v[68:71], v[156:159]
    ds_read_b64_tr_b16 v[42:43], v5 offset:58368
    s_waitcnt vmcnt(8) lgkmcnt(10)
    v_mfma_f32_16x16x32_bf16 v[128:131], v[48:51], v[72:75], v[128:131]
    buffer_load_dwordx4 v[112:115], v2, s[4:7], s42 offen offset:2048 sc1
    ds_read_b64_tr_b16 v[44:45], v6 offset:57344
    v_mfma_f32_16x16x32_bf16 v[132:135], v[48:51], v[76:79], v[132:135]
    ds_read_b64_tr_b16 v[46:47], v6 offset:58368
    v_mfma_f32_16x16x32_bf16 v[136:139], v[52:55], v[72:75], v[136:139]
    ds_read_b64_tr_b16 v[48:49], v3 offset:61440
    v_mfma_f32_16x16x32_bf16 v[140:143], v[52:55], v[76:79], v[140:143]
    ds_read_b64_tr_b16 v[50:51], v3 offset:62464
    s_waitcnt lgkmcnt(10)
    v_mfma_f32_16x16x32_bf16 v[144:147], v[56:59], v[72:75], v[144:147]
    buffer_load_dwordx4 v[116:119], v2, s[4:7], s42 offen offset:2304 sc1
    ds_read_b64_tr_b16 v[52:53], v4 offset:61440
    s_xor_b32 s42, s41, 12288
    v_mfma_f32_16x16x32_bf16 v[148:151], v[56:59], v[76:79], v[148:151]
    ds_read_b64_tr_b16 v[54:55], v4 offset:62464
    v_mfma_f32_16x16x32_bf16 v[152:155], v[60:63], v[72:75], v[152:155]
    ds_read_b64_tr_b16 v[56:57], v5 offset:61440
    v_mfma_f32_16x16x32_bf16 v[156:159], v[60:63], v[76:79], v[156:159]
    ds_read_b64_tr_b16 v[58:59], v5 offset:62464
    s_waitcnt vmcnt(8) lgkmcnt(10)
    v_mfma_f32_16x16x32_bf16 v[128:131], v[32:35], v[80:83], v[128:131]
    ds_read_b64_tr_b16 v[60:61], v6 offset:61440
    buffer_load_dwordx4 v[120:123], v2, s[4:7], s42 offen offset:2048 sc1
    v_mfma_f32_16x16x32_bf16 v[132:135], v[32:35], v[84:87], v[132:135]
    ds_read_b64_tr_b16 v[62:63], v6 offset:62464
    v_xor_b32 v3, 0x10000, v3
    v_xor_b32 v4, 0x10000, v4
    v_xor_b32 v5, 0x10000, v5
    v_xor_b32 v6, 0x10000, v6
    v_mfma_f32_16x16x32_bf16 v[136:139], v[36:39], v[80:83], v[136:139]
    ds_read_b64_tr_b16 v[32:33], v3 offset:0
    v_mfma_f32_16x16x32_bf16 v[140:143], v[36:39], v[84:87], v[140:143]
    ds_read_b64_tr_b16 v[34:35], v3 offset:1024
    s_waitcnt lgkmcnt(10)
    v_mfma_f32_16x16x32_bf16 v[144:147], v[40:43], v[80:83], v[144:147]
    buffer_load_dwordx4 v[124:127], v2, s[4:7], s42 offen offset:2304 sc1
    ds_read_b64_tr_b16 v[36:37], v4 offset:0
    s_xor_b32 s42, s41, 16384
    v_mfma_f32_16x16x32_bf16 v[148:151], v[40:43], v[84:87], v[148:151]
    ds_read_b64_tr_b16 v[38:39], v4 offset:1024
    v_mfma_f32_16x16x32_bf16 v[152:155], v[44:47], v[80:83], v[152:155]
    ds_read_b64_tr_b16 v[40:41], v5 offset:0
    v_mfma_f32_16x16x32_bf16 v[156:159], v[44:47], v[84:87], v[156:159]
    ds_read_b64_tr_b16 v[42:43], v5 offset:1024
    s_waitcnt vmcnt(8) lgkmcnt(10)
    v_mfma_f32_16x16x32_bf16 v[128:131], v[48:51], v[88:91], v[128:131]
    buffer_load_dwordx4 v[160:163], v2, s[4:7], s42 offen offset:2048 sc1
    ds_read_b64_tr_b16 v[44:45], v6 offset:0
    v_mfma_f32_16x16x32_bf16 v[132:135], v[48:51], v[92:95], v[132:135]
    ds_read_b64_tr_b16 v[46:47], v6 offset:1024
    v_mfma_f32_16x16x32_bf16 v[136:139], v[52:55], v[88:91], v[136:139]
    ds_read_b64_tr_b16 v[48:49], v3 offset:4096
    v_mfma_f32_16x16x32_bf16 v[140:143], v[52:55], v[92:95], v[140:143]
    ds_read_b64_tr_b16 v[50:51], v3 offset:5120
    s_waitcnt lgkmcnt(10)
    v_mfma_f32_16x16x32_bf16 v[144:147], v[56:59], v[88:91], v[144:147]
    buffer_load_dwordx4 v[164:167], v2, s[4:7], s42 offen offset:2304 sc1
    ds_read_b64_tr_b16 v[52:53], v4 offset:4096
    s_xor_b32 s42, s41, 20480
    v_mfma_f32_16x16x32_bf16 v[148:151], v[56:59], v[92:95], v[148:151]
    ds_read_b64_tr_b16 v[54:55], v4 offset:5120
    v_mfma_f32_16x16x32_bf16 v[152:155], v[60:63], v[88:91], v[152:155]
    ds_read_b64_tr_b16 v[56:57], v5 offset:4096
    v_mfma_f32_16x16x32_bf16 v[156:159], v[60:63], v[92:95], v[156:159]
    ds_read_b64_tr_b16 v[58:59], v5 offset:5120
    s_waitcnt vmcnt(8) lgkmcnt(10)
    v_mfma_f32_16x16x32_bf16 v[128:131], v[32:35], v[96:99], v[128:131]
    ds_read_b64_tr_b16 v[60:61], v6 offset:4096
    buffer_load_dwordx4 v[168:171], v2, s[4:7], s42 offen offset:2048 sc1
    v_mfma_f32_16x16x32_bf16 v[132:135], v[32:35], v[100:103], v[132:135]
    ds_read_b64_tr_b16 v[62:63], v6 offset:5120
    v_mfma_f32_16x16x32_bf16 v[136:139], v[36:39], v[96:99], v[136:139]
    ds_read_b64_tr_b16 v[32:33], v3 offset:8192
    v_mfma_f32_16x16x32_bf16 v[140:143], v[36:39], v[100:103], v[140:143]
    ds_read_b64_tr_b16 v[34:35], v3 offset:9216
    s_waitcnt lgkmcnt(10)
    v_mfma_f32_16x16x32_bf16 v[144:147], v[40:43], v[96:99], v[144:147]
    buffer_load_dwordx4 v[172:175], v2, s[4:7], s42 offen offset:2304 sc1
    ds_read_b64_tr_b16 v[36:37], v4 offset:8192
    s_xor_b32 s42, s41, 24576
    v_mfma_f32_16x16x32_bf16 v[148:151], v[40:43], v[100:103], v[148:151]
    ds_read_b64_tr_b16 v[38:39], v4 offset:9216
    v_mfma_f32_16x16x32_bf16 v[152:155], v[44:47], v[96:99], v[152:155]
    ds_read_b64_tr_b16 v[40:41], v5 offset:8192
    v_mfma_f32_16x16x32_bf16 v[156:159], v[44:47], v[100:103], v[156:159]
    ds_read_b64_tr_b16 v[42:43], v5 offset:9216
    s_waitcnt vmcnt(8) lgkmcnt(10)
    v_mfma_f32_16x16x32_bf16 v[128:131], v[48:51], v[104:107], v[128:131]
    buffer_load_dwordx4 v[176:179], v2, s[4:7], s42 offen offset:2048 sc1
    ds_read_b64_tr_b16 v[44:45], v6 offset:8192
    v_mfma_f32_16x16x32_bf16 v[132:135], v[48:51], v[108:111], v[132:135]
    ds_read_b64_tr_b16 v[46:47], v6 offset:9216
    v_mfma_f32_16x16x32_bf16 v[136:139], v[52:55], v[104:107], v[136:139]
    ds_read_b64_tr_b16 v[48:49], v3 offset:12288
    v_mfma_f32_16x16x32_bf16 v[140:143], v[52:55], v[108:111], v[140:143]
    ds_read_b64_tr_b16 v[50:51], v3 offset:13312
    s_waitcnt lgkmcnt(10)
    v_mfma_f32_16x16x32_bf16 v[144:147], v[56:59], v[104:107], v[144:147]
    buffer_load_dwordx4 v[180:183], v2, s[4:7], s42 offen offset:2304 sc1
    ds_read_b64_tr_b16 v[52:53], v4 offset:12288
    s_xor_b32 s42, s41, 28672
    v_mfma_f32_16x16x32_bf16 v[148:151], v[56:59], v[108:111], v[148:151]
    ds_read_b64_tr_b16 v[54:55], v4 offset:13312
    v_mfma_f32_16x16x32_bf16 v[152:155], v[60:63], v[104:107], v[152:155]
    ds_read_b64_tr_b16 v[56:57], v5 offset:12288
    v_mfma_f32_16x16x32_bf16 v[156:159], v[60:63], v[108:111], v[156:159]
    ds_read_b64_tr_b16 v[58:59], v5 offset:13312
    s_waitcnt vmcnt(8) lgkmcnt(10)
    v_mfma_f32_16x16x32_bf16 v[128:131], v[32:35], v[112:115], v[128:131]
    ds_read_b64_tr_b16 v[60:61], v6 offset:12288
    buffer_load_dwordx4 v[184:187], v2, s[4:7], s42 offen offset:2048 sc1
    v_mfma_f32_16x16x32_bf16 v[132:135], v[32:35], v[116:119], v[132:135]
    ds_read_b64_tr_b16 v[62:63], v6 offset:13312
    v_mfma_f32_16x16x32_bf16 v[136:139], v[36:39], v[112:115], v[136:139]
    ds_read_b64_tr_b16 v[32:33], v3 offset:16384
    v_mfma_f32_16x16x32_bf16 v[140:143], v[36:39], v[116:119], v[140:143]
    ds_read_b64_tr_b16 v[34:35], v3 offset:17408
    s_waitcnt lgkmcnt(10)
    v_mfma_f32_16x16x32_bf16 v[144:147], v[40:43], v[112:115], v[144:147]
    buffer_load_dwordx4 v[188:191], v2, s[4:7], s42 offen offset:2304 sc1
    ds_read_b64_tr_b16 v[36:37], v4 offset:16384
    s_xor_b32 s42, s41, 32768
    v_mfma_f32_16x16x32_bf16 v[148:151], v[40:43], v[116:119], v[148:151]
    ds_read_b64_tr_b16 v[38:39], v4 offset:17408
    v_mfma_f32_16x16x32_bf16 v[152:155], v[44:47], v[112:115], v[152:155]
    ds_read_b64_tr_b16 v[40:41], v5 offset:16384
    v_mfma_f32_16x16x32_bf16 v[156:159], v[44:47], v[116:119], v[156:159]
    ds_read_b64_tr_b16 v[42:43], v5 offset:17408
    s_waitcnt vmcnt(8) lgkmcnt(10)
    v_mfma_f32_16x16x32_bf16 v[128:131], v[48:51], v[120:123], v[128:131]
    buffer_load_dwordx4 v[64:67], v2, s[4:7], s42 offen offset:2048 sc1
    ds_read_b64_tr_b16 v[44:45], v6 offset:16384
    v_mfma_f32_16x16x32_bf16 v[132:135], v[48:51], v[124:127], v[132:135]
    ds_read_b64_tr_b16 v[46:47], v6 offset:17408
    v_mfma_f32_16x16x32_bf16 v[136:139], v[52:55], v[120:123], v[136:139]
    ds_read_b64_tr_b16 v[48:49], v3 offset:20480
    v_mfma_f32_16x16x32_bf16 v[140:143], v[52:55], v[124:127], v[140:143]
    ds_read_b64_tr_b16 v[50:51], v3 offset:21504
    s_waitcnt lgkmcnt(10)
    v_mfma_f32_16x16x32_bf16 v[144:147], v[56:59], v[120:123], v[144:147]
    buffer_load_dwordx4 v[68:71], v2, s[4:7], s42 offen offset:2304 sc1
    ds_read_b64_tr_b16 v[52:53], v4 offset:20480
    s_xor_b32 s42, s41, 36864
    v_mfma_f32_16x16x32_bf16 v[148:151], v[56:59], v[124:127], v[148:151]
    ds_read_b64_tr_b16 v[54:55], v4 offset:21504
    v_mfma_f32_16x16x32_bf16 v[152:155], v[60:63], v[120:123], v[152:155]
    ds_read_b64_tr_b16 v[56:57], v5 offset:20480
    v_mfma_f32_16x16x32_bf16 v[156:159], v[60:63], v[124:127], v[156:159]
    ds_read_b64_tr_b16 v[58:59], v5 offset:21504
    s_waitcnt vmcnt(8) lgkmcnt(10)
    v_mfma_f32_16x16x32_bf16 v[128:131], v[32:35], v[160:163], v[128:131]
    ds_read_b64_tr_b16 v[60:61], v6 offset:20480
    buffer_load_dwordx4 v[72:75], v2, s[4:7], s42 offen offset:2048 sc1
    v_mfma_f32_16x16x32_bf16 v[132:135], v[32:35], v[164:167], v[132:135]
    ds_read_b64_tr_b16 v[62:63], v6 offset:21504
    v_mfma_f32_16x16x32_bf16 v[136:139], v[36:39], v[160:163], v[136:139]
    ds_read_b64_tr_b16 v[32:33], v3 offset:24576
    v_mfma_f32_16x16x32_bf16 v[140:143], v[36:39], v[164:167], v[140:143]
    ds_read_b64_tr_b16 v[34:35], v3 offset:25600
    s_waitcnt lgkmcnt(10)
    v_mfma_f32_16x16x32_bf16 v[144:147], v[40:43], v[160:163], v[144:147]
    buffer_load_dwordx4 v[76:79], v2, s[4:7], s42 offen offset:2304 sc1
    ds_read_b64_tr_b16 v[36:37], v4 offset:24576
    s_xor_b32 s42, s41, 40960
    v_mfma_f32_16x16x32_bf16 v[148:151], v[40:43], v[164:167], v[148:151]
    ds_read_b64_tr_b16 v[38:39], v4 offset:25600
    v_mfma_f32_16x16x32_bf16 v[152:155], v[44:47], v[160:163], v[152:155]
    ds_read_b64_tr_b16 v[40:41], v5 offset:24576
    v_mfma_f32_16x16x32_bf16 v[156:159], v[44:47], v[164:167], v[156:159]
    ds_read_b64_tr_b16 v[42:43], v5 offset:25600
    s_waitcnt vmcnt(8) lgkmcnt(10)
    v_mfma_f32_16x16x32_bf16 v[128:131], v[48:51], v[168:171], v[128:131]
    buffer_load_dwordx4 v[80:83], v2, s[4:7], s42 offen offset:2048 sc1
    ds_read_b64_tr_b16 v[44:45], v6 offset:24576
    v_mfma_f32_16x16x32_bf16 v[132:135], v[48:51], v[172:175], v[132:135]
    ds_read_b64_tr_b16 v[46:47], v6 offset:25600
    v_mfma_f32_16x16x32_bf16 v[136:139], v[52:55], v[168:171], v[136:139]
    ds_read_b64_tr_b16 v[48:49], v3 offset:28672
    v_mfma_f32_16x16x32_bf16 v[140:143], v[52:55], v[172:175], v[140:143]
    ds_read_b64_tr_b16 v[50:51], v3 offset:29696
    s_waitcnt lgkmcnt(10)
    v_mfma_f32_16x16x32_bf16 v[144:147], v[56:59], v[168:171], v[144:147]
    buffer_load_dwordx4 v[84:87], v2, s[4:7], s42 offen offset:2304 sc1
    ds_read_b64_tr_b16 v[52:53], v4 offset:28672
    s_xor_b32 s42, s41, 45056
    v_mfma_f32_16x16x32_bf16 v[148:151], v[56:59], v[172:175], v[148:151]
    ds_read_b64_tr_b16 v[54:55], v4 offset:29696
    v_mfma_f32_16x16x32_bf16 v[152:155], v[60:63], v[168:171], v[152:155]
    ds_read_b64_tr_b16 v[56:57], v5 offset:28672
    v_mfma_f32_16x16x32_bf16 v[156:159], v[60:63], v[172:175], v[156:159]
    ds_read_b64_tr_b16 v[58:59], v5 offset:29696
    s_waitcnt vmcnt(8) lgkmcnt(10)
    v_mfma_f32_16x16x32_bf16 v[128:131], v[32:35], v[176:179], v[128:131]
    ds_read_b64_tr_b16 v[60:61], v6 offset:28672
    buffer_load_dwordx4 v[88:91], v2, s[4:7], s42 offen offset:2048 sc1
    v_mfma_f32_16x16x32_bf16 v[132:135], v[32:35], v[180:183], v[132:135]
    ds_read_b64_tr_b16 v[62:63], v6 offset:29696
    v_mfma_f32_16x16x32_bf16 v[136:139], v[36:39], v[176:179], v[136:139]
    ds_read_b64_tr_b16 v[32:33], v3 offset:32768
    v_mfma_f32_16x16x32_bf16 v[140:143], v[36:39], v[180:183], v[140:143]
    ds_read_b64_tr_b16 v[34:35], v3 offset:33792
    s_waitcnt lgkmcnt(10)
    v_mfma_f32_16x16x32_bf16 v[144:147], v[40:43], v[176:179], v[144:147]
    buffer_load_dwordx4 v[92:95], v2, s[4:7], s42 offen offset:2304 sc1
    ds_read_b64_tr_b16 v[36:37], v4 offset:32768
    s_xor_b32 s42, s41, 49152
    v_mfma_f32_16x16x32_bf16 v[148:151], v[40:43], v[180:183], v[148:151]
    ds_read_b64_tr_b16 v[38:39], v4 offset:33792
    v_mfma_f32_16x16x32_bf16 v[152:155], v[44:47], v[176:179], v[152:155]
    ds_read_b64_tr_b16 v[40:41], v5 offset:32768
    v_mfma_f32_16x16x32_bf16 v[156:159], v[44:47], v[180:183], v[156:159]
    ds_read_b64_tr_b16 v[42:43], v5 offset:33792
    s_waitcnt vmcnt(8) lgkmcnt(10)
    v_mfma_f32_16x16x32_bf16 v[128:131], v[48:51], v[184:187], v[128:131]
    buffer_load_dwordx4 v[96:99], v2, s[4:7], s42 offen offset:2048 sc1
    ds_read_b64_tr_b16 v[44:45], v6 offset:32768
    v_mfma_f32_16x16x32_bf16 v[132:135], v[48:51], v[188:191], v[132:135]
    ds_read_b64_tr_b16 v[46:47], v6 offset:33792
    v_mfma_f32_16x16x32_bf16 v[136:139], v[52:55], v[184:187], v[136:139]
    ds_read_b64_tr_b16 v[48:49], v3 offset:36864
    v_mfma_f32_16x16x32_bf16 v[140:143], v[52:55], v[188:191], v[140:143]
    ds_read_b64_tr_b16 v[50:51], v3 offset:37888
    s_waitcnt lgkmcnt(10)
    v_mfma_f32_16x16x32_bf16 v[144:147], v[56:59], v[184:187], v[144:147]
    buffer_load_dwordx4 v[100:103], v2, s[4:7], s42 offen offset:2304 sc1
    ds_read_b64_tr_b16 v[52:53], v4 offset:36864
    s_xor_b32 s42, s41, 53248
    v_mfma_f32_16x16x32_bf16 v[148:151], v[56:59], v[188:191], v[148:151]
    ds_read_b64_tr_b16 v[54:55], v4 offset:37888
    v_mfma_f32_16x16x32_bf16 v[152:155], v[60:63], v[184:187], v[152:155]
    ds_read_b64_tr_b16 v[56:57], v5 offset:36864
    v_mfma_f32_16x16x32_bf16 v[156:159], v[60:63], v[188:191], v[156:159]
    ds_read_b64_tr_b16 v[58:59], v5 offset:37888
    s_waitcnt vmcnt(8) lgkmcnt(10)
    v_mfma_f32_16x16x32_bf16 v[128:131], v[32:35], v[64:67], v[128:131]
    ds_read_b64_tr_b16 v[60:61], v6 offset:36864
    buffer_load_dwordx4 v[104:107], v2, s[4:7], s42 offen offset:2048 sc1
    v_mfma_f32_16x16x32_bf16 v[132:135], v[32:35], v[68:71], v[132:135]
    ds_read_b64_tr_b16 v[62:63], v6 offset:37888
    v_mfma_f32_16x16x32_bf16 v[136:139], v[36:39], v[64:67], v[136:139]
    ds_read_b64_tr_b16 v[32:33], v3 offset:40960
    v_mfma_f32_16x16x32_bf16 v[140:143], v[36:39], v[68:71], v[140:143]
    ds_read_b64_tr_b16 v[34:35], v3 offset:41984
    s_waitcnt lgkmcnt(10)
    v_mfma_f32_16x16x32_bf16 v[144:147], v[40:43], v[64:67], v[144:147]
    buffer_load_dwordx4 v[108:111], v2, s[4:7], s42 offen offset:2304 sc1
    ds_read_b64_tr_b16 v[36:37], v4 offset:40960
    s_xor_b32 s42, s41, 57344
    v_mfma_f32_16x16x32_bf16 v[148:151], v[40:43], v[68:71], v[148:151]
    ds_read_b64_tr_b16 v[38:39], v4 offset:41984
    v_mfma_f32_16x16x32_bf16 v[152:155], v[44:47], v[64:67], v[152:155]
    ds_read_b64_tr_b16 v[40:41], v5 offset:40960
    v_mfma_f32_16x16x32_bf16 v[156:159], v[44:47], v[68:71], v[156:159]
    ds_read_b64_tr_b16 v[42:43], v5 offset:41984
    s_waitcnt vmcnt(8) lgkmcnt(10)
    v_mfma_f32_16x16x32_bf16 v[128:131], v[48:51], v[72:75], v[128:131]
    buffer_load_dwordx4 v[112:115], v2, s[4:7], s42 offen offset:2048 sc1
    ds_read_b64_tr_b16 v[44:45], v6 offset:40960
    v_mfma_f32_16x16x32_bf16 v[132:135], v[48:51], v[76:79], v[132:135]
    ds_read_b64_tr_b16 v[46:47], v6 offset:41984
    v_mfma_f32_16x16x32_bf16 v[136:139], v[52:55], v[72:75], v[136:139]
    ds_read_b64_tr_b16 v[48:49], v3 offset:45056
    v_mfma_f32_16x16x32_bf16 v[140:143], v[52:55], v[76:79], v[140:143]
    ds_read_b64_tr_b16 v[50:51], v3 offset:46080
    s_waitcnt lgkmcnt(10)
    v_mfma_f32_16x16x32_bf16 v[144:147], v[56:59], v[72:75], v[144:147]
    buffer_load_dwordx4 v[116:119], v2, s[4:7], s42 offen offset:2304 sc1
    ds_read_b64_tr_b16 v[52:53], v4 offset:45056
    s_xor_b32 s42, s41, 61440
    v_mfma_f32_16x16x32_bf16 v[148:151], v[56:59], v[76:79], v[148:151]
    ds_read_b64_tr_b16 v[54:55], v4 offset:46080
    v_mfma_f32_16x16x32_bf16 v[152:155], v[60:63], v[72:75], v[152:155]
    ds_read_b64_tr_b16 v[56:57], v5 offset:45056
    v_mfma_f32_16x16x32_bf16 v[156:159], v[60:63], v[76:79], v[156:159]
    ds_read_b64_tr_b16 v[58:59], v5 offset:46080
    s_waitcnt vmcnt(8) lgkmcnt(10)
    v_mfma_f32_16x16x32_bf16 v[128:131], v[32:35], v[80:83], v[128:131]
    ds_read_b64_tr_b16 v[60:61], v6 offset:45056
    buffer_load_dwordx4 v[120:123], v2, s[4:7], s42 offen offset:2048 sc1
    v_mfma_f32_16x16x32_bf16 v[132:135], v[32:35], v[84:87], v[132:135]
    ds_read_b64_tr_b16 v[62:63], v6 offset:46080
    v_mfma_f32_16x16x32_bf16 v[136:139], v[36:39], v[80:83], v[136:139]
    ds_read_b64_tr_b16 v[32:33], v3 offset:49152
    v_mfma_f32_16x16x32_bf16 v[140:143], v[36:39], v[84:87], v[140:143]
    ds_read_b64_tr_b16 v[34:35], v3 offset:50176
    s_waitcnt lgkmcnt(10)
    v_mfma_f32_16x16x32_bf16 v[144:147], v[40:43], v[80:83], v[144:147]
    buffer_load_dwordx4 v[124:127], v2, s[4:7], s42 offen offset:2304 sc1
    ds_read_b64_tr_b16 v[36:37], v4 offset:49152
    v_mfma_f32_16x16x32_bf16 v[148:151], v[40:43], v[84:87], v[148:151]
    ds_read_b64_tr_b16 v[38:39], v4 offset:50176
    v_mfma_f32_16x16x32_bf16 v[152:155], v[44:47], v[80:83], v[152:155]
    ds_read_b64_tr_b16 v[40:41], v5 offset:49152
    v_mfma_f32_16x16x32_bf16 v[156:159], v[44:47], v[84:87], v[156:159]
    ds_read_b64_tr_b16 v[42:43], v5 offset:50176
    s_waitcnt vmcnt(8) lgkmcnt(10)
    v_mfma_f32_16x16x32_bf16 v[128:131], v[48:51], v[88:91], v[128:131]
    ds_read_b64_tr_b16 v[44:45], v6 offset:49152
    v_mfma_f32_16x16x32_bf16 v[132:135], v[48:51], v[92:95], v[132:135]
    ds_read_b64_tr_b16 v[46:47], v6 offset:50176
    v_mfma_f32_16x16x32_bf16 v[136:139], v[52:55], v[88:91], v[136:139]
    ds_read_b64_tr_b16 v[48:49], v3 offset:53248
    v_mfma_f32_16x16x32_bf16 v[140:143], v[52:55], v[92:95], v[140:143]
    ds_read_b64_tr_b16 v[50:51], v3 offset:54272
    s_waitcnt lgkmcnt(10)
    v_mfma_f32_16x16x32_bf16 v[144:147], v[56:59], v[88:91], v[144:147]
    ds_read_b64_tr_b16 v[52:53], v4 offset:53248
    v_mfma_f32_16x16x32_bf16 v[148:151], v[56:59], v[92:95], v[148:151]
    ds_read_b64_tr_b16 v[54:55], v4 offset:54272
    v_mfma_f32_16x16x32_bf16 v[152:155], v[60:63], v[88:91], v[152:155]
    ds_read_b64_tr_b16 v[56:57], v5 offset:53248
    v_mfma_f32_16x16x32_bf16 v[156:159], v[60:63], v[92:95], v[156:159]
    ds_read_b64_tr_b16 v[58:59], v5 offset:54272
    s_waitcnt vmcnt(6) lgkmcnt(10)
    v_mfma_f32_16x16x32_bf16 v[128:131], v[32:35], v[96:99], v[128:131]
    ds_read_b64_tr_b16 v[60:61], v6 offset:53248
    v_mfma_f32_16x16x32_bf16 v[132:135], v[32:35], v[100:103], v[132:135]
    ds_read_b64_tr_b16 v[62:63], v6 offset:54272
    v_mfma_f32_16x16x32_bf16 v[136:139], v[36:39], v[96:99], v[136:139]
    ds_read_b64_tr_b16 v[32:33], v3 offset:57344
    v_mfma_f32_16x16x32_bf16 v[140:143], v[36:39], v[100:103], v[140:143]
    ds_read_b64_tr_b16 v[34:35], v3 offset:58368
    s_waitcnt lgkmcnt(10)
    v_mfma_f32_16x16x32_bf16 v[144:147], v[40:43], v[96:99], v[144:147]
    ds_read_b64_tr_b16 v[36:37], v4 offset:57344
    v_mfma_f32_16x16x32_bf16 v[148:151], v[40:43], v[100:103], v[148:151]
    ds_read_b64_tr_b16 v[38:39], v4 offset:58368
    v_mfma_f32_16x16x32_bf16 v[152:155], v[44:47], v[96:99], v[152:155]
    ds_read_b64_tr_b16 v[40:41], v5 offset:57344
    v_mfma_f32_16x16x32_bf16 v[156:159], v[44:47], v[100:103], v[156:159]
    ds_read_b64_tr_b16 v[42:43], v5 offset:58368
    s_waitcnt vmcnt(4) lgkmcnt(10)
    v_mfma_f32_16x16x32_bf16 v[128:131], v[48:51], v[104:107], v[128:131]
    ds_read_b64_tr_b16 v[44:45], v6 offset:57344
    v_mfma_f32_16x16x32_bf16 v[132:135], v[48:51], v[108:111], v[132:135]
    ds_read_b64_tr_b16 v[46:47], v6 offset:58368
    v_mfma_f32_16x16x32_bf16 v[136:139], v[52:55], v[104:107], v[136:139]
    ds_read_b64_tr_b16 v[48:49], v3 offset:61440
    v_mfma_f32_16x16x32_bf16 v[140:143], v[52:55], v[108:111], v[140:143]
    ds_read_b64_tr_b16 v[50:51], v3 offset:62464
    s_waitcnt lgkmcnt(10)
    v_mfma_f32_16x16x32_bf16 v[144:147], v[56:59], v[104:107], v[144:147]
    ds_read_b64_tr_b16 v[52:53], v4 offset:61440
    v_mfma_f32_16x16x32_bf16 v[148:151], v[56:59], v[108:111], v[148:151]
    ds_read_b64_tr_b16 v[54:55], v4 offset:62464
    v_mfma_f32_16x16x32_bf16 v[152:155], v[60:63], v[104:107], v[152:155]
    ds_read_b64_tr_b16 v[56:57], v5 offset:61440
    v_mfma_f32_16x16x32_bf16 v[156:159], v[60:63], v[108:111], v[156:159]
    ds_read_b64_tr_b16 v[58:59], v5 offset:62464
    s_waitcnt vmcnt(2) lgkmcnt(10)
    v_mfma_f32_16x16x32_bf16 v[128:131], v[32:35], v[112:115], v[128:131]
    ds_read_b64_tr_b16 v[60:61], v6 offset:61440
    v_mfma_f32_16x16x32_bf16 v[132:135], v[32:35], v[116:119], v[132:135]
    ds_read_b64_tr_b16 v[62:63], v6 offset:62464
    v_xor_b32 v3, 0x10000, v3
    v_xor_b32 v4, 0x10000, v4
    v_xor_b32 v5, 0x10000, v5
    v_xor_b32 v6, 0x10000, v6
    v_mfma_f32_16x16x32_bf16 v[136:139], v[36:39], v[112:115], v[136:139]
    v_mfma_f32_16x16x32_bf16 v[140:143], v[36:39], v[116:119], v[140:143]
    s_waitcnt lgkmcnt(8)
    v_mfma_f32_16x16x32_bf16 v[144:147], v[40:43], v[112:115], v[144:147]
    v_mfma_f32_16x16x32_bf16 v[148:151], v[40:43], v[116:119], v[148:151]
    v_mfma_f32_16x16x32_bf16 v[152:155], v[44:47], v[112:115], v[152:155]
    v_mfma_f32_16x16x32_bf16 v[156:159], v[44:47], v[116:119], v[156:159]
    s_waitcnt vmcnt(0) lgkmcnt(4)
    v_mfma_f32_16x16x32_bf16 v[128:131], v[48:51], v[120:123], v[128:131]
    v_mfma_f32_16x16x32_bf16 v[132:135], v[48:51], v[124:127], v[132:135]
    v_mfma_f32_16x16x32_bf16 v[136:139], v[52:55], v[120:123], v[136:139]
    v_mfma_f32_16x16x32_bf16 v[140:143], v[52:55], v[124:127], v[140:143]
    s_waitcnt lgkmcnt(0)
    v_mfma_f32_16x16x32_bf16 v[144:147], v[56:59], v[120:123], v[144:147]
    v_mfma_f32_16x16x32_bf16 v[148:151], v[56:59], v[124:127], v[148:151]
    v_mfma_f32_16x16x32_bf16 v[152:155], v[60:63], v[120:123], v[152:155]
    v_mfma_f32_16x16x32_bf16 v[156:159], v[60:63], v[124:127], v[156:159]
    s_cmp_eq_u32 s21, 3
    s_cbranch_scc1 c_final
    s_add_u32 s43, s43, 4194304
    v_cvt_pk_bf16_f32 v160, v128, v129
    v_cvt_pk_bf16_f32 v161, v130, v131
    v_cvt_pk_bf16_f32 v162, v136, v137
    v_cvt_pk_bf16_f32 v163, v138, v139
    v_cvt_pk_bf16_f32 v168, v144, v145
    v_cvt_pk_bf16_f32 v169, v146, v147
    v_cvt_pk_bf16_f32 v170, v152, v153
    v_cvt_pk_bf16_f32 v171, v154, v155
    v_permlane32_swap_b32 v160, v162
    v_permlane32_swap_b32 v161, v163
    buffer_store_dwordx4 v[160:163], v2, s[4:7], s43 offen offset:0 sc1
    v_permlane32_swap_b32 v168, v170
    v_permlane32_swap_b32 v169, v171
    buffer_store_dwordx4 v[168:171], v2, s[4:7], s43 offen offset:2048 sc1
    v_cvt_pk_bf16_f32 v164, v132, v133
    v_cvt_pk_bf16_f32 v165, v134, v135
    v_cvt_pk_bf16_f32 v166, v140, v141
    v_cvt_pk_bf16_f32 v167, v142, v143
    v_cvt_pk_bf16_f32 v172, v148, v149
    v_cvt_pk_bf16_f32 v173, v150, v151
    v_cvt_pk_bf16_f32 v174, v156, v157
    v_cvt_pk_bf16_f32 v175, v158, v159
    v_permlane32_swap_b32 v164, v166
    v_permlane32_swap_b32 v165, v167
    buffer_store_dwordx4 v[164:167], v2, s[4:7], s43 offen offset:256 sc1
    v_permlane32_swap_b32 v172, v174
    v_permlane32_swap_b32 v173, v175
    buffer_store_dwordx4 v[172:175], v2, s[4:7], s43 offen offset:2304 sc1
    s_barrier
    v_mov_b32 v12, 0x3f803f80
    v_mov_b32 v14, 0
    v_mov_b32 v15, 0
    v_mov_b32 v16, 0
    v_mov_b32 v17, 0
    v_dot2_f32_bf16 v14, v160, v12, v14
    v_dot2_f32_bf16 v15, v160, v160, v15
    v_dot2_f32_bf16 v16, v164, v12, v16
    v_dot2_f32_bf16 v17, v164, v164, v17
    v_dot2_f32_bf16 v14, v161, v12, v14
    v_dot2_f32_bf16 v15, v161, v161, v15
    v_dot2_f32_bf16 v16, v165, v12, v16
    v_dot2_f32_bf16 v17, v165, v165, v17
    v_dot2_f32_bf16 v14, v162, v12, v14
    v_dot2_f32_bf16 v15, v162, v162, v15
    v_dot2_f32_bf16 v16, v166, v12, v16
    v_dot2_f32_bf16 v17, v166, v166, v17
    v_dot2_f32_bf16 v14, v163, v12, v14
    v_dot2_f32_bf16 v15, v163, v163, v15
    v_dot2_f32_bf16 v16, v167, v12, v16
    v_dot2_f32_bf16 v17, v167, v167, v17
    v_dot2_f32_bf16 v14, v168, v12, v14
    v_dot2_f32_bf16 v15, v168, v168, v15
    v_dot2_f32_bf16 v16, v172, v12, v16
    v_dot2_f32_bf16 v17, v172, v172, v17
    v_dot2_f32_bf16 v14, v169, v12, v14
    v_dot2_f32_bf16 v15, v169, v169, v15
    v_dot2_f32_bf16 v16, v173, v12, v16
    v_dot2_f32_bf16 v17, v173, v173, v17
    v_dot2_f32_bf16 v14, v170, v12, v14
    v_dot2_f32_bf16 v15, v170, v170, v15
    v_dot2_f32_bf16 v16, v174, v12, v16
    v_dot2_f32_bf16 v17, v174, v174, v17
    v_dot2_f32_bf16 v14, v171, v12, v14
    v_dot2_f32_bf16 v15, v171, v171, v15
    v_dot2_f32_bf16 v16, v175, v12, v16
    v_dot2_f32_bf16 v17, v175, v175, v17
    s_nop 2
    v_permlane16_swap_b32 v14, v16
    v_permlane16_swap_b32 v15, v17
    v_pk_add_f32 v[14:15], v[14:15], v[16:17]
    v_mov_b32 v16, v14
    v_mov_b32 v17, v15
    s_nop 0
    v_permlane32_swap_b32 v14, v16
    v_permlane32_swap_b32 v15, v17
    v_pk_add_f32 v[14:15], v[14:15], v[16:17]
    v_lshrrev_b32 v13, 1, v1
    v_and_b32 v13, 0xf8, v13
    s_add_u32 s21, s21, 1
    s_lshl_b32 s44, s21, 18
    s_lshl_b32 s45, s38, 12
    s_add_u32 s44, s44, s45
    s_lshl_b32 s45, s18, 8
    s_add_u32 s44, s44, s45
    s_add_u32 s44, s44, 50331648
    buffer_store_dwordx2 v[14:15], v13, s[4:7], s44 offen sc1
    s_lshl_b32 s46, s21, 14
    s_lshl_b32 s67, s38, 7
    s_add_u32 s46, s46, s67
    s_add_u32 s46, s46, 4096
    s_add_u32 s47, s46, 8192
    s_waitcnt vmcnt(1)
    s_atomic_add s40, s[22:23], s46
    s_branch c_layer
c_final:
    s_mov_b32 s8, s32
    s_mov_b32 s9, s33
    s_mov_b32 s10, 4194304
    s_mov_b32 s11, 0x00020000
    v_lshrrev_b32 v12, 4, v1
    s_mul_i32 s44, s16, 4608
    s_add_u32 s44, s44, 131072
    v_and_b32 v13, 15, v12
    v_mul_u32_u24 v13, 144, v13
    v_lshrrev_b32 v14, 4, v12
    v_lshl_add_u32 v13, v14, 3, v13
    v_add_u32 v13, s44, v13
    v_cvt_pk_bf16_f32 v128, v128, v129
    v_cvt_pk_bf16_f32 v129, v130, v131
    ds_write_b64 v13, v[128:129] offset:0
    v_cvt_pk_bf16_f32 v136, v136, v137
    v_cvt_pk_bf16_f32 v137, v138, v139
    ds_write_b64 v13, v[136:137] offset:32
    v_cvt_pk_bf16_f32 v144, v144, v145
    v_cvt_pk_bf16_f32 v145, v146, v147
    ds_write_b64 v13, v[144:145] offset:64
    v_cvt_pk_bf16_f32 v152, v152, v153
    v_cvt_pk_bf16_f32 v153, v154, v155
    ds_write_b64 v13, v[152:153] offset:96
    v_cvt_pk_bf16_f32 v132, v132, v133
    v_cvt_pk_bf16_f32 v133, v134, v135
    ds_write_b64 v13, v[132:133] offset:2304
    v_cvt_pk_bf16_f32 v140, v140, v141
    v_cvt_pk_bf16_f32 v141, v142, v143
    ds_write_b64 v13, v[140:141] offset:2336
    v_cvt_pk_bf16_f32 v148, v148, v149
    v_cvt_pk_bf16_f32 v149, v150, v151
    ds_write_b64 v13, v[148:149] offset:2368
    v_cvt_pk_bf16_f32 v156, v156, v157
    v_cvt_pk_bf16_f32 v157, v158, v159
    ds_write_b64 v13, v[156:157] offset:2400
    v_lshrrev_b32 v14, 3, v12
    v_and_b32 v15, 7, v12
    v_mul_u32_u24 v16, 144, v14
    v_lshl_add_u32 v16, v15, 4, v16
    v_add_u32 v16, s44, v16
    v_lshlrev_b32 v17, 11, v14
    v_lshl_add_u32 v17, v15, 4, v17
    ds_read_b128 v[32:35], v16 offset:0
    ds_read_b128 v[36:39], v16 offset:1152
    ds_read_b128 v[40:43], v16 offset:2304
    ds_read_b128 v[44:47], v16 offset:3456
    s_lshl_b32 s44, s38, 16
    s_lshl_b32 s45, s18, 7
    s_add_u32 s44, s44, s45
    s_waitcnt lgkmcnt(3)
    buffer_store_dwordx4 v[32:35], v17, s[8:11], s44 offen sc1
    s_add_u32 s44, s44, 16384
    s_waitcnt lgkmcnt(2)
    buffer_store_dwordx4 v[36:39], v17, s[8:11], s44 offen sc1
    s_add_u32 s44, s44, 16384
    s_waitcnt lgkmcnt(1)
    buffer_store_dwordx4 v[40:43], v17, s[8:11], s44 offen sc1
    s_add_u32 s44, s44, 16384
    s_waitcnt lgkmcnt(0)
    buffer_store_dwordx4 v[44:47], v17, s[8:11], s44 offen sc1
    s_endpgm
s_start:
    v_mov_b32 v14, 0
    v_mov_b32 v15, 0
    v_mov_b32 v20, 0
    v_mov_b32 v21, 0
    v_mov_b32 v22, 0
    s_mov_b32 s41, 0
    s_mov_b32 s42, 0
    s_mov_b32 s43, 0
    s_mov_b32 s62, 0
    s_cmp_eq_u32 s16, 4
    s_cbranch_scc1 h_start
    s_cmp_eq_u32 s16, 7
    s_cbranch_scc1 z_start
l_start:
    v_lshrrev_b32 v24, 4, v1
    v_lshrrev_b32 v25, 3, v24
    v_mul_u32_u24 v12, 6144, v25
    v_and_b32 v26, 2, v25
    v_lshrrev_b32 v25, 2, v25
    v_or_b32 v26, v26, v25
    v_bfe_u32 v25, v24, 1, 2
    v_xor_b32 v26, v26, v25
    v_lshl_add_u32 v12, v26, 5, v12
    v_and_b32 v26, 1, v24
    v_lshl_add_u32 v12, v26, 4, v12
    s_lshl_b32 s3, s18, 7
    v_add_u32 v12, s3, v12
    v_add_u32 v13, 48128, v12
    s_mul_i32 s84, s18, 393216
    s_cmp_eq_u32 s18, 1
    s_cselect_b32 s85, 0, 393216
    s_sub_u32 s3, s16, 5
    s_lshl_b32 s41, s3, 11
    s_mul_i32 s42, s3, 98304
    s_lshl_b32 s62, s3, 15
    v_add_u32 v14, s42, v12
    v_add_u32 v15, s42, v13
    s_bitcmp1_b32 s21, 0
    s_cselect_b32 s8, s28, s24
    s_cselect_b32 s9, s29, s25
    s_cselect_b32 s12, s30, s26
    s_cselect_b32 s13, s31, s27
    s_mov_b32 s10, 6291456
    s_mov_b32 s11, 0x00020000
    s_mov_b32 s14, 2097152
    s_mov_b32 s15, 0x00020000
    s_add_u32 m0, s41, 0
    s_add_u32 s44, s84, 2048
    buffer_load_dwordx4 v14, s[8:11], s44 offen offset:0 lds
    buffer_load_dwordx4 v15, s[8:11], s44 offen offset:1024 lds
    s_add_u32 m0, s41, 4096
    s_add_u32 s44, s84, 4096
    buffer_load_dwordx4 v14, s[8:11], s44 offen offset:0 lds
    buffer_load_dwordx4 v15, s[8:11], s44 offen offset:1024 lds
    s_add_u32 m0, s41, 8192
    s_add_u32 s44, s84, 0
    buffer_load_dwordx4 v14, s[8:11], s44 offen offset:0 lds
    buffer_load_dwordx4 v15, s[8:11], s44 offen offset:1024 lds
    s_add_u32 m0, s41, 12288
    s_add_u32 s44, s84, 198656
    buffer_load_dwordx4 v14, s[8:11], s44 offen offset:0 lds
    buffer_load_dwordx4 v15, s[8:11], s44 offen offset:1024 lds
    s_add_u32 m0, s41, 16384
    s_add_u32 s44, s84, 200704
    buffer_load_dwordx4 v14, s[8:11], s44 offen offset:0 lds
    buffer_load_dwordx4 v15, s[8:11], s44 offen offset:1024 lds
    s_add_u32 m0, s41, 20480
    s_add_u32 s44, s84, 196608
    buffer_load_dwordx4 v14, s[8:11], s44 offen offset:0 lds
    buffer_load_dwordx4 v15, s[8:11], s44 offen offset:1024 lds
    s_add_u32 m0, s41, 24576
    s_add_u32 s44, s85, 2048
    buffer_load_dwordx4 v14, s[8:11], s44 offen offset:0 lds
    buffer_load_dwordx4 v15, s[8:11], s44 offen offset:1024 lds
    s_add_u32 m0, s41, 28672
    s_add_u32 s44, s85, 4096
    buffer_load_dwordx4 v14, s[8:11], s44 offen offset:0 lds
    buffer_load_dwordx4 v15, s[8:11], s44 offen offset:1024 lds
    s_cmp_eq_u32 s18, 2
    s_cselect_b32 s86, 0, 786432
    s_cmp_eq_u32 s18, 3
    s_cselect_b32 s87, 0, 1179648
    s_cmp_eq_u32 s18, 4
    s_cselect_b32 s88, 0, 1572864
    s_cmp_eq_u32 s18, 5
    s_cselect_b32 s89, 0, 1966080
    s_cmp_eq_u32 s18, 6
    s_cselect_b32 s90, 0, 2359296
    s_cmp_eq_u32 s18, 7
    s_cselect_b32 s91, 0, 2752512
    s_cmp_eq_u32 s18, 8
    s_cselect_b32 s92, 0, 3145728
    s_cmp_eq_u32 s18, 9
    s_cselect_b32 s93, 0, 3538944
    s_cmp_eq_u32 s18, 10
    s_cselect_b32 s94, 0, 3932160
    s_cmp_eq_u32 s18, 11
    s_cselect_b32 s95, 0, 4325376
    s_cmp_eq_u32 s18, 12
    s_cselect_b32 s96, 0, 4718592
    s_cmp_eq_u32 s18, 13
    s_cselect_b32 s97, 0, 5111808
    s_cmp_eq_u32 s18, 14
    s_cselect_b32 s98, 0, 5505024
    s_cmp_eq_u32 s18, 15
    s_cselect_b32 s99, 0, 5898240
    v_lshrrev_b32 v24, 4, v1
    v_lshrrev_b32 v25, 3, v24
    v_mul_u32_u24 v16, 2048, v25
    v_and_b32 v26, 2, v25
    v_lshrrev_b32 v25, 2, v25
    v_or_b32 v26, v26, v25
    v_bfe_u32 v25, v24, 1, 2
    v_xor_b32 v26, v26, v25
    v_lshl_add_u32 v16, v26, 5, v16
    v_and_b32 v26, 1, v24
    v_lshl_add_u32 v16, v26, 4, v16
    s_lshl_b32 s3, s18, 7
    v_add_u32 v16, s3, v16
    v_add_u32 v17, 15360, v16
    v_add_u32 v18, 30720, v16
    v_add_u32 v19, 46080, v16
    s_and_b32 s3, s16, 3
    s_mul_i32 s3, s3, 49152
    v_add_u32 v11, s3, v12
    s_and_b32 s3, s16, 3
    s_lshl_b32 s3, s3, 10
    v_add_u32 v9, s3, v1
    v_add_u32 v10, 0x10000, v9
    s_barrier
    s_waitcnt vmcnt(0)
    s_barrier
    s_add_u32 m0, s41, 32768
    s_add_u32 s44, s85, 0
    buffer_load_dwordx4 v14, s[8:11], s44 offen offset:0 lds
    buffer_load_dwordx4 v15, s[8:11], s44 offen offset:1024 lds
    s_add_u32 m0, s41, 36864
    s_add_u32 s44, s85, 198656
    buffer_load_dwordx4 v14, s[8:11], s44 offen offset:0 lds
    buffer_load_dwordx4 v15, s[8:11], s44 offen offset:1024 lds
    s_add_u32 m0, s41, 40960
    s_add_u32 s44, s85, 200704
    buffer_load_dwordx4 v14, s[8:11], s44 offen offset:0 lds
    buffer_load_dwordx4 v15, s[8:11], s44 offen offset:1024 lds
    s_add_u32 m0, s41, 45056
    s_add_u32 s44, s85, 196608
    buffer_load_dwordx4 v14, s[8:11], s44 offen offset:0 lds
    buffer_load_dwordx4 v15, s[8:11], s44 offen offset:1024 lds
    s_add_u32 m0, s41, 49152
    s_add_u32 s44, s86, 2048
    buffer_load_dwordx4 v14, s[8:11], s44 offen offset:0 lds
    buffer_load_dwordx4 v15, s[8:11], s44 offen offset:1024 lds
    s_add_u32 m0, s41, 53248
    s_add_u32 s44, s86, 4096
    buffer_load_dwordx4 v14, s[8:11], s44 offen offset:0 lds
    buffer_load_dwordx4 v15, s[8:11], s44 offen offset:1024 lds
    s_add_u32 m0, s41, 57344
    s_add_u32 s44, s86, 0
    buffer_load_dwordx4 v14, s[8:11], s44 offen offset:0 lds
    buffer_load_dwordx4 v15, s[8:11], s44 offen offset:1024 lds
    s_add_u32 m0, s41, 61440
    s_add_u32 s44, s86, 198656
    buffer_load_dwordx4 v14, s[8:11], s44 offen offset:0 lds
    buffer_load_dwordx4 v15, s[8:11], s44 offen offset:1024 lds
    s_waitcnt vmcnt(0)
    s_barrier
    s_add_u32 m0, s41, 65536
    s_add_u32 s44, s86, 200704
    buffer_load_dwordx4 v14, s[8:11], s44 offen offset:0 lds
    buffer_load_dwordx4 v15, s[8:11], s44 offen offset:1024 lds
    s_add_u32 m0, s41, 69632
    s_add_u32 s44, s86, 196608
    buffer_load_dwordx4 v14, s[8:11], s44 offen offset:0 lds
    buffer_load_dwordx4 v15, s[8:11], s44 offen offset:1024 lds
    s_add_u32 m0, s41, 73728
    s_add_u32 s44, s87, 2048
    buffer_load_dwordx4 v14, s[8:11], s44 offen offset:0 lds
    buffer_load_dwordx4 v15, s[8:11], s44 offen offset:1024 lds
    s_add_u32 m0, s41, 77824
    s_add_u32 s44, s87, 4096
    buffer_load_dwordx4 v14, s[8:11], s44 offen offset:0 lds
    buffer_load_dwordx4 v15, s[8:11], s44 offen offset:1024 lds
    s_add_u32 m0, s41, 81920
    s_add_u32 s44, s87, 0
    buffer_load_dwordx4 v14, s[8:11], s44 offen offset:0 lds
    buffer_load_dwordx4 v15, s[8:11], s44 offen offset:1024 lds
    s_add_u32 m0, s41, 86016
    s_add_u32 s44, s87, 198656
    buffer_load_dwordx4 v14, s[8:11], s44 offen offset:0 lds
    buffer_load_dwordx4 v15, s[8:11], s44 offen offset:1024 lds
    s_add_u32 m0, s41, 90112
    s_add_u32 s44, s87, 200704
    buffer_load_dwordx4 v14, s[8:11], s44 offen offset:0 lds
    buffer_load_dwordx4 v15, s[8:11], s44 offen offset:1024 lds
    s_add_u32 m0, s41, 94208
    s_add_u32 s44, s87, 196608
    buffer_load_dwordx4 v14, s[8:11], s44 offen offset:0 lds
    buffer_load_dwordx4 v15, s[8:11], s44 offen offset:1024 lds
    s_add_u32 m0, s41, 98304
    s_add_u32 s44, s88, 2048
    buffer_load_dwordx4 v14, s[8:11], s44 offen offset:0 lds
    buffer_load_dwordx4 v15, s[8:11], s44 offen offset:1024 lds
    s_add_u32 m0, s41, 102400
    s_add_u32 s44, s88, 4096
    buffer_load_dwordx4 v14, s[8:11], s44 offen offset:0 lds
    buffer_load_dwordx4 v15, s[8:11], s44 offen offset:1024 lds
    s_add_u32 m0, s41, 106496
    s_add_u32 s44, s88, 0
    buffer_load_dwordx4 v14, s[8:11], s44 offen offset:0 lds
    buffer_load_dwordx4 v15, s[8:11], s44 offen offset:1024 lds
    s_add_u32 m0, s41, 110592
    s_add_u32 s44, s88, 198656
    buffer_load_dwordx4 v14, s[8:11], s44 offen offset:0 lds
    buffer_load_dwordx4 v15, s[8:11], s44 offen offset:1024 lds
    s_add_u32 m0, s41, 114688
    s_add_u32 s44, s88, 200704
    buffer_load_dwordx4 v14, s[8:11], s44 offen offset:0 lds
    buffer_load_dwordx4 v15, s[8:11], s44 offen offset:1024 lds
    s_add_u32 m0, s41, 118784
    s_add_u32 s44, s88, 196608
    buffer_load_dwordx4 v14, s[8:11], s44 offen offset:0 lds
    buffer_load_dwordx4 v15, s[8:11], s44 offen offset:1024 lds
    s_add_u32 m0, s41, 122880
    s_add_u32 s44, s89, 2048
    buffer_load_dwordx4 v14, s[8:11], s44 offen offset:0 lds
    buffer_load_dwordx4 v15, s[8:11], s44 offen offset:1024 lds
    s_add_u32 m0, s41, 126976
    s_add_u32 s44, s89, 4096
    buffer_load_dwordx4 v14, s[8:11], s44 offen offset:0 lds
    buffer_load_dwordx4 v15, s[8:11], s44 offen offset:1024 lds
    s_add_u32 m0, s41, 0
    s_add_u32 s44, s89, 0
    buffer_load_dwordx4 v14, s[8:11], s44 offen offset:0 lds
    buffer_load_dwordx4 v15, s[8:11], s44 offen offset:1024 lds
    s_add_u32 m0, s41, 4096
    s_add_u32 s44, s89, 198656
    buffer_load_dwordx4 v14, s[8:11], s44 offen offset:0 lds
    buffer_load_dwordx4 v15, s[8:11], s44 offen offset:1024 lds
    s_add_u32 m0, s41, 8192
    s_add_u32 s44, s89, 200704
    buffer_load_dwordx4 v14, s[8:11], s44 offen offset:0 lds
    buffer_load_dwordx4 v15, s[8:11], s44 offen offset:1024 lds
    s_add_u32 m0, s41, 12288
    s_add_u32 s44, s89, 196608
    buffer_load_dwordx4 v14, s[8:11], s44 offen offset:0 lds
    buffer_load_dwordx4 v15, s[8:11], s44 offen offset:1024 lds
    s_waitcnt vmcnt(24)
    s_branch l_join
l_layer:
    s_waitcnt lgkmcnt(0)
    s_barrier
    s_add_u32 m0, s41, 0
    s_add_u32 s44, s89, 0
    buffer_load_dwordx4 v14, s[8:11], s44 offen offset:0 lds
    buffer_load_dwordx4 v15, s[8:11], s44 offen offset:1024 lds
    s_add_u32 m0, s41, 4096
    s_add_u32 s44, s89, 198656
    buffer_load_dwordx4 v14, s[8:11], s44 offen offset:0 lds
    buffer_load_dwordx4 v15, s[8:11], s44 offen offset:1024 lds
    s_add_u32 m0, s41, 8192
    s_add_u32 s44, s89, 200704
    buffer_load_dwordx4 v14, s[8:11], s44 offen offset:0 lds
    buffer_load_dwordx4 v15, s[8:11], s44 offen offset:1024 lds
    s_add_u32 m0, s41, 12288
    s_add_u32 s44, s89, 196608
    buffer_load_dwordx4 v14, s[8:11], s44 offen offset:0 lds
    buffer_load_dwordx4 v15, s[8:11], s44 offen offset:1024 lds
l_join:
    s_barrier
    s_add_u32 m0, s41, 16384
    s_add_u32 s44, s90, 2048
    buffer_load_dwordx4 v14, s[8:11], s44 offen offset:0 lds
    buffer_load_dwordx4 v15, s[8:11], s44 offen offset:1024 lds
    s_add_u32 m0, s41, 20480
    s_add_u32 s44, s90, 4096
    buffer_load_dwordx4 v14, s[8:11], s44 offen offset:0 lds
    buffer_load_dwordx4 v15, s[8:11], s44 offen offset:1024 lds
    s_add_u32 m0, s41, 24576
    s_add_u32 s44, s90, 0
    buffer_load_dwordx4 v14, s[8:11], s44 offen offset:0 lds
    buffer_load_dwordx4 v15, s[8:11], s44 offen offset:1024 lds
    s_add_u32 m0, s41, 28672
    s_add_u32 s44, s90, 198656
    buffer_load_dwordx4 v14, s[8:11], s44 offen offset:0 lds
    buffer_load_dwordx4 v15, s[8:11], s44 offen offset:1024 lds
    s_add_u32 m0, s41, 32768
    s_add_u32 s44, s90, 200704
    buffer_load_dwordx4 v14, s[8:11], s44 offen offset:0 lds
    buffer_load_dwordx4 v15, s[8:11], s44 offen offset:1024 lds
    s_add_u32 m0, s41, 36864
    s_add_u32 s44, s90, 196608
    buffer_load_dwordx4 v14, s[8:11], s44 offen offset:0 lds
    buffer_load_dwordx4 v15, s[8:11], s44 offen offset:1024 lds
    s_add_u32 m0, s41, 40960
    s_add_u32 s44, s91, 2048
    buffer_load_dwordx4 v14, s[8:11], s44 offen offset:0 lds
    buffer_load_dwordx4 v15, s[8:11], s44 offen offset:1024 lds
    s_add_u32 m0, s41, 45056
    s_add_u32 s44, s91, 4096
    buffer_load_dwordx4 v14, s[8:11], s44 offen offset:0 lds
    buffer_load_dwordx4 v15, s[8:11], s44 offen offset:1024 lds
    s_waitcnt vmcnt(24)
    s_barrier
    s_add_u32 m0, s41, 49152
    s_add_u32 s44, s91, 0
    buffer_load_dwordx4 v14, s[8:11], s44 offen offset:0 lds
    buffer_load_dwordx4 v15, s[8:11], s44 offen offset:1024 lds
    s_add_u32 m0, s41, 53248
    s_add_u32 s44, s91, 198656
    buffer_load_dwordx4 v14, s[8:11], s44 offen offset:0 lds
    buffer_load_dwordx4 v15, s[8:11], s44 offen offset:1024 lds
    s_add_u32 m0, s41, 57344
    s_add_u32 s44, s91, 200704
    buffer_load_dwordx4 v14, s[8:11], s44 offen offset:0 lds
    buffer_load_dwordx4 v15, s[8:11], s44 offen offset:1024 lds
    s_add_u32 m0, s41, 61440
    s_add_u32 s44, s91, 196608
    buffer_load_dwordx4 v14, s[8:11], s44 offen offset:0 lds
    buffer_load_dwordx4 v15, s[8:11], s44 offen offset:1024 lds
    s_waitcnt vmcnt(16)
    s_barrier
    s_add_u32 m0, s41, 65536
    s_add_u32 s44, s92, 2048
    buffer_load_dwordx4 v14, s[8:11], s44 offen offset:0 lds
    buffer_load_dwordx4 v15, s[8:11], s44 offen offset:1024 lds
    s_add_u32 m0, s41, 69632
    s_add_u32 s44, s92, 4096
    buffer_load_dwordx4 v14, s[8:11], s44 offen offset:0 lds
    buffer_load_dwordx4 v15, s[8:11], s44 offen offset:1024 lds
    s_add_u32 m0, s41, 73728
    s_add_u32 s44, s92, 0
    buffer_load_dwordx4 v14, s[8:11], s44 offen offset:0 lds
    buffer_load_dwordx4 v15, s[8:11], s44 offen offset:1024 lds
    s_add_u32 m0, s41, 77824
    s_add_u32 s44, s92, 198656
    buffer_load_dwordx4 v14, s[8:11], s44 offen offset:0 lds
    buffer_load_dwordx4 v15, s[8:11], s44 offen offset:1024 lds
    s_add_u32 m0, s41, 81920
    s_add_u32 s44, s92, 200704
    buffer_load_dwordx4 v14, s[8:11], s44 offen offset:0 lds
    buffer_load_dwordx4 v15, s[8:11], s44 offen offset:1024 lds
    s_add_u32 m0, s41, 86016
    s_add_u32 s44, s92, 196608
    buffer_load_dwordx4 v14, s[8:11], s44 offen offset:0 lds
    buffer_load_dwordx4 v15, s[8:11], s44 offen offset:1024 lds
    s_add_u32 m0, s41, 90112
    s_add_u32 s44, s93, 2048
    buffer_load_dwordx4 v14, s[8:11], s44 offen offset:0 lds
    buffer_load_dwordx4 v15, s[8:11], s44 offen offset:1024 lds
    s_add_u32 m0, s41, 94208
    s_add_u32 s44, s93, 4096
    buffer_load_dwordx4 v14, s[8:11], s44 offen offset:0 lds
    buffer_load_dwordx4 v15, s[8:11], s44 offen offset:1024 lds
    s_waitcnt vmcnt(16)
    s_barrier
    s_add_u32 m0, s41, 98304
    s_add_u32 s44, s93, 0
    buffer_load_dwordx4 v14, s[8:11], s44 offen offset:0 lds
    buffer_load_dwordx4 v15, s[8:11], s44 offen offset:1024 lds
    s_add_u32 m0, s41, 102400
    s_add_u32 s44, s93, 198656
    buffer_load_dwordx4 v14, s[8:11], s44 offen offset:0 lds
    buffer_load_dwordx4 v15, s[8:11], s44 offen offset:1024 lds
    s_add_u32 m0, s41, 106496
    s_add_u32 s44, s93, 200704
    buffer_load_dwordx4 v14, s[8:11], s44 offen offset:0 lds
    buffer_load_dwordx4 v15, s[8:11], s44 offen offset:1024 lds
    s_add_u32 m0, s41, 110592
    s_add_u32 s44, s93, 196608
    buffer_load_dwordx4 v14, s[8:11], s44 offen offset:0 lds
    buffer_load_dwordx4 v15, s[8:11], s44 offen offset:1024 lds
    s_add_u32 m0, s41, 114688
    s_add_u32 s44, s94, 2048
    buffer_load_dwordx4 v14, s[8:11], s44 offen offset:0 lds
    buffer_load_dwordx4 v15, s[8:11], s44 offen offset:1024 lds
    s_add_u32 m0, s41, 118784
    s_add_u32 s44, s94, 4096
    buffer_load_dwordx4 v14, s[8:11], s44 offen offset:0 lds
    buffer_load_dwordx4 v15, s[8:11], s44 offen offset:1024 lds
    s_add_u32 m0, s41, 122880
    s_add_u32 s44, s94, 198656
    buffer_load_dwordx4 v14, s[8:11], s44 offen offset:0 lds
    buffer_load_dwordx4 v15, s[8:11], s44 offen offset:1024 lds
    s_add_u32 m0, s41, 126976
    s_add_u32 s44, s94, 200704
    buffer_load_dwordx4 v14, s[8:11], s44 offen offset:0 lds
    buffer_load_dwordx4 v15, s[8:11], s44 offen offset:1024 lds
    s_waitcnt vmcnt(16)
    s_barrier
    s_add_u32 m0, s41, 0
    s_add_u32 s44, s95, 2048
    buffer_load_dwordx4 v14, s[8:11], s44 offen offset:0 lds
    buffer_load_dwordx4 v15, s[8:11], s44 offen offset:1024 lds
    s_add_u32 m0, s41, 4096
    s_add_u32 s44, s95, 4096
    buffer_load_dwordx4 v14, s[8:11], s44 offen offset:0 lds
    buffer_load_dwordx4 v15, s[8:11], s44 offen offset:1024 lds
    s_add_u32 m0, s41, 8192
    s_add_u32 s44, s95, 198656
    buffer_load_dwordx4 v14, s[8:11], s44 offen offset:0 lds
    buffer_load_dwordx4 v15, s[8:11], s44 offen offset:1024 lds
    s_add_u32 m0, s41, 12288
    s_add_u32 s44, s95, 200704
    buffer_load_dwordx4 v14, s[8:11], s44 offen offset:0 lds
    buffer_load_dwordx4 v15, s[8:11], s44 offen offset:1024 lds
    s_add_u32 m0, s41, 16384
    s_add_u32 s44, s96, 2048
    buffer_load_dwordx4 v14, s[8:11], s44 offen offset:0 lds
    buffer_load_dwordx4 v15, s[8:11], s44 offen offset:1024 lds
    s_add_u32 m0, s41, 20480
    s_add_u32 s44, s96, 198656
    buffer_load_dwordx4 v14, s[8:11], s44 offen offset:0 lds
    buffer_load_dwordx4 v15, s[8:11], s44 offen offset:1024 lds
    s_add_u32 m0, s41, 24576
    s_add_u32 s44, s97, 2048
    buffer_load_dwordx4 v14, s[8:11], s44 offen offset:0 lds
    buffer_load_dwordx4 v15, s[8:11], s44 offen offset:1024 lds
    s_add_u32 m0, s41, 28672
    s_add_u32 s44, s97, 198656
    buffer_load_dwordx4 v14, s[8:11], s44 offen offset:0 lds
    buffer_load_dwordx4 v15, s[8:11], s44 offen offset:1024 lds
    s_waitcnt vmcnt(16)
    s_barrier
    s_add_u32 m0, s41, 32768
    s_add_u32 s44, s98, 2048
    buffer_load_dwordx4 v14, s[8:11], s44 offen offset:0 lds
    buffer_load_dwordx4 v15, s[8:11], s44 offen offset:1024 lds
    s_add_u32 m0, s41, 36864
    s_add_u32 s44, s98, 198656
    buffer_load_dwordx4 v14, s[8:11], s44 offen offset:0 lds
    buffer_load_dwordx4 v15, s[8:11], s44 offen offset:1024 lds
    s_add_u32 m0, s41, 40960
    s_add_u32 s44, s99, 2048
    buffer_load_dwordx4 v14, s[8:11], s44 offen offset:0 lds
    buffer_load_dwordx4 v15, s[8:11], s44 offen offset:1024 lds
    s_add_u32 m0, s41, 45056
    s_add_u32 s44, s99, 198656
    buffer_load_dwordx4 v14, s[8:11], s44 offen offset:0 lds
    buffer_load_dwordx4 v15, s[8:11], s44 offen offset:1024 lds
    s_add_u32 m0, s41, 49152
    s_add_u32 s44, s96, 4096
    buffer_load_dwordx4 v14, s[8:11], s44 offen offset:0 lds
    buffer_load_dwordx4 v15, s[8:11], s44 offen offset:1024 lds
    s_add_u32 m0, s41, 53248
    s_add_u32 s44, s96, 200704
    buffer_load_dwordx4 v14, s[8:11], s44 offen offset:0 lds
    buffer_load_dwordx4 v15, s[8:11], s44 offen offset:1024 lds
    s_add_u32 m0, s41, 57344
    s_add_u32 s44, s97, 4096
    buffer_load_dwordx4 v14, s[8:11], s44 offen offset:0 lds
    buffer_load_dwordx4 v15, s[8:11], s44 offen offset:1024 lds
    s_add_u32 m0, s41, 61440
    s_add_u32 s44, s97, 200704
    buffer_load_dwordx4 v14, s[8:11], s44 offen offset:0 lds
    buffer_load_dwordx4 v15, s[8:11], s44 offen offset:1024 lds
    s_waitcnt vmcnt(16)
    s_barrier
    s_add_u32 m0, s41, 65536
    s_add_u32 s44, s98, 4096
    buffer_load_dwordx4 v14, s[8:11], s44 offen offset:0 lds
    buffer_load_dwordx4 v15, s[8:11], s44 offen offset:1024 lds
    s_add_u32 m0, s41, 69632
    s_add_u32 s44, s98, 200704
    buffer_load_dwordx4 v14, s[8:11], s44 offen offset:0 lds
    buffer_load_dwordx4 v15, s[8:11], s44 offen offset:1024 lds
    s_add_u32 m0, s41, 73728
    s_add_u32 s44, s99, 4096
    buffer_load_dwordx4 v14, s[8:11], s44 offen offset:0 lds
    buffer_load_dwordx4 v15, s[8:11], s44 offen offset:1024 lds
    s_add_u32 m0, s41, 77824
    s_add_u32 s44, s99, 200704
    buffer_load_dwordx4 v14, s[8:11], s44 offen offset:0 lds
    buffer_load_dwordx4 v15, s[8:11], s44 offen offset:1024 lds
    s_add_u32 m0, s41, 81920
    s_add_u32 s44, s94, 0
    buffer_load_dwordx4 v14, s[8:11], s44 offen offset:0 lds
    buffer_load_dwordx4 v15, s[8:11], s44 offen offset:1024 lds
    s_add_u32 m0, s41, 86016
    s_add_u32 s44, s94, 196608
    buffer_load_dwordx4 v14, s[8:11], s44 offen offset:0 lds
    buffer_load_dwordx4 v15, s[8:11], s44 offen offset:1024 lds
    s_add_u32 m0, s41, 90112
    s_add_u32 s44, s95, 0
    buffer_load_dwordx4 v14, s[8:11], s44 offen offset:0 lds
    buffer_load_dwordx4 v15, s[8:11], s44 offen offset:1024 lds
    s_add_u32 m0, s41, 94208
    s_add_u32 s44, s95, 196608
    buffer_load_dwordx4 v14, s[8:11], s44 offen offset:0 lds
    buffer_load_dwordx4 v15, s[8:11], s44 offen offset:1024 lds
    s_waitcnt vmcnt(16)
    s_barrier
    s_add_u32 m0, s41, 98304
    s_add_u32 s44, s96, 0
    buffer_load_dwordx4 v14, s[8:11], s44 offen offset:0 lds
    buffer_load_dwordx4 v15, s[8:11], s44 offen offset:1024 lds
    s_add_u32 m0, s41, 102400
    s_add_u32 s44, s96, 196608
    buffer_load_dwordx4 v14, s[8:11], s44 offen offset:0 lds
    buffer_load_dwordx4 v15, s[8:11], s44 offen offset:1024 lds
    s_add_u32 m0, s41, 106496
    s_add_u32 s44, s97, 0
    buffer_load_dwordx4 v14, s[8:11], s44 offen offset:0 lds
    buffer_load_dwordx4 v15, s[8:11], s44 offen offset:1024 lds
    s_add_u32 m0, s41, 110592
    s_add_u32 s44, s97, 196608
    buffer_load_dwordx4 v14, s[8:11], s44 offen offset:0 lds
    buffer_load_dwordx4 v15, s[8:11], s44 offen offset:1024 lds
    s_add_u32 m0, s41, 114688
    s_add_u32 s44, s98, 0
    buffer_load_dwordx4 v14, s[8:11], s44 offen offset:0 lds
    buffer_load_dwordx4 v15, s[8:11], s44 offen offset:1024 lds
    s_add_u32 m0, s41, 118784
    s_add_u32 s44, s98, 196608
    buffer_load_dwordx4 v14, s[8:11], s44 offen offset:0 lds
    buffer_load_dwordx4 v15, s[8:11], s44 offen offset:1024 lds
    s_add_u32 m0, s41, 122880
    s_add_u32 s44, s99, 0
    buffer_load_dwordx4 v14, s[8:11], s44 offen offset:0 lds
    buffer_load_dwordx4 v15, s[8:11], s44 offen offset:1024 lds
    s_add_u32 m0, s41, 126976
    s_add_u32 s44, s99, 196608
    buffer_load_dwordx4 v14, s[8:11], s44 offen offset:0 lds
    buffer_load_dwordx4 v15, s[8:11], s44 offen offset:1024 lds
    s_waitcnt vmcnt(16)
    s_barrier
    v_lshrrev_b32 v28, 4, v1
    v_and_b32 v29, 7, v28
    v_lshrrev_b32 v28, 3, v28
    v_mul_u32_u24 v28, 2048, v28
    v_lshl_add_u32 v28, v29, 4, v28
    s_and_b32 s3, s18, 12
    s_or_b32 s3, s3, 3
    s_lshl_b32 s3, s3, 7
    v_add_u32 v28, s3, v28
    s_lshr_b32 s3, s2, 3
    s_lshl_b32 s3, s3, 2
    s_and_b32 s60, s16, 3
    s_add_u32 s60, s60, s3
    s_lshl_b32 s61, s60, 14
    buffer_load_dwordx4 v[144:147], v28, s[12:15], s61 offen
    s_bitcmp0_b32 s21, 0
    s_cselect_b32 s56, s28, s24
    s_cselect_b32 s57, s29, s25
    s_mov_b32 s58, 6291456
    s_mov_b32 s59, 0x00020000
    v_lshrrev_b32 v28, 4, v1
    v_and_b32 v29, 7, v28
    v_lshrrev_b32 v28, 3, v28
    v_mul_u32_u24 v28, 6144, v28
    v_lshl_add_u32 v28, v29, 4, v28
    s_and_b32 s3, s18, 12
    s_or_b32 s3, s3, 3
    s_lshl_b32 s3, s3, 7
    v_add_u32 v28, s3, v28
    s_lshr_b32 s3, s2, 3
    s_lshl_b32 s3, s3, 2
    s_and_b32 s60, s16, 3
    s_add_u32 s60, s60, s3
    s_and_b32 s3, s60, 31
    s_mul_i32 s3, s3, 49152
    s_lshr_b32 s61, s60, 5
    s_min_u32 s61, s61, 2
    s_lshl_b32 s61, s61, 11
    s_add_u32 s61, s61, s3
    s_and_b32 s3, s18, 0
    s_mul_i32 s3, s3, 393216
    s_add_u32 s61, s61, s3
    buffer_load_dwordx4 v[148:151], v28, s[56:59], s61 offen
    s_waitcnt vmcnt(2)
    s_cmp_lg_u32 s21, 2
    s_cbranch_scc1 l_pe
    s_bitcmp0_b32 s21, 0
    s_cselect_b32 s56, s28, s24
    s_cselect_b32 s57, s29, s25
    s_mov_b32 s58, 6291456
    s_mov_b32 s59, 0x00020000
    s_add_u32 s61, s84, 2048
    buffer_load_dwordx4 v[160:163], v11, s[56:59], s61 offen
    s_add_u32 s61, s84, 4096
    buffer_load_dwordx4 v[164:167], v11, s[56:59], s61 offen
    s_add_u32 s61, s84, 0
    buffer_load_dwordx4 v[168:171], v11, s[56:59], s61 offen
    s_add_u32 s61, s84, 198656
    buffer_load_dwordx4 v[172:175], v11, s[56:59], s61 offen
    s_add_u32 s61, s84, 200704
    buffer_load_dwordx4 v[176:179], v11, s[56:59], s61 offen
    s_add_u32 s61, s84, 196608
    buffer_load_dwordx4 v[180:183], v11, s[56:59], s61 offen
    s_add_u32 s61, s85, 2048
    buffer_load_dwordx4 v[184:187], v11, s[56:59], s61 offen
    s_add_u32 s61, s85, 4096
    buffer_load_dwordx4 v[188:191], v11, s[56:59], s61 offen
    s_add_u32 s61, s85, 0
    buffer_load_dwordx4 v[192:195], v11, s[56:59], s61 offen
    s_add_u32 s61, s85, 198656
    buffer_load_dwordx4 v[196:199], v11, s[56:59], s61 offen
l_pe:
    s_barrier
    s_bitcmp1_b32 s21, 0
    s_cbranch_scc1 s_B
    s_add_u32 m0, s41, 0
    s_xor_b32 s44, s62, 0
    buffer_load_dwordx4 v16, s[12:15], s44 offen offset:0 lds
    buffer_load_dwordx4 v17, s[12:15], s44 offen offset:1024 lds
    s_add_u32 m0, s41, 4096
    s_xor_b32 s44, s62, 131072
    buffer_load_dwordx4 v16, s[12:15], s44 offen offset:0 lds
    buffer_load_dwordx4 v17, s[12:15], s44 offen offset:1024 lds
    s_add_u32 m0, s41, 8192
    s_xor_b32 s44, s62, 262144
    buffer_load_dwordx4 v16, s[12:15], s44 offen offset:0 lds
    buffer_load_dwordx4 v17, s[12:15], s44 offen offset:1024 lds
    s_add_u32 m0, s41, 12288
    s_xor_b32 s44, s62, 393216
    buffer_load_dwordx4 v16, s[12:15], s44 offen offset:0 lds
    buffer_load_dwordx4 v17, s[12:15], s44 offen offset:1024 lds
    s_add_u32 m0, s41, 16384
    s_xor_b32 s44, s62, 524288
    buffer_load_dwordx4 v16, s[12:15], s44 offen offset:0 lds
    buffer_load_dwordx4 v17, s[12:15], s44 offen offset:1024 lds
    s_add_u32 m0, s41, 20480
    s_xor_b32 s44, s62, 655360
    buffer_load_dwordx4 v16, s[12:15], s44 offen offset:0 lds
    buffer_load_dwordx4 v17, s[12:15], s44 offen offset:1024 lds
    s_add_u32 m0, s41, 24576
    s_xor_b32 s44, s62, 786432
    buffer_load_dwordx4 v16, s[12:15], s44 offen offset:0 lds
    buffer_load_dwordx4 v17, s[12:15], s44 offen offset:1024 lds
    s_add_u32 m0, s41, 28672
    s_xor_b32 s44, s62, 917504
    buffer_load_dwordx4 v16, s[12:15], s44 offen offset:0 lds
    buffer_load_dwordx4 v17, s[12:15], s44 offen offset:1024 lds
    s_add_u32 m0, s41, 32768
    s_xor_b32 s44, s62, 1048576
    buffer_load_dwordx4 v16, s[12:15], s44 offen offset:0 lds
    buffer_load_dwordx4 v17, s[12:15], s44 offen offset:1024 lds
    s_add_u32 m0, s41, 36864
    s_xor_b32 s44, s62, 1179648
    buffer_load_dwordx4 v16, s[12:15], s44 offen offset:0 lds
    buffer_load_dwordx4 v17, s[12:15], s44 offen offset:1024 lds
    s_add_u32 m0, s41, 40960
    s_xor_b32 s44, s62, 1310720
    buffer_load_dwordx4 v16, s[12:15], s44 offen offset:0 lds
    buffer_load_dwordx4 v17, s[12:15], s44 offen offset:1024 lds
    s_add_u32 m0, s41, 45056
    s_xor_b32 s44, s62, 1441792
    buffer_load_dwordx4 v16, s[12:15], s44 offen offset:0 lds
    buffer_load_dwordx4 v17, s[12:15], s44 offen offset:1024 lds
    s_add_u32 m0, s41, 49152
    s_xor_b32 s44, s62, 1572864
    buffer_load_dwordx4 v16, s[12:15], s44 offen offset:0 lds
    buffer_load_dwordx4 v17, s[12:15], s44 offen offset:1024 lds
    s_add_u32 m0, s41, 53248
    s_xor_b32 s44, s62, 1703936
    buffer_load_dwordx4 v16, s[12:15], s44 offen offset:0 lds
    buffer_load_dwordx4 v17, s[12:15], s44 offen offset:1024 lds
    s_add_u32 m0, s41, 57344
    s_xor_b32 s44, s62, 1835008
    buffer_load_dwordx4 v16, s[12:15], s44 offen offset:0 lds
    buffer_load_dwordx4 v17, s[12:15], s44 offen offset:1024 lds
    s_add_u32 m0, s41, 61440
    s_xor_b32 s44, s62, 1966080
    buffer_load_dwordx4 v16, s[12:15], s44 offen offset:0 lds
    buffer_load_dwordx4 v17, s[12:15], s44 offen offset:1024 lds
    s_branch s_tail
h_start:
    v_mov_b32 v20, 0
    v_mov_b32 v21, 0
    v_mov_b32 v22, 0
    v_mov_b32 v23, 0
    s_cmp_lt_u32 s2, 10
    s_cbranch_scc0 h_z0
    s_load_dword s101, s[34:35], 192
    s_lshl_b32 s44, s2, 11
    s_mov_b32 s45, 0
    s_mov_b32 s46, 0
    s_mov_b32 s47, 0
    s_mov_b32 s48, 0
    s_mov_b32 s49, 0
    s_mov_b32 s50, 0
    s_mov_b32 s51, 0
    s_mov_b32 s52, 0
    s_mov_b32 s53, 0
    s_mov_b32 s54, 0
    s_mov_b32 s55, 0
    s_mov_b32 s56, 0
    s_mov_b32 s57, 0
    s_mov_b32 s58, 0
    s_mov_b32 s59, 0
    s_mov_b32 s60, 0
    s_atomic_swap s45, s[22:23], s44 offset:0 glc
    s_atomic_swap s46, s[22:23], s44 offset:128 glc
    s_atomic_swap s47, s[22:23], s44 offset:256 glc
    s_atomic_swap s48, s[22:23], s44 offset:384 glc
    s_atomic_swap s49, s[22:23], s44 offset:512 glc
    s_atomic_swap s50, s[22:23], s44 offset:640 glc
    s_atomic_swap s51, s[22:23], s44 offset:768 glc
    s_atomic_swap s52, s[22:23], s44 offset:896 glc
    s_atomic_swap s53, s[22:23], s44 offset:1024 glc
    s_atomic_swap s54, s[22:23], s44 offset:1152 glc
    s_atomic_swap s55, s[22:23], s44 offset:1280 glc
    s_atomic_swap s56, s[22:23], s44 offset:1408 glc
    s_atomic_swap s57, s[22:23], s44 offset:1536 glc
    s_atomic_swap s58, s[22:23], s44 offset:1664 glc
    s_atomic_swap s59, s[22:23], s44 offset:1792 glc
    s_atomic_swap s60, s[22:23], s44 offset:1920 glc
    s_waitcnt lgkmcnt(0)
    s_atomic_add s40, s[34:35], 0
h_z0:
    v_lshrrev_b32 v24, 4, v1
    v_lshrrev_b32 v25, 3, v24
    v_mul_u32_u24 v12, 6144, v25
    v_and_b32 v26, 2, v25
    v_lshrrev_b32 v25, 2, v25
    v_or_b32 v26, v26, v25
    v_bfe_u32 v25, v24, 1, 2
    v_xor_b32 v26, v26, v25
    v_lshl_add_u32 v12, v26, 5, v12
    v_and_b32 v26, 1, v24
    v_lshl_add_u32 v12, v26, 4, v12
    s_lshl_b32 s3, s18, 7
    v_add_u32 v12, s3, v12
    v_add_u32 v13, 48128, v12
    s_mul_i32 s84, s18, 393216
    s_cmp_eq_u32 s18, 1
    s_cselect_b32 s85, 0, 393216
    s_cmp_eq_u32 s18, 2
    s_cselect_b32 s86, 0, 786432
    s_cmp_eq_u32 s18, 3
    s_cselect_b32 s87, 0, 1179648
    s_cmp_eq_u32 s18, 4
    s_cselect_b32 s88, 0, 1572864
    s_cmp_eq_u32 s18, 5
    s_cselect_b32 s89, 0, 1966080
    s_cmp_eq_u32 s18, 6
    s_cselect_b32 s90, 0, 2359296
    s_cmp_eq_u32 s18, 7
    s_cselect_b32 s91, 0, 2752512
    s_cmp_eq_u32 s18, 8
    s_cselect_b32 s92, 0, 3145728
    s_cmp_eq_u32 s18, 9
    s_cselect_b32 s93, 0, 3538944
    s_cmp_eq_u32 s18, 10
    s_cselect_b32 s94, 0, 3932160
    s_cmp_eq_u32 s18, 11
    s_cselect_b32 s95, 0, 4325376
    s_cmp_eq_u32 s18, 12
    s_cselect_b32 s96, 0, 4718592
    s_cmp_eq_u32 s18, 13
    s_cselect_b32 s97, 0, 5111808
    s_cmp_eq_u32 s18, 14
    s_cselect_b32 s98, 0, 5505024
    s_cmp_eq_u32 s18, 15
    s_cselect_b32 s99, 0, 5898240
    v_lshrrev_b32 v24, 4, v1
    v_lshrrev_b32 v25, 3, v24
    v_mul_u32_u24 v16, 2048, v25
    v_and_b32 v26, 2, v25
    v_lshrrev_b32 v25, 2, v25
    v_or_b32 v26, v26, v25
    v_bfe_u32 v25, v24, 1, 2
    v_xor_b32 v26, v26, v25
    v_lshl_add_u32 v16, v26, 5, v16
    v_and_b32 v26, 1, v24
    v_lshl_add_u32 v16, v26, 4, v16
    s_lshl_b32 s3, s18, 7
    v_add_u32 v16, s3, v16
    v_add_u32 v17, 15360, v16
    v_add_u32 v18, 30720, v16
    v_add_u32 v19, 46080, v16
    s_and_b32 s3, s16, 3
    s_mul_i32 s3, s3, 49152
    v_add_u32 v11, s3, v12
    s_and_b32 s3, s16, 3
    s_lshl_b32 s3, s3, 10
    v_add_u32 v9, s3, v1
    v_add_u32 v10, 0x10000, v9
    v_lshrrev_b32 v24, 4, v1
    v_and_b32 v25, 15, v24
    v_lshrrev_b32 v24, 4, v24
    v_lshlrev_b32 v24, 2, v24
    v_sub_u32 v24, v25, v24
    v_mov_b32 v25, 0xf149f2ca
    v_add_u32 v26, 0x0, v24
    v_and_b32 v26, 0xfffffff1, v26
    v_cmp_eq_u32 vcc, 0, v26
    s_nop 1
    v_cndmask_b32 v32, v25, 0, vcc
    v_add_u32 v26, 0xffffffff, v24
    v_and_b32 v26, 0xfffffff1, v26
    v_cmp_eq_u32 vcc, 0, v26
    s_nop 1
    v_cndmask_b32 v33, v25, 0, vcc
    v_add_u32 v26, 0xfffffffe, v24
    v_and_b32 v26, 0xfffffff1, v26
    v_cmp_eq_u32 vcc, 0, v26
    s_nop 1
    v_cndmask_b32 v34, v25, 0, vcc
    v_add_u32 v26, 0xfffffffd, v24
    v_and_b32 v26, 0xfffffff1, v26
    v_cmp_eq_u32 vcc, 0, v26
    s_nop 1
    v_cndmask_b32 v35, v25, 0, vcc
    v_add_u32 v26, 0x10, v24
    v_and_b32 v26, 0xfffffff1, v26
    v_cmp_eq_u32 vcc, 0, v26
    s_nop 1
    v_cndmask_b32 v36, v25, 0, vcc
    v_add_u32 v26, 0xf, v24
    v_and_b32 v26, 0xfffffff1, v26
    v_cmp_eq_u32 vcc, 0, v26
    s_nop 1
    v_cndmask_b32 v37, v25, 0, vcc
    v_add_u32 v26, 0xe, v24
    v_and_b32 v26, 0xfffffff1, v26
    v_cmp_eq_u32 vcc, 0, v26
    s_nop 1
    v_cndmask_b32 v38, v25, 0, vcc
    v_add_u32 v26, 0xd, v24
    v_and_b32 v26, 0xfffffff1, v26
    v_cmp_eq_u32 vcc, 0, v26
    s_nop 1
    v_cndmask_b32 v39, v25, 0, vcc
    v_add_u32 v24, 153600, v1
    ds_write_b128 v24, v[32:35] offset:0
    ds_write_b128 v24, v[36:39] offset:1024
    s_barrier
    s_waitcnt lgkmcnt(0)
    s_lshl_b32 s44, s21, 14
    s_lshl_b32 s67, s17, 9
    s_add_u32 s44, s44, s67
    s_add_u32 s44, s44, 4096
    s_barrier
    s_mov_b32 s66, 0x10000
h_s0_poll:
    s_mov_b32 s68, 0
    s_mov_b32 s69, 0
    s_mov_b32 s70, 0
    s_mov_b32 s71, 0
    s_atomic_add s68, s[22:23], s44 offset:0 glc
    s_atomic_add s69, s[22:23], s44 offset:128 glc
    s_atomic_add s70, s[22:23], s44 offset:256 glc
    s_atomic_add s71, s[22:23], s44 offset:384 glc
    s_sub_u32 s66, s66, 1
    s_cselect_b32 s67, 16, 0
    s_waitcnt lgkmcnt(0)
    s_and_b32 s68, s68, s69
    s_and_b32 s68, s68, s70
    s_and_b32 s68, s68, s71
    s_max_u32 s68, s68, s67
    s_cmp_lt_u32 s68, 16
    s_cbranch_scc1 h_s0_poll
h_s0_ok:
    s_barrier
    s_lshr_b32 s3, s2, 3
    s_cmp_eq_u32 s3, 2
    s_cbranch_scc0 h_g4
    s_mul_i32 s44, s2, 24576
    s_add_u32 s44, s44, 58347520
    s_mov_b32 s45, 24
h_zloop:
    buffer_store_dwordx4 v[20:23], v1, s[4:7], s44 offen sc1
    s_add_u32 s44, s44, 1024
    s_sub_u32 s45, s45, 1
    s_cmp_lg_u32 s45, 0
    s_cbranch_scc1 h_zloop
    s_branch h_g4
h_layer:
    s_waitcnt lgkmcnt(0)
    s_barrier
h_g4:
    s_barrier
    s_lshl_b32 s44, s21, 14
    s_lshl_b32 s67, s17, 9
    s_add_u32 s44, s44, s67
    s_add_u32 s44, s44, 12288
    s_mov_b32 s66, 0x10000
h_s_poll:
    s_mov_b32 s68, 0
    s_mov_b32 s69, 0
    s_mov_b32 s70, 0
    s_mov_b32 s71, 0
    s_atomic_add s68, s[22:23], s44 offset:0 glc
    s_atomic_add s69, s[22:23], s44 offset:128 glc
    s_atomic_add s70, s[22:23], s44 offset:256 glc
    s_atomic_add s71, s[22:23], s44 offset:384 glc
    s_sub_u32 s66, s66, 1
    s_cselect_b32 s67, 16, 0
    s_waitcnt lgkmcnt(0)
    s_and_b32 s68, s68, s69
    s_and_b32 s68, s68, s70
    s_and_b32 s68, s68, s71
    s_max_u32 s68, s68, s67
    s_cmp_lt_u32 s68, 16
    s_cbranch_scc1 h_s_poll
h_s_ok:
    s_barrier
    s_lshl_b32 s44, s21, 18
    s_lshl_b32 s45, s17, 14
    s_add_u32 s44, s44, s45
    s_add_u32 s44, s44, 50331648
    buffer_load_dwordx4 v[32:35], v1, s[4:7], s44 offen offset:0 sc1
    buffer_load_dwordx4 v[36:39], v1, s[4:7], s44 offen offset:1024 sc1
    buffer_load_dwordx4 v[40:43], v1, s[4:7], s44 offen offset:2048 sc1
    buffer_load_dwordx4 v[44:47], v1, s[4:7], s44 offen offset:3072 sc1
    s_add_u32 s44, s44, 4096
    buffer_load_dwordx4 v[48:51], v1, s[4:7], s44 offen offset:0 sc1
    buffer_load_dwordx4 v[52:55], v1, s[4:7], s44 offen offset:1024 sc1
    buffer_load_dwordx4 v[56:59], v1, s[4:7], s44 offen offset:2048 sc1
    buffer_load_dwordx4 v[60:63], v1, s[4:7], s44 offen offset:3072 sc1
    s_add_u32 s44, s44, 4096
    buffer_load_dwordx4 v[64:67], v1, s[4:7], s44 offen offset:0 sc1
    buffer_load_dwordx4 v[68:71], v1, s[4:7], s44 offen offset:1024 sc1
    buffer_load_dwordx4 v[72:75], v1, s[4:7], s44 offen offset:2048 sc1
    buffer_load_dwordx4 v[76:79], v1, s[4:7], s44 offen offset:3072 sc1
    s_add_u32 s44, s44, 4096
    buffer_load_dwordx4 v[80:83], v1, s[4:7], s44 offen offset:0 sc1
    buffer_load_dwordx4 v[84:87], v1, s[4:7], s44 offen offset:1024 sc1
    buffer_load_dwordx4 v[88:91], v1, s[4:7], s44 offen offset:2048 sc1
    buffer_load_dwordx4 v[92:95], v1, s[4:7], s44 offen offset:3072 sc1
    s_barrier
    s_cmp_ge_u32 s21, 2
    s_cbranch_scc1 h_c_ok
    s_lshl_b32 s44, s21, 11
    s_lshl_b32 s67, s18, 7
    s_add_u32 s44, s44, s67
    s_add_u32 s44, s44, 0
    s_mov_b32 s66, 0x10000
h_c_poll:
    s_mov_b32 s68, 0
    s_atomic_add s68, s[22:23], s44 offset:0 glc
    s_sub_u32 s66, s66, 1
    s_cselect_b32 s67, 48, 0
    s_waitcnt lgkmcnt(0)
    s_max_u32 s68, s68, s67
    s_cmp_lt_u32 s68, 48
    s_cbranch_scc1 h_c_poll
h_c_ok:
    s_waitcnt vmcnt(0)
    s_lshl_b32 s3, s21, 8
    s_add_u32 s3, s3, s2
    s_lshr_b32 s3, s3, 3
    s_cmp_eq_u32 s3, 2
    s_cbranch_scc0 h_nf1
    s_atomic_add s40, s[34:35], 128
h_nf1:
    s_barrier
    s_cmp_ge_u32 s21, 2
    s_cbranch_scc1 h_cs1
    s_lshl_b32 s44, s21, 18
    s_lshl_b32 s45, s18, 14
    s_add_u32 s44, s44, s45
    s_add_u32 s44, s44, 52428800
    buffer_load_dwordx4 v[96:99], v1, s[4:7], s44 offen offset:0 sc1
    buffer_load_dwordx4 v[100:103], v1, s[4:7], s44 offen offset:1024 sc1
    buffer_load_dwordx4 v[104:107], v1, s[4:7], s44 offen offset:2048 sc1
    buffer_load_dwordx4 v[108:111], v1, s[4:7], s44 offen offset:3072 sc1
    s_add_u32 s44, s44, 4096
    buffer_load_dwordx4 v[112:115], v1, s[4:7], s44 offen offset:0 sc1
    buffer_load_dwordx4 v[116:119], v1, s[4:7], s44 offen offset:1024 sc1
    buffer_load_dwordx4 v[120:123], v1, s[4:7], s44 offen offset:2048 sc1
    buffer_load_dwordx4 v[124:127], v1, s[4:7], s44 offen offset:3072 sc1
    s_add_u32 s44, s44, 4096
    buffer_load_dwordx4 v[128:131], v1, s[4:7], s44 offen offset:0 sc1
    buffer_load_dwordx4 v[132:135], v1, s[4:7], s44 offen offset:1024 sc1
    buffer_load_dwordx4 v[136:139], v1, s[4:7], s44 offen offset:2048 sc1
    buffer_load_dwordx4 v[140:143], v1, s[4:7], s44 offen offset:3072 sc1
    s_add_u32 s44, s44, 4096
    buffer_load_dwordx4 v[144:147], v1, s[4:7], s44 offen offset:0 sc1
    buffer_load_dwordx4 v[148:151], v1, s[4:7], s44 offen offset:1024 sc1
    buffer_load_dwordx4 v[152:155], v1, s[4:7], s44 offen offset:2048 sc1
    buffer_load_dwordx4 v[156:159], v1, s[4:7], s44 offen offset:3072 sc1
h_cs1:
    v_add_f32 v32, v32, v36
    v_add_f32 v33, v33, v37
    v_add_f32 v34, v34, v38
    v_add_f32 v35, v35, v39
    v_add_f32 v48, v48, v52
    v_add_f32 v49, v49, v53
    v_add_f32 v50, v50, v54
    v_add_f32 v51, v51, v55
    v_add_f32 v64, v64, v68
    v_add_f32 v65, v65, v69
    v_add_f32 v66, v66, v70
    v_add_f32 v67, v67, v71
    v_add_f32 v80, v80, v84
    v_add_f32 v81, v81, v85
    v_add_f32 v82, v82, v86
    v_add_f32 v83, v83, v87
    v_add_f32 v32, v32, v40
    v_add_f32 v33, v33, v41
    v_add_f32 v34, v34, v42
    v_add_f32 v35, v35, v43
    v_add_f32 v48, v48, v56
    v_add_f32 v49, v49, v57
    v_add_f32 v50, v50, v58
    v_add_f32 v51, v51, v59
    v_add_f32 v64, v64, v72
    v_add_f32 v65, v65, v73
    v_add_f32 v66, v66, v74
    v_add_f32 v67, v67, v75
    v_add_f32 v80, v80, v88
    v_add_f32 v81, v81, v89
    v_add_f32 v82, v82, v90
    v_add_f32 v83, v83, v91
    s_barrier
    v_add_f32 v32, v32, v44
    v_add_f32 v33, v33, v45
    v_add_f32 v34, v34, v46
    v_add_f32 v35, v35, v47
    v_add_f32 v48, v48, v60
    v_add_f32 v49, v49, v61
    v_add_f32 v50, v50, v62
    v_add_f32 v51, v51, v63
    v_add_f32 v64, v64, v76
    v_add_f32 v65, v65, v77
    v_add_f32 v66, v66, v78
    v_add_f32 v67, v67, v79
    v_add_f32 v80, v80, v92
    v_add_f32 v81, v81, v93
    v_add_f32 v82, v82, v94
    v_add_f32 v83, v83, v95
    v_permlane32_swap_b32 v32, v64
    v_permlane32_swap_b32 v33, v65
    v_permlane32_swap_b32 v34, v66
    v_permlane32_swap_b32 v35, v67
    v_add_f32 v32, v32, v64
    v_add_f32 v33, v33, v65
    v_add_f32 v34, v34, v66
    v_add_f32 v35, v35, v67
    v_permlane32_swap_b32 v48, v80
    v_permlane32_swap_b32 v49, v81
    v_permlane32_swap_b32 v50, v82
    v_permlane32_swap_b32 v51, v83
    v_add_f32 v48, v48, v80
    v_add_f32 v49, v49, v81
    v_add_f32 v50, v50, v82
    v_add_f32 v51, v51, v83
    v_permlane16_swap_b32 v32, v48
    v_permlane16_swap_b32 v33, v49
    v_permlane16_swap_b32 v34, v50
    v_permlane16_swap_b32 v35, v51
    v_add_f32 v32, v32, v48
    v_add_f32 v33, v33, v49
    v_add_f32 v34, v34, v50
    v_add_f32 v35, v35, v51
    s_barrier
    v_mul_f32 v32, 0x3a800000, v32
    v_mul_f32 v33, 0x3a800000, v33
    v_mul_f32 v34, 0x3a800000, v34
    v_mul_f32 v35, 0x3a800000, v35
    v_fma_f32 v33, -v32, v32, v33
    v_fma_f32 v35, -v34, v34, v35
    v_max_f32 v33, 0, v33
    v_max_f32 v35, 0, v35
    v_add_f32 v33, 0x3727c5ac, v33
    v_add_f32 v35, 0x3727c5ac, v35
    v_rsq_f32 v33, v33
    v_rsq_f32 v35, v35
    v_lshrrev_b32 v26, 1, v1
    v_add_u32 v26, 155648, v26
    ds_write2_b32 v26, v32, v34 offset0:0 offset1:1
    ds_write2_b32 v26, v33, v35 offset0:128 offset1:129
    s_barrier
    s_cmp_ge_u32 s21, 2
    s_cbranch_scc1 h_cs_done
    s_waitcnt vmcnt(0)
    v_add_f32 v96, v96, v100
    v_add_f32 v97, v97, v101
    v_add_f32 v98, v98, v102
    v_add_f32 v99, v99, v103
    v_add_f32 v96, v96, v104
    v_add_f32 v97, v97, v105
    v_add_f32 v98, v98, v106
    v_add_f32 v99, v99, v107
    v_add_f32 v96, v96, v108
    v_add_f32 v97, v97, v109
    v_add_f32 v98, v98, v110
    v_add_f32 v99, v99, v111
    v_add_f32 v96, v96, v112
    v_add_f32 v97, v97, v113
    v_add_f32 v98, v98, v114
    v_add_f32 v99, v99, v115
    v_add_f32 v96, v96, v116
    v_add_f32 v97, v97, v117
    v_add_f32 v98, v98, v118
    v_add_f32 v99, v99, v119
    v_add_f32 v96, v96, v120
    v_add_f32 v97, v97, v121
    v_add_f32 v98, v98, v122
    v_add_f32 v99, v99, v123
    v_add_f32 v96, v96, v124
    v_add_f32 v97, v97, v125
    v_add_f32 v98, v98, v126
    v_add_f32 v99, v99, v127
    v_add_f32 v96, v96, v128
    v_add_f32 v97, v97, v129
    v_add_f32 v98, v98, v130
    v_add_f32 v99, v99, v131
    v_add_f32 v96, v96, v132
    v_add_f32 v97, v97, v133
    v_add_f32 v98, v98, v134
    v_add_f32 v99, v99, v135
    v_add_f32 v96, v96, v136
    v_add_f32 v97, v97, v137
    v_add_f32 v98, v98, v138
    v_add_f32 v99, v99, v139
    v_add_f32 v96, v96, v140
    v_add_f32 v97, v97, v141
    v_add_f32 v98, v98, v142
    v_add_f32 v99, v99, v143
    v_add_f32 v96, v96, v144
    v_add_f32 v97, v97, v145
    v_add_f32 v98, v98, v146
    v_add_f32 v99, v99, v147
    v_add_f32 v96, v96, v148
    v_add_f32 v97, v97, v149
    v_add_f32 v98, v98, v150
    v_add_f32 v99, v99, v151
    v_add_f32 v96, v96, v152
    v_add_f32 v97, v97, v153
    v_add_f32 v98, v98, v154
    v_add_f32 v99, v99, v155
    v_add_f32 v96, v96, v156
    v_add_f32 v97, v97, v157
    v_add_f32 v98, v98, v158
    v_add_f32 v99, v99, v159
    s_lshl_b32 s44, s21, 10
    s_add_u32 s44, s44, 151552
    v_add_u32 v24, s44, v1
    ds_write_b128 v24, v[96:99]
h_cs_done:
    s_waitcnt lgkmcnt(0)
    s_barrier
    s_cmp_lg_u32 s21, 0
    s_cbranch_scc1 h_f1_ok
    s_load_dword s68, s[34:35], 128
    s_mov_b32 s8, s34
    s_mov_b32 s9, s35
    s_mov_b32 s10, 256
    s_mov_b32 s11, 0x00020000
    s_mov_b32 s66, 0x10000
    v_mov_b32 v24, 0
    s_waitcnt lgkmcnt(0)
h_f1:
    s_cmp_eq_u32 s68, 8
    s_cbranch_scc1 h_f1_ok
    buffer_load_dword v25, v24, s[8:11], 0 offen offset:128 sc1
    s_waitcnt vmcnt(0)
    v_readfirstlane_b32 s68, v25
    s_sub_u32 s66, s66, 1
    s_cmp_lg_u32 s66, 0
    s_cbranch_scc1 h_f1
h_f1_ok:
    s_barrier
    s_bitcmp1_b32 s21, 0
    s_cselect_b32 s8, s28, s24
    s_cselect_b32 s9, s29, s25
    s_cselect_b32 s12, s30, s26
    s_cselect_b32 s13, s31, s27
    s_mov_b32 s10, 6291456
    s_mov_b32 s11, 0x00020000
    s_mov_b32 s14, 2097152
    s_mov_b32 s15, 0x00020000
    v_lshrrev_b32 v28, 4, v1
    v_and_b32 v29, 7, v28
    v_lshrrev_b32 v28, 3, v28
    v_mul_u32_u24 v28, 2048, v28
    v_lshl_add_u32 v28, v29, 4, v28
    s_and_b32 s3, s18, 12
    s_or_b32 s3, s3, 3
    s_lshl_b32 s3, s3, 7
    v_add_u32 v28, s3, v28
    s_lshr_b32 s3, s2, 3
    s_lshl_b32 s3, s3, 2
    s_and_b32 s60, s16, 3
    s_add_u32 s60, s60, s3
    s_lshl_b32 s61, s60, 14
    buffer_load_dwordx4 v[144:147], v28, s[12:15], s61 offen
    s_bitcmp0_b32 s21, 0
    s_cselect_b32 s56, s28, s24
    s_cselect_b32 s57, s29, s25
    s_mov_b32 s58, 6291456
    s_mov_b32 s59, 0x00020000
    v_lshrrev_b32 v28, 4, v1
    v_and_b32 v29, 7, v28
    v_lshrrev_b32 v28, 3, v28
    v_mul_u32_u24 v28, 6144, v28
    v_lshl_add_u32 v28, v29, 4, v28
    s_and_b32 s3, s18, 12
    s_or_b32 s3, s3, 3
    s_lshl_b32 s3, s3, 7
    v_add_u32 v28, s3, v28
    s_lshr_b32 s3, s2, 3
    s_lshl_b32 s3, s3, 2
    s_and_b32 s60, s16, 3
    s_add_u32 s60, s60, s3
    s_and_b32 s3, s60, 31
    s_mul_i32 s3, s3, 49152
    s_lshr_b32 s61, s60, 5
    s_min_u32 s61, s61, 2
    s_lshl_b32 s61, s61, 11
    s_add_u32 s61, s61, s3
    s_and_b32 s3, s18, 0
    s_mul_i32 s3, s3, 393216
    s_add_u32 s61, s61, s3
    buffer_load_dwordx4 v[148:151], v28, s[56:59], s61 offen
    s_cmp_lg_u32 s21, 2
    s_cbranch_scc1 h_pe
    s_bitcmp0_b32 s21, 0
    s_cselect_b32 s56, s28, s24
    s_cselect_b32 s57, s29, s25
    s_mov_b32 s58, 6291456
    s_mov_b32 s59, 0x00020000
    s_add_u32 s61, s84, 2048
    buffer_load_dwordx4 v[160:163], v11, s[56:59], s61 offen
    s_add_u32 s61, s84, 4096
    buffer_load_dwordx4 v[164:167], v11, s[56:59], s61 offen
    s_add_u32 s61, s84, 0
    buffer_load_dwordx4 v[168:171], v11, s[56:59], s61 offen
    s_add_u32 s61, s84, 198656
    buffer_load_dwordx4 v[172:175], v11, s[56:59], s61 offen
    s_add_u32 s61, s84, 200704
    buffer_load_dwordx4 v[176:179], v11, s[56:59], s61 offen
    s_add_u32 s61, s84, 196608
    buffer_load_dwordx4 v[180:183], v11, s[56:59], s61 offen
    s_add_u32 s61, s85, 2048
    buffer_load_dwordx4 v[184:187], v11, s[56:59], s61 offen
    s_add_u32 s61, s85, 4096
    buffer_load_dwordx4 v[188:191], v11, s[56:59], s61 offen
    s_add_u32 s61, s85, 0
    buffer_load_dwordx4 v[192:195], v11, s[56:59], s61 offen
    s_add_u32 s61, s85, 198656
    buffer_load_dwordx4 v[196:199], v11, s[56:59], s61 offen
h_pe:
    s_barrier
    s_branch s_tail
z_start:
    v_lshrrev_b32 v24, 4, v1
    v_lshrrev_b32 v25, 3, v24
    v_mul_u32_u24 v20, 6144, v25
    v_and_b32 v25, 7, v24
    v_lshl_add_u32 v20, v25, 4, v20
    s_add_u32 s3, s18, 2
    s_and_b32 s3, s3, 15
    s_lshl_b32 s3, s3, 7
    s_add_u32 s3, s3, 4096
    v_add_u32 v22, s3, v20
    s_add_u32 s3, s18, 1
    s_and_b32 s3, s3, 15
    s_lshl_b32 s3, s3, 7
    s_add_u32 s3, s3, 2048
    v_add_u32 v21, s3, v20
    s_add_u32 s3, s18, 0
    s_and_b32 s3, s3, 15
    s_lshl_b32 s3, s3, 7
    s_add_u32 s3, s3, 0
    v_add_u32 v20, s3, v20
    v_lshrrev_b32 v24, 4, v1
    v_lshrrev_b32 v25, 3, v24
    v_mul_u32_u24 v12, 6144, v25
    v_and_b32 v26, 2, v25
    v_lshrrev_b32 v25, 2, v25
    v_or_b32 v26, v26, v25
    v_bfe_u32 v25, v24, 1, 2
    v_xor_b32 v26, v26, v25
    v_lshl_add_u32 v12, v26, 5, v12
    v_and_b32 v26, 1, v24
    v_lshl_add_u32 v12, v26, 4, v12
    s_lshl_b32 s3, s18, 7
    v_add_u32 v12, s3, v12
    v_add_u32 v13, 48128, v12
    s_mul_i32 s84, s18, 393216
    s_cmp_eq_u32 s18, 1
    s_cselect_b32 s85, 0, 393216
    s_cmp_eq_u32 s18, 2
    s_cselect_b32 s86, 0, 786432
    s_cmp_eq_u32 s18, 3
    s_cselect_b32 s87, 0, 1179648
    s_cmp_eq_u32 s18, 4
    s_cselect_b32 s88, 0, 1572864
    s_cmp_eq_u32 s18, 5
    s_cselect_b32 s89, 0, 1966080
    s_cmp_eq_u32 s18, 6
    s_cselect_b32 s90, 0, 2359296
    s_cmp_eq_u32 s18, 7
    s_cselect_b32 s91, 0, 2752512
    s_cmp_eq_u32 s18, 8
    s_cselect_b32 s92, 0, 3145728
    s_cmp_eq_u32 s18, 9
    s_cselect_b32 s93, 0, 3538944
    s_cmp_eq_u32 s18, 10
    s_cselect_b32 s94, 0, 3932160
    s_cmp_eq_u32 s18, 11
    s_cselect_b32 s95, 0, 4325376
    s_cmp_eq_u32 s18, 12
    s_cselect_b32 s96, 0, 4718592
    s_cmp_eq_u32 s18, 13
    s_cselect_b32 s97, 0, 5111808
    s_cmp_eq_u32 s18, 14
    s_cselect_b32 s98, 0, 5505024
    s_cmp_eq_u32 s18, 15
    s_cselect_b32 s99, 0, 5898240
    v_lshrrev_b32 v24, 4, v1
    v_lshrrev_b32 v25, 3, v24
    v_mul_u32_u24 v16, 2048, v25
    v_and_b32 v26, 2, v25
    v_lshrrev_b32 v25, 2, v25
    v_or_b32 v26, v26, v25
    v_bfe_u32 v25, v24, 1, 2
    v_xor_b32 v26, v26, v25
    v_lshl_add_u32 v16, v26, 5, v16
    v_and_b32 v26, 1, v24
    v_lshl_add_u32 v16, v26, 4, v16
    s_lshl_b32 s3, s18, 7
    v_add_u32 v16, s3, v16
    v_add_u32 v17, 15360, v16
    v_add_u32 v18, 30720, v16
    v_add_u32 v19, 46080, v16
    s_and_b32 s3, s16, 3
    s_mul_i32 s3, s3, 49152
    v_add_u32 v11, s3, v12
    s_and_b32 s3, s16, 3
    s_lshl_b32 s3, s3, 10
    v_add_u32 v9, s3, v1
    v_add_u32 v10, 0x10000, v9
    s_barrier
    s_mov_b32 s8, s24
    s_mov_b32 s9, s25
    s_mov_b32 s10, 6291456
    s_mov_b32 s11, 0x00020000
    s_mul_i32 s44, s17, 393216
    buffer_load_dwordx4 v[32:35], v20, s[8:11], s44 offen
    buffer_load_dwordx4 v[64:67], v21, s[8:11], s44 offen
    buffer_load_dwordx4 v[96:99], v22, s[8:11], s44 offen
    s_add_u32 s44, s44, 49152
    buffer_load_dwordx4 v[36:39], v20, s[8:11], s44 offen
    buffer_load_dwordx4 v[68:71], v21, s[8:11], s44 offen
    buffer_load_dwordx4 v[100:103], v22, s[8:11], s44 offen
    s_add_u32 s44, s44, 49152
    buffer_load_dwordx4 v[40:43], v20, s[8:11], s44 offen
    buffer_load_dwordx4 v[72:75], v21, s[8:11], s44 offen
    buffer_load_dwordx4 v[104:107], v22, s[8:11], s44 offen
    s_add_u32 s44, s44, 49152
    buffer_load_dwordx4 v[44:47], v20, s[8:11], s44 offen
    buffer_load_dwordx4 v[76:79], v21, s[8:11], s44 offen
    buffer_load_dwordx4 v[108:111], v22, s[8:11], s44 offen
    s_add_u32 s44, s44, 49152
    buffer_load_dwordx4 v[48:51], v20, s[8:11], s44 offen
    buffer_load_dwordx4 v[80:83], v21, s[8:11], s44 offen
    buffer_load_dwordx4 v[112:115], v22, s[8:11], s44 offen
    s_add_u32 s44, s44, 49152
    buffer_load_dwordx4 v[52:55], v20, s[8:11], s44 offen
    buffer_load_dwordx4 v[84:87], v21, s[8:11], s44 offen
    buffer_load_dwordx4 v[116:119], v22, s[8:11], s44 offen
    s_add_u32 s44, s44, 49152
    buffer_load_dwordx4 v[56:59], v20, s[8:11], s44 offen
    buffer_load_dwordx4 v[88:91], v21, s[8:11], s44 offen
    buffer_load_dwordx4 v[120:123], v22, s[8:11], s44 offen
    s_add_u32 s44, s44, 49152
    buffer_load_dwordx4 v[60:63], v20, s[8:11], s44 offen
    buffer_load_dwordx4 v[92:95], v21, s[8:11], s44 offen
    buffer_load_dwordx4 v[124:127], v22, s[8:11], s44 offen
    s_barrier
    s_waitcnt vmcnt(0)
    v_lshrrev_b32 v28, 4, v1
    v_and_b32 v29, 7, v28
    v_lshrrev_b32 v28, 3, v28
    v_mul_u32_u24 v28, 6144, v28
    v_lshl_add_u32 v28, v29, 4, v28
    s_and_b32 s3, s18, 12
    s_or_b32 s3, s3, 3
    s_lshl_b32 s3, s3, 7
    v_add_u32 v28, s3, v28
    s_lshr_b32 s3, s2, 3
    s_lshl_b32 s3, s3, 2
    s_and_b32 s60, s16, 3
    s_add_u32 s60, s60, s3
    s_lshr_b32 s60, s60, 2
    s_mul_i32 s60, s60, 49152
    s_and_b32 s3, s18, 0
    s_xor_b32 s3, s3, 0
    s_mul_i32 s3, s3, 393216
    s_add_u32 s3, s3, s60
    s_add_u32 s61, s3, 0
    buffer_load_dwordx4 v[160:163], v28, s[8:11], s61 offen
    s_add_u32 s61, s3, 2048
    buffer_load_dwordx4 v[164:167], v28, s[8:11], s61 offen
    s_add_u32 s61, s3, 4096
    buffer_load_dwordx4 v[168:171], v28, s[8:11], s61 offen
    s_and_b32 s3, s18, 0
    s_xor_b32 s3, s3, 4
    s_mul_i32 s3, s3, 393216
    s_add_u32 s3, s3, s60
    s_add_u32 s61, s3, 0
    buffer_load_dwordx4 v[172:175], v28, s[8:11], s61 offen
    s_add_u32 s61, s3, 2048
    buffer_load_dwordx4 v[176:179], v28, s[8:11], s61 offen
    s_add_u32 s61, s3, 4096
    buffer_load_dwordx4 v[180:183], v28, s[8:11], s61 offen
    s_and_b32 s3, s18, 0
    s_xor_b32 s3, s3, 8
    s_mul_i32 s3, s3, 393216
    s_add_u32 s3, s3, s60
    s_add_u32 s61, s3, 0
    buffer_load_dwordx4 v[184:187], v28, s[8:11], s61 offen
    s_add_u32 s61, s3, 2048
    buffer_load_dwordx4 v[188:191], v28, s[8:11], s61 offen
    s_add_u32 s61, s3, 4096
    buffer_load_dwordx4 v[192:195], v28, s[8:11], s61 offen
    s_and_b32 s3, s18, 0
    s_xor_b32 s3, s3, 12
    s_mul_i32 s3, s3, 393216
    s_add_u32 s3, s3, s60
    s_add_u32 s61, s3, 0
    buffer_load_dwordx4 v[196:199], v28, s[8:11], s61 offen
    s_add_u32 s61, s3, 2048
    buffer_load_dwordx4 v[200:203], v28, s[8:11], s61 offen
    s_add_u32 s61, s3, 4096
    buffer_load_dwordx4 v[204:207], v28, s[8:11], s61 offen
    v_lshrrev_b32 v24, 4, v1
    v_and_b32 v25, 1, v24
    v_lshlrev_b32 v25, 4, v25
    v_mov_b32 v26, 0x3f80
    v_lshlrev_b32 v25, v25, v26
    v_bfe_u32 v26, v24, 1, 2
    v_cmp_eq_u32 vcc, 0, v26
    s_nop 1
    v_cndmask_b32 v140, 0, v25, vcc
    v_cmp_eq_u32 vcc, 1, v26
    s_nop 1
    v_cndmask_b32 v141, 0, v25, vcc
    v_cmp_eq_u32 vcc, 2, v26
    s_nop 1
    v_cndmask_b32 v142, 0, v25, vcc
    v_cmp_eq_u32 vcc, 3, v26
    s_nop 1
    v_cndmask_b32 v143, 0, v25, vcc
    s_nop 1
    v_mfma_f32_16x16x32_bf16 v[128:131], v[140:143], v[32:35], 0
    v_mfma_f32_16x16x32_bf16 v[132:135], v[140:143], v[64:67], 0
    v_mfma_f32_16x16x32_bf16 v[136:139], v[140:143], v[96:99], 0
    v_mfma_f32_16x16x32_bf16 v[128:131], v[140:143], v[36:39], v[128:131]
    v_mfma_f32_16x16x32_bf16 v[132:135], v[140:143], v[68:71], v[132:135]
    v_mfma_f32_16x16x32_bf16 v[136:139], v[140:143], v[100:103], v[136:139]
    v_mfma_f32_16x16x32_bf16 v[128:131], v[140:143], v[40:43], v[128:131]
    v_mfma_f32_16x16x32_bf16 v[132:135], v[140:143], v[72:75], v[132:135]
    v_mfma_f32_16x16x32_bf16 v[136:139], v[140:143], v[104:107], v[136:139]
    v_mfma_f32_16x16x32_bf16 v[128:131], v[140:143], v[44:47], v[128:131]
    v_mfma_f32_16x16x32_bf16 v[132:135], v[140:143], v[76:79], v[132:135]
    v_mfma_f32_16x16x32_bf16 v[136:139], v[140:143], v[108:111], v[136:139]
    v_mfma_f32_16x16x32_bf16 v[128:131], v[140:143], v[48:51], v[128:131]
    v_mfma_f32_16x16x32_bf16 v[132:135], v[140:143], v[80:83], v[132:135]
    v_mfma_f32_16x16x32_bf16 v[136:139], v[140:143], v[112:115], v[136:139]
    v_mfma_f32_16x16x32_bf16 v[128:131], v[140:143], v[52:55], v[128:131]
    v_mfma_f32_16x16x32_bf16 v[132:135], v[140:143], v[84:87], v[132:135]
    v_mfma_f32_16x16x32_bf16 v[136:139], v[140:143], v[116:119], v[136:139]
    v_mfma_f32_16x16x32_bf16 v[128:131], v[140:143], v[56:59], v[128:131]
    v_mfma_f32_16x16x32_bf16 v[132:135], v[140:143], v[88:91], v[132:135]
    v_mfma_f32_16x16x32_bf16 v[136:139], v[140:143], v[120:123], v[136:139]
    v_mfma_f32_16x16x32_bf16 v[128:131], v[140:143], v[60:63], v[128:131]
    v_mfma_f32_16x16x32_bf16 v[132:135], v[140:143], v[92:95], v[132:135]
    v_mfma_f32_16x16x32_bf16 v[136:139], v[140:143], v[124:127], v[136:139]
    v_bfe_u32 v25, v24, 3, 1
    v_lshrrev_b32 v26, 5, v24
    v_lshl_add_u32 v26, v26, 1, v25
    v_lshlrev_b32 v25, 8, v26
    v_and_b32 v27, 7, v24
    v_lshl_add_u32 v25, v27, 5, v25
    v_bfe_u32 v27, v24, 4, 1
    v_lshl_add_u32 v25, v27, 4, v25
    v_add_f32_dpp v128, v128, v128 row_ror:8 row_mask:0xf bank_mask:0xf
    v_add_f32_dpp v129, v129, v129 row_ror:8 row_mask:0xf bank_mask:0xf
    v_add_f32_dpp v130, v130, v130 row_ror:8 row_mask:0xf bank_mask:0xf
    v_add_f32_dpp v131, v131, v131 row_ror:8 row_mask:0xf bank_mask:0xf
    v_add_f32_dpp v132, v132, v132 row_ror:8 row_mask:0xf bank_mask:0xf
    v_add_f32_dpp v133, v133, v133 row_ror:8 row_mask:0xf bank_mask:0xf
    v_add_f32_dpp v134, v134, v134 row_ror:8 row_mask:0xf bank_mask:0xf
    v_add_f32_dpp v135, v135, v135 row_ror:8 row_mask:0xf bank_mask:0xf
    v_add_f32_dpp v136, v136, v136 row_ror:8 row_mask:0xf bank_mask:0xf
    v_add_f32_dpp v137, v137, v137 row_ror:8 row_mask:0xf bank_mask:0xf
    v_add_f32_dpp v138, v138, v138 row_ror:8 row_mask:0xf bank_mask:0xf
    v_add_f32_dpp v139, v139, v139 row_ror:8 row_mask:0xf bank_mask:0xf
    v_cmp_le_u32 vcc, 1, v26
    s_nop 1
    v_cndmask_b32 v128, v128, v132, vcc
    v_cndmask_b32 v129, v129, v133, vcc
    v_cndmask_b32 v130, v130, v134, vcc
    v_cndmask_b32 v131, v131, v135, vcc
    v_cmp_le_u32 vcc, 2, v26
    s_nop 1
    v_cndmask_b32 v128, v128, v136, vcc
    v_cndmask_b32 v129, v129, v137, vcc
    v_cndmask_b32 v130, v130, v138, vcc
    v_cndmask_b32 v131, v131, v139, vcc
    v_add_u32 v27, s18, v26
    v_and_b32 v27, 15, v27
    v_lshl_add_u32 v25, v27, 14, v25
    s_lshl_b32 s44, s17, 10
    s_add_u32 s44, s44, 52428800
    buffer_store_dwordx4 v[128:131], v25, s[4:7], s44 offen sc1
    s_barrier
    s_barrier
    s_waitcnt vmcnt(0)
    s_add_u32 s44, s18, 0
    s_and_b32 s44, s44, 15
    s_lshl_b32 s44, s44, 7
    s_add_u32 s44, s44, 0
    s_atomic_add s40, s[22:23], s44
    s_add_u32 s45, s18, 1
    s_and_b32 s45, s45, 15
    s_lshl_b32 s45, s45, 7
    s_add_u32 s45, s45, 0
    s_atomic_add s40, s[22:23], s45
    s_add_u32 s46, s18, 2
    s_and_b32 s46, s46, 15
    s_lshl_b32 s46, s46, 7
    s_add_u32 s46, s46, 0
    s_atomic_add s40, s[22:23], s46
    s_barrier
    s_barrier
    s_barrier
    s_barrier
    s_barrier
    s_barrier
    s_barrier
    s_mov_b32 s12, s26
    s_mov_b32 s13, s27
    s_mov_b32 s14, 2097152
    s_mov_b32 s15, 0x00020000
    s_lshl_b32 s44, s2, 13
    buffer_load_dwordx4 v[160:163], v1, s[12:15], s44 offen offset:0
    buffer_load_dwordx4 v[164:167], v1, s[12:15], s44 offen offset:1024
    buffer_load_dwordx4 v[168:171], v1, s[12:15], s44 offen offset:2048
    buffer_load_dwordx4 v[172:175], v1, s[12:15], s44 offen offset:3072
    s_add_u32 s44, s44, 4096
    buffer_load_dwordx4 v[176:179], v1, s[12:15], s44 offen offset:0
    buffer_load_dwordx4 v[180:183], v1, s[12:15], s44 offen offset:1024
    buffer_load_dwordx4 v[184:187], v1, s[12:15], s44 offen offset:2048
    buffer_load_dwordx4 v[188:191], v1, s[12:15], s44 offen offset:3072
    s_mov_b32 s8, s28
    s_mov_b32 s9, s29
    s_mov_b32 s10, 6291456
    s_mov_b32 s11, 0x00020000
    s_mul_i32 s44, s17, 393216
    buffer_load_dwordx4 v[32:35], v20, s[8:11], s44 offen
    buffer_load_dwordx4 v[64:67], v21, s[8:11], s44 offen
    buffer_load_dwordx4 v[96:99], v22, s[8:11], s44 offen
    s_add_u32 s44, s44, 49152
    buffer_load_dwordx4 v[36:39], v20, s[8:11], s44 offen
    buffer_load_dwordx4 v[68:71], v21, s[8:11], s44 offen
    buffer_load_dwordx4 v[100:103], v22, s[8:11], s44 offen
    s_add_u32 s44, s44, 49152
    buffer_load_dwordx4 v[40:43], v20, s[8:11], s44 offen
    buffer_load_dwordx4 v[72:75], v21, s[8:11], s44 offen
    buffer_load_dwordx4 v[104:107], v22, s[8:11], s44 offen
    s_add_u32 s44, s44, 49152
    s_barrier
    buffer_load_dwordx4 v[44:47], v20, s[8:11], s44 offen
    buffer_load_dwordx4 v[76:79], v21, s[8:11], s44 offen
    buffer_load_dwordx4 v[108:111], v22, s[8:11], s44 offen
    s_add_u32 s44, s44, 49152
    buffer_load_dwordx4 v[48:51], v20, s[8:11], s44 offen
    buffer_load_dwordx4 v[80:83], v21, s[8:11], s44 offen
    buffer_load_dwordx4 v[112:115], v22, s[8:11], s44 offen
    s_add_u32 s44, s44, 49152
    buffer_load_dwordx4 v[52:55], v20, s[8:11], s44 offen
    buffer_load_dwordx4 v[84:87], v21, s[8:11], s44 offen
    buffer_load_dwordx4 v[116:119], v22, s[8:11], s44 offen
    s_add_u32 s44, s44, 49152
    buffer_load_dwordx4 v[56:59], v20, s[8:11], s44 offen
    buffer_load_dwordx4 v[88:91], v21, s[8:11], s44 offen
    buffer_load_dwordx4 v[120:123], v22, s[8:11], s44 offen
    s_add_u32 s44, s44, 49152
    buffer_load_dwordx4 v[60:63], v20, s[8:11], s44 offen
    buffer_load_dwordx4 v[92:95], v21, s[8:11], s44 offen
    buffer_load_dwordx4 v[124:127], v22, s[8:11], s44 offen
    s_barrier
    s_bitcmp1_b32 s21, 0
    s_cselect_b32 s8, s28, s24
    s_cselect_b32 s9, s29, s25
    s_cselect_b32 s12, s30, s26
    s_cselect_b32 s13, s31, s27
    s_mov_b32 s10, 6291456
    s_mov_b32 s11, 0x00020000
    s_mov_b32 s14, 2097152
    s_mov_b32 s15, 0x00020000
    s_branch s_tail
z_layer:
    s_waitcnt lgkmcnt(0)
    v_lshrrev_b32 v28, 4, v1
    v_and_b32 v29, 7, v28
    v_lshrrev_b32 v28, 3, v28
    v_mul_u32_u24 v28, 6144, v28
    v_lshl_add_u32 v28, v29, 4, v28
    s_and_b32 s3, s18, 12
    s_or_b32 s3, s3, 3
    s_lshl_b32 s3, s3, 7
    v_add_u32 v28, s3, v28
    s_lshr_b32 s3, s2, 3
    s_lshl_b32 s3, s3, 2
    s_and_b32 s60, s16, 3
    s_add_u32 s60, s60, s3
    s_lshr_b32 s60, s60, 2
    s_mul_i32 s60, s60, 49152
    s_and_b32 s3, s18, 0
    s_xor_b32 s3, s3, 4
    s_mul_i32 s3, s3, 393216
    s_add_u32 s3, s3, s60
    s_add_u32 s61, s3, 0
    buffer_load_dwordx4 v[160:163], v28, s[8:11], s61 offen
    s_add_u32 s61, s3, 2048
    buffer_load_dwordx4 v[164:167], v28, s[8:11], s61 offen
    s_add_u32 s61, s3, 4096
    buffer_load_dwordx4 v[168:171], v28, s[8:11], s61 offen
    s_and_b32 s3, s18, 0
    s_xor_b32 s3, s3, 8
    s_mul_i32 s3, s3, 393216
    s_add_u32 s3, s3, s60
    s_add_u32 s61, s3, 0
    buffer_load_dwordx4 v[172:175], v28, s[8:11], s61 offen
    s_add_u32 s61, s3, 2048
    buffer_load_dwordx4 v[176:179], v28, s[8:11], s61 offen
    s_add_u32 s61, s3, 4096
    buffer_load_dwordx4 v[180:183], v28, s[8:11], s61 offen
    s_and_b32 s3, s18, 0
    s_xor_b32 s3, s3, 12
    s_mul_i32 s3, s3, 393216
    s_add_u32 s3, s3, s60
    s_add_u32 s61, s3, 0
    buffer_load_dwordx4 v[184:187], v28, s[8:11], s61 offen
    s_add_u32 s61, s3, 2048
    buffer_load_dwordx4 v[188:191], v28, s[8:11], s61 offen
    s_add_u32 s61, s3, 4096
    buffer_load_dwordx4 v[192:195], v28, s[8:11], s61 offen
    s_barrier
    s_barrier
    s_barrier
    s_barrier
    s_barrier
    s_barrier
    s_barrier
    s_barrier
    s_barrier
    s_barrier
    v_lshrrev_b32 v28, 4, v1
    v_and_b32 v29, 7, v28
    v_lshrrev_b32 v28, 3, v28
    v_mul_u32_u24 v28, 2048, v28
    v_lshl_add_u32 v28, v29, 4, v28
    s_and_b32 s3, s18, 12
    s_or_b32 s3, s3, 3
    s_lshl_b32 s3, s3, 7
    v_add_u32 v28, s3, v28
    s_lshr_b32 s3, s2, 3
    s_lshl_b32 s3, s3, 2
    s_and_b32 s60, s16, 3
    s_add_u32 s60, s60, s3
    s_lshl_b32 s61, s60, 14
    buffer_load_dwordx4 v[144:147], v28, s[12:15], s61 offen
    s_bitcmp0_b32 s21, 0
    s_cselect_b32 s56, s28, s24
    s_cselect_b32 s57, s29, s25
    s_mov_b32 s58, 6291456
    s_mov_b32 s59, 0x00020000
    v_lshrrev_b32 v28, 4, v1
    v_and_b32 v29, 7, v28
    v_lshrrev_b32 v28, 3, v28
    v_mul_u32_u24 v28, 6144, v28
    v_lshl_add_u32 v28, v29, 4, v28
    s_and_b32 s3, s18, 12
    s_or_b32 s3, s3, 3
    s_lshl_b32 s3, s3, 7
    v_add_u32 v28, s3, v28
    s_lshr_b32 s3, s2, 3
    s_lshl_b32 s3, s3, 2
    s_and_b32 s60, s16, 3
    s_add_u32 s60, s60, s3
    s_and_b32 s3, s60, 31
    s_mul_i32 s3, s3, 49152
    s_lshr_b32 s61, s60, 5
    s_min_u32 s61, s61, 2
    s_lshl_b32 s61, s61, 11
    s_add_u32 s61, s61, s3
    s_and_b32 s3, s18, 0
    s_mul_i32 s3, s3, 393216
    s_add_u32 s61, s61, s3
    buffer_load_dwordx4 v[148:151], v28, s[56:59], s61 offen
    s_cmp_lg_u32 s21, 2
    s_cbranch_scc1 z_pe
    s_bitcmp0_b32 s21, 0
    s_cselect_b32 s56, s28, s24
    s_cselect_b32 s57, s29, s25
    s_mov_b32 s58, 6291456
    s_mov_b32 s59, 0x00020000
    s_add_u32 s61, s84, 2048
    buffer_load_dwordx4 v[160:163], v11, s[56:59], s61 offen
    s_add_u32 s61, s84, 4096
    buffer_load_dwordx4 v[164:167], v11, s[56:59], s61 offen
    s_add_u32 s61, s84, 0
    buffer_load_dwordx4 v[168:171], v11, s[56:59], s61 offen
    s_add_u32 s61, s84, 198656
    buffer_load_dwordx4 v[172:175], v11, s[56:59], s61 offen
    s_add_u32 s61, s84, 200704
    buffer_load_dwordx4 v[176:179], v11, s[56:59], s61 offen
    s_add_u32 s61, s84, 196608
    buffer_load_dwordx4 v[180:183], v11, s[56:59], s61 offen
    s_add_u32 s61, s85, 2048
    buffer_load_dwordx4 v[184:187], v11, s[56:59], s61 offen
    s_add_u32 s61, s85, 4096
    buffer_load_dwordx4 v[188:191], v11, s[56:59], s61 offen
    s_add_u32 s61, s85, 0
    buffer_load_dwordx4 v[192:195], v11, s[56:59], s61 offen
    s_add_u32 s61, s85, 198656
    buffer_load_dwordx4 v[196:199], v11, s[56:59], s61 offen
z_pe:
    s_barrier
    s_branch s_tail
s_tail:
    s_bitcmp1_b32 s21, 0
    s_cbranch_scc1 s_B
    s_cmp_lg_u32 s16, 4
    s_cbranch_scc1 s_a1
    s_mov_b32 s45, 2146435072
    s_cmp_eq_u32 s17, 0
    s_cbranch_scc1 s_a0
    s_lshr_b32 s46, s21, 1
    s_lshl_b32 s44, s46, 15
    s_lshl_b32 s67, s17, 11
    s_add_u32 s44, s44, s67
    s_lshl_b32 s67, s18, 7
    s_add_u32 s44, s44, s67
    s_add_u32 s44, s44, 149504
    s_sub_u32 s45, s44, 151552
    s_lshl_b32 s45, s45, 5
    s_add_u32 s45, s45, 54525952
    s_mov_b32 s66, 0x10000
s_h_poll:
    s_mov_b32 s68, 0
    s_atomic_add s68, s[22:23], s44 offset:0 glc
    s_sub_u32 s66, s66, 1
    s_cselect_b32 s67, 1, 0
    s_waitcnt lgkmcnt(0)
    s_max_u32 s68, s68, s67
    s_cmp_lt_u32 s68, 1
    s_cbranch_scc1 s_h_poll
s_h_ok:
s_a0:
    s_mov_b32 m0, 131072
    s_nop 0
    buffer_load_dwordx4 v1, s[4:7], s45 offen offset:0 sc1 lds
    buffer_load_dwordx4 v1, s[4:7], s45 offen offset:1024 sc1 lds
    buffer_load_dwordx4 v1, s[4:7], s45 offen offset:2048 sc1 lds
    buffer_load_dwordx4 v1, s[4:7], s45 offen offset:3072 sc1 lds
    s_waitcnt vmcnt(0)
s_a1:
    s_barrier
    s_waitcnt vmcnt(0)
    s_barrier
    s_sub_u32 s3, s16, 5
    s_cmp_gt_u32 s3, 1
    s_cbranch_scc1 s_a2
    s_add_u32 m0, s41, 65536
    s_xor_b32 s44, s62, 65536
    buffer_load_dwordx4 v16, s[12:15], s44 offen offset:0 lds
    buffer_load_dwordx4 v17, s[12:15], s44 offen offset:1024 lds
    s_add_u32 m0, s41, 69632
    s_xor_b32 s44, s62, 196608
    buffer_load_dwordx4 v16, s[12:15], s44 offen offset:0 lds
    buffer_load_dwordx4 v17, s[12:15], s44 offen offset:1024 lds
    s_add_u32 m0, s41, 73728
    s_xor_b32 s44, s62, 327680
    buffer_load_dwordx4 v16, s[12:15], s44 offen offset:0 lds
    buffer_load_dwordx4 v17, s[12:15], s44 offen offset:1024 lds
    s_add_u32 m0, s41, 77824
    s_xor_b32 s44, s62, 458752
    buffer_load_dwordx4 v16, s[12:15], s44 offen offset:0 lds
    buffer_load_dwordx4 v17, s[12:15], s44 offen offset:1024 lds
    s_add_u32 m0, s41, 81920
    s_xor_b32 s44, s62, 589824
    buffer_load_dwordx4 v16, s[12:15], s44 offen offset:0 lds
    buffer_load_dwordx4 v17, s[12:15], s44 offen offset:1024 lds
    s_add_u32 m0, s41, 86016
    s_xor_b32 s44, s62, 720896
    buffer_load_dwordx4 v16, s[12:15], s44 offen offset:0 lds
    buffer_load_dwordx4 v17, s[12:15], s44 offen offset:1024 lds
    s_add_u32 m0, s41, 90112
    s_xor_b32 s44, s62, 851968
    buffer_load_dwordx4 v16, s[12:15], s44 offen offset:0 lds
    buffer_load_dwordx4 v17, s[12:15], s44 offen offset:1024 lds
    s_add_u32 m0, s41, 94208
    s_xor_b32 s44, s62, 983040
    buffer_load_dwordx4 v16, s[12:15], s44 offen offset:0 lds
    buffer_load_dwordx4 v17, s[12:15], s44 offen offset:1024 lds
    s_add_u32 m0, s41, 98304
    s_xor_b32 s44, s62, 1114112
    buffer_load_dwordx4 v16, s[12:15], s44 offen offset:0 lds
    buffer_load_dwordx4 v17, s[12:15], s44 offen offset:1024 lds
    s_add_u32 m0, s41, 102400
    s_xor_b32 s44, s62, 1245184
    buffer_load_dwordx4 v16, s[12:15], s44 offen offset:0 lds
    buffer_load_dwordx4 v17, s[12:15], s44 offen offset:1024 lds
    s_add_u32 m0, s41, 106496
    s_xor_b32 s44, s62, 1376256
    buffer_load_dwordx4 v16, s[12:15], s44 offen offset:0 lds
    buffer_load_dwordx4 v17, s[12:15], s44 offen offset:1024 lds
    s_add_u32 m0, s41, 110592
    s_xor_b32 s44, s62, 1507328
    buffer_load_dwordx4 v16, s[12:15], s44 offen offset:0 lds
    buffer_load_dwordx4 v17, s[12:15], s44 offen offset:1024 lds
    s_add_u32 m0, s41, 114688
    s_xor_b32 s44, s62, 1638400
    buffer_load_dwordx4 v16, s[12:15], s44 offen offset:0 lds
    buffer_load_dwordx4 v17, s[12:15], s44 offen offset:1024 lds
    s_add_u32 m0, s41, 118784
    s_xor_b32 s44, s62, 1769472
    buffer_load_dwordx4 v16, s[12:15], s44 offen offset:0 lds
    buffer_load_dwordx4 v17, s[12:15], s44 offen offset:1024 lds
    s_add_u32 m0, s41, 122880
    s_xor_b32 s44, s62, 1900544
    buffer_load_dwordx4 v16, s[12:15], s44 offen offset:0 lds
    buffer_load_dwordx4 v17, s[12:15], s44 offen offset:1024 lds
    s_add_u32 m0, s41, 126976
    s_xor_b32 s44, s62, 2031616
    buffer_load_dwordx4 v16, s[12:15], s44 offen offset:0 lds
    buffer_load_dwordx4 v17, s[12:15], s44 offen offset:1024 lds
s_a2:
    s_cmp_eq_u32 s21, 2
    s_cbranch_scc1 s_a3
    s_bitcmp0_b32 s21, 0
    s_cselect_b32 s56, s28, s24
    s_cselect_b32 s57, s29, s25
    s_mov_b32 s58, 6291456
    s_mov_b32 s59, 0x00020000
    s_add_u32 s61, s84, 2048
    buffer_load_dwordx4 v[160:163], v11, s[56:59], s61 offen
    s_add_u32 s61, s84, 4096
    buffer_load_dwordx4 v[164:167], v11, s[56:59], s61 offen
    s_add_u32 s61, s84, 0
    buffer_load_dwordx4 v[168:171], v11, s[56:59], s61 offen
    s_add_u32 s61, s84, 198656
    buffer_load_dwordx4 v[172:175], v11, s[56:59], s61 offen
    s_add_u32 s61, s84, 200704
    buffer_load_dwordx4 v[176:179], v11, s[56:59], s61 offen
    s_add_u32 s61, s84, 196608
    buffer_load_dwordx4 v[180:183], v11, s[56:59], s61 offen
    s_add_u32 s61, s85, 2048
    buffer_load_dwordx4 v[184:187], v11, s[56:59], s61 offen
    s_add_u32 s61, s85, 4096
    buffer_load_dwordx4 v[188:191], v11, s[56:59], s61 offen
    s_add_u32 s61, s85, 0
    buffer_load_dwordx4 v[192:195], v11, s[56:59], s61 offen
    s_add_u32 s61, s85, 198656
    buffer_load_dwordx4 v[196:199], v11, s[56:59], s61 offen
s_a3:
    s_bitcmp0_b32 s21, 0
    s_cselect_b32 s56, s28, s24
    s_cselect_b32 s57, s29, s25
    s_mov_b32 s58, 6291456
    s_mov_b32 s59, 0x00020000
    s_add_u32 s61, s85, 200704
    buffer_load_dwordx4 v[200:203], v11, s[56:59], s61 offen
    s_add_u32 s61, s85, 196608
    buffer_load_dwordx4 v[204:207], v11, s[56:59], s61 offen
    s_add_u32 s61, s86, 2048
    buffer_load_dwordx4 v[208:211], v11, s[56:59], s61 offen
    s_add_u32 s61, s86, 4096
    buffer_load_dwordx4 v[212:215], v11, s[56:59], s61 offen
    s_add_u32 s61, s86, 0
    buffer_load_dwordx4 v[216:219], v11, s[56:59], s61 offen
    s_add_u32 s61, s86, 198656
    buffer_load_dwordx4 v[220:223], v11, s[56:59], s61 offen
    s_add_u32 s61, s86, 200704
    buffer_load_dwordx4 v[224:227], v11, s[56:59], s61 offen
    s_add_u32 s61, s86, 196608
    buffer_load_dwordx4 v[228:231], v11, s[56:59], s61 offen
    s_add_u32 s61, s87, 2048
    buffer_load_dwordx4 v[232:235], v11, s[56:59], s61 offen
    s_add_u32 s61, s87, 4096
    buffer_load_dwordx4 v[236:239], v11, s[56:59], s61 offen
    s_add_u32 s61, s87, 0
    buffer_load_dwordx4 v[240:243], v11, s[56:59], s61 offen
    s_add_u32 s61, s87, 198656
    buffer_load_dwordx4 v[244:247], v11, s[56:59], s61 offen
    s_add_u32 s61, s87, 200704
    buffer_load_dwordx4 v[248:251], v11, s[56:59], s61 offen
    s_add_u32 s61, s87, 196608
    buffer_load_dwordx4 v[252:255], v11, s[56:59], s61 offen
    s_waitcnt vmcnt(0)
    s_lshl_b32 s3, s21, 3
    s_add_u32 s3, s3, s16
    s_cmp_lg_u32 s3, 7
    s_cbranch_scc1 s_g3
    v_lshrrev_b32 v24, 4, v1
    v_and_b32 v25, 1, v24
    v_lshlrev_b32 v25, 4, v25
    v_mov_b32 v26, 0x3f80
    v_lshlrev_b32 v25, v25, v26
    v_bfe_u32 v26, v24, 1, 2
    v_cmp_eq_u32 vcc, 0, v26
    s_nop 1
    v_cndmask_b32 v140, 0, v25, vcc
    v_cmp_eq_u32 vcc, 1, v26
    s_nop 1
    v_cndmask_b32 v141, 0, v25, vcc
    v_cmp_eq_u32 vcc, 2, v26
    s_nop 1
    v_cndmask_b32 v142, 0, v25, vcc
    v_cmp_eq_u32 vcc, 3, v26
    s_nop 1
    v_cndmask_b32 v143, 0, v25, vcc
    s_nop 1
    v_mfma_f32_16x16x32_bf16 v[128:131], v[140:143], v[32:35], 0
    v_mfma_f32_16x16x32_bf16 v[132:135], v[140:143], v[64:67], 0
    v_mfma_f32_16x16x32_bf16 v[136:139], v[140:143], v[96:99], 0
    v_mfma_f32_16x16x32_bf16 v[128:131], v[140:143], v[36:39], v[128:131]
    v_mfma_f32_16x16x32_bf16 v[132:135], v[140:143], v[68:71], v[132:135]
    v_mfma_f32_16x16x32_bf16 v[136:139], v[140:143], v[100:103], v[136:139]
    v_mfma_f32_16x16x32_bf16 v[128:131], v[140:143], v[40:43], v[128:131]
    v_mfma_f32_16x16x32_bf16 v[132:135], v[140:143], v[72:75], v[132:135]
    v_mfma_f32_16x16x32_bf16 v[136:139], v[140:143], v[104:107], v[136:139]
    v_mfma_f32_16x16x32_bf16 v[128:131], v[140:143], v[44:47], v[128:131]
    v_mfma_f32_16x16x32_bf16 v[132:135], v[140:143], v[76:79], v[132:135]
    v_mfma_f32_16x16x32_bf16 v[136:139], v[140:143], v[108:111], v[136:139]
    v_mfma_f32_16x16x32_bf16 v[128:131], v[140:143], v[48:51], v[128:131]
    v_mfma_f32_16x16x32_bf16 v[132:135], v[140:143], v[80:83], v[132:135]
    v_mfma_f32_16x16x32_bf16 v[136:139], v[140:143], v[112:115], v[136:139]
    v_mfma_f32_16x16x32_bf16 v[128:131], v[140:143], v[52:55], v[128:131]
    v_mfma_f32_16x16x32_bf16 v[132:135], v[140:143], v[84:87], v[132:135]
    v_mfma_f32_16x16x32_bf16 v[136:139], v[140:143], v[116:119], v[136:139]
    v_mfma_f32_16x16x32_bf16 v[128:131], v[140:143], v[56:59], v[128:131]
    v_mfma_f32_16x16x32_bf16 v[132:135], v[140:143], v[88:91], v[132:135]
    v_mfma_f32_16x16x32_bf16 v[136:139], v[140:143], v[120:123], v[136:139]
    v_mfma_f32_16x16x32_bf16 v[128:131], v[140:143], v[60:63], v[128:131]
    v_mfma_f32_16x16x32_bf16 v[132:135], v[140:143], v[92:95], v[132:135]
    v_mfma_f32_16x16x32_bf16 v[136:139], v[140:143], v[124:127], v[136:139]
    v_bfe_u32 v25, v24, 3, 1
    v_lshrrev_b32 v26, 5, v24
    v_lshl_add_u32 v26, v26, 1, v25
    v_lshlrev_b32 v25, 8, v26
    v_and_b32 v27, 7, v24
    v_lshl_add_u32 v25, v27, 5, v25
    v_bfe_u32 v27, v24, 4, 1
    v_lshl_add_u32 v25, v27, 4, v25
    v_add_f32_dpp v128, v128, v128 row_ror:8 row_mask:0xf bank_mask:0xf
    v_add_f32_dpp v129, v129, v129 row_ror:8 row_mask:0xf bank_mask:0xf
    v_add_f32_dpp v130, v130, v130 row_ror:8 row_mask:0xf bank_mask:0xf
    v_add_f32_dpp v131, v131, v131 row_ror:8 row_mask:0xf bank_mask:0xf
    v_add_f32_dpp v132, v132, v132 row_ror:8 row_mask:0xf bank_mask:0xf
    v_add_f32_dpp v133, v133, v133 row_ror:8 row_mask:0xf bank_mask:0xf
    v_add_f32_dpp v134, v134, v134 row_ror:8 row_mask:0xf bank_mask:0xf
    v_add_f32_dpp v135, v135, v135 row_ror:8 row_mask:0xf bank_mask:0xf
    v_add_f32_dpp v136, v136, v136 row_ror:8 row_mask:0xf bank_mask:0xf
    v_add_f32_dpp v137, v137, v137 row_ror:8 row_mask:0xf bank_mask:0xf
    v_add_f32_dpp v138, v138, v138 row_ror:8 row_mask:0xf bank_mask:0xf
    v_add_f32_dpp v139, v139, v139 row_ror:8 row_mask:0xf bank_mask:0xf
    v_cmp_le_u32 vcc, 1, v26
    s_nop 1
    v_cndmask_b32 v128, v128, v132, vcc
    v_cndmask_b32 v129, v129, v133, vcc
    v_cndmask_b32 v130, v130, v134, vcc
    v_cndmask_b32 v131, v131, v135, vcc
    v_cmp_le_u32 vcc, 2, v26
    s_nop 1
    v_cndmask_b32 v128, v128, v136, vcc
    v_cndmask_b32 v129, v129, v137, vcc
    v_cndmask_b32 v130, v130, v138, vcc
    v_cndmask_b32 v131, v131, v139, vcc
    v_add_u32 v27, s18, v26
    v_and_b32 v27, 15, v27
    v_lshl_add_u32 v25, v27, 14, v25
    s_lshl_b32 s44, s17, 10
    s_add_u32 s44, s44, 52690944
    buffer_store_dwordx4 v[128:131], v25, s[4:7], s44 offen sc1
    s_waitcnt vmcnt(0)
    s_add_u32 s44, s18, 0
    s_and_b32 s44, s44, 15
    s_lshl_b32 s44, s44, 7
    s_add_u32 s44, s44, 2048
    s_atomic_add s40, s[22:23], s44
    s_add_u32 s45, s18, 1
    s_and_b32 s45, s45, 15
    s_lshl_b32 s45, s45, 7
    s_add_u32 s45, s45, 2048
    s_atomic_add s40, s[22:23], s45
    s_add_u32 s46, s18, 2
    s_and_b32 s46, s46, 15
    s_lshl_b32 s46, s46, 7
    s_add_u32 s46, s46, 2048
    s_atomic_add s40, s[22:23], s46
    s_branch s_g3
s_B:
    s_barrier
    s_cmp_eq_u32 s21, 3
    s_cbranch_scc1 s_nopf
    s_bitcmp0_b32 s21, 0
    s_cselect_b32 s56, s28, s24
    s_cselect_b32 s57, s29, s25
    s_mov_b32 s58, 6291456
    s_mov_b32 s59, 0x00020000
    s_add_u32 s61, s84, 2048
    buffer_load_dwordx4 v[160:163], v11, s[56:59], s61 offen
    s_add_u32 s61, s84, 4096
    buffer_load_dwordx4 v[164:167], v11, s[56:59], s61 offen
    s_add_u32 s61, s84, 0
    buffer_load_dwordx4 v[168:171], v11, s[56:59], s61 offen
    s_add_u32 s61, s84, 198656
    buffer_load_dwordx4 v[172:175], v11, s[56:59], s61 offen
    s_waitcnt vmcnt(2)
    s_add_u32 s61, s84, 200704
    buffer_load_dwordx4 v[176:179], v11, s[56:59], s61 offen
    s_add_u32 s61, s84, 196608
    buffer_load_dwordx4 v[180:183], v11, s[56:59], s61 offen
    s_add_u32 s61, s85, 2048
    buffer_load_dwordx4 v[184:187], v11, s[56:59], s61 offen
    s_add_u32 s61, s85, 4096
    buffer_load_dwordx4 v[188:191], v11, s[56:59], s61 offen
    s_waitcnt vmcnt(2)
    s_add_u32 s61, s85, 0
    buffer_load_dwordx4 v[192:195], v11, s[56:59], s61 offen
    s_add_u32 s61, s85, 198656
    buffer_load_dwordx4 v[196:199], v11, s[56:59], s61 offen
    s_add_u32 s61, s85, 200704
    buffer_load_dwordx4 v[200:203], v11, s[56:59], s61 offen
    s_add_u32 s61, s85, 196608
    buffer_load_dwordx4 v[204:207], v11, s[56:59], s61 offen
    s_waitcnt vmcnt(2)
    s_add_u32 s61, s86, 2048
    buffer_load_dwordx4 v[208:211], v11, s[56:59], s61 offen
    s_add_u32 s61, s86, 4096
    buffer_load_dwordx4 v[212:215], v11, s[56:59], s61 offen
    s_add_u32 s61, s86, 0
    buffer_load_dwordx4 v[216:219], v11, s[56:59], s61 offen
    s_add_u32 s61, s86, 198656
    buffer_load_dwordx4 v[220:223], v11, s[56:59], s61 offen
    s_waitcnt vmcnt(2)
    s_add_u32 s61, s86, 200704
    buffer_load_dwordx4 v[224:227], v11, s[56:59], s61 offen
    s_add_u32 s61, s86, 196608
    buffer_load_dwordx4 v[228:231], v11, s[56:59], s61 offen
    s_add_u32 s61, s87, 2048
    buffer_load_dwordx4 v[232:235], v11, s[56:59], s61 offen
    s_add_u32 s61, s87, 4096
    buffer_load_dwordx4 v[236:239], v11, s[56:59], s61 offen
    s_waitcnt vmcnt(2)
    s_add_u32 s61, s87, 0
    buffer_load_dwordx4 v[240:243], v11, s[56:59], s61 offen
    s_add_u32 s61, s87, 198656
    buffer_load_dwordx4 v[244:247], v11, s[56:59], s61 offen
    s_add_u32 s61, s87, 200704
    buffer_load_dwordx4 v[248:251], v11, s[56:59], s61 offen
    s_add_u32 s61, s87, 196608
    buffer_load_dwordx4 v[252:255], v11, s[56:59], s61 offen
    s_waitcnt vmcnt(2)
    s_lshl_b32 s3, s2, 2
    s_and_b32 s60, s16, 3
    s_add_u32 s60, s60, s3
    s_lshl_b32 s60, s60, 11
    buffer_load_dwordx4 v[96:99], v1, s[12:15], s60 offen offset:0
    buffer_load_dwordx4 v[100:103], v1, s[12:15], s60 offen offset:1024
s_nopf:
    s_setprio 3
    s_mov_b32 s52, 0
    s_lshl_b32 s44, s16, 14
    v_add_u32 v24, s44, v1
    s_and_b32 s3, s16, 3
    s_lshl_b32 s44, s3, 10
    s_add_u32 s44, s44, 147456
    v_lshrrev_b32 v25, 2, v1
    v_add_u32 v25, s44, v25
    s_lshl_b32 s53, s21, 22
    s_lshl_b32 s44, s38, 16
    s_add_u32 s53, s53, s44
    s_lshl_b32 s44, s18, 12
    s_add_u32 s53, s53, s44
    s_add_u32 s53, s53, 16777216
    s_lshl_b32 s54, s21, 14
    s_lshl_b32 s67, s38, 8
    s_add_u32 s54, s54, s67
    s_add_u32 s54, s54, 86016
s_bhead:
    s_barrier
    s_waitcnt vmcnt(0) lgkmcnt(0)
    s_barrier
    ds_read_b32 v28, v25 offset:0
    ds_read_b32 v29, v25 offset:256
    ds_read_b32 v30, v25 offset:512
    ds_read_b32 v31, v25 offset:768
    ds_read_b128 v[32:35], v24 offset:0
    ds_read_b128 v[36:39], v24 offset:1024
    ds_read_b128 v[40:43], v24 offset:2048
    ds_read_b128 v[44:47], v24 offset:3072
    ds_read_b128 v[48:51], v24 offset:4096
    ds_read_b128 v[52:55], v24 offset:5120
    ds_read_b128 v[56:59], v24 offset:6144
    ds_read_b128 v[60:63], v24 offset:7168
    ds_read_b128 v[64:67], v24 offset:8192
    ds_read_b128 v[68:71], v24 offset:9216
    ds_read_b128 v[72:75], v24 offset:10240
    ds_read_b128 v[76:79], v24 offset:11264
    ds_read_b128 v[80:83], v24 offset:12288
    ds_read_b128 v[84:87], v24 offset:13312
    ds_read_b128 v[88:91], v24 offset:14336
    ds_read_b128 v[92:95], v24 offset:15360
    s_waitcnt lgkmcnt(14)
    v_add_f32 v28, v28, v29
    v_add_f32 v30, v30, v31
    v_add_f32 v28, v28, v30
    v_mov_b32 v29, 0x5d800000
    v_mov_b32 v30, 0x21800000
    v_cmp_nlt_f32 s[44:45], v28, v29
    v_cmp_ngt_f32 vcc, v28, v30
    v_rcp_f32 v28, v28
    s_or_b64 vcc, vcc, s[44:45]
    s_waitcnt lgkmcnt(8)
    v_pk_add_f32 v[32:33], v[32:33], v[48:49]
    v_pk_add_f32 v[34:35], v[34:35], v[50:51]
    v_pk_add_f32 v[36:37], v[36:37], v[52:53]
    v_pk_add_f32 v[38:39], v[38:39], v[54:55]
    v_pk_add_f32 v[40:41], v[40:41], v[56:57]
    v_pk_add_f32 v[42:43], v[42:43], v[58:59]
    v_pk_add_f32 v[44:45], v[44:45], v[60:61]
    v_pk_add_f32 v[46:47], v[46:47], v[62:63]
    s_waitcnt lgkmcnt(4)
    v_pk_add_f32 v[32:33], v[32:33], v[64:65]
    v_pk_add_f32 v[34:35], v[34:35], v[66:67]
    v_pk_add_f32 v[36:37], v[36:37], v[68:69]
    v_pk_add_f32 v[38:39], v[38:39], v[70:71]
    v_pk_add_f32 v[40:41], v[40:41], v[72:73]
    v_pk_add_f32 v[42:43], v[42:43], v[74:75]
    v_pk_add_f32 v[44:45], v[44:45], v[76:77]
    v_pk_add_f32 v[46:47], v[46:47], v[78:79]
    s_waitcnt lgkmcnt(0)
    v_pk_add_f32 v[32:33], v[32:33], v[80:81]
    v_pk_add_f32 v[34:35], v[34:35], v[82:83]
    v_pk_add_f32 v[36:37], v[36:37], v[84:85]
    v_pk_add_f32 v[38:39], v[38:39], v[86:87]
    v_pk_add_f32 v[40:41], v[40:41], v[88:89]
    v_pk_add_f32 v[42:43], v[42:43], v[90:91]
    v_pk_add_f32 v[44:45], v[44:45], v[92:93]
    v_pk_add_f32 v[46:47], v[46:47], v[94:95]
    s_cbranch_vccnz s_slow
s_fin:
    v_pk_mul_f32 v[32:33], v[28:29], v[32:33] op_sel_hi:[0,1]
    v_pk_mul_f32 v[34:35], v[28:29], v[34:35] op_sel_hi:[0,1]
    v_pk_mul_f32 v[36:37], v[28:29], v[36:37] op_sel_hi:[0,1]
    v_pk_mul_f32 v[38:39], v[28:29], v[38:39] op_sel_hi:[0,1]
    v_pk_mul_f32 v[40:41], v[28:29], v[40:41] op_sel_hi:[0,1]
    v_pk_mul_f32 v[42:43], v[28:29], v[42:43] op_sel_hi:[0,1]
    v_pk_mul_f32 v[44:45], v[28:29], v[44:45] op_sel_hi:[0,1]
    v_pk_mul_f32 v[46:47], v[28:29], v[46:47] op_sel_hi:[0,1]
    v_cvt_pk_bf16_f32 v32, v32, v33
    v_cvt_pk_bf16_f32 v33, v34, v35
    v_cvt_pk_bf16_f32 v34, v36, v37
    v_cvt_pk_bf16_f32 v35, v38, v39
    v_cvt_pk_bf16_f32 v36, v40, v41
    v_cvt_pk_bf16_f32 v37, v42, v43
    v_cvt_pk_bf16_f32 v38, v44, v45
    v_cvt_pk_bf16_f32 v39, v46, v47
    buffer_store_dwordx4 v[32:35], v1, s[4:7], s53 offen offset:0 sc1
    buffer_store_dwordx4 v[36:39], v1, s[4:7], s53 offen offset:1024 sc1
    s_cmp_lg_u32 s52, 0
    s_cbranch_scc1 s_b2
    s_waitcnt vmcnt(0)
    s_atomic_add s40, s[22:23], s54
    s_mov_b32 s52, 1
    s_add_u32 s53, s53, 2048
    s_waitcnt lgkmcnt(0)
    s_add_u32 s54, s54, 128
    s_setprio 0
    s_and_b32 s3, s16, 3
    s_lshl_b32 s46, s3, 19
    s_lshl_b32 s45, s3, 14
    s_and_b32 s3, s18, 0
    s_lshl_b32 s3, s3, 17
    s_xor_b32 s46, s46, s3
    s_add_u32 m0, s45, 0
    s_xor_b32 s44, s46, 0
    buffer_load_dwordx4 v16, s[12:15], s44 offen offset:0 lds
    buffer_load_dwordx4 v17, s[12:15], s44 offen offset:1024 lds
    buffer_load_dwordx4 v18, s[12:15], s44 offen offset:2048 lds
    buffer_load_dwordx4 v19, s[12:15], s44 offen offset:3072 lds
    s_add_u32 s44, s44, 65536
    s_waitcnt vmcnt(2)
    buffer_load_dwordx4 v[96:99], v16, s[12:15], s44 offen offset:0
    buffer_load_dwordx4 v[100:103], v17, s[12:15], s44 offen offset:1024
    buffer_load_dwordx4 v[104:107], v18, s[12:15], s44 offen offset:2048
    buffer_load_dwordx4 v[108:111], v19, s[12:15], s44 offen offset:3072
    s_waitcnt vmcnt(2)
    s_add_u32 m0, s45, 4096
    s_xor_b32 s44, s46, 131072
    buffer_load_dwordx4 v16, s[12:15], s44 offen offset:0 lds
    buffer_load_dwordx4 v17, s[12:15], s44 offen offset:1024 lds
    buffer_load_dwordx4 v18, s[12:15], s44 offen offset:2048 lds
    buffer_load_dwordx4 v19, s[12:15], s44 offen offset:3072 lds
    s_add_u32 s44, s44, 65536
    s_waitcnt vmcnt(2)
    buffer_load_dwordx4 v[112:115], v16, s[12:15], s44 offen offset:0
    buffer_load_dwordx4 v[116:119], v17, s[12:15], s44 offen offset:1024
    buffer_load_dwordx4 v[120:123], v18, s[12:15], s44 offen offset:2048
    buffer_load_dwordx4 v[124:127], v19, s[12:15], s44 offen offset:3072
    s_waitcnt vmcnt(2)
    s_add_u32 m0, s45, 8192
    s_xor_b32 s44, s46, 262144
    buffer_load_dwordx4 v16, s[12:15], s44 offen offset:0 lds
    buffer_load_dwordx4 v17, s[12:15], s44 offen offset:1024 lds
    buffer_load_dwordx4 v18, s[12:15], s44 offen offset:2048 lds
    buffer_load_dwordx4 v19, s[12:15], s44 offen offset:3072 lds
    s_add_u32 s44, s44, 65536
    s_waitcnt vmcnt(2)
    buffer_load_dwordx4 v[128:131], v16, s[12:15], s44 offen offset:0
    buffer_load_dwordx4 v[132:135], v17, s[12:15], s44 offen offset:1024
    buffer_load_dwordx4 v[136:139], v18, s[12:15], s44 offen offset:2048
    buffer_load_dwordx4 v[140:143], v19, s[12:15], s44 offen offset:3072
    s_waitcnt vmcnt(2)
    s_add_u32 m0, s45, 12288
    s_xor_b32 s44, s46, 393216
    buffer_load_dwordx4 v16, s[12:15], s44 offen offset:0 lds
    buffer_load_dwordx4 v17, s[12:15], s44 offen offset:1024 lds
    buffer_load_dwordx4 v18, s[12:15], s44 offen offset:2048 lds
    buffer_load_dwordx4 v19, s[12:15], s44 offen offset:3072 lds
    s_add_u32 s44, s44, 65536
    s_waitcnt vmcnt(2)
    buffer_load_dwordx4 v[144:147], v16, s[12:15], s44 offen offset:0
    buffer_load_dwordx4 v[148:151], v17, s[12:15], s44 offen offset:1024
    buffer_load_dwordx4 v[152:155], v18, s[12:15], s44 offen offset:2048
    buffer_load_dwordx4 v[156:159], v19, s[12:15], s44 offen offset:3072
    s_waitcnt vmcnt(2)
    s_setprio 3
    s_sub_u32 s44, s54, 128
    s_mov_b32 s66, 0x10000
s_o0_poll:
    s_mov_b32 s68, 0
    s_atomic_add s68, s[22:23], s44 offset:0 glc
    s_sub_u32 s66, s66, 1
    s_cselect_b32 s67, 16, 0
    s_waitcnt lgkmcnt(0)
    s_max_u32 s68, s68, s67
    s_cmp_lt_u32 s68, 16
    s_cbranch_scc1 s_o0_poll
s_o0_ok:
    s_branch s_bhead
s_b2:
    ds_write_b128 v24, v[96:99] offset:0
    ds_write_b128 v24, v[100:103] offset:1024
    ds_write_b128 v24, v[104:107] offset:2048
    ds_write_b128 v24, v[108:111] offset:3072
    ds_write_b128 v24, v[112:115] offset:4096
    ds_write_b128 v24, v[116:119] offset:5120
    ds_write_b128 v24, v[120:123] offset:6144
    ds_write_b128 v24, v[124:127] offset:7168
    ds_write_b128 v24, v[128:131] offset:8192
    ds_write_b128 v24, v[132:135] offset:9216
    ds_write_b128 v24, v[136:139] offset:10240
    ds_write_b128 v24, v[140:143] offset:11264
    ds_write_b128 v24, v[144:147] offset:12288
    ds_write_b128 v24, v[148:151] offset:13312
    ds_write_b128 v24, v[152:155] offset:14336
    ds_write_b128 v24, v[156:159] offset:15360
    s_waitcnt vmcnt(0)
    s_atomic_add s40, s[22:23], s54
    s_mov_b32 s66, 0x10000
s_o1_poll:
    s_mov_b32 s68, 0
    s_atomic_add s68, s[22:23], s54 offset:0 glc
    s_sub_u32 s66, s66, 1
    s_cselect_b32 s67, 16, 0
    s_waitcnt lgkmcnt(0)
    s_max_u32 s68, s68, s67
    s_cmp_lt_u32 s68, 16
    s_cbranch_scc1 s_o1_poll
s_o1_ok:
s_b3:
    s_setprio 0
    s_waitcnt lgkmcnt(0)
s_g3:
    s_barrier
    s_cmp_eq_u32 s21, 3
    s_cbranch_scc1 s_end
    s_barrier
    ds_write_b128 v9, v[160:163] offset:0
    ds_write_b128 v9, v[164:167] offset:4096
    ds_write_b128 v9, v[168:171] offset:8192
    ds_write_b128 v9, v[172:175] offset:12288
    ds_write_b128 v9, v[176:179] offset:16384
    ds_write_b128 v9, v[180:183] offset:20480
    ds_write_b128 v9, v[184:187] offset:24576
    ds_write_b128 v9, v[188:191] offset:28672
    s_add_u32 s21, s21, 1
    s_bitcmp1_b32 s21, 0
    s_cselect_b32 s8, s28, s24
    s_cselect_b32 s9, s29, s25
    s_cselect_b32 s12, s30, s26
    s_cselect_b32 s13, s31, s27
    s_mov_b32 s10, 6291456
    s_mov_b32 s11, 0x00020000
    s_mov_b32 s14, 2097152
    s_mov_b32 s15, 0x00020000
    s_sub_u32 s3, s16, 5
    s_cmp_gt_u32 s3, 1
    s_cbranch_scc1 s_n67
    s_add_u32 m0, s41, 98304
    s_add_u32 s44, s88, 2048
    buffer_load_dwordx4 v14, s[8:11], s44 offen offset:0 lds
    buffer_load_dwordx4 v15, s[8:11], s44 offen offset:1024 lds
    s_add_u32 m0, s41, 102400
    s_add_u32 s44, s88, 4096
    buffer_load_dwordx4 v14, s[8:11], s44 offen offset:0 lds
    buffer_load_dwordx4 v15, s[8:11], s44 offen offset:1024 lds
    s_add_u32 m0, s41, 106496
    s_add_u32 s44, s88, 0
    buffer_load_dwordx4 v14, s[8:11], s44 offen offset:0 lds
    buffer_load_dwordx4 v15, s[8:11], s44 offen offset:1024 lds
    s_add_u32 m0, s41, 110592
    s_add_u32 s44, s88, 198656
    buffer_load_dwordx4 v14, s[8:11], s44 offen offset:0 lds
    buffer_load_dwordx4 v15, s[8:11], s44 offen offset:1024 lds
    s_add_u32 m0, s41, 114688
    s_add_u32 s44, s88, 200704
    buffer_load_dwordx4 v14, s[8:11], s44 offen offset:0 lds
    buffer_load_dwordx4 v15, s[8:11], s44 offen offset:1024 lds
    s_add_u32 m0, s41, 118784
    s_add_u32 s44, s88, 196608
    buffer_load_dwordx4 v14, s[8:11], s44 offen offset:0 lds
    buffer_load_dwordx4 v15, s[8:11], s44 offen offset:1024 lds
    s_add_u32 m0, s41, 122880
    s_add_u32 s44, s89, 2048
    buffer_load_dwordx4 v14, s[8:11], s44 offen offset:0 lds
    buffer_load_dwordx4 v15, s[8:11], s44 offen offset:1024 lds
    s_add_u32 m0, s41, 126976
    s_add_u32 s44, s89, 4096
    buffer_load_dwordx4 v14, s[8:11], s44 offen offset:0 lds
    buffer_load_dwordx4 v15, s[8:11], s44 offen offset:1024 lds
s_n67:
    s_waitcnt lgkmcnt(0)
    s_barrier
    ds_write_b128 v9, v[192:195] offset:32768
    ds_write_b128 v9, v[196:199] offset:36864
    ds_write_b128 v9, v[200:203] offset:40960
    ds_write_b128 v9, v[204:207] offset:45056
    ds_write_b128 v9, v[208:211] offset:49152
    ds_write_b128 v9, v[212:215] offset:53248
    ds_write_b128 v9, v[216:219] offset:57344
    ds_write_b128 v9, v[220:223] offset:61440
    ds_write_b128 v10, v[224:227] offset:0
    ds_write_b128 v10, v[228:231] offset:4096
    ds_write_b128 v10, v[232:235] offset:8192
    ds_write_b128 v10, v[236:239] offset:12288
    ds_write_b128 v10, v[240:243] offset:16384
    ds_write_b128 v10, v[244:247] offset:20480
    ds_write_b128 v10, v[248:251] offset:24576
    ds_write_b128 v10, v[252:255] offset:28672
    s_cmp_eq_u32 s16, 4
    s_cbranch_scc1 h_layer
    s_cmp_eq_u32 s16, 7
    s_cbranch_scc1 z_layer
    s_branch l_layer
s_end:
    s_lshl_b32 s3, s2, 3
    s_add_u32 s3, s3, s16
    s_cmp_lg_u32 s3, 7
    s_cbranch_scc1 k_exit
    s_mov_b32 s8, s34
    s_mov_b32 s9, s35
    s_mov_b32 s10, 256
    s_mov_b32 s11, 0x00020000
    v_lshrrev_b32 v24, 2, v1
    v_mov_b32 v25, 0
    buffer_store_dword v25, v24, s[8:11], 0 offen sc1
    s_branch k_exit
s_slow:
    s_and_b32 s3, s16, 3
    s_lshl_b32 s44, s3, 11
    s_lshl_b32 s45, s52, 13
    s_add_u32 s44, s44, s45
    s_add_u32 s44, s44, 131072
    v_add_u32 v26, s44, v1
    ds_read_b128 v[48:51], v26 offset:0
    ds_read_b128 v[52:55], v26 offset:1024
    s_lshr_b32 s55, s21, 1
    s_lshl_b32 s55, s55, 23
    s_lshl_b32 s44, s18, 18
    s_add_u32 s55, s55, s44
    s_lshl_b32 s44, s52, 17
    s_add_u32 s55, s55, s44
    s_add_u32 s55, s55, 33554432
    s_waitcnt lgkmcnt(0)
    v_mov_b32 v26, 0xff800000
    s_mov_b32 s61, 0
s_slow1:
    s_add_u32 s44, s55, s61
    buffer_load_dwordx4 v[56:59], v1, s[4:7], s44 offen offset:0 sc1
    buffer_load_dwordx4 v[60:63], v1, s[4:7], s44 offen offset:1024 sc1
    s_waitcnt vmcnt(0)
    v_mfma_f32_32x32x16_bf16 v[72:87], v[56:59], v[48:51], 0
    v_mfma_f32_32x32x16_bf16 v[72:87], v[60:63], v[52:55], v[72:87]
    s_nop 11
    v_max3_f32 v26, v26, v72, v73
    v_max3_f32 v26, v26, v74, v75
    v_max3_f32 v26, v26, v76, v77
    v_max3_f32 v26, v26, v78, v79
    v_max3_f32 v26, v26, v80, v81
    v_max3_f32 v26, v26, v82, v83
    v_max3_f32 v26, v26, v84, v85
    v_max3_f32 v26, v26, v86, v87
    s_add_u32 s61, s61, 2048
    s_cmp_lt_u32 s61, 131072
    s_cbranch_scc1 s_slow1
    v_mov_b32 v27, v26
    s_nop 1
    v_permlane32_swap_b32 v26, v27
    v_max_f32 v26, v26, v27
    v_mov_b32 v32, 0
    v_mov_b32 v33, 0
    v_mov_b32 v34, 0
    v_mov_b32 v35, 0
    v_mov_b32 v36, 0
    v_mov_b32 v37, 0
    v_mov_b32 v38, 0
    v_mov_b32 v39, 0
    v_mov_b32 v40, 0
    v_mov_b32 v41, 0
    v_mov_b32 v42, 0
    v_mov_b32 v43, 0
    v_mov_b32 v44, 0
    v_mov_b32 v45, 0
    v_mov_b32 v46, 0
    v_mov_b32 v47, 0
    v_mov_b32 v28, 0
    v_mov_b32 v29, 0xdddddddd
    s_mov_b32 s3, 0xffff0000
    s_mov_b32 s61, 0
s_slow2:
    s_add_u32 s44, s55, s61
    buffer_load_dwordx4 v[56:59], v1, s[4:7], s44 offen offset:0 sc1
    buffer_load_dwordx4 v[60:63], v1, s[4:7], s44 offen offset:1024 sc1
    s_add_u32 s44, s44, 4194304
    buffer_load_dwordx4 v[64:67], v1, s[4:7], s44 offen offset:0 sc1
    buffer_load_dwordx4 v[68:71], v1, s[4:7], s44 offen offset:1024 sc1
    s_waitcnt vmcnt(0)
    v_mfma_f32_32x32x16_bf16 v[72:87], v[56:59], v[48:51], 0
    v_mfma_f32_32x32x16_bf16 v[72:87], v[60:63], v[52:55], v[72:87]
    s_nop 11
    v_sub_f32 v72, v72, v26
    v_sub_f32 v73, v73, v26
    v_sub_f32 v74, v74, v26
    v_sub_f32 v75, v75, v26
    v_sub_f32 v76, v76, v26
    v_sub_f32 v77, v77, v26
    v_sub_f32 v78, v78, v26
    v_sub_f32 v79, v79, v26
    v_sub_f32 v80, v80, v26
    v_sub_f32 v81, v81, v26
    v_sub_f32 v82, v82, v26
    v_sub_f32 v83, v83, v26
    v_sub_f32 v84, v84, v26
    v_sub_f32 v85, v85, v26
    v_sub_f32 v86, v86, v26
    v_sub_f32 v87, v87, v26
    v_exp_f32 v72, v72
    v_exp_f32 v73, v73
    v_exp_f32 v74, v74
    v_exp_f32 v75, v75
    v_exp_f32 v76, v76
    v_exp_f32 v77, v77
    v_exp_f32 v78, v78
    v_exp_f32 v79, v79
    v_exp_f32 v80, v80
    v_exp_f32 v81, v81
    v_exp_f32 v82, v82
    v_exp_f32 v83, v83
    v_exp_f32 v84, v84
    v_exp_f32 v85, v85
    v_exp_f32 v86, v86
    v_exp_f32 v87, v87
    v_and_b32 v72, s3, v72
    v_and_b32 v73, s3, v73
    v_and_b32 v74, s3, v74
    v_and_b32 v75, s3, v75
    v_and_b32 v76, s3, v76
    v_and_b32 v77, s3, v77
    v_and_b32 v78, s3, v78
    v_and_b32 v79, s3, v79
    v_and_b32 v80, s3, v80
    v_and_b32 v81, s3, v81
    v_and_b32 v82, s3, v82
    v_and_b32 v83, s3, v83
    v_and_b32 v84, s3, v84
    v_and_b32 v85, s3, v85
    v_and_b32 v86, s3, v86
    v_and_b32 v87, s3, v87
    v_add_f32 v28, v28, v72
    v_add_f32 v28, v28, v73
    v_add_f32 v28, v28, v74
    v_add_f32 v28, v28, v75
    v_add_f32 v28, v28, v76
    v_add_f32 v28, v28, v77
    v_add_f32 v28, v28, v78
    v_add_f32 v28, v28, v79
    v_add_f32 v28, v28, v80
    v_add_f32 v28, v28, v81
    v_add_f32 v28, v28, v82
    v_add_f32 v28, v28, v83
    v_add_f32 v28, v28, v84
    v_add_f32 v28, v28, v85
    v_add_f32 v28, v28, v86
    v_add_f32 v28, v28, v87
    v_smfmac_f32_32x32x32_bf16 v[32:47], v[64:67], v[72:79], v29
    v_smfmac_f32_32x32x32_bf16 v[32:47], v[68:71], v[80:87], v29
    s_add_u32 s61, s61, 2048
    s_cmp_lt_u32 s61, 131072
    s_cbranch_scc1 s_slow2
    v_mov_b32 v29, v28
    s_nop 1
    v_permlane32_swap_b32 v28, v29
    v_add_f32 v28, v28, v29
    v_rcp_f32 v28, v28
    s_nop 7
    s_branch s_fin
k_exit:
    s_endpgm
.if k_exit - interleave_layers__sliding_local_dilated__softmax_full_mha__prompt_kernel < 49152
.error "code prefetch reads past the end of the code"
.endif
.section .rodata,"a"
.p2align 6
.amdhsa_kernel interleave_layers__sliding_local_dilated__softmax_full_mha__prompt_kernel
  .amdhsa_next_free_vgpr 256
  .amdhsa_next_free_sgpr 102
  .amdhsa_accum_offset 256
  .amdhsa_group_segment_fixed_size 0
  .amdhsa_kernarg_size 72
  .amdhsa_user_sgpr_count 2
  .amdhsa_user_sgpr_kernarg_segment_ptr 1
  .amdhsa_system_sgpr_workgroup_id_x 1
.end_amdhsa_kernel
```

```asm
; @launch grid=(256,1,1) block=(512,1,1) lds=156736
.amdgcn_target "amdgcn-amd-amdhsa--gfx950"
.text
.globl interleave_layers__sliding_local_dilated__softmax_full_mha__prompt_kernel
.type interleave_layers__sliding_local_dilated__softmax_full_mha__prompt_kernel,@function
.p2align 8
interleave_layers__sliding_local_dilated__softmax_full_mha__prompt_kernel:
    s_cmp_ge_u32 s2, 256
    s_cbranch_scc1 k_exit
    s_load_dwordx2 s[36:37], s[0:1], 0
    s_load_dwordx4 s[24:27], s[0:1], 8
    s_load_dwordx8 s[28:35], s[0:1], 32
    s_load_dwordx2 s[44:45], s[0:1], 64
    v_lshrrev_b32 v2, 6, v0
    v_and_b32 v0, 63, v0
    v_readfirstlane_b32 s16, v2
    v_lshlrev_b32 v1, 4, v0
    s_mov_b32 s21, 0
    s_mov_b32 s40, 1
    s_and_b32 s3, s2, 1
    s_lshl_b32 s3, s3, 3
    s_bfe_u32 s17, s2, 0x30003
    s_add_u32 s17, s17, s3
    s_bfe_u32 s3, s2, 0x20001
    s_lshl_b32 s3, s3, 2
    s_lshr_b32 s18, s2, 6
    s_add_u32 s18, s18, s3
    s_and_b32 s3, s16, 3
    s_lshl_b32 s38, s17, 2
    s_add_u32 s38, s38, s3
    v_lshrrev_b32 v32, 3, v0
    v_and_b32 v33, 7, v0
    v_lshlrev_b32 v34, 11, v32
    v_lshl_add_u32 v34, v33, 4, v34
    s_lshl_b32 s46, s38, 16
    s_lshl_b32 s47, s18, 7
    s_add_u32 s46, s46, s47
    s_getpc_b64 s[76:77]
e_pc:
    s_sub_u32 s76, s76, e_pc - interleave_layers__sliding_local_dilated__softmax_full_mha__prompt_kernel
    s_subb_u32 s77, s77, 0
    s_and_b32 s3, s2, 0xf8
    s_add_u32 s3, s3, s16
    s_lshl_b32 s3, s3, 6
    s_add_u32 s78, s3, 49152
    s_min_u32 s78, s78, k_exit - interleave_layers__sliding_local_dilated__softmax_full_mha__prompt_kernel
    s_waitcnt lgkmcnt(0)
    s_mov_b32 s8, s36
    s_mov_b32 s9, s37
    s_mov_b32 s10, 4194304
    s_mov_b32 s11, 0x00020000
    s_cmp_gt_u32 s16, 3
    s_cbranch_scc1 e_side
    buffer_load_dwordx4 v[40:43], v34, s[8:11], s46 offen
    s_add_u32 s46, s46, 16384
    buffer_load_dwordx4 v[44:47], v34, s[8:11], s46 offen
    s_add_u32 s46, s46, 16384
    buffer_load_dwordx4 v[48:51], v34, s[8:11], s46 offen
    s_add_u32 s46, s46, 16384
    buffer_load_dwordx4 v[52:55], v34, s[8:11], s46 offen
e_side:
    s_load_dword s80, s[76:77], s3 offset:0
    s_load_dword s81, s[76:77], s3 offset:16384
    s_load_dword s82, s[76:77], s3 offset:32768
    s_load_dword s83, s[76:77], s78
    s_mov_b32 s4, s44
    s_mov_b32 s5, s45
    s_mov_b32 s6, 67108864
    s_mov_b32 s7, 0x00020000
    s_add_u32 s22, s44, 58720256
    s_addc_u32 s23, s45, 0
    s_load_dword s100, s[22:23], 217088
    s_cmp_gt_u32 s16, 3
    s_cbranch_scc1 s_start
    v_lshrrev_b32 v8, 4, v1
    s_lshl_b32 s44, s38, 16
    v_xor_b32 v88, v33, v32
    v_lshlrev_b32 v88, 4, v88
    v_lshl_add_u32 v88, v32, 11, v88
    v_xor_b32 v89, 16, v88
    v_add_u32 v89, 15360, v89
    v_add_u32 v90, 30720, v88
    v_add_u32 v91, 30720, v89
    s_mul_i32 s76, s16, 16384
    s_add_u32 s76, s76, 61440
    s_lshl_b32 s77, s38, 16
    s_mul_i32 s84, s18, 4096
    s_cmp_eq_u32 s18, 1
    s_cselect_b32 s85, 0, 4096
    s_cmp_eq_u32 s18, 2
    s_cselect_b32 s86, 0, 8192
    s_cmp_eq_u32 s18, 3
    s_cselect_b32 s87, 0, 12288
    s_cmp_eq_u32 s18, 4
    s_cselect_b32 s88, 0, 16384
    s_cmp_eq_u32 s18, 5
    s_cselect_b32 s89, 0, 20480
    s_cmp_eq_u32 s18, 6
    s_cselect_b32 s90, 0, 24576
    s_cmp_eq_u32 s18, 7
    s_cselect_b32 s91, 0, 28672
    s_cmp_eq_u32 s18, 8
    s_cselect_b32 s92, 0, 32768
    s_cmp_eq_u32 s18, 9
    s_cselect_b32 s93, 0, 36864
    s_cmp_eq_u32 s18, 10
    s_cselect_b32 s94, 0, 40960
    s_cmp_eq_u32 s18, 11
    s_cselect_b32 s95, 0, 45056
    s_cmp_eq_u32 s18, 12
    s_cselect_b32 s96, 0, 49152
    s_cmp_eq_u32 s18, 13
    s_cselect_b32 s97, 0, 53248
    s_cmp_eq_u32 s18, 14
    s_cselect_b32 s98, 0, 57344
    s_cmp_eq_u32 s18, 15
    s_cselect_b32 s99, 0, 61440
    v_lshrrev_b32 v12, 4, v1
    v_and_b32 v13, 15, v12
    v_bfe_u32 v14, v12, 4, 1
    v_lshrrev_b32 v12, 5, v12
    v_lshl_add_u32 v2, v14, 5, v13
    v_lshlrev_b32 v2, 4, v2
    v_lshl_add_u32 v2, v12, 10, v2
    v_lshrrev_b32 v15, 2, v13
    v_lshl_add_u32 v15, v14, 2, v15
    v_lshlrev_b32 v3, 7, v15
    v_lshl_add_u32 v3, v12, 11, v3
    v_and_b32 v15, 3, v13
    v_lshl_add_u32 v3, v15, 3, v3
    v_lshrrev_b32 v15, 3, v13
    v_lshl_add_u32 v15, v15, 1, v14
    v_lshl_add_u32 v3, v15, 5, v3
    v_xor_b32 v4, 32, v3
    v_xor_b32 v5, 64, v3
    v_xor_b32 v6, 96, v3
    s_lshl_b32 s45, s16, 12
    s_add_u32 s45, s45, 131072
    v_lshrrev_b32 v35, 1, v33
    v_lshlrev_b32 v35, 10, v35
    v_lshl_add_u32 v35, v32, 4, v35
    v_and_b32 v36, 1, v33
    v_lshl_add_u32 v35, v36, 3, v35
    v_add_u32 v35, s45, v35
    v_add_u32 v36, s45, v1
    v_mov_b32 v37, 0x3f803f80
    v_and_b32 v38, 3, v8
    v_lshl_add_u32 v39, v38, 3, v32
    v_lshlrev_b32 v39, 3, v39
    v_mov_b32 v56, 0
    v_mov_b32 v57, 0
    v_mov_b32 v58, 0
    v_mov_b32 v59, 0
    v_mov_b32 v60, 0
    v_mov_b32 v61, 0
    v_mov_b32 v62, 0
    v_mov_b32 v63, 0
    s_waitcnt vmcnt(3)
    ds_write_b64 v35, v[40:41] offset:0
    ds_write_b64 v35, v[42:43] offset:512
    s_waitcnt vmcnt(2)
    ds_write_b64 v35, v[44:45] offset:128
    ds_write_b64 v35, v[46:47] offset:640
    s_waitcnt vmcnt(1)
    ds_write_b64 v35, v[48:49] offset:256
    ds_write_b64 v35, v[50:51] offset:768
    s_waitcnt vmcnt(0)
    ds_write_b64 v35, v[52:53] offset:384
    ds_write_b64 v35, v[54:55] offset:896
    ds_read_b128 v[64:67], v36 offset:0
    ds_read_b128 v[68:71], v36 offset:1024
    ds_read_b128 v[72:75], v36 offset:2048
    ds_read_b128 v[76:79], v36 offset:3072
    s_lshl_b32 s45, s18, 12
    s_add_u32 s46, s44, s45
    s_waitcnt lgkmcnt(3)
    buffer_store_dwordx4 v[64:67], v1, s[4:7], s46 offen offset:0 sc1
    s_waitcnt lgkmcnt(2)
    buffer_store_dwordx4 v[68:71], v1, s[4:7], s46 offen offset:1024 sc1
    s_waitcnt lgkmcnt(1)
    buffer_store_dwordx4 v[72:75], v1, s[4:7], s46 offen offset:2048 sc1
    s_waitcnt lgkmcnt(0)
    buffer_store_dwordx4 v[76:79], v1, s[4:7], s46 offen offset:3072 sc1
    s_add_u32 m0, s76, 4096
    s_lshr_b32 s78, s85, 5
    s_add_u32 s78, s78, s77
    buffer_load_dwordx4 v88, s[8:11], s78 offen offset:0 lds
    buffer_load_dwordx4 v89, s[8:11], s78 offen offset:1024 lds
    buffer_load_dwordx4 v90, s[8:11], s78 offen offset:2048 lds
    buffer_load_dwordx4 v91, s[8:11], s78 offen offset:3072 lds
    s_add_u32 m0, s76, 8192
    s_lshr_b32 s78, s86, 5
    s_add_u32 s78, s78, s77
    buffer_load_dwordx4 v88, s[8:11], s78 offen offset:0 lds
    buffer_load_dwordx4 v89, s[8:11], s78 offen offset:1024 lds
    buffer_load_dwordx4 v90, s[8:11], s78 offen offset:2048 lds
    buffer_load_dwordx4 v91, s[8:11], s78 offen offset:3072 lds
    s_add_u32 m0, s76, 12288
    s_lshr_b32 s78, s87, 5
    s_add_u32 s78, s78, s77
    buffer_load_dwordx4 v88, s[8:11], s78 offen offset:0 lds
    buffer_load_dwordx4 v89, s[8:11], s78 offen offset:1024 lds
    buffer_load_dwordx4 v90, s[8:11], s78 offen offset:2048 lds
    buffer_load_dwordx4 v91, s[8:11], s78 offen offset:3072 lds
    s_add_u32 m0, s76, 16384
    s_lshr_b32 s78, s88, 5
    s_add_u32 s78, s78, s77
    buffer_load_dwordx4 v88, s[8:11], s78 offen offset:0 lds
    buffer_load_dwordx4 v89, s[8:11], s78 offen offset:1024 lds
    buffer_load_dwordx4 v90, s[8:11], s78 offen offset:2048 lds
    buffer_load_dwordx4 v91, s[8:11], s78 offen offset:3072 lds
    v_dot2_f32_bf16 v56, v40, v37, v56
    v_dot2_f32_bf16 v57, v40, v40, v57
    v_dot2_f32_bf16 v58, v44, v37, v58
    v_dot2_f32_bf16 v59, v44, v44, v59
    v_dot2_f32_bf16 v60, v48, v37, v60
    v_dot2_f32_bf16 v61, v48, v48, v61
    v_dot2_f32_bf16 v62, v52, v37, v62
    v_dot2_f32_bf16 v63, v52, v52, v63
    v_dot2_f32_bf16 v56, v41, v37, v56
    v_dot2_f32_bf16 v57, v41, v41, v57
    v_dot2_f32_bf16 v58, v45, v37, v58
    v_dot2_f32_bf16 v59, v45, v45, v59
    v_dot2_f32_bf16 v60, v49, v37, v60
    v_dot2_f32_bf16 v61, v49, v49, v61
    v_dot2_f32_bf16 v62, v53, v37, v62
    v_dot2_f32_bf16 v63, v53, v53, v63
    v_dot2_f32_bf16 v56, v42, v37, v56
    v_dot2_f32_bf16 v57, v42, v42, v57
    v_dot2_f32_bf16 v58, v46, v37, v58
    v_dot2_f32_bf16 v59, v46, v46, v59
    v_dot2_f32_bf16 v60, v50, v37, v60
    v_dot2_f32_bf16 v61, v50, v50, v61
    v_dot2_f32_bf16 v62, v54, v37, v62
    v_dot2_f32_bf16 v63, v54, v54, v63
    v_dot2_f32_bf16 v56, v43, v37, v56
    v_dot2_f32_bf16 v57, v43, v43, v57
    v_dot2_f32_bf16 v58, v47, v37, v58
    v_dot2_f32_bf16 v59, v47, v47, v59
    v_dot2_f32_bf16 v60, v51, v37, v60
    v_dot2_f32_bf16 v61, v51, v51, v61
    v_dot2_f32_bf16 v62, v55, v37, v62
    v_dot2_f32_bf16 v63, v55, v55, v63
    s_nop 2
    v_add_f32_dpp v56, v56, v56 quad_perm:[1,0,3,2] row_mask:0xf bank_mask:0xf
    v_add_f32_dpp v57, v57, v57 quad_perm:[1,0,3,2] row_mask:0xf bank_mask:0xf
    v_add_f32_dpp v58, v58, v58 quad_perm:[1,0,3,2] row_mask:0xf bank_mask:0xf
    v_add_f32_dpp v59, v59, v59 quad_perm:[1,0,3,2] row_mask:0xf bank_mask:0xf
    v_add_f32_dpp v60, v60, v60 quad_perm:[1,0,3,2] row_mask:0xf bank_mask:0xf
    v_add_f32_dpp v61, v61, v61 quad_perm:[1,0,3,2] row_mask:0xf bank_mask:0xf
    v_add_f32_dpp v62, v62, v62 quad_perm:[1,0,3,2] row_mask:0xf bank_mask:0xf
    v_add_f32_dpp v63, v63, v63 quad_perm:[1,0,3,2] row_mask:0xf bank_mask:0xf
    v_add_f32_dpp v56, v56, v56 quad_perm:[2,3,0,1] row_mask:0xf bank_mask:0xf
    v_add_f32_dpp v57, v57, v57 quad_perm:[2,3,0,1] row_mask:0xf bank_mask:0xf
    v_add_f32_dpp v58, v58, v58 quad_perm:[2,3,0,1] row_mask:0xf bank_mask:0xf
    v_add_f32_dpp v59, v59, v59 quad_perm:[2,3,0,1] row_mask:0xf bank_mask:0xf
    v_add_f32_dpp v60, v60, v60 quad_perm:[2,3,0,1] row_mask:0xf bank_mask:0xf
    v_add_f32_dpp v61, v61, v61 quad_perm:[2,3,0,1] row_mask:0xf bank_mask:0xf
    v_add_f32_dpp v62, v62, v62 quad_perm:[2,3,0,1] row_mask:0xf bank_mask:0xf
    v_add_f32_dpp v63, v63, v63 quad_perm:[2,3,0,1] row_mask:0xf bank_mask:0xf
    v_add_f32_dpp v56, v56, v56 row_half_mirror row_mask:0xf bank_mask:0xf
    v_add_f32_dpp v57, v57, v57 row_half_mirror row_mask:0xf bank_mask:0xf
    v_add_f32_dpp v58, v58, v58 row_half_mirror row_mask:0xf bank_mask:0xf
    v_add_f32_dpp v59, v59, v59 row_half_mirror row_mask:0xf bank_mask:0xf
    v_add_f32_dpp v60, v60, v60 row_half_mirror row_mask:0xf bank_mask:0xf
    v_add_f32_dpp v61, v61, v61 row_half_mirror row_mask:0xf bank_mask:0xf
    v_add_f32_dpp v62, v62, v62 row_half_mirror row_mask:0xf bank_mask:0xf
    v_add_f32_dpp v63, v63, v63 row_half_mirror row_mask:0xf bank_mask:0xf
    v_cmp_eq_u32 vcc, 1, v38
    s_nop 1
    v_cndmask_b32 v56, v56, v58, vcc
    v_cndmask_b32 v57, v57, v59, vcc
    v_cmp_eq_u32 vcc, 2, v38
    s_nop 1
    v_cndmask_b32 v56, v56, v60, vcc
    v_cndmask_b32 v57, v57, v61, vcc
    v_cmp_eq_u32 vcc, 3, v38
    s_nop 1
    v_cndmask_b32 v56, v56, v62, vcc
    v_cndmask_b32 v57, v57, v63, vcc
    s_lshl_b32 s44, s21, 18
    s_lshl_b32 s45, s38, 12
    s_add_u32 s44, s44, s45
    s_lshl_b32 s45, s18, 8
    s_add_u32 s44, s44, s45
    s_add_u32 s44, s44, 50331648
    buffer_store_dwordx2 v[56:57], v39, s[4:7], s44 offen sc1
    s_lshl_b32 s46, s21, 14
    s_lshl_b32 s67, s38, 7
    s_add_u32 s46, s46, s67
    s_add_u32 s46, s46, 4096
    s_add_u32 s47, s46, 8192
    s_lshl_b32 s48, s21, 22
    s_lshl_b32 s49, s38, 16
    s_add_u32 s41, s48, s49
    s_lshl_b32 s48, s21, 14
    s_lshl_b32 s67, s38, 7
    s_add_u32 s48, s48, s67
    s_add_u32 s48, s48, 4096
    v_lshrrev_b32 v16, 4, v1
    v_and_b32 v17, 15, v16
    v_lshrrev_b32 v16, 4, v16
    s_lshl_b32 s49, s16, 7
    s_add_u32 s50, s49, 151552
    s_and_b32 s49, s21, 1
    s_lshl_b32 s49, s49, 10
    s_add_u32 s49, s49, 151552
    v_lshlrev_b32 v11, 4, v16
    v_add_u32 v13, s50, v11
    v_add_u32 v11, s49, v11
    v_lshlrev_b32 v15, 2, v17
    v_add_u32 v9, s50, v15
    v_add_u32 v15, s49, v15
    s_lshr_b32 s49, s21, 1
    s_lshl_b32 s53, s49, 23
    s_lshl_b32 s50, s18, 18
    s_add_u32 s53, s53, s50
    s_add_u32 s53, s53, 33554432
    s_lshl_b32 s54, s38, 11
    s_add_u32 s52, s53, s54
    s_lshl_b32 s59, s49, 13
    s_lshl_b32 s67, s18, 9
    s_add_u32 s59, s59, s67
    s_lshl_b32 s67, s16, 7
    s_add_u32 s59, s59, s67
    s_add_u32 s59, s59, 69632
    s_lshl_b32 s61, s49, 15
    s_lshl_b32 s67, s17, 11
    s_add_u32 s61, s61, s67
    s_lshl_b32 s67, s18, 7
    s_add_u32 s61, s61, s67
    s_add_u32 s61, s61, 151552
    s_sub_u32 s60, s61, 151552
    s_lshl_b32 s60, s60, 5
    s_add_u32 s60, s60, 54525952
    s_lshl_b32 s62, s16, 12
    s_add_u32 s62, s62, 131072
    v_bfe_u32 v80, v8, 3, 1
    v_and_b32 v81, 7, v8
    v_lshrrev_b32 v82, 5, v8
    v_lshlrev_b32 v82, 1, v82
    v_xor_b32 v82, v82, v81
    v_xor_b32 v82, v82, v80
    v_lshlrev_b32 v82, 4, v82
    v_lshl_add_u32 v82, v81, 7, v82
    v_lshl_add_u32 v82, v80, 10, v82
    v_bfe_u32 v80, v8, 4, 1
    v_lshl_add_u32 v82, v80, 3, v82
    v_add_u32 v20, s76, v82
    v_xor_b32 v21, 16, v20
    v_xor_b32 v22, 64, v20
    v_xor_b32 v23, 80, v20
    v_add_u32 v80, s62, v2
    ds_read_b128 v[160:163], v80 offset:0
    ds_read_b128 v[164:167], v80 offset:256
    ds_read_b128 v[168:171], v80 offset:2048
    ds_read_b128 v[172:175], v80 offset:2304
    s_mov_b64 vcc, -1
    s_barrier
    ds_read_b64_tr_b16 v[32:33], v3 offset:0
    ds_read_b64_tr_b16 v[34:35], v3 offset:1024
    ds_read_b64_tr_b16 v[36:37], v4 offset:0
    ds_read_b64_tr_b16 v[38:39], v4 offset:1024
    ds_read_b64_tr_b16 v[40:41], v5 offset:0
    ds_read_b64_tr_b16 v[42:43], v5 offset:1024
    ds_read_b64_tr_b16 v[44:45], v6 offset:0
    ds_read_b64_tr_b16 v[46:47], v6 offset:1024
    ds_read_b64_tr_b16 v[48:49], v3 offset:4096
    ds_read_b64_tr_b16 v[50:51], v3 offset:5120
    ds_read_b64_tr_b16 v[52:53], v4 offset:4096
    ds_read_b64_tr_b16 v[54:55], v4 offset:5120
    ds_read_b64_tr_b16 v[56:57], v5 offset:4096
    ds_read_b64_tr_b16 v[58:59], v5 offset:5120
    s_branch c_g0
c_st1:
    s_waitcnt vmcnt(1)
    ds_read_b64 v[176:177], v20 offset:4096
    ds_read_b64 v[178:179], v21 offset:4096
    ds_read_b64 v[180:181], v20 offset:6144
    ds_read_b64 v[182:183], v21 offset:6144
    ds_read_b64 v[184:185], v22 offset:4096
    ds_read_b64 v[186:187], v23 offset:4096
    ds_read_b64 v[188:189], v22 offset:6144
    ds_read_b64 v[190:191], v23 offset:6144
    ds_read_b64 v[192:193], v20 offset:8192
    ds_read_b64 v[194:195], v21 offset:8192
    ds_read_b64 v[196:197], v20 offset:10240
    ds_read_b64 v[198:199], v21 offset:10240
    ds_read_b64 v[200:201], v22 offset:8192
    ds_read_b64 v[202:203], v23 offset:8192
    ds_read_b64 v[204:205], v22 offset:10240
    ds_read_b64 v[206:207], v23 offset:10240
    ds_read_b64 v[208:209], v20 offset:12288
    ds_read_b64 v[210:211], v21 offset:12288
    ds_read_b64 v[212:213], v20 offset:14336
    ds_read_b64 v[214:215], v21 offset:14336
    ds_read_b64 v[216:217], v22 offset:12288
    ds_read_b64 v[218:219], v23 offset:12288
    ds_read_b64 v[220:221], v22 offset:14336
    ds_read_b64 v[222:223], v23 offset:14336
    ds_read_b64 v[224:225], v20 offset:16384
    ds_read_b64 v[226:227], v21 offset:16384
    ds_read_b64 v[228:229], v20 offset:18432
    ds_read_b64 v[230:231], v21 offset:18432
    ds_read_b64 v[232:233], v22 offset:16384
    ds_read_b64 v[234:235], v23 offset:16384
    ds_read_b64 v[236:237], v22 offset:18432
    ds_read_b64 v[238:239], v23 offset:18432
    s_load_dword s68, s[34:35], 0
    s_mov_b32 s8, s34
    s_mov_b32 s9, s35
    s_mov_b32 s10, 256
    s_mov_b32 s11, 0x00020000
    s_mov_b32 s66, 0x10000
    v_mov_b32 v16, 0
    s_waitcnt lgkmcnt(0)
c_f0:
    s_cmp_eq_u32 s68, 10
    s_cbranch_scc1 c_f0_ok
    buffer_load_dword v17, v16, s[8:11], 0 offen offset:0 sc1
    s_waitcnt vmcnt(0)
    v_readfirstlane_b32 s68, v17
    s_sub_u32 s66, s66, 1
    s_cmp_lg_u32 s66, 0
    s_cbranch_scc1 c_f0
c_f0_ok:
    s_atomic_add s40, s[22:23], s46
    s_branch c_st2
c_cs1:
    s_waitcnt vmcnt(0)
    s_atomic_add s40, s[22:23], s47
    s_branch c_cs2
c_layer:
    s_lshl_b32 s48, s21, 22
    s_lshl_b32 s49, s38, 16
    s_add_u32 s41, s48, s49
    s_lshl_b32 s48, s21, 14
    s_lshl_b32 s67, s38, 7
    s_add_u32 s48, s48, s67
    s_add_u32 s48, s48, 4096
    v_lshrrev_b32 v16, 4, v1
    v_and_b32 v17, 15, v16
    v_lshrrev_b32 v16, 4, v16
    s_lshl_b32 s49, s16, 7
    s_add_u32 s50, s49, 151552
    s_and_b32 s49, s21, 1
    s_lshl_b32 s49, s49, 10
    s_add_u32 s49, s49, 151552
    v_lshlrev_b32 v11, 4, v16
    v_add_u32 v13, s50, v11
    v_add_u32 v11, s49, v11
    v_lshlrev_b32 v15, 2, v17
    v_add_u32 v9, s50, v15
    v_add_u32 v15, s49, v15
    s_lshr_b32 s49, s21, 1
    s_lshl_b32 s53, s49, 23
    s_lshl_b32 s50, s18, 18
    s_add_u32 s53, s53, s50
    s_add_u32 s53, s53, 33554432
    s_lshl_b32 s54, s38, 11
    s_add_u32 s52, s53, s54
    s_lshl_b32 s59, s49, 13
    s_lshl_b32 s67, s18, 9
    s_add_u32 s59, s59, s67
    s_lshl_b32 s67, s16, 7
    s_add_u32 s59, s59, s67
    s_add_u32 s59, s59, 69632
    s_lshl_b32 s61, s49, 15
    s_lshl_b32 s67, s17, 11
    s_add_u32 s61, s61, s67
    s_lshl_b32 s67, s18, 7
    s_add_u32 s61, s61, s67
    s_add_u32 s61, s61, 151552
    s_sub_u32 s60, s61, 151552
    s_lshl_b32 s60, s60, 5
    s_add_u32 s60, s60, 54525952
    s_lshl_b32 s62, s16, 12
    s_add_u32 s62, s62, 131072
    s_mov_b32 s68, 0
    s_atomic_add s68, s[22:23], s48 glc
    s_mov_b64 vcc, 0
    s_barrier
    ds_read_b64_tr_b16 v[32:33], v3 offset:0
    ds_read_b64_tr_b16 v[34:35], v3 offset:1024
    ds_read_b64_tr_b16 v[36:37], v4 offset:0
    ds_read_b64_tr_b16 v[38:39], v4 offset:1024
    ds_read_b64_tr_b16 v[40:41], v5 offset:0
    ds_read_b64_tr_b16 v[42:43], v5 offset:1024
    ds_read_b64_tr_b16 v[44:45], v6 offset:0
    ds_read_b64_tr_b16 v[46:47], v6 offset:1024
    ds_read_b64_tr_b16 v[48:49], v3 offset:4096
    ds_read_b64_tr_b16 v[50:51], v3 offset:5120
    ds_read_b64_tr_b16 v[52:53], v4 offset:4096
    ds_read_b64_tr_b16 v[54:55], v4 offset:5120
    ds_read_b64_tr_b16 v[56:57], v5 offset:4096
    ds_read_b64_tr_b16 v[58:59], v5 offset:5120
c_g0:
    s_waitcnt lgkmcnt(10)
    v_mfma_f32_16x16x32_bf16 v[64:67], v[32:35], v[160:163], 0
    ds_read_b64_tr_b16 v[60:61], v6 offset:4096
    v_mfma_f32_16x16x32_bf16 v[68:71], v[32:35], v[164:167], 0
    ds_read_b64_tr_b16 v[62:63], v6 offset:5120
    v_mfma_f32_16x16x32_bf16 v[72:75], v[36:39], v[160:163], 0
    ds_read_b64_tr_b16 v[32:33], v3 offset:8192
    v_mfma_f32_16x16x32_bf16 v[76:79], v[36:39], v[164:167], 0
    ds_read_b64_tr_b16 v[34:35], v3 offset:9216
    s_waitcnt lgkmcnt(10)
    v_mfma_f32_16x16x32_bf16 v[80:83], v[40:43], v[160:163], 0
    ds_read_b64_tr_b16 v[36:37], v4 offset:8192
    v_mfma_f32_16x16x32_bf16 v[84:87], v[40:43], v[164:167], 0
    ds_read_b64_tr_b16 v[38:39], v4 offset:9216
    v_mfma_f32_16x16x32_bf16 v[88:91], v[44:47], v[160:163], 0
    ds_read_b64_tr_b16 v[40:41], v5 offset:8192
    v_mfma_f32_16x16x32_bf16 v[92:95], v[44:47], v[164:167], 0
    ds_read_b64_tr_b16 v[42:43], v5 offset:9216
    s_waitcnt lgkmcnt(10)
    v_mfma_f32_16x16x32_bf16 v[96:99], v[160:163], v[48:51], 0
    ds_read_b64_tr_b16 v[44:45], v6 offset:8192
    v_mfma_f32_16x16x32_bf16 v[100:103], v[164:167], v[48:51], 0
    ds_read_b64_tr_b16 v[46:47], v6 offset:9216
    v_mfma_f32_16x16x32_bf16 v[104:107], v[160:163], v[52:55], 0
    ds_read_b64_tr_b16 v[48:49], v3 offset:12288
    v_mfma_f32_16x16x32_bf16 v[108:111], v[164:167], v[52:55], 0
    ds_read_b64_tr_b16 v[50:51], v3 offset:13312
    s_waitcnt lgkmcnt(10)
    v_mfma_f32_16x16x32_bf16 v[112:115], v[160:163], v[56:59], 0
    ds_read_b64_tr_b16 v[52:53], v4 offset:12288
    v_mfma_f32_16x16x32_bf16 v[116:119], v[164:167], v[56:59], 0
    ds_read_b64_tr_b16 v[54:55], v4 offset:13312
    v_mfma_f32_16x16x32_bf16 v[120:123], v[160:163], v[60:63], 0
    ds_read_b64_tr_b16 v[56:57], v5 offset:12288
    v_mfma_f32_16x16x32_bf16 v[124:127], v[164:167], v[60:63], 0
    ds_read_b64_tr_b16 v[58:59], v5 offset:13312
    s_cbranch_vccnz c_gate
    s_mov_b32 s66, 0x10000
    s_waitcnt lgkmcnt(0)
    s_cmp_eq_u32 s68, 16
    s_cbranch_scc1 c_x_ok
c_x_poll:
    s_mov_b32 s68, 0
    s_atomic_add s68, s[22:23], s48 offset:0 glc
    s_sub_u32 s66, s66, 1
    s_cselect_b32 s67, 16, 0
    s_waitcnt lgkmcnt(0)
    s_max_u32 s68, s68, s67
    s_cmp_lt_u32 s68, 16
    s_cbranch_scc1 c_x_poll
c_x_ok:
    s_add_u32 s42, s41, s85
    buffer_load_dwordx4 v[176:179], v2, s[4:7], s42 offen offset:0 sc1
    buffer_load_dwordx4 v[180:183], v2, s[4:7], s42 offen offset:256 sc1
    buffer_load_dwordx4 v[184:187], v2, s[4:7], s42 offen offset:2048 sc1
    buffer_load_dwordx4 v[188:191], v2, s[4:7], s42 offen offset:2304 sc1
    s_add_u32 s42, s41, s86
    buffer_load_dwordx4 v[192:195], v2, s[4:7], s42 offen offset:0 sc1
    buffer_load_dwordx4 v[196:199], v2, s[4:7], s42 offen offset:256 sc1
    buffer_load_dwordx4 v[200:203], v2, s[4:7], s42 offen offset:2048 sc1
    buffer_load_dwordx4 v[204:207], v2, s[4:7], s42 offen offset:2304 sc1
    s_add_u32 s42, s41, s87
    buffer_load_dwordx4 v[208:211], v2, s[4:7], s42 offen offset:0 sc1
    buffer_load_dwordx4 v[212:215], v2, s[4:7], s42 offen offset:256 sc1
    s_waitcnt vmcnt(10)
    s_atomic_add s40, s[22:23], s47
c_gate:
    s_waitcnt lgkmcnt(10)
    v_mfma_f32_16x16x32_bf16 v[128:131], v[32:35], v[160:163], 0
    ds_read_b64_tr_b16 v[60:61], v6 offset:12288
    v_mfma_f32_16x16x32_bf16 v[132:135], v[32:35], v[164:167], 0
    ds_read_b64_tr_b16 v[62:63], v6 offset:13312
    v_mfma_f32_16x16x32_bf16 v[136:139], v[36:39], v[160:163], 0
    ds_read_b64_tr_b16 v[32:33], v3 offset:16384
    v_mfma_f32_16x16x32_bf16 v[140:143], v[36:39], v[164:167], 0
    ds_read_b64_tr_b16 v[34:35], v3 offset:17408
    s_waitcnt lgkmcnt(10)
    v_mfma_f32_16x16x32_bf16 v[144:147], v[40:43], v[160:163], 0
    ds_read_b64_tr_b16 v[36:37], v4 offset:16384
    v_mfma_f32_16x16x32_bf16 v[148:151], v[40:43], v[164:167], 0
    ds_read_b64_tr_b16 v[38:39], v4 offset:17408
    v_mfma_f32_16x16x32_bf16 v[152:155], v[44:47], v[160:163], 0
    ds_read_b64_tr_b16 v[40:41], v5 offset:16384
    v_mfma_f32_16x16x32_bf16 v[156:159], v[44:47], v[164:167], 0
    ds_read_b64_tr_b16 v[42:43], v5 offset:17408
    s_waitcnt lgkmcnt(10)
    v_mfma_f32_16x16x32_bf16 v[64:67], v[48:51], v[168:171], v[64:67]
    ds_read_b64_tr_b16 v[44:45], v6 offset:16384
    v_mfma_f32_16x16x32_bf16 v[68:71], v[48:51], v[172:175], v[68:71]
    ds_read_b64_tr_b16 v[46:47], v6 offset:17408
    v_mfma_f32_16x16x32_bf16 v[72:75], v[52:55], v[168:171], v[72:75]
    ds_read_b64_tr_b16 v[48:49], v3 offset:20480
    v_mfma_f32_16x16x32_bf16 v[76:79], v[52:55], v[172:175], v[76:79]
    ds_read_b64_tr_b16 v[50:51], v3 offset:21504
    s_waitcnt lgkmcnt(10)
    v_mfma_f32_16x16x32_bf16 v[80:83], v[56:59], v[168:171], v[80:83]
    ds_read_b64_tr_b16 v[52:53], v4 offset:20480
    v_mfma_f32_16x16x32_bf16 v[84:87], v[56:59], v[172:175], v[84:87]
    ds_read_b64_tr_b16 v[54:55], v4 offset:21504
    v_mfma_f32_16x16x32_bf16 v[88:91], v[60:63], v[168:171], v[88:91]
    ds_read_b64_tr_b16 v[56:57], v5 offset:20480
    v_mfma_f32_16x16x32_bf16 v[92:95], v[60:63], v[172:175], v[92:95]
    ds_read_b64_tr_b16 v[58:59], v5 offset:21504
    s_waitcnt lgkmcnt(10)
    v_mfma_f32_16x16x32_bf16 v[96:99], v[168:171], v[32:35], v[96:99]
    ds_read_b64_tr_b16 v[60:61], v6 offset:20480
    v_mfma_f32_16x16x32_bf16 v[100:103], v[172:175], v[32:35], v[100:103]
    ds_read_b64_tr_b16 v[62:63], v6 offset:21504
    v_mfma_f32_16x16x32_bf16 v[104:107], v[168:171], v[36:39], v[104:107]
    ds_read_b64_tr_b16 v[32:33], v3 offset:24576
    v_mfma_f32_16x16x32_bf16 v[108:111], v[172:175], v[36:39], v[108:111]
    ds_read_b64_tr_b16 v[34:35], v3 offset:25600
    s_waitcnt lgkmcnt(10)
    v_mfma_f32_16x16x32_bf16 v[112:115], v[168:171], v[40:43], v[112:115]
    ds_read_b64_tr_b16 v[36:37], v4 offset:24576
    v_mfma_f32_16x16x32_bf16 v[116:119], v[172:175], v[40:43], v[116:119]
    ds_read_b64_tr_b16 v[38:39], v4 offset:25600
    v_mfma_f32_16x16x32_bf16 v[120:123], v[168:171], v[44:47], v[120:123]
    ds_read_b64_tr_b16 v[40:41], v5 offset:24576
    v_mfma_f32_16x16x32_bf16 v[124:127], v[172:175], v[44:47], v[124:127]
    ds_read_b64_tr_b16 v[42:43], v5 offset:25600
    s_waitcnt lgkmcnt(10)
    v_mfma_f32_16x16x32_bf16 v[128:131], v[48:51], v[168:171], v[128:131]
    ds_read_b64_tr_b16 v[44:45], v6 offset:24576
    v_mfma_f32_16x16x32_bf16 v[132:135], v[48:51], v[172:175], v[132:135]
    ds_read_b64_tr_b16 v[46:47], v6 offset:25600
    v_mfma_f32_16x16x32_bf16 v[136:139], v[52:55], v[168:171], v[136:139]
    ds_read_b64_tr_b16 v[48:49], v3 offset:28672
    v_mfma_f32_16x16x32_bf16 v[140:143], v[52:55], v[172:175], v[140:143]
    ds_read_b64_tr_b16 v[50:51], v3 offset:29696
    s_waitcnt lgkmcnt(10)
    v_mfma_f32_16x16x32_bf16 v[144:147], v[56:59], v[168:171], v[144:147]
    ds_read_b64_tr_b16 v[52:53], v4 offset:28672
    v_mfma_f32_16x16x32_bf16 v[148:151], v[56:59], v[172:175], v[148:151]
    ds_read_b64_tr_b16 v[54:55], v4 offset:29696
    v_mfma_f32_16x16x32_bf16 v[152:155], v[60:63], v[168:171], v[152:155]
    ds_read_b64_tr_b16 v[56:57], v5 offset:28672
    v_mfma_f32_16x16x32_bf16 v[156:159], v[60:63], v[172:175], v[156:159]
    ds_read_b64_tr_b16 v[58:59], v5 offset:29696
    s_cbranch_vccnz c_st1
c_st2:
    s_waitcnt vmcnt(8) lgkmcnt(10)
    v_mfma_f32_16x16x32_bf16 v[64:67], v[32:35], v[176:179], v[64:67]
    ds_read_b64_tr_b16 v[60:61], v6 offset:28672
    v_mfma_f32_16x16x32_bf16 v[68:71], v[32:35], v[180:183], v[68:71]
    ds_read_b64_tr_b16 v[62:63], v6 offset:29696
    s_barrier
    v_mfma_f32_16x16x32_bf16 v[72:75], v[36:39], v[176:179], v[72:75]
    ds_read_b64_tr_b16 v[32:33], v3 offset:32768
    v_mfma_f32_16x16x32_bf16 v[76:79], v[36:39], v[180:183], v[76:79]
    ds_read_b64_tr_b16 v[34:35], v3 offset:33792
    s_waitcnt lgkmcnt(10)
    v_mfma_f32_16x16x32_bf16 v[80:83], v[40:43], v[176:179], v[80:83]
    ds_read_b64_tr_b16 v[36:37], v4 offset:32768
    v_mfma_f32_16x16x32_bf16 v[84:87], v[40:43], v[180:183], v[84:87]
    ds_read_b64_tr_b16 v[38:39], v4 offset:33792
    v_mfma_f32_16x16x32_bf16 v[88:91], v[44:47], v[176:179], v[88:91]
    ds_read_b64_tr_b16 v[40:41], v5 offset:32768
    v_mfma_f32_16x16x32_bf16 v[92:95], v[44:47], v[180:183], v[92:95]
    ds_read_b64_tr_b16 v[42:43], v5 offset:33792
    s_waitcnt lgkmcnt(10)
    v_mfma_f32_16x16x32_bf16 v[96:99], v[176:179], v[48:51], v[96:99]
    ds_read_b64_tr_b16 v[44:45], v6 offset:32768
    v_mfma_f32_16x16x32_bf16 v[100:103], v[180:183], v[48:51], v[100:103]
    ds_read_b64_tr_b16 v[46:47], v6 offset:33792
    v_mfma_f32_16x16x32_bf16 v[104:107], v[176:179], v[52:55], v[104:107]
    ds_read_b64_tr_b16 v[48:49], v3 offset:36864
    v_mfma_f32_16x16x32_bf16 v[108:111], v[180:183], v[52:55], v[108:111]
    ds_read_b64_tr_b16 v[50:51], v3 offset:37888
    s_waitcnt lgkmcnt(10)
    v_mfma_f32_16x16x32_bf16 v[112:115], v[176:179], v[56:59], v[112:115]
    ds_read_b64_tr_b16 v[52:53], v4 offset:36864
    v_mfma_f32_16x16x32_bf16 v[116:119], v[180:183], v[56:59], v[116:119]
    ds_read_b64_tr_b16 v[54:55], v4 offset:37888
    v_mfma_f32_16x16x32_bf16 v[120:123], v[176:179], v[60:63], v[120:123]
    ds_read_b64_tr_b16 v[56:57], v5 offset:36864
    v_mfma_f32_16x16x32_bf16 v[124:127], v[180:183], v[60:63], v[124:127]
    ds_read_b64_tr_b16 v[58:59], v5 offset:37888
    s_waitcnt lgkmcnt(10)
    v_mfma_f32_16x16x32_bf16 v[128:131], v[32:35], v[176:179], v[128:131]
    ds_read_b64_tr_b16 v[60:61], v6 offset:36864
    v_mfma_f32_16x16x32_bf16 v[132:135], v[32:35], v[180:183], v[132:135]
    ds_read_b64_tr_b16 v[62:63], v6 offset:37888
    v_mfma_f32_16x16x32_bf16 v[136:139], v[36:39], v[176:179], v[136:139]
    ds_read_b64_tr_b16 v[32:33], v3 offset:40960
    v_mfma_f32_16x16x32_bf16 v[140:143], v[36:39], v[180:183], v[140:143]
    ds_read_b64_tr_b16 v[34:35], v3 offset:41984
    s_waitcnt lgkmcnt(10)
    v_mfma_f32_16x16x32_bf16 v[144:147], v[40:43], v[176:179], v[144:147]
    ds_read_b64_tr_b16 v[36:37], v4 offset:40960
    v_mfma_f32_16x16x32_bf16 v[148:151], v[40:43], v[180:183], v[148:151]
    ds_read_b64_tr_b16 v[38:39], v4 offset:41984
    v_mfma_f32_16x16x32_bf16 v[152:155], v[44:47], v[176:179], v[152:155]
    ds_read_b64_tr_b16 v[40:41], v5 offset:40960
    v_mfma_f32_16x16x32_bf16 v[156:159], v[44:47], v[180:183], v[156:159]
    ds_read_b64_tr_b16 v[42:43], v5 offset:41984
    s_waitcnt vmcnt(6) lgkmcnt(10)
    v_mfma_f32_16x16x32_bf16 v[64:67], v[48:51], v[184:187], v[64:67]
    s_add_u32 s42, s41, s87
    s_cbranch_vccnz xs1
    buffer_load_dwordx4 v[216:219], v2, s[4:7], s42 offen offset:2048 sc1
xs1:
    ds_read_b64_tr_b16 v[44:45], v6 offset:40960
    v_mfma_f32_16x16x32_bf16 v[68:71], v[48:51], v[188:191], v[68:71]
    ds_read_b64_tr_b16 v[46:47], v6 offset:41984
    v_mfma_f32_16x16x32_bf16 v[72:75], v[52:55], v[184:187], v[72:75]
    s_cbranch_vccnz xs2
    buffer_load_dwordx4 v[220:223], v2, s[4:7], s42 offen offset:2304 sc1
xs2:
    ds_read_b64_tr_b16 v[48:49], v3 offset:45056
    s_add_u32 s42, s41, s88
    v_mfma_f32_16x16x32_bf16 v[76:79], v[52:55], v[188:191], v[76:79]
    ds_read_b64_tr_b16 v[50:51], v3 offset:46080
    s_waitcnt lgkmcnt(10)
    v_mfma_f32_16x16x32_bf16 v[80:83], v[56:59], v[184:187], v[80:83]
    s_cbranch_vccnz xs3
    buffer_load_dwordx4 v[224:227], v2, s[4:7], s42 offen offset:0 sc1
xs3:
    ds_read_b64_tr_b16 v[52:53], v4 offset:45056
    v_mfma_f32_16x16x32_bf16 v[84:87], v[56:59], v[188:191], v[84:87]
    ds_read_b64_tr_b16 v[54:55], v4 offset:46080
    v_mfma_f32_16x16x32_bf16 v[88:91], v[60:63], v[184:187], v[88:91]
    s_cbranch_vccnz xs4
    buffer_load_dwordx4 v[228:231], v2, s[4:7], s42 offen offset:256 sc1
xs4:
    ds_read_b64_tr_b16 v[56:57], v5 offset:45056
    v_mfma_f32_16x16x32_bf16 v[92:95], v[60:63], v[188:191], v[92:95]
    ds_read_b64_tr_b16 v[58:59], v5 offset:46080
    s_waitcnt lgkmcnt(10)
    v_mfma_f32_16x16x32_bf16 v[96:99], v[184:187], v[32:35], v[96:99]
    ds_read_b64_tr_b16 v[60:61], v6 offset:45056
    s_cbranch_vccnz xs5
    buffer_load_dwordx4 v[232:235], v2, s[4:7], s42 offen offset:2048 sc1
xs5:
    s_cbranch_vccnz c_cs1
c_cs2:
    v_mfma_f32_16x16x32_bf16 v[100:103], v[188:191], v[32:35], v[100:103]
    ds_read_b64_tr_b16 v[62:63], v6 offset:46080
    v_mfma_f32_16x16x32_bf16 v[104:107], v[184:187], v[36:39], v[104:107]
    s_cbranch_vccnz xs6
    buffer_load_dwordx4 v[236:239], v2, s[4:7], s42 offen offset:2304 sc1
xs6:
    ds_read_b64_tr_b16 v[32:33], v3 offset:49152
    s_add_u32 s42, s41, s89
    v_mfma_f32_16x16x32_bf16 v[108:111], v[188:191], v[36:39], v[108:111]
    ds_read_b64_tr_b16 v[34:35], v3 offset:50176
    s_waitcnt lgkmcnt(10)
    v_mfma_f32_16x16x32_bf16 v[112:115], v[184:187], v[40:43], v[112:115]
    ds_read_b64_tr_b16 v[36:37], v4 offset:49152
    v_mfma_f32_16x16x32_bf16 v[116:119], v[188:191], v[40:43], v[116:119]
    ds_read_b64_tr_b16 v[38:39], v4 offset:50176
    v_mfma_f32_16x16x32_bf16 v[120:123], v[184:187], v[44:47], v[120:123]
    ds_read_b64_tr_b16 v[40:41], v5 offset:49152
    v_mfma_f32_16x16x32_bf16 v[124:127], v[188:191], v[44:47], v[124:127]
    ds_read_b64_tr_b16 v[42:43], v5 offset:50176
    s_waitcnt lgkmcnt(10)
    v_mfma_f32_16x16x32_bf16 v[128:131], v[48:51], v[184:187], v[128:131]
    ds_read_b64_tr_b16 v[44:45], v6 offset:49152
    v_mfma_f32_16x16x32_bf16 v[132:135], v[48:51], v[188:191], v[132:135]
    ds_read_b64_tr_b16 v[46:47], v6 offset:50176
    v_mfma_f32_16x16x32_bf16 v[136:139], v[52:55], v[184:187], v[136:139]
    ds_read_b64_tr_b16 v[48:49], v3 offset:53248
    v_mfma_f32_16x16x32_bf16 v[140:143], v[52:55], v[188:191], v[140:143]
    ds_read_b64_tr_b16 v[50:51], v3 offset:54272
    s_waitcnt lgkmcnt(10)
    v_mfma_f32_16x16x32_bf16 v[144:147], v[56:59], v[184:187], v[144:147]
    ds_read_b64_tr_b16 v[52:53], v4 offset:53248
    v_mfma_f32_16x16x32_bf16 v[148:151], v[56:59], v[188:191], v[148:151]
    ds_read_b64_tr_b16 v[54:55], v4 offset:54272
    v_mfma_f32_16x16x32_bf16 v[152:155], v[60:63], v[184:187], v[152:155]
    ds_read_b64_tr_b16 v[56:57], v5 offset:53248
    v_mfma_f32_16x16x32_bf16 v[156:159], v[60:63], v[188:191], v[156:159]
    ds_read_b64_tr_b16 v[58:59], v5 offset:54272
    s_waitcnt vmcnt(10) lgkmcnt(10)
    v_mfma_f32_16x16x32_bf16 v[64:67], v[32:35], v[192:195], v[64:67]
    ds_read_b64_tr_b16 v[60:61], v6 offset:53248
    v_mfma_f32_16x16x32_bf16 v[68:71], v[32:35], v[196:199], v[68:71]
    ds_read_b64_tr_b16 v[62:63], v6 offset:54272
    v_mfma_f32_16x16x32_bf16 v[72:75], v[36:39], v[192:195], v[72:75]
    ds_read_b64_tr_b16 v[32:33], v3 offset:57344
    v_mfma_f32_16x16x32_bf16 v[76:79], v[36:39], v[196:199], v[76:79]
    ds_read_b64_tr_b16 v[34:35], v3 offset:58368
    s_waitcnt lgkmcnt(10)
    v_mfma_f32_16x16x32_bf16 v[80:83], v[40:43], v[192:195], v[80:83]
    ds_read_b64_tr_b16 v[36:37], v4 offset:57344
    v_mfma_f32_16x16x32_bf16 v[84:87], v[40:43], v[196:199], v[84:87]
    ds_read_b64_tr_b16 v[38:39], v4 offset:58368
    v_mfma_f32_16x16x32_bf16 v[88:91], v[44:47], v[192:195], v[88:91]
    ds_read_b64_tr_b16 v[40:41], v5 offset:57344
    v_mfma_f32_16x16x32_bf16 v[92:95], v[44:47], v[196:199], v[92:95]
    ds_read_b64_tr_b16 v[42:43], v5 offset:58368
    s_waitcnt lgkmcnt(10)
    v_mfma_f32_16x16x32_bf16 v[96:99], v[192:195], v[48:51], v[96:99]
    ds_read_b64_tr_b16 v[44:45], v6 offset:57344
    v_mfma_f32_16x16x32_bf16 v[100:103], v[196:199], v[48:51], v[100:103]
    ds_read_b64_tr_b16 v[46:47], v6 offset:58368
    v_mfma_f32_16x16x32_bf16 v[104:107], v[192:195], v[52:55], v[104:107]
    ds_read_b64_tr_b16 v[48:49], v3 offset:61440
    v_mfma_f32_16x16x32_bf16 v[108:111], v[196:199], v[52:55], v[108:111]
    ds_read_b64_tr_b16 v[50:51], v3 offset:62464
    s_waitcnt lgkmcnt(10)
    v_mfma_f32_16x16x32_bf16 v[112:115], v[192:195], v[56:59], v[112:115]
    ds_read_b64_tr_b16 v[52:53], v4 offset:61440
    v_mfma_f32_16x16x32_bf16 v[116:119], v[196:199], v[56:59], v[116:119]
    ds_read_b64_tr_b16 v[54:55], v4 offset:62464
    v_mfma_f32_16x16x32_bf16 v[120:123], v[192:195], v[60:63], v[120:123]
    ds_read_b64_tr_b16 v[56:57], v5 offset:61440
    v_mfma_f32_16x16x32_bf16 v[124:127], v[196:199], v[60:63], v[124:127]
    ds_read_b64_tr_b16 v[58:59], v5 offset:62464
    s_waitcnt lgkmcnt(10)
    v_mfma_f32_16x16x32_bf16 v[128:131], v[32:35], v[192:195], v[128:131]
    ds_read_b64_tr_b16 v[60:61], v6 offset:61440
    v_mfma_f32_16x16x32_bf16 v[132:135], v[32:35], v[196:199], v[132:135]
    ds_read_b64_tr_b16 v[62:63], v6 offset:62464
    s_barrier
    v_xor_b32 v3, 0x10000, v3
    v_xor_b32 v4, 0x10000, v4
    v_xor_b32 v5, 0x10000, v5
    v_xor_b32 v6, 0x10000, v6
    v_mfma_f32_16x16x32_bf16 v[136:139], v[36:39], v[192:195], v[136:139]
    ds_read_b64_tr_b16 v[32:33], v3 offset:0
    v_mfma_f32_16x16x32_bf16 v[140:143], v[36:39], v[196:199], v[140:143]
    ds_read_b64_tr_b16 v[34:35], v3 offset:1024
    s_waitcnt lgkmcnt(10)
    v_mfma_f32_16x16x32_bf16 v[144:147], v[40:43], v[192:195], v[144:147]
    ds_read_b64_tr_b16 v[36:37], v4 offset:0
    v_mfma_f32_16x16x32_bf16 v[148:151], v[40:43], v[196:199], v[148:151]
    ds_read_b64_tr_b16 v[38:39], v4 offset:1024
    v_mfma_f32_16x16x32_bf16 v[152:155], v[44:47], v[192:195], v[152:155]
    ds_read_b64_tr_b16 v[40:41], v5 offset:0
    v_mfma_f32_16x16x32_bf16 v[156:159], v[44:47], v[196:199], v[156:159]
    ds_read_b64_tr_b16 v[42:43], v5 offset:1024
    s_waitcnt vmcnt(8) lgkmcnt(10)
    v_mfma_f32_16x16x32_bf16 v[64:67], v[48:51], v[200:203], v[64:67]
    ds_read_b64_tr_b16 v[44:45], v6 offset:0
    v_mfma_f32_16x16x32_bf16 v[68:71], v[48:51], v[204:207], v[68:71]
    ds_read_b64_tr_b16 v[46:47], v6 offset:1024
    v_mfma_f32_16x16x32_bf16 v[72:75], v[52:55], v[200:203], v[72:75]
    ds_read_b64_tr_b16 v[48:49], v3 offset:4096
    v_mfma_f32_16x16x32_bf16 v[76:79], v[52:55], v[204:207], v[76:79]
    ds_read_b64_tr_b16 v[50:51], v3 offset:5120
    s_waitcnt lgkmcnt(10)
    v_mfma_f32_16x16x32_bf16 v[80:83], v[56:59], v[200:203], v[80:83]
    ds_read_b64_tr_b16 v[52:53], v4 offset:4096
    v_mfma_f32_16x16x32_bf16 v[84:87], v[56:59], v[204:207], v[84:87]
    ds_read_b64_tr_b16 v[54:55], v4 offset:5120
    v_mfma_f32_16x16x32_bf16 v[88:91], v[60:63], v[200:203], v[88:91]
    ds_read_b64_tr_b16 v[56:57], v5 offset:4096
    v_mfma_f32_16x16x32_bf16 v[92:95], v[60:63], v[204:207], v[92:95]
    ds_read_b64_tr_b16 v[58:59], v5 offset:5120
    s_waitcnt lgkmcnt(10)
    v_mfma_f32_16x16x32_bf16 v[96:99], v[200:203], v[32:35], v[96:99]
    ds_read_b64_tr_b16 v[60:61], v6 offset:4096
    v_mfma_f32_16x16x32_bf16 v[100:103], v[204:207], v[32:35], v[100:103]
    ds_read_b64_tr_b16 v[62:63], v6 offset:5120
    v_mfma_f32_16x16x32_bf16 v[104:107], v[200:203], v[36:39], v[104:107]
    ds_read_b64_tr_b16 v[32:33], v3 offset:8192
    v_mfma_f32_16x16x32_bf16 v[108:111], v[204:207], v[36:39], v[108:111]
    ds_read_b64_tr_b16 v[34:35], v3 offset:9216
    s_waitcnt lgkmcnt(10)
    v_mfma_f32_16x16x32_bf16 v[112:115], v[200:203], v[40:43], v[112:115]
    ds_read_b64_tr_b16 v[36:37], v4 offset:8192
    v_mfma_f32_16x16x32_bf16 v[116:119], v[204:207], v[40:43], v[116:119]
    ds_read_b64_tr_b16 v[38:39], v4 offset:9216
    v_mfma_f32_16x16x32_bf16 v[120:123], v[200:203], v[44:47], v[120:123]
    ds_read_b64_tr_b16 v[40:41], v5 offset:8192
    v_mfma_f32_16x16x32_bf16 v[124:127], v[204:207], v[44:47], v[124:127]
    ds_read_b64_tr_b16 v[42:43], v5 offset:9216
    s_waitcnt lgkmcnt(10)
    v_mfma_f32_16x16x32_bf16 v[128:131], v[48:51], v[200:203], v[128:131]
    ds_read_b64_tr_b16 v[44:45], v6 offset:8192
    v_mfma_f32_16x16x32_bf16 v[132:135], v[48:51], v[204:207], v[132:135]
    ds_read_b64_tr_b16 v[46:47], v6 offset:9216
    v_mfma_f32_16x16x32_bf16 v[136:139], v[52:55], v[200:203], v[136:139]
    ds_read_b64_tr_b16 v[48:49], v3 offset:12288
    v_mfma_f32_16x16x32_bf16 v[140:143], v[52:55], v[204:207], v[140:143]
    ds_read_b64_tr_b16 v[50:51], v3 offset:13312
    s_waitcnt lgkmcnt(10)
    v_mfma_f32_16x16x32_bf16 v[144:147], v[56:59], v[200:203], v[144:147]
    ds_read_b64_tr_b16 v[52:53], v4 offset:12288
    v_mfma_f32_16x16x32_bf16 v[148:151], v[56:59], v[204:207], v[148:151]
    ds_read_b64_tr_b16 v[54:55], v4 offset:13312
    v_mfma_f32_16x16x32_bf16 v[152:155], v[60:63], v[200:203], v[152:155]
    ds_read_b64_tr_b16 v[56:57], v5 offset:12288
    v_mfma_f32_16x16x32_bf16 v[156:159], v[60:63], v[204:207], v[156:159]
    ds_read_b64_tr_b16 v[58:59], v5 offset:13312
    s_waitcnt vmcnt(6) lgkmcnt(10)
    v_mfma_f32_16x16x32_bf16 v[64:67], v[32:35], v[208:211], v[64:67]
    ds_read_b64_tr_b16 v[60:61], v6 offset:12288
    v_mfma_f32_16x16x32_bf16 v[68:71], v[32:35], v[212:215], v[68:71]
    ds_read_b64_tr_b16 v[62:63], v6 offset:13312
    v_mfma_f32_16x16x32_bf16 v[72:75], v[36:39], v[208:211], v[72:75]
    ds_read_b64_tr_b16 v[32:33], v3 offset:16384
    v_mfma_f32_16x16x32_bf16 v[76:79], v[36:39], v[212:215], v[76:79]
    ds_read_b64_tr_b16 v[34:35], v3 offset:17408
    s_waitcnt lgkmcnt(10)
    v_mfma_f32_16x16x32_bf16 v[80:83], v[40:43], v[208:211], v[80:83]
    ds_read_b64_tr_b16 v[36:37], v4 offset:16384
    v_mfma_f32_16x16x32_bf16 v[84:87], v[40:43], v[212:215], v[84:87]
    ds_read_b64_tr_b16 v[38:39], v4 offset:17408
    v_mfma_f32_16x16x32_bf16 v[88:91], v[44:47], v[208:211], v[88:91]
    ds_read_b64_tr_b16 v[40:41], v5 offset:16384
    v_mfma_f32_16x16x32_bf16 v[92:95], v[44:47], v[212:215], v[92:95]
    ds_read_b64_tr_b16 v[42:43], v5 offset:17408
    s_waitcnt lgkmcnt(10)
    v_mfma_f32_16x16x32_bf16 v[96:99], v[208:211], v[48:51], v[96:99]
    buffer_load_dwordx4 v[240:243], v2, s[4:7], s42 offen offset:0 sc1
    ds_read_b64_tr_b16 v[44:45], v6 offset:16384
    v_mfma_f32_16x16x32_bf16 v[100:103], v[212:215], v[48:51], v[100:103]
    ds_read_b64_tr_b16 v[46:47], v6 offset:17408
    v_mfma_f32_16x16x32_bf16 v[104:107], v[208:211], v[52:55], v[104:107]
    buffer_load_dwordx4 v[244:247], v2, s[4:7], s42 offen offset:256 sc1
    ds_read_b64_tr_b16 v[48:49], v3 offset:20480
    v_mfma_f32_16x16x32_bf16 v[108:111], v[212:215], v[52:55], v[108:111]
    ds_read_b64_tr_b16 v[50:51], v3 offset:21504
    s_waitcnt lgkmcnt(10)
    v_mfma_f32_16x16x32_bf16 v[112:115], v[208:211], v[56:59], v[112:115]
    buffer_load_dwordx4 v[248:251], v2, s[4:7], s42 offen offset:2048 sc1
    ds_read_b64_tr_b16 v[52:53], v4 offset:20480
    v_mfma_f32_16x16x32_bf16 v[116:119], v[212:215], v[56:59], v[116:119]
    ds_read_b64_tr_b16 v[54:55], v4 offset:21504
    v_mfma_f32_16x16x32_bf16 v[120:123], v[208:211], v[60:63], v[120:123]
    buffer_load_dwordx4 v[252:255], v2, s[4:7], s42 offen offset:2304 sc1
    ds_read_b64_tr_b16 v[56:57], v5 offset:20480
    s_add_u32 s42, s41, s90
    v_mfma_f32_16x16x32_bf16 v[124:127], v[212:215], v[60:63], v[124:127]
    ds_read_b64_tr_b16 v[58:59], v5 offset:21504
    s_waitcnt lgkmcnt(10)
    v_mfma_f32_16x16x32_bf16 v[128:131], v[32:35], v[208:211], v[128:131]
    ds_read_b64_tr_b16 v[60:61], v6 offset:20480
    buffer_load_dwordx4 v[160:163], v2, s[4:7], s42 offen offset:0 sc1
    v_mfma_f32_16x16x32_bf16 v[132:135], v[32:35], v[212:215], v[132:135]
    ds_read_b64_tr_b16 v[62:63], v6 offset:21504
    v_mfma_f32_16x16x32_bf16 v[136:139], v[36:39], v[208:211], v[136:139]
    buffer_load_dwordx4 v[164:167], v2, s[4:7], s42 offen offset:256 sc1
    ds_read_b64_tr_b16 v[32:33], v3 offset:24576
    v_mfma_f32_16x16x32_bf16 v[140:143], v[36:39], v[212:215], v[140:143]
    ds_read_b64_tr_b16 v[34:35], v3 offset:25600
    s_waitcnt lgkmcnt(10)
    v_mfma_f32_16x16x32_bf16 v[144:147], v[40:43], v[208:211], v[144:147]
    buffer_load_dwordx4 v[168:171], v2, s[4:7], s42 offen offset:2048 sc1
    ds_read_b64_tr_b16 v[36:37], v4 offset:24576
    v_mfma_f32_16x16x32_bf16 v[148:151], v[40:43], v[212:215], v[148:151]
    ds_read_b64_tr_b16 v[38:39], v4 offset:25600
    v_mfma_f32_16x16x32_bf16 v[152:155], v[44:47], v[208:211], v[152:155]
    buffer_load_dwordx4 v[172:175], v2, s[4:7], s42 offen offset:2304 sc1
    ds_read_b64_tr_b16 v[40:41], v5 offset:24576
    s_add_u32 s42, s41, s91
    v_mfma_f32_16x16x32_bf16 v[156:159], v[44:47], v[212:215], v[156:159]
    ds_read_b64_tr_b16 v[42:43], v5 offset:25600
    s_waitcnt vmcnt(12) lgkmcnt(10)
    v_mfma_f32_16x16x32_bf16 v[64:67], v[48:51], v[216:219], v[64:67]
    buffer_load_dwordx4 v[176:179], v2, s[4:7], s42 offen offset:0 sc1
    ds_read_b64_tr_b16 v[44:45], v6 offset:24576
    v_mfma_f32_16x16x32_bf16 v[68:71], v[48:51], v[220:223], v[68:71]
    ds_read_b64_tr_b16 v[46:47], v6 offset:25600
    v_mfma_f32_16x16x32_bf16 v[72:75], v[52:55], v[216:219], v[72:75]
    buffer_load_dwordx4 v[180:183], v2, s[4:7], s42 offen offset:256 sc1
    ds_read_b64_tr_b16 v[48:49], v3 offset:28672
    v_mfma_f32_16x16x32_bf16 v[76:79], v[52:55], v[220:223], v[76:79]
    ds_read_b64_tr_b16 v[50:51], v3 offset:29696
    s_waitcnt lgkmcnt(10)
    v_mfma_f32_16x16x32_bf16 v[80:83], v[56:59], v[216:219], v[80:83]
    buffer_load_dwordx4 v[184:187], v2, s[4:7], s42 offen offset:2048 sc1
    ds_read_b64_tr_b16 v[52:53], v4 offset:28672
    v_mfma_f32_16x16x32_bf16 v[84:87], v[56:59], v[220:223], v[84:87]
    ds_read_b64_tr_b16 v[54:55], v4 offset:29696
    v_mfma_f32_16x16x32_bf16 v[88:91], v[60:63], v[216:219], v[88:91]
    buffer_load_dwordx4 v[188:191], v2, s[4:7], s42 offen offset:2304 sc1
    ds_read_b64_tr_b16 v[56:57], v5 offset:28672
    s_add_u32 s42, s41, s92
    v_mfma_f32_16x16x32_bf16 v[92:95], v[60:63], v[220:223], v[92:95]
    ds_read_b64_tr_b16 v[58:59], v5 offset:29696
    s_waitcnt lgkmcnt(10)
    v_mfma_f32_16x16x32_bf16 v[96:99], v[216:219], v[32:35], v[96:99]
    ds_read_b64_tr_b16 v[60:61], v6 offset:28672
    v_mfma_f32_16x16x32_bf16 v[100:103], v[220:223], v[32:35], v[100:103]
    ds_read_b64_tr_b16 v[62:63], v6 offset:29696
    s_barrier
    v_mfma_f32_16x16x32_bf16 v[104:107], v[216:219], v[36:39], v[104:107]
    ds_read_b64_tr_b16 v[32:33], v3 offset:32768
    v_mfma_f32_16x16x32_bf16 v[108:111], v[220:223], v[36:39], v[108:111]
    ds_read_b64_tr_b16 v[34:35], v3 offset:33792
    s_waitcnt lgkmcnt(10)
    v_mfma_f32_16x16x32_bf16 v[112:115], v[216:219], v[40:43], v[112:115]
    ds_read_b64_tr_b16 v[36:37], v4 offset:32768
    v_mfma_f32_16x16x32_bf16 v[116:119], v[220:223], v[40:43], v[116:119]
    ds_read_b64_tr_b16 v[38:39], v4 offset:33792
    v_mfma_f32_16x16x32_bf16 v[120:123], v[216:219], v[44:47], v[120:123]
    ds_read_b64_tr_b16 v[40:41], v5 offset:32768
    v_mfma_f32_16x16x32_bf16 v[124:127], v[220:223], v[44:47], v[124:127]
    ds_read_b64_tr_b16 v[42:43], v5 offset:33792
    s_waitcnt lgkmcnt(10)
    v_mfma_f32_16x16x32_bf16 v[128:131], v[48:51], v[216:219], v[128:131]
    ds_read_b64_tr_b16 v[44:45], v6 offset:32768
    v_mfma_f32_16x16x32_bf16 v[132:135], v[48:51], v[220:223], v[132:135]
    ds_read_b64_tr_b16 v[46:47], v6 offset:33792
    v_mfma_f32_16x16x32_bf16 v[136:139], v[52:55], v[216:219], v[136:139]
    ds_read_b64_tr_b16 v[48:49], v3 offset:36864
    v_mfma_f32_16x16x32_bf16 v[140:143], v[52:55], v[220:223], v[140:143]
    ds_read_b64_tr_b16 v[50:51], v3 offset:37888
    s_waitcnt lgkmcnt(10)
    v_mfma_f32_16x16x32_bf16 v[144:147], v[56:59], v[216:219], v[144:147]
    ds_read_b64_tr_b16 v[52:53], v4 offset:36864
    v_mfma_f32_16x16x32_bf16 v[148:151], v[56:59], v[220:223], v[148:151]
    ds_read_b64_tr_b16 v[54:55], v4 offset:37888
    v_mfma_f32_16x16x32_bf16 v[152:155], v[60:63], v[216:219], v[152:155]
    ds_read_b64_tr_b16 v[56:57], v5 offset:36864
    v_mfma_f32_16x16x32_bf16 v[156:159], v[60:63], v[220:223], v[156:159]
    ds_read_b64_tr_b16 v[58:59], v5 offset:37888
    s_waitcnt vmcnt(14) lgkmcnt(10)
    v_mfma_f32_16x16x32_bf16 v[64:67], v[32:35], v[224:227], v[64:67]
    ds_read_b64_tr_b16 v[60:61], v6 offset:36864
    v_mfma_f32_16x16x32_bf16 v[68:71], v[32:35], v[228:231], v[68:71]
    ds_read_b64_tr_b16 v[62:63], v6 offset:37888
    v_mfma_f32_16x16x32_bf16 v[72:75], v[36:39], v[224:227], v[72:75]
    ds_read_b64_tr_b16 v[32:33], v3 offset:40960
    v_mfma_f32_16x16x32_bf16 v[76:79], v[36:39], v[228:231], v[76:79]
    ds_read_b64_tr_b16 v[34:35], v3 offset:41984
    s_waitcnt lgkmcnt(10)
    v_mfma_f32_16x16x32_bf16 v[80:83], v[40:43], v[224:227], v[80:83]
    ds_read_b64_tr_b16 v[36:37], v4 offset:40960
    v_mfma_f32_16x16x32_bf16 v[84:87], v[40:43], v[228:231], v[84:87]
    ds_read_b64_tr_b16 v[38:39], v4 offset:41984
    v_mfma_f32_16x16x32_bf16 v[88:91], v[44:47], v[224:227], v[88:91]
    ds_read_b64_tr_b16 v[40:41], v5 offset:40960
    v_mfma_f32_16x16x32_bf16 v[92:95], v[44:47], v[228:231], v[92:95]
    ds_read_b64_tr_b16 v[42:43], v5 offset:41984
    s_waitcnt lgkmcnt(10)
    v_mfma_f32_16x16x32_bf16 v[96:99], v[224:227], v[48:51], v[96:99]
    ds_read_b64_tr_b16 v[44:45], v6 offset:40960
    v_mfma_f32_16x16x32_bf16 v[100:103], v[228:231], v[48:51], v[100:103]
    ds_read_b64_tr_b16 v[46:47], v6 offset:41984
    v_mfma_f32_16x16x32_bf16 v[104:107], v[224:227], v[52:55], v[104:107]
    ds_read_b64_tr_b16 v[48:49], v3 offset:45056
    v_mfma_f32_16x16x32_bf16 v[108:111], v[228:231], v[52:55], v[108:111]
    ds_read_b64_tr_b16 v[50:51], v3 offset:46080
    s_waitcnt lgkmcnt(10)
    v_mfma_f32_16x16x32_bf16 v[112:115], v[224:227], v[56:59], v[112:115]
    ds_read_b64_tr_b16 v[52:53], v4 offset:45056
    v_mfma_f32_16x16x32_bf16 v[116:119], v[228:231], v[56:59], v[116:119]
    ds_read_b64_tr_b16 v[54:55], v4 offset:46080
    v_mfma_f32_16x16x32_bf16 v[120:123], v[224:227], v[60:63], v[120:123]
    ds_read_b64_tr_b16 v[56:57], v5 offset:45056
    v_mfma_f32_16x16x32_bf16 v[124:127], v[228:231], v[60:63], v[124:127]
    ds_read_b64_tr_b16 v[58:59], v5 offset:46080
    s_waitcnt lgkmcnt(10)
    v_mfma_f32_16x16x32_bf16 v[128:131], v[32:35], v[224:227], v[128:131]
    ds_read_b64_tr_b16 v[60:61], v6 offset:45056
    v_mfma_f32_16x16x32_bf16 v[132:135], v[32:35], v[228:231], v[132:135]
    ds_read_b64_tr_b16 v[62:63], v6 offset:46080
    v_mfma_f32_16x16x32_bf16 v[136:139], v[36:39], v[224:227], v[136:139]
    ds_read_b64_tr_b16 v[32:33], v3 offset:49152
    v_mfma_f32_16x16x32_bf16 v[140:143], v[36:39], v[228:231], v[140:143]
    ds_read_b64_tr_b16 v[34:35], v3 offset:50176
    s_waitcnt lgkmcnt(10)
    v_mfma_f32_16x16x32_bf16 v[144:147], v[40:43], v[224:227], v[144:147]
    ds_read_b64_tr_b16 v[36:37], v4 offset:49152
    v_mfma_f32_16x16x32_bf16 v[148:151], v[40:43], v[228:231], v[148:151]
    ds_read_b64_tr_b16 v[38:39], v4 offset:50176
    v_mfma_f32_16x16x32_bf16 v[152:155], v[44:47], v[224:227], v[152:155]
    ds_read_b64_tr_b16 v[40:41], v5 offset:49152
    v_mfma_f32_16x16x32_bf16 v[156:159], v[44:47], v[228:231], v[156:159]
    ds_read_b64_tr_b16 v[42:43], v5 offset:50176
    s_waitcnt vmcnt(12) lgkmcnt(10)
    v_mfma_f32_16x16x32_bf16 v[64:67], v[48:51], v[232:235], v[64:67]
    buffer_load_dwordx4 v[192:195], v2, s[4:7], s42 offen offset:0 sc1
    ds_read_b64_tr_b16 v[44:45], v6 offset:49152
    v_mfma_f32_16x16x32_bf16 v[68:71], v[48:51], v[236:239], v[68:71]
    ds_read_b64_tr_b16 v[46:47], v6 offset:50176
    v_mfma_f32_16x16x32_bf16 v[72:75], v[52:55], v[232:235], v[72:75]
    buffer_load_dwordx4 v[196:199], v2, s[4:7], s42 offen offset:256 sc1
    ds_read_b64_tr_b16 v[48:49], v3 offset:53248
    v_mfma_f32_16x16x32_bf16 v[76:79], v[52:55], v[236:239], v[76:79]
    ds_read_b64_tr_b16 v[50:51], v3 offset:54272
    s_waitcnt lgkmcnt(10)
    v_mfma_f32_16x16x32_bf16 v[80:83], v[56:59], v[232:235], v[80:83]
    buffer_load_dwordx4 v[200:203], v2, s[4:7], s42 offen offset:2048 sc1
    ds_read_b64_tr_b16 v[52:53], v4 offset:53248
    v_mfma_f32_16x16x32_bf16 v[84:87], v[56:59], v[236:239], v[84:87]
    ds_read_b64_tr_b16 v[54:55], v4 offset:54272
    v_mfma_f32_16x16x32_bf16 v[88:91], v[60:63], v[232:235], v[88:91]
    buffer_load_dwordx4 v[204:207], v2, s[4:7], s42 offen offset:2304 sc1
    ds_read_b64_tr_b16 v[56:57], v5 offset:53248
    s_add_u32 s42, s41, s93
    v_mfma_f32_16x16x32_bf16 v[92:95], v[60:63], v[236:239], v[92:95]
    ds_read_b64_tr_b16 v[58:59], v5 offset:54272
    s_waitcnt lgkmcnt(10)
    v_mfma_f32_16x16x32_bf16 v[96:99], v[232:235], v[32:35], v[96:99]
    ds_read_b64_tr_b16 v[60:61], v6 offset:53248
    buffer_load_dwordx4 v[208:211], v2, s[4:7], s42 offen offset:0 sc1
    v_mfma_f32_16x16x32_bf16 v[100:103], v[236:239], v[32:35], v[100:103]
    ds_read_b64_tr_b16 v[62:63], v6 offset:54272
    v_mfma_f32_16x16x32_bf16 v[104:107], v[232:235], v[36:39], v[104:107]
    ds_read_b64_tr_b16 v[32:33], v3 offset:57344
    v_mfma_f32_16x16x32_bf16 v[108:111], v[236:239], v[36:39], v[108:111]
    ds_read_b64_tr_b16 v[34:35], v3 offset:58368
    s_waitcnt lgkmcnt(10)
    v_mfma_f32_16x16x32_bf16 v[112:115], v[232:235], v[40:43], v[112:115]
    ds_read_b64_tr_b16 v[36:37], v4 offset:57344
    v_mfma_f32_16x16x32_bf16 v[116:119], v[236:239], v[40:43], v[116:119]
    ds_read_b64_tr_b16 v[38:39], v4 offset:58368
    v_mfma_f32_16x16x32_bf16 v[120:123], v[232:235], v[44:47], v[120:123]
    buffer_load_dwordx4 v[212:215], v2, s[4:7], s42 offen offset:256 sc1
    ds_read_b64_tr_b16 v[40:41], v5 offset:57344
    v_mfma_f32_16x16x32_bf16 v[124:127], v[236:239], v[44:47], v[124:127]
    ds_read_b64_tr_b16 v[42:43], v5 offset:58368
    s_waitcnt lgkmcnt(10)
    v_mfma_f32_16x16x32_bf16 v[128:131], v[48:51], v[232:235], v[128:131]
    ds_read_b64_tr_b16 v[44:45], v6 offset:57344
    v_mfma_f32_16x16x32_bf16 v[132:135], v[48:51], v[236:239], v[132:135]
    ds_read_b64_tr_b16 v[46:47], v6 offset:58368
    v_mfma_f32_16x16x32_bf16 v[136:139], v[52:55], v[232:235], v[136:139]
    ds_read_b64_tr_b16 v[48:49], v3 offset:61440
    v_mfma_f32_16x16x32_bf16 v[140:143], v[52:55], v[236:239], v[140:143]
    ds_read_b64_tr_b16 v[50:51], v3 offset:62464
    s_waitcnt lgkmcnt(10)
    v_mfma_f32_16x16x32_bf16 v[144:147], v[56:59], v[232:235], v[144:147]
    ds_read_b64_tr_b16 v[52:53], v4 offset:61440
    v_mfma_f32_16x16x32_bf16 v[148:151], v[56:59], v[236:239], v[148:151]
    ds_read_b64_tr_b16 v[54:55], v4 offset:62464
    v_mfma_f32_16x16x32_bf16 v[152:155], v[60:63], v[232:235], v[152:155]
    ds_read_b64_tr_b16 v[56:57], v5 offset:61440
    v_mfma_f32_16x16x32_bf16 v[156:159], v[60:63], v[236:239], v[156:159]
    ds_read_b64_tr_b16 v[58:59], v5 offset:62464
    s_waitcnt vmcnt(16) lgkmcnt(10)
    v_mfma_f32_16x16x32_bf16 v[64:67], v[32:35], v[240:243], v[64:67]
    ds_read_b64_tr_b16 v[60:61], v6 offset:61440
    v_mfma_f32_16x16x32_bf16 v[68:71], v[32:35], v[244:247], v[68:71]
    ds_read_b64_tr_b16 v[62:63], v6 offset:62464
    s_barrier
    v_xor_b32 v3, 0x10000, v3
    v_xor_b32 v4, 0x10000, v4
    v_xor_b32 v5, 0x10000, v5
    v_xor_b32 v6, 0x10000, v6
    v_mfma_f32_16x16x32_bf16 v[72:75], v[36:39], v[240:243], v[72:75]
    ds_read_b64_tr_b16 v[32:33], v3 offset:0
    v_mfma_f32_16x16x32_bf16 v[76:79], v[36:39], v[244:247], v[76:79]
    ds_read_b64_tr_b16 v[34:35], v3 offset:1024
    s_waitcnt lgkmcnt(10)
    v_mfma_f32_16x16x32_bf16 v[80:83], v[40:43], v[240:243], v[80:83]
    ds_read_b64_tr_b16 v[36:37], v4 offset:0
    v_mfma_f32_16x16x32_bf16 v[84:87], v[40:43], v[244:247], v[84:87]
    ds_read_b64_tr_b16 v[38:39], v4 offset:1024
    v_mfma_f32_16x16x32_bf16 v[88:91], v[44:47], v[240:243], v[88:91]
    ds_read_b64_tr_b16 v[40:41], v5 offset:0
    v_mfma_f32_16x16x32_bf16 v[92:95], v[44:47], v[244:247], v[92:95]
    ds_read_b64_tr_b16 v[42:43], v5 offset:1024
    s_waitcnt lgkmcnt(10)
    v_mfma_f32_16x16x32_bf16 v[96:99], v[240:243], v[48:51], v[96:99]
    ds_read_b64_tr_b16 v[44:45], v6 offset:0
    v_mfma_f32_16x16x32_bf16 v[100:103], v[244:247], v[48:51], v[100:103]
    ds_read_b64_tr_b16 v[46:47], v6 offset:1024
    v_mfma_f32_16x16x32_bf16 v[104:107], v[240:243], v[52:55], v[104:107]
    ds_read_b64_tr_b16 v[48:49], v3 offset:4096
    v_mfma_f32_16x16x32_bf16 v[108:111], v[244:247], v[52:55], v[108:111]
    ds_read_b64_tr_b16 v[50:51], v3 offset:5120
    s_waitcnt lgkmcnt(10)
    v_mfma_f32_16x16x32_bf16 v[112:115], v[240:243], v[56:59], v[112:115]
    ds_read_b64_tr_b16 v[52:53], v4 offset:4096
    v_mfma_f32_16x16x32_bf16 v[116:119], v[244:247], v[56:59], v[116:119]
    ds_read_b64_tr_b16 v[54:55], v4 offset:5120
    v_mfma_f32_16x16x32_bf16 v[120:123], v[240:243], v[60:63], v[120:123]
    ds_read_b64_tr_b16 v[56:57], v5 offset:4096
    v_mfma_f32_16x16x32_bf16 v[124:127], v[244:247], v[60:63], v[124:127]
    ds_read_b64_tr_b16 v[58:59], v5 offset:5120
    s_waitcnt lgkmcnt(10)
    v_mfma_f32_16x16x32_bf16 v[128:131], v[32:35], v[240:243], v[128:131]
    ds_read_b64_tr_b16 v[60:61], v6 offset:4096
    v_mfma_f32_16x16x32_bf16 v[132:135], v[32:35], v[244:247], v[132:135]
    ds_read_b64_tr_b16 v[62:63], v6 offset:5120
    v_mfma_f32_16x16x32_bf16 v[136:139], v[36:39], v[240:243], v[136:139]
    ds_read_b64_tr_b16 v[32:33], v3 offset:8192
    v_mfma_f32_16x16x32_bf16 v[140:143], v[36:39], v[244:247], v[140:143]
    ds_read_b64_tr_b16 v[34:35], v3 offset:9216
    s_waitcnt lgkmcnt(10)
    v_mfma_f32_16x16x32_bf16 v[144:147], v[40:43], v[240:243], v[144:147]
    ds_read_b64_tr_b16 v[36:37], v4 offset:8192
    v_mfma_f32_16x16x32_bf16 v[148:151], v[40:43], v[244:247], v[148:151]
    ds_read_b64_tr_b16 v[38:39], v4 offset:9216
    v_mfma_f32_16x16x32_bf16 v[152:155], v[44:47], v[240:243], v[152:155]
    ds_read_b64_tr_b16 v[40:41], v5 offset:8192
    v_mfma_f32_16x16x32_bf16 v[156:159], v[44:47], v[244:247], v[156:159]
    ds_read_b64_tr_b16 v[42:43], v5 offset:9216
    s_waitcnt vmcnt(14) lgkmcnt(10)
    v_mfma_f32_16x16x32_bf16 v[64:67], v[48:51], v[248:251], v[64:67]
    ds_read_b64_tr_b16 v[44:45], v6 offset:8192
    v_mfma_f32_16x16x32_bf16 v[68:71], v[48:51], v[252:255], v[68:71]
    ds_read_b64_tr_b16 v[46:47], v6 offset:9216
    v_mfma_f32_16x16x32_bf16 v[72:75], v[52:55], v[248:251], v[72:75]
    ds_read_b64_tr_b16 v[48:49], v3 offset:12288
    v_mfma_f32_16x16x32_bf16 v[76:79], v[52:55], v[252:255], v[76:79]
    ds_read_b64_tr_b16 v[50:51], v3 offset:13312
    s_waitcnt lgkmcnt(10)
    v_mfma_f32_16x16x32_bf16 v[80:83], v[56:59], v[248:251], v[80:83]
    ds_read_b64_tr_b16 v[52:53], v4 offset:12288
    v_mfma_f32_16x16x32_bf16 v[84:87], v[56:59], v[252:255], v[84:87]
    ds_read_b64_tr_b16 v[54:55], v4 offset:13312
    v_mfma_f32_16x16x32_bf16 v[88:91], v[60:63], v[248:251], v[88:91]
    ds_read_b64_tr_b16 v[56:57], v5 offset:12288
    v_mfma_f32_16x16x32_bf16 v[92:95], v[60:63], v[252:255], v[92:95]
    ds_read_b64_tr_b16 v[58:59], v5 offset:13312
    s_waitcnt lgkmcnt(10)
    v_mfma_f32_16x16x32_bf16 v[96:99], v[248:251], v[32:35], v[96:99]
    ds_read_b64_tr_b16 v[60:61], v6 offset:12288
    v_mfma_f32_16x16x32_bf16 v[100:103], v[252:255], v[32:35], v[100:103]
    ds_read_b64_tr_b16 v[62:63], v6 offset:13312
    v_mfma_f32_16x16x32_bf16 v[104:107], v[248:251], v[36:39], v[104:107]
    ds_read_b64_tr_b16 v[32:33], v3 offset:16384
    v_mfma_f32_16x16x32_bf16 v[108:111], v[252:255], v[36:39], v[108:111]
    ds_read_b64_tr_b16 v[34:35], v3 offset:17408
    s_waitcnt lgkmcnt(10)
    v_mfma_f32_16x16x32_bf16 v[112:115], v[248:251], v[40:43], v[112:115]
    ds_read_b64_tr_b16 v[36:37], v4 offset:16384
    v_mfma_f32_16x16x32_bf16 v[116:119], v[252:255], v[40:43], v[116:119]
    ds_read_b64_tr_b16 v[38:39], v4 offset:17408
    v_mfma_f32_16x16x32_bf16 v[120:123], v[248:251], v[44:47], v[120:123]
    ds_read_b64_tr_b16 v[40:41], v5 offset:16384
    v_mfma_f32_16x16x32_bf16 v[124:127], v[252:255], v[44:47], v[124:127]
    ds_read_b64_tr_b16 v[42:43], v5 offset:17408
    s_waitcnt lgkmcnt(10)
    v_mfma_f32_16x16x32_bf16 v[128:131], v[48:51], v[248:251], v[128:131]
    buffer_load_dwordx4 v[216:219], v2, s[4:7], s42 offen offset:2048 sc1
    ds_read_b64_tr_b16 v[44:45], v6 offset:16384
    v_mfma_f32_16x16x32_bf16 v[132:135], v[48:51], v[252:255], v[132:135]
    ds_read_b64_tr_b16 v[46:47], v6 offset:17408
    v_mfma_f32_16x16x32_bf16 v[136:139], v[52:55], v[248:251], v[136:139]
    buffer_load_dwordx4 v[220:223], v2, s[4:7], s42 offen offset:2304 sc1
    ds_read_b64_tr_b16 v[48:49], v3 offset:20480
    s_add_u32 s42, s41, s94
    v_mfma_f32_16x16x32_bf16 v[140:143], v[52:55], v[252:255], v[140:143]
    ds_read_b64_tr_b16 v[50:51], v3 offset:21504
    s_waitcnt lgkmcnt(10)
    v_mfma_f32_16x16x32_bf16 v[144:147], v[56:59], v[248:251], v[144:147]
    buffer_load_dwordx4 v[224:227], v2, s[4:7], s42 offen offset:0 sc1
    ds_read_b64_tr_b16 v[52:53], v4 offset:20480
    v_mfma_f32_16x16x32_bf16 v[148:151], v[56:59], v[252:255], v[148:151]
    ds_read_b64_tr_b16 v[54:55], v4 offset:21504
    v_mfma_f32_16x16x32_bf16 v[152:155], v[60:63], v[248:251], v[152:155]
    buffer_load_dwordx4 v[228:231], v2, s[4:7], s42 offen offset:256 sc1
    ds_read_b64_tr_b16 v[56:57], v5 offset:20480
    v_mfma_f32_16x16x32_bf16 v[156:159], v[60:63], v[252:255], v[156:159]
    ds_read_b64_tr_b16 v[58:59], v5 offset:21504
    s_waitcnt vmcnt(16) lgkmcnt(10)
    v_mfma_f32_16x16x32_bf16 v[64:67], v[32:35], v[160:163], v[64:67]
    ds_read_b64_tr_b16 v[60:61], v6 offset:20480
    buffer_load_dwordx4 v[232:235], v2, s[4:7], s42 offen offset:2048 sc1
    v_mfma_f32_16x16x32_bf16 v[68:71], v[32:35], v[164:167], v[68:71]
    ds_read_b64_tr_b16 v[62:63], v6 offset:21504
    v_mfma_f32_16x16x32_bf16 v[72:75], v[36:39], v[160:163], v[72:75]
    buffer_load_dwordx4 v[236:239], v2, s[4:7], s42 offen offset:2304 sc1
    ds_read_b64_tr_b16 v[32:33], v3 offset:24576
    s_add_u32 s42, s41, s95
    v_mfma_f32_16x16x32_bf16 v[76:79], v[36:39], v[164:167], v[76:79]
    ds_read_b64_tr_b16 v[34:35], v3 offset:25600
    s_waitcnt lgkmcnt(10)
    v_mfma_f32_16x16x32_bf16 v[80:83], v[40:43], v[160:163], v[80:83]
    ds_read_b64_tr_b16 v[36:37], v4 offset:24576
    v_mfma_f32_16x16x32_bf16 v[84:87], v[40:43], v[164:167], v[84:87]
    ds_read_b64_tr_b16 v[38:39], v4 offset:25600
    v_mfma_f32_16x16x32_bf16 v[88:91], v[44:47], v[160:163], v[88:91]
    ds_read_b64_tr_b16 v[40:41], v5 offset:24576
    v_mfma_f32_16x16x32_bf16 v[92:95], v[44:47], v[164:167], v[92:95]
    ds_read_b64_tr_b16 v[42:43], v5 offset:25600
    s_waitcnt lgkmcnt(10)
    v_mfma_f32_16x16x32_bf16 v[96:99], v[160:163], v[48:51], v[96:99]
    buffer_load_dwordx4 v[240:243], v2, s[4:7], s42 offen offset:0 sc1
    ds_read_b64_tr_b16 v[44:45], v6 offset:24576
    v_mfma_f32_16x16x32_bf16 v[100:103], v[164:167], v[48:51], v[100:103]
    ds_read_b64_tr_b16 v[46:47], v6 offset:25600
    v_mfma_f32_16x16x32_bf16 v[104:107], v[160:163], v[52:55], v[104:107]
    ds_read_b64_tr_b16 v[48:49], v3 offset:28672
    v_mfma_f32_16x16x32_bf16 v[108:111], v[164:167], v[52:55], v[108:111]
    ds_read_b64_tr_b16 v[50:51], v3 offset:29696
    s_waitcnt lgkmcnt(10)
    v_mfma_f32_16x16x32_bf16 v[112:115], v[160:163], v[56:59], v[112:115]
    ds_read_b64_tr_b16 v[52:53], v4 offset:28672
    v_mfma_f32_16x16x32_bf16 v[116:119], v[164:167], v[56:59], v[116:119]
    ds_read_b64_tr_b16 v[54:55], v4 offset:29696
    v_mfma_f32_16x16x32_bf16 v[120:123], v[160:163], v[60:63], v[120:123]
    ds_read_b64_tr_b16 v[56:57], v5 offset:28672
    v_mfma_f32_16x16x32_bf16 v[124:127], v[164:167], v[60:63], v[124:127]
    ds_read_b64_tr_b16 v[58:59], v5 offset:29696
    s_waitcnt lgkmcnt(10)
    v_mfma_f32_16x16x32_bf16 v[128:131], v[32:35], v[160:163], v[128:131]
    ds_read_b64_tr_b16 v[60:61], v6 offset:28672
    v_mfma_f32_16x16x32_bf16 v[132:135], v[32:35], v[164:167], v[132:135]
    ds_read_b64_tr_b16 v[62:63], v6 offset:29696
    s_barrier
    v_mfma_f32_16x16x32_bf16 v[136:139], v[36:39], v[160:163], v[136:139]
    ds_read_b64_tr_b16 v[32:33], v3 offset:32768
    v_mfma_f32_16x16x32_bf16 v[140:143], v[36:39], v[164:167], v[140:143]
    ds_read_b64_tr_b16 v[34:35], v3 offset:33792
    s_waitcnt lgkmcnt(10)
    v_mfma_f32_16x16x32_bf16 v[144:147], v[40:43], v[160:163], v[144:147]
    ds_read_b64_tr_b16 v[36:37], v4 offset:32768
    v_mfma_f32_16x16x32_bf16 v[148:151], v[40:43], v[164:167], v[148:151]
    ds_read_b64_tr_b16 v[38:39], v4 offset:33792
    v_mfma_f32_16x16x32_bf16 v[152:155], v[44:47], v[160:163], v[152:155]
    ds_read_b64_tr_b16 v[40:41], v5 offset:32768
    v_mfma_f32_16x16x32_bf16 v[156:159], v[44:47], v[164:167], v[156:159]
    ds_read_b64_tr_b16 v[42:43], v5 offset:33792
    s_waitcnt vmcnt(17) lgkmcnt(10)
    v_mfma_f32_16x16x32_bf16 v[64:67], v[48:51], v[168:171], v[64:67]
    ds_read_b64_tr_b16 v[44:45], v6 offset:32768
    v_mfma_f32_16x16x32_bf16 v[68:71], v[48:51], v[172:175], v[68:71]
    ds_read_b64_tr_b16 v[46:47], v6 offset:33792
    v_mfma_f32_16x16x32_bf16 v[72:75], v[52:55], v[168:171], v[72:75]
    ds_read_b64_tr_b16 v[48:49], v3 offset:36864
    v_mfma_f32_16x16x32_bf16 v[76:79], v[52:55], v[172:175], v[76:79]
    ds_read_b64_tr_b16 v[50:51], v3 offset:37888
    s_waitcnt lgkmcnt(10)
    v_mfma_f32_16x16x32_bf16 v[80:83], v[56:59], v[168:171], v[80:83]
    ds_read_b64_tr_b16 v[52:53], v4 offset:36864
    v_mfma_f32_16x16x32_bf16 v[84:87], v[56:59], v[172:175], v[84:87]
    ds_read_b64_tr_b16 v[54:55], v4 offset:37888
    v_mfma_f32_16x16x32_bf16 v[88:91], v[60:63], v[168:171], v[88:91]
    ds_read_b64_tr_b16 v[56:57], v5 offset:36864
    v_mfma_f32_16x16x32_bf16 v[92:95], v[60:63], v[172:175], v[92:95]
    ds_read_b64_tr_b16 v[58:59], v5 offset:37888
    s_waitcnt lgkmcnt(10)
    v_mfma_f32_16x16x32_bf16 v[96:99], v[168:171], v[32:35], v[96:99]
    ds_read_b64_tr_b16 v[60:61], v6 offset:36864
    v_mfma_f32_16x16x32_bf16 v[100:103], v[172:175], v[32:35], v[100:103]
    ds_read_b64_tr_b16 v[62:63], v6 offset:37888
    v_mfma_f32_16x16x32_bf16 v[104:107], v[168:171], v[36:39], v[104:107]
    ds_read_b64_tr_b16 v[32:33], v3 offset:40960
    v_mfma_f32_16x16x32_bf16 v[108:111], v[172:175], v[36:39], v[108:111]
    ds_read_b64_tr_b16 v[34:35], v3 offset:41984
    s_waitcnt lgkmcnt(10)
    v_mfma_f32_16x16x32_bf16 v[112:115], v[168:171], v[40:43], v[112:115]
    ds_read_b64_tr_b16 v[36:37], v4 offset:40960
    v_mfma_f32_16x16x32_bf16 v[116:119], v[172:175], v[40:43], v[116:119]
    ds_read_b64_tr_b16 v[38:39], v4 offset:41984
    v_mfma_f32_16x16x32_bf16 v[120:123], v[168:171], v[44:47], v[120:123]
    ds_read_b64_tr_b16 v[40:41], v5 offset:40960
    v_mfma_f32_16x16x32_bf16 v[124:127], v[172:175], v[44:47], v[124:127]
    ds_read_b64_tr_b16 v[42:43], v5 offset:41984
    s_waitcnt lgkmcnt(10)
    v_mfma_f32_16x16x32_bf16 v[128:131], v[48:51], v[168:171], v[128:131]
    ds_read_b64_tr_b16 v[44:45], v6 offset:40960
    v_mfma_f32_16x16x32_bf16 v[132:135], v[48:51], v[172:175], v[132:135]
    ds_read_b64_tr_b16 v[46:47], v6 offset:41984
    v_mfma_f32_16x16x32_bf16 v[136:139], v[52:55], v[168:171], v[136:139]
    ds_read_b64_tr_b16 v[48:49], v3 offset:45056
    v_mfma_f32_16x16x32_bf16 v[140:143], v[52:55], v[172:175], v[140:143]
    ds_read_b64_tr_b16 v[50:51], v3 offset:46080
    s_waitcnt lgkmcnt(10)
    v_mfma_f32_16x16x32_bf16 v[144:147], v[56:59], v[168:171], v[144:147]
    ds_read_b64_tr_b16 v[52:53], v4 offset:45056
    v_mfma_f32_16x16x32_bf16 v[148:151], v[56:59], v[172:175], v[148:151]
    ds_read_b64_tr_b16 v[54:55], v4 offset:46080
    v_mfma_f32_16x16x32_bf16 v[152:155], v[60:63], v[168:171], v[152:155]
    ds_read_b64_tr_b16 v[56:57], v5 offset:45056
    v_mfma_f32_16x16x32_bf16 v[156:159], v[60:63], v[172:175], v[156:159]
    ds_read_b64_tr_b16 v[58:59], v5 offset:46080
    s_waitcnt vmcnt(15) lgkmcnt(10)
    v_mfma_f32_16x16x32_bf16 v[64:67], v[32:35], v[176:179], v[64:67]
    ds_read_b64_tr_b16 v[60:61], v6 offset:45056
    v_mfma_f32_16x16x32_bf16 v[68:71], v[32:35], v[180:183], v[68:71]
    ds_read_b64_tr_b16 v[62:63], v6 offset:46080
    v_mfma_f32_16x16x32_bf16 v[72:75], v[36:39], v[176:179], v[72:75]
    ds_read_b64_tr_b16 v[32:33], v3 offset:49152
    v_mfma_f32_16x16x32_bf16 v[76:79], v[36:39], v[180:183], v[76:79]
    ds_read_b64_tr_b16 v[34:35], v3 offset:50176
    s_waitcnt lgkmcnt(10)
    v_mfma_f32_16x16x32_bf16 v[80:83], v[40:43], v[176:179], v[80:83]
    ds_read_b64_tr_b16 v[36:37], v4 offset:49152
    v_mfma_f32_16x16x32_bf16 v[84:87], v[40:43], v[180:183], v[84:87]
    ds_read_b64_tr_b16 v[38:39], v4 offset:50176
    v_mfma_f32_16x16x32_bf16 v[88:91], v[44:47], v[176:179], v[88:91]
    ds_read_b64_tr_b16 v[40:41], v5 offset:49152
    v_mfma_f32_16x16x32_bf16 v[92:95], v[44:47], v[180:183], v[92:95]
    ds_read_b64_tr_b16 v[42:43], v5 offset:50176
    s_waitcnt lgkmcnt(10)
    v_mfma_f32_16x16x32_bf16 v[96:99], v[176:179], v[48:51], v[96:99]
    buffer_load_dwordx4 v[244:247], v2, s[4:7], s42 offen offset:256 sc1
    ds_read_b64_tr_b16 v[44:45], v6 offset:49152
    v_mfma_f32_16x16x32_bf16 v[100:103], v[180:183], v[48:51], v[100:103]
    ds_read_b64_tr_b16 v[46:47], v6 offset:50176
    v_mfma_f32_16x16x32_bf16 v[104:107], v[176:179], v[52:55], v[104:107]
    buffer_load_dwordx4 v[248:251], v2, s[4:7], s42 offen offset:2048 sc1
    ds_read_b64_tr_b16 v[48:49], v3 offset:53248
    v_mfma_f32_16x16x32_bf16 v[108:111], v[180:183], v[52:55], v[108:111]
    ds_read_b64_tr_b16 v[50:51], v3 offset:54272
    s_waitcnt lgkmcnt(10)
    v_mfma_f32_16x16x32_bf16 v[112:115], v[176:179], v[56:59], v[112:115]
    buffer_load_dwordx4 v[252:255], v2, s[4:7], s42 offen offset:2304 sc1
    ds_read_b64_tr_b16 v[52:53], v4 offset:53248
    s_add_u32 s42, s41, s96
    v_mfma_f32_16x16x32_bf16 v[116:119], v[180:183], v[56:59], v[116:119]
    ds_read_b64_tr_b16 v[54:55], v4 offset:54272
    v_mfma_f32_16x16x32_bf16 v[120:123], v[176:179], v[60:63], v[120:123]
    buffer_load_dwordx4 v[160:163], v2, s[4:7], s42 offen offset:0 sc1
    ds_read_b64_tr_b16 v[56:57], v5 offset:53248
    v_mfma_f32_16x16x32_bf16 v[124:127], v[180:183], v[60:63], v[124:127]
    ds_read_b64_tr_b16 v[58:59], v5 offset:54272
    s_waitcnt lgkmcnt(10)
    v_mfma_f32_16x16x32_bf16 v[128:131], v[32:35], v[176:179], v[128:131]
    ds_read_b64_tr_b16 v[60:61], v6 offset:53248
    buffer_load_dwordx4 v[164:167], v2, s[4:7], s42 offen offset:256 sc1
    v_mfma_f32_16x16x32_bf16 v[132:135], v[32:35], v[180:183], v[132:135]
    ds_read_b64_tr_b16 v[62:63], v6 offset:54272
    v_mfma_f32_16x16x32_bf16 v[136:139], v[36:39], v[176:179], v[136:139]
    buffer_load_dwordx4 v[168:171], v2, s[4:7], s42 offen offset:2048 sc1
    ds_read_b64_tr_b16 v[32:33], v3 offset:57344
    v_mfma_f32_16x16x32_bf16 v[140:143], v[36:39], v[180:183], v[140:143]
    ds_read_b64_tr_b16 v[34:35], v3 offset:58368
    s_waitcnt lgkmcnt(10)
    v_mfma_f32_16x16x32_bf16 v[144:147], v[40:43], v[176:179], v[144:147]
    ds_read_b64_tr_b16 v[36:37], v4 offset:57344
    v_mfma_f32_16x16x32_bf16 v[148:151], v[40:43], v[180:183], v[148:151]
    ds_read_b64_tr_b16 v[38:39], v4 offset:58368
    v_mfma_f32_16x16x32_bf16 v[152:155], v[44:47], v[176:179], v[152:155]
    ds_read_b64_tr_b16 v[40:41], v5 offset:57344
    v_mfma_f32_16x16x32_bf16 v[156:159], v[44:47], v[180:183], v[156:159]
    ds_read_b64_tr_b16 v[42:43], v5 offset:58368
    s_waitcnt vmcnt(19) lgkmcnt(10)
    v_mfma_f32_16x16x32_bf16 v[64:67], v[48:51], v[184:187], v[64:67]
    ds_read_b64_tr_b16 v[44:45], v6 offset:57344
    v_mfma_f32_16x16x32_bf16 v[68:71], v[48:51], v[188:191], v[68:71]
    ds_read_b64_tr_b16 v[46:47], v6 offset:58368
    v_mfma_f32_16x16x32_bf16 v[72:75], v[52:55], v[184:187], v[72:75]
    ds_read_b64_tr_b16 v[48:49], v3 offset:61440
    v_mfma_f32_16x16x32_bf16 v[76:79], v[52:55], v[188:191], v[76:79]
    ds_read_b64_tr_b16 v[50:51], v3 offset:62464
    s_waitcnt lgkmcnt(10)
    v_mfma_f32_16x16x32_bf16 v[80:83], v[56:59], v[184:187], v[80:83]
    buffer_load_dwordx4 v[172:175], v2, s[4:7], s42 offen offset:2304 sc1
    ds_read_b64_tr_b16 v[52:53], v4 offset:61440
    s_add_u32 s42, s41, s97
    v_mfma_f32_16x16x32_bf16 v[84:87], v[56:59], v[188:191], v[84:87]
    ds_read_b64_tr_b16 v[54:55], v4 offset:62464
    v_mfma_f32_16x16x32_bf16 v[88:91], v[60:63], v[184:187], v[88:91]
    ds_read_b64_tr_b16 v[56:57], v5 offset:61440
    v_mfma_f32_16x16x32_bf16 v[92:95], v[60:63], v[188:191], v[92:95]
    ds_read_b64_tr_b16 v[58:59], v5 offset:62464
    s_waitcnt lgkmcnt(10)
    v_mfma_f32_16x16x32_bf16 v[96:99], v[184:187], v[32:35], v[96:99]
    ds_read_b64_tr_b16 v[60:61], v6 offset:61440
    v_mfma_f32_16x16x32_bf16 v[100:103], v[188:191], v[32:35], v[100:103]
    ds_read_b64_tr_b16 v[62:63], v6 offset:62464
    s_barrier
    v_xor_b32 v3, 0x10000, v3
    v_xor_b32 v4, 0x10000, v4
    v_xor_b32 v5, 0x10000, v5
    v_xor_b32 v6, 0x10000, v6
    v_mfma_f32_16x16x32_bf16 v[104:107], v[184:187], v[36:39], v[104:107]
    ds_read_b64_tr_b16 v[32:33], v3 offset:0
    v_mfma_f32_16x16x32_bf16 v[108:111], v[188:191], v[36:39], v[108:111]
    ds_read_b64_tr_b16 v[34:35], v3 offset:1024
    s_waitcnt lgkmcnt(10)
    v_mfma_f32_16x16x32_bf16 v[112:115], v[184:187], v[40:43], v[112:115]
    ds_read_b64_tr_b16 v[36:37], v4 offset:0
    v_mfma_f32_16x16x32_bf16 v[116:119], v[188:191], v[40:43], v[116:119]
    ds_read_b64_tr_b16 v[38:39], v4 offset:1024
    v_mfma_f32_16x16x32_bf16 v[120:123], v[184:187], v[44:47], v[120:123]
    ds_read_b64_tr_b16 v[40:41], v5 offset:0
    v_mfma_f32_16x16x32_bf16 v[124:127], v[188:191], v[44:47], v[124:127]
    ds_read_b64_tr_b16 v[42:43], v5 offset:1024
    s_waitcnt lgkmcnt(10)
    v_mfma_f32_16x16x32_bf16 v[128:131], v[48:51], v[184:187], v[128:131]
    ds_read_b64_tr_b16 v[44:45], v6 offset:0
    v_mfma_f32_16x16x32_bf16 v[132:135], v[48:51], v[188:191], v[132:135]
    ds_read_b64_tr_b16 v[46:47], v6 offset:1024
    v_mfma_f32_16x16x32_bf16 v[136:139], v[52:55], v[184:187], v[136:139]
    ds_read_b64_tr_b16 v[48:49], v3 offset:4096
    v_mfma_f32_16x16x32_bf16 v[140:143], v[52:55], v[188:191], v[140:143]
    ds_read_b64_tr_b16 v[50:51], v3 offset:5120
    s_waitcnt lgkmcnt(10)
    v_mfma_f32_16x16x32_bf16 v[144:147], v[56:59], v[184:187], v[144:147]
    ds_read_b64_tr_b16 v[52:53], v4 offset:4096
    v_mfma_f32_16x16x32_bf16 v[148:151], v[56:59], v[188:191], v[148:151]
    ds_read_b64_tr_b16 v[54:55], v4 offset:5120
    v_mfma_f32_16x16x32_bf16 v[152:155], v[60:63], v[184:187], v[152:155]
    ds_read_b64_tr_b16 v[56:57], v5 offset:4096
    v_mfma_f32_16x16x32_bf16 v[156:159], v[60:63], v[188:191], v[156:159]
    ds_read_b64_tr_b16 v[58:59], v5 offset:5120
    s_waitcnt vmcnt(18) lgkmcnt(10)
    v_mfma_f32_16x16x32_bf16 v[64:67], v[32:35], v[192:195], v[64:67]
    ds_read_b64_tr_b16 v[60:61], v6 offset:4096
    v_mfma_f32_16x16x32_bf16 v[68:71], v[32:35], v[196:199], v[68:71]
    ds_read_b64_tr_b16 v[62:63], v6 offset:5120
    v_mfma_f32_16x16x32_bf16 v[72:75], v[36:39], v[192:195], v[72:75]
    ds_read_b64_tr_b16 v[32:33], v3 offset:8192
    v_mfma_f32_16x16x32_bf16 v[76:79], v[36:39], v[196:199], v[76:79]
    ds_read_b64_tr_b16 v[34:35], v3 offset:9216
    s_waitcnt lgkmcnt(10)
    v_mfma_f32_16x16x32_bf16 v[80:83], v[40:43], v[192:195], v[80:83]
    ds_read_b64_tr_b16 v[36:37], v4 offset:8192
    v_mfma_f32_16x16x32_bf16 v[84:87], v[40:43], v[196:199], v[84:87]
    ds_read_b64_tr_b16 v[38:39], v4 offset:9216
    v_mfma_f32_16x16x32_bf16 v[88:91], v[44:47], v[192:195], v[88:91]
    ds_read_b64_tr_b16 v[40:41], v5 offset:8192
    v_mfma_f32_16x16x32_bf16 v[92:95], v[44:47], v[196:199], v[92:95]
    ds_read_b64_tr_b16 v[42:43], v5 offset:9216
    s_waitcnt lgkmcnt(10)
    v_mfma_f32_16x16x32_bf16 v[96:99], v[192:195], v[48:51], v[96:99]
    ds_read_b64_tr_b16 v[44:45], v6 offset:8192
    v_mfma_f32_16x16x32_bf16 v[100:103], v[196:199], v[48:51], v[100:103]
    ds_read_b64_tr_b16 v[46:47], v6 offset:9216
    v_mfma_f32_16x16x32_bf16 v[104:107], v[192:195], v[52:55], v[104:107]
    ds_read_b64_tr_b16 v[48:49], v3 offset:12288
    v_mfma_f32_16x16x32_bf16 v[108:111], v[196:199], v[52:55], v[108:111]
    ds_read_b64_tr_b16 v[50:51], v3 offset:13312
    s_waitcnt lgkmcnt(10)
    v_mfma_f32_16x16x32_bf16 v[112:115], v[192:195], v[56:59], v[112:115]
    ds_read_b64_tr_b16 v[52:53], v4 offset:12288
    v_mfma_f32_16x16x32_bf16 v[116:119], v[196:199], v[56:59], v[116:119]
    ds_read_b64_tr_b16 v[54:55], v4 offset:13312
    v_mfma_f32_16x16x32_bf16 v[120:123], v[192:195], v[60:63], v[120:123]
    ds_read_b64_tr_b16 v[56:57], v5 offset:12288
    v_mfma_f32_16x16x32_bf16 v[124:127], v[196:199], v[60:63], v[124:127]
    ds_read_b64_tr_b16 v[58:59], v5 offset:13312
    s_waitcnt lgkmcnt(10)
    v_mfma_f32_16x16x32_bf16 v[128:131], v[32:35], v[192:195], v[128:131]
    ds_read_b64_tr_b16 v[60:61], v6 offset:12288
    v_mfma_f32_16x16x32_bf16 v[132:135], v[32:35], v[196:199], v[132:135]
    ds_read_b64_tr_b16 v[62:63], v6 offset:13312
    v_mfma_f32_16x16x32_bf16 v[136:139], v[36:39], v[192:195], v[136:139]
    ds_read_b64_tr_b16 v[32:33], v3 offset:16384
    v_mfma_f32_16x16x32_bf16 v[140:143], v[36:39], v[196:199], v[140:143]
    ds_read_b64_tr_b16 v[34:35], v3 offset:17408
    s_waitcnt lgkmcnt(10)
    v_mfma_f32_16x16x32_bf16 v[144:147], v[40:43], v[192:195], v[144:147]
    ds_read_b64_tr_b16 v[36:37], v4 offset:16384
    v_mfma_f32_16x16x32_bf16 v[148:151], v[40:43], v[196:199], v[148:151]
    ds_read_b64_tr_b16 v[38:39], v4 offset:17408
    v_mfma_f32_16x16x32_bf16 v[152:155], v[44:47], v[192:195], v[152:155]
    ds_read_b64_tr_b16 v[40:41], v5 offset:16384
    v_mfma_f32_16x16x32_bf16 v[156:159], v[44:47], v[196:199], v[156:159]
    ds_read_b64_tr_b16 v[42:43], v5 offset:17408
    s_waitcnt vmcnt(16) lgkmcnt(10)
    v_mfma_f32_16x16x32_bf16 v[64:67], v[48:51], v[200:203], v[64:67]
    buffer_load_dwordx4 v[176:179], v2, s[4:7], s42 offen offset:0 sc1
    ds_read_b64_tr_b16 v[44:45], v6 offset:16384
    v_mfma_f32_16x16x32_bf16 v[68:71], v[48:51], v[204:207], v[68:71]
    ds_read_b64_tr_b16 v[46:47], v6 offset:17408
    v_mfma_f32_16x16x32_bf16 v[72:75], v[52:55], v[200:203], v[72:75]
    buffer_load_dwordx4 v[180:183], v2, s[4:7], s42 offen offset:256 sc1
    ds_read_b64_tr_b16 v[48:49], v3 offset:20480
    v_mfma_f32_16x16x32_bf16 v[76:79], v[52:55], v[204:207], v[76:79]
    ds_read_b64_tr_b16 v[50:51], v3 offset:21504
    s_waitcnt lgkmcnt(10)
    v_mfma_f32_16x16x32_bf16 v[80:83], v[56:59], v[200:203], v[80:83]
    buffer_load_dwordx4 v[184:187], v2, s[4:7], s42 offen offset:2048 sc1
    ds_read_b64_tr_b16 v[52:53], v4 offset:20480
    v_mfma_f32_16x16x32_bf16 v[84:87], v[56:59], v[204:207], v[84:87]
    ds_read_b64_tr_b16 v[54:55], v4 offset:21504
    v_mfma_f32_16x16x32_bf16 v[88:91], v[60:63], v[200:203], v[88:91]
    buffer_load_dwordx4 v[188:191], v2, s[4:7], s42 offen offset:2304 sc1
    ds_read_b64_tr_b16 v[56:57], v5 offset:20480
    s_add_u32 s42, s41, s98
    v_mfma_f32_16x16x32_bf16 v[92:95], v[60:63], v[204:207], v[92:95]
    ds_read_b64_tr_b16 v[58:59], v5 offset:21504
    s_waitcnt lgkmcnt(10)
    v_mfma_f32_16x16x32_bf16 v[96:99], v[200:203], v[32:35], v[96:99]
    ds_read_b64_tr_b16 v[60:61], v6 offset:20480
    buffer_load_dwordx4 v[192:195], v2, s[4:7], s42 offen offset:0 sc1
    v_mfma_f32_16x16x32_bf16 v[100:103], v[204:207], v[32:35], v[100:103]
    ds_read_b64_tr_b16 v[62:63], v6 offset:21504
    v_mfma_f32_16x16x32_bf16 v[104:107], v[200:203], v[36:39], v[104:107]
    ds_read_b64_tr_b16 v[32:33], v3 offset:24576
    v_mfma_f32_16x16x32_bf16 v[108:111], v[204:207], v[36:39], v[108:111]
    ds_read_b64_tr_b16 v[34:35], v3 offset:25600
    s_waitcnt lgkmcnt(10)
    v_mfma_f32_16x16x32_bf16 v[112:115], v[200:203], v[40:43], v[112:115]
    ds_read_b64_tr_b16 v[36:37], v4 offset:24576
    v_mfma_f32_16x16x32_bf16 v[116:119], v[204:207], v[40:43], v[116:119]
    ds_read_b64_tr_b16 v[38:39], v4 offset:25600
    v_mfma_f32_16x16x32_bf16 v[120:123], v[200:203], v[44:47], v[120:123]
    buffer_load_dwordx4 v[196:199], v2, s[4:7], s42 offen offset:256 sc1
    ds_read_b64_tr_b16 v[40:41], v5 offset:24576
    v_mfma_f32_16x16x32_bf16 v[124:127], v[204:207], v[44:47], v[124:127]
    ds_read_b64_tr_b16 v[42:43], v5 offset:25600
    s_waitcnt lgkmcnt(10)
    v_mfma_f32_16x16x32_bf16 v[128:131], v[48:51], v[200:203], v[128:131]
    ds_read_b64_tr_b16 v[44:45], v6 offset:24576
    v_mfma_f32_16x16x32_bf16 v[132:135], v[48:51], v[204:207], v[132:135]
    ds_read_b64_tr_b16 v[46:47], v6 offset:25600
    v_mfma_f32_16x16x32_bf16 v[136:139], v[52:55], v[200:203], v[136:139]
    ds_read_b64_tr_b16 v[48:49], v3 offset:28672
    v_mfma_f32_16x16x32_bf16 v[140:143], v[52:55], v[204:207], v[140:143]
    ds_read_b64_tr_b16 v[50:51], v3 offset:29696
    s_waitcnt lgkmcnt(10)
    v_mfma_f32_16x16x32_bf16 v[144:147], v[56:59], v[200:203], v[144:147]
    ds_read_b64_tr_b16 v[52:53], v4 offset:28672
    v_mfma_f32_16x16x32_bf16 v[148:151], v[56:59], v[204:207], v[148:151]
    ds_read_b64_tr_b16 v[54:55], v4 offset:29696
    v_mfma_f32_16x16x32_bf16 v[152:155], v[60:63], v[200:203], v[152:155]
    ds_read_b64_tr_b16 v[56:57], v5 offset:28672
    v_mfma_f32_16x16x32_bf16 v[156:159], v[60:63], v[204:207], v[156:159]
    ds_read_b64_tr_b16 v[58:59], v5 offset:29696
    s_waitcnt vmcnt(20) lgkmcnt(10)
    v_mfma_f32_16x16x32_bf16 v[64:67], v[32:35], v[208:211], v[64:67]
    ds_read_b64_tr_b16 v[60:61], v6 offset:28672
    v_mfma_f32_16x16x32_bf16 v[68:71], v[32:35], v[212:215], v[68:71]
    ds_read_b64_tr_b16 v[62:63], v6 offset:29696
    s_barrier
    v_mfma_f32_16x16x32_bf16 v[72:75], v[36:39], v[208:211], v[72:75]
    ds_read_b64_tr_b16 v[32:33], v3 offset:32768
    v_mfma_f32_16x16x32_bf16 v[76:79], v[36:39], v[212:215], v[76:79]
    ds_read_b64_tr_b16 v[34:35], v3 offset:33792
    s_waitcnt lgkmcnt(10)
    v_mfma_f32_16x16x32_bf16 v[80:83], v[40:43], v[208:211], v[80:83]
    ds_read_b64_tr_b16 v[36:37], v4 offset:32768
    v_mfma_f32_16x16x32_bf16 v[84:87], v[40:43], v[212:215], v[84:87]
    ds_read_b64_tr_b16 v[38:39], v4 offset:33792
    v_mfma_f32_16x16x32_bf16 v[88:91], v[44:47], v[208:211], v[88:91]
    ds_read_b64_tr_b16 v[40:41], v5 offset:32768
    v_mfma_f32_16x16x32_bf16 v[92:95], v[44:47], v[212:215], v[92:95]
    ds_read_b64_tr_b16 v[42:43], v5 offset:33792
    s_waitcnt lgkmcnt(10)
    v_mfma_f32_16x16x32_bf16 v[96:99], v[208:211], v[48:51], v[96:99]
    ds_read_b64_tr_b16 v[44:45], v6 offset:32768
    v_mfma_f32_16x16x32_bf16 v[100:103], v[212:215], v[48:51], v[100:103]
    ds_read_b64_tr_b16 v[46:47], v6 offset:33792
    v_mfma_f32_16x16x32_bf16 v[104:107], v[208:211], v[52:55], v[104:107]
    ds_read_b64_tr_b16 v[48:49], v3 offset:36864
    v_mfma_f32_16x16x32_bf16 v[108:111], v[212:215], v[52:55], v[108:111]
    ds_read_b64_tr_b16 v[50:51], v3 offset:37888
    s_waitcnt lgkmcnt(10)
    v_mfma_f32_16x16x32_bf16 v[112:115], v[208:211], v[56:59], v[112:115]
    ds_read_b64_tr_b16 v[52:53], v4 offset:36864
    v_mfma_f32_16x16x32_bf16 v[116:119], v[212:215], v[56:59], v[116:119]
    ds_read_b64_tr_b16 v[54:55], v4 offset:37888
    v_mfma_f32_16x16x32_bf16 v[120:123], v[208:211], v[60:63], v[120:123]
    ds_read_b64_tr_b16 v[56:57], v5 offset:36864
    v_mfma_f32_16x16x32_bf16 v[124:127], v[212:215], v[60:63], v[124:127]
    ds_read_b64_tr_b16 v[58:59], v5 offset:37888
    s_waitcnt lgkmcnt(10)
    v_mfma_f32_16x16x32_bf16 v[128:131], v[32:35], v[208:211], v[128:131]
    ds_read_b64_tr_b16 v[60:61], v6 offset:36864
    v_mfma_f32_16x16x32_bf16 v[132:135], v[32:35], v[212:215], v[132:135]
    ds_read_b64_tr_b16 v[62:63], v6 offset:37888
    v_mfma_f32_16x16x32_bf16 v[136:139], v[36:39], v[208:211], v[136:139]
    ds_read_b64_tr_b16 v[32:33], v3 offset:40960
    v_mfma_f32_16x16x32_bf16 v[140:143], v[36:39], v[212:215], v[140:143]
    ds_read_b64_tr_b16 v[34:35], v3 offset:41984
    s_waitcnt lgkmcnt(10)
    v_mfma_f32_16x16x32_bf16 v[144:147], v[40:43], v[208:211], v[144:147]
    ds_read_b64_tr_b16 v[36:37], v4 offset:40960
    v_mfma_f32_16x16x32_bf16 v[148:151], v[40:43], v[212:215], v[148:151]
    ds_read_b64_tr_b16 v[38:39], v4 offset:41984
    v_mfma_f32_16x16x32_bf16 v[152:155], v[44:47], v[208:211], v[152:155]
    ds_read_b64_tr_b16 v[40:41], v5 offset:40960
    v_mfma_f32_16x16x32_bf16 v[156:159], v[44:47], v[212:215], v[156:159]
    ds_read_b64_tr_b16 v[42:43], v5 offset:41984
    s_waitcnt vmcnt(18) lgkmcnt(10)
    v_mfma_f32_16x16x32_bf16 v[64:67], v[48:51], v[216:219], v[64:67]
    ds_read_b64_tr_b16 v[44:45], v6 offset:40960
    v_mfma_f32_16x16x32_bf16 v[68:71], v[48:51], v[220:223], v[68:71]
    ds_read_b64_tr_b16 v[46:47], v6 offset:41984
    v_mfma_f32_16x16x32_bf16 v[72:75], v[52:55], v[216:219], v[72:75]
    ds_read_b64_tr_b16 v[48:49], v3 offset:45056
    v_mfma_f32_16x16x32_bf16 v[76:79], v[52:55], v[220:223], v[76:79]
    ds_read_b64_tr_b16 v[50:51], v3 offset:46080
    s_waitcnt lgkmcnt(10)
    v_mfma_f32_16x16x32_bf16 v[80:83], v[56:59], v[216:219], v[80:83]
    ds_read_b64_tr_b16 v[52:53], v4 offset:45056
    v_mfma_f32_16x16x32_bf16 v[84:87], v[56:59], v[220:223], v[84:87]
    ds_read_b64_tr_b16 v[54:55], v4 offset:46080
    v_mfma_f32_16x16x32_bf16 v[88:91], v[60:63], v[216:219], v[88:91]
    ds_read_b64_tr_b16 v[56:57], v5 offset:45056
    v_mfma_f32_16x16x32_bf16 v[92:95], v[60:63], v[220:223], v[92:95]
    ds_read_b64_tr_b16 v[58:59], v5 offset:46080
    s_waitcnt lgkmcnt(10)
    v_mfma_f32_16x16x32_bf16 v[96:99], v[216:219], v[32:35], v[96:99]
    ds_read_b64_tr_b16 v[60:61], v6 offset:45056
    v_mfma_f32_16x16x32_bf16 v[100:103], v[220:223], v[32:35], v[100:103]
    ds_read_b64_tr_b16 v[62:63], v6 offset:46080
    v_mfma_f32_16x16x32_bf16 v[104:107], v[216:219], v[36:39], v[104:107]
    ds_read_b64_tr_b16 v[32:33], v3 offset:49152
    v_mfma_f32_16x16x32_bf16 v[108:111], v[220:223], v[36:39], v[108:111]
    ds_read_b64_tr_b16 v[34:35], v3 offset:50176
    s_waitcnt lgkmcnt(10)
    v_mfma_f32_16x16x32_bf16 v[112:115], v[216:219], v[40:43], v[112:115]
    ds_read_b64_tr_b16 v[36:37], v4 offset:49152
    v_mfma_f32_16x16x32_bf16 v[116:119], v[220:223], v[40:43], v[116:119]
    ds_read_b64_tr_b16 v[38:39], v4 offset:50176
    v_mfma_f32_16x16x32_bf16 v[120:123], v[216:219], v[44:47], v[120:123]
    ds_read_b64_tr_b16 v[40:41], v5 offset:49152
    v_mfma_f32_16x16x32_bf16 v[124:127], v[220:223], v[44:47], v[124:127]
    ds_read_b64_tr_b16 v[42:43], v5 offset:50176
    s_waitcnt lgkmcnt(10)
    v_mfma_f32_16x16x32_bf16 v[128:131], v[48:51], v[216:219], v[128:131]
    buffer_load_dwordx4 v[200:203], v2, s[4:7], s42 offen offset:2048 sc1
    ds_read_b64_tr_b16 v[44:45], v6 offset:49152
    v_mfma_f32_16x16x32_bf16 v[132:135], v[48:51], v[220:223], v[132:135]
    ds_read_b64_tr_b16 v[46:47], v6 offset:50176
    v_mfma_f32_16x16x32_bf16 v[136:139], v[52:55], v[216:219], v[136:139]
    buffer_load_dwordx4 v[204:207], v2, s[4:7], s42 offen offset:2304 sc1
    ds_read_b64_tr_b16 v[48:49], v3 offset:53248
    s_add_u32 s42, s41, s99
    v_mfma_f32_16x16x32_bf16 v[140:143], v[52:55], v[220:223], v[140:143]
    ds_read_b64_tr_b16 v[50:51], v3 offset:54272
    s_waitcnt lgkmcnt(10)
    v_mfma_f32_16x16x32_bf16 v[144:147], v[56:59], v[216:219], v[144:147]
    buffer_load_dwordx4 v[208:211], v2, s[4:7], s42 offen offset:0 sc1
    ds_read_b64_tr_b16 v[52:53], v4 offset:53248
    v_mfma_f32_16x16x32_bf16 v[148:151], v[56:59], v[220:223], v[148:151]
    ds_read_b64_tr_b16 v[54:55], v4 offset:54272
    v_mfma_f32_16x16x32_bf16 v[152:155], v[60:63], v[216:219], v[152:155]
    buffer_load_dwordx4 v[212:215], v2, s[4:7], s42 offen offset:256 sc1
    ds_read_b64_tr_b16 v[56:57], v5 offset:53248
    v_mfma_f32_16x16x32_bf16 v[156:159], v[60:63], v[220:223], v[156:159]
    ds_read_b64_tr_b16 v[58:59], v5 offset:54272
    s_waitcnt vmcnt(20) lgkmcnt(10)
    v_mfma_f32_16x16x32_bf16 v[64:67], v[32:35], v[224:227], v[64:67]
    ds_read_b64_tr_b16 v[60:61], v6 offset:53248
    buffer_load_dwordx4 v[216:219], v2, s[4:7], s42 offen offset:2048 sc1
    v_mfma_f32_16x16x32_bf16 v[68:71], v[32:35], v[228:231], v[68:71]
    ds_read_b64_tr_b16 v[62:63], v6 offset:54272
    v_mfma_f32_16x16x32_bf16 v[72:75], v[36:39], v[224:227], v[72:75]
    buffer_load_dwordx4 v[220:223], v2, s[4:7], s42 offen offset:2304 sc1
    ds_read_b64_tr_b16 v[32:33], v3 offset:57344
    v_mfma_f32_16x16x32_bf16 v[76:79], v[36:39], v[228:231], v[76:79]
    ds_read_b64_tr_b16 v[34:35], v3 offset:58368
    s_waitcnt lgkmcnt(10)
    v_mfma_f32_16x16x32_bf16 v[80:83], v[40:43], v[224:227], v[80:83]
    ds_read_b64_tr_b16 v[36:37], v4 offset:57344
    v_mfma_f32_16x16x32_bf16 v[84:87], v[40:43], v[228:231], v[84:87]
    ds_read_b64_tr_b16 v[38:39], v4 offset:58368
    v_mfma_f32_16x16x32_bf16 v[88:91], v[44:47], v[224:227], v[88:91]
    ds_read_b64_tr_b16 v[40:41], v5 offset:57344
    v_mfma_f32_16x16x32_bf16 v[92:95], v[44:47], v[228:231], v[92:95]
    ds_read_b64_tr_b16 v[42:43], v5 offset:58368
    s_waitcnt lgkmcnt(10)
    v_mfma_f32_16x16x32_bf16 v[96:99], v[224:227], v[48:51], v[96:99]
    ds_read_b64_tr_b16 v[44:45], v6 offset:57344
    v_mfma_f32_16x16x32_bf16 v[100:103], v[228:231], v[48:51], v[100:103]
    ds_read_b64_tr_b16 v[46:47], v6 offset:58368
    v_mfma_f32_16x16x32_bf16 v[104:107], v[224:227], v[52:55], v[104:107]
    ds_read_b64_tr_b16 v[48:49], v3 offset:61440
    v_mfma_f32_16x16x32_bf16 v[108:111], v[228:231], v[52:55], v[108:111]
    ds_read_b64_tr_b16 v[50:51], v3 offset:62464
    s_waitcnt lgkmcnt(10)
    v_mfma_f32_16x16x32_bf16 v[112:115], v[224:227], v[56:59], v[112:115]
    ds_read_b64_tr_b16 v[52:53], v4 offset:61440
    v_mfma_f32_16x16x32_bf16 v[116:119], v[228:231], v[56:59], v[116:119]
    ds_read_b64_tr_b16 v[54:55], v4 offset:62464
    v_mfma_f32_16x16x32_bf16 v[120:123], v[224:227], v[60:63], v[120:123]
    ds_read_b64_tr_b16 v[56:57], v5 offset:61440
    v_mfma_f32_16x16x32_bf16 v[124:127], v[228:231], v[60:63], v[124:127]
    ds_read_b64_tr_b16 v[58:59], v5 offset:62464
    s_waitcnt vmcnt(20) lgkmcnt(10)
    v_mfma_f32_16x16x32_bf16 v[64:67], v[32:35], v[232:235], v[64:67]
    ds_read_b64_tr_b16 v[60:61], v6 offset:61440
    v_mfma_f32_16x16x32_bf16 v[68:71], v[32:35], v[236:239], v[68:71]
    ds_read_b64_tr_b16 v[62:63], v6 offset:62464
    s_barrier
    v_xor_b32 v3, 0x10000, v3
    v_xor_b32 v4, 0x10000, v4
    v_xor_b32 v5, 0x10000, v5
    v_xor_b32 v6, 0x10000, v6
    v_mfma_f32_16x16x32_bf16 v[72:75], v[36:39], v[232:235], v[72:75]
    ds_read_b64_tr_b16 v[32:33], v3 offset:0
    v_mfma_f32_16x16x32_bf16 v[76:79], v[36:39], v[236:239], v[76:79]
    ds_read_b64_tr_b16 v[34:35], v3 offset:1024
    s_waitcnt lgkmcnt(10)
    v_mfma_f32_16x16x32_bf16 v[80:83], v[40:43], v[232:235], v[80:83]
    ds_read_b64_tr_b16 v[36:37], v4 offset:0
    v_mfma_f32_16x16x32_bf16 v[84:87], v[40:43], v[236:239], v[84:87]
    ds_read_b64_tr_b16 v[38:39], v4 offset:1024
    v_mfma_f32_16x16x32_bf16 v[88:91], v[44:47], v[232:235], v[88:91]
    ds_read_b64_tr_b16 v[40:41], v5 offset:0
    v_mfma_f32_16x16x32_bf16 v[92:95], v[44:47], v[236:239], v[92:95]
    ds_read_b64_tr_b16 v[42:43], v5 offset:1024
    s_waitcnt lgkmcnt(10)
    v_mfma_f32_16x16x32_bf16 v[96:99], v[232:235], v[48:51], v[96:99]
    ds_read_b64_tr_b16 v[44:45], v6 offset:0
    v_mfma_f32_16x16x32_bf16 v[100:103], v[236:239], v[48:51], v[100:103]
    ds_read_b64_tr_b16 v[46:47], v6 offset:1024
    v_mfma_f32_16x16x32_bf16 v[104:107], v[232:235], v[52:55], v[104:107]
    ds_read_b64_tr_b16 v[48:49], v3 offset:4096
    v_mfma_f32_16x16x32_bf16 v[108:111], v[236:239], v[52:55], v[108:111]
    ds_read_b64_tr_b16 v[50:51], v3 offset:5120
    s_waitcnt lgkmcnt(10)
    v_mfma_f32_16x16x32_bf16 v[112:115], v[232:235], v[56:59], v[112:115]
    ds_read_b64_tr_b16 v[52:53], v4 offset:4096
    v_mfma_f32_16x16x32_bf16 v[116:119], v[236:239], v[56:59], v[116:119]
    ds_read_b64_tr_b16 v[54:55], v4 offset:5120
    v_mfma_f32_16x16x32_bf16 v[120:123], v[232:235], v[60:63], v[120:123]
    ds_read_b64_tr_b16 v[56:57], v5 offset:4096
    v_mfma_f32_16x16x32_bf16 v[124:127], v[236:239], v[60:63], v[124:127]
    ds_read_b64_tr_b16 v[58:59], v5 offset:5120
    s_waitcnt vmcnt(18) lgkmcnt(10)
    v_mfma_f32_16x16x32_bf16 v[64:67], v[32:35], v[240:243], v[64:67]
    ds_read_b64_tr_b16 v[60:61], v6 offset:4096
    v_mfma_f32_16x16x32_bf16 v[68:71], v[32:35], v[244:247], v[68:71]
    ds_read_b64_tr_b16 v[62:63], v6 offset:5120
    v_mfma_f32_16x16x32_bf16 v[72:75], v[36:39], v[240:243], v[72:75]
    ds_read_b64_tr_b16 v[32:33], v3 offset:8192
    v_mfma_f32_16x16x32_bf16 v[76:79], v[36:39], v[244:247], v[76:79]
    ds_read_b64_tr_b16 v[34:35], v3 offset:9216
    s_waitcnt lgkmcnt(10)
    v_mfma_f32_16x16x32_bf16 v[80:83], v[40:43], v[240:243], v[80:83]
    ds_read_b64_tr_b16 v[36:37], v4 offset:8192
    v_mfma_f32_16x16x32_bf16 v[84:87], v[40:43], v[244:247], v[84:87]
    ds_read_b64_tr_b16 v[38:39], v4 offset:9216
    v_mfma_f32_16x16x32_bf16 v[88:91], v[44:47], v[240:243], v[88:91]
    ds_read_b64_tr_b16 v[40:41], v5 offset:8192
    v_mfma_f32_16x16x32_bf16 v[92:95], v[44:47], v[244:247], v[92:95]
    ds_read_b64_tr_b16 v[42:43], v5 offset:9216
    s_waitcnt lgkmcnt(10)
    v_mfma_f32_16x16x32_bf16 v[96:99], v[240:243], v[48:51], v[96:99]
    ds_read_b64_tr_b16 v[44:45], v6 offset:8192
    v_mfma_f32_16x16x32_bf16 v[100:103], v[244:247], v[48:51], v[100:103]
    ds_read_b64_tr_b16 v[46:47], v6 offset:9216
    v_mfma_f32_16x16x32_bf16 v[104:107], v[240:243], v[52:55], v[104:107]
    ds_read_b64_tr_b16 v[48:49], v3 offset:12288
    v_mfma_f32_16x16x32_bf16 v[108:111], v[244:247], v[52:55], v[108:111]
    ds_read_b64_tr_b16 v[50:51], v3 offset:13312
    s_waitcnt lgkmcnt(10)
    v_mfma_f32_16x16x32_bf16 v[112:115], v[240:243], v[56:59], v[112:115]
    ds_read_b64_tr_b16 v[52:53], v4 offset:12288
    v_mfma_f32_16x16x32_bf16 v[116:119], v[244:247], v[56:59], v[116:119]
    ds_read_b64_tr_b16 v[54:55], v4 offset:13312
    v_mfma_f32_16x16x32_bf16 v[120:123], v[240:243], v[60:63], v[120:123]
    ds_read_b64_tr_b16 v[56:57], v5 offset:12288
    v_mfma_f32_16x16x32_bf16 v[124:127], v[244:247], v[60:63], v[124:127]
    ds_read_b64_tr_b16 v[58:59], v5 offset:13312
    s_waitcnt vmcnt(16) lgkmcnt(10)
    v_mfma_f32_16x16x32_bf16 v[64:67], v[32:35], v[248:251], v[64:67]
    ds_read_b64_tr_b16 v[60:61], v6 offset:12288
    v_mfma_f32_16x16x32_bf16 v[68:71], v[32:35], v[252:255], v[68:71]
    ds_read_b64_tr_b16 v[62:63], v6 offset:13312
    v_mfma_f32_16x16x32_bf16 v[72:75], v[36:39], v[248:251], v[72:75]
    ds_read_b64_tr_b16 v[32:33], v3 offset:16384
    v_mfma_f32_16x16x32_bf16 v[76:79], v[36:39], v[252:255], v[76:79]
    ds_read_b64_tr_b16 v[34:35], v3 offset:17408
    s_waitcnt lgkmcnt(10)
    v_mfma_f32_16x16x32_bf16 v[80:83], v[40:43], v[248:251], v[80:83]
    ds_read_b64_tr_b16 v[36:37], v4 offset:16384
    v_mfma_f32_16x16x32_bf16 v[84:87], v[40:43], v[252:255], v[84:87]
    ds_read_b64_tr_b16 v[38:39], v4 offset:17408
    v_mfma_f32_16x16x32_bf16 v[88:91], v[44:47], v[248:251], v[88:91]
    ds_read_b64_tr_b16 v[40:41], v5 offset:16384
    v_mfma_f32_16x16x32_bf16 v[92:95], v[44:47], v[252:255], v[92:95]
    ds_read_b64_tr_b16 v[42:43], v5 offset:17408
    s_waitcnt lgkmcnt(10)
    v_mfma_f32_16x16x32_bf16 v[96:99], v[248:251], v[48:51], v[96:99]
    ds_read_b64_tr_b16 v[44:45], v6 offset:16384
    v_mfma_f32_16x16x32_bf16 v[100:103], v[252:255], v[48:51], v[100:103]
    ds_read_b64_tr_b16 v[46:47], v6 offset:17408
    v_mfma_f32_16x16x32_bf16 v[104:107], v[248:251], v[52:55], v[104:107]
    ds_read_b64_tr_b16 v[48:49], v3 offset:20480
    v_mfma_f32_16x16x32_bf16 v[108:111], v[252:255], v[52:55], v[108:111]
    ds_read_b64_tr_b16 v[50:51], v3 offset:21504
    s_waitcnt lgkmcnt(10)
    v_mfma_f32_16x16x32_bf16 v[112:115], v[248:251], v[56:59], v[112:115]
    ds_read_b64_tr_b16 v[52:53], v4 offset:20480
    v_mfma_f32_16x16x32_bf16 v[116:119], v[252:255], v[56:59], v[116:119]
    ds_read_b64_tr_b16 v[54:55], v4 offset:21504
    v_mfma_f32_16x16x32_bf16 v[120:123], v[248:251], v[60:63], v[120:123]
    ds_read_b64_tr_b16 v[56:57], v5 offset:20480
    v_mfma_f32_16x16x32_bf16 v[124:127], v[252:255], v[60:63], v[124:127]
    ds_read_b64_tr_b16 v[58:59], v5 offset:21504
    s_waitcnt vmcnt(14) lgkmcnt(10)
    v_mfma_f32_16x16x32_bf16 v[64:67], v[32:35], v[160:163], v[64:67]
    ds_read_b64_tr_b16 v[60:61], v6 offset:20480
    v_mfma_f32_16x16x32_bf16 v[68:71], v[32:35], v[164:167], v[68:71]
    ds_read_b64_tr_b16 v[62:63], v6 offset:21504
    v_mfma_f32_16x16x32_bf16 v[72:75], v[36:39], v[160:163], v[72:75]
    ds_read_b64_tr_b16 v[32:33], v3 offset:24576
    v_mfma_f32_16x16x32_bf16 v[76:79], v[36:39], v[164:167], v[76:79]
    ds_read_b64_tr_b16 v[34:35], v3 offset:25600
    s_waitcnt lgkmcnt(10)
    v_mfma_f32_16x16x32_bf16 v[80:83], v[40:43], v[160:163], v[80:83]
    ds_read_b64_tr_b16 v[36:37], v4 offset:24576
    v_mfma_f32_16x16x32_bf16 v[84:87], v[40:43], v[164:167], v[84:87]
    ds_read_b64_tr_b16 v[38:39], v4 offset:25600
    v_mfma_f32_16x16x32_bf16 v[88:91], v[44:47], v[160:163], v[88:91]
    ds_read_b64_tr_b16 v[40:41], v5 offset:24576
    v_mfma_f32_16x16x32_bf16 v[92:95], v[44:47], v[164:167], v[92:95]
    ds_read_b64_tr_b16 v[42:43], v5 offset:25600
    s_waitcnt vmcnt(12) lgkmcnt(10)
    v_mfma_f32_16x16x32_bf16 v[64:67], v[48:51], v[168:171], v[64:67]
    ds_read_b64_tr_b16 v[44:45], v6 offset:24576
    v_mfma_f32_16x16x32_bf16 v[68:71], v[48:51], v[172:175], v[68:71]
    ds_read_b64_tr_b16 v[46:47], v6 offset:25600
    v_mfma_f32_16x16x32_bf16 v[72:75], v[52:55], v[168:171], v[72:75]
    ds_read_b64_tr_b16 v[48:49], v3 offset:28672
    v_mfma_f32_16x16x32_bf16 v[76:79], v[52:55], v[172:175], v[76:79]
    ds_read_b64_tr_b16 v[50:51], v3 offset:29696
    s_waitcnt lgkmcnt(10)
    v_mfma_f32_16x16x32_bf16 v[80:83], v[56:59], v[168:171], v[80:83]
    ds_read_b64_tr_b16 v[52:53], v4 offset:28672
    v_mfma_f32_16x16x32_bf16 v[84:87], v[56:59], v[172:175], v[84:87]
    ds_read_b64_tr_b16 v[54:55], v4 offset:29696
    v_mfma_f32_16x16x32_bf16 v[88:91], v[60:63], v[168:171], v[88:91]
    ds_read_b64_tr_b16 v[56:57], v5 offset:28672
    v_mfma_f32_16x16x32_bf16 v[92:95], v[60:63], v[172:175], v[92:95]
    ds_read_b64_tr_b16 v[58:59], v5 offset:29696
    s_waitcnt vmcnt(10) lgkmcnt(10)
    v_mfma_f32_16x16x32_bf16 v[64:67], v[32:35], v[176:179], v[64:67]
    ds_read_b64_tr_b16 v[60:61], v6 offset:28672
    v_mfma_f32_16x16x32_bf16 v[68:71], v[32:35], v[180:183], v[68:71]
    ds_read_b64_tr_b16 v[62:63], v6 offset:29696
    s_barrier
    v_mfma_f32_16x16x32_bf16 v[72:75], v[36:39], v[176:179], v[72:75]
    ds_read_b64_tr_b16 v[32:33], v3 offset:32768
    v_mfma_f32_16x16x32_bf16 v[76:79], v[36:39], v[180:183], v[76:79]
    ds_read_b64_tr_b16 v[34:35], v3 offset:33792
    s_waitcnt lgkmcnt(10)
    v_mfma_f32_16x16x32_bf16 v[80:83], v[40:43], v[176:179], v[80:83]
    ds_read_b64_tr_b16 v[36:37], v4 offset:32768
    v_mfma_f32_16x16x32_bf16 v[84:87], v[40:43], v[180:183], v[84:87]
    ds_read_b64_tr_b16 v[38:39], v4 offset:33792
    v_mfma_f32_16x16x32_bf16 v[88:91], v[44:47], v[176:179], v[88:91]
    ds_read_b64_tr_b16 v[40:41], v5 offset:32768
    v_mfma_f32_16x16x32_bf16 v[92:95], v[44:47], v[180:183], v[92:95]
    ds_read_b64_tr_b16 v[42:43], v5 offset:33792
    s_waitcnt vmcnt(8) lgkmcnt(10)
    v_mfma_f32_16x16x32_bf16 v[64:67], v[48:51], v[184:187], v[64:67]
    ds_read_b64_tr_b16 v[44:45], v6 offset:32768
    v_mfma_f32_16x16x32_bf16 v[68:71], v[48:51], v[188:191], v[68:71]
    ds_read_b64_tr_b16 v[46:47], v6 offset:33792
    v_mfma_f32_16x16x32_bf16 v[72:75], v[52:55], v[184:187], v[72:75]
    ds_read_b64_tr_b16 v[48:49], v3 offset:36864
    v_mfma_f32_16x16x32_bf16 v[76:79], v[52:55], v[188:191], v[76:79]
    ds_read_b64_tr_b16 v[50:51], v3 offset:37888
    s_waitcnt lgkmcnt(10)
    v_mfma_f32_16x16x32_bf16 v[80:83], v[56:59], v[184:187], v[80:83]
    ds_read_b64_tr_b16 v[52:53], v4 offset:36864
    v_mfma_f32_16x16x32_bf16 v[84:87], v[56:59], v[188:191], v[84:87]
    ds_read_b64_tr_b16 v[54:55], v4 offset:37888
    v_mfma_f32_16x16x32_bf16 v[88:91], v[60:63], v[184:187], v[88:91]
    ds_read_b64_tr_b16 v[56:57], v5 offset:36864
    v_mfma_f32_16x16x32_bf16 v[92:95], v[60:63], v[188:191], v[92:95]
    ds_read_b64_tr_b16 v[58:59], v5 offset:37888
    s_waitcnt vmcnt(6) lgkmcnt(10)
    v_mfma_f32_16x16x32_bf16 v[64:67], v[32:35], v[192:195], v[64:67]
    ds_read_b64_tr_b16 v[60:61], v6 offset:36864
    v_mfma_f32_16x16x32_bf16 v[68:71], v[32:35], v[196:199], v[68:71]
    ds_read_b64_tr_b16 v[62:63], v6 offset:37888
    v_mfma_f32_16x16x32_bf16 v[72:75], v[36:39], v[192:195], v[72:75]
    ds_read_b64_tr_b16 v[32:33], v3 offset:40960
    v_mfma_f32_16x16x32_bf16 v[76:79], v[36:39], v[196:199], v[76:79]
    ds_read_b64_tr_b16 v[34:35], v3 offset:41984
    s_waitcnt lgkmcnt(10)
    v_mfma_f32_16x16x32_bf16 v[80:83], v[40:43], v[192:195], v[80:83]
    ds_read_b64_tr_b16 v[36:37], v4 offset:40960
    v_mfma_f32_16x16x32_bf16 v[84:87], v[40:43], v[196:199], v[84:87]
    ds_read_b64_tr_b16 v[38:39], v4 offset:41984
    v_mfma_f32_16x16x32_bf16 v[88:91], v[44:47], v[192:195], v[88:91]
    ds_read_b64_tr_b16 v[40:41], v5 offset:40960
    v_mfma_f32_16x16x32_bf16 v[92:95], v[44:47], v[196:199], v[92:95]
    ds_read_b64_tr_b16 v[42:43], v5 offset:41984
    s_waitcnt vmcnt(4) lgkmcnt(10)
    v_mfma_f32_16x16x32_bf16 v[64:67], v[48:51], v[200:203], v[64:67]
    ds_read_b64_tr_b16 v[44:45], v6 offset:40960
    v_mfma_f32_16x16x32_bf16 v[68:71], v[48:51], v[204:207], v[68:71]
    ds_read_b64_tr_b16 v[46:47], v6 offset:41984
    v_mfma_f32_16x16x32_bf16 v[72:75], v[52:55], v[200:203], v[72:75]
    ds_read_b64_tr_b16 v[48:49], v3 offset:45056
    v_mfma_f32_16x16x32_bf16 v[76:79], v[52:55], v[204:207], v[76:79]
    ds_read_b64_tr_b16 v[50:51], v3 offset:46080
    s_waitcnt lgkmcnt(10)
    v_mfma_f32_16x16x32_bf16 v[80:83], v[56:59], v[200:203], v[80:83]
    ds_read_b64_tr_b16 v[52:53], v4 offset:45056
    v_mfma_f32_16x16x32_bf16 v[84:87], v[56:59], v[204:207], v[84:87]
    ds_read_b64_tr_b16 v[54:55], v4 offset:46080
    v_mfma_f32_16x16x32_bf16 v[88:91], v[60:63], v[200:203], v[88:91]
    ds_read_b64_tr_b16 v[56:57], v5 offset:45056
    v_mfma_f32_16x16x32_bf16 v[92:95], v[60:63], v[204:207], v[92:95]
    ds_read_b64_tr_b16 v[58:59], v5 offset:46080
    s_waitcnt vmcnt(2) lgkmcnt(10)
    v_mfma_f32_16x16x32_bf16 v[64:67], v[32:35], v[208:211], v[64:67]
    ds_read_b64_tr_b16 v[60:61], v6 offset:45056
    v_mfma_f32_16x16x32_bf16 v[68:71], v[32:35], v[212:215], v[68:71]
    ds_read_b64_tr_b16 v[62:63], v6 offset:46080
    v_mfma_f32_16x16x32_bf16 v[72:75], v[36:39], v[208:211], v[72:75]
    ds_read_b64_tr_b16 v[32:33], v3 offset:49152
    ds_read_b32 v8, v9 offset:4096
    v_mfma_f32_16x16x32_bf16 v[76:79], v[36:39], v[212:215], v[76:79]
    ds_read_b64_tr_b16 v[34:35], v3 offset:50176
    ds_read_b32 v10, v9 offset:4608
    s_waitcnt lgkmcnt(12)
    v_mfma_f32_16x16x32_bf16 v[80:83], v[40:43], v[208:211], v[80:83]
    ds_read_b64_tr_b16 v[36:37], v4 offset:49152
    ds_read_b32 v12, v9 offset:4160
    v_mfma_f32_16x16x32_bf16 v[84:87], v[40:43], v[212:215], v[84:87]
    ds_read_b64_tr_b16 v[38:39], v4 offset:50176
    ds_read_b32 v14, v9 offset:4672
    v_mfma_f32_16x16x32_bf16 v[88:91], v[44:47], v[208:211], v[88:91]
    ds_read_b64_tr_b16 v[40:41], v5 offset:49152
    ds_read_b128 v[16:19], v11 offset:256
    v_mfma_f32_16x16x32_bf16 v[92:95], v[44:47], v[212:215], v[92:95]
    ds_read_b64_tr_b16 v[42:43], v5 offset:50176
    ds_read_b128 v[20:23], v11 offset:320
    s_waitcnt vmcnt(0) lgkmcnt(14)
    v_mfma_f32_16x16x32_bf16 v[64:67], v[48:51], v[216:219], v[64:67]
    ds_read_b64_tr_b16 v[44:45], v6 offset:49152
    ds_read_b128 v[24:27], v11 offset:384
    v_mfma_f32_16x16x32_bf16 v[68:71], v[48:51], v[220:223], v[68:71]
    ds_read_b64_tr_b16 v[46:47], v6 offset:50176
    ds_read_b128 v[28:31], v11 offset:448
    v_mfma_f32_16x16x32_bf16 v[72:75], v[52:55], v[216:219], v[72:75]
    ds_read_b64_tr_b16 v[48:49], v3 offset:53248
    v_mfma_f32_16x16x32_bf16 v[76:79], v[52:55], v[220:223], v[76:79]
    ds_read_b64_tr_b16 v[50:51], v3 offset:54272
    s_waitcnt lgkmcnt(14)
    v_mfma_f32_16x16x32_bf16 v[80:83], v[56:59], v[216:219], v[80:83]
    ds_read_b64_tr_b16 v[52:53], v4 offset:53248
    v_mfma_f32_16x16x32_bf16 v[84:87], v[56:59], v[220:223], v[84:87]
    ds_read_b64_tr_b16 v[54:55], v4 offset:54272
    v_mfma_f32_16x16x32_bf16 v[88:91], v[60:63], v[216:219], v[88:91]
    ds_read_b64_tr_b16 v[56:57], v5 offset:53248
    v_mfma_f32_16x16x32_bf16 v[92:95], v[60:63], v[220:223], v[92:95]
    ds_read_b64_tr_b16 v[58:59], v5 offset:54272
    s_bitcmp1_b32 s21, 0
    s_cbranch_scc1 c_B
    v_add_u32 v7, s62, v1
    s_waitcnt lgkmcnt(6)
    v_pk_fma_f32 v[68:69], v[12:13], v[16:17], v[68:69] op_sel_hi:[0,1,1] neg_lo:[1,0,0] neg_hi:[1,0,0]
    v_pk_fma_f32 v[70:71], v[12:13], v[18:19], v[70:71] op_sel_hi:[0,1,1] neg_lo:[1,0,0] neg_hi:[1,0,0]
    v_pk_fma_f32 v[76:77], v[12:13], v[20:21], v[76:77] op_sel_hi:[0,1,1] neg_lo:[1,0,0] neg_hi:[1,0,0]
    v_pk_fma_f32 v[78:79], v[12:13], v[22:23], v[78:79] op_sel_hi:[0,1,1] neg_lo:[1,0,0] neg_hi:[1,0,0]
    v_pk_mul_f32 v[68:69], v[14:15], v[68:69] op_sel_hi:[0,1]
    v_pk_mul_f32 v[70:71], v[14:15], v[70:71] op_sel_hi:[0,1]
    v_pk_mul_f32 v[76:77], v[14:15], v[76:77] op_sel_hi:[0,1]
    v_pk_mul_f32 v[78:79], v[14:15], v[78:79] op_sel_hi:[0,1]
    v_cvt_pk_bf16_f32 v68, v68, v69
    v_cvt_pk_bf16_f32 v69, v70, v71
    v_cvt_pk_bf16_f32 v70, v76, v77
    v_cvt_pk_bf16_f32 v71, v78, v79
    ds_write_b128 v7, v[68:71] offset:4096
    v_pk_fma_f32 v[64:65], v[8:9], v[16:17], v[64:65] op_sel_hi:[0,1,1] neg_lo:[1,0,0] neg_hi:[1,0,0]
    v_pk_fma_f32 v[66:67], v[8:9], v[18:19], v[66:67] op_sel_hi:[0,1,1] neg_lo:[1,0,0] neg_hi:[1,0,0]
    v_pk_fma_f32 v[72:73], v[8:9], v[20:21], v[72:73] op_sel_hi:[0,1,1] neg_lo:[1,0,0] neg_hi:[1,0,0]
    v_pk_fma_f32 v[74:75], v[8:9], v[22:23], v[74:75] op_sel_hi:[0,1,1] neg_lo:[1,0,0] neg_hi:[1,0,0]
    v_pk_mul_f32 v[64:65], v[10:11], v[64:65] op_sel_hi:[0,1]
    v_pk_mul_f32 v[66:67], v[10:11], v[66:67] op_sel_hi:[0,1]
    v_pk_mul_f32 v[72:73], v[10:11], v[72:73] op_sel_hi:[0,1]
    v_pk_mul_f32 v[74:75], v[10:11], v[74:75] op_sel_hi:[0,1]
    v_cvt_pk_bf16_f32 v64, v64, v65
    v_cvt_pk_bf16_f32 v65, v66, v67
    v_cvt_pk_bf16_f32 v66, v72, v73
    v_cvt_pk_bf16_f32 v67, v74, v75
    v_pk_fma_f32 v[84:85], v[12:13], v[24:25], v[84:85] op_sel_hi:[0,1,1] neg_lo:[1,0,0] neg_hi:[1,0,0]
    v_pk_fma_f32 v[86:87], v[12:13], v[26:27], v[86:87] op_sel_hi:[0,1,1] neg_lo:[1,0,0] neg_hi:[1,0,0]
    v_pk_fma_f32 v[92:93], v[12:13], v[28:29], v[92:93] op_sel_hi:[0,1,1] neg_lo:[1,0,0] neg_hi:[1,0,0]
    v_pk_fma_f32 v[94:95], v[12:13], v[30:31], v[94:95] op_sel_hi:[0,1,1] neg_lo:[1,0,0] neg_hi:[1,0,0]
    v_pk_mul_f32 v[84:85], v[14:15], v[84:85] op_sel_hi:[0,1]
    v_pk_mul_f32 v[86:87], v[14:15], v[86:87] op_sel_hi:[0,1]
    v_pk_mul_f32 v[92:93], v[14:15], v[92:93] op_sel_hi:[0,1]
    v_pk_mul_f32 v[94:95], v[14:15], v[94:95] op_sel_hi:[0,1]
    v_cvt_pk_bf16_f32 v84, v84, v85
    v_cvt_pk_bf16_f32 v85, v86, v87
    v_cvt_pk_bf16_f32 v86, v92, v93
    v_cvt_pk_bf16_f32 v87, v94, v95
    ds_write_b128 v7, v[84:87] offset:5120
    v_pk_fma_f32 v[80:81], v[8:9], v[24:25], v[80:81] op_sel_hi:[0,1,1] neg_lo:[1,0,0] neg_hi:[1,0,0]
    v_pk_fma_f32 v[82:83], v[8:9], v[26:27], v[82:83] op_sel_hi:[0,1,1] neg_lo:[1,0,0] neg_hi:[1,0,0]
    v_pk_fma_f32 v[88:89], v[8:9], v[28:29], v[88:89] op_sel_hi:[0,1,1] neg_lo:[1,0,0] neg_hi:[1,0,0]
    v_pk_fma_f32 v[90:91], v[8:9], v[30:31], v[90:91] op_sel_hi:[0,1,1] neg_lo:[1,0,0] neg_hi:[1,0,0]
    v_pk_mul_f32 v[80:81], v[10:11], v[80:81] op_sel_hi:[0,1]
    v_pk_mul_f32 v[82:83], v[10:11], v[82:83] op_sel_hi:[0,1]
    v_pk_mul_f32 v[88:89], v[10:11], v[88:89] op_sel_hi:[0,1]
    v_pk_mul_f32 v[90:91], v[10:11], v[90:91] op_sel_hi:[0,1]
    v_cvt_pk_bf16_f32 v80, v80, v81
    v_cvt_pk_bf16_f32 v81, v82, v83
    v_cvt_pk_bf16_f32 v82, v88, v89
    v_cvt_pk_bf16_f32 v83, v90, v91
    v_mfma_f32_16x16x32_bf16 v[96:99], v[160:163], v[32:35], v[96:99]
    ds_read_b64_tr_b16 v[60:61], v6 offset:53248
    v_mfma_f32_16x16x32_bf16 v[100:103], v[164:167], v[32:35], v[100:103]
    ds_read_b64_tr_b16 v[62:63], v6 offset:54272
    v_mfma_f32_16x16x32_bf16 v[104:107], v[160:163], v[36:39], v[104:107]
    ds_read_b64_tr_b16 v[32:33], v3 offset:57344
    v_mfma_f32_16x16x32_bf16 v[108:111], v[164:167], v[36:39], v[108:111]
    ds_read_b64_tr_b16 v[34:35], v3 offset:58368
    v_mfma_f32_16x16x32_bf16 v[112:115], v[160:163], v[40:43], v[112:115]
    ds_read_b64_tr_b16 v[36:37], v4 offset:57344
    v_mfma_f32_16x16x32_bf16 v[116:119], v[164:167], v[40:43], v[116:119]
    ds_read_b64_tr_b16 v[38:39], v4 offset:58368
    v_mfma_f32_16x16x32_bf16 v[120:123], v[160:163], v[44:47], v[120:123]
    ds_read_b64_tr_b16 v[40:41], v5 offset:57344
    v_mfma_f32_16x16x32_bf16 v[124:127], v[164:167], v[44:47], v[124:127]
    ds_read_b64_tr_b16 v[42:43], v5 offset:58368
    s_waitcnt lgkmcnt(12)
    v_mfma_f32_16x16x32_bf16 v[96:99], v[168:171], v[48:51], v[96:99]
    ds_read_b64_tr_b16 v[44:45], v6 offset:57344
    v_mfma_f32_16x16x32_bf16 v[100:103], v[172:175], v[48:51], v[100:103]
    ds_read_b64_tr_b16 v[46:47], v6 offset:58368
    v_mfma_f32_16x16x32_bf16 v[104:107], v[168:171], v[52:55], v[104:107]
    ds_read_b64_tr_b16 v[48:49], v3 offset:61440
    v_mfma_f32_16x16x32_bf16 v[108:111], v[172:175], v[52:55], v[108:111]
    ds_read_b64_tr_b16 v[50:51], v3 offset:62464
    s_waitcnt lgkmcnt(10)
    v_mfma_f32_16x16x32_bf16 v[112:115], v[168:171], v[56:59], v[112:115]
    ds_read_b64_tr_b16 v[52:53], v4 offset:61440
    v_mfma_f32_16x16x32_bf16 v[116:119], v[172:175], v[56:59], v[116:119]
    ds_read_b64_tr_b16 v[54:55], v4 offset:62464
    v_mfma_f32_16x16x32_bf16 v[120:123], v[168:171], v[60:63], v[120:123]
    ds_read_b64_tr_b16 v[56:57], v5 offset:61440
    v_mfma_f32_16x16x32_bf16 v[124:127], v[172:175], v[60:63], v[124:127]
    ds_read_b64_tr_b16 v[58:59], v5 offset:62464
    s_waitcnt lgkmcnt(10)
    v_mfma_f32_16x16x32_bf16 v[96:99], v[176:179], v[32:35], v[96:99]
    ds_read_b64_tr_b16 v[60:61], v6 offset:61440
    v_mfma_f32_16x16x32_bf16 v[100:103], v[180:183], v[32:35], v[100:103]
    ds_read_b64_tr_b16 v[62:63], v6 offset:62464
    s_barrier
    v_xor_b32 v3, 0x10000, v3
    v_xor_b32 v4, 0x10000, v4
    v_xor_b32 v5, 0x10000, v5
    v_xor_b32 v6, 0x10000, v6
    v_mfma_f32_16x16x32_bf16 v[104:107], v[176:179], v[36:39], v[104:107]
    ds_read_b64_tr_b16 v[32:33], v3 offset:0
    v_mfma_f32_16x16x32_bf16 v[108:111], v[180:183], v[36:39], v[108:111]
    ds_read_b64_tr_b16 v[34:35], v3 offset:1024
    s_waitcnt lgkmcnt(10)
    v_mfma_f32_16x16x32_bf16 v[112:115], v[176:179], v[40:43], v[112:115]
    ds_read_b64_tr_b16 v[36:37], v4 offset:0
    v_mfma_f32_16x16x32_bf16 v[116:119], v[180:183], v[40:43], v[116:119]
    ds_read_b64_tr_b16 v[38:39], v4 offset:1024
    v_mfma_f32_16x16x32_bf16 v[120:123], v[176:179], v[44:47], v[120:123]
    ds_read_b64_tr_b16 v[40:41], v5 offset:0
    v_mfma_f32_16x16x32_bf16 v[124:127], v[180:183], v[44:47], v[124:127]
    ds_read_b64_tr_b16 v[42:43], v5 offset:1024
    s_waitcnt lgkmcnt(10)
    v_mfma_f32_16x16x32_bf16 v[96:99], v[184:187], v[48:51], v[96:99]
    ds_read_b64_tr_b16 v[44:45], v6 offset:0
    v_mfma_f32_16x16x32_bf16 v[100:103], v[188:191], v[48:51], v[100:103]
    ds_read_b64_tr_b16 v[46:47], v6 offset:1024
    v_mfma_f32_16x16x32_bf16 v[104:107], v[184:187], v[52:55], v[104:107]
    ds_read_b64_tr_b16 v[48:49], v3 offset:4096
    v_mfma_f32_16x16x32_bf16 v[108:111], v[188:191], v[52:55], v[108:111]
    ds_read_b64_tr_b16 v[50:51], v3 offset:5120
    s_waitcnt lgkmcnt(10)
    v_mfma_f32_16x16x32_bf16 v[112:115], v[184:187], v[56:59], v[112:115]
    ds_read_b64_tr_b16 v[52:53], v4 offset:4096
    v_mfma_f32_16x16x32_bf16 v[116:119], v[188:191], v[56:59], v[116:119]
    ds_read_b64_tr_b16 v[54:55], v4 offset:5120
    v_mfma_f32_16x16x32_bf16 v[120:123], v[184:187], v[60:63], v[120:123]
    ds_read_b64_tr_b16 v[56:57], v5 offset:4096
    v_mfma_f32_16x16x32_bf16 v[124:127], v[188:191], v[60:63], v[124:127]
    ds_read_b64_tr_b16 v[58:59], v5 offset:5120
    s_waitcnt lgkmcnt(10)
    v_mfma_f32_16x16x32_bf16 v[96:99], v[192:195], v[32:35], v[96:99]
    ds_read_b64_tr_b16 v[60:61], v6 offset:4096
    v_mfma_f32_16x16x32_bf16 v[100:103], v[196:199], v[32:35], v[100:103]
    ds_read_b64_tr_b16 v[62:63], v6 offset:5120
    v_mfma_f32_16x16x32_bf16 v[104:107], v[192:195], v[36:39], v[104:107]
    ds_read_b64_tr_b16 v[32:33], v3 offset:8192
    v_mfma_f32_16x16x32_bf16 v[108:111], v[196:199], v[36:39], v[108:111]
    ds_read_b64_tr_b16 v[34:35], v3 offset:9216
    s_waitcnt lgkmcnt(10)
    v_mfma_f32_16x16x32_bf16 v[112:115], v[192:195], v[40:43], v[112:115]
    ds_read_b64_tr_b16 v[36:37], v4 offset:8192
    v_mfma_f32_16x16x32_bf16 v[116:119], v[196:199], v[40:43], v[116:119]
    ds_read_b64_tr_b16 v[38:39], v4 offset:9216
    v_mfma_f32_16x16x32_bf16 v[120:123], v[192:195], v[44:47], v[120:123]
    ds_read_b64_tr_b16 v[40:41], v5 offset:8192
    v_mfma_f32_16x16x32_bf16 v[124:127], v[196:199], v[44:47], v[124:127]
    ds_read_b64_tr_b16 v[42:43], v5 offset:9216
    s_waitcnt lgkmcnt(10)
    v_mfma_f32_16x16x32_bf16 v[96:99], v[200:203], v[48:51], v[96:99]
    ds_read_b64_tr_b16 v[44:45], v6 offset:8192
    v_mfma_f32_16x16x32_bf16 v[100:103], v[204:207], v[48:51], v[100:103]
    ds_read_b64_tr_b16 v[46:47], v6 offset:9216
    v_mfma_f32_16x16x32_bf16 v[104:107], v[200:203], v[52:55], v[104:107]
    ds_read_b64_tr_b16 v[48:49], v3 offset:12288
    v_mfma_f32_16x16x32_bf16 v[108:111], v[204:207], v[52:55], v[108:111]
    ds_read_b64_tr_b16 v[50:51], v3 offset:13312
    s_waitcnt lgkmcnt(10)
    v_mfma_f32_16x16x32_bf16 v[112:115], v[200:203], v[56:59], v[112:115]
    ds_read_b64_tr_b16 v[52:53], v4 offset:12288
    v_mfma_f32_16x16x32_bf16 v[116:119], v[204:207], v[56:59], v[116:119]
    ds_read_b64_tr_b16 v[54:55], v4 offset:13312
    v_mfma_f32_16x16x32_bf16 v[120:123], v[200:203], v[60:63], v[120:123]
    ds_read_b64_tr_b16 v[56:57], v5 offset:12288
    v_mfma_f32_16x16x32_bf16 v[124:127], v[204:207], v[60:63], v[124:127]
    ds_read_b64_tr_b16 v[58:59], v5 offset:13312
    s_waitcnt lgkmcnt(10)
    v_mfma_f32_16x16x32_bf16 v[96:99], v[208:211], v[32:35], v[96:99]
    ds_read_b64_tr_b16 v[60:61], v6 offset:12288
    v_mfma_f32_16x16x32_bf16 v[100:103], v[212:215], v[32:35], v[100:103]
    ds_read_b64_tr_b16 v[62:63], v6 offset:13312
    v_mfma_f32_16x16x32_bf16 v[104:107], v[208:211], v[36:39], v[104:107]
    ds_read_b64_tr_b16 v[32:33], v3 offset:16384
    ds_read_b128 v[16:19], v13 offset:4096
    v_mfma_f32_16x16x32_bf16 v[108:111], v[212:215], v[36:39], v[108:111]
    ds_read_b64_tr_b16 v[34:35], v3 offset:17408
    ds_read_b128 v[20:23], v13 offset:4608
    s_waitcnt lgkmcnt(12)
    v_mfma_f32_16x16x32_bf16 v[112:115], v[208:211], v[40:43], v[112:115]
    ds_read_b64_tr_b16 v[36:37], v4 offset:16384
    ds_read_b128 v[24:27], v13 offset:4160
    v_mfma_f32_16x16x32_bf16 v[116:119], v[212:215], v[40:43], v[116:119]
    ds_read_b64_tr_b16 v[38:39], v4 offset:17408
    ds_read_b128 v[28:31], v13 offset:4672
    v_mfma_f32_16x16x32_bf16 v[120:123], v[208:211], v[44:47], v[120:123]
    ds_read_b64_tr_b16 v[40:41], v5 offset:16384
    ds_read_b32 v8, v15 offset:512
    v_mfma_f32_16x16x32_bf16 v[124:127], v[212:215], v[44:47], v[124:127]
    ds_read_b64_tr_b16 v[42:43], v5 offset:17408
    ds_read_b32 v10, v15 offset:576
    s_waitcnt lgkmcnt(14)
    v_mfma_f32_16x16x32_bf16 v[96:99], v[216:219], v[48:51], v[96:99]
    ds_read_b64_tr_b16 v[44:45], v6 offset:16384
    ds_read_b32 v12, v15 offset:640
    v_mfma_f32_16x16x32_bf16 v[100:103], v[220:223], v[48:51], v[100:103]
    ds_read_b64_tr_b16 v[46:47], v6 offset:17408
    ds_read_b32 v14, v15 offset:704
    v_mfma_f32_16x16x32_bf16 v[104:107], v[216:219], v[52:55], v[104:107]
    ds_read_b64_tr_b16 v[48:49], v3 offset:20480
    v_mfma_f32_16x16x32_bf16 v[108:111], v[220:223], v[52:55], v[108:111]
    ds_read_b64_tr_b16 v[50:51], v3 offset:21504
    s_waitcnt lgkmcnt(14)
    v_mfma_f32_16x16x32_bf16 v[112:115], v[216:219], v[56:59], v[112:115]
    ds_read_b64_tr_b16 v[52:53], v4 offset:20480
    v_mfma_f32_16x16x32_bf16 v[116:119], v[220:223], v[56:59], v[116:119]
    ds_read_b64_tr_b16 v[54:55], v4 offset:21504
    v_mfma_f32_16x16x32_bf16 v[120:123], v[216:219], v[60:63], v[120:123]
    ds_read_b64_tr_b16 v[56:57], v5 offset:20480
    v_mfma_f32_16x16x32_bf16 v[124:127], v[220:223], v[60:63], v[124:127]
    ds_read_b64_tr_b16 v[58:59], v5 offset:21504
    s_waitcnt lgkmcnt(6)
    v_pk_fma_f32 v[100:101], v[8:9], v[24:25], v[100:101] op_sel_hi:[0,1,1] neg_lo:[1,0,0] neg_hi:[1,0,0]
    v_pk_fma_f32 v[102:103], v[8:9], v[26:27], v[102:103] op_sel_hi:[0,1,1] neg_lo:[1,0,0] neg_hi:[1,0,0]
    v_pk_fma_f32 v[108:109], v[10:11], v[24:25], v[108:109] op_sel_hi:[0,1,1] neg_lo:[1,0,0] neg_hi:[1,0,0]
    v_pk_fma_f32 v[110:111], v[10:11], v[26:27], v[110:111] op_sel_hi:[0,1,1] neg_lo:[1,0,0] neg_hi:[1,0,0]
    v_pk_mul_f32 v[100:101], v[28:29], v[100:101]
    v_pk_mul_f32 v[102:103], v[30:31], v[102:103]
    v_pk_mul_f32 v[108:109], v[28:29], v[108:109]
    v_pk_mul_f32 v[110:111], v[30:31], v[110:111]
    v_cvt_pk_bf16_f32 v74, v100, v101
    v_cvt_pk_bf16_f32 v75, v102, v103
    v_cvt_pk_bf16_f32 v78, v108, v109
    v_cvt_pk_bf16_f32 v79, v110, v111
    v_cvt_pk_bf16_f32 v100, v100, v101
    v_cvt_pk_bf16_f32 v101, v102, v103
    v_cvt_pk_bf16_f32 v102, v108, v109
    v_cvt_pk_bf16_f32 v103, v110, v111
    ds_write_b128 v7, v[100:103] offset:6144
    v_pk_fma_f32 v[116:117], v[12:13], v[24:25], v[116:117] op_sel_hi:[0,1,1] neg_lo:[1,0,0] neg_hi:[1,0,0]
    v_pk_fma_f32 v[118:119], v[12:13], v[26:27], v[118:119] op_sel_hi:[0,1,1] neg_lo:[1,0,0] neg_hi:[1,0,0]
    v_pk_fma_f32 v[124:125], v[14:15], v[24:25], v[124:125] op_sel_hi:[0,1,1] neg_lo:[1,0,0] neg_hi:[1,0,0]
    v_pk_fma_f32 v[126:127], v[14:15], v[26:27], v[126:127] op_sel_hi:[0,1,1] neg_lo:[1,0,0] neg_hi:[1,0,0]
    v_pk_mul_f32 v[116:117], v[28:29], v[116:117]
    v_pk_mul_f32 v[118:119], v[30:31], v[118:119]
    v_pk_mul_f32 v[124:125], v[28:29], v[124:125]
    v_pk_mul_f32 v[126:127], v[30:31], v[126:127]
    v_cvt_pk_bf16_f32 v90, v116, v117
    v_cvt_pk_bf16_f32 v91, v118, v119
    v_cvt_pk_bf16_f32 v94, v124, v125
    v_cvt_pk_bf16_f32 v95, v126, v127
    v_cvt_pk_bf16_f32 v116, v116, v117
    v_cvt_pk_bf16_f32 v117, v118, v119
    v_cvt_pk_bf16_f32 v118, v124, v125
    v_cvt_pk_bf16_f32 v119, v126, v127
    ds_write_b128 v7, v[116:119] offset:7168
    s_cmp_lg_u32 s16, 3
    s_cbranch_scc1 a_nh
    buffer_store_dwordx4 v[68:71], v1, s[4:7], s60 offen offset:0 sc1
    buffer_store_dwordx4 v[84:87], v1, s[4:7], s60 offen offset:1024 sc1
    buffer_store_dwordx4 v[100:103], v1, s[4:7], s60 offen offset:2048 sc1
    buffer_store_dwordx4 v[116:119], v1, s[4:7], s60 offen offset:3072 sc1
a_nh:
    v_pk_fma_f32 v[96:97], v[8:9], v[16:17], v[96:97] op_sel_hi:[0,1,1] neg_lo:[1,0,0] neg_hi:[1,0,0]
    v_pk_fma_f32 v[98:99], v[8:9], v[18:19], v[98:99] op_sel_hi:[0,1,1] neg_lo:[1,0,0] neg_hi:[1,0,0]
    v_pk_fma_f32 v[104:105], v[10:11], v[16:17], v[104:105] op_sel_hi:[0,1,1] neg_lo:[1,0,0] neg_hi:[1,0,0]
    v_pk_fma_f32 v[106:107], v[10:11], v[18:19], v[106:107] op_sel_hi:[0,1,1] neg_lo:[1,0,0] neg_hi:[1,0,0]
    v_pk_mul_f32 v[96:97], v[20:21], v[96:97]
    v_pk_mul_f32 v[98:99], v[22:23], v[98:99]
    v_pk_mul_f32 v[104:105], v[20:21], v[104:105]
    v_pk_mul_f32 v[106:107], v[22:23], v[106:107]
    v_cvt_pk_bf16_f32 v72, v96, v97
    v_cvt_pk_bf16_f32 v73, v98, v99
    v_cvt_pk_bf16_f32 v76, v104, v105
    v_cvt_pk_bf16_f32 v77, v106, v107
    v_pk_fma_f32 v[112:113], v[12:13], v[16:17], v[112:113] op_sel_hi:[0,1,1] neg_lo:[1,0,0] neg_hi:[1,0,0]
    v_pk_fma_f32 v[114:115], v[12:13], v[18:19], v[114:115] op_sel_hi:[0,1,1] neg_lo:[1,0,0] neg_hi:[1,0,0]
    v_pk_fma_f32 v[120:121], v[14:15], v[16:17], v[120:121] op_sel_hi:[0,1,1] neg_lo:[1,0,0] neg_hi:[1,0,0]
    v_pk_fma_f32 v[122:123], v[14:15], v[18:19], v[122:123] op_sel_hi:[0,1,1] neg_lo:[1,0,0] neg_hi:[1,0,0]
    v_pk_mul_f32 v[112:113], v[20:21], v[112:113]
    v_pk_mul_f32 v[114:115], v[22:23], v[114:115]
    v_pk_mul_f32 v[120:121], v[20:21], v[120:121]
    v_pk_mul_f32 v[122:123], v[22:23], v[122:123]
    v_cvt_pk_bf16_f32 v88, v112, v113
    v_cvt_pk_bf16_f32 v89, v114, v115
    v_cvt_pk_bf16_f32 v92, v120, v121
    v_cvt_pk_bf16_f32 v93, v122, v123
    v_mfma_f32_16x16x32_bf16 v[128:131], v[32:35], v[224:227], v[128:131]
    ds_read_b64_tr_b16 v[60:61], v6 offset:20480
    v_mfma_f32_16x16x32_bf16 v[132:135], v[32:35], v[228:231], v[132:135]
    ds_read_b64_tr_b16 v[62:63], v6 offset:21504
    v_mfma_f32_16x16x32_bf16 v[136:139], v[36:39], v[224:227], v[136:139]
    ds_read_b64_tr_b16 v[32:33], v3 offset:24576
    v_mfma_f32_16x16x32_bf16 v[140:143], v[36:39], v[228:231], v[140:143]
    ds_read_b64_tr_b16 v[34:35], v3 offset:25600
    v_mfma_f32_16x16x32_bf16 v[144:147], v[40:43], v[224:227], v[144:147]
    ds_read_b64_tr_b16 v[36:37], v4 offset:24576
    v_mfma_f32_16x16x32_bf16 v[148:151], v[40:43], v[228:231], v[148:151]
    ds_read_b64_tr_b16 v[38:39], v4 offset:25600
    v_mfma_f32_16x16x32_bf16 v[152:155], v[44:47], v[224:227], v[152:155]
    ds_read_b64_tr_b16 v[40:41], v5 offset:24576
    v_mfma_f32_16x16x32_bf16 v[156:159], v[44:47], v[228:231], v[156:159]
    ds_read_b64_tr_b16 v[42:43], v5 offset:25600
    s_waitcnt lgkmcnt(12)
    v_mfma_f32_16x16x32_bf16 v[128:131], v[48:51], v[232:235], v[128:131]
    ds_read_b64_tr_b16 v[44:45], v6 offset:24576
    v_mfma_f32_16x16x32_bf16 v[132:135], v[48:51], v[236:239], v[132:135]
    ds_read_b64_tr_b16 v[46:47], v6 offset:25600
    v_mfma_f32_16x16x32_bf16 v[136:139], v[52:55], v[232:235], v[136:139]
    ds_read_b64_tr_b16 v[48:49], v3 offset:28672
    v_mfma_f32_16x16x32_bf16 v[140:143], v[52:55], v[236:239], v[140:143]
    ds_read_b64_tr_b16 v[50:51], v3 offset:29696
    s_waitcnt lgkmcnt(10)
    v_mfma_f32_16x16x32_bf16 v[144:147], v[56:59], v[232:235], v[144:147]
    ds_read_b64_tr_b16 v[52:53], v4 offset:28672
    v_mfma_f32_16x16x32_bf16 v[148:151], v[56:59], v[236:239], v[148:151]
    ds_read_b64_tr_b16 v[54:55], v4 offset:29696
    v_mfma_f32_16x16x32_bf16 v[152:155], v[60:63], v[232:235], v[152:155]
    ds_read_b64_tr_b16 v[56:57], v5 offset:28672
    v_mfma_f32_16x16x32_bf16 v[156:159], v[60:63], v[236:239], v[156:159]
    ds_read_b64_tr_b16 v[58:59], v5 offset:29696
    s_waitcnt lgkmcnt(10)
    v_mfma_f32_16x16x32_bf16 v[128:131], v[32:35], v[240:243], v[128:131]
    ds_read_b64_tr_b16 v[60:61], v6 offset:28672
    v_mfma_f32_16x16x32_bf16 v[132:135], v[32:35], v[244:247], v[132:135]
    ds_read_b64_tr_b16 v[62:63], v6 offset:29696
    s_barrier
    v_mfma_f32_16x16x32_bf16 v[136:139], v[36:39], v[240:243], v[136:139]
    ds_read_b64_tr_b16 v[32:33], v3 offset:32768
    v_mfma_f32_16x16x32_bf16 v[140:143], v[36:39], v[244:247], v[140:143]
    ds_read_b64_tr_b16 v[34:35], v3 offset:33792
    s_waitcnt lgkmcnt(10)
    v_mfma_f32_16x16x32_bf16 v[144:147], v[40:43], v[240:243], v[144:147]
    ds_read_b64_tr_b16 v[36:37], v4 offset:32768
    v_mfma_f32_16x16x32_bf16 v[148:151], v[40:43], v[244:247], v[148:151]
    ds_read_b64_tr_b16 v[38:39], v4 offset:33792
    v_mfma_f32_16x16x32_bf16 v[152:155], v[44:47], v[240:243], v[152:155]
    ds_read_b64_tr_b16 v[40:41], v5 offset:32768
    v_mfma_f32_16x16x32_bf16 v[156:159], v[44:47], v[244:247], v[156:159]
    ds_read_b64_tr_b16 v[42:43], v5 offset:33792
    s_waitcnt lgkmcnt(10)
    v_mfma_f32_16x16x32_bf16 v[128:131], v[48:51], v[248:251], v[128:131]
    ds_read_b64_tr_b16 v[44:45], v6 offset:32768
    v_mfma_f32_16x16x32_bf16 v[132:135], v[48:51], v[252:255], v[132:135]
    ds_read_b64_tr_b16 v[46:47], v6 offset:33792
    v_mfma_f32_16x16x32_bf16 v[136:139], v[52:55], v[248:251], v[136:139]
    ds_read_b64_tr_b16 v[48:49], v3 offset:36864
    v_mfma_f32_16x16x32_bf16 v[140:143], v[52:55], v[252:255], v[140:143]
    ds_read_b64_tr_b16 v[50:51], v3 offset:37888
    s_waitcnt lgkmcnt(10)
    v_mfma_f32_16x16x32_bf16 v[144:147], v[56:59], v[248:251], v[144:147]
    ds_read_b64_tr_b16 v[52:53], v4 offset:36864
    v_mfma_f32_16x16x32_bf16 v[148:151], v[56:59], v[252:255], v[148:151]
    ds_read_b64_tr_b16 v[54:55], v4 offset:37888
    v_mfma_f32_16x16x32_bf16 v[152:155], v[60:63], v[248:251], v[152:155]
    ds_read_b64_tr_b16 v[56:57], v5 offset:36864
    v_mfma_f32_16x16x32_bf16 v[156:159], v[60:63], v[252:255], v[156:159]
    ds_read_b64_tr_b16 v[58:59], v5 offset:37888
    s_waitcnt lgkmcnt(10)
    v_mfma_f32_16x16x32_bf16 v[128:131], v[32:35], v[160:163], v[128:131]
    ds_read_b64_tr_b16 v[60:61], v6 offset:36864
    v_mfma_f32_16x16x32_bf16 v[132:135], v[32:35], v[164:167], v[132:135]
    ds_read_b64_tr_b16 v[62:63], v6 offset:37888
    v_mfma_f32_16x16x32_bf16 v[136:139], v[36:39], v[160:163], v[136:139]
    ds_read_b64_tr_b16 v[32:33], v3 offset:40960
    v_mfma_f32_16x16x32_bf16 v[140:143], v[36:39], v[164:167], v[140:143]
    ds_read_b64_tr_b16 v[34:35], v3 offset:41984
    s_waitcnt lgkmcnt(10)
    v_mfma_f32_16x16x32_bf16 v[144:147], v[40:43], v[160:163], v[144:147]
    ds_read_b64_tr_b16 v[36:37], v4 offset:40960
    v_mfma_f32_16x16x32_bf16 v[148:151], v[40:43], v[164:167], v[148:151]
    ds_read_b64_tr_b16 v[38:39], v4 offset:41984
    v_mfma_f32_16x16x32_bf16 v[152:155], v[44:47], v[160:163], v[152:155]
    ds_read_b64_tr_b16 v[40:41], v5 offset:40960
    v_mfma_f32_16x16x32_bf16 v[156:159], v[44:47], v[164:167], v[156:159]
    ds_read_b64_tr_b16 v[42:43], v5 offset:41984
    s_waitcnt lgkmcnt(10)
    v_mfma_f32_16x16x32_bf16 v[128:131], v[48:51], v[168:171], v[128:131]
    ds_read_b64_tr_b16 v[44:45], v6 offset:40960
    s_cmp_lg_u32 s16, 3
    s_cbranch_scc1 a_nopub
    s_waitcnt vmcnt(0)
    s_atomic_add s40, s[22:23], s61
a_nopub:
    v_mfma_f32_16x16x32_bf16 v[132:135], v[48:51], v[172:175], v[132:135]
    ds_read_b64_tr_b16 v[46:47], v6 offset:41984
    v_mfma_f32_16x16x32_bf16 v[136:139], v[52:55], v[168:171], v[136:139]
    ds_read_b64_tr_b16 v[48:49], v3 offset:45056
    v_mfma_f32_16x16x32_bf16 v[140:143], v[52:55], v[172:175], v[140:143]
    ds_read_b64_tr_b16 v[50:51], v3 offset:46080
    s_waitcnt lgkmcnt(10)
    v_mfma_f32_16x16x32_bf16 v[144:147], v[56:59], v[168:171], v[144:147]
    ds_read_b64_tr_b16 v[52:53], v4 offset:45056
    v_mfma_f32_16x16x32_bf16 v[148:151], v[56:59], v[172:175], v[148:151]
    ds_read_b64_tr_b16 v[54:55], v4 offset:46080
    v_mfma_f32_16x16x32_bf16 v[152:155], v[60:63], v[168:171], v[152:155]
    ds_read_b64_tr_b16 v[56:57], v5 offset:45056
    v_mfma_f32_16x16x32_bf16 v[156:159], v[60:63], v[172:175], v[156:159]
    ds_read_b64_tr_b16 v[58:59], v5 offset:46080
    s_waitcnt lgkmcnt(10)
    v_mfma_f32_16x16x32_bf16 v[128:131], v[32:35], v[176:179], v[128:131]
    ds_read_b64_tr_b16 v[60:61], v6 offset:45056
    v_mfma_f32_16x16x32_bf16 v[132:135], v[32:35], v[180:183], v[132:135]
    ds_read_b64_tr_b16 v[62:63], v6 offset:46080
    v_mfma_f32_16x16x32_bf16 v[136:139], v[36:39], v[176:179], v[136:139]
    ds_read_b64_tr_b16 v[32:33], v3 offset:49152
    v_mfma_f32_16x16x32_bf16 v[140:143], v[36:39], v[180:183], v[140:143]
    ds_read_b64_tr_b16 v[34:35], v3 offset:50176
    s_waitcnt lgkmcnt(10)
    v_mfma_f32_16x16x32_bf16 v[144:147], v[40:43], v[176:179], v[144:147]
    ds_read_b64_tr_b16 v[36:37], v4 offset:49152
    v_mfma_f32_16x16x32_bf16 v[148:151], v[40:43], v[180:183], v[148:151]
    ds_read_b64_tr_b16 v[38:39], v4 offset:50176
    v_mfma_f32_16x16x32_bf16 v[152:155], v[44:47], v[176:179], v[152:155]
    ds_read_b64_tr_b16 v[40:41], v5 offset:49152
    v_mfma_f32_16x16x32_bf16 v[156:159], v[44:47], v[180:183], v[156:159]
    ds_read_b64_tr_b16 v[42:43], v5 offset:50176
    s_waitcnt lgkmcnt(10)
    v_mfma_f32_16x16x32_bf16 v[128:131], v[48:51], v[184:187], v[128:131]
    ds_read_b64_tr_b16 v[44:45], v6 offset:49152
    ds_read_b32 v8, v9 offset:4096
    v_mfma_f32_16x16x32_bf16 v[132:135], v[48:51], v[188:191], v[132:135]
    ds_read_b64_tr_b16 v[46:47], v6 offset:50176
    ds_read_b32 v10, v9 offset:4608
    v_mfma_f32_16x16x32_bf16 v[136:139], v[52:55], v[184:187], v[136:139]
    ds_read_b64_tr_b16 v[48:49], v3 offset:53248
    ds_read_b32 v12, v9 offset:4160
    v_mfma_f32_16x16x32_bf16 v[140:143], v[52:55], v[188:191], v[140:143]
    ds_read_b64_tr_b16 v[50:51], v3 offset:54272
    ds_read_b32 v14, v9 offset:4672
    s_waitcnt lgkmcnt(14)
    v_mfma_f32_16x16x32_bf16 v[144:147], v[56:59], v[184:187], v[144:147]
    ds_read_b64_tr_b16 v[52:53], v4 offset:53248
    ds_read_b128 v[16:19], v11 offset:0
    v_mfma_f32_16x16x32_bf16 v[148:151], v[56:59], v[188:191], v[148:151]
    ds_read_b64_tr_b16 v[54:55], v4 offset:54272
    ds_read_b128 v[20:23], v11 offset:64
    v_mfma_f32_16x16x32_bf16 v[152:155], v[60:63], v[184:187], v[152:155]
    ds_read_b64_tr_b16 v[56:57], v5 offset:53248
    ds_read_b128 v[24:27], v11 offset:128
    v_mfma_f32_16x16x32_bf16 v[156:159], v[60:63], v[188:191], v[156:159]
    ds_read_b64_tr_b16 v[58:59], v5 offset:54272
    ds_read_b128 v[28:31], v11 offset:192
    s_waitcnt lgkmcnt(14)
    v_mfma_f32_16x16x32_bf16 v[128:131], v[32:35], v[192:195], v[128:131]
    ds_read_b64_tr_b16 v[60:61], v6 offset:53248
    v_add_u32 v13, 153600, v1
    v_mfma_f32_16x16x32_bf16 v[132:135], v[32:35], v[196:199], v[132:135]
    ds_read_b64_tr_b16 v[62:63], v6 offset:54272
    v_mfma_f32_16x16x32_bf16 v[136:139], v[36:39], v[192:195], v[136:139]
    ds_read_b64_tr_b16 v[32:33], v3 offset:57344
    v_mfma_f32_16x16x32_bf16 v[140:143], v[36:39], v[196:199], v[140:143]
    ds_read_b64_tr_b16 v[34:35], v3 offset:58368
    s_waitcnt lgkmcnt(14)
    v_mfma_f32_16x16x32_bf16 v[144:147], v[40:43], v[192:195], v[144:147]
    ds_read_b64_tr_b16 v[36:37], v4 offset:57344
    v_mfma_f32_16x16x32_bf16 v[148:151], v[40:43], v[196:199], v[148:151]
    ds_read_b64_tr_b16 v[38:39], v4 offset:58368
    v_mfma_f32_16x16x32_bf16 v[152:155], v[44:47], v[192:195], v[152:155]
    ds_read_b64_tr_b16 v[40:41], v5 offset:57344
    v_mfma_f32_16x16x32_bf16 v[156:159], v[44:47], v[196:199], v[156:159]
    ds_read_b64_tr_b16 v[42:43], v5 offset:58368
    s_waitcnt lgkmcnt(13)
    v_mfma_f32_16x16x32_bf16 v[128:131], v[48:51], v[200:203], v[128:131]
    ds_read_b64_tr_b16 v[44:45], v6 offset:57344
    s_waitcnt lgkmcnt(9)
    v_mfma_f32_16x16x32_bf16 v[132:135], v[48:51], v[204:207], v[132:135]
    ds_read_b64_tr_b16 v[46:47], v6 offset:58368
    v_mul_f32 v10, 0x3e8293ee, v10
    v_mfma_f32_16x16x32_bf16 v[136:139], v[52:55], v[200:203], v[136:139]
    ds_read_b64_tr_b16 v[48:49], v3 offset:61440
    v_mul_f32 v14, 0x3e8293ee, v14
    v_mfma_f32_16x16x32_bf16 v[140:143], v[52:55], v[204:207], v[140:143]
    ds_read_b64_tr_b16 v[50:51], v3 offset:62464
    ds_read_b128 v[120:123], v13 offset:0
    s_waitcnt lgkmcnt(11)
    v_mfma_f32_16x16x32_bf16 v[144:147], v[56:59], v[200:203], v[144:147]
    ds_read_b64_tr_b16 v[52:53], v4 offset:61440
    ds_read_b128 v[124:127], v13 offset:1024
    v_mfma_f32_16x16x32_bf16 v[148:151], v[56:59], v[204:207], v[148:151]
    ds_read_b64_tr_b16 v[54:55], v4 offset:62464
    v_mfma_f32_16x16x32_bf16 v[152:155], v[60:63], v[200:203], v[152:155]
    ds_read_b64_tr_b16 v[56:57], v5 offset:61440
    v_mfma_f32_16x16x32_bf16 v[156:159], v[60:63], v[204:207], v[156:159]
    ds_read_b64_tr_b16 v[58:59], v5 offset:62464
    s_waitcnt lgkmcnt(12)
    v_mfma_f32_16x16x32_bf16 v[128:131], v[32:35], v[208:211], v[128:131]
    ds_read_b64_tr_b16 v[60:61], v6 offset:61440
    v_mfma_f32_16x16x32_bf16 v[132:135], v[32:35], v[212:215], v[132:135]
    ds_read_b64_tr_b16 v[62:63], v6 offset:62464
    v_xor_b32 v3, 0x10000, v3
    v_xor_b32 v4, 0x10000, v4
    v_xor_b32 v5, 0x10000, v5
    v_xor_b32 v6, 0x10000, v6
    v_mfma_f32_16x16x32_bf16 v[136:139], v[36:39], v[208:211], v[136:139]
    v_mfma_f32_16x16x32_bf16 v[140:143], v[36:39], v[212:215], v[140:143]
    s_waitcnt lgkmcnt(10)
    v_mfma_f32_16x16x32_bf16 v[144:147], v[40:43], v[208:211], v[144:147]
    v_mfma_f32_16x16x32_bf16 v[148:151], v[40:43], v[212:215], v[148:151]
    v_mfma_f32_16x16x32_bf16 v[152:155], v[44:47], v[208:211], v[152:155]
    v_mfma_f32_16x16x32_bf16 v[156:159], v[44:47], v[212:215], v[156:159]
    s_waitcnt lgkmcnt(4)
    v_mfma_f32_16x16x32_bf16 v[128:131], v[48:51], v[216:219], v[128:131]
    v_mfma_f32_16x16x32_bf16 v[132:135], v[48:51], v[220:223], v[132:135]
    v_mfma_f32_16x16x32_bf16 v[136:139], v[52:55], v[216:219], v[136:139]
    v_mfma_f32_16x16x32_bf16 v[140:143], v[52:55], v[220:223], v[140:143]
    s_waitcnt lgkmcnt(0)
    v_mfma_f32_16x16x32_bf16 v[144:147], v[56:59], v[216:219], v[144:147]
    v_mfma_f32_16x16x32_bf16 v[148:151], v[56:59], v[220:223], v[148:151]
    v_mfma_f32_16x16x32_bf16 v[152:155], v[60:63], v[216:219], v[152:155]
    v_mfma_f32_16x16x32_bf16 v[156:159], v[60:63], v[220:223], v[156:159]
    s_lshl_b32 s44, s21, 22
    s_lshl_b32 s45, s38, 16
    s_add_u32 s44, s44, s45
    s_lshl_b32 s45, s18, 12
    s_add_u32 s44, s44, s45
    s_add_u32 s52, s44, 16777216
    v_pk_fma_f32 v[132:133], v[12:13], v[16:17], v[132:133] op_sel_hi:[0,1,1] neg_lo:[1,0,0] neg_hi:[1,0,0]
    v_pk_fma_f32 v[134:135], v[12:13], v[18:19], v[134:135] op_sel_hi:[0,1,1] neg_lo:[1,0,0] neg_hi:[1,0,0]
    v_pk_fma_f32 v[140:141], v[12:13], v[20:21], v[140:141] op_sel_hi:[0,1,1] neg_lo:[1,0,0] neg_hi:[1,0,0]
    v_pk_fma_f32 v[142:143], v[12:13], v[22:23], v[142:143] op_sel_hi:[0,1,1] neg_lo:[1,0,0] neg_hi:[1,0,0]
    v_pk_fma_f32 v[148:149], v[12:13], v[24:25], v[148:149] op_sel_hi:[0,1,1] neg_lo:[1,0,0] neg_hi:[1,0,0]
    v_pk_fma_f32 v[150:151], v[12:13], v[26:27], v[150:151] op_sel_hi:[0,1,1] neg_lo:[1,0,0] neg_hi:[1,0,0]
    v_pk_fma_f32 v[156:157], v[12:13], v[28:29], v[156:157] op_sel_hi:[0,1,1] neg_lo:[1,0,0] neg_hi:[1,0,0]
    v_pk_fma_f32 v[158:159], v[12:13], v[30:31], v[158:159] op_sel_hi:[0,1,1] neg_lo:[1,0,0] neg_hi:[1,0,0]
    v_pk_mul_f32 v[132:133], v[14:15], v[132:133] op_sel_hi:[0,1]
    v_pk_mul_f32 v[134:135], v[14:15], v[134:135] op_sel_hi:[0,1]
    v_pk_mul_f32 v[140:141], v[14:15], v[140:141] op_sel_hi:[0,1]
    v_pk_mul_f32 v[142:143], v[14:15], v[142:143] op_sel_hi:[0,1]
    v_pk_mul_f32 v[148:149], v[14:15], v[148:149] op_sel_hi:[0,1]
    v_pk_mul_f32 v[150:151], v[14:15], v[150:151] op_sel_hi:[0,1]
    v_pk_mul_f32 v[156:157], v[14:15], v[156:157] op_sel_hi:[0,1]
    v_pk_mul_f32 v[158:159], v[14:15], v[158:159] op_sel_hi:[0,1]
    v_cvt_pk_bf16_f32 v132, v132, v133
    v_cvt_pk_bf16_f32 v133, v134, v135
    v_cvt_pk_bf16_f32 v134, v140, v141
    v_cvt_pk_bf16_f32 v135, v142, v143
    v_cvt_pk_bf16_f32 v148, v148, v149
    v_cvt_pk_bf16_f32 v149, v150, v151
    v_cvt_pk_bf16_f32 v150, v156, v157
    v_cvt_pk_bf16_f32 v151, v158, v159
    v_mfma_f32_16x16x32_bf16 v[172:175], v[68:71], v[132:135], v[120:123]
    v_mfma_f32_16x16x32_bf16 v[168:171], v[64:67], v[132:135], v[124:127]
    v_mfma_f32_16x16x32_bf16 v[188:191], v[84:87], v[148:151], v[120:123]
    v_mfma_f32_16x16x32_bf16 v[184:187], v[80:83], v[148:151], v[124:127]
    v_pk_fma_f32 v[128:129], v[8:9], v[16:17], v[128:129] op_sel_hi:[0,1,1] neg_lo:[1,0,0] neg_hi:[1,0,0]
    v_pk_fma_f32 v[130:131], v[8:9], v[18:19], v[130:131] op_sel_hi:[0,1,1] neg_lo:[1,0,0] neg_hi:[1,0,0]
    v_pk_fma_f32 v[136:137], v[8:9], v[20:21], v[136:137] op_sel_hi:[0,1,1] neg_lo:[1,0,0] neg_hi:[1,0,0]
    v_pk_fma_f32 v[138:139], v[8:9], v[22:23], v[138:139] op_sel_hi:[0,1,1] neg_lo:[1,0,0] neg_hi:[1,0,0]
    v_pk_fma_f32 v[144:145], v[8:9], v[24:25], v[144:145] op_sel_hi:[0,1,1] neg_lo:[1,0,0] neg_hi:[1,0,0]
    v_pk_fma_f32 v[146:147], v[8:9], v[26:27], v[146:147] op_sel_hi:[0,1,1] neg_lo:[1,0,0] neg_hi:[1,0,0]
    v_pk_fma_f32 v[152:153], v[8:9], v[28:29], v[152:153] op_sel_hi:[0,1,1] neg_lo:[1,0,0] neg_hi:[1,0,0]
    v_pk_fma_f32 v[154:155], v[8:9], v[30:31], v[154:155] op_sel_hi:[0,1,1] neg_lo:[1,0,0] neg_hi:[1,0,0]
    v_pk_mul_f32 v[128:129], v[10:11], v[128:129] op_sel_hi:[0,1]
    v_pk_mul_f32 v[130:131], v[10:11], v[130:131] op_sel_hi:[0,1]
    v_pk_mul_f32 v[136:137], v[10:11], v[136:137] op_sel_hi:[0,1]
    v_pk_mul_f32 v[138:139], v[10:11], v[138:139] op_sel_hi:[0,1]
    v_pk_mul_f32 v[144:145], v[10:11], v[144:145] op_sel_hi:[0,1]
    v_pk_mul_f32 v[146:147], v[10:11], v[146:147] op_sel_hi:[0,1]
    v_pk_mul_f32 v[152:153], v[10:11], v[152:153] op_sel_hi:[0,1]
    v_pk_mul_f32 v[154:155], v[10:11], v[154:155] op_sel_hi:[0,1]
    v_cvt_pk_bf16_f32 v128, v128, v129
    v_cvt_pk_bf16_f32 v129, v130, v131
    v_cvt_pk_bf16_f32 v130, v136, v137
    v_cvt_pk_bf16_f32 v131, v138, v139
    v_cvt_pk_bf16_f32 v144, v144, v145
    v_cvt_pk_bf16_f32 v145, v146, v147
    v_cvt_pk_bf16_f32 v146, v152, v153
    v_cvt_pk_bf16_f32 v147, v154, v155
    v_mfma_f32_16x16x32_bf16 v[164:167], v[64:67], v[128:131], v[120:123]
    s_nop 0
    v_mfma_f32_16x16x32_bf16 v[180:183], v[80:83], v[144:147], v[120:123]
    v_mov_b32 v232, 0x3f803f80
    v_mov_b32 v233, 0x3f803f80
    v_mov_b32 v234, 0x3f803f80
    v_mov_b32 v235, 0x3f803f80
    v_exp_f32 v172, v172
    v_exp_f32 v173, v173
    v_exp_f32 v174, v174
    v_exp_f32 v175, v175
    v_exp_f32 v188, v188
    v_exp_f32 v189, v189
    v_exp_f32 v190, v190
    v_exp_f32 v191, v191
    s_mov_b32 s46, 1006632960
a_exp1:
    v_exp_f32 v168, v168
    v_exp_f32 v169, v169
    v_exp_f32 v170, v170
    v_exp_f32 v171, v171
    v_exp_f32 v184, v184
    v_exp_f32 v185, v185
    v_exp_f32 v186, v186
    v_exp_f32 v187, v187
    v_cvt_pk_bf16_f32 v200, v168, v169
    v_cvt_pk_bf16_f32 v201, v170, v171
    v_cvt_pk_bf16_f32 v202, v172, v173
    v_cvt_pk_bf16_f32 v203, v174, v175
    v_cvt_pk_bf16_f32 v204, v184, v185
    v_cvt_pk_bf16_f32 v205, v186, v187
    v_cvt_pk_bf16_f32 v206, v188, v189
    v_cvt_pk_bf16_f32 v207, v190, v191
    v_mfma_f32_16x16x32_bf16 v[16:19], v[232:235], v[200:203], 0
    s_nop 0
    v_mfma_f32_16x16x32_bf16 v[20:23], v[232:235], v[204:207], 0
    v_mfma_f32_16x16x32_bf16 v[40:43], v[72:75], v[200:203], 0
    v_mfma_f32_16x16x32_bf16 v[44:47], v[76:79], v[200:203], 0
    v_mfma_f32_16x16x32_bf16 v[56:59], v[88:91], v[204:207], 0
    v_mfma_f32_16x16x32_bf16 v[60:63], v[92:95], v[204:207], 0
    v_mov_b32 v218, v72
    v_mov_b32 v219, v73
    v_mov_b32 v222, v76
    v_mov_b32 v223, v77
    v_mov_b32 v226, v88
    v_mov_b32 v227, v89
    v_mov_b32 v230, v92
    v_mov_b32 v231, v93
    v_subrev_u32 v18, 0x21800000, v16
    v_subrev_u32 v22, 0x21800000, v20
    v_max_u32 v18, v18, v22
    v_cmp_le_u32 vcc, s46, v18
    v_rcp_f32 v16, v16
    v_rcp_f32 v20, v20
    s_cbranch_vccnz a_slow1
a_fin1:
    v_pk_mul_f32 v[40:41], v[16:17], v[40:41] op_sel_hi:[0,1]
    v_pk_mul_f32 v[42:43], v[16:17], v[42:43] op_sel_hi:[0,1]
    v_pk_mul_f32 v[44:45], v[16:17], v[44:45] op_sel_hi:[0,1]
    v_pk_mul_f32 v[46:47], v[16:17], v[46:47] op_sel_hi:[0,1]
    v_pk_mul_f32 v[56:57], v[20:21], v[56:57] op_sel_hi:[0,1]
    v_pk_mul_f32 v[58:59], v[20:21], v[58:59] op_sel_hi:[0,1]
    v_pk_mul_f32 v[60:61], v[20:21], v[60:61] op_sel_hi:[0,1]
    v_pk_mul_f32 v[62:63], v[20:21], v[62:63] op_sel_hi:[0,1]
    v_cvt_pk_bf16_f32 v40, v40, v41
    v_cvt_pk_bf16_f32 v41, v42, v43
    v_cvt_pk_bf16_f32 v42, v44, v45
    v_cvt_pk_bf16_f32 v43, v46, v47
    v_cvt_pk_bf16_f32 v56, v56, v57
    v_cvt_pk_bf16_f32 v57, v58, v59
    v_cvt_pk_bf16_f32 v58, v60, v61
    v_cvt_pk_bf16_f32 v59, v62, v63
    v_permlane32_swap_b32 v40, v42
    v_permlane32_swap_b32 v41, v43
    buffer_store_dwordx4 v[40:43], v2, s[4:7], s52 offen offset:256 sc1
    v_permlane32_swap_b32 v56, v58
    v_permlane32_swap_b32 v57, v59
    buffer_store_dwordx4 v[56:59], v2, s[4:7], s52 offen offset:2304 sc1
    s_cmp_lg_u32 s38, 0
    s_cbranch_scc1 a_hasprev
    v_mov_b32 v124, 0xf149f2ca
    v_mov_b32 v125, 0xf149f2ca
    v_mov_b32 v126, 0xf149f2ca
    v_mov_b32 v127, 0xf149f2ca
a_hasprev:
    s_waitcnt lgkmcnt(0)
    s_barrier
    ds_read_b128 v[192:195], v7 offset:0
    ds_read_b128 v[196:199], v7 offset:1024
    ds_read_b64 v[216:217], v7 offset:2048
    ds_read_b64 v[220:221], v7 offset:2056
    ds_read_b64 v[224:225], v7 offset:3072
    ds_read_b64 v[228:229], v7 offset:3080
    s_waitcnt lgkmcnt(4)
    v_mfma_f32_16x16x32_bf16 v[160:163], v[192:195], v[128:131], v[124:127]
    v_mfma_f32_16x16x32_bf16 v[176:179], v[196:199], v[144:147], v[124:127]
    v_exp_f32 v164, v164
    v_exp_f32 v165, v165
    v_exp_f32 v166, v166
    v_exp_f32 v167, v167
    v_exp_f32 v180, v180
    v_exp_f32 v181, v181
    v_exp_f32 v182, v182
    v_exp_f32 v183, v183
    s_waitcnt lgkmcnt(0)
    s_mov_b32 s46, 1006632960
a_exp0:
    v_exp_f32 v160, v160
    v_exp_f32 v161, v161
    v_exp_f32 v162, v162
    v_exp_f32 v163, v163
    v_exp_f32 v176, v176
    v_exp_f32 v177, v177
    v_exp_f32 v178, v178
    v_exp_f32 v179, v179
    v_cvt_pk_bf16_f32 v200, v160, v161
    v_cvt_pk_bf16_f32 v201, v162, v163
    v_cvt_pk_bf16_f32 v202, v164, v165
    v_cvt_pk_bf16_f32 v203, v166, v167
    v_cvt_pk_bf16_f32 v204, v176, v177
    v_cvt_pk_bf16_f32 v205, v178, v179
    v_cvt_pk_bf16_f32 v206, v180, v181
    v_cvt_pk_bf16_f32 v207, v182, v183
    v_mfma_f32_16x16x32_bf16 v[16:19], v[232:235], v[200:203], 0
    s_nop 0
    v_mfma_f32_16x16x32_bf16 v[20:23], v[232:235], v[204:207], 0
    v_mfma_f32_16x16x32_bf16 v[32:35], v[216:219], v[200:203], 0
    v_mfma_f32_16x16x32_bf16 v[36:39], v[220:223], v[200:203], 0
    v_mfma_f32_16x16x32_bf16 v[48:51], v[224:227], v[204:207], 0
    v_mfma_f32_16x16x32_bf16 v[52:55], v[228:231], v[204:207], 0
    s_nop 1
    v_subrev_u32 v18, 0x21800000, v16
    s_nop 0
    v_subrev_u32 v22, 0x21800000, v20
    v_max_u32 v18, v18, v22
    v_cmp_le_u32 vcc, s46, v18
    v_rcp_f32 v16, v16
    v_rcp_f32 v20, v20
    s_cbranch_vccnz a_slow0
a_fin0:
    v_pk_mul_f32 v[32:33], v[16:17], v[32:33] op_sel_hi:[0,1]
    v_pk_mul_f32 v[34:35], v[16:17], v[34:35] op_sel_hi:[0,1]
    v_pk_mul_f32 v[36:37], v[16:17], v[36:37] op_sel_hi:[0,1]
    v_pk_mul_f32 v[38:39], v[16:17], v[38:39] op_sel_hi:[0,1]
    v_pk_mul_f32 v[48:49], v[20:21], v[48:49] op_sel_hi:[0,1]
    v_pk_mul_f32 v[50:51], v[20:21], v[50:51] op_sel_hi:[0,1]
    v_pk_mul_f32 v[52:53], v[20:21], v[52:53] op_sel_hi:[0,1]
    v_pk_mul_f32 v[54:55], v[20:21], v[54:55] op_sel_hi:[0,1]
    v_cvt_pk_bf16_f32 v32, v32, v33
    v_cvt_pk_bf16_f32 v33, v34, v35
    v_cvt_pk_bf16_f32 v34, v36, v37
    v_cvt_pk_bf16_f32 v35, v38, v39
    v_cvt_pk_bf16_f32 v48, v48, v49
    v_cvt_pk_bf16_f32 v49, v50, v51
    v_cvt_pk_bf16_f32 v50, v52, v53
    v_cvt_pk_bf16_f32 v51, v54, v55
    v_permlane32_swap_b32 v32, v34
    v_permlane32_swap_b32 v33, v35
    buffer_store_dwordx4 v[32:35], v2, s[4:7], s52 offen offset:0 sc1
    v_permlane32_swap_b32 v48, v50
    v_permlane32_swap_b32 v49, v51
    buffer_store_dwordx4 v[48:51], v2, s[4:7], s52 offen offset:2048 sc1
    s_lshl_b32 s44, s21, 22
    s_lshl_b32 s45, s38, 16
    s_add_u32 s41, s44, s45
    s_lshl_b32 s45, s18, 12
    s_add_u32 s43, s41, s45
    s_and_b32 s45, s45, 0
    s_add_u32 s41, s41, s45
    s_add_u32 s41, s41, 16777216
    buffer_load_dwordx4 v[224:227], v2, s[4:7], s43 offen offset:0 sc1
    buffer_load_dwordx4 v[228:231], v2, s[4:7], s43 offen offset:256 sc1
    buffer_load_dwordx4 v[232:235], v2, s[4:7], s43 offen offset:2048 sc1
    buffer_load_dwordx4 v[236:239], v2, s[4:7], s43 offen offset:2304 sc1
    s_barrier
    s_lshl_b32 s46, s21, 14
    s_lshl_b32 s67, s38, 8
    s_add_u32 s46, s46, s67
    s_add_u32 s46, s46, 86144
    s_lshl_b32 s47, s21, 14
    s_lshl_b32 s67, s38, 8
    s_add_u32 s47, s47, s67
    s_add_u32 s47, s47, 86144
    s_waitcnt vmcnt(4)
    s_atomic_add s40, s[22:23], s46
    s_mov_b32 s66, 0x10000
c_o_poll:
    s_mov_b32 s68, 0
    s_atomic_add s68, s[22:23], s47 offset:0 glc
    s_sub_u32 s66, s66, 1
    s_cselect_b32 s67, 16, 0
    s_waitcnt lgkmcnt(0)
    s_max_u32 s68, s68, s67
    s_cmp_lt_u32 s68, 16
    s_cbranch_scc1 c_o_poll
c_o_ok:
    s_branch c_wo
a_slow1:
    s_cmp_eq_u32 s46, 0
    s_cbranch_scc1 a_fin1
    s_mov_b32 s46, 0
    v_mfma_f32_16x16x32_bf16 v[172:175], v[68:71], v[132:135], v[120:123]
    v_mfma_f32_16x16x32_bf16 v[168:171], v[64:67], v[132:135], v[124:127]
    v_mfma_f32_16x16x32_bf16 v[188:191], v[84:87], v[148:151], v[120:123]
    v_mfma_f32_16x16x32_bf16 v[184:187], v[80:83], v[148:151], v[124:127]
    s_nop 5
    v_max3_f32 v24, v168, v169, v170
    v_max3_f32 v24, v24, v171, v172
    v_max3_f32 v24, v24, v173, v174
    v_max_f32 v24, v24, v175
    v_max3_f32 v26, v184, v185, v186
    v_max3_f32 v26, v26, v187, v188
    v_max3_f32 v26, v26, v189, v190
    v_max_f32 v26, v26, v191
    v_mov_b32 v25, v24
    v_mov_b32 v27, v26
    s_nop 0
    v_permlane32_swap_b32 v24, v25
    v_permlane32_swap_b32 v26, v27
    v_max_f32 v24, v24, v25
    v_max_f32 v26, v26, v27
    v_mov_b32 v25, v24
    v_mov_b32 v27, v26
    s_nop 0
    v_permlane16_swap_b32 v24, v25
    v_permlane16_swap_b32 v26, v27
    v_max_f32 v24, v24, v25
    v_max_f32 v26, v26, v27
    v_sub_f32 v168, v168, v24
    v_sub_f32 v169, v169, v24
    v_sub_f32 v170, v170, v24
    v_sub_f32 v171, v171, v24
    v_sub_f32 v172, v172, v24
    v_sub_f32 v173, v173, v24
    v_sub_f32 v174, v174, v24
    v_sub_f32 v175, v175, v24
    v_sub_f32 v184, v184, v26
    v_sub_f32 v185, v185, v26
    v_sub_f32 v186, v186, v26
    v_sub_f32 v187, v187, v26
    v_sub_f32 v188, v188, v26
    v_sub_f32 v189, v189, v26
    v_sub_f32 v190, v190, v26
    v_sub_f32 v191, v191, v26
    v_exp_f32 v172, v172
    v_exp_f32 v173, v173
    v_exp_f32 v174, v174
    v_exp_f32 v175, v175
    v_exp_f32 v188, v188
    v_exp_f32 v189, v189
    v_exp_f32 v190, v190
    v_exp_f32 v191, v191
    s_branch a_exp1
a_slow0:
    s_cmp_eq_u32 s46, 0
    s_cbranch_scc1 a_fin0
    s_mov_b32 s46, 0
    v_mfma_f32_16x16x32_bf16 v[164:167], v[64:67], v[128:131], v[120:123]
    v_mfma_f32_16x16x32_bf16 v[160:163], v[192:195], v[128:131], v[124:127]
    v_mfma_f32_16x16x32_bf16 v[180:183], v[80:83], v[144:147], v[120:123]
    v_mfma_f32_16x16x32_bf16 v[176:179], v[196:199], v[144:147], v[124:127]
    s_nop 5
    v_max3_f32 v24, v160, v161, v162
    v_max3_f32 v24, v24, v163, v164
    v_max3_f32 v24, v24, v165, v166
    v_max_f32 v24, v24, v167
    v_max3_f32 v26, v176, v177, v178
    v_max3_f32 v26, v26, v179, v180
    v_max3_f32 v26, v26, v181, v182
    v_max_f32 v26, v26, v183
    v_mov_b32 v25, v24
    v_mov_b32 v27, v26
    s_nop 0
    v_permlane32_swap_b32 v24, v25
    v_permlane32_swap_b32 v26, v27
    v_max_f32 v24, v24, v25
    v_max_f32 v26, v26, v27
    v_mov_b32 v25, v24
    v_mov_b32 v27, v26
    s_nop 0
    v_permlane16_swap_b32 v24, v25
    v_permlane16_swap_b32 v26, v27
    v_max_f32 v24, v24, v25
    v_max_f32 v26, v26, v27
    v_sub_f32 v160, v160, v24
    v_sub_f32 v161, v161, v24
    v_sub_f32 v162, v162, v24
    v_sub_f32 v163, v163, v24
    v_sub_f32 v164, v164, v24
    v_sub_f32 v165, v165, v24
    v_sub_f32 v166, v166, v24
    v_sub_f32 v167, v167, v24
    v_sub_f32 v176, v176, v26
    v_sub_f32 v177, v177, v26
    v_sub_f32 v178, v178, v26
    v_sub_f32 v179, v179, v26
    v_sub_f32 v180, v180, v26
    v_sub_f32 v181, v181, v26
    v_sub_f32 v182, v182, v26
    v_sub_f32 v183, v183, v26
    v_exp_f32 v164, v164
    v_exp_f32 v165, v165
    v_exp_f32 v166, v166
    v_exp_f32 v167, v167
    v_exp_f32 v180, v180
    v_exp_f32 v181, v181
    v_exp_f32 v182, v182
    v_exp_f32 v183, v183
    s_branch a_exp0
c_B:
    s_waitcnt lgkmcnt(6)
    v_pk_fma_f32 v[64:65], v[8:9], v[16:17], v[64:65] op_sel_hi:[0,1,1] neg_lo:[1,0,0] neg_hi:[1,0,0]
    v_pk_fma_f32 v[66:67], v[8:9], v[18:19], v[66:67] op_sel_hi:[0,1,1] neg_lo:[1,0,0] neg_hi:[1,0,0]
    v_pk_fma_f32 v[72:73], v[8:9], v[20:21], v[72:73] op_sel_hi:[0,1,1] neg_lo:[1,0,0] neg_hi:[1,0,0]
    v_pk_fma_f32 v[74:75], v[8:9], v[22:23], v[74:75] op_sel_hi:[0,1,1] neg_lo:[1,0,0] neg_hi:[1,0,0]
    v_pk_mul_f32 v[64:65], v[10:11], v[64:65] op_sel_hi:[0,1]
    v_pk_mul_f32 v[66:67], v[10:11], v[66:67] op_sel_hi:[0,1]
    v_pk_mul_f32 v[72:73], v[10:11], v[72:73] op_sel_hi:[0,1]
    v_pk_mul_f32 v[74:75], v[10:11], v[74:75] op_sel_hi:[0,1]
    v_cvt_pk_bf16_f32 v64, v64, v65
    v_cvt_pk_bf16_f32 v65, v66, v67
    v_cvt_pk_bf16_f32 v66, v72, v73
    v_cvt_pk_bf16_f32 v67, v74, v75
    s_add_u32 s55, s52, 0
    buffer_store_dwordx4 v[64:67], v2, s[4:7], s55 offen offset:0 sc1
    v_pk_fma_f32 v[68:69], v[12:13], v[16:17], v[68:69] op_sel_hi:[0,1,1] neg_lo:[1,0,0] neg_hi:[1,0,0]
    v_pk_fma_f32 v[70:71], v[12:13], v[18:19], v[70:71] op_sel_hi:[0,1,1] neg_lo:[1,0,0] neg_hi:[1,0,0]
    v_pk_fma_f32 v[76:77], v[12:13], v[20:21], v[76:77] op_sel_hi:[0,1,1] neg_lo:[1,0,0] neg_hi:[1,0,0]
    v_pk_fma_f32 v[78:79], v[12:13], v[22:23], v[78:79] op_sel_hi:[0,1,1] neg_lo:[1,0,0] neg_hi:[1,0,0]
    v_pk_mul_f32 v[68:69], v[14:15], v[68:69] op_sel_hi:[0,1]
    v_pk_mul_f32 v[70:71], v[14:15], v[70:71] op_sel_hi:[0,1]
    v_pk_mul_f32 v[76:77], v[14:15], v[76:77] op_sel_hi:[0,1]
    v_pk_mul_f32 v[78:79], v[14:15], v[78:79] op_sel_hi:[0,1]
    v_cvt_pk_bf16_f32 v68, v68, v69
    v_cvt_pk_bf16_f32 v69, v70, v71
    v_cvt_pk_bf16_f32 v70, v76, v77
    v_cvt_pk_bf16_f32 v71, v78, v79
    buffer_store_dwordx4 v[68:71], v2, s[4:7], s55 offen offset:256 sc1
    v_pk_fma_f32 v[80:81], v[8:9], v[24:25], v[80:81] op_sel_hi:[0,1,1] neg_lo:[1,0,0] neg_hi:[1,0,0]
    v_pk_fma_f32 v[82:83], v[8:9], v[26:27], v[82:83] op_sel_hi:[0,1,1] neg_lo:[1,0,0] neg_hi:[1,0,0]
    v_pk_fma_f32 v[88:89], v[8:9], v[28:29], v[88:89] op_sel_hi:[0,1,1] neg_lo:[1,0,0] neg_hi:[1,0,0]
    v_pk_fma_f32 v[90:91], v[8:9], v[30:31], v[90:91] op_sel_hi:[0,1,1] neg_lo:[1,0,0] neg_hi:[1,0,0]
    v_pk_mul_f32 v[80:81], v[10:11], v[80:81] op_sel_hi:[0,1]
    v_pk_mul_f32 v[82:83], v[10:11], v[82:83] op_sel_hi:[0,1]
    v_pk_mul_f32 v[88:89], v[10:11], v[88:89] op_sel_hi:[0,1]
    v_pk_mul_f32 v[90:91], v[10:11], v[90:91] op_sel_hi:[0,1]
    v_cvt_pk_bf16_f32 v80, v80, v81
    v_cvt_pk_bf16_f32 v81, v82, v83
    v_cvt_pk_bf16_f32 v82, v88, v89
    v_cvt_pk_bf16_f32 v83, v90, v91
    s_add_u32 s55, s52, 131072
    buffer_store_dwordx4 v[80:83], v2, s[4:7], s55 offen offset:0 sc1
    v_pk_fma_f32 v[84:85], v[12:13], v[24:25], v[84:85] op_sel_hi:[0,1,1] neg_lo:[1,0,0] neg_hi:[1,0,0]
    v_pk_fma_f32 v[86:87], v[12:13], v[26:27], v[86:87] op_sel_hi:[0,1,1] neg_lo:[1,0,0] neg_hi:[1,0,0]
    v_pk_fma_f32 v[92:93], v[12:13], v[28:29], v[92:93] op_sel_hi:[0,1,1] neg_lo:[1,0,0] neg_hi:[1,0,0]
    v_pk_fma_f32 v[94:95], v[12:13], v[30:31], v[94:95] op_sel_hi:[0,1,1] neg_lo:[1,0,0] neg_hi:[1,0,0]
    v_pk_mul_f32 v[84:85], v[14:15], v[84:85] op_sel_hi:[0,1]
    v_pk_mul_f32 v[86:87], v[14:15], v[86:87] op_sel_hi:[0,1]
    v_pk_mul_f32 v[92:93], v[14:15], v[92:93] op_sel_hi:[0,1]
    v_pk_mul_f32 v[94:95], v[14:15], v[94:95] op_sel_hi:[0,1]
    v_cvt_pk_bf16_f32 v84, v84, v85
    v_cvt_pk_bf16_f32 v85, v86, v87
    v_cvt_pk_bf16_f32 v86, v92, v93
    v_cvt_pk_bf16_f32 v87, v94, v95
    buffer_store_dwordx4 v[84:87], v2, s[4:7], s55 offen offset:256 sc1
    v_mfma_f32_16x16x32_bf16 v[96:99], v[160:163], v[32:35], v[96:99]
    ds_read_b64_tr_b16 v[60:61], v6 offset:53248
    v_mfma_f32_16x16x32_bf16 v[100:103], v[164:167], v[32:35], v[100:103]
    ds_read_b64_tr_b16 v[62:63], v6 offset:54272
    v_mfma_f32_16x16x32_bf16 v[104:107], v[160:163], v[36:39], v[104:107]
    ds_read_b64_tr_b16 v[32:33], v3 offset:57344
    v_mfma_f32_16x16x32_bf16 v[108:111], v[164:167], v[36:39], v[108:111]
    ds_read_b64_tr_b16 v[34:35], v3 offset:58368
    v_mfma_f32_16x16x32_bf16 v[112:115], v[160:163], v[40:43], v[112:115]
    ds_read_b64_tr_b16 v[36:37], v4 offset:57344
    v_mfma_f32_16x16x32_bf16 v[116:119], v[164:167], v[40:43], v[116:119]
    ds_read_b64_tr_b16 v[38:39], v4 offset:58368
    v_mfma_f32_16x16x32_bf16 v[120:123], v[160:163], v[44:47], v[120:123]
    ds_read_b64_tr_b16 v[40:41], v5 offset:57344
    v_mfma_f32_16x16x32_bf16 v[124:127], v[164:167], v[44:47], v[124:127]
    ds_read_b64_tr_b16 v[42:43], v5 offset:58368
    s_waitcnt lgkmcnt(10)
    v_mfma_f32_16x16x32_bf16 v[96:99], v[168:171], v[48:51], v[96:99]
    ds_read_b64_tr_b16 v[44:45], v6 offset:57344
    v_mfma_f32_16x16x32_bf16 v[100:103], v[172:175], v[48:51], v[100:103]
    ds_read_b64_tr_b16 v[46:47], v6 offset:58368
    v_mfma_f32_16x16x32_bf16 v[104:107], v[168:171], v[52:55], v[104:107]
    ds_read_b64_tr_b16 v[48:49], v3 offset:61440
    v_mfma_f32_16x16x32_bf16 v[108:111], v[172:175], v[52:55], v[108:111]
    ds_read_b64_tr_b16 v[50:51], v3 offset:62464
    s_waitcnt lgkmcnt(10)
    v_mfma_f32_16x16x32_bf16 v[112:115], v[168:171], v[56:59], v[112:115]
    ds_read_b64_tr_b16 v[52:53], v4 offset:61440
    v_mfma_f32_16x16x32_bf16 v[116:119], v[172:175], v[56:59], v[116:119]
    ds_read_b64_tr_b16 v[54:55], v4 offset:62464
    v_mfma_f32_16x16x32_bf16 v[120:123], v[168:171], v[60:63], v[120:123]
    ds_read_b64_tr_b16 v[56:57], v5 offset:61440
    v_mfma_f32_16x16x32_bf16 v[124:127], v[172:175], v[60:63], v[124:127]
    ds_read_b64_tr_b16 v[58:59], v5 offset:62464
    s_waitcnt lgkmcnt(10)
    v_mfma_f32_16x16x32_bf16 v[96:99], v[176:179], v[32:35], v[96:99]
    ds_read_b64_tr_b16 v[60:61], v6 offset:61440
    v_mfma_f32_16x16x32_bf16 v[100:103], v[180:183], v[32:35], v[100:103]
    ds_read_b64_tr_b16 v[62:63], v6 offset:62464
    s_barrier
    v_xor_b32 v3, 0x10000, v3
    v_xor_b32 v4, 0x10000, v4
    v_xor_b32 v5, 0x10000, v5
    v_xor_b32 v6, 0x10000, v6
    v_mfma_f32_16x16x32_bf16 v[104:107], v[176:179], v[36:39], v[104:107]
    ds_read_b64_tr_b16 v[32:33], v3 offset:0
    v_mfma_f32_16x16x32_bf16 v[108:111], v[180:183], v[36:39], v[108:111]
    ds_read_b64_tr_b16 v[34:35], v3 offset:1024
    s_waitcnt lgkmcnt(10)
    v_mfma_f32_16x16x32_bf16 v[112:115], v[176:179], v[40:43], v[112:115]
    ds_read_b64_tr_b16 v[36:37], v4 offset:0
    v_mfma_f32_16x16x32_bf16 v[116:119], v[180:183], v[40:43], v[116:119]
    ds_read_b64_tr_b16 v[38:39], v4 offset:1024
    v_mfma_f32_16x16x32_bf16 v[120:123], v[176:179], v[44:47], v[120:123]
    ds_read_b64_tr_b16 v[40:41], v5 offset:0
    v_mfma_f32_16x16x32_bf16 v[124:127], v[180:183], v[44:47], v[124:127]
    ds_read_b64_tr_b16 v[42:43], v5 offset:1024
    s_waitcnt lgkmcnt(10)
    v_mfma_f32_16x16x32_bf16 v[96:99], v[184:187], v[48:51], v[96:99]
    ds_read_b64_tr_b16 v[44:45], v6 offset:0
    v_mfma_f32_16x16x32_bf16 v[100:103], v[188:191], v[48:51], v[100:103]
    ds_read_b64_tr_b16 v[46:47], v6 offset:1024
    v_mfma_f32_16x16x32_bf16 v[104:107], v[184:187], v[52:55], v[104:107]
    ds_read_b64_tr_b16 v[48:49], v3 offset:4096
    v_mfma_f32_16x16x32_bf16 v[108:111], v[188:191], v[52:55], v[108:111]
    ds_read_b64_tr_b16 v[50:51], v3 offset:5120
    s_waitcnt lgkmcnt(10)
    v_mfma_f32_16x16x32_bf16 v[112:115], v[184:187], v[56:59], v[112:115]
    ds_read_b64_tr_b16 v[52:53], v4 offset:4096
    v_mfma_f32_16x16x32_bf16 v[116:119], v[188:191], v[56:59], v[116:119]
    ds_read_b64_tr_b16 v[54:55], v4 offset:5120
    v_mfma_f32_16x16x32_bf16 v[120:123], v[184:187], v[60:63], v[120:123]
    ds_read_b64_tr_b16 v[56:57], v5 offset:4096
    v_mfma_f32_16x16x32_bf16 v[124:127], v[188:191], v[60:63], v[124:127]
    ds_read_b64_tr_b16 v[58:59], v5 offset:5120
    s_waitcnt lgkmcnt(10)
    v_mfma_f32_16x16x32_bf16 v[96:99], v[192:195], v[32:35], v[96:99]
    ds_read_b64_tr_b16 v[60:61], v6 offset:4096
    v_mfma_f32_16x16x32_bf16 v[100:103], v[196:199], v[32:35], v[100:103]
    ds_read_b64_tr_b16 v[62:63], v6 offset:5120
    v_mfma_f32_16x16x32_bf16 v[104:107], v[192:195], v[36:39], v[104:107]
    ds_read_b64_tr_b16 v[32:33], v3 offset:8192
    v_mfma_f32_16x16x32_bf16 v[108:111], v[196:199], v[36:39], v[108:111]
    ds_read_b64_tr_b16 v[34:35], v3 offset:9216
    s_waitcnt lgkmcnt(10)
    v_mfma_f32_16x16x32_bf16 v[112:115], v[192:195], v[40:43], v[112:115]
    ds_read_b64_tr_b16 v[36:37], v4 offset:8192
    v_mfma_f32_16x16x32_bf16 v[116:119], v[196:199], v[40:43], v[116:119]
    ds_read_b64_tr_b16 v[38:39], v4 offset:9216
    v_mfma_f32_16x16x32_bf16 v[120:123], v[192:195], v[44:47], v[120:123]
    ds_read_b64_tr_b16 v[40:41], v5 offset:8192
    v_mfma_f32_16x16x32_bf16 v[124:127], v[196:199], v[44:47], v[124:127]
    ds_read_b64_tr_b16 v[42:43], v5 offset:9216
    s_waitcnt lgkmcnt(10)
    v_mfma_f32_16x16x32_bf16 v[96:99], v[200:203], v[48:51], v[96:99]
    ds_read_b64_tr_b16 v[44:45], v6 offset:8192
    v_mfma_f32_16x16x32_bf16 v[100:103], v[204:207], v[48:51], v[100:103]
    ds_read_b64_tr_b16 v[46:47], v6 offset:9216
    v_mfma_f32_16x16x32_bf16 v[104:107], v[200:203], v[52:55], v[104:107]
    ds_read_b64_tr_b16 v[48:49], v3 offset:12288
    v_mfma_f32_16x16x32_bf16 v[108:111], v[204:207], v[52:55], v[108:111]
    ds_read_b64_tr_b16 v[50:51], v3 offset:13312
    s_waitcnt lgkmcnt(10)
    v_mfma_f32_16x16x32_bf16 v[112:115], v[200:203], v[56:59], v[112:115]
    ds_read_b64_tr_b16 v[52:53], v4 offset:12288
    v_mfma_f32_16x16x32_bf16 v[116:119], v[204:207], v[56:59], v[116:119]
    ds_read_b64_tr_b16 v[54:55], v4 offset:13312
    v_mfma_f32_16x16x32_bf16 v[120:123], v[200:203], v[60:63], v[120:123]
    ds_read_b64_tr_b16 v[56:57], v5 offset:12288
    v_mfma_f32_16x16x32_bf16 v[124:127], v[204:207], v[60:63], v[124:127]
    ds_read_b64_tr_b16 v[58:59], v5 offset:13312
    s_waitcnt lgkmcnt(10)
    v_mfma_f32_16x16x32_bf16 v[96:99], v[208:211], v[32:35], v[96:99]
    ds_read_b64_tr_b16 v[60:61], v6 offset:12288
    v_mfma_f32_16x16x32_bf16 v[100:103], v[212:215], v[32:35], v[100:103]
    ds_read_b64_tr_b16 v[62:63], v6 offset:13312
    v_mfma_f32_16x16x32_bf16 v[104:107], v[208:211], v[36:39], v[104:107]
    ds_read_b64_tr_b16 v[32:33], v3 offset:16384
    ds_read_b128 v[16:19], v13 offset:4096
    v_mfma_f32_16x16x32_bf16 v[108:111], v[212:215], v[36:39], v[108:111]
    ds_read_b64_tr_b16 v[34:35], v3 offset:17408
    ds_read_b128 v[20:23], v13 offset:4608
    s_waitcnt lgkmcnt(12)
    v_mfma_f32_16x16x32_bf16 v[112:115], v[208:211], v[40:43], v[112:115]
    ds_read_b64_tr_b16 v[36:37], v4 offset:16384
    ds_read_b128 v[24:27], v13 offset:4160
    v_mfma_f32_16x16x32_bf16 v[116:119], v[212:215], v[40:43], v[116:119]
    ds_read_b64_tr_b16 v[38:39], v4 offset:17408
    ds_read_b128 v[28:31], v13 offset:4672
    v_mfma_f32_16x16x32_bf16 v[120:123], v[208:211], v[44:47], v[120:123]
    ds_read_b64_tr_b16 v[40:41], v5 offset:16384
    ds_read_b32 v8, v15 offset:512
    v_mfma_f32_16x16x32_bf16 v[124:127], v[212:215], v[44:47], v[124:127]
    ds_read_b64_tr_b16 v[42:43], v5 offset:17408
    ds_read_b32 v10, v15 offset:576
    s_waitcnt lgkmcnt(14)
    v_mfma_f32_16x16x32_bf16 v[96:99], v[216:219], v[48:51], v[96:99]
    ds_read_b64_tr_b16 v[44:45], v6 offset:16384
    ds_read_b32 v12, v15 offset:640
    v_mfma_f32_16x16x32_bf16 v[100:103], v[220:223], v[48:51], v[100:103]
    ds_read_b64_tr_b16 v[46:47], v6 offset:17408
    ds_read_b32 v14, v15 offset:704
    v_mfma_f32_16x16x32_bf16 v[104:107], v[216:219], v[52:55], v[104:107]
    ds_read_b64_tr_b16 v[48:49], v3 offset:20480
    v_mfma_f32_16x16x32_bf16 v[108:111], v[220:223], v[52:55], v[108:111]
    ds_read_b64_tr_b16 v[50:51], v3 offset:21504
    s_waitcnt lgkmcnt(14)
    v_mfma_f32_16x16x32_bf16 v[112:115], v[216:219], v[56:59], v[112:115]
    ds_read_b64_tr_b16 v[52:53], v4 offset:20480
    v_mfma_f32_16x16x32_bf16 v[116:119], v[220:223], v[56:59], v[116:119]
    ds_read_b64_tr_b16 v[54:55], v4 offset:21504
    v_mfma_f32_16x16x32_bf16 v[120:123], v[216:219], v[60:63], v[120:123]
    ds_read_b64_tr_b16 v[56:57], v5 offset:20480
    v_mfma_f32_16x16x32_bf16 v[124:127], v[220:223], v[60:63], v[124:127]
    ds_read_b64_tr_b16 v[58:59], v5 offset:21504
    s_waitcnt lgkmcnt(6)
    v_pk_fma_f32 v[96:97], v[8:9], v[16:17], v[96:97] op_sel_hi:[0,1,1] neg_lo:[1,0,0] neg_hi:[1,0,0]
    v_pk_fma_f32 v[98:99], v[8:9], v[18:19], v[98:99] op_sel_hi:[0,1,1] neg_lo:[1,0,0] neg_hi:[1,0,0]
    v_pk_fma_f32 v[104:105], v[10:11], v[16:17], v[104:105] op_sel_hi:[0,1,1] neg_lo:[1,0,0] neg_hi:[1,0,0]
    v_pk_fma_f32 v[106:107], v[10:11], v[18:19], v[106:107] op_sel_hi:[0,1,1] neg_lo:[1,0,0] neg_hi:[1,0,0]
    v_pk_mul_f32 v[96:97], v[20:21], v[96:97]
    v_pk_mul_f32 v[98:99], v[22:23], v[98:99]
    v_pk_mul_f32 v[104:105], v[20:21], v[104:105]
    v_pk_mul_f32 v[106:107], v[22:23], v[106:107]
    v_cvt_pk_bf16_f32 v72, v96, v97
    v_cvt_pk_bf16_f32 v73, v98, v99
    v_cvt_pk_bf16_f32 v74, v104, v105
    v_cvt_pk_bf16_f32 v75, v106, v107
    s_add_u32 s56, s52, 4194304
    v_permlane16_swap_b32 v72, v74
    v_permlane16_swap_b32 v73, v75
    buffer_store_dwordx4 v[72:75], v1, s[4:7], s56 offen offset:0 sc1
    v_pk_fma_f32 v[112:113], v[12:13], v[16:17], v[112:113] op_sel_hi:[0,1,1] neg_lo:[1,0,0] neg_hi:[1,0,0]
    v_pk_fma_f32 v[114:115], v[12:13], v[18:19], v[114:115] op_sel_hi:[0,1,1] neg_lo:[1,0,0] neg_hi:[1,0,0]
    v_pk_fma_f32 v[120:121], v[14:15], v[16:17], v[120:121] op_sel_hi:[0,1,1] neg_lo:[1,0,0] neg_hi:[1,0,0]
    v_pk_fma_f32 v[122:123], v[14:15], v[18:19], v[122:123] op_sel_hi:[0,1,1] neg_lo:[1,0,0] neg_hi:[1,0,0]
    v_pk_mul_f32 v[112:113], v[20:21], v[112:113]
    v_pk_mul_f32 v[114:115], v[22:23], v[114:115]
    v_pk_mul_f32 v[120:121], v[20:21], v[120:121]
    v_pk_mul_f32 v[122:123], v[22:23], v[122:123]
    v_cvt_pk_bf16_f32 v88, v112, v113
    v_cvt_pk_bf16_f32 v89, v114, v115
    v_cvt_pk_bf16_f32 v90, v120, v121
    v_cvt_pk_bf16_f32 v91, v122, v123
    s_add_u32 s56, s52, 4325376
    v_permlane16_swap_b32 v88, v90
    v_permlane16_swap_b32 v89, v91
    buffer_store_dwordx4 v[88:91], v1, s[4:7], s56 offen offset:0 sc1
    v_pk_fma_f32 v[100:101], v[8:9], v[24:25], v[100:101] op_sel_hi:[0,1,1] neg_lo:[1,0,0] neg_hi:[1,0,0]
    v_pk_fma_f32 v[102:103], v[8:9], v[26:27], v[102:103] op_sel_hi:[0,1,1] neg_lo:[1,0,0] neg_hi:[1,0,0]
    v_pk_fma_f32 v[108:109], v[10:11], v[24:25], v[108:109] op_sel_hi:[0,1,1] neg_lo:[1,0,0] neg_hi:[1,0,0]
    v_pk_fma_f32 v[110:111], v[10:11], v[26:27], v[110:111] op_sel_hi:[0,1,1] neg_lo:[1,0,0] neg_hi:[1,0,0]
    v_pk_mul_f32 v[100:101], v[28:29], v[100:101]
    v_pk_mul_f32 v[102:103], v[30:31], v[102:103]
    v_pk_mul_f32 v[108:109], v[28:29], v[108:109]
    v_pk_mul_f32 v[110:111], v[30:31], v[110:111]
    v_cvt_pk_bf16_f32 v76, v100, v101
    v_cvt_pk_bf16_f32 v77, v102, v103
    v_cvt_pk_bf16_f32 v78, v108, v109
    v_cvt_pk_bf16_f32 v79, v110, v111
    s_add_u32 s56, s52, 4194304
    v_permlane16_swap_b32 v76, v78
    v_permlane16_swap_b32 v77, v79
    buffer_store_dwordx4 v[76:79], v1, s[4:7], s56 offen offset:1024 sc1
    v_pk_fma_f32 v[116:117], v[12:13], v[24:25], v[116:117] op_sel_hi:[0,1,1] neg_lo:[1,0,0] neg_hi:[1,0,0]
    v_pk_fma_f32 v[118:119], v[12:13], v[26:27], v[118:119] op_sel_hi:[0,1,1] neg_lo:[1,0,0] neg_hi:[1,0,0]
    v_pk_fma_f32 v[124:125], v[14:15], v[24:25], v[124:125] op_sel_hi:[0,1,1] neg_lo:[1,0,0] neg_hi:[1,0,0]
    v_pk_fma_f32 v[126:127], v[14:15], v[26:27], v[126:127] op_sel_hi:[0,1,1] neg_lo:[1,0,0] neg_hi:[1,0,0]
    v_pk_mul_f32 v[116:117], v[28:29], v[116:117]
    v_pk_mul_f32 v[118:119], v[30:31], v[118:119]
    v_pk_mul_f32 v[124:125], v[28:29], v[124:125]
    v_pk_mul_f32 v[126:127], v[30:31], v[126:127]
    v_cvt_pk_bf16_f32 v92, v116, v117
    v_cvt_pk_bf16_f32 v93, v118, v119
    v_cvt_pk_bf16_f32 v94, v124, v125
    v_cvt_pk_bf16_f32 v95, v126, v127
    s_add_u32 s56, s52, 4325376
    v_permlane16_swap_b32 v92, v94
    v_permlane16_swap_b32 v93, v95
    buffer_store_dwordx4 v[92:95], v1, s[4:7], s56 offen offset:1024 sc1
    v_mfma_f32_16x16x32_bf16 v[128:131], v[32:35], v[224:227], v[128:131]
    ds_read_b64_tr_b16 v[60:61], v6 offset:20480
    v_mfma_f32_16x16x32_bf16 v[132:135], v[32:35], v[228:231], v[132:135]
    ds_read_b64_tr_b16 v[62:63], v6 offset:21504
    v_mfma_f32_16x16x32_bf16 v[136:139], v[36:39], v[224:227], v[136:139]
    ds_read_b64_tr_b16 v[32:33], v3 offset:24576
    v_mfma_f32_16x16x32_bf16 v[140:143], v[36:39], v[228:231], v[140:143]
    ds_read_b64_tr_b16 v[34:35], v3 offset:25600
    v_mfma_f32_16x16x32_bf16 v[144:147], v[40:43], v[224:227], v[144:147]
    ds_read_b64_tr_b16 v[36:37], v4 offset:24576
    v_mfma_f32_16x16x32_bf16 v[148:151], v[40:43], v[228:231], v[148:151]
    ds_read_b64_tr_b16 v[38:39], v4 offset:25600
    v_mfma_f32_16x16x32_bf16 v[152:155], v[44:47], v[224:227], v[152:155]
    ds_read_b64_tr_b16 v[40:41], v5 offset:24576
    v_mfma_f32_16x16x32_bf16 v[156:159], v[44:47], v[228:231], v[156:159]
    ds_read_b64_tr_b16 v[42:43], v5 offset:25600
    s_waitcnt lgkmcnt(10)
    v_mfma_f32_16x16x32_bf16 v[128:131], v[48:51], v[232:235], v[128:131]
    ds_read_b64_tr_b16 v[44:45], v6 offset:24576
    v_mfma_f32_16x16x32_bf16 v[132:135], v[48:51], v[236:239], v[132:135]
    ds_read_b64_tr_b16 v[46:47], v6 offset:25600
    v_mfma_f32_16x16x32_bf16 v[136:139], v[52:55], v[232:235], v[136:139]
    ds_read_b64_tr_b16 v[48:49], v3 offset:28672
    v_mfma_f32_16x16x32_bf16 v[140:143], v[52:55], v[236:239], v[140:143]
    ds_read_b64_tr_b16 v[50:51], v3 offset:29696
    s_waitcnt lgkmcnt(10)
    v_mfma_f32_16x16x32_bf16 v[144:147], v[56:59], v[232:235], v[144:147]
    ds_read_b64_tr_b16 v[52:53], v4 offset:28672
    v_mfma_f32_16x16x32_bf16 v[148:151], v[56:59], v[236:239], v[148:151]
    ds_read_b64_tr_b16 v[54:55], v4 offset:29696
    v_mfma_f32_16x16x32_bf16 v[152:155], v[60:63], v[232:235], v[152:155]
    ds_read_b64_tr_b16 v[56:57], v5 offset:28672
    v_mfma_f32_16x16x32_bf16 v[156:159], v[60:63], v[236:239], v[156:159]
    ds_read_b64_tr_b16 v[58:59], v5 offset:29696
    s_waitcnt lgkmcnt(10)
    v_mfma_f32_16x16x32_bf16 v[128:131], v[32:35], v[240:243], v[128:131]
    ds_read_b64_tr_b16 v[60:61], v6 offset:28672
    v_mfma_f32_16x16x32_bf16 v[132:135], v[32:35], v[244:247], v[132:135]
    ds_read_b64_tr_b16 v[62:63], v6 offset:29696
    s_barrier
    v_mfma_f32_16x16x32_bf16 v[136:139], v[36:39], v[240:243], v[136:139]
    ds_read_b64_tr_b16 v[32:33], v3 offset:32768
    v_mfma_f32_16x16x32_bf16 v[140:143], v[36:39], v[244:247], v[140:143]
    ds_read_b64_tr_b16 v[34:35], v3 offset:33792
    s_waitcnt lgkmcnt(10)
    v_mfma_f32_16x16x32_bf16 v[144:147], v[40:43], v[240:243], v[144:147]
    ds_read_b64_tr_b16 v[36:37], v4 offset:32768
    v_mfma_f32_16x16x32_bf16 v[148:151], v[40:43], v[244:247], v[148:151]
    ds_read_b64_tr_b16 v[38:39], v4 offset:33792
    v_mfma_f32_16x16x32_bf16 v[152:155], v[44:47], v[240:243], v[152:155]
    ds_read_b64_tr_b16 v[40:41], v5 offset:32768
    v_mfma_f32_16x16x32_bf16 v[156:159], v[44:47], v[244:247], v[156:159]
    ds_read_b64_tr_b16 v[42:43], v5 offset:33792
    s_waitcnt lgkmcnt(10)
    v_mfma_f32_16x16x32_bf16 v[128:131], v[48:51], v[248:251], v[128:131]
    ds_read_b64_tr_b16 v[44:45], v6 offset:32768
    v_mfma_f32_16x16x32_bf16 v[132:135], v[48:51], v[252:255], v[132:135]
    ds_read_b64_tr_b16 v[46:47], v6 offset:33792
    v_mfma_f32_16x16x32_bf16 v[136:139], v[52:55], v[248:251], v[136:139]
    ds_read_b64_tr_b16 v[48:49], v3 offset:36864
    v_mfma_f32_16x16x32_bf16 v[140:143], v[52:55], v[252:255], v[140:143]
    ds_read_b64_tr_b16 v[50:51], v3 offset:37888
    s_waitcnt lgkmcnt(10)
    v_mfma_f32_16x16x32_bf16 v[144:147], v[56:59], v[248:251], v[144:147]
    ds_read_b64_tr_b16 v[52:53], v4 offset:36864
    v_mfma_f32_16x16x32_bf16 v[148:151], v[56:59], v[252:255], v[148:151]
    ds_read_b64_tr_b16 v[54:55], v4 offset:37888
    v_mfma_f32_16x16x32_bf16 v[152:155], v[60:63], v[248:251], v[152:155]
    ds_read_b64_tr_b16 v[56:57], v5 offset:36864
    v_mfma_f32_16x16x32_bf16 v[156:159], v[60:63], v[252:255], v[156:159]
    ds_read_b64_tr_b16 v[58:59], v5 offset:37888
    s_waitcnt lgkmcnt(10)
    v_mfma_f32_16x16x32_bf16 v[128:131], v[32:35], v[160:163], v[128:131]
    ds_read_b64_tr_b16 v[60:61], v6 offset:36864
    v_mfma_f32_16x16x32_bf16 v[132:135], v[32:35], v[164:167], v[132:135]
    ds_read_b64_tr_b16 v[62:63], v6 offset:37888
    v_mfma_f32_16x16x32_bf16 v[136:139], v[36:39], v[160:163], v[136:139]
    ds_read_b64_tr_b16 v[32:33], v3 offset:40960
    v_mfma_f32_16x16x32_bf16 v[140:143], v[36:39], v[164:167], v[140:143]
    ds_read_b64_tr_b16 v[34:35], v3 offset:41984
    s_waitcnt lgkmcnt(10)
    v_mfma_f32_16x16x32_bf16 v[144:147], v[40:43], v[160:163], v[144:147]
    ds_read_b64_tr_b16 v[36:37], v4 offset:40960
    v_mfma_f32_16x16x32_bf16 v[148:151], v[40:43], v[164:167], v[148:151]
    ds_read_b64_tr_b16 v[38:39], v4 offset:41984
    v_mfma_f32_16x16x32_bf16 v[152:155], v[44:47], v[160:163], v[152:155]
    ds_read_b64_tr_b16 v[40:41], v5 offset:40960
    v_mfma_f32_16x16x32_bf16 v[156:159], v[44:47], v[164:167], v[156:159]
    ds_read_b64_tr_b16 v[42:43], v5 offset:41984
    s_waitcnt lgkmcnt(10)
    v_mfma_f32_16x16x32_bf16 v[128:131], v[48:51], v[168:171], v[128:131]
    ds_read_b64_tr_b16 v[44:45], v6 offset:40960
    v_mfma_f32_16x16x32_bf16 v[132:135], v[48:51], v[172:175], v[132:135]
    ds_read_b64_tr_b16 v[46:47], v6 offset:41984
    v_mfma_f32_16x16x32_bf16 v[136:139], v[52:55], v[168:171], v[136:139]
    ds_read_b64_tr_b16 v[48:49], v3 offset:45056
    v_mfma_f32_16x16x32_bf16 v[140:143], v[52:55], v[172:175], v[140:143]
    ds_read_b64_tr_b16 v[50:51], v3 offset:46080
    s_waitcnt lgkmcnt(10)
    v_mfma_f32_16x16x32_bf16 v[144:147], v[56:59], v[168:171], v[144:147]
    ds_read_b64_tr_b16 v[52:53], v4 offset:45056
    v_mfma_f32_16x16x32_bf16 v[148:151], v[56:59], v[172:175], v[148:151]
    ds_read_b64_tr_b16 v[54:55], v4 offset:46080
    v_mfma_f32_16x16x32_bf16 v[152:155], v[60:63], v[168:171], v[152:155]
    ds_read_b64_tr_b16 v[56:57], v5 offset:45056
    v_mfma_f32_16x16x32_bf16 v[156:159], v[60:63], v[172:175], v[156:159]
    ds_read_b64_tr_b16 v[58:59], v5 offset:46080
    s_waitcnt lgkmcnt(10)
    v_mfma_f32_16x16x32_bf16 v[128:131], v[32:35], v[176:179], v[128:131]
    ds_read_b64_tr_b16 v[60:61], v6 offset:45056
    v_mfma_f32_16x16x32_bf16 v[132:135], v[32:35], v[180:183], v[132:135]
    ds_read_b64_tr_b16 v[62:63], v6 offset:46080
    v_mfma_f32_16x16x32_bf16 v[136:139], v[36:39], v[176:179], v[136:139]
    ds_read_b64_tr_b16 v[32:33], v3 offset:49152
    v_mfma_f32_16x16x32_bf16 v[140:143], v[36:39], v[180:183], v[140:143]
    ds_read_b64_tr_b16 v[34:35], v3 offset:50176
    s_waitcnt lgkmcnt(10)
    v_mfma_f32_16x16x32_bf16 v[144:147], v[40:43], v[176:179], v[144:147]
    ds_read_b64_tr_b16 v[36:37], v4 offset:49152
    v_mfma_f32_16x16x32_bf16 v[148:151], v[40:43], v[180:183], v[148:151]
    ds_read_b64_tr_b16 v[38:39], v4 offset:50176
    v_mfma_f32_16x16x32_bf16 v[152:155], v[44:47], v[176:179], v[152:155]
    ds_read_b64_tr_b16 v[40:41], v5 offset:49152
    v_mfma_f32_16x16x32_bf16 v[156:159], v[44:47], v[180:183], v[156:159]
    ds_read_b64_tr_b16 v[42:43], v5 offset:50176
    s_waitcnt lgkmcnt(10)
    v_mfma_f32_16x16x32_bf16 v[128:131], v[48:51], v[184:187], v[128:131]
    ds_read_b64_tr_b16 v[44:45], v6 offset:49152
    s_waitcnt vmcnt(0)
    s_atomic_add s40, s[22:23], s59
    s_mov_b32 s68, 0
    s_atomic_add s68, s[22:23], s59 glc
    s_mov_b32 s55, s52
    s_add_u32 s56, s52, 4194304
    ds_read_b32 v8, v9 offset:4096
    v_mfma_f32_16x16x32_bf16 v[132:135], v[48:51], v[188:191], v[132:135]
    ds_read_b64_tr_b16 v[46:47], v6 offset:50176
    buffer_load_dwordx4 v[64:67], v1, s[4:7], s55 offen offset:0 sc1
    ds_read_b32 v10, v9 offset:4608
    v_mfma_f32_16x16x32_bf16 v[136:139], v[52:55], v[184:187], v[136:139]
    ds_read_b64_tr_b16 v[48:49], v3 offset:53248
    buffer_load_dwordx4 v[68:71], v1, s[4:7], s55 offen offset:1024 sc1
    ds_read_b32 v12, v9 offset:4160
    v_mfma_f32_16x16x32_bf16 v[140:143], v[52:55], v[188:191], v[140:143]
    ds_read_b64_tr_b16 v[50:51], v3 offset:54272
    buffer_load_dwordx4 v[72:75], v1, s[4:7], s56 offen offset:0 sc1
    ds_read_b32 v14, v9 offset:4672
    s_waitcnt lgkmcnt(14)
    v_mfma_f32_16x16x32_bf16 v[144:147], v[56:59], v[184:187], v[144:147]
    ds_read_b64_tr_b16 v[52:53], v4 offset:53248
    buffer_load_dwordx4 v[76:79], v1, s[4:7], s56 offen offset:1024 sc1
    ds_read_b128 v[16:19], v11 offset:0
    v_mfma_f32_16x16x32_bf16 v[148:151], v[56:59], v[188:191], v[148:151]
    ds_read_b64_tr_b16 v[54:55], v4 offset:54272
    ds_read_b128 v[20:23], v11 offset:64
    v_mfma_f32_16x16x32_bf16 v[152:155], v[60:63], v[184:187], v[152:155]
    ds_read_b64_tr_b16 v[56:57], v5 offset:53248
    ds_read_b128 v[24:27], v11 offset:128
    v_mfma_f32_16x16x32_bf16 v[156:159], v[60:63], v[188:191], v[156:159]
    ds_read_b64_tr_b16 v[58:59], v5 offset:54272
    ds_read_b128 v[28:31], v11 offset:192
    s_waitcnt lgkmcnt(14)
    v_mfma_f32_16x16x32_bf16 v[128:131], v[32:35], v[192:195], v[128:131]
    ds_read_b64_tr_b16 v[60:61], v6 offset:53248
    v_mfma_f32_16x16x32_bf16 v[132:135], v[32:35], v[196:199], v[132:135]
    ds_read_b64_tr_b16 v[62:63], v6 offset:54272
    v_mfma_f32_16x16x32_bf16 v[136:139], v[36:39], v[192:195], v[136:139]
    ds_read_b64_tr_b16 v[32:33], v3 offset:57344
    v_mfma_f32_16x16x32_bf16 v[140:143], v[36:39], v[196:199], v[140:143]
    ds_read_b64_tr_b16 v[34:35], v3 offset:58368
    s_waitcnt lgkmcnt(14)
    v_mfma_f32_16x16x32_bf16 v[144:147], v[40:43], v[192:195], v[144:147]
    ds_read_b64_tr_b16 v[36:37], v4 offset:57344
    v_mfma_f32_16x16x32_bf16 v[148:151], v[40:43], v[196:199], v[148:151]
    ds_read_b64_tr_b16 v[38:39], v4 offset:58368
    v_mfma_f32_16x16x32_bf16 v[152:155], v[44:47], v[192:195], v[152:155]
    ds_read_b64_tr_b16 v[40:41], v5 offset:57344
    v_mfma_f32_16x16x32_bf16 v[156:159], v[44:47], v[196:199], v[156:159]
    ds_read_b64_tr_b16 v[42:43], v5 offset:58368
    s_waitcnt lgkmcnt(13)
    v_mfma_f32_16x16x32_bf16 v[128:131], v[48:51], v[200:203], v[128:131]
    ds_read_b64_tr_b16 v[44:45], v6 offset:57344
    s_waitcnt lgkmcnt(9)
    v_mfma_f32_16x16x32_bf16 v[132:135], v[48:51], v[204:207], v[132:135]
    ds_read_b64_tr_b16 v[46:47], v6 offset:58368
    v_mul_f32 v10, 0x3e8293ee, v10
    v_mfma_f32_16x16x32_bf16 v[136:139], v[52:55], v[200:203], v[136:139]
    ds_read_b64_tr_b16 v[48:49], v3 offset:61440
    v_mul_f32 v14, 0x3e8293ee, v14
    v_mfma_f32_16x16x32_bf16 v[140:143], v[52:55], v[204:207], v[140:143]
    ds_read_b64_tr_b16 v[50:51], v3 offset:62464
    s_lshl_b32 s44, s16, 11
    s_waitcnt lgkmcnt(10)
    v_mfma_f32_16x16x32_bf16 v[144:147], v[56:59], v[200:203], v[144:147]
    ds_read_b64_tr_b16 v[52:53], v4 offset:61440
    s_add_u32 s44, s44, 131072
    v_mfma_f32_16x16x32_bf16 v[148:151], v[56:59], v[204:207], v[148:151]
    ds_read_b64_tr_b16 v[54:55], v4 offset:62464
    v_add_u32 v13, s44, v2
    v_mfma_f32_16x16x32_bf16 v[152:155], v[60:63], v[200:203], v[152:155]
    ds_read_b64_tr_b16 v[56:57], v5 offset:61440
    v_mfma_f32_16x16x32_bf16 v[156:159], v[60:63], v[204:207], v[156:159]
    ds_read_b64_tr_b16 v[58:59], v5 offset:62464
    s_waitcnt lgkmcnt(10)
    v_mfma_f32_16x16x32_bf16 v[128:131], v[32:35], v[208:211], v[128:131]
    ds_read_b64_tr_b16 v[60:61], v6 offset:61440
    v_mfma_f32_16x16x32_bf16 v[132:135], v[32:35], v[212:215], v[132:135]
    ds_read_b64_tr_b16 v[62:63], v6 offset:62464
    v_xor_b32 v3, 0x10000, v3
    v_xor_b32 v4, 0x10000, v4
    v_xor_b32 v5, 0x10000, v5
    v_xor_b32 v6, 0x10000, v6
    v_mfma_f32_16x16x32_bf16 v[136:139], v[36:39], v[208:211], v[136:139]
    v_mfma_f32_16x16x32_bf16 v[140:143], v[36:39], v[212:215], v[140:143]
    s_waitcnt lgkmcnt(8)
    v_mfma_f32_16x16x32_bf16 v[144:147], v[40:43], v[208:211], v[144:147]
    v_mfma_f32_16x16x32_bf16 v[148:151], v[40:43], v[212:215], v[148:151]
    v_mfma_f32_16x16x32_bf16 v[152:155], v[44:47], v[208:211], v[152:155]
    v_mfma_f32_16x16x32_bf16 v[156:159], v[44:47], v[212:215], v[156:159]
    s_waitcnt lgkmcnt(4)
    v_mfma_f32_16x16x32_bf16 v[128:131], v[48:51], v[216:219], v[128:131]
    v_mfma_f32_16x16x32_bf16 v[132:135], v[48:51], v[220:223], v[132:135]
    v_mfma_f32_16x16x32_bf16 v[136:139], v[52:55], v[216:219], v[136:139]
    v_mfma_f32_16x16x32_bf16 v[140:143], v[52:55], v[220:223], v[140:143]
    s_waitcnt lgkmcnt(0)
    v_mfma_f32_16x16x32_bf16 v[144:147], v[56:59], v[216:219], v[144:147]
    v_mfma_f32_16x16x32_bf16 v[148:151], v[56:59], v[220:223], v[148:151]
    v_mfma_f32_16x16x32_bf16 v[152:155], v[60:63], v[216:219], v[152:155]
    v_mfma_f32_16x16x32_bf16 v[156:159], v[60:63], v[220:223], v[156:159]
    v_pk_fma_f32 v[128:129], v[8:9], v[16:17], v[128:129] op_sel_hi:[0,1,1] neg_lo:[1,0,0] neg_hi:[1,0,0]
    v_pk_fma_f32 v[130:131], v[8:9], v[18:19], v[130:131] op_sel_hi:[0,1,1] neg_lo:[1,0,0] neg_hi:[1,0,0]
    v_pk_fma_f32 v[136:137], v[8:9], v[20:21], v[136:137] op_sel_hi:[0,1,1] neg_lo:[1,0,0] neg_hi:[1,0,0]
    v_pk_fma_f32 v[138:139], v[8:9], v[22:23], v[138:139] op_sel_hi:[0,1,1] neg_lo:[1,0,0] neg_hi:[1,0,0]
    v_pk_mul_f32 v[128:129], v[10:11], v[128:129] op_sel_hi:[0,1]
    v_pk_mul_f32 v[130:131], v[10:11], v[130:131] op_sel_hi:[0,1]
    v_pk_mul_f32 v[136:137], v[10:11], v[136:137] op_sel_hi:[0,1]
    v_pk_mul_f32 v[138:139], v[10:11], v[138:139] op_sel_hi:[0,1]
    v_cvt_pk_bf16_f32 v128, v128, v129
    v_cvt_pk_bf16_f32 v129, v130, v131
    v_cvt_pk_bf16_f32 v130, v136, v137
    v_cvt_pk_bf16_f32 v131, v138, v139
    ds_write_b128 v13, v[128:131] offset:0
    v_pk_fma_f32 v[132:133], v[12:13], v[16:17], v[132:133] op_sel_hi:[0,1,1] neg_lo:[1,0,0] neg_hi:[1,0,0]
    v_pk_fma_f32 v[134:135], v[12:13], v[18:19], v[134:135] op_sel_hi:[0,1,1] neg_lo:[1,0,0] neg_hi:[1,0,0]
    v_pk_fma_f32 v[140:141], v[12:13], v[20:21], v[140:141] op_sel_hi:[0,1,1] neg_lo:[1,0,0] neg_hi:[1,0,0]
    v_pk_fma_f32 v[142:143], v[12:13], v[22:23], v[142:143] op_sel_hi:[0,1,1] neg_lo:[1,0,0] neg_hi:[1,0,0]
    v_pk_mul_f32 v[132:133], v[14:15], v[132:133] op_sel_hi:[0,1]
    v_pk_mul_f32 v[134:135], v[14:15], v[134:135] op_sel_hi:[0,1]
    v_pk_mul_f32 v[140:141], v[14:15], v[140:141] op_sel_hi:[0,1]
    v_pk_mul_f32 v[142:143], v[14:15], v[142:143] op_sel_hi:[0,1]
    v_cvt_pk_bf16_f32 v132, v132, v133
    v_cvt_pk_bf16_f32 v133, v134, v135
    v_cvt_pk_bf16_f32 v134, v140, v141
    v_cvt_pk_bf16_f32 v135, v142, v143
    ds_write_b128 v13, v[132:135] offset:256
    v_add_u32 v4, 131072, v1
    s_waitcnt lgkmcnt(0)
    s_barrier
    ds_read_b128 v[32:35], v4 offset:0
    ds_read_b128 v[36:39], v4 offset:1024
    ds_read_b128 v[40:43], v4 offset:2048
    ds_read_b128 v[44:47], v4 offset:3072
    ds_read_b128 v[48:51], v4 offset:4096
    ds_read_b128 v[52:55], v4 offset:5120
    ds_read_b128 v[56:59], v4 offset:6144
    ds_read_b128 v[60:63], v4 offset:7168
    v_pk_fma_f32 v[144:145], v[8:9], v[24:25], v[144:145] op_sel_hi:[0,1,1] neg_lo:[1,0,0] neg_hi:[1,0,0]
    v_pk_fma_f32 v[146:147], v[8:9], v[26:27], v[146:147] op_sel_hi:[0,1,1] neg_lo:[1,0,0] neg_hi:[1,0,0]
    v_pk_fma_f32 v[152:153], v[8:9], v[28:29], v[152:153] op_sel_hi:[0,1,1] neg_lo:[1,0,0] neg_hi:[1,0,0]
    v_pk_fma_f32 v[154:155], v[8:9], v[30:31], v[154:155] op_sel_hi:[0,1,1] neg_lo:[1,0,0] neg_hi:[1,0,0]
    v_pk_mul_f32 v[144:145], v[10:11], v[144:145] op_sel_hi:[0,1]
    v_pk_mul_f32 v[146:147], v[10:11], v[146:147] op_sel_hi:[0,1]
    v_pk_mul_f32 v[152:153], v[10:11], v[152:153] op_sel_hi:[0,1]
    v_pk_mul_f32 v[154:155], v[10:11], v[154:155] op_sel_hi:[0,1]
    v_cvt_pk_bf16_f32 v144, v144, v145
    v_cvt_pk_bf16_f32 v145, v146, v147
    v_cvt_pk_bf16_f32 v146, v152, v153
    v_cvt_pk_bf16_f32 v147, v154, v155
    ds_write_b128 v13, v[144:147] offset:8192
    s_waitcnt vmcnt(0) lgkmcnt(7)
    v_mfma_f32_32x32x16_bf16 v[192:207], v[64:67], v[32:35], 0
    v_mfma_f32_32x32x16_bf16 v[192:207], v[68:71], v[36:39], v[192:207]
    v_pk_fma_f32 v[148:149], v[12:13], v[24:25], v[148:149] op_sel_hi:[0,1,1] neg_lo:[1,0,0] neg_hi:[1,0,0]
    v_pk_fma_f32 v[150:151], v[12:13], v[26:27], v[150:151] op_sel_hi:[0,1,1] neg_lo:[1,0,0] neg_hi:[1,0,0]
    v_pk_fma_f32 v[156:157], v[12:13], v[28:29], v[156:157] op_sel_hi:[0,1,1] neg_lo:[1,0,0] neg_hi:[1,0,0]
    v_pk_fma_f32 v[158:159], v[12:13], v[30:31], v[158:159] op_sel_hi:[0,1,1] neg_lo:[1,0,0] neg_hi:[1,0,0]
    v_pk_mul_f32 v[148:149], v[14:15], v[148:149] op_sel_hi:[0,1]
    v_pk_mul_f32 v[150:151], v[14:15], v[150:151] op_sel_hi:[0,1]
    v_pk_mul_f32 v[156:157], v[14:15], v[156:157] op_sel_hi:[0,1]
    v_pk_mul_f32 v[158:159], v[14:15], v[158:159] op_sel_hi:[0,1]
    v_cvt_pk_bf16_f32 v148, v148, v149
    v_cvt_pk_bf16_f32 v149, v150, v151
    v_cvt_pk_bf16_f32 v150, v156, v157
    v_cvt_pk_bf16_f32 v151, v158, v159
    ds_write_b128 v13, v[148:151] offset:8448
    v_mov_b32 v9, 0xdddddddd
    v_bfe_u32 v10, v1, 4, 3
    v_mov_b32 v11, 0x3f803f80
    v_cmp_eq_u32 vcc, 0, v10
    v_cmp_eq_u32 s[44:45], 4, v10
    s_mov_b32 s57, 0
    v_cndmask_b32 v28, 0, v11, vcc
    v_cndmask_b32 v29, 0, v11, vcc
    v_cndmask_b32 v30, 0, v11, s[44:45]
    v_cndmask_b32 v31, 0, v11, s[44:45]
    v_mov_b32 v10, 0
    v_mov_b32 v11, 0
    s_mov_b32 s66, 0x10000
    s_waitcnt lgkmcnt(0)
    s_cmp_eq_u32 s68, 16
    s_cbranch_scc1 c_k_ok
c_k_poll:
    s_mov_b32 s68, 0
    s_atomic_add s68, s[22:23], s59 offset:0 glc
    s_sub_u32 s66, s66, 1
    s_cselect_b32 s67, 16, 0
    s_waitcnt lgkmcnt(0)
    s_max_u32 s68, s68, s67
    s_cmp_lt_u32 s68, 16
    s_cbranch_scc1 c_k_poll
c_k_ok:
    s_add_u32 s54, s54, 8192
    s_and_b32 s54, s54, 0x1ffff
    s_add_u32 s55, s53, s54
    s_add_u32 s56, s55, 4194304
    buffer_load_dwordx4 v[80:83], v1, s[4:7], s55 offen offset:0 sc1
    buffer_load_dwordx4 v[84:87], v1, s[4:7], s55 offen offset:1024 sc1
    buffer_load_dwordx4 v[88:91], v1, s[4:7], s56 offen offset:0 sc1
    buffer_load_dwordx4 v[92:95], v1, s[4:7], s56 offen offset:1024 sc1
    s_add_u32 s54, s54, 8192
    s_and_b32 s54, s54, 0x1ffff
    s_add_u32 s55, s53, s54
    s_add_u32 s56, s55, 4194304
    buffer_load_dwordx4 v[96:99], v1, s[4:7], s55 offen offset:0 sc1
    buffer_load_dwordx4 v[100:103], v1, s[4:7], s55 offen offset:1024 sc1
    buffer_load_dwordx4 v[104:107], v1, s[4:7], s56 offen offset:0 sc1
    buffer_load_dwordx4 v[108:111], v1, s[4:7], s56 offen offset:1024 sc1
    v_mfma_f32_32x32x16_bf16 v[208:223], v[64:67], v[40:43], 0
    s_add_u32 s54, s54, 8192
    s_and_b32 s54, s54, 0x1ffff
    s_add_u32 s55, s53, s54
    s_add_u32 s56, s55, 4194304
    v_exp_f32 v192, v192
    v_exp_f32 v193, v193
    v_exp_f32 v194, v194
    v_mfma_f32_32x32x8_bf16 v[128:143], v[10:11], v[10:11], 0
    v_mov_b32 v12, 0
    v_exp_f32 v195, v195
    v_exp_f32 v196, v196
    v_exp_f32 v197, v197
    v_mfma_f32_32x32x16_bf16 v[208:223], v[68:71], v[44:47], v[208:223]
    v_exp_f32 v198, v198
    v_exp_f32 v199, v199
    v_exp_f32 v200, v200
    v_mfma_f32_32x32x8_bf16 v[144:159], v[10:11], v[10:11], 0
    v_mov_b32 v16, 0
    v_exp_f32 v201, v201
    v_exp_f32 v202, v202
    v_mfma_f32_32x32x8_bf16 v[160:175], v[10:11], v[10:11], 0
    v_mov_b32 v20, 0
    s_lshl_b32 s44, s16, 12
    s_add_u32 s44, s44, 65536
    v_add_u32 v5, s44, v1
    s_lshl_b32 s44, s16, 8
    s_add_u32 s44, s44, 147456
    v_lshrrev_b32 v6, 2, v1
    v_add_u32 v6, s44, v6
    s_lshl_b32 s44, s21, 22
    s_lshl_b32 s45, s38, 16
    s_add_u32 s41, s44, s45
    s_lshl_b32 s45, s18, 12
    s_add_u32 s43, s41, s45
    s_and_b32 s45, s45, 0
    s_add_u32 s41, s41, s45
    s_add_u32 s41, s41, 16777216
    v_exp_f32 v203, v203
    v_exp_f32 v204, v204
    buffer_load_dwordx4 v[112:115], v1, s[4:7], s55 offen offset:0 sc1
    v_exp_f32 v205, v205
    v_mfma_f32_32x32x8_bf16 v[176:191], v[10:11], v[10:11], 0
    v_mov_b32 v24, 0
    v_exp_f32 v206, v206
    v_exp_f32 v207, v207
    v_mfma_f32_32x32x16_bf16 v[224:239], v[64:67], v[48:51], 0
    v_exp_f32 v208, v208
    v_exp_f32 v209, v209
    v_exp_f32 v210, v210
    v_smfmac_f32_32x32x32_bf16 v[128:143], v[72:75], v[192:199], v9
    v_exp_f32 v211, v211
    v_exp_f32 v212, v212
    v_exp_f32 v213, v213
    v_mfma_f32_32x32x16_bf16 v[224:239], v[68:71], v[52:55], v[224:239]
    v_exp_f32 v214, v214
    v_exp_f32 v215, v215
    v_exp_f32 v216, v216
    v_smfmac_f32_16x16x64_bf16 v[12:15], v[28:31], v[192:199], v9
    v_exp_f32 v217, v217
    v_smfmac_f32_32x32x32_bf16 v[128:143], v[76:79], v[200:207], v9
    v_exp_f32 v218, v218
    v_exp_f32 v219, v219
    v_exp_f32 v220, v220
    v_smfmac_f32_16x16x64_bf16 v[12:15], v[28:31], v[200:207], v9
    buffer_load_dwordx4 v[116:119], v1, s[4:7], s55 offen offset:1024 sc1
    v_exp_f32 v221, v221
    v_exp_f32 v222, v222
    v_exp_f32 v223, v223
b_head:
    s_mov_b32 s58, 3
b_loop:
    v_mfma_f32_32x32x16_bf16 v[240:255], v[64:67], v[56:59], 0
    v_exp_f32 v224, v224
    v_exp_f32 v225, v225
    v_exp_f32 v226, v226
    v_smfmac_f32_32x32x32_bf16 v[144:159], v[72:75], v[208:215], v9
    v_exp_f32 v227, v227
    v_exp_f32 v228, v228
    v_exp_f32 v229, v229
    v_mfma_f32_32x32x16_bf16 v[240:255], v[68:71], v[60:63], v[240:255]
    v_exp_f32 v230, v230
    v_exp_f32 v231, v231
    v_exp_f32 v232, v232
    v_smfmac_f32_16x16x64_bf16 v[16:19], v[28:31], v[208:215], v9
    v_exp_f32 v233, v233
    v_smfmac_f32_32x32x32_bf16 v[144:159], v[76:79], v[216:223], v9
    v_exp_f32 v234, v234
    v_exp_f32 v235, v235
    v_exp_f32 v236, v236
    v_smfmac_f32_16x16x64_bf16 v[16:19], v[28:31], v[216:223], v9
    buffer_load_dwordx4 v[120:123], v1, s[4:7], s56 offen offset:0 sc1
    v_exp_f32 v237, v237
    v_exp_f32 v238, v238
    v_exp_f32 v239, v239
    s_waitcnt vmcnt(7)
    v_mfma_f32_32x32x16_bf16 v[192:207], v[80:83], v[32:35], 0
    v_exp_f32 v240, v240
    v_exp_f32 v241, v241
    v_exp_f32 v242, v242
    v_smfmac_f32_32x32x32_bf16 v[160:175], v[72:75], v[224:231], v9
    v_exp_f32 v243, v243
    v_exp_f32 v244, v244
    v_exp_f32 v245, v245
    v_mfma_f32_32x32x16_bf16 v[192:207], v[84:87], v[36:39], v[192:207]
    v_exp_f32 v246, v246
    v_exp_f32 v247, v247
    v_exp_f32 v248, v248
    v_smfmac_f32_16x16x64_bf16 v[20:23], v[28:31], v[224:231], v9
    v_exp_f32 v249, v249
    v_smfmac_f32_32x32x32_bf16 v[160:175], v[76:79], v[232:239], v9
    v_exp_f32 v250, v250
    v_exp_f32 v251, v251
    v_exp_f32 v252, v252
    v_smfmac_f32_16x16x64_bf16 v[20:23], v[28:31], v[232:239], v9
    buffer_load_dwordx4 v[124:127], v1, s[4:7], s56 offen offset:1024 sc1
    v_exp_f32 v253, v253
    v_exp_f32 v254, v254
    v_exp_f32 v255, v255
    v_mfma_f32_32x32x16_bf16 v[208:223], v[80:83], v[40:43], 0
    s_add_u32 s54, s54, 8192
    s_and_b32 s54, s54, 0x1ffff
    s_add_u32 s55, s53, s54
    s_add_u32 s56, s55, 4194304
    v_exp_f32 v192, v192
    v_exp_f32 v193, v193
    v_exp_f32 v194, v194
    v_smfmac_f32_32x32x32_bf16 v[176:191], v[72:75], v[240:247], v9
    v_exp_f32 v195, v195
    v_exp_f32 v196, v196
    v_exp_f32 v197, v197
    v_mfma_f32_32x32x16_bf16 v[208:223], v[84:87], v[44:47], v[208:223]
    v_exp_f32 v198, v198
    v_exp_f32 v199, v199
    v_exp_f32 v200, v200
    v_smfmac_f32_16x16x64_bf16 v[24:27], v[28:31], v[240:247], v9
    v_exp_f32 v201, v201
    v_smfmac_f32_32x32x32_bf16 v[176:191], v[76:79], v[248:255], v9
    v_exp_f32 v202, v202
    v_exp_f32 v203, v203
    v_exp_f32 v204, v204
    v_smfmac_f32_16x16x64_bf16 v[24:27], v[28:31], v[248:255], v9
    buffer_load_dwordx4 v[64:67], v1, s[4:7], s55 offen offset:0 sc1
    v_exp_f32 v205, v205
    v_exp_f32 v206, v206
    v_exp_f32 v207, v207
    v_mfma_f32_32x32x16_bf16 v[224:239], v[80:83], v[48:51], 0
    v_exp_f32 v208, v208
    v_exp_f32 v209, v209
    v_exp_f32 v210, v210
    v_smfmac_f32_32x32x32_bf16 v[128:143], v[88:91], v[192:199], v9
    v_exp_f32 v211, v211
    v_exp_f32 v212, v212
    v_exp_f32 v213, v213
    v_mfma_f32_32x32x16_bf16 v[224:239], v[84:87], v[52:55], v[224:239]
    v_exp_f32 v214, v214
    v_exp_f32 v215, v215
    v_exp_f32 v216, v216
    v_smfmac_f32_16x16x64_bf16 v[12:15], v[28:31], v[192:199], v9
    v_exp_f32 v217, v217
    v_smfmac_f32_32x32x32_bf16 v[128:143], v[92:95], v[200:207], v9
    v_exp_f32 v218, v218
    v_exp_f32 v219, v219
    v_exp_f32 v220, v220
    v_smfmac_f32_16x16x64_bf16 v[12:15], v[28:31], v[200:207], v9
    buffer_load_dwordx4 v[68:71], v1, s[4:7], s55 offen offset:1024 sc1
    v_exp_f32 v221, v221
    v_exp_f32 v222, v222
    v_exp_f32 v223, v223
    v_mfma_f32_32x32x16_bf16 v[240:255], v[80:83], v[56:59], 0
    v_exp_f32 v224, v224
    v_exp_f32 v225, v225
    v_exp_f32 v226, v226
    v_smfmac_f32_32x32x32_bf16 v[144:159], v[88:91], v[208:215], v9
    v_exp_f32 v227, v227
    v_exp_f32 v228, v228
    v_exp_f32 v229, v229
    v_mfma_f32_32x32x16_bf16 v[240:255], v[84:87], v[60:63], v[240:255]
    v_exp_f32 v230, v230
    v_exp_f32 v231, v231
    v_exp_f32 v232, v232
    v_smfmac_f32_16x16x64_bf16 v[16:19], v[28:31], v[208:215], v9
    v_exp_f32 v233, v233
    v_smfmac_f32_32x32x32_bf16 v[144:159], v[92:95], v[216:223], v9
    v_exp_f32 v234, v234
    v_exp_f32 v235, v235
    v_exp_f32 v236, v236
    v_smfmac_f32_16x16x64_bf16 v[16:19], v[28:31], v[216:223], v9
    buffer_load_dwordx4 v[72:75], v1, s[4:7], s56 offen offset:0 sc1
    v_exp_f32 v237, v237
    v_exp_f32 v238, v238
    v_exp_f32 v239, v239
    s_waitcnt vmcnt(7)
    v_mfma_f32_32x32x16_bf16 v[192:207], v[96:99], v[32:35], 0
    v_exp_f32 v240, v240
    v_exp_f32 v241, v241
    v_exp_f32 v242, v242
    v_smfmac_f32_32x32x32_bf16 v[160:175], v[88:91], v[224:231], v9
    v_exp_f32 v243, v243
    v_exp_f32 v244, v244
    v_exp_f32 v245, v245
    v_mfma_f32_32x32x16_bf16 v[192:207], v[100:103], v[36:39], v[192:207]
    v_exp_f32 v246, v246
    v_exp_f32 v247, v247
    v_exp_f32 v248, v248
    v_smfmac_f32_16x16x64_bf16 v[20:23], v[28:31], v[224:231], v9
    v_exp_f32 v249, v249
    v_smfmac_f32_32x32x32_bf16 v[160:175], v[92:95], v[232:239], v9
    v_exp_f32 v250, v250
    v_exp_f32 v251, v251
    v_exp_f32 v252, v252
    v_smfmac_f32_16x16x64_bf16 v[20:23], v[28:31], v[232:239], v9
    buffer_load_dwordx4 v[76:79], v1, s[4:7], s56 offen offset:1024 sc1
    v_exp_f32 v253, v253
    v_exp_f32 v254, v254
    v_exp_f32 v255, v255
    v_mfma_f32_32x32x16_bf16 v[208:223], v[96:99], v[40:43], 0
    s_add_u32 s54, s54, 8192
    s_and_b32 s54, s54, 0x1ffff
    s_add_u32 s55, s53, s54
    s_add_u32 s56, s55, 4194304
    v_exp_f32 v192, v192
    v_exp_f32 v193, v193
    v_exp_f32 v194, v194
    v_smfmac_f32_32x32x32_bf16 v[176:191], v[88:91], v[240:247], v9
    v_exp_f32 v195, v195
    v_exp_f32 v196, v196
    v_exp_f32 v197, v197
    v_mfma_f32_32x32x16_bf16 v[208:223], v[100:103], v[44:47], v[208:223]
    v_exp_f32 v198, v198
    v_exp_f32 v199, v199
    v_exp_f32 v200, v200
    v_smfmac_f32_16x16x64_bf16 v[24:27], v[28:31], v[240:247], v9
    v_exp_f32 v201, v201
    v_smfmac_f32_32x32x32_bf16 v[176:191], v[92:95], v[248:255], v9
    v_exp_f32 v202, v202
    v_exp_f32 v203, v203
    v_exp_f32 v204, v204
    v_smfmac_f32_16x16x64_bf16 v[24:27], v[28:31], v[248:255], v9
    buffer_load_dwordx4 v[80:83], v1, s[4:7], s55 offen offset:0 sc1
    v_exp_f32 v205, v205
    v_exp_f32 v206, v206
    v_exp_f32 v207, v207
    v_mfma_f32_32x32x16_bf16 v[224:239], v[96:99], v[48:51], 0
    v_exp_f32 v208, v208
    v_exp_f32 v209, v209
    v_exp_f32 v210, v210
    v_smfmac_f32_32x32x32_bf16 v[128:143], v[104:107], v[192:199], v9
    v_exp_f32 v211, v211
    v_exp_f32 v212, v212
    v_exp_f32 v213, v213
    v_mfma_f32_32x32x16_bf16 v[224:239], v[100:103], v[52:55], v[224:239]
    v_exp_f32 v214, v214
    v_exp_f32 v215, v215
    v_exp_f32 v216, v216
    v_smfmac_f32_16x16x64_bf16 v[12:15], v[28:31], v[192:199], v9
    v_exp_f32 v217, v217
    v_smfmac_f32_32x32x32_bf16 v[128:143], v[108:111], v[200:207], v9
    v_exp_f32 v218, v218
    v_exp_f32 v219, v219
    v_exp_f32 v220, v220
    v_smfmac_f32_16x16x64_bf16 v[12:15], v[28:31], v[200:207], v9
    buffer_load_dwordx4 v[84:87], v1, s[4:7], s55 offen offset:1024 sc1
    v_exp_f32 v221, v221
    v_exp_f32 v222, v222
    v_exp_f32 v223, v223
    v_mfma_f32_32x32x16_bf16 v[240:255], v[96:99], v[56:59], 0
    v_exp_f32 v224, v224
    v_exp_f32 v225, v225
    v_exp_f32 v226, v226
    v_smfmac_f32_32x32x32_bf16 v[144:159], v[104:107], v[208:215], v9
    v_exp_f32 v227, v227
    v_exp_f32 v228, v228
    v_exp_f32 v229, v229
    v_mfma_f32_32x32x16_bf16 v[240:255], v[100:103], v[60:63], v[240:255]
    v_exp_f32 v230, v230
    v_exp_f32 v231, v231
    v_exp_f32 v232, v232
    v_smfmac_f32_16x16x64_bf16 v[16:19], v[28:31], v[208:215], v9
    v_exp_f32 v233, v233
    v_smfmac_f32_32x32x32_bf16 v[144:159], v[108:111], v[216:223], v9
    v_exp_f32 v234, v234
    v_exp_f32 v235, v235
    v_exp_f32 v236, v236
    v_smfmac_f32_16x16x64_bf16 v[16:19], v[28:31], v[216:223], v9
    buffer_load_dwordx4 v[88:91], v1, s[4:7], s56 offen offset:0 sc1
    v_exp_f32 v237, v237
    v_exp_f32 v238, v238
    v_exp_f32 v239, v239
    s_waitcnt vmcnt(7)
    v_mfma_f32_32x32x16_bf16 v[192:207], v[112:115], v[32:35], 0
    v_exp_f32 v240, v240
    v_exp_f32 v241, v241
    v_exp_f32 v242, v242
    v_smfmac_f32_32x32x32_bf16 v[160:175], v[104:107], v[224:231], v9
    v_exp_f32 v243, v243
    v_exp_f32 v244, v244
    v_exp_f32 v245, v245
    v_mfma_f32_32x32x16_bf16 v[192:207], v[116:119], v[36:39], v[192:207]
    v_exp_f32 v246, v246
    v_exp_f32 v247, v247
    v_exp_f32 v248, v248
    v_smfmac_f32_16x16x64_bf16 v[20:23], v[28:31], v[224:231], v9
    v_exp_f32 v249, v249
    v_smfmac_f32_32x32x32_bf16 v[160:175], v[108:111], v[232:239], v9
    v_exp_f32 v250, v250
    v_exp_f32 v251, v251
    v_exp_f32 v252, v252
    v_smfmac_f32_16x16x64_bf16 v[20:23], v[28:31], v[232:239], v9
    buffer_load_dwordx4 v[92:95], v1, s[4:7], s56 offen offset:1024 sc1
    v_exp_f32 v253, v253
    v_exp_f32 v254, v254
    v_exp_f32 v255, v255
    v_mfma_f32_32x32x16_bf16 v[208:223], v[112:115], v[40:43], 0
    s_add_u32 s54, s54, 8192
    s_and_b32 s54, s54, 0x1ffff
    s_add_u32 s55, s53, s54
    s_add_u32 s56, s55, 4194304
    v_exp_f32 v192, v192
    v_exp_f32 v193, v193
    v_exp_f32 v194, v194
    v_smfmac_f32_32x32x32_bf16 v[176:191], v[104:107], v[240:247], v9
    v_exp_f32 v195, v195
    v_exp_f32 v196, v196
    v_exp_f32 v197, v197
    v_mfma_f32_32x32x16_bf16 v[208:223], v[116:119], v[44:47], v[208:223]
    v_exp_f32 v198, v198
    v_exp_f32 v199, v199
    v_exp_f32 v200, v200
    v_smfmac_f32_16x16x64_bf16 v[24:27], v[28:31], v[240:247], v9
    v_exp_f32 v201, v201
    v_smfmac_f32_32x32x32_bf16 v[176:191], v[108:111], v[248:255], v9
    v_exp_f32 v202, v202
    v_exp_f32 v203, v203
    v_exp_f32 v204, v204
    v_smfmac_f32_16x16x64_bf16 v[24:27], v[28:31], v[248:255], v9
    buffer_load_dwordx4 v[96:99], v1, s[4:7], s55 offen offset:0 sc1
    v_exp_f32 v205, v205
    v_exp_f32 v206, v206
    v_exp_f32 v207, v207
    v_mfma_f32_32x32x16_bf16 v[224:239], v[112:115], v[48:51], 0
    v_exp_f32 v208, v208
    v_exp_f32 v209, v209
    v_exp_f32 v210, v210
    v_smfmac_f32_32x32x32_bf16 v[128:143], v[120:123], v[192:199], v9
    v_exp_f32 v211, v211
    v_exp_f32 v212, v212
    v_exp_f32 v213, v213
    v_mfma_f32_32x32x16_bf16 v[224:239], v[116:119], v[52:55], v[224:239]
    v_exp_f32 v214, v214
    v_exp_f32 v215, v215
    v_exp_f32 v216, v216
    v_smfmac_f32_16x16x64_bf16 v[12:15], v[28:31], v[192:199], v9
    v_exp_f32 v217, v217
    v_smfmac_f32_32x32x32_bf16 v[128:143], v[124:127], v[200:207], v9
    v_exp_f32 v218, v218
    v_exp_f32 v219, v219
    v_exp_f32 v220, v220
    v_smfmac_f32_16x16x64_bf16 v[12:15], v[28:31], v[200:207], v9
    buffer_load_dwordx4 v[100:103], v1, s[4:7], s55 offen offset:1024 sc1
    v_exp_f32 v221, v221
    v_exp_f32 v222, v222
    v_exp_f32 v223, v223
    v_mfma_f32_32x32x16_bf16 v[240:255], v[112:115], v[56:59], 0
    v_exp_f32 v224, v224
    v_exp_f32 v225, v225
    v_exp_f32 v226, v226
    v_smfmac_f32_32x32x32_bf16 v[144:159], v[120:123], v[208:215], v9
    v_exp_f32 v227, v227
    v_exp_f32 v228, v228
    v_exp_f32 v229, v229
    v_mfma_f32_32x32x16_bf16 v[240:255], v[116:119], v[60:63], v[240:255]
    v_exp_f32 v230, v230
    v_exp_f32 v231, v231
    v_exp_f32 v232, v232
    v_smfmac_f32_16x16x64_bf16 v[16:19], v[28:31], v[208:215], v9
    v_exp_f32 v233, v233
    v_smfmac_f32_32x32x32_bf16 v[144:159], v[124:127], v[216:223], v9
    v_exp_f32 v234, v234
    v_exp_f32 v235, v235
    v_exp_f32 v236, v236
    v_smfmac_f32_16x16x64_bf16 v[16:19], v[28:31], v[216:223], v9
    buffer_load_dwordx4 v[104:107], v1, s[4:7], s56 offen offset:0 sc1
    v_exp_f32 v237, v237
    v_exp_f32 v238, v238
    v_exp_f32 v239, v239
    s_waitcnt vmcnt(7)
    v_mfma_f32_32x32x16_bf16 v[192:207], v[64:67], v[32:35], 0
    v_exp_f32 v240, v240
    v_exp_f32 v241, v241
    v_exp_f32 v242, v242
    v_smfmac_f32_32x32x32_bf16 v[160:175], v[120:123], v[224:231], v9
    v_exp_f32 v243, v243
    v_exp_f32 v244, v244
    v_exp_f32 v245, v245
    v_mfma_f32_32x32x16_bf16 v[192:207], v[68:71], v[36:39], v[192:207]
    v_exp_f32 v246, v246
    v_exp_f32 v247, v247
    v_exp_f32 v248, v248
    v_smfmac_f32_16x16x64_bf16 v[20:23], v[28:31], v[224:231], v9
    v_exp_f32 v249, v249
    v_smfmac_f32_32x32x32_bf16 v[160:175], v[124:127], v[232:239], v9
    v_exp_f32 v250, v250
    v_exp_f32 v251, v251
    v_exp_f32 v252, v252
    v_smfmac_f32_16x16x64_bf16 v[20:23], v[28:31], v[232:239], v9
    buffer_load_dwordx4 v[108:111], v1, s[4:7], s56 offen offset:1024 sc1
    v_exp_f32 v253, v253
    v_exp_f32 v254, v254
    v_exp_f32 v255, v255
    v_mfma_f32_32x32x16_bf16 v[208:223], v[64:67], v[40:43], 0
    s_add_u32 s54, s54, 8192
    s_and_b32 s54, s54, 0x1ffff
    s_add_u32 s55, s53, s54
    s_add_u32 s56, s55, 4194304
    v_exp_f32 v192, v192
    v_exp_f32 v193, v193
    v_exp_f32 v194, v194
    v_smfmac_f32_32x32x32_bf16 v[176:191], v[120:123], v[240:247], v9
    v_exp_f32 v195, v195
    v_exp_f32 v196, v196
    v_exp_f32 v197, v197
    v_mfma_f32_32x32x16_bf16 v[208:223], v[68:71], v[44:47], v[208:223]
    v_exp_f32 v198, v198
    v_exp_f32 v199, v199
    v_exp_f32 v200, v200
    v_smfmac_f32_16x16x64_bf16 v[24:27], v[28:31], v[240:247], v9
    v_exp_f32 v201, v201
    v_smfmac_f32_32x32x32_bf16 v[176:191], v[124:127], v[248:255], v9
    v_exp_f32 v202, v202
    v_exp_f32 v203, v203
    v_exp_f32 v204, v204
    v_smfmac_f32_16x16x64_bf16 v[24:27], v[28:31], v[248:255], v9
    buffer_load_dwordx4 v[112:115], v1, s[4:7], s55 offen offset:0 sc1
    v_exp_f32 v205, v205
    v_exp_f32 v206, v206
    v_exp_f32 v207, v207
    v_mfma_f32_32x32x16_bf16 v[224:239], v[64:67], v[48:51], 0
    v_exp_f32 v208, v208
    v_exp_f32 v209, v209
    v_exp_f32 v210, v210
    v_smfmac_f32_32x32x32_bf16 v[128:143], v[72:75], v[192:199], v9
    v_exp_f32 v211, v211
    v_exp_f32 v212, v212
    v_exp_f32 v213, v213
    v_mfma_f32_32x32x16_bf16 v[224:239], v[68:71], v[52:55], v[224:239]
    v_exp_f32 v214, v214
    v_exp_f32 v215, v215
    v_exp_f32 v216, v216
    v_smfmac_f32_16x16x64_bf16 v[12:15], v[28:31], v[192:199], v9
    v_exp_f32 v217, v217
    v_smfmac_f32_32x32x32_bf16 v[128:143], v[76:79], v[200:207], v9
    v_exp_f32 v218, v218
    v_exp_f32 v219, v219
    v_exp_f32 v220, v220
    v_smfmac_f32_16x16x64_bf16 v[12:15], v[28:31], v[200:207], v9
    buffer_load_dwordx4 v[116:119], v1, s[4:7], s55 offen offset:1024 sc1
    v_exp_f32 v221, v221
    v_exp_f32 v222, v222
    v_exp_f32 v223, v223
    s_sub_u32 s58, s58, 1
    s_cmp_lg_u32 s58, 0
    s_cbranch_scc1 b_loop
    v_mfma_f32_32x32x16_bf16 v[240:255], v[64:67], v[56:59], 0
    v_exp_f32 v224, v224
    v_exp_f32 v225, v225
    v_exp_f32 v226, v226
    v_smfmac_f32_32x32x32_bf16 v[144:159], v[72:75], v[208:215], v9
    v_exp_f32 v227, v227
    v_exp_f32 v228, v228
    v_exp_f32 v229, v229
    v_mfma_f32_32x32x16_bf16 v[240:255], v[68:71], v[60:63], v[240:255]
    v_exp_f32 v230, v230
    v_exp_f32 v231, v231
    v_exp_f32 v232, v232
    v_smfmac_f32_16x16x64_bf16 v[16:19], v[28:31], v[208:215], v9
    v_exp_f32 v233, v233
    v_smfmac_f32_32x32x32_bf16 v[144:159], v[76:79], v[216:223], v9
    v_exp_f32 v234, v234
    v_exp_f32 v235, v235
    v_exp_f32 v236, v236
    v_smfmac_f32_16x16x64_bf16 v[16:19], v[28:31], v[216:223], v9
    buffer_load_dwordx4 v[120:123], v1, s[4:7], s56 offen offset:0 sc1
    v_exp_f32 v237, v237
    v_exp_f32 v238, v238
    v_exp_f32 v239, v239
    s_waitcnt vmcnt(7)
    v_mfma_f32_32x32x16_bf16 v[192:207], v[80:83], v[32:35], 0
    v_exp_f32 v240, v240
    v_exp_f32 v241, v241
    v_exp_f32 v242, v242
    v_smfmac_f32_32x32x32_bf16 v[160:175], v[72:75], v[224:231], v9
    v_exp_f32 v243, v243
    v_exp_f32 v244, v244
    v_exp_f32 v245, v245
    v_mfma_f32_32x32x16_bf16 v[192:207], v[84:87], v[36:39], v[192:207]
    v_exp_f32 v246, v246
    v_exp_f32 v247, v247
    v_exp_f32 v248, v248
    v_smfmac_f32_16x16x64_bf16 v[20:23], v[28:31], v[224:231], v9
    v_exp_f32 v249, v249
    v_smfmac_f32_32x32x32_bf16 v[160:175], v[76:79], v[232:239], v9
    v_exp_f32 v250, v250
    v_exp_f32 v251, v251
    v_exp_f32 v252, v252
    v_smfmac_f32_16x16x64_bf16 v[20:23], v[28:31], v[232:239], v9
    buffer_load_dwordx4 v[124:127], v1, s[4:7], s56 offen offset:1024 sc1
    v_exp_f32 v253, v253
    v_exp_f32 v254, v254
    v_exp_f32 v255, v255
    s_add_u32 s53, s53, 131072
    s_cmp_eq_u32 s57, 0
    s_cselect_b32 s53, s53, 2146435072
    v_mfma_f32_32x32x16_bf16 v[208:223], v[80:83], v[40:43], 0
    s_add_u32 s54, s54, 8192
    s_and_b32 s54, s54, 0x1ffff
    s_add_u32 s55, s53, s54
    s_add_u32 s56, s55, 4194304
    v_exp_f32 v192, v192
    v_exp_f32 v193, v193
    v_exp_f32 v194, v194
    v_smfmac_f32_32x32x32_bf16 v[176:191], v[72:75], v[240:247], v9
    v_exp_f32 v195, v195
    v_exp_f32 v196, v196
    v_exp_f32 v197, v197
    v_mfma_f32_32x32x16_bf16 v[208:223], v[84:87], v[44:47], v[208:223]
    v_exp_f32 v198, v198
    v_exp_f32 v199, v199
    v_exp_f32 v200, v200
    v_smfmac_f32_16x16x64_bf16 v[24:27], v[28:31], v[240:247], v9
    v_exp_f32 v201, v201
    v_smfmac_f32_32x32x32_bf16 v[176:191], v[76:79], v[248:255], v9
    v_exp_f32 v202, v202
    v_exp_f32 v203, v203
    v_exp_f32 v204, v204
    v_smfmac_f32_16x16x64_bf16 v[24:27], v[28:31], v[248:255], v9
    buffer_load_dwordx4 v[64:67], v1, s[4:7], s55 offen offset:0 sc1
    v_exp_f32 v205, v205
    v_exp_f32 v206, v206
    v_exp_f32 v207, v207
    v_mfma_f32_32x32x16_bf16 v[224:239], v[80:83], v[48:51], 0
    v_exp_f32 v208, v208
    v_exp_f32 v209, v209
    v_exp_f32 v210, v210
    v_smfmac_f32_32x32x32_bf16 v[128:143], v[88:91], v[192:199], v9
    v_exp_f32 v211, v211
    v_exp_f32 v212, v212
    v_exp_f32 v213, v213
    v_mfma_f32_32x32x16_bf16 v[224:239], v[84:87], v[52:55], v[224:239]
    v_exp_f32 v214, v214
    v_exp_f32 v215, v215
    v_exp_f32 v216, v216
    v_smfmac_f32_16x16x64_bf16 v[12:15], v[28:31], v[192:199], v9
    v_exp_f32 v217, v217
    v_smfmac_f32_32x32x32_bf16 v[128:143], v[92:95], v[200:207], v9
    v_exp_f32 v218, v218
    v_exp_f32 v219, v219
    v_exp_f32 v220, v220
    v_smfmac_f32_16x16x64_bf16 v[12:15], v[28:31], v[200:207], v9
    buffer_load_dwordx4 v[68:71], v1, s[4:7], s55 offen offset:1024 sc1
    v_exp_f32 v221, v221
    v_exp_f32 v222, v222
    v_exp_f32 v223, v223
    v_mfma_f32_32x32x16_bf16 v[240:255], v[80:83], v[56:59], 0
    v_exp_f32 v224, v224
    v_exp_f32 v225, v225
    v_exp_f32 v226, v226
    v_smfmac_f32_32x32x32_bf16 v[144:159], v[88:91], v[208:215], v9
    v_exp_f32 v227, v227
    v_exp_f32 v228, v228
    v_exp_f32 v229, v229
    v_mfma_f32_32x32x16_bf16 v[240:255], v[84:87], v[60:63], v[240:255]
    v_exp_f32 v230, v230
    v_exp_f32 v231, v231
    v_exp_f32 v232, v232
    v_smfmac_f32_16x16x64_bf16 v[16:19], v[28:31], v[208:215], v9
    v_exp_f32 v233, v233
    v_smfmac_f32_32x32x32_bf16 v[144:159], v[92:95], v[216:223], v9
    v_exp_f32 v234, v234
    v_exp_f32 v235, v235
    v_exp_f32 v236, v236
    v_smfmac_f32_16x16x64_bf16 v[16:19], v[28:31], v[216:223], v9
    buffer_load_dwordx4 v[72:75], v1, s[4:7], s56 offen offset:0 sc1
    v_exp_f32 v237, v237
    v_exp_f32 v238, v238
    v_exp_f32 v239, v239
    s_waitcnt vmcnt(7)
    v_mfma_f32_32x32x16_bf16 v[192:207], v[96:99], v[32:35], 0
    v_exp_f32 v240, v240
    v_exp_f32 v241, v241
    v_exp_f32 v242, v242
    v_smfmac_f32_32x32x32_bf16 v[160:175], v[88:91], v[224:231], v9
    v_exp_f32 v243, v243
    v_exp_f32 v244, v244
    v_exp_f32 v245, v245
    v_mfma_f32_32x32x16_bf16 v[192:207], v[100:103], v[36:39], v[192:207]
    v_exp_f32 v246, v246
    v_exp_f32 v247, v247
    v_exp_f32 v248, v248
    v_smfmac_f32_16x16x64_bf16 v[20:23], v[28:31], v[224:231], v9
    v_exp_f32 v249, v249
    v_smfmac_f32_32x32x32_bf16 v[160:175], v[92:95], v[232:239], v9
    v_exp_f32 v250, v250
    v_exp_f32 v251, v251
    v_exp_f32 v252, v252
    v_smfmac_f32_16x16x64_bf16 v[20:23], v[28:31], v[232:239], v9
    buffer_load_dwordx4 v[76:79], v1, s[4:7], s56 offen offset:1024 sc1
    v_exp_f32 v253, v253
    v_exp_f32 v254, v254
    v_exp_f32 v255, v255
    v_mfma_f32_32x32x16_bf16 v[208:223], v[96:99], v[40:43], 0
    s_add_u32 s54, s54, 8192
    s_and_b32 s54, s54, 0x1ffff
    s_add_u32 s55, s53, s54
    s_add_u32 s56, s55, 4194304
    v_exp_f32 v192, v192
    v_exp_f32 v193, v193
    v_exp_f32 v194, v194
    v_smfmac_f32_32x32x32_bf16 v[176:191], v[88:91], v[240:247], v9
    v_exp_f32 v195, v195
    v_exp_f32 v196, v196
    v_exp_f32 v197, v197
    v_mfma_f32_32x32x16_bf16 v[208:223], v[100:103], v[44:47], v[208:223]
    v_exp_f32 v198, v198
    v_exp_f32 v199, v199
    v_exp_f32 v200, v200
    v_smfmac_f32_16x16x64_bf16 v[24:27], v[28:31], v[240:247], v9
    v_exp_f32 v201, v201
    v_smfmac_f32_32x32x32_bf16 v[176:191], v[92:95], v[248:255], v9
    v_exp_f32 v202, v202
    v_exp_f32 v203, v203
    v_exp_f32 v204, v204
    v_smfmac_f32_16x16x64_bf16 v[24:27], v[28:31], v[248:255], v9
    buffer_load_dwordx4 v[80:83], v1, s[4:7], s55 offen offset:0 sc1
    v_exp_f32 v205, v205
    v_exp_f32 v206, v206
    v_exp_f32 v207, v207
    v_mfma_f32_32x32x16_bf16 v[224:239], v[96:99], v[48:51], 0
    v_exp_f32 v208, v208
    v_exp_f32 v209, v209
    v_exp_f32 v210, v210
    v_smfmac_f32_32x32x32_bf16 v[128:143], v[104:107], v[192:199], v9
    v_exp_f32 v211, v211
    v_exp_f32 v212, v212
    v_exp_f32 v213, v213
    v_mfma_f32_32x32x16_bf16 v[224:239], v[100:103], v[52:55], v[224:239]
    v_exp_f32 v214, v214
    v_exp_f32 v215, v215
    v_exp_f32 v216, v216
    v_smfmac_f32_16x16x64_bf16 v[12:15], v[28:31], v[192:199], v9
    v_exp_f32 v217, v217
    v_smfmac_f32_32x32x32_bf16 v[128:143], v[108:111], v[200:207], v9
    v_exp_f32 v218, v218
    v_exp_f32 v219, v219
    v_exp_f32 v220, v220
    v_smfmac_f32_16x16x64_bf16 v[12:15], v[28:31], v[200:207], v9
    buffer_load_dwordx4 v[84:87], v1, s[4:7], s55 offen offset:1024 sc1
    v_exp_f32 v221, v221
    v_exp_f32 v222, v222
    v_exp_f32 v223, v223
    v_mfma_f32_32x32x16_bf16 v[240:255], v[96:99], v[56:59], 0
    v_exp_f32 v224, v224
    v_exp_f32 v225, v225
    v_exp_f32 v226, v226
    v_smfmac_f32_32x32x32_bf16 v[144:159], v[104:107], v[208:215], v9
    v_exp_f32 v227, v227
    v_exp_f32 v228, v228
    v_exp_f32 v229, v229
    v_mfma_f32_32x32x16_bf16 v[240:255], v[100:103], v[60:63], v[240:255]
    v_exp_f32 v230, v230
    v_exp_f32 v231, v231
    v_exp_f32 v232, v232
    v_smfmac_f32_16x16x64_bf16 v[16:19], v[28:31], v[208:215], v9
    v_exp_f32 v233, v233
    v_smfmac_f32_32x32x32_bf16 v[144:159], v[108:111], v[216:223], v9
    v_exp_f32 v234, v234
    v_exp_f32 v235, v235
    v_exp_f32 v236, v236
    v_smfmac_f32_16x16x64_bf16 v[16:19], v[28:31], v[216:223], v9
    buffer_load_dwordx4 v[88:91], v1, s[4:7], s56 offen offset:0 sc1
    v_exp_f32 v237, v237
    v_exp_f32 v238, v238
    v_exp_f32 v239, v239
    s_waitcnt vmcnt(7)
    v_mfma_f32_32x32x16_bf16 v[192:207], v[112:115], v[32:35], 0
    v_exp_f32 v240, v240
    v_exp_f32 v241, v241
    v_exp_f32 v242, v242
    v_smfmac_f32_32x32x32_bf16 v[160:175], v[104:107], v[224:231], v9
    v_exp_f32 v243, v243
    v_exp_f32 v244, v244
    v_exp_f32 v245, v245
    v_mfma_f32_32x32x16_bf16 v[192:207], v[116:119], v[36:39], v[192:207]
    v_exp_f32 v246, v246
    v_exp_f32 v247, v247
    v_exp_f32 v248, v248
    v_smfmac_f32_16x16x64_bf16 v[20:23], v[28:31], v[224:231], v9
    v_exp_f32 v249, v249
    v_smfmac_f32_32x32x32_bf16 v[160:175], v[108:111], v[232:239], v9
    v_exp_f32 v250, v250
    v_exp_f32 v251, v251
    v_exp_f32 v252, v252
    v_smfmac_f32_16x16x64_bf16 v[20:23], v[28:31], v[232:239], v9
    buffer_load_dwordx4 v[92:95], v1, s[4:7], s56 offen offset:1024 sc1
    v_exp_f32 v253, v253
    v_exp_f32 v254, v254
    v_exp_f32 v255, v255
    s_barrier
    v_mfma_f32_32x32x16_bf16 v[208:223], v[112:115], v[40:43], 0
    s_add_u32 s54, s54, 8192
    s_and_b32 s54, s54, 0x1ffff
    s_add_u32 s55, s53, s54
    s_add_u32 s56, s55, 4194304
    ds_read_b128 v[32:35], v4 offset:8192
    ds_read_b128 v[36:39], v4 offset:9216
    v_exp_f32 v192, v192
    v_exp_f32 v193, v193
    v_exp_f32 v194, v194
    v_smfmac_f32_32x32x32_bf16 v[176:191], v[104:107], v[240:247], v9
    v_exp_f32 v195, v195
    v_exp_f32 v196, v196
    v_exp_f32 v197, v197
    v_mfma_f32_32x32x16_bf16 v[208:223], v[116:119], v[44:47], v[208:223]
    v_exp_f32 v198, v198
    v_exp_f32 v199, v199
    v_exp_f32 v200, v200
    v_smfmac_f32_16x16x64_bf16 v[24:27], v[28:31], v[240:247], v9
    v_exp_f32 v201, v201
    v_smfmac_f32_32x32x32_bf16 v[176:191], v[108:111], v[248:255], v9
    v_exp_f32 v202, v202
    v_exp_f32 v203, v203
    v_exp_f32 v204, v204
    v_smfmac_f32_16x16x64_bf16 v[24:27], v[28:31], v[248:255], v9
    buffer_load_dwordx4 v[96:99], v1, s[4:7], s55 offen offset:0 sc1
    v_exp_f32 v205, v205
    v_exp_f32 v206, v206
    v_exp_f32 v207, v207
    v_mfma_f32_32x32x16_bf16 v[224:239], v[112:115], v[48:51], 0
    ds_read_b128 v[40:43], v4 offset:10240
    ds_read_b128 v[44:47], v4 offset:11264
    v_exp_f32 v208, v208
    v_exp_f32 v209, v209
    v_exp_f32 v210, v210
    v_smfmac_f32_32x32x32_bf16 v[128:143], v[120:123], v[192:199], v9
    v_exp_f32 v211, v211
    v_exp_f32 v212, v212
    v_exp_f32 v213, v213
    v_mfma_f32_32x32x16_bf16 v[224:239], v[116:119], v[52:55], v[224:239]
    v_exp_f32 v214, v214
    v_exp_f32 v215, v215
    v_exp_f32 v216, v216
    v_smfmac_f32_16x16x64_bf16 v[12:15], v[28:31], v[192:199], v9
    v_exp_f32 v217, v217
    v_smfmac_f32_32x32x32_bf16 v[128:143], v[124:127], v[200:207], v9
    v_exp_f32 v218, v218
    v_exp_f32 v219, v219
    v_exp_f32 v220, v220
    v_smfmac_f32_16x16x64_bf16 v[12:15], v[28:31], v[200:207], v9
    buffer_load_dwordx4 v[100:103], v1, s[4:7], s55 offen offset:1024 sc1
    v_exp_f32 v221, v221
    v_exp_f32 v222, v222
    v_exp_f32 v223, v223
    v_mfma_f32_32x32x16_bf16 v[240:255], v[112:115], v[56:59], 0
    ds_read_b128 v[48:51], v4 offset:12288
    ds_read_b128 v[52:55], v4 offset:13312
    v_exp_f32 v224, v224
    v_exp_f32 v225, v225
    v_exp_f32 v226, v226
    v_smfmac_f32_32x32x32_bf16 v[144:159], v[120:123], v[208:215], v9
    v_exp_f32 v227, v227
    ds_write_b128 v5, v[128:131] offset:0
    v_exp_f32 v228, v228
    v_exp_f32 v229, v229
    v_mfma_f32_32x32x16_bf16 v[240:255], v[116:119], v[60:63], v[240:255]
    ds_write_b128 v5, v[132:135] offset:1024
    v_exp_f32 v230, v230
    v_exp_f32 v231, v231
    v_exp_f32 v232, v232
    v_smfmac_f32_16x16x64_bf16 v[16:19], v[28:31], v[208:215], v9
    ds_write_b32 v6, v12 offset:0
    v_exp_f32 v233, v233
    v_smfmac_f32_32x32x32_bf16 v[144:159], v[124:127], v[216:223], v9
    ds_write_b128 v5, v[136:139] offset:2048
    v_exp_f32 v234, v234
    v_exp_f32 v235, v235
    v_exp_f32 v236, v236
    v_smfmac_f32_16x16x64_bf16 v[16:19], v[28:31], v[216:223], v9
    buffer_load_dwordx4 v[104:107], v1, s[4:7], s56 offen offset:0 sc1
    ds_write_b128 v5, v[140:143] offset:3072
    v_exp_f32 v237, v237
    v_exp_f32 v238, v238
    v_exp_f32 v239, v239
    s_waitcnt vmcnt(7)
    s_waitcnt lgkmcnt(9)
    v_mfma_f32_32x32x16_bf16 v[192:207], v[64:67], v[32:35], 0
    ds_read_b128 v[56:59], v4 offset:14336
    ds_read_b128 v[60:63], v4 offset:15360
    v_exp_f32 v240, v240
    v_exp_f32 v241, v241
    v_exp_f32 v242, v242
    v_smfmac_f32_32x32x32_bf16 v[160:175], v[120:123], v[224:231], v9
    v_exp_f32 v243, v243
    ds_write_b128 v5, v[144:147] offset:16384
    v_exp_f32 v244, v244
    v_exp_f32 v245, v245
    v_mfma_f32_32x32x16_bf16 v[192:207], v[68:71], v[36:39], v[192:207]
    ds_write_b128 v5, v[148:151] offset:17408
    v_exp_f32 v246, v246
    v_exp_f32 v247, v247
    v_exp_f32 v248, v248
    s_waitcnt lgkmcnt(4)
    v_mfma_f32_32x32x8_bf16 v[128:143], v[10:11], v[10:11], 0
    v_mov_b32 v12, 0
    v_smfmac_f32_16x16x64_bf16 v[20:23], v[28:31], v[224:231], v9
    ds_write_b32 v6, v16 offset:1024
    v_exp_f32 v249, v249
    v_smfmac_f32_32x32x32_bf16 v[160:175], v[124:127], v[232:239], v9
    ds_write_b128 v5, v[152:155] offset:18432
    v_exp_f32 v250, v250
    v_exp_f32 v251, v251
    v_exp_f32 v252, v252
    v_smfmac_f32_16x16x64_bf16 v[20:23], v[28:31], v[232:239], v9
    buffer_load_dwordx4 v[108:111], v1, s[4:7], s56 offen offset:1024 sc1
    ds_write_b128 v5, v[156:159] offset:19456
    v_exp_f32 v253, v253
    v_exp_f32 v254, v254
    v_exp_f32 v255, v255
    s_cmp_lg_u32 s57, 0
    s_cbranch_scc1 b_tail
    v_mfma_f32_32x32x16_bf16 v[208:223], v[64:67], v[40:43], 0
    s_add_u32 s54, s54, 8192
    s_and_b32 s54, s54, 0x1ffff
    s_add_u32 s55, s53, s54
    s_add_u32 s56, s55, 4194304
    v_exp_f32 v192, v192
    v_exp_f32 v193, v193
    v_exp_f32 v194, v194
    v_smfmac_f32_32x32x32_bf16 v[176:191], v[120:123], v[240:247], v9
    v_exp_f32 v195, v195
    ds_write_b128 v5, v[160:163] offset:32768
    v_exp_f32 v196, v196
    v_exp_f32 v197, v197
    v_mfma_f32_32x32x16_bf16 v[208:223], v[68:71], v[44:47], v[208:223]
    ds_write_b128 v5, v[164:167] offset:33792
    v_exp_f32 v198, v198
    v_exp_f32 v199, v199
    v_exp_f32 v200, v200
    s_waitcnt lgkmcnt(2)
    v_mfma_f32_32x32x8_bf16 v[144:159], v[10:11], v[10:11], 0
    v_mov_b32 v16, 0
    v_smfmac_f32_16x16x64_bf16 v[24:27], v[28:31], v[240:247], v9
    ds_write_b32 v6, v20 offset:2048
    v_exp_f32 v201, v201
    v_smfmac_f32_32x32x32_bf16 v[176:191], v[124:127], v[248:255], v9
    ds_write_b128 v5, v[168:171] offset:34816
    v_exp_f32 v202, v202
    v_exp_f32 v203, v203
    v_exp_f32 v204, v204
    v_smfmac_f32_16x16x64_bf16 v[24:27], v[28:31], v[248:255], v9
    buffer_load_dwordx4 v[112:115], v1, s[4:7], s55 offen offset:0 sc1
    ds_write_b128 v5, v[172:175] offset:35840
    v_exp_f32 v205, v205
    v_exp_f32 v206, v206
    v_exp_f32 v207, v207
    v_mfma_f32_32x32x16_bf16 v[224:239], v[64:67], v[48:51], 0
    v_exp_f32 v208, v208
    v_exp_f32 v209, v209
    v_exp_f32 v210, v210
    v_smfmac_f32_32x32x32_bf16 v[128:143], v[72:75], v[192:199], v9
    v_exp_f32 v211, v211
    ds_write_b128 v5, v[176:179] offset:49152
    v_exp_f32 v212, v212
    v_exp_f32 v213, v213
    v_mfma_f32_32x32x16_bf16 v[224:239], v[68:71], v[52:55], v[224:239]
    ds_write_b128 v5, v[180:183] offset:50176
    v_exp_f32 v214, v214
    v_exp_f32 v215, v215
    v_exp_f32 v216, v216
    s_waitcnt lgkmcnt(2)
    v_mfma_f32_32x32x8_bf16 v[160:175], v[10:11], v[10:11], 0
    v_mov_b32 v20, 0
    v_smfmac_f32_16x16x64_bf16 v[12:15], v[28:31], v[192:199], v9
    ds_write_b32 v6, v24 offset:3072
    v_exp_f32 v217, v217
    v_smfmac_f32_32x32x32_bf16 v[128:143], v[76:79], v[200:207], v9
    ds_write_b128 v5, v[184:187] offset:51200
    v_exp_f32 v218, v218
    v_exp_f32 v219, v219
    v_exp_f32 v220, v220
    v_smfmac_f32_16x16x64_bf16 v[12:15], v[28:31], v[200:207], v9
    buffer_load_dwordx4 v[116:119], v1, s[4:7], s55 offen offset:1024 sc1
    ds_write_b128 v5, v[188:191] offset:52224
    v_exp_f32 v221, v221
    v_exp_f32 v222, v222
    v_exp_f32 v223, v223
    s_waitcnt lgkmcnt(0)
    v_mfma_f32_32x32x8_bf16 v[176:191], v[10:11], v[10:11], 0
    v_mov_b32 v24, 0
    s_barrier
    s_mov_b32 s57, 1
    s_branch b_head
b_tail:
    v_smfmac_f32_32x32x32_bf16 v[176:191], v[120:123], v[240:247], v9
    v_smfmac_f32_32x32x32_bf16 v[176:191], v[124:127], v[248:255], v9
    ds_write_b128 v5, v[160:163] offset:32768
    ds_write_b128 v5, v[164:167] offset:33792
    v_smfmac_f32_16x16x64_bf16 v[24:27], v[28:31], v[240:247], v9
    ds_write_b128 v5, v[168:171] offset:34816
    v_smfmac_f32_16x16x64_bf16 v[24:27], v[28:31], v[248:255], v9
    ds_write_b128 v5, v[172:175] offset:35840
    ds_write_b32 v6, v20 offset:2048
    s_nop 4
    ds_write_b128 v5, v[176:179] offset:49152
    ds_write_b128 v5, v[180:183] offset:50176
    ds_write_b128 v5, v[184:187] offset:51200
    ds_write_b128 v5, v[188:191] offset:52224
    s_nop 0
    ds_write_b32 v6, v24 offset:3072
    buffer_load_dwordx4 v[224:227], v2, s[4:7], s43 offen offset:0 sc1
    buffer_load_dwordx4 v[228:231], v2, s[4:7], s43 offen offset:256 sc1
    buffer_load_dwordx4 v[232:235], v2, s[4:7], s43 offen offset:2048 sc1
    buffer_load_dwordx4 v[236:239], v2, s[4:7], s43 offen offset:2304 sc1
    s_waitcnt lgkmcnt(0)
    s_barrier
    v_xor_b32 v4, 32, v3
    v_xor_b32 v5, 64, v3
    v_xor_b32 v6, 96, v3
c_wo:
    s_xor_b32 s42, s41, 0
    buffer_load_dwordx4 v[64:67], v2, s[4:7], s42 offen offset:0 sc1
    buffer_load_dwordx4 v[68:71], v2, s[4:7], s42 offen offset:256 sc1
    s_xor_b32 s42, s41, 4096
    buffer_load_dwordx4 v[72:75], v2, s[4:7], s42 offen offset:0 sc1
    buffer_load_dwordx4 v[76:79], v2, s[4:7], s42 offen offset:256 sc1
    s_xor_b32 s42, s41, 8192
    buffer_load_dwordx4 v[80:83], v2, s[4:7], s42 offen offset:0 sc1
    buffer_load_dwordx4 v[84:87], v2, s[4:7], s42 offen offset:256 sc1
    s_xor_b32 s42, s41, 12288
    buffer_load_dwordx4 v[88:91], v2, s[4:7], s42 offen offset:0 sc1
    buffer_load_dwordx4 v[92:95], v2, s[4:7], s42 offen offset:256 sc1
    s_xor_b32 s42, s41, 16384
    buffer_load_dwordx4 v[96:99], v2, s[4:7], s42 offen offset:0 sc1
    buffer_load_dwordx4 v[100:103], v2, s[4:7], s42 offen offset:256 sc1
    ds_read_b64_tr_b16 v[32:33], v3 offset:0
    ds_read_b64_tr_b16 v[34:35], v3 offset:1024
    ds_read_b64_tr_b16 v[36:37], v4 offset:0
    ds_read_b64_tr_b16 v[38:39], v4 offset:1024
    ds_read_b64_tr_b16 v[40:41], v5 offset:0
    ds_read_b64_tr_b16 v[42:43], v5 offset:1024
    ds_read_b64_tr_b16 v[44:45], v6 offset:0
    ds_read_b64_tr_b16 v[46:47], v6 offset:1024
    ds_read_b64_tr_b16 v[48:49], v3 offset:4096
    ds_read_b64_tr_b16 v[50:51], v3 offset:5120
    ds_read_b64_tr_b16 v[52:53], v4 offset:4096
    ds_read_b64_tr_b16 v[54:55], v4 offset:5120
    ds_read_b64_tr_b16 v[56:57], v5 offset:4096
    ds_read_b64_tr_b16 v[58:59], v5 offset:5120
    v_lshrrev_b32 v12, 4, v1
    v_and_b32 v13, 1, v12
    v_lshlrev_b32 v13, 4, v13
    v_mov_b32 v14, 0x3f80
    v_lshlrev_b32 v13, v13, v14
    v_lshrrev_b32 v14, 2, v12
    v_lshrrev_b32 v15, 4, v12
    v_xor_b32 v14, v14, v15
    v_and_b32 v14, 1, v14
    v_bfe_u32 v15, v12, 3, 1
    v_bfe_u32 v16, v12, 1, 1
    v_lshl_add_u32 v15, v15, 1, v16
    v_lshrrev_b32 v16, 5, v12
    v_lshl_add_u32 v15, v16, 2, v15
    v_lshl_add_u32 v15, v14, 3, v15
    v_cmp_eq_u32 vcc, 0, v15
    s_nop 1
    v_cndmask_b32 v240, 0, v13, vcc
    v_cmp_eq_u32 vcc, 1, v15
    s_nop 1
    v_cndmask_b32 v241, 0, v13, vcc
    v_cmp_eq_u32 vcc, 2, v15
    s_nop 1
    v_cndmask_b32 v242, 0, v13, vcc
    v_cmp_eq_u32 vcc, 3, v15
    s_nop 1
    v_cndmask_b32 v243, 0, v13, vcc
    v_cmp_eq_u32 vcc, 4, v15
    s_nop 1
    v_cndmask_b32 v244, 0, v13, vcc
    v_cmp_eq_u32 vcc, 5, v15
    s_nop 1
    v_cndmask_b32 v245, 0, v13, vcc
    v_cmp_eq_u32 vcc, 6, v15
    s_nop 1
    v_cndmask_b32 v246, 0, v13, vcc
    v_cmp_eq_u32 vcc, 7, v15
    s_nop 1
    v_cndmask_b32 v247, 0, v13, vcc
    s_waitcnt vmcnt(10)
    v_mfma_f32_16x16x32_bf16 v[128:131], v[240:243], v[224:227], 0
    v_mfma_f32_16x16x32_bf16 v[132:135], v[240:243], v[228:231], 0
    v_mfma_f32_16x16x32_bf16 v[136:139], v[244:247], v[224:227], 0
    v_mfma_f32_16x16x32_bf16 v[140:143], v[244:247], v[228:231], 0
    v_mfma_f32_16x16x32_bf16 v[144:147], v[240:243], v[232:235], 0
    v_mfma_f32_16x16x32_bf16 v[148:151], v[240:243], v[236:239], 0
    v_mfma_f32_16x16x32_bf16 v[152:155], v[244:247], v[232:235], 0
    v_mfma_f32_16x16x32_bf16 v[156:159], v[244:247], v[236:239], 0
    s_waitcnt vmcnt(8) lgkmcnt(10)
    v_mfma_f32_16x16x32_bf16 v[128:131], v[32:35], v[64:67], v[128:131]
    ds_read_b64_tr_b16 v[60:61], v6 offset:4096
    s_xor_b32 s42, s41, 20480
    buffer_load_dwordx4 v[104:107], v2, s[4:7], s42 offen offset:0 sc1
    v_mfma_f32_16x16x32_bf16 v[132:135], v[32:35], v[68:71], v[132:135]
    ds_read_b64_tr_b16 v[62:63], v6 offset:5120
    v_mfma_f32_16x16x32_bf16 v[136:139], v[36:39], v[64:67], v[136:139]
    ds_read_b64_tr_b16 v[32:33], v3 offset:8192
    v_mfma_f32_16x16x32_bf16 v[140:143], v[36:39], v[68:71], v[140:143]
    ds_read_b64_tr_b16 v[34:35], v3 offset:9216
    s_waitcnt lgkmcnt(10)
    v_mfma_f32_16x16x32_bf16 v[144:147], v[40:43], v[64:67], v[144:147]
    buffer_load_dwordx4 v[108:111], v2, s[4:7], s42 offen offset:256 sc1
    ds_read_b64_tr_b16 v[36:37], v4 offset:8192
    s_xor_b32 s42, s41, 24576
    v_mfma_f32_16x16x32_bf16 v[148:151], v[40:43], v[68:71], v[148:151]
    ds_read_b64_tr_b16 v[38:39], v4 offset:9216
    v_mfma_f32_16x16x32_bf16 v[152:155], v[44:47], v[64:67], v[152:155]
    ds_read_b64_tr_b16 v[40:41], v5 offset:8192
    v_mfma_f32_16x16x32_bf16 v[156:159], v[44:47], v[68:71], v[156:159]
    ds_read_b64_tr_b16 v[42:43], v5 offset:9216
    s_waitcnt vmcnt(8) lgkmcnt(10)
    v_mfma_f32_16x16x32_bf16 v[128:131], v[48:51], v[72:75], v[128:131]
    buffer_load_dwordx4 v[112:115], v2, s[4:7], s42 offen offset:0 sc1
    ds_read_b64_tr_b16 v[44:45], v6 offset:8192
    v_mfma_f32_16x16x32_bf16 v[132:135], v[48:51], v[76:79], v[132:135]
    ds_read_b64_tr_b16 v[46:47], v6 offset:9216
    v_mfma_f32_16x16x32_bf16 v[136:139], v[52:55], v[72:75], v[136:139]
    ds_read_b64_tr_b16 v[48:49], v3 offset:12288
    v_mfma_f32_16x16x32_bf16 v[140:143], v[52:55], v[76:79], v[140:143]
    ds_read_b64_tr_b16 v[50:51], v3 offset:13312
    s_waitcnt lgkmcnt(10)
    v_mfma_f32_16x16x32_bf16 v[144:147], v[56:59], v[72:75], v[144:147]
    buffer_load_dwordx4 v[116:119], v2, s[4:7], s42 offen offset:256 sc1
    ds_read_b64_tr_b16 v[52:53], v4 offset:12288
    s_xor_b32 s42, s41, 28672
    v_mfma_f32_16x16x32_bf16 v[148:151], v[56:59], v[76:79], v[148:151]
    ds_read_b64_tr_b16 v[54:55], v4 offset:13312
    v_mfma_f32_16x16x32_bf16 v[152:155], v[60:63], v[72:75], v[152:155]
    ds_read_b64_tr_b16 v[56:57], v5 offset:12288
    v_mfma_f32_16x16x32_bf16 v[156:159], v[60:63], v[76:79], v[156:159]
    ds_read_b64_tr_b16 v[58:59], v5 offset:13312
    s_waitcnt vmcnt(8) lgkmcnt(10)
    v_mfma_f32_16x16x32_bf16 v[128:131], v[32:35], v[80:83], v[128:131]
    ds_read_b64_tr_b16 v[60:61], v6 offset:12288
    buffer_load_dwordx4 v[120:123], v2, s[4:7], s42 offen offset:0 sc1
    v_mfma_f32_16x16x32_bf16 v[132:135], v[32:35], v[84:87], v[132:135]
    ds_read_b64_tr_b16 v[62:63], v6 offset:13312
    v_mfma_f32_16x16x32_bf16 v[136:139], v[36:39], v[80:83], v[136:139]
    ds_read_b64_tr_b16 v[32:33], v3 offset:16384
    v_mfma_f32_16x16x32_bf16 v[140:143], v[36:39], v[84:87], v[140:143]
    ds_read_b64_tr_b16 v[34:35], v3 offset:17408
    s_waitcnt lgkmcnt(10)
    v_mfma_f32_16x16x32_bf16 v[144:147], v[40:43], v[80:83], v[144:147]
    buffer_load_dwordx4 v[124:127], v2, s[4:7], s42 offen offset:256 sc1
    ds_read_b64_tr_b16 v[36:37], v4 offset:16384
    s_xor_b32 s42, s41, 32768
    v_mfma_f32_16x16x32_bf16 v[148:151], v[40:43], v[84:87], v[148:151]
    ds_read_b64_tr_b16 v[38:39], v4 offset:17408
    v_mfma_f32_16x16x32_bf16 v[152:155], v[44:47], v[80:83], v[152:155]
    ds_read_b64_tr_b16 v[40:41], v5 offset:16384
    v_mfma_f32_16x16x32_bf16 v[156:159], v[44:47], v[84:87], v[156:159]
    ds_read_b64_tr_b16 v[42:43], v5 offset:17408
    s_waitcnt vmcnt(8) lgkmcnt(10)
    v_mfma_f32_16x16x32_bf16 v[128:131], v[48:51], v[88:91], v[128:131]
    buffer_load_dwordx4 v[160:163], v2, s[4:7], s42 offen offset:0 sc1
    ds_read_b64_tr_b16 v[44:45], v6 offset:16384
    v_mfma_f32_16x16x32_bf16 v[132:135], v[48:51], v[92:95], v[132:135]
    ds_read_b64_tr_b16 v[46:47], v6 offset:17408
    v_mfma_f32_16x16x32_bf16 v[136:139], v[52:55], v[88:91], v[136:139]
    ds_read_b64_tr_b16 v[48:49], v3 offset:20480
    v_mfma_f32_16x16x32_bf16 v[140:143], v[52:55], v[92:95], v[140:143]
    ds_read_b64_tr_b16 v[50:51], v3 offset:21504
    s_waitcnt lgkmcnt(10)
    v_mfma_f32_16x16x32_bf16 v[144:147], v[56:59], v[88:91], v[144:147]
    buffer_load_dwordx4 v[164:167], v2, s[4:7], s42 offen offset:256 sc1
    ds_read_b64_tr_b16 v[52:53], v4 offset:20480
    s_xor_b32 s42, s41, 36864
    v_mfma_f32_16x16x32_bf16 v[148:151], v[56:59], v[92:95], v[148:151]
    ds_read_b64_tr_b16 v[54:55], v4 offset:21504
    v_mfma_f32_16x16x32_bf16 v[152:155], v[60:63], v[88:91], v[152:155]
    ds_read_b64_tr_b16 v[56:57], v5 offset:20480
    v_mfma_f32_16x16x32_bf16 v[156:159], v[60:63], v[92:95], v[156:159]
    ds_read_b64_tr_b16 v[58:59], v5 offset:21504
    s_waitcnt vmcnt(8) lgkmcnt(10)
    v_mfma_f32_16x16x32_bf16 v[128:131], v[32:35], v[96:99], v[128:131]
    ds_read_b64_tr_b16 v[60:61], v6 offset:20480
    buffer_load_dwordx4 v[168:171], v2, s[4:7], s42 offen offset:0 sc1
    v_mfma_f32_16x16x32_bf16 v[132:135], v[32:35], v[100:103], v[132:135]
    ds_read_b64_tr_b16 v[62:63], v6 offset:21504
    v_mfma_f32_16x16x32_bf16 v[136:139], v[36:39], v[96:99], v[136:139]
    ds_read_b64_tr_b16 v[32:33], v3 offset:24576
    v_mfma_f32_16x16x32_bf16 v[140:143], v[36:39], v[100:103], v[140:143]
    ds_read_b64_tr_b16 v[34:35], v3 offset:25600
    s_waitcnt lgkmcnt(10)
    v_mfma_f32_16x16x32_bf16 v[144:147], v[40:43], v[96:99], v[144:147]
    buffer_load_dwordx4 v[172:175], v2, s[4:7], s42 offen offset:256 sc1
    ds_read_b64_tr_b16 v[36:37], v4 offset:24576
    s_xor_b32 s42, s41, 40960
    v_mfma_f32_16x16x32_bf16 v[148:151], v[40:43], v[100:103], v[148:151]
    ds_read_b64_tr_b16 v[38:39], v4 offset:25600
    v_mfma_f32_16x16x32_bf16 v[152:155], v[44:47], v[96:99], v[152:155]
    ds_read_b64_tr_b16 v[40:41], v5 offset:24576
    v_mfma_f32_16x16x32_bf16 v[156:159], v[44:47], v[100:103], v[156:159]
    ds_read_b64_tr_b16 v[42:43], v5 offset:25600
    s_waitcnt vmcnt(8) lgkmcnt(10)
    v_mfma_f32_16x16x32_bf16 v[128:131], v[48:51], v[104:107], v[128:131]
    buffer_load_dwordx4 v[176:179], v2, s[4:7], s42 offen offset:0 sc1
    ds_read_b64_tr_b16 v[44:45], v6 offset:24576
    v_mfma_f32_16x16x32_bf16 v[132:135], v[48:51], v[108:111], v[132:135]
    ds_read_b64_tr_b16 v[46:47], v6 offset:25600
    v_mfma_f32_16x16x32_bf16 v[136:139], v[52:55], v[104:107], v[136:139]
    ds_read_b64_tr_b16 v[48:49], v3 offset:28672
    v_mfma_f32_16x16x32_bf16 v[140:143], v[52:55], v[108:111], v[140:143]
    ds_read_b64_tr_b16 v[50:51], v3 offset:29696
    s_waitcnt lgkmcnt(10)
    v_mfma_f32_16x16x32_bf16 v[144:147], v[56:59], v[104:107], v[144:147]
    buffer_load_dwordx4 v[180:183], v2, s[4:7], s42 offen offset:256 sc1
    ds_read_b64_tr_b16 v[52:53], v4 offset:28672
    s_xor_b32 s42, s41, 45056
    v_mfma_f32_16x16x32_bf16 v[148:151], v[56:59], v[108:111], v[148:151]
    ds_read_b64_tr_b16 v[54:55], v4 offset:29696
    v_mfma_f32_16x16x32_bf16 v[152:155], v[60:63], v[104:107], v[152:155]
    ds_read_b64_tr_b16 v[56:57], v5 offset:28672
    v_mfma_f32_16x16x32_bf16 v[156:159], v[60:63], v[108:111], v[156:159]
    ds_read_b64_tr_b16 v[58:59], v5 offset:29696
    s_waitcnt vmcnt(8) lgkmcnt(10)
    v_mfma_f32_16x16x32_bf16 v[128:131], v[32:35], v[112:115], v[128:131]
    ds_read_b64_tr_b16 v[60:61], v6 offset:28672
    buffer_load_dwordx4 v[184:187], v2, s[4:7], s42 offen offset:0 sc1
    v_mfma_f32_16x16x32_bf16 v[132:135], v[32:35], v[116:119], v[132:135]
    ds_read_b64_tr_b16 v[62:63], v6 offset:29696
    v_mfma_f32_16x16x32_bf16 v[136:139], v[36:39], v[112:115], v[136:139]
    ds_read_b64_tr_b16 v[32:33], v3 offset:32768
    v_mfma_f32_16x16x32_bf16 v[140:143], v[36:39], v[116:119], v[140:143]
    ds_read_b64_tr_b16 v[34:35], v3 offset:33792
    s_waitcnt lgkmcnt(10)
    v_mfma_f32_16x16x32_bf16 v[144:147], v[40:43], v[112:115], v[144:147]
    buffer_load_dwordx4 v[188:191], v2, s[4:7], s42 offen offset:256 sc1
    ds_read_b64_tr_b16 v[36:37], v4 offset:32768
    s_xor_b32 s42, s41, 49152
    v_mfma_f32_16x16x32_bf16 v[148:151], v[40:43], v[116:119], v[148:151]
    ds_read_b64_tr_b16 v[38:39], v4 offset:33792
    v_mfma_f32_16x16x32_bf16 v[152:155], v[44:47], v[112:115], v[152:155]
    ds_read_b64_tr_b16 v[40:41], v5 offset:32768
    v_mfma_f32_16x16x32_bf16 v[156:159], v[44:47], v[116:119], v[156:159]
    ds_read_b64_tr_b16 v[42:43], v5 offset:33792
    s_waitcnt vmcnt(8) lgkmcnt(10)
    v_mfma_f32_16x16x32_bf16 v[128:131], v[48:51], v[120:123], v[128:131]
    buffer_load_dwordx4 v[64:67], v2, s[4:7], s42 offen offset:0 sc1
    ds_read_b64_tr_b16 v[44:45], v6 offset:32768
    v_mfma_f32_16x16x32_bf16 v[132:135], v[48:51], v[124:127], v[132:135]
    ds_read_b64_tr_b16 v[46:47], v6 offset:33792
    v_mfma_f32_16x16x32_bf16 v[136:139], v[52:55], v[120:123], v[136:139]
    ds_read_b64_tr_b16 v[48:49], v3 offset:36864
    v_mfma_f32_16x16x32_bf16 v[140:143], v[52:55], v[124:127], v[140:143]
    ds_read_b64_tr_b16 v[50:51], v3 offset:37888
    s_waitcnt lgkmcnt(10)
    v_mfma_f32_16x16x32_bf16 v[144:147], v[56:59], v[120:123], v[144:147]
    buffer_load_dwordx4 v[68:71], v2, s[4:7], s42 offen offset:256 sc1
    ds_read_b64_tr_b16 v[52:53], v4 offset:36864
    s_xor_b32 s42, s41, 53248
    v_mfma_f32_16x16x32_bf16 v[148:151], v[56:59], v[124:127], v[148:151]
    ds_read_b64_tr_b16 v[54:55], v4 offset:37888
    v_mfma_f32_16x16x32_bf16 v[152:155], v[60:63], v[120:123], v[152:155]
    ds_read_b64_tr_b16 v[56:57], v5 offset:36864
    v_mfma_f32_16x16x32_bf16 v[156:159], v[60:63], v[124:127], v[156:159]
    ds_read_b64_tr_b16 v[58:59], v5 offset:37888
    s_waitcnt vmcnt(8) lgkmcnt(10)
    v_mfma_f32_16x16x32_bf16 v[128:131], v[32:35], v[160:163], v[128:131]
    ds_read_b64_tr_b16 v[60:61], v6 offset:36864
    buffer_load_dwordx4 v[72:75], v2, s[4:7], s42 offen offset:0 sc1
    v_mfma_f32_16x16x32_bf16 v[132:135], v[32:35], v[164:167], v[132:135]
    ds_read_b64_tr_b16 v[62:63], v6 offset:37888
    v_mfma_f32_16x16x32_bf16 v[136:139], v[36:39], v[160:163], v[136:139]
    ds_read_b64_tr_b16 v[32:33], v3 offset:40960
    v_mfma_f32_16x16x32_bf16 v[140:143], v[36:39], v[164:167], v[140:143]
    ds_read_b64_tr_b16 v[34:35], v3 offset:41984
    s_waitcnt lgkmcnt(10)
    v_mfma_f32_16x16x32_bf16 v[144:147], v[40:43], v[160:163], v[144:147]
    buffer_load_dwordx4 v[76:79], v2, s[4:7], s42 offen offset:256 sc1
    ds_read_b64_tr_b16 v[36:37], v4 offset:40960
    s_xor_b32 s42, s41, 57344
    v_mfma_f32_16x16x32_bf16 v[148:151], v[40:43], v[164:167], v[148:151]
    ds_read_b64_tr_b16 v[38:39], v4 offset:41984
    v_mfma_f32_16x16x32_bf16 v[152:155], v[44:47], v[160:163], v[152:155]
    ds_read_b64_tr_b16 v[40:41], v5 offset:40960
    v_mfma_f32_16x16x32_bf16 v[156:159], v[44:47], v[164:167], v[156:159]
    ds_read_b64_tr_b16 v[42:43], v5 offset:41984
    s_waitcnt vmcnt(8) lgkmcnt(10)
    v_mfma_f32_16x16x32_bf16 v[128:131], v[48:51], v[168:171], v[128:131]
    buffer_load_dwordx4 v[80:83], v2, s[4:7], s42 offen offset:0 sc1
    ds_read_b64_tr_b16 v[44:45], v6 offset:40960
    v_mfma_f32_16x16x32_bf16 v[132:135], v[48:51], v[172:175], v[132:135]
    ds_read_b64_tr_b16 v[46:47], v6 offset:41984
    v_mfma_f32_16x16x32_bf16 v[136:139], v[52:55], v[168:171], v[136:139]
    ds_read_b64_tr_b16 v[48:49], v3 offset:45056
    v_mfma_f32_16x16x32_bf16 v[140:143], v[52:55], v[172:175], v[140:143]
    ds_read_b64_tr_b16 v[50:51], v3 offset:46080
    s_waitcnt lgkmcnt(10)
    v_mfma_f32_16x16x32_bf16 v[144:147], v[56:59], v[168:171], v[144:147]
    buffer_load_dwordx4 v[84:87], v2, s[4:7], s42 offen offset:256 sc1
    ds_read_b64_tr_b16 v[52:53], v4 offset:45056
    s_xor_b32 s42, s41, 61440
    v_mfma_f32_16x16x32_bf16 v[148:151], v[56:59], v[172:175], v[148:151]
    ds_read_b64_tr_b16 v[54:55], v4 offset:46080
    v_mfma_f32_16x16x32_bf16 v[152:155], v[60:63], v[168:171], v[152:155]
    ds_read_b64_tr_b16 v[56:57], v5 offset:45056
    v_mfma_f32_16x16x32_bf16 v[156:159], v[60:63], v[172:175], v[156:159]
    ds_read_b64_tr_b16 v[58:59], v5 offset:46080
    s_waitcnt vmcnt(8) lgkmcnt(10)
    v_mfma_f32_16x16x32_bf16 v[128:131], v[32:35], v[176:179], v[128:131]
    ds_read_b64_tr_b16 v[60:61], v6 offset:45056
    buffer_load_dwordx4 v[88:91], v2, s[4:7], s42 offen offset:0 sc1
    v_mfma_f32_16x16x32_bf16 v[132:135], v[32:35], v[180:183], v[132:135]
    ds_read_b64_tr_b16 v[62:63], v6 offset:46080
    s_barrier
    v_mfma_f32_16x16x32_bf16 v[136:139], v[36:39], v[176:179], v[136:139]
    ds_read_b64_tr_b16 v[32:33], v3 offset:49152
    v_mfma_f32_16x16x32_bf16 v[140:143], v[36:39], v[180:183], v[140:143]
    ds_read_b64_tr_b16 v[34:35], v3 offset:50176
    s_waitcnt lgkmcnt(10)
    v_mfma_f32_16x16x32_bf16 v[144:147], v[40:43], v[176:179], v[144:147]
    buffer_load_dwordx4 v[92:95], v2, s[4:7], s42 offen offset:256 sc1
    ds_read_b64_tr_b16 v[36:37], v4 offset:49152
    s_xor_b32 s42, s41, 0
    v_mfma_f32_16x16x32_bf16 v[148:151], v[40:43], v[180:183], v[148:151]
    ds_read_b64_tr_b16 v[38:39], v4 offset:50176
    v_mfma_f32_16x16x32_bf16 v[152:155], v[44:47], v[176:179], v[152:155]
    ds_read_b64_tr_b16 v[40:41], v5 offset:49152
    v_mfma_f32_16x16x32_bf16 v[156:159], v[44:47], v[180:183], v[156:159]
    ds_read_b64_tr_b16 v[42:43], v5 offset:50176
    s_waitcnt vmcnt(8) lgkmcnt(10)
    v_mfma_f32_16x16x32_bf16 v[128:131], v[48:51], v[184:187], v[128:131]
    buffer_load_dwordx4 v[96:99], v2, s[4:7], s42 offen offset:2048 sc1
    ds_read_b64_tr_b16 v[44:45], v6 offset:49152
    v_mfma_f32_16x16x32_bf16 v[132:135], v[48:51], v[188:191], v[132:135]
    ds_read_b64_tr_b16 v[46:47], v6 offset:50176
    v_mfma_f32_16x16x32_bf16 v[136:139], v[52:55], v[184:187], v[136:139]
    ds_read_b64_tr_b16 v[48:49], v3 offset:53248
    v_mfma_f32_16x16x32_bf16 v[140:143], v[52:55], v[188:191], v[140:143]
    ds_read_b64_tr_b16 v[50:51], v3 offset:54272
    s_waitcnt lgkmcnt(10)
    v_mfma_f32_16x16x32_bf16 v[144:147], v[56:59], v[184:187], v[144:147]
    buffer_load_dwordx4 v[100:103], v2, s[4:7], s42 offen offset:2304 sc1
    ds_read_b64_tr_b16 v[52:53], v4 offset:53248
    s_xor_b32 s42, s41, 4096
    v_mfma_f32_16x16x32_bf16 v[148:151], v[56:59], v[188:191], v[148:151]
    ds_read_b64_tr_b16 v[54:55], v4 offset:54272
    v_mfma_f32_16x16x32_bf16 v[152:155], v[60:63], v[184:187], v[152:155]
    ds_read_b64_tr_b16 v[56:57], v5 offset:53248
    v_mfma_f32_16x16x32_bf16 v[156:159], v[60:63], v[188:191], v[156:159]
    ds_read_b64_tr_b16 v[58:59], v5 offset:54272
    s_waitcnt vmcnt(8) lgkmcnt(10)
    v_mfma_f32_16x16x32_bf16 v[128:131], v[32:35], v[64:67], v[128:131]
    ds_read_b64_tr_b16 v[60:61], v6 offset:53248
    buffer_load_dwordx4 v[104:107], v2, s[4:7], s42 offen offset:2048 sc1
    v_mfma_f32_16x16x32_bf16 v[132:135], v[32:35], v[68:71], v[132:135]
    ds_read_b64_tr_b16 v[62:63], v6 offset:54272
    v_mfma_f32_16x16x32_bf16 v[136:139], v[36:39], v[64:67], v[136:139]
    ds_read_b64_tr_b16 v[32:33], v3 offset:57344
    v_mfma_f32_16x16x32_bf16 v[140:143], v[36:39], v[68:71], v[140:143]
    ds_read_b64_tr_b16 v[34:35], v3 offset:58368
    s_waitcnt lgkmcnt(10)
    v_mfma_f32_16x16x32_bf16 v[144:147], v[40:43], v[64:67], v[144:147]
    buffer_load_dwordx4 v[108:111], v2, s[4:7], s42 offen offset:2304 sc1
    ds_read_b64_tr_b16 v[36:37], v4 offset:57344
    s_xor_b32 s42, s41, 8192
    v_mfma_f32_16x16x32_bf16 v[148:151], v[40:43], v[68:71], v[148:151]
    ds_read_b64_tr_b16 v[38:39], v4 offset:58368
    v_mfma_f32_16x16x32_bf16 v[152:155], v[44:47], v[64:67], v[152:155]
    ds_read_b64_tr_b16 v[40:41], v5 offset:57344
    v_mfma_f32_16x16x32_bf16 v[156:159], v[44:47], v[68:71], v[156:159]
    ds_read_b64_tr_b16 v[42:43], v5 offset:58368
    s_waitcnt vmcnt(8) lgkmcnt(10)
    v_mfma_f32_16x16x32_bf16 v[128:131], v[48:51], v[72:75], v[128:131]
    buffer_load_dwordx4 v[112:115], v2, s[4:7], s42 offen offset:2048 sc1
    ds_read_b64_tr_b16 v[44:45], v6 offset:57344
    v_mfma_f32_16x16x32_bf16 v[132:135], v[48:51], v[76:79], v[132:135]
    ds_read_b64_tr_b16 v[46:47], v6 offset:58368
    v_mfma_f32_16x16x32_bf16 v[136:139], v[52:55], v[72:75], v[136:139]
    ds_read_b64_tr_b16 v[48:49], v3 offset:61440
    v_mfma_f32_16x16x32_bf16 v[140:143], v[52:55], v[76:79], v[140:143]
    ds_read_b64_tr_b16 v[50:51], v3 offset:62464
    s_waitcnt lgkmcnt(10)
    v_mfma_f32_16x16x32_bf16 v[144:147], v[56:59], v[72:75], v[144:147]
    buffer_load_dwordx4 v[116:119], v2, s[4:7], s42 offen offset:2304 sc1
    ds_read_b64_tr_b16 v[52:53], v4 offset:61440
    s_xor_b32 s42, s41, 12288
    v_mfma_f32_16x16x32_bf16 v[148:151], v[56:59], v[76:79], v[148:151]
    ds_read_b64_tr_b16 v[54:55], v4 offset:62464
    v_mfma_f32_16x16x32_bf16 v[152:155], v[60:63], v[72:75], v[152:155]
    ds_read_b64_tr_b16 v[56:57], v5 offset:61440
    v_mfma_f32_16x16x32_bf16 v[156:159], v[60:63], v[76:79], v[156:159]
    ds_read_b64_tr_b16 v[58:59], v5 offset:62464
    s_waitcnt vmcnt(8) lgkmcnt(10)
    v_mfma_f32_16x16x32_bf16 v[128:131], v[32:35], v[80:83], v[128:131]
    ds_read_b64_tr_b16 v[60:61], v6 offset:61440
    buffer_load_dwordx4 v[120:123], v2, s[4:7], s42 offen offset:2048 sc1
    v_mfma_f32_16x16x32_bf16 v[132:135], v[32:35], v[84:87], v[132:135]
    ds_read_b64_tr_b16 v[62:63], v6 offset:62464
    v_xor_b32 v3, 0x10000, v3
    v_xor_b32 v4, 0x10000, v4
    v_xor_b32 v5, 0x10000, v5
    v_xor_b32 v6, 0x10000, v6
    v_mfma_f32_16x16x32_bf16 v[136:139], v[36:39], v[80:83], v[136:139]
    ds_read_b64_tr_b16 v[32:33], v3 offset:0
    v_mfma_f32_16x16x32_bf16 v[140:143], v[36:39], v[84:87], v[140:143]
    ds_read_b64_tr_b16 v[34:35], v3 offset:1024
    s_waitcnt lgkmcnt(10)
    v_mfma_f32_16x16x32_bf16 v[144:147], v[40:43], v[80:83], v[144:147]
    buffer_load_dwordx4 v[124:127], v2, s[4:7], s42 offen offset:2304 sc1
    ds_read_b64_tr_b16 v[36:37], v4 offset:0
    s_xor_b32 s42, s41, 16384
    v_mfma_f32_16x16x32_bf16 v[148:151], v[40:43], v[84:87], v[148:151]
    ds_read_b64_tr_b16 v[38:39], v4 offset:1024
    v_mfma_f32_16x16x32_bf16 v[152:155], v[44:47], v[80:83], v[152:155]
    ds_read_b64_tr_b16 v[40:41], v5 offset:0
    v_mfma_f32_16x16x32_bf16 v[156:159], v[44:47], v[84:87], v[156:159]
    ds_read_b64_tr_b16 v[42:43], v5 offset:1024
    s_waitcnt vmcnt(8) lgkmcnt(10)
    v_mfma_f32_16x16x32_bf16 v[128:131], v[48:51], v[88:91], v[128:131]
    buffer_load_dwordx4 v[160:163], v2, s[4:7], s42 offen offset:2048 sc1
    ds_read_b64_tr_b16 v[44:45], v6 offset:0
    v_mfma_f32_16x16x32_bf16 v[132:135], v[48:51], v[92:95], v[132:135]
    ds_read_b64_tr_b16 v[46:47], v6 offset:1024
    v_mfma_f32_16x16x32_bf16 v[136:139], v[52:55], v[88:91], v[136:139]
    ds_read_b64_tr_b16 v[48:49], v3 offset:4096
    v_mfma_f32_16x16x32_bf16 v[140:143], v[52:55], v[92:95], v[140:143]
    ds_read_b64_tr_b16 v[50:51], v3 offset:5120
    s_waitcnt lgkmcnt(10)
    v_mfma_f32_16x16x32_bf16 v[144:147], v[56:59], v[88:91], v[144:147]
    buffer_load_dwordx4 v[164:167], v2, s[4:7], s42 offen offset:2304 sc1
    ds_read_b64_tr_b16 v[52:53], v4 offset:4096
    s_xor_b32 s42, s41, 20480
    v_mfma_f32_16x16x32_bf16 v[148:151], v[56:59], v[92:95], v[148:151]
    ds_read_b64_tr_b16 v[54:55], v4 offset:5120
    v_mfma_f32_16x16x32_bf16 v[152:155], v[60:63], v[88:91], v[152:155]
    ds_read_b64_tr_b16 v[56:57], v5 offset:4096
    v_mfma_f32_16x16x32_bf16 v[156:159], v[60:63], v[92:95], v[156:159]
    ds_read_b64_tr_b16 v[58:59], v5 offset:5120
    s_waitcnt vmcnt(8) lgkmcnt(10)
    v_mfma_f32_16x16x32_bf16 v[128:131], v[32:35], v[96:99], v[128:131]
    ds_read_b64_tr_b16 v[60:61], v6 offset:4096
    buffer_load_dwordx4 v[168:171], v2, s[4:7], s42 offen offset:2048 sc1
    v_mfma_f32_16x16x32_bf16 v[132:135], v[32:35], v[100:103], v[132:135]
    ds_read_b64_tr_b16 v[62:63], v6 offset:5120
    v_mfma_f32_16x16x32_bf16 v[136:139], v[36:39], v[96:99], v[136:139]
    ds_read_b64_tr_b16 v[32:33], v3 offset:8192
    v_mfma_f32_16x16x32_bf16 v[140:143], v[36:39], v[100:103], v[140:143]
    ds_read_b64_tr_b16 v[34:35], v3 offset:9216
    s_waitcnt lgkmcnt(10)
    v_mfma_f32_16x16x32_bf16 v[144:147], v[40:43], v[96:99], v[144:147]
    buffer_load_dwordx4 v[172:175], v2, s[4:7], s42 offen offset:2304 sc1
    ds_read_b64_tr_b16 v[36:37], v4 offset:8192
    s_xor_b32 s42, s41, 24576
    v_mfma_f32_16x16x32_bf16 v[148:151], v[40:43], v[100:103], v[148:151]
    ds_read_b64_tr_b16 v[38:39], v4 offset:9216
    v_mfma_f32_16x16x32_bf16 v[152:155], v[44:47], v[96:99], v[152:155]
    ds_read_b64_tr_b16 v[40:41], v5 offset:8192
    v_mfma_f32_16x16x32_bf16 v[156:159], v[44:47], v[100:103], v[156:159]
    ds_read_b64_tr_b16 v[42:43], v5 offset:9216
    s_waitcnt vmcnt(8) lgkmcnt(10)
    v_mfma_f32_16x16x32_bf16 v[128:131], v[48:51], v[104:107], v[128:131]
    buffer_load_dwordx4 v[176:179], v2, s[4:7], s42 offen offset:2048 sc1
    ds_read_b64_tr_b16 v[44:45], v6 offset:8192
    v_mfma_f32_16x16x32_bf16 v[132:135], v[48:51], v[108:111], v[132:135]
    ds_read_b64_tr_b16 v[46:47], v6 offset:9216
    v_mfma_f32_16x16x32_bf16 v[136:139], v[52:55], v[104:107], v[136:139]
    ds_read_b64_tr_b16 v[48:49], v3 offset:12288
    v_mfma_f32_16x16x32_bf16 v[140:143], v[52:55], v[108:111], v[140:143]
    ds_read_b64_tr_b16 v[50:51], v3 offset:13312
    s_waitcnt lgkmcnt(10)
    v_mfma_f32_16x16x32_bf16 v[144:147], v[56:59], v[104:107], v[144:147]
    buffer_load_dwordx4 v[180:183], v2, s[4:7], s42 offen offset:2304 sc1
    ds_read_b64_tr_b16 v[52:53], v4 offset:12288
    s_xor_b32 s42, s41, 28672
    v_mfma_f32_16x16x32_bf16 v[148:151], v[56:59], v[108:111], v[148:151]
    ds_read_b64_tr_b16 v[54:55], v4 offset:13312
    v_mfma_f32_16x16x32_bf16 v[152:155], v[60:63], v[104:107], v[152:155]
    ds_read_b64_tr_b16 v[56:57], v5 offset:12288
    v_mfma_f32_16x16x32_bf16 v[156:159], v[60:63], v[108:111], v[156:159]
    ds_read_b64_tr_b16 v[58:59], v5 offset:13312
    s_waitcnt vmcnt(8) lgkmcnt(10)
    v_mfma_f32_16x16x32_bf16 v[128:131], v[32:35], v[112:115], v[128:131]
    ds_read_b64_tr_b16 v[60:61], v6 offset:12288
    buffer_load_dwordx4 v[184:187], v2, s[4:7], s42 offen offset:2048 sc1
    v_mfma_f32_16x16x32_bf16 v[132:135], v[32:35], v[116:119], v[132:135]
    ds_read_b64_tr_b16 v[62:63], v6 offset:13312
    v_mfma_f32_16x16x32_bf16 v[136:139], v[36:39], v[112:115], v[136:139]
    ds_read_b64_tr_b16 v[32:33], v3 offset:16384
    v_mfma_f32_16x16x32_bf16 v[140:143], v[36:39], v[116:119], v[140:143]
    ds_read_b64_tr_b16 v[34:35], v3 offset:17408
    s_waitcnt lgkmcnt(10)
    v_mfma_f32_16x16x32_bf16 v[144:147], v[40:43], v[112:115], v[144:147]
    buffer_load_dwordx4 v[188:191], v2, s[4:7], s42 offen offset:2304 sc1
    ds_read_b64_tr_b16 v[36:37], v4 offset:16384
    s_xor_b32 s42, s41, 32768
    v_mfma_f32_16x16x32_bf16 v[148:151], v[40:43], v[116:119], v[148:151]
    ds_read_b64_tr_b16 v[38:39], v4 offset:17408
    v_mfma_f32_16x16x32_bf16 v[152:155], v[44:47], v[112:115], v[152:155]
    ds_read_b64_tr_b16 v[40:41], v5 offset:16384
    v_mfma_f32_16x16x32_bf16 v[156:159], v[44:47], v[116:119], v[156:159]
    ds_read_b64_tr_b16 v[42:43], v5 offset:17408
    s_waitcnt vmcnt(8) lgkmcnt(10)
    v_mfma_f32_16x16x32_bf16 v[128:131], v[48:51], v[120:123], v[128:131]
    buffer_load_dwordx4 v[64:67], v2, s[4:7], s42 offen offset:2048 sc1
    ds_read_b64_tr_b16 v[44:45], v6 offset:16384
    v_mfma_f32_16x16x32_bf16 v[132:135], v[48:51], v[124:127], v[132:135]
    ds_read_b64_tr_b16 v[46:47], v6 offset:17408
    v_mfma_f32_16x16x32_bf16 v[136:139], v[52:55], v[120:123], v[136:139]
    ds_read_b64_tr_b16 v[48:49], v3 offset:20480
    v_mfma_f32_16x16x32_bf16 v[140:143], v[52:55], v[124:127], v[140:143]
    ds_read_b64_tr_b16 v[50:51], v3 offset:21504
    s_waitcnt lgkmcnt(10)
    v_mfma_f32_16x16x32_bf16 v[144:147], v[56:59], v[120:123], v[144:147]
    buffer_load_dwordx4 v[68:71], v2, s[4:7], s42 offen offset:2304 sc1
    ds_read_b64_tr_b16 v[52:53], v4 offset:20480
    s_xor_b32 s42, s41, 36864
    v_mfma_f32_16x16x32_bf16 v[148:151], v[56:59], v[124:127], v[148:151]
    ds_read_b64_tr_b16 v[54:55], v4 offset:21504
    v_mfma_f32_16x16x32_bf16 v[152:155], v[60:63], v[120:123], v[152:155]
    ds_read_b64_tr_b16 v[56:57], v5 offset:20480
    v_mfma_f32_16x16x32_bf16 v[156:159], v[60:63], v[124:127], v[156:159]
    ds_read_b64_tr_b16 v[58:59], v5 offset:21504
    s_waitcnt vmcnt(8) lgkmcnt(10)
    v_mfma_f32_16x16x32_bf16 v[128:131], v[32:35], v[160:163], v[128:131]
    ds_read_b64_tr_b16 v[60:61], v6 offset:20480
    buffer_load_dwordx4 v[72:75], v2, s[4:7], s42 offen offset:2048 sc1
    v_mfma_f32_16x16x32_bf16 v[132:135], v[32:35], v[164:167], v[132:135]
    ds_read_b64_tr_b16 v[62:63], v6 offset:21504
    v_mfma_f32_16x16x32_bf16 v[136:139], v[36:39], v[160:163], v[136:139]
    ds_read_b64_tr_b16 v[32:33], v3 offset:24576
    v_mfma_f32_16x16x32_bf16 v[140:143], v[36:39], v[164:167], v[140:143]
    ds_read_b64_tr_b16 v[34:35], v3 offset:25600
    s_waitcnt lgkmcnt(10)
    v_mfma_f32_16x16x32_bf16 v[144:147], v[40:43], v[160:163], v[144:147]
    buffer_load_dwordx4 v[76:79], v2, s[4:7], s42 offen offset:2304 sc1
    ds_read_b64_tr_b16 v[36:37], v4 offset:24576
    s_xor_b32 s42, s41, 40960
    v_mfma_f32_16x16x32_bf16 v[148:151], v[40:43], v[164:167], v[148:151]
    ds_read_b64_tr_b16 v[38:39], v4 offset:25600
    v_mfma_f32_16x16x32_bf16 v[152:155], v[44:47], v[160:163], v[152:155]
    ds_read_b64_tr_b16 v[40:41], v5 offset:24576
    v_mfma_f32_16x16x32_bf16 v[156:159], v[44:47], v[164:167], v[156:159]
    ds_read_b64_tr_b16 v[42:43], v5 offset:25600
    s_waitcnt vmcnt(8) lgkmcnt(10)
    v_mfma_f32_16x16x32_bf16 v[128:131], v[48:51], v[168:171], v[128:131]
    buffer_load_dwordx4 v[80:83], v2, s[4:7], s42 offen offset:2048 sc1
    ds_read_b64_tr_b16 v[44:45], v6 offset:24576
    v_mfma_f32_16x16x32_bf16 v[132:135], v[48:51], v[172:175], v[132:135]
    ds_read_b64_tr_b16 v[46:47], v6 offset:25600
    v_mfma_f32_16x16x32_bf16 v[136:139], v[52:55], v[168:171], v[136:139]
    ds_read_b64_tr_b16 v[48:49], v3 offset:28672
    v_mfma_f32_16x16x32_bf16 v[140:143], v[52:55], v[172:175], v[140:143]
    ds_read_b64_tr_b16 v[50:51], v3 offset:29696
    s_waitcnt lgkmcnt(10)
    v_mfma_f32_16x16x32_bf16 v[144:147], v[56:59], v[168:171], v[144:147]
    buffer_load_dwordx4 v[84:87], v2, s[4:7], s42 offen offset:2304 sc1
    ds_read_b64_tr_b16 v[52:53], v4 offset:28672
    s_xor_b32 s42, s41, 45056
    v_mfma_f32_16x16x32_bf16 v[148:151], v[56:59], v[172:175], v[148:151]
    ds_read_b64_tr_b16 v[54:55], v4 offset:29696
    v_mfma_f32_16x16x32_bf16 v[152:155], v[60:63], v[168:171], v[152:155]
    ds_read_b64_tr_b16 v[56:57], v5 offset:28672
    v_mfma_f32_16x16x32_bf16 v[156:159], v[60:63], v[172:175], v[156:159]
    ds_read_b64_tr_b16 v[58:59], v5 offset:29696
    s_waitcnt vmcnt(8) lgkmcnt(10)
    v_mfma_f32_16x16x32_bf16 v[128:131], v[32:35], v[176:179], v[128:131]
    ds_read_b64_tr_b16 v[60:61], v6 offset:28672
    buffer_load_dwordx4 v[88:91], v2, s[4:7], s42 offen offset:2048 sc1
    v_mfma_f32_16x16x32_bf16 v[132:135], v[32:35], v[180:183], v[132:135]
    ds_read_b64_tr_b16 v[62:63], v6 offset:29696
    v_mfma_f32_16x16x32_bf16 v[136:139], v[36:39], v[176:179], v[136:139]
    ds_read_b64_tr_b16 v[32:33], v3 offset:32768
    v_mfma_f32_16x16x32_bf16 v[140:143], v[36:39], v[180:183], v[140:143]
    ds_read_b64_tr_b16 v[34:35], v3 offset:33792
    s_waitcnt lgkmcnt(10)
    v_mfma_f32_16x16x32_bf16 v[144:147], v[40:43], v[176:179], v[144:147]
    buffer_load_dwordx4 v[92:95], v2, s[4:7], s42 offen offset:2304 sc1
    ds_read_b64_tr_b16 v[36:37], v4 offset:32768
    s_xor_b32 s42, s41, 49152
    v_mfma_f32_16x16x32_bf16 v[148:151], v[40:43], v[180:183], v[148:151]
    ds_read_b64_tr_b16 v[38:39], v4 offset:33792
    v_mfma_f32_16x16x32_bf16 v[152:155], v[44:47], v[176:179], v[152:155]
    ds_read_b64_tr_b16 v[40:41], v5 offset:32768
    v_mfma_f32_16x16x32_bf16 v[156:159], v[44:47], v[180:183], v[156:159]
    ds_read_b64_tr_b16 v[42:43], v5 offset:33792
    s_waitcnt vmcnt(8) lgkmcnt(10)
    v_mfma_f32_16x16x32_bf16 v[128:131], v[48:51], v[184:187], v[128:131]
    buffer_load_dwordx4 v[96:99], v2, s[4:7], s42 offen offset:2048 sc1
    ds_read_b64_tr_b16 v[44:45], v6 offset:32768
    v_mfma_f32_16x16x32_bf16 v[132:135], v[48:51], v[188:191], v[132:135]
    ds_read_b64_tr_b16 v[46:47], v6 offset:33792
    v_mfma_f32_16x16x32_bf16 v[136:139], v[52:55], v[184:187], v[136:139]
    ds_read_b64_tr_b16 v[48:49], v3 offset:36864
    v_mfma_f32_16x16x32_bf16 v[140:143], v[52:55], v[188:191], v[140:143]
    ds_read_b64_tr_b16 v[50:51], v3 offset:37888
    s_waitcnt lgkmcnt(10)
    v_mfma_f32_16x16x32_bf16 v[144:147], v[56:59], v[184:187], v[144:147]
    buffer_load_dwordx4 v[100:103], v2, s[4:7], s42 offen offset:2304 sc1
    ds_read_b64_tr_b16 v[52:53], v4 offset:36864
    s_xor_b32 s42, s41, 53248
    v_mfma_f32_16x16x32_bf16 v[148:151], v[56:59], v[188:191], v[148:151]
    ds_read_b64_tr_b16 v[54:55], v4 offset:37888
    v_mfma_f32_16x16x32_bf16 v[152:155], v[60:63], v[184:187], v[152:155]
    ds_read_b64_tr_b16 v[56:57], v5 offset:36864
    v_mfma_f32_16x16x32_bf16 v[156:159], v[60:63], v[188:191], v[156:159]
    ds_read_b64_tr_b16 v[58:59], v5 offset:37888
    s_waitcnt vmcnt(8) lgkmcnt(10)
    v_mfma_f32_16x16x32_bf16 v[128:131], v[32:35], v[64:67], v[128:131]
    ds_read_b64_tr_b16 v[60:61], v6 offset:36864
    buffer_load_dwordx4 v[104:107], v2, s[4:7], s42 offen offset:2048 sc1
    v_mfma_f32_16x16x32_bf16 v[132:135], v[32:35], v[68:71], v[132:135]
    ds_read_b64_tr_b16 v[62:63], v6 offset:37888
    v_mfma_f32_16x16x32_bf16 v[136:139], v[36:39], v[64:67], v[136:139]
    ds_read_b64_tr_b16 v[32:33], v3 offset:40960
    v_mfma_f32_16x16x32_bf16 v[140:143], v[36:39], v[68:71], v[140:143]
    ds_read_b64_tr_b16 v[34:35], v3 offset:41984
    s_waitcnt lgkmcnt(10)
    v_mfma_f32_16x16x32_bf16 v[144:147], v[40:43], v[64:67], v[144:147]
    buffer_load_dwordx4 v[108:111], v2, s[4:7], s42 offen offset:2304 sc1
    ds_read_b64_tr_b16 v[36:37], v4 offset:40960
    s_xor_b32 s42, s41, 57344
    v_mfma_f32_16x16x32_bf16 v[148:151], v[40:43], v[68:71], v[148:151]
    ds_read_b64_tr_b16 v[38:39], v4 offset:41984
    v_mfma_f32_16x16x32_bf16 v[152:155], v[44:47], v[64:67], v[152:155]
    ds_read_b64_tr_b16 v[40:41], v5 offset:40960
    v_mfma_f32_16x16x32_bf16 v[156:159], v[44:47], v[68:71], v[156:159]
    ds_read_b64_tr_b16 v[42:43], v5 offset:41984
    s_waitcnt vmcnt(8) lgkmcnt(10)
    v_mfma_f32_16x16x32_bf16 v[128:131], v[48:51], v[72:75], v[128:131]
    buffer_load_dwordx4 v[112:115], v2, s[4:7], s42 offen offset:2048 sc1
    ds_read_b64_tr_b16 v[44:45], v6 offset:40960
    v_mfma_f32_16x16x32_bf16 v[132:135], v[48:51], v[76:79], v[132:135]
    ds_read_b64_tr_b16 v[46:47], v6 offset:41984
    v_mfma_f32_16x16x32_bf16 v[136:139], v[52:55], v[72:75], v[136:139]
    ds_read_b64_tr_b16 v[48:49], v3 offset:45056
    v_mfma_f32_16x16x32_bf16 v[140:143], v[52:55], v[76:79], v[140:143]
    ds_read_b64_tr_b16 v[50:51], v3 offset:46080
    s_waitcnt lgkmcnt(10)
    v_mfma_f32_16x16x32_bf16 v[144:147], v[56:59], v[72:75], v[144:147]
    buffer_load_dwordx4 v[116:119], v2, s[4:7], s42 offen offset:2304 sc1
    ds_read_b64_tr_b16 v[52:53], v4 offset:45056
    s_xor_b32 s42, s41, 61440
    v_mfma_f32_16x16x32_bf16 v[148:151], v[56:59], v[76:79], v[148:151]
    ds_read_b64_tr_b16 v[54:55], v4 offset:46080
    v_mfma_f32_16x16x32_bf16 v[152:155], v[60:63], v[72:75], v[152:155]
    ds_read_b64_tr_b16 v[56:57], v5 offset:45056
    v_mfma_f32_16x16x32_bf16 v[156:159], v[60:63], v[76:79], v[156:159]
    ds_read_b64_tr_b16 v[58:59], v5 offset:46080
    s_waitcnt vmcnt(8) lgkmcnt(10)
    v_mfma_f32_16x16x32_bf16 v[128:131], v[32:35], v[80:83], v[128:131]
    ds_read_b64_tr_b16 v[60:61], v6 offset:45056
    buffer_load_dwordx4 v[120:123], v2, s[4:7], s42 offen offset:2048 sc1
    v_mfma_f32_16x16x32_bf16 v[132:135], v[32:35], v[84:87], v[132:135]
    ds_read_b64_tr_b16 v[62:63], v6 offset:46080
    v_mfma_f32_16x16x32_bf16 v[136:139], v[36:39], v[80:83], v[136:139]
    ds_read_b64_tr_b16 v[32:33], v3 offset:49152
    v_mfma_f32_16x16x32_bf16 v[140:143], v[36:39], v[84:87], v[140:143]
    ds_read_b64_tr_b16 v[34:35], v3 offset:50176
    s_waitcnt lgkmcnt(10)
    v_mfma_f32_16x16x32_bf16 v[144:147], v[40:43], v[80:83], v[144:147]
    buffer_load_dwordx4 v[124:127], v2, s[4:7], s42 offen offset:2304 sc1
    ds_read_b64_tr_b16 v[36:37], v4 offset:49152
    v_mfma_f32_16x16x32_bf16 v[148:151], v[40:43], v[84:87], v[148:151]
    ds_read_b64_tr_b16 v[38:39], v4 offset:50176
    v_mfma_f32_16x16x32_bf16 v[152:155], v[44:47], v[80:83], v[152:155]
    ds_read_b64_tr_b16 v[40:41], v5 offset:49152
    v_mfma_f32_16x16x32_bf16 v[156:159], v[44:47], v[84:87], v[156:159]
    ds_read_b64_tr_b16 v[42:43], v5 offset:50176
    s_waitcnt vmcnt(8) lgkmcnt(10)
    v_mfma_f32_16x16x32_bf16 v[128:131], v[48:51], v[88:91], v[128:131]
    ds_read_b64_tr_b16 v[44:45], v6 offset:49152
    v_mfma_f32_16x16x32_bf16 v[132:135], v[48:51], v[92:95], v[132:135]
    ds_read_b64_tr_b16 v[46:47], v6 offset:50176
    v_mfma_f32_16x16x32_bf16 v[136:139], v[52:55], v[88:91], v[136:139]
    ds_read_b64_tr_b16 v[48:49], v3 offset:53248
    v_mfma_f32_16x16x32_bf16 v[140:143], v[52:55], v[92:95], v[140:143]
    ds_read_b64_tr_b16 v[50:51], v3 offset:54272
    s_waitcnt lgkmcnt(10)
    v_mfma_f32_16x16x32_bf16 v[144:147], v[56:59], v[88:91], v[144:147]
    ds_read_b64_tr_b16 v[52:53], v4 offset:53248
    v_mfma_f32_16x16x32_bf16 v[148:151], v[56:59], v[92:95], v[148:151]
    ds_read_b64_tr_b16 v[54:55], v4 offset:54272
    v_mfma_f32_16x16x32_bf16 v[152:155], v[60:63], v[88:91], v[152:155]
    ds_read_b64_tr_b16 v[56:57], v5 offset:53248
    v_mfma_f32_16x16x32_bf16 v[156:159], v[60:63], v[92:95], v[156:159]
    ds_read_b64_tr_b16 v[58:59], v5 offset:54272
    s_waitcnt vmcnt(6) lgkmcnt(10)
    v_mfma_f32_16x16x32_bf16 v[128:131], v[32:35], v[96:99], v[128:131]
    ds_read_b64_tr_b16 v[60:61], v6 offset:53248
    v_mfma_f32_16x16x32_bf16 v[132:135], v[32:35], v[100:103], v[132:135]
    ds_read_b64_tr_b16 v[62:63], v6 offset:54272
    v_mfma_f32_16x16x32_bf16 v[136:139], v[36:39], v[96:99], v[136:139]
    ds_read_b64_tr_b16 v[32:33], v3 offset:57344
    v_mfma_f32_16x16x32_bf16 v[140:143], v[36:39], v[100:103], v[140:143]
    ds_read_b64_tr_b16 v[34:35], v3 offset:58368
    s_waitcnt lgkmcnt(10)
    v_mfma_f32_16x16x32_bf16 v[144:147], v[40:43], v[96:99], v[144:147]
    ds_read_b64_tr_b16 v[36:37], v4 offset:57344
    v_mfma_f32_16x16x32_bf16 v[148:151], v[40:43], v[100:103], v[148:151]
    ds_read_b64_tr_b16 v[38:39], v4 offset:58368
    v_mfma_f32_16x16x32_bf16 v[152:155], v[44:47], v[96:99], v[152:155]
    ds_read_b64_tr_b16 v[40:41], v5 offset:57344
    v_mfma_f32_16x16x32_bf16 v[156:159], v[44:47], v[100:103], v[156:159]
    ds_read_b64_tr_b16 v[42:43], v5 offset:58368
    s_waitcnt vmcnt(4) lgkmcnt(10)
    v_mfma_f32_16x16x32_bf16 v[128:131], v[48:51], v[104:107], v[128:131]
    ds_read_b64_tr_b16 v[44:45], v6 offset:57344
    v_mfma_f32_16x16x32_bf16 v[132:135], v[48:51], v[108:111], v[132:135]
    ds_read_b64_tr_b16 v[46:47], v6 offset:58368
    v_mfma_f32_16x16x32_bf16 v[136:139], v[52:55], v[104:107], v[136:139]
    ds_read_b64_tr_b16 v[48:49], v3 offset:61440
    v_mfma_f32_16x16x32_bf16 v[140:143], v[52:55], v[108:111], v[140:143]
    ds_read_b64_tr_b16 v[50:51], v3 offset:62464
    s_waitcnt lgkmcnt(10)
    v_mfma_f32_16x16x32_bf16 v[144:147], v[56:59], v[104:107], v[144:147]
    ds_read_b64_tr_b16 v[52:53], v4 offset:61440
    v_mfma_f32_16x16x32_bf16 v[148:151], v[56:59], v[108:111], v[148:151]
    ds_read_b64_tr_b16 v[54:55], v4 offset:62464
    v_mfma_f32_16x16x32_bf16 v[152:155], v[60:63], v[104:107], v[152:155]
    ds_read_b64_tr_b16 v[56:57], v5 offset:61440
    v_mfma_f32_16x16x32_bf16 v[156:159], v[60:63], v[108:111], v[156:159]
    ds_read_b64_tr_b16 v[58:59], v5 offset:62464
    s_waitcnt vmcnt(2) lgkmcnt(10)
    v_mfma_f32_16x16x32_bf16 v[128:131], v[32:35], v[112:115], v[128:131]
    ds_read_b64_tr_b16 v[60:61], v6 offset:61440
    v_mfma_f32_16x16x32_bf16 v[132:135], v[32:35], v[116:119], v[132:135]
    ds_read_b64_tr_b16 v[62:63], v6 offset:62464
    v_xor_b32 v3, 0x10000, v3
    v_xor_b32 v4, 0x10000, v4
    v_xor_b32 v5, 0x10000, v5
    v_xor_b32 v6, 0x10000, v6
    v_mfma_f32_16x16x32_bf16 v[136:139], v[36:39], v[112:115], v[136:139]
    v_mfma_f32_16x16x32_bf16 v[140:143], v[36:39], v[116:119], v[140:143]
    s_waitcnt lgkmcnt(8)
    v_mfma_f32_16x16x32_bf16 v[144:147], v[40:43], v[112:115], v[144:147]
    v_mfma_f32_16x16x32_bf16 v[148:151], v[40:43], v[116:119], v[148:151]
    v_mfma_f32_16x16x32_bf16 v[152:155], v[44:47], v[112:115], v[152:155]
    v_mfma_f32_16x16x32_bf16 v[156:159], v[44:47], v[116:119], v[156:159]
    s_waitcnt vmcnt(0) lgkmcnt(4)
    v_mfma_f32_16x16x32_bf16 v[128:131], v[48:51], v[120:123], v[128:131]
    v_mfma_f32_16x16x32_bf16 v[132:135], v[48:51], v[124:127], v[132:135]
    v_mfma_f32_16x16x32_bf16 v[136:139], v[52:55], v[120:123], v[136:139]
    v_mfma_f32_16x16x32_bf16 v[140:143], v[52:55], v[124:127], v[140:143]
    s_waitcnt lgkmcnt(0)
    v_mfma_f32_16x16x32_bf16 v[144:147], v[56:59], v[120:123], v[144:147]
    v_mfma_f32_16x16x32_bf16 v[148:151], v[56:59], v[124:127], v[148:151]
    v_mfma_f32_16x16x32_bf16 v[152:155], v[60:63], v[120:123], v[152:155]
    v_mfma_f32_16x16x32_bf16 v[156:159], v[60:63], v[124:127], v[156:159]
    s_cmp_eq_u32 s21, 3
    s_cbranch_scc1 c_final
    s_add_u32 s43, s43, 4194304
    v_cvt_pk_bf16_f32 v160, v128, v129
    v_cvt_pk_bf16_f32 v161, v130, v131
    v_cvt_pk_bf16_f32 v162, v136, v137
    v_cvt_pk_bf16_f32 v163, v138, v139
    v_cvt_pk_bf16_f32 v168, v144, v145
    v_cvt_pk_bf16_f32 v169, v146, v147
    v_cvt_pk_bf16_f32 v170, v152, v153
    v_cvt_pk_bf16_f32 v171, v154, v155
    v_permlane32_swap_b32 v160, v162
    v_permlane32_swap_b32 v161, v163
    buffer_store_dwordx4 v[160:163], v2, s[4:7], s43 offen offset:0 sc1
    v_permlane32_swap_b32 v168, v170
    v_permlane32_swap_b32 v169, v171
    buffer_store_dwordx4 v[168:171], v2, s[4:7], s43 offen offset:2048 sc1
    v_cvt_pk_bf16_f32 v164, v132, v133
    v_cvt_pk_bf16_f32 v165, v134, v135
    v_cvt_pk_bf16_f32 v166, v140, v141
    v_cvt_pk_bf16_f32 v167, v142, v143
    v_cvt_pk_bf16_f32 v172, v148, v149
    v_cvt_pk_bf16_f32 v173, v150, v151
    v_cvt_pk_bf16_f32 v174, v156, v157
    v_cvt_pk_bf16_f32 v175, v158, v159
    v_permlane32_swap_b32 v164, v166
    v_permlane32_swap_b32 v165, v167
    buffer_store_dwordx4 v[164:167], v2, s[4:7], s43 offen offset:256 sc1
    v_permlane32_swap_b32 v172, v174
    v_permlane32_swap_b32 v173, v175
    buffer_store_dwordx4 v[172:175], v2, s[4:7], s43 offen offset:2304 sc1
    s_barrier
    v_mov_b32 v12, 0x3f803f80
    v_mov_b32 v14, 0
    v_mov_b32 v15, 0
    v_mov_b32 v16, 0
    v_mov_b32 v17, 0
    v_dot2_f32_bf16 v14, v160, v12, v14
    v_dot2_f32_bf16 v15, v160, v160, v15
    v_dot2_f32_bf16 v16, v164, v12, v16
    v_dot2_f32_bf16 v17, v164, v164, v17
    v_dot2_f32_bf16 v14, v161, v12, v14
    v_dot2_f32_bf16 v15, v161, v161, v15
    v_dot2_f32_bf16 v16, v165, v12, v16
    v_dot2_f32_bf16 v17, v165, v165, v17
    v_dot2_f32_bf16 v14, v162, v12, v14
    v_dot2_f32_bf16 v15, v162, v162, v15
    v_dot2_f32_bf16 v16, v166, v12, v16
    v_dot2_f32_bf16 v17, v166, v166, v17
    v_dot2_f32_bf16 v14, v163, v12, v14
    v_dot2_f32_bf16 v15, v163, v163, v15
    v_dot2_f32_bf16 v16, v167, v12, v16
    v_dot2_f32_bf16 v17, v167, v167, v17
    v_dot2_f32_bf16 v14, v168, v12, v14
    v_dot2_f32_bf16 v15, v168, v168, v15
    v_dot2_f32_bf16 v16, v172, v12, v16
    v_dot2_f32_bf16 v17, v172, v172, v17
    v_dot2_f32_bf16 v14, v169, v12, v14
    v_dot2_f32_bf16 v15, v169, v169, v15
    v_dot2_f32_bf16 v16, v173, v12, v16
    v_dot2_f32_bf16 v17, v173, v173, v17
    v_dot2_f32_bf16 v14, v170, v12, v14
    v_dot2_f32_bf16 v15, v170, v170, v15
    v_dot2_f32_bf16 v16, v174, v12, v16
    v_dot2_f32_bf16 v17, v174, v174, v17
    v_dot2_f32_bf16 v14, v171, v12, v14
    v_dot2_f32_bf16 v15, v171, v171, v15
    v_dot2_f32_bf16 v16, v175, v12, v16
    v_dot2_f32_bf16 v17, v175, v175, v17
    s_nop 2
    v_permlane16_swap_b32 v14, v16
    v_permlane16_swap_b32 v15, v17
    v_pk_add_f32 v[14:15], v[14:15], v[16:17]
    v_mov_b32 v16, v14
    v_mov_b32 v17, v15
    s_nop 0
    v_permlane32_swap_b32 v14, v16
    v_permlane32_swap_b32 v15, v17
    v_pk_add_f32 v[14:15], v[14:15], v[16:17]
    v_lshrrev_b32 v13, 1, v1
    v_and_b32 v13, 0xf8, v13
    s_add_u32 s21, s21, 1
    s_lshl_b32 s44, s21, 18
    s_lshl_b32 s45, s38, 12
    s_add_u32 s44, s44, s45
    s_lshl_b32 s45, s18, 8
    s_add_u32 s44, s44, s45
    s_add_u32 s44, s44, 50331648
    buffer_store_dwordx2 v[14:15], v13, s[4:7], s44 offen sc1
    s_lshl_b32 s46, s21, 14
    s_lshl_b32 s67, s38, 7
    s_add_u32 s46, s46, s67
    s_add_u32 s46, s46, 4096
    s_add_u32 s47, s46, 8192
    s_waitcnt vmcnt(1)
    s_atomic_add s40, s[22:23], s46
    s_branch c_layer
c_final:
    s_mov_b32 s8, s32
    s_mov_b32 s9, s33
    s_mov_b32 s10, 4194304
    s_mov_b32 s11, 0x00020000
    v_lshrrev_b32 v12, 4, v1
    s_mul_i32 s44, s16, 4608
    s_add_u32 s44, s44, 131072
    v_and_b32 v13, 15, v12
    v_mul_u32_u24 v13, 144, v13
    v_lshrrev_b32 v14, 4, v12
    v_lshl_add_u32 v13, v14, 3, v13
    v_add_u32 v13, s44, v13
    v_cvt_pk_bf16_f32 v128, v128, v129
    v_cvt_pk_bf16_f32 v129, v130, v131
    ds_write_b64 v13, v[128:129] offset:0
    v_cvt_pk_bf16_f32 v136, v136, v137
    v_cvt_pk_bf16_f32 v137, v138, v139
    ds_write_b64 v13, v[136:137] offset:32
    v_cvt_pk_bf16_f32 v144, v144, v145
    v_cvt_pk_bf16_f32 v145, v146, v147
    ds_write_b64 v13, v[144:145] offset:64
    v_cvt_pk_bf16_f32 v152, v152, v153
    v_cvt_pk_bf16_f32 v153, v154, v155
    ds_write_b64 v13, v[152:153] offset:96
    v_cvt_pk_bf16_f32 v132, v132, v133
    v_cvt_pk_bf16_f32 v133, v134, v135
    ds_write_b64 v13, v[132:133] offset:2304
    v_cvt_pk_bf16_f32 v140, v140, v141
    v_cvt_pk_bf16_f32 v141, v142, v143
    ds_write_b64 v13, v[140:141] offset:2336
    v_cvt_pk_bf16_f32 v148, v148, v149
    v_cvt_pk_bf16_f32 v149, v150, v151
    ds_write_b64 v13, v[148:149] offset:2368
    v_cvt_pk_bf16_f32 v156, v156, v157
    v_cvt_pk_bf16_f32 v157, v158, v159
    ds_write_b64 v13, v[156:157] offset:2400
    v_lshrrev_b32 v14, 3, v12
    v_and_b32 v15, 7, v12
    v_mul_u32_u24 v16, 144, v14
    v_lshl_add_u32 v16, v15, 4, v16
    v_add_u32 v16, s44, v16
    v_lshlrev_b32 v17, 11, v14
    v_lshl_add_u32 v17, v15, 4, v17
    ds_read_b128 v[32:35], v16 offset:0
    ds_read_b128 v[36:39], v16 offset:1152
    ds_read_b128 v[40:43], v16 offset:2304
    ds_read_b128 v[44:47], v16 offset:3456
    s_lshl_b32 s44, s38, 16
    s_lshl_b32 s45, s18, 7
    s_add_u32 s44, s44, s45
    s_waitcnt lgkmcnt(3)
    buffer_store_dwordx4 v[32:35], v17, s[8:11], s44 offen sc1
    s_add_u32 s44, s44, 16384
    s_waitcnt lgkmcnt(2)
    buffer_store_dwordx4 v[36:39], v17, s[8:11], s44 offen sc1
    s_add_u32 s44, s44, 16384
    s_waitcnt lgkmcnt(1)
    buffer_store_dwordx4 v[40:43], v17, s[8:11], s44 offen sc1
    s_add_u32 s44, s44, 16384
    s_waitcnt lgkmcnt(0)
    buffer_store_dwordx4 v[44:47], v17, s[8:11], s44 offen sc1
    s_endpgm
s_start:
    v_mov_b32 v14, 0
    v_mov_b32 v15, 0
    v_mov_b32 v20, 0
    v_mov_b32 v21, 0
    v_mov_b32 v22, 0
    s_mov_b32 s41, 0
    s_mov_b32 s42, 0
    s_mov_b32 s43, 0
    s_mov_b32 s62, 0
    s_cmp_eq_u32 s16, 4
    s_cbranch_scc1 h_start
    s_cmp_eq_u32 s16, 7
    s_cbranch_scc1 z_start
l_start:
    v_lshrrev_b32 v24, 4, v1
    v_lshrrev_b32 v25, 3, v24
    v_mul_u32_u24 v12, 6144, v25
    v_and_b32 v26, 2, v25
    v_lshrrev_b32 v25, 2, v25
    v_or_b32 v26, v26, v25
    v_bfe_u32 v25, v24, 1, 2
    v_xor_b32 v26, v26, v25
    v_lshl_add_u32 v12, v26, 5, v12
    v_and_b32 v26, 1, v24
    v_lshl_add_u32 v12, v26, 4, v12
    s_lshl_b32 s3, s18, 7
    v_add_u32 v12, s3, v12
    v_add_u32 v13, 48128, v12
    s_mul_i32 s84, s18, 393216
    s_cmp_eq_u32 s18, 1
    s_cselect_b32 s85, 0, 393216
    s_sub_u32 s3, s16, 5
    s_lshl_b32 s41, s3, 11
    s_mul_i32 s42, s3, 98304
    s_lshl_b32 s62, s3, 15
    v_add_u32 v14, s42, v12
    v_add_u32 v15, s42, v13
    s_bitcmp1_b32 s21, 0
    s_cselect_b32 s8, s28, s24
    s_cselect_b32 s9, s29, s25
    s_cselect_b32 s12, s30, s26
    s_cselect_b32 s13, s31, s27
    s_mov_b32 s10, 6291456
    s_mov_b32 s11, 0x00020000
    s_mov_b32 s14, 2097152
    s_mov_b32 s15, 0x00020000
    s_add_u32 m0, s41, 0
    s_add_u32 s44, s84, 2048
    buffer_load_dwordx4 v14, s[8:11], s44 offen offset:0 lds
    buffer_load_dwordx4 v15, s[8:11], s44 offen offset:1024 lds
    s_add_u32 m0, s41, 4096
    s_add_u32 s44, s84, 4096
    buffer_load_dwordx4 v14, s[8:11], s44 offen offset:0 lds
    buffer_load_dwordx4 v15, s[8:11], s44 offen offset:1024 lds
    s_add_u32 m0, s41, 8192
    s_add_u32 s44, s84, 0
    buffer_load_dwordx4 v14, s[8:11], s44 offen offset:0 lds
    buffer_load_dwordx4 v15, s[8:11], s44 offen offset:1024 lds
    s_add_u32 m0, s41, 12288
    s_add_u32 s44, s84, 198656
    buffer_load_dwordx4 v14, s[8:11], s44 offen offset:0 lds
    buffer_load_dwordx4 v15, s[8:11], s44 offen offset:1024 lds
    s_add_u32 m0, s41, 16384
    s_add_u32 s44, s84, 200704
    buffer_load_dwordx4 v14, s[8:11], s44 offen offset:0 lds
    buffer_load_dwordx4 v15, s[8:11], s44 offen offset:1024 lds
    s_add_u32 m0, s41, 20480
    s_add_u32 s44, s84, 196608
    buffer_load_dwordx4 v14, s[8:11], s44 offen offset:0 lds
    buffer_load_dwordx4 v15, s[8:11], s44 offen offset:1024 lds
    s_add_u32 m0, s41, 24576
    s_add_u32 s44, s85, 2048
    buffer_load_dwordx4 v14, s[8:11], s44 offen offset:0 lds
    buffer_load_dwordx4 v15, s[8:11], s44 offen offset:1024 lds
    s_add_u32 m0, s41, 28672
    s_add_u32 s44, s85, 4096
    buffer_load_dwordx4 v14, s[8:11], s44 offen offset:0 lds
    buffer_load_dwordx4 v15, s[8:11], s44 offen offset:1024 lds
    s_cmp_eq_u32 s18, 2
    s_cselect_b32 s86, 0, 786432
    s_cmp_eq_u32 s18, 3
    s_cselect_b32 s87, 0, 1179648
    s_cmp_eq_u32 s18, 4
    s_cselect_b32 s88, 0, 1572864
    s_cmp_eq_u32 s18, 5
    s_cselect_b32 s89, 0, 1966080
    s_cmp_eq_u32 s18, 6
    s_cselect_b32 s90, 0, 2359296
    s_cmp_eq_u32 s18, 7
    s_cselect_b32 s91, 0, 2752512
    s_cmp_eq_u32 s18, 8
    s_cselect_b32 s92, 0, 3145728
    s_cmp_eq_u32 s18, 9
    s_cselect_b32 s93, 0, 3538944
    s_cmp_eq_u32 s18, 10
    s_cselect_b32 s94, 0, 3932160
    s_cmp_eq_u32 s18, 11
    s_cselect_b32 s95, 0, 4325376
    s_cmp_eq_u32 s18, 12
    s_cselect_b32 s96, 0, 4718592
    s_cmp_eq_u32 s18, 13
    s_cselect_b32 s97, 0, 5111808
    s_cmp_eq_u32 s18, 14
    s_cselect_b32 s98, 0, 5505024
    s_cmp_eq_u32 s18, 15
    s_cselect_b32 s99, 0, 5898240
    v_lshrrev_b32 v24, 4, v1
    v_lshrrev_b32 v25, 3, v24
    v_mul_u32_u24 v16, 2048, v25
    v_and_b32 v26, 2, v25
    v_lshrrev_b32 v25, 2, v25
    v_or_b32 v26, v26, v25
    v_bfe_u32 v25, v24, 1, 2
    v_xor_b32 v26, v26, v25
    v_lshl_add_u32 v16, v26, 5, v16
    v_and_b32 v26, 1, v24
    v_lshl_add_u32 v16, v26, 4, v16
    s_lshl_b32 s3, s18, 7
    v_add_u32 v16, s3, v16
    v_add_u32 v17, 15360, v16
    v_add_u32 v18, 30720, v16
    v_add_u32 v19, 46080, v16
    s_and_b32 s3, s16, 3
    s_mul_i32 s3, s3, 49152
    v_add_u32 v11, s3, v12
    s_and_b32 s3, s16, 3
    s_lshl_b32 s3, s3, 10
    v_add_u32 v9, s3, v1
    v_add_u32 v10, 0x10000, v9
    s_waitcnt vmcnt(0)
    s_barrier
    s_add_u32 m0, s41, 32768
    s_add_u32 s44, s85, 0
    buffer_load_dwordx4 v14, s[8:11], s44 offen offset:0 lds
    buffer_load_dwordx4 v15, s[8:11], s44 offen offset:1024 lds
    s_add_u32 m0, s41, 36864
    s_add_u32 s44, s85, 198656
    buffer_load_dwordx4 v14, s[8:11], s44 offen offset:0 lds
    buffer_load_dwordx4 v15, s[8:11], s44 offen offset:1024 lds
    s_add_u32 m0, s41, 40960
    s_add_u32 s44, s85, 200704
    buffer_load_dwordx4 v14, s[8:11], s44 offen offset:0 lds
    buffer_load_dwordx4 v15, s[8:11], s44 offen offset:1024 lds
    s_add_u32 m0, s41, 45056
    s_add_u32 s44, s85, 196608
    buffer_load_dwordx4 v14, s[8:11], s44 offen offset:0 lds
    buffer_load_dwordx4 v15, s[8:11], s44 offen offset:1024 lds
    s_add_u32 m0, s41, 49152
    s_add_u32 s44, s86, 2048
    buffer_load_dwordx4 v14, s[8:11], s44 offen offset:0 lds
    buffer_load_dwordx4 v15, s[8:11], s44 offen offset:1024 lds
    s_add_u32 m0, s41, 53248
    s_add_u32 s44, s86, 4096
    buffer_load_dwordx4 v14, s[8:11], s44 offen offset:0 lds
    buffer_load_dwordx4 v15, s[8:11], s44 offen offset:1024 lds
    s_add_u32 m0, s41, 57344
    s_add_u32 s44, s86, 0
    buffer_load_dwordx4 v14, s[8:11], s44 offen offset:0 lds
    buffer_load_dwordx4 v15, s[8:11], s44 offen offset:1024 lds
    s_add_u32 m0, s41, 61440
    s_add_u32 s44, s86, 198656
    buffer_load_dwordx4 v14, s[8:11], s44 offen offset:0 lds
    buffer_load_dwordx4 v15, s[8:11], s44 offen offset:1024 lds
    s_waitcnt vmcnt(0)
    s_barrier
    s_add_u32 m0, s41, 65536
    s_add_u32 s44, s86, 200704
    buffer_load_dwordx4 v14, s[8:11], s44 offen offset:0 lds
    buffer_load_dwordx4 v15, s[8:11], s44 offen offset:1024 lds
    s_add_u32 m0, s41, 69632
    s_add_u32 s44, s86, 196608
    buffer_load_dwordx4 v14, s[8:11], s44 offen offset:0 lds
    buffer_load_dwordx4 v15, s[8:11], s44 offen offset:1024 lds
    s_add_u32 m0, s41, 73728
    s_add_u32 s44, s87, 2048
    buffer_load_dwordx4 v14, s[8:11], s44 offen offset:0 lds
    buffer_load_dwordx4 v15, s[8:11], s44 offen offset:1024 lds
    s_add_u32 m0, s41, 77824
    s_add_u32 s44, s87, 4096
    buffer_load_dwordx4 v14, s[8:11], s44 offen offset:0 lds
    buffer_load_dwordx4 v15, s[8:11], s44 offen offset:1024 lds
    s_add_u32 m0, s41, 81920
    s_add_u32 s44, s87, 0
    buffer_load_dwordx4 v14, s[8:11], s44 offen offset:0 lds
    buffer_load_dwordx4 v15, s[8:11], s44 offen offset:1024 lds
    s_add_u32 m0, s41, 86016
    s_add_u32 s44, s87, 198656
    buffer_load_dwordx4 v14, s[8:11], s44 offen offset:0 lds
    buffer_load_dwordx4 v15, s[8:11], s44 offen offset:1024 lds
    s_add_u32 m0, s41, 90112
    s_add_u32 s44, s87, 200704
    buffer_load_dwordx4 v14, s[8:11], s44 offen offset:0 lds
    buffer_load_dwordx4 v15, s[8:11], s44 offen offset:1024 lds
    s_add_u32 m0, s41, 94208
    s_add_u32 s44, s87, 196608
    buffer_load_dwordx4 v14, s[8:11], s44 offen offset:0 lds
    buffer_load_dwordx4 v15, s[8:11], s44 offen offset:1024 lds
    s_add_u32 m0, s41, 98304
    s_add_u32 s44, s88, 2048
    buffer_load_dwordx4 v14, s[8:11], s44 offen offset:0 lds
    buffer_load_dwordx4 v15, s[8:11], s44 offen offset:1024 lds
    s_add_u32 m0, s41, 102400
    s_add_u32 s44, s88, 4096
    buffer_load_dwordx4 v14, s[8:11], s44 offen offset:0 lds
    buffer_load_dwordx4 v15, s[8:11], s44 offen offset:1024 lds
    s_add_u32 m0, s41, 106496
    s_add_u32 s44, s88, 0
    buffer_load_dwordx4 v14, s[8:11], s44 offen offset:0 lds
    buffer_load_dwordx4 v15, s[8:11], s44 offen offset:1024 lds
    s_add_u32 m0, s41, 110592
    s_add_u32 s44, s88, 198656
    buffer_load_dwordx4 v14, s[8:11], s44 offen offset:0 lds
    buffer_load_dwordx4 v15, s[8:11], s44 offen offset:1024 lds
    s_add_u32 m0, s41, 114688
    s_add_u32 s44, s88, 200704
    buffer_load_dwordx4 v14, s[8:11], s44 offen offset:0 lds
    buffer_load_dwordx4 v15, s[8:11], s44 offen offset:1024 lds
    s_add_u32 m0, s41, 118784
    s_add_u32 s44, s88, 196608
    buffer_load_dwordx4 v14, s[8:11], s44 offen offset:0 lds
    buffer_load_dwordx4 v15, s[8:11], s44 offen offset:1024 lds
    s_add_u32 m0, s41, 122880
    s_add_u32 s44, s89, 2048
    buffer_load_dwordx4 v14, s[8:11], s44 offen offset:0 lds
    buffer_load_dwordx4 v15, s[8:11], s44 offen offset:1024 lds
    s_add_u32 m0, s41, 126976
    s_add_u32 s44, s89, 4096
    buffer_load_dwordx4 v14, s[8:11], s44 offen offset:0 lds
    buffer_load_dwordx4 v15, s[8:11], s44 offen offset:1024 lds
    s_add_u32 m0, s41, 0
    s_add_u32 s44, s89, 0
    buffer_load_dwordx4 v14, s[8:11], s44 offen offset:0 lds
    buffer_load_dwordx4 v15, s[8:11], s44 offen offset:1024 lds
    s_add_u32 m0, s41, 4096
    s_add_u32 s44, s89, 198656
    buffer_load_dwordx4 v14, s[8:11], s44 offen offset:0 lds
    buffer_load_dwordx4 v15, s[8:11], s44 offen offset:1024 lds
    s_add_u32 m0, s41, 8192
    s_add_u32 s44, s89, 200704
    buffer_load_dwordx4 v14, s[8:11], s44 offen offset:0 lds
    buffer_load_dwordx4 v15, s[8:11], s44 offen offset:1024 lds
    s_add_u32 m0, s41, 12288
    s_add_u32 s44, s89, 196608
    buffer_load_dwordx4 v14, s[8:11], s44 offen offset:0 lds
    buffer_load_dwordx4 v15, s[8:11], s44 offen offset:1024 lds
    s_waitcnt vmcnt(24)
    s_branch l_join
l_layer:
    s_waitcnt lgkmcnt(0)
    s_barrier
    s_add_u32 m0, s41, 0
    s_add_u32 s44, s89, 0
    buffer_load_dwordx4 v14, s[8:11], s44 offen offset:0 lds
    buffer_load_dwordx4 v15, s[8:11], s44 offen offset:1024 lds
    s_add_u32 m0, s41, 4096
    s_add_u32 s44, s89, 198656
    buffer_load_dwordx4 v14, s[8:11], s44 offen offset:0 lds
    buffer_load_dwordx4 v15, s[8:11], s44 offen offset:1024 lds
    s_add_u32 m0, s41, 8192
    s_add_u32 s44, s89, 200704
    buffer_load_dwordx4 v14, s[8:11], s44 offen offset:0 lds
    buffer_load_dwordx4 v15, s[8:11], s44 offen offset:1024 lds
    s_add_u32 m0, s41, 12288
    s_add_u32 s44, s89, 196608
    buffer_load_dwordx4 v14, s[8:11], s44 offen offset:0 lds
    buffer_load_dwordx4 v15, s[8:11], s44 offen offset:1024 lds
l_join:
    s_barrier
    s_add_u32 m0, s41, 16384
    s_add_u32 s44, s90, 2048
    buffer_load_dwordx4 v14, s[8:11], s44 offen offset:0 lds
    buffer_load_dwordx4 v15, s[8:11], s44 offen offset:1024 lds
    s_add_u32 m0, s41, 20480
    s_add_u32 s44, s90, 4096
    buffer_load_dwordx4 v14, s[8:11], s44 offen offset:0 lds
    buffer_load_dwordx4 v15, s[8:11], s44 offen offset:1024 lds
    s_add_u32 m0, s41, 24576
    s_add_u32 s44, s90, 0
    buffer_load_dwordx4 v14, s[8:11], s44 offen offset:0 lds
    buffer_load_dwordx4 v15, s[8:11], s44 offen offset:1024 lds
    s_add_u32 m0, s41, 28672
    s_add_u32 s44, s90, 198656
    buffer_load_dwordx4 v14, s[8:11], s44 offen offset:0 lds
    buffer_load_dwordx4 v15, s[8:11], s44 offen offset:1024 lds
    s_add_u32 m0, s41, 32768
    s_add_u32 s44, s90, 200704
    buffer_load_dwordx4 v14, s[8:11], s44 offen offset:0 lds
    buffer_load_dwordx4 v15, s[8:11], s44 offen offset:1024 lds
    s_add_u32 m0, s41, 36864
    s_add_u32 s44, s90, 196608
    buffer_load_dwordx4 v14, s[8:11], s44 offen offset:0 lds
    buffer_load_dwordx4 v15, s[8:11], s44 offen offset:1024 lds
    s_add_u32 m0, s41, 40960
    s_add_u32 s44, s91, 2048
    buffer_load_dwordx4 v14, s[8:11], s44 offen offset:0 lds
    buffer_load_dwordx4 v15, s[8:11], s44 offen offset:1024 lds
    s_add_u32 m0, s41, 45056
    s_add_u32 s44, s91, 4096
    buffer_load_dwordx4 v14, s[8:11], s44 offen offset:0 lds
    buffer_load_dwordx4 v15, s[8:11], s44 offen offset:1024 lds
    s_waitcnt vmcnt(24)
    s_barrier
    s_add_u32 m0, s41, 49152
    s_add_u32 s44, s91, 0
    buffer_load_dwordx4 v14, s[8:11], s44 offen offset:0 lds
    buffer_load_dwordx4 v15, s[8:11], s44 offen offset:1024 lds
    s_add_u32 m0, s41, 53248
    s_add_u32 s44, s91, 198656
    buffer_load_dwordx4 v14, s[8:11], s44 offen offset:0 lds
    buffer_load_dwordx4 v15, s[8:11], s44 offen offset:1024 lds
    s_add_u32 m0, s41, 57344
    s_add_u32 s44, s91, 200704
    buffer_load_dwordx4 v14, s[8:11], s44 offen offset:0 lds
    buffer_load_dwordx4 v15, s[8:11], s44 offen offset:1024 lds
    s_add_u32 m0, s41, 61440
    s_add_u32 s44, s91, 196608
    buffer_load_dwordx4 v14, s[8:11], s44 offen offset:0 lds
    buffer_load_dwordx4 v15, s[8:11], s44 offen offset:1024 lds
    s_waitcnt vmcnt(16)
    s_barrier
    s_add_u32 m0, s41, 65536
    s_add_u32 s44, s92, 2048
    buffer_load_dwordx4 v14, s[8:11], s44 offen offset:0 lds
    buffer_load_dwordx4 v15, s[8:11], s44 offen offset:1024 lds
    s_add_u32 m0, s41, 69632
    s_add_u32 s44, s92, 4096
    buffer_load_dwordx4 v14, s[8:11], s44 offen offset:0 lds
    buffer_load_dwordx4 v15, s[8:11], s44 offen offset:1024 lds
    s_add_u32 m0, s41, 73728
    s_add_u32 s44, s92, 0
    buffer_load_dwordx4 v14, s[8:11], s44 offen offset:0 lds
    buffer_load_dwordx4 v15, s[8:11], s44 offen offset:1024 lds
    s_add_u32 m0, s41, 77824
    s_add_u32 s44, s92, 198656
    buffer_load_dwordx4 v14, s[8:11], s44 offen offset:0 lds
    buffer_load_dwordx4 v15, s[8:11], s44 offen offset:1024 lds
    s_add_u32 m0, s41, 81920
    s_add_u32 s44, s92, 200704
    buffer_load_dwordx4 v14, s[8:11], s44 offen offset:0 lds
    buffer_load_dwordx4 v15, s[8:11], s44 offen offset:1024 lds
    s_add_u32 m0, s41, 86016
    s_add_u32 s44, s92, 196608
    buffer_load_dwordx4 v14, s[8:11], s44 offen offset:0 lds
    buffer_load_dwordx4 v15, s[8:11], s44 offen offset:1024 lds
    s_add_u32 m0, s41, 90112
    s_add_u32 s44, s93, 2048
    buffer_load_dwordx4 v14, s[8:11], s44 offen offset:0 lds
    buffer_load_dwordx4 v15, s[8:11], s44 offen offset:1024 lds
    s_add_u32 m0, s41, 94208
    s_add_u32 s44, s93, 4096
    buffer_load_dwordx4 v14, s[8:11], s44 offen offset:0 lds
    buffer_load_dwordx4 v15, s[8:11], s44 offen offset:1024 lds
    s_waitcnt vmcnt(16)
    s_barrier
    s_add_u32 m0, s41, 98304
    s_add_u32 s44, s93, 0
    buffer_load_dwordx4 v14, s[8:11], s44 offen offset:0 lds
    buffer_load_dwordx4 v15, s[8:11], s44 offen offset:1024 lds
    s_add_u32 m0, s41, 102400
    s_add_u32 s44, s93, 198656
    buffer_load_dwordx4 v14, s[8:11], s44 offen offset:0 lds
    buffer_load_dwordx4 v15, s[8:11], s44 offen offset:1024 lds
    s_add_u32 m0, s41, 106496
    s_add_u32 s44, s93, 200704
    buffer_load_dwordx4 v14, s[8:11], s44 offen offset:0 lds
    buffer_load_dwordx4 v15, s[8:11], s44 offen offset:1024 lds
    s_add_u32 m0, s41, 110592
    s_add_u32 s44, s93, 196608
    buffer_load_dwordx4 v14, s[8:11], s44 offen offset:0 lds
    buffer_load_dwordx4 v15, s[8:11], s44 offen offset:1024 lds
    s_add_u32 m0, s41, 114688
    s_add_u32 s44, s94, 2048
    buffer_load_dwordx4 v14, s[8:11], s44 offen offset:0 lds
    buffer_load_dwordx4 v15, s[8:11], s44 offen offset:1024 lds
    s_add_u32 m0, s41, 118784
    s_add_u32 s44, s94, 4096
    buffer_load_dwordx4 v14, s[8:11], s44 offen offset:0 lds
    buffer_load_dwordx4 v15, s[8:11], s44 offen offset:1024 lds
    s_add_u32 m0, s41, 122880
    s_add_u32 s44, s94, 198656
    buffer_load_dwordx4 v14, s[8:11], s44 offen offset:0 lds
    buffer_load_dwordx4 v15, s[8:11], s44 offen offset:1024 lds
    s_add_u32 m0, s41, 126976
    s_add_u32 s44, s94, 200704
    buffer_load_dwordx4 v14, s[8:11], s44 offen offset:0 lds
    buffer_load_dwordx4 v15, s[8:11], s44 offen offset:1024 lds
    s_waitcnt vmcnt(16)
    s_barrier
    s_add_u32 m0, s41, 0
    s_add_u32 s44, s95, 2048
    buffer_load_dwordx4 v14, s[8:11], s44 offen offset:0 lds
    buffer_load_dwordx4 v15, s[8:11], s44 offen offset:1024 lds
    s_add_u32 m0, s41, 4096
    s_add_u32 s44, s95, 4096
    buffer_load_dwordx4 v14, s[8:11], s44 offen offset:0 lds
    buffer_load_dwordx4 v15, s[8:11], s44 offen offset:1024 lds
    s_add_u32 m0, s41, 8192
    s_add_u32 s44, s95, 198656
    buffer_load_dwordx4 v14, s[8:11], s44 offen offset:0 lds
    buffer_load_dwordx4 v15, s[8:11], s44 offen offset:1024 lds
    s_add_u32 m0, s41, 12288
    s_add_u32 s44, s95, 200704
    buffer_load_dwordx4 v14, s[8:11], s44 offen offset:0 lds
    buffer_load_dwordx4 v15, s[8:11], s44 offen offset:1024 lds
    s_add_u32 m0, s41, 16384
    s_add_u32 s44, s96, 2048
    buffer_load_dwordx4 v14, s[8:11], s44 offen offset:0 lds
    buffer_load_dwordx4 v15, s[8:11], s44 offen offset:1024 lds
    s_add_u32 m0, s41, 20480
    s_add_u32 s44, s96, 198656
    buffer_load_dwordx4 v14, s[8:11], s44 offen offset:0 lds
    buffer_load_dwordx4 v15, s[8:11], s44 offen offset:1024 lds
    s_add_u32 m0, s41, 24576
    s_add_u32 s44, s97, 2048
    buffer_load_dwordx4 v14, s[8:11], s44 offen offset:0 lds
    buffer_load_dwordx4 v15, s[8:11], s44 offen offset:1024 lds
    s_add_u32 m0, s41, 28672
    s_add_u32 s44, s97, 198656
    buffer_load_dwordx4 v14, s[8:11], s44 offen offset:0 lds
    buffer_load_dwordx4 v15, s[8:11], s44 offen offset:1024 lds
    s_waitcnt vmcnt(16)
    s_barrier
    s_add_u32 m0, s41, 32768
    s_add_u32 s44, s98, 2048
    buffer_load_dwordx4 v14, s[8:11], s44 offen offset:0 lds
    buffer_load_dwordx4 v15, s[8:11], s44 offen offset:1024 lds
    s_add_u32 m0, s41, 36864
    s_add_u32 s44, s98, 198656
    buffer_load_dwordx4 v14, s[8:11], s44 offen offset:0 lds
    buffer_load_dwordx4 v15, s[8:11], s44 offen offset:1024 lds
    s_add_u32 m0, s41, 40960
    s_add_u32 s44, s99, 2048
    buffer_load_dwordx4 v14, s[8:11], s44 offen offset:0 lds
    buffer_load_dwordx4 v15, s[8:11], s44 offen offset:1024 lds
    s_add_u32 m0, s41, 45056
    s_add_u32 s44, s99, 198656
    buffer_load_dwordx4 v14, s[8:11], s44 offen offset:0 lds
    buffer_load_dwordx4 v15, s[8:11], s44 offen offset:1024 lds
    s_add_u32 m0, s41, 49152
    s_add_u32 s44, s96, 4096
    buffer_load_dwordx4 v14, s[8:11], s44 offen offset:0 lds
    buffer_load_dwordx4 v15, s[8:11], s44 offen offset:1024 lds
    s_add_u32 m0, s41, 53248
    s_add_u32 s44, s96, 200704
    buffer_load_dwordx4 v14, s[8:11], s44 offen offset:0 lds
    buffer_load_dwordx4 v15, s[8:11], s44 offen offset:1024 lds
    s_add_u32 m0, s41, 57344
    s_add_u32 s44, s97, 4096
    buffer_load_dwordx4 v14, s[8:11], s44 offen offset:0 lds
    buffer_load_dwordx4 v15, s[8:11], s44 offen offset:1024 lds
    s_add_u32 m0, s41, 61440
    s_add_u32 s44, s97, 200704
    buffer_load_dwordx4 v14, s[8:11], s44 offen offset:0 lds
    buffer_load_dwordx4 v15, s[8:11], s44 offen offset:1024 lds
    s_waitcnt vmcnt(16)
    s_barrier
    s_add_u32 m0, s41, 65536
    s_add_u32 s44, s98, 4096
    buffer_load_dwordx4 v14, s[8:11], s44 offen offset:0 lds
    buffer_load_dwordx4 v15, s[8:11], s44 offen offset:1024 lds
    s_add_u32 m0, s41, 69632
    s_add_u32 s44, s98, 200704
    buffer_load_dwordx4 v14, s[8:11], s44 offen offset:0 lds
    buffer_load_dwordx4 v15, s[8:11], s44 offen offset:1024 lds
    s_add_u32 m0, s41, 73728
    s_add_u32 s44, s99, 4096
    buffer_load_dwordx4 v14, s[8:11], s44 offen offset:0 lds
    buffer_load_dwordx4 v15, s[8:11], s44 offen offset:1024 lds
    s_add_u32 m0, s41, 77824
    s_add_u32 s44, s99, 200704
    buffer_load_dwordx4 v14, s[8:11], s44 offen offset:0 lds
    buffer_load_dwordx4 v15, s[8:11], s44 offen offset:1024 lds
    s_add_u32 m0, s41, 81920
    s_add_u32 s44, s94, 0
    buffer_load_dwordx4 v14, s[8:11], s44 offen offset:0 lds
    buffer_load_dwordx4 v15, s[8:11], s44 offen offset:1024 lds
    s_add_u32 m0, s41, 86016
    s_add_u32 s44, s94, 196608
    buffer_load_dwordx4 v14, s[8:11], s44 offen offset:0 lds
    buffer_load_dwordx4 v15, s[8:11], s44 offen offset:1024 lds
    s_add_u32 m0, s41, 90112
    s_add_u32 s44, s95, 0
    buffer_load_dwordx4 v14, s[8:11], s44 offen offset:0 lds
    buffer_load_dwordx4 v15, s[8:11], s44 offen offset:1024 lds
    s_add_u32 m0, s41, 94208
    s_add_u32 s44, s95, 196608
    buffer_load_dwordx4 v14, s[8:11], s44 offen offset:0 lds
    buffer_load_dwordx4 v15, s[8:11], s44 offen offset:1024 lds
    s_waitcnt vmcnt(16)
    s_barrier
    s_add_u32 m0, s41, 98304
    s_add_u32 s44, s96, 0
    buffer_load_dwordx4 v14, s[8:11], s44 offen offset:0 lds
    buffer_load_dwordx4 v15, s[8:11], s44 offen offset:1024 lds
    s_add_u32 m0, s41, 102400
    s_add_u32 s44, s96, 196608
    buffer_load_dwordx4 v14, s[8:11], s44 offen offset:0 lds
    buffer_load_dwordx4 v15, s[8:11], s44 offen offset:1024 lds
    s_add_u32 m0, s41, 106496
    s_add_u32 s44, s97, 0
    buffer_load_dwordx4 v14, s[8:11], s44 offen offset:0 lds
    buffer_load_dwordx4 v15, s[8:11], s44 offen offset:1024 lds
    s_add_u32 m0, s41, 110592
    s_add_u32 s44, s97, 196608
    buffer_load_dwordx4 v14, s[8:11], s44 offen offset:0 lds
    buffer_load_dwordx4 v15, s[8:11], s44 offen offset:1024 lds
    s_add_u32 m0, s41, 114688
    s_add_u32 s44, s98, 0
    buffer_load_dwordx4 v14, s[8:11], s44 offen offset:0 lds
    buffer_load_dwordx4 v15, s[8:11], s44 offen offset:1024 lds
    s_add_u32 m0, s41, 118784
    s_add_u32 s44, s98, 196608
    buffer_load_dwordx4 v14, s[8:11], s44 offen offset:0 lds
    buffer_load_dwordx4 v15, s[8:11], s44 offen offset:1024 lds
    s_add_u32 m0, s41, 122880
    s_add_u32 s44, s99, 0
    buffer_load_dwordx4 v14, s[8:11], s44 offen offset:0 lds
    buffer_load_dwordx4 v15, s[8:11], s44 offen offset:1024 lds
    s_add_u32 m0, s41, 126976
    s_add_u32 s44, s99, 196608
    buffer_load_dwordx4 v14, s[8:11], s44 offen offset:0 lds
    buffer_load_dwordx4 v15, s[8:11], s44 offen offset:1024 lds
    s_waitcnt vmcnt(16)
    s_barrier
    v_lshrrev_b32 v28, 4, v1
    v_and_b32 v29, 7, v28
    v_lshrrev_b32 v28, 3, v28
    v_mul_u32_u24 v28, 2048, v28
    v_lshl_add_u32 v28, v29, 4, v28
    s_and_b32 s3, s18, 12
    s_or_b32 s3, s3, 3
    s_lshl_b32 s3, s3, 7
    v_add_u32 v28, s3, v28
    s_lshr_b32 s3, s2, 3
    s_lshl_b32 s3, s3, 2
    s_and_b32 s60, s16, 3
    s_add_u32 s60, s60, s3
    s_lshl_b32 s61, s60, 14
    buffer_load_dwordx4 v[144:147], v28, s[12:15], s61 offen
    s_bitcmp0_b32 s21, 0
    s_cselect_b32 s56, s28, s24
    s_cselect_b32 s57, s29, s25
    s_mov_b32 s58, 6291456
    s_mov_b32 s59, 0x00020000
    v_lshrrev_b32 v28, 4, v1
    v_and_b32 v29, 7, v28
    v_lshrrev_b32 v28, 3, v28
    v_mul_u32_u24 v28, 6144, v28
    v_lshl_add_u32 v28, v29, 4, v28
    s_and_b32 s3, s18, 12
    s_or_b32 s3, s3, 3
    s_lshl_b32 s3, s3, 7
    v_add_u32 v28, s3, v28
    s_lshr_b32 s3, s2, 3
    s_lshl_b32 s3, s3, 2
    s_and_b32 s60, s16, 3
    s_add_u32 s60, s60, s3
    s_and_b32 s3, s60, 31
    s_mul_i32 s3, s3, 49152
    s_lshr_b32 s61, s60, 5
    s_min_u32 s61, s61, 2
    s_lshl_b32 s61, s61, 11
    s_add_u32 s61, s61, s3
    s_and_b32 s3, s18, 0
    s_mul_i32 s3, s3, 393216
    s_add_u32 s61, s61, s3
    buffer_load_dwordx4 v[148:151], v28, s[56:59], s61 offen
    s_waitcnt vmcnt(2)
    s_cmp_lg_u32 s21, 2
    s_cbranch_scc1 l_pe
    s_bitcmp0_b32 s21, 0
    s_cselect_b32 s56, s28, s24
    s_cselect_b32 s57, s29, s25
    s_mov_b32 s58, 6291456
    s_mov_b32 s59, 0x00020000
    s_add_u32 s61, s84, 2048
    buffer_load_dwordx4 v[160:163], v11, s[56:59], s61 offen
    s_add_u32 s61, s84, 4096
    buffer_load_dwordx4 v[164:167], v11, s[56:59], s61 offen
    s_add_u32 s61, s84, 0
    buffer_load_dwordx4 v[168:171], v11, s[56:59], s61 offen
    s_add_u32 s61, s84, 198656
    buffer_load_dwordx4 v[172:175], v11, s[56:59], s61 offen
    s_add_u32 s61, s84, 200704
    buffer_load_dwordx4 v[176:179], v11, s[56:59], s61 offen
    s_add_u32 s61, s84, 196608
    buffer_load_dwordx4 v[180:183], v11, s[56:59], s61 offen
    s_add_u32 s61, s85, 2048
    buffer_load_dwordx4 v[184:187], v11, s[56:59], s61 offen
    s_add_u32 s61, s85, 4096
    buffer_load_dwordx4 v[188:191], v11, s[56:59], s61 offen
    s_add_u32 s61, s85, 0
    buffer_load_dwordx4 v[192:195], v11, s[56:59], s61 offen
    s_add_u32 s61, s85, 198656
    buffer_load_dwordx4 v[196:199], v11, s[56:59], s61 offen
l_pe:
    s_barrier
    s_bitcmp1_b32 s21, 0
    s_cbranch_scc1 s_B
    s_add_u32 m0, s41, 0
    s_xor_b32 s44, s62, 0
    buffer_load_dwordx4 v16, s[12:15], s44 offen offset:0 lds
    buffer_load_dwordx4 v17, s[12:15], s44 offen offset:1024 lds
    s_add_u32 m0, s41, 4096
    s_xor_b32 s44, s62, 131072
    buffer_load_dwordx4 v16, s[12:15], s44 offen offset:0 lds
    buffer_load_dwordx4 v17, s[12:15], s44 offen offset:1024 lds
    s_add_u32 m0, s41, 8192
    s_xor_b32 s44, s62, 262144
    buffer_load_dwordx4 v16, s[12:15], s44 offen offset:0 lds
    buffer_load_dwordx4 v17, s[12:15], s44 offen offset:1024 lds
    s_add_u32 m0, s41, 12288
    s_xor_b32 s44, s62, 393216
    buffer_load_dwordx4 v16, s[12:15], s44 offen offset:0 lds
    buffer_load_dwordx4 v17, s[12:15], s44 offen offset:1024 lds
    s_add_u32 m0, s41, 16384
    s_xor_b32 s44, s62, 524288
    buffer_load_dwordx4 v16, s[12:15], s44 offen offset:0 lds
    buffer_load_dwordx4 v17, s[12:15], s44 offen offset:1024 lds
    s_add_u32 m0, s41, 20480
    s_xor_b32 s44, s62, 655360
    buffer_load_dwordx4 v16, s[12:15], s44 offen offset:0 lds
    buffer_load_dwordx4 v17, s[12:15], s44 offen offset:1024 lds
    s_add_u32 m0, s41, 24576
    s_xor_b32 s44, s62, 786432
    buffer_load_dwordx4 v16, s[12:15], s44 offen offset:0 lds
    buffer_load_dwordx4 v17, s[12:15], s44 offen offset:1024 lds
    s_add_u32 m0, s41, 28672
    s_xor_b32 s44, s62, 917504
    buffer_load_dwordx4 v16, s[12:15], s44 offen offset:0 lds
    buffer_load_dwordx4 v17, s[12:15], s44 offen offset:1024 lds
    s_add_u32 m0, s41, 32768
    s_xor_b32 s44, s62, 1048576
    buffer_load_dwordx4 v16, s[12:15], s44 offen offset:0 lds
    buffer_load_dwordx4 v17, s[12:15], s44 offen offset:1024 lds
    s_add_u32 m0, s41, 36864
    s_xor_b32 s44, s62, 1179648
    buffer_load_dwordx4 v16, s[12:15], s44 offen offset:0 lds
    buffer_load_dwordx4 v17, s[12:15], s44 offen offset:1024 lds
    s_add_u32 m0, s41, 40960
    s_xor_b32 s44, s62, 1310720
    buffer_load_dwordx4 v16, s[12:15], s44 offen offset:0 lds
    buffer_load_dwordx4 v17, s[12:15], s44 offen offset:1024 lds
    s_add_u32 m0, s41, 45056
    s_xor_b32 s44, s62, 1441792
    buffer_load_dwordx4 v16, s[12:15], s44 offen offset:0 lds
    buffer_load_dwordx4 v17, s[12:15], s44 offen offset:1024 lds
    s_add_u32 m0, s41, 49152
    s_xor_b32 s44, s62, 1572864
    buffer_load_dwordx4 v16, s[12:15], s44 offen offset:0 lds
    buffer_load_dwordx4 v17, s[12:15], s44 offen offset:1024 lds
    s_add_u32 m0, s41, 53248
    s_xor_b32 s44, s62, 1703936
    buffer_load_dwordx4 v16, s[12:15], s44 offen offset:0 lds
    buffer_load_dwordx4 v17, s[12:15], s44 offen offset:1024 lds
    s_add_u32 m0, s41, 57344
    s_xor_b32 s44, s62, 1835008
    buffer_load_dwordx4 v16, s[12:15], s44 offen offset:0 lds
    buffer_load_dwordx4 v17, s[12:15], s44 offen offset:1024 lds
    s_add_u32 m0, s41, 61440
    s_xor_b32 s44, s62, 1966080
    buffer_load_dwordx4 v16, s[12:15], s44 offen offset:0 lds
    buffer_load_dwordx4 v17, s[12:15], s44 offen offset:1024 lds
    s_branch s_tail
h_start:
    v_mov_b32 v20, 0
    v_mov_b32 v21, 0
    v_mov_b32 v22, 0
    v_mov_b32 v23, 0
    s_cmp_lt_u32 s2, 10
    s_cbranch_scc0 h_z0
    s_load_dword s101, s[34:35], 192
    s_lshl_b32 s44, s2, 11
    s_mov_b32 s45, 0
    s_mov_b32 s46, 0
    s_mov_b32 s47, 0
    s_mov_b32 s48, 0
    s_mov_b32 s49, 0
    s_mov_b32 s50, 0
    s_mov_b32 s51, 0
    s_mov_b32 s52, 0
    s_mov_b32 s53, 0
    s_mov_b32 s54, 0
    s_mov_b32 s55, 0
    s_mov_b32 s56, 0
    s_mov_b32 s57, 0
    s_mov_b32 s58, 0
    s_mov_b32 s59, 0
    s_mov_b32 s60, 0
    s_atomic_swap s45, s[22:23], s44 offset:0 glc
    s_atomic_swap s46, s[22:23], s44 offset:128 glc
    s_atomic_swap s47, s[22:23], s44 offset:256 glc
    s_atomic_swap s48, s[22:23], s44 offset:384 glc
    s_atomic_swap s49, s[22:23], s44 offset:512 glc
    s_atomic_swap s50, s[22:23], s44 offset:640 glc
    s_atomic_swap s51, s[22:23], s44 offset:768 glc
    s_atomic_swap s52, s[22:23], s44 offset:896 glc
    s_atomic_swap s53, s[22:23], s44 offset:1024 glc
    s_atomic_swap s54, s[22:23], s44 offset:1152 glc
    s_atomic_swap s55, s[22:23], s44 offset:1280 glc
    s_atomic_swap s56, s[22:23], s44 offset:1408 glc
    s_atomic_swap s57, s[22:23], s44 offset:1536 glc
    s_atomic_swap s58, s[22:23], s44 offset:1664 glc
    s_atomic_swap s59, s[22:23], s44 offset:1792 glc
    s_atomic_swap s60, s[22:23], s44 offset:1920 glc
    s_waitcnt lgkmcnt(0)
    s_atomic_add s40, s[34:35], 0
h_z0:
    v_lshrrev_b32 v24, 4, v1
    v_lshrrev_b32 v25, 3, v24
    v_mul_u32_u24 v12, 6144, v25
    v_and_b32 v26, 2, v25
    v_lshrrev_b32 v25, 2, v25
    v_or_b32 v26, v26, v25
    v_bfe_u32 v25, v24, 1, 2
    v_xor_b32 v26, v26, v25
    v_lshl_add_u32 v12, v26, 5, v12
    v_and_b32 v26, 1, v24
    v_lshl_add_u32 v12, v26, 4, v12
    s_lshl_b32 s3, s18, 7
    v_add_u32 v12, s3, v12
    v_add_u32 v13, 48128, v12
    s_mul_i32 s84, s18, 393216
    s_cmp_eq_u32 s18, 1
    s_cselect_b32 s85, 0, 393216
    s_cmp_eq_u32 s18, 2
    s_cselect_b32 s86, 0, 786432
    s_cmp_eq_u32 s18, 3
    s_cselect_b32 s87, 0, 1179648
    s_cmp_eq_u32 s18, 4
    s_cselect_b32 s88, 0, 1572864
    s_cmp_eq_u32 s18, 5
    s_cselect_b32 s89, 0, 1966080
    s_cmp_eq_u32 s18, 6
    s_cselect_b32 s90, 0, 2359296
    s_cmp_eq_u32 s18, 7
    s_cselect_b32 s91, 0, 2752512
    s_cmp_eq_u32 s18, 8
    s_cselect_b32 s92, 0, 3145728
    s_cmp_eq_u32 s18, 9
    s_cselect_b32 s93, 0, 3538944
    s_cmp_eq_u32 s18, 10
    s_cselect_b32 s94, 0, 3932160
    s_cmp_eq_u32 s18, 11
    s_cselect_b32 s95, 0, 4325376
    s_cmp_eq_u32 s18, 12
    s_cselect_b32 s96, 0, 4718592
    s_cmp_eq_u32 s18, 13
    s_cselect_b32 s97, 0, 5111808
    s_cmp_eq_u32 s18, 14
    s_cselect_b32 s98, 0, 5505024
    s_cmp_eq_u32 s18, 15
    s_cselect_b32 s99, 0, 5898240
    v_lshrrev_b32 v24, 4, v1
    v_lshrrev_b32 v25, 3, v24
    v_mul_u32_u24 v16, 2048, v25
    v_and_b32 v26, 2, v25
    v_lshrrev_b32 v25, 2, v25
    v_or_b32 v26, v26, v25
    v_bfe_u32 v25, v24, 1, 2
    v_xor_b32 v26, v26, v25
    v_lshl_add_u32 v16, v26, 5, v16
    v_and_b32 v26, 1, v24
    v_lshl_add_u32 v16, v26, 4, v16
    s_lshl_b32 s3, s18, 7
    v_add_u32 v16, s3, v16
    v_add_u32 v17, 15360, v16
    v_add_u32 v18, 30720, v16
    v_add_u32 v19, 46080, v16
    s_and_b32 s3, s16, 3
    s_mul_i32 s3, s3, 49152
    v_add_u32 v11, s3, v12
    s_and_b32 s3, s16, 3
    s_lshl_b32 s3, s3, 10
    v_add_u32 v9, s3, v1
    v_add_u32 v10, 0x10000, v9
    v_lshrrev_b32 v24, 4, v1
    v_and_b32 v25, 15, v24
    v_lshrrev_b32 v24, 4, v24
    v_lshlrev_b32 v24, 2, v24
    v_sub_u32 v24, v25, v24
    v_mov_b32 v25, 0xf149f2ca
    v_add_u32 v26, 0x0, v24
    v_and_b32 v26, 0xfffffff1, v26
    v_cmp_eq_u32 vcc, 0, v26
    s_nop 1
    v_cndmask_b32 v32, v25, 0, vcc
    v_add_u32 v26, 0xffffffff, v24
    v_and_b32 v26, 0xfffffff1, v26
    v_cmp_eq_u32 vcc, 0, v26
    s_nop 1
    v_cndmask_b32 v33, v25, 0, vcc
    v_add_u32 v26, 0xfffffffe, v24
    v_and_b32 v26, 0xfffffff1, v26
    v_cmp_eq_u32 vcc, 0, v26
    s_nop 1
    v_cndmask_b32 v34, v25, 0, vcc
    v_add_u32 v26, 0xfffffffd, v24
    v_and_b32 v26, 0xfffffff1, v26
    v_cmp_eq_u32 vcc, 0, v26
    s_nop 1
    v_cndmask_b32 v35, v25, 0, vcc
    v_add_u32 v26, 0x10, v24
    v_and_b32 v26, 0xfffffff1, v26
    v_cmp_eq_u32 vcc, 0, v26
    s_nop 1
    v_cndmask_b32 v36, v25, 0, vcc
    v_add_u32 v26, 0xf, v24
    v_and_b32 v26, 0xfffffff1, v26
    v_cmp_eq_u32 vcc, 0, v26
    s_nop 1
    v_cndmask_b32 v37, v25, 0, vcc
    v_add_u32 v26, 0xe, v24
    v_and_b32 v26, 0xfffffff1, v26
    v_cmp_eq_u32 vcc, 0, v26
    s_nop 1
    v_cndmask_b32 v38, v25, 0, vcc
    v_add_u32 v26, 0xd, v24
    v_and_b32 v26, 0xfffffff1, v26
    v_cmp_eq_u32 vcc, 0, v26
    s_nop 1
    v_cndmask_b32 v39, v25, 0, vcc
    v_add_u32 v24, 153600, v1
    ds_write_b128 v24, v[32:35] offset:0
    ds_write_b128 v24, v[36:39] offset:1024
    s_waitcnt lgkmcnt(0)
    s_lshl_b32 s44, s21, 14
    s_lshl_b32 s67, s17, 9
    s_add_u32 s44, s44, s67
    s_add_u32 s44, s44, 4096
    s_barrier
    s_barrier
    s_mov_b32 s66, 0x10000
h_s0_poll:
    s_mov_b32 s68, 0
    s_mov_b32 s69, 0
    s_mov_b32 s70, 0
    s_mov_b32 s71, 0
    s_atomic_add s68, s[22:23], s44 offset:0 glc
    s_atomic_add s69, s[22:23], s44 offset:128 glc
    s_atomic_add s70, s[22:23], s44 offset:256 glc
    s_atomic_add s71, s[22:23], s44 offset:384 glc
    s_sub_u32 s66, s66, 1
    s_cselect_b32 s67, 16, 0
    s_waitcnt lgkmcnt(0)
    s_and_b32 s68, s68, s69
    s_and_b32 s68, s68, s70
    s_and_b32 s68, s68, s71
    s_max_u32 s68, s68, s67
    s_cmp_lt_u32 s68, 16
    s_cbranch_scc1 h_s0_poll
h_s0_ok:
    s_lshr_b32 s3, s2, 3
    s_cmp_eq_u32 s3, 2
    s_cbranch_scc0 h_g4
    s_barrier
    s_mul_i32 s44, s2, 24576
    s_add_u32 s44, s44, 58347520
    s_mov_b32 s45, 24
h_zloop:
    buffer_store_dwordx4 v[20:23], v1, s[4:7], s44 offen sc1
    s_add_u32 s44, s44, 1024
    s_sub_u32 s45, s45, 1
    s_cmp_lg_u32 s45, 0
    s_cbranch_scc1 h_zloop
    s_branch h_g4b
h_layer:
    s_waitcnt lgkmcnt(0)
    s_barrier
h_g4:
    s_barrier
h_g4b:
    s_lshl_b32 s44, s21, 14
    s_lshl_b32 s67, s17, 9
    s_add_u32 s44, s44, s67
    s_add_u32 s44, s44, 12288
    s_mov_b32 s66, 0x10000
h_s_poll:
    s_mov_b32 s68, 0
    s_mov_b32 s69, 0
    s_mov_b32 s70, 0
    s_mov_b32 s71, 0
    s_atomic_add s68, s[22:23], s44 offset:0 glc
    s_atomic_add s69, s[22:23], s44 offset:128 glc
    s_atomic_add s70, s[22:23], s44 offset:256 glc
    s_atomic_add s71, s[22:23], s44 offset:384 glc
    s_sub_u32 s66, s66, 1
    s_cselect_b32 s67, 16, 0
    s_waitcnt lgkmcnt(0)
    s_and_b32 s68, s68, s69
    s_and_b32 s68, s68, s70
    s_and_b32 s68, s68, s71
    s_max_u32 s68, s68, s67
    s_cmp_lt_u32 s68, 16
    s_cbranch_scc1 h_s_poll
h_s_ok:
    s_barrier
    s_lshl_b32 s44, s21, 18
    s_lshl_b32 s45, s17, 14
    s_add_u32 s44, s44, s45
    s_add_u32 s44, s44, 50331648
    buffer_load_dwordx4 v[32:35], v1, s[4:7], s44 offen offset:0 sc1
    buffer_load_dwordx4 v[36:39], v1, s[4:7], s44 offen offset:1024 sc1
    buffer_load_dwordx4 v[40:43], v1, s[4:7], s44 offen offset:2048 sc1
    buffer_load_dwordx4 v[44:47], v1, s[4:7], s44 offen offset:3072 sc1
    s_add_u32 s44, s44, 4096
    buffer_load_dwordx4 v[48:51], v1, s[4:7], s44 offen offset:0 sc1
    buffer_load_dwordx4 v[52:55], v1, s[4:7], s44 offen offset:1024 sc1
    buffer_load_dwordx4 v[56:59], v1, s[4:7], s44 offen offset:2048 sc1
    buffer_load_dwordx4 v[60:63], v1, s[4:7], s44 offen offset:3072 sc1
    s_add_u32 s44, s44, 4096
    buffer_load_dwordx4 v[64:67], v1, s[4:7], s44 offen offset:0 sc1
    buffer_load_dwordx4 v[68:71], v1, s[4:7], s44 offen offset:1024 sc1
    buffer_load_dwordx4 v[72:75], v1, s[4:7], s44 offen offset:2048 sc1
    buffer_load_dwordx4 v[76:79], v1, s[4:7], s44 offen offset:3072 sc1
    s_add_u32 s44, s44, 4096
    buffer_load_dwordx4 v[80:83], v1, s[4:7], s44 offen offset:0 sc1
    buffer_load_dwordx4 v[84:87], v1, s[4:7], s44 offen offset:1024 sc1
    buffer_load_dwordx4 v[88:91], v1, s[4:7], s44 offen offset:2048 sc1
    buffer_load_dwordx4 v[92:95], v1, s[4:7], s44 offen offset:3072 sc1
    s_barrier
    s_cmp_ge_u32 s21, 2
    s_cbranch_scc1 h_c_ok
    s_lshl_b32 s44, s21, 11
    s_lshl_b32 s67, s18, 7
    s_add_u32 s44, s44, s67
    s_add_u32 s44, s44, 0
    s_mov_b32 s66, 0x10000
h_c_poll:
    s_mov_b32 s68, 0
    s_atomic_add s68, s[22:23], s44 offset:0 glc
    s_sub_u32 s66, s66, 1
    s_cselect_b32 s67, 48, 0
    s_waitcnt lgkmcnt(0)
    s_max_u32 s68, s68, s67
    s_cmp_lt_u32 s68, 48
    s_cbranch_scc1 h_c_poll
h_c_ok:
    s_waitcnt vmcnt(0)
    s_lshl_b32 s3, s21, 8
    s_add_u32 s3, s3, s2
    s_lshr_b32 s3, s3, 3
    s_cmp_eq_u32 s3, 2
    s_cbranch_scc0 h_nf1
    s_atomic_add s40, s[34:35], 128
h_nf1:
    s_barrier
    s_cmp_ge_u32 s21, 2
    s_cbranch_scc1 h_cs1
    s_lshl_b32 s44, s21, 18
    s_lshl_b32 s45, s18, 14
    s_add_u32 s44, s44, s45
    s_add_u32 s44, s44, 52428800
    buffer_load_dwordx4 v[96:99], v1, s[4:7], s44 offen offset:0 sc1
    buffer_load_dwordx4 v[100:103], v1, s[4:7], s44 offen offset:1024 sc1
    buffer_load_dwordx4 v[104:107], v1, s[4:7], s44 offen offset:2048 sc1
    buffer_load_dwordx4 v[108:111], v1, s[4:7], s44 offen offset:3072 sc1
    s_add_u32 s44, s44, 4096
    buffer_load_dwordx4 v[112:115], v1, s[4:7], s44 offen offset:0 sc1
    buffer_load_dwordx4 v[116:119], v1, s[4:7], s44 offen offset:1024 sc1
    buffer_load_dwordx4 v[120:123], v1, s[4:7], s44 offen offset:2048 sc1
    buffer_load_dwordx4 v[124:127], v1, s[4:7], s44 offen offset:3072 sc1
    s_add_u32 s44, s44, 4096
    buffer_load_dwordx4 v[128:131], v1, s[4:7], s44 offen offset:0 sc1
    buffer_load_dwordx4 v[132:135], v1, s[4:7], s44 offen offset:1024 sc1
    buffer_load_dwordx4 v[136:139], v1, s[4:7], s44 offen offset:2048 sc1
    buffer_load_dwordx4 v[140:143], v1, s[4:7], s44 offen offset:3072 sc1
    s_add_u32 s44, s44, 4096
    buffer_load_dwordx4 v[144:147], v1, s[4:7], s44 offen offset:0 sc1
    buffer_load_dwordx4 v[148:151], v1, s[4:7], s44 offen offset:1024 sc1
    buffer_load_dwordx4 v[152:155], v1, s[4:7], s44 offen offset:2048 sc1
    buffer_load_dwordx4 v[156:159], v1, s[4:7], s44 offen offset:3072 sc1
h_cs1:
    v_add_f32 v32, v32, v36
    v_add_f32 v33, v33, v37
    v_add_f32 v34, v34, v38
    v_add_f32 v35, v35, v39
    v_add_f32 v48, v48, v52
    v_add_f32 v49, v49, v53
    v_add_f32 v50, v50, v54
    v_add_f32 v51, v51, v55
    v_add_f32 v64, v64, v68
    v_add_f32 v65, v65, v69
    v_add_f32 v66, v66, v70
    v_add_f32 v67, v67, v71
    v_add_f32 v80, v80, v84
    v_add_f32 v81, v81, v85
    v_add_f32 v82, v82, v86
    v_add_f32 v83, v83, v87
    v_add_f32 v32, v32, v40
    v_add_f32 v33, v33, v41
    v_add_f32 v34, v34, v42
    v_add_f32 v35, v35, v43
    v_add_f32 v48, v48, v56
    v_add_f32 v49, v49, v57
    v_add_f32 v50, v50, v58
    v_add_f32 v51, v51, v59
    v_add_f32 v64, v64, v72
    v_add_f32 v65, v65, v73
    v_add_f32 v66, v66, v74
    v_add_f32 v67, v67, v75
    v_add_f32 v80, v80, v88
    v_add_f32 v81, v81, v89
    v_add_f32 v82, v82, v90
    v_add_f32 v83, v83, v91
    s_barrier
    v_add_f32 v32, v32, v44
    v_add_f32 v33, v33, v45
    v_add_f32 v34, v34, v46
    v_add_f32 v35, v35, v47
    v_add_f32 v48, v48, v60
    v_add_f32 v49, v49, v61
    v_add_f32 v50, v50, v62
    v_add_f32 v51, v51, v63
    v_add_f32 v64, v64, v76
    v_add_f32 v65, v65, v77
    v_add_f32 v66, v66, v78
    v_add_f32 v67, v67, v79
    v_add_f32 v80, v80, v92
    v_add_f32 v81, v81, v93
    v_add_f32 v82, v82, v94
    v_add_f32 v83, v83, v95
    v_permlane32_swap_b32 v32, v64
    v_permlane32_swap_b32 v33, v65
    v_permlane32_swap_b32 v34, v66
    v_permlane32_swap_b32 v35, v67
    v_add_f32 v32, v32, v64
    v_add_f32 v33, v33, v65
    v_add_f32 v34, v34, v66
    v_add_f32 v35, v35, v67
    v_permlane32_swap_b32 v48, v80
    v_permlane32_swap_b32 v49, v81
    v_permlane32_swap_b32 v50, v82
    v_permlane32_swap_b32 v51, v83
    v_add_f32 v48, v48, v80
    v_add_f32 v49, v49, v81
    v_add_f32 v50, v50, v82
    v_add_f32 v51, v51, v83
    v_permlane16_swap_b32 v32, v48
    v_permlane16_swap_b32 v33, v49
    v_permlane16_swap_b32 v34, v50
    v_permlane16_swap_b32 v35, v51
    v_add_f32 v32, v32, v48
    v_add_f32 v33, v33, v49
    v_add_f32 v34, v34, v50
    v_add_f32 v35, v35, v51
    s_barrier
    v_mul_f32 v32, 0x3a800000, v32
    v_mul_f32 v33, 0x3a800000, v33
    v_mul_f32 v34, 0x3a800000, v34
    v_mul_f32 v35, 0x3a800000, v35
    v_fma_f32 v33, -v32, v32, v33
    v_fma_f32 v35, -v34, v34, v35
    v_max_f32 v33, 0, v33
    v_max_f32 v35, 0, v35
    v_add_f32 v33, 0x3727c5ac, v33
    v_add_f32 v35, 0x3727c5ac, v35
    v_rsq_f32 v33, v33
    v_rsq_f32 v35, v35
    v_lshrrev_b32 v26, 1, v1
    v_add_u32 v26, 155648, v26
    ds_write2_b32 v26, v32, v34 offset0:0 offset1:1
    ds_write2_b32 v26, v33, v35 offset0:128 offset1:129
    s_barrier
    s_cmp_ge_u32 s21, 2
    s_cbranch_scc1 h_cs_done
    s_waitcnt vmcnt(0)
    v_add_f32 v96, v96, v100
    v_add_f32 v97, v97, v101
    v_add_f32 v98, v98, v102
    v_add_f32 v99, v99, v103
    v_add_f32 v96, v96, v104
    v_add_f32 v97, v97, v105
    v_add_f32 v98, v98, v106
    v_add_f32 v99, v99, v107
    v_add_f32 v96, v96, v108
    v_add_f32 v97, v97, v109
    v_add_f32 v98, v98, v110
    v_add_f32 v99, v99, v111
    v_add_f32 v96, v96, v112
    v_add_f32 v97, v97, v113
    v_add_f32 v98, v98, v114
    v_add_f32 v99, v99, v115
    v_add_f32 v96, v96, v116
    v_add_f32 v97, v97, v117
    v_add_f32 v98, v98, v118
    v_add_f32 v99, v99, v119
    v_add_f32 v96, v96, v120
    v_add_f32 v97, v97, v121
    v_add_f32 v98, v98, v122
    v_add_f32 v99, v99, v123
    v_add_f32 v96, v96, v124
    v_add_f32 v97, v97, v125
    v_add_f32 v98, v98, v126
    v_add_f32 v99, v99, v127
    v_add_f32 v96, v96, v128
    v_add_f32 v97, v97, v129
    v_add_f32 v98, v98, v130
    v_add_f32 v99, v99, v131
    v_add_f32 v96, v96, v132
    v_add_f32 v97, v97, v133
    v_add_f32 v98, v98, v134
    v_add_f32 v99, v99, v135
    v_add_f32 v96, v96, v136
    v_add_f32 v97, v97, v137
    v_add_f32 v98, v98, v138
    v_add_f32 v99, v99, v139
    v_add_f32 v96, v96, v140
    v_add_f32 v97, v97, v141
    v_add_f32 v98, v98, v142
    v_add_f32 v99, v99, v143
    v_add_f32 v96, v96, v144
    v_add_f32 v97, v97, v145
    v_add_f32 v98, v98, v146
    v_add_f32 v99, v99, v147
    v_add_f32 v96, v96, v148
    v_add_f32 v97, v97, v149
    v_add_f32 v98, v98, v150
    v_add_f32 v99, v99, v151
    v_add_f32 v96, v96, v152
    v_add_f32 v97, v97, v153
    v_add_f32 v98, v98, v154
    v_add_f32 v99, v99, v155
    v_add_f32 v96, v96, v156
    v_add_f32 v97, v97, v157
    v_add_f32 v98, v98, v158
    v_add_f32 v99, v99, v159
    s_lshl_b32 s44, s21, 10
    s_add_u32 s44, s44, 151552
    v_add_u32 v24, s44, v1
    ds_write_b128 v24, v[96:99]
h_cs_done:
    s_waitcnt lgkmcnt(0)
    s_barrier
    s_cmp_lg_u32 s21, 0
    s_cbranch_scc1 h_f1_ok
    s_load_dword s68, s[34:35], 128
    s_mov_b32 s8, s34
    s_mov_b32 s9, s35
    s_mov_b32 s10, 256
    s_mov_b32 s11, 0x00020000
    s_mov_b32 s66, 0x10000
    v_mov_b32 v24, 0
    s_waitcnt lgkmcnt(0)
h_f1:
    s_cmp_eq_u32 s68, 8
    s_cbranch_scc1 h_f1_ok
    buffer_load_dword v25, v24, s[8:11], 0 offen offset:128 sc1
    s_waitcnt vmcnt(0)
    v_readfirstlane_b32 s68, v25
    s_sub_u32 s66, s66, 1
    s_cmp_lg_u32 s66, 0
    s_cbranch_scc1 h_f1
h_f1_ok:
    s_barrier
    s_bitcmp1_b32 s21, 0
    s_cselect_b32 s8, s28, s24
    s_cselect_b32 s9, s29, s25
    s_cselect_b32 s12, s30, s26
    s_cselect_b32 s13, s31, s27
    s_mov_b32 s10, 6291456
    s_mov_b32 s11, 0x00020000
    s_mov_b32 s14, 2097152
    s_mov_b32 s15, 0x00020000
    v_lshrrev_b32 v28, 4, v1
    v_and_b32 v29, 7, v28
    v_lshrrev_b32 v28, 3, v28
    v_mul_u32_u24 v28, 2048, v28
    v_lshl_add_u32 v28, v29, 4, v28
    s_and_b32 s3, s18, 12
    s_or_b32 s3, s3, 3
    s_lshl_b32 s3, s3, 7
    v_add_u32 v28, s3, v28
    s_lshr_b32 s3, s2, 3
    s_lshl_b32 s3, s3, 2
    s_and_b32 s60, s16, 3
    s_add_u32 s60, s60, s3
    s_lshl_b32 s61, s60, 14
    buffer_load_dwordx4 v[144:147], v28, s[12:15], s61 offen
    s_bitcmp0_b32 s21, 0
    s_cselect_b32 s56, s28, s24
    s_cselect_b32 s57, s29, s25
    s_mov_b32 s58, 6291456
    s_mov_b32 s59, 0x00020000
    v_lshrrev_b32 v28, 4, v1
    v_and_b32 v29, 7, v28
    v_lshrrev_b32 v28, 3, v28
    v_mul_u32_u24 v28, 6144, v28
    v_lshl_add_u32 v28, v29, 4, v28
    s_and_b32 s3, s18, 12
    s_or_b32 s3, s3, 3
    s_lshl_b32 s3, s3, 7
    v_add_u32 v28, s3, v28
    s_lshr_b32 s3, s2, 3
    s_lshl_b32 s3, s3, 2
    s_and_b32 s60, s16, 3
    s_add_u32 s60, s60, s3
    s_and_b32 s3, s60, 31
    s_mul_i32 s3, s3, 49152
    s_lshr_b32 s61, s60, 5
    s_min_u32 s61, s61, 2
    s_lshl_b32 s61, s61, 11
    s_add_u32 s61, s61, s3
    s_and_b32 s3, s18, 0
    s_mul_i32 s3, s3, 393216
    s_add_u32 s61, s61, s3
    buffer_load_dwordx4 v[148:151], v28, s[56:59], s61 offen
    s_cmp_lg_u32 s21, 2
    s_cbranch_scc1 h_pe
    s_bitcmp0_b32 s21, 0
    s_cselect_b32 s56, s28, s24
    s_cselect_b32 s57, s29, s25
    s_mov_b32 s58, 6291456
    s_mov_b32 s59, 0x00020000
    s_add_u32 s61, s84, 2048
    buffer_load_dwordx4 v[160:163], v11, s[56:59], s61 offen
    s_add_u32 s61, s84, 4096
    buffer_load_dwordx4 v[164:167], v11, s[56:59], s61 offen
    s_add_u32 s61, s84, 0
    buffer_load_dwordx4 v[168:171], v11, s[56:59], s61 offen
    s_add_u32 s61, s84, 198656
    buffer_load_dwordx4 v[172:175], v11, s[56:59], s61 offen
    s_add_u32 s61, s84, 200704
    buffer_load_dwordx4 v[176:179], v11, s[56:59], s61 offen
    s_add_u32 s61, s84, 196608
    buffer_load_dwordx4 v[180:183], v11, s[56:59], s61 offen
    s_add_u32 s61, s85, 2048
    buffer_load_dwordx4 v[184:187], v11, s[56:59], s61 offen
    s_add_u32 s61, s85, 4096
    buffer_load_dwordx4 v[188:191], v11, s[56:59], s61 offen
    s_add_u32 s61, s85, 0
    buffer_load_dwordx4 v[192:195], v11, s[56:59], s61 offen
    s_add_u32 s61, s85, 198656
    buffer_load_dwordx4 v[196:199], v11, s[56:59], s61 offen
h_pe:
    s_barrier
    s_branch s_tail
z_start:
    v_lshrrev_b32 v24, 4, v1
    v_lshrrev_b32 v25, 3, v24
    v_mul_u32_u24 v20, 6144, v25
    v_and_b32 v25, 7, v24
    v_lshl_add_u32 v20, v25, 4, v20
    s_add_u32 s3, s18, 2
    s_and_b32 s3, s3, 15
    s_lshl_b32 s3, s3, 7
    s_add_u32 s3, s3, 4096
    v_add_u32 v22, s3, v20
    s_add_u32 s3, s18, 1
    s_and_b32 s3, s3, 15
    s_lshl_b32 s3, s3, 7
    s_add_u32 s3, s3, 2048
    v_add_u32 v21, s3, v20
    s_add_u32 s3, s18, 0
    s_and_b32 s3, s3, 15
    s_lshl_b32 s3, s3, 7
    s_add_u32 s3, s3, 0
    v_add_u32 v20, s3, v20
    s_waitcnt lgkmcnt(0)
    s_mov_b32 s8, s24
    s_mov_b32 s9, s25
    s_mov_b32 s10, 6291456
    s_mov_b32 s11, 0x00020000
    s_mul_i32 s44, s17, 393216
    buffer_load_dwordx4 v[32:35], v20, s[8:11], s44 offen
    buffer_load_dwordx4 v[64:67], v21, s[8:11], s44 offen
    buffer_load_dwordx4 v[96:99], v22, s[8:11], s44 offen
    s_add_u32 s44, s44, 49152
    buffer_load_dwordx4 v[36:39], v20, s[8:11], s44 offen
    buffer_load_dwordx4 v[68:71], v21, s[8:11], s44 offen
    buffer_load_dwordx4 v[100:103], v22, s[8:11], s44 offen
    s_add_u32 s44, s44, 49152
    buffer_load_dwordx4 v[40:43], v20, s[8:11], s44 offen
    buffer_load_dwordx4 v[72:75], v21, s[8:11], s44 offen
    buffer_load_dwordx4 v[104:107], v22, s[8:11], s44 offen
    s_add_u32 s44, s44, 49152
    buffer_load_dwordx4 v[44:47], v20, s[8:11], s44 offen
    buffer_load_dwordx4 v[76:79], v21, s[8:11], s44 offen
    buffer_load_dwordx4 v[108:111], v22, s[8:11], s44 offen
    s_add_u32 s44, s44, 49152
    buffer_load_dwordx4 v[48:51], v20, s[8:11], s44 offen
    buffer_load_dwordx4 v[80:83], v21, s[8:11], s44 offen
    buffer_load_dwordx4 v[112:115], v22, s[8:11], s44 offen
    s_add_u32 s44, s44, 49152
    buffer_load_dwordx4 v[52:55], v20, s[8:11], s44 offen
    buffer_load_dwordx4 v[84:87], v21, s[8:11], s44 offen
    buffer_load_dwordx4 v[116:119], v22, s[8:11], s44 offen
    s_add_u32 s44, s44, 49152
    buffer_load_dwordx4 v[56:59], v20, s[8:11], s44 offen
    buffer_load_dwordx4 v[88:91], v21, s[8:11], s44 offen
    buffer_load_dwordx4 v[120:123], v22, s[8:11], s44 offen
    s_add_u32 s44, s44, 49152
    buffer_load_dwordx4 v[60:63], v20, s[8:11], s44 offen
    buffer_load_dwordx4 v[92:95], v21, s[8:11], s44 offen
    buffer_load_dwordx4 v[124:127], v22, s[8:11], s44 offen
    v_lshrrev_b32 v24, 4, v1
    v_lshrrev_b32 v25, 3, v24
    v_mul_u32_u24 v12, 6144, v25
    v_and_b32 v26, 2, v25
    v_lshrrev_b32 v25, 2, v25
    v_or_b32 v26, v26, v25
    v_bfe_u32 v25, v24, 1, 2
    v_xor_b32 v26, v26, v25
    v_lshl_add_u32 v12, v26, 5, v12
    v_and_b32 v26, 1, v24
    v_lshl_add_u32 v12, v26, 4, v12
    s_lshl_b32 s3, s18, 7
    v_add_u32 v12, s3, v12
    v_add_u32 v13, 48128, v12
    s_mul_i32 s84, s18, 393216
    s_cmp_eq_u32 s18, 1
    s_cselect_b32 s85, 0, 393216
    s_cmp_eq_u32 s18, 2
    s_cselect_b32 s86, 0, 786432
    s_cmp_eq_u32 s18, 3
    s_cselect_b32 s87, 0, 1179648
    s_cmp_eq_u32 s18, 4
    s_cselect_b32 s88, 0, 1572864
    s_cmp_eq_u32 s18, 5
    s_cselect_b32 s89, 0, 1966080
    s_cmp_eq_u32 s18, 6
    s_cselect_b32 s90, 0, 2359296
    s_cmp_eq_u32 s18, 7
    s_cselect_b32 s91, 0, 2752512
    s_cmp_eq_u32 s18, 8
    s_cselect_b32 s92, 0, 3145728
    s_cmp_eq_u32 s18, 9
    s_cselect_b32 s93, 0, 3538944
    s_cmp_eq_u32 s18, 10
    s_cselect_b32 s94, 0, 3932160
    s_cmp_eq_u32 s18, 11
    s_cselect_b32 s95, 0, 4325376
    s_cmp_eq_u32 s18, 12
    s_cselect_b32 s96, 0, 4718592
    s_cmp_eq_u32 s18, 13
    s_cselect_b32 s97, 0, 5111808
    s_cmp_eq_u32 s18, 14
    s_cselect_b32 s98, 0, 5505024
    s_cmp_eq_u32 s18, 15
    s_cselect_b32 s99, 0, 5898240
    v_lshrrev_b32 v24, 4, v1
    v_lshrrev_b32 v25, 3, v24
    v_mul_u32_u24 v16, 2048, v25
    v_and_b32 v26, 2, v25
    v_lshrrev_b32 v25, 2, v25
    v_or_b32 v26, v26, v25
    v_bfe_u32 v25, v24, 1, 2
    v_xor_b32 v26, v26, v25
    v_lshl_add_u32 v16, v26, 5, v16
    v_and_b32 v26, 1, v24
    v_lshl_add_u32 v16, v26, 4, v16
    s_lshl_b32 s3, s18, 7
    v_add_u32 v16, s3, v16
    v_add_u32 v17, 15360, v16
    v_add_u32 v18, 30720, v16
    v_add_u32 v19, 46080, v16
    s_and_b32 s3, s16, 3
    s_mul_i32 s3, s3, 49152
    v_add_u32 v11, s3, v12
    s_and_b32 s3, s16, 3
    s_lshl_b32 s3, s3, 10
    v_add_u32 v9, s3, v1
    v_add_u32 v10, 0x10000, v9
    s_barrier
    v_lshrrev_b32 v24, 4, v1
    v_and_b32 v25, 1, v24
    v_lshlrev_b32 v25, 4, v25
    v_mov_b32 v26, 0x3f80
    v_lshlrev_b32 v25, v25, v26
    v_bfe_u32 v26, v24, 1, 2
    v_cmp_eq_u32 vcc, 0, v26
    s_nop 1
    v_cndmask_b32 v140, 0, v25, vcc
    v_cmp_eq_u32 vcc, 1, v26
    s_nop 1
    v_cndmask_b32 v141, 0, v25, vcc
    v_cmp_eq_u32 vcc, 2, v26
    s_nop 1
    v_cndmask_b32 v142, 0, v25, vcc
    v_cmp_eq_u32 vcc, 3, v26
    s_nop 1
    v_cndmask_b32 v143, 0, v25, vcc
    v_bfe_u32 v25, v24, 3, 1
    v_lshrrev_b32 v26, 5, v24
    v_lshl_add_u32 v26, v26, 1, v25
    v_lshlrev_b32 v25, 8, v26
    v_and_b32 v27, 7, v24
    v_lshl_add_u32 v25, v27, 5, v25
    v_bfe_u32 v27, v24, 4, 1
    v_lshl_add_u32 v25, v27, 4, v25
    v_add_u32 v27, s18, v26
    v_and_b32 v27, 15, v27
    v_lshl_add_u32 v25, v27, 14, v25
    s_lshl_b32 s44, s17, 10
    s_add_u32 s44, s44, 52428800
    s_waitcnt vmcnt(21)
    v_mfma_f32_16x16x32_bf16 v[128:131], v[140:143], v[32:35], 0
    v_mfma_f32_16x16x32_bf16 v[132:135], v[140:143], v[64:67], 0
    v_mfma_f32_16x16x32_bf16 v[136:139], v[140:143], v[96:99], 0
    s_waitcnt vmcnt(18)
    v_mfma_f32_16x16x32_bf16 v[128:131], v[140:143], v[36:39], v[128:131]
    v_mfma_f32_16x16x32_bf16 v[132:135], v[140:143], v[68:71], v[132:135]
    v_mfma_f32_16x16x32_bf16 v[136:139], v[140:143], v[100:103], v[136:139]
    s_waitcnt vmcnt(15)
    v_mfma_f32_16x16x32_bf16 v[128:131], v[140:143], v[40:43], v[128:131]
    v_mfma_f32_16x16x32_bf16 v[132:135], v[140:143], v[72:75], v[132:135]
    v_mfma_f32_16x16x32_bf16 v[136:139], v[140:143], v[104:107], v[136:139]
    s_waitcnt vmcnt(12)
    v_mfma_f32_16x16x32_bf16 v[128:131], v[140:143], v[44:47], v[128:131]
    v_mfma_f32_16x16x32_bf16 v[132:135], v[140:143], v[76:79], v[132:135]
    v_mfma_f32_16x16x32_bf16 v[136:139], v[140:143], v[108:111], v[136:139]
    s_waitcnt vmcnt(9)
    v_mfma_f32_16x16x32_bf16 v[128:131], v[140:143], v[48:51], v[128:131]
    v_mfma_f32_16x16x32_bf16 v[132:135], v[140:143], v[80:83], v[132:135]
    v_mfma_f32_16x16x32_bf16 v[136:139], v[140:143], v[112:115], v[136:139]
    s_waitcnt vmcnt(6)
    v_mfma_f32_16x16x32_bf16 v[128:131], v[140:143], v[52:55], v[128:131]
    v_mfma_f32_16x16x32_bf16 v[132:135], v[140:143], v[84:87], v[132:135]
    v_mfma_f32_16x16x32_bf16 v[136:139], v[140:143], v[116:119], v[136:139]
    s_waitcnt vmcnt(3)
    v_mfma_f32_16x16x32_bf16 v[128:131], v[140:143], v[56:59], v[128:131]
    v_mfma_f32_16x16x32_bf16 v[132:135], v[140:143], v[88:91], v[132:135]
    v_mfma_f32_16x16x32_bf16 v[136:139], v[140:143], v[120:123], v[136:139]
    s_waitcnt vmcnt(0)
    v_mfma_f32_16x16x32_bf16 v[128:131], v[140:143], v[60:63], v[128:131]
    v_mfma_f32_16x16x32_bf16 v[132:135], v[140:143], v[92:95], v[132:135]
    v_mfma_f32_16x16x32_bf16 v[136:139], v[140:143], v[124:127], v[136:139]
    s_barrier
    v_lshrrev_b32 v28, 4, v1
    v_and_b32 v29, 7, v28
    v_lshrrev_b32 v28, 3, v28
    v_mul_u32_u24 v28, 6144, v28
    v_lshl_add_u32 v28, v29, 4, v28
    s_and_b32 s3, s18, 12
    s_or_b32 s3, s3, 3
    s_lshl_b32 s3, s3, 7
    v_add_u32 v28, s3, v28
    s_lshr_b32 s3, s2, 3
    s_lshl_b32 s3, s3, 2
    s_and_b32 s60, s16, 3
    s_add_u32 s60, s60, s3
    s_lshr_b32 s60, s60, 2
    s_mul_i32 s60, s60, 49152
    s_and_b32 s3, s18, 0
    s_xor_b32 s3, s3, 4
    s_mul_i32 s3, s3, 393216
    s_add_u32 s3, s3, s60
    s_add_u32 s61, s3, 0
    buffer_load_dwordx4 v[160:163], v28, s[8:11], s61 offen
    s_add_u32 s61, s3, 2048
    buffer_load_dwordx4 v[164:167], v28, s[8:11], s61 offen
    s_add_u32 s61, s3, 4096
    buffer_load_dwordx4 v[168:171], v28, s[8:11], s61 offen
    s_and_b32 s3, s18, 0
    s_xor_b32 s3, s3, 8
    s_mul_i32 s3, s3, 393216
    s_add_u32 s3, s3, s60
    s_add_u32 s61, s3, 0
    buffer_load_dwordx4 v[172:175], v28, s[8:11], s61 offen
    s_add_u32 s61, s3, 2048
    buffer_load_dwordx4 v[176:179], v28, s[8:11], s61 offen
    s_add_u32 s61, s3, 4096
    buffer_load_dwordx4 v[180:183], v28, s[8:11], s61 offen
    s_and_b32 s3, s18, 0
    s_xor_b32 s3, s3, 12
    s_mul_i32 s3, s3, 393216
    s_add_u32 s3, s3, s60
    s_add_u32 s61, s3, 0
    buffer_load_dwordx4 v[184:187], v28, s[8:11], s61 offen
    s_add_u32 s61, s3, 2048
    buffer_load_dwordx4 v[188:191], v28, s[8:11], s61 offen
    s_add_u32 s61, s3, 4096
    buffer_load_dwordx4 v[192:195], v28, s[8:11], s61 offen
    v_add_f32_dpp v128, v128, v128 row_ror:8 row_mask:0xf bank_mask:0xf
    v_add_f32_dpp v129, v129, v129 row_ror:8 row_mask:0xf bank_mask:0xf
    v_add_f32_dpp v130, v130, v130 row_ror:8 row_mask:0xf bank_mask:0xf
    v_add_f32_dpp v131, v131, v131 row_ror:8 row_mask:0xf bank_mask:0xf
    v_add_f32_dpp v132, v132, v132 row_ror:8 row_mask:0xf bank_mask:0xf
    v_add_f32_dpp v133, v133, v133 row_ror:8 row_mask:0xf bank_mask:0xf
    v_add_f32_dpp v134, v134, v134 row_ror:8 row_mask:0xf bank_mask:0xf
    v_add_f32_dpp v135, v135, v135 row_ror:8 row_mask:0xf bank_mask:0xf
    v_add_f32_dpp v136, v136, v136 row_ror:8 row_mask:0xf bank_mask:0xf
    v_add_f32_dpp v137, v137, v137 row_ror:8 row_mask:0xf bank_mask:0xf
    v_add_f32_dpp v138, v138, v138 row_ror:8 row_mask:0xf bank_mask:0xf
    v_add_f32_dpp v139, v139, v139 row_ror:8 row_mask:0xf bank_mask:0xf
    v_cmp_le_u32 vcc, 1, v26
    s_nop 1
    v_cndmask_b32 v128, v128, v132, vcc
    v_cndmask_b32 v129, v129, v133, vcc
    v_cndmask_b32 v130, v130, v134, vcc
    v_cndmask_b32 v131, v131, v135, vcc
    v_cmp_le_u32 vcc, 2, v26
    s_nop 1
    v_cndmask_b32 v128, v128, v136, vcc
    v_cndmask_b32 v129, v129, v137, vcc
    v_cndmask_b32 v130, v130, v138, vcc
    v_cndmask_b32 v131, v131, v139, vcc
    buffer_store_dwordx4 v[128:131], v25, s[4:7], s44 offen sc1
    s_barrier
    s_barrier
    s_waitcnt vmcnt(0)
    s_add_u32 s44, s18, 0
    s_and_b32 s44, s44, 15
    s_lshl_b32 s44, s44, 7
    s_add_u32 s44, s44, 0
    s_atomic_add s40, s[22:23], s44
    s_add_u32 s45, s18, 1
    s_and_b32 s45, s45, 15
    s_lshl_b32 s45, s45, 7
    s_add_u32 s45, s45, 0
    s_atomic_add s40, s[22:23], s45
    s_add_u32 s46, s18, 2
    s_and_b32 s46, s46, 15
    s_lshl_b32 s46, s46, 7
    s_add_u32 s46, s46, 0
    s_atomic_add s40, s[22:23], s46
    s_barrier
    s_barrier
    s_barrier
    s_barrier
    s_barrier
    s_barrier
    s_mov_b32 s12, s26
    s_mov_b32 s13, s27
    s_mov_b32 s14, 2097152
    s_mov_b32 s15, 0x00020000
    s_lshl_b32 s44, s2, 13
    buffer_load_dwordx4 v[160:163], v1, s[12:15], s44 offen offset:0
    buffer_load_dwordx4 v[164:167], v1, s[12:15], s44 offen offset:1024
    buffer_load_dwordx4 v[168:171], v1, s[12:15], s44 offen offset:2048
    buffer_load_dwordx4 v[172:175], v1, s[12:15], s44 offen offset:3072
    s_add_u32 s44, s44, 4096
    buffer_load_dwordx4 v[176:179], v1, s[12:15], s44 offen offset:0
    buffer_load_dwordx4 v[180:183], v1, s[12:15], s44 offen offset:1024
    buffer_load_dwordx4 v[184:187], v1, s[12:15], s44 offen offset:2048
    buffer_load_dwordx4 v[188:191], v1, s[12:15], s44 offen offset:3072
    s_mov_b32 s8, s28
    s_mov_b32 s9, s29
    s_mov_b32 s10, 6291456
    s_mov_b32 s11, 0x00020000
    s_mul_i32 s44, s17, 393216
    buffer_load_dwordx4 v[32:35], v20, s[8:11], s44 offen
    buffer_load_dwordx4 v[64:67], v21, s[8:11], s44 offen
    buffer_load_dwordx4 v[96:99], v22, s[8:11], s44 offen
    s_add_u32 s44, s44, 49152
    buffer_load_dwordx4 v[36:39], v20, s[8:11], s44 offen
    buffer_load_dwordx4 v[68:71], v21, s[8:11], s44 offen
    buffer_load_dwordx4 v[100:103], v22, s[8:11], s44 offen
    s_add_u32 s44, s44, 49152
    buffer_load_dwordx4 v[40:43], v20, s[8:11], s44 offen
    buffer_load_dwordx4 v[72:75], v21, s[8:11], s44 offen
    buffer_load_dwordx4 v[104:107], v22, s[8:11], s44 offen
    s_add_u32 s44, s44, 49152
    s_barrier
    buffer_load_dwordx4 v[44:47], v20, s[8:11], s44 offen
    buffer_load_dwordx4 v[76:79], v21, s[8:11], s44 offen
    buffer_load_dwordx4 v[108:111], v22, s[8:11], s44 offen
    s_add_u32 s44, s44, 49152
    buffer_load_dwordx4 v[48:51], v20, s[8:11], s44 offen
    buffer_load_dwordx4 v[80:83], v21, s[8:11], s44 offen
    buffer_load_dwordx4 v[112:115], v22, s[8:11], s44 offen
    s_add_u32 s44, s44, 49152
    buffer_load_dwordx4 v[52:55], v20, s[8:11], s44 offen
    buffer_load_dwordx4 v[84:87], v21, s[8:11], s44 offen
    buffer_load_dwordx4 v[116:119], v22, s[8:11], s44 offen
    s_add_u32 s44, s44, 49152
    buffer_load_dwordx4 v[56:59], v20, s[8:11], s44 offen
    buffer_load_dwordx4 v[88:91], v21, s[8:11], s44 offen
    buffer_load_dwordx4 v[120:123], v22, s[8:11], s44 offen
    s_add_u32 s44, s44, 49152
    buffer_load_dwordx4 v[60:63], v20, s[8:11], s44 offen
    buffer_load_dwordx4 v[92:95], v21, s[8:11], s44 offen
    buffer_load_dwordx4 v[124:127], v22, s[8:11], s44 offen
    s_barrier
    s_bitcmp1_b32 s21, 0
    s_cselect_b32 s8, s28, s24
    s_cselect_b32 s9, s29, s25
    s_cselect_b32 s12, s30, s26
    s_cselect_b32 s13, s31, s27
    s_mov_b32 s10, 6291456
    s_mov_b32 s11, 0x00020000
    s_mov_b32 s14, 2097152
    s_mov_b32 s15, 0x00020000
    s_branch s_tail
z_layer:
    s_waitcnt lgkmcnt(0)
    v_lshrrev_b32 v28, 4, v1
    v_and_b32 v29, 7, v28
    v_lshrrev_b32 v28, 3, v28
    v_mul_u32_u24 v28, 6144, v28
    v_lshl_add_u32 v28, v29, 4, v28
    s_and_b32 s3, s18, 12
    s_or_b32 s3, s3, 3
    s_lshl_b32 s3, s3, 7
    v_add_u32 v28, s3, v28
    s_lshr_b32 s3, s2, 3
    s_lshl_b32 s3, s3, 2
    s_and_b32 s60, s16, 3
    s_add_u32 s60, s60, s3
    s_lshr_b32 s60, s60, 2
    s_mul_i32 s60, s60, 49152
    s_and_b32 s3, s18, 0
    s_xor_b32 s3, s3, 4
    s_mul_i32 s3, s3, 393216
    s_add_u32 s3, s3, s60
    s_add_u32 s61, s3, 0
    buffer_load_dwordx4 v[160:163], v28, s[8:11], s61 offen
    s_add_u32 s61, s3, 2048
    buffer_load_dwordx4 v[164:167], v28, s[8:11], s61 offen
    s_add_u32 s61, s3, 4096
    buffer_load_dwordx4 v[168:171], v28, s[8:11], s61 offen
    s_and_b32 s3, s18, 0
    s_xor_b32 s3, s3, 8
    s_mul_i32 s3, s3, 393216
    s_add_u32 s3, s3, s60
    s_add_u32 s61, s3, 0
    buffer_load_dwordx4 v[172:175], v28, s[8:11], s61 offen
    s_add_u32 s61, s3, 2048
    buffer_load_dwordx4 v[176:179], v28, s[8:11], s61 offen
    s_add_u32 s61, s3, 4096
    buffer_load_dwordx4 v[180:183], v28, s[8:11], s61 offen
    s_and_b32 s3, s18, 0
    s_xor_b32 s3, s3, 12
    s_mul_i32 s3, s3, 393216
    s_add_u32 s3, s3, s60
    s_add_u32 s61, s3, 0
    buffer_load_dwordx4 v[184:187], v28, s[8:11], s61 offen
    s_add_u32 s61, s3, 2048
    buffer_load_dwordx4 v[188:191], v28, s[8:11], s61 offen
    s_add_u32 s61, s3, 4096
    buffer_load_dwordx4 v[192:195], v28, s[8:11], s61 offen
    s_barrier
    s_barrier
    s_barrier
    s_barrier
    s_barrier
    s_barrier
    s_barrier
    s_barrier
    s_barrier
    s_barrier
    v_lshrrev_b32 v28, 4, v1
    v_and_b32 v29, 7, v28
    v_lshrrev_b32 v28, 3, v28
    v_mul_u32_u24 v28, 2048, v28
    v_lshl_add_u32 v28, v29, 4, v28
    s_and_b32 s3, s18, 12
    s_or_b32 s3, s3, 3
    s_lshl_b32 s3, s3, 7
    v_add_u32 v28, s3, v28
    s_lshr_b32 s3, s2, 3
    s_lshl_b32 s3, s3, 2
    s_and_b32 s60, s16, 3
    s_add_u32 s60, s60, s3
    s_lshl_b32 s61, s60, 14
    buffer_load_dwordx4 v[144:147], v28, s[12:15], s61 offen
    s_bitcmp0_b32 s21, 0
    s_cselect_b32 s56, s28, s24
    s_cselect_b32 s57, s29, s25
    s_mov_b32 s58, 6291456
    s_mov_b32 s59, 0x00020000
    v_lshrrev_b32 v28, 4, v1
    v_and_b32 v29, 7, v28
    v_lshrrev_b32 v28, 3, v28
    v_mul_u32_u24 v28, 6144, v28
    v_lshl_add_u32 v28, v29, 4, v28
    s_and_b32 s3, s18, 12
    s_or_b32 s3, s3, 3
    s_lshl_b32 s3, s3, 7
    v_add_u32 v28, s3, v28
    s_lshr_b32 s3, s2, 3
    s_lshl_b32 s3, s3, 2
    s_and_b32 s60, s16, 3
    s_add_u32 s60, s60, s3
    s_and_b32 s3, s60, 31
    s_mul_i32 s3, s3, 49152
    s_lshr_b32 s61, s60, 5
    s_min_u32 s61, s61, 2
    s_lshl_b32 s61, s61, 11
    s_add_u32 s61, s61, s3
    s_and_b32 s3, s18, 0
    s_mul_i32 s3, s3, 393216
    s_add_u32 s61, s61, s3
    buffer_load_dwordx4 v[148:151], v28, s[56:59], s61 offen
    s_cmp_lg_u32 s21, 2
    s_cbranch_scc1 z_pe
    s_bitcmp0_b32 s21, 0
    s_cselect_b32 s56, s28, s24
    s_cselect_b32 s57, s29, s25
    s_mov_b32 s58, 6291456
    s_mov_b32 s59, 0x00020000
    s_add_u32 s61, s84, 2048
    buffer_load_dwordx4 v[160:163], v11, s[56:59], s61 offen
    s_add_u32 s61, s84, 4096
    buffer_load_dwordx4 v[164:167], v11, s[56:59], s61 offen
    s_add_u32 s61, s84, 0
    buffer_load_dwordx4 v[168:171], v11, s[56:59], s61 offen
    s_add_u32 s61, s84, 198656
    buffer_load_dwordx4 v[172:175], v11, s[56:59], s61 offen
    s_add_u32 s61, s84, 200704
    buffer_load_dwordx4 v[176:179], v11, s[56:59], s61 offen
    s_add_u32 s61, s84, 196608
    buffer_load_dwordx4 v[180:183], v11, s[56:59], s61 offen
    s_add_u32 s61, s85, 2048
    buffer_load_dwordx4 v[184:187], v11, s[56:59], s61 offen
    s_add_u32 s61, s85, 4096
    buffer_load_dwordx4 v[188:191], v11, s[56:59], s61 offen
    s_add_u32 s61, s85, 0
    buffer_load_dwordx4 v[192:195], v11, s[56:59], s61 offen
    s_add_u32 s61, s85, 198656
    buffer_load_dwordx4 v[196:199], v11, s[56:59], s61 offen
z_pe:
    s_barrier
    s_branch s_tail
s_tail:
    s_bitcmp1_b32 s21, 0
    s_cbranch_scc1 s_B
    s_cmp_lg_u32 s16, 4
    s_cbranch_scc1 s_a1
    s_mov_b32 s45, 2146435072
    s_cmp_eq_u32 s17, 0
    s_cbranch_scc1 s_a0
    s_lshr_b32 s46, s21, 1
    s_lshl_b32 s44, s46, 15
    s_lshl_b32 s67, s17, 11
    s_add_u32 s44, s44, s67
    s_lshl_b32 s67, s18, 7
    s_add_u32 s44, s44, s67
    s_add_u32 s44, s44, 149504
    s_sub_u32 s45, s44, 151552
    s_lshl_b32 s45, s45, 5
    s_add_u32 s45, s45, 54525952
    s_mov_b32 s66, 0x10000
s_h_poll:
    s_mov_b32 s68, 0
    s_atomic_add s68, s[22:23], s44 offset:0 glc
    s_sub_u32 s66, s66, 1
    s_cselect_b32 s67, 1, 0
    s_waitcnt lgkmcnt(0)
    s_max_u32 s68, s68, s67
    s_cmp_lt_u32 s68, 1
    s_cbranch_scc1 s_h_poll
s_h_ok:
s_a0:
    s_mov_b32 m0, 131072
    s_nop 0
    buffer_load_dwordx4 v1, s[4:7], s45 offen offset:0 sc1 lds
    buffer_load_dwordx4 v1, s[4:7], s45 offen offset:1024 sc1 lds
    buffer_load_dwordx4 v1, s[4:7], s45 offen offset:2048 sc1 lds
    buffer_load_dwordx4 v1, s[4:7], s45 offen offset:3072 sc1 lds
    s_waitcnt vmcnt(0)
s_a1:
    s_barrier
    s_waitcnt vmcnt(0)
    s_barrier
    s_sub_u32 s3, s16, 5
    s_cmp_gt_u32 s3, 1
    s_cbranch_scc1 s_a2
    s_add_u32 m0, s41, 65536
    s_xor_b32 s44, s62, 65536
    buffer_load_dwordx4 v16, s[12:15], s44 offen offset:0 lds
    buffer_load_dwordx4 v17, s[12:15], s44 offen offset:1024 lds
    s_add_u32 m0, s41, 69632
    s_xor_b32 s44, s62, 196608
    buffer_load_dwordx4 v16, s[12:15], s44 offen offset:0 lds
    buffer_load_dwordx4 v17, s[12:15], s44 offen offset:1024 lds
    s_add_u32 m0, s41, 73728
    s_xor_b32 s44, s62, 327680
    buffer_load_dwordx4 v16, s[12:15], s44 offen offset:0 lds
    buffer_load_dwordx4 v17, s[12:15], s44 offen offset:1024 lds
    s_add_u32 m0, s41, 77824
    s_xor_b32 s44, s62, 458752
    buffer_load_dwordx4 v16, s[12:15], s44 offen offset:0 lds
    buffer_load_dwordx4 v17, s[12:15], s44 offen offset:1024 lds
    s_add_u32 m0, s41, 81920
    s_xor_b32 s44, s62, 589824
    buffer_load_dwordx4 v16, s[12:15], s44 offen offset:0 lds
    buffer_load_dwordx4 v17, s[12:15], s44 offen offset:1024 lds
    s_add_u32 m0, s41, 86016
    s_xor_b32 s44, s62, 720896
    buffer_load_dwordx4 v16, s[12:15], s44 offen offset:0 lds
    buffer_load_dwordx4 v17, s[12:15], s44 offen offset:1024 lds
    s_add_u32 m0, s41, 90112
    s_xor_b32 s44, s62, 851968
    buffer_load_dwordx4 v16, s[12:15], s44 offen offset:0 lds
    buffer_load_dwordx4 v17, s[12:15], s44 offen offset:1024 lds
    s_add_u32 m0, s41, 94208
    s_xor_b32 s44, s62, 983040
    buffer_load_dwordx4 v16, s[12:15], s44 offen offset:0 lds
    buffer_load_dwordx4 v17, s[12:15], s44 offen offset:1024 lds
    s_add_u32 m0, s41, 98304
    s_xor_b32 s44, s62, 1114112
    buffer_load_dwordx4 v16, s[12:15], s44 offen offset:0 lds
    buffer_load_dwordx4 v17, s[12:15], s44 offen offset:1024 lds
    s_add_u32 m0, s41, 102400
    s_xor_b32 s44, s62, 1245184
    buffer_load_dwordx4 v16, s[12:15], s44 offen offset:0 lds
    buffer_load_dwordx4 v17, s[12:15], s44 offen offset:1024 lds
    s_add_u32 m0, s41, 106496
    s_xor_b32 s44, s62, 1376256
    buffer_load_dwordx4 v16, s[12:15], s44 offen offset:0 lds
    buffer_load_dwordx4 v17, s[12:15], s44 offen offset:1024 lds
    s_add_u32 m0, s41, 110592
    s_xor_b32 s44, s62, 1507328
    buffer_load_dwordx4 v16, s[12:15], s44 offen offset:0 lds
    buffer_load_dwordx4 v17, s[12:15], s44 offen offset:1024 lds
    s_add_u32 m0, s41, 114688
    s_xor_b32 s44, s62, 1638400
    buffer_load_dwordx4 v16, s[12:15], s44 offen offset:0 lds
    buffer_load_dwordx4 v17, s[12:15], s44 offen offset:1024 lds
    s_add_u32 m0, s41, 118784
    s_xor_b32 s44, s62, 1769472
    buffer_load_dwordx4 v16, s[12:15], s44 offen offset:0 lds
    buffer_load_dwordx4 v17, s[12:15], s44 offen offset:1024 lds
    s_add_u32 m0, s41, 122880
    s_xor_b32 s44, s62, 1900544
    buffer_load_dwordx4 v16, s[12:15], s44 offen offset:0 lds
    buffer_load_dwordx4 v17, s[12:15], s44 offen offset:1024 lds
    s_add_u32 m0, s41, 126976
    s_xor_b32 s44, s62, 2031616
    buffer_load_dwordx4 v16, s[12:15], s44 offen offset:0 lds
    buffer_load_dwordx4 v17, s[12:15], s44 offen offset:1024 lds
s_a2:
    s_cmp_eq_u32 s21, 2
    s_cbranch_scc1 s_a3
    s_bitcmp0_b32 s21, 0
    s_cselect_b32 s56, s28, s24
    s_cselect_b32 s57, s29, s25
    s_mov_b32 s58, 6291456
    s_mov_b32 s59, 0x00020000
    s_add_u32 s61, s84, 2048
    buffer_load_dwordx4 v[160:163], v11, s[56:59], s61 offen
    s_add_u32 s61, s84, 4096
    buffer_load_dwordx4 v[164:167], v11, s[56:59], s61 offen
    s_add_u32 s61, s84, 0
    buffer_load_dwordx4 v[168:171], v11, s[56:59], s61 offen
    s_add_u32 s61, s84, 198656
    buffer_load_dwordx4 v[172:175], v11, s[56:59], s61 offen
    s_add_u32 s61, s84, 200704
    buffer_load_dwordx4 v[176:179], v11, s[56:59], s61 offen
    s_add_u32 s61, s84, 196608
    buffer_load_dwordx4 v[180:183], v11, s[56:59], s61 offen
    s_add_u32 s61, s85, 2048
    buffer_load_dwordx4 v[184:187], v11, s[56:59], s61 offen
    s_add_u32 s61, s85, 4096
    buffer_load_dwordx4 v[188:191], v11, s[56:59], s61 offen
    s_add_u32 s61, s85, 0
    buffer_load_dwordx4 v[192:195], v11, s[56:59], s61 offen
    s_add_u32 s61, s85, 198656
    buffer_load_dwordx4 v[196:199], v11, s[56:59], s61 offen
s_a3:
    s_bitcmp0_b32 s21, 0
    s_cselect_b32 s56, s28, s24
    s_cselect_b32 s57, s29, s25
    s_mov_b32 s58, 6291456
    s_mov_b32 s59, 0x00020000
    s_add_u32 s61, s85, 200704
    buffer_load_dwordx4 v[200:203], v11, s[56:59], s61 offen
    s_add_u32 s61, s85, 196608
    buffer_load_dwordx4 v[204:207], v11, s[56:59], s61 offen
    s_add_u32 s61, s86, 2048
    buffer_load_dwordx4 v[208:211], v11, s[56:59], s61 offen
    s_add_u32 s61, s86, 4096
    buffer_load_dwordx4 v[212:215], v11, s[56:59], s61 offen
    s_add_u32 s61, s86, 0
    buffer_load_dwordx4 v[216:219], v11, s[56:59], s61 offen
    s_add_u32 s61, s86, 198656
    buffer_load_dwordx4 v[220:223], v11, s[56:59], s61 offen
    s_add_u32 s61, s86, 200704
    buffer_load_dwordx4 v[224:227], v11, s[56:59], s61 offen
    s_add_u32 s61, s86, 196608
    buffer_load_dwordx4 v[228:231], v11, s[56:59], s61 offen
    s_add_u32 s61, s87, 2048
    buffer_load_dwordx4 v[232:235], v11, s[56:59], s61 offen
    s_add_u32 s61, s87, 4096
    buffer_load_dwordx4 v[236:239], v11, s[56:59], s61 offen
    s_add_u32 s61, s87, 0
    buffer_load_dwordx4 v[240:243], v11, s[56:59], s61 offen
    s_add_u32 s61, s87, 198656
    buffer_load_dwordx4 v[244:247], v11, s[56:59], s61 offen
    s_add_u32 s61, s87, 200704
    buffer_load_dwordx4 v[248:251], v11, s[56:59], s61 offen
    s_add_u32 s61, s87, 196608
    buffer_load_dwordx4 v[252:255], v11, s[56:59], s61 offen
    s_waitcnt vmcnt(0)
    s_lshl_b32 s3, s21, 3
    s_add_u32 s3, s3, s16
    s_cmp_lg_u32 s3, 7
    s_cbranch_scc1 s_g3
    v_lshrrev_b32 v24, 4, v1
    v_and_b32 v25, 1, v24
    v_lshlrev_b32 v25, 4, v25
    v_mov_b32 v26, 0x3f80
    v_lshlrev_b32 v25, v25, v26
    v_bfe_u32 v26, v24, 1, 2
    v_cmp_eq_u32 vcc, 0, v26
    s_nop 1
    v_cndmask_b32 v140, 0, v25, vcc
    v_cmp_eq_u32 vcc, 1, v26
    s_nop 1
    v_cndmask_b32 v141, 0, v25, vcc
    v_cmp_eq_u32 vcc, 2, v26
    s_nop 1
    v_cndmask_b32 v142, 0, v25, vcc
    v_cmp_eq_u32 vcc, 3, v26
    s_nop 1
    v_cndmask_b32 v143, 0, v25, vcc
    v_bfe_u32 v25, v24, 3, 1
    v_lshrrev_b32 v26, 5, v24
    v_lshl_add_u32 v26, v26, 1, v25
    v_lshlrev_b32 v25, 8, v26
    v_and_b32 v27, 7, v24
    v_lshl_add_u32 v25, v27, 5, v25
    v_bfe_u32 v27, v24, 4, 1
    v_lshl_add_u32 v25, v27, 4, v25
    v_add_u32 v27, s18, v26
    v_and_b32 v27, 15, v27
    v_lshl_add_u32 v25, v27, 14, v25
    s_lshl_b32 s44, s17, 10
    s_add_u32 s44, s44, 52690944
    v_mfma_f32_16x16x32_bf16 v[128:131], v[140:143], v[32:35], 0
    v_mfma_f32_16x16x32_bf16 v[132:135], v[140:143], v[64:67], 0
    v_mfma_f32_16x16x32_bf16 v[136:139], v[140:143], v[96:99], 0
    v_mfma_f32_16x16x32_bf16 v[128:131], v[140:143], v[36:39], v[128:131]
    v_mfma_f32_16x16x32_bf16 v[132:135], v[140:143], v[68:71], v[132:135]
    v_mfma_f32_16x16x32_bf16 v[136:139], v[140:143], v[100:103], v[136:139]
    v_mfma_f32_16x16x32_bf16 v[128:131], v[140:143], v[40:43], v[128:131]
    v_mfma_f32_16x16x32_bf16 v[132:135], v[140:143], v[72:75], v[132:135]
    v_mfma_f32_16x16x32_bf16 v[136:139], v[140:143], v[104:107], v[136:139]
    v_mfma_f32_16x16x32_bf16 v[128:131], v[140:143], v[44:47], v[128:131]
    v_mfma_f32_16x16x32_bf16 v[132:135], v[140:143], v[76:79], v[132:135]
    v_mfma_f32_16x16x32_bf16 v[136:139], v[140:143], v[108:111], v[136:139]
    v_mfma_f32_16x16x32_bf16 v[128:131], v[140:143], v[48:51], v[128:131]
    v_mfma_f32_16x16x32_bf16 v[132:135], v[140:143], v[80:83], v[132:135]
    v_mfma_f32_16x16x32_bf16 v[136:139], v[140:143], v[112:115], v[136:139]
    v_mfma_f32_16x16x32_bf16 v[128:131], v[140:143], v[52:55], v[128:131]
    v_mfma_f32_16x16x32_bf16 v[132:135], v[140:143], v[84:87], v[132:135]
    v_mfma_f32_16x16x32_bf16 v[136:139], v[140:143], v[116:119], v[136:139]
    v_mfma_f32_16x16x32_bf16 v[128:131], v[140:143], v[56:59], v[128:131]
    v_mfma_f32_16x16x32_bf16 v[132:135], v[140:143], v[88:91], v[132:135]
    v_mfma_f32_16x16x32_bf16 v[136:139], v[140:143], v[120:123], v[136:139]
    v_mfma_f32_16x16x32_bf16 v[128:131], v[140:143], v[60:63], v[128:131]
    v_mfma_f32_16x16x32_bf16 v[132:135], v[140:143], v[92:95], v[132:135]
    v_mfma_f32_16x16x32_bf16 v[136:139], v[140:143], v[124:127], v[136:139]
    s_nop 5
    v_add_f32_dpp v128, v128, v128 row_ror:8 row_mask:0xf bank_mask:0xf
    v_add_f32_dpp v129, v129, v129 row_ror:8 row_mask:0xf bank_mask:0xf
    v_add_f32_dpp v130, v130, v130 row_ror:8 row_mask:0xf bank_mask:0xf
    v_add_f32_dpp v131, v131, v131 row_ror:8 row_mask:0xf bank_mask:0xf
    v_add_f32_dpp v132, v132, v132 row_ror:8 row_mask:0xf bank_mask:0xf
    v_add_f32_dpp v133, v133, v133 row_ror:8 row_mask:0xf bank_mask:0xf
    v_add_f32_dpp v134, v134, v134 row_ror:8 row_mask:0xf bank_mask:0xf
    v_add_f32_dpp v135, v135, v135 row_ror:8 row_mask:0xf bank_mask:0xf
    v_add_f32_dpp v136, v136, v136 row_ror:8 row_mask:0xf bank_mask:0xf
    v_add_f32_dpp v137, v137, v137 row_ror:8 row_mask:0xf bank_mask:0xf
    v_add_f32_dpp v138, v138, v138 row_ror:8 row_mask:0xf bank_mask:0xf
    v_add_f32_dpp v139, v139, v139 row_ror:8 row_mask:0xf bank_mask:0xf
    v_cmp_le_u32 vcc, 1, v26
    s_nop 1
    v_cndmask_b32 v128, v128, v132, vcc
    v_cndmask_b32 v129, v129, v133, vcc
    v_cndmask_b32 v130, v130, v134, vcc
    v_cndmask_b32 v131, v131, v135, vcc
    v_cmp_le_u32 vcc, 2, v26
    s_nop 1
    v_cndmask_b32 v128, v128, v136, vcc
    v_cndmask_b32 v129, v129, v137, vcc
    v_cndmask_b32 v130, v130, v138, vcc
    v_cndmask_b32 v131, v131, v139, vcc
    buffer_store_dwordx4 v[128:131], v25, s[4:7], s44 offen sc1
    s_waitcnt vmcnt(0)
    s_add_u32 s44, s18, 0
    s_and_b32 s44, s44, 15
    s_lshl_b32 s44, s44, 7
    s_add_u32 s44, s44, 2048
    s_atomic_add s40, s[22:23], s44
    s_add_u32 s45, s18, 1
    s_and_b32 s45, s45, 15
    s_lshl_b32 s45, s45, 7
    s_add_u32 s45, s45, 2048
    s_atomic_add s40, s[22:23], s45
    s_add_u32 s46, s18, 2
    s_and_b32 s46, s46, 15
    s_lshl_b32 s46, s46, 7
    s_add_u32 s46, s46, 2048
    s_atomic_add s40, s[22:23], s46
    s_branch s_g3
s_B:
    s_barrier
    s_cmp_eq_u32 s21, 3
    s_cbranch_scc1 s_nopf
    s_bitcmp0_b32 s21, 0
    s_cselect_b32 s56, s28, s24
    s_cselect_b32 s57, s29, s25
    s_mov_b32 s58, 6291456
    s_mov_b32 s59, 0x00020000
    s_add_u32 s61, s84, 2048
    buffer_load_dwordx4 v[160:163], v11, s[56:59], s61 offen
    s_add_u32 s61, s84, 4096
    buffer_load_dwordx4 v[164:167], v11, s[56:59], s61 offen
    s_add_u32 s61, s84, 0
    buffer_load_dwordx4 v[168:171], v11, s[56:59], s61 offen
    s_add_u32 s61, s84, 198656
    buffer_load_dwordx4 v[172:175], v11, s[56:59], s61 offen
    s_waitcnt vmcnt(2)
    s_add_u32 s61, s84, 200704
    buffer_load_dwordx4 v[176:179], v11, s[56:59], s61 offen
    s_add_u32 s61, s84, 196608
    buffer_load_dwordx4 v[180:183], v11, s[56:59], s61 offen
    s_add_u32 s61, s85, 2048
    buffer_load_dwordx4 v[184:187], v11, s[56:59], s61 offen
    s_add_u32 s61, s85, 4096
    buffer_load_dwordx4 v[188:191], v11, s[56:59], s61 offen
    s_waitcnt vmcnt(2)
    s_add_u32 s61, s85, 0
    buffer_load_dwordx4 v[192:195], v11, s[56:59], s61 offen
    s_add_u32 s61, s85, 198656
    buffer_load_dwordx4 v[196:199], v11, s[56:59], s61 offen
    s_add_u32 s61, s85, 200704
    buffer_load_dwordx4 v[200:203], v11, s[56:59], s61 offen
    s_add_u32 s61, s85, 196608
    buffer_load_dwordx4 v[204:207], v11, s[56:59], s61 offen
    s_waitcnt vmcnt(2)
    s_add_u32 s61, s86, 2048
    buffer_load_dwordx4 v[208:211], v11, s[56:59], s61 offen
    s_add_u32 s61, s86, 4096
    buffer_load_dwordx4 v[212:215], v11, s[56:59], s61 offen
    s_add_u32 s61, s86, 0
    buffer_load_dwordx4 v[216:219], v11, s[56:59], s61 offen
    s_add_u32 s61, s86, 198656
    buffer_load_dwordx4 v[220:223], v11, s[56:59], s61 offen
    s_waitcnt vmcnt(2)
    s_add_u32 s61, s86, 200704
    buffer_load_dwordx4 v[224:227], v11, s[56:59], s61 offen
    s_add_u32 s61, s86, 196608
    buffer_load_dwordx4 v[228:231], v11, s[56:59], s61 offen
    s_add_u32 s61, s87, 2048
    buffer_load_dwordx4 v[232:235], v11, s[56:59], s61 offen
    s_add_u32 s61, s87, 4096
    buffer_load_dwordx4 v[236:239], v11, s[56:59], s61 offen
    s_waitcnt vmcnt(2)
    s_add_u32 s61, s87, 0
    buffer_load_dwordx4 v[240:243], v11, s[56:59], s61 offen
    s_add_u32 s61, s87, 198656
    buffer_load_dwordx4 v[244:247], v11, s[56:59], s61 offen
    s_add_u32 s61, s87, 200704
    buffer_load_dwordx4 v[248:251], v11, s[56:59], s61 offen
    s_add_u32 s61, s87, 196608
    buffer_load_dwordx4 v[252:255], v11, s[56:59], s61 offen
    s_waitcnt vmcnt(2)
    s_lshl_b32 s3, s2, 2
    s_and_b32 s60, s16, 3
    s_add_u32 s60, s60, s3
    s_lshl_b32 s60, s60, 11
    buffer_load_dwordx4 v[96:99], v1, s[12:15], s60 offen offset:0
    buffer_load_dwordx4 v[100:103], v1, s[12:15], s60 offen offset:1024
s_nopf:
    s_setprio 3
    s_mov_b32 s52, 0
    s_lshl_b32 s44, s16, 14
    v_add_u32 v24, s44, v1
    s_and_b32 s3, s16, 3
    s_lshl_b32 s44, s3, 10
    s_add_u32 s44, s44, 147456
    v_lshrrev_b32 v25, 2, v1
    v_add_u32 v25, s44, v25
    s_lshl_b32 s53, s21, 22
    s_lshl_b32 s44, s38, 16
    s_add_u32 s53, s53, s44
    s_lshl_b32 s44, s18, 12
    s_add_u32 s53, s53, s44
    s_add_u32 s53, s53, 16777216
    s_lshl_b32 s54, s21, 14
    s_lshl_b32 s67, s38, 8
    s_add_u32 s54, s54, s67
    s_add_u32 s54, s54, 86016
s_bhead:
    s_barrier
    s_waitcnt vmcnt(0) lgkmcnt(0)
    s_barrier
    ds_read_b32 v28, v25 offset:0
    ds_read_b32 v29, v25 offset:256
    ds_read_b32 v30, v25 offset:512
    ds_read_b32 v31, v25 offset:768
    ds_read_b128 v[32:35], v24 offset:0
    ds_read_b128 v[36:39], v24 offset:1024
    ds_read_b128 v[40:43], v24 offset:2048
    ds_read_b128 v[44:47], v24 offset:3072
    ds_read_b128 v[48:51], v24 offset:4096
    ds_read_b128 v[52:55], v24 offset:5120
    ds_read_b128 v[56:59], v24 offset:6144
    ds_read_b128 v[60:63], v24 offset:7168
    ds_read_b128 v[64:67], v24 offset:8192
    ds_read_b128 v[68:71], v24 offset:9216
    ds_read_b128 v[72:75], v24 offset:10240
    ds_read_b128 v[76:79], v24 offset:11264
    ds_read_b128 v[80:83], v24 offset:12288
    ds_read_b128 v[84:87], v24 offset:13312
    ds_read_b128 v[88:91], v24 offset:14336
    ds_read_b128 v[92:95], v24 offset:15360
    s_waitcnt lgkmcnt(14)
    v_add_f32 v28, v28, v29
    v_add_f32 v30, v30, v31
    v_add_f32 v28, v28, v30
    v_mov_b32 v29, 0x5d800000
    v_mov_b32 v30, 0x21800000
    v_cmp_nlt_f32 s[44:45], v28, v29
    v_cmp_ngt_f32 vcc, v28, v30
    v_rcp_f32 v28, v28
    s_or_b64 vcc, vcc, s[44:45]
    s_waitcnt lgkmcnt(8)
    v_pk_add_f32 v[32:33], v[32:33], v[48:49]
    v_pk_add_f32 v[34:35], v[34:35], v[50:51]
    v_pk_add_f32 v[36:37], v[36:37], v[52:53]
    v_pk_add_f32 v[38:39], v[38:39], v[54:55]
    v_pk_add_f32 v[40:41], v[40:41], v[56:57]
    v_pk_add_f32 v[42:43], v[42:43], v[58:59]
    v_pk_add_f32 v[44:45], v[44:45], v[60:61]
    v_pk_add_f32 v[46:47], v[46:47], v[62:63]
    s_waitcnt lgkmcnt(4)
    v_pk_add_f32 v[32:33], v[32:33], v[64:65]
    v_pk_add_f32 v[34:35], v[34:35], v[66:67]
    v_pk_add_f32 v[36:37], v[36:37], v[68:69]
    v_pk_add_f32 v[38:39], v[38:39], v[70:71]
    v_pk_add_f32 v[40:41], v[40:41], v[72:73]
    v_pk_add_f32 v[42:43], v[42:43], v[74:75]
    v_pk_add_f32 v[44:45], v[44:45], v[76:77]
    v_pk_add_f32 v[46:47], v[46:47], v[78:79]
    s_waitcnt lgkmcnt(0)
    v_pk_add_f32 v[32:33], v[32:33], v[80:81]
    v_pk_add_f32 v[34:35], v[34:35], v[82:83]
    v_pk_add_f32 v[36:37], v[36:37], v[84:85]
    v_pk_add_f32 v[38:39], v[38:39], v[86:87]
    v_pk_add_f32 v[40:41], v[40:41], v[88:89]
    v_pk_add_f32 v[42:43], v[42:43], v[90:91]
    v_pk_add_f32 v[44:45], v[44:45], v[92:93]
    v_pk_add_f32 v[46:47], v[46:47], v[94:95]
    s_cbranch_vccnz s_slow
s_fin:
    v_pk_mul_f32 v[32:33], v[28:29], v[32:33] op_sel_hi:[0,1]
    v_pk_mul_f32 v[34:35], v[28:29], v[34:35] op_sel_hi:[0,1]
    v_pk_mul_f32 v[36:37], v[28:29], v[36:37] op_sel_hi:[0,1]
    v_pk_mul_f32 v[38:39], v[28:29], v[38:39] op_sel_hi:[0,1]
    v_pk_mul_f32 v[40:41], v[28:29], v[40:41] op_sel_hi:[0,1]
    v_pk_mul_f32 v[42:43], v[28:29], v[42:43] op_sel_hi:[0,1]
    v_pk_mul_f32 v[44:45], v[28:29], v[44:45] op_sel_hi:[0,1]
    v_pk_mul_f32 v[46:47], v[28:29], v[46:47] op_sel_hi:[0,1]
    v_cvt_pk_bf16_f32 v32, v32, v33
    v_cvt_pk_bf16_f32 v33, v34, v35
    v_cvt_pk_bf16_f32 v34, v36, v37
    v_cvt_pk_bf16_f32 v35, v38, v39
    v_cvt_pk_bf16_f32 v36, v40, v41
    v_cvt_pk_bf16_f32 v37, v42, v43
    v_cvt_pk_bf16_f32 v38, v44, v45
    v_cvt_pk_bf16_f32 v39, v46, v47
    buffer_store_dwordx4 v[32:35], v1, s[4:7], s53 offen offset:0 sc1
    buffer_store_dwordx4 v[36:39], v1, s[4:7], s53 offen offset:1024 sc1
    s_cmp_lg_u32 s52, 0
    s_cbranch_scc1 s_b2
    s_waitcnt vmcnt(0)
    s_atomic_add s40, s[22:23], s54
    s_mov_b32 s52, 1
    s_add_u32 s53, s53, 2048
    s_waitcnt lgkmcnt(0)
    s_add_u32 s54, s54, 128
    s_setprio 0
    s_and_b32 s3, s16, 3
    s_lshl_b32 s46, s3, 19
    s_lshl_b32 s45, s3, 14
    s_and_b32 s3, s18, 0
    s_lshl_b32 s3, s3, 17
    s_xor_b32 s46, s46, s3
    s_add_u32 m0, s45, 0
    s_xor_b32 s44, s46, 0
    buffer_load_dwordx4 v16, s[12:15], s44 offen offset:0 lds
    buffer_load_dwordx4 v17, s[12:15], s44 offen offset:1024 lds
    buffer_load_dwordx4 v18, s[12:15], s44 offen offset:2048 lds
    buffer_load_dwordx4 v19, s[12:15], s44 offen offset:3072 lds
    s_add_u32 s44, s44, 65536
    s_waitcnt vmcnt(2)
    buffer_load_dwordx4 v[96:99], v16, s[12:15], s44 offen offset:0
    buffer_load_dwordx4 v[100:103], v17, s[12:15], s44 offen offset:1024
    buffer_load_dwordx4 v[104:107], v18, s[12:15], s44 offen offset:2048
    buffer_load_dwordx4 v[108:111], v19, s[12:15], s44 offen offset:3072
    s_waitcnt vmcnt(2)
    s_add_u32 m0, s45, 4096
    s_xor_b32 s44, s46, 131072
    buffer_load_dwordx4 v16, s[12:15], s44 offen offset:0 lds
    buffer_load_dwordx4 v17, s[12:15], s44 offen offset:1024 lds
    buffer_load_dwordx4 v18, s[12:15], s44 offen offset:2048 lds
    buffer_load_dwordx4 v19, s[12:15], s44 offen offset:3072 lds
    s_add_u32 s44, s44, 65536
    s_waitcnt vmcnt(2)
    buffer_load_dwordx4 v[112:115], v16, s[12:15], s44 offen offset:0
    buffer_load_dwordx4 v[116:119], v17, s[12:15], s44 offen offset:1024
    buffer_load_dwordx4 v[120:123], v18, s[12:15], s44 offen offset:2048
    buffer_load_dwordx4 v[124:127], v19, s[12:15], s44 offen offset:3072
    s_waitcnt vmcnt(2)
    s_add_u32 m0, s45, 8192
    s_xor_b32 s44, s46, 262144
    buffer_load_dwordx4 v16, s[12:15], s44 offen offset:0 lds
    buffer_load_dwordx4 v17, s[12:15], s44 offen offset:1024 lds
    buffer_load_dwordx4 v18, s[12:15], s44 offen offset:2048 lds
    buffer_load_dwordx4 v19, s[12:15], s44 offen offset:3072 lds
    s_add_u32 s44, s44, 65536
    s_waitcnt vmcnt(2)
    buffer_load_dwordx4 v[128:131], v16, s[12:15], s44 offen offset:0
    buffer_load_dwordx4 v[132:135], v17, s[12:15], s44 offen offset:1024
    buffer_load_dwordx4 v[136:139], v18, s[12:15], s44 offen offset:2048
    buffer_load_dwordx4 v[140:143], v19, s[12:15], s44 offen offset:3072
    s_waitcnt vmcnt(2)
    s_add_u32 m0, s45, 12288
    s_xor_b32 s44, s46, 393216
    buffer_load_dwordx4 v16, s[12:15], s44 offen offset:0 lds
    buffer_load_dwordx4 v17, s[12:15], s44 offen offset:1024 lds
    buffer_load_dwordx4 v18, s[12:15], s44 offen offset:2048 lds
    buffer_load_dwordx4 v19, s[12:15], s44 offen offset:3072 lds
    s_add_u32 s44, s44, 65536
    s_waitcnt vmcnt(2)
    buffer_load_dwordx4 v[144:147], v16, s[12:15], s44 offen offset:0
    buffer_load_dwordx4 v[148:151], v17, s[12:15], s44 offen offset:1024
    buffer_load_dwordx4 v[152:155], v18, s[12:15], s44 offen offset:2048
    buffer_load_dwordx4 v[156:159], v19, s[12:15], s44 offen offset:3072
    s_waitcnt vmcnt(2)
    s_setprio 3
    s_sub_u32 s44, s54, 128
    s_mov_b32 s66, 0x10000
s_o0_poll:
    s_mov_b32 s68, 0
    s_atomic_add s68, s[22:23], s44 offset:0 glc
    s_sub_u32 s66, s66, 1
    s_cselect_b32 s67, 16, 0
    s_waitcnt lgkmcnt(0)
    s_max_u32 s68, s68, s67
    s_cmp_lt_u32 s68, 16
    s_cbranch_scc1 s_o0_poll
s_o0_ok:
    s_branch s_bhead
s_b2:
    ds_write_b128 v24, v[96:99] offset:0
    ds_write_b128 v24, v[100:103] offset:1024
    ds_write_b128 v24, v[104:107] offset:2048
    ds_write_b128 v24, v[108:111] offset:3072
    ds_write_b128 v24, v[112:115] offset:4096
    ds_write_b128 v24, v[116:119] offset:5120
    ds_write_b128 v24, v[120:123] offset:6144
    ds_write_b128 v24, v[124:127] offset:7168
    ds_write_b128 v24, v[128:131] offset:8192
    ds_write_b128 v24, v[132:135] offset:9216
    ds_write_b128 v24, v[136:139] offset:10240
    ds_write_b128 v24, v[140:143] offset:11264
    ds_write_b128 v24, v[144:147] offset:12288
    ds_write_b128 v24, v[148:151] offset:13312
    ds_write_b128 v24, v[152:155] offset:14336
    ds_write_b128 v24, v[156:159] offset:15360
    s_waitcnt vmcnt(0)
    s_atomic_add s40, s[22:23], s54
    s_mov_b32 s66, 0x10000
s_o1_poll:
    s_mov_b32 s68, 0
    s_atomic_add s68, s[22:23], s54 offset:0 glc
    s_sub_u32 s66, s66, 1
    s_cselect_b32 s67, 16, 0
    s_waitcnt lgkmcnt(0)
    s_max_u32 s68, s68, s67
    s_cmp_lt_u32 s68, 16
    s_cbranch_scc1 s_o1_poll
s_o1_ok:
s_b3:
    s_setprio 0
    s_waitcnt lgkmcnt(0)
s_g3:
    s_barrier
    s_cmp_eq_u32 s21, 3
    s_cbranch_scc1 s_end
    s_barrier
    ds_write_b128 v9, v[160:163] offset:0
    ds_write_b128 v9, v[164:167] offset:4096
    ds_write_b128 v9, v[168:171] offset:8192
    ds_write_b128 v9, v[172:175] offset:12288
    ds_write_b128 v9, v[176:179] offset:16384
    ds_write_b128 v9, v[180:183] offset:20480
    ds_write_b128 v9, v[184:187] offset:24576
    ds_write_b128 v9, v[188:191] offset:28672
    s_add_u32 s21, s21, 1
    s_bitcmp1_b32 s21, 0
    s_cselect_b32 s8, s28, s24
    s_cselect_b32 s9, s29, s25
    s_cselect_b32 s12, s30, s26
    s_cselect_b32 s13, s31, s27
    s_mov_b32 s10, 6291456
    s_mov_b32 s11, 0x00020000
    s_mov_b32 s14, 2097152
    s_mov_b32 s15, 0x00020000
    s_sub_u32 s3, s16, 5
    s_cmp_gt_u32 s3, 1
    s_cbranch_scc1 s_n67
    s_add_u32 m0, s41, 98304
    s_add_u32 s44, s88, 2048
    buffer_load_dwordx4 v14, s[8:11], s44 offen offset:0 lds
    buffer_load_dwordx4 v15, s[8:11], s44 offen offset:1024 lds
    s_add_u32 m0, s41, 102400
    s_add_u32 s44, s88, 4096
    buffer_load_dwordx4 v14, s[8:11], s44 offen offset:0 lds
    buffer_load_dwordx4 v15, s[8:11], s44 offen offset:1024 lds
    s_add_u32 m0, s41, 106496
    s_add_u32 s44, s88, 0
    buffer_load_dwordx4 v14, s[8:11], s44 offen offset:0 lds
    buffer_load_dwordx4 v15, s[8:11], s44 offen offset:1024 lds
    s_add_u32 m0, s41, 110592
    s_add_u32 s44, s88, 198656
    buffer_load_dwordx4 v14, s[8:11], s44 offen offset:0 lds
    buffer_load_dwordx4 v15, s[8:11], s44 offen offset:1024 lds
    s_add_u32 m0, s41, 114688
    s_add_u32 s44, s88, 200704
    buffer_load_dwordx4 v14, s[8:11], s44 offen offset:0 lds
    buffer_load_dwordx4 v15, s[8:11], s44 offen offset:1024 lds
    s_add_u32 m0, s41, 118784
    s_add_u32 s44, s88, 196608
    buffer_load_dwordx4 v14, s[8:11], s44 offen offset:0 lds
    buffer_load_dwordx4 v15, s[8:11], s44 offen offset:1024 lds
    s_add_u32 m0, s41, 122880
    s_add_u32 s44, s89, 2048
    buffer_load_dwordx4 v14, s[8:11], s44 offen offset:0 lds
    buffer_load_dwordx4 v15, s[8:11], s44 offen offset:1024 lds
    s_add_u32 m0, s41, 126976
    s_add_u32 s44, s89, 4096
    buffer_load_dwordx4 v14, s[8:11], s44 offen offset:0 lds
    buffer_load_dwordx4 v15, s[8:11], s44 offen offset:1024 lds
s_n67:
    s_waitcnt lgkmcnt(0)
    s_barrier
    ds_write_b128 v9, v[192:195] offset:32768
    ds_write_b128 v9, v[196:199] offset:36864
    ds_write_b128 v9, v[200:203] offset:40960
    ds_write_b128 v9, v[204:207] offset:45056
    ds_write_b128 v9, v[208:211] offset:49152
    ds_write_b128 v9, v[212:215] offset:53248
    ds_write_b128 v9, v[216:219] offset:57344
    ds_write_b128 v9, v[220:223] offset:61440
    ds_write_b128 v10, v[224:227] offset:0
    ds_write_b128 v10, v[228:231] offset:4096
    ds_write_b128 v10, v[232:235] offset:8192
    ds_write_b128 v10, v[236:239] offset:12288
    ds_write_b128 v10, v[240:243] offset:16384
    ds_write_b128 v10, v[244:247] offset:20480
    ds_write_b128 v10, v[248:251] offset:24576
    ds_write_b128 v10, v[252:255] offset:28672
    s_cmp_eq_u32 s16, 4
    s_cbranch_scc1 h_layer
    s_cmp_eq_u32 s16, 7
    s_cbranch_scc1 z_layer
    s_branch l_layer
s_end:
    s_lshl_b32 s3, s2, 3
    s_add_u32 s3, s3, s16
    s_cmp_lg_u32 s3, 7
    s_cbranch_scc1 k_exit
    s_mov_b32 s8, s34
    s_mov_b32 s9, s35
    s_mov_b32 s10, 256
    s_mov_b32 s11, 0x00020000
    v_lshrrev_b32 v24, 2, v1
    v_mov_b32 v25, 0
    buffer_store_dword v25, v24, s[8:11], 0 offen sc1
    s_branch k_exit
s_slow:
    s_and_b32 s3, s16, 3
    s_lshl_b32 s44, s3, 11
    s_lshl_b32 s45, s52, 13
    s_add_u32 s44, s44, s45
    s_add_u32 s44, s44, 131072
    v_add_u32 v26, s44, v1
    ds_read_b128 v[48:51], v26 offset:0
    ds_read_b128 v[52:55], v26 offset:1024
    s_lshr_b32 s55, s21, 1
    s_lshl_b32 s55, s55, 23
    s_lshl_b32 s44, s18, 18
    s_add_u32 s55, s55, s44
    s_lshl_b32 s44, s52, 17
    s_add_u32 s55, s55, s44
    s_add_u32 s55, s55, 33554432
    s_waitcnt lgkmcnt(0)
    v_mov_b32 v26, 0xff800000
    s_mov_b32 s61, 0
s_slow1:
    s_add_u32 s44, s55, s61
    buffer_load_dwordx4 v[56:59], v1, s[4:7], s44 offen offset:0 sc1
    buffer_load_dwordx4 v[60:63], v1, s[4:7], s44 offen offset:1024 sc1
    s_waitcnt vmcnt(0)
    v_mfma_f32_32x32x16_bf16 v[72:87], v[56:59], v[48:51], 0
    v_mfma_f32_32x32x16_bf16 v[72:87], v[60:63], v[52:55], v[72:87]
    s_nop 11
    v_max3_f32 v26, v26, v72, v73
    v_max3_f32 v26, v26, v74, v75
    v_max3_f32 v26, v26, v76, v77
    v_max3_f32 v26, v26, v78, v79
    v_max3_f32 v26, v26, v80, v81
    v_max3_f32 v26, v26, v82, v83
    v_max3_f32 v26, v26, v84, v85
    v_max3_f32 v26, v26, v86, v87
    s_add_u32 s61, s61, 2048
    s_cmp_lt_u32 s61, 131072
    s_cbranch_scc1 s_slow1
    v_mov_b32 v27, v26
    s_nop 1
    v_permlane32_swap_b32 v26, v27
    v_max_f32 v26, v26, v27
    v_mov_b32 v32, 0
    v_mov_b32 v33, 0
    v_mov_b32 v34, 0
    v_mov_b32 v35, 0
    v_mov_b32 v36, 0
    v_mov_b32 v37, 0
    v_mov_b32 v38, 0
    v_mov_b32 v39, 0
    v_mov_b32 v40, 0
    v_mov_b32 v41, 0
    v_mov_b32 v42, 0
    v_mov_b32 v43, 0
    v_mov_b32 v44, 0
    v_mov_b32 v45, 0
    v_mov_b32 v46, 0
    v_mov_b32 v47, 0
    v_mov_b32 v28, 0
    v_mov_b32 v29, 0xdddddddd
    s_mov_b32 s3, 0xffff0000
    s_mov_b32 s61, 0
s_slow2:
    s_add_u32 s44, s55, s61
    buffer_load_dwordx4 v[56:59], v1, s[4:7], s44 offen offset:0 sc1
    buffer_load_dwordx4 v[60:63], v1, s[4:7], s44 offen offset:1024 sc1
    s_add_u32 s44, s44, 4194304
    buffer_load_dwordx4 v[64:67], v1, s[4:7], s44 offen offset:0 sc1
    buffer_load_dwordx4 v[68:71], v1, s[4:7], s44 offen offset:1024 sc1
    s_waitcnt vmcnt(0)
    v_mfma_f32_32x32x16_bf16 v[72:87], v[56:59], v[48:51], 0
    v_mfma_f32_32x32x16_bf16 v[72:87], v[60:63], v[52:55], v[72:87]
    s_nop 11
    v_sub_f32 v72, v72, v26
    v_sub_f32 v73, v73, v26
    v_sub_f32 v74, v74, v26
    v_sub_f32 v75, v75, v26
    v_sub_f32 v76, v76, v26
    v_sub_f32 v77, v77, v26
    v_sub_f32 v78, v78, v26
    v_sub_f32 v79, v79, v26
    v_sub_f32 v80, v80, v26
    v_sub_f32 v81, v81, v26
    v_sub_f32 v82, v82, v26
    v_sub_f32 v83, v83, v26
    v_sub_f32 v84, v84, v26
    v_sub_f32 v85, v85, v26
    v_sub_f32 v86, v86, v26
    v_sub_f32 v87, v87, v26
    v_exp_f32 v72, v72
    v_exp_f32 v73, v73
    v_exp_f32 v74, v74
    v_exp_f32 v75, v75
    v_exp_f32 v76, v76
    v_exp_f32 v77, v77
    v_exp_f32 v78, v78
    v_exp_f32 v79, v79
    v_exp_f32 v80, v80
    v_exp_f32 v81, v81
    v_exp_f32 v82, v82
    v_exp_f32 v83, v83
    v_exp_f32 v84, v84
    v_exp_f32 v85, v85
    v_exp_f32 v86, v86
    v_exp_f32 v87, v87
    v_and_b32 v72, s3, v72
    v_and_b32 v73, s3, v73
    v_and_b32 v74, s3, v74
    v_and_b32 v75, s3, v75
    v_and_b32 v76, s3, v76
    v_and_b32 v77, s3, v77
    v_and_b32 v78, s3, v78
    v_and_b32 v79, s3, v79
    v_and_b32 v80, s3, v80
    v_and_b32 v81, s3, v81
    v_and_b32 v82, s3, v82
    v_and_b32 v83, s3, v83
    v_and_b32 v84, s3, v84
    v_and_b32 v85, s3, v85
    v_and_b32 v86, s3, v86
    v_and_b32 v87, s3, v87
    v_add_f32 v28, v28, v72
    v_add_f32 v28, v28, v73
    v_add_f32 v28, v28, v74
    v_add_f32 v28, v28, v75
    v_add_f32 v28, v28, v76
    v_add_f32 v28, v28, v77
    v_add_f32 v28, v28, v78
    v_add_f32 v28, v28, v79
    v_add_f32 v28, v28, v80
    v_add_f32 v28, v28, v81
    v_add_f32 v28, v28, v82
    v_add_f32 v28, v28, v83
    v_add_f32 v28, v28, v84
    v_add_f32 v28, v28, v85
    v_add_f32 v28, v28, v86
    v_add_f32 v28, v28, v87
    v_smfmac_f32_32x32x32_bf16 v[32:47], v[64:67], v[72:79], v29
    v_smfmac_f32_32x32x32_bf16 v[32:47], v[68:71], v[80:87], v29
    s_add_u32 s61, s61, 2048
    s_cmp_lt_u32 s61, 131072
    s_cbranch_scc1 s_slow2
    v_mov_b32 v29, v28
    s_nop 1
    v_permlane32_swap_b32 v28, v29
    v_add_f32 v28, v28, v29
    v_rcp_f32 v28, v28
    s_nop 7
    s_branch s_fin
k_exit:
    s_endpgm
.if k_exit - interleave_layers__sliding_local_dilated__softmax_full_mha__prompt_kernel < 49152
.error "code prefetch reads past the end of the code"
.endif
.section .rodata,"a"
.p2align 6
.amdhsa_kernel interleave_layers__sliding_local_dilated__softmax_full_mha__prompt_kernel
  .amdhsa_next_free_vgpr 256
  .amdhsa_next_free_sgpr 102
  .amdhsa_accum_offset 256
  .amdhsa_group_segment_fixed_size 0
  .amdhsa_kernarg_size 72
  .amdhsa_user_sgpr_count 2
  .amdhsa_user_sgpr_kernarg_segment_ptr 1
  .amdhsa_system_sgpr_workgroup_id_x 1
.end_amdhsa_kernel
```

```asm
; @launch grid=(256,1,1) block=(512,1,1) lds=156736
.amdgcn_target "amdgcn-amd-amdhsa--gfx950"
.text
.globl interleave_layers__sliding_local_dilated__softmax_full_mha__prompt_kernel
.type interleave_layers__sliding_local_dilated__softmax_full_mha__prompt_kernel,@function
.p2align 8
interleave_layers__sliding_local_dilated__softmax_full_mha__prompt_kernel:
    s_cmp_ge_u32 s2, 256
    s_cbranch_scc1 k_exit
    s_load_dwordx2 s[36:37], s[0:1], 0
    s_load_dwordx4 s[24:27], s[0:1], 8
    s_load_dwordx8 s[28:35], s[0:1], 32
    s_load_dwordx2 s[44:45], s[0:1], 64
    v_lshrrev_b32 v2, 6, v0
    v_and_b32 v0, 63, v0
    v_readfirstlane_b32 s16, v2
    v_lshlrev_b32 v1, 4, v0
    s_mov_b32 s21, 0
    s_mov_b32 s40, 1
    s_and_b32 s3, s2, 1
    s_lshl_b32 s3, s3, 3
    s_bfe_u32 s17, s2, 0x30003
    s_add_u32 s17, s17, s3
    s_bfe_u32 s3, s2, 0x20001
    s_lshl_b32 s3, s3, 2
    s_lshr_b32 s18, s2, 6
    s_add_u32 s18, s18, s3
    s_and_b32 s3, s16, 3
    s_lshl_b32 s38, s17, 2
    s_add_u32 s38, s38, s3
    v_lshrrev_b32 v32, 3, v0
    v_and_b32 v33, 7, v0
    v_lshlrev_b32 v34, 11, v32
    v_lshl_add_u32 v34, v33, 4, v34
    s_lshl_b32 s46, s38, 16
    s_lshl_b32 s47, s18, 7
    s_add_u32 s46, s46, s47
    s_getpc_b64 s[76:77]
e_pc:
    s_sub_u32 s76, s76, e_pc - interleave_layers__sliding_local_dilated__softmax_full_mha__prompt_kernel
    s_subb_u32 s77, s77, 0
    s_and_b32 s3, s2, 0xf8
    s_add_u32 s3, s3, s16
    s_lshl_b32 s3, s3, 6
    s_add_u32 s78, s3, 49152
    s_min_u32 s78, s78, k_exit - interleave_layers__sliding_local_dilated__softmax_full_mha__prompt_kernel
    s_waitcnt lgkmcnt(0)
    s_mov_b32 s8, s36
    s_mov_b32 s9, s37
    s_mov_b32 s10, 4194304
    s_mov_b32 s11, 0x00020000
    s_cmp_gt_u32 s16, 3
    s_cbranch_scc1 e_side
    buffer_load_dwordx4 v[40:43], v34, s[8:11], s46 offen
    s_add_u32 s46, s46, 16384
    buffer_load_dwordx4 v[44:47], v34, s[8:11], s46 offen
    s_add_u32 s46, s46, 16384
    buffer_load_dwordx4 v[48:51], v34, s[8:11], s46 offen
    s_add_u32 s46, s46, 16384
    buffer_load_dwordx4 v[52:55], v34, s[8:11], s46 offen
e_side:
    s_load_dword s80, s[76:77], s3 offset:0
    s_load_dword s81, s[76:77], s3 offset:16384
    s_load_dword s82, s[76:77], s3 offset:32768
    s_load_dword s83, s[76:77], s78
    s_mov_b32 s4, s44
    s_mov_b32 s5, s45
    s_mov_b32 s6, 67108864
    s_mov_b32 s7, 0x00020000
    s_add_u32 s22, s44, 58720256
    s_addc_u32 s23, s45, 0
    s_load_dword s100, s[22:23], 217088
    s_cmp_gt_u32 s16, 3
    s_cbranch_scc1 s_start
    v_lshrrev_b32 v8, 4, v1
    s_lshl_b32 s44, s38, 16
    v_xor_b32 v88, v33, v32
    v_lshlrev_b32 v88, 4, v88
    v_lshl_add_u32 v88, v32, 11, v88
    v_xor_b32 v89, 16, v88
    v_add_u32 v89, 15360, v89
    v_add_u32 v90, 30720, v88
    v_add_u32 v91, 30720, v89
    s_mul_i32 s76, s16, 16384
    s_add_u32 s76, s76, 61440
    s_lshl_b32 s77, s38, 16
    s_mul_i32 s84, s18, 4096
    s_cmp_lt_u32 s18, 4
    s_cselect_b32 s85, 4, 0
    s_mul_i32 s85, s85, 4096
    s_cmp_lt_u32 s18, 4
    s_cselect_b32 s86, 5, 1
    s_mul_i32 s86, s86, 4096
    s_cmp_lt_u32 s18, 4
    s_cselect_b32 s87, 6, 2
    s_mul_i32 s87, s87, 4096
    s_cmp_lt_u32 s18, 4
    s_cselect_b32 s88, 7, 3
    s_mul_i32 s88, s88, 4096
    s_cmp_lt_u32 s18, 8
    s_cselect_b32 s89, 8, 4
    s_mul_i32 s89, s89, 4096
    s_cmp_lt_u32 s18, 8
    s_cselect_b32 s90, 9, 5
    s_mul_i32 s90, s90, 4096
    s_cmp_lt_u32 s18, 8
    s_cselect_b32 s91, 10, 6
    s_mul_i32 s91, s91, 4096
    s_cmp_lt_u32 s18, 8
    s_cselect_b32 s92, 11, 7
    s_mul_i32 s92, s92, 4096
    s_cmp_lt_u32 s18, 12
    s_cselect_b32 s93, 12, 8
    s_mul_i32 s93, s93, 4096
    s_cmp_lt_u32 s18, 12
    s_cselect_b32 s94, 13, 9
    s_mul_i32 s94, s94, 4096
    s_cmp_lt_u32 s18, 12
    s_cselect_b32 s95, 14, 10
    s_mul_i32 s95, s95, 4096
    s_cmp_lt_u32 s18, 12
    s_cselect_b32 s96, 15, 11
    s_mul_i32 s96, s96, 4096
    s_xor_b32 s97, s18, 1
    s_mul_i32 s97, s97, 4096
    s_xor_b32 s98, s18, 2
    s_mul_i32 s98, s98, 4096
    s_xor_b32 s99, s18, 3
    s_mul_i32 s99, s99, 4096
    s_lshr_b32 s3, s18, 2
    s_lshl_b32 s3, s3, 3
    s_lshl_b32 s63, 1, s3
    s_lshl_b32 s3, s63, 2
    s_andn2_b32 s19, 67372036, s3
    v_lshrrev_b32 v12, 4, v1
    v_and_b32 v13, 15, v12
    v_bfe_u32 v14, v12, 4, 1
    v_lshrrev_b32 v12, 5, v12
    v_lshl_add_u32 v2, v14, 5, v13
    v_lshlrev_b32 v2, 4, v2
    v_lshl_add_u32 v2, v12, 10, v2
    v_lshrrev_b32 v15, 2, v13
    v_lshl_add_u32 v15, v14, 2, v15
    v_lshlrev_b32 v3, 7, v15
    v_lshl_add_u32 v3, v12, 11, v3
    v_and_b32 v15, 3, v13
    v_lshl_add_u32 v3, v15, 3, v3
    v_lshrrev_b32 v15, 3, v13
    v_lshl_add_u32 v15, v15, 1, v14
    v_lshl_add_u32 v3, v15, 5, v3
    v_xor_b32 v4, 32, v3
    v_xor_b32 v5, 64, v3
    v_xor_b32 v6, 96, v3
    s_lshl_b32 s45, s16, 12
    s_add_u32 s45, s45, 131072
    v_lshrrev_b32 v35, 1, v33
    v_lshlrev_b32 v35, 10, v35
    v_lshl_add_u32 v35, v32, 4, v35
    v_and_b32 v36, 1, v33
    v_lshl_add_u32 v35, v36, 3, v35
    v_add_u32 v35, s45, v35
    v_add_u32 v36, s45, v1
    v_mov_b32 v37, 0x3f803f80
    v_and_b32 v38, 3, v8
    v_lshl_add_u32 v39, v38, 3, v32
    v_lshlrev_b32 v39, 3, v39
    v_mov_b32 v56, 0
    v_mov_b32 v57, 0
    v_mov_b32 v58, 0
    v_mov_b32 v59, 0
    v_mov_b32 v60, 0
    v_mov_b32 v61, 0
    v_mov_b32 v62, 0
    v_mov_b32 v63, 0
    s_waitcnt vmcnt(3)
    ds_write_b64 v35, v[40:41] offset:0
    ds_write_b64 v35, v[42:43] offset:512
    s_waitcnt vmcnt(2)
    ds_write_b64 v35, v[44:45] offset:128
    ds_write_b64 v35, v[46:47] offset:640
    s_waitcnt vmcnt(1)
    ds_write_b64 v35, v[48:49] offset:256
    ds_write_b64 v35, v[50:51] offset:768
    s_waitcnt vmcnt(0)
    ds_write_b64 v35, v[52:53] offset:384
    ds_write_b64 v35, v[54:55] offset:896
    ds_read_b128 v[64:67], v36 offset:0
    ds_read_b128 v[68:71], v36 offset:1024
    ds_read_b128 v[72:75], v36 offset:2048
    ds_read_b128 v[76:79], v36 offset:3072
    s_lshl_b32 s45, s18, 12
    s_add_u32 s46, s44, s45
    s_waitcnt lgkmcnt(3)
    buffer_store_dwordx4 v[64:67], v1, s[4:7], s46 offen offset:0 sc1
    s_waitcnt lgkmcnt(2)
    buffer_store_dwordx4 v[68:71], v1, s[4:7], s46 offen offset:1024 sc1
    s_waitcnt lgkmcnt(1)
    buffer_store_dwordx4 v[72:75], v1, s[4:7], s46 offen offset:2048 sc1
    s_waitcnt lgkmcnt(0)
    buffer_store_dwordx4 v[76:79], v1, s[4:7], s46 offen offset:3072 sc1
    s_add_u32 m0, s76, 4096
    s_lshr_b32 s78, s85, 5
    s_add_u32 s78, s78, s77
    buffer_load_dwordx4 v88, s[8:11], s78 offen offset:0 lds
    buffer_load_dwordx4 v89, s[8:11], s78 offen offset:1024 lds
    buffer_load_dwordx4 v90, s[8:11], s78 offen offset:2048 lds
    buffer_load_dwordx4 v91, s[8:11], s78 offen offset:3072 lds
    s_add_u32 m0, s76, 8192
    s_lshr_b32 s78, s86, 5
    s_add_u32 s78, s78, s77
    buffer_load_dwordx4 v88, s[8:11], s78 offen offset:0 lds
    buffer_load_dwordx4 v89, s[8:11], s78 offen offset:1024 lds
    buffer_load_dwordx4 v90, s[8:11], s78 offen offset:2048 lds
    buffer_load_dwordx4 v91, s[8:11], s78 offen offset:3072 lds
    s_add_u32 m0, s76, 12288
    s_lshr_b32 s78, s87, 5
    s_add_u32 s78, s78, s77
    buffer_load_dwordx4 v88, s[8:11], s78 offen offset:0 lds
    buffer_load_dwordx4 v89, s[8:11], s78 offen offset:1024 lds
    buffer_load_dwordx4 v90, s[8:11], s78 offen offset:2048 lds
    buffer_load_dwordx4 v91, s[8:11], s78 offen offset:3072 lds
    s_add_u32 m0, s76, 16384
    s_lshr_b32 s78, s88, 5
    s_add_u32 s78, s78, s77
    buffer_load_dwordx4 v88, s[8:11], s78 offen offset:0 lds
    buffer_load_dwordx4 v89, s[8:11], s78 offen offset:1024 lds
    buffer_load_dwordx4 v90, s[8:11], s78 offen offset:2048 lds
    buffer_load_dwordx4 v91, s[8:11], s78 offen offset:3072 lds
    v_dot2_f32_bf16 v56, v40, v37, v56
    v_dot2_f32_bf16 v57, v40, v40, v57
    v_dot2_f32_bf16 v58, v44, v37, v58
    v_dot2_f32_bf16 v59, v44, v44, v59
    v_dot2_f32_bf16 v60, v48, v37, v60
    v_dot2_f32_bf16 v61, v48, v48, v61
    v_dot2_f32_bf16 v62, v52, v37, v62
    v_dot2_f32_bf16 v63, v52, v52, v63
    v_dot2_f32_bf16 v56, v41, v37, v56
    v_dot2_f32_bf16 v57, v41, v41, v57
    v_dot2_f32_bf16 v58, v45, v37, v58
    v_dot2_f32_bf16 v59, v45, v45, v59
    v_dot2_f32_bf16 v60, v49, v37, v60
    v_dot2_f32_bf16 v61, v49, v49, v61
    v_dot2_f32_bf16 v62, v53, v37, v62
    v_dot2_f32_bf16 v63, v53, v53, v63
    v_dot2_f32_bf16 v56, v42, v37, v56
    v_dot2_f32_bf16 v57, v42, v42, v57
    v_dot2_f32_bf16 v58, v46, v37, v58
    v_dot2_f32_bf16 v59, v46, v46, v59
    v_dot2_f32_bf16 v60, v50, v37, v60
    v_dot2_f32_bf16 v61, v50, v50, v61
    v_dot2_f32_bf16 v62, v54, v37, v62
    v_dot2_f32_bf16 v63, v54, v54, v63
    v_dot2_f32_bf16 v56, v43, v37, v56
    v_dot2_f32_bf16 v57, v43, v43, v57
    v_dot2_f32_bf16 v58, v47, v37, v58
    v_dot2_f32_bf16 v59, v47, v47, v59
    v_dot2_f32_bf16 v60, v51, v37, v60
    v_dot2_f32_bf16 v61, v51, v51, v61
    v_dot2_f32_bf16 v62, v55, v37, v62
    v_dot2_f32_bf16 v63, v55, v55, v63
    s_nop 2
    v_add_f32_dpp v56, v56, v56 quad_perm:[1,0,3,2] row_mask:0xf bank_mask:0xf
    v_add_f32_dpp v57, v57, v57 quad_perm:[1,0,3,2] row_mask:0xf bank_mask:0xf
    v_add_f32_dpp v58, v58, v58 quad_perm:[1,0,3,2] row_mask:0xf bank_mask:0xf
    v_add_f32_dpp v59, v59, v59 quad_perm:[1,0,3,2] row_mask:0xf bank_mask:0xf
    v_add_f32_dpp v60, v60, v60 quad_perm:[1,0,3,2] row_mask:0xf bank_mask:0xf
    v_add_f32_dpp v61, v61, v61 quad_perm:[1,0,3,2] row_mask:0xf bank_mask:0xf
    v_add_f32_dpp v62, v62, v62 quad_perm:[1,0,3,2] row_mask:0xf bank_mask:0xf
    v_add_f32_dpp v63, v63, v63 quad_perm:[1,0,3,2] row_mask:0xf bank_mask:0xf
    v_add_f32_dpp v56, v56, v56 quad_perm:[2,3,0,1] row_mask:0xf bank_mask:0xf
    v_add_f32_dpp v57, v57, v57 quad_perm:[2,3,0,1] row_mask:0xf bank_mask:0xf
    v_add_f32_dpp v58, v58, v58 quad_perm:[2,3,0,1] row_mask:0xf bank_mask:0xf
    v_add_f32_dpp v59, v59, v59 quad_perm:[2,3,0,1] row_mask:0xf bank_mask:0xf
    v_add_f32_dpp v60, v60, v60 quad_perm:[2,3,0,1] row_mask:0xf bank_mask:0xf
    v_add_f32_dpp v61, v61, v61 quad_perm:[2,3,0,1] row_mask:0xf bank_mask:0xf
    v_add_f32_dpp v62, v62, v62 quad_perm:[2,3,0,1] row_mask:0xf bank_mask:0xf
    v_add_f32_dpp v63, v63, v63 quad_perm:[2,3,0,1] row_mask:0xf bank_mask:0xf
    v_add_f32_dpp v56, v56, v56 row_half_mirror row_mask:0xf bank_mask:0xf
    v_add_f32_dpp v57, v57, v57 row_half_mirror row_mask:0xf bank_mask:0xf
    v_add_f32_dpp v58, v58, v58 row_half_mirror row_mask:0xf bank_mask:0xf
    v_add_f32_dpp v59, v59, v59 row_half_mirror row_mask:0xf bank_mask:0xf
    v_add_f32_dpp v60, v60, v60 row_half_mirror row_mask:0xf bank_mask:0xf
    v_add_f32_dpp v61, v61, v61 row_half_mirror row_mask:0xf bank_mask:0xf
    v_add_f32_dpp v62, v62, v62 row_half_mirror row_mask:0xf bank_mask:0xf
    v_add_f32_dpp v63, v63, v63 row_half_mirror row_mask:0xf bank_mask:0xf
    v_cmp_eq_u32 vcc, 1, v38
    s_nop 1
    v_cndmask_b32 v56, v56, v58, vcc
    v_cndmask_b32 v57, v57, v59, vcc
    v_cmp_eq_u32 vcc, 2, v38
    s_nop 1
    v_cndmask_b32 v56, v56, v60, vcc
    v_cndmask_b32 v57, v57, v61, vcc
    v_cmp_eq_u32 vcc, 3, v38
    s_nop 1
    v_cndmask_b32 v56, v56, v62, vcc
    v_cndmask_b32 v57, v57, v63, vcc
    s_lshl_b32 s44, s21, 18
    s_lshl_b32 s45, s38, 12
    s_add_u32 s44, s44, s45
    s_lshl_b32 s45, s18, 8
    s_add_u32 s44, s44, s45
    s_add_u32 s44, s44, 50331648
    buffer_store_dwordx2 v[56:57], v39, s[4:7], s44 offen sc1
    s_lshl_b32 s46, s21, 14
    s_lshl_b32 s67, s38, 7
    s_add_u32 s46, s46, s67
    s_add_u32 s46, s46, 4096
    s_add_u32 s47, s46, 8192
    s_lshl_b32 s48, s21, 22
    s_lshl_b32 s49, s38, 16
    s_add_u32 s41, s48, s49
    v_lshrrev_b32 v16, 4, v1
    v_and_b32 v17, 15, v16
    v_lshrrev_b32 v16, 4, v16
    s_lshl_b32 s49, s16, 7
    s_add_u32 s50, s49, 151552
    s_and_b32 s49, s21, 1
    s_lshl_b32 s49, s49, 10
    s_add_u32 s49, s49, 151552
    v_lshlrev_b32 v11, 4, v16
    v_add_u32 v13, s50, v11
    v_add_u32 v11, s49, v11
    v_lshlrev_b32 v15, 2, v17
    v_add_u32 v9, s50, v15
    v_add_u32 v15, s49, v15
    s_lshr_b32 s49, s21, 1
    s_lshl_b32 s53, s49, 23
    s_lshl_b32 s50, s18, 18
    s_add_u32 s53, s53, s50
    s_add_u32 s53, s53, 33554432
    s_lshl_b32 s54, s38, 11
    s_add_u32 s52, s53, s54
    s_lshl_b32 s59, s49, 13
    s_lshl_b32 s67, s18, 9
    s_add_u32 s59, s59, s67
    s_lshl_b32 s67, s16, 7
    s_add_u32 s59, s59, s67
    s_add_u32 s59, s59, 69632
    s_lshl_b32 s61, s49, 15
    s_lshl_b32 s67, s17, 11
    s_add_u32 s61, s61, s67
    s_lshl_b32 s67, s18, 7
    s_add_u32 s61, s61, s67
    s_add_u32 s61, s61, 151552
    s_sub_u32 s60, s61, 151552
    s_lshl_b32 s60, s60, 5
    s_add_u32 s60, s60, 54525952
    s_lshl_b32 s62, s16, 12
    s_add_u32 s62, s62, 131072
    v_bfe_u32 v80, v8, 3, 1
    v_and_b32 v81, 7, v8
    v_lshrrev_b32 v82, 5, v8
    v_lshlrev_b32 v82, 1, v82
    v_xor_b32 v82, v82, v81
    v_xor_b32 v82, v82, v80
    v_lshlrev_b32 v82, 4, v82
    v_lshl_add_u32 v82, v81, 7, v82
    v_lshl_add_u32 v82, v80, 10, v82
    v_bfe_u32 v80, v8, 4, 1
    v_lshl_add_u32 v82, v80, 3, v82
    v_add_u32 v20, s76, v82
    v_xor_b32 v21, 16, v20
    v_xor_b32 v22, 64, v20
    v_xor_b32 v23, 80, v20
    v_add_u32 v80, s62, v2
    ds_read_b128 v[160:163], v80 offset:0
    ds_read_b128 v[164:167], v80 offset:256
    ds_read_b128 v[168:171], v80 offset:2048
    ds_read_b128 v[172:175], v80 offset:2304
    s_mov_b64 vcc, -1
    s_mov_b32 s48, 1
    s_or_b32 s20, s19, 0x80000000
    s_barrier
    ds_read_b64_tr_b16 v[32:33], v3 offset:0
    ds_read_b64_tr_b16 v[34:35], v3 offset:1024
    ds_read_b64_tr_b16 v[36:37], v4 offset:0
    ds_read_b64_tr_b16 v[38:39], v4 offset:1024
    ds_read_b64_tr_b16 v[40:41], v5 offset:0
    ds_read_b64_tr_b16 v[42:43], v5 offset:1024
    ds_read_b64_tr_b16 v[44:45], v6 offset:0
    ds_read_b64_tr_b16 v[46:47], v6 offset:1024
    ds_read_b64_tr_b16 v[48:49], v3 offset:4096
    ds_read_b64_tr_b16 v[50:51], v3 offset:5120
    ds_read_b64_tr_b16 v[52:53], v4 offset:4096
    ds_read_b64_tr_b16 v[54:55], v4 offset:5120
    ds_read_b64_tr_b16 v[56:57], v5 offset:4096
    ds_read_b64_tr_b16 v[58:59], v5 offset:5120
    s_branch c_g0
c_st1:
    s_waitcnt vmcnt(1)
    ds_read_b64 v[176:177], v20 offset:4096
    ds_read_b64 v[178:179], v21 offset:4096
    ds_read_b64 v[180:181], v20 offset:6144
    ds_read_b64 v[182:183], v21 offset:6144
    ds_read_b64 v[184:185], v22 offset:4096
    ds_read_b64 v[186:187], v23 offset:4096
    ds_read_b64 v[188:189], v22 offset:6144
    ds_read_b64 v[190:191], v23 offset:6144
    ds_read_b64 v[192:193], v20 offset:8192
    ds_read_b64 v[194:195], v21 offset:8192
    ds_read_b64 v[196:197], v20 offset:10240
    ds_read_b64 v[198:199], v21 offset:10240
    ds_read_b64 v[200:201], v22 offset:8192
    ds_read_b64 v[202:203], v23 offset:8192
    ds_read_b64 v[204:205], v22 offset:10240
    ds_read_b64 v[206:207], v23 offset:10240
    ds_read_b64 v[208:209], v20 offset:12288
    ds_read_b64 v[210:211], v21 offset:12288
    ds_read_b64 v[212:213], v20 offset:14336
    ds_read_b64 v[214:215], v21 offset:14336
    ds_read_b64 v[216:217], v22 offset:12288
    ds_read_b64 v[218:219], v23 offset:12288
    ds_read_b64 v[220:221], v22 offset:14336
    ds_read_b64 v[222:223], v23 offset:14336
    ds_read_b64 v[224:225], v20 offset:16384
    ds_read_b64 v[226:227], v21 offset:16384
    ds_read_b64 v[228:229], v20 offset:18432
    ds_read_b64 v[230:231], v21 offset:18432
    ds_read_b64 v[232:233], v22 offset:16384
    ds_read_b64 v[234:235], v23 offset:16384
    ds_read_b64 v[236:237], v22 offset:18432
    ds_read_b64 v[238:239], v23 offset:18432
    s_load_dword s68, s[34:35], 0
    s_mov_b32 s8, s34
    s_mov_b32 s9, s35
    s_mov_b32 s10, 256
    s_mov_b32 s11, 0x00020000
    s_mov_b32 s66, 0x10000
    v_mov_b32 v16, 0
    s_waitcnt lgkmcnt(0)
c_f0:
    s_cmp_eq_u32 s68, 10
    s_cbranch_scc1 c_f0_ok
    buffer_load_dword v17, v16, s[8:11], 0 offen offset:0 sc1
    s_waitcnt vmcnt(0)
    v_readfirstlane_b32 s68, v17
    s_sub_u32 s66, s66, 1
    s_cmp_lg_u32 s66, 0
    s_cbranch_scc1 c_f0
c_f0_ok:
    s_atomic_add s63, s[22:23], s46
    s_branch c_st2
c_cs1:
    s_waitcnt vmcnt(0)
    s_atomic_add s40, s[22:23], s47
    s_branch c_cs2
c_layer:
    s_mov_b64 vcc, 0
    s_mov_b32 s68, 0
    s_atomic_add s68, s[22:23], s46 glc
c_early2:
    s_barrier
    ds_read_b64_tr_b16 v[32:33], v3 offset:0
    ds_read_b64_tr_b16 v[34:35], v3 offset:1024
    ds_read_b64_tr_b16 v[36:37], v4 offset:0
    ds_read_b64_tr_b16 v[38:39], v4 offset:1024
    ds_read_b64_tr_b16 v[40:41], v5 offset:0
    ds_read_b64_tr_b16 v[42:43], v5 offset:1024
    ds_read_b64_tr_b16 v[44:45], v6 offset:0
    ds_read_b64_tr_b16 v[46:47], v6 offset:1024
    ds_read_b64_tr_b16 v[48:49], v3 offset:4096
    ds_read_b64_tr_b16 v[50:51], v3 offset:5120
    ds_read_b64_tr_b16 v[52:53], v4 offset:4096
    ds_read_b64_tr_b16 v[54:55], v4 offset:5120
    ds_read_b64_tr_b16 v[56:57], v5 offset:4096
    ds_read_b64_tr_b16 v[58:59], v5 offset:5120
c_g0:
    s_waitcnt lgkmcnt(10)
    v_mfma_f32_16x16x32_bf16 v[64:67], v[32:35], v[160:163], 0
    ds_read_b64_tr_b16 v[60:61], v6 offset:4096
    v_mfma_f32_16x16x32_bf16 v[68:71], v[32:35], v[164:167], 0
    ds_read_b64_tr_b16 v[62:63], v6 offset:5120
    v_mfma_f32_16x16x32_bf16 v[72:75], v[36:39], v[160:163], 0
    ds_read_b64_tr_b16 v[32:33], v3 offset:8192
    v_mfma_f32_16x16x32_bf16 v[76:79], v[36:39], v[164:167], 0
    ds_read_b64_tr_b16 v[34:35], v3 offset:9216
    s_waitcnt lgkmcnt(10)
    v_mfma_f32_16x16x32_bf16 v[80:83], v[40:43], v[160:163], 0
    ds_read_b64_tr_b16 v[36:37], v4 offset:8192
    v_mfma_f32_16x16x32_bf16 v[84:87], v[40:43], v[164:167], 0
    ds_read_b64_tr_b16 v[38:39], v4 offset:9216
    v_mfma_f32_16x16x32_bf16 v[88:91], v[44:47], v[160:163], 0
    ds_read_b64_tr_b16 v[40:41], v5 offset:8192
    v_mfma_f32_16x16x32_bf16 v[92:95], v[44:47], v[164:167], 0
    ds_read_b64_tr_b16 v[42:43], v5 offset:9216
    s_waitcnt lgkmcnt(10)
    v_mfma_f32_16x16x32_bf16 v[96:99], v[160:163], v[48:51], 0
    ds_read_b64_tr_b16 v[44:45], v6 offset:8192
    v_mfma_f32_16x16x32_bf16 v[100:103], v[164:167], v[48:51], 0
    ds_read_b64_tr_b16 v[46:47], v6 offset:9216
    v_mfma_f32_16x16x32_bf16 v[104:107], v[160:163], v[52:55], 0
    ds_read_b64_tr_b16 v[48:49], v3 offset:12288
    v_mfma_f32_16x16x32_bf16 v[108:111], v[164:167], v[52:55], 0
    ds_read_b64_tr_b16 v[50:51], v3 offset:13312
    s_waitcnt lgkmcnt(10)
    v_mfma_f32_16x16x32_bf16 v[112:115], v[160:163], v[56:59], 0
    ds_read_b64_tr_b16 v[52:53], v4 offset:12288
    v_mfma_f32_16x16x32_bf16 v[116:119], v[164:167], v[56:59], 0
    ds_read_b64_tr_b16 v[54:55], v4 offset:13312
    v_mfma_f32_16x16x32_bf16 v[120:123], v[160:163], v[60:63], 0
    ds_read_b64_tr_b16 v[56:57], v5 offset:12288
    v_mfma_f32_16x16x32_bf16 v[124:127], v[164:167], v[60:63], 0
    ds_read_b64_tr_b16 v[58:59], v5 offset:13312
    s_cmp_lg_u32 s48, 0
    s_cbranch_scc1 c_gate
    s_mov_b32 s66, 0x10000
    s_waitcnt lgkmcnt(0)
    s_and_b32 s68, s68, s19
    s_cmp_eq_u32 s68, s19
    s_cbranch_scc1 c_x_ok
c_x_poll:
    s_mov_b32 s68, 0
    s_atomic_add s68, s[22:23], s46 offset:0 glc
    s_sub_u32 s66, s66, 1
    s_cselect_b32 s67, s19, 0
    s_waitcnt lgkmcnt(0)
    s_and_b32 s68, s68, s19
    s_max_u32 s68, s68, s67
    s_cmp_lt_u32 s68, s19
    s_cbranch_scc1 c_x_poll
c_x_ok:
    s_add_u32 s42, s41, s85
    buffer_load_dwordx4 v[176:179], v2, s[4:7], s42 offen offset:0 sc1
    buffer_load_dwordx4 v[180:183], v2, s[4:7], s42 offen offset:256 sc1
    buffer_load_dwordx4 v[184:187], v2, s[4:7], s42 offen offset:2048 sc1
    buffer_load_dwordx4 v[188:191], v2, s[4:7], s42 offen offset:2304 sc1
    s_add_u32 s42, s41, s86
    buffer_load_dwordx4 v[192:195], v2, s[4:7], s42 offen offset:0 sc1
    buffer_load_dwordx4 v[196:199], v2, s[4:7], s42 offen offset:256 sc1
    buffer_load_dwordx4 v[200:203], v2, s[4:7], s42 offen offset:2048 sc1
    buffer_load_dwordx4 v[204:207], v2, s[4:7], s42 offen offset:2304 sc1
    s_add_u32 s42, s41, s87
    buffer_load_dwordx4 v[208:211], v2, s[4:7], s42 offen offset:0 sc1
    buffer_load_dwordx4 v[212:215], v2, s[4:7], s42 offen offset:256 sc1
    s_waitcnt vmcnt(10)
    s_atomic_add s40, s[22:23], s47
c_gate:
    s_waitcnt lgkmcnt(10)
    v_mfma_f32_16x16x32_bf16 v[128:131], v[32:35], v[160:163], 0
    ds_read_b64_tr_b16 v[60:61], v6 offset:12288
    v_mfma_f32_16x16x32_bf16 v[132:135], v[32:35], v[164:167], 0
    ds_read_b64_tr_b16 v[62:63], v6 offset:13312
    v_mfma_f32_16x16x32_bf16 v[136:139], v[36:39], v[160:163], 0
    ds_read_b64_tr_b16 v[32:33], v3 offset:16384
    v_mfma_f32_16x16x32_bf16 v[140:143], v[36:39], v[164:167], 0
    ds_read_b64_tr_b16 v[34:35], v3 offset:17408
    s_waitcnt lgkmcnt(10)
    v_mfma_f32_16x16x32_bf16 v[144:147], v[40:43], v[160:163], 0
    ds_read_b64_tr_b16 v[36:37], v4 offset:16384
    v_mfma_f32_16x16x32_bf16 v[148:151], v[40:43], v[164:167], 0
    ds_read_b64_tr_b16 v[38:39], v4 offset:17408
    v_mfma_f32_16x16x32_bf16 v[152:155], v[44:47], v[160:163], 0
    ds_read_b64_tr_b16 v[40:41], v5 offset:16384
    v_mfma_f32_16x16x32_bf16 v[156:159], v[44:47], v[164:167], 0
    ds_read_b64_tr_b16 v[42:43], v5 offset:17408
    s_waitcnt lgkmcnt(10)
    v_mfma_f32_16x16x32_bf16 v[64:67], v[48:51], v[168:171], v[64:67]
    ds_read_b64_tr_b16 v[44:45], v6 offset:16384
    v_mfma_f32_16x16x32_bf16 v[68:71], v[48:51], v[172:175], v[68:71]
    ds_read_b64_tr_b16 v[46:47], v6 offset:17408
    v_mfma_f32_16x16x32_bf16 v[72:75], v[52:55], v[168:171], v[72:75]
    ds_read_b64_tr_b16 v[48:49], v3 offset:20480
    v_mfma_f32_16x16x32_bf16 v[76:79], v[52:55], v[172:175], v[76:79]
    ds_read_b64_tr_b16 v[50:51], v3 offset:21504
    s_waitcnt lgkmcnt(10)
    v_mfma_f32_16x16x32_bf16 v[80:83], v[56:59], v[168:171], v[80:83]
    ds_read_b64_tr_b16 v[52:53], v4 offset:20480
    v_mfma_f32_16x16x32_bf16 v[84:87], v[56:59], v[172:175], v[84:87]
    ds_read_b64_tr_b16 v[54:55], v4 offset:21504
    v_mfma_f32_16x16x32_bf16 v[88:91], v[60:63], v[168:171], v[88:91]
    ds_read_b64_tr_b16 v[56:57], v5 offset:20480
    v_mfma_f32_16x16x32_bf16 v[92:95], v[60:63], v[172:175], v[92:95]
    ds_read_b64_tr_b16 v[58:59], v5 offset:21504
    s_waitcnt lgkmcnt(10)
    v_mfma_f32_16x16x32_bf16 v[96:99], v[168:171], v[32:35], v[96:99]
    ds_read_b64_tr_b16 v[60:61], v6 offset:20480
    v_mfma_f32_16x16x32_bf16 v[100:103], v[172:175], v[32:35], v[100:103]
    ds_read_b64_tr_b16 v[62:63], v6 offset:21504
    v_mfma_f32_16x16x32_bf16 v[104:107], v[168:171], v[36:39], v[104:107]
    ds_read_b64_tr_b16 v[32:33], v3 offset:24576
    v_mfma_f32_16x16x32_bf16 v[108:111], v[172:175], v[36:39], v[108:111]
    ds_read_b64_tr_b16 v[34:35], v3 offset:25600
    s_waitcnt lgkmcnt(10)
    v_mfma_f32_16x16x32_bf16 v[112:115], v[168:171], v[40:43], v[112:115]
    ds_read_b64_tr_b16 v[36:37], v4 offset:24576
    v_mfma_f32_16x16x32_bf16 v[116:119], v[172:175], v[40:43], v[116:119]
    ds_read_b64_tr_b16 v[38:39], v4 offset:25600
    v_mfma_f32_16x16x32_bf16 v[120:123], v[168:171], v[44:47], v[120:123]
    ds_read_b64_tr_b16 v[40:41], v5 offset:24576
    v_mfma_f32_16x16x32_bf16 v[124:127], v[172:175], v[44:47], v[124:127]
    ds_read_b64_tr_b16 v[42:43], v5 offset:25600
    s_waitcnt lgkmcnt(10)
    v_mfma_f32_16x16x32_bf16 v[128:131], v[48:51], v[168:171], v[128:131]
    ds_read_b64_tr_b16 v[44:45], v6 offset:24576
    v_mfma_f32_16x16x32_bf16 v[132:135], v[48:51], v[172:175], v[132:135]
    ds_read_b64_tr_b16 v[46:47], v6 offset:25600
    v_mfma_f32_16x16x32_bf16 v[136:139], v[52:55], v[168:171], v[136:139]
    ds_read_b64_tr_b16 v[48:49], v3 offset:28672
    v_mfma_f32_16x16x32_bf16 v[140:143], v[52:55], v[172:175], v[140:143]
    ds_read_b64_tr_b16 v[50:51], v3 offset:29696
    s_waitcnt lgkmcnt(10)
    v_mfma_f32_16x16x32_bf16 v[144:147], v[56:59], v[168:171], v[144:147]
    ds_read_b64_tr_b16 v[52:53], v4 offset:28672
    v_mfma_f32_16x16x32_bf16 v[148:151], v[56:59], v[172:175], v[148:151]
    ds_read_b64_tr_b16 v[54:55], v4 offset:29696
    v_mfma_f32_16x16x32_bf16 v[152:155], v[60:63], v[168:171], v[152:155]
    ds_read_b64_tr_b16 v[56:57], v5 offset:28672
    v_mfma_f32_16x16x32_bf16 v[156:159], v[60:63], v[172:175], v[156:159]
    ds_read_b64_tr_b16 v[58:59], v5 offset:29696
    s_cbranch_vccnz c_st1
c_st2:
    s_waitcnt vmcnt(8) lgkmcnt(10)
    v_mfma_f32_16x16x32_bf16 v[64:67], v[32:35], v[176:179], v[64:67]
    ds_read_b64_tr_b16 v[60:61], v6 offset:28672
    v_mfma_f32_16x16x32_bf16 v[68:71], v[32:35], v[180:183], v[68:71]
    ds_read_b64_tr_b16 v[62:63], v6 offset:29696
    s_barrier
    v_mfma_f32_16x16x32_bf16 v[72:75], v[36:39], v[176:179], v[72:75]
    ds_read_b64_tr_b16 v[32:33], v3 offset:32768
    v_mfma_f32_16x16x32_bf16 v[76:79], v[36:39], v[180:183], v[76:79]
    ds_read_b64_tr_b16 v[34:35], v3 offset:33792
    s_waitcnt lgkmcnt(10)
    v_mfma_f32_16x16x32_bf16 v[80:83], v[40:43], v[176:179], v[80:83]
    ds_read_b64_tr_b16 v[36:37], v4 offset:32768
    v_mfma_f32_16x16x32_bf16 v[84:87], v[40:43], v[180:183], v[84:87]
    ds_read_b64_tr_b16 v[38:39], v4 offset:33792
    v_mfma_f32_16x16x32_bf16 v[88:91], v[44:47], v[176:179], v[88:91]
    ds_read_b64_tr_b16 v[40:41], v5 offset:32768
    v_mfma_f32_16x16x32_bf16 v[92:95], v[44:47], v[180:183], v[92:95]
    ds_read_b64_tr_b16 v[42:43], v5 offset:33792
    s_waitcnt lgkmcnt(10)
    v_mfma_f32_16x16x32_bf16 v[96:99], v[176:179], v[48:51], v[96:99]
    ds_read_b64_tr_b16 v[44:45], v6 offset:32768
    v_mfma_f32_16x16x32_bf16 v[100:103], v[180:183], v[48:51], v[100:103]
    ds_read_b64_tr_b16 v[46:47], v6 offset:33792
    v_mfma_f32_16x16x32_bf16 v[104:107], v[176:179], v[52:55], v[104:107]
    ds_read_b64_tr_b16 v[48:49], v3 offset:36864
    v_mfma_f32_16x16x32_bf16 v[108:111], v[180:183], v[52:55], v[108:111]
    ds_read_b64_tr_b16 v[50:51], v3 offset:37888
    s_waitcnt lgkmcnt(10)
    v_mfma_f32_16x16x32_bf16 v[112:115], v[176:179], v[56:59], v[112:115]
    ds_read_b64_tr_b16 v[52:53], v4 offset:36864
    v_mfma_f32_16x16x32_bf16 v[116:119], v[180:183], v[56:59], v[116:119]
    ds_read_b64_tr_b16 v[54:55], v4 offset:37888
    v_mfma_f32_16x16x32_bf16 v[120:123], v[176:179], v[60:63], v[120:123]
    ds_read_b64_tr_b16 v[56:57], v5 offset:36864
    v_mfma_f32_16x16x32_bf16 v[124:127], v[180:183], v[60:63], v[124:127]
    ds_read_b64_tr_b16 v[58:59], v5 offset:37888
    s_waitcnt lgkmcnt(10)
    v_mfma_f32_16x16x32_bf16 v[128:131], v[32:35], v[176:179], v[128:131]
    ds_read_b64_tr_b16 v[60:61], v6 offset:36864
    v_mfma_f32_16x16x32_bf16 v[132:135], v[32:35], v[180:183], v[132:135]
    ds_read_b64_tr_b16 v[62:63], v6 offset:37888
    v_mfma_f32_16x16x32_bf16 v[136:139], v[36:39], v[176:179], v[136:139]
    ds_read_b64_tr_b16 v[32:33], v3 offset:40960
    v_mfma_f32_16x16x32_bf16 v[140:143], v[36:39], v[180:183], v[140:143]
    ds_read_b64_tr_b16 v[34:35], v3 offset:41984
    s_waitcnt lgkmcnt(10)
    v_mfma_f32_16x16x32_bf16 v[144:147], v[40:43], v[176:179], v[144:147]
    ds_read_b64_tr_b16 v[36:37], v4 offset:40960
    v_mfma_f32_16x16x32_bf16 v[148:151], v[40:43], v[180:183], v[148:151]
    ds_read_b64_tr_b16 v[38:39], v4 offset:41984
    v_mfma_f32_16x16x32_bf16 v[152:155], v[44:47], v[176:179], v[152:155]
    ds_read_b64_tr_b16 v[40:41], v5 offset:40960
    v_mfma_f32_16x16x32_bf16 v[156:159], v[44:47], v[180:183], v[156:159]
    ds_read_b64_tr_b16 v[42:43], v5 offset:41984
    s_waitcnt vmcnt(6) lgkmcnt(10)
    v_mfma_f32_16x16x32_bf16 v[64:67], v[48:51], v[184:187], v[64:67]
    s_add_u32 s42, s41, s87
    s_cbranch_vccnz xs1
    buffer_load_dwordx4 v[216:219], v2, s[4:7], s42 offen offset:2048 sc1
xs1:
    ds_read_b64_tr_b16 v[44:45], v6 offset:40960
    v_mfma_f32_16x16x32_bf16 v[68:71], v[48:51], v[188:191], v[68:71]
    ds_read_b64_tr_b16 v[46:47], v6 offset:41984
    v_mfma_f32_16x16x32_bf16 v[72:75], v[52:55], v[184:187], v[72:75]
    s_cbranch_vccnz xs2
    buffer_load_dwordx4 v[220:223], v2, s[4:7], s42 offen offset:2304 sc1
xs2:
    ds_read_b64_tr_b16 v[48:49], v3 offset:45056
    s_add_u32 s42, s41, s88
    v_mfma_f32_16x16x32_bf16 v[76:79], v[52:55], v[188:191], v[76:79]
    ds_read_b64_tr_b16 v[50:51], v3 offset:46080
    s_waitcnt lgkmcnt(10)
    v_mfma_f32_16x16x32_bf16 v[80:83], v[56:59], v[184:187], v[80:83]
    s_cbranch_vccnz xs3
    buffer_load_dwordx4 v[224:227], v2, s[4:7], s42 offen offset:0 sc1
xs3:
    ds_read_b64_tr_b16 v[52:53], v4 offset:45056
    v_mfma_f32_16x16x32_bf16 v[84:87], v[56:59], v[188:191], v[84:87]
    ds_read_b64_tr_b16 v[54:55], v4 offset:46080
    v_mfma_f32_16x16x32_bf16 v[88:91], v[60:63], v[184:187], v[88:91]
    s_cbranch_vccnz xs4
    buffer_load_dwordx4 v[228:231], v2, s[4:7], s42 offen offset:256 sc1
xs4:
    ds_read_b64_tr_b16 v[56:57], v5 offset:45056
    v_mfma_f32_16x16x32_bf16 v[92:95], v[60:63], v[188:191], v[92:95]
    ds_read_b64_tr_b16 v[58:59], v5 offset:46080
    s_waitcnt lgkmcnt(10)
    v_mfma_f32_16x16x32_bf16 v[96:99], v[184:187], v[32:35], v[96:99]
    ds_read_b64_tr_b16 v[60:61], v6 offset:45056
    s_cbranch_vccnz xs5
    buffer_load_dwordx4 v[232:235], v2, s[4:7], s42 offen offset:2048 sc1
xs5:
    s_cbranch_vccnz c_cs1
c_cs2:
    v_mfma_f32_16x16x32_bf16 v[100:103], v[188:191], v[32:35], v[100:103]
    ds_read_b64_tr_b16 v[62:63], v6 offset:46080
    v_mfma_f32_16x16x32_bf16 v[104:107], v[184:187], v[36:39], v[104:107]
    s_cbranch_vccnz xs6
    buffer_load_dwordx4 v[236:239], v2, s[4:7], s42 offen offset:2304 sc1
xs6:
    ds_read_b64_tr_b16 v[32:33], v3 offset:49152
    s_add_u32 s42, s41, s89
    v_mfma_f32_16x16x32_bf16 v[108:111], v[188:191], v[36:39], v[108:111]
    ds_read_b64_tr_b16 v[34:35], v3 offset:50176
    s_waitcnt lgkmcnt(10)
    v_mfma_f32_16x16x32_bf16 v[112:115], v[184:187], v[40:43], v[112:115]
    ds_read_b64_tr_b16 v[36:37], v4 offset:49152
    v_mfma_f32_16x16x32_bf16 v[116:119], v[188:191], v[40:43], v[116:119]
    ds_read_b64_tr_b16 v[38:39], v4 offset:50176
    v_mfma_f32_16x16x32_bf16 v[120:123], v[184:187], v[44:47], v[120:123]
    ds_read_b64_tr_b16 v[40:41], v5 offset:49152
    v_mfma_f32_16x16x32_bf16 v[124:127], v[188:191], v[44:47], v[124:127]
    ds_read_b64_tr_b16 v[42:43], v5 offset:50176
    s_waitcnt lgkmcnt(10)
    v_mfma_f32_16x16x32_bf16 v[128:131], v[48:51], v[184:187], v[128:131]
    ds_read_b64_tr_b16 v[44:45], v6 offset:49152
    v_mfma_f32_16x16x32_bf16 v[132:135], v[48:51], v[188:191], v[132:135]
    ds_read_b64_tr_b16 v[46:47], v6 offset:50176
    v_mfma_f32_16x16x32_bf16 v[136:139], v[52:55], v[184:187], v[136:139]
    ds_read_b64_tr_b16 v[48:49], v3 offset:53248
    v_mfma_f32_16x16x32_bf16 v[140:143], v[52:55], v[188:191], v[140:143]
    ds_read_b64_tr_b16 v[50:51], v3 offset:54272
    s_waitcnt lgkmcnt(10)
    v_mfma_f32_16x16x32_bf16 v[144:147], v[56:59], v[184:187], v[144:147]
    ds_read_b64_tr_b16 v[52:53], v4 offset:53248
    v_mfma_f32_16x16x32_bf16 v[148:151], v[56:59], v[188:191], v[148:151]
    ds_read_b64_tr_b16 v[54:55], v4 offset:54272
    v_mfma_f32_16x16x32_bf16 v[152:155], v[60:63], v[184:187], v[152:155]
    ds_read_b64_tr_b16 v[56:57], v5 offset:53248
    v_mfma_f32_16x16x32_bf16 v[156:159], v[60:63], v[188:191], v[156:159]
    ds_read_b64_tr_b16 v[58:59], v5 offset:54272
    s_waitcnt vmcnt(10) lgkmcnt(10)
    v_mfma_f32_16x16x32_bf16 v[64:67], v[32:35], v[192:195], v[64:67]
    ds_read_b64_tr_b16 v[60:61], v6 offset:53248
    v_mfma_f32_16x16x32_bf16 v[68:71], v[32:35], v[196:199], v[68:71]
    ds_read_b64_tr_b16 v[62:63], v6 offset:54272
    v_mfma_f32_16x16x32_bf16 v[72:75], v[36:39], v[192:195], v[72:75]
    ds_read_b64_tr_b16 v[32:33], v3 offset:57344
    v_mfma_f32_16x16x32_bf16 v[76:79], v[36:39], v[196:199], v[76:79]
    ds_read_b64_tr_b16 v[34:35], v3 offset:58368
    s_waitcnt lgkmcnt(10)
    v_mfma_f32_16x16x32_bf16 v[80:83], v[40:43], v[192:195], v[80:83]
    ds_read_b64_tr_b16 v[36:37], v4 offset:57344
    v_mfma_f32_16x16x32_bf16 v[84:87], v[40:43], v[196:199], v[84:87]
    ds_read_b64_tr_b16 v[38:39], v4 offset:58368
    v_mfma_f32_16x16x32_bf16 v[88:91], v[44:47], v[192:195], v[88:91]
    ds_read_b64_tr_b16 v[40:41], v5 offset:57344
    v_mfma_f32_16x16x32_bf16 v[92:95], v[44:47], v[196:199], v[92:95]
    ds_read_b64_tr_b16 v[42:43], v5 offset:58368
    s_waitcnt lgkmcnt(10)
    v_mfma_f32_16x16x32_bf16 v[96:99], v[192:195], v[48:51], v[96:99]
    ds_read_b64_tr_b16 v[44:45], v6 offset:57344
    v_mfma_f32_16x16x32_bf16 v[100:103], v[196:199], v[48:51], v[100:103]
    ds_read_b64_tr_b16 v[46:47], v6 offset:58368
    v_mfma_f32_16x16x32_bf16 v[104:107], v[192:195], v[52:55], v[104:107]
    ds_read_b64_tr_b16 v[48:49], v3 offset:61440
    v_mfma_f32_16x16x32_bf16 v[108:111], v[196:199], v[52:55], v[108:111]
    ds_read_b64_tr_b16 v[50:51], v3 offset:62464
    s_waitcnt lgkmcnt(10)
    v_mfma_f32_16x16x32_bf16 v[112:115], v[192:195], v[56:59], v[112:115]
    ds_read_b64_tr_b16 v[52:53], v4 offset:61440
    v_mfma_f32_16x16x32_bf16 v[116:119], v[196:199], v[56:59], v[116:119]
    ds_read_b64_tr_b16 v[54:55], v4 offset:62464
    v_mfma_f32_16x16x32_bf16 v[120:123], v[192:195], v[60:63], v[120:123]
    ds_read_b64_tr_b16 v[56:57], v5 offset:61440
    v_mfma_f32_16x16x32_bf16 v[124:127], v[196:199], v[60:63], v[124:127]
    ds_read_b64_tr_b16 v[58:59], v5 offset:62464
    s_waitcnt lgkmcnt(10)
    v_mfma_f32_16x16x32_bf16 v[128:131], v[32:35], v[192:195], v[128:131]
    ds_read_b64_tr_b16 v[60:61], v6 offset:61440
    v_mfma_f32_16x16x32_bf16 v[132:135], v[32:35], v[196:199], v[132:135]
    ds_read_b64_tr_b16 v[62:63], v6 offset:62464
    s_barrier
    v_xor_b32 v3, 0x10000, v3
    v_xor_b32 v4, 0x10000, v4
    v_xor_b32 v5, 0x10000, v5
    v_xor_b32 v6, 0x10000, v6
    v_mfma_f32_16x16x32_bf16 v[136:139], v[36:39], v[192:195], v[136:139]
    ds_read_b64_tr_b16 v[32:33], v3 offset:0
    v_mfma_f32_16x16x32_bf16 v[140:143], v[36:39], v[196:199], v[140:143]
    ds_read_b64_tr_b16 v[34:35], v3 offset:1024
    s_waitcnt lgkmcnt(10)
    v_mfma_f32_16x16x32_bf16 v[144:147], v[40:43], v[192:195], v[144:147]
    ds_read_b64_tr_b16 v[36:37], v4 offset:0
    v_mfma_f32_16x16x32_bf16 v[148:151], v[40:43], v[196:199], v[148:151]
    ds_read_b64_tr_b16 v[38:39], v4 offset:1024
    v_mfma_f32_16x16x32_bf16 v[152:155], v[44:47], v[192:195], v[152:155]
    ds_read_b64_tr_b16 v[40:41], v5 offset:0
    v_mfma_f32_16x16x32_bf16 v[156:159], v[44:47], v[196:199], v[156:159]
    ds_read_b64_tr_b16 v[42:43], v5 offset:1024
    s_waitcnt vmcnt(8) lgkmcnt(10)
    v_mfma_f32_16x16x32_bf16 v[64:67], v[48:51], v[200:203], v[64:67]
    ds_read_b64_tr_b16 v[44:45], v6 offset:0
    v_mfma_f32_16x16x32_bf16 v[68:71], v[48:51], v[204:207], v[68:71]
    ds_read_b64_tr_b16 v[46:47], v6 offset:1024
    v_mfma_f32_16x16x32_bf16 v[72:75], v[52:55], v[200:203], v[72:75]
    ds_read_b64_tr_b16 v[48:49], v3 offset:4096
    v_mfma_f32_16x16x32_bf16 v[76:79], v[52:55], v[204:207], v[76:79]
    ds_read_b64_tr_b16 v[50:51], v3 offset:5120
    s_waitcnt lgkmcnt(10)
    v_mfma_f32_16x16x32_bf16 v[80:83], v[56:59], v[200:203], v[80:83]
    ds_read_b64_tr_b16 v[52:53], v4 offset:4096
    v_mfma_f32_16x16x32_bf16 v[84:87], v[56:59], v[204:207], v[84:87]
    ds_read_b64_tr_b16 v[54:55], v4 offset:5120
    v_mfma_f32_16x16x32_bf16 v[88:91], v[60:63], v[200:203], v[88:91]
    ds_read_b64_tr_b16 v[56:57], v5 offset:4096
    v_mfma_f32_16x16x32_bf16 v[92:95], v[60:63], v[204:207], v[92:95]
    ds_read_b64_tr_b16 v[58:59], v5 offset:5120
    s_waitcnt lgkmcnt(10)
    v_mfma_f32_16x16x32_bf16 v[96:99], v[200:203], v[32:35], v[96:99]
    ds_read_b64_tr_b16 v[60:61], v6 offset:4096
    v_mfma_f32_16x16x32_bf16 v[100:103], v[204:207], v[32:35], v[100:103]
    ds_read_b64_tr_b16 v[62:63], v6 offset:5120
    v_mfma_f32_16x16x32_bf16 v[104:107], v[200:203], v[36:39], v[104:107]
    ds_read_b64_tr_b16 v[32:33], v3 offset:8192
    v_mfma_f32_16x16x32_bf16 v[108:111], v[204:207], v[36:39], v[108:111]
    ds_read_b64_tr_b16 v[34:35], v3 offset:9216
    s_waitcnt lgkmcnt(10)
    v_mfma_f32_16x16x32_bf16 v[112:115], v[200:203], v[40:43], v[112:115]
    ds_read_b64_tr_b16 v[36:37], v4 offset:8192
    v_mfma_f32_16x16x32_bf16 v[116:119], v[204:207], v[40:43], v[116:119]
    ds_read_b64_tr_b16 v[38:39], v4 offset:9216
    v_mfma_f32_16x16x32_bf16 v[120:123], v[200:203], v[44:47], v[120:123]
    ds_read_b64_tr_b16 v[40:41], v5 offset:8192
    v_mfma_f32_16x16x32_bf16 v[124:127], v[204:207], v[44:47], v[124:127]
    ds_read_b64_tr_b16 v[42:43], v5 offset:9216
    s_waitcnt lgkmcnt(10)
    v_mfma_f32_16x16x32_bf16 v[128:131], v[48:51], v[200:203], v[128:131]
    ds_read_b64_tr_b16 v[44:45], v6 offset:8192
    v_mfma_f32_16x16x32_bf16 v[132:135], v[48:51], v[204:207], v[132:135]
    ds_read_b64_tr_b16 v[46:47], v6 offset:9216
    v_mfma_f32_16x16x32_bf16 v[136:139], v[52:55], v[200:203], v[136:139]
    ds_read_b64_tr_b16 v[48:49], v3 offset:12288
    v_mfma_f32_16x16x32_bf16 v[140:143], v[52:55], v[204:207], v[140:143]
    ds_read_b64_tr_b16 v[50:51], v3 offset:13312
    s_waitcnt lgkmcnt(10)
    v_mfma_f32_16x16x32_bf16 v[144:147], v[56:59], v[200:203], v[144:147]
    ds_read_b64_tr_b16 v[52:53], v4 offset:12288
    v_mfma_f32_16x16x32_bf16 v[148:151], v[56:59], v[204:207], v[148:151]
    ds_read_b64_tr_b16 v[54:55], v4 offset:13312
    v_mfma_f32_16x16x32_bf16 v[152:155], v[60:63], v[200:203], v[152:155]
    ds_read_b64_tr_b16 v[56:57], v5 offset:12288
    v_mfma_f32_16x16x32_bf16 v[156:159], v[60:63], v[204:207], v[156:159]
    ds_read_b64_tr_b16 v[58:59], v5 offset:13312
    s_waitcnt vmcnt(6) lgkmcnt(10)
    v_mfma_f32_16x16x32_bf16 v[64:67], v[32:35], v[208:211], v[64:67]
    ds_read_b64_tr_b16 v[60:61], v6 offset:12288
    v_mfma_f32_16x16x32_bf16 v[68:71], v[32:35], v[212:215], v[68:71]
    ds_read_b64_tr_b16 v[62:63], v6 offset:13312
    v_mfma_f32_16x16x32_bf16 v[72:75], v[36:39], v[208:211], v[72:75]
    ds_read_b64_tr_b16 v[32:33], v3 offset:16384
    v_mfma_f32_16x16x32_bf16 v[76:79], v[36:39], v[212:215], v[76:79]
    ds_read_b64_tr_b16 v[34:35], v3 offset:17408
    s_waitcnt lgkmcnt(10)
    v_mfma_f32_16x16x32_bf16 v[80:83], v[40:43], v[208:211], v[80:83]
    ds_read_b64_tr_b16 v[36:37], v4 offset:16384
    v_mfma_f32_16x16x32_bf16 v[84:87], v[40:43], v[212:215], v[84:87]
    ds_read_b64_tr_b16 v[38:39], v4 offset:17408
    v_mfma_f32_16x16x32_bf16 v[88:91], v[44:47], v[208:211], v[88:91]
    ds_read_b64_tr_b16 v[40:41], v5 offset:16384
    v_mfma_f32_16x16x32_bf16 v[92:95], v[44:47], v[212:215], v[92:95]
    ds_read_b64_tr_b16 v[42:43], v5 offset:17408
    s_waitcnt lgkmcnt(10)
    v_mfma_f32_16x16x32_bf16 v[96:99], v[208:211], v[48:51], v[96:99]
    buffer_load_dwordx4 v[240:243], v2, s[4:7], s42 offen offset:0 sc1
    ds_read_b64_tr_b16 v[44:45], v6 offset:16384
    v_mfma_f32_16x16x32_bf16 v[100:103], v[212:215], v[48:51], v[100:103]
    ds_read_b64_tr_b16 v[46:47], v6 offset:17408
    v_mfma_f32_16x16x32_bf16 v[104:107], v[208:211], v[52:55], v[104:107]
    buffer_load_dwordx4 v[244:247], v2, s[4:7], s42 offen offset:256 sc1
    ds_read_b64_tr_b16 v[48:49], v3 offset:20480
    v_mfma_f32_16x16x32_bf16 v[108:111], v[212:215], v[52:55], v[108:111]
    ds_read_b64_tr_b16 v[50:51], v3 offset:21504
    s_waitcnt lgkmcnt(10)
    v_mfma_f32_16x16x32_bf16 v[112:115], v[208:211], v[56:59], v[112:115]
    buffer_load_dwordx4 v[248:251], v2, s[4:7], s42 offen offset:2048 sc1
    ds_read_b64_tr_b16 v[52:53], v4 offset:20480
    v_mfma_f32_16x16x32_bf16 v[116:119], v[212:215], v[56:59], v[116:119]
    ds_read_b64_tr_b16 v[54:55], v4 offset:21504
    v_mfma_f32_16x16x32_bf16 v[120:123], v[208:211], v[60:63], v[120:123]
    buffer_load_dwordx4 v[252:255], v2, s[4:7], s42 offen offset:2304 sc1
    ds_read_b64_tr_b16 v[56:57], v5 offset:20480
    s_add_u32 s42, s41, s90
    v_mfma_f32_16x16x32_bf16 v[124:127], v[212:215], v[60:63], v[124:127]
    ds_read_b64_tr_b16 v[58:59], v5 offset:21504
    s_waitcnt lgkmcnt(10)
    v_mfma_f32_16x16x32_bf16 v[128:131], v[32:35], v[208:211], v[128:131]
    ds_read_b64_tr_b16 v[60:61], v6 offset:20480
    buffer_load_dwordx4 v[160:163], v2, s[4:7], s42 offen offset:0 sc1
    v_mfma_f32_16x16x32_bf16 v[132:135], v[32:35], v[212:215], v[132:135]
    ds_read_b64_tr_b16 v[62:63], v6 offset:21504
    v_mfma_f32_16x16x32_bf16 v[136:139], v[36:39], v[208:211], v[136:139]
    buffer_load_dwordx4 v[164:167], v2, s[4:7], s42 offen offset:256 sc1
    ds_read_b64_tr_b16 v[32:33], v3 offset:24576
    v_mfma_f32_16x16x32_bf16 v[140:143], v[36:39], v[212:215], v[140:143]
    ds_read_b64_tr_b16 v[34:35], v3 offset:25600
    s_waitcnt lgkmcnt(10)
    v_mfma_f32_16x16x32_bf16 v[144:147], v[40:43], v[208:211], v[144:147]
    buffer_load_dwordx4 v[168:171], v2, s[4:7], s42 offen offset:2048 sc1
    ds_read_b64_tr_b16 v[36:37], v4 offset:24576
    v_mfma_f32_16x16x32_bf16 v[148:151], v[40:43], v[212:215], v[148:151]
    ds_read_b64_tr_b16 v[38:39], v4 offset:25600
    v_mfma_f32_16x16x32_bf16 v[152:155], v[44:47], v[208:211], v[152:155]
    buffer_load_dwordx4 v[172:175], v2, s[4:7], s42 offen offset:2304 sc1
    ds_read_b64_tr_b16 v[40:41], v5 offset:24576
    s_add_u32 s42, s41, s91
    v_mfma_f32_16x16x32_bf16 v[156:159], v[44:47], v[212:215], v[156:159]
    ds_read_b64_tr_b16 v[42:43], v5 offset:25600
    s_waitcnt vmcnt(12) lgkmcnt(10)
    v_mfma_f32_16x16x32_bf16 v[64:67], v[48:51], v[216:219], v[64:67]
    buffer_load_dwordx4 v[176:179], v2, s[4:7], s42 offen offset:0 sc1
    ds_read_b64_tr_b16 v[44:45], v6 offset:24576
    v_mfma_f32_16x16x32_bf16 v[68:71], v[48:51], v[220:223], v[68:71]
    ds_read_b64_tr_b16 v[46:47], v6 offset:25600
    v_mfma_f32_16x16x32_bf16 v[72:75], v[52:55], v[216:219], v[72:75]
    buffer_load_dwordx4 v[180:183], v2, s[4:7], s42 offen offset:256 sc1
    ds_read_b64_tr_b16 v[48:49], v3 offset:28672
    v_mfma_f32_16x16x32_bf16 v[76:79], v[52:55], v[220:223], v[76:79]
    ds_read_b64_tr_b16 v[50:51], v3 offset:29696
    s_waitcnt lgkmcnt(10)
    v_mfma_f32_16x16x32_bf16 v[80:83], v[56:59], v[216:219], v[80:83]
    buffer_load_dwordx4 v[184:187], v2, s[4:7], s42 offen offset:2048 sc1
    ds_read_b64_tr_b16 v[52:53], v4 offset:28672
    v_mfma_f32_16x16x32_bf16 v[84:87], v[56:59], v[220:223], v[84:87]
    ds_read_b64_tr_b16 v[54:55], v4 offset:29696
    v_mfma_f32_16x16x32_bf16 v[88:91], v[60:63], v[216:219], v[88:91]
    buffer_load_dwordx4 v[188:191], v2, s[4:7], s42 offen offset:2304 sc1
    ds_read_b64_tr_b16 v[56:57], v5 offset:28672
    s_add_u32 s42, s41, s92
    v_mfma_f32_16x16x32_bf16 v[92:95], v[60:63], v[220:223], v[92:95]
    ds_read_b64_tr_b16 v[58:59], v5 offset:29696
    s_waitcnt lgkmcnt(10)
    v_mfma_f32_16x16x32_bf16 v[96:99], v[216:219], v[32:35], v[96:99]
    ds_read_b64_tr_b16 v[60:61], v6 offset:28672
    v_mfma_f32_16x16x32_bf16 v[100:103], v[220:223], v[32:35], v[100:103]
    ds_read_b64_tr_b16 v[62:63], v6 offset:29696
    s_barrier
    v_mfma_f32_16x16x32_bf16 v[104:107], v[216:219], v[36:39], v[104:107]
    ds_read_b64_tr_b16 v[32:33], v3 offset:32768
    v_mfma_f32_16x16x32_bf16 v[108:111], v[220:223], v[36:39], v[108:111]
    ds_read_b64_tr_b16 v[34:35], v3 offset:33792
    s_waitcnt lgkmcnt(10)
    v_mfma_f32_16x16x32_bf16 v[112:115], v[216:219], v[40:43], v[112:115]
    ds_read_b64_tr_b16 v[36:37], v4 offset:32768
    v_mfma_f32_16x16x32_bf16 v[116:119], v[220:223], v[40:43], v[116:119]
    ds_read_b64_tr_b16 v[38:39], v4 offset:33792
    v_mfma_f32_16x16x32_bf16 v[120:123], v[216:219], v[44:47], v[120:123]
    ds_read_b64_tr_b16 v[40:41], v5 offset:32768
    v_mfma_f32_16x16x32_bf16 v[124:127], v[220:223], v[44:47], v[124:127]
    ds_read_b64_tr_b16 v[42:43], v5 offset:33792
    s_waitcnt lgkmcnt(10)
    v_mfma_f32_16x16x32_bf16 v[128:131], v[48:51], v[216:219], v[128:131]
    ds_read_b64_tr_b16 v[44:45], v6 offset:32768
    v_mfma_f32_16x16x32_bf16 v[132:135], v[48:51], v[220:223], v[132:135]
    ds_read_b64_tr_b16 v[46:47], v6 offset:33792
    v_mfma_f32_16x16x32_bf16 v[136:139], v[52:55], v[216:219], v[136:139]
    ds_read_b64_tr_b16 v[48:49], v3 offset:36864
    v_mfma_f32_16x16x32_bf16 v[140:143], v[52:55], v[220:223], v[140:143]
    ds_read_b64_tr_b16 v[50:51], v3 offset:37888
    s_waitcnt lgkmcnt(10)
    v_mfma_f32_16x16x32_bf16 v[144:147], v[56:59], v[216:219], v[144:147]
    ds_read_b64_tr_b16 v[52:53], v4 offset:36864
    v_mfma_f32_16x16x32_bf16 v[148:151], v[56:59], v[220:223], v[148:151]
    ds_read_b64_tr_b16 v[54:55], v4 offset:37888
    v_mfma_f32_16x16x32_bf16 v[152:155], v[60:63], v[216:219], v[152:155]
    ds_read_b64_tr_b16 v[56:57], v5 offset:36864
    v_mfma_f32_16x16x32_bf16 v[156:159], v[60:63], v[220:223], v[156:159]
    ds_read_b64_tr_b16 v[58:59], v5 offset:37888
    s_waitcnt vmcnt(14) lgkmcnt(10)
    v_mfma_f32_16x16x32_bf16 v[64:67], v[32:35], v[224:227], v[64:67]
    ds_read_b64_tr_b16 v[60:61], v6 offset:36864
    v_mfma_f32_16x16x32_bf16 v[68:71], v[32:35], v[228:231], v[68:71]
    ds_read_b64_tr_b16 v[62:63], v6 offset:37888
    v_mfma_f32_16x16x32_bf16 v[72:75], v[36:39], v[224:227], v[72:75]
    ds_read_b64_tr_b16 v[32:33], v3 offset:40960
    v_mfma_f32_16x16x32_bf16 v[76:79], v[36:39], v[228:231], v[76:79]
    ds_read_b64_tr_b16 v[34:35], v3 offset:41984
    s_waitcnt lgkmcnt(10)
    v_mfma_f32_16x16x32_bf16 v[80:83], v[40:43], v[224:227], v[80:83]
    ds_read_b64_tr_b16 v[36:37], v4 offset:40960
    v_mfma_f32_16x16x32_bf16 v[84:87], v[40:43], v[228:231], v[84:87]
    ds_read_b64_tr_b16 v[38:39], v4 offset:41984
    v_mfma_f32_16x16x32_bf16 v[88:91], v[44:47], v[224:227], v[88:91]
    ds_read_b64_tr_b16 v[40:41], v5 offset:40960
    v_mfma_f32_16x16x32_bf16 v[92:95], v[44:47], v[228:231], v[92:95]
    ds_read_b64_tr_b16 v[42:43], v5 offset:41984
    s_waitcnt lgkmcnt(10)
    v_mfma_f32_16x16x32_bf16 v[96:99], v[224:227], v[48:51], v[96:99]
    ds_read_b64_tr_b16 v[44:45], v6 offset:40960
    v_mfma_f32_16x16x32_bf16 v[100:103], v[228:231], v[48:51], v[100:103]
    ds_read_b64_tr_b16 v[46:47], v6 offset:41984
    v_mfma_f32_16x16x32_bf16 v[104:107], v[224:227], v[52:55], v[104:107]
    ds_read_b64_tr_b16 v[48:49], v3 offset:45056
    v_mfma_f32_16x16x32_bf16 v[108:111], v[228:231], v[52:55], v[108:111]
    ds_read_b64_tr_b16 v[50:51], v3 offset:46080
    s_waitcnt lgkmcnt(10)
    v_mfma_f32_16x16x32_bf16 v[112:115], v[224:227], v[56:59], v[112:115]
    ds_read_b64_tr_b16 v[52:53], v4 offset:45056
    v_mfma_f32_16x16x32_bf16 v[116:119], v[228:231], v[56:59], v[116:119]
    ds_read_b64_tr_b16 v[54:55], v4 offset:46080
    v_mfma_f32_16x16x32_bf16 v[120:123], v[224:227], v[60:63], v[120:123]
    ds_read_b64_tr_b16 v[56:57], v5 offset:45056
    v_mfma_f32_16x16x32_bf16 v[124:127], v[228:231], v[60:63], v[124:127]
    ds_read_b64_tr_b16 v[58:59], v5 offset:46080
    s_waitcnt lgkmcnt(10)
    v_mfma_f32_16x16x32_bf16 v[128:131], v[32:35], v[224:227], v[128:131]
    ds_read_b64_tr_b16 v[60:61], v6 offset:45056
    v_mfma_f32_16x16x32_bf16 v[132:135], v[32:35], v[228:231], v[132:135]
    ds_read_b64_tr_b16 v[62:63], v6 offset:46080
    v_mfma_f32_16x16x32_bf16 v[136:139], v[36:39], v[224:227], v[136:139]
    ds_read_b64_tr_b16 v[32:33], v3 offset:49152
    v_mfma_f32_16x16x32_bf16 v[140:143], v[36:39], v[228:231], v[140:143]
    ds_read_b64_tr_b16 v[34:35], v3 offset:50176
    s_waitcnt lgkmcnt(10)
    v_mfma_f32_16x16x32_bf16 v[144:147], v[40:43], v[224:227], v[144:147]
    ds_read_b64_tr_b16 v[36:37], v4 offset:49152
    v_mfma_f32_16x16x32_bf16 v[148:151], v[40:43], v[228:231], v[148:151]
    ds_read_b64_tr_b16 v[38:39], v4 offset:50176
    v_mfma_f32_16x16x32_bf16 v[152:155], v[44:47], v[224:227], v[152:155]
    ds_read_b64_tr_b16 v[40:41], v5 offset:49152
    v_mfma_f32_16x16x32_bf16 v[156:159], v[44:47], v[228:231], v[156:159]
    ds_read_b64_tr_b16 v[42:43], v5 offset:50176
    s_waitcnt vmcnt(12) lgkmcnt(10)
    v_mfma_f32_16x16x32_bf16 v[64:67], v[48:51], v[232:235], v[64:67]
    buffer_load_dwordx4 v[192:195], v2, s[4:7], s42 offen offset:0 sc1
    ds_read_b64_tr_b16 v[44:45], v6 offset:49152
    v_mfma_f32_16x16x32_bf16 v[68:71], v[48:51], v[236:239], v[68:71]
    ds_read_b64_tr_b16 v[46:47], v6 offset:50176
    v_mfma_f32_16x16x32_bf16 v[72:75], v[52:55], v[232:235], v[72:75]
    buffer_load_dwordx4 v[196:199], v2, s[4:7], s42 offen offset:256 sc1
    ds_read_b64_tr_b16 v[48:49], v3 offset:53248
    v_mfma_f32_16x16x32_bf16 v[76:79], v[52:55], v[236:239], v[76:79]
    ds_read_b64_tr_b16 v[50:51], v3 offset:54272
    s_waitcnt lgkmcnt(10)
    v_mfma_f32_16x16x32_bf16 v[80:83], v[56:59], v[232:235], v[80:83]
    buffer_load_dwordx4 v[200:203], v2, s[4:7], s42 offen offset:2048 sc1
    ds_read_b64_tr_b16 v[52:53], v4 offset:53248
    v_mfma_f32_16x16x32_bf16 v[84:87], v[56:59], v[236:239], v[84:87]
    ds_read_b64_tr_b16 v[54:55], v4 offset:54272
    v_mfma_f32_16x16x32_bf16 v[88:91], v[60:63], v[232:235], v[88:91]
    buffer_load_dwordx4 v[204:207], v2, s[4:7], s42 offen offset:2304 sc1
    ds_read_b64_tr_b16 v[56:57], v5 offset:53248
    s_add_u32 s42, s41, s93
    v_mfma_f32_16x16x32_bf16 v[92:95], v[60:63], v[236:239], v[92:95]
    ds_read_b64_tr_b16 v[58:59], v5 offset:54272
    s_waitcnt lgkmcnt(10)
    v_mfma_f32_16x16x32_bf16 v[96:99], v[232:235], v[32:35], v[96:99]
    ds_read_b64_tr_b16 v[60:61], v6 offset:53248
    buffer_load_dwordx4 v[208:211], v2, s[4:7], s42 offen offset:0 sc1
    v_mfma_f32_16x16x32_bf16 v[100:103], v[236:239], v[32:35], v[100:103]
    ds_read_b64_tr_b16 v[62:63], v6 offset:54272
    v_mfma_f32_16x16x32_bf16 v[104:107], v[232:235], v[36:39], v[104:107]
    ds_read_b64_tr_b16 v[32:33], v3 offset:57344
    v_mfma_f32_16x16x32_bf16 v[108:111], v[236:239], v[36:39], v[108:111]
    ds_read_b64_tr_b16 v[34:35], v3 offset:58368
    s_waitcnt lgkmcnt(10)
    v_mfma_f32_16x16x32_bf16 v[112:115], v[232:235], v[40:43], v[112:115]
    ds_read_b64_tr_b16 v[36:37], v4 offset:57344
    v_mfma_f32_16x16x32_bf16 v[116:119], v[236:239], v[40:43], v[116:119]
    ds_read_b64_tr_b16 v[38:39], v4 offset:58368
    v_mfma_f32_16x16x32_bf16 v[120:123], v[232:235], v[44:47], v[120:123]
    buffer_load_dwordx4 v[212:215], v2, s[4:7], s42 offen offset:256 sc1
    ds_read_b64_tr_b16 v[40:41], v5 offset:57344
    v_mfma_f32_16x16x32_bf16 v[124:127], v[236:239], v[44:47], v[124:127]
    ds_read_b64_tr_b16 v[42:43], v5 offset:58368
    s_waitcnt lgkmcnt(10)
    v_mfma_f32_16x16x32_bf16 v[128:131], v[48:51], v[232:235], v[128:131]
    ds_read_b64_tr_b16 v[44:45], v6 offset:57344
    v_mfma_f32_16x16x32_bf16 v[132:135], v[48:51], v[236:239], v[132:135]
    ds_read_b64_tr_b16 v[46:47], v6 offset:58368
    v_mfma_f32_16x16x32_bf16 v[136:139], v[52:55], v[232:235], v[136:139]
    ds_read_b64_tr_b16 v[48:49], v3 offset:61440
    v_mfma_f32_16x16x32_bf16 v[140:143], v[52:55], v[236:239], v[140:143]
    ds_read_b64_tr_b16 v[50:51], v3 offset:62464
    s_waitcnt lgkmcnt(10)
    v_mfma_f32_16x16x32_bf16 v[144:147], v[56:59], v[232:235], v[144:147]
    ds_read_b64_tr_b16 v[52:53], v4 offset:61440
    v_mfma_f32_16x16x32_bf16 v[148:151], v[56:59], v[236:239], v[148:151]
    ds_read_b64_tr_b16 v[54:55], v4 offset:62464
    v_mfma_f32_16x16x32_bf16 v[152:155], v[60:63], v[232:235], v[152:155]
    ds_read_b64_tr_b16 v[56:57], v5 offset:61440
    v_mfma_f32_16x16x32_bf16 v[156:159], v[60:63], v[236:239], v[156:159]
    ds_read_b64_tr_b16 v[58:59], v5 offset:62464
    s_waitcnt vmcnt(16) lgkmcnt(10)
    v_mfma_f32_16x16x32_bf16 v[64:67], v[32:35], v[240:243], v[64:67]
    ds_read_b64_tr_b16 v[60:61], v6 offset:61440
    v_mfma_f32_16x16x32_bf16 v[68:71], v[32:35], v[244:247], v[68:71]
    ds_read_b64_tr_b16 v[62:63], v6 offset:62464
    s_barrier
    v_xor_b32 v3, 0x10000, v3
    v_xor_b32 v4, 0x10000, v4
    v_xor_b32 v5, 0x10000, v5
    v_xor_b32 v6, 0x10000, v6
    v_mfma_f32_16x16x32_bf16 v[72:75], v[36:39], v[240:243], v[72:75]
    ds_read_b64_tr_b16 v[32:33], v3 offset:0
    v_mfma_f32_16x16x32_bf16 v[76:79], v[36:39], v[244:247], v[76:79]
    ds_read_b64_tr_b16 v[34:35], v3 offset:1024
    s_waitcnt lgkmcnt(10)
    v_mfma_f32_16x16x32_bf16 v[80:83], v[40:43], v[240:243], v[80:83]
    ds_read_b64_tr_b16 v[36:37], v4 offset:0
    v_mfma_f32_16x16x32_bf16 v[84:87], v[40:43], v[244:247], v[84:87]
    ds_read_b64_tr_b16 v[38:39], v4 offset:1024
    v_mfma_f32_16x16x32_bf16 v[88:91], v[44:47], v[240:243], v[88:91]
    ds_read_b64_tr_b16 v[40:41], v5 offset:0
    v_mfma_f32_16x16x32_bf16 v[92:95], v[44:47], v[244:247], v[92:95]
    ds_read_b64_tr_b16 v[42:43], v5 offset:1024
    s_waitcnt lgkmcnt(10)
    v_mfma_f32_16x16x32_bf16 v[96:99], v[240:243], v[48:51], v[96:99]
    ds_read_b64_tr_b16 v[44:45], v6 offset:0
    v_mfma_f32_16x16x32_bf16 v[100:103], v[244:247], v[48:51], v[100:103]
    ds_read_b64_tr_b16 v[46:47], v6 offset:1024
    v_mfma_f32_16x16x32_bf16 v[104:107], v[240:243], v[52:55], v[104:107]
    ds_read_b64_tr_b16 v[48:49], v3 offset:4096
    v_mfma_f32_16x16x32_bf16 v[108:111], v[244:247], v[52:55], v[108:111]
    ds_read_b64_tr_b16 v[50:51], v3 offset:5120
    s_waitcnt lgkmcnt(10)
    v_mfma_f32_16x16x32_bf16 v[112:115], v[240:243], v[56:59], v[112:115]
    ds_read_b64_tr_b16 v[52:53], v4 offset:4096
    v_mfma_f32_16x16x32_bf16 v[116:119], v[244:247], v[56:59], v[116:119]
    ds_read_b64_tr_b16 v[54:55], v4 offset:5120
    v_mfma_f32_16x16x32_bf16 v[120:123], v[240:243], v[60:63], v[120:123]
    ds_read_b64_tr_b16 v[56:57], v5 offset:4096
    v_mfma_f32_16x16x32_bf16 v[124:127], v[244:247], v[60:63], v[124:127]
    ds_read_b64_tr_b16 v[58:59], v5 offset:5120
    s_waitcnt lgkmcnt(10)
    v_mfma_f32_16x16x32_bf16 v[128:131], v[32:35], v[240:243], v[128:131]
    ds_read_b64_tr_b16 v[60:61], v6 offset:4096
    v_mfma_f32_16x16x32_bf16 v[132:135], v[32:35], v[244:247], v[132:135]
    ds_read_b64_tr_b16 v[62:63], v6 offset:5120
    v_mfma_f32_16x16x32_bf16 v[136:139], v[36:39], v[240:243], v[136:139]
    ds_read_b64_tr_b16 v[32:33], v3 offset:8192
    v_mfma_f32_16x16x32_bf16 v[140:143], v[36:39], v[244:247], v[140:143]
    ds_read_b64_tr_b16 v[34:35], v3 offset:9216
    s_waitcnt lgkmcnt(10)
    v_mfma_f32_16x16x32_bf16 v[144:147], v[40:43], v[240:243], v[144:147]
    ds_read_b64_tr_b16 v[36:37], v4 offset:8192
    v_mfma_f32_16x16x32_bf16 v[148:151], v[40:43], v[244:247], v[148:151]
    ds_read_b64_tr_b16 v[38:39], v4 offset:9216
    v_mfma_f32_16x16x32_bf16 v[152:155], v[44:47], v[240:243], v[152:155]
    ds_read_b64_tr_b16 v[40:41], v5 offset:8192
    v_mfma_f32_16x16x32_bf16 v[156:159], v[44:47], v[244:247], v[156:159]
    ds_read_b64_tr_b16 v[42:43], v5 offset:9216
    s_waitcnt vmcnt(14) lgkmcnt(10)
    v_mfma_f32_16x16x32_bf16 v[64:67], v[48:51], v[248:251], v[64:67]
    ds_read_b64_tr_b16 v[44:45], v6 offset:8192
    v_mfma_f32_16x16x32_bf16 v[68:71], v[48:51], v[252:255], v[68:71]
    ds_read_b64_tr_b16 v[46:47], v6 offset:9216
    v_mfma_f32_16x16x32_bf16 v[72:75], v[52:55], v[248:251], v[72:75]
    ds_read_b64_tr_b16 v[48:49], v3 offset:12288
    v_mfma_f32_16x16x32_bf16 v[76:79], v[52:55], v[252:255], v[76:79]
    ds_read_b64_tr_b16 v[50:51], v3 offset:13312
    s_waitcnt lgkmcnt(10)
    v_mfma_f32_16x16x32_bf16 v[80:83], v[56:59], v[248:251], v[80:83]
    ds_read_b64_tr_b16 v[52:53], v4 offset:12288
    v_mfma_f32_16x16x32_bf16 v[84:87], v[56:59], v[252:255], v[84:87]
    ds_read_b64_tr_b16 v[54:55], v4 offset:13312
    v_mfma_f32_16x16x32_bf16 v[88:91], v[60:63], v[248:251], v[88:91]
    ds_read_b64_tr_b16 v[56:57], v5 offset:12288
    v_mfma_f32_16x16x32_bf16 v[92:95], v[60:63], v[252:255], v[92:95]
    ds_read_b64_tr_b16 v[58:59], v5 offset:13312
    s_waitcnt lgkmcnt(10)
    v_mfma_f32_16x16x32_bf16 v[96:99], v[248:251], v[32:35], v[96:99]
    ds_read_b64_tr_b16 v[60:61], v6 offset:12288
    v_mfma_f32_16x16x32_bf16 v[100:103], v[252:255], v[32:35], v[100:103]
    ds_read_b64_tr_b16 v[62:63], v6 offset:13312
    v_mfma_f32_16x16x32_bf16 v[104:107], v[248:251], v[36:39], v[104:107]
    ds_read_b64_tr_b16 v[32:33], v3 offset:16384
    v_mfma_f32_16x16x32_bf16 v[108:111], v[252:255], v[36:39], v[108:111]
    ds_read_b64_tr_b16 v[34:35], v3 offset:17408
    s_waitcnt lgkmcnt(10)
    v_mfma_f32_16x16x32_bf16 v[112:115], v[248:251], v[40:43], v[112:115]
    ds_read_b64_tr_b16 v[36:37], v4 offset:16384
    v_mfma_f32_16x16x32_bf16 v[116:119], v[252:255], v[40:43], v[116:119]
    ds_read_b64_tr_b16 v[38:39], v4 offset:17408
    v_mfma_f32_16x16x32_bf16 v[120:123], v[248:251], v[44:47], v[120:123]
    ds_read_b64_tr_b16 v[40:41], v5 offset:16384
    v_mfma_f32_16x16x32_bf16 v[124:127], v[252:255], v[44:47], v[124:127]
    ds_read_b64_tr_b16 v[42:43], v5 offset:17408
    s_waitcnt lgkmcnt(10)
    v_mfma_f32_16x16x32_bf16 v[128:131], v[48:51], v[248:251], v[128:131]
    buffer_load_dwordx4 v[216:219], v2, s[4:7], s42 offen offset:2048 sc1
    ds_read_b64_tr_b16 v[44:45], v6 offset:16384
    v_mfma_f32_16x16x32_bf16 v[132:135], v[48:51], v[252:255], v[132:135]
    ds_read_b64_tr_b16 v[46:47], v6 offset:17408
    v_mfma_f32_16x16x32_bf16 v[136:139], v[52:55], v[248:251], v[136:139]
    buffer_load_dwordx4 v[220:223], v2, s[4:7], s42 offen offset:2304 sc1
    ds_read_b64_tr_b16 v[48:49], v3 offset:20480
    s_add_u32 s42, s41, s94
    v_mfma_f32_16x16x32_bf16 v[140:143], v[52:55], v[252:255], v[140:143]
    ds_read_b64_tr_b16 v[50:51], v3 offset:21504
    s_waitcnt lgkmcnt(10)
    v_mfma_f32_16x16x32_bf16 v[144:147], v[56:59], v[248:251], v[144:147]
    buffer_load_dwordx4 v[224:227], v2, s[4:7], s42 offen offset:0 sc1
    ds_read_b64_tr_b16 v[52:53], v4 offset:20480
    v_mfma_f32_16x16x32_bf16 v[148:151], v[56:59], v[252:255], v[148:151]
    ds_read_b64_tr_b16 v[54:55], v4 offset:21504
    v_mfma_f32_16x16x32_bf16 v[152:155], v[60:63], v[248:251], v[152:155]
    buffer_load_dwordx4 v[228:231], v2, s[4:7], s42 offen offset:256 sc1
    ds_read_b64_tr_b16 v[56:57], v5 offset:20480
    v_mfma_f32_16x16x32_bf16 v[156:159], v[60:63], v[252:255], v[156:159]
    ds_read_b64_tr_b16 v[58:59], v5 offset:21504
    s_waitcnt vmcnt(16) lgkmcnt(10)
    v_mfma_f32_16x16x32_bf16 v[64:67], v[32:35], v[160:163], v[64:67]
    ds_read_b64_tr_b16 v[60:61], v6 offset:20480
    buffer_load_dwordx4 v[232:235], v2, s[4:7], s42 offen offset:2048 sc1
    v_mfma_f32_16x16x32_bf16 v[68:71], v[32:35], v[164:167], v[68:71]
    ds_read_b64_tr_b16 v[62:63], v6 offset:21504
    v_mfma_f32_16x16x32_bf16 v[72:75], v[36:39], v[160:163], v[72:75]
    buffer_load_dwordx4 v[236:239], v2, s[4:7], s42 offen offset:2304 sc1
    ds_read_b64_tr_b16 v[32:33], v3 offset:24576
    s_add_u32 s42, s41, s95
    v_mfma_f32_16x16x32_bf16 v[76:79], v[36:39], v[164:167], v[76:79]
    ds_read_b64_tr_b16 v[34:35], v3 offset:25600
    s_waitcnt lgkmcnt(10)
    v_mfma_f32_16x16x32_bf16 v[80:83], v[40:43], v[160:163], v[80:83]
    ds_read_b64_tr_b16 v[36:37], v4 offset:24576
    v_mfma_f32_16x16x32_bf16 v[84:87], v[40:43], v[164:167], v[84:87]
    ds_read_b64_tr_b16 v[38:39], v4 offset:25600
    v_mfma_f32_16x16x32_bf16 v[88:91], v[44:47], v[160:163], v[88:91]
    ds_read_b64_tr_b16 v[40:41], v5 offset:24576
    v_mfma_f32_16x16x32_bf16 v[92:95], v[44:47], v[164:167], v[92:95]
    ds_read_b64_tr_b16 v[42:43], v5 offset:25600
    s_waitcnt lgkmcnt(10)
    v_mfma_f32_16x16x32_bf16 v[96:99], v[160:163], v[48:51], v[96:99]
    buffer_load_dwordx4 v[240:243], v2, s[4:7], s42 offen offset:0 sc1
    ds_read_b64_tr_b16 v[44:45], v6 offset:24576
    v_mfma_f32_16x16x32_bf16 v[100:103], v[164:167], v[48:51], v[100:103]
    ds_read_b64_tr_b16 v[46:47], v6 offset:25600
    v_mfma_f32_16x16x32_bf16 v[104:107], v[160:163], v[52:55], v[104:107]
    ds_read_b64_tr_b16 v[48:49], v3 offset:28672
    v_mfma_f32_16x16x32_bf16 v[108:111], v[164:167], v[52:55], v[108:111]
    ds_read_b64_tr_b16 v[50:51], v3 offset:29696
    s_waitcnt lgkmcnt(10)
    v_mfma_f32_16x16x32_bf16 v[112:115], v[160:163], v[56:59], v[112:115]
    ds_read_b64_tr_b16 v[52:53], v4 offset:28672
    v_mfma_f32_16x16x32_bf16 v[116:119], v[164:167], v[56:59], v[116:119]
    ds_read_b64_tr_b16 v[54:55], v4 offset:29696
    v_mfma_f32_16x16x32_bf16 v[120:123], v[160:163], v[60:63], v[120:123]
    ds_read_b64_tr_b16 v[56:57], v5 offset:28672
    v_mfma_f32_16x16x32_bf16 v[124:127], v[164:167], v[60:63], v[124:127]
    ds_read_b64_tr_b16 v[58:59], v5 offset:29696
    s_waitcnt lgkmcnt(10)
    v_mfma_f32_16x16x32_bf16 v[128:131], v[32:35], v[160:163], v[128:131]
    ds_read_b64_tr_b16 v[60:61], v6 offset:28672
    v_mfma_f32_16x16x32_bf16 v[132:135], v[32:35], v[164:167], v[132:135]
    ds_read_b64_tr_b16 v[62:63], v6 offset:29696
    s_barrier
    v_mfma_f32_16x16x32_bf16 v[136:139], v[36:39], v[160:163], v[136:139]
    ds_read_b64_tr_b16 v[32:33], v3 offset:32768
    v_mfma_f32_16x16x32_bf16 v[140:143], v[36:39], v[164:167], v[140:143]
    ds_read_b64_tr_b16 v[34:35], v3 offset:33792
    s_waitcnt lgkmcnt(10)
    v_mfma_f32_16x16x32_bf16 v[144:147], v[40:43], v[160:163], v[144:147]
    ds_read_b64_tr_b16 v[36:37], v4 offset:32768
    v_mfma_f32_16x16x32_bf16 v[148:151], v[40:43], v[164:167], v[148:151]
    ds_read_b64_tr_b16 v[38:39], v4 offset:33792
    v_mfma_f32_16x16x32_bf16 v[152:155], v[44:47], v[160:163], v[152:155]
    ds_read_b64_tr_b16 v[40:41], v5 offset:32768
    v_mfma_f32_16x16x32_bf16 v[156:159], v[44:47], v[164:167], v[156:159]
    ds_read_b64_tr_b16 v[42:43], v5 offset:33792
    s_waitcnt vmcnt(17) lgkmcnt(10)
    v_mfma_f32_16x16x32_bf16 v[64:67], v[48:51], v[168:171], v[64:67]
    ds_read_b64_tr_b16 v[44:45], v6 offset:32768
    v_mfma_f32_16x16x32_bf16 v[68:71], v[48:51], v[172:175], v[68:71]
    ds_read_b64_tr_b16 v[46:47], v6 offset:33792
    v_mfma_f32_16x16x32_bf16 v[72:75], v[52:55], v[168:171], v[72:75]
    ds_read_b64_tr_b16 v[48:49], v3 offset:36864
    v_mfma_f32_16x16x32_bf16 v[76:79], v[52:55], v[172:175], v[76:79]
    ds_read_b64_tr_b16 v[50:51], v3 offset:37888
    s_waitcnt lgkmcnt(10)
    v_mfma_f32_16x16x32_bf16 v[80:83], v[56:59], v[168:171], v[80:83]
    ds_read_b64_tr_b16 v[52:53], v4 offset:36864
    v_mfma_f32_16x16x32_bf16 v[84:87], v[56:59], v[172:175], v[84:87]
    ds_read_b64_tr_b16 v[54:55], v4 offset:37888
    v_mfma_f32_16x16x32_bf16 v[88:91], v[60:63], v[168:171], v[88:91]
    ds_read_b64_tr_b16 v[56:57], v5 offset:36864
    v_mfma_f32_16x16x32_bf16 v[92:95], v[60:63], v[172:175], v[92:95]
    ds_read_b64_tr_b16 v[58:59], v5 offset:37888
    s_waitcnt lgkmcnt(10)
    v_mfma_f32_16x16x32_bf16 v[96:99], v[168:171], v[32:35], v[96:99]
    ds_read_b64_tr_b16 v[60:61], v6 offset:36864
    v_mfma_f32_16x16x32_bf16 v[100:103], v[172:175], v[32:35], v[100:103]
    ds_read_b64_tr_b16 v[62:63], v6 offset:37888
    v_mfma_f32_16x16x32_bf16 v[104:107], v[168:171], v[36:39], v[104:107]
    ds_read_b64_tr_b16 v[32:33], v3 offset:40960
    v_mfma_f32_16x16x32_bf16 v[108:111], v[172:175], v[36:39], v[108:111]
    ds_read_b64_tr_b16 v[34:35], v3 offset:41984
    s_waitcnt lgkmcnt(10)
    v_mfma_f32_16x16x32_bf16 v[112:115], v[168:171], v[40:43], v[112:115]
    ds_read_b64_tr_b16 v[36:37], v4 offset:40960
    v_mfma_f32_16x16x32_bf16 v[116:119], v[172:175], v[40:43], v[116:119]
    ds_read_b64_tr_b16 v[38:39], v4 offset:41984
    v_mfma_f32_16x16x32_bf16 v[120:123], v[168:171], v[44:47], v[120:123]
    ds_read_b64_tr_b16 v[40:41], v5 offset:40960
    v_mfma_f32_16x16x32_bf16 v[124:127], v[172:175], v[44:47], v[124:127]
    ds_read_b64_tr_b16 v[42:43], v5 offset:41984
    s_waitcnt lgkmcnt(10)
    v_mfma_f32_16x16x32_bf16 v[128:131], v[48:51], v[168:171], v[128:131]
    ds_read_b64_tr_b16 v[44:45], v6 offset:40960
    v_mfma_f32_16x16x32_bf16 v[132:135], v[48:51], v[172:175], v[132:135]
    ds_read_b64_tr_b16 v[46:47], v6 offset:41984
    v_mfma_f32_16x16x32_bf16 v[136:139], v[52:55], v[168:171], v[136:139]
    ds_read_b64_tr_b16 v[48:49], v3 offset:45056
    v_mfma_f32_16x16x32_bf16 v[140:143], v[52:55], v[172:175], v[140:143]
    ds_read_b64_tr_b16 v[50:51], v3 offset:46080
    s_waitcnt lgkmcnt(10)
    v_mfma_f32_16x16x32_bf16 v[144:147], v[56:59], v[168:171], v[144:147]
    ds_read_b64_tr_b16 v[52:53], v4 offset:45056
    v_mfma_f32_16x16x32_bf16 v[148:151], v[56:59], v[172:175], v[148:151]
    ds_read_b64_tr_b16 v[54:55], v4 offset:46080
    v_mfma_f32_16x16x32_bf16 v[152:155], v[60:63], v[168:171], v[152:155]
    ds_read_b64_tr_b16 v[56:57], v5 offset:45056
    v_mfma_f32_16x16x32_bf16 v[156:159], v[60:63], v[172:175], v[156:159]
    ds_read_b64_tr_b16 v[58:59], v5 offset:46080
    s_waitcnt vmcnt(15) lgkmcnt(10)
    v_mfma_f32_16x16x32_bf16 v[64:67], v[32:35], v[176:179], v[64:67]
    ds_read_b64_tr_b16 v[60:61], v6 offset:45056
    v_mfma_f32_16x16x32_bf16 v[68:71], v[32:35], v[180:183], v[68:71]
    ds_read_b64_tr_b16 v[62:63], v6 offset:46080
    v_mfma_f32_16x16x32_bf16 v[72:75], v[36:39], v[176:179], v[72:75]
    ds_read_b64_tr_b16 v[32:33], v3 offset:49152
    v_mfma_f32_16x16x32_bf16 v[76:79], v[36:39], v[180:183], v[76:79]
    ds_read_b64_tr_b16 v[34:35], v3 offset:50176
    s_waitcnt lgkmcnt(10)
    v_mfma_f32_16x16x32_bf16 v[80:83], v[40:43], v[176:179], v[80:83]
    ds_read_b64_tr_b16 v[36:37], v4 offset:49152
    v_mfma_f32_16x16x32_bf16 v[84:87], v[40:43], v[180:183], v[84:87]
    ds_read_b64_tr_b16 v[38:39], v4 offset:50176
    v_mfma_f32_16x16x32_bf16 v[88:91], v[44:47], v[176:179], v[88:91]
    ds_read_b64_tr_b16 v[40:41], v5 offset:49152
    v_mfma_f32_16x16x32_bf16 v[92:95], v[44:47], v[180:183], v[92:95]
    ds_read_b64_tr_b16 v[42:43], v5 offset:50176
    s_waitcnt lgkmcnt(10)
    v_mfma_f32_16x16x32_bf16 v[96:99], v[176:179], v[48:51], v[96:99]
    buffer_load_dwordx4 v[244:247], v2, s[4:7], s42 offen offset:256 sc1
    ds_read_b64_tr_b16 v[44:45], v6 offset:49152
    v_mfma_f32_16x16x32_bf16 v[100:103], v[180:183], v[48:51], v[100:103]
    ds_read_b64_tr_b16 v[46:47], v6 offset:50176
    v_mfma_f32_16x16x32_bf16 v[104:107], v[176:179], v[52:55], v[104:107]
    buffer_load_dwordx4 v[248:251], v2, s[4:7], s42 offen offset:2048 sc1
    ds_read_b64_tr_b16 v[48:49], v3 offset:53248
    v_mfma_f32_16x16x32_bf16 v[108:111], v[180:183], v[52:55], v[108:111]
    ds_read_b64_tr_b16 v[50:51], v3 offset:54272
    s_waitcnt lgkmcnt(10)
    v_mfma_f32_16x16x32_bf16 v[112:115], v[176:179], v[56:59], v[112:115]
    buffer_load_dwordx4 v[252:255], v2, s[4:7], s42 offen offset:2304 sc1
    ds_read_b64_tr_b16 v[52:53], v4 offset:53248
    s_add_u32 s42, s41, s96
    v_mfma_f32_16x16x32_bf16 v[116:119], v[180:183], v[56:59], v[116:119]
    ds_read_b64_tr_b16 v[54:55], v4 offset:54272
    v_mfma_f32_16x16x32_bf16 v[120:123], v[176:179], v[60:63], v[120:123]
    buffer_load_dwordx4 v[160:163], v2, s[4:7], s42 offen offset:0 sc1
    ds_read_b64_tr_b16 v[56:57], v5 offset:53248
    v_mfma_f32_16x16x32_bf16 v[124:127], v[180:183], v[60:63], v[124:127]
    ds_read_b64_tr_b16 v[58:59], v5 offset:54272
    s_waitcnt lgkmcnt(10)
    v_mfma_f32_16x16x32_bf16 v[128:131], v[32:35], v[176:179], v[128:131]
    ds_read_b64_tr_b16 v[60:61], v6 offset:53248
    buffer_load_dwordx4 v[164:167], v2, s[4:7], s42 offen offset:256 sc1
    v_mfma_f32_16x16x32_bf16 v[132:135], v[32:35], v[180:183], v[132:135]
    ds_read_b64_tr_b16 v[62:63], v6 offset:54272
    v_mfma_f32_16x16x32_bf16 v[136:139], v[36:39], v[176:179], v[136:139]
    buffer_load_dwordx4 v[168:171], v2, s[4:7], s42 offen offset:2048 sc1
    ds_read_b64_tr_b16 v[32:33], v3 offset:57344
    v_mfma_f32_16x16x32_bf16 v[140:143], v[36:39], v[180:183], v[140:143]
    ds_read_b64_tr_b16 v[34:35], v3 offset:58368
    s_waitcnt lgkmcnt(10)
    v_mfma_f32_16x16x32_bf16 v[144:147], v[40:43], v[176:179], v[144:147]
    ds_read_b64_tr_b16 v[36:37], v4 offset:57344
    v_mfma_f32_16x16x32_bf16 v[148:151], v[40:43], v[180:183], v[148:151]
    ds_read_b64_tr_b16 v[38:39], v4 offset:58368
    v_mfma_f32_16x16x32_bf16 v[152:155], v[44:47], v[176:179], v[152:155]
    ds_read_b64_tr_b16 v[40:41], v5 offset:57344
    v_mfma_f32_16x16x32_bf16 v[156:159], v[44:47], v[180:183], v[156:159]
    ds_read_b64_tr_b16 v[42:43], v5 offset:58368
    s_waitcnt vmcnt(19) lgkmcnt(10)
    v_mfma_f32_16x16x32_bf16 v[64:67], v[48:51], v[184:187], v[64:67]
    ds_read_b64_tr_b16 v[44:45], v6 offset:57344
    v_mfma_f32_16x16x32_bf16 v[68:71], v[48:51], v[188:191], v[68:71]
    ds_read_b64_tr_b16 v[46:47], v6 offset:58368
    v_mfma_f32_16x16x32_bf16 v[72:75], v[52:55], v[184:187], v[72:75]
    ds_read_b64_tr_b16 v[48:49], v3 offset:61440
    v_mfma_f32_16x16x32_bf16 v[76:79], v[52:55], v[188:191], v[76:79]
    ds_read_b64_tr_b16 v[50:51], v3 offset:62464
    s_waitcnt lgkmcnt(10)
    v_mfma_f32_16x16x32_bf16 v[80:83], v[56:59], v[184:187], v[80:83]
    buffer_load_dwordx4 v[172:175], v2, s[4:7], s42 offen offset:2304 sc1
    ds_read_b64_tr_b16 v[52:53], v4 offset:61440
    s_add_u32 s42, s41, s97
    v_mfma_f32_16x16x32_bf16 v[84:87], v[56:59], v[188:191], v[84:87]
    ds_read_b64_tr_b16 v[54:55], v4 offset:62464
    v_mfma_f32_16x16x32_bf16 v[88:91], v[60:63], v[184:187], v[88:91]
    ds_read_b64_tr_b16 v[56:57], v5 offset:61440
    v_mfma_f32_16x16x32_bf16 v[92:95], v[60:63], v[188:191], v[92:95]
    ds_read_b64_tr_b16 v[58:59], v5 offset:62464
    s_waitcnt lgkmcnt(10)
    v_mfma_f32_16x16x32_bf16 v[96:99], v[184:187], v[32:35], v[96:99]
    ds_read_b64_tr_b16 v[60:61], v6 offset:61440
    v_mfma_f32_16x16x32_bf16 v[100:103], v[188:191], v[32:35], v[100:103]
    ds_read_b64_tr_b16 v[62:63], v6 offset:62464
    s_barrier
    v_xor_b32 v3, 0x10000, v3
    v_xor_b32 v4, 0x10000, v4
    v_xor_b32 v5, 0x10000, v5
    v_xor_b32 v6, 0x10000, v6
    v_mfma_f32_16x16x32_bf16 v[104:107], v[184:187], v[36:39], v[104:107]
    ds_read_b64_tr_b16 v[32:33], v3 offset:0
    v_mfma_f32_16x16x32_bf16 v[108:111], v[188:191], v[36:39], v[108:111]
    ds_read_b64_tr_b16 v[34:35], v3 offset:1024
    s_waitcnt lgkmcnt(10)
    v_mfma_f32_16x16x32_bf16 v[112:115], v[184:187], v[40:43], v[112:115]
    ds_read_b64_tr_b16 v[36:37], v4 offset:0
    v_mfma_f32_16x16x32_bf16 v[116:119], v[188:191], v[40:43], v[116:119]
    ds_read_b64_tr_b16 v[38:39], v4 offset:1024
    v_mfma_f32_16x16x32_bf16 v[120:123], v[184:187], v[44:47], v[120:123]
    ds_read_b64_tr_b16 v[40:41], v5 offset:0
    v_mfma_f32_16x16x32_bf16 v[124:127], v[188:191], v[44:47], v[124:127]
    ds_read_b64_tr_b16 v[42:43], v5 offset:1024
    s_waitcnt lgkmcnt(10)
    v_mfma_f32_16x16x32_bf16 v[128:131], v[48:51], v[184:187], v[128:131]
    ds_read_b64_tr_b16 v[44:45], v6 offset:0
    v_mfma_f32_16x16x32_bf16 v[132:135], v[48:51], v[188:191], v[132:135]
    ds_read_b64_tr_b16 v[46:47], v6 offset:1024
    v_mfma_f32_16x16x32_bf16 v[136:139], v[52:55], v[184:187], v[136:139]
    ds_read_b64_tr_b16 v[48:49], v3 offset:4096
    v_mfma_f32_16x16x32_bf16 v[140:143], v[52:55], v[188:191], v[140:143]
    ds_read_b64_tr_b16 v[50:51], v3 offset:5120
    s_waitcnt lgkmcnt(10)
    v_mfma_f32_16x16x32_bf16 v[144:147], v[56:59], v[184:187], v[144:147]
    ds_read_b64_tr_b16 v[52:53], v4 offset:4096
    v_mfma_f32_16x16x32_bf16 v[148:151], v[56:59], v[188:191], v[148:151]
    ds_read_b64_tr_b16 v[54:55], v4 offset:5120
    v_mfma_f32_16x16x32_bf16 v[152:155], v[60:63], v[184:187], v[152:155]
    ds_read_b64_tr_b16 v[56:57], v5 offset:4096
    v_mfma_f32_16x16x32_bf16 v[156:159], v[60:63], v[188:191], v[156:159]
    ds_read_b64_tr_b16 v[58:59], v5 offset:5120
    s_waitcnt vmcnt(18) lgkmcnt(10)
    v_mfma_f32_16x16x32_bf16 v[64:67], v[32:35], v[192:195], v[64:67]
    ds_read_b64_tr_b16 v[60:61], v6 offset:4096
    v_mfma_f32_16x16x32_bf16 v[68:71], v[32:35], v[196:199], v[68:71]
    ds_read_b64_tr_b16 v[62:63], v6 offset:5120
    v_mfma_f32_16x16x32_bf16 v[72:75], v[36:39], v[192:195], v[72:75]
    ds_read_b64_tr_b16 v[32:33], v3 offset:8192
    v_mfma_f32_16x16x32_bf16 v[76:79], v[36:39], v[196:199], v[76:79]
    ds_read_b64_tr_b16 v[34:35], v3 offset:9216
    s_waitcnt lgkmcnt(10)
    v_mfma_f32_16x16x32_bf16 v[80:83], v[40:43], v[192:195], v[80:83]
    ds_read_b64_tr_b16 v[36:37], v4 offset:8192
    v_mfma_f32_16x16x32_bf16 v[84:87], v[40:43], v[196:199], v[84:87]
    ds_read_b64_tr_b16 v[38:39], v4 offset:9216
    v_mfma_f32_16x16x32_bf16 v[88:91], v[44:47], v[192:195], v[88:91]
    ds_read_b64_tr_b16 v[40:41], v5 offset:8192
    v_mfma_f32_16x16x32_bf16 v[92:95], v[44:47], v[196:199], v[92:95]
    ds_read_b64_tr_b16 v[42:43], v5 offset:9216
    s_waitcnt lgkmcnt(10)
    v_mfma_f32_16x16x32_bf16 v[96:99], v[192:195], v[48:51], v[96:99]
    ds_read_b64_tr_b16 v[44:45], v6 offset:8192
    v_mfma_f32_16x16x32_bf16 v[100:103], v[196:199], v[48:51], v[100:103]
    ds_read_b64_tr_b16 v[46:47], v6 offset:9216
    v_mfma_f32_16x16x32_bf16 v[104:107], v[192:195], v[52:55], v[104:107]
    ds_read_b64_tr_b16 v[48:49], v3 offset:12288
    v_mfma_f32_16x16x32_bf16 v[108:111], v[196:199], v[52:55], v[108:111]
    ds_read_b64_tr_b16 v[50:51], v3 offset:13312
    s_waitcnt lgkmcnt(10)
    v_mfma_f32_16x16x32_bf16 v[112:115], v[192:195], v[56:59], v[112:115]
    ds_read_b64_tr_b16 v[52:53], v4 offset:12288
    v_mfma_f32_16x16x32_bf16 v[116:119], v[196:199], v[56:59], v[116:119]
    ds_read_b64_tr_b16 v[54:55], v4 offset:13312
    v_mfma_f32_16x16x32_bf16 v[120:123], v[192:195], v[60:63], v[120:123]
    ds_read_b64_tr_b16 v[56:57], v5 offset:12288
    v_mfma_f32_16x16x32_bf16 v[124:127], v[196:199], v[60:63], v[124:127]
    ds_read_b64_tr_b16 v[58:59], v5 offset:13312
    s_waitcnt lgkmcnt(10)
    v_mfma_f32_16x16x32_bf16 v[128:131], v[32:35], v[192:195], v[128:131]
    ds_read_b64_tr_b16 v[60:61], v6 offset:12288
    v_mfma_f32_16x16x32_bf16 v[132:135], v[32:35], v[196:199], v[132:135]
    ds_read_b64_tr_b16 v[62:63], v6 offset:13312
    v_mfma_f32_16x16x32_bf16 v[136:139], v[36:39], v[192:195], v[136:139]
    ds_read_b64_tr_b16 v[32:33], v3 offset:16384
    v_mfma_f32_16x16x32_bf16 v[140:143], v[36:39], v[196:199], v[140:143]
    ds_read_b64_tr_b16 v[34:35], v3 offset:17408
    s_waitcnt lgkmcnt(10)
    v_mfma_f32_16x16x32_bf16 v[144:147], v[40:43], v[192:195], v[144:147]
    ds_read_b64_tr_b16 v[36:37], v4 offset:16384
    v_mfma_f32_16x16x32_bf16 v[148:151], v[40:43], v[196:199], v[148:151]
    ds_read_b64_tr_b16 v[38:39], v4 offset:17408
    v_mfma_f32_16x16x32_bf16 v[152:155], v[44:47], v[192:195], v[152:155]
    ds_read_b64_tr_b16 v[40:41], v5 offset:16384
    v_mfma_f32_16x16x32_bf16 v[156:159], v[44:47], v[196:199], v[156:159]
    ds_read_b64_tr_b16 v[42:43], v5 offset:17408
    s_waitcnt vmcnt(16) lgkmcnt(10)
    v_mfma_f32_16x16x32_bf16 v[64:67], v[48:51], v[200:203], v[64:67]
    buffer_load_dwordx4 v[176:179], v2, s[4:7], s42 offen offset:0 sc1
    ds_read_b64_tr_b16 v[44:45], v6 offset:16384
    v_mfma_f32_16x16x32_bf16 v[68:71], v[48:51], v[204:207], v[68:71]
    ds_read_b64_tr_b16 v[46:47], v6 offset:17408
    v_mfma_f32_16x16x32_bf16 v[72:75], v[52:55], v[200:203], v[72:75]
    buffer_load_dwordx4 v[180:183], v2, s[4:7], s42 offen offset:256 sc1
    ds_read_b64_tr_b16 v[48:49], v3 offset:20480
    v_mfma_f32_16x16x32_bf16 v[76:79], v[52:55], v[204:207], v[76:79]
    ds_read_b64_tr_b16 v[50:51], v3 offset:21504
    s_waitcnt lgkmcnt(10)
    v_mfma_f32_16x16x32_bf16 v[80:83], v[56:59], v[200:203], v[80:83]
    buffer_load_dwordx4 v[184:187], v2, s[4:7], s42 offen offset:2048 sc1
    ds_read_b64_tr_b16 v[52:53], v4 offset:20480
    v_mfma_f32_16x16x32_bf16 v[84:87], v[56:59], v[204:207], v[84:87]
    ds_read_b64_tr_b16 v[54:55], v4 offset:21504
    v_mfma_f32_16x16x32_bf16 v[88:91], v[60:63], v[200:203], v[88:91]
    buffer_load_dwordx4 v[188:191], v2, s[4:7], s42 offen offset:2304 sc1
    ds_read_b64_tr_b16 v[56:57], v5 offset:20480
    s_add_u32 s42, s41, s98
    v_mfma_f32_16x16x32_bf16 v[92:95], v[60:63], v[204:207], v[92:95]
    ds_read_b64_tr_b16 v[58:59], v5 offset:21504
    s_waitcnt lgkmcnt(10)
    v_mfma_f32_16x16x32_bf16 v[96:99], v[200:203], v[32:35], v[96:99]
    ds_read_b64_tr_b16 v[60:61], v6 offset:20480
    buffer_load_dwordx4 v[192:195], v2, s[4:7], s42 offen offset:0 sc1
    v_mfma_f32_16x16x32_bf16 v[100:103], v[204:207], v[32:35], v[100:103]
    ds_read_b64_tr_b16 v[62:63], v6 offset:21504
    v_mfma_f32_16x16x32_bf16 v[104:107], v[200:203], v[36:39], v[104:107]
    ds_read_b64_tr_b16 v[32:33], v3 offset:24576
    v_mfma_f32_16x16x32_bf16 v[108:111], v[204:207], v[36:39], v[108:111]
    ds_read_b64_tr_b16 v[34:35], v3 offset:25600
    s_waitcnt lgkmcnt(10)
    v_mfma_f32_16x16x32_bf16 v[112:115], v[200:203], v[40:43], v[112:115]
    ds_read_b64_tr_b16 v[36:37], v4 offset:24576
    v_mfma_f32_16x16x32_bf16 v[116:119], v[204:207], v[40:43], v[116:119]
    ds_read_b64_tr_b16 v[38:39], v4 offset:25600
    v_mfma_f32_16x16x32_bf16 v[120:123], v[200:203], v[44:47], v[120:123]
    buffer_load_dwordx4 v[196:199], v2, s[4:7], s42 offen offset:256 sc1
    ds_read_b64_tr_b16 v[40:41], v5 offset:24576
    v_mfma_f32_16x16x32_bf16 v[124:127], v[204:207], v[44:47], v[124:127]
    ds_read_b64_tr_b16 v[42:43], v5 offset:25600
    s_waitcnt lgkmcnt(10)
    v_mfma_f32_16x16x32_bf16 v[128:131], v[48:51], v[200:203], v[128:131]
    ds_read_b64_tr_b16 v[44:45], v6 offset:24576
    v_mfma_f32_16x16x32_bf16 v[132:135], v[48:51], v[204:207], v[132:135]
    ds_read_b64_tr_b16 v[46:47], v6 offset:25600
    v_mfma_f32_16x16x32_bf16 v[136:139], v[52:55], v[200:203], v[136:139]
    ds_read_b64_tr_b16 v[48:49], v3 offset:28672
    v_mfma_f32_16x16x32_bf16 v[140:143], v[52:55], v[204:207], v[140:143]
    ds_read_b64_tr_b16 v[50:51], v3 offset:29696
    s_waitcnt lgkmcnt(10)
    v_mfma_f32_16x16x32_bf16 v[144:147], v[56:59], v[200:203], v[144:147]
    ds_read_b64_tr_b16 v[52:53], v4 offset:28672
    v_mfma_f32_16x16x32_bf16 v[148:151], v[56:59], v[204:207], v[148:151]
    ds_read_b64_tr_b16 v[54:55], v4 offset:29696
    v_mfma_f32_16x16x32_bf16 v[152:155], v[60:63], v[200:203], v[152:155]
    ds_read_b64_tr_b16 v[56:57], v5 offset:28672
    v_mfma_f32_16x16x32_bf16 v[156:159], v[60:63], v[204:207], v[156:159]
    ds_read_b64_tr_b16 v[58:59], v5 offset:29696
    s_waitcnt vmcnt(20) lgkmcnt(10)
    v_mfma_f32_16x16x32_bf16 v[64:67], v[32:35], v[208:211], v[64:67]
    ds_read_b64_tr_b16 v[60:61], v6 offset:28672
    v_mfma_f32_16x16x32_bf16 v[68:71], v[32:35], v[212:215], v[68:71]
    ds_read_b64_tr_b16 v[62:63], v6 offset:29696
    s_barrier
    v_mfma_f32_16x16x32_bf16 v[72:75], v[36:39], v[208:211], v[72:75]
    ds_read_b64_tr_b16 v[32:33], v3 offset:32768
    v_mfma_f32_16x16x32_bf16 v[76:79], v[36:39], v[212:215], v[76:79]
    ds_read_b64_tr_b16 v[34:35], v3 offset:33792
    s_waitcnt lgkmcnt(10)
    v_mfma_f32_16x16x32_bf16 v[80:83], v[40:43], v[208:211], v[80:83]
    ds_read_b64_tr_b16 v[36:37], v4 offset:32768
    v_mfma_f32_16x16x32_bf16 v[84:87], v[40:43], v[212:215], v[84:87]
    ds_read_b64_tr_b16 v[38:39], v4 offset:33792
    v_mfma_f32_16x16x32_bf16 v[88:91], v[44:47], v[208:211], v[88:91]
    ds_read_b64_tr_b16 v[40:41], v5 offset:32768
    v_mfma_f32_16x16x32_bf16 v[92:95], v[44:47], v[212:215], v[92:95]
    ds_read_b64_tr_b16 v[42:43], v5 offset:33792
    s_waitcnt lgkmcnt(10)
    v_mfma_f32_16x16x32_bf16 v[96:99], v[208:211], v[48:51], v[96:99]
    ds_read_b64_tr_b16 v[44:45], v6 offset:32768
    v_mfma_f32_16x16x32_bf16 v[100:103], v[212:215], v[48:51], v[100:103]
    ds_read_b64_tr_b16 v[46:47], v6 offset:33792
    v_mfma_f32_16x16x32_bf16 v[104:107], v[208:211], v[52:55], v[104:107]
    ds_read_b64_tr_b16 v[48:49], v3 offset:36864
    v_mfma_f32_16x16x32_bf16 v[108:111], v[212:215], v[52:55], v[108:111]
    ds_read_b64_tr_b16 v[50:51], v3 offset:37888
    s_waitcnt lgkmcnt(10)
    v_mfma_f32_16x16x32_bf16 v[112:115], v[208:211], v[56:59], v[112:115]
    ds_read_b64_tr_b16 v[52:53], v4 offset:36864
    v_mfma_f32_16x16x32_bf16 v[116:119], v[212:215], v[56:59], v[116:119]
    ds_read_b64_tr_b16 v[54:55], v4 offset:37888
    v_mfma_f32_16x16x32_bf16 v[120:123], v[208:211], v[60:63], v[120:123]
    ds_read_b64_tr_b16 v[56:57], v5 offset:36864
    v_mfma_f32_16x16x32_bf16 v[124:127], v[212:215], v[60:63], v[124:127]
    ds_read_b64_tr_b16 v[58:59], v5 offset:37888
    s_waitcnt lgkmcnt(10)
    v_mfma_f32_16x16x32_bf16 v[128:131], v[32:35], v[208:211], v[128:131]
    ds_read_b64_tr_b16 v[60:61], v6 offset:36864
    v_mfma_f32_16x16x32_bf16 v[132:135], v[32:35], v[212:215], v[132:135]
    ds_read_b64_tr_b16 v[62:63], v6 offset:37888
    v_mfma_f32_16x16x32_bf16 v[136:139], v[36:39], v[208:211], v[136:139]
    ds_read_b64_tr_b16 v[32:33], v3 offset:40960
    v_mfma_f32_16x16x32_bf16 v[140:143], v[36:39], v[212:215], v[140:143]
    ds_read_b64_tr_b16 v[34:35], v3 offset:41984
    s_waitcnt lgkmcnt(10)
    v_mfma_f32_16x16x32_bf16 v[144:147], v[40:43], v[208:211], v[144:147]
    ds_read_b64_tr_b16 v[36:37], v4 offset:40960
    v_mfma_f32_16x16x32_bf16 v[148:151], v[40:43], v[212:215], v[148:151]
    ds_read_b64_tr_b16 v[38:39], v4 offset:41984
    v_mfma_f32_16x16x32_bf16 v[152:155], v[44:47], v[208:211], v[152:155]
    ds_read_b64_tr_b16 v[40:41], v5 offset:40960
    v_mfma_f32_16x16x32_bf16 v[156:159], v[44:47], v[212:215], v[156:159]
    ds_read_b64_tr_b16 v[42:43], v5 offset:41984
    s_waitcnt vmcnt(18) lgkmcnt(10)
    v_mfma_f32_16x16x32_bf16 v[64:67], v[48:51], v[216:219], v[64:67]
    ds_read_b64_tr_b16 v[44:45], v6 offset:40960
    v_mfma_f32_16x16x32_bf16 v[68:71], v[48:51], v[220:223], v[68:71]
    ds_read_b64_tr_b16 v[46:47], v6 offset:41984
    v_mfma_f32_16x16x32_bf16 v[72:75], v[52:55], v[216:219], v[72:75]
    ds_read_b64_tr_b16 v[48:49], v3 offset:45056
    v_mfma_f32_16x16x32_bf16 v[76:79], v[52:55], v[220:223], v[76:79]
    ds_read_b64_tr_b16 v[50:51], v3 offset:46080
    s_waitcnt lgkmcnt(10)
    v_mfma_f32_16x16x32_bf16 v[80:83], v[56:59], v[216:219], v[80:83]
    ds_read_b64_tr_b16 v[52:53], v4 offset:45056
    v_mfma_f32_16x16x32_bf16 v[84:87], v[56:59], v[220:223], v[84:87]
    ds_read_b64_tr_b16 v[54:55], v4 offset:46080
    v_mfma_f32_16x16x32_bf16 v[88:91], v[60:63], v[216:219], v[88:91]
    ds_read_b64_tr_b16 v[56:57], v5 offset:45056
    v_mfma_f32_16x16x32_bf16 v[92:95], v[60:63], v[220:223], v[92:95]
    ds_read_b64_tr_b16 v[58:59], v5 offset:46080
    s_waitcnt lgkmcnt(10)
    v_mfma_f32_16x16x32_bf16 v[96:99], v[216:219], v[32:35], v[96:99]
    ds_read_b64_tr_b16 v[60:61], v6 offset:45056
    v_mfma_f32_16x16x32_bf16 v[100:103], v[220:223], v[32:35], v[100:103]
    ds_read_b64_tr_b16 v[62:63], v6 offset:46080
    v_mfma_f32_16x16x32_bf16 v[104:107], v[216:219], v[36:39], v[104:107]
    ds_read_b64_tr_b16 v[32:33], v3 offset:49152
    v_mfma_f32_16x16x32_bf16 v[108:111], v[220:223], v[36:39], v[108:111]
    ds_read_b64_tr_b16 v[34:35], v3 offset:50176
    s_waitcnt lgkmcnt(10)
    v_mfma_f32_16x16x32_bf16 v[112:115], v[216:219], v[40:43], v[112:115]
    ds_read_b64_tr_b16 v[36:37], v4 offset:49152
    v_mfma_f32_16x16x32_bf16 v[116:119], v[220:223], v[40:43], v[116:119]
    ds_read_b64_tr_b16 v[38:39], v4 offset:50176
    v_mfma_f32_16x16x32_bf16 v[120:123], v[216:219], v[44:47], v[120:123]
    ds_read_b64_tr_b16 v[40:41], v5 offset:49152
    v_mfma_f32_16x16x32_bf16 v[124:127], v[220:223], v[44:47], v[124:127]
    ds_read_b64_tr_b16 v[42:43], v5 offset:50176
    s_waitcnt lgkmcnt(10)
    v_mfma_f32_16x16x32_bf16 v[128:131], v[48:51], v[216:219], v[128:131]
    buffer_load_dwordx4 v[200:203], v2, s[4:7], s42 offen offset:2048 sc1
    ds_read_b64_tr_b16 v[44:45], v6 offset:49152
    v_mfma_f32_16x16x32_bf16 v[132:135], v[48:51], v[220:223], v[132:135]
    ds_read_b64_tr_b16 v[46:47], v6 offset:50176
    v_mfma_f32_16x16x32_bf16 v[136:139], v[52:55], v[216:219], v[136:139]
    buffer_load_dwordx4 v[204:207], v2, s[4:7], s42 offen offset:2304 sc1
    ds_read_b64_tr_b16 v[48:49], v3 offset:53248
    s_add_u32 s42, s41, s99
    v_mfma_f32_16x16x32_bf16 v[140:143], v[52:55], v[220:223], v[140:143]
    ds_read_b64_tr_b16 v[50:51], v3 offset:54272
    s_waitcnt lgkmcnt(10)
    v_mfma_f32_16x16x32_bf16 v[144:147], v[56:59], v[216:219], v[144:147]
    buffer_load_dwordx4 v[208:211], v2, s[4:7], s42 offen offset:0 sc1
    ds_read_b64_tr_b16 v[52:53], v4 offset:53248
    v_mfma_f32_16x16x32_bf16 v[148:151], v[56:59], v[220:223], v[148:151]
    ds_read_b64_tr_b16 v[54:55], v4 offset:54272
    v_mfma_f32_16x16x32_bf16 v[152:155], v[60:63], v[216:219], v[152:155]
    buffer_load_dwordx4 v[212:215], v2, s[4:7], s42 offen offset:256 sc1
    ds_read_b64_tr_b16 v[56:57], v5 offset:53248
    v_mfma_f32_16x16x32_bf16 v[156:159], v[60:63], v[220:223], v[156:159]
    ds_read_b64_tr_b16 v[58:59], v5 offset:54272
    s_waitcnt vmcnt(20) lgkmcnt(10)
    v_mfma_f32_16x16x32_bf16 v[64:67], v[32:35], v[224:227], v[64:67]
    ds_read_b64_tr_b16 v[60:61], v6 offset:53248
    buffer_load_dwordx4 v[216:219], v2, s[4:7], s42 offen offset:2048 sc1
    v_mfma_f32_16x16x32_bf16 v[68:71], v[32:35], v[228:231], v[68:71]
    ds_read_b64_tr_b16 v[62:63], v6 offset:54272
    v_mfma_f32_16x16x32_bf16 v[72:75], v[36:39], v[224:227], v[72:75]
    buffer_load_dwordx4 v[220:223], v2, s[4:7], s42 offen offset:2304 sc1
    ds_read_b64_tr_b16 v[32:33], v3 offset:57344
    v_mfma_f32_16x16x32_bf16 v[76:79], v[36:39], v[228:231], v[76:79]
    ds_read_b64_tr_b16 v[34:35], v3 offset:58368
    s_waitcnt lgkmcnt(10)
    v_mfma_f32_16x16x32_bf16 v[80:83], v[40:43], v[224:227], v[80:83]
    ds_read_b64_tr_b16 v[36:37], v4 offset:57344
    v_mfma_f32_16x16x32_bf16 v[84:87], v[40:43], v[228:231], v[84:87]
    ds_read_b64_tr_b16 v[38:39], v4 offset:58368
    v_mfma_f32_16x16x32_bf16 v[88:91], v[44:47], v[224:227], v[88:91]
    ds_read_b64_tr_b16 v[40:41], v5 offset:57344
    v_mfma_f32_16x16x32_bf16 v[92:95], v[44:47], v[228:231], v[92:95]
    ds_read_b64_tr_b16 v[42:43], v5 offset:58368
    s_waitcnt lgkmcnt(10)
    v_mfma_f32_16x16x32_bf16 v[96:99], v[224:227], v[48:51], v[96:99]
    ds_read_b64_tr_b16 v[44:45], v6 offset:57344
    v_mfma_f32_16x16x32_bf16 v[100:103], v[228:231], v[48:51], v[100:103]
    ds_read_b64_tr_b16 v[46:47], v6 offset:58368
    v_mfma_f32_16x16x32_bf16 v[104:107], v[224:227], v[52:55], v[104:107]
    ds_read_b64_tr_b16 v[48:49], v3 offset:61440
    v_mfma_f32_16x16x32_bf16 v[108:111], v[228:231], v[52:55], v[108:111]
    ds_read_b64_tr_b16 v[50:51], v3 offset:62464
    s_waitcnt lgkmcnt(10)
    v_mfma_f32_16x16x32_bf16 v[112:115], v[224:227], v[56:59], v[112:115]
    ds_read_b64_tr_b16 v[52:53], v4 offset:61440
    v_mfma_f32_16x16x32_bf16 v[116:119], v[228:231], v[56:59], v[116:119]
    ds_read_b64_tr_b16 v[54:55], v4 offset:62464
    v_mfma_f32_16x16x32_bf16 v[120:123], v[224:227], v[60:63], v[120:123]
    ds_read_b64_tr_b16 v[56:57], v5 offset:61440
    v_mfma_f32_16x16x32_bf16 v[124:127], v[228:231], v[60:63], v[124:127]
    ds_read_b64_tr_b16 v[58:59], v5 offset:62464
    s_waitcnt vmcnt(20) lgkmcnt(10)
    v_mfma_f32_16x16x32_bf16 v[64:67], v[32:35], v[232:235], v[64:67]
    ds_read_b64_tr_b16 v[60:61], v6 offset:61440
    v_mfma_f32_16x16x32_bf16 v[68:71], v[32:35], v[236:239], v[68:71]
    ds_read_b64_tr_b16 v[62:63], v6 offset:62464
    s_barrier
    v_xor_b32 v3, 0x10000, v3
    v_xor_b32 v4, 0x10000, v4
    v_xor_b32 v5, 0x10000, v5
    v_xor_b32 v6, 0x10000, v6
    v_mfma_f32_16x16x32_bf16 v[72:75], v[36:39], v[232:235], v[72:75]
    ds_read_b64_tr_b16 v[32:33], v3 offset:0
    v_mfma_f32_16x16x32_bf16 v[76:79], v[36:39], v[236:239], v[76:79]
    ds_read_b64_tr_b16 v[34:35], v3 offset:1024
    s_waitcnt lgkmcnt(10)
    v_mfma_f32_16x16x32_bf16 v[80:83], v[40:43], v[232:235], v[80:83]
    ds_read_b64_tr_b16 v[36:37], v4 offset:0
    v_mfma_f32_16x16x32_bf16 v[84:87], v[40:43], v[236:239], v[84:87]
    ds_read_b64_tr_b16 v[38:39], v4 offset:1024
    v_mfma_f32_16x16x32_bf16 v[88:91], v[44:47], v[232:235], v[88:91]
    ds_read_b64_tr_b16 v[40:41], v5 offset:0
    v_mfma_f32_16x16x32_bf16 v[92:95], v[44:47], v[236:239], v[92:95]
    ds_read_b64_tr_b16 v[42:43], v5 offset:1024
    s_waitcnt lgkmcnt(10)
    v_mfma_f32_16x16x32_bf16 v[96:99], v[232:235], v[48:51], v[96:99]
    ds_read_b64_tr_b16 v[44:45], v6 offset:0
    v_mfma_f32_16x16x32_bf16 v[100:103], v[236:239], v[48:51], v[100:103]
    ds_read_b64_tr_b16 v[46:47], v6 offset:1024
    v_mfma_f32_16x16x32_bf16 v[104:107], v[232:235], v[52:55], v[104:107]
    ds_read_b64_tr_b16 v[48:49], v3 offset:4096
    v_mfma_f32_16x16x32_bf16 v[108:111], v[236:239], v[52:55], v[108:111]
    ds_read_b64_tr_b16 v[50:51], v3 offset:5120
    s_waitcnt lgkmcnt(10)
    v_mfma_f32_16x16x32_bf16 v[112:115], v[232:235], v[56:59], v[112:115]
    ds_read_b64_tr_b16 v[52:53], v4 offset:4096
    v_mfma_f32_16x16x32_bf16 v[116:119], v[236:239], v[56:59], v[116:119]
    ds_read_b64_tr_b16 v[54:55], v4 offset:5120
    v_mfma_f32_16x16x32_bf16 v[120:123], v[232:235], v[60:63], v[120:123]
    ds_read_b64_tr_b16 v[56:57], v5 offset:4096
    v_mfma_f32_16x16x32_bf16 v[124:127], v[236:239], v[60:63], v[124:127]
    ds_read_b64_tr_b16 v[58:59], v5 offset:5120
    s_waitcnt vmcnt(18) lgkmcnt(10)
    v_mfma_f32_16x16x32_bf16 v[64:67], v[32:35], v[240:243], v[64:67]
    ds_read_b64_tr_b16 v[60:61], v6 offset:4096
    v_mfma_f32_16x16x32_bf16 v[68:71], v[32:35], v[244:247], v[68:71]
    ds_read_b64_tr_b16 v[62:63], v6 offset:5120
    v_mfma_f32_16x16x32_bf16 v[72:75], v[36:39], v[240:243], v[72:75]
    ds_read_b64_tr_b16 v[32:33], v3 offset:8192
    v_mfma_f32_16x16x32_bf16 v[76:79], v[36:39], v[244:247], v[76:79]
    ds_read_b64_tr_b16 v[34:35], v3 offset:9216
    s_waitcnt lgkmcnt(10)
    v_mfma_f32_16x16x32_bf16 v[80:83], v[40:43], v[240:243], v[80:83]
    ds_read_b64_tr_b16 v[36:37], v4 offset:8192
    v_mfma_f32_16x16x32_bf16 v[84:87], v[40:43], v[244:247], v[84:87]
    ds_read_b64_tr_b16 v[38:39], v4 offset:9216
    v_mfma_f32_16x16x32_bf16 v[88:91], v[44:47], v[240:243], v[88:91]
    ds_read_b64_tr_b16 v[40:41], v5 offset:8192
    v_mfma_f32_16x16x32_bf16 v[92:95], v[44:47], v[244:247], v[92:95]
    ds_read_b64_tr_b16 v[42:43], v5 offset:9216
    s_waitcnt lgkmcnt(10)
    v_mfma_f32_16x16x32_bf16 v[96:99], v[240:243], v[48:51], v[96:99]
    ds_read_b64_tr_b16 v[44:45], v6 offset:8192
    v_mfma_f32_16x16x32_bf16 v[100:103], v[244:247], v[48:51], v[100:103]
    ds_read_b64_tr_b16 v[46:47], v6 offset:9216
    v_mfma_f32_16x16x32_bf16 v[104:107], v[240:243], v[52:55], v[104:107]
    ds_read_b64_tr_b16 v[48:49], v3 offset:12288
    v_mfma_f32_16x16x32_bf16 v[108:111], v[244:247], v[52:55], v[108:111]
    ds_read_b64_tr_b16 v[50:51], v3 offset:13312
    s_waitcnt lgkmcnt(10)
    v_mfma_f32_16x16x32_bf16 v[112:115], v[240:243], v[56:59], v[112:115]
    ds_read_b64_tr_b16 v[52:53], v4 offset:12288
    v_mfma_f32_16x16x32_bf16 v[116:119], v[244:247], v[56:59], v[116:119]
    ds_read_b64_tr_b16 v[54:55], v4 offset:13312
    v_mfma_f32_16x16x32_bf16 v[120:123], v[240:243], v[60:63], v[120:123]
    ds_read_b64_tr_b16 v[56:57], v5 offset:12288
    v_mfma_f32_16x16x32_bf16 v[124:127], v[244:247], v[60:63], v[124:127]
    ds_read_b64_tr_b16 v[58:59], v5 offset:13312
    s_waitcnt vmcnt(16) lgkmcnt(10)
    v_mfma_f32_16x16x32_bf16 v[64:67], v[32:35], v[248:251], v[64:67]
    ds_read_b64_tr_b16 v[60:61], v6 offset:12288
    v_mfma_f32_16x16x32_bf16 v[68:71], v[32:35], v[252:255], v[68:71]
    ds_read_b64_tr_b16 v[62:63], v6 offset:13312
    v_mfma_f32_16x16x32_bf16 v[72:75], v[36:39], v[248:251], v[72:75]
    ds_read_b64_tr_b16 v[32:33], v3 offset:16384
    v_mfma_f32_16x16x32_bf16 v[76:79], v[36:39], v[252:255], v[76:79]
    ds_read_b64_tr_b16 v[34:35], v3 offset:17408
    s_waitcnt lgkmcnt(10)
    v_mfma_f32_16x16x32_bf16 v[80:83], v[40:43], v[248:251], v[80:83]
    ds_read_b64_tr_b16 v[36:37], v4 offset:16384
    v_mfma_f32_16x16x32_bf16 v[84:87], v[40:43], v[252:255], v[84:87]
    ds_read_b64_tr_b16 v[38:39], v4 offset:17408
    v_mfma_f32_16x16x32_bf16 v[88:91], v[44:47], v[248:251], v[88:91]
    ds_read_b64_tr_b16 v[40:41], v5 offset:16384
    v_mfma_f32_16x16x32_bf16 v[92:95], v[44:47], v[252:255], v[92:95]
    ds_read_b64_tr_b16 v[42:43], v5 offset:17408
    s_waitcnt lgkmcnt(10)
    v_mfma_f32_16x16x32_bf16 v[96:99], v[248:251], v[48:51], v[96:99]
    ds_read_b64_tr_b16 v[44:45], v6 offset:16384
    v_mfma_f32_16x16x32_bf16 v[100:103], v[252:255], v[48:51], v[100:103]
    ds_read_b64_tr_b16 v[46:47], v6 offset:17408
    v_mfma_f32_16x16x32_bf16 v[104:107], v[248:251], v[52:55], v[104:107]
    ds_read_b64_tr_b16 v[48:49], v3 offset:20480
    v_mfma_f32_16x16x32_bf16 v[108:111], v[252:255], v[52:55], v[108:111]
    ds_read_b64_tr_b16 v[50:51], v3 offset:21504
    s_waitcnt lgkmcnt(10)
    v_mfma_f32_16x16x32_bf16 v[112:115], v[248:251], v[56:59], v[112:115]
    ds_read_b64_tr_b16 v[52:53], v4 offset:20480
    v_mfma_f32_16x16x32_bf16 v[116:119], v[252:255], v[56:59], v[116:119]
    ds_read_b64_tr_b16 v[54:55], v4 offset:21504
    v_mfma_f32_16x16x32_bf16 v[120:123], v[248:251], v[60:63], v[120:123]
    ds_read_b64_tr_b16 v[56:57], v5 offset:20480
    v_mfma_f32_16x16x32_bf16 v[124:127], v[252:255], v[60:63], v[124:127]
    ds_read_b64_tr_b16 v[58:59], v5 offset:21504
    s_waitcnt vmcnt(14) lgkmcnt(10)
    v_mfma_f32_16x16x32_bf16 v[64:67], v[32:35], v[160:163], v[64:67]
    ds_read_b64_tr_b16 v[60:61], v6 offset:20480
    v_mfma_f32_16x16x32_bf16 v[68:71], v[32:35], v[164:167], v[68:71]
    ds_read_b64_tr_b16 v[62:63], v6 offset:21504
    v_mfma_f32_16x16x32_bf16 v[72:75], v[36:39], v[160:163], v[72:75]
    ds_read_b64_tr_b16 v[32:33], v3 offset:24576
    v_mfma_f32_16x16x32_bf16 v[76:79], v[36:39], v[164:167], v[76:79]
    ds_read_b64_tr_b16 v[34:35], v3 offset:25600
    s_waitcnt lgkmcnt(10)
    v_mfma_f32_16x16x32_bf16 v[80:83], v[40:43], v[160:163], v[80:83]
    ds_read_b64_tr_b16 v[36:37], v4 offset:24576
    v_mfma_f32_16x16x32_bf16 v[84:87], v[40:43], v[164:167], v[84:87]
    ds_read_b64_tr_b16 v[38:39], v4 offset:25600
    v_mfma_f32_16x16x32_bf16 v[88:91], v[44:47], v[160:163], v[88:91]
    ds_read_b64_tr_b16 v[40:41], v5 offset:24576
    v_mfma_f32_16x16x32_bf16 v[92:95], v[44:47], v[164:167], v[92:95]
    ds_read_b64_tr_b16 v[42:43], v5 offset:25600
    s_waitcnt vmcnt(12) lgkmcnt(10)
    v_mfma_f32_16x16x32_bf16 v[64:67], v[48:51], v[168:171], v[64:67]
    ds_read_b64_tr_b16 v[44:45], v6 offset:24576
    v_mfma_f32_16x16x32_bf16 v[68:71], v[48:51], v[172:175], v[68:71]
    ds_read_b64_tr_b16 v[46:47], v6 offset:25600
    v_mfma_f32_16x16x32_bf16 v[72:75], v[52:55], v[168:171], v[72:75]
    ds_read_b64_tr_b16 v[48:49], v3 offset:28672
    v_mfma_f32_16x16x32_bf16 v[76:79], v[52:55], v[172:175], v[76:79]
    ds_read_b64_tr_b16 v[50:51], v3 offset:29696
    s_waitcnt lgkmcnt(10)
    v_mfma_f32_16x16x32_bf16 v[80:83], v[56:59], v[168:171], v[80:83]
    ds_read_b64_tr_b16 v[52:53], v4 offset:28672
    v_mfma_f32_16x16x32_bf16 v[84:87], v[56:59], v[172:175], v[84:87]
    ds_read_b64_tr_b16 v[54:55], v4 offset:29696
    v_mfma_f32_16x16x32_bf16 v[88:91], v[60:63], v[168:171], v[88:91]
    ds_read_b64_tr_b16 v[56:57], v5 offset:28672
    v_mfma_f32_16x16x32_bf16 v[92:95], v[60:63], v[172:175], v[92:95]
    ds_read_b64_tr_b16 v[58:59], v5 offset:29696
    s_waitcnt vmcnt(10) lgkmcnt(10)
    v_mfma_f32_16x16x32_bf16 v[64:67], v[32:35], v[176:179], v[64:67]
    ds_read_b64_tr_b16 v[60:61], v6 offset:28672
    v_mfma_f32_16x16x32_bf16 v[68:71], v[32:35], v[180:183], v[68:71]
    ds_read_b64_tr_b16 v[62:63], v6 offset:29696
    s_barrier
    v_mfma_f32_16x16x32_bf16 v[72:75], v[36:39], v[176:179], v[72:75]
    ds_read_b64_tr_b16 v[32:33], v3 offset:32768
    v_mfma_f32_16x16x32_bf16 v[76:79], v[36:39], v[180:183], v[76:79]
    ds_read_b64_tr_b16 v[34:35], v3 offset:33792
    s_waitcnt lgkmcnt(10)
    v_mfma_f32_16x16x32_bf16 v[80:83], v[40:43], v[176:179], v[80:83]
    ds_read_b64_tr_b16 v[36:37], v4 offset:32768
    v_mfma_f32_16x16x32_bf16 v[84:87], v[40:43], v[180:183], v[84:87]
    ds_read_b64_tr_b16 v[38:39], v4 offset:33792
    v_mfma_f32_16x16x32_bf16 v[88:91], v[44:47], v[176:179], v[88:91]
    ds_read_b64_tr_b16 v[40:41], v5 offset:32768
    v_mfma_f32_16x16x32_bf16 v[92:95], v[44:47], v[180:183], v[92:95]
    ds_read_b64_tr_b16 v[42:43], v5 offset:33792
    s_waitcnt vmcnt(8) lgkmcnt(10)
    v_mfma_f32_16x16x32_bf16 v[64:67], v[48:51], v[184:187], v[64:67]
    ds_read_b64_tr_b16 v[44:45], v6 offset:32768
    v_mfma_f32_16x16x32_bf16 v[68:71], v[48:51], v[188:191], v[68:71]
    ds_read_b64_tr_b16 v[46:47], v6 offset:33792
    v_mfma_f32_16x16x32_bf16 v[72:75], v[52:55], v[184:187], v[72:75]
    ds_read_b64_tr_b16 v[48:49], v3 offset:36864
    v_mfma_f32_16x16x32_bf16 v[76:79], v[52:55], v[188:191], v[76:79]
    ds_read_b64_tr_b16 v[50:51], v3 offset:37888
    s_waitcnt lgkmcnt(10)
    v_mfma_f32_16x16x32_bf16 v[80:83], v[56:59], v[184:187], v[80:83]
    ds_read_b64_tr_b16 v[52:53], v4 offset:36864
    v_mfma_f32_16x16x32_bf16 v[84:87], v[56:59], v[188:191], v[84:87]
    ds_read_b64_tr_b16 v[54:55], v4 offset:37888
    v_mfma_f32_16x16x32_bf16 v[88:91], v[60:63], v[184:187], v[88:91]
    ds_read_b64_tr_b16 v[56:57], v5 offset:36864
    v_mfma_f32_16x16x32_bf16 v[92:95], v[60:63], v[188:191], v[92:95]
    ds_read_b64_tr_b16 v[58:59], v5 offset:37888
    s_waitcnt vmcnt(6) lgkmcnt(10)
    v_mfma_f32_16x16x32_bf16 v[64:67], v[32:35], v[192:195], v[64:67]
    ds_read_b64_tr_b16 v[60:61], v6 offset:36864
    v_mfma_f32_16x16x32_bf16 v[68:71], v[32:35], v[196:199], v[68:71]
    ds_read_b64_tr_b16 v[62:63], v6 offset:37888
    v_mfma_f32_16x16x32_bf16 v[72:75], v[36:39], v[192:195], v[72:75]
    ds_read_b64_tr_b16 v[32:33], v3 offset:40960
    v_mfma_f32_16x16x32_bf16 v[76:79], v[36:39], v[196:199], v[76:79]
    ds_read_b64_tr_b16 v[34:35], v3 offset:41984
    s_waitcnt lgkmcnt(10)
    v_mfma_f32_16x16x32_bf16 v[80:83], v[40:43], v[192:195], v[80:83]
    ds_read_b64_tr_b16 v[36:37], v4 offset:40960
    v_mfma_f32_16x16x32_bf16 v[84:87], v[40:43], v[196:199], v[84:87]
    ds_read_b64_tr_b16 v[38:39], v4 offset:41984
    v_mfma_f32_16x16x32_bf16 v[88:91], v[44:47], v[192:195], v[88:91]
    ds_read_b64_tr_b16 v[40:41], v5 offset:40960
    v_mfma_f32_16x16x32_bf16 v[92:95], v[44:47], v[196:199], v[92:95]
    ds_read_b64_tr_b16 v[42:43], v5 offset:41984
    s_waitcnt vmcnt(4) lgkmcnt(10)
    v_mfma_f32_16x16x32_bf16 v[64:67], v[48:51], v[200:203], v[64:67]
    ds_read_b64_tr_b16 v[44:45], v6 offset:40960
    v_mfma_f32_16x16x32_bf16 v[68:71], v[48:51], v[204:207], v[68:71]
    ds_read_b64_tr_b16 v[46:47], v6 offset:41984
    v_mfma_f32_16x16x32_bf16 v[72:75], v[52:55], v[200:203], v[72:75]
    ds_read_b64_tr_b16 v[48:49], v3 offset:45056
    v_mfma_f32_16x16x32_bf16 v[76:79], v[52:55], v[204:207], v[76:79]
    ds_read_b64_tr_b16 v[50:51], v3 offset:46080
    s_waitcnt lgkmcnt(10)
    v_mfma_f32_16x16x32_bf16 v[80:83], v[56:59], v[200:203], v[80:83]
    ds_read_b64_tr_b16 v[52:53], v4 offset:45056
    v_mfma_f32_16x16x32_bf16 v[84:87], v[56:59], v[204:207], v[84:87]
    ds_read_b64_tr_b16 v[54:55], v4 offset:46080
    v_mfma_f32_16x16x32_bf16 v[88:91], v[60:63], v[200:203], v[88:91]
    ds_read_b64_tr_b16 v[56:57], v5 offset:45056
    v_mfma_f32_16x16x32_bf16 v[92:95], v[60:63], v[204:207], v[92:95]
    ds_read_b64_tr_b16 v[58:59], v5 offset:46080
    s_waitcnt vmcnt(2) lgkmcnt(10)
    v_mfma_f32_16x16x32_bf16 v[64:67], v[32:35], v[208:211], v[64:67]
    ds_read_b64_tr_b16 v[60:61], v6 offset:45056
    v_mfma_f32_16x16x32_bf16 v[68:71], v[32:35], v[212:215], v[68:71]
    ds_read_b64_tr_b16 v[62:63], v6 offset:46080
    v_mfma_f32_16x16x32_bf16 v[72:75], v[36:39], v[208:211], v[72:75]
    ds_read_b64_tr_b16 v[32:33], v3 offset:49152
    ds_read_b32 v8, v9 offset:4096
    v_mfma_f32_16x16x32_bf16 v[76:79], v[36:39], v[212:215], v[76:79]
    ds_read_b64_tr_b16 v[34:35], v3 offset:50176
    ds_read_b32 v10, v9 offset:4608
    s_waitcnt lgkmcnt(12)
    v_mfma_f32_16x16x32_bf16 v[80:83], v[40:43], v[208:211], v[80:83]
    ds_read_b64_tr_b16 v[36:37], v4 offset:49152
    ds_read_b32 v12, v9 offset:4160
    v_mfma_f32_16x16x32_bf16 v[84:87], v[40:43], v[212:215], v[84:87]
    ds_read_b64_tr_b16 v[38:39], v4 offset:50176
    ds_read_b32 v14, v9 offset:4672
    v_mfma_f32_16x16x32_bf16 v[88:91], v[44:47], v[208:211], v[88:91]
    ds_read_b64_tr_b16 v[40:41], v5 offset:49152
    ds_read_b128 v[16:19], v11 offset:256
    v_mfma_f32_16x16x32_bf16 v[92:95], v[44:47], v[212:215], v[92:95]
    ds_read_b64_tr_b16 v[42:43], v5 offset:50176
    ds_read_b128 v[20:23], v11 offset:320
    s_waitcnt vmcnt(0) lgkmcnt(14)
    v_mfma_f32_16x16x32_bf16 v[64:67], v[48:51], v[216:219], v[64:67]
    ds_read_b64_tr_b16 v[44:45], v6 offset:49152
    ds_read_b128 v[24:27], v11 offset:384
    v_mfma_f32_16x16x32_bf16 v[68:71], v[48:51], v[220:223], v[68:71]
    ds_read_b64_tr_b16 v[46:47], v6 offset:50176
    ds_read_b128 v[28:31], v11 offset:448
    v_mfma_f32_16x16x32_bf16 v[72:75], v[52:55], v[216:219], v[72:75]
    ds_read_b64_tr_b16 v[48:49], v3 offset:53248
    v_mfma_f32_16x16x32_bf16 v[76:79], v[52:55], v[220:223], v[76:79]
    ds_read_b64_tr_b16 v[50:51], v3 offset:54272
    s_waitcnt lgkmcnt(14)
    v_mfma_f32_16x16x32_bf16 v[80:83], v[56:59], v[216:219], v[80:83]
    ds_read_b64_tr_b16 v[52:53], v4 offset:53248
    v_mfma_f32_16x16x32_bf16 v[84:87], v[56:59], v[220:223], v[84:87]
    ds_read_b64_tr_b16 v[54:55], v4 offset:54272
    v_mfma_f32_16x16x32_bf16 v[88:91], v[60:63], v[216:219], v[88:91]
    ds_read_b64_tr_b16 v[56:57], v5 offset:53248
    v_mfma_f32_16x16x32_bf16 v[92:95], v[60:63], v[220:223], v[92:95]
    ds_read_b64_tr_b16 v[58:59], v5 offset:54272
    s_bitcmp1_b32 s21, 0
    s_cbranch_scc1 c_B
    v_add_u32 v7, s62, v1
    s_waitcnt lgkmcnt(6)
    v_pk_fma_f32 v[68:69], v[12:13], v[16:17], v[68:69] op_sel_hi:[0,1,1] neg_lo:[1,0,0] neg_hi:[1,0,0]
    v_pk_fma_f32 v[70:71], v[12:13], v[18:19], v[70:71] op_sel_hi:[0,1,1] neg_lo:[1,0,0] neg_hi:[1,0,0]
    v_pk_fma_f32 v[76:77], v[12:13], v[20:21], v[76:77] op_sel_hi:[0,1,1] neg_lo:[1,0,0] neg_hi:[1,0,0]
    v_pk_fma_f32 v[78:79], v[12:13], v[22:23], v[78:79] op_sel_hi:[0,1,1] neg_lo:[1,0,0] neg_hi:[1,0,0]
    v_pk_mul_f32 v[68:69], v[14:15], v[68:69] op_sel_hi:[0,1]
    v_pk_mul_f32 v[70:71], v[14:15], v[70:71] op_sel_hi:[0,1]
    v_pk_mul_f32 v[76:77], v[14:15], v[76:77] op_sel_hi:[0,1]
    v_pk_mul_f32 v[78:79], v[14:15], v[78:79] op_sel_hi:[0,1]
    v_cvt_pk_bf16_f32 v68, v68, v69
    v_cvt_pk_bf16_f32 v69, v70, v71
    v_cvt_pk_bf16_f32 v70, v76, v77
    v_cvt_pk_bf16_f32 v71, v78, v79
    ds_write_b128 v7, v[68:71] offset:4096
    v_pk_fma_f32 v[64:65], v[8:9], v[16:17], v[64:65] op_sel_hi:[0,1,1] neg_lo:[1,0,0] neg_hi:[1,0,0]
    v_pk_fma_f32 v[66:67], v[8:9], v[18:19], v[66:67] op_sel_hi:[0,1,1] neg_lo:[1,0,0] neg_hi:[1,0,0]
    v_pk_fma_f32 v[72:73], v[8:9], v[20:21], v[72:73] op_sel_hi:[0,1,1] neg_lo:[1,0,0] neg_hi:[1,0,0]
    v_pk_fma_f32 v[74:75], v[8:9], v[22:23], v[74:75] op_sel_hi:[0,1,1] neg_lo:[1,0,0] neg_hi:[1,0,0]
    v_pk_mul_f32 v[64:65], v[10:11], v[64:65] op_sel_hi:[0,1]
    v_pk_mul_f32 v[66:67], v[10:11], v[66:67] op_sel_hi:[0,1]
    v_pk_mul_f32 v[72:73], v[10:11], v[72:73] op_sel_hi:[0,1]
    v_pk_mul_f32 v[74:75], v[10:11], v[74:75] op_sel_hi:[0,1]
    v_cvt_pk_bf16_f32 v64, v64, v65
    v_cvt_pk_bf16_f32 v65, v66, v67
    v_cvt_pk_bf16_f32 v66, v72, v73
    v_cvt_pk_bf16_f32 v67, v74, v75
    v_pk_fma_f32 v[84:85], v[12:13], v[24:25], v[84:85] op_sel_hi:[0,1,1] neg_lo:[1,0,0] neg_hi:[1,0,0]
    v_pk_fma_f32 v[86:87], v[12:13], v[26:27], v[86:87] op_sel_hi:[0,1,1] neg_lo:[1,0,0] neg_hi:[1,0,0]
    v_pk_fma_f32 v[92:93], v[12:13], v[28:29], v[92:93] op_sel_hi:[0,1,1] neg_lo:[1,0,0] neg_hi:[1,0,0]
    v_pk_fma_f32 v[94:95], v[12:13], v[30:31], v[94:95] op_sel_hi:[0,1,1] neg_lo:[1,0,0] neg_hi:[1,0,0]
    v_pk_mul_f32 v[84:85], v[14:15], v[84:85] op_sel_hi:[0,1]
    v_pk_mul_f32 v[86:87], v[14:15], v[86:87] op_sel_hi:[0,1]
    v_pk_mul_f32 v[92:93], v[14:15], v[92:93] op_sel_hi:[0,1]
    v_pk_mul_f32 v[94:95], v[14:15], v[94:95] op_sel_hi:[0,1]
    v_cvt_pk_bf16_f32 v84, v84, v85
    v_cvt_pk_bf16_f32 v85, v86, v87
    v_cvt_pk_bf16_f32 v86, v92, v93
    v_cvt_pk_bf16_f32 v87, v94, v95
    ds_write_b128 v7, v[84:87] offset:5120
    v_pk_fma_f32 v[80:81], v[8:9], v[24:25], v[80:81] op_sel_hi:[0,1,1] neg_lo:[1,0,0] neg_hi:[1,0,0]
    v_pk_fma_f32 v[82:83], v[8:9], v[26:27], v[82:83] op_sel_hi:[0,1,1] neg_lo:[1,0,0] neg_hi:[1,0,0]
    v_pk_fma_f32 v[88:89], v[8:9], v[28:29], v[88:89] op_sel_hi:[0,1,1] neg_lo:[1,0,0] neg_hi:[1,0,0]
    v_pk_fma_f32 v[90:91], v[8:9], v[30:31], v[90:91] op_sel_hi:[0,1,1] neg_lo:[1,0,0] neg_hi:[1,0,0]
    v_pk_mul_f32 v[80:81], v[10:11], v[80:81] op_sel_hi:[0,1]
    v_pk_mul_f32 v[82:83], v[10:11], v[82:83] op_sel_hi:[0,1]
    v_pk_mul_f32 v[88:89], v[10:11], v[88:89] op_sel_hi:[0,1]
    v_pk_mul_f32 v[90:91], v[10:11], v[90:91] op_sel_hi:[0,1]
    v_cvt_pk_bf16_f32 v80, v80, v81
    v_cvt_pk_bf16_f32 v81, v82, v83
    v_cvt_pk_bf16_f32 v82, v88, v89
    v_cvt_pk_bf16_f32 v83, v90, v91
    v_mfma_f32_16x16x32_bf16 v[96:99], v[160:163], v[32:35], v[96:99]
    ds_read_b64_tr_b16 v[60:61], v6 offset:53248
    v_mfma_f32_16x16x32_bf16 v[100:103], v[164:167], v[32:35], v[100:103]
    ds_read_b64_tr_b16 v[62:63], v6 offset:54272
    v_mfma_f32_16x16x32_bf16 v[104:107], v[160:163], v[36:39], v[104:107]
    ds_read_b64_tr_b16 v[32:33], v3 offset:57344
    v_mfma_f32_16x16x32_bf16 v[108:111], v[164:167], v[36:39], v[108:111]
    ds_read_b64_tr_b16 v[34:35], v3 offset:58368
    v_mfma_f32_16x16x32_bf16 v[112:115], v[160:163], v[40:43], v[112:115]
    ds_read_b64_tr_b16 v[36:37], v4 offset:57344
    v_mfma_f32_16x16x32_bf16 v[116:119], v[164:167], v[40:43], v[116:119]
    ds_read_b64_tr_b16 v[38:39], v4 offset:58368
    v_mfma_f32_16x16x32_bf16 v[120:123], v[160:163], v[44:47], v[120:123]
    ds_read_b64_tr_b16 v[40:41], v5 offset:57344
    v_mfma_f32_16x16x32_bf16 v[124:127], v[164:167], v[44:47], v[124:127]
    ds_read_b64_tr_b16 v[42:43], v5 offset:58368
    s_waitcnt lgkmcnt(12)
    v_mfma_f32_16x16x32_bf16 v[96:99], v[168:171], v[48:51], v[96:99]
    ds_read_b64_tr_b16 v[44:45], v6 offset:57344
    v_mfma_f32_16x16x32_bf16 v[100:103], v[172:175], v[48:51], v[100:103]
    ds_read_b64_tr_b16 v[46:47], v6 offset:58368
    v_mfma_f32_16x16x32_bf16 v[104:107], v[168:171], v[52:55], v[104:107]
    ds_read_b64_tr_b16 v[48:49], v3 offset:61440
    v_mfma_f32_16x16x32_bf16 v[108:111], v[172:175], v[52:55], v[108:111]
    ds_read_b64_tr_b16 v[50:51], v3 offset:62464
    s_waitcnt lgkmcnt(10)
    v_mfma_f32_16x16x32_bf16 v[112:115], v[168:171], v[56:59], v[112:115]
    ds_read_b64_tr_b16 v[52:53], v4 offset:61440
    v_mfma_f32_16x16x32_bf16 v[116:119], v[172:175], v[56:59], v[116:119]
    ds_read_b64_tr_b16 v[54:55], v4 offset:62464
    v_mfma_f32_16x16x32_bf16 v[120:123], v[168:171], v[60:63], v[120:123]
    ds_read_b64_tr_b16 v[56:57], v5 offset:61440
    v_mfma_f32_16x16x32_bf16 v[124:127], v[172:175], v[60:63], v[124:127]
    ds_read_b64_tr_b16 v[58:59], v5 offset:62464
    s_waitcnt lgkmcnt(10)
    v_mfma_f32_16x16x32_bf16 v[96:99], v[176:179], v[32:35], v[96:99]
    ds_read_b64_tr_b16 v[60:61], v6 offset:61440
    v_mfma_f32_16x16x32_bf16 v[100:103], v[180:183], v[32:35], v[100:103]
    ds_read_b64_tr_b16 v[62:63], v6 offset:62464
    s_barrier
    v_xor_b32 v3, 0x10000, v3
    v_xor_b32 v4, 0x10000, v4
    v_xor_b32 v5, 0x10000, v5
    v_xor_b32 v6, 0x10000, v6
    v_mfma_f32_16x16x32_bf16 v[104:107], v[176:179], v[36:39], v[104:107]
    ds_read_b64_tr_b16 v[32:33], v3 offset:0
    v_mfma_f32_16x16x32_bf16 v[108:111], v[180:183], v[36:39], v[108:111]
    ds_read_b64_tr_b16 v[34:35], v3 offset:1024
    s_waitcnt lgkmcnt(10)
    v_mfma_f32_16x16x32_bf16 v[112:115], v[176:179], v[40:43], v[112:115]
    ds_read_b64_tr_b16 v[36:37], v4 offset:0
    v_mfma_f32_16x16x32_bf16 v[116:119], v[180:183], v[40:43], v[116:119]
    ds_read_b64_tr_b16 v[38:39], v4 offset:1024
    v_mfma_f32_16x16x32_bf16 v[120:123], v[176:179], v[44:47], v[120:123]
    ds_read_b64_tr_b16 v[40:41], v5 offset:0
    v_mfma_f32_16x16x32_bf16 v[124:127], v[180:183], v[44:47], v[124:127]
    ds_read_b64_tr_b16 v[42:43], v5 offset:1024
    s_waitcnt lgkmcnt(10)
    v_mfma_f32_16x16x32_bf16 v[96:99], v[184:187], v[48:51], v[96:99]
    ds_read_b64_tr_b16 v[44:45], v6 offset:0
    v_mfma_f32_16x16x32_bf16 v[100:103], v[188:191], v[48:51], v[100:103]
    ds_read_b64_tr_b16 v[46:47], v6 offset:1024
    v_mfma_f32_16x16x32_bf16 v[104:107], v[184:187], v[52:55], v[104:107]
    ds_read_b64_tr_b16 v[48:49], v3 offset:4096
    v_mfma_f32_16x16x32_bf16 v[108:111], v[188:191], v[52:55], v[108:111]
    ds_read_b64_tr_b16 v[50:51], v3 offset:5120
    s_waitcnt lgkmcnt(10)
    v_mfma_f32_16x16x32_bf16 v[112:115], v[184:187], v[56:59], v[112:115]
    ds_read_b64_tr_b16 v[52:53], v4 offset:4096
    v_mfma_f32_16x16x32_bf16 v[116:119], v[188:191], v[56:59], v[116:119]
    ds_read_b64_tr_b16 v[54:55], v4 offset:5120
    v_mfma_f32_16x16x32_bf16 v[120:123], v[184:187], v[60:63], v[120:123]
    ds_read_b64_tr_b16 v[56:57], v5 offset:4096
    v_mfma_f32_16x16x32_bf16 v[124:127], v[188:191], v[60:63], v[124:127]
    ds_read_b64_tr_b16 v[58:59], v5 offset:5120
    s_waitcnt lgkmcnt(10)
    v_mfma_f32_16x16x32_bf16 v[96:99], v[192:195], v[32:35], v[96:99]
    ds_read_b64_tr_b16 v[60:61], v6 offset:4096
    v_mfma_f32_16x16x32_bf16 v[100:103], v[196:199], v[32:35], v[100:103]
    ds_read_b64_tr_b16 v[62:63], v6 offset:5120
    v_mfma_f32_16x16x32_bf16 v[104:107], v[192:195], v[36:39], v[104:107]
    ds_read_b64_tr_b16 v[32:33], v3 offset:8192
    v_mfma_f32_16x16x32_bf16 v[108:111], v[196:199], v[36:39], v[108:111]
    ds_read_b64_tr_b16 v[34:35], v3 offset:9216
    s_waitcnt lgkmcnt(10)
    v_mfma_f32_16x16x32_bf16 v[112:115], v[192:195], v[40:43], v[112:115]
    ds_read_b64_tr_b16 v[36:37], v4 offset:8192
    v_mfma_f32_16x16x32_bf16 v[116:119], v[196:199], v[40:43], v[116:119]
    ds_read_b64_tr_b16 v[38:39], v4 offset:9216
    v_mfma_f32_16x16x32_bf16 v[120:123], v[192:195], v[44:47], v[120:123]
    ds_read_b64_tr_b16 v[40:41], v5 offset:8192
    v_mfma_f32_16x16x32_bf16 v[124:127], v[196:199], v[44:47], v[124:127]
    ds_read_b64_tr_b16 v[42:43], v5 offset:9216
    s_waitcnt lgkmcnt(10)
    v_mfma_f32_16x16x32_bf16 v[96:99], v[200:203], v[48:51], v[96:99]
    ds_read_b64_tr_b16 v[44:45], v6 offset:8192
    v_mfma_f32_16x16x32_bf16 v[100:103], v[204:207], v[48:51], v[100:103]
    ds_read_b64_tr_b16 v[46:47], v6 offset:9216
    v_mfma_f32_16x16x32_bf16 v[104:107], v[200:203], v[52:55], v[104:107]
    ds_read_b64_tr_b16 v[48:49], v3 offset:12288
    v_mfma_f32_16x16x32_bf16 v[108:111], v[204:207], v[52:55], v[108:111]
    ds_read_b64_tr_b16 v[50:51], v3 offset:13312
    s_waitcnt lgkmcnt(10)
    v_mfma_f32_16x16x32_bf16 v[112:115], v[200:203], v[56:59], v[112:115]
    ds_read_b64_tr_b16 v[52:53], v4 offset:12288
    v_mfma_f32_16x16x32_bf16 v[116:119], v[204:207], v[56:59], v[116:119]
    ds_read_b64_tr_b16 v[54:55], v4 offset:13312
    v_mfma_f32_16x16x32_bf16 v[120:123], v[200:203], v[60:63], v[120:123]
    ds_read_b64_tr_b16 v[56:57], v5 offset:12288
    v_mfma_f32_16x16x32_bf16 v[124:127], v[204:207], v[60:63], v[124:127]
    ds_read_b64_tr_b16 v[58:59], v5 offset:13312
    s_waitcnt lgkmcnt(10)
    v_mfma_f32_16x16x32_bf16 v[96:99], v[208:211], v[32:35], v[96:99]
    ds_read_b64_tr_b16 v[60:61], v6 offset:12288
    v_mfma_f32_16x16x32_bf16 v[100:103], v[212:215], v[32:35], v[100:103]
    ds_read_b64_tr_b16 v[62:63], v6 offset:13312
    v_mfma_f32_16x16x32_bf16 v[104:107], v[208:211], v[36:39], v[104:107]
    ds_read_b64_tr_b16 v[32:33], v3 offset:16384
    ds_read_b128 v[16:19], v13 offset:4096
    v_mfma_f32_16x16x32_bf16 v[108:111], v[212:215], v[36:39], v[108:111]
    ds_read_b64_tr_b16 v[34:35], v3 offset:17408
    ds_read_b128 v[20:23], v13 offset:4608
    s_waitcnt lgkmcnt(12)
    v_mfma_f32_16x16x32_bf16 v[112:115], v[208:211], v[40:43], v[112:115]
    ds_read_b64_tr_b16 v[36:37], v4 offset:16384
    ds_read_b128 v[24:27], v13 offset:4160
    v_mfma_f32_16x16x32_bf16 v[116:119], v[212:215], v[40:43], v[116:119]
    ds_read_b64_tr_b16 v[38:39], v4 offset:17408
    ds_read_b128 v[28:31], v13 offset:4672
    v_mfma_f32_16x16x32_bf16 v[120:123], v[208:211], v[44:47], v[120:123]
    ds_read_b64_tr_b16 v[40:41], v5 offset:16384
    ds_read_b32 v8, v15 offset:512
    v_mfma_f32_16x16x32_bf16 v[124:127], v[212:215], v[44:47], v[124:127]
    ds_read_b64_tr_b16 v[42:43], v5 offset:17408
    ds_read_b32 v10, v15 offset:576
    s_waitcnt lgkmcnt(14)
    v_mfma_f32_16x16x32_bf16 v[96:99], v[216:219], v[48:51], v[96:99]
    ds_read_b64_tr_b16 v[44:45], v6 offset:16384
    ds_read_b32 v12, v15 offset:640
    v_mfma_f32_16x16x32_bf16 v[100:103], v[220:223], v[48:51], v[100:103]
    ds_read_b64_tr_b16 v[46:47], v6 offset:17408
    ds_read_b32 v14, v15 offset:704
    v_mfma_f32_16x16x32_bf16 v[104:107], v[216:219], v[52:55], v[104:107]
    ds_read_b64_tr_b16 v[48:49], v3 offset:20480
    v_mfma_f32_16x16x32_bf16 v[108:111], v[220:223], v[52:55], v[108:111]
    ds_read_b64_tr_b16 v[50:51], v3 offset:21504
    s_waitcnt lgkmcnt(14)
    v_mfma_f32_16x16x32_bf16 v[112:115], v[216:219], v[56:59], v[112:115]
    ds_read_b64_tr_b16 v[52:53], v4 offset:20480
    v_mfma_f32_16x16x32_bf16 v[116:119], v[220:223], v[56:59], v[116:119]
    ds_read_b64_tr_b16 v[54:55], v4 offset:21504
    v_mfma_f32_16x16x32_bf16 v[120:123], v[216:219], v[60:63], v[120:123]
    ds_read_b64_tr_b16 v[56:57], v5 offset:20480
    v_mfma_f32_16x16x32_bf16 v[124:127], v[220:223], v[60:63], v[124:127]
    ds_read_b64_tr_b16 v[58:59], v5 offset:21504
    s_waitcnt lgkmcnt(6)
    v_pk_fma_f32 v[100:101], v[8:9], v[24:25], v[100:101] op_sel_hi:[0,1,1] neg_lo:[1,0,0] neg_hi:[1,0,0]
    v_pk_fma_f32 v[102:103], v[8:9], v[26:27], v[102:103] op_sel_hi:[0,1,1] neg_lo:[1,0,0] neg_hi:[1,0,0]
    v_pk_fma_f32 v[108:109], v[10:11], v[24:25], v[108:109] op_sel_hi:[0,1,1] neg_lo:[1,0,0] neg_hi:[1,0,0]
    v_pk_fma_f32 v[110:111], v[10:11], v[26:27], v[110:111] op_sel_hi:[0,1,1] neg_lo:[1,0,0] neg_hi:[1,0,0]
    v_pk_mul_f32 v[100:101], v[28:29], v[100:101]
    v_pk_mul_f32 v[102:103], v[30:31], v[102:103]
    v_pk_mul_f32 v[108:109], v[28:29], v[108:109]
    v_pk_mul_f32 v[110:111], v[30:31], v[110:111]
    v_cvt_pk_bf16_f32 v74, v100, v101
    v_cvt_pk_bf16_f32 v75, v102, v103
    v_cvt_pk_bf16_f32 v78, v108, v109
    v_cvt_pk_bf16_f32 v79, v110, v111
    v_cvt_pk_bf16_f32 v100, v100, v101
    v_cvt_pk_bf16_f32 v101, v102, v103
    v_cvt_pk_bf16_f32 v102, v108, v109
    v_cvt_pk_bf16_f32 v103, v110, v111
    ds_write_b128 v7, v[100:103] offset:6144
    v_pk_fma_f32 v[116:117], v[12:13], v[24:25], v[116:117] op_sel_hi:[0,1,1] neg_lo:[1,0,0] neg_hi:[1,0,0]
    v_pk_fma_f32 v[118:119], v[12:13], v[26:27], v[118:119] op_sel_hi:[0,1,1] neg_lo:[1,0,0] neg_hi:[1,0,0]
    v_pk_fma_f32 v[124:125], v[14:15], v[24:25], v[124:125] op_sel_hi:[0,1,1] neg_lo:[1,0,0] neg_hi:[1,0,0]
    v_pk_fma_f32 v[126:127], v[14:15], v[26:27], v[126:127] op_sel_hi:[0,1,1] neg_lo:[1,0,0] neg_hi:[1,0,0]
    v_pk_mul_f32 v[116:117], v[28:29], v[116:117]
    v_pk_mul_f32 v[118:119], v[30:31], v[118:119]
    v_pk_mul_f32 v[124:125], v[28:29], v[124:125]
    v_pk_mul_f32 v[126:127], v[30:31], v[126:127]
    v_cvt_pk_bf16_f32 v90, v116, v117
    v_cvt_pk_bf16_f32 v91, v118, v119
    v_cvt_pk_bf16_f32 v94, v124, v125
    v_cvt_pk_bf16_f32 v95, v126, v127
    v_cvt_pk_bf16_f32 v116, v116, v117
    v_cvt_pk_bf16_f32 v117, v118, v119
    v_cvt_pk_bf16_f32 v118, v124, v125
    v_cvt_pk_bf16_f32 v119, v126, v127
    ds_write_b128 v7, v[116:119] offset:7168
    s_cmp_lg_u32 s16, 3
    s_cbranch_scc1 a_nh
    buffer_store_dwordx4 v[68:71], v1, s[4:7], s60 offen offset:0 sc1
    buffer_store_dwordx4 v[84:87], v1, s[4:7], s60 offen offset:1024 sc1
    buffer_store_dwordx4 v[100:103], v1, s[4:7], s60 offen offset:2048 sc1
    buffer_store_dwordx4 v[116:119], v1, s[4:7], s60 offen offset:3072 sc1
a_nh:
    v_pk_fma_f32 v[96:97], v[8:9], v[16:17], v[96:97] op_sel_hi:[0,1,1] neg_lo:[1,0,0] neg_hi:[1,0,0]
    v_pk_fma_f32 v[98:99], v[8:9], v[18:19], v[98:99] op_sel_hi:[0,1,1] neg_lo:[1,0,0] neg_hi:[1,0,0]
    v_pk_fma_f32 v[104:105], v[10:11], v[16:17], v[104:105] op_sel_hi:[0,1,1] neg_lo:[1,0,0] neg_hi:[1,0,0]
    v_pk_fma_f32 v[106:107], v[10:11], v[18:19], v[106:107] op_sel_hi:[0,1,1] neg_lo:[1,0,0] neg_hi:[1,0,0]
    v_pk_mul_f32 v[96:97], v[20:21], v[96:97]
    v_pk_mul_f32 v[98:99], v[22:23], v[98:99]
    v_pk_mul_f32 v[104:105], v[20:21], v[104:105]
    v_pk_mul_f32 v[106:107], v[22:23], v[106:107]
    v_cvt_pk_bf16_f32 v72, v96, v97
    v_cvt_pk_bf16_f32 v73, v98, v99
    v_cvt_pk_bf16_f32 v76, v104, v105
    v_cvt_pk_bf16_f32 v77, v106, v107
    v_pk_fma_f32 v[112:113], v[12:13], v[16:17], v[112:113] op_sel_hi:[0,1,1] neg_lo:[1,0,0] neg_hi:[1,0,0]
    v_pk_fma_f32 v[114:115], v[12:13], v[18:19], v[114:115] op_sel_hi:[0,1,1] neg_lo:[1,0,0] neg_hi:[1,0,0]
    v_pk_fma_f32 v[120:121], v[14:15], v[16:17], v[120:121] op_sel_hi:[0,1,1] neg_lo:[1,0,0] neg_hi:[1,0,0]
    v_pk_fma_f32 v[122:123], v[14:15], v[18:19], v[122:123] op_sel_hi:[0,1,1] neg_lo:[1,0,0] neg_hi:[1,0,0]
    v_pk_mul_f32 v[112:113], v[20:21], v[112:113]
    v_pk_mul_f32 v[114:115], v[22:23], v[114:115]
    v_pk_mul_f32 v[120:121], v[20:21], v[120:121]
    v_pk_mul_f32 v[122:123], v[22:23], v[122:123]
    v_cvt_pk_bf16_f32 v88, v112, v113
    v_cvt_pk_bf16_f32 v89, v114, v115
    v_cvt_pk_bf16_f32 v92, v120, v121
    v_cvt_pk_bf16_f32 v93, v122, v123
    v_mfma_f32_16x16x32_bf16 v[128:131], v[32:35], v[224:227], v[128:131]
    ds_read_b64_tr_b16 v[60:61], v6 offset:20480
    v_mfma_f32_16x16x32_bf16 v[132:135], v[32:35], v[228:231], v[132:135]
    ds_read_b64_tr_b16 v[62:63], v6 offset:21504
    v_mfma_f32_16x16x32_bf16 v[136:139], v[36:39], v[224:227], v[136:139]
    ds_read_b64_tr_b16 v[32:33], v3 offset:24576
    v_mfma_f32_16x16x32_bf16 v[140:143], v[36:39], v[228:231], v[140:143]
    ds_read_b64_tr_b16 v[34:35], v3 offset:25600
    v_mfma_f32_16x16x32_bf16 v[144:147], v[40:43], v[224:227], v[144:147]
    ds_read_b64_tr_b16 v[36:37], v4 offset:24576
    v_mfma_f32_16x16x32_bf16 v[148:151], v[40:43], v[228:231], v[148:151]
    ds_read_b64_tr_b16 v[38:39], v4 offset:25600
    v_mfma_f32_16x16x32_bf16 v[152:155], v[44:47], v[224:227], v[152:155]
    ds_read_b64_tr_b16 v[40:41], v5 offset:24576
    v_mfma_f32_16x16x32_bf16 v[156:159], v[44:47], v[228:231], v[156:159]
    ds_read_b64_tr_b16 v[42:43], v5 offset:25600
    s_waitcnt lgkmcnt(12)
    v_mfma_f32_16x16x32_bf16 v[128:131], v[48:51], v[232:235], v[128:131]
    ds_read_b64_tr_b16 v[44:45], v6 offset:24576
    v_mfma_f32_16x16x32_bf16 v[132:135], v[48:51], v[236:239], v[132:135]
    ds_read_b64_tr_b16 v[46:47], v6 offset:25600
    v_mfma_f32_16x16x32_bf16 v[136:139], v[52:55], v[232:235], v[136:139]
    ds_read_b64_tr_b16 v[48:49], v3 offset:28672
    v_mfma_f32_16x16x32_bf16 v[140:143], v[52:55], v[236:239], v[140:143]
    ds_read_b64_tr_b16 v[50:51], v3 offset:29696
    s_waitcnt lgkmcnt(10)
    v_mfma_f32_16x16x32_bf16 v[144:147], v[56:59], v[232:235], v[144:147]
    ds_read_b64_tr_b16 v[52:53], v4 offset:28672
    v_mfma_f32_16x16x32_bf16 v[148:151], v[56:59], v[236:239], v[148:151]
    ds_read_b64_tr_b16 v[54:55], v4 offset:29696
    v_mfma_f32_16x16x32_bf16 v[152:155], v[60:63], v[232:235], v[152:155]
    ds_read_b64_tr_b16 v[56:57], v5 offset:28672
    v_mfma_f32_16x16x32_bf16 v[156:159], v[60:63], v[236:239], v[156:159]
    ds_read_b64_tr_b16 v[58:59], v5 offset:29696
    s_waitcnt lgkmcnt(10)
    v_mfma_f32_16x16x32_bf16 v[128:131], v[32:35], v[240:243], v[128:131]
    ds_read_b64_tr_b16 v[60:61], v6 offset:28672
    v_mfma_f32_16x16x32_bf16 v[132:135], v[32:35], v[244:247], v[132:135]
    ds_read_b64_tr_b16 v[62:63], v6 offset:29696
    s_barrier
    v_mfma_f32_16x16x32_bf16 v[136:139], v[36:39], v[240:243], v[136:139]
    ds_read_b64_tr_b16 v[32:33], v3 offset:32768
    v_mfma_f32_16x16x32_bf16 v[140:143], v[36:39], v[244:247], v[140:143]
    ds_read_b64_tr_b16 v[34:35], v3 offset:33792
    s_waitcnt lgkmcnt(10)
    v_mfma_f32_16x16x32_bf16 v[144:147], v[40:43], v[240:243], v[144:147]
    ds_read_b64_tr_b16 v[36:37], v4 offset:32768
    v_mfma_f32_16x16x32_bf16 v[148:151], v[40:43], v[244:247], v[148:151]
    ds_read_b64_tr_b16 v[38:39], v4 offset:33792
    v_mfma_f32_16x16x32_bf16 v[152:155], v[44:47], v[240:243], v[152:155]
    ds_read_b64_tr_b16 v[40:41], v5 offset:32768
    v_mfma_f32_16x16x32_bf16 v[156:159], v[44:47], v[244:247], v[156:159]
    ds_read_b64_tr_b16 v[42:43], v5 offset:33792
    s_waitcnt lgkmcnt(10)
    v_mfma_f32_16x16x32_bf16 v[128:131], v[48:51], v[248:251], v[128:131]
    ds_read_b64_tr_b16 v[44:45], v6 offset:32768
    v_mfma_f32_16x16x32_bf16 v[132:135], v[48:51], v[252:255], v[132:135]
    ds_read_b64_tr_b16 v[46:47], v6 offset:33792
    v_mfma_f32_16x16x32_bf16 v[136:139], v[52:55], v[248:251], v[136:139]
    ds_read_b64_tr_b16 v[48:49], v3 offset:36864
    v_mfma_f32_16x16x32_bf16 v[140:143], v[52:55], v[252:255], v[140:143]
    ds_read_b64_tr_b16 v[50:51], v3 offset:37888
    s_waitcnt lgkmcnt(10)
    v_mfma_f32_16x16x32_bf16 v[144:147], v[56:59], v[248:251], v[144:147]
    ds_read_b64_tr_b16 v[52:53], v4 offset:36864
    v_mfma_f32_16x16x32_bf16 v[148:151], v[56:59], v[252:255], v[148:151]
    ds_read_b64_tr_b16 v[54:55], v4 offset:37888
    v_mfma_f32_16x16x32_bf16 v[152:155], v[60:63], v[248:251], v[152:155]
    ds_read_b64_tr_b16 v[56:57], v5 offset:36864
    v_mfma_f32_16x16x32_bf16 v[156:159], v[60:63], v[252:255], v[156:159]
    ds_read_b64_tr_b16 v[58:59], v5 offset:37888
    s_waitcnt lgkmcnt(10)
    v_mfma_f32_16x16x32_bf16 v[128:131], v[32:35], v[160:163], v[128:131]
    ds_read_b64_tr_b16 v[60:61], v6 offset:36864
    v_mfma_f32_16x16x32_bf16 v[132:135], v[32:35], v[164:167], v[132:135]
    ds_read_b64_tr_b16 v[62:63], v6 offset:37888
    v_mfma_f32_16x16x32_bf16 v[136:139], v[36:39], v[160:163], v[136:139]
    ds_read_b64_tr_b16 v[32:33], v3 offset:40960
    v_mfma_f32_16x16x32_bf16 v[140:143], v[36:39], v[164:167], v[140:143]
    ds_read_b64_tr_b16 v[34:35], v3 offset:41984
    s_waitcnt lgkmcnt(10)
    v_mfma_f32_16x16x32_bf16 v[144:147], v[40:43], v[160:163], v[144:147]
    ds_read_b64_tr_b16 v[36:37], v4 offset:40960
    v_mfma_f32_16x16x32_bf16 v[148:151], v[40:43], v[164:167], v[148:151]
    ds_read_b64_tr_b16 v[38:39], v4 offset:41984
    v_mfma_f32_16x16x32_bf16 v[152:155], v[44:47], v[160:163], v[152:155]
    ds_read_b64_tr_b16 v[40:41], v5 offset:40960
    v_mfma_f32_16x16x32_bf16 v[156:159], v[44:47], v[164:167], v[156:159]
    ds_read_b64_tr_b16 v[42:43], v5 offset:41984
    s_waitcnt lgkmcnt(10)
    v_mfma_f32_16x16x32_bf16 v[128:131], v[48:51], v[168:171], v[128:131]
    ds_read_b64_tr_b16 v[44:45], v6 offset:40960
    s_cmp_lg_u32 s16, 3
    s_cbranch_scc1 a_nopub
    s_waitcnt vmcnt(0)
    s_atomic_add s40, s[22:23], s61
a_nopub:
    v_mfma_f32_16x16x32_bf16 v[132:135], v[48:51], v[172:175], v[132:135]
    ds_read_b64_tr_b16 v[46:47], v6 offset:41984
    v_mfma_f32_16x16x32_bf16 v[136:139], v[52:55], v[168:171], v[136:139]
    ds_read_b64_tr_b16 v[48:49], v3 offset:45056
    v_mfma_f32_16x16x32_bf16 v[140:143], v[52:55], v[172:175], v[140:143]
    ds_read_b64_tr_b16 v[50:51], v3 offset:46080
    s_waitcnt lgkmcnt(10)
    v_mfma_f32_16x16x32_bf16 v[144:147], v[56:59], v[168:171], v[144:147]
    ds_read_b64_tr_b16 v[52:53], v4 offset:45056
    v_mfma_f32_16x16x32_bf16 v[148:151], v[56:59], v[172:175], v[148:151]
    ds_read_b64_tr_b16 v[54:55], v4 offset:46080
    v_mfma_f32_16x16x32_bf16 v[152:155], v[60:63], v[168:171], v[152:155]
    ds_read_b64_tr_b16 v[56:57], v5 offset:45056
    v_mfma_f32_16x16x32_bf16 v[156:159], v[60:63], v[172:175], v[156:159]
    ds_read_b64_tr_b16 v[58:59], v5 offset:46080
    s_waitcnt lgkmcnt(10)
    v_mfma_f32_16x16x32_bf16 v[128:131], v[32:35], v[176:179], v[128:131]
    ds_read_b64_tr_b16 v[60:61], v6 offset:45056
    v_mfma_f32_16x16x32_bf16 v[132:135], v[32:35], v[180:183], v[132:135]
    ds_read_b64_tr_b16 v[62:63], v6 offset:46080
    v_mfma_f32_16x16x32_bf16 v[136:139], v[36:39], v[176:179], v[136:139]
    ds_read_b64_tr_b16 v[32:33], v3 offset:49152
    v_mfma_f32_16x16x32_bf16 v[140:143], v[36:39], v[180:183], v[140:143]
    ds_read_b64_tr_b16 v[34:35], v3 offset:50176
    s_waitcnt lgkmcnt(10)
    v_mfma_f32_16x16x32_bf16 v[144:147], v[40:43], v[176:179], v[144:147]
    ds_read_b64_tr_b16 v[36:37], v4 offset:49152
    v_mfma_f32_16x16x32_bf16 v[148:151], v[40:43], v[180:183], v[148:151]
    ds_read_b64_tr_b16 v[38:39], v4 offset:50176
    v_mfma_f32_16x16x32_bf16 v[152:155], v[44:47], v[176:179], v[152:155]
    ds_read_b64_tr_b16 v[40:41], v5 offset:49152
    v_mfma_f32_16x16x32_bf16 v[156:159], v[44:47], v[180:183], v[156:159]
    ds_read_b64_tr_b16 v[42:43], v5 offset:50176
    s_waitcnt lgkmcnt(10)
    v_mfma_f32_16x16x32_bf16 v[128:131], v[48:51], v[184:187], v[128:131]
    ds_read_b64_tr_b16 v[44:45], v6 offset:49152
    ds_read_b32 v8, v9 offset:4096
    v_mfma_f32_16x16x32_bf16 v[132:135], v[48:51], v[188:191], v[132:135]
    ds_read_b64_tr_b16 v[46:47], v6 offset:50176
    ds_read_b32 v10, v9 offset:4608
    v_mfma_f32_16x16x32_bf16 v[136:139], v[52:55], v[184:187], v[136:139]
    ds_read_b64_tr_b16 v[48:49], v3 offset:53248
    ds_read_b32 v12, v9 offset:4160
    v_mfma_f32_16x16x32_bf16 v[140:143], v[52:55], v[188:191], v[140:143]
    ds_read_b64_tr_b16 v[50:51], v3 offset:54272
    ds_read_b32 v14, v9 offset:4672
    s_waitcnt lgkmcnt(14)
    v_mfma_f32_16x16x32_bf16 v[144:147], v[56:59], v[184:187], v[144:147]
    ds_read_b64_tr_b16 v[52:53], v4 offset:53248
    ds_read_b128 v[16:19], v11 offset:0
    v_mfma_f32_16x16x32_bf16 v[148:151], v[56:59], v[188:191], v[148:151]
    ds_read_b64_tr_b16 v[54:55], v4 offset:54272
    ds_read_b128 v[20:23], v11 offset:64
    v_mfma_f32_16x16x32_bf16 v[152:155], v[60:63], v[184:187], v[152:155]
    ds_read_b64_tr_b16 v[56:57], v5 offset:53248
    ds_read_b128 v[24:27], v11 offset:128
    v_mfma_f32_16x16x32_bf16 v[156:159], v[60:63], v[188:191], v[156:159]
    ds_read_b64_tr_b16 v[58:59], v5 offset:54272
    ds_read_b128 v[28:31], v11 offset:192
    s_waitcnt lgkmcnt(14)
    v_mfma_f32_16x16x32_bf16 v[128:131], v[32:35], v[192:195], v[128:131]
    ds_read_b64_tr_b16 v[60:61], v6 offset:53248
    v_add_u32 v13, 153600, v1
    v_mfma_f32_16x16x32_bf16 v[132:135], v[32:35], v[196:199], v[132:135]
    ds_read_b64_tr_b16 v[62:63], v6 offset:54272
    v_mfma_f32_16x16x32_bf16 v[136:139], v[36:39], v[192:195], v[136:139]
    ds_read_b64_tr_b16 v[32:33], v3 offset:57344
    v_mfma_f32_16x16x32_bf16 v[140:143], v[36:39], v[196:199], v[140:143]
    ds_read_b64_tr_b16 v[34:35], v3 offset:58368
    s_waitcnt lgkmcnt(14)
    v_mfma_f32_16x16x32_bf16 v[144:147], v[40:43], v[192:195], v[144:147]
    ds_read_b64_tr_b16 v[36:37], v4 offset:57344
    v_mfma_f32_16x16x32_bf16 v[148:151], v[40:43], v[196:199], v[148:151]
    ds_read_b64_tr_b16 v[38:39], v4 offset:58368
    v_mfma_f32_16x16x32_bf16 v[152:155], v[44:47], v[192:195], v[152:155]
    ds_read_b64_tr_b16 v[40:41], v5 offset:57344
    v_mfma_f32_16x16x32_bf16 v[156:159], v[44:47], v[196:199], v[156:159]
    ds_read_b64_tr_b16 v[42:43], v5 offset:58368
    s_waitcnt lgkmcnt(13)
    v_mfma_f32_16x16x32_bf16 v[128:131], v[48:51], v[200:203], v[128:131]
    ds_read_b64_tr_b16 v[44:45], v6 offset:57344
    s_waitcnt lgkmcnt(9)
    v_mfma_f32_16x16x32_bf16 v[132:135], v[48:51], v[204:207], v[132:135]
    ds_read_b64_tr_b16 v[46:47], v6 offset:58368
    v_mul_f32 v10, 0x3e8293ee, v10
    v_mfma_f32_16x16x32_bf16 v[136:139], v[52:55], v[200:203], v[136:139]
    ds_read_b64_tr_b16 v[48:49], v3 offset:61440
    v_mul_f32 v14, 0x3e8293ee, v14
    v_mfma_f32_16x16x32_bf16 v[140:143], v[52:55], v[204:207], v[140:143]
    ds_read_b64_tr_b16 v[50:51], v3 offset:62464
    ds_read_b128 v[120:123], v13 offset:0
    s_waitcnt lgkmcnt(11)
    v_mfma_f32_16x16x32_bf16 v[144:147], v[56:59], v[200:203], v[144:147]
    ds_read_b64_tr_b16 v[52:53], v4 offset:61440
    ds_read_b128 v[124:127], v13 offset:1024
    v_mfma_f32_16x16x32_bf16 v[148:151], v[56:59], v[204:207], v[148:151]
    ds_read_b64_tr_b16 v[54:55], v4 offset:62464
    v_mfma_f32_16x16x32_bf16 v[152:155], v[60:63], v[200:203], v[152:155]
    ds_read_b64_tr_b16 v[56:57], v5 offset:61440
    v_mfma_f32_16x16x32_bf16 v[156:159], v[60:63], v[204:207], v[156:159]
    ds_read_b64_tr_b16 v[58:59], v5 offset:62464
    s_waitcnt lgkmcnt(12)
    v_mfma_f32_16x16x32_bf16 v[128:131], v[32:35], v[208:211], v[128:131]
    ds_read_b64_tr_b16 v[60:61], v6 offset:61440
    v_mfma_f32_16x16x32_bf16 v[132:135], v[32:35], v[212:215], v[132:135]
    ds_read_b64_tr_b16 v[62:63], v6 offset:62464
    v_xor_b32 v3, 0x10000, v3
    v_xor_b32 v4, 0x10000, v4
    v_xor_b32 v5, 0x10000, v5
    v_xor_b32 v6, 0x10000, v6
    v_mfma_f32_16x16x32_bf16 v[136:139], v[36:39], v[208:211], v[136:139]
    v_mfma_f32_16x16x32_bf16 v[140:143], v[36:39], v[212:215], v[140:143]
    s_waitcnt lgkmcnt(10)
    v_mfma_f32_16x16x32_bf16 v[144:147], v[40:43], v[208:211], v[144:147]
    v_mfma_f32_16x16x32_bf16 v[148:151], v[40:43], v[212:215], v[148:151]
    v_mfma_f32_16x16x32_bf16 v[152:155], v[44:47], v[208:211], v[152:155]
    v_mfma_f32_16x16x32_bf16 v[156:159], v[44:47], v[212:215], v[156:159]
    s_waitcnt lgkmcnt(4)
    v_mfma_f32_16x16x32_bf16 v[128:131], v[48:51], v[216:219], v[128:131]
    v_mfma_f32_16x16x32_bf16 v[132:135], v[48:51], v[220:223], v[132:135]
    v_mfma_f32_16x16x32_bf16 v[136:139], v[52:55], v[216:219], v[136:139]
    v_mfma_f32_16x16x32_bf16 v[140:143], v[52:55], v[220:223], v[140:143]
    s_waitcnt lgkmcnt(0)
    v_mfma_f32_16x16x32_bf16 v[144:147], v[56:59], v[216:219], v[144:147]
    v_mfma_f32_16x16x32_bf16 v[148:151], v[56:59], v[220:223], v[148:151]
    v_mfma_f32_16x16x32_bf16 v[152:155], v[60:63], v[216:219], v[152:155]
    v_mfma_f32_16x16x32_bf16 v[156:159], v[60:63], v[220:223], v[156:159]
    s_lshl_b32 s44, s21, 22
    s_lshl_b32 s45, s38, 16
    s_add_u32 s44, s44, s45
    s_lshl_b32 s45, s18, 12
    s_add_u32 s44, s44, s45
    s_add_u32 s52, s44, 16777216
    v_pk_fma_f32 v[132:133], v[12:13], v[16:17], v[132:133] op_sel_hi:[0,1,1] neg_lo:[1,0,0] neg_hi:[1,0,0]
    v_pk_fma_f32 v[134:135], v[12:13], v[18:19], v[134:135] op_sel_hi:[0,1,1] neg_lo:[1,0,0] neg_hi:[1,0,0]
    v_pk_fma_f32 v[140:141], v[12:13], v[20:21], v[140:141] op_sel_hi:[0,1,1] neg_lo:[1,0,0] neg_hi:[1,0,0]
    v_pk_fma_f32 v[142:143], v[12:13], v[22:23], v[142:143] op_sel_hi:[0,1,1] neg_lo:[1,0,0] neg_hi:[1,0,0]
    v_pk_fma_f32 v[148:149], v[12:13], v[24:25], v[148:149] op_sel_hi:[0,1,1] neg_lo:[1,0,0] neg_hi:[1,0,0]
    v_pk_fma_f32 v[150:151], v[12:13], v[26:27], v[150:151] op_sel_hi:[0,1,1] neg_lo:[1,0,0] neg_hi:[1,0,0]
    v_pk_fma_f32 v[156:157], v[12:13], v[28:29], v[156:157] op_sel_hi:[0,1,1] neg_lo:[1,0,0] neg_hi:[1,0,0]
    v_pk_fma_f32 v[158:159], v[12:13], v[30:31], v[158:159] op_sel_hi:[0,1,1] neg_lo:[1,0,0] neg_hi:[1,0,0]
    v_pk_mul_f32 v[132:133], v[14:15], v[132:133] op_sel_hi:[0,1]
    v_pk_mul_f32 v[134:135], v[14:15], v[134:135] op_sel_hi:[0,1]
    v_pk_mul_f32 v[140:141], v[14:15], v[140:141] op_sel_hi:[0,1]
    v_pk_mul_f32 v[142:143], v[14:15], v[142:143] op_sel_hi:[0,1]
    v_pk_mul_f32 v[148:149], v[14:15], v[148:149] op_sel_hi:[0,1]
    v_pk_mul_f32 v[150:151], v[14:15], v[150:151] op_sel_hi:[0,1]
    v_pk_mul_f32 v[156:157], v[14:15], v[156:157] op_sel_hi:[0,1]
    v_pk_mul_f32 v[158:159], v[14:15], v[158:159] op_sel_hi:[0,1]
    v_cvt_pk_bf16_f32 v132, v132, v133
    v_cvt_pk_bf16_f32 v133, v134, v135
    v_cvt_pk_bf16_f32 v134, v140, v141
    v_cvt_pk_bf16_f32 v135, v142, v143
    v_cvt_pk_bf16_f32 v148, v148, v149
    v_cvt_pk_bf16_f32 v149, v150, v151
    v_cvt_pk_bf16_f32 v150, v156, v157
    v_cvt_pk_bf16_f32 v151, v158, v159
    v_mfma_f32_16x16x32_bf16 v[172:175], v[68:71], v[132:135], v[120:123]
    v_mfma_f32_16x16x32_bf16 v[168:171], v[64:67], v[132:135], v[124:127]
    v_mfma_f32_16x16x32_bf16 v[188:191], v[84:87], v[148:151], v[120:123]
    v_mfma_f32_16x16x32_bf16 v[184:187], v[80:83], v[148:151], v[124:127]
    v_pk_fma_f32 v[128:129], v[8:9], v[16:17], v[128:129] op_sel_hi:[0,1,1] neg_lo:[1,0,0] neg_hi:[1,0,0]
    v_pk_fma_f32 v[130:131], v[8:9], v[18:19], v[130:131] op_sel_hi:[0,1,1] neg_lo:[1,0,0] neg_hi:[1,0,0]
    v_pk_fma_f32 v[136:137], v[8:9], v[20:21], v[136:137] op_sel_hi:[0,1,1] neg_lo:[1,0,0] neg_hi:[1,0,0]
    v_pk_fma_f32 v[138:139], v[8:9], v[22:23], v[138:139] op_sel_hi:[0,1,1] neg_lo:[1,0,0] neg_hi:[1,0,0]
    v_pk_fma_f32 v[144:145], v[8:9], v[24:25], v[144:145] op_sel_hi:[0,1,1] neg_lo:[1,0,0] neg_hi:[1,0,0]
    v_pk_fma_f32 v[146:147], v[8:9], v[26:27], v[146:147] op_sel_hi:[0,1,1] neg_lo:[1,0,0] neg_hi:[1,0,0]
    v_pk_fma_f32 v[152:153], v[8:9], v[28:29], v[152:153] op_sel_hi:[0,1,1] neg_lo:[1,0,0] neg_hi:[1,0,0]
    v_pk_fma_f32 v[154:155], v[8:9], v[30:31], v[154:155] op_sel_hi:[0,1,1] neg_lo:[1,0,0] neg_hi:[1,0,0]
    v_pk_mul_f32 v[128:129], v[10:11], v[128:129] op_sel_hi:[0,1]
    v_pk_mul_f32 v[130:131], v[10:11], v[130:131] op_sel_hi:[0,1]
    v_pk_mul_f32 v[136:137], v[10:11], v[136:137] op_sel_hi:[0,1]
    v_pk_mul_f32 v[138:139], v[10:11], v[138:139] op_sel_hi:[0,1]
    v_pk_mul_f32 v[144:145], v[10:11], v[144:145] op_sel_hi:[0,1]
    v_pk_mul_f32 v[146:147], v[10:11], v[146:147] op_sel_hi:[0,1]
    v_pk_mul_f32 v[152:153], v[10:11], v[152:153] op_sel_hi:[0,1]
    v_pk_mul_f32 v[154:155], v[10:11], v[154:155] op_sel_hi:[0,1]
    v_cvt_pk_bf16_f32 v128, v128, v129
    v_cvt_pk_bf16_f32 v129, v130, v131
    v_cvt_pk_bf16_f32 v130, v136, v137
    v_cvt_pk_bf16_f32 v131, v138, v139
    v_cvt_pk_bf16_f32 v144, v144, v145
    v_cvt_pk_bf16_f32 v145, v146, v147
    v_cvt_pk_bf16_f32 v146, v152, v153
    v_cvt_pk_bf16_f32 v147, v154, v155
    v_mfma_f32_16x16x32_bf16 v[164:167], v[64:67], v[128:131], v[120:123]
    s_nop 0
    v_mfma_f32_16x16x32_bf16 v[180:183], v[80:83], v[144:147], v[120:123]
    v_mov_b32 v232, 0x3f803f80
    v_mov_b32 v233, 0x3f803f80
    v_mov_b32 v234, 0x3f803f80
    v_mov_b32 v235, 0x3f803f80
    v_exp_f32 v172, v172
    v_exp_f32 v173, v173
    v_exp_f32 v174, v174
    v_exp_f32 v175, v175
    v_exp_f32 v188, v188
    v_exp_f32 v189, v189
    v_exp_f32 v190, v190
    v_exp_f32 v191, v191
    s_mov_b32 s46, 1006632960
a_exp1:
    v_exp_f32 v168, v168
    v_exp_f32 v169, v169
    v_exp_f32 v170, v170
    v_exp_f32 v171, v171
    v_exp_f32 v184, v184
    v_exp_f32 v185, v185
    v_exp_f32 v186, v186
    v_exp_f32 v187, v187
    v_cvt_pk_bf16_f32 v200, v168, v169
    v_cvt_pk_bf16_f32 v201, v170, v171
    v_cvt_pk_bf16_f32 v202, v172, v173
    v_cvt_pk_bf16_f32 v203, v174, v175
    v_cvt_pk_bf16_f32 v204, v184, v185
    v_cvt_pk_bf16_f32 v205, v186, v187
    v_cvt_pk_bf16_f32 v206, v188, v189
    v_cvt_pk_bf16_f32 v207, v190, v191
    v_mfma_f32_16x16x32_bf16 v[16:19], v[232:235], v[200:203], 0
    s_nop 0
    v_mfma_f32_16x16x32_bf16 v[20:23], v[232:235], v[204:207], 0
    v_mfma_f32_16x16x32_bf16 v[40:43], v[72:75], v[200:203], 0
    v_mfma_f32_16x16x32_bf16 v[44:47], v[76:79], v[200:203], 0
    v_mfma_f32_16x16x32_bf16 v[56:59], v[88:91], v[204:207], 0
    v_mfma_f32_16x16x32_bf16 v[60:63], v[92:95], v[204:207], 0
    v_mov_b32 v218, v72
    v_mov_b32 v219, v73
    v_mov_b32 v222, v76
    v_mov_b32 v223, v77
    v_mov_b32 v226, v88
    v_mov_b32 v227, v89
    v_mov_b32 v230, v92
    v_mov_b32 v231, v93
    v_subrev_u32 v18, 0x21800000, v16
    v_subrev_u32 v22, 0x21800000, v20
    v_max_u32 v18, v18, v22
    v_cmp_le_u32 vcc, s46, v18
    v_rcp_f32 v16, v16
    v_rcp_f32 v20, v20
    s_cbranch_vccnz a_slow1
a_fin1:
    v_pk_mul_f32 v[40:41], v[16:17], v[40:41] op_sel_hi:[0,1]
    v_pk_mul_f32 v[42:43], v[16:17], v[42:43] op_sel_hi:[0,1]
    v_pk_mul_f32 v[44:45], v[16:17], v[44:45] op_sel_hi:[0,1]
    v_pk_mul_f32 v[46:47], v[16:17], v[46:47] op_sel_hi:[0,1]
    v_pk_mul_f32 v[56:57], v[20:21], v[56:57] op_sel_hi:[0,1]
    v_pk_mul_f32 v[58:59], v[20:21], v[58:59] op_sel_hi:[0,1]
    v_pk_mul_f32 v[60:61], v[20:21], v[60:61] op_sel_hi:[0,1]
    v_pk_mul_f32 v[62:63], v[20:21], v[62:63] op_sel_hi:[0,1]
    v_cvt_pk_bf16_f32 v40, v40, v41
    v_cvt_pk_bf16_f32 v41, v42, v43
    v_cvt_pk_bf16_f32 v42, v44, v45
    v_cvt_pk_bf16_f32 v43, v46, v47
    v_cvt_pk_bf16_f32 v56, v56, v57
    v_cvt_pk_bf16_f32 v57, v58, v59
    v_cvt_pk_bf16_f32 v58, v60, v61
    v_cvt_pk_bf16_f32 v59, v62, v63
    v_permlane32_swap_b32 v40, v42
    v_permlane32_swap_b32 v41, v43
    buffer_store_dwordx4 v[40:43], v2, s[4:7], s52 offen offset:256 sc1
    v_permlane32_swap_b32 v56, v58
    v_permlane32_swap_b32 v57, v59
    buffer_store_dwordx4 v[56:59], v2, s[4:7], s52 offen offset:2304 sc1
    s_cmp_lg_u32 s38, 0
    s_cbranch_scc1 a_hasprev
    v_mov_b32 v124, 0xf149f2ca
    v_mov_b32 v125, 0xf149f2ca
    v_mov_b32 v126, 0xf149f2ca
    v_mov_b32 v127, 0xf149f2ca
a_hasprev:
    s_waitcnt lgkmcnt(0)
    s_barrier
    ds_read_b128 v[192:195], v7 offset:0
    ds_read_b128 v[196:199], v7 offset:1024
    ds_read_b64 v[216:217], v7 offset:2048
    ds_read_b64 v[220:221], v7 offset:2056
    ds_read_b64 v[224:225], v7 offset:3072
    ds_read_b64 v[228:229], v7 offset:3080
    s_waitcnt lgkmcnt(4)
    v_mfma_f32_16x16x32_bf16 v[160:163], v[192:195], v[128:131], v[124:127]
    v_mfma_f32_16x16x32_bf16 v[176:179], v[196:199], v[144:147], v[124:127]
    v_exp_f32 v164, v164
    v_exp_f32 v165, v165
    v_exp_f32 v166, v166
    v_exp_f32 v167, v167
    v_exp_f32 v180, v180
    v_exp_f32 v181, v181
    v_exp_f32 v182, v182
    v_exp_f32 v183, v183
    s_waitcnt lgkmcnt(0)
    s_mov_b32 s46, 1006632960
a_exp0:
    v_exp_f32 v160, v160
    v_exp_f32 v161, v161
    v_exp_f32 v162, v162
    v_exp_f32 v163, v163
    v_exp_f32 v176, v176
    v_exp_f32 v177, v177
    v_exp_f32 v178, v178
    v_exp_f32 v179, v179
    v_cvt_pk_bf16_f32 v200, v160, v161
    v_cvt_pk_bf16_f32 v201, v162, v163
    v_cvt_pk_bf16_f32 v202, v164, v165
    v_cvt_pk_bf16_f32 v203, v166, v167
    v_cvt_pk_bf16_f32 v204, v176, v177
    v_cvt_pk_bf16_f32 v205, v178, v179
    v_cvt_pk_bf16_f32 v206, v180, v181
    v_cvt_pk_bf16_f32 v207, v182, v183
    v_mfma_f32_16x16x32_bf16 v[16:19], v[232:235], v[200:203], 0
    s_nop 0
    v_mfma_f32_16x16x32_bf16 v[20:23], v[232:235], v[204:207], 0
    v_mfma_f32_16x16x32_bf16 v[32:35], v[216:219], v[200:203], 0
    v_mfma_f32_16x16x32_bf16 v[36:39], v[220:223], v[200:203], 0
    v_mfma_f32_16x16x32_bf16 v[48:51], v[224:227], v[204:207], 0
    v_mfma_f32_16x16x32_bf16 v[52:55], v[228:231], v[204:207], 0
    s_nop 1
    v_subrev_u32 v18, 0x21800000, v16
    s_nop 0
    v_subrev_u32 v22, 0x21800000, v20
    v_max_u32 v18, v18, v22
    v_cmp_le_u32 vcc, s46, v18
    v_rcp_f32 v16, v16
    v_rcp_f32 v20, v20
    s_cbranch_vccnz a_slow0
a_fin0:
    v_pk_mul_f32 v[32:33], v[16:17], v[32:33] op_sel_hi:[0,1]
    v_pk_mul_f32 v[34:35], v[16:17], v[34:35] op_sel_hi:[0,1]
    v_pk_mul_f32 v[36:37], v[16:17], v[36:37] op_sel_hi:[0,1]
    v_pk_mul_f32 v[38:39], v[16:17], v[38:39] op_sel_hi:[0,1]
    v_pk_mul_f32 v[48:49], v[20:21], v[48:49] op_sel_hi:[0,1]
    v_pk_mul_f32 v[50:51], v[20:21], v[50:51] op_sel_hi:[0,1]
    v_pk_mul_f32 v[52:53], v[20:21], v[52:53] op_sel_hi:[0,1]
    v_pk_mul_f32 v[54:55], v[20:21], v[54:55] op_sel_hi:[0,1]
    v_cvt_pk_bf16_f32 v32, v32, v33
    v_cvt_pk_bf16_f32 v33, v34, v35
    v_cvt_pk_bf16_f32 v34, v36, v37
    v_cvt_pk_bf16_f32 v35, v38, v39
    v_cvt_pk_bf16_f32 v48, v48, v49
    v_cvt_pk_bf16_f32 v49, v50, v51
    v_cvt_pk_bf16_f32 v50, v52, v53
    v_cvt_pk_bf16_f32 v51, v54, v55
    v_permlane32_swap_b32 v32, v34
    v_permlane32_swap_b32 v33, v35
    buffer_store_dwordx4 v[32:35], v2, s[4:7], s52 offen offset:0 sc1
    v_permlane32_swap_b32 v48, v50
    v_permlane32_swap_b32 v49, v51
    buffer_store_dwordx4 v[48:51], v2, s[4:7], s52 offen offset:2048 sc1
    s_lshl_b32 s44, s21, 22
    s_lshl_b32 s45, s38, 16
    s_add_u32 s41, s44, s45
    s_lshl_b32 s45, s18, 12
    s_add_u32 s43, s41, s45
    s_and_b32 s45, s45, 0
    s_add_u32 s41, s41, s45
    s_add_u32 s41, s41, 16777216
    buffer_load_dwordx4 v[224:227], v2, s[4:7], s43 offen offset:0 sc1
    buffer_load_dwordx4 v[228:231], v2, s[4:7], s43 offen offset:256 sc1
    buffer_load_dwordx4 v[232:235], v2, s[4:7], s43 offen offset:2048 sc1
    buffer_load_dwordx4 v[236:239], v2, s[4:7], s43 offen offset:2304 sc1
    s_barrier
    s_lshl_b32 s46, s21, 14
    s_lshl_b32 s67, s38, 8
    s_add_u32 s46, s46, s67
    s_add_u32 s46, s46, 86144
    s_lshl_b32 s47, s21, 14
    s_lshl_b32 s67, s38, 8
    s_add_u32 s47, s47, s67
    s_add_u32 s47, s47, 86144
    s_waitcnt vmcnt(4)
    s_atomic_add s40, s[22:23], s46
    s_mov_b32 s66, 0x10000
c_o_poll:
    s_mov_b32 s68, 0
    s_atomic_add s68, s[22:23], s47 offset:0 glc
    s_sub_u32 s66, s66, 1
    s_cselect_b32 s67, 16, 0
    s_waitcnt lgkmcnt(0)
    s_max_u32 s68, s68, s67
    s_cmp_lt_u32 s68, 16
    s_cbranch_scc1 c_o_poll
c_o_ok:
    s_branch c_wo
a_slow1:
    s_cmp_eq_u32 s46, 0
    s_cbranch_scc1 a_fin1
    s_mov_b32 s46, 0
    v_mfma_f32_16x16x32_bf16 v[172:175], v[68:71], v[132:135], v[120:123]
    v_mfma_f32_16x16x32_bf16 v[168:171], v[64:67], v[132:135], v[124:127]
    v_mfma_f32_16x16x32_bf16 v[188:191], v[84:87], v[148:151], v[120:123]
    v_mfma_f32_16x16x32_bf16 v[184:187], v[80:83], v[148:151], v[124:127]
    s_nop 5
    v_max3_f32 v24, v168, v169, v170
    v_max3_f32 v24, v24, v171, v172
    v_max3_f32 v24, v24, v173, v174
    v_max_f32 v24, v24, v175
    v_max3_f32 v26, v184, v185, v186
    v_max3_f32 v26, v26, v187, v188
    v_max3_f32 v26, v26, v189, v190
    v_max_f32 v26, v26, v191
    v_mov_b32 v25, v24
    v_mov_b32 v27, v26
    s_nop 0
    v_permlane32_swap_b32 v24, v25
    v_permlane32_swap_b32 v26, v27
    v_max_f32 v24, v24, v25
    v_max_f32 v26, v26, v27
    v_mov_b32 v25, v24
    v_mov_b32 v27, v26
    s_nop 0
    v_permlane16_swap_b32 v24, v25
    v_permlane16_swap_b32 v26, v27
    v_max_f32 v24, v24, v25
    v_max_f32 v26, v26, v27
    v_sub_f32 v168, v168, v24
    v_sub_f32 v169, v169, v24
    v_sub_f32 v170, v170, v24
    v_sub_f32 v171, v171, v24
    v_sub_f32 v172, v172, v24
    v_sub_f32 v173, v173, v24
    v_sub_f32 v174, v174, v24
    v_sub_f32 v175, v175, v24
    v_sub_f32 v184, v184, v26
    v_sub_f32 v185, v185, v26
    v_sub_f32 v186, v186, v26
    v_sub_f32 v187, v187, v26
    v_sub_f32 v188, v188, v26
    v_sub_f32 v189, v189, v26
    v_sub_f32 v190, v190, v26
    v_sub_f32 v191, v191, v26
    v_exp_f32 v172, v172
    v_exp_f32 v173, v173
    v_exp_f32 v174, v174
    v_exp_f32 v175, v175
    v_exp_f32 v188, v188
    v_exp_f32 v189, v189
    v_exp_f32 v190, v190
    v_exp_f32 v191, v191
    s_branch a_exp1
a_slow0:
    s_cmp_eq_u32 s46, 0
    s_cbranch_scc1 a_fin0
    s_mov_b32 s46, 0
    v_mfma_f32_16x16x32_bf16 v[164:167], v[64:67], v[128:131], v[120:123]
    v_mfma_f32_16x16x32_bf16 v[160:163], v[192:195], v[128:131], v[124:127]
    v_mfma_f32_16x16x32_bf16 v[180:183], v[80:83], v[144:147], v[120:123]
    v_mfma_f32_16x16x32_bf16 v[176:179], v[196:199], v[144:147], v[124:127]
    s_nop 5
    v_max3_f32 v24, v160, v161, v162
    v_max3_f32 v24, v24, v163, v164
    v_max3_f32 v24, v24, v165, v166
    v_max_f32 v24, v24, v167
    v_max3_f32 v26, v176, v177, v178
    v_max3_f32 v26, v26, v179, v180
    v_max3_f32 v26, v26, v181, v182
    v_max_f32 v26, v26, v183
    v_mov_b32 v25, v24
    v_mov_b32 v27, v26
    s_nop 0
    v_permlane32_swap_b32 v24, v25
    v_permlane32_swap_b32 v26, v27
    v_max_f32 v24, v24, v25
    v_max_f32 v26, v26, v27
    v_mov_b32 v25, v24
    v_mov_b32 v27, v26
    s_nop 0
    v_permlane16_swap_b32 v24, v25
    v_permlane16_swap_b32 v26, v27
    v_max_f32 v24, v24, v25
    v_max_f32 v26, v26, v27
    v_sub_f32 v160, v160, v24
    v_sub_f32 v161, v161, v24
    v_sub_f32 v162, v162, v24
    v_sub_f32 v163, v163, v24
    v_sub_f32 v164, v164, v24
    v_sub_f32 v165, v165, v24
    v_sub_f32 v166, v166, v24
    v_sub_f32 v167, v167, v24
    v_sub_f32 v176, v176, v26
    v_sub_f32 v177, v177, v26
    v_sub_f32 v178, v178, v26
    v_sub_f32 v179, v179, v26
    v_sub_f32 v180, v180, v26
    v_sub_f32 v181, v181, v26
    v_sub_f32 v182, v182, v26
    v_sub_f32 v183, v183, v26
    v_exp_f32 v164, v164
    v_exp_f32 v165, v165
    v_exp_f32 v166, v166
    v_exp_f32 v167, v167
    v_exp_f32 v180, v180
    v_exp_f32 v181, v181
    v_exp_f32 v182, v182
    v_exp_f32 v183, v183
    s_branch a_exp0
c_B:
    s_waitcnt lgkmcnt(6)
    v_pk_fma_f32 v[64:65], v[8:9], v[16:17], v[64:65] op_sel_hi:[0,1,1] neg_lo:[1,0,0] neg_hi:[1,0,0]
    v_pk_fma_f32 v[66:67], v[8:9], v[18:19], v[66:67] op_sel_hi:[0,1,1] neg_lo:[1,0,0] neg_hi:[1,0,0]
    v_pk_fma_f32 v[72:73], v[8:9], v[20:21], v[72:73] op_sel_hi:[0,1,1] neg_lo:[1,0,0] neg_hi:[1,0,0]
    v_pk_fma_f32 v[74:75], v[8:9], v[22:23], v[74:75] op_sel_hi:[0,1,1] neg_lo:[1,0,0] neg_hi:[1,0,0]
    v_pk_mul_f32 v[64:65], v[10:11], v[64:65] op_sel_hi:[0,1]
    v_pk_mul_f32 v[66:67], v[10:11], v[66:67] op_sel_hi:[0,1]
    v_pk_mul_f32 v[72:73], v[10:11], v[72:73] op_sel_hi:[0,1]
    v_pk_mul_f32 v[74:75], v[10:11], v[74:75] op_sel_hi:[0,1]
    v_cvt_pk_bf16_f32 v64, v64, v65
    v_cvt_pk_bf16_f32 v65, v66, v67
    v_cvt_pk_bf16_f32 v66, v72, v73
    v_cvt_pk_bf16_f32 v67, v74, v75
    s_add_u32 s55, s52, 0
    buffer_store_dwordx4 v[64:67], v2, s[4:7], s55 offen offset:0 sc1
    v_pk_fma_f32 v[68:69], v[12:13], v[16:17], v[68:69] op_sel_hi:[0,1,1] neg_lo:[1,0,0] neg_hi:[1,0,0]
    v_pk_fma_f32 v[70:71], v[12:13], v[18:19], v[70:71] op_sel_hi:[0,1,1] neg_lo:[1,0,0] neg_hi:[1,0,0]
    v_pk_fma_f32 v[76:77], v[12:13], v[20:21], v[76:77] op_sel_hi:[0,1,1] neg_lo:[1,0,0] neg_hi:[1,0,0]
    v_pk_fma_f32 v[78:79], v[12:13], v[22:23], v[78:79] op_sel_hi:[0,1,1] neg_lo:[1,0,0] neg_hi:[1,0,0]
    v_pk_mul_f32 v[68:69], v[14:15], v[68:69] op_sel_hi:[0,1]
    v_pk_mul_f32 v[70:71], v[14:15], v[70:71] op_sel_hi:[0,1]
    v_pk_mul_f32 v[76:77], v[14:15], v[76:77] op_sel_hi:[0,1]
    v_pk_mul_f32 v[78:79], v[14:15], v[78:79] op_sel_hi:[0,1]
    v_cvt_pk_bf16_f32 v68, v68, v69
    v_cvt_pk_bf16_f32 v69, v70, v71
    v_cvt_pk_bf16_f32 v70, v76, v77
    v_cvt_pk_bf16_f32 v71, v78, v79
    buffer_store_dwordx4 v[68:71], v2, s[4:7], s55 offen offset:256 sc1
    v_pk_fma_f32 v[80:81], v[8:9], v[24:25], v[80:81] op_sel_hi:[0,1,1] neg_lo:[1,0,0] neg_hi:[1,0,0]
    v_pk_fma_f32 v[82:83], v[8:9], v[26:27], v[82:83] op_sel_hi:[0,1,1] neg_lo:[1,0,0] neg_hi:[1,0,0]
    v_pk_fma_f32 v[88:89], v[8:9], v[28:29], v[88:89] op_sel_hi:[0,1,1] neg_lo:[1,0,0] neg_hi:[1,0,0]
    v_pk_fma_f32 v[90:91], v[8:9], v[30:31], v[90:91] op_sel_hi:[0,1,1] neg_lo:[1,0,0] neg_hi:[1,0,0]
    v_pk_mul_f32 v[80:81], v[10:11], v[80:81] op_sel_hi:[0,1]
    v_pk_mul_f32 v[82:83], v[10:11], v[82:83] op_sel_hi:[0,1]
    v_pk_mul_f32 v[88:89], v[10:11], v[88:89] op_sel_hi:[0,1]
    v_pk_mul_f32 v[90:91], v[10:11], v[90:91] op_sel_hi:[0,1]
    v_cvt_pk_bf16_f32 v80, v80, v81
    v_cvt_pk_bf16_f32 v81, v82, v83
    v_cvt_pk_bf16_f32 v82, v88, v89
    v_cvt_pk_bf16_f32 v83, v90, v91
    s_add_u32 s55, s52, 131072
    buffer_store_dwordx4 v[80:83], v2, s[4:7], s55 offen offset:0 sc1
    v_pk_fma_f32 v[84:85], v[12:13], v[24:25], v[84:85] op_sel_hi:[0,1,1] neg_lo:[1,0,0] neg_hi:[1,0,0]
    v_pk_fma_f32 v[86:87], v[12:13], v[26:27], v[86:87] op_sel_hi:[0,1,1] neg_lo:[1,0,0] neg_hi:[1,0,0]
    v_pk_fma_f32 v[92:93], v[12:13], v[28:29], v[92:93] op_sel_hi:[0,1,1] neg_lo:[1,0,0] neg_hi:[1,0,0]
    v_pk_fma_f32 v[94:95], v[12:13], v[30:31], v[94:95] op_sel_hi:[0,1,1] neg_lo:[1,0,0] neg_hi:[1,0,0]
    v_pk_mul_f32 v[84:85], v[14:15], v[84:85] op_sel_hi:[0,1]
    v_pk_mul_f32 v[86:87], v[14:15], v[86:87] op_sel_hi:[0,1]
    v_pk_mul_f32 v[92:93], v[14:15], v[92:93] op_sel_hi:[0,1]
    v_pk_mul_f32 v[94:95], v[14:15], v[94:95] op_sel_hi:[0,1]
    v_cvt_pk_bf16_f32 v84, v84, v85
    v_cvt_pk_bf16_f32 v85, v86, v87
    v_cvt_pk_bf16_f32 v86, v92, v93
    v_cvt_pk_bf16_f32 v87, v94, v95
    buffer_store_dwordx4 v[84:87], v2, s[4:7], s55 offen offset:256 sc1
    v_mfma_f32_16x16x32_bf16 v[96:99], v[160:163], v[32:35], v[96:99]
    ds_read_b64_tr_b16 v[60:61], v6 offset:53248
    v_mfma_f32_16x16x32_bf16 v[100:103], v[164:167], v[32:35], v[100:103]
    ds_read_b64_tr_b16 v[62:63], v6 offset:54272
    v_mfma_f32_16x16x32_bf16 v[104:107], v[160:163], v[36:39], v[104:107]
    ds_read_b64_tr_b16 v[32:33], v3 offset:57344
    v_mfma_f32_16x16x32_bf16 v[108:111], v[164:167], v[36:39], v[108:111]
    ds_read_b64_tr_b16 v[34:35], v3 offset:58368
    v_mfma_f32_16x16x32_bf16 v[112:115], v[160:163], v[40:43], v[112:115]
    ds_read_b64_tr_b16 v[36:37], v4 offset:57344
    v_mfma_f32_16x16x32_bf16 v[116:119], v[164:167], v[40:43], v[116:119]
    ds_read_b64_tr_b16 v[38:39], v4 offset:58368
    v_mfma_f32_16x16x32_bf16 v[120:123], v[160:163], v[44:47], v[120:123]
    ds_read_b64_tr_b16 v[40:41], v5 offset:57344
    v_mfma_f32_16x16x32_bf16 v[124:127], v[164:167], v[44:47], v[124:127]
    ds_read_b64_tr_b16 v[42:43], v5 offset:58368
    s_waitcnt lgkmcnt(10)
    v_mfma_f32_16x16x32_bf16 v[96:99], v[168:171], v[48:51], v[96:99]
    ds_read_b64_tr_b16 v[44:45], v6 offset:57344
    v_mfma_f32_16x16x32_bf16 v[100:103], v[172:175], v[48:51], v[100:103]
    ds_read_b64_tr_b16 v[46:47], v6 offset:58368
    v_mfma_f32_16x16x32_bf16 v[104:107], v[168:171], v[52:55], v[104:107]
    ds_read_b64_tr_b16 v[48:49], v3 offset:61440
    v_mfma_f32_16x16x32_bf16 v[108:111], v[172:175], v[52:55], v[108:111]
    ds_read_b64_tr_b16 v[50:51], v3 offset:62464
    s_waitcnt lgkmcnt(10)
    v_mfma_f32_16x16x32_bf16 v[112:115], v[168:171], v[56:59], v[112:115]
    ds_read_b64_tr_b16 v[52:53], v4 offset:61440
    v_mfma_f32_16x16x32_bf16 v[116:119], v[172:175], v[56:59], v[116:119]
    ds_read_b64_tr_b16 v[54:55], v4 offset:62464
    v_mfma_f32_16x16x32_bf16 v[120:123], v[168:171], v[60:63], v[120:123]
    ds_read_b64_tr_b16 v[56:57], v5 offset:61440
    v_mfma_f32_16x16x32_bf16 v[124:127], v[172:175], v[60:63], v[124:127]
    ds_read_b64_tr_b16 v[58:59], v5 offset:62464
    s_waitcnt lgkmcnt(10)
    v_mfma_f32_16x16x32_bf16 v[96:99], v[176:179], v[32:35], v[96:99]
    ds_read_b64_tr_b16 v[60:61], v6 offset:61440
    v_mfma_f32_16x16x32_bf16 v[100:103], v[180:183], v[32:35], v[100:103]
    ds_read_b64_tr_b16 v[62:63], v6 offset:62464
    s_barrier
    v_xor_b32 v3, 0x10000, v3
    v_xor_b32 v4, 0x10000, v4
    v_xor_b32 v5, 0x10000, v5
    v_xor_b32 v6, 0x10000, v6
    v_mfma_f32_16x16x32_bf16 v[104:107], v[176:179], v[36:39], v[104:107]
    ds_read_b64_tr_b16 v[32:33], v3 offset:0
    v_mfma_f32_16x16x32_bf16 v[108:111], v[180:183], v[36:39], v[108:111]
    ds_read_b64_tr_b16 v[34:35], v3 offset:1024
    s_waitcnt lgkmcnt(10)
    v_mfma_f32_16x16x32_bf16 v[112:115], v[176:179], v[40:43], v[112:115]
    ds_read_b64_tr_b16 v[36:37], v4 offset:0
    v_mfma_f32_16x16x32_bf16 v[116:119], v[180:183], v[40:43], v[116:119]
    ds_read_b64_tr_b16 v[38:39], v4 offset:1024
    v_mfma_f32_16x16x32_bf16 v[120:123], v[176:179], v[44:47], v[120:123]
    ds_read_b64_tr_b16 v[40:41], v5 offset:0
    v_mfma_f32_16x16x32_bf16 v[124:127], v[180:183], v[44:47], v[124:127]
    ds_read_b64_tr_b16 v[42:43], v5 offset:1024
    s_waitcnt lgkmcnt(10)
    v_mfma_f32_16x16x32_bf16 v[96:99], v[184:187], v[48:51], v[96:99]
    ds_read_b64_tr_b16 v[44:45], v6 offset:0
    v_mfma_f32_16x16x32_bf16 v[100:103], v[188:191], v[48:51], v[100:103]
    ds_read_b64_tr_b16 v[46:47], v6 offset:1024
    v_mfma_f32_16x16x32_bf16 v[104:107], v[184:187], v[52:55], v[104:107]
    ds_read_b64_tr_b16 v[48:49], v3 offset:4096
    v_mfma_f32_16x16x32_bf16 v[108:111], v[188:191], v[52:55], v[108:111]
    ds_read_b64_tr_b16 v[50:51], v3 offset:5120
    s_waitcnt lgkmcnt(10)
    v_mfma_f32_16x16x32_bf16 v[112:115], v[184:187], v[56:59], v[112:115]
    ds_read_b64_tr_b16 v[52:53], v4 offset:4096
    v_mfma_f32_16x16x32_bf16 v[116:119], v[188:191], v[56:59], v[116:119]
    ds_read_b64_tr_b16 v[54:55], v4 offset:5120
    v_mfma_f32_16x16x32_bf16 v[120:123], v[184:187], v[60:63], v[120:123]
    ds_read_b64_tr_b16 v[56:57], v5 offset:4096
    v_mfma_f32_16x16x32_bf16 v[124:127], v[188:191], v[60:63], v[124:127]
    ds_read_b64_tr_b16 v[58:59], v5 offset:5120
    s_waitcnt lgkmcnt(10)
    v_mfma_f32_16x16x32_bf16 v[96:99], v[192:195], v[32:35], v[96:99]
    ds_read_b64_tr_b16 v[60:61], v6 offset:4096
    v_mfma_f32_16x16x32_bf16 v[100:103], v[196:199], v[32:35], v[100:103]
    ds_read_b64_tr_b16 v[62:63], v6 offset:5120
    v_mfma_f32_16x16x32_bf16 v[104:107], v[192:195], v[36:39], v[104:107]
    ds_read_b64_tr_b16 v[32:33], v3 offset:8192
    v_mfma_f32_16x16x32_bf16 v[108:111], v[196:199], v[36:39], v[108:111]
    ds_read_b64_tr_b16 v[34:35], v3 offset:9216
    s_waitcnt lgkmcnt(10)
    v_mfma_f32_16x16x32_bf16 v[112:115], v[192:195], v[40:43], v[112:115]
    ds_read_b64_tr_b16 v[36:37], v4 offset:8192
    v_mfma_f32_16x16x32_bf16 v[116:119], v[196:199], v[40:43], v[116:119]
    ds_read_b64_tr_b16 v[38:39], v4 offset:9216
    v_mfma_f32_16x16x32_bf16 v[120:123], v[192:195], v[44:47], v[120:123]
    ds_read_b64_tr_b16 v[40:41], v5 offset:8192
    v_mfma_f32_16x16x32_bf16 v[124:127], v[196:199], v[44:47], v[124:127]
    ds_read_b64_tr_b16 v[42:43], v5 offset:9216
    s_waitcnt lgkmcnt(10)
    v_mfma_f32_16x16x32_bf16 v[96:99], v[200:203], v[48:51], v[96:99]
    ds_read_b64_tr_b16 v[44:45], v6 offset:8192
    v_mfma_f32_16x16x32_bf16 v[100:103], v[204:207], v[48:51], v[100:103]
    ds_read_b64_tr_b16 v[46:47], v6 offset:9216
    v_mfma_f32_16x16x32_bf16 v[104:107], v[200:203], v[52:55], v[104:107]
    ds_read_b64_tr_b16 v[48:49], v3 offset:12288
    v_mfma_f32_16x16x32_bf16 v[108:111], v[204:207], v[52:55], v[108:111]
    ds_read_b64_tr_b16 v[50:51], v3 offset:13312
    s_waitcnt lgkmcnt(10)
    v_mfma_f32_16x16x32_bf16 v[112:115], v[200:203], v[56:59], v[112:115]
    ds_read_b64_tr_b16 v[52:53], v4 offset:12288
    v_mfma_f32_16x16x32_bf16 v[116:119], v[204:207], v[56:59], v[116:119]
    ds_read_b64_tr_b16 v[54:55], v4 offset:13312
    v_mfma_f32_16x16x32_bf16 v[120:123], v[200:203], v[60:63], v[120:123]
    ds_read_b64_tr_b16 v[56:57], v5 offset:12288
    v_mfma_f32_16x16x32_bf16 v[124:127], v[204:207], v[60:63], v[124:127]
    ds_read_b64_tr_b16 v[58:59], v5 offset:13312
    s_waitcnt lgkmcnt(10)
    v_mfma_f32_16x16x32_bf16 v[96:99], v[208:211], v[32:35], v[96:99]
    ds_read_b64_tr_b16 v[60:61], v6 offset:12288
    v_mfma_f32_16x16x32_bf16 v[100:103], v[212:215], v[32:35], v[100:103]
    ds_read_b64_tr_b16 v[62:63], v6 offset:13312
    v_mfma_f32_16x16x32_bf16 v[104:107], v[208:211], v[36:39], v[104:107]
    ds_read_b64_tr_b16 v[32:33], v3 offset:16384
    ds_read_b128 v[16:19], v13 offset:4096
    v_mfma_f32_16x16x32_bf16 v[108:111], v[212:215], v[36:39], v[108:111]
    ds_read_b64_tr_b16 v[34:35], v3 offset:17408
    ds_read_b128 v[20:23], v13 offset:4608
    s_waitcnt lgkmcnt(12)
    v_mfma_f32_16x16x32_bf16 v[112:115], v[208:211], v[40:43], v[112:115]
    ds_read_b64_tr_b16 v[36:37], v4 offset:16384
    ds_read_b128 v[24:27], v13 offset:4160
    v_mfma_f32_16x16x32_bf16 v[116:119], v[212:215], v[40:43], v[116:119]
    ds_read_b64_tr_b16 v[38:39], v4 offset:17408
    ds_read_b128 v[28:31], v13 offset:4672
    v_mfma_f32_16x16x32_bf16 v[120:123], v[208:211], v[44:47], v[120:123]
    ds_read_b64_tr_b16 v[40:41], v5 offset:16384
    ds_read_b32 v8, v15 offset:512
    v_mfma_f32_16x16x32_bf16 v[124:127], v[212:215], v[44:47], v[124:127]
    ds_read_b64_tr_b16 v[42:43], v5 offset:17408
    ds_read_b32 v10, v15 offset:576
    s_waitcnt lgkmcnt(14)
    v_mfma_f32_16x16x32_bf16 v[96:99], v[216:219], v[48:51], v[96:99]
    ds_read_b64_tr_b16 v[44:45], v6 offset:16384
    ds_read_b32 v12, v15 offset:640
    v_mfma_f32_16x16x32_bf16 v[100:103], v[220:223], v[48:51], v[100:103]
    ds_read_b64_tr_b16 v[46:47], v6 offset:17408
    ds_read_b32 v14, v15 offset:704
    v_mfma_f32_16x16x32_bf16 v[104:107], v[216:219], v[52:55], v[104:107]
    ds_read_b64_tr_b16 v[48:49], v3 offset:20480
    v_mfma_f32_16x16x32_bf16 v[108:111], v[220:223], v[52:55], v[108:111]
    ds_read_b64_tr_b16 v[50:51], v3 offset:21504
    s_waitcnt lgkmcnt(14)
    v_mfma_f32_16x16x32_bf16 v[112:115], v[216:219], v[56:59], v[112:115]
    ds_read_b64_tr_b16 v[52:53], v4 offset:20480
    v_mfma_f32_16x16x32_bf16 v[116:119], v[220:223], v[56:59], v[116:119]
    ds_read_b64_tr_b16 v[54:55], v4 offset:21504
    v_mfma_f32_16x16x32_bf16 v[120:123], v[216:219], v[60:63], v[120:123]
    ds_read_b64_tr_b16 v[56:57], v5 offset:20480
    v_mfma_f32_16x16x32_bf16 v[124:127], v[220:223], v[60:63], v[124:127]
    ds_read_b64_tr_b16 v[58:59], v5 offset:21504
    s_waitcnt lgkmcnt(6)
    v_pk_fma_f32 v[96:97], v[8:9], v[16:17], v[96:97] op_sel_hi:[0,1,1] neg_lo:[1,0,0] neg_hi:[1,0,0]
    v_pk_fma_f32 v[98:99], v[8:9], v[18:19], v[98:99] op_sel_hi:[0,1,1] neg_lo:[1,0,0] neg_hi:[1,0,0]
    v_pk_fma_f32 v[104:105], v[10:11], v[16:17], v[104:105] op_sel_hi:[0,1,1] neg_lo:[1,0,0] neg_hi:[1,0,0]
    v_pk_fma_f32 v[106:107], v[10:11], v[18:19], v[106:107] op_sel_hi:[0,1,1] neg_lo:[1,0,0] neg_hi:[1,0,0]
    v_pk_mul_f32 v[96:97], v[20:21], v[96:97]
    v_pk_mul_f32 v[98:99], v[22:23], v[98:99]
    v_pk_mul_f32 v[104:105], v[20:21], v[104:105]
    v_pk_mul_f32 v[106:107], v[22:23], v[106:107]
    v_cvt_pk_bf16_f32 v72, v96, v97
    v_cvt_pk_bf16_f32 v73, v98, v99
    v_cvt_pk_bf16_f32 v74, v104, v105
    v_cvt_pk_bf16_f32 v75, v106, v107
    s_add_u32 s56, s52, 4194304
    v_permlane16_swap_b32 v72, v74
    v_permlane16_swap_b32 v73, v75
    buffer_store_dwordx4 v[72:75], v1, s[4:7], s56 offen offset:0 sc1
    v_pk_fma_f32 v[112:113], v[12:13], v[16:17], v[112:113] op_sel_hi:[0,1,1] neg_lo:[1,0,0] neg_hi:[1,0,0]
    v_pk_fma_f32 v[114:115], v[12:13], v[18:19], v[114:115] op_sel_hi:[0,1,1] neg_lo:[1,0,0] neg_hi:[1,0,0]
    v_pk_fma_f32 v[120:121], v[14:15], v[16:17], v[120:121] op_sel_hi:[0,1,1] neg_lo:[1,0,0] neg_hi:[1,0,0]
    v_pk_fma_f32 v[122:123], v[14:15], v[18:19], v[122:123] op_sel_hi:[0,1,1] neg_lo:[1,0,0] neg_hi:[1,0,0]
    v_pk_mul_f32 v[112:113], v[20:21], v[112:113]
    v_pk_mul_f32 v[114:115], v[22:23], v[114:115]
    v_pk_mul_f32 v[120:121], v[20:21], v[120:121]
    v_pk_mul_f32 v[122:123], v[22:23], v[122:123]
    v_cvt_pk_bf16_f32 v88, v112, v113
    v_cvt_pk_bf16_f32 v89, v114, v115
    v_cvt_pk_bf16_f32 v90, v120, v121
    v_cvt_pk_bf16_f32 v91, v122, v123
    s_add_u32 s56, s52, 4325376
    v_permlane16_swap_b32 v88, v90
    v_permlane16_swap_b32 v89, v91
    buffer_store_dwordx4 v[88:91], v1, s[4:7], s56 offen offset:0 sc1
    v_pk_fma_f32 v[100:101], v[8:9], v[24:25], v[100:101] op_sel_hi:[0,1,1] neg_lo:[1,0,0] neg_hi:[1,0,0]
    v_pk_fma_f32 v[102:103], v[8:9], v[26:27], v[102:103] op_sel_hi:[0,1,1] neg_lo:[1,0,0] neg_hi:[1,0,0]
    v_pk_fma_f32 v[108:109], v[10:11], v[24:25], v[108:109] op_sel_hi:[0,1,1] neg_lo:[1,0,0] neg_hi:[1,0,0]
    v_pk_fma_f32 v[110:111], v[10:11], v[26:27], v[110:111] op_sel_hi:[0,1,1] neg_lo:[1,0,0] neg_hi:[1,0,0]
    v_pk_mul_f32 v[100:101], v[28:29], v[100:101]
    v_pk_mul_f32 v[102:103], v[30:31], v[102:103]
    v_pk_mul_f32 v[108:109], v[28:29], v[108:109]
    v_pk_mul_f32 v[110:111], v[30:31], v[110:111]
    v_cvt_pk_bf16_f32 v76, v100, v101
    v_cvt_pk_bf16_f32 v77, v102, v103
    v_cvt_pk_bf16_f32 v78, v108, v109
    v_cvt_pk_bf16_f32 v79, v110, v111
    s_add_u32 s56, s52, 4194304
    v_permlane16_swap_b32 v76, v78
    v_permlane16_swap_b32 v77, v79
    buffer_store_dwordx4 v[76:79], v1, s[4:7], s56 offen offset:1024 sc1
    v_pk_fma_f32 v[116:117], v[12:13], v[24:25], v[116:117] op_sel_hi:[0,1,1] neg_lo:[1,0,0] neg_hi:[1,0,0]
    v_pk_fma_f32 v[118:119], v[12:13], v[26:27], v[118:119] op_sel_hi:[0,1,1] neg_lo:[1,0,0] neg_hi:[1,0,0]
    v_pk_fma_f32 v[124:125], v[14:15], v[24:25], v[124:125] op_sel_hi:[0,1,1] neg_lo:[1,0,0] neg_hi:[1,0,0]
    v_pk_fma_f32 v[126:127], v[14:15], v[26:27], v[126:127] op_sel_hi:[0,1,1] neg_lo:[1,0,0] neg_hi:[1,0,0]
    v_pk_mul_f32 v[116:117], v[28:29], v[116:117]
    v_pk_mul_f32 v[118:119], v[30:31], v[118:119]
    v_pk_mul_f32 v[124:125], v[28:29], v[124:125]
    v_pk_mul_f32 v[126:127], v[30:31], v[126:127]
    v_cvt_pk_bf16_f32 v92, v116, v117
    v_cvt_pk_bf16_f32 v93, v118, v119
    v_cvt_pk_bf16_f32 v94, v124, v125
    v_cvt_pk_bf16_f32 v95, v126, v127
    s_add_u32 s56, s52, 4325376
    v_permlane16_swap_b32 v92, v94
    v_permlane16_swap_b32 v93, v95
    buffer_store_dwordx4 v[92:95], v1, s[4:7], s56 offen offset:1024 sc1
    v_mfma_f32_16x16x32_bf16 v[128:131], v[32:35], v[224:227], v[128:131]
    ds_read_b64_tr_b16 v[60:61], v6 offset:20480
    v_mfma_f32_16x16x32_bf16 v[132:135], v[32:35], v[228:231], v[132:135]
    ds_read_b64_tr_b16 v[62:63], v6 offset:21504
    v_mfma_f32_16x16x32_bf16 v[136:139], v[36:39], v[224:227], v[136:139]
    ds_read_b64_tr_b16 v[32:33], v3 offset:24576
    v_mfma_f32_16x16x32_bf16 v[140:143], v[36:39], v[228:231], v[140:143]
    ds_read_b64_tr_b16 v[34:35], v3 offset:25600
    v_mfma_f32_16x16x32_bf16 v[144:147], v[40:43], v[224:227], v[144:147]
    ds_read_b64_tr_b16 v[36:37], v4 offset:24576
    v_mfma_f32_16x16x32_bf16 v[148:151], v[40:43], v[228:231], v[148:151]
    ds_read_b64_tr_b16 v[38:39], v4 offset:25600
    v_mfma_f32_16x16x32_bf16 v[152:155], v[44:47], v[224:227], v[152:155]
    ds_read_b64_tr_b16 v[40:41], v5 offset:24576
    v_mfma_f32_16x16x32_bf16 v[156:159], v[44:47], v[228:231], v[156:159]
    ds_read_b64_tr_b16 v[42:43], v5 offset:25600
    s_waitcnt lgkmcnt(10)
    v_mfma_f32_16x16x32_bf16 v[128:131], v[48:51], v[232:235], v[128:131]
    ds_read_b64_tr_b16 v[44:45], v6 offset:24576
    v_mfma_f32_16x16x32_bf16 v[132:135], v[48:51], v[236:239], v[132:135]
    ds_read_b64_tr_b16 v[46:47], v6 offset:25600
    v_mfma_f32_16x16x32_bf16 v[136:139], v[52:55], v[232:235], v[136:139]
    ds_read_b64_tr_b16 v[48:49], v3 offset:28672
    v_mfma_f32_16x16x32_bf16 v[140:143], v[52:55], v[236:239], v[140:143]
    ds_read_b64_tr_b16 v[50:51], v3 offset:29696
    s_waitcnt lgkmcnt(10)
    v_mfma_f32_16x16x32_bf16 v[144:147], v[56:59], v[232:235], v[144:147]
    ds_read_b64_tr_b16 v[52:53], v4 offset:28672
    v_mfma_f32_16x16x32_bf16 v[148:151], v[56:59], v[236:239], v[148:151]
    ds_read_b64_tr_b16 v[54:55], v4 offset:29696
    v_mfma_f32_16x16x32_bf16 v[152:155], v[60:63], v[232:235], v[152:155]
    ds_read_b64_tr_b16 v[56:57], v5 offset:28672
    v_mfma_f32_16x16x32_bf16 v[156:159], v[60:63], v[236:239], v[156:159]
    ds_read_b64_tr_b16 v[58:59], v5 offset:29696
    s_waitcnt lgkmcnt(10)
    v_mfma_f32_16x16x32_bf16 v[128:131], v[32:35], v[240:243], v[128:131]
    ds_read_b64_tr_b16 v[60:61], v6 offset:28672
    v_mfma_f32_16x16x32_bf16 v[132:135], v[32:35], v[244:247], v[132:135]
    ds_read_b64_tr_b16 v[62:63], v6 offset:29696
    s_barrier
    v_mfma_f32_16x16x32_bf16 v[136:139], v[36:39], v[240:243], v[136:139]
    ds_read_b64_tr_b16 v[32:33], v3 offset:32768
    v_mfma_f32_16x16x32_bf16 v[140:143], v[36:39], v[244:247], v[140:143]
    ds_read_b64_tr_b16 v[34:35], v3 offset:33792
    s_waitcnt lgkmcnt(10)
    v_mfma_f32_16x16x32_bf16 v[144:147], v[40:43], v[240:243], v[144:147]
    ds_read_b64_tr_b16 v[36:37], v4 offset:32768
    v_mfma_f32_16x16x32_bf16 v[148:151], v[40:43], v[244:247], v[148:151]
    ds_read_b64_tr_b16 v[38:39], v4 offset:33792
    v_mfma_f32_16x16x32_bf16 v[152:155], v[44:47], v[240:243], v[152:155]
    ds_read_b64_tr_b16 v[40:41], v5 offset:32768
    v_mfma_f32_16x16x32_bf16 v[156:159], v[44:47], v[244:247], v[156:159]
    ds_read_b64_tr_b16 v[42:43], v5 offset:33792
    s_waitcnt lgkmcnt(10)
    v_mfma_f32_16x16x32_bf16 v[128:131], v[48:51], v[248:251], v[128:131]
    ds_read_b64_tr_b16 v[44:45], v6 offset:32768
    v_mfma_f32_16x16x32_bf16 v[132:135], v[48:51], v[252:255], v[132:135]
    ds_read_b64_tr_b16 v[46:47], v6 offset:33792
    v_mfma_f32_16x16x32_bf16 v[136:139], v[52:55], v[248:251], v[136:139]
    ds_read_b64_tr_b16 v[48:49], v3 offset:36864
    v_mfma_f32_16x16x32_bf16 v[140:143], v[52:55], v[252:255], v[140:143]
    ds_read_b64_tr_b16 v[50:51], v3 offset:37888
    s_waitcnt lgkmcnt(10)
    v_mfma_f32_16x16x32_bf16 v[144:147], v[56:59], v[248:251], v[144:147]
    ds_read_b64_tr_b16 v[52:53], v4 offset:36864
    v_mfma_f32_16x16x32_bf16 v[148:151], v[56:59], v[252:255], v[148:151]
    ds_read_b64_tr_b16 v[54:55], v4 offset:37888
    v_mfma_f32_16x16x32_bf16 v[152:155], v[60:63], v[248:251], v[152:155]
    ds_read_b64_tr_b16 v[56:57], v5 offset:36864
    v_mfma_f32_16x16x32_bf16 v[156:159], v[60:63], v[252:255], v[156:159]
    ds_read_b64_tr_b16 v[58:59], v5 offset:37888
    s_waitcnt lgkmcnt(10)
    v_mfma_f32_16x16x32_bf16 v[128:131], v[32:35], v[160:163], v[128:131]
    ds_read_b64_tr_b16 v[60:61], v6 offset:36864
    v_mfma_f32_16x16x32_bf16 v[132:135], v[32:35], v[164:167], v[132:135]
    ds_read_b64_tr_b16 v[62:63], v6 offset:37888
    v_mfma_f32_16x16x32_bf16 v[136:139], v[36:39], v[160:163], v[136:139]
    ds_read_b64_tr_b16 v[32:33], v3 offset:40960
    v_mfma_f32_16x16x32_bf16 v[140:143], v[36:39], v[164:167], v[140:143]
    ds_read_b64_tr_b16 v[34:35], v3 offset:41984
    s_waitcnt lgkmcnt(10)
    v_mfma_f32_16x16x32_bf16 v[144:147], v[40:43], v[160:163], v[144:147]
    ds_read_b64_tr_b16 v[36:37], v4 offset:40960
    v_mfma_f32_16x16x32_bf16 v[148:151], v[40:43], v[164:167], v[148:151]
    ds_read_b64_tr_b16 v[38:39], v4 offset:41984
    v_mfma_f32_16x16x32_bf16 v[152:155], v[44:47], v[160:163], v[152:155]
    ds_read_b64_tr_b16 v[40:41], v5 offset:40960
    v_mfma_f32_16x16x32_bf16 v[156:159], v[44:47], v[164:167], v[156:159]
    ds_read_b64_tr_b16 v[42:43], v5 offset:41984
    s_waitcnt lgkmcnt(10)
    v_mfma_f32_16x16x32_bf16 v[128:131], v[48:51], v[168:171], v[128:131]
    ds_read_b64_tr_b16 v[44:45], v6 offset:40960
    v_mfma_f32_16x16x32_bf16 v[132:135], v[48:51], v[172:175], v[132:135]
    ds_read_b64_tr_b16 v[46:47], v6 offset:41984
    v_mfma_f32_16x16x32_bf16 v[136:139], v[52:55], v[168:171], v[136:139]
    ds_read_b64_tr_b16 v[48:49], v3 offset:45056
    v_mfma_f32_16x16x32_bf16 v[140:143], v[52:55], v[172:175], v[140:143]
    ds_read_b64_tr_b16 v[50:51], v3 offset:46080
    s_waitcnt lgkmcnt(10)
    v_mfma_f32_16x16x32_bf16 v[144:147], v[56:59], v[168:171], v[144:147]
    ds_read_b64_tr_b16 v[52:53], v4 offset:45056
    v_mfma_f32_16x16x32_bf16 v[148:151], v[56:59], v[172:175], v[148:151]
    ds_read_b64_tr_b16 v[54:55], v4 offset:46080
    v_mfma_f32_16x16x32_bf16 v[152:155], v[60:63], v[168:171], v[152:155]
    ds_read_b64_tr_b16 v[56:57], v5 offset:45056
    v_mfma_f32_16x16x32_bf16 v[156:159], v[60:63], v[172:175], v[156:159]
    ds_read_b64_tr_b16 v[58:59], v5 offset:46080
    s_waitcnt lgkmcnt(10)
    v_mfma_f32_16x16x32_bf16 v[128:131], v[32:35], v[176:179], v[128:131]
    ds_read_b64_tr_b16 v[60:61], v6 offset:45056
    v_mfma_f32_16x16x32_bf16 v[132:135], v[32:35], v[180:183], v[132:135]
    ds_read_b64_tr_b16 v[62:63], v6 offset:46080
    v_mfma_f32_16x16x32_bf16 v[136:139], v[36:39], v[176:179], v[136:139]
    ds_read_b64_tr_b16 v[32:33], v3 offset:49152
    v_mfma_f32_16x16x32_bf16 v[140:143], v[36:39], v[180:183], v[140:143]
    ds_read_b64_tr_b16 v[34:35], v3 offset:50176
    s_waitcnt lgkmcnt(10)
    v_mfma_f32_16x16x32_bf16 v[144:147], v[40:43], v[176:179], v[144:147]
    ds_read_b64_tr_b16 v[36:37], v4 offset:49152
    v_mfma_f32_16x16x32_bf16 v[148:151], v[40:43], v[180:183], v[148:151]
    ds_read_b64_tr_b16 v[38:39], v4 offset:50176
    v_mfma_f32_16x16x32_bf16 v[152:155], v[44:47], v[176:179], v[152:155]
    ds_read_b64_tr_b16 v[40:41], v5 offset:49152
    v_mfma_f32_16x16x32_bf16 v[156:159], v[44:47], v[180:183], v[156:159]
    ds_read_b64_tr_b16 v[42:43], v5 offset:50176
    s_waitcnt lgkmcnt(10)
    v_mfma_f32_16x16x32_bf16 v[128:131], v[48:51], v[184:187], v[128:131]
    ds_read_b64_tr_b16 v[44:45], v6 offset:49152
    s_waitcnt vmcnt(0)
    s_atomic_add s40, s[22:23], s59
    s_mov_b32 s68, 0
    s_atomic_add s68, s[22:23], s59 glc
    s_mov_b32 s55, s52
    s_add_u32 s56, s52, 4194304
    ds_read_b32 v8, v9 offset:4096
    v_mfma_f32_16x16x32_bf16 v[132:135], v[48:51], v[188:191], v[132:135]
    ds_read_b64_tr_b16 v[46:47], v6 offset:50176
    buffer_load_dwordx4 v[64:67], v1, s[4:7], s55 offen offset:0 sc1
    ds_read_b32 v10, v9 offset:4608
    v_mfma_f32_16x16x32_bf16 v[136:139], v[52:55], v[184:187], v[136:139]
    ds_read_b64_tr_b16 v[48:49], v3 offset:53248
    buffer_load_dwordx4 v[68:71], v1, s[4:7], s55 offen offset:1024 sc1
    ds_read_b32 v12, v9 offset:4160
    v_mfma_f32_16x16x32_bf16 v[140:143], v[52:55], v[188:191], v[140:143]
    ds_read_b64_tr_b16 v[50:51], v3 offset:54272
    buffer_load_dwordx4 v[72:75], v1, s[4:7], s56 offen offset:0 sc1
    ds_read_b32 v14, v9 offset:4672
    s_waitcnt lgkmcnt(14)
    v_mfma_f32_16x16x32_bf16 v[144:147], v[56:59], v[184:187], v[144:147]
    ds_read_b64_tr_b16 v[52:53], v4 offset:53248
    buffer_load_dwordx4 v[76:79], v1, s[4:7], s56 offen offset:1024 sc1
    ds_read_b128 v[16:19], v11 offset:0
    v_mfma_f32_16x16x32_bf16 v[148:151], v[56:59], v[188:191], v[148:151]
    ds_read_b64_tr_b16 v[54:55], v4 offset:54272
    ds_read_b128 v[20:23], v11 offset:64
    v_mfma_f32_16x16x32_bf16 v[152:155], v[60:63], v[184:187], v[152:155]
    ds_read_b64_tr_b16 v[56:57], v5 offset:53248
    ds_read_b128 v[24:27], v11 offset:128
    v_mfma_f32_16x16x32_bf16 v[156:159], v[60:63], v[188:191], v[156:159]
    ds_read_b64_tr_b16 v[58:59], v5 offset:54272
    ds_read_b128 v[28:31], v11 offset:192
    s_waitcnt lgkmcnt(14)
    v_mfma_f32_16x16x32_bf16 v[128:131], v[32:35], v[192:195], v[128:131]
    ds_read_b64_tr_b16 v[60:61], v6 offset:53248
    v_mfma_f32_16x16x32_bf16 v[132:135], v[32:35], v[196:199], v[132:135]
    ds_read_b64_tr_b16 v[62:63], v6 offset:54272
    v_mfma_f32_16x16x32_bf16 v[136:139], v[36:39], v[192:195], v[136:139]
    ds_read_b64_tr_b16 v[32:33], v3 offset:57344
    v_mfma_f32_16x16x32_bf16 v[140:143], v[36:39], v[196:199], v[140:143]
    ds_read_b64_tr_b16 v[34:35], v3 offset:58368
    s_waitcnt lgkmcnt(14)
    v_mfma_f32_16x16x32_bf16 v[144:147], v[40:43], v[192:195], v[144:147]
    ds_read_b64_tr_b16 v[36:37], v4 offset:57344
    v_mfma_f32_16x16x32_bf16 v[148:151], v[40:43], v[196:199], v[148:151]
    ds_read_b64_tr_b16 v[38:39], v4 offset:58368
    v_mfma_f32_16x16x32_bf16 v[152:155], v[44:47], v[192:195], v[152:155]
    ds_read_b64_tr_b16 v[40:41], v5 offset:57344
    v_mfma_f32_16x16x32_bf16 v[156:159], v[44:47], v[196:199], v[156:159]
    ds_read_b64_tr_b16 v[42:43], v5 offset:58368
    s_waitcnt lgkmcnt(13)
    v_mfma_f32_16x16x32_bf16 v[128:131], v[48:51], v[200:203], v[128:131]
    ds_read_b64_tr_b16 v[44:45], v6 offset:57344
    s_waitcnt lgkmcnt(9)
    v_mfma_f32_16x16x32_bf16 v[132:135], v[48:51], v[204:207], v[132:135]
    ds_read_b64_tr_b16 v[46:47], v6 offset:58368
    v_mul_f32 v10, 0x3e8293ee, v10
    v_mfma_f32_16x16x32_bf16 v[136:139], v[52:55], v[200:203], v[136:139]
    ds_read_b64_tr_b16 v[48:49], v3 offset:61440
    v_mul_f32 v14, 0x3e8293ee, v14
    v_mfma_f32_16x16x32_bf16 v[140:143], v[52:55], v[204:207], v[140:143]
    ds_read_b64_tr_b16 v[50:51], v3 offset:62464
    s_lshl_b32 s44, s16, 11
    s_waitcnt lgkmcnt(10)
    v_mfma_f32_16x16x32_bf16 v[144:147], v[56:59], v[200:203], v[144:147]
    ds_read_b64_tr_b16 v[52:53], v4 offset:61440
    s_add_u32 s44, s44, 131072
    v_mfma_f32_16x16x32_bf16 v[148:151], v[56:59], v[204:207], v[148:151]
    ds_read_b64_tr_b16 v[54:55], v4 offset:62464
    v_add_u32 v13, s44, v2
    v_mfma_f32_16x16x32_bf16 v[152:155], v[60:63], v[200:203], v[152:155]
    ds_read_b64_tr_b16 v[56:57], v5 offset:61440
    v_mfma_f32_16x16x32_bf16 v[156:159], v[60:63], v[204:207], v[156:159]
    ds_read_b64_tr_b16 v[58:59], v5 offset:62464
    s_waitcnt lgkmcnt(10)
    v_mfma_f32_16x16x32_bf16 v[128:131], v[32:35], v[208:211], v[128:131]
    ds_read_b64_tr_b16 v[60:61], v6 offset:61440
    v_mfma_f32_16x16x32_bf16 v[132:135], v[32:35], v[212:215], v[132:135]
    ds_read_b64_tr_b16 v[62:63], v6 offset:62464
    v_xor_b32 v3, 0x10000, v3
    v_xor_b32 v4, 0x10000, v4
    v_xor_b32 v5, 0x10000, v5
    v_xor_b32 v6, 0x10000, v6
    v_mfma_f32_16x16x32_bf16 v[136:139], v[36:39], v[208:211], v[136:139]
    v_mfma_f32_16x16x32_bf16 v[140:143], v[36:39], v[212:215], v[140:143]
    s_waitcnt lgkmcnt(8)
    v_mfma_f32_16x16x32_bf16 v[144:147], v[40:43], v[208:211], v[144:147]
    v_mfma_f32_16x16x32_bf16 v[148:151], v[40:43], v[212:215], v[148:151]
    v_mfma_f32_16x16x32_bf16 v[152:155], v[44:47], v[208:211], v[152:155]
    v_mfma_f32_16x16x32_bf16 v[156:159], v[44:47], v[212:215], v[156:159]
    s_waitcnt lgkmcnt(4)
    v_mfma_f32_16x16x32_bf16 v[128:131], v[48:51], v[216:219], v[128:131]
    v_mfma_f32_16x16x32_bf16 v[132:135], v[48:51], v[220:223], v[132:135]
    v_mfma_f32_16x16x32_bf16 v[136:139], v[52:55], v[216:219], v[136:139]
    v_mfma_f32_16x16x32_bf16 v[140:143], v[52:55], v[220:223], v[140:143]
    s_waitcnt lgkmcnt(0)
    v_mfma_f32_16x16x32_bf16 v[144:147], v[56:59], v[216:219], v[144:147]
    v_mfma_f32_16x16x32_bf16 v[148:151], v[56:59], v[220:223], v[148:151]
    v_mfma_f32_16x16x32_bf16 v[152:155], v[60:63], v[216:219], v[152:155]
    v_mfma_f32_16x16x32_bf16 v[156:159], v[60:63], v[220:223], v[156:159]
    v_pk_fma_f32 v[128:129], v[8:9], v[16:17], v[128:129] op_sel_hi:[0,1,1] neg_lo:[1,0,0] neg_hi:[1,0,0]
    v_pk_fma_f32 v[130:131], v[8:9], v[18:19], v[130:131] op_sel_hi:[0,1,1] neg_lo:[1,0,0] neg_hi:[1,0,0]
    v_pk_fma_f32 v[136:137], v[8:9], v[20:21], v[136:137] op_sel_hi:[0,1,1] neg_lo:[1,0,0] neg_hi:[1,0,0]
    v_pk_fma_f32 v[138:139], v[8:9], v[22:23], v[138:139] op_sel_hi:[0,1,1] neg_lo:[1,0,0] neg_hi:[1,0,0]
    v_pk_mul_f32 v[128:129], v[10:11], v[128:129] op_sel_hi:[0,1]
    v_pk_mul_f32 v[130:131], v[10:11], v[130:131] op_sel_hi:[0,1]
    v_pk_mul_f32 v[136:137], v[10:11], v[136:137] op_sel_hi:[0,1]
    v_pk_mul_f32 v[138:139], v[10:11], v[138:139] op_sel_hi:[0,1]
    v_cvt_pk_bf16_f32 v128, v128, v129
    v_cvt_pk_bf16_f32 v129, v130, v131
    v_cvt_pk_bf16_f32 v130, v136, v137
    v_cvt_pk_bf16_f32 v131, v138, v139
    ds_write_b128 v13, v[128:131] offset:0
    v_pk_fma_f32 v[132:133], v[12:13], v[16:17], v[132:133] op_sel_hi:[0,1,1] neg_lo:[1,0,0] neg_hi:[1,0,0]
    v_pk_fma_f32 v[134:135], v[12:13], v[18:19], v[134:135] op_sel_hi:[0,1,1] neg_lo:[1,0,0] neg_hi:[1,0,0]
    v_pk_fma_f32 v[140:141], v[12:13], v[20:21], v[140:141] op_sel_hi:[0,1,1] neg_lo:[1,0,0] neg_hi:[1,0,0]
    v_pk_fma_f32 v[142:143], v[12:13], v[22:23], v[142:143] op_sel_hi:[0,1,1] neg_lo:[1,0,0] neg_hi:[1,0,0]
    v_pk_mul_f32 v[132:133], v[14:15], v[132:133] op_sel_hi:[0,1]
    v_pk_mul_f32 v[134:135], v[14:15], v[134:135] op_sel_hi:[0,1]
    v_pk_mul_f32 v[140:141], v[14:15], v[140:141] op_sel_hi:[0,1]
    v_pk_mul_f32 v[142:143], v[14:15], v[142:143] op_sel_hi:[0,1]
    v_cvt_pk_bf16_f32 v132, v132, v133
    v_cvt_pk_bf16_f32 v133, v134, v135
    v_cvt_pk_bf16_f32 v134, v140, v141
    v_cvt_pk_bf16_f32 v135, v142, v143
    ds_write_b128 v13, v[132:135] offset:256
    v_add_u32 v4, 131072, v1
    s_waitcnt lgkmcnt(0)
    s_barrier
    ds_read_b128 v[32:35], v4 offset:0
    ds_read_b128 v[36:39], v4 offset:1024
    ds_read_b128 v[40:43], v4 offset:2048
    ds_read_b128 v[44:47], v4 offset:3072
    ds_read_b128 v[48:51], v4 offset:4096
    ds_read_b128 v[52:55], v4 offset:5120
    ds_read_b128 v[56:59], v4 offset:6144
    ds_read_b128 v[60:63], v4 offset:7168
    v_pk_fma_f32 v[144:145], v[8:9], v[24:25], v[144:145] op_sel_hi:[0,1,1] neg_lo:[1,0,0] neg_hi:[1,0,0]
    v_pk_fma_f32 v[146:147], v[8:9], v[26:27], v[146:147] op_sel_hi:[0,1,1] neg_lo:[1,0,0] neg_hi:[1,0,0]
    v_pk_fma_f32 v[152:153], v[8:9], v[28:29], v[152:153] op_sel_hi:[0,1,1] neg_lo:[1,0,0] neg_hi:[1,0,0]
    v_pk_fma_f32 v[154:155], v[8:9], v[30:31], v[154:155] op_sel_hi:[0,1,1] neg_lo:[1,0,0] neg_hi:[1,0,0]
    v_pk_mul_f32 v[144:145], v[10:11], v[144:145] op_sel_hi:[0,1]
    v_pk_mul_f32 v[146:147], v[10:11], v[146:147] op_sel_hi:[0,1]
    v_pk_mul_f32 v[152:153], v[10:11], v[152:153] op_sel_hi:[0,1]
    v_pk_mul_f32 v[154:155], v[10:11], v[154:155] op_sel_hi:[0,1]
    v_cvt_pk_bf16_f32 v144, v144, v145
    v_cvt_pk_bf16_f32 v145, v146, v147
    v_cvt_pk_bf16_f32 v146, v152, v153
    v_cvt_pk_bf16_f32 v147, v154, v155
    ds_write_b128 v13, v[144:147] offset:8192
    s_waitcnt vmcnt(0) lgkmcnt(7)
    v_mfma_f32_32x32x16_bf16 v[192:207], v[64:67], v[32:35], 0
    v_mfma_f32_32x32x16_bf16 v[192:207], v[68:71], v[36:39], v[192:207]
    v_pk_fma_f32 v[148:149], v[12:13], v[24:25], v[148:149] op_sel_hi:[0,1,1] neg_lo:[1,0,0] neg_hi:[1,0,0]
    v_pk_fma_f32 v[150:151], v[12:13], v[26:27], v[150:151] op_sel_hi:[0,1,1] neg_lo:[1,0,0] neg_hi:[1,0,0]
    v_pk_fma_f32 v[156:157], v[12:13], v[28:29], v[156:157] op_sel_hi:[0,1,1] neg_lo:[1,0,0] neg_hi:[1,0,0]
    v_pk_fma_f32 v[158:159], v[12:13], v[30:31], v[158:159] op_sel_hi:[0,1,1] neg_lo:[1,0,0] neg_hi:[1,0,0]
    v_pk_mul_f32 v[148:149], v[14:15], v[148:149] op_sel_hi:[0,1]
    v_pk_mul_f32 v[150:151], v[14:15], v[150:151] op_sel_hi:[0,1]
    v_pk_mul_f32 v[156:157], v[14:15], v[156:157] op_sel_hi:[0,1]
    v_pk_mul_f32 v[158:159], v[14:15], v[158:159] op_sel_hi:[0,1]
    v_cvt_pk_bf16_f32 v148, v148, v149
    v_cvt_pk_bf16_f32 v149, v150, v151
    v_cvt_pk_bf16_f32 v150, v156, v157
    v_cvt_pk_bf16_f32 v151, v158, v159
    ds_write_b128 v13, v[148:151] offset:8448
    v_mov_b32 v9, 0xdddddddd
    v_bfe_u32 v10, v1, 4, 3
    v_mov_b32 v11, 0x3f803f80
    v_cmp_eq_u32 vcc, 0, v10
    v_cmp_eq_u32 s[44:45], 4, v10
    s_mov_b32 s57, 0
    v_cndmask_b32 v28, 0, v11, vcc
    v_cndmask_b32 v29, 0, v11, vcc
    v_cndmask_b32 v30, 0, v11, s[44:45]
    v_cndmask_b32 v31, 0, v11, s[44:45]
    v_mov_b32 v10, 0
    v_mov_b32 v11, 0
    s_mov_b32 s66, 0x10000
    s_waitcnt lgkmcnt(0)
    s_cmp_eq_u32 s68, 16
    s_cbranch_scc1 c_k_ok
c_k_poll:
    s_mov_b32 s68, 0
    s_atomic_add s68, s[22:23], s59 offset:0 glc
    s_sub_u32 s66, s66, 1
    s_cselect_b32 s67, 16, 0
    s_waitcnt lgkmcnt(0)
    s_max_u32 s68, s68, s67
    s_cmp_lt_u32 s68, 16
    s_cbranch_scc1 c_k_poll
c_k_ok:
    s_add_u32 s54, s54, 8192
    s_and_b32 s54, s54, 0x1ffff
    s_add_u32 s55, s53, s54
    s_add_u32 s56, s55, 4194304
    buffer_load_dwordx4 v[80:83], v1, s[4:7], s55 offen offset:0 sc1
    buffer_load_dwordx4 v[84:87], v1, s[4:7], s55 offen offset:1024 sc1
    buffer_load_dwordx4 v[88:91], v1, s[4:7], s56 offen offset:0 sc1
    buffer_load_dwordx4 v[92:95], v1, s[4:7], s56 offen offset:1024 sc1
    s_add_u32 s54, s54, 8192
    s_and_b32 s54, s54, 0x1ffff
    s_add_u32 s55, s53, s54
    s_add_u32 s56, s55, 4194304
    buffer_load_dwordx4 v[96:99], v1, s[4:7], s55 offen offset:0 sc1
    buffer_load_dwordx4 v[100:103], v1, s[4:7], s55 offen offset:1024 sc1
    buffer_load_dwordx4 v[104:107], v1, s[4:7], s56 offen offset:0 sc1
    buffer_load_dwordx4 v[108:111], v1, s[4:7], s56 offen offset:1024 sc1
    v_mfma_f32_32x32x16_bf16 v[208:223], v[64:67], v[40:43], 0
    s_add_u32 s54, s54, 8192
    s_and_b32 s54, s54, 0x1ffff
    s_add_u32 s55, s53, s54
    s_add_u32 s56, s55, 4194304
    v_exp_f32 v192, v192
    v_exp_f32 v193, v193
    v_exp_f32 v194, v194
    v_mfma_f32_32x32x8_bf16 v[128:143], v[10:11], v[10:11], 0
    v_mov_b32 v12, 0
    v_exp_f32 v195, v195
    v_exp_f32 v196, v196
    v_exp_f32 v197, v197
    v_mfma_f32_32x32x16_bf16 v[208:223], v[68:71], v[44:47], v[208:223]
    v_exp_f32 v198, v198
    v_exp_f32 v199, v199
    v_exp_f32 v200, v200
    v_mfma_f32_32x32x8_bf16 v[144:159], v[10:11], v[10:11], 0
    v_mov_b32 v16, 0
    v_exp_f32 v201, v201
    v_exp_f32 v202, v202
    v_mfma_f32_32x32x8_bf16 v[160:175], v[10:11], v[10:11], 0
    v_mov_b32 v20, 0
    s_lshl_b32 s44, s16, 12
    s_add_u32 s44, s44, 65536
    v_add_u32 v5, s44, v1
    s_lshl_b32 s44, s16, 8
    s_add_u32 s44, s44, 147456
    v_lshrrev_b32 v6, 2, v1
    v_add_u32 v6, s44, v6
    s_lshl_b32 s44, s21, 22
    s_lshl_b32 s45, s38, 16
    s_add_u32 s41, s44, s45
    s_lshl_b32 s45, s18, 12
    s_add_u32 s43, s41, s45
    s_and_b32 s45, s45, 0
    s_add_u32 s41, s41, s45
    s_add_u32 s41, s41, 16777216
    v_exp_f32 v203, v203
    v_exp_f32 v204, v204
    buffer_load_dwordx4 v[112:115], v1, s[4:7], s55 offen offset:0 sc1
    v_exp_f32 v205, v205
    v_mfma_f32_32x32x8_bf16 v[176:191], v[10:11], v[10:11], 0
    v_mov_b32 v24, 0
    v_exp_f32 v206, v206
    v_exp_f32 v207, v207
    v_mfma_f32_32x32x16_bf16 v[224:239], v[64:67], v[48:51], 0
    v_exp_f32 v208, v208
    v_exp_f32 v209, v209
    v_exp_f32 v210, v210
    v_smfmac_f32_32x32x32_bf16 v[128:143], v[72:75], v[192:199], v9
    v_exp_f32 v211, v211
    v_exp_f32 v212, v212
    v_exp_f32 v213, v213
    v_mfma_f32_32x32x16_bf16 v[224:239], v[68:71], v[52:55], v[224:239]
    v_exp_f32 v214, v214
    v_exp_f32 v215, v215
    v_exp_f32 v216, v216
    v_smfmac_f32_16x16x64_bf16 v[12:15], v[28:31], v[192:199], v9
    v_exp_f32 v217, v217
    v_smfmac_f32_32x32x32_bf16 v[128:143], v[76:79], v[200:207], v9
    v_exp_f32 v218, v218
    v_exp_f32 v219, v219
    v_exp_f32 v220, v220
    v_smfmac_f32_16x16x64_bf16 v[12:15], v[28:31], v[200:207], v9
    buffer_load_dwordx4 v[116:119], v1, s[4:7], s55 offen offset:1024 sc1
    v_exp_f32 v221, v221
    v_exp_f32 v222, v222
    v_exp_f32 v223, v223
b_head:
    s_mov_b32 s58, 3
b_loop:
    v_mfma_f32_32x32x16_bf16 v[240:255], v[64:67], v[56:59], 0
    v_exp_f32 v224, v224
    v_exp_f32 v225, v225
    v_exp_f32 v226, v226
    v_smfmac_f32_32x32x32_bf16 v[144:159], v[72:75], v[208:215], v9
    v_exp_f32 v227, v227
    v_exp_f32 v228, v228
    v_exp_f32 v229, v229
    v_mfma_f32_32x32x16_bf16 v[240:255], v[68:71], v[60:63], v[240:255]
    v_exp_f32 v230, v230
    v_exp_f32 v231, v231
    v_exp_f32 v232, v232
    v_smfmac_f32_16x16x64_bf16 v[16:19], v[28:31], v[208:215], v9
    v_exp_f32 v233, v233
    v_smfmac_f32_32x32x32_bf16 v[144:159], v[76:79], v[216:223], v9
    v_exp_f32 v234, v234
    v_exp_f32 v235, v235
    v_exp_f32 v236, v236
    v_smfmac_f32_16x16x64_bf16 v[16:19], v[28:31], v[216:223], v9
    buffer_load_dwordx4 v[120:123], v1, s[4:7], s56 offen offset:0 sc1
    v_exp_f32 v237, v237
    v_exp_f32 v238, v238
    v_exp_f32 v239, v239
    s_waitcnt vmcnt(7)
    v_mfma_f32_32x32x16_bf16 v[192:207], v[80:83], v[32:35], 0
    v_exp_f32 v240, v240
    v_exp_f32 v241, v241
    v_exp_f32 v242, v242
    v_smfmac_f32_32x32x32_bf16 v[160:175], v[72:75], v[224:231], v9
    v_exp_f32 v243, v243
    v_exp_f32 v244, v244
    v_exp_f32 v245, v245
    v_mfma_f32_32x32x16_bf16 v[192:207], v[84:87], v[36:39], v[192:207]
    v_exp_f32 v246, v246
    v_exp_f32 v247, v247
    v_exp_f32 v248, v248
    v_smfmac_f32_16x16x64_bf16 v[20:23], v[28:31], v[224:231], v9
    v_exp_f32 v249, v249
    v_smfmac_f32_32x32x32_bf16 v[160:175], v[76:79], v[232:239], v9
    v_exp_f32 v250, v250
    v_exp_f32 v251, v251
    v_exp_f32 v252, v252
    v_smfmac_f32_16x16x64_bf16 v[20:23], v[28:31], v[232:239], v9
    buffer_load_dwordx4 v[124:127], v1, s[4:7], s56 offen offset:1024 sc1
    v_exp_f32 v253, v253
    v_exp_f32 v254, v254
    v_exp_f32 v255, v255
    v_mfma_f32_32x32x16_bf16 v[208:223], v[80:83], v[40:43], 0
    s_add_u32 s54, s54, 8192
    s_and_b32 s54, s54, 0x1ffff
    s_add_u32 s55, s53, s54
    s_add_u32 s56, s55, 4194304
    v_exp_f32 v192, v192
    v_exp_f32 v193, v193
    v_exp_f32 v194, v194
    v_smfmac_f32_32x32x32_bf16 v[176:191], v[72:75], v[240:247], v9
    v_exp_f32 v195, v195
    v_exp_f32 v196, v196
    v_exp_f32 v197, v197
    v_mfma_f32_32x32x16_bf16 v[208:223], v[84:87], v[44:47], v[208:223]
    v_exp_f32 v198, v198
    v_exp_f32 v199, v199
    v_exp_f32 v200, v200
    v_smfmac_f32_16x16x64_bf16 v[24:27], v[28:31], v[240:247], v9
    v_exp_f32 v201, v201
    v_smfmac_f32_32x32x32_bf16 v[176:191], v[76:79], v[248:255], v9
    v_exp_f32 v202, v202
    v_exp_f32 v203, v203
    v_exp_f32 v204, v204
    v_smfmac_f32_16x16x64_bf16 v[24:27], v[28:31], v[248:255], v9
    buffer_load_dwordx4 v[64:67], v1, s[4:7], s55 offen offset:0 sc1
    v_exp_f32 v205, v205
    v_exp_f32 v206, v206
    v_exp_f32 v207, v207
    v_mfma_f32_32x32x16_bf16 v[224:239], v[80:83], v[48:51], 0
    v_exp_f32 v208, v208
    v_exp_f32 v209, v209
    v_exp_f32 v210, v210
    v_smfmac_f32_32x32x32_bf16 v[128:143], v[88:91], v[192:199], v9
    v_exp_f32 v211, v211
    v_exp_f32 v212, v212
    v_exp_f32 v213, v213
    v_mfma_f32_32x32x16_bf16 v[224:239], v[84:87], v[52:55], v[224:239]
    v_exp_f32 v214, v214
    v_exp_f32 v215, v215
    v_exp_f32 v216, v216
    v_smfmac_f32_16x16x64_bf16 v[12:15], v[28:31], v[192:199], v9
    v_exp_f32 v217, v217
    v_smfmac_f32_32x32x32_bf16 v[128:143], v[92:95], v[200:207], v9
    v_exp_f32 v218, v218
    v_exp_f32 v219, v219
    v_exp_f32 v220, v220
    v_smfmac_f32_16x16x64_bf16 v[12:15], v[28:31], v[200:207], v9
    buffer_load_dwordx4 v[68:71], v1, s[4:7], s55 offen offset:1024 sc1
    v_exp_f32 v221, v221
    v_exp_f32 v222, v222
    v_exp_f32 v223, v223
    v_mfma_f32_32x32x16_bf16 v[240:255], v[80:83], v[56:59], 0
    v_exp_f32 v224, v224
    v_exp_f32 v225, v225
    v_exp_f32 v226, v226
    v_smfmac_f32_32x32x32_bf16 v[144:159], v[88:91], v[208:215], v9
    v_exp_f32 v227, v227
    v_exp_f32 v228, v228
    v_exp_f32 v229, v229
    v_mfma_f32_32x32x16_bf16 v[240:255], v[84:87], v[60:63], v[240:255]
    v_exp_f32 v230, v230
    v_exp_f32 v231, v231
    v_exp_f32 v232, v232
    v_smfmac_f32_16x16x64_bf16 v[16:19], v[28:31], v[208:215], v9
    v_exp_f32 v233, v233
    v_smfmac_f32_32x32x32_bf16 v[144:159], v[92:95], v[216:223], v9
    v_exp_f32 v234, v234
    v_exp_f32 v235, v235
    v_exp_f32 v236, v236
    v_smfmac_f32_16x16x64_bf16 v[16:19], v[28:31], v[216:223], v9
    buffer_load_dwordx4 v[72:75], v1, s[4:7], s56 offen offset:0 sc1
    v_exp_f32 v237, v237
    v_exp_f32 v238, v238
    v_exp_f32 v239, v239
    s_waitcnt vmcnt(7)
    v_mfma_f32_32x32x16_bf16 v[192:207], v[96:99], v[32:35], 0
    v_exp_f32 v240, v240
    v_exp_f32 v241, v241
    v_exp_f32 v242, v242
    v_smfmac_f32_32x32x32_bf16 v[160:175], v[88:91], v[224:231], v9
    v_exp_f32 v243, v243
    v_exp_f32 v244, v244
    v_exp_f32 v245, v245
    v_mfma_f32_32x32x16_bf16 v[192:207], v[100:103], v[36:39], v[192:207]
    v_exp_f32 v246, v246
    v_exp_f32 v247, v247
    v_exp_f32 v248, v248
    v_smfmac_f32_16x16x64_bf16 v[20:23], v[28:31], v[224:231], v9
    v_exp_f32 v249, v249
    v_smfmac_f32_32x32x32_bf16 v[160:175], v[92:95], v[232:239], v9
    v_exp_f32 v250, v250
    v_exp_f32 v251, v251
    v_exp_f32 v252, v252
    v_smfmac_f32_16x16x64_bf16 v[20:23], v[28:31], v[232:239], v9
    buffer_load_dwordx4 v[76:79], v1, s[4:7], s56 offen offset:1024 sc1
    v_exp_f32 v253, v253
    v_exp_f32 v254, v254
    v_exp_f32 v255, v255
    v_mfma_f32_32x32x16_bf16 v[208:223], v[96:99], v[40:43], 0
    s_add_u32 s54, s54, 8192
    s_and_b32 s54, s54, 0x1ffff
    s_add_u32 s55, s53, s54
    s_add_u32 s56, s55, 4194304
    v_exp_f32 v192, v192
    v_exp_f32 v193, v193
    v_exp_f32 v194, v194
    v_smfmac_f32_32x32x32_bf16 v[176:191], v[88:91], v[240:247], v9
    v_exp_f32 v195, v195
    v_exp_f32 v196, v196
    v_exp_f32 v197, v197
    v_mfma_f32_32x32x16_bf16 v[208:223], v[100:103], v[44:47], v[208:223]
    v_exp_f32 v198, v198
    v_exp_f32 v199, v199
    v_exp_f32 v200, v200
    v_smfmac_f32_16x16x64_bf16 v[24:27], v[28:31], v[240:247], v9
    v_exp_f32 v201, v201
    v_smfmac_f32_32x32x32_bf16 v[176:191], v[92:95], v[248:255], v9
    v_exp_f32 v202, v202
    v_exp_f32 v203, v203
    v_exp_f32 v204, v204
    v_smfmac_f32_16x16x64_bf16 v[24:27], v[28:31], v[248:255], v9
    buffer_load_dwordx4 v[80:83], v1, s[4:7], s55 offen offset:0 sc1
    v_exp_f32 v205, v205
    v_exp_f32 v206, v206
    v_exp_f32 v207, v207
    v_mfma_f32_32x32x16_bf16 v[224:239], v[96:99], v[48:51], 0
    v_exp_f32 v208, v208
    v_exp_f32 v209, v209
    v_exp_f32 v210, v210
    v_smfmac_f32_32x32x32_bf16 v[128:143], v[104:107], v[192:199], v9
    v_exp_f32 v211, v211
    v_exp_f32 v212, v212
    v_exp_f32 v213, v213
    v_mfma_f32_32x32x16_bf16 v[224:239], v[100:103], v[52:55], v[224:239]
    v_exp_f32 v214, v214
    v_exp_f32 v215, v215
    v_exp_f32 v216, v216
    v_smfmac_f32_16x16x64_bf16 v[12:15], v[28:31], v[192:199], v9
    v_exp_f32 v217, v217
    v_smfmac_f32_32x32x32_bf16 v[128:143], v[108:111], v[200:207], v9
    v_exp_f32 v218, v218
    v_exp_f32 v219, v219
    v_exp_f32 v220, v220
    v_smfmac_f32_16x16x64_bf16 v[12:15], v[28:31], v[200:207], v9
    buffer_load_dwordx4 v[84:87], v1, s[4:7], s55 offen offset:1024 sc1
    v_exp_f32 v221, v221
    v_exp_f32 v222, v222
    v_exp_f32 v223, v223
    v_mfma_f32_32x32x16_bf16 v[240:255], v[96:99], v[56:59], 0
    v_exp_f32 v224, v224
    v_exp_f32 v225, v225
    v_exp_f32 v226, v226
    v_smfmac_f32_32x32x32_bf16 v[144:159], v[104:107], v[208:215], v9
    v_exp_f32 v227, v227
    v_exp_f32 v228, v228
    v_exp_f32 v229, v229
    v_mfma_f32_32x32x16_bf16 v[240:255], v[100:103], v[60:63], v[240:255]
    v_exp_f32 v230, v230
    v_exp_f32 v231, v231
    v_exp_f32 v232, v232
    v_smfmac_f32_16x16x64_bf16 v[16:19], v[28:31], v[208:215], v9
    v_exp_f32 v233, v233
    v_smfmac_f32_32x32x32_bf16 v[144:159], v[108:111], v[216:223], v9
    v_exp_f32 v234, v234
    v_exp_f32 v235, v235
    v_exp_f32 v236, v236
    v_smfmac_f32_16x16x64_bf16 v[16:19], v[28:31], v[216:223], v9
    buffer_load_dwordx4 v[88:91], v1, s[4:7], s56 offen offset:0 sc1
    v_exp_f32 v237, v237
    v_exp_f32 v238, v238
    v_exp_f32 v239, v239
    s_waitcnt vmcnt(7)
    v_mfma_f32_32x32x16_bf16 v[192:207], v[112:115], v[32:35], 0
    v_exp_f32 v240, v240
    v_exp_f32 v241, v241
    v_exp_f32 v242, v242
    v_smfmac_f32_32x32x32_bf16 v[160:175], v[104:107], v[224:231], v9
    v_exp_f32 v243, v243
    v_exp_f32 v244, v244
    v_exp_f32 v245, v245
    v_mfma_f32_32x32x16_bf16 v[192:207], v[116:119], v[36:39], v[192:207]
    v_exp_f32 v246, v246
    v_exp_f32 v247, v247
    v_exp_f32 v248, v248
    v_smfmac_f32_16x16x64_bf16 v[20:23], v[28:31], v[224:231], v9
    v_exp_f32 v249, v249
    v_smfmac_f32_32x32x32_bf16 v[160:175], v[108:111], v[232:239], v9
    v_exp_f32 v250, v250
    v_exp_f32 v251, v251
    v_exp_f32 v252, v252
    v_smfmac_f32_16x16x64_bf16 v[20:23], v[28:31], v[232:239], v9
    buffer_load_dwordx4 v[92:95], v1, s[4:7], s56 offen offset:1024 sc1
    v_exp_f32 v253, v253
    v_exp_f32 v254, v254
    v_exp_f32 v255, v255
    v_mfma_f32_32x32x16_bf16 v[208:223], v[112:115], v[40:43], 0
    s_add_u32 s54, s54, 8192
    s_and_b32 s54, s54, 0x1ffff
    s_add_u32 s55, s53, s54
    s_add_u32 s56, s55, 4194304
    v_exp_f32 v192, v192
    v_exp_f32 v193, v193
    v_exp_f32 v194, v194
    v_smfmac_f32_32x32x32_bf16 v[176:191], v[104:107], v[240:247], v9
    v_exp_f32 v195, v195
    v_exp_f32 v196, v196
    v_exp_f32 v197, v197
    v_mfma_f32_32x32x16_bf16 v[208:223], v[116:119], v[44:47], v[208:223]
    v_exp_f32 v198, v198
    v_exp_f32 v199, v199
    v_exp_f32 v200, v200
    v_smfmac_f32_16x16x64_bf16 v[24:27], v[28:31], v[240:247], v9
    v_exp_f32 v201, v201
    v_smfmac_f32_32x32x32_bf16 v[176:191], v[108:111], v[248:255], v9
    v_exp_f32 v202, v202
    v_exp_f32 v203, v203
    v_exp_f32 v204, v204
    v_smfmac_f32_16x16x64_bf16 v[24:27], v[28:31], v[248:255], v9
    buffer_load_dwordx4 v[96:99], v1, s[4:7], s55 offen offset:0 sc1
    v_exp_f32 v205, v205
    v_exp_f32 v206, v206
    v_exp_f32 v207, v207
    v_mfma_f32_32x32x16_bf16 v[224:239], v[112:115], v[48:51], 0
    v_exp_f32 v208, v208
    v_exp_f32 v209, v209
    v_exp_f32 v210, v210
    v_smfmac_f32_32x32x32_bf16 v[128:143], v[120:123], v[192:199], v9
    v_exp_f32 v211, v211
    v_exp_f32 v212, v212
    v_exp_f32 v213, v213
    v_mfma_f32_32x32x16_bf16 v[224:239], v[116:119], v[52:55], v[224:239]
    v_exp_f32 v214, v214
    v_exp_f32 v215, v215
    v_exp_f32 v216, v216
    v_smfmac_f32_16x16x64_bf16 v[12:15], v[28:31], v[192:199], v9
    v_exp_f32 v217, v217
    v_smfmac_f32_32x32x32_bf16 v[128:143], v[124:127], v[200:207], v9
    v_exp_f32 v218, v218
    v_exp_f32 v219, v219
    v_exp_f32 v220, v220
    v_smfmac_f32_16x16x64_bf16 v[12:15], v[28:31], v[200:207], v9
    buffer_load_dwordx4 v[100:103], v1, s[4:7], s55 offen offset:1024 sc1
    v_exp_f32 v221, v221
    v_exp_f32 v222, v222
    v_exp_f32 v223, v223
    v_mfma_f32_32x32x16_bf16 v[240:255], v[112:115], v[56:59], 0
    v_exp_f32 v224, v224
    v_exp_f32 v225, v225
    v_exp_f32 v226, v226
    v_smfmac_f32_32x32x32_bf16 v[144:159], v[120:123], v[208:215], v9
    v_exp_f32 v227, v227
    v_exp_f32 v228, v228
    v_exp_f32 v229, v229
    v_mfma_f32_32x32x16_bf16 v[240:255], v[116:119], v[60:63], v[240:255]
    v_exp_f32 v230, v230
    v_exp_f32 v231, v231
    v_exp_f32 v232, v232
    v_smfmac_f32_16x16x64_bf16 v[16:19], v[28:31], v[208:215], v9
    v_exp_f32 v233, v233
    v_smfmac_f32_32x32x32_bf16 v[144:159], v[124:127], v[216:223], v9
    v_exp_f32 v234, v234
    v_exp_f32 v235, v235
    v_exp_f32 v236, v236
    v_smfmac_f32_16x16x64_bf16 v[16:19], v[28:31], v[216:223], v9
    buffer_load_dwordx4 v[104:107], v1, s[4:7], s56 offen offset:0 sc1
    v_exp_f32 v237, v237
    v_exp_f32 v238, v238
    v_exp_f32 v239, v239
    s_waitcnt vmcnt(7)
    v_mfma_f32_32x32x16_bf16 v[192:207], v[64:67], v[32:35], 0
    v_exp_f32 v240, v240
    v_exp_f32 v241, v241
    v_exp_f32 v242, v242
    v_smfmac_f32_32x32x32_bf16 v[160:175], v[120:123], v[224:231], v9
    v_exp_f32 v243, v243
    v_exp_f32 v244, v244
    v_exp_f32 v245, v245
    v_mfma_f32_32x32x16_bf16 v[192:207], v[68:71], v[36:39], v[192:207]
    v_exp_f32 v246, v246
    v_exp_f32 v247, v247
    v_exp_f32 v248, v248
    v_smfmac_f32_16x16x64_bf16 v[20:23], v[28:31], v[224:231], v9
    v_exp_f32 v249, v249
    v_smfmac_f32_32x32x32_bf16 v[160:175], v[124:127], v[232:239], v9
    v_exp_f32 v250, v250
    v_exp_f32 v251, v251
    v_exp_f32 v252, v252
    v_smfmac_f32_16x16x64_bf16 v[20:23], v[28:31], v[232:239], v9
    buffer_load_dwordx4 v[108:111], v1, s[4:7], s56 offen offset:1024 sc1
    v_exp_f32 v253, v253
    v_exp_f32 v254, v254
    v_exp_f32 v255, v255
    v_mfma_f32_32x32x16_bf16 v[208:223], v[64:67], v[40:43], 0
    s_add_u32 s54, s54, 8192
    s_and_b32 s54, s54, 0x1ffff
    s_add_u32 s55, s53, s54
    s_add_u32 s56, s55, 4194304
    v_exp_f32 v192, v192
    v_exp_f32 v193, v193
    v_exp_f32 v194, v194
    v_smfmac_f32_32x32x32_bf16 v[176:191], v[120:123], v[240:247], v9
    v_exp_f32 v195, v195
    v_exp_f32 v196, v196
    v_exp_f32 v197, v197
    v_mfma_f32_32x32x16_bf16 v[208:223], v[68:71], v[44:47], v[208:223]
    v_exp_f32 v198, v198
    v_exp_f32 v199, v199
    v_exp_f32 v200, v200
    v_smfmac_f32_16x16x64_bf16 v[24:27], v[28:31], v[240:247], v9
    v_exp_f32 v201, v201
    v_smfmac_f32_32x32x32_bf16 v[176:191], v[124:127], v[248:255], v9
    v_exp_f32 v202, v202
    v_exp_f32 v203, v203
    v_exp_f32 v204, v204
    v_smfmac_f32_16x16x64_bf16 v[24:27], v[28:31], v[248:255], v9
    buffer_load_dwordx4 v[112:115], v1, s[4:7], s55 offen offset:0 sc1
    v_exp_f32 v205, v205
    v_exp_f32 v206, v206
    v_exp_f32 v207, v207
    v_mfma_f32_32x32x16_bf16 v[224:239], v[64:67], v[48:51], 0
    v_exp_f32 v208, v208
    v_exp_f32 v209, v209
    v_exp_f32 v210, v210
    v_smfmac_f32_32x32x32_bf16 v[128:143], v[72:75], v[192:199], v9
    v_exp_f32 v211, v211
    v_exp_f32 v212, v212
    v_exp_f32 v213, v213
    v_mfma_f32_32x32x16_bf16 v[224:239], v[68:71], v[52:55], v[224:239]
    v_exp_f32 v214, v214
    v_exp_f32 v215, v215
    v_exp_f32 v216, v216
    v_smfmac_f32_16x16x64_bf16 v[12:15], v[28:31], v[192:199], v9
    v_exp_f32 v217, v217
    v_smfmac_f32_32x32x32_bf16 v[128:143], v[76:79], v[200:207], v9
    v_exp_f32 v218, v218
    v_exp_f32 v219, v219
    v_exp_f32 v220, v220
    v_smfmac_f32_16x16x64_bf16 v[12:15], v[28:31], v[200:207], v9
    buffer_load_dwordx4 v[116:119], v1, s[4:7], s55 offen offset:1024 sc1
    v_exp_f32 v221, v221
    v_exp_f32 v222, v222
    v_exp_f32 v223, v223
    s_sub_u32 s58, s58, 1
    s_cmp_lg_u32 s58, 0
    s_cbranch_scc1 b_loop
    v_mfma_f32_32x32x16_bf16 v[240:255], v[64:67], v[56:59], 0
    v_exp_f32 v224, v224
    v_exp_f32 v225, v225
    v_exp_f32 v226, v226
    v_smfmac_f32_32x32x32_bf16 v[144:159], v[72:75], v[208:215], v9
    v_exp_f32 v227, v227
    v_exp_f32 v228, v228
    v_exp_f32 v229, v229
    v_mfma_f32_32x32x16_bf16 v[240:255], v[68:71], v[60:63], v[240:255]
    v_exp_f32 v230, v230
    v_exp_f32 v231, v231
    v_exp_f32 v232, v232
    v_smfmac_f32_16x16x64_bf16 v[16:19], v[28:31], v[208:215], v9
    v_exp_f32 v233, v233
    v_smfmac_f32_32x32x32_bf16 v[144:159], v[76:79], v[216:223], v9
    v_exp_f32 v234, v234
    v_exp_f32 v235, v235
    v_exp_f32 v236, v236
    v_smfmac_f32_16x16x64_bf16 v[16:19], v[28:31], v[216:223], v9
    buffer_load_dwordx4 v[120:123], v1, s[4:7], s56 offen offset:0 sc1
    v_exp_f32 v237, v237
    v_exp_f32 v238, v238
    v_exp_f32 v239, v239
    s_waitcnt vmcnt(7)
    v_mfma_f32_32x32x16_bf16 v[192:207], v[80:83], v[32:35], 0
    v_exp_f32 v240, v240
    v_exp_f32 v241, v241
    v_exp_f32 v242, v242
    v_smfmac_f32_32x32x32_bf16 v[160:175], v[72:75], v[224:231], v9
    v_exp_f32 v243, v243
    v_exp_f32 v244, v244
    v_exp_f32 v245, v245
    v_mfma_f32_32x32x16_bf16 v[192:207], v[84:87], v[36:39], v[192:207]
    v_exp_f32 v246, v246
    v_exp_f32 v247, v247
    v_exp_f32 v248, v248
    v_smfmac_f32_16x16x64_bf16 v[20:23], v[28:31], v[224:231], v9
    v_exp_f32 v249, v249
    v_smfmac_f32_32x32x32_bf16 v[160:175], v[76:79], v[232:239], v9
    v_exp_f32 v250, v250
    v_exp_f32 v251, v251
    v_exp_f32 v252, v252
    v_smfmac_f32_16x16x64_bf16 v[20:23], v[28:31], v[232:239], v9
    buffer_load_dwordx4 v[124:127], v1, s[4:7], s56 offen offset:1024 sc1
    v_exp_f32 v253, v253
    v_exp_f32 v254, v254
    v_exp_f32 v255, v255
    s_add_u32 s53, s53, 131072
    s_cmp_eq_u32 s57, 0
    s_cselect_b32 s53, s53, 2146435072
    v_mfma_f32_32x32x16_bf16 v[208:223], v[80:83], v[40:43], 0
    s_add_u32 s54, s54, 8192
    s_and_b32 s54, s54, 0x1ffff
    s_add_u32 s55, s53, s54
    s_add_u32 s56, s55, 4194304
    v_exp_f32 v192, v192
    v_exp_f32 v193, v193
    v_exp_f32 v194, v194
    v_smfmac_f32_32x32x32_bf16 v[176:191], v[72:75], v[240:247], v9
    v_exp_f32 v195, v195
    v_exp_f32 v196, v196
    v_exp_f32 v197, v197
    v_mfma_f32_32x32x16_bf16 v[208:223], v[84:87], v[44:47], v[208:223]
    v_exp_f32 v198, v198
    v_exp_f32 v199, v199
    v_exp_f32 v200, v200
    v_smfmac_f32_16x16x64_bf16 v[24:27], v[28:31], v[240:247], v9
    v_exp_f32 v201, v201
    v_smfmac_f32_32x32x32_bf16 v[176:191], v[76:79], v[248:255], v9
    v_exp_f32 v202, v202
    v_exp_f32 v203, v203
    v_exp_f32 v204, v204
    v_smfmac_f32_16x16x64_bf16 v[24:27], v[28:31], v[248:255], v9
    buffer_load_dwordx4 v[64:67], v1, s[4:7], s55 offen offset:0 sc1
    v_exp_f32 v205, v205
    v_exp_f32 v206, v206
    v_exp_f32 v207, v207
    v_mfma_f32_32x32x16_bf16 v[224:239], v[80:83], v[48:51], 0
    v_exp_f32 v208, v208
    v_exp_f32 v209, v209
    v_exp_f32 v210, v210
    v_smfmac_f32_32x32x32_bf16 v[128:143], v[88:91], v[192:199], v9
    v_exp_f32 v211, v211
    v_exp_f32 v212, v212
    v_exp_f32 v213, v213
    v_mfma_f32_32x32x16_bf16 v[224:239], v[84:87], v[52:55], v[224:239]
    v_exp_f32 v214, v214
    v_exp_f32 v215, v215
    v_exp_f32 v216, v216
    v_smfmac_f32_16x16x64_bf16 v[12:15], v[28:31], v[192:199], v9
    v_exp_f32 v217, v217
    v_smfmac_f32_32x32x32_bf16 v[128:143], v[92:95], v[200:207], v9
    v_exp_f32 v218, v218
    v_exp_f32 v219, v219
    v_exp_f32 v220, v220
    v_smfmac_f32_16x16x64_bf16 v[12:15], v[28:31], v[200:207], v9
    buffer_load_dwordx4 v[68:71], v1, s[4:7], s55 offen offset:1024 sc1
    v_exp_f32 v221, v221
    v_exp_f32 v222, v222
    v_exp_f32 v223, v223
    v_mfma_f32_32x32x16_bf16 v[240:255], v[80:83], v[56:59], 0
    v_exp_f32 v224, v224
    v_exp_f32 v225, v225
    v_exp_f32 v226, v226
    v_smfmac_f32_32x32x32_bf16 v[144:159], v[88:91], v[208:215], v9
    v_exp_f32 v227, v227
    v_exp_f32 v228, v228
    v_exp_f32 v229, v229
    v_mfma_f32_32x32x16_bf16 v[240:255], v[84:87], v[60:63], v[240:255]
    v_exp_f32 v230, v230
    v_exp_f32 v231, v231
    v_exp_f32 v232, v232
    v_smfmac_f32_16x16x64_bf16 v[16:19], v[28:31], v[208:215], v9
    v_exp_f32 v233, v233
    v_smfmac_f32_32x32x32_bf16 v[144:159], v[92:95], v[216:223], v9
    v_exp_f32 v234, v234
    v_exp_f32 v235, v235
    v_exp_f32 v236, v236
    v_smfmac_f32_16x16x64_bf16 v[16:19], v[28:31], v[216:223], v9
    buffer_load_dwordx4 v[72:75], v1, s[4:7], s56 offen offset:0 sc1
    v_exp_f32 v237, v237
    v_exp_f32 v238, v238
    v_exp_f32 v239, v239
    s_waitcnt vmcnt(7)
    v_mfma_f32_32x32x16_bf16 v[192:207], v[96:99], v[32:35], 0
    v_exp_f32 v240, v240
    v_exp_f32 v241, v241
    v_exp_f32 v242, v242
    v_smfmac_f32_32x32x32_bf16 v[160:175], v[88:91], v[224:231], v9
    v_exp_f32 v243, v243
    v_exp_f32 v244, v244
    v_exp_f32 v245, v245
    v_mfma_f32_32x32x16_bf16 v[192:207], v[100:103], v[36:39], v[192:207]
    v_exp_f32 v246, v246
    v_exp_f32 v247, v247
    v_exp_f32 v248, v248
    v_smfmac_f32_16x16x64_bf16 v[20:23], v[28:31], v[224:231], v9
    v_exp_f32 v249, v249
    v_smfmac_f32_32x32x32_bf16 v[160:175], v[92:95], v[232:239], v9
    v_exp_f32 v250, v250
    v_exp_f32 v251, v251
    v_exp_f32 v252, v252
    v_smfmac_f32_16x16x64_bf16 v[20:23], v[28:31], v[232:239], v9
    buffer_load_dwordx4 v[76:79], v1, s[4:7], s56 offen offset:1024 sc1
    v_exp_f32 v253, v253
    v_exp_f32 v254, v254
    v_exp_f32 v255, v255
    v_mfma_f32_32x32x16_bf16 v[208:223], v[96:99], v[40:43], 0
    s_add_u32 s54, s54, 8192
    s_and_b32 s54, s54, 0x1ffff
    s_add_u32 s55, s53, s54
    s_add_u32 s56, s55, 4194304
    v_exp_f32 v192, v192
    v_exp_f32 v193, v193
    v_exp_f32 v194, v194
    v_smfmac_f32_32x32x32_bf16 v[176:191], v[88:91], v[240:247], v9
    v_exp_f32 v195, v195
    v_exp_f32 v196, v196
    v_exp_f32 v197, v197
    v_mfma_f32_32x32x16_bf16 v[208:223], v[100:103], v[44:47], v[208:223]
    v_exp_f32 v198, v198
    v_exp_f32 v199, v199
    v_exp_f32 v200, v200
    v_smfmac_f32_16x16x64_bf16 v[24:27], v[28:31], v[240:247], v9
    v_exp_f32 v201, v201
    v_smfmac_f32_32x32x32_bf16 v[176:191], v[92:95], v[248:255], v9
    v_exp_f32 v202, v202
    v_exp_f32 v203, v203
    v_exp_f32 v204, v204
    v_smfmac_f32_16x16x64_bf16 v[24:27], v[28:31], v[248:255], v9
    buffer_load_dwordx4 v[80:83], v1, s[4:7], s55 offen offset:0 sc1
    v_exp_f32 v205, v205
    v_exp_f32 v206, v206
    v_exp_f32 v207, v207
    v_mfma_f32_32x32x16_bf16 v[224:239], v[96:99], v[48:51], 0
    v_exp_f32 v208, v208
    v_exp_f32 v209, v209
    v_exp_f32 v210, v210
    v_smfmac_f32_32x32x32_bf16 v[128:143], v[104:107], v[192:199], v9
    v_exp_f32 v211, v211
    v_exp_f32 v212, v212
    v_exp_f32 v213, v213
    v_mfma_f32_32x32x16_bf16 v[224:239], v[100:103], v[52:55], v[224:239]
    v_exp_f32 v214, v214
    v_exp_f32 v215, v215
    v_exp_f32 v216, v216
    v_smfmac_f32_16x16x64_bf16 v[12:15], v[28:31], v[192:199], v9
    v_exp_f32 v217, v217
    v_smfmac_f32_32x32x32_bf16 v[128:143], v[108:111], v[200:207], v9
    v_exp_f32 v218, v218
    v_exp_f32 v219, v219
    v_exp_f32 v220, v220
    v_smfmac_f32_16x16x64_bf16 v[12:15], v[28:31], v[200:207], v9
    buffer_load_dwordx4 v[84:87], v1, s[4:7], s55 offen offset:1024 sc1
    v_exp_f32 v221, v221
    v_exp_f32 v222, v222
    v_exp_f32 v223, v223
    v_mfma_f32_32x32x16_bf16 v[240:255], v[96:99], v[56:59], 0
    v_exp_f32 v224, v224
    v_exp_f32 v225, v225
    v_exp_f32 v226, v226
    v_smfmac_f32_32x32x32_bf16 v[144:159], v[104:107], v[208:215], v9
    v_exp_f32 v227, v227
    v_exp_f32 v228, v228
    v_exp_f32 v229, v229
    v_mfma_f32_32x32x16_bf16 v[240:255], v[100:103], v[60:63], v[240:255]
    v_exp_f32 v230, v230
    v_exp_f32 v231, v231
    v_exp_f32 v232, v232
    v_smfmac_f32_16x16x64_bf16 v[16:19], v[28:31], v[208:215], v9
    v_exp_f32 v233, v233
    v_smfmac_f32_32x32x32_bf16 v[144:159], v[108:111], v[216:223], v9
    v_exp_f32 v234, v234
    v_exp_f32 v235, v235
    v_exp_f32 v236, v236
    v_smfmac_f32_16x16x64_bf16 v[16:19], v[28:31], v[216:223], v9
    buffer_load_dwordx4 v[88:91], v1, s[4:7], s56 offen offset:0 sc1
    v_exp_f32 v237, v237
    v_exp_f32 v238, v238
    v_exp_f32 v239, v239
    s_waitcnt vmcnt(7)
    v_mfma_f32_32x32x16_bf16 v[192:207], v[112:115], v[32:35], 0
    v_exp_f32 v240, v240
    v_exp_f32 v241, v241
    v_exp_f32 v242, v242
    v_smfmac_f32_32x32x32_bf16 v[160:175], v[104:107], v[224:231], v9
    v_exp_f32 v243, v243
    v_exp_f32 v244, v244
    v_exp_f32 v245, v245
    v_mfma_f32_32x32x16_bf16 v[192:207], v[116:119], v[36:39], v[192:207]
    v_exp_f32 v246, v246
    v_exp_f32 v247, v247
    v_exp_f32 v248, v248
    v_smfmac_f32_16x16x64_bf16 v[20:23], v[28:31], v[224:231], v9
    v_exp_f32 v249, v249
    v_smfmac_f32_32x32x32_bf16 v[160:175], v[108:111], v[232:239], v9
    v_exp_f32 v250, v250
    v_exp_f32 v251, v251
    v_exp_f32 v252, v252
    v_smfmac_f32_16x16x64_bf16 v[20:23], v[28:31], v[232:239], v9
    buffer_load_dwordx4 v[92:95], v1, s[4:7], s56 offen offset:1024 sc1
    v_exp_f32 v253, v253
    v_exp_f32 v254, v254
    v_exp_f32 v255, v255
    s_barrier
    v_mfma_f32_32x32x16_bf16 v[208:223], v[112:115], v[40:43], 0
    s_add_u32 s54, s54, 8192
    s_and_b32 s54, s54, 0x1ffff
    s_add_u32 s55, s53, s54
    s_add_u32 s56, s55, 4194304
    ds_read_b128 v[32:35], v4 offset:8192
    ds_read_b128 v[36:39], v4 offset:9216
    v_exp_f32 v192, v192
    v_exp_f32 v193, v193
    v_exp_f32 v194, v194
    v_smfmac_f32_32x32x32_bf16 v[176:191], v[104:107], v[240:247], v9
    v_exp_f32 v195, v195
    v_exp_f32 v196, v196
    v_exp_f32 v197, v197
    v_mfma_f32_32x32x16_bf16 v[208:223], v[116:119], v[44:47], v[208:223]
    v_exp_f32 v198, v198
    v_exp_f32 v199, v199
    v_exp_f32 v200, v200
    v_smfmac_f32_16x16x64_bf16 v[24:27], v[28:31], v[240:247], v9
    v_exp_f32 v201, v201
    v_smfmac_f32_32x32x32_bf16 v[176:191], v[108:111], v[248:255], v9
    v_exp_f32 v202, v202
    v_exp_f32 v203, v203
    v_exp_f32 v204, v204
    v_smfmac_f32_16x16x64_bf16 v[24:27], v[28:31], v[248:255], v9
    buffer_load_dwordx4 v[96:99], v1, s[4:7], s55 offen offset:0 sc1
    v_exp_f32 v205, v205
    v_exp_f32 v206, v206
    v_exp_f32 v207, v207
    v_mfma_f32_32x32x16_bf16 v[224:239], v[112:115], v[48:51], 0
    ds_read_b128 v[40:43], v4 offset:10240
    ds_read_b128 v[44:47], v4 offset:11264
    v_exp_f32 v208, v208
    v_exp_f32 v209, v209
    v_exp_f32 v210, v210
    v_smfmac_f32_32x32x32_bf16 v[128:143], v[120:123], v[192:199], v9
    v_exp_f32 v211, v211
    v_exp_f32 v212, v212
    v_exp_f32 v213, v213
    v_mfma_f32_32x32x16_bf16 v[224:239], v[116:119], v[52:55], v[224:239]
    v_exp_f32 v214, v214
    v_exp_f32 v215, v215
    v_exp_f32 v216, v216
    v_smfmac_f32_16x16x64_bf16 v[12:15], v[28:31], v[192:199], v9
    v_exp_f32 v217, v217
    v_smfmac_f32_32x32x32_bf16 v[128:143], v[124:127], v[200:207], v9
    v_exp_f32 v218, v218
    v_exp_f32 v219, v219
    v_exp_f32 v220, v220
    v_smfmac_f32_16x16x64_bf16 v[12:15], v[28:31], v[200:207], v9
    buffer_load_dwordx4 v[100:103], v1, s[4:7], s55 offen offset:1024 sc1
    v_exp_f32 v221, v221
    v_exp_f32 v222, v222
    v_exp_f32 v223, v223
    v_mfma_f32_32x32x16_bf16 v[240:255], v[112:115], v[56:59], 0
    ds_read_b128 v[48:51], v4 offset:12288
    ds_read_b128 v[52:55], v4 offset:13312
    v_exp_f32 v224, v224
    v_exp_f32 v225, v225
    v_exp_f32 v226, v226
    v_smfmac_f32_32x32x32_bf16 v[144:159], v[120:123], v[208:215], v9
    v_exp_f32 v227, v227
    ds_write_b128 v5, v[128:131] offset:0
    v_exp_f32 v228, v228
    v_exp_f32 v229, v229
    v_mfma_f32_32x32x16_bf16 v[240:255], v[116:119], v[60:63], v[240:255]
    ds_write_b128 v5, v[132:135] offset:1024
    v_exp_f32 v230, v230
    v_exp_f32 v231, v231
    v_exp_f32 v232, v232
    v_smfmac_f32_16x16x64_bf16 v[16:19], v[28:31], v[208:215], v9
    ds_write_b32 v6, v12 offset:0
    v_exp_f32 v233, v233
    v_smfmac_f32_32x32x32_bf16 v[144:159], v[124:127], v[216:223], v9
    ds_write_b128 v5, v[136:139] offset:2048
    v_exp_f32 v234, v234
    v_exp_f32 v235, v235
    v_exp_f32 v236, v236
    v_smfmac_f32_16x16x64_bf16 v[16:19], v[28:31], v[216:223], v9
    buffer_load_dwordx4 v[104:107], v1, s[4:7], s56 offen offset:0 sc1
    ds_write_b128 v5, v[140:143] offset:3072
    v_exp_f32 v237, v237
    v_exp_f32 v238, v238
    v_exp_f32 v239, v239
    s_waitcnt vmcnt(7)
    s_waitcnt lgkmcnt(9)
    v_mfma_f32_32x32x16_bf16 v[192:207], v[64:67], v[32:35], 0
    ds_read_b128 v[56:59], v4 offset:14336
    ds_read_b128 v[60:63], v4 offset:15360
    v_exp_f32 v240, v240
    v_exp_f32 v241, v241
    v_exp_f32 v242, v242
    v_smfmac_f32_32x32x32_bf16 v[160:175], v[120:123], v[224:231], v9
    v_exp_f32 v243, v243
    ds_write_b128 v5, v[144:147] offset:16384
    v_exp_f32 v244, v244
    v_exp_f32 v245, v245
    v_mfma_f32_32x32x16_bf16 v[192:207], v[68:71], v[36:39], v[192:207]
    ds_write_b128 v5, v[148:151] offset:17408
    v_exp_f32 v246, v246
    v_exp_f32 v247, v247
    v_exp_f32 v248, v248
    s_waitcnt lgkmcnt(4)
    v_mfma_f32_32x32x8_bf16 v[128:143], v[10:11], v[10:11], 0
    v_mov_b32 v12, 0
    v_smfmac_f32_16x16x64_bf16 v[20:23], v[28:31], v[224:231], v9
    ds_write_b32 v6, v16 offset:1024
    v_exp_f32 v249, v249
    v_smfmac_f32_32x32x32_bf16 v[160:175], v[124:127], v[232:239], v9
    ds_write_b128 v5, v[152:155] offset:18432
    v_exp_f32 v250, v250
    v_exp_f32 v251, v251
    v_exp_f32 v252, v252
    v_smfmac_f32_16x16x64_bf16 v[20:23], v[28:31], v[232:239], v9
    buffer_load_dwordx4 v[108:111], v1, s[4:7], s56 offen offset:1024 sc1
    ds_write_b128 v5, v[156:159] offset:19456
    v_exp_f32 v253, v253
    v_exp_f32 v254, v254
    v_exp_f32 v255, v255
    s_cmp_lg_u32 s57, 0
    s_cbranch_scc1 b_tail
    v_mfma_f32_32x32x16_bf16 v[208:223], v[64:67], v[40:43], 0
    s_add_u32 s54, s54, 8192
    s_and_b32 s54, s54, 0x1ffff
    s_add_u32 s55, s53, s54
    s_add_u32 s56, s55, 4194304
    v_exp_f32 v192, v192
    v_exp_f32 v193, v193
    v_exp_f32 v194, v194
    v_smfmac_f32_32x32x32_bf16 v[176:191], v[120:123], v[240:247], v9
    v_exp_f32 v195, v195
    ds_write_b128 v5, v[160:163] offset:32768
    v_exp_f32 v196, v196
    v_exp_f32 v197, v197
    v_mfma_f32_32x32x16_bf16 v[208:223], v[68:71], v[44:47], v[208:223]
    ds_write_b128 v5, v[164:167] offset:33792
    v_exp_f32 v198, v198
    v_exp_f32 v199, v199
    v_exp_f32 v200, v200
    s_waitcnt lgkmcnt(2)
    v_mfma_f32_32x32x8_bf16 v[144:159], v[10:11], v[10:11], 0
    v_mov_b32 v16, 0
    v_smfmac_f32_16x16x64_bf16 v[24:27], v[28:31], v[240:247], v9
    ds_write_b32 v6, v20 offset:2048
    v_exp_f32 v201, v201
    v_smfmac_f32_32x32x32_bf16 v[176:191], v[124:127], v[248:255], v9
    ds_write_b128 v5, v[168:171] offset:34816
    v_exp_f32 v202, v202
    v_exp_f32 v203, v203
    v_exp_f32 v204, v204
    v_smfmac_f32_16x16x64_bf16 v[24:27], v[28:31], v[248:255], v9
    buffer_load_dwordx4 v[112:115], v1, s[4:7], s55 offen offset:0 sc1
    ds_write_b128 v5, v[172:175] offset:35840
    v_exp_f32 v205, v205
    v_exp_f32 v206, v206
    v_exp_f32 v207, v207
    v_mfma_f32_32x32x16_bf16 v[224:239], v[64:67], v[48:51], 0
    v_exp_f32 v208, v208
    v_exp_f32 v209, v209
    v_exp_f32 v210, v210
    v_smfmac_f32_32x32x32_bf16 v[128:143], v[72:75], v[192:199], v9
    v_exp_f32 v211, v211
    ds_write_b128 v5, v[176:179] offset:49152
    v_exp_f32 v212, v212
    v_exp_f32 v213, v213
    v_mfma_f32_32x32x16_bf16 v[224:239], v[68:71], v[52:55], v[224:239]
    ds_write_b128 v5, v[180:183] offset:50176
    v_exp_f32 v214, v214
    v_exp_f32 v215, v215
    v_exp_f32 v216, v216
    s_waitcnt lgkmcnt(2)
    v_mfma_f32_32x32x8_bf16 v[160:175], v[10:11], v[10:11], 0
    v_mov_b32 v20, 0
    v_smfmac_f32_16x16x64_bf16 v[12:15], v[28:31], v[192:199], v9
    ds_write_b32 v6, v24 offset:3072
    v_exp_f32 v217, v217
    v_smfmac_f32_32x32x32_bf16 v[128:143], v[76:79], v[200:207], v9
    ds_write_b128 v5, v[184:187] offset:51200
    v_exp_f32 v218, v218
    v_exp_f32 v219, v219
    v_exp_f32 v220, v220
    v_smfmac_f32_16x16x64_bf16 v[12:15], v[28:31], v[200:207], v9
    buffer_load_dwordx4 v[116:119], v1, s[4:7], s55 offen offset:1024 sc1
    ds_write_b128 v5, v[188:191] offset:52224
    v_exp_f32 v221, v221
    v_exp_f32 v222, v222
    v_exp_f32 v223, v223
    s_waitcnt lgkmcnt(0)
    v_mfma_f32_32x32x8_bf16 v[176:191], v[10:11], v[10:11], 0
    v_mov_b32 v24, 0
    s_barrier
    s_mov_b32 s57, 1
    s_branch b_head
b_tail:
    v_smfmac_f32_32x32x32_bf16 v[176:191], v[120:123], v[240:247], v9
    v_smfmac_f32_32x32x32_bf16 v[176:191], v[124:127], v[248:255], v9
    ds_write_b128 v5, v[160:163] offset:32768
    ds_write_b128 v5, v[164:167] offset:33792
    v_smfmac_f32_16x16x64_bf16 v[24:27], v[28:31], v[240:247], v9
    ds_write_b128 v5, v[168:171] offset:34816
    v_smfmac_f32_16x16x64_bf16 v[24:27], v[28:31], v[248:255], v9
    ds_write_b128 v5, v[172:175] offset:35840
    ds_write_b32 v6, v20 offset:2048
    s_nop 4
    ds_write_b128 v5, v[176:179] offset:49152
    ds_write_b128 v5, v[180:183] offset:50176
    ds_write_b128 v5, v[184:187] offset:51200
    ds_write_b128 v5, v[188:191] offset:52224
    s_nop 0
    ds_write_b32 v6, v24 offset:3072
    buffer_load_dwordx4 v[224:227], v2, s[4:7], s43 offen offset:0 sc1
    buffer_load_dwordx4 v[228:231], v2, s[4:7], s43 offen offset:256 sc1
    buffer_load_dwordx4 v[232:235], v2, s[4:7], s43 offen offset:2048 sc1
    buffer_load_dwordx4 v[236:239], v2, s[4:7], s43 offen offset:2304 sc1
    s_waitcnt lgkmcnt(0)
    s_barrier
    v_xor_b32 v4, 32, v3
    v_xor_b32 v5, 64, v3
    v_xor_b32 v6, 96, v3
c_wo:
    s_xor_b32 s42, s41, 0
    buffer_load_dwordx4 v[64:67], v2, s[4:7], s42 offen offset:0 sc1
    buffer_load_dwordx4 v[68:71], v2, s[4:7], s42 offen offset:256 sc1
    s_xor_b32 s42, s41, 4096
    buffer_load_dwordx4 v[72:75], v2, s[4:7], s42 offen offset:0 sc1
    buffer_load_dwordx4 v[76:79], v2, s[4:7], s42 offen offset:256 sc1
    s_xor_b32 s42, s41, 8192
    buffer_load_dwordx4 v[80:83], v2, s[4:7], s42 offen offset:0 sc1
    buffer_load_dwordx4 v[84:87], v2, s[4:7], s42 offen offset:256 sc1
    s_xor_b32 s42, s41, 12288
    buffer_load_dwordx4 v[88:91], v2, s[4:7], s42 offen offset:0 sc1
    buffer_load_dwordx4 v[92:95], v2, s[4:7], s42 offen offset:256 sc1
    s_xor_b32 s42, s41, 16384
    buffer_load_dwordx4 v[96:99], v2, s[4:7], s42 offen offset:0 sc1
    buffer_load_dwordx4 v[100:103], v2, s[4:7], s42 offen offset:256 sc1
    ds_read_b64_tr_b16 v[32:33], v3 offset:0
    ds_read_b64_tr_b16 v[34:35], v3 offset:1024
    ds_read_b64_tr_b16 v[36:37], v4 offset:0
    ds_read_b64_tr_b16 v[38:39], v4 offset:1024
    ds_read_b64_tr_b16 v[40:41], v5 offset:0
    ds_read_b64_tr_b16 v[42:43], v5 offset:1024
    ds_read_b64_tr_b16 v[44:45], v6 offset:0
    ds_read_b64_tr_b16 v[46:47], v6 offset:1024
    ds_read_b64_tr_b16 v[48:49], v3 offset:4096
    ds_read_b64_tr_b16 v[50:51], v3 offset:5120
    ds_read_b64_tr_b16 v[52:53], v4 offset:4096
    ds_read_b64_tr_b16 v[54:55], v4 offset:5120
    ds_read_b64_tr_b16 v[56:57], v5 offset:4096
    ds_read_b64_tr_b16 v[58:59], v5 offset:5120
    v_lshrrev_b32 v12, 4, v1
    v_and_b32 v13, 1, v12
    v_lshlrev_b32 v13, 4, v13
    v_mov_b32 v14, 0x3f80
    v_lshlrev_b32 v13, v13, v14
    v_lshrrev_b32 v14, 2, v12
    v_lshrrev_b32 v15, 4, v12
    v_xor_b32 v14, v14, v15
    v_and_b32 v14, 1, v14
    v_bfe_u32 v15, v12, 3, 1
    v_bfe_u32 v16, v12, 1, 1
    v_lshl_add_u32 v15, v15, 1, v16
    v_lshrrev_b32 v16, 5, v12
    v_lshl_add_u32 v15, v16, 2, v15
    v_lshl_add_u32 v15, v14, 3, v15
    v_cmp_eq_u32 vcc, 0, v15
    s_nop 1
    v_cndmask_b32 v240, 0, v13, vcc
    v_cmp_eq_u32 vcc, 1, v15
    s_nop 1
    v_cndmask_b32 v241, 0, v13, vcc
    v_cmp_eq_u32 vcc, 2, v15
    s_nop 1
    v_cndmask_b32 v242, 0, v13, vcc
    v_cmp_eq_u32 vcc, 3, v15
    s_nop 1
    v_cndmask_b32 v243, 0, v13, vcc
    v_cmp_eq_u32 vcc, 4, v15
    s_nop 1
    v_cndmask_b32 v244, 0, v13, vcc
    v_cmp_eq_u32 vcc, 5, v15
    s_nop 1
    v_cndmask_b32 v245, 0, v13, vcc
    v_cmp_eq_u32 vcc, 6, v15
    s_nop 1
    v_cndmask_b32 v246, 0, v13, vcc
    v_cmp_eq_u32 vcc, 7, v15
    s_nop 1
    v_cndmask_b32 v247, 0, v13, vcc
    s_waitcnt vmcnt(10)
    v_mfma_f32_16x16x32_bf16 v[128:131], v[240:243], v[224:227], 0
    v_mfma_f32_16x16x32_bf16 v[132:135], v[240:243], v[228:231], 0
    v_mfma_f32_16x16x32_bf16 v[136:139], v[244:247], v[224:227], 0
    v_mfma_f32_16x16x32_bf16 v[140:143], v[244:247], v[228:231], 0
    v_mfma_f32_16x16x32_bf16 v[144:147], v[240:243], v[232:235], 0
    v_mfma_f32_16x16x32_bf16 v[148:151], v[240:243], v[236:239], 0
    v_mfma_f32_16x16x32_bf16 v[152:155], v[244:247], v[232:235], 0
    v_mfma_f32_16x16x32_bf16 v[156:159], v[244:247], v[236:239], 0
    s_waitcnt vmcnt(8) lgkmcnt(10)
    v_mfma_f32_16x16x32_bf16 v[128:131], v[32:35], v[64:67], v[128:131]
    ds_read_b64_tr_b16 v[60:61], v6 offset:4096
    s_xor_b32 s42, s41, 20480
    buffer_load_dwordx4 v[104:107], v2, s[4:7], s42 offen offset:0 sc1
    v_mfma_f32_16x16x32_bf16 v[132:135], v[32:35], v[68:71], v[132:135]
    ds_read_b64_tr_b16 v[62:63], v6 offset:5120
    v_mfma_f32_16x16x32_bf16 v[136:139], v[36:39], v[64:67], v[136:139]
    ds_read_b64_tr_b16 v[32:33], v3 offset:8192
    v_mfma_f32_16x16x32_bf16 v[140:143], v[36:39], v[68:71], v[140:143]
    ds_read_b64_tr_b16 v[34:35], v3 offset:9216
    s_waitcnt lgkmcnt(10)
    v_mfma_f32_16x16x32_bf16 v[144:147], v[40:43], v[64:67], v[144:147]
    buffer_load_dwordx4 v[108:111], v2, s[4:7], s42 offen offset:256 sc1
    ds_read_b64_tr_b16 v[36:37], v4 offset:8192
    s_xor_b32 s42, s41, 24576
    v_mfma_f32_16x16x32_bf16 v[148:151], v[40:43], v[68:71], v[148:151]
    ds_read_b64_tr_b16 v[38:39], v4 offset:9216
    v_mfma_f32_16x16x32_bf16 v[152:155], v[44:47], v[64:67], v[152:155]
    ds_read_b64_tr_b16 v[40:41], v5 offset:8192
    v_mfma_f32_16x16x32_bf16 v[156:159], v[44:47], v[68:71], v[156:159]
    ds_read_b64_tr_b16 v[42:43], v5 offset:9216
    s_waitcnt vmcnt(8) lgkmcnt(10)
    v_mfma_f32_16x16x32_bf16 v[128:131], v[48:51], v[72:75], v[128:131]
    buffer_load_dwordx4 v[112:115], v2, s[4:7], s42 offen offset:0 sc1
    ds_read_b64_tr_b16 v[44:45], v6 offset:8192
    v_mfma_f32_16x16x32_bf16 v[132:135], v[48:51], v[76:79], v[132:135]
    ds_read_b64_tr_b16 v[46:47], v6 offset:9216
    v_mfma_f32_16x16x32_bf16 v[136:139], v[52:55], v[72:75], v[136:139]
    ds_read_b64_tr_b16 v[48:49], v3 offset:12288
    v_mfma_f32_16x16x32_bf16 v[140:143], v[52:55], v[76:79], v[140:143]
    ds_read_b64_tr_b16 v[50:51], v3 offset:13312
    s_waitcnt lgkmcnt(10)
    v_mfma_f32_16x16x32_bf16 v[144:147], v[56:59], v[72:75], v[144:147]
    buffer_load_dwordx4 v[116:119], v2, s[4:7], s42 offen offset:256 sc1
    ds_read_b64_tr_b16 v[52:53], v4 offset:12288
    s_xor_b32 s42, s41, 28672
    v_mfma_f32_16x16x32_bf16 v[148:151], v[56:59], v[76:79], v[148:151]
    ds_read_b64_tr_b16 v[54:55], v4 offset:13312
    v_mfma_f32_16x16x32_bf16 v[152:155], v[60:63], v[72:75], v[152:155]
    ds_read_b64_tr_b16 v[56:57], v5 offset:12288
    v_mfma_f32_16x16x32_bf16 v[156:159], v[60:63], v[76:79], v[156:159]
    ds_read_b64_tr_b16 v[58:59], v5 offset:13312
    s_waitcnt vmcnt(8) lgkmcnt(10)
    v_mfma_f32_16x16x32_bf16 v[128:131], v[32:35], v[80:83], v[128:131]
    ds_read_b64_tr_b16 v[60:61], v6 offset:12288
    buffer_load_dwordx4 v[120:123], v2, s[4:7], s42 offen offset:0 sc1
    v_mfma_f32_16x16x32_bf16 v[132:135], v[32:35], v[84:87], v[132:135]
    ds_read_b64_tr_b16 v[62:63], v6 offset:13312
    v_mfma_f32_16x16x32_bf16 v[136:139], v[36:39], v[80:83], v[136:139]
    ds_read_b64_tr_b16 v[32:33], v3 offset:16384
    v_mfma_f32_16x16x32_bf16 v[140:143], v[36:39], v[84:87], v[140:143]
    ds_read_b64_tr_b16 v[34:35], v3 offset:17408
    s_waitcnt lgkmcnt(10)
    v_mfma_f32_16x16x32_bf16 v[144:147], v[40:43], v[80:83], v[144:147]
    buffer_load_dwordx4 v[124:127], v2, s[4:7], s42 offen offset:256 sc1
    ds_read_b64_tr_b16 v[36:37], v4 offset:16384
    s_xor_b32 s42, s41, 32768
    v_mfma_f32_16x16x32_bf16 v[148:151], v[40:43], v[84:87], v[148:151]
    ds_read_b64_tr_b16 v[38:39], v4 offset:17408
    v_mfma_f32_16x16x32_bf16 v[152:155], v[44:47], v[80:83], v[152:155]
    ds_read_b64_tr_b16 v[40:41], v5 offset:16384
    v_mfma_f32_16x16x32_bf16 v[156:159], v[44:47], v[84:87], v[156:159]
    ds_read_b64_tr_b16 v[42:43], v5 offset:17408
    s_waitcnt vmcnt(8) lgkmcnt(10)
    v_mfma_f32_16x16x32_bf16 v[128:131], v[48:51], v[88:91], v[128:131]
    buffer_load_dwordx4 v[160:163], v2, s[4:7], s42 offen offset:0 sc1
    ds_read_b64_tr_b16 v[44:45], v6 offset:16384
    v_mfma_f32_16x16x32_bf16 v[132:135], v[48:51], v[92:95], v[132:135]
    ds_read_b64_tr_b16 v[46:47], v6 offset:17408
    v_mfma_f32_16x16x32_bf16 v[136:139], v[52:55], v[88:91], v[136:139]
    ds_read_b64_tr_b16 v[48:49], v3 offset:20480
    v_mfma_f32_16x16x32_bf16 v[140:143], v[52:55], v[92:95], v[140:143]
    ds_read_b64_tr_b16 v[50:51], v3 offset:21504
    s_waitcnt lgkmcnt(10)
    v_mfma_f32_16x16x32_bf16 v[144:147], v[56:59], v[88:91], v[144:147]
    buffer_load_dwordx4 v[164:167], v2, s[4:7], s42 offen offset:256 sc1
    ds_read_b64_tr_b16 v[52:53], v4 offset:20480
    s_xor_b32 s42, s41, 36864
    v_mfma_f32_16x16x32_bf16 v[148:151], v[56:59], v[92:95], v[148:151]
    ds_read_b64_tr_b16 v[54:55], v4 offset:21504
    v_mfma_f32_16x16x32_bf16 v[152:155], v[60:63], v[88:91], v[152:155]
    ds_read_b64_tr_b16 v[56:57], v5 offset:20480
    v_mfma_f32_16x16x32_bf16 v[156:159], v[60:63], v[92:95], v[156:159]
    ds_read_b64_tr_b16 v[58:59], v5 offset:21504
    s_waitcnt vmcnt(8) lgkmcnt(10)
    v_mfma_f32_16x16x32_bf16 v[128:131], v[32:35], v[96:99], v[128:131]
    ds_read_b64_tr_b16 v[60:61], v6 offset:20480
    buffer_load_dwordx4 v[168:171], v2, s[4:7], s42 offen offset:0 sc1
    v_mfma_f32_16x16x32_bf16 v[132:135], v[32:35], v[100:103], v[132:135]
    ds_read_b64_tr_b16 v[62:63], v6 offset:21504
    v_mfma_f32_16x16x32_bf16 v[136:139], v[36:39], v[96:99], v[136:139]
    ds_read_b64_tr_b16 v[32:33], v3 offset:24576
    v_mfma_f32_16x16x32_bf16 v[140:143], v[36:39], v[100:103], v[140:143]
    ds_read_b64_tr_b16 v[34:35], v3 offset:25600
    s_waitcnt lgkmcnt(10)
    v_mfma_f32_16x16x32_bf16 v[144:147], v[40:43], v[96:99], v[144:147]
    buffer_load_dwordx4 v[172:175], v2, s[4:7], s42 offen offset:256 sc1
    ds_read_b64_tr_b16 v[36:37], v4 offset:24576
    s_xor_b32 s42, s41, 40960
    v_mfma_f32_16x16x32_bf16 v[148:151], v[40:43], v[100:103], v[148:151]
    ds_read_b64_tr_b16 v[38:39], v4 offset:25600
    v_mfma_f32_16x16x32_bf16 v[152:155], v[44:47], v[96:99], v[152:155]
    ds_read_b64_tr_b16 v[40:41], v5 offset:24576
    v_mfma_f32_16x16x32_bf16 v[156:159], v[44:47], v[100:103], v[156:159]
    ds_read_b64_tr_b16 v[42:43], v5 offset:25600
    s_waitcnt vmcnt(8) lgkmcnt(10)
    v_mfma_f32_16x16x32_bf16 v[128:131], v[48:51], v[104:107], v[128:131]
    buffer_load_dwordx4 v[176:179], v2, s[4:7], s42 offen offset:0 sc1
    ds_read_b64_tr_b16 v[44:45], v6 offset:24576
    v_mfma_f32_16x16x32_bf16 v[132:135], v[48:51], v[108:111], v[132:135]
    ds_read_b64_tr_b16 v[46:47], v6 offset:25600
    v_mfma_f32_16x16x32_bf16 v[136:139], v[52:55], v[104:107], v[136:139]
    ds_read_b64_tr_b16 v[48:49], v3 offset:28672
    v_mfma_f32_16x16x32_bf16 v[140:143], v[52:55], v[108:111], v[140:143]
    ds_read_b64_tr_b16 v[50:51], v3 offset:29696
    s_waitcnt lgkmcnt(10)
    v_mfma_f32_16x16x32_bf16 v[144:147], v[56:59], v[104:107], v[144:147]
    buffer_load_dwordx4 v[180:183], v2, s[4:7], s42 offen offset:256 sc1
    ds_read_b64_tr_b16 v[52:53], v4 offset:28672
    s_xor_b32 s42, s41, 45056
    v_mfma_f32_16x16x32_bf16 v[148:151], v[56:59], v[108:111], v[148:151]
    ds_read_b64_tr_b16 v[54:55], v4 offset:29696
    v_mfma_f32_16x16x32_bf16 v[152:155], v[60:63], v[104:107], v[152:155]
    ds_read_b64_tr_b16 v[56:57], v5 offset:28672
    v_mfma_f32_16x16x32_bf16 v[156:159], v[60:63], v[108:111], v[156:159]
    ds_read_b64_tr_b16 v[58:59], v5 offset:29696
    s_waitcnt vmcnt(8) lgkmcnt(10)
    v_mfma_f32_16x16x32_bf16 v[128:131], v[32:35], v[112:115], v[128:131]
    ds_read_b64_tr_b16 v[60:61], v6 offset:28672
    buffer_load_dwordx4 v[184:187], v2, s[4:7], s42 offen offset:0 sc1
    v_mfma_f32_16x16x32_bf16 v[132:135], v[32:35], v[116:119], v[132:135]
    ds_read_b64_tr_b16 v[62:63], v6 offset:29696
    v_mfma_f32_16x16x32_bf16 v[136:139], v[36:39], v[112:115], v[136:139]
    ds_read_b64_tr_b16 v[32:33], v3 offset:32768
    v_mfma_f32_16x16x32_bf16 v[140:143], v[36:39], v[116:119], v[140:143]
    ds_read_b64_tr_b16 v[34:35], v3 offset:33792
    s_waitcnt lgkmcnt(10)
    v_mfma_f32_16x16x32_bf16 v[144:147], v[40:43], v[112:115], v[144:147]
    buffer_load_dwordx4 v[188:191], v2, s[4:7], s42 offen offset:256 sc1
    ds_read_b64_tr_b16 v[36:37], v4 offset:32768
    s_xor_b32 s42, s41, 49152
    v_mfma_f32_16x16x32_bf16 v[148:151], v[40:43], v[116:119], v[148:151]
    ds_read_b64_tr_b16 v[38:39], v4 offset:33792
    v_mfma_f32_16x16x32_bf16 v[152:155], v[44:47], v[112:115], v[152:155]
    ds_read_b64_tr_b16 v[40:41], v5 offset:32768
    v_mfma_f32_16x16x32_bf16 v[156:159], v[44:47], v[116:119], v[156:159]
    ds_read_b64_tr_b16 v[42:43], v5 offset:33792
    s_waitcnt vmcnt(8) lgkmcnt(10)
    v_mfma_f32_16x16x32_bf16 v[128:131], v[48:51], v[120:123], v[128:131]
    buffer_load_dwordx4 v[64:67], v2, s[4:7], s42 offen offset:0 sc1
    ds_read_b64_tr_b16 v[44:45], v6 offset:32768
    v_mfma_f32_16x16x32_bf16 v[132:135], v[48:51], v[124:127], v[132:135]
    ds_read_b64_tr_b16 v[46:47], v6 offset:33792
    v_mfma_f32_16x16x32_bf16 v[136:139], v[52:55], v[120:123], v[136:139]
    ds_read_b64_tr_b16 v[48:49], v3 offset:36864
    v_mfma_f32_16x16x32_bf16 v[140:143], v[52:55], v[124:127], v[140:143]
    ds_read_b64_tr_b16 v[50:51], v3 offset:37888
    s_waitcnt lgkmcnt(10)
    v_mfma_f32_16x16x32_bf16 v[144:147], v[56:59], v[120:123], v[144:147]
    buffer_load_dwordx4 v[68:71], v2, s[4:7], s42 offen offset:256 sc1
    ds_read_b64_tr_b16 v[52:53], v4 offset:36864
    s_xor_b32 s42, s41, 53248
    v_mfma_f32_16x16x32_bf16 v[148:151], v[56:59], v[124:127], v[148:151]
    ds_read_b64_tr_b16 v[54:55], v4 offset:37888
    v_mfma_f32_16x16x32_bf16 v[152:155], v[60:63], v[120:123], v[152:155]
    ds_read_b64_tr_b16 v[56:57], v5 offset:36864
    v_mfma_f32_16x16x32_bf16 v[156:159], v[60:63], v[124:127], v[156:159]
    ds_read_b64_tr_b16 v[58:59], v5 offset:37888
    s_waitcnt vmcnt(8) lgkmcnt(10)
    v_mfma_f32_16x16x32_bf16 v[128:131], v[32:35], v[160:163], v[128:131]
    ds_read_b64_tr_b16 v[60:61], v6 offset:36864
    buffer_load_dwordx4 v[72:75], v2, s[4:7], s42 offen offset:0 sc1
    v_mfma_f32_16x16x32_bf16 v[132:135], v[32:35], v[164:167], v[132:135]
    ds_read_b64_tr_b16 v[62:63], v6 offset:37888
    v_mfma_f32_16x16x32_bf16 v[136:139], v[36:39], v[160:163], v[136:139]
    ds_read_b64_tr_b16 v[32:33], v3 offset:40960
    v_mfma_f32_16x16x32_bf16 v[140:143], v[36:39], v[164:167], v[140:143]
    ds_read_b64_tr_b16 v[34:35], v3 offset:41984
    s_waitcnt lgkmcnt(10)
    v_mfma_f32_16x16x32_bf16 v[144:147], v[40:43], v[160:163], v[144:147]
    buffer_load_dwordx4 v[76:79], v2, s[4:7], s42 offen offset:256 sc1
    ds_read_b64_tr_b16 v[36:37], v4 offset:40960
    s_xor_b32 s42, s41, 57344
    v_mfma_f32_16x16x32_bf16 v[148:151], v[40:43], v[164:167], v[148:151]
    ds_read_b64_tr_b16 v[38:39], v4 offset:41984
    v_mfma_f32_16x16x32_bf16 v[152:155], v[44:47], v[160:163], v[152:155]
    ds_read_b64_tr_b16 v[40:41], v5 offset:40960
    v_mfma_f32_16x16x32_bf16 v[156:159], v[44:47], v[164:167], v[156:159]
    ds_read_b64_tr_b16 v[42:43], v5 offset:41984
    s_waitcnt vmcnt(8) lgkmcnt(10)
    v_mfma_f32_16x16x32_bf16 v[128:131], v[48:51], v[168:171], v[128:131]
    buffer_load_dwordx4 v[80:83], v2, s[4:7], s42 offen offset:0 sc1
    ds_read_b64_tr_b16 v[44:45], v6 offset:40960
    v_mfma_f32_16x16x32_bf16 v[132:135], v[48:51], v[172:175], v[132:135]
    ds_read_b64_tr_b16 v[46:47], v6 offset:41984
    v_mfma_f32_16x16x32_bf16 v[136:139], v[52:55], v[168:171], v[136:139]
    ds_read_b64_tr_b16 v[48:49], v3 offset:45056
    v_mfma_f32_16x16x32_bf16 v[140:143], v[52:55], v[172:175], v[140:143]
    ds_read_b64_tr_b16 v[50:51], v3 offset:46080
    s_waitcnt lgkmcnt(10)
    v_mfma_f32_16x16x32_bf16 v[144:147], v[56:59], v[168:171], v[144:147]
    buffer_load_dwordx4 v[84:87], v2, s[4:7], s42 offen offset:256 sc1
    ds_read_b64_tr_b16 v[52:53], v4 offset:45056
    s_xor_b32 s42, s41, 61440
    v_mfma_f32_16x16x32_bf16 v[148:151], v[56:59], v[172:175], v[148:151]
    ds_read_b64_tr_b16 v[54:55], v4 offset:46080
    v_mfma_f32_16x16x32_bf16 v[152:155], v[60:63], v[168:171], v[152:155]
    ds_read_b64_tr_b16 v[56:57], v5 offset:45056
    v_mfma_f32_16x16x32_bf16 v[156:159], v[60:63], v[172:175], v[156:159]
    ds_read_b64_tr_b16 v[58:59], v5 offset:46080
    s_waitcnt vmcnt(8) lgkmcnt(10)
    v_mfma_f32_16x16x32_bf16 v[128:131], v[32:35], v[176:179], v[128:131]
    ds_read_b64_tr_b16 v[60:61], v6 offset:45056
    buffer_load_dwordx4 v[88:91], v2, s[4:7], s42 offen offset:0 sc1
    v_mfma_f32_16x16x32_bf16 v[132:135], v[32:35], v[180:183], v[132:135]
    ds_read_b64_tr_b16 v[62:63], v6 offset:46080
    s_barrier
    v_mfma_f32_16x16x32_bf16 v[136:139], v[36:39], v[176:179], v[136:139]
    ds_read_b64_tr_b16 v[32:33], v3 offset:49152
    v_mfma_f32_16x16x32_bf16 v[140:143], v[36:39], v[180:183], v[140:143]
    ds_read_b64_tr_b16 v[34:35], v3 offset:50176
    s_waitcnt lgkmcnt(10)
    v_mfma_f32_16x16x32_bf16 v[144:147], v[40:43], v[176:179], v[144:147]
    buffer_load_dwordx4 v[92:95], v2, s[4:7], s42 offen offset:256 sc1
    ds_read_b64_tr_b16 v[36:37], v4 offset:49152
    s_xor_b32 s42, s41, 0
    v_mfma_f32_16x16x32_bf16 v[148:151], v[40:43], v[180:183], v[148:151]
    ds_read_b64_tr_b16 v[38:39], v4 offset:50176
    v_mfma_f32_16x16x32_bf16 v[152:155], v[44:47], v[176:179], v[152:155]
    ds_read_b64_tr_b16 v[40:41], v5 offset:49152
    v_mfma_f32_16x16x32_bf16 v[156:159], v[44:47], v[180:183], v[156:159]
    ds_read_b64_tr_b16 v[42:43], v5 offset:50176
    s_waitcnt vmcnt(8) lgkmcnt(10)
    v_mfma_f32_16x16x32_bf16 v[128:131], v[48:51], v[184:187], v[128:131]
    buffer_load_dwordx4 v[96:99], v2, s[4:7], s42 offen offset:2048 sc1
    ds_read_b64_tr_b16 v[44:45], v6 offset:49152
    v_mfma_f32_16x16x32_bf16 v[132:135], v[48:51], v[188:191], v[132:135]
    ds_read_b64_tr_b16 v[46:47], v6 offset:50176
    v_mfma_f32_16x16x32_bf16 v[136:139], v[52:55], v[184:187], v[136:139]
    ds_read_b64_tr_b16 v[48:49], v3 offset:53248
    v_mfma_f32_16x16x32_bf16 v[140:143], v[52:55], v[188:191], v[140:143]
    ds_read_b64_tr_b16 v[50:51], v3 offset:54272
    s_waitcnt lgkmcnt(10)
    v_mfma_f32_16x16x32_bf16 v[144:147], v[56:59], v[184:187], v[144:147]
    buffer_load_dwordx4 v[100:103], v2, s[4:7], s42 offen offset:2304 sc1
    ds_read_b64_tr_b16 v[52:53], v4 offset:53248
    s_xor_b32 s42, s41, 4096
    v_mfma_f32_16x16x32_bf16 v[148:151], v[56:59], v[188:191], v[148:151]
    ds_read_b64_tr_b16 v[54:55], v4 offset:54272
    v_mfma_f32_16x16x32_bf16 v[152:155], v[60:63], v[184:187], v[152:155]
    ds_read_b64_tr_b16 v[56:57], v5 offset:53248
    v_mfma_f32_16x16x32_bf16 v[156:159], v[60:63], v[188:191], v[156:159]
    ds_read_b64_tr_b16 v[58:59], v5 offset:54272
    s_waitcnt vmcnt(8) lgkmcnt(10)
    v_mfma_f32_16x16x32_bf16 v[128:131], v[32:35], v[64:67], v[128:131]
    ds_read_b64_tr_b16 v[60:61], v6 offset:53248
    buffer_load_dwordx4 v[104:107], v2, s[4:7], s42 offen offset:2048 sc1
    v_mfma_f32_16x16x32_bf16 v[132:135], v[32:35], v[68:71], v[132:135]
    ds_read_b64_tr_b16 v[62:63], v6 offset:54272
    v_mfma_f32_16x16x32_bf16 v[136:139], v[36:39], v[64:67], v[136:139]
    ds_read_b64_tr_b16 v[32:33], v3 offset:57344
    v_mfma_f32_16x16x32_bf16 v[140:143], v[36:39], v[68:71], v[140:143]
    ds_read_b64_tr_b16 v[34:35], v3 offset:58368
    s_waitcnt lgkmcnt(10)
    v_mfma_f32_16x16x32_bf16 v[144:147], v[40:43], v[64:67], v[144:147]
    buffer_load_dwordx4 v[108:111], v2, s[4:7], s42 offen offset:2304 sc1
    ds_read_b64_tr_b16 v[36:37], v4 offset:57344
    s_xor_b32 s42, s41, 8192
    v_mfma_f32_16x16x32_bf16 v[148:151], v[40:43], v[68:71], v[148:151]
    ds_read_b64_tr_b16 v[38:39], v4 offset:58368
    v_mfma_f32_16x16x32_bf16 v[152:155], v[44:47], v[64:67], v[152:155]
    ds_read_b64_tr_b16 v[40:41], v5 offset:57344
    v_mfma_f32_16x16x32_bf16 v[156:159], v[44:47], v[68:71], v[156:159]
    ds_read_b64_tr_b16 v[42:43], v5 offset:58368
    s_waitcnt vmcnt(8) lgkmcnt(10)
    v_mfma_f32_16x16x32_bf16 v[128:131], v[48:51], v[72:75], v[128:131]
    buffer_load_dwordx4 v[112:115], v2, s[4:7], s42 offen offset:2048 sc1
    ds_read_b64_tr_b16 v[44:45], v6 offset:57344
    v_mfma_f32_16x16x32_bf16 v[132:135], v[48:51], v[76:79], v[132:135]
    ds_read_b64_tr_b16 v[46:47], v6 offset:58368
    v_mfma_f32_16x16x32_bf16 v[136:139], v[52:55], v[72:75], v[136:139]
    ds_read_b64_tr_b16 v[48:49], v3 offset:61440
    v_mfma_f32_16x16x32_bf16 v[140:143], v[52:55], v[76:79], v[140:143]
    ds_read_b64_tr_b16 v[50:51], v3 offset:62464
    s_waitcnt lgkmcnt(10)
    v_mfma_f32_16x16x32_bf16 v[144:147], v[56:59], v[72:75], v[144:147]
    buffer_load_dwordx4 v[116:119], v2, s[4:7], s42 offen offset:2304 sc1
    ds_read_b64_tr_b16 v[52:53], v4 offset:61440
    s_xor_b32 s42, s41, 12288
    v_mfma_f32_16x16x32_bf16 v[148:151], v[56:59], v[76:79], v[148:151]
    ds_read_b64_tr_b16 v[54:55], v4 offset:62464
    v_mfma_f32_16x16x32_bf16 v[152:155], v[60:63], v[72:75], v[152:155]
    ds_read_b64_tr_b16 v[56:57], v5 offset:61440
    v_mfma_f32_16x16x32_bf16 v[156:159], v[60:63], v[76:79], v[156:159]
    ds_read_b64_tr_b16 v[58:59], v5 offset:62464
    s_waitcnt vmcnt(8) lgkmcnt(10)
    v_mfma_f32_16x16x32_bf16 v[128:131], v[32:35], v[80:83], v[128:131]
    ds_read_b64_tr_b16 v[60:61], v6 offset:61440
    buffer_load_dwordx4 v[120:123], v2, s[4:7], s42 offen offset:2048 sc1
    v_mfma_f32_16x16x32_bf16 v[132:135], v[32:35], v[84:87], v[132:135]
    ds_read_b64_tr_b16 v[62:63], v6 offset:62464
    v_xor_b32 v3, 0x10000, v3
    v_xor_b32 v4, 0x10000, v4
    v_xor_b32 v5, 0x10000, v5
    v_xor_b32 v6, 0x10000, v6
    v_mfma_f32_16x16x32_bf16 v[136:139], v[36:39], v[80:83], v[136:139]
    ds_read_b64_tr_b16 v[32:33], v3 offset:0
    v_mfma_f32_16x16x32_bf16 v[140:143], v[36:39], v[84:87], v[140:143]
    ds_read_b64_tr_b16 v[34:35], v3 offset:1024
    s_waitcnt lgkmcnt(10)
    v_mfma_f32_16x16x32_bf16 v[144:147], v[40:43], v[80:83], v[144:147]
    buffer_load_dwordx4 v[124:127], v2, s[4:7], s42 offen offset:2304 sc1
    ds_read_b64_tr_b16 v[36:37], v4 offset:0
    s_xor_b32 s42, s41, 16384
    v_mfma_f32_16x16x32_bf16 v[148:151], v[40:43], v[84:87], v[148:151]
    ds_read_b64_tr_b16 v[38:39], v4 offset:1024
    v_mfma_f32_16x16x32_bf16 v[152:155], v[44:47], v[80:83], v[152:155]
    ds_read_b64_tr_b16 v[40:41], v5 offset:0
    v_mfma_f32_16x16x32_bf16 v[156:159], v[44:47], v[84:87], v[156:159]
    ds_read_b64_tr_b16 v[42:43], v5 offset:1024
    s_waitcnt vmcnt(8) lgkmcnt(10)
    v_mfma_f32_16x16x32_bf16 v[128:131], v[48:51], v[88:91], v[128:131]
    buffer_load_dwordx4 v[160:163], v2, s[4:7], s42 offen offset:2048 sc1
    ds_read_b64_tr_b16 v[44:45], v6 offset:0
    v_mfma_f32_16x16x32_bf16 v[132:135], v[48:51], v[92:95], v[132:135]
    ds_read_b64_tr_b16 v[46:47], v6 offset:1024
    v_mfma_f32_16x16x32_bf16 v[136:139], v[52:55], v[88:91], v[136:139]
    ds_read_b64_tr_b16 v[48:49], v3 offset:4096
    v_mfma_f32_16x16x32_bf16 v[140:143], v[52:55], v[92:95], v[140:143]
    ds_read_b64_tr_b16 v[50:51], v3 offset:5120
    s_waitcnt lgkmcnt(10)
    v_mfma_f32_16x16x32_bf16 v[144:147], v[56:59], v[88:91], v[144:147]
    buffer_load_dwordx4 v[164:167], v2, s[4:7], s42 offen offset:2304 sc1
    ds_read_b64_tr_b16 v[52:53], v4 offset:4096
    s_xor_b32 s42, s41, 20480
    v_mfma_f32_16x16x32_bf16 v[148:151], v[56:59], v[92:95], v[148:151]
    ds_read_b64_tr_b16 v[54:55], v4 offset:5120
    v_mfma_f32_16x16x32_bf16 v[152:155], v[60:63], v[88:91], v[152:155]
    ds_read_b64_tr_b16 v[56:57], v5 offset:4096
    v_mfma_f32_16x16x32_bf16 v[156:159], v[60:63], v[92:95], v[156:159]
    ds_read_b64_tr_b16 v[58:59], v5 offset:5120
    s_waitcnt vmcnt(8) lgkmcnt(10)
    v_mfma_f32_16x16x32_bf16 v[128:131], v[32:35], v[96:99], v[128:131]
    ds_read_b64_tr_b16 v[60:61], v6 offset:4096
    buffer_load_dwordx4 v[168:171], v2, s[4:7], s42 offen offset:2048 sc1
    v_mfma_f32_16x16x32_bf16 v[132:135], v[32:35], v[100:103], v[132:135]
    ds_read_b64_tr_b16 v[62:63], v6 offset:5120
    v_mfma_f32_16x16x32_bf16 v[136:139], v[36:39], v[96:99], v[136:139]
    ds_read_b64_tr_b16 v[32:33], v3 offset:8192
    v_mfma_f32_16x16x32_bf16 v[140:143], v[36:39], v[100:103], v[140:143]
    ds_read_b64_tr_b16 v[34:35], v3 offset:9216
    s_waitcnt lgkmcnt(10)
    v_mfma_f32_16x16x32_bf16 v[144:147], v[40:43], v[96:99], v[144:147]
    buffer_load_dwordx4 v[172:175], v2, s[4:7], s42 offen offset:2304 sc1
    ds_read_b64_tr_b16 v[36:37], v4 offset:8192
    s_xor_b32 s42, s41, 24576
    v_mfma_f32_16x16x32_bf16 v[148:151], v[40:43], v[100:103], v[148:151]
    ds_read_b64_tr_b16 v[38:39], v4 offset:9216
    v_mfma_f32_16x16x32_bf16 v[152:155], v[44:47], v[96:99], v[152:155]
    ds_read_b64_tr_b16 v[40:41], v5 offset:8192
    v_mfma_f32_16x16x32_bf16 v[156:159], v[44:47], v[100:103], v[156:159]
    ds_read_b64_tr_b16 v[42:43], v5 offset:9216
    s_waitcnt vmcnt(8) lgkmcnt(10)
    v_mfma_f32_16x16x32_bf16 v[128:131], v[48:51], v[104:107], v[128:131]
    buffer_load_dwordx4 v[176:179], v2, s[4:7], s42 offen offset:2048 sc1
    ds_read_b64_tr_b16 v[44:45], v6 offset:8192
    v_mfma_f32_16x16x32_bf16 v[132:135], v[48:51], v[108:111], v[132:135]
    ds_read_b64_tr_b16 v[46:47], v6 offset:9216
    v_mfma_f32_16x16x32_bf16 v[136:139], v[52:55], v[104:107], v[136:139]
    ds_read_b64_tr_b16 v[48:49], v3 offset:12288
    v_mfma_f32_16x16x32_bf16 v[140:143], v[52:55], v[108:111], v[140:143]
    ds_read_b64_tr_b16 v[50:51], v3 offset:13312
    s_waitcnt lgkmcnt(10)
    v_mfma_f32_16x16x32_bf16 v[144:147], v[56:59], v[104:107], v[144:147]
    buffer_load_dwordx4 v[180:183], v2, s[4:7], s42 offen offset:2304 sc1
    ds_read_b64_tr_b16 v[52:53], v4 offset:12288
    s_xor_b32 s42, s41, 28672
    v_mfma_f32_16x16x32_bf16 v[148:151], v[56:59], v[108:111], v[148:151]
    ds_read_b64_tr_b16 v[54:55], v4 offset:13312
    v_mfma_f32_16x16x32_bf16 v[152:155], v[60:63], v[104:107], v[152:155]
    ds_read_b64_tr_b16 v[56:57], v5 offset:12288
    v_mfma_f32_16x16x32_bf16 v[156:159], v[60:63], v[108:111], v[156:159]
    ds_read_b64_tr_b16 v[58:59], v5 offset:13312
    s_waitcnt vmcnt(8) lgkmcnt(10)
    v_mfma_f32_16x16x32_bf16 v[128:131], v[32:35], v[112:115], v[128:131]
    ds_read_b64_tr_b16 v[60:61], v6 offset:12288
    buffer_load_dwordx4 v[184:187], v2, s[4:7], s42 offen offset:2048 sc1
    v_mfma_f32_16x16x32_bf16 v[132:135], v[32:35], v[116:119], v[132:135]
    ds_read_b64_tr_b16 v[62:63], v6 offset:13312
    v_mfma_f32_16x16x32_bf16 v[136:139], v[36:39], v[112:115], v[136:139]
    ds_read_b64_tr_b16 v[32:33], v3 offset:16384
    v_mfma_f32_16x16x32_bf16 v[140:143], v[36:39], v[116:119], v[140:143]
    ds_read_b64_tr_b16 v[34:35], v3 offset:17408
    s_waitcnt lgkmcnt(10)
    v_mfma_f32_16x16x32_bf16 v[144:147], v[40:43], v[112:115], v[144:147]
    buffer_load_dwordx4 v[188:191], v2, s[4:7], s42 offen offset:2304 sc1
    ds_read_b64_tr_b16 v[36:37], v4 offset:16384
    s_xor_b32 s42, s41, 32768
    v_mfma_f32_16x16x32_bf16 v[148:151], v[40:43], v[116:119], v[148:151]
    ds_read_b64_tr_b16 v[38:39], v4 offset:17408
    v_mfma_f32_16x16x32_bf16 v[152:155], v[44:47], v[112:115], v[152:155]
    ds_read_b64_tr_b16 v[40:41], v5 offset:16384
    v_mfma_f32_16x16x32_bf16 v[156:159], v[44:47], v[116:119], v[156:159]
    ds_read_b64_tr_b16 v[42:43], v5 offset:17408
    s_waitcnt vmcnt(8) lgkmcnt(10)
    v_mfma_f32_16x16x32_bf16 v[128:131], v[48:51], v[120:123], v[128:131]
    buffer_load_dwordx4 v[64:67], v2, s[4:7], s42 offen offset:2048 sc1
    ds_read_b64_tr_b16 v[44:45], v6 offset:16384
    v_mfma_f32_16x16x32_bf16 v[132:135], v[48:51], v[124:127], v[132:135]
    ds_read_b64_tr_b16 v[46:47], v6 offset:17408
    v_mfma_f32_16x16x32_bf16 v[136:139], v[52:55], v[120:123], v[136:139]
    ds_read_b64_tr_b16 v[48:49], v3 offset:20480
    v_mfma_f32_16x16x32_bf16 v[140:143], v[52:55], v[124:127], v[140:143]
    ds_read_b64_tr_b16 v[50:51], v3 offset:21504
    s_waitcnt lgkmcnt(10)
    v_mfma_f32_16x16x32_bf16 v[144:147], v[56:59], v[120:123], v[144:147]
    buffer_load_dwordx4 v[68:71], v2, s[4:7], s42 offen offset:2304 sc1
    ds_read_b64_tr_b16 v[52:53], v4 offset:20480
    s_xor_b32 s42, s41, 36864
    v_mfma_f32_16x16x32_bf16 v[148:151], v[56:59], v[124:127], v[148:151]
    ds_read_b64_tr_b16 v[54:55], v4 offset:21504
    v_mfma_f32_16x16x32_bf16 v[152:155], v[60:63], v[120:123], v[152:155]
    ds_read_b64_tr_b16 v[56:57], v5 offset:20480
    v_mfma_f32_16x16x32_bf16 v[156:159], v[60:63], v[124:127], v[156:159]
    ds_read_b64_tr_b16 v[58:59], v5 offset:21504
    s_waitcnt vmcnt(8) lgkmcnt(10)
    v_mfma_f32_16x16x32_bf16 v[128:131], v[32:35], v[160:163], v[128:131]
    ds_read_b64_tr_b16 v[60:61], v6 offset:20480
    buffer_load_dwordx4 v[72:75], v2, s[4:7], s42 offen offset:2048 sc1
    v_mfma_f32_16x16x32_bf16 v[132:135], v[32:35], v[164:167], v[132:135]
    ds_read_b64_tr_b16 v[62:63], v6 offset:21504
    v_mfma_f32_16x16x32_bf16 v[136:139], v[36:39], v[160:163], v[136:139]
    ds_read_b64_tr_b16 v[32:33], v3 offset:24576
    v_mfma_f32_16x16x32_bf16 v[140:143], v[36:39], v[164:167], v[140:143]
    ds_read_b64_tr_b16 v[34:35], v3 offset:25600
    s_waitcnt lgkmcnt(10)
    v_mfma_f32_16x16x32_bf16 v[144:147], v[40:43], v[160:163], v[144:147]
    buffer_load_dwordx4 v[76:79], v2, s[4:7], s42 offen offset:2304 sc1
    ds_read_b64_tr_b16 v[36:37], v4 offset:24576
    s_xor_b32 s42, s41, 40960
    v_mfma_f32_16x16x32_bf16 v[148:151], v[40:43], v[164:167], v[148:151]
    ds_read_b64_tr_b16 v[38:39], v4 offset:25600
    v_mfma_f32_16x16x32_bf16 v[152:155], v[44:47], v[160:163], v[152:155]
    ds_read_b64_tr_b16 v[40:41], v5 offset:24576
    v_mfma_f32_16x16x32_bf16 v[156:159], v[44:47], v[164:167], v[156:159]
    ds_read_b64_tr_b16 v[42:43], v5 offset:25600
    s_waitcnt vmcnt(8) lgkmcnt(10)
    v_mfma_f32_16x16x32_bf16 v[128:131], v[48:51], v[168:171], v[128:131]
    buffer_load_dwordx4 v[80:83], v2, s[4:7], s42 offen offset:2048 sc1
    ds_read_b64_tr_b16 v[44:45], v6 offset:24576
    v_mfma_f32_16x16x32_bf16 v[132:135], v[48:51], v[172:175], v[132:135]
    ds_read_b64_tr_b16 v[46:47], v6 offset:25600
    v_mfma_f32_16x16x32_bf16 v[136:139], v[52:55], v[168:171], v[136:139]
    ds_read_b64_tr_b16 v[48:49], v3 offset:28672
    v_mfma_f32_16x16x32_bf16 v[140:143], v[52:55], v[172:175], v[140:143]
    ds_read_b64_tr_b16 v[50:51], v3 offset:29696
    s_waitcnt lgkmcnt(10)
    v_mfma_f32_16x16x32_bf16 v[144:147], v[56:59], v[168:171], v[144:147]
    buffer_load_dwordx4 v[84:87], v2, s[4:7], s42 offen offset:2304 sc1
    ds_read_b64_tr_b16 v[52:53], v4 offset:28672
    s_xor_b32 s42, s41, 45056
    v_mfma_f32_16x16x32_bf16 v[148:151], v[56:59], v[172:175], v[148:151]
    ds_read_b64_tr_b16 v[54:55], v4 offset:29696
    v_mfma_f32_16x16x32_bf16 v[152:155], v[60:63], v[168:171], v[152:155]
    ds_read_b64_tr_b16 v[56:57], v5 offset:28672
    v_mfma_f32_16x16x32_bf16 v[156:159], v[60:63], v[172:175], v[156:159]
    ds_read_b64_tr_b16 v[58:59], v5 offset:29696
    s_waitcnt vmcnt(8) lgkmcnt(10)
    v_mfma_f32_16x16x32_bf16 v[128:131], v[32:35], v[176:179], v[128:131]
    ds_read_b64_tr_b16 v[60:61], v6 offset:28672
    buffer_load_dwordx4 v[88:91], v2, s[4:7], s42 offen offset:2048 sc1
    v_mfma_f32_16x16x32_bf16 v[132:135], v[32:35], v[180:183], v[132:135]
    ds_read_b64_tr_b16 v[62:63], v6 offset:29696
    v_mfma_f32_16x16x32_bf16 v[136:139], v[36:39], v[176:179], v[136:139]
    ds_read_b64_tr_b16 v[32:33], v3 offset:32768
    v_mfma_f32_16x16x32_bf16 v[140:143], v[36:39], v[180:183], v[140:143]
    ds_read_b64_tr_b16 v[34:35], v3 offset:33792
    s_waitcnt lgkmcnt(10)
    v_mfma_f32_16x16x32_bf16 v[144:147], v[40:43], v[176:179], v[144:147]
    buffer_load_dwordx4 v[92:95], v2, s[4:7], s42 offen offset:2304 sc1
    ds_read_b64_tr_b16 v[36:37], v4 offset:32768
    s_xor_b32 s42, s41, 49152
    v_mfma_f32_16x16x32_bf16 v[148:151], v[40:43], v[180:183], v[148:151]
    ds_read_b64_tr_b16 v[38:39], v4 offset:33792
    v_mfma_f32_16x16x32_bf16 v[152:155], v[44:47], v[176:179], v[152:155]
    ds_read_b64_tr_b16 v[40:41], v5 offset:32768
    v_mfma_f32_16x16x32_bf16 v[156:159], v[44:47], v[180:183], v[156:159]
    ds_read_b64_tr_b16 v[42:43], v5 offset:33792
    s_waitcnt vmcnt(8) lgkmcnt(10)
    v_mfma_f32_16x16x32_bf16 v[128:131], v[48:51], v[184:187], v[128:131]
    buffer_load_dwordx4 v[96:99], v2, s[4:7], s42 offen offset:2048 sc1
    ds_read_b64_tr_b16 v[44:45], v6 offset:32768
    v_mfma_f32_16x16x32_bf16 v[132:135], v[48:51], v[188:191], v[132:135]
    ds_read_b64_tr_b16 v[46:47], v6 offset:33792
    v_mfma_f32_16x16x32_bf16 v[136:139], v[52:55], v[184:187], v[136:139]
    ds_read_b64_tr_b16 v[48:49], v3 offset:36864
    v_mfma_f32_16x16x32_bf16 v[140:143], v[52:55], v[188:191], v[140:143]
    ds_read_b64_tr_b16 v[50:51], v3 offset:37888
    s_waitcnt lgkmcnt(10)
    v_mfma_f32_16x16x32_bf16 v[144:147], v[56:59], v[184:187], v[144:147]
    buffer_load_dwordx4 v[100:103], v2, s[4:7], s42 offen offset:2304 sc1
    ds_read_b64_tr_b16 v[52:53], v4 offset:36864
    s_xor_b32 s42, s41, 53248
    v_mfma_f32_16x16x32_bf16 v[148:151], v[56:59], v[188:191], v[148:151]
    ds_read_b64_tr_b16 v[54:55], v4 offset:37888
    v_mfma_f32_16x16x32_bf16 v[152:155], v[60:63], v[184:187], v[152:155]
    ds_read_b64_tr_b16 v[56:57], v5 offset:36864
    v_mfma_f32_16x16x32_bf16 v[156:159], v[60:63], v[188:191], v[156:159]
    ds_read_b64_tr_b16 v[58:59], v5 offset:37888
    s_waitcnt vmcnt(8) lgkmcnt(10)
    v_mfma_f32_16x16x32_bf16 v[128:131], v[32:35], v[64:67], v[128:131]
    ds_read_b64_tr_b16 v[60:61], v6 offset:36864
    buffer_load_dwordx4 v[104:107], v2, s[4:7], s42 offen offset:2048 sc1
    v_mfma_f32_16x16x32_bf16 v[132:135], v[32:35], v[68:71], v[132:135]
    ds_read_b64_tr_b16 v[62:63], v6 offset:37888
    v_mfma_f32_16x16x32_bf16 v[136:139], v[36:39], v[64:67], v[136:139]
    ds_read_b64_tr_b16 v[32:33], v3 offset:40960
    v_mfma_f32_16x16x32_bf16 v[140:143], v[36:39], v[68:71], v[140:143]
    ds_read_b64_tr_b16 v[34:35], v3 offset:41984
    s_waitcnt lgkmcnt(10)
    v_mfma_f32_16x16x32_bf16 v[144:147], v[40:43], v[64:67], v[144:147]
    buffer_load_dwordx4 v[108:111], v2, s[4:7], s42 offen offset:2304 sc1
    ds_read_b64_tr_b16 v[36:37], v4 offset:40960
    s_xor_b32 s42, s41, 57344
    v_mfma_f32_16x16x32_bf16 v[148:151], v[40:43], v[68:71], v[148:151]
    ds_read_b64_tr_b16 v[38:39], v4 offset:41984
    v_mfma_f32_16x16x32_bf16 v[152:155], v[44:47], v[64:67], v[152:155]
    ds_read_b64_tr_b16 v[40:41], v5 offset:40960
    v_mfma_f32_16x16x32_bf16 v[156:159], v[44:47], v[68:71], v[156:159]
    ds_read_b64_tr_b16 v[42:43], v5 offset:41984
    s_waitcnt vmcnt(8) lgkmcnt(10)
    v_mfma_f32_16x16x32_bf16 v[128:131], v[48:51], v[72:75], v[128:131]
    buffer_load_dwordx4 v[112:115], v2, s[4:7], s42 offen offset:2048 sc1
    ds_read_b64_tr_b16 v[44:45], v6 offset:40960
    v_mfma_f32_16x16x32_bf16 v[132:135], v[48:51], v[76:79], v[132:135]
    ds_read_b64_tr_b16 v[46:47], v6 offset:41984
    v_mfma_f32_16x16x32_bf16 v[136:139], v[52:55], v[72:75], v[136:139]
    ds_read_b64_tr_b16 v[48:49], v3 offset:45056
    v_mfma_f32_16x16x32_bf16 v[140:143], v[52:55], v[76:79], v[140:143]
    ds_read_b64_tr_b16 v[50:51], v3 offset:46080
    s_waitcnt lgkmcnt(10)
    v_mfma_f32_16x16x32_bf16 v[144:147], v[56:59], v[72:75], v[144:147]
    buffer_load_dwordx4 v[116:119], v2, s[4:7], s42 offen offset:2304 sc1
    ds_read_b64_tr_b16 v[52:53], v4 offset:45056
    s_xor_b32 s42, s41, 61440
    v_mfma_f32_16x16x32_bf16 v[148:151], v[56:59], v[76:79], v[148:151]
    ds_read_b64_tr_b16 v[54:55], v4 offset:46080
    v_mfma_f32_16x16x32_bf16 v[152:155], v[60:63], v[72:75], v[152:155]
    ds_read_b64_tr_b16 v[56:57], v5 offset:45056
    v_mfma_f32_16x16x32_bf16 v[156:159], v[60:63], v[76:79], v[156:159]
    ds_read_b64_tr_b16 v[58:59], v5 offset:46080
    s_waitcnt vmcnt(8) lgkmcnt(10)
    v_mfma_f32_16x16x32_bf16 v[128:131], v[32:35], v[80:83], v[128:131]
    ds_read_b64_tr_b16 v[60:61], v6 offset:45056
    buffer_load_dwordx4 v[120:123], v2, s[4:7], s42 offen offset:2048 sc1
    v_mfma_f32_16x16x32_bf16 v[132:135], v[32:35], v[84:87], v[132:135]
    ds_read_b64_tr_b16 v[62:63], v6 offset:46080
    v_mfma_f32_16x16x32_bf16 v[136:139], v[36:39], v[80:83], v[136:139]
    ds_read_b64_tr_b16 v[32:33], v3 offset:49152
    v_mfma_f32_16x16x32_bf16 v[140:143], v[36:39], v[84:87], v[140:143]
    ds_read_b64_tr_b16 v[34:35], v3 offset:50176
    s_waitcnt lgkmcnt(10)
    v_mfma_f32_16x16x32_bf16 v[144:147], v[40:43], v[80:83], v[144:147]
    buffer_load_dwordx4 v[124:127], v2, s[4:7], s42 offen offset:2304 sc1
    ds_read_b64_tr_b16 v[36:37], v4 offset:49152
    v_mfma_f32_16x16x32_bf16 v[148:151], v[40:43], v[84:87], v[148:151]
    ds_read_b64_tr_b16 v[38:39], v4 offset:50176
    v_mfma_f32_16x16x32_bf16 v[152:155], v[44:47], v[80:83], v[152:155]
    ds_read_b64_tr_b16 v[40:41], v5 offset:49152
    v_mfma_f32_16x16x32_bf16 v[156:159], v[44:47], v[84:87], v[156:159]
    ds_read_b64_tr_b16 v[42:43], v5 offset:50176
    s_waitcnt vmcnt(8) lgkmcnt(10)
    v_mfma_f32_16x16x32_bf16 v[128:131], v[48:51], v[88:91], v[128:131]
    ds_read_b64_tr_b16 v[44:45], v6 offset:49152
    v_mfma_f32_16x16x32_bf16 v[132:135], v[48:51], v[92:95], v[132:135]
    ds_read_b64_tr_b16 v[46:47], v6 offset:50176
    v_mfma_f32_16x16x32_bf16 v[136:139], v[52:55], v[88:91], v[136:139]
    ds_read_b64_tr_b16 v[48:49], v3 offset:53248
    v_mfma_f32_16x16x32_bf16 v[140:143], v[52:55], v[92:95], v[140:143]
    ds_read_b64_tr_b16 v[50:51], v3 offset:54272
    s_waitcnt lgkmcnt(10)
    v_mfma_f32_16x16x32_bf16 v[144:147], v[56:59], v[88:91], v[144:147]
    ds_read_b64_tr_b16 v[52:53], v4 offset:53248
    v_mfma_f32_16x16x32_bf16 v[148:151], v[56:59], v[92:95], v[148:151]
    ds_read_b64_tr_b16 v[54:55], v4 offset:54272
    v_mfma_f32_16x16x32_bf16 v[152:155], v[60:63], v[88:91], v[152:155]
    ds_read_b64_tr_b16 v[56:57], v5 offset:53248
    v_mfma_f32_16x16x32_bf16 v[156:159], v[60:63], v[92:95], v[156:159]
    ds_read_b64_tr_b16 v[58:59], v5 offset:54272
    s_waitcnt vmcnt(6) lgkmcnt(10)
    v_mfma_f32_16x16x32_bf16 v[128:131], v[32:35], v[96:99], v[128:131]
    ds_read_b64_tr_b16 v[60:61], v6 offset:53248
    v_mfma_f32_16x16x32_bf16 v[132:135], v[32:35], v[100:103], v[132:135]
    ds_read_b64_tr_b16 v[62:63], v6 offset:54272
    v_mfma_f32_16x16x32_bf16 v[136:139], v[36:39], v[96:99], v[136:139]
    ds_read_b64_tr_b16 v[32:33], v3 offset:57344
    v_mfma_f32_16x16x32_bf16 v[140:143], v[36:39], v[100:103], v[140:143]
    ds_read_b64_tr_b16 v[34:35], v3 offset:58368
    s_waitcnt lgkmcnt(10)
    v_mfma_f32_16x16x32_bf16 v[144:147], v[40:43], v[96:99], v[144:147]
    ds_read_b64_tr_b16 v[36:37], v4 offset:57344
    v_mfma_f32_16x16x32_bf16 v[148:151], v[40:43], v[100:103], v[148:151]
    ds_read_b64_tr_b16 v[38:39], v4 offset:58368
    v_mfma_f32_16x16x32_bf16 v[152:155], v[44:47], v[96:99], v[152:155]
    ds_read_b64_tr_b16 v[40:41], v5 offset:57344
    v_mfma_f32_16x16x32_bf16 v[156:159], v[44:47], v[100:103], v[156:159]
    ds_read_b64_tr_b16 v[42:43], v5 offset:58368
    s_waitcnt vmcnt(4) lgkmcnt(10)
    v_mfma_f32_16x16x32_bf16 v[128:131], v[48:51], v[104:107], v[128:131]
    ds_read_b64_tr_b16 v[44:45], v6 offset:57344
    v_mfma_f32_16x16x32_bf16 v[132:135], v[48:51], v[108:111], v[132:135]
    ds_read_b64_tr_b16 v[46:47], v6 offset:58368
    v_mfma_f32_16x16x32_bf16 v[136:139], v[52:55], v[104:107], v[136:139]
    ds_read_b64_tr_b16 v[48:49], v3 offset:61440
    v_mfma_f32_16x16x32_bf16 v[140:143], v[52:55], v[108:111], v[140:143]
    ds_read_b64_tr_b16 v[50:51], v3 offset:62464
    s_waitcnt lgkmcnt(10)
    v_mfma_f32_16x16x32_bf16 v[144:147], v[56:59], v[104:107], v[144:147]
    ds_read_b64_tr_b16 v[52:53], v4 offset:61440
    v_mfma_f32_16x16x32_bf16 v[148:151], v[56:59], v[108:111], v[148:151]
    ds_read_b64_tr_b16 v[54:55], v4 offset:62464
    v_mfma_f32_16x16x32_bf16 v[152:155], v[60:63], v[104:107], v[152:155]
    ds_read_b64_tr_b16 v[56:57], v5 offset:61440
    v_mfma_f32_16x16x32_bf16 v[156:159], v[60:63], v[108:111], v[156:159]
    ds_read_b64_tr_b16 v[58:59], v5 offset:62464
    s_waitcnt vmcnt(2) lgkmcnt(10)
    v_mfma_f32_16x16x32_bf16 v[128:131], v[32:35], v[112:115], v[128:131]
    ds_read_b64_tr_b16 v[60:61], v6 offset:61440
    v_mfma_f32_16x16x32_bf16 v[132:135], v[32:35], v[116:119], v[132:135]
    ds_read_b64_tr_b16 v[62:63], v6 offset:62464
    v_xor_b32 v3, 0x10000, v3
    v_xor_b32 v4, 0x10000, v4
    v_xor_b32 v5, 0x10000, v5
    v_xor_b32 v6, 0x10000, v6
    v_mfma_f32_16x16x32_bf16 v[136:139], v[36:39], v[112:115], v[136:139]
    v_mfma_f32_16x16x32_bf16 v[140:143], v[36:39], v[116:119], v[140:143]
    s_waitcnt lgkmcnt(8)
    v_mfma_f32_16x16x32_bf16 v[144:147], v[40:43], v[112:115], v[144:147]
    v_mfma_f32_16x16x32_bf16 v[148:151], v[40:43], v[116:119], v[148:151]
    v_mfma_f32_16x16x32_bf16 v[152:155], v[44:47], v[112:115], v[152:155]
    v_mfma_f32_16x16x32_bf16 v[156:159], v[44:47], v[116:119], v[156:159]
    s_waitcnt vmcnt(0) lgkmcnt(4)
    v_mfma_f32_16x16x32_bf16 v[128:131], v[48:51], v[120:123], v[128:131]
    v_mfma_f32_16x16x32_bf16 v[132:135], v[48:51], v[124:127], v[132:135]
    v_mfma_f32_16x16x32_bf16 v[136:139], v[52:55], v[120:123], v[136:139]
    v_mfma_f32_16x16x32_bf16 v[140:143], v[52:55], v[124:127], v[140:143]
    s_waitcnt lgkmcnt(0)
    v_mfma_f32_16x16x32_bf16 v[144:147], v[56:59], v[120:123], v[144:147]
    v_mfma_f32_16x16x32_bf16 v[148:151], v[56:59], v[124:127], v[148:151]
    v_mfma_f32_16x16x32_bf16 v[152:155], v[60:63], v[120:123], v[152:155]
    v_mfma_f32_16x16x32_bf16 v[156:159], v[60:63], v[124:127], v[156:159]
    s_cmp_eq_u32 s21, 3
    s_cbranch_scc1 c_final
    s_add_u32 s43, s43, 4194304
    v_cvt_pk_bf16_f32 v160, v128, v129
    v_cvt_pk_bf16_f32 v161, v130, v131
    v_cvt_pk_bf16_f32 v162, v136, v137
    v_cvt_pk_bf16_f32 v163, v138, v139
    v_cvt_pk_bf16_f32 v168, v144, v145
    v_cvt_pk_bf16_f32 v169, v146, v147
    v_cvt_pk_bf16_f32 v170, v152, v153
    v_cvt_pk_bf16_f32 v171, v154, v155
    v_permlane32_swap_b32 v160, v162
    v_permlane32_swap_b32 v161, v163
    buffer_store_dwordx4 v[160:163], v2, s[4:7], s43 offen offset:0 sc1
    v_permlane32_swap_b32 v168, v170
    v_permlane32_swap_b32 v169, v171
    buffer_store_dwordx4 v[168:171], v2, s[4:7], s43 offen offset:2048 sc1
    v_cvt_pk_bf16_f32 v164, v132, v133
    v_cvt_pk_bf16_f32 v165, v134, v135
    v_cvt_pk_bf16_f32 v166, v140, v141
    v_cvt_pk_bf16_f32 v167, v142, v143
    v_cvt_pk_bf16_f32 v172, v148, v149
    v_cvt_pk_bf16_f32 v173, v150, v151
    v_cvt_pk_bf16_f32 v174, v156, v157
    v_cvt_pk_bf16_f32 v175, v158, v159
    v_permlane32_swap_b32 v164, v166
    v_permlane32_swap_b32 v165, v167
    buffer_store_dwordx4 v[164:167], v2, s[4:7], s43 offen offset:256 sc1
    v_permlane32_swap_b32 v172, v174
    v_permlane32_swap_b32 v173, v175
    buffer_store_dwordx4 v[172:175], v2, s[4:7], s43 offen offset:2304 sc1
    s_barrier
    s_add_u32 s21, s21, 1
    v_mov_b32 v22, 0x3f803f80
    v_dot2_f32_bf16 v24, v160, v22, 0
    v_dot2_f32_bf16 v25, v160, v160, 0
    v_dot2_f32_bf16 v26, v164, v22, 0
    v_dot2_f32_bf16 v27, v164, v164, 0
    v_dot2_f32_bf16 v24, v161, v22, v24
    v_dot2_f32_bf16 v25, v161, v161, v25
    v_dot2_f32_bf16 v26, v165, v22, v26
    v_dot2_f32_bf16 v27, v165, v165, v27
    v_dot2_f32_bf16 v24, v162, v22, v24
    v_dot2_f32_bf16 v25, v162, v162, v25
    v_dot2_f32_bf16 v26, v166, v22, v26
    v_dot2_f32_bf16 v27, v166, v166, v27
    v_dot2_f32_bf16 v24, v163, v22, v24
    v_dot2_f32_bf16 v25, v163, v163, v25
    v_dot2_f32_bf16 v26, v167, v22, v26
    v_dot2_f32_bf16 v27, v167, v167, v27
    v_dot2_f32_bf16 v24, v168, v22, v24
    v_dot2_f32_bf16 v25, v168, v168, v25
    v_dot2_f32_bf16 v26, v172, v22, v26
    v_dot2_f32_bf16 v27, v172, v172, v27
    v_dot2_f32_bf16 v24, v169, v22, v24
    v_dot2_f32_bf16 v25, v169, v169, v25
    v_dot2_f32_bf16 v26, v173, v22, v26
    v_dot2_f32_bf16 v27, v173, v173, v27
    v_dot2_f32_bf16 v24, v170, v22, v24
    v_dot2_f32_bf16 v25, v170, v170, v25
    v_dot2_f32_bf16 v26, v174, v22, v26
    v_dot2_f32_bf16 v27, v174, v174, v27
    v_dot2_f32_bf16 v24, v171, v22, v24
    v_dot2_f32_bf16 v25, v171, v171, v25
    v_dot2_f32_bf16 v26, v175, v22, v26
    v_dot2_f32_bf16 v27, v175, v175, v27
    v_lshrrev_b32 v23, 1, v1
    v_and_b32 v23, 0xf8, v23
    s_nop 0
    v_permlane16_swap_b32 v24, v26
    v_permlane16_swap_b32 v25, v27
    v_pk_add_f32 v[24:25], v[24:25], v[26:27]
    v_mov_b32 v26, v24
    v_mov_b32 v27, v25
    s_nop 0
    v_permlane32_swap_b32 v24, v26
    v_permlane32_swap_b32 v25, v27
    v_pk_add_f32 v[24:25], v[24:25], v[26:27]
    s_lshl_b32 s44, s21, 18
    s_lshl_b32 s45, s38, 12
    s_add_u32 s44, s44, s45
    s_lshl_b32 s45, s18, 8
    s_add_u32 s44, s44, s45
    s_add_u32 s44, s44, 50331648
    buffer_store_dwordx2 v[24:25], v23, s[4:7], s44 offen sc1
    s_lshl_b32 s46, s21, 14
    s_lshl_b32 s67, s38, 7
    s_add_u32 s46, s46, s67
    s_add_u32 s46, s46, 4096
    s_add_u32 s47, s46, 8192
    s_lshl_b32 s48, s21, 22
    s_lshl_b32 s49, s38, 16
    s_add_u32 s41, s48, s49
    v_lshrrev_b32 v16, 4, v1
    v_and_b32 v17, 15, v16
    v_lshrrev_b32 v16, 4, v16
    s_lshl_b32 s49, s16, 7
    s_add_u32 s50, s49, 151552
    s_and_b32 s49, s21, 1
    s_lshl_b32 s49, s49, 10
    s_add_u32 s49, s49, 151552
    v_lshlrev_b32 v11, 4, v16
    v_add_u32 v13, s50, v11
    v_add_u32 v11, s49, v11
    v_lshlrev_b32 v15, 2, v17
    v_add_u32 v9, s50, v15
    v_add_u32 v15, s49, v15
    s_lshr_b32 s49, s21, 1
    s_lshl_b32 s53, s49, 23
    s_lshl_b32 s50, s18, 18
    s_add_u32 s53, s53, s50
    s_add_u32 s53, s53, 33554432
    s_lshl_b32 s54, s38, 11
    s_add_u32 s52, s53, s54
    s_lshl_b32 s59, s49, 13
    s_lshl_b32 s67, s18, 9
    s_add_u32 s59, s59, s67
    s_lshl_b32 s67, s16, 7
    s_add_u32 s59, s59, s67
    s_add_u32 s59, s59, 69632
    s_lshl_b32 s61, s49, 15
    s_lshl_b32 s67, s17, 11
    s_add_u32 s61, s61, s67
    s_lshl_b32 s67, s18, 7
    s_add_u32 s61, s61, s67
    s_add_u32 s61, s61, 151552
    s_sub_u32 s60, s61, 151552
    s_lshl_b32 s60, s60, 5
    s_add_u32 s60, s60, 54525952
    s_lshl_b32 s62, s16, 12
    s_add_u32 s62, s62, 131072
    s_waitcnt vmcnt(1)
    s_atomic_add s63, s[22:23], s46
    s_mov_b32 s48, 0
    s_branch c_layer
c_final:
    s_mov_b32 s8, s32
    s_mov_b32 s9, s33
    s_mov_b32 s10, 4194304
    s_mov_b32 s11, 0x00020000
    v_lshrrev_b32 v12, 4, v1
    s_mul_i32 s44, s16, 4608
    s_add_u32 s44, s44, 131072
    v_and_b32 v13, 15, v12
    v_mul_u32_u24 v13, 144, v13
    v_lshrrev_b32 v14, 4, v12
    v_lshl_add_u32 v13, v14, 3, v13
    v_add_u32 v13, s44, v13
    v_cvt_pk_bf16_f32 v128, v128, v129
    v_cvt_pk_bf16_f32 v129, v130, v131
    ds_write_b64 v13, v[128:129] offset:0
    v_cvt_pk_bf16_f32 v136, v136, v137
    v_cvt_pk_bf16_f32 v137, v138, v139
    ds_write_b64 v13, v[136:137] offset:32
    v_cvt_pk_bf16_f32 v144, v144, v145
    v_cvt_pk_bf16_f32 v145, v146, v147
    ds_write_b64 v13, v[144:145] offset:64
    v_cvt_pk_bf16_f32 v152, v152, v153
    v_cvt_pk_bf16_f32 v153, v154, v155
    ds_write_b64 v13, v[152:153] offset:96
    v_cvt_pk_bf16_f32 v132, v132, v133
    v_cvt_pk_bf16_f32 v133, v134, v135
    ds_write_b64 v13, v[132:133] offset:2304
    v_cvt_pk_bf16_f32 v140, v140, v141
    v_cvt_pk_bf16_f32 v141, v142, v143
    ds_write_b64 v13, v[140:141] offset:2336
    v_cvt_pk_bf16_f32 v148, v148, v149
    v_cvt_pk_bf16_f32 v149, v150, v151
    ds_write_b64 v13, v[148:149] offset:2368
    v_cvt_pk_bf16_f32 v156, v156, v157
    v_cvt_pk_bf16_f32 v157, v158, v159
    ds_write_b64 v13, v[156:157] offset:2400
    v_lshrrev_b32 v14, 3, v12
    v_and_b32 v15, 7, v12
    v_mul_u32_u24 v16, 144, v14
    v_lshl_add_u32 v16, v15, 4, v16
    v_add_u32 v16, s44, v16
    v_lshlrev_b32 v17, 11, v14
    v_lshl_add_u32 v17, v15, 4, v17
    ds_read_b128 v[32:35], v16 offset:0
    ds_read_b128 v[36:39], v16 offset:1152
    ds_read_b128 v[40:43], v16 offset:2304
    ds_read_b128 v[44:47], v16 offset:3456
    s_lshl_b32 s44, s38, 16
    s_lshl_b32 s45, s18, 7
    s_add_u32 s44, s44, s45
    s_waitcnt lgkmcnt(3)
    buffer_store_dwordx4 v[32:35], v17, s[8:11], s44 offen sc1
    s_add_u32 s44, s44, 16384
    s_waitcnt lgkmcnt(2)
    buffer_store_dwordx4 v[36:39], v17, s[8:11], s44 offen sc1
    s_add_u32 s44, s44, 16384
    s_waitcnt lgkmcnt(1)
    buffer_store_dwordx4 v[40:43], v17, s[8:11], s44 offen sc1
    s_add_u32 s44, s44, 16384
    s_waitcnt lgkmcnt(0)
    buffer_store_dwordx4 v[44:47], v17, s[8:11], s44 offen sc1
    s_endpgm
s_start:
    v_mov_b32 v14, 0
    v_mov_b32 v15, 0
    v_mov_b32 v20, 0
    v_mov_b32 v21, 0
    v_mov_b32 v22, 0
    s_mov_b32 s41, 0
    s_mov_b32 s42, 0
    s_mov_b32 s43, 0
    s_mov_b32 s62, 0
    s_cmp_eq_u32 s16, 4
    s_cbranch_scc1 h_start
    s_cmp_eq_u32 s16, 7
    s_cbranch_scc1 z_start
l_start:
    v_lshrrev_b32 v24, 4, v1
    v_lshrrev_b32 v25, 3, v24
    v_mul_u32_u24 v12, 6144, v25
    v_and_b32 v26, 2, v25
    v_lshrrev_b32 v25, 2, v25
    v_or_b32 v26, v26, v25
    v_bfe_u32 v25, v24, 1, 2
    v_xor_b32 v26, v26, v25
    v_lshl_add_u32 v12, v26, 5, v12
    v_and_b32 v26, 1, v24
    v_lshl_add_u32 v12, v26, 4, v12
    s_lshl_b32 s3, s18, 7
    v_add_u32 v12, s3, v12
    v_add_u32 v13, 48128, v12
    s_mul_i32 s84, s18, 393216
    s_cmp_lt_u32 s18, 4
    s_cselect_b32 s85, 4, 0
    s_mul_i32 s85, s85, 393216
    s_sub_u32 s3, s16, 5
    s_lshl_b32 s41, s3, 11
    s_mul_i32 s42, s3, 98304
    s_lshl_b32 s62, s3, 15
    v_add_u32 v14, s42, v12
    v_add_u32 v15, s42, v13
    s_bitcmp1_b32 s21, 0
    s_cselect_b32 s8, s28, s24
    s_cselect_b32 s9, s29, s25
    s_cselect_b32 s12, s30, s26
    s_cselect_b32 s13, s31, s27
    s_mov_b32 s10, 6291456
    s_mov_b32 s11, 0x00020000
    s_mov_b32 s14, 2097152
    s_mov_b32 s15, 0x00020000
    s_add_u32 m0, s41, 0
    s_add_u32 s44, s84, 2048
    buffer_load_dwordx4 v14, s[8:11], s44 offen offset:0 lds
    buffer_load_dwordx4 v15, s[8:11], s44 offen offset:1024 lds
    s_add_u32 m0, s41, 4096
    s_add_u32 s44, s84, 4096
    buffer_load_dwordx4 v14, s[8:11], s44 offen offset:0 lds
    buffer_load_dwordx4 v15, s[8:11], s44 offen offset:1024 lds
    s_add_u32 m0, s41, 8192
    s_add_u32 s44, s84, 0
    buffer_load_dwordx4 v14, s[8:11], s44 offen offset:0 lds
    buffer_load_dwordx4 v15, s[8:11], s44 offen offset:1024 lds
    s_add_u32 m0, s41, 12288
    s_add_u32 s44, s84, 198656
    buffer_load_dwordx4 v14, s[8:11], s44 offen offset:0 lds
    buffer_load_dwordx4 v15, s[8:11], s44 offen offset:1024 lds
    s_add_u32 m0, s41, 16384
    s_add_u32 s44, s84, 200704
    buffer_load_dwordx4 v14, s[8:11], s44 offen offset:0 lds
    buffer_load_dwordx4 v15, s[8:11], s44 offen offset:1024 lds
    s_add_u32 m0, s41, 20480
    s_add_u32 s44, s84, 196608
    buffer_load_dwordx4 v14, s[8:11], s44 offen offset:0 lds
    buffer_load_dwordx4 v15, s[8:11], s44 offen offset:1024 lds
    s_add_u32 m0, s41, 24576
    s_add_u32 s44, s85, 2048
    buffer_load_dwordx4 v14, s[8:11], s44 offen offset:0 lds
    buffer_load_dwordx4 v15, s[8:11], s44 offen offset:1024 lds
    s_add_u32 m0, s41, 28672
    s_add_u32 s44, s85, 4096
    buffer_load_dwordx4 v14, s[8:11], s44 offen offset:0 lds
    buffer_load_dwordx4 v15, s[8:11], s44 offen offset:1024 lds
    s_cmp_lt_u32 s18, 4
    s_cselect_b32 s86, 5, 1
    s_mul_i32 s86, s86, 393216
    s_cmp_lt_u32 s18, 4
    s_cselect_b32 s87, 6, 2
    s_mul_i32 s87, s87, 393216
    s_cmp_lt_u32 s18, 4
    s_cselect_b32 s88, 7, 3
    s_mul_i32 s88, s88, 393216
    s_cmp_lt_u32 s18, 8
    s_cselect_b32 s89, 8, 4
    s_mul_i32 s89, s89, 393216
    s_cmp_lt_u32 s18, 8
    s_cselect_b32 s90, 9, 5
    s_mul_i32 s90, s90, 393216
    s_cmp_lt_u32 s18, 8
    s_cselect_b32 s91, 10, 6
    s_mul_i32 s91, s91, 393216
    s_cmp_lt_u32 s18, 8
    s_cselect_b32 s92, 11, 7
    s_mul_i32 s92, s92, 393216
    s_cmp_lt_u32 s18, 12
    s_cselect_b32 s93, 12, 8
    s_mul_i32 s93, s93, 393216
    s_cmp_lt_u32 s18, 12
    s_cselect_b32 s94, 13, 9
    s_mul_i32 s94, s94, 393216
    s_cmp_lt_u32 s18, 12
    s_cselect_b32 s95, 14, 10
    s_mul_i32 s95, s95, 393216
    s_cmp_lt_u32 s18, 12
    s_cselect_b32 s96, 15, 11
    s_mul_i32 s96, s96, 393216
    s_xor_b32 s97, s18, 1
    s_mul_i32 s97, s97, 393216
    s_xor_b32 s98, s18, 2
    s_mul_i32 s98, s98, 393216
    s_xor_b32 s99, s18, 3
    s_mul_i32 s99, s99, 393216
    v_lshrrev_b32 v24, 4, v1
    v_lshrrev_b32 v25, 3, v24
    v_mul_u32_u24 v16, 2048, v25
    v_and_b32 v26, 2, v25
    v_lshrrev_b32 v25, 2, v25
    v_or_b32 v26, v26, v25
    v_bfe_u32 v25, v24, 1, 2
    v_xor_b32 v26, v26, v25
    v_lshl_add_u32 v16, v26, 5, v16
    v_and_b32 v26, 1, v24
    v_lshl_add_u32 v16, v26, 4, v16
    s_lshl_b32 s3, s18, 7
    v_add_u32 v16, s3, v16
    v_add_u32 v17, 15360, v16
    v_add_u32 v18, 30720, v16
    v_add_u32 v19, 46080, v16
    s_and_b32 s3, s16, 3
    s_mul_i32 s3, s3, 49152
    v_add_u32 v11, s3, v12
    s_and_b32 s3, s16, 3
    s_lshl_b32 s3, s3, 10
    v_add_u32 v9, s3, v1
    v_add_u32 v10, 0x10000, v9
    s_waitcnt vmcnt(0)
    s_barrier
    s_add_u32 m0, s41, 32768
    s_add_u32 s44, s85, 0
    buffer_load_dwordx4 v14, s[8:11], s44 offen offset:0 lds
    buffer_load_dwordx4 v15, s[8:11], s44 offen offset:1024 lds
    s_add_u32 m0, s41, 36864
    s_add_u32 s44, s85, 198656
    buffer_load_dwordx4 v14, s[8:11], s44 offen offset:0 lds
    buffer_load_dwordx4 v15, s[8:11], s44 offen offset:1024 lds
    s_add_u32 m0, s41, 40960
    s_add_u32 s44, s85, 200704
    buffer_load_dwordx4 v14, s[8:11], s44 offen offset:0 lds
    buffer_load_dwordx4 v15, s[8:11], s44 offen offset:1024 lds
    s_add_u32 m0, s41, 45056
    s_add_u32 s44, s85, 196608
    buffer_load_dwordx4 v14, s[8:11], s44 offen offset:0 lds
    buffer_load_dwordx4 v15, s[8:11], s44 offen offset:1024 lds
    s_add_u32 m0, s41, 49152
    s_add_u32 s44, s86, 2048
    buffer_load_dwordx4 v14, s[8:11], s44 offen offset:0 lds
    buffer_load_dwordx4 v15, s[8:11], s44 offen offset:1024 lds
    s_add_u32 m0, s41, 53248
    s_add_u32 s44, s86, 4096
    buffer_load_dwordx4 v14, s[8:11], s44 offen offset:0 lds
    buffer_load_dwordx4 v15, s[8:11], s44 offen offset:1024 lds
    s_add_u32 m0, s41, 57344
    s_add_u32 s44, s86, 0
    buffer_load_dwordx4 v14, s[8:11], s44 offen offset:0 lds
    buffer_load_dwordx4 v15, s[8:11], s44 offen offset:1024 lds
    s_add_u32 m0, s41, 61440
    s_add_u32 s44, s86, 198656
    buffer_load_dwordx4 v14, s[8:11], s44 offen offset:0 lds
    buffer_load_dwordx4 v15, s[8:11], s44 offen offset:1024 lds
    s_waitcnt vmcnt(0)
    s_barrier
    s_add_u32 m0, s41, 65536
    s_add_u32 s44, s86, 200704
    buffer_load_dwordx4 v14, s[8:11], s44 offen offset:0 lds
    buffer_load_dwordx4 v15, s[8:11], s44 offen offset:1024 lds
    s_add_u32 m0, s41, 69632
    s_add_u32 s44, s86, 196608
    buffer_load_dwordx4 v14, s[8:11], s44 offen offset:0 lds
    buffer_load_dwordx4 v15, s[8:11], s44 offen offset:1024 lds
    s_add_u32 m0, s41, 73728
    s_add_u32 s44, s87, 2048
    buffer_load_dwordx4 v14, s[8:11], s44 offen offset:0 lds
    buffer_load_dwordx4 v15, s[8:11], s44 offen offset:1024 lds
    s_add_u32 m0, s41, 77824
    s_add_u32 s44, s87, 4096
    buffer_load_dwordx4 v14, s[8:11], s44 offen offset:0 lds
    buffer_load_dwordx4 v15, s[8:11], s44 offen offset:1024 lds
    s_add_u32 m0, s41, 81920
    s_add_u32 s44, s87, 0
    buffer_load_dwordx4 v14, s[8:11], s44 offen offset:0 lds
    buffer_load_dwordx4 v15, s[8:11], s44 offen offset:1024 lds
    s_add_u32 m0, s41, 86016
    s_add_u32 s44, s87, 198656
    buffer_load_dwordx4 v14, s[8:11], s44 offen offset:0 lds
    buffer_load_dwordx4 v15, s[8:11], s44 offen offset:1024 lds
    s_add_u32 m0, s41, 90112
    s_add_u32 s44, s87, 200704
    buffer_load_dwordx4 v14, s[8:11], s44 offen offset:0 lds
    buffer_load_dwordx4 v15, s[8:11], s44 offen offset:1024 lds
    s_add_u32 m0, s41, 94208
    s_add_u32 s44, s87, 196608
    buffer_load_dwordx4 v14, s[8:11], s44 offen offset:0 lds
    buffer_load_dwordx4 v15, s[8:11], s44 offen offset:1024 lds
    s_add_u32 m0, s41, 98304
    s_add_u32 s44, s88, 2048
    buffer_load_dwordx4 v14, s[8:11], s44 offen offset:0 lds
    buffer_load_dwordx4 v15, s[8:11], s44 offen offset:1024 lds
    s_add_u32 m0, s41, 102400
    s_add_u32 s44, s88, 4096
    buffer_load_dwordx4 v14, s[8:11], s44 offen offset:0 lds
    buffer_load_dwordx4 v15, s[8:11], s44 offen offset:1024 lds
    s_add_u32 m0, s41, 106496
    s_add_u32 s44, s88, 0
    buffer_load_dwordx4 v14, s[8:11], s44 offen offset:0 lds
    buffer_load_dwordx4 v15, s[8:11], s44 offen offset:1024 lds
    s_add_u32 m0, s41, 110592
    s_add_u32 s44, s88, 198656
    buffer_load_dwordx4 v14, s[8:11], s44 offen offset:0 lds
    buffer_load_dwordx4 v15, s[8:11], s44 offen offset:1024 lds
    s_add_u32 m0, s41, 114688
    s_add_u32 s44, s88, 200704
    buffer_load_dwordx4 v14, s[8:11], s44 offen offset:0 lds
    buffer_load_dwordx4 v15, s[8:11], s44 offen offset:1024 lds
    s_add_u32 m0, s41, 118784
    s_add_u32 s44, s88, 196608
    buffer_load_dwordx4 v14, s[8:11], s44 offen offset:0 lds
    buffer_load_dwordx4 v15, s[8:11], s44 offen offset:1024 lds
    s_add_u32 m0, s41, 122880
    s_add_u32 s44, s89, 2048
    buffer_load_dwordx4 v14, s[8:11], s44 offen offset:0 lds
    buffer_load_dwordx4 v15, s[8:11], s44 offen offset:1024 lds
    s_add_u32 m0, s41, 126976
    s_add_u32 s44, s89, 4096
    buffer_load_dwordx4 v14, s[8:11], s44 offen offset:0 lds
    buffer_load_dwordx4 v15, s[8:11], s44 offen offset:1024 lds
    s_add_u32 m0, s41, 0
    s_add_u32 s44, s89, 0
    buffer_load_dwordx4 v14, s[8:11], s44 offen offset:0 lds
    buffer_load_dwordx4 v15, s[8:11], s44 offen offset:1024 lds
    s_add_u32 m0, s41, 4096
    s_add_u32 s44, s89, 198656
    buffer_load_dwordx4 v14, s[8:11], s44 offen offset:0 lds
    buffer_load_dwordx4 v15, s[8:11], s44 offen offset:1024 lds
    s_add_u32 m0, s41, 8192
    s_add_u32 s44, s89, 200704
    buffer_load_dwordx4 v14, s[8:11], s44 offen offset:0 lds
    buffer_load_dwordx4 v15, s[8:11], s44 offen offset:1024 lds
    s_add_u32 m0, s41, 12288
    s_add_u32 s44, s89, 196608
    buffer_load_dwordx4 v14, s[8:11], s44 offen offset:0 lds
    buffer_load_dwordx4 v15, s[8:11], s44 offen offset:1024 lds
    s_waitcnt vmcnt(24)
    s_branch l_join
l_layer:
    s_waitcnt lgkmcnt(0)
    s_barrier
    s_add_u32 m0, s41, 0
    s_add_u32 s44, s89, 0
    buffer_load_dwordx4 v14, s[8:11], s44 offen offset:0 lds
    buffer_load_dwordx4 v15, s[8:11], s44 offen offset:1024 lds
    s_add_u32 m0, s41, 4096
    s_add_u32 s44, s89, 198656
    buffer_load_dwordx4 v14, s[8:11], s44 offen offset:0 lds
    buffer_load_dwordx4 v15, s[8:11], s44 offen offset:1024 lds
    s_add_u32 m0, s41, 8192
    s_add_u32 s44, s89, 200704
    buffer_load_dwordx4 v14, s[8:11], s44 offen offset:0 lds
    buffer_load_dwordx4 v15, s[8:11], s44 offen offset:1024 lds
    s_add_u32 m0, s41, 12288
    s_add_u32 s44, s89, 196608
    buffer_load_dwordx4 v14, s[8:11], s44 offen offset:0 lds
    buffer_load_dwordx4 v15, s[8:11], s44 offen offset:1024 lds
l_join:
    s_barrier
    s_add_u32 m0, s41, 16384
    s_add_u32 s44, s90, 2048
    buffer_load_dwordx4 v14, s[8:11], s44 offen offset:0 lds
    buffer_load_dwordx4 v15, s[8:11], s44 offen offset:1024 lds
    s_add_u32 m0, s41, 20480
    s_add_u32 s44, s90, 4096
    buffer_load_dwordx4 v14, s[8:11], s44 offen offset:0 lds
    buffer_load_dwordx4 v15, s[8:11], s44 offen offset:1024 lds
    s_add_u32 m0, s41, 24576
    s_add_u32 s44, s90, 0
    buffer_load_dwordx4 v14, s[8:11], s44 offen offset:0 lds
    buffer_load_dwordx4 v15, s[8:11], s44 offen offset:1024 lds
    s_add_u32 m0, s41, 28672
    s_add_u32 s44, s90, 198656
    buffer_load_dwordx4 v14, s[8:11], s44 offen offset:0 lds
    buffer_load_dwordx4 v15, s[8:11], s44 offen offset:1024 lds
    s_add_u32 m0, s41, 32768
    s_add_u32 s44, s90, 200704
    buffer_load_dwordx4 v14, s[8:11], s44 offen offset:0 lds
    buffer_load_dwordx4 v15, s[8:11], s44 offen offset:1024 lds
    s_add_u32 m0, s41, 36864
    s_add_u32 s44, s90, 196608
    buffer_load_dwordx4 v14, s[8:11], s44 offen offset:0 lds
    buffer_load_dwordx4 v15, s[8:11], s44 offen offset:1024 lds
    s_add_u32 m0, s41, 40960
    s_add_u32 s44, s91, 2048
    buffer_load_dwordx4 v14, s[8:11], s44 offen offset:0 lds
    buffer_load_dwordx4 v15, s[8:11], s44 offen offset:1024 lds
    s_add_u32 m0, s41, 45056
    s_add_u32 s44, s91, 4096
    buffer_load_dwordx4 v14, s[8:11], s44 offen offset:0 lds
    buffer_load_dwordx4 v15, s[8:11], s44 offen offset:1024 lds
    s_waitcnt vmcnt(24)
    s_barrier
    s_add_u32 m0, s41, 49152
    s_add_u32 s44, s91, 0
    buffer_load_dwordx4 v14, s[8:11], s44 offen offset:0 lds
    buffer_load_dwordx4 v15, s[8:11], s44 offen offset:1024 lds
    s_add_u32 m0, s41, 53248
    s_add_u32 s44, s91, 198656
    buffer_load_dwordx4 v14, s[8:11], s44 offen offset:0 lds
    buffer_load_dwordx4 v15, s[8:11], s44 offen offset:1024 lds
    s_add_u32 m0, s41, 57344
    s_add_u32 s44, s91, 200704
    buffer_load_dwordx4 v14, s[8:11], s44 offen offset:0 lds
    buffer_load_dwordx4 v15, s[8:11], s44 offen offset:1024 lds
    s_add_u32 m0, s41, 61440
    s_add_u32 s44, s91, 196608
    buffer_load_dwordx4 v14, s[8:11], s44 offen offset:0 lds
    buffer_load_dwordx4 v15, s[8:11], s44 offen offset:1024 lds
    s_waitcnt vmcnt(16)
    s_barrier
    s_add_u32 m0, s41, 65536
    s_add_u32 s44, s92, 2048
    buffer_load_dwordx4 v14, s[8:11], s44 offen offset:0 lds
    buffer_load_dwordx4 v15, s[8:11], s44 offen offset:1024 lds
    s_add_u32 m0, s41, 69632
    s_add_u32 s44, s92, 4096
    buffer_load_dwordx4 v14, s[8:11], s44 offen offset:0 lds
    buffer_load_dwordx4 v15, s[8:11], s44 offen offset:1024 lds
    s_add_u32 m0, s41, 73728
    s_add_u32 s44, s92, 0
    buffer_load_dwordx4 v14, s[8:11], s44 offen offset:0 lds
    buffer_load_dwordx4 v15, s[8:11], s44 offen offset:1024 lds
    s_add_u32 m0, s41, 77824
    s_add_u32 s44, s92, 198656
    buffer_load_dwordx4 v14, s[8:11], s44 offen offset:0 lds
    buffer_load_dwordx4 v15, s[8:11], s44 offen offset:1024 lds
    s_add_u32 m0, s41, 81920
    s_add_u32 s44, s92, 200704
    buffer_load_dwordx4 v14, s[8:11], s44 offen offset:0 lds
    buffer_load_dwordx4 v15, s[8:11], s44 offen offset:1024 lds
    s_add_u32 m0, s41, 86016
    s_add_u32 s44, s92, 196608
    buffer_load_dwordx4 v14, s[8:11], s44 offen offset:0 lds
    buffer_load_dwordx4 v15, s[8:11], s44 offen offset:1024 lds
    s_add_u32 m0, s41, 90112
    s_add_u32 s44, s93, 2048
    buffer_load_dwordx4 v14, s[8:11], s44 offen offset:0 lds
    buffer_load_dwordx4 v15, s[8:11], s44 offen offset:1024 lds
    s_add_u32 m0, s41, 94208
    s_add_u32 s44, s93, 4096
    buffer_load_dwordx4 v14, s[8:11], s44 offen offset:0 lds
    buffer_load_dwordx4 v15, s[8:11], s44 offen offset:1024 lds
    s_waitcnt vmcnt(16)
    s_barrier
    s_add_u32 m0, s41, 98304
    s_add_u32 s44, s93, 0
    buffer_load_dwordx4 v14, s[8:11], s44 offen offset:0 lds
    buffer_load_dwordx4 v15, s[8:11], s44 offen offset:1024 lds
    s_add_u32 m0, s41, 102400
    s_add_u32 s44, s93, 198656
    buffer_load_dwordx4 v14, s[8:11], s44 offen offset:0 lds
    buffer_load_dwordx4 v15, s[8:11], s44 offen offset:1024 lds
    s_add_u32 m0, s41, 106496
    s_add_u32 s44, s93, 200704
    buffer_load_dwordx4 v14, s[8:11], s44 offen offset:0 lds
    buffer_load_dwordx4 v15, s[8:11], s44 offen offset:1024 lds
    s_add_u32 m0, s41, 110592
    s_add_u32 s44, s93, 196608
    buffer_load_dwordx4 v14, s[8:11], s44 offen offset:0 lds
    buffer_load_dwordx4 v15, s[8:11], s44 offen offset:1024 lds
    s_add_u32 m0, s41, 114688
    s_add_u32 s44, s94, 2048
    buffer_load_dwordx4 v14, s[8:11], s44 offen offset:0 lds
    buffer_load_dwordx4 v15, s[8:11], s44 offen offset:1024 lds
    s_add_u32 m0, s41, 118784
    s_add_u32 s44, s94, 4096
    buffer_load_dwordx4 v14, s[8:11], s44 offen offset:0 lds
    buffer_load_dwordx4 v15, s[8:11], s44 offen offset:1024 lds
    s_add_u32 m0, s41, 122880
    s_add_u32 s44, s94, 198656
    buffer_load_dwordx4 v14, s[8:11], s44 offen offset:0 lds
    buffer_load_dwordx4 v15, s[8:11], s44 offen offset:1024 lds
    s_add_u32 m0, s41, 126976
    s_add_u32 s44, s94, 200704
    buffer_load_dwordx4 v14, s[8:11], s44 offen offset:0 lds
    buffer_load_dwordx4 v15, s[8:11], s44 offen offset:1024 lds
    s_waitcnt vmcnt(16)
    s_barrier
    s_add_u32 m0, s41, 0
    s_add_u32 s44, s95, 2048
    buffer_load_dwordx4 v14, s[8:11], s44 offen offset:0 lds
    buffer_load_dwordx4 v15, s[8:11], s44 offen offset:1024 lds
    s_add_u32 m0, s41, 4096
    s_add_u32 s44, s95, 4096
    buffer_load_dwordx4 v14, s[8:11], s44 offen offset:0 lds
    buffer_load_dwordx4 v15, s[8:11], s44 offen offset:1024 lds
    s_add_u32 m0, s41, 8192
    s_add_u32 s44, s95, 198656
    buffer_load_dwordx4 v14, s[8:11], s44 offen offset:0 lds
    buffer_load_dwordx4 v15, s[8:11], s44 offen offset:1024 lds
    s_add_u32 m0, s41, 12288
    s_add_u32 s44, s95, 200704
    buffer_load_dwordx4 v14, s[8:11], s44 offen offset:0 lds
    buffer_load_dwordx4 v15, s[8:11], s44 offen offset:1024 lds
    s_add_u32 m0, s41, 16384
    s_add_u32 s44, s96, 2048
    buffer_load_dwordx4 v14, s[8:11], s44 offen offset:0 lds
    buffer_load_dwordx4 v15, s[8:11], s44 offen offset:1024 lds
    s_add_u32 m0, s41, 20480
    s_add_u32 s44, s96, 198656
    buffer_load_dwordx4 v14, s[8:11], s44 offen offset:0 lds
    buffer_load_dwordx4 v15, s[8:11], s44 offen offset:1024 lds
    s_add_u32 m0, s41, 24576
    s_add_u32 s44, s97, 2048
    buffer_load_dwordx4 v14, s[8:11], s44 offen offset:0 lds
    buffer_load_dwordx4 v15, s[8:11], s44 offen offset:1024 lds
    s_add_u32 m0, s41, 28672
    s_add_u32 s44, s97, 198656
    buffer_load_dwordx4 v14, s[8:11], s44 offen offset:0 lds
    buffer_load_dwordx4 v15, s[8:11], s44 offen offset:1024 lds
    s_waitcnt vmcnt(16)
    s_barrier
    s_add_u32 m0, s41, 32768
    s_add_u32 s44, s98, 2048
    buffer_load_dwordx4 v14, s[8:11], s44 offen offset:0 lds
    buffer_load_dwordx4 v15, s[8:11], s44 offen offset:1024 lds
    s_add_u32 m0, s41, 36864
    s_add_u32 s44, s98, 198656
    buffer_load_dwordx4 v14, s[8:11], s44 offen offset:0 lds
    buffer_load_dwordx4 v15, s[8:11], s44 offen offset:1024 lds
    s_add_u32 m0, s41, 40960
    s_add_u32 s44, s99, 2048
    buffer_load_dwordx4 v14, s[8:11], s44 offen offset:0 lds
    buffer_load_dwordx4 v15, s[8:11], s44 offen offset:1024 lds
    s_add_u32 m0, s41, 45056
    s_add_u32 s44, s99, 198656
    buffer_load_dwordx4 v14, s[8:11], s44 offen offset:0 lds
    buffer_load_dwordx4 v15, s[8:11], s44 offen offset:1024 lds
    s_add_u32 m0, s41, 49152
    s_add_u32 s44, s96, 4096
    buffer_load_dwordx4 v14, s[8:11], s44 offen offset:0 lds
    buffer_load_dwordx4 v15, s[8:11], s44 offen offset:1024 lds
    s_add_u32 m0, s41, 53248
    s_add_u32 s44, s96, 200704
    buffer_load_dwordx4 v14, s[8:11], s44 offen offset:0 lds
    buffer_load_dwordx4 v15, s[8:11], s44 offen offset:1024 lds
    s_add_u32 m0, s41, 57344
    s_add_u32 s44, s97, 4096
    buffer_load_dwordx4 v14, s[8:11], s44 offen offset:0 lds
    buffer_load_dwordx4 v15, s[8:11], s44 offen offset:1024 lds
    s_add_u32 m0, s41, 61440
    s_add_u32 s44, s97, 200704
    buffer_load_dwordx4 v14, s[8:11], s44 offen offset:0 lds
    buffer_load_dwordx4 v15, s[8:11], s44 offen offset:1024 lds
    s_waitcnt vmcnt(16)
    s_barrier
    s_add_u32 m0, s41, 65536
    s_add_u32 s44, s98, 4096
    buffer_load_dwordx4 v14, s[8:11], s44 offen offset:0 lds
    buffer_load_dwordx4 v15, s[8:11], s44 offen offset:1024 lds
    s_add_u32 m0, s41, 69632
    s_add_u32 s44, s98, 200704
    buffer_load_dwordx4 v14, s[8:11], s44 offen offset:0 lds
    buffer_load_dwordx4 v15, s[8:11], s44 offen offset:1024 lds
    s_add_u32 m0, s41, 73728
    s_add_u32 s44, s99, 4096
    buffer_load_dwordx4 v14, s[8:11], s44 offen offset:0 lds
    buffer_load_dwordx4 v15, s[8:11], s44 offen offset:1024 lds
    s_add_u32 m0, s41, 77824
    s_add_u32 s44, s99, 200704
    buffer_load_dwordx4 v14, s[8:11], s44 offen offset:0 lds
    buffer_load_dwordx4 v15, s[8:11], s44 offen offset:1024 lds
    s_add_u32 m0, s41, 81920
    s_add_u32 s44, s94, 0
    buffer_load_dwordx4 v14, s[8:11], s44 offen offset:0 lds
    buffer_load_dwordx4 v15, s[8:11], s44 offen offset:1024 lds
    s_add_u32 m0, s41, 86016
    s_add_u32 s44, s94, 196608
    buffer_load_dwordx4 v14, s[8:11], s44 offen offset:0 lds
    buffer_load_dwordx4 v15, s[8:11], s44 offen offset:1024 lds
    s_add_u32 m0, s41, 90112
    s_add_u32 s44, s95, 0
    buffer_load_dwordx4 v14, s[8:11], s44 offen offset:0 lds
    buffer_load_dwordx4 v15, s[8:11], s44 offen offset:1024 lds
    s_add_u32 m0, s41, 94208
    s_add_u32 s44, s95, 196608
    buffer_load_dwordx4 v14, s[8:11], s44 offen offset:0 lds
    buffer_load_dwordx4 v15, s[8:11], s44 offen offset:1024 lds
    s_waitcnt vmcnt(16)
    s_barrier
    s_add_u32 m0, s41, 98304
    s_add_u32 s44, s96, 0
    buffer_load_dwordx4 v14, s[8:11], s44 offen offset:0 lds
    buffer_load_dwordx4 v15, s[8:11], s44 offen offset:1024 lds
    s_add_u32 m0, s41, 102400
    s_add_u32 s44, s96, 196608
    buffer_load_dwordx4 v14, s[8:11], s44 offen offset:0 lds
    buffer_load_dwordx4 v15, s[8:11], s44 offen offset:1024 lds
    s_add_u32 m0, s41, 106496
    s_add_u32 s44, s97, 0
    buffer_load_dwordx4 v14, s[8:11], s44 offen offset:0 lds
    buffer_load_dwordx4 v15, s[8:11], s44 offen offset:1024 lds
    s_add_u32 m0, s41, 110592
    s_add_u32 s44, s97, 196608
    buffer_load_dwordx4 v14, s[8:11], s44 offen offset:0 lds
    buffer_load_dwordx4 v15, s[8:11], s44 offen offset:1024 lds
    s_add_u32 m0, s41, 114688
    s_add_u32 s44, s98, 0
    buffer_load_dwordx4 v14, s[8:11], s44 offen offset:0 lds
    buffer_load_dwordx4 v15, s[8:11], s44 offen offset:1024 lds
    s_add_u32 m0, s41, 118784
    s_add_u32 s44, s98, 196608
    buffer_load_dwordx4 v14, s[8:11], s44 offen offset:0 lds
    buffer_load_dwordx4 v15, s[8:11], s44 offen offset:1024 lds
    s_add_u32 m0, s41, 122880
    s_add_u32 s44, s99, 0
    buffer_load_dwordx4 v14, s[8:11], s44 offen offset:0 lds
    buffer_load_dwordx4 v15, s[8:11], s44 offen offset:1024 lds
    s_add_u32 m0, s41, 126976
    s_add_u32 s44, s99, 196608
    buffer_load_dwordx4 v14, s[8:11], s44 offen offset:0 lds
    buffer_load_dwordx4 v15, s[8:11], s44 offen offset:1024 lds
    s_waitcnt vmcnt(16)
    s_barrier
    v_lshrrev_b32 v28, 4, v1
    v_and_b32 v29, 7, v28
    v_lshrrev_b32 v28, 3, v28
    v_mul_u32_u24 v28, 2048, v28
    v_lshl_add_u32 v28, v29, 4, v28
    s_and_b32 s3, s18, 12
    s_or_b32 s3, s3, 3
    s_lshl_b32 s3, s3, 7
    v_add_u32 v28, s3, v28
    s_lshr_b32 s3, s2, 3
    s_lshl_b32 s3, s3, 2
    s_and_b32 s60, s16, 3
    s_add_u32 s60, s60, s3
    s_lshl_b32 s61, s60, 14
    buffer_load_dwordx4 v[144:147], v28, s[12:15], s61 offen
    s_bitcmp0_b32 s21, 0
    s_cselect_b32 s56, s28, s24
    s_cselect_b32 s57, s29, s25
    s_mov_b32 s58, 6291456
    s_mov_b32 s59, 0x00020000
    v_lshrrev_b32 v28, 4, v1
    v_and_b32 v29, 7, v28
    v_lshrrev_b32 v28, 3, v28
    v_mul_u32_u24 v28, 6144, v28
    v_lshl_add_u32 v28, v29, 4, v28
    s_and_b32 s3, s18, 12
    s_or_b32 s3, s3, 3
    s_lshl_b32 s3, s3, 7
    v_add_u32 v28, s3, v28
    s_lshr_b32 s3, s2, 3
    s_lshl_b32 s3, s3, 2
    s_and_b32 s60, s16, 3
    s_add_u32 s60, s60, s3
    s_and_b32 s3, s60, 31
    s_mul_i32 s3, s3, 49152
    s_lshr_b32 s61, s60, 5
    s_min_u32 s61, s61, 2
    s_lshl_b32 s61, s61, 11
    s_add_u32 s61, s61, s3
    s_cmp_lt_u32 s18, 4
    s_cselect_b32 s3, 1572864, 0
    s_add_u32 s61, s61, s3
    buffer_load_dwordx4 v[148:151], v28, s[56:59], s61 offen
    s_waitcnt vmcnt(2)
    s_cmp_lg_u32 s21, 2
    s_cbranch_scc1 l_pe
    s_bitcmp0_b32 s21, 0
    s_cselect_b32 s56, s28, s24
    s_cselect_b32 s57, s29, s25
    s_mov_b32 s58, 6291456
    s_mov_b32 s59, 0x00020000
    s_add_u32 s61, s84, 2048
    buffer_load_dwordx4 v[160:163], v11, s[56:59], s61 offen
    s_add_u32 s61, s84, 4096
    buffer_load_dwordx4 v[164:167], v11, s[56:59], s61 offen
    s_add_u32 s61, s84, 0
    buffer_load_dwordx4 v[168:171], v11, s[56:59], s61 offen
    s_add_u32 s61, s84, 198656
    buffer_load_dwordx4 v[172:175], v11, s[56:59], s61 offen
    s_add_u32 s61, s84, 200704
    buffer_load_dwordx4 v[176:179], v11, s[56:59], s61 offen
    s_add_u32 s61, s84, 196608
    buffer_load_dwordx4 v[180:183], v11, s[56:59], s61 offen
    s_add_u32 s61, s85, 2048
    buffer_load_dwordx4 v[184:187], v11, s[56:59], s61 offen
    s_add_u32 s61, s85, 4096
    buffer_load_dwordx4 v[188:191], v11, s[56:59], s61 offen
    s_add_u32 s61, s85, 0
    buffer_load_dwordx4 v[192:195], v11, s[56:59], s61 offen
    s_add_u32 s61, s85, 198656
    buffer_load_dwordx4 v[196:199], v11, s[56:59], s61 offen
l_pe:
    s_barrier
    s_bitcmp1_b32 s21, 0
    s_cbranch_scc1 s_B
    s_add_u32 m0, s41, 0
    s_xor_b32 s44, s62, 0
    buffer_load_dwordx4 v16, s[12:15], s44 offen offset:0 lds
    buffer_load_dwordx4 v17, s[12:15], s44 offen offset:1024 lds
    s_add_u32 m0, s41, 4096
    s_xor_b32 s44, s62, 131072
    buffer_load_dwordx4 v16, s[12:15], s44 offen offset:0 lds
    buffer_load_dwordx4 v17, s[12:15], s44 offen offset:1024 lds
    s_add_u32 m0, s41, 8192
    s_xor_b32 s44, s62, 262144
    buffer_load_dwordx4 v16, s[12:15], s44 offen offset:0 lds
    buffer_load_dwordx4 v17, s[12:15], s44 offen offset:1024 lds
    s_add_u32 m0, s41, 12288
    s_xor_b32 s44, s62, 393216
    buffer_load_dwordx4 v16, s[12:15], s44 offen offset:0 lds
    buffer_load_dwordx4 v17, s[12:15], s44 offen offset:1024 lds
    s_add_u32 m0, s41, 16384
    s_xor_b32 s44, s62, 524288
    buffer_load_dwordx4 v16, s[12:15], s44 offen offset:0 lds
    buffer_load_dwordx4 v17, s[12:15], s44 offen offset:1024 lds
    s_add_u32 m0, s41, 20480
    s_xor_b32 s44, s62, 655360
    buffer_load_dwordx4 v16, s[12:15], s44 offen offset:0 lds
    buffer_load_dwordx4 v17, s[12:15], s44 offen offset:1024 lds
    s_add_u32 m0, s41, 24576
    s_xor_b32 s44, s62, 786432
    buffer_load_dwordx4 v16, s[12:15], s44 offen offset:0 lds
    buffer_load_dwordx4 v17, s[12:15], s44 offen offset:1024 lds
    s_add_u32 m0, s41, 28672
    s_xor_b32 s44, s62, 917504
    buffer_load_dwordx4 v16, s[12:15], s44 offen offset:0 lds
    buffer_load_dwordx4 v17, s[12:15], s44 offen offset:1024 lds
    s_add_u32 m0, s41, 32768
    s_xor_b32 s44, s62, 1048576
    buffer_load_dwordx4 v16, s[12:15], s44 offen offset:0 lds
    buffer_load_dwordx4 v17, s[12:15], s44 offen offset:1024 lds
    s_add_u32 m0, s41, 36864
    s_xor_b32 s44, s62, 1179648
    buffer_load_dwordx4 v16, s[12:15], s44 offen offset:0 lds
    buffer_load_dwordx4 v17, s[12:15], s44 offen offset:1024 lds
    s_add_u32 m0, s41, 40960
    s_xor_b32 s44, s62, 1310720
    buffer_load_dwordx4 v16, s[12:15], s44 offen offset:0 lds
    buffer_load_dwordx4 v17, s[12:15], s44 offen offset:1024 lds
    s_add_u32 m0, s41, 45056
    s_xor_b32 s44, s62, 1441792
    buffer_load_dwordx4 v16, s[12:15], s44 offen offset:0 lds
    buffer_load_dwordx4 v17, s[12:15], s44 offen offset:1024 lds
    s_add_u32 m0, s41, 49152
    s_xor_b32 s44, s62, 1572864
    buffer_load_dwordx4 v16, s[12:15], s44 offen offset:0 lds
    buffer_load_dwordx4 v17, s[12:15], s44 offen offset:1024 lds
    s_add_u32 m0, s41, 53248
    s_xor_b32 s44, s62, 1703936
    buffer_load_dwordx4 v16, s[12:15], s44 offen offset:0 lds
    buffer_load_dwordx4 v17, s[12:15], s44 offen offset:1024 lds
    s_add_u32 m0, s41, 57344
    s_xor_b32 s44, s62, 1835008
    buffer_load_dwordx4 v16, s[12:15], s44 offen offset:0 lds
    buffer_load_dwordx4 v17, s[12:15], s44 offen offset:1024 lds
    s_add_u32 m0, s41, 61440
    s_xor_b32 s44, s62, 1966080
    buffer_load_dwordx4 v16, s[12:15], s44 offen offset:0 lds
    buffer_load_dwordx4 v17, s[12:15], s44 offen offset:1024 lds
    s_branch s_tail
h_start:
    v_mov_b32 v20, 0
    v_mov_b32 v21, 0
    v_mov_b32 v22, 0
    v_mov_b32 v23, 0
    s_cmp_lt_u32 s2, 10
    s_cbranch_scc0 h_z0
    s_load_dword s101, s[34:35], 192
    s_lshl_b32 s44, s2, 11
    s_mov_b32 s45, 0
    s_mov_b32 s46, 0
    s_mov_b32 s47, 0
    s_mov_b32 s48, 0
    s_mov_b32 s49, 0
    s_mov_b32 s50, 0
    s_mov_b32 s51, 0
    s_mov_b32 s52, 0
    s_mov_b32 s53, 0
    s_mov_b32 s54, 0
    s_mov_b32 s55, 0
    s_mov_b32 s56, 0
    s_mov_b32 s57, 0
    s_mov_b32 s58, 0
    s_mov_b32 s59, 0
    s_mov_b32 s60, 0
    s_atomic_swap s45, s[22:23], s44 offset:0 glc
    s_atomic_swap s46, s[22:23], s44 offset:128 glc
    s_atomic_swap s47, s[22:23], s44 offset:256 glc
    s_atomic_swap s48, s[22:23], s44 offset:384 glc
    s_atomic_swap s49, s[22:23], s44 offset:512 glc
    s_atomic_swap s50, s[22:23], s44 offset:640 glc
    s_atomic_swap s51, s[22:23], s44 offset:768 glc
    s_atomic_swap s52, s[22:23], s44 offset:896 glc
    s_atomic_swap s53, s[22:23], s44 offset:1024 glc
    s_atomic_swap s54, s[22:23], s44 offset:1152 glc
    s_atomic_swap s55, s[22:23], s44 offset:1280 glc
    s_atomic_swap s56, s[22:23], s44 offset:1408 glc
    s_atomic_swap s57, s[22:23], s44 offset:1536 glc
    s_atomic_swap s58, s[22:23], s44 offset:1664 glc
    s_atomic_swap s59, s[22:23], s44 offset:1792 glc
    s_atomic_swap s60, s[22:23], s44 offset:1920 glc
    s_waitcnt lgkmcnt(0)
    s_atomic_add s40, s[34:35], 0
h_z0:
    v_lshrrev_b32 v24, 4, v1
    v_lshrrev_b32 v25, 3, v24
    v_mul_u32_u24 v12, 6144, v25
    v_and_b32 v26, 2, v25
    v_lshrrev_b32 v25, 2, v25
    v_or_b32 v26, v26, v25
    v_bfe_u32 v25, v24, 1, 2
    v_xor_b32 v26, v26, v25
    v_lshl_add_u32 v12, v26, 5, v12
    v_and_b32 v26, 1, v24
    v_lshl_add_u32 v12, v26, 4, v12
    s_lshl_b32 s3, s18, 7
    v_add_u32 v12, s3, v12
    v_add_u32 v13, 48128, v12
    s_mul_i32 s84, s18, 393216
    s_cmp_lt_u32 s18, 4
    s_cselect_b32 s85, 4, 0
    s_mul_i32 s85, s85, 393216
    s_cmp_lt_u32 s18, 4
    s_cselect_b32 s86, 5, 1
    s_mul_i32 s86, s86, 393216
    s_cmp_lt_u32 s18, 4
    s_cselect_b32 s87, 6, 2
    s_mul_i32 s87, s87, 393216
    s_cmp_lt_u32 s18, 4
    s_cselect_b32 s88, 7, 3
    s_mul_i32 s88, s88, 393216
    s_cmp_lt_u32 s18, 8
    s_cselect_b32 s89, 8, 4
    s_mul_i32 s89, s89, 393216
    s_cmp_lt_u32 s18, 8
    s_cselect_b32 s90, 9, 5
    s_mul_i32 s90, s90, 393216
    s_cmp_lt_u32 s18, 8
    s_cselect_b32 s91, 10, 6
    s_mul_i32 s91, s91, 393216
    s_cmp_lt_u32 s18, 8
    s_cselect_b32 s92, 11, 7
    s_mul_i32 s92, s92, 393216
    s_cmp_lt_u32 s18, 12
    s_cselect_b32 s93, 12, 8
    s_mul_i32 s93, s93, 393216
    s_cmp_lt_u32 s18, 12
    s_cselect_b32 s94, 13, 9
    s_mul_i32 s94, s94, 393216
    s_cmp_lt_u32 s18, 12
    s_cselect_b32 s95, 14, 10
    s_mul_i32 s95, s95, 393216
    s_cmp_lt_u32 s18, 12
    s_cselect_b32 s96, 15, 11
    s_mul_i32 s96, s96, 393216
    s_xor_b32 s97, s18, 1
    s_mul_i32 s97, s97, 393216
    s_xor_b32 s98, s18, 2
    s_mul_i32 s98, s98, 393216
    s_xor_b32 s99, s18, 3
    s_mul_i32 s99, s99, 393216
    v_lshrrev_b32 v24, 4, v1
    v_lshrrev_b32 v25, 3, v24
    v_mul_u32_u24 v16, 2048, v25
    v_and_b32 v26, 2, v25
    v_lshrrev_b32 v25, 2, v25
    v_or_b32 v26, v26, v25
    v_bfe_u32 v25, v24, 1, 2
    v_xor_b32 v26, v26, v25
    v_lshl_add_u32 v16, v26, 5, v16
    v_and_b32 v26, 1, v24
    v_lshl_add_u32 v16, v26, 4, v16
    s_lshl_b32 s3, s18, 7
    v_add_u32 v16, s3, v16
    v_add_u32 v17, 15360, v16
    v_add_u32 v18, 30720, v16
    v_add_u32 v19, 46080, v16
    s_and_b32 s3, s16, 3
    s_mul_i32 s3, s3, 49152
    v_add_u32 v11, s3, v12
    s_and_b32 s3, s16, 3
    s_lshl_b32 s3, s3, 10
    v_add_u32 v9, s3, v1
    v_add_u32 v10, 0x10000, v9
    v_lshrrev_b32 v24, 4, v1
    v_and_b32 v25, 15, v24
    v_lshrrev_b32 v24, 4, v24
    v_lshlrev_b32 v24, 2, v24
    v_sub_u32 v24, v25, v24
    v_mov_b32 v25, 0xf149f2ca
    v_add_u32 v26, 0x0, v24
    v_and_b32 v26, 0xfffffff1, v26
    v_cmp_eq_u32 vcc, 0, v26
    s_nop 1
    v_cndmask_b32 v32, v25, 0, vcc
    v_add_u32 v26, 0xffffffff, v24
    v_and_b32 v26, 0xfffffff1, v26
    v_cmp_eq_u32 vcc, 0, v26
    s_nop 1
    v_cndmask_b32 v33, v25, 0, vcc
    v_add_u32 v26, 0xfffffffe, v24
    v_and_b32 v26, 0xfffffff1, v26
    v_cmp_eq_u32 vcc, 0, v26
    s_nop 1
    v_cndmask_b32 v34, v25, 0, vcc
    v_add_u32 v26, 0xfffffffd, v24
    v_and_b32 v26, 0xfffffff1, v26
    v_cmp_eq_u32 vcc, 0, v26
    s_nop 1
    v_cndmask_b32 v35, v25, 0, vcc
    v_add_u32 v26, 0x10, v24
    v_and_b32 v26, 0xfffffff1, v26
    v_cmp_eq_u32 vcc, 0, v26
    s_nop 1
    v_cndmask_b32 v36, v25, 0, vcc
    v_add_u32 v26, 0xf, v24
    v_and_b32 v26, 0xfffffff1, v26
    v_cmp_eq_u32 vcc, 0, v26
    s_nop 1
    v_cndmask_b32 v37, v25, 0, vcc
    v_add_u32 v26, 0xe, v24
    v_and_b32 v26, 0xfffffff1, v26
    v_cmp_eq_u32 vcc, 0, v26
    s_nop 1
    v_cndmask_b32 v38, v25, 0, vcc
    v_add_u32 v26, 0xd, v24
    v_and_b32 v26, 0xfffffff1, v26
    v_cmp_eq_u32 vcc, 0, v26
    s_nop 1
    v_cndmask_b32 v39, v25, 0, vcc
    v_add_u32 v24, 153600, v1
    ds_write_b128 v24, v[32:35] offset:0
    ds_write_b128 v24, v[36:39] offset:1024
    s_waitcnt lgkmcnt(0)
    s_lshl_b32 s44, s21, 14
    s_lshl_b32 s67, s17, 9
    s_add_u32 s44, s44, s67
    s_add_u32 s44, s44, 4096
    s_barrier
    s_barrier
    s_mov_b32 s66, 0x10000
h_s0_poll:
    s_mov_b32 s68, 0
    s_mov_b32 s69, 0
    s_mov_b32 s70, 0
    s_mov_b32 s71, 0
    s_atomic_add s68, s[22:23], s44 offset:0 glc
    s_atomic_add s69, s[22:23], s44 offset:128 glc
    s_atomic_add s70, s[22:23], s44 offset:256 glc
    s_atomic_add s71, s[22:23], s44 offset:384 glc
    s_sub_u32 s66, s66, 1
    s_cselect_b32 s67, 67372036, 0
    s_waitcnt lgkmcnt(0)
    s_and_b32 s68, s68, s69
    s_and_b32 s68, s68, s70
    s_and_b32 s68, s68, s71
    s_max_u32 s68, s68, s67
    s_cmp_lt_u32 s68, 67372036
    s_cbranch_scc1 h_s0_poll
h_s0_ok:
    s_lshr_b32 s3, s2, 3
    s_cmp_eq_u32 s3, 2
    s_cbranch_scc0 h_g4
    s_barrier
    s_mul_i32 s44, s2, 24576
    s_add_u32 s44, s44, 58347520
    s_mov_b32 s45, 24
h_zloop:
    buffer_store_dwordx4 v[20:23], v1, s[4:7], s44 offen sc1
    s_add_u32 s44, s44, 1024
    s_sub_u32 s45, s45, 1
    s_cmp_lg_u32 s45, 0
    s_cbranch_scc1 h_zloop
    s_branch h_g4b
h_layer:
    s_waitcnt lgkmcnt(0)
    s_barrier
h_g4:
    s_barrier
h_g4b:
    s_lshl_b32 s44, s21, 14
    s_lshl_b32 s67, s17, 9
    s_add_u32 s44, s44, s67
    s_add_u32 s44, s44, 12288
    s_mov_b32 s66, 0x10000
h_s_poll:
    s_mov_b32 s68, 0
    s_mov_b32 s69, 0
    s_mov_b32 s70, 0
    s_mov_b32 s71, 0
    s_atomic_add s68, s[22:23], s44 offset:0 glc
    s_atomic_add s69, s[22:23], s44 offset:128 glc
    s_atomic_add s70, s[22:23], s44 offset:256 glc
    s_atomic_add s71, s[22:23], s44 offset:384 glc
    s_sub_u32 s66, s66, 1
    s_cselect_b32 s67, 16, 0
    s_waitcnt lgkmcnt(0)
    s_and_b32 s68, s68, s69
    s_and_b32 s68, s68, s70
    s_and_b32 s68, s68, s71
    s_max_u32 s68, s68, s67
    s_cmp_lt_u32 s68, 16
    s_cbranch_scc1 h_s_poll
h_s_ok:
    s_barrier
    s_lshl_b32 s44, s21, 18
    s_lshl_b32 s45, s17, 14
    s_add_u32 s44, s44, s45
    s_add_u32 s44, s44, 50331648
    buffer_load_dwordx4 v[32:35], v1, s[4:7], s44 offen offset:0 sc1
    buffer_load_dwordx4 v[36:39], v1, s[4:7], s44 offen offset:1024 sc1
    buffer_load_dwordx4 v[40:43], v1, s[4:7], s44 offen offset:2048 sc1
    buffer_load_dwordx4 v[44:47], v1, s[4:7], s44 offen offset:3072 sc1
    s_add_u32 s44, s44, 4096
    buffer_load_dwordx4 v[48:51], v1, s[4:7], s44 offen offset:0 sc1
    buffer_load_dwordx4 v[52:55], v1, s[4:7], s44 offen offset:1024 sc1
    buffer_load_dwordx4 v[56:59], v1, s[4:7], s44 offen offset:2048 sc1
    buffer_load_dwordx4 v[60:63], v1, s[4:7], s44 offen offset:3072 sc1
    s_add_u32 s44, s44, 4096
    buffer_load_dwordx4 v[64:67], v1, s[4:7], s44 offen offset:0 sc1
    buffer_load_dwordx4 v[68:71], v1, s[4:7], s44 offen offset:1024 sc1
    buffer_load_dwordx4 v[72:75], v1, s[4:7], s44 offen offset:2048 sc1
    buffer_load_dwordx4 v[76:79], v1, s[4:7], s44 offen offset:3072 sc1
    s_add_u32 s44, s44, 4096
    buffer_load_dwordx4 v[80:83], v1, s[4:7], s44 offen offset:0 sc1
    buffer_load_dwordx4 v[84:87], v1, s[4:7], s44 offen offset:1024 sc1
    buffer_load_dwordx4 v[88:91], v1, s[4:7], s44 offen offset:2048 sc1
    buffer_load_dwordx4 v[92:95], v1, s[4:7], s44 offen offset:3072 sc1
    s_barrier
    s_cmp_ge_u32 s21, 2
    s_cbranch_scc1 h_c_ok
    s_lshl_b32 s44, s21, 11
    s_lshl_b32 s67, s18, 7
    s_add_u32 s44, s44, s67
    s_add_u32 s44, s44, 0
    s_mov_b32 s66, 0x10000
h_c_poll:
    s_mov_b32 s68, 0
    s_atomic_add s68, s[22:23], s44 offset:0 glc
    s_sub_u32 s66, s66, 1
    s_cselect_b32 s67, 48, 0
    s_waitcnt lgkmcnt(0)
    s_max_u32 s68, s68, s67
    s_cmp_lt_u32 s68, 48
    s_cbranch_scc1 h_c_poll
h_c_ok:
    s_waitcnt vmcnt(0)
    s_lshl_b32 s3, s21, 8
    s_add_u32 s3, s3, s2
    s_lshr_b32 s3, s3, 3
    s_cmp_eq_u32 s3, 2
    s_cbranch_scc0 h_nf1
    s_atomic_add s40, s[34:35], 128
h_nf1:
    s_barrier
    s_cmp_ge_u32 s21, 2
    s_cbranch_scc1 h_cs1
    s_lshl_b32 s44, s21, 18
    s_lshl_b32 s45, s18, 14
    s_add_u32 s44, s44, s45
    s_add_u32 s44, s44, 52428800
    buffer_load_dwordx4 v[96:99], v1, s[4:7], s44 offen offset:0 sc1
    buffer_load_dwordx4 v[100:103], v1, s[4:7], s44 offen offset:1024 sc1
    buffer_load_dwordx4 v[104:107], v1, s[4:7], s44 offen offset:2048 sc1
    buffer_load_dwordx4 v[108:111], v1, s[4:7], s44 offen offset:3072 sc1
    s_add_u32 s44, s44, 4096
    buffer_load_dwordx4 v[112:115], v1, s[4:7], s44 offen offset:0 sc1
    buffer_load_dwordx4 v[116:119], v1, s[4:7], s44 offen offset:1024 sc1
    buffer_load_dwordx4 v[120:123], v1, s[4:7], s44 offen offset:2048 sc1
    buffer_load_dwordx4 v[124:127], v1, s[4:7], s44 offen offset:3072 sc1
    s_add_u32 s44, s44, 4096
    buffer_load_dwordx4 v[128:131], v1, s[4:7], s44 offen offset:0 sc1
    buffer_load_dwordx4 v[132:135], v1, s[4:7], s44 offen offset:1024 sc1
    buffer_load_dwordx4 v[136:139], v1, s[4:7], s44 offen offset:2048 sc1
    buffer_load_dwordx4 v[140:143], v1, s[4:7], s44 offen offset:3072 sc1
    s_add_u32 s44, s44, 4096
    buffer_load_dwordx4 v[144:147], v1, s[4:7], s44 offen offset:0 sc1
    buffer_load_dwordx4 v[148:151], v1, s[4:7], s44 offen offset:1024 sc1
    buffer_load_dwordx4 v[152:155], v1, s[4:7], s44 offen offset:2048 sc1
    buffer_load_dwordx4 v[156:159], v1, s[4:7], s44 offen offset:3072 sc1
h_cs1:
    v_add_f32 v32, v32, v36
    v_add_f32 v33, v33, v37
    v_add_f32 v34, v34, v38
    v_add_f32 v35, v35, v39
    v_add_f32 v48, v48, v52
    v_add_f32 v49, v49, v53
    v_add_f32 v50, v50, v54
    v_add_f32 v51, v51, v55
    v_add_f32 v64, v64, v68
    v_add_f32 v65, v65, v69
    v_add_f32 v66, v66, v70
    v_add_f32 v67, v67, v71
    v_add_f32 v80, v80, v84
    v_add_f32 v81, v81, v85
    v_add_f32 v82, v82, v86
    v_add_f32 v83, v83, v87
    v_add_f32 v32, v32, v40
    v_add_f32 v33, v33, v41
    v_add_f32 v34, v34, v42
    v_add_f32 v35, v35, v43
    v_add_f32 v48, v48, v56
    v_add_f32 v49, v49, v57
    v_add_f32 v50, v50, v58
    v_add_f32 v51, v51, v59
    v_add_f32 v64, v64, v72
    v_add_f32 v65, v65, v73
    v_add_f32 v66, v66, v74
    v_add_f32 v67, v67, v75
    v_add_f32 v80, v80, v88
    v_add_f32 v81, v81, v89
    v_add_f32 v82, v82, v90
    v_add_f32 v83, v83, v91
    s_barrier
    v_add_f32 v32, v32, v44
    v_add_f32 v33, v33, v45
    v_add_f32 v34, v34, v46
    v_add_f32 v35, v35, v47
    v_add_f32 v48, v48, v60
    v_add_f32 v49, v49, v61
    v_add_f32 v50, v50, v62
    v_add_f32 v51, v51, v63
    v_add_f32 v64, v64, v76
    v_add_f32 v65, v65, v77
    v_add_f32 v66, v66, v78
    v_add_f32 v67, v67, v79
    v_add_f32 v80, v80, v92
    v_add_f32 v81, v81, v93
    v_add_f32 v82, v82, v94
    v_add_f32 v83, v83, v95
    v_permlane32_swap_b32 v32, v64
    v_permlane32_swap_b32 v33, v65
    v_permlane32_swap_b32 v34, v66
    v_permlane32_swap_b32 v35, v67
    v_add_f32 v32, v32, v64
    v_add_f32 v33, v33, v65
    v_add_f32 v34, v34, v66
    v_add_f32 v35, v35, v67
    v_permlane32_swap_b32 v48, v80
    v_permlane32_swap_b32 v49, v81
    v_permlane32_swap_b32 v50, v82
    v_permlane32_swap_b32 v51, v83
    v_add_f32 v48, v48, v80
    v_add_f32 v49, v49, v81
    v_add_f32 v50, v50, v82
    v_add_f32 v51, v51, v83
    v_permlane16_swap_b32 v32, v48
    v_permlane16_swap_b32 v33, v49
    v_permlane16_swap_b32 v34, v50
    v_permlane16_swap_b32 v35, v51
    v_add_f32 v32, v32, v48
    v_add_f32 v33, v33, v49
    v_add_f32 v34, v34, v50
    v_add_f32 v35, v35, v51
    s_barrier
    v_mul_f32 v32, 0x3a800000, v32
    v_mul_f32 v33, 0x3a800000, v33
    v_mul_f32 v34, 0x3a800000, v34
    v_mul_f32 v35, 0x3a800000, v35
    v_fma_f32 v33, -v32, v32, v33
    v_fma_f32 v35, -v34, v34, v35
    v_max_f32 v33, 0, v33
    v_max_f32 v35, 0, v35
    v_add_f32 v33, 0x3727c5ac, v33
    v_add_f32 v35, 0x3727c5ac, v35
    v_rsq_f32 v33, v33
    v_rsq_f32 v35, v35
    v_lshrrev_b32 v26, 1, v1
    v_add_u32 v26, 155648, v26
    ds_write2_b32 v26, v32, v34 offset0:0 offset1:1
    ds_write2_b32 v26, v33, v35 offset0:128 offset1:129
    s_barrier
    s_cmp_ge_u32 s21, 2
    s_cbranch_scc1 h_cs_done
    s_waitcnt vmcnt(0)
    v_add_f32 v96, v96, v100
    v_add_f32 v97, v97, v101
    v_add_f32 v98, v98, v102
    v_add_f32 v99, v99, v103
    v_add_f32 v96, v96, v104
    v_add_f32 v97, v97, v105
    v_add_f32 v98, v98, v106
    v_add_f32 v99, v99, v107
    v_add_f32 v96, v96, v108
    v_add_f32 v97, v97, v109
    v_add_f32 v98, v98, v110
    v_add_f32 v99, v99, v111
    v_add_f32 v96, v96, v112
    v_add_f32 v97, v97, v113
    v_add_f32 v98, v98, v114
    v_add_f32 v99, v99, v115
    v_add_f32 v96, v96, v116
    v_add_f32 v97, v97, v117
    v_add_f32 v98, v98, v118
    v_add_f32 v99, v99, v119
    v_add_f32 v96, v96, v120
    v_add_f32 v97, v97, v121
    v_add_f32 v98, v98, v122
    v_add_f32 v99, v99, v123
    v_add_f32 v96, v96, v124
    v_add_f32 v97, v97, v125
    v_add_f32 v98, v98, v126
    v_add_f32 v99, v99, v127
    v_add_f32 v96, v96, v128
    v_add_f32 v97, v97, v129
    v_add_f32 v98, v98, v130
    v_add_f32 v99, v99, v131
    v_add_f32 v96, v96, v132
    v_add_f32 v97, v97, v133
    v_add_f32 v98, v98, v134
    v_add_f32 v99, v99, v135
    v_add_f32 v96, v96, v136
    v_add_f32 v97, v97, v137
    v_add_f32 v98, v98, v138
    v_add_f32 v99, v99, v139
    v_add_f32 v96, v96, v140
    v_add_f32 v97, v97, v141
    v_add_f32 v98, v98, v142
    v_add_f32 v99, v99, v143
    v_add_f32 v96, v96, v144
    v_add_f32 v97, v97, v145
    v_add_f32 v98, v98, v146
    v_add_f32 v99, v99, v147
    v_add_f32 v96, v96, v148
    v_add_f32 v97, v97, v149
    v_add_f32 v98, v98, v150
    v_add_f32 v99, v99, v151
    v_add_f32 v96, v96, v152
    v_add_f32 v97, v97, v153
    v_add_f32 v98, v98, v154
    v_add_f32 v99, v99, v155
    v_add_f32 v96, v96, v156
    v_add_f32 v97, v97, v157
    v_add_f32 v98, v98, v158
    v_add_f32 v99, v99, v159
    s_lshl_b32 s44, s21, 10
    s_add_u32 s44, s44, 151552
    v_add_u32 v24, s44, v1
    ds_write_b128 v24, v[96:99]
h_cs_done:
    s_waitcnt lgkmcnt(0)
    s_barrier
    s_cmp_lg_u32 s21, 0
    s_cbranch_scc1 h_f1_ok
    s_load_dword s68, s[34:35], 128
    s_mov_b32 s8, s34
    s_mov_b32 s9, s35
    s_mov_b32 s10, 256
    s_mov_b32 s11, 0x00020000
    s_mov_b32 s66, 0x10000
    v_mov_b32 v24, 0
    s_waitcnt lgkmcnt(0)
h_f1:
    s_cmp_eq_u32 s68, 8
    s_cbranch_scc1 h_f1_ok
    buffer_load_dword v25, v24, s[8:11], 0 offen offset:128 sc1
    s_waitcnt vmcnt(0)
    v_readfirstlane_b32 s68, v25
    s_sub_u32 s66, s66, 1
    s_cmp_lg_u32 s66, 0
    s_cbranch_scc1 h_f1
h_f1_ok:
    s_barrier
    s_bitcmp1_b32 s21, 0
    s_cselect_b32 s8, s28, s24
    s_cselect_b32 s9, s29, s25
    s_cselect_b32 s12, s30, s26
    s_cselect_b32 s13, s31, s27
    s_mov_b32 s10, 6291456
    s_mov_b32 s11, 0x00020000
    s_mov_b32 s14, 2097152
    s_mov_b32 s15, 0x00020000
    v_lshrrev_b32 v28, 4, v1
    v_and_b32 v29, 7, v28
    v_lshrrev_b32 v28, 3, v28
    v_mul_u32_u24 v28, 2048, v28
    v_lshl_add_u32 v28, v29, 4, v28
    s_and_b32 s3, s18, 12
    s_or_b32 s3, s3, 3
    s_lshl_b32 s3, s3, 7
    v_add_u32 v28, s3, v28
    s_lshr_b32 s3, s2, 3
    s_lshl_b32 s3, s3, 2
    s_and_b32 s60, s16, 3
    s_add_u32 s60, s60, s3
    s_lshl_b32 s61, s60, 14
    buffer_load_dwordx4 v[144:147], v28, s[12:15], s61 offen
    s_bitcmp0_b32 s21, 0
    s_cselect_b32 s56, s28, s24
    s_cselect_b32 s57, s29, s25
    s_mov_b32 s58, 6291456
    s_mov_b32 s59, 0x00020000
    v_lshrrev_b32 v28, 4, v1
    v_and_b32 v29, 7, v28
    v_lshrrev_b32 v28, 3, v28
    v_mul_u32_u24 v28, 6144, v28
    v_lshl_add_u32 v28, v29, 4, v28
    s_and_b32 s3, s18, 12
    s_or_b32 s3, s3, 3
    s_lshl_b32 s3, s3, 7
    v_add_u32 v28, s3, v28
    s_lshr_b32 s3, s2, 3
    s_lshl_b32 s3, s3, 2
    s_and_b32 s60, s16, 3
    s_add_u32 s60, s60, s3
    s_and_b32 s3, s60, 31
    s_mul_i32 s3, s3, 49152
    s_lshr_b32 s61, s60, 5
    s_min_u32 s61, s61, 2
    s_lshl_b32 s61, s61, 11
    s_add_u32 s61, s61, s3
    s_cmp_lt_u32 s18, 4
    s_cselect_b32 s3, 1572864, 0
    s_add_u32 s61, s61, s3
    buffer_load_dwordx4 v[148:151], v28, s[56:59], s61 offen
    s_cmp_lg_u32 s21, 2
    s_cbranch_scc1 h_pe
    s_bitcmp0_b32 s21, 0
    s_cselect_b32 s56, s28, s24
    s_cselect_b32 s57, s29, s25
    s_mov_b32 s58, 6291456
    s_mov_b32 s59, 0x00020000
    s_add_u32 s61, s84, 2048
    buffer_load_dwordx4 v[160:163], v11, s[56:59], s61 offen
    s_add_u32 s61, s84, 4096
    buffer_load_dwordx4 v[164:167], v11, s[56:59], s61 offen
    s_add_u32 s61, s84, 0
    buffer_load_dwordx4 v[168:171], v11, s[56:59], s61 offen
    s_add_u32 s61, s84, 198656
    buffer_load_dwordx4 v[172:175], v11, s[56:59], s61 offen
    s_add_u32 s61, s84, 200704
    buffer_load_dwordx4 v[176:179], v11, s[56:59], s61 offen
    s_add_u32 s61, s84, 196608
    buffer_load_dwordx4 v[180:183], v11, s[56:59], s61 offen
    s_add_u32 s61, s85, 2048
    buffer_load_dwordx4 v[184:187], v11, s[56:59], s61 offen
    s_add_u32 s61, s85, 4096
    buffer_load_dwordx4 v[188:191], v11, s[56:59], s61 offen
    s_add_u32 s61, s85, 0
    buffer_load_dwordx4 v[192:195], v11, s[56:59], s61 offen
    s_add_u32 s61, s85, 198656
    buffer_load_dwordx4 v[196:199], v11, s[56:59], s61 offen
h_pe:
    s_barrier
    s_branch s_tail
z_start:
    v_lshrrev_b32 v24, 4, v1
    v_lshrrev_b32 v25, 3, v24
    v_mul_u32_u24 v20, 6144, v25
    v_and_b32 v25, 7, v24
    v_lshl_add_u32 v20, v25, 4, v20
    s_add_u32 s3, s18, 2
    s_and_b32 s3, s3, 15
    s_lshl_b32 s3, s3, 7
    s_add_u32 s3, s3, 4096
    v_add_u32 v22, s3, v20
    s_add_u32 s3, s18, 1
    s_and_b32 s3, s3, 15
    s_lshl_b32 s3, s3, 7
    s_add_u32 s3, s3, 2048
    v_add_u32 v21, s3, v20
    s_add_u32 s3, s18, 0
    s_and_b32 s3, s3, 15
    s_lshl_b32 s3, s3, 7
    s_add_u32 s3, s3, 0
    v_add_u32 v20, s3, v20
    s_waitcnt lgkmcnt(0)
    s_mov_b32 s8, s24
    s_mov_b32 s9, s25
    s_mov_b32 s10, 6291456
    s_mov_b32 s11, 0x00020000
    s_mul_i32 s44, s17, 393216
    buffer_load_dwordx4 v[32:35], v20, s[8:11], s44 offen
    buffer_load_dwordx4 v[64:67], v21, s[8:11], s44 offen
    buffer_load_dwordx4 v[96:99], v22, s[8:11], s44 offen
    s_add_u32 s44, s44, 49152
    buffer_load_dwordx4 v[36:39], v20, s[8:11], s44 offen
    buffer_load_dwordx4 v[68:71], v21, s[8:11], s44 offen
    buffer_load_dwordx4 v[100:103], v22, s[8:11], s44 offen
    s_add_u32 s44, s44, 49152
    buffer_load_dwordx4 v[40:43], v20, s[8:11], s44 offen
    buffer_load_dwordx4 v[72:75], v21, s[8:11], s44 offen
    buffer_load_dwordx4 v[104:107], v22, s[8:11], s44 offen
    s_add_u32 s44, s44, 49152
    buffer_load_dwordx4 v[44:47], v20, s[8:11], s44 offen
    buffer_load_dwordx4 v[76:79], v21, s[8:11], s44 offen
    buffer_load_dwordx4 v[108:111], v22, s[8:11], s44 offen
    s_add_u32 s44, s44, 49152
    buffer_load_dwordx4 v[48:51], v20, s[8:11], s44 offen
    buffer_load_dwordx4 v[80:83], v21, s[8:11], s44 offen
    buffer_load_dwordx4 v[112:115], v22, s[8:11], s44 offen
    s_add_u32 s44, s44, 49152
    buffer_load_dwordx4 v[52:55], v20, s[8:11], s44 offen
    buffer_load_dwordx4 v[84:87], v21, s[8:11], s44 offen
    buffer_load_dwordx4 v[116:119], v22, s[8:11], s44 offen
    s_add_u32 s44, s44, 49152
    buffer_load_dwordx4 v[56:59], v20, s[8:11], s44 offen
    buffer_load_dwordx4 v[88:91], v21, s[8:11], s44 offen
    buffer_load_dwordx4 v[120:123], v22, s[8:11], s44 offen
    s_add_u32 s44, s44, 49152
    buffer_load_dwordx4 v[60:63], v20, s[8:11], s44 offen
    buffer_load_dwordx4 v[92:95], v21, s[8:11], s44 offen
    buffer_load_dwordx4 v[124:127], v22, s[8:11], s44 offen
    v_lshrrev_b32 v24, 4, v1
    v_lshrrev_b32 v25, 3, v24
    v_mul_u32_u24 v12, 6144, v25
    v_and_b32 v26, 2, v25
    v_lshrrev_b32 v25, 2, v25
    v_or_b32 v26, v26, v25
    v_bfe_u32 v25, v24, 1, 2
    v_xor_b32 v26, v26, v25
    v_lshl_add_u32 v12, v26, 5, v12
    v_and_b32 v26, 1, v24
    v_lshl_add_u32 v12, v26, 4, v12
    s_lshl_b32 s3, s18, 7
    v_add_u32 v12, s3, v12
    v_add_u32 v13, 48128, v12
    s_mul_i32 s84, s18, 393216
    s_cmp_lt_u32 s18, 4
    s_cselect_b32 s85, 4, 0
    s_mul_i32 s85, s85, 393216
    s_cmp_lt_u32 s18, 4
    s_cselect_b32 s86, 5, 1
    s_mul_i32 s86, s86, 393216
    s_cmp_lt_u32 s18, 4
    s_cselect_b32 s87, 6, 2
    s_mul_i32 s87, s87, 393216
    s_cmp_lt_u32 s18, 4
    s_cselect_b32 s88, 7, 3
    s_mul_i32 s88, s88, 393216
    s_cmp_lt_u32 s18, 8
    s_cselect_b32 s89, 8, 4
    s_mul_i32 s89, s89, 393216
    s_cmp_lt_u32 s18, 8
    s_cselect_b32 s90, 9, 5
    s_mul_i32 s90, s90, 393216
    s_cmp_lt_u32 s18, 8
    s_cselect_b32 s91, 10, 6
    s_mul_i32 s91, s91, 393216
    s_cmp_lt_u32 s18, 8
    s_cselect_b32 s92, 11, 7
    s_mul_i32 s92, s92, 393216
    s_cmp_lt_u32 s18, 12
    s_cselect_b32 s93, 12, 8
    s_mul_i32 s93, s93, 393216
    s_cmp_lt_u32 s18, 12
    s_cselect_b32 s94, 13, 9
    s_mul_i32 s94, s94, 393216
    s_cmp_lt_u32 s18, 12
    s_cselect_b32 s95, 14, 10
    s_mul_i32 s95, s95, 393216
    s_cmp_lt_u32 s18, 12
    s_cselect_b32 s96, 15, 11
    s_mul_i32 s96, s96, 393216
    s_xor_b32 s97, s18, 1
    s_mul_i32 s97, s97, 393216
    s_xor_b32 s98, s18, 2
    s_mul_i32 s98, s98, 393216
    s_xor_b32 s99, s18, 3
    s_mul_i32 s99, s99, 393216
    v_lshrrev_b32 v24, 4, v1
    v_lshrrev_b32 v25, 3, v24
    v_mul_u32_u24 v16, 2048, v25
    v_and_b32 v26, 2, v25
    v_lshrrev_b32 v25, 2, v25
    v_or_b32 v26, v26, v25
    v_bfe_u32 v25, v24, 1, 2
    v_xor_b32 v26, v26, v25
    v_lshl_add_u32 v16, v26, 5, v16
    v_and_b32 v26, 1, v24
    v_lshl_add_u32 v16, v26, 4, v16
    s_lshl_b32 s3, s18, 7
    v_add_u32 v16, s3, v16
    v_add_u32 v17, 15360, v16
    v_add_u32 v18, 30720, v16
    v_add_u32 v19, 46080, v16
    s_and_b32 s3, s16, 3
    s_mul_i32 s3, s3, 49152
    v_add_u32 v11, s3, v12
    s_and_b32 s3, s16, 3
    s_lshl_b32 s3, s3, 10
    v_add_u32 v9, s3, v1
    v_add_u32 v10, 0x10000, v9
    s_barrier
    v_lshrrev_b32 v24, 4, v1
    v_and_b32 v25, 1, v24
    v_lshlrev_b32 v25, 4, v25
    v_mov_b32 v26, 0x3f80
    v_lshlrev_b32 v25, v25, v26
    v_bfe_u32 v26, v24, 1, 2
    v_cmp_eq_u32 vcc, 0, v26
    s_nop 1
    v_cndmask_b32 v140, 0, v25, vcc
    v_cmp_eq_u32 vcc, 1, v26
    s_nop 1
    v_cndmask_b32 v141, 0, v25, vcc
    v_cmp_eq_u32 vcc, 2, v26
    s_nop 1
    v_cndmask_b32 v142, 0, v25, vcc
    v_cmp_eq_u32 vcc, 3, v26
    s_nop 1
    v_cndmask_b32 v143, 0, v25, vcc
    v_bfe_u32 v25, v24, 3, 1
    v_lshrrev_b32 v26, 5, v24
    v_lshl_add_u32 v26, v26, 1, v25
    v_lshlrev_b32 v25, 8, v26
    v_and_b32 v27, 7, v24
    v_lshl_add_u32 v25, v27, 5, v25
    v_bfe_u32 v27, v24, 4, 1
    v_lshl_add_u32 v25, v27, 4, v25
    v_add_u32 v27, s18, v26
    v_and_b32 v27, 15, v27
    v_lshl_add_u32 v25, v27, 14, v25
    s_lshl_b32 s44, s17, 10
    s_add_u32 s44, s44, 52428800
    s_waitcnt vmcnt(21)
    v_mfma_f32_16x16x32_bf16 v[128:131], v[140:143], v[32:35], 0
    v_mfma_f32_16x16x32_bf16 v[132:135], v[140:143], v[64:67], 0
    v_mfma_f32_16x16x32_bf16 v[136:139], v[140:143], v[96:99], 0
    s_waitcnt vmcnt(18)
    v_mfma_f32_16x16x32_bf16 v[128:131], v[140:143], v[36:39], v[128:131]
    v_mfma_f32_16x16x32_bf16 v[132:135], v[140:143], v[68:71], v[132:135]
    v_mfma_f32_16x16x32_bf16 v[136:139], v[140:143], v[100:103], v[136:139]
    s_waitcnt vmcnt(15)
    v_mfma_f32_16x16x32_bf16 v[128:131], v[140:143], v[40:43], v[128:131]
    v_mfma_f32_16x16x32_bf16 v[132:135], v[140:143], v[72:75], v[132:135]
    v_mfma_f32_16x16x32_bf16 v[136:139], v[140:143], v[104:107], v[136:139]
    s_waitcnt vmcnt(12)
    v_mfma_f32_16x16x32_bf16 v[128:131], v[140:143], v[44:47], v[128:131]
    v_mfma_f32_16x16x32_bf16 v[132:135], v[140:143], v[76:79], v[132:135]
    v_mfma_f32_16x16x32_bf16 v[136:139], v[140:143], v[108:111], v[136:139]
    s_waitcnt vmcnt(9)
    v_mfma_f32_16x16x32_bf16 v[128:131], v[140:143], v[48:51], v[128:131]
    v_mfma_f32_16x16x32_bf16 v[132:135], v[140:143], v[80:83], v[132:135]
    v_mfma_f32_16x16x32_bf16 v[136:139], v[140:143], v[112:115], v[136:139]
    s_waitcnt vmcnt(6)
    v_mfma_f32_16x16x32_bf16 v[128:131], v[140:143], v[52:55], v[128:131]
    v_mfma_f32_16x16x32_bf16 v[132:135], v[140:143], v[84:87], v[132:135]
    v_mfma_f32_16x16x32_bf16 v[136:139], v[140:143], v[116:119], v[136:139]
    s_waitcnt vmcnt(3)
    v_mfma_f32_16x16x32_bf16 v[128:131], v[140:143], v[56:59], v[128:131]
    v_mfma_f32_16x16x32_bf16 v[132:135], v[140:143], v[88:91], v[132:135]
    v_mfma_f32_16x16x32_bf16 v[136:139], v[140:143], v[120:123], v[136:139]
    s_waitcnt vmcnt(0)
    v_mfma_f32_16x16x32_bf16 v[128:131], v[140:143], v[60:63], v[128:131]
    v_mfma_f32_16x16x32_bf16 v[132:135], v[140:143], v[92:95], v[132:135]
    v_mfma_f32_16x16x32_bf16 v[136:139], v[140:143], v[124:127], v[136:139]
    s_barrier
    v_lshrrev_b32 v28, 4, v1
    v_and_b32 v29, 7, v28
    v_lshrrev_b32 v28, 3, v28
    v_mul_u32_u24 v28, 6144, v28
    v_lshl_add_u32 v28, v29, 4, v28
    s_and_b32 s3, s18, 12
    s_or_b32 s3, s3, 3
    s_lshl_b32 s3, s3, 7
    v_add_u32 v28, s3, v28
    s_lshr_b32 s3, s2, 3
    s_lshl_b32 s3, s3, 2
    s_and_b32 s60, s16, 3
    s_add_u32 s60, s60, s3
    s_lshr_b32 s60, s60, 2
    s_mul_i32 s60, s60, 49152
    s_cmp_lt_u32 s18, 4
    s_cselect_b32 s3, 0, 1
    s_mul_i32 s3, s3, 1572864
    s_add_u32 s3, s3, s60
    s_add_u32 s61, s3, 0
    buffer_load_dwordx4 v[160:163], v28, s[8:11], s61 offen
    s_add_u32 s61, s3, 2048
    buffer_load_dwordx4 v[164:167], v28, s[8:11], s61 offen
    s_add_u32 s61, s3, 4096
    buffer_load_dwordx4 v[168:171], v28, s[8:11], s61 offen
    s_add_u32 s3, s60, 3145728
    s_add_u32 s61, s3, 0
    buffer_load_dwordx4 v[172:175], v28, s[8:11], s61 offen
    s_add_u32 s61, s3, 2048
    buffer_load_dwordx4 v[176:179], v28, s[8:11], s61 offen
    s_add_u32 s61, s3, 4096
    buffer_load_dwordx4 v[180:183], v28, s[8:11], s61 offen
    s_add_u32 s3, s60, 4718592
    s_add_u32 s61, s3, 0
    buffer_load_dwordx4 v[184:187], v28, s[8:11], s61 offen
    s_add_u32 s61, s3, 2048
    buffer_load_dwordx4 v[188:191], v28, s[8:11], s61 offen
    s_add_u32 s61, s3, 4096
    buffer_load_dwordx4 v[192:195], v28, s[8:11], s61 offen
    v_add_f32_dpp v128, v128, v128 row_ror:8 row_mask:0xf bank_mask:0xf
    v_add_f32_dpp v129, v129, v129 row_ror:8 row_mask:0xf bank_mask:0xf
    v_add_f32_dpp v130, v130, v130 row_ror:8 row_mask:0xf bank_mask:0xf
    v_add_f32_dpp v131, v131, v131 row_ror:8 row_mask:0xf bank_mask:0xf
    v_add_f32_dpp v132, v132, v132 row_ror:8 row_mask:0xf bank_mask:0xf
    v_add_f32_dpp v133, v133, v133 row_ror:8 row_mask:0xf bank_mask:0xf
    v_add_f32_dpp v134, v134, v134 row_ror:8 row_mask:0xf bank_mask:0xf
    v_add_f32_dpp v135, v135, v135 row_ror:8 row_mask:0xf bank_mask:0xf
    v_add_f32_dpp v136, v136, v136 row_ror:8 row_mask:0xf bank_mask:0xf
    v_add_f32_dpp v137, v137, v137 row_ror:8 row_mask:0xf bank_mask:0xf
    v_add_f32_dpp v138, v138, v138 row_ror:8 row_mask:0xf bank_mask:0xf
    v_add_f32_dpp v139, v139, v139 row_ror:8 row_mask:0xf bank_mask:0xf
    v_cmp_le_u32 vcc, 1, v26
    s_nop 1
    v_cndmask_b32 v128, v128, v132, vcc
    v_cndmask_b32 v129, v129, v133, vcc
    v_cndmask_b32 v130, v130, v134, vcc
    v_cndmask_b32 v131, v131, v135, vcc
    v_cmp_le_u32 vcc, 2, v26
    s_nop 1
    v_cndmask_b32 v128, v128, v136, vcc
    v_cndmask_b32 v129, v129, v137, vcc
    v_cndmask_b32 v130, v130, v138, vcc
    v_cndmask_b32 v131, v131, v139, vcc
    buffer_store_dwordx4 v[128:131], v25, s[4:7], s44 offen sc1
    s_barrier
    s_barrier
    s_waitcnt vmcnt(0)
    s_add_u32 s44, s18, 0
    s_and_b32 s44, s44, 15
    s_lshl_b32 s44, s44, 7
    s_add_u32 s44, s44, 0
    s_atomic_add s40, s[22:23], s44
    s_add_u32 s45, s18, 1
    s_and_b32 s45, s45, 15
    s_lshl_b32 s45, s45, 7
    s_add_u32 s45, s45, 0
    s_atomic_add s40, s[22:23], s45
    s_add_u32 s46, s18, 2
    s_and_b32 s46, s46, 15
    s_lshl_b32 s46, s46, 7
    s_add_u32 s46, s46, 0
    s_atomic_add s40, s[22:23], s46
    s_barrier
    s_barrier
    s_barrier
    s_barrier
    s_barrier
    s_barrier
    s_mov_b32 s12, s26
    s_mov_b32 s13, s27
    s_mov_b32 s14, 2097152
    s_mov_b32 s15, 0x00020000
    s_lshl_b32 s44, s2, 13
    buffer_load_dwordx4 v[160:163], v1, s[12:15], s44 offen offset:0
    buffer_load_dwordx4 v[164:167], v1, s[12:15], s44 offen offset:1024
    buffer_load_dwordx4 v[168:171], v1, s[12:15], s44 offen offset:2048
    buffer_load_dwordx4 v[172:175], v1, s[12:15], s44 offen offset:3072
    s_add_u32 s44, s44, 4096
    buffer_load_dwordx4 v[176:179], v1, s[12:15], s44 offen offset:0
    buffer_load_dwordx4 v[180:183], v1, s[12:15], s44 offen offset:1024
    buffer_load_dwordx4 v[184:187], v1, s[12:15], s44 offen offset:2048
    buffer_load_dwordx4 v[188:191], v1, s[12:15], s44 offen offset:3072
    s_mov_b32 s8, s28
    s_mov_b32 s9, s29
    s_mov_b32 s10, 6291456
    s_mov_b32 s11, 0x00020000
    s_mul_i32 s44, s17, 393216
    buffer_load_dwordx4 v[32:35], v20, s[8:11], s44 offen
    buffer_load_dwordx4 v[64:67], v21, s[8:11], s44 offen
    buffer_load_dwordx4 v[96:99], v22, s[8:11], s44 offen
    s_add_u32 s44, s44, 49152
    buffer_load_dwordx4 v[36:39], v20, s[8:11], s44 offen
    buffer_load_dwordx4 v[68:71], v21, s[8:11], s44 offen
    buffer_load_dwordx4 v[100:103], v22, s[8:11], s44 offen
    s_add_u32 s44, s44, 49152
    buffer_load_dwordx4 v[40:43], v20, s[8:11], s44 offen
    buffer_load_dwordx4 v[72:75], v21, s[8:11], s44 offen
    buffer_load_dwordx4 v[104:107], v22, s[8:11], s44 offen
    s_add_u32 s44, s44, 49152
    s_barrier
    buffer_load_dwordx4 v[44:47], v20, s[8:11], s44 offen
    buffer_load_dwordx4 v[76:79], v21, s[8:11], s44 offen
    buffer_load_dwordx4 v[108:111], v22, s[8:11], s44 offen
    s_add_u32 s44, s44, 49152
    buffer_load_dwordx4 v[48:51], v20, s[8:11], s44 offen
    buffer_load_dwordx4 v[80:83], v21, s[8:11], s44 offen
    buffer_load_dwordx4 v[112:115], v22, s[8:11], s44 offen
    s_add_u32 s44, s44, 49152
    buffer_load_dwordx4 v[52:55], v20, s[8:11], s44 offen
    buffer_load_dwordx4 v[84:87], v21, s[8:11], s44 offen
    buffer_load_dwordx4 v[116:119], v22, s[8:11], s44 offen
    s_add_u32 s44, s44, 49152
    buffer_load_dwordx4 v[56:59], v20, s[8:11], s44 offen
    buffer_load_dwordx4 v[88:91], v21, s[8:11], s44 offen
    buffer_load_dwordx4 v[120:123], v22, s[8:11], s44 offen
    s_add_u32 s44, s44, 49152
    buffer_load_dwordx4 v[60:63], v20, s[8:11], s44 offen
    buffer_load_dwordx4 v[92:95], v21, s[8:11], s44 offen
    buffer_load_dwordx4 v[124:127], v22, s[8:11], s44 offen
    s_barrier
    s_bitcmp1_b32 s21, 0
    s_cselect_b32 s8, s28, s24
    s_cselect_b32 s9, s29, s25
    s_cselect_b32 s12, s30, s26
    s_cselect_b32 s13, s31, s27
    s_mov_b32 s10, 6291456
    s_mov_b32 s11, 0x00020000
    s_mov_b32 s14, 2097152
    s_mov_b32 s15, 0x00020000
    s_branch s_tail
z_layer:
    s_waitcnt lgkmcnt(0)
    v_lshrrev_b32 v28, 4, v1
    v_and_b32 v29, 7, v28
    v_lshrrev_b32 v28, 3, v28
    v_mul_u32_u24 v28, 6144, v28
    v_lshl_add_u32 v28, v29, 4, v28
    s_and_b32 s3, s18, 12
    s_or_b32 s3, s3, 3
    s_lshl_b32 s3, s3, 7
    v_add_u32 v28, s3, v28
    s_lshr_b32 s3, s2, 3
    s_lshl_b32 s3, s3, 2
    s_and_b32 s60, s16, 3
    s_add_u32 s60, s60, s3
    s_lshr_b32 s60, s60, 2
    s_mul_i32 s60, s60, 49152
    s_cmp_lt_u32 s18, 4
    s_cselect_b32 s3, 0, 1
    s_mul_i32 s3, s3, 1572864
    s_add_u32 s3, s3, s60
    s_add_u32 s61, s3, 0
    buffer_load_dwordx4 v[160:163], v28, s[8:11], s61 offen
    s_add_u32 s61, s3, 2048
    buffer_load_dwordx4 v[164:167], v28, s[8:11], s61 offen
    s_add_u32 s61, s3, 4096
    buffer_load_dwordx4 v[168:171], v28, s[8:11], s61 offen
    s_add_u32 s3, s60, 3145728
    s_add_u32 s61, s3, 0
    buffer_load_dwordx4 v[172:175], v28, s[8:11], s61 offen
    s_add_u32 s61, s3, 2048
    buffer_load_dwordx4 v[176:179], v28, s[8:11], s61 offen
    s_add_u32 s61, s3, 4096
    buffer_load_dwordx4 v[180:183], v28, s[8:11], s61 offen
    s_add_u32 s3, s60, 4718592
    s_add_u32 s61, s3, 0
    buffer_load_dwordx4 v[184:187], v28, s[8:11], s61 offen
    s_add_u32 s61, s3, 2048
    buffer_load_dwordx4 v[188:191], v28, s[8:11], s61 offen
    s_add_u32 s61, s3, 4096
    buffer_load_dwordx4 v[192:195], v28, s[8:11], s61 offen
    s_barrier
    s_barrier
    s_barrier
    s_barrier
    s_barrier
    s_barrier
    s_barrier
    s_barrier
    s_barrier
    s_barrier
    v_lshrrev_b32 v28, 4, v1
    v_and_b32 v29, 7, v28
    v_lshrrev_b32 v28, 3, v28
    v_mul_u32_u24 v28, 2048, v28
    v_lshl_add_u32 v28, v29, 4, v28
    s_and_b32 s3, s18, 12
    s_or_b32 s3, s3, 3
    s_lshl_b32 s3, s3, 7
    v_add_u32 v28, s3, v28
    s_lshr_b32 s3, s2, 3
    s_lshl_b32 s3, s3, 2
    s_and_b32 s60, s16, 3
    s_add_u32 s60, s60, s3
    s_lshl_b32 s61, s60, 14
    buffer_load_dwordx4 v[144:147], v28, s[12:15], s61 offen
    s_bitcmp0_b32 s21, 0
    s_cselect_b32 s56, s28, s24
    s_cselect_b32 s57, s29, s25
    s_mov_b32 s58, 6291456
    s_mov_b32 s59, 0x00020000
    v_lshrrev_b32 v28, 4, v1
    v_and_b32 v29, 7, v28
    v_lshrrev_b32 v28, 3, v28
    v_mul_u32_u24 v28, 6144, v28
    v_lshl_add_u32 v28, v29, 4, v28
    s_and_b32 s3, s18, 12
    s_or_b32 s3, s3, 3
    s_lshl_b32 s3, s3, 7
    v_add_u32 v28, s3, v28
    s_lshr_b32 s3, s2, 3
    s_lshl_b32 s3, s3, 2
    s_and_b32 s60, s16, 3
    s_add_u32 s60, s60, s3
    s_and_b32 s3, s60, 31
    s_mul_i32 s3, s3, 49152
    s_lshr_b32 s61, s60, 5
    s_min_u32 s61, s61, 2
    s_lshl_b32 s61, s61, 11
    s_add_u32 s61, s61, s3
    s_cmp_lt_u32 s18, 4
    s_cselect_b32 s3, 1572864, 0
    s_add_u32 s61, s61, s3
    buffer_load_dwordx4 v[148:151], v28, s[56:59], s61 offen
    s_cmp_lg_u32 s21, 2
    s_cbranch_scc1 z_pe
    s_bitcmp0_b32 s21, 0
    s_cselect_b32 s56, s28, s24
    s_cselect_b32 s57, s29, s25
    s_mov_b32 s58, 6291456
    s_mov_b32 s59, 0x00020000
    s_add_u32 s61, s84, 2048
    buffer_load_dwordx4 v[160:163], v11, s[56:59], s61 offen
    s_add_u32 s61, s84, 4096
    buffer_load_dwordx4 v[164:167], v11, s[56:59], s61 offen
    s_add_u32 s61, s84, 0
    buffer_load_dwordx4 v[168:171], v11, s[56:59], s61 offen
    s_add_u32 s61, s84, 198656
    buffer_load_dwordx4 v[172:175], v11, s[56:59], s61 offen
    s_add_u32 s61, s84, 200704
    buffer_load_dwordx4 v[176:179], v11, s[56:59], s61 offen
    s_add_u32 s61, s84, 196608
    buffer_load_dwordx4 v[180:183], v11, s[56:59], s61 offen
    s_add_u32 s61, s85, 2048
    buffer_load_dwordx4 v[184:187], v11, s[56:59], s61 offen
    s_add_u32 s61, s85, 4096
    buffer_load_dwordx4 v[188:191], v11, s[56:59], s61 offen
    s_add_u32 s61, s85, 0
    buffer_load_dwordx4 v[192:195], v11, s[56:59], s61 offen
    s_add_u32 s61, s85, 198656
    buffer_load_dwordx4 v[196:199], v11, s[56:59], s61 offen
z_pe:
    s_barrier
    s_branch s_tail
s_tail:
    s_bitcmp1_b32 s21, 0
    s_cbranch_scc1 s_B
    s_cmp_lg_u32 s16, 4
    s_cbranch_scc1 s_a1
    s_mov_b32 s45, 2146435072
    s_cmp_eq_u32 s17, 0
    s_cbranch_scc1 s_a0
    s_lshr_b32 s46, s21, 1
    s_lshl_b32 s44, s46, 15
    s_lshl_b32 s67, s17, 11
    s_add_u32 s44, s44, s67
    s_lshl_b32 s67, s18, 7
    s_add_u32 s44, s44, s67
    s_add_u32 s44, s44, 149504
    s_sub_u32 s45, s44, 151552
    s_lshl_b32 s45, s45, 5
    s_add_u32 s45, s45, 54525952
    s_mov_b32 s66, 0x10000
s_h_poll:
    s_mov_b32 s68, 0
    s_atomic_add s68, s[22:23], s44 offset:0 glc
    s_sub_u32 s66, s66, 1
    s_cselect_b32 s67, 1, 0
    s_waitcnt lgkmcnt(0)
    s_max_u32 s68, s68, s67
    s_cmp_lt_u32 s68, 1
    s_cbranch_scc1 s_h_poll
s_h_ok:
s_a0:
    s_mov_b32 m0, 131072
    s_nop 0
    buffer_load_dwordx4 v1, s[4:7], s45 offen offset:0 sc1 lds
    buffer_load_dwordx4 v1, s[4:7], s45 offen offset:1024 sc1 lds
    buffer_load_dwordx4 v1, s[4:7], s45 offen offset:2048 sc1 lds
    buffer_load_dwordx4 v1, s[4:7], s45 offen offset:3072 sc1 lds
    s_waitcnt vmcnt(0)
s_a1:
    s_barrier
    s_waitcnt vmcnt(0)
    s_barrier
    s_sub_u32 s3, s16, 5
    s_cmp_gt_u32 s3, 1
    s_cbranch_scc1 s_a2
    s_add_u32 m0, s41, 65536
    s_xor_b32 s44, s62, 65536
    buffer_load_dwordx4 v16, s[12:15], s44 offen offset:0 lds
    buffer_load_dwordx4 v17, s[12:15], s44 offen offset:1024 lds
    s_add_u32 m0, s41, 69632
    s_xor_b32 s44, s62, 196608
    buffer_load_dwordx4 v16, s[12:15], s44 offen offset:0 lds
    buffer_load_dwordx4 v17, s[12:15], s44 offen offset:1024 lds
    s_add_u32 m0, s41, 73728
    s_xor_b32 s44, s62, 327680
    buffer_load_dwordx4 v16, s[12:15], s44 offen offset:0 lds
    buffer_load_dwordx4 v17, s[12:15], s44 offen offset:1024 lds
    s_add_u32 m0, s41, 77824
    s_xor_b32 s44, s62, 458752
    buffer_load_dwordx4 v16, s[12:15], s44 offen offset:0 lds
    buffer_load_dwordx4 v17, s[12:15], s44 offen offset:1024 lds
    s_add_u32 m0, s41, 81920
    s_xor_b32 s44, s62, 589824
    buffer_load_dwordx4 v16, s[12:15], s44 offen offset:0 lds
    buffer_load_dwordx4 v17, s[12:15], s44 offen offset:1024 lds
    s_add_u32 m0, s41, 86016
    s_xor_b32 s44, s62, 720896
    buffer_load_dwordx4 v16, s[12:15], s44 offen offset:0 lds
    buffer_load_dwordx4 v17, s[12:15], s44 offen offset:1024 lds
    s_add_u32 m0, s41, 90112
    s_xor_b32 s44, s62, 851968
    buffer_load_dwordx4 v16, s[12:15], s44 offen offset:0 lds
    buffer_load_dwordx4 v17, s[12:15], s44 offen offset:1024 lds
    s_add_u32 m0, s41, 94208
    s_xor_b32 s44, s62, 983040
    buffer_load_dwordx4 v16, s[12:15], s44 offen offset:0 lds
    buffer_load_dwordx4 v17, s[12:15], s44 offen offset:1024 lds
    s_add_u32 m0, s41, 98304
    s_xor_b32 s44, s62, 1114112
    buffer_load_dwordx4 v16, s[12:15], s44 offen offset:0 lds
    buffer_load_dwordx4 v17, s[12:15], s44 offen offset:1024 lds
    s_add_u32 m0, s41, 102400
    s_xor_b32 s44, s62, 1245184
    buffer_load_dwordx4 v16, s[12:15], s44 offen offset:0 lds
    buffer_load_dwordx4 v17, s[12:15], s44 offen offset:1024 lds
    s_add_u32 m0, s41, 106496
    s_xor_b32 s44, s62, 1376256
    buffer_load_dwordx4 v16, s[12:15], s44 offen offset:0 lds
    buffer_load_dwordx4 v17, s[12:15], s44 offen offset:1024 lds
    s_add_u32 m0, s41, 110592
    s_xor_b32 s44, s62, 1507328
    buffer_load_dwordx4 v16, s[12:15], s44 offen offset:0 lds
    buffer_load_dwordx4 v17, s[12:15], s44 offen offset:1024 lds
    s_add_u32 m0, s41, 114688
    s_xor_b32 s44, s62, 1638400
    buffer_load_dwordx4 v16, s[12:15], s44 offen offset:0 lds
    buffer_load_dwordx4 v17, s[12:15], s44 offen offset:1024 lds
    s_add_u32 m0, s41, 118784
    s_xor_b32 s44, s62, 1769472
    buffer_load_dwordx4 v16, s[12:15], s44 offen offset:0 lds
    buffer_load_dwordx4 v17, s[12:15], s44 offen offset:1024 lds
    s_add_u32 m0, s41, 122880
    s_xor_b32 s44, s62, 1900544
    buffer_load_dwordx4 v16, s[12:15], s44 offen offset:0 lds
    buffer_load_dwordx4 v17, s[12:15], s44 offen offset:1024 lds
    s_add_u32 m0, s41, 126976
    s_xor_b32 s44, s62, 2031616
    buffer_load_dwordx4 v16, s[12:15], s44 offen offset:0 lds
    buffer_load_dwordx4 v17, s[12:15], s44 offen offset:1024 lds
s_a2:
    s_cmp_eq_u32 s21, 2
    s_cbranch_scc1 s_a3
    s_bitcmp0_b32 s21, 0
    s_cselect_b32 s56, s28, s24
    s_cselect_b32 s57, s29, s25
    s_mov_b32 s58, 6291456
    s_mov_b32 s59, 0x00020000
    s_add_u32 s61, s84, 2048
    buffer_load_dwordx4 v[160:163], v11, s[56:59], s61 offen
    s_add_u32 s61, s84, 4096
    buffer_load_dwordx4 v[164:167], v11, s[56:59], s61 offen
    s_add_u32 s61, s84, 0
    buffer_load_dwordx4 v[168:171], v11, s[56:59], s61 offen
    s_add_u32 s61, s84, 198656
    buffer_load_dwordx4 v[172:175], v11, s[56:59], s61 offen
    s_add_u32 s61, s84, 200704
    buffer_load_dwordx4 v[176:179], v11, s[56:59], s61 offen
    s_add_u32 s61, s84, 196608
    buffer_load_dwordx4 v[180:183], v11, s[56:59], s61 offen
    s_add_u32 s61, s85, 2048
    buffer_load_dwordx4 v[184:187], v11, s[56:59], s61 offen
    s_add_u32 s61, s85, 4096
    buffer_load_dwordx4 v[188:191], v11, s[56:59], s61 offen
    s_add_u32 s61, s85, 0
    buffer_load_dwordx4 v[192:195], v11, s[56:59], s61 offen
    s_add_u32 s61, s85, 198656
    buffer_load_dwordx4 v[196:199], v11, s[56:59], s61 offen
s_a3:
    s_bitcmp0_b32 s21, 0
    s_cselect_b32 s56, s28, s24
    s_cselect_b32 s57, s29, s25
    s_mov_b32 s58, 6291456
    s_mov_b32 s59, 0x00020000
    s_add_u32 s61, s85, 200704
    buffer_load_dwordx4 v[200:203], v11, s[56:59], s61 offen
    s_add_u32 s61, s85, 196608
    buffer_load_dwordx4 v[204:207], v11, s[56:59], s61 offen
    s_add_u32 s61, s86, 2048
    buffer_load_dwordx4 v[208:211], v11, s[56:59], s61 offen
    s_add_u32 s61, s86, 4096
    buffer_load_dwordx4 v[212:215], v11, s[56:59], s61 offen
    s_add_u32 s61, s86, 0
    buffer_load_dwordx4 v[216:219], v11, s[56:59], s61 offen
    s_add_u32 s61, s86, 198656
    buffer_load_dwordx4 v[220:223], v11, s[56:59], s61 offen
    s_add_u32 s61, s86, 200704
    buffer_load_dwordx4 v[224:227], v11, s[56:59], s61 offen
    s_add_u32 s61, s86, 196608
    buffer_load_dwordx4 v[228:231], v11, s[56:59], s61 offen
    s_add_u32 s61, s87, 2048
    buffer_load_dwordx4 v[232:235], v11, s[56:59], s61 offen
    s_add_u32 s61, s87, 4096
    buffer_load_dwordx4 v[236:239], v11, s[56:59], s61 offen
    s_add_u32 s61, s87, 0
    buffer_load_dwordx4 v[240:243], v11, s[56:59], s61 offen
    s_add_u32 s61, s87, 198656
    buffer_load_dwordx4 v[244:247], v11, s[56:59], s61 offen
    s_add_u32 s61, s87, 200704
    buffer_load_dwordx4 v[248:251], v11, s[56:59], s61 offen
    s_add_u32 s61, s87, 196608
    buffer_load_dwordx4 v[252:255], v11, s[56:59], s61 offen
    s_waitcnt vmcnt(0)
    s_lshl_b32 s3, s21, 3
    s_add_u32 s3, s3, s16
    s_cmp_lg_u32 s3, 7
    s_cbranch_scc1 s_g3
    v_lshrrev_b32 v24, 4, v1
    v_and_b32 v25, 1, v24
    v_lshlrev_b32 v25, 4, v25
    v_mov_b32 v26, 0x3f80
    v_lshlrev_b32 v25, v25, v26
    v_bfe_u32 v26, v24, 1, 2
    v_cmp_eq_u32 vcc, 0, v26
    s_nop 1
    v_cndmask_b32 v140, 0, v25, vcc
    v_cmp_eq_u32 vcc, 1, v26
    s_nop 1
    v_cndmask_b32 v141, 0, v25, vcc
    v_cmp_eq_u32 vcc, 2, v26
    s_nop 1
    v_cndmask_b32 v142, 0, v25, vcc
    v_cmp_eq_u32 vcc, 3, v26
    s_nop 1
    v_cndmask_b32 v143, 0, v25, vcc
    v_bfe_u32 v25, v24, 3, 1
    v_lshrrev_b32 v26, 5, v24
    v_lshl_add_u32 v26, v26, 1, v25
    v_lshlrev_b32 v25, 8, v26
    v_and_b32 v27, 7, v24
    v_lshl_add_u32 v25, v27, 5, v25
    v_bfe_u32 v27, v24, 4, 1
    v_lshl_add_u32 v25, v27, 4, v25
    v_add_u32 v27, s18, v26
    v_and_b32 v27, 15, v27
    v_lshl_add_u32 v25, v27, 14, v25
    s_lshl_b32 s44, s17, 10
    s_add_u32 s44, s44, 52690944
    v_mfma_f32_16x16x32_bf16 v[128:131], v[140:143], v[32:35], 0
    v_mfma_f32_16x16x32_bf16 v[132:135], v[140:143], v[64:67], 0
    v_mfma_f32_16x16x32_bf16 v[136:139], v[140:143], v[96:99], 0
    v_mfma_f32_16x16x32_bf16 v[128:131], v[140:143], v[36:39], v[128:131]
    v_mfma_f32_16x16x32_bf16 v[132:135], v[140:143], v[68:71], v[132:135]
    v_mfma_f32_16x16x32_bf16 v[136:139], v[140:143], v[100:103], v[136:139]
    v_mfma_f32_16x16x32_bf16 v[128:131], v[140:143], v[40:43], v[128:131]
    v_mfma_f32_16x16x32_bf16 v[132:135], v[140:143], v[72:75], v[132:135]
    v_mfma_f32_16x16x32_bf16 v[136:139], v[140:143], v[104:107], v[136:139]
    v_mfma_f32_16x16x32_bf16 v[128:131], v[140:143], v[44:47], v[128:131]
    v_mfma_f32_16x16x32_bf16 v[132:135], v[140:143], v[76:79], v[132:135]
    v_mfma_f32_16x16x32_bf16 v[136:139], v[140:143], v[108:111], v[136:139]
    v_mfma_f32_16x16x32_bf16 v[128:131], v[140:143], v[48:51], v[128:131]
    v_mfma_f32_16x16x32_bf16 v[132:135], v[140:143], v[80:83], v[132:135]
    v_mfma_f32_16x16x32_bf16 v[136:139], v[140:143], v[112:115], v[136:139]
    v_mfma_f32_16x16x32_bf16 v[128:131], v[140:143], v[52:55], v[128:131]
    v_mfma_f32_16x16x32_bf16 v[132:135], v[140:143], v[84:87], v[132:135]
    v_mfma_f32_16x16x32_bf16 v[136:139], v[140:143], v[116:119], v[136:139]
    v_mfma_f32_16x16x32_bf16 v[128:131], v[140:143], v[56:59], v[128:131]
    v_mfma_f32_16x16x32_bf16 v[132:135], v[140:143], v[88:91], v[132:135]
    v_mfma_f32_16x16x32_bf16 v[136:139], v[140:143], v[120:123], v[136:139]
    v_mfma_f32_16x16x32_bf16 v[128:131], v[140:143], v[60:63], v[128:131]
    v_mfma_f32_16x16x32_bf16 v[132:135], v[140:143], v[92:95], v[132:135]
    v_mfma_f32_16x16x32_bf16 v[136:139], v[140:143], v[124:127], v[136:139]
    s_nop 5
    v_add_f32_dpp v128, v128, v128 row_ror:8 row_mask:0xf bank_mask:0xf
    v_add_f32_dpp v129, v129, v129 row_ror:8 row_mask:0xf bank_mask:0xf
    v_add_f32_dpp v130, v130, v130 row_ror:8 row_mask:0xf bank_mask:0xf
    v_add_f32_dpp v131, v131, v131 row_ror:8 row_mask:0xf bank_mask:0xf
    v_add_f32_dpp v132, v132, v132 row_ror:8 row_mask:0xf bank_mask:0xf
    v_add_f32_dpp v133, v133, v133 row_ror:8 row_mask:0xf bank_mask:0xf
    v_add_f32_dpp v134, v134, v134 row_ror:8 row_mask:0xf bank_mask:0xf
    v_add_f32_dpp v135, v135, v135 row_ror:8 row_mask:0xf bank_mask:0xf
    v_add_f32_dpp v136, v136, v136 row_ror:8 row_mask:0xf bank_mask:0xf
    v_add_f32_dpp v137, v137, v137 row_ror:8 row_mask:0xf bank_mask:0xf
    v_add_f32_dpp v138, v138, v138 row_ror:8 row_mask:0xf bank_mask:0xf
    v_add_f32_dpp v139, v139, v139 row_ror:8 row_mask:0xf bank_mask:0xf
    v_cmp_le_u32 vcc, 1, v26
    s_nop 1
    v_cndmask_b32 v128, v128, v132, vcc
    v_cndmask_b32 v129, v129, v133, vcc
    v_cndmask_b32 v130, v130, v134, vcc
    v_cndmask_b32 v131, v131, v135, vcc
    v_cmp_le_u32 vcc, 2, v26
    s_nop 1
    v_cndmask_b32 v128, v128, v136, vcc
    v_cndmask_b32 v129, v129, v137, vcc
    v_cndmask_b32 v130, v130, v138, vcc
    v_cndmask_b32 v131, v131, v139, vcc
    buffer_store_dwordx4 v[128:131], v25, s[4:7], s44 offen sc1
    s_waitcnt vmcnt(0)
    s_add_u32 s44, s18, 0
    s_and_b32 s44, s44, 15
    s_lshl_b32 s44, s44, 7
    s_add_u32 s44, s44, 2048
    s_atomic_add s40, s[22:23], s44
    s_add_u32 s45, s18, 1
    s_and_b32 s45, s45, 15
    s_lshl_b32 s45, s45, 7
    s_add_u32 s45, s45, 2048
    s_atomic_add s40, s[22:23], s45
    s_add_u32 s46, s18, 2
    s_and_b32 s46, s46, 15
    s_lshl_b32 s46, s46, 7
    s_add_u32 s46, s46, 2048
    s_atomic_add s40, s[22:23], s46
    s_branch s_g3
s_B:
    s_barrier
    s_cmp_eq_u32 s21, 3
    s_cbranch_scc1 s_nopf
    s_bitcmp0_b32 s21, 0
    s_cselect_b32 s56, s28, s24
    s_cselect_b32 s57, s29, s25
    s_mov_b32 s58, 6291456
    s_mov_b32 s59, 0x00020000
    s_add_u32 s61, s84, 2048
    buffer_load_dwordx4 v[160:163], v11, s[56:59], s61 offen
    s_add_u32 s61, s84, 4096
    buffer_load_dwordx4 v[164:167], v11, s[56:59], s61 offen
    s_add_u32 s61, s84, 0
    buffer_load_dwordx4 v[168:171], v11, s[56:59], s61 offen
    s_add_u32 s61, s84, 198656
    buffer_load_dwordx4 v[172:175], v11, s[56:59], s61 offen
    s_waitcnt vmcnt(2)
    s_add_u32 s61, s84, 200704
    buffer_load_dwordx4 v[176:179], v11, s[56:59], s61 offen
    s_add_u32 s61, s84, 196608
    buffer_load_dwordx4 v[180:183], v11, s[56:59], s61 offen
    s_add_u32 s61, s85, 2048
    buffer_load_dwordx4 v[184:187], v11, s[56:59], s61 offen
    s_add_u32 s61, s85, 4096
    buffer_load_dwordx4 v[188:191], v11, s[56:59], s61 offen
    s_waitcnt vmcnt(2)
    s_add_u32 s61, s85, 0
    buffer_load_dwordx4 v[192:195], v11, s[56:59], s61 offen
    s_add_u32 s61, s85, 198656
    buffer_load_dwordx4 v[196:199], v11, s[56:59], s61 offen
    s_add_u32 s61, s85, 200704
    buffer_load_dwordx4 v[200:203], v11, s[56:59], s61 offen
    s_add_u32 s61, s85, 196608
    buffer_load_dwordx4 v[204:207], v11, s[56:59], s61 offen
    s_waitcnt vmcnt(2)
    s_add_u32 s61, s86, 2048
    buffer_load_dwordx4 v[208:211], v11, s[56:59], s61 offen
    s_add_u32 s61, s86, 4096
    buffer_load_dwordx4 v[212:215], v11, s[56:59], s61 offen
    s_add_u32 s61, s86, 0
    buffer_load_dwordx4 v[216:219], v11, s[56:59], s61 offen
    s_add_u32 s61, s86, 198656
    buffer_load_dwordx4 v[220:223], v11, s[56:59], s61 offen
    s_waitcnt vmcnt(2)
    s_add_u32 s61, s86, 200704
    buffer_load_dwordx4 v[224:227], v11, s[56:59], s61 offen
    s_add_u32 s61, s86, 196608
    buffer_load_dwordx4 v[228:231], v11, s[56:59], s61 offen
    s_add_u32 s61, s87, 2048
    buffer_load_dwordx4 v[232:235], v11, s[56:59], s61 offen
    s_add_u32 s61, s87, 4096
    buffer_load_dwordx4 v[236:239], v11, s[56:59], s61 offen
    s_waitcnt vmcnt(2)
    s_add_u32 s61, s87, 0
    buffer_load_dwordx4 v[240:243], v11, s[56:59], s61 offen
    s_add_u32 s61, s87, 198656
    buffer_load_dwordx4 v[244:247], v11, s[56:59], s61 offen
    s_add_u32 s61, s87, 200704
    buffer_load_dwordx4 v[248:251], v11, s[56:59], s61 offen
    s_add_u32 s61, s87, 196608
    buffer_load_dwordx4 v[252:255], v11, s[56:59], s61 offen
    s_waitcnt vmcnt(2)
    s_lshl_b32 s3, s2, 2
    s_and_b32 s60, s16, 3
    s_add_u32 s60, s60, s3
    s_lshl_b32 s60, s60, 11
    buffer_load_dwordx4 v[96:99], v1, s[12:15], s60 offen offset:0
    buffer_load_dwordx4 v[100:103], v1, s[12:15], s60 offen offset:1024
s_nopf:
    s_setprio 3
    s_mov_b32 s52, 0
    s_lshl_b32 s44, s16, 14
    v_add_u32 v24, s44, v1
    s_and_b32 s3, s16, 3
    s_lshl_b32 s44, s3, 10
    s_add_u32 s44, s44, 147456
    v_lshrrev_b32 v25, 2, v1
    v_add_u32 v25, s44, v25
    s_lshl_b32 s53, s21, 22
    s_lshl_b32 s44, s38, 16
    s_add_u32 s53, s53, s44
    s_lshl_b32 s44, s18, 12
    s_add_u32 s53, s53, s44
    s_add_u32 s53, s53, 16777216
    s_lshl_b32 s54, s21, 14
    s_lshl_b32 s67, s38, 8
    s_add_u32 s54, s54, s67
    s_add_u32 s54, s54, 86016
s_bhead:
    s_barrier
    s_waitcnt vmcnt(0) lgkmcnt(0)
    s_barrier
    ds_read_b32 v28, v25 offset:0
    ds_read_b32 v29, v25 offset:256
    ds_read_b32 v30, v25 offset:512
    ds_read_b32 v31, v25 offset:768
    ds_read_b128 v[32:35], v24 offset:0
    ds_read_b128 v[36:39], v24 offset:1024
    ds_read_b128 v[40:43], v24 offset:2048
    ds_read_b128 v[44:47], v24 offset:3072
    ds_read_b128 v[48:51], v24 offset:4096
    ds_read_b128 v[52:55], v24 offset:5120
    ds_read_b128 v[56:59], v24 offset:6144
    ds_read_b128 v[60:63], v24 offset:7168
    ds_read_b128 v[64:67], v24 offset:8192
    ds_read_b128 v[68:71], v24 offset:9216
    ds_read_b128 v[72:75], v24 offset:10240
    ds_read_b128 v[76:79], v24 offset:11264
    ds_read_b128 v[80:83], v24 offset:12288
    ds_read_b128 v[84:87], v24 offset:13312
    ds_read_b128 v[88:91], v24 offset:14336
    ds_read_b128 v[92:95], v24 offset:15360
    s_waitcnt lgkmcnt(14)
    v_add_f32 v28, v28, v29
    v_add_f32 v30, v30, v31
    v_add_f32 v28, v28, v30
    v_mov_b32 v29, 0x5d800000
    v_mov_b32 v30, 0x21800000
    v_cmp_nlt_f32 s[44:45], v28, v29
    v_cmp_ngt_f32 vcc, v28, v30
    v_rcp_f32 v28, v28
    s_or_b64 vcc, vcc, s[44:45]
    s_waitcnt lgkmcnt(8)
    v_pk_add_f32 v[32:33], v[32:33], v[48:49]
    v_pk_add_f32 v[34:35], v[34:35], v[50:51]
    v_pk_add_f32 v[36:37], v[36:37], v[52:53]
    v_pk_add_f32 v[38:39], v[38:39], v[54:55]
    v_pk_add_f32 v[40:41], v[40:41], v[56:57]
    v_pk_add_f32 v[42:43], v[42:43], v[58:59]
    v_pk_add_f32 v[44:45], v[44:45], v[60:61]
    v_pk_add_f32 v[46:47], v[46:47], v[62:63]
    s_waitcnt lgkmcnt(4)
    v_pk_add_f32 v[32:33], v[32:33], v[64:65]
    v_pk_add_f32 v[34:35], v[34:35], v[66:67]
    v_pk_add_f32 v[36:37], v[36:37], v[68:69]
    v_pk_add_f32 v[38:39], v[38:39], v[70:71]
    v_pk_add_f32 v[40:41], v[40:41], v[72:73]
    v_pk_add_f32 v[42:43], v[42:43], v[74:75]
    v_pk_add_f32 v[44:45], v[44:45], v[76:77]
    v_pk_add_f32 v[46:47], v[46:47], v[78:79]
    s_waitcnt lgkmcnt(0)
    v_pk_add_f32 v[32:33], v[32:33], v[80:81]
    v_pk_add_f32 v[34:35], v[34:35], v[82:83]
    v_pk_add_f32 v[36:37], v[36:37], v[84:85]
    v_pk_add_f32 v[38:39], v[38:39], v[86:87]
    v_pk_add_f32 v[40:41], v[40:41], v[88:89]
    v_pk_add_f32 v[42:43], v[42:43], v[90:91]
    v_pk_add_f32 v[44:45], v[44:45], v[92:93]
    v_pk_add_f32 v[46:47], v[46:47], v[94:95]
    s_cbranch_vccnz s_slow
s_fin:
    v_pk_mul_f32 v[32:33], v[28:29], v[32:33] op_sel_hi:[0,1]
    v_pk_mul_f32 v[34:35], v[28:29], v[34:35] op_sel_hi:[0,1]
    v_pk_mul_f32 v[36:37], v[28:29], v[36:37] op_sel_hi:[0,1]
    v_pk_mul_f32 v[38:39], v[28:29], v[38:39] op_sel_hi:[0,1]
    v_pk_mul_f32 v[40:41], v[28:29], v[40:41] op_sel_hi:[0,1]
    v_pk_mul_f32 v[42:43], v[28:29], v[42:43] op_sel_hi:[0,1]
    v_pk_mul_f32 v[44:45], v[28:29], v[44:45] op_sel_hi:[0,1]
    v_pk_mul_f32 v[46:47], v[28:29], v[46:47] op_sel_hi:[0,1]
    v_cvt_pk_bf16_f32 v32, v32, v33
    v_cvt_pk_bf16_f32 v33, v34, v35
    v_cvt_pk_bf16_f32 v34, v36, v37
    v_cvt_pk_bf16_f32 v35, v38, v39
    v_cvt_pk_bf16_f32 v36, v40, v41
    v_cvt_pk_bf16_f32 v37, v42, v43
    v_cvt_pk_bf16_f32 v38, v44, v45
    v_cvt_pk_bf16_f32 v39, v46, v47
    buffer_store_dwordx4 v[32:35], v1, s[4:7], s53 offen offset:0 sc1
    buffer_store_dwordx4 v[36:39], v1, s[4:7], s53 offen offset:1024 sc1
    s_cmp_lg_u32 s52, 0
    s_cbranch_scc1 s_b2
    s_waitcnt vmcnt(0)
    s_atomic_add s40, s[22:23], s54
    s_mov_b32 s52, 1
    s_add_u32 s53, s53, 2048
    s_waitcnt lgkmcnt(0)
    s_add_u32 s54, s54, 128
    s_setprio 0
    s_and_b32 s3, s16, 3
    s_lshl_b32 s46, s3, 19
    s_lshl_b32 s45, s3, 14
    s_and_b32 s3, s18, 0
    s_lshl_b32 s3, s3, 17
    s_xor_b32 s46, s46, s3
    s_add_u32 m0, s45, 0
    s_xor_b32 s44, s46, 0
    buffer_load_dwordx4 v16, s[12:15], s44 offen offset:0 lds
    buffer_load_dwordx4 v17, s[12:15], s44 offen offset:1024 lds
    buffer_load_dwordx4 v18, s[12:15], s44 offen offset:2048 lds
    buffer_load_dwordx4 v19, s[12:15], s44 offen offset:3072 lds
    s_add_u32 s44, s44, 65536
    s_waitcnt vmcnt(2)
    buffer_load_dwordx4 v[96:99], v16, s[12:15], s44 offen offset:0
    buffer_load_dwordx4 v[100:103], v17, s[12:15], s44 offen offset:1024
    buffer_load_dwordx4 v[104:107], v18, s[12:15], s44 offen offset:2048
    buffer_load_dwordx4 v[108:111], v19, s[12:15], s44 offen offset:3072
    s_waitcnt vmcnt(2)
    s_add_u32 m0, s45, 4096
    s_xor_b32 s44, s46, 131072
    buffer_load_dwordx4 v16, s[12:15], s44 offen offset:0 lds
    buffer_load_dwordx4 v17, s[12:15], s44 offen offset:1024 lds
    buffer_load_dwordx4 v18, s[12:15], s44 offen offset:2048 lds
    buffer_load_dwordx4 v19, s[12:15], s44 offen offset:3072 lds
    s_add_u32 s44, s44, 65536
    s_waitcnt vmcnt(2)
    buffer_load_dwordx4 v[112:115], v16, s[12:15], s44 offen offset:0
    buffer_load_dwordx4 v[116:119], v17, s[12:15], s44 offen offset:1024
    buffer_load_dwordx4 v[120:123], v18, s[12:15], s44 offen offset:2048
    buffer_load_dwordx4 v[124:127], v19, s[12:15], s44 offen offset:3072
    s_waitcnt vmcnt(2)
    s_add_u32 m0, s45, 8192
    s_xor_b32 s44, s46, 262144
    buffer_load_dwordx4 v16, s[12:15], s44 offen offset:0 lds
    buffer_load_dwordx4 v17, s[12:15], s44 offen offset:1024 lds
    buffer_load_dwordx4 v18, s[12:15], s44 offen offset:2048 lds
    buffer_load_dwordx4 v19, s[12:15], s44 offen offset:3072 lds
    s_add_u32 s44, s44, 65536
    s_waitcnt vmcnt(2)
    buffer_load_dwordx4 v[128:131], v16, s[12:15], s44 offen offset:0
    buffer_load_dwordx4 v[132:135], v17, s[12:15], s44 offen offset:1024
    buffer_load_dwordx4 v[136:139], v18, s[12:15], s44 offen offset:2048
    buffer_load_dwordx4 v[140:143], v19, s[12:15], s44 offen offset:3072
    s_waitcnt vmcnt(2)
    s_add_u32 m0, s45, 12288
    s_xor_b32 s44, s46, 393216
    buffer_load_dwordx4 v16, s[12:15], s44 offen offset:0 lds
    buffer_load_dwordx4 v17, s[12:15], s44 offen offset:1024 lds
    buffer_load_dwordx4 v18, s[12:15], s44 offen offset:2048 lds
    buffer_load_dwordx4 v19, s[12:15], s44 offen offset:3072 lds
    s_add_u32 s44, s44, 65536
    s_waitcnt vmcnt(2)
    buffer_load_dwordx4 v[144:147], v16, s[12:15], s44 offen offset:0
    buffer_load_dwordx4 v[148:151], v17, s[12:15], s44 offen offset:1024
    buffer_load_dwordx4 v[152:155], v18, s[12:15], s44 offen offset:2048
    buffer_load_dwordx4 v[156:159], v19, s[12:15], s44 offen offset:3072
    s_waitcnt vmcnt(2)
    s_setprio 3
    s_sub_u32 s44, s54, 128
    s_mov_b32 s66, 0x10000
s_o0_poll:
    s_mov_b32 s68, 0
    s_atomic_add s68, s[22:23], s44 offset:0 glc
    s_sub_u32 s66, s66, 1
    s_cselect_b32 s67, 16, 0
    s_waitcnt lgkmcnt(0)
    s_max_u32 s68, s68, s67
    s_cmp_lt_u32 s68, 16
    s_cbranch_scc1 s_o0_poll
s_o0_ok:
    s_branch s_bhead
s_b2:
    ds_write_b128 v24, v[96:99] offset:0
    ds_write_b128 v24, v[100:103] offset:1024
    ds_write_b128 v24, v[104:107] offset:2048
    ds_write_b128 v24, v[108:111] offset:3072
    ds_write_b128 v24, v[112:115] offset:4096
    ds_write_b128 v24, v[116:119] offset:5120
    ds_write_b128 v24, v[120:123] offset:6144
    ds_write_b128 v24, v[124:127] offset:7168
    ds_write_b128 v24, v[128:131] offset:8192
    ds_write_b128 v24, v[132:135] offset:9216
    ds_write_b128 v24, v[136:139] offset:10240
    ds_write_b128 v24, v[140:143] offset:11264
    ds_write_b128 v24, v[144:147] offset:12288
    ds_write_b128 v24, v[148:151] offset:13312
    ds_write_b128 v24, v[152:155] offset:14336
    ds_write_b128 v24, v[156:159] offset:15360
    s_waitcnt vmcnt(0)
    s_atomic_add s40, s[22:23], s54
    s_mov_b32 s66, 0x10000
s_o1_poll:
    s_mov_b32 s68, 0
    s_atomic_add s68, s[22:23], s54 offset:0 glc
    s_sub_u32 s66, s66, 1
    s_cselect_b32 s67, 16, 0
    s_waitcnt lgkmcnt(0)
    s_max_u32 s68, s68, s67
    s_cmp_lt_u32 s68, 16
    s_cbranch_scc1 s_o1_poll
s_o1_ok:
s_b3:
    s_setprio 0
    s_waitcnt lgkmcnt(0)
s_g3:
    s_barrier
    s_cmp_eq_u32 s21, 3
    s_cbranch_scc1 s_end
    s_barrier
    ds_write_b128 v9, v[160:163] offset:0
    ds_write_b128 v9, v[164:167] offset:4096
    ds_write_b128 v9, v[168:171] offset:8192
    ds_write_b128 v9, v[172:175] offset:12288
    ds_write_b128 v9, v[176:179] offset:16384
    ds_write_b128 v9, v[180:183] offset:20480
    ds_write_b128 v9, v[184:187] offset:24576
    ds_write_b128 v9, v[188:191] offset:28672
    s_add_u32 s21, s21, 1
    s_bitcmp1_b32 s21, 0
    s_cselect_b32 s8, s28, s24
    s_cselect_b32 s9, s29, s25
    s_cselect_b32 s12, s30, s26
    s_cselect_b32 s13, s31, s27
    s_mov_b32 s10, 6291456
    s_mov_b32 s11, 0x00020000
    s_mov_b32 s14, 2097152
    s_mov_b32 s15, 0x00020000
    s_sub_u32 s3, s16, 5
    s_cmp_gt_u32 s3, 1
    s_cbranch_scc1 s_n67
    s_add_u32 m0, s41, 98304
    s_add_u32 s44, s88, 2048
    buffer_load_dwordx4 v14, s[8:11], s44 offen offset:0 lds
    buffer_load_dwordx4 v15, s[8:11], s44 offen offset:1024 lds
    s_add_u32 m0, s41, 102400
    s_add_u32 s44, s88, 4096
    buffer_load_dwordx4 v14, s[8:11], s44 offen offset:0 lds
    buffer_load_dwordx4 v15, s[8:11], s44 offen offset:1024 lds
    s_add_u32 m0, s41, 106496
    s_add_u32 s44, s88, 0
    buffer_load_dwordx4 v14, s[8:11], s44 offen offset:0 lds
    buffer_load_dwordx4 v15, s[8:11], s44 offen offset:1024 lds
    s_add_u32 m0, s41, 110592
    s_add_u32 s44, s88, 198656
    buffer_load_dwordx4 v14, s[8:11], s44 offen offset:0 lds
    buffer_load_dwordx4 v15, s[8:11], s44 offen offset:1024 lds
    s_add_u32 m0, s41, 114688
    s_add_u32 s44, s88, 200704
    buffer_load_dwordx4 v14, s[8:11], s44 offen offset:0 lds
    buffer_load_dwordx4 v15, s[8:11], s44 offen offset:1024 lds
    s_add_u32 m0, s41, 118784
    s_add_u32 s44, s88, 196608
    buffer_load_dwordx4 v14, s[8:11], s44 offen offset:0 lds
    buffer_load_dwordx4 v15, s[8:11], s44 offen offset:1024 lds
    s_add_u32 m0, s41, 122880
    s_add_u32 s44, s89, 2048
    buffer_load_dwordx4 v14, s[8:11], s44 offen offset:0 lds
    buffer_load_dwordx4 v15, s[8:11], s44 offen offset:1024 lds
    s_add_u32 m0, s41, 126976
    s_add_u32 s44, s89, 4096
    buffer_load_dwordx4 v14, s[8:11], s44 offen offset:0 lds
    buffer_load_dwordx4 v15, s[8:11], s44 offen offset:1024 lds
s_n67:
    s_waitcnt lgkmcnt(0)
    s_barrier
    ds_write_b128 v9, v[192:195] offset:32768
    ds_write_b128 v9, v[196:199] offset:36864
    ds_write_b128 v9, v[200:203] offset:40960
    ds_write_b128 v9, v[204:207] offset:45056
    ds_write_b128 v9, v[208:211] offset:49152
    ds_write_b128 v9, v[212:215] offset:53248
    ds_write_b128 v9, v[216:219] offset:57344
    ds_write_b128 v9, v[220:223] offset:61440
    ds_write_b128 v10, v[224:227] offset:0
    ds_write_b128 v10, v[228:231] offset:4096
    ds_write_b128 v10, v[232:235] offset:8192
    ds_write_b128 v10, v[236:239] offset:12288
    ds_write_b128 v10, v[240:243] offset:16384
    ds_write_b128 v10, v[244:247] offset:20480
    ds_write_b128 v10, v[248:251] offset:24576
    ds_write_b128 v10, v[252:255] offset:28672
    s_cmp_eq_u32 s16, 4
    s_cbranch_scc1 h_layer
    s_cmp_eq_u32 s16, 7
    s_cbranch_scc1 z_layer
    s_branch l_layer
s_end:
    s_lshl_b32 s3, s2, 3
    s_add_u32 s3, s3, s16
    s_cmp_lg_u32 s3, 7
    s_cbranch_scc1 k_exit
    s_mov_b32 s8, s34
    s_mov_b32 s9, s35
    s_mov_b32 s10, 256
    s_mov_b32 s11, 0x00020000
    v_lshrrev_b32 v24, 2, v1
    v_mov_b32 v25, 0
    buffer_store_dword v25, v24, s[8:11], 0 offen sc1
    s_branch k_exit
s_slow:
    s_and_b32 s3, s16, 3
    s_lshl_b32 s44, s3, 11
    s_lshl_b32 s45, s52, 13
    s_add_u32 s44, s44, s45
    s_add_u32 s44, s44, 131072
    v_add_u32 v26, s44, v1
    ds_read_b128 v[48:51], v26 offset:0
    ds_read_b128 v[52:55], v26 offset:1024
    s_lshr_b32 s55, s21, 1
    s_lshl_b32 s55, s55, 23
    s_lshl_b32 s44, s18, 18
    s_add_u32 s55, s55, s44
    s_lshl_b32 s44, s52, 17
    s_add_u32 s55, s55, s44
    s_add_u32 s55, s55, 33554432
    s_waitcnt lgkmcnt(0)
    v_mov_b32 v26, 0xff800000
    s_mov_b32 s61, 0
s_slow1:
    s_add_u32 s44, s55, s61
    buffer_load_dwordx4 v[56:59], v1, s[4:7], s44 offen offset:0 sc1
    buffer_load_dwordx4 v[60:63], v1, s[4:7], s44 offen offset:1024 sc1
    s_waitcnt vmcnt(0)
    v_mfma_f32_32x32x16_bf16 v[72:87], v[56:59], v[48:51], 0
    v_mfma_f32_32x32x16_bf16 v[72:87], v[60:63], v[52:55], v[72:87]
    s_nop 11
    v_max3_f32 v26, v26, v72, v73
    v_max3_f32 v26, v26, v74, v75
    v_max3_f32 v26, v26, v76, v77
    v_max3_f32 v26, v26, v78, v79
    v_max3_f32 v26, v26, v80, v81
    v_max3_f32 v26, v26, v82, v83
    v_max3_f32 v26, v26, v84, v85
    v_max3_f32 v26, v26, v86, v87
    s_add_u32 s61, s61, 2048
    s_cmp_lt_u32 s61, 131072
    s_cbranch_scc1 s_slow1
    v_mov_b32 v27, v26
    s_nop 1
    v_permlane32_swap_b32 v26, v27
    v_max_f32 v26, v26, v27
    v_mov_b32 v32, 0
    v_mov_b32 v33, 0
    v_mov_b32 v34, 0
    v_mov_b32 v35, 0
    v_mov_b32 v36, 0
    v_mov_b32 v37, 0
    v_mov_b32 v38, 0
    v_mov_b32 v39, 0
    v_mov_b32 v40, 0
    v_mov_b32 v41, 0
    v_mov_b32 v42, 0
    v_mov_b32 v43, 0
    v_mov_b32 v44, 0
    v_mov_b32 v45, 0
    v_mov_b32 v46, 0
    v_mov_b32 v47, 0
    v_mov_b32 v28, 0
    v_mov_b32 v29, 0xdddddddd
    s_mov_b32 s3, 0xffff0000
    s_mov_b32 s61, 0
s_slow2:
    s_add_u32 s44, s55, s61
    buffer_load_dwordx4 v[56:59], v1, s[4:7], s44 offen offset:0 sc1
    buffer_load_dwordx4 v[60:63], v1, s[4:7], s44 offen offset:1024 sc1
    s_add_u32 s44, s44, 4194304
    buffer_load_dwordx4 v[64:67], v1, s[4:7], s44 offen offset:0 sc1
    buffer_load_dwordx4 v[68:71], v1, s[4:7], s44 offen offset:1024 sc1
    s_waitcnt vmcnt(0)
    v_mfma_f32_32x32x16_bf16 v[72:87], v[56:59], v[48:51], 0
    v_mfma_f32_32x32x16_bf16 v[72:87], v[60:63], v[52:55], v[72:87]
    s_nop 11
    v_sub_f32 v72, v72, v26
    v_sub_f32 v73, v73, v26
    v_sub_f32 v74, v74, v26
    v_sub_f32 v75, v75, v26
    v_sub_f32 v76, v76, v26
    v_sub_f32 v77, v77, v26
    v_sub_f32 v78, v78, v26
    v_sub_f32 v79, v79, v26
    v_sub_f32 v80, v80, v26
    v_sub_f32 v81, v81, v26
    v_sub_f32 v82, v82, v26
    v_sub_f32 v83, v83, v26
    v_sub_f32 v84, v84, v26
    v_sub_f32 v85, v85, v26
    v_sub_f32 v86, v86, v26
    v_sub_f32 v87, v87, v26
    v_exp_f32 v72, v72
    v_exp_f32 v73, v73
    v_exp_f32 v74, v74
    v_exp_f32 v75, v75
    v_exp_f32 v76, v76
    v_exp_f32 v77, v77
    v_exp_f32 v78, v78
    v_exp_f32 v79, v79
    v_exp_f32 v80, v80
    v_exp_f32 v81, v81
    v_exp_f32 v82, v82
    v_exp_f32 v83, v83
    v_exp_f32 v84, v84
    v_exp_f32 v85, v85
    v_exp_f32 v86, v86
    v_exp_f32 v87, v87
    v_and_b32 v72, s3, v72
    v_and_b32 v73, s3, v73
    v_and_b32 v74, s3, v74
    v_and_b32 v75, s3, v75
    v_and_b32 v76, s3, v76
    v_and_b32 v77, s3, v77
    v_and_b32 v78, s3, v78
    v_and_b32 v79, s3, v79
    v_and_b32 v80, s3, v80
    v_and_b32 v81, s3, v81
    v_and_b32 v82, s3, v82
    v_and_b32 v83, s3, v83
    v_and_b32 v84, s3, v84
    v_and_b32 v85, s3, v85
    v_and_b32 v86, s3, v86
    v_and_b32 v87, s3, v87
    v_add_f32 v28, v28, v72
    v_add_f32 v28, v28, v73
    v_add_f32 v28, v28, v74
    v_add_f32 v28, v28, v75
    v_add_f32 v28, v28, v76
    v_add_f32 v28, v28, v77
    v_add_f32 v28, v28, v78
    v_add_f32 v28, v28, v79
    v_add_f32 v28, v28, v80
    v_add_f32 v28, v28, v81
    v_add_f32 v28, v28, v82
    v_add_f32 v28, v28, v83
    v_add_f32 v28, v28, v84
    v_add_f32 v28, v28, v85
    v_add_f32 v28, v28, v86
    v_add_f32 v28, v28, v87
    v_smfmac_f32_32x32x32_bf16 v[32:47], v[64:67], v[72:79], v29
    v_smfmac_f32_32x32x32_bf16 v[32:47], v[68:71], v[80:87], v29
    s_add_u32 s61, s61, 2048
    s_cmp_lt_u32 s61, 131072
    s_cbranch_scc1 s_slow2
    v_mov_b32 v29, v28
    s_nop 1
    v_permlane32_swap_b32 v28, v29
    v_add_f32 v28, v28, v29
    v_rcp_f32 v28, v28
    s_nop 7
    s_branch s_fin
k_exit:
    s_endpgm
.if k_exit - interleave_layers__sliding_local_dilated__softmax_full_mha__prompt_kernel < 49152
.error "code prefetch reads past the end of the code"
.endif
.section .rodata,"a"
.p2align 6
.amdhsa_kernel interleave_layers__sliding_local_dilated__softmax_full_mha__prompt_kernel
  .amdhsa_next_free_vgpr 256
  .amdhsa_next_free_sgpr 102
  .amdhsa_accum_offset 256
  .amdhsa_group_segment_fixed_size 0
  .amdhsa_kernarg_size 72
  .amdhsa_user_sgpr_count 2
  .amdhsa_user_sgpr_kernarg_segment_ptr 1
  .amdhsa_system_sgpr_workgroup_id_x 1
.end_amdhsa_kernel
```

```asm
; @launch grid=(256,1,1) block=(512,1,1) lds=156736
.amdgcn_target "amdgcn-amd-amdhsa--gfx950"
.text
.globl interleave_layers__sliding_local_dilated__softmax_full_mha__prompt_kernel
.type interleave_layers__sliding_local_dilated__softmax_full_mha__prompt_kernel,@function
.p2align 8
interleave_layers__sliding_local_dilated__softmax_full_mha__prompt_kernel:
    s_cmp_ge_u32 s2, 256
    s_cbranch_scc1 k_exit
    s_load_dwordx2 s[36:37], s[0:1], 0
    s_load_dwordx4 s[24:27], s[0:1], 8
    s_load_dwordx8 s[28:35], s[0:1], 32
    s_load_dwordx2 s[44:45], s[0:1], 64
    v_lshrrev_b32 v2, 6, v0
    v_and_b32 v0, 63, v0
    v_readfirstlane_b32 s16, v2
    v_lshlrev_b32 v1, 4, v0
    s_mov_b32 s21, 0
    s_mov_b32 s40, 1
    s_and_b32 s3, s2, 1
    s_lshl_b32 s3, s3, 3
    s_bfe_u32 s17, s2, 0x30003
    s_add_u32 s17, s17, s3
    s_bfe_u32 s3, s2, 0x20001
    s_lshl_b32 s3, s3, 2
    s_lshr_b32 s18, s2, 6
    s_add_u32 s18, s18, s3
    s_and_b32 s3, s16, 3
    s_lshl_b32 s38, s17, 2
    s_add_u32 s38, s38, s3
    v_lshrrev_b32 v32, 3, v0
    v_and_b32 v33, 7, v0
    v_lshlrev_b32 v34, 11, v32
    v_lshl_add_u32 v34, v33, 4, v34
    s_lshl_b32 s46, s38, 16
    s_lshl_b32 s47, s18, 7
    s_add_u32 s46, s46, s47
    s_getpc_b64 s[76:77]
e_pc:
    s_sub_u32 s76, s76, e_pc - interleave_layers__sliding_local_dilated__softmax_full_mha__prompt_kernel
    s_subb_u32 s77, s77, 0
    s_and_b32 s3, s2, 0xf8
    s_add_u32 s3, s3, s16
    s_lshl_b32 s3, s3, 6
    s_add_u32 s78, s3, 49152
    s_min_u32 s78, s78, k_exit - interleave_layers__sliding_local_dilated__softmax_full_mha__prompt_kernel
    s_waitcnt lgkmcnt(0)
    s_mov_b32 s8, s36
    s_mov_b32 s9, s37
    s_mov_b32 s10, 4194304
    s_mov_b32 s11, 0x00020000
    s_cmp_gt_u32 s16, 3
    s_cbranch_scc1 e_side
    buffer_load_dwordx4 v[40:43], v34, s[8:11], s46 offen
    s_add_u32 s46, s46, 16384
    buffer_load_dwordx4 v[44:47], v34, s[8:11], s46 offen
    s_add_u32 s46, s46, 16384
    buffer_load_dwordx4 v[48:51], v34, s[8:11], s46 offen
    s_add_u32 s46, s46, 16384
    buffer_load_dwordx4 v[52:55], v34, s[8:11], s46 offen
e_side:
    s_load_dword s80, s[76:77], s3 offset:0
    s_load_dword s81, s[76:77], s3 offset:16384
    s_load_dword s82, s[76:77], s3 offset:32768
    s_load_dword s83, s[76:77], s78
    s_mov_b32 s4, s44
    s_mov_b32 s5, s45
    s_mov_b32 s6, 67108864
    s_mov_b32 s7, 0x00020000
    s_add_u32 s22, s44, 58720256
    s_addc_u32 s23, s45, 0
    s_load_dword s100, s[22:23], 217088
    s_cmp_gt_u32 s16, 3
    s_cbranch_scc1 s_start
    v_lshrrev_b32 v8, 4, v1
    s_lshl_b32 s44, s38, 16
    v_xor_b32 v88, v33, v32
    v_lshlrev_b32 v88, 4, v88
    v_lshl_add_u32 v88, v32, 11, v88
    v_xor_b32 v89, 16, v88
    v_add_u32 v89, 15360, v89
    v_add_u32 v90, 30720, v88
    v_add_u32 v91, 30720, v89
    s_mul_i32 s76, s16, 16384
    s_add_u32 s76, s76, 61440
    s_lshl_b32 s77, s38, 16
    s_mul_i32 s84, s18, 4096
    s_cmp_lt_u32 s18, 4
    s_cselect_b32 s85, 4, 0
    s_mul_i32 s85, s85, 4096
    s_cmp_lt_u32 s18, 4
    s_cselect_b32 s86, 5, 1
    s_mul_i32 s86, s86, 4096
    s_cmp_lt_u32 s18, 4
    s_cselect_b32 s87, 6, 2
    s_mul_i32 s87, s87, 4096
    s_cmp_lt_u32 s18, 4
    s_cselect_b32 s88, 7, 3
    s_mul_i32 s88, s88, 4096
    s_cmp_lt_u32 s18, 8
    s_cselect_b32 s89, 8, 4
    s_mul_i32 s89, s89, 4096
    s_cmp_lt_u32 s18, 8
    s_cselect_b32 s90, 9, 5
    s_mul_i32 s90, s90, 4096
    s_cmp_lt_u32 s18, 8
    s_cselect_b32 s91, 10, 6
    s_mul_i32 s91, s91, 4096
    s_cmp_lt_u32 s18, 8
    s_cselect_b32 s92, 11, 7
    s_mul_i32 s92, s92, 4096
    s_cmp_lt_u32 s18, 12
    s_cselect_b32 s93, 12, 8
    s_mul_i32 s93, s93, 4096
    s_cmp_lt_u32 s18, 12
    s_cselect_b32 s94, 13, 9
    s_mul_i32 s94, s94, 4096
    s_cmp_lt_u32 s18, 12
    s_cselect_b32 s95, 14, 10
    s_mul_i32 s95, s95, 4096
    s_cmp_lt_u32 s18, 12
    s_cselect_b32 s96, 15, 11
    s_mul_i32 s96, s96, 4096
    s_xor_b32 s97, s18, 1
    s_mul_i32 s97, s97, 4096
    s_xor_b32 s98, s18, 2
    s_mul_i32 s98, s98, 4096
    s_xor_b32 s99, s18, 3
    s_mul_i32 s99, s99, 4096
    s_lshr_b32 s3, s18, 2
    s_lshl_b32 s3, s3, 3
    s_lshl_b32 s63, 1, s3
    s_lshl_b32 s3, s63, 2
    s_andn2_b32 s19, 67372036, s3
    v_lshrrev_b32 v12, 4, v1
    v_and_b32 v13, 15, v12
    v_bfe_u32 v14, v12, 4, 1
    v_lshrrev_b32 v12, 5, v12
    v_lshl_add_u32 v2, v14, 5, v13
    v_lshlrev_b32 v2, 4, v2
    v_lshl_add_u32 v2, v12, 10, v2
    v_lshrrev_b32 v15, 2, v13
    v_lshl_add_u32 v15, v14, 2, v15
    v_lshlrev_b32 v3, 7, v15
    v_lshl_add_u32 v3, v12, 11, v3
    v_and_b32 v15, 3, v13
    v_lshl_add_u32 v3, v15, 3, v3
    v_lshrrev_b32 v15, 3, v13
    v_lshl_add_u32 v15, v15, 1, v14
    v_lshl_add_u32 v3, v15, 5, v3
    v_xor_b32 v4, 32, v3
    v_xor_b32 v5, 64, v3
    v_xor_b32 v6, 96, v3
    s_lshl_b32 s45, s16, 12
    s_add_u32 s45, s45, 131072
    v_lshrrev_b32 v35, 1, v33
    v_lshlrev_b32 v35, 10, v35
    v_lshl_add_u32 v35, v32, 4, v35
    v_and_b32 v36, 1, v33
    v_lshl_add_u32 v35, v36, 3, v35
    v_add_u32 v35, s45, v35
    v_add_u32 v36, s45, v1
    v_mov_b32 v37, 0x3f803f80
    v_and_b32 v38, 3, v8
    v_lshl_add_u32 v39, v38, 3, v32
    v_lshlrev_b32 v39, 3, v39
    v_mov_b32 v56, 0
    v_mov_b32 v57, 0
    v_mov_b32 v58, 0
    v_mov_b32 v59, 0
    v_mov_b32 v60, 0
    v_mov_b32 v61, 0
    v_mov_b32 v62, 0
    v_mov_b32 v63, 0
    s_waitcnt vmcnt(3)
    ds_write_b64 v35, v[40:41] offset:0
    ds_write_b64 v35, v[42:43] offset:512
    s_waitcnt vmcnt(2)
    ds_write_b64 v35, v[44:45] offset:128
    ds_write_b64 v35, v[46:47] offset:640
    s_waitcnt vmcnt(1)
    ds_write_b64 v35, v[48:49] offset:256
    ds_write_b64 v35, v[50:51] offset:768
    s_waitcnt vmcnt(0)
    ds_write_b64 v35, v[52:53] offset:384
    ds_write_b64 v35, v[54:55] offset:896
    ds_read_b128 v[64:67], v36 offset:0
    ds_read_b128 v[68:71], v36 offset:1024
    ds_read_b128 v[72:75], v36 offset:2048
    ds_read_b128 v[76:79], v36 offset:3072
    s_lshl_b32 s45, s18, 12
    s_add_u32 s46, s44, s45
    s_waitcnt lgkmcnt(3)
    buffer_store_dwordx4 v[64:67], v1, s[4:7], s46 offen offset:0 sc1
    s_waitcnt lgkmcnt(2)
    buffer_store_dwordx4 v[68:71], v1, s[4:7], s46 offen offset:1024 sc1
    s_waitcnt lgkmcnt(1)
    buffer_store_dwordx4 v[72:75], v1, s[4:7], s46 offen offset:2048 sc1
    s_waitcnt lgkmcnt(0)
    buffer_store_dwordx4 v[76:79], v1, s[4:7], s46 offen offset:3072 sc1
    s_add_u32 m0, s76, 4096
    s_lshr_b32 s78, s85, 5
    s_add_u32 s78, s78, s77
    buffer_load_dwordx4 v88, s[8:11], s78 offen offset:0 lds
    buffer_load_dwordx4 v89, s[8:11], s78 offen offset:1024 lds
    buffer_load_dwordx4 v90, s[8:11], s78 offen offset:2048 lds
    buffer_load_dwordx4 v91, s[8:11], s78 offen offset:3072 lds
    s_add_u32 m0, s76, 8192
    s_lshr_b32 s78, s86, 5
    s_add_u32 s78, s78, s77
    buffer_load_dwordx4 v88, s[8:11], s78 offen offset:0 lds
    buffer_load_dwordx4 v89, s[8:11], s78 offen offset:1024 lds
    buffer_load_dwordx4 v90, s[8:11], s78 offen offset:2048 lds
    buffer_load_dwordx4 v91, s[8:11], s78 offen offset:3072 lds
    s_add_u32 m0, s76, 12288
    s_lshr_b32 s78, s87, 5
    s_add_u32 s78, s78, s77
    buffer_load_dwordx4 v88, s[8:11], s78 offen offset:0 lds
    buffer_load_dwordx4 v89, s[8:11], s78 offen offset:1024 lds
    buffer_load_dwordx4 v90, s[8:11], s78 offen offset:2048 lds
    buffer_load_dwordx4 v91, s[8:11], s78 offen offset:3072 lds
    s_add_u32 m0, s76, 16384
    s_lshr_b32 s78, s88, 5
    s_add_u32 s78, s78, s77
    buffer_load_dwordx4 v88, s[8:11], s78 offen offset:0 lds
    buffer_load_dwordx4 v89, s[8:11], s78 offen offset:1024 lds
    buffer_load_dwordx4 v90, s[8:11], s78 offen offset:2048 lds
    buffer_load_dwordx4 v91, s[8:11], s78 offen offset:3072 lds
    v_dot2_f32_bf16 v56, v40, v37, v56
    v_dot2_f32_bf16 v57, v40, v40, v57
    v_dot2_f32_bf16 v58, v44, v37, v58
    v_dot2_f32_bf16 v59, v44, v44, v59
    v_dot2_f32_bf16 v60, v48, v37, v60
    v_dot2_f32_bf16 v61, v48, v48, v61
    v_dot2_f32_bf16 v62, v52, v37, v62
    v_dot2_f32_bf16 v63, v52, v52, v63
    v_dot2_f32_bf16 v56, v41, v37, v56
    v_dot2_f32_bf16 v57, v41, v41, v57
    v_dot2_f32_bf16 v58, v45, v37, v58
    v_dot2_f32_bf16 v59, v45, v45, v59
    v_dot2_f32_bf16 v60, v49, v37, v60
    v_dot2_f32_bf16 v61, v49, v49, v61
    v_dot2_f32_bf16 v62, v53, v37, v62
    v_dot2_f32_bf16 v63, v53, v53, v63
    v_dot2_f32_bf16 v56, v42, v37, v56
    v_dot2_f32_bf16 v57, v42, v42, v57
    v_dot2_f32_bf16 v58, v46, v37, v58
    v_dot2_f32_bf16 v59, v46, v46, v59
    v_dot2_f32_bf16 v60, v50, v37, v60
    v_dot2_f32_bf16 v61, v50, v50, v61
    v_dot2_f32_bf16 v62, v54, v37, v62
    v_dot2_f32_bf16 v63, v54, v54, v63
    v_dot2_f32_bf16 v56, v43, v37, v56
    v_dot2_f32_bf16 v57, v43, v43, v57
    v_dot2_f32_bf16 v58, v47, v37, v58
    v_dot2_f32_bf16 v59, v47, v47, v59
    v_dot2_f32_bf16 v60, v51, v37, v60
    v_dot2_f32_bf16 v61, v51, v51, v61
    v_dot2_f32_bf16 v62, v55, v37, v62
    v_dot2_f32_bf16 v63, v55, v55, v63
    s_nop 2
    v_add_f32_dpp v56, v56, v56 quad_perm:[1,0,3,2] row_mask:0xf bank_mask:0xf
    v_add_f32_dpp v57, v57, v57 quad_perm:[1,0,3,2] row_mask:0xf bank_mask:0xf
    v_add_f32_dpp v58, v58, v58 quad_perm:[1,0,3,2] row_mask:0xf bank_mask:0xf
    v_add_f32_dpp v59, v59, v59 quad_perm:[1,0,3,2] row_mask:0xf bank_mask:0xf
    v_add_f32_dpp v60, v60, v60 quad_perm:[1,0,3,2] row_mask:0xf bank_mask:0xf
    v_add_f32_dpp v61, v61, v61 quad_perm:[1,0,3,2] row_mask:0xf bank_mask:0xf
    v_add_f32_dpp v62, v62, v62 quad_perm:[1,0,3,2] row_mask:0xf bank_mask:0xf
    v_add_f32_dpp v63, v63, v63 quad_perm:[1,0,3,2] row_mask:0xf bank_mask:0xf
    v_add_f32_dpp v56, v56, v56 quad_perm:[2,3,0,1] row_mask:0xf bank_mask:0xf
    v_add_f32_dpp v57, v57, v57 quad_perm:[2,3,0,1] row_mask:0xf bank_mask:0xf
    v_add_f32_dpp v58, v58, v58 quad_perm:[2,3,0,1] row_mask:0xf bank_mask:0xf
    v_add_f32_dpp v59, v59, v59 quad_perm:[2,3,0,1] row_mask:0xf bank_mask:0xf
    v_add_f32_dpp v60, v60, v60 quad_perm:[2,3,0,1] row_mask:0xf bank_mask:0xf
    v_add_f32_dpp v61, v61, v61 quad_perm:[2,3,0,1] row_mask:0xf bank_mask:0xf
    v_add_f32_dpp v62, v62, v62 quad_perm:[2,3,0,1] row_mask:0xf bank_mask:0xf
    v_add_f32_dpp v63, v63, v63 quad_perm:[2,3,0,1] row_mask:0xf bank_mask:0xf
    v_add_f32_dpp v56, v56, v56 row_half_mirror row_mask:0xf bank_mask:0xf
    v_add_f32_dpp v57, v57, v57 row_half_mirror row_mask:0xf bank_mask:0xf
    v_add_f32_dpp v58, v58, v58 row_half_mirror row_mask:0xf bank_mask:0xf
    v_add_f32_dpp v59, v59, v59 row_half_mirror row_mask:0xf bank_mask:0xf
    v_add_f32_dpp v60, v60, v60 row_half_mirror row_mask:0xf bank_mask:0xf
    v_add_f32_dpp v61, v61, v61 row_half_mirror row_mask:0xf bank_mask:0xf
    v_add_f32_dpp v62, v62, v62 row_half_mirror row_mask:0xf bank_mask:0xf
    v_add_f32_dpp v63, v63, v63 row_half_mirror row_mask:0xf bank_mask:0xf
    v_cmp_eq_u32 vcc, 1, v38
    s_nop 1
    v_cndmask_b32 v56, v56, v58, vcc
    v_cndmask_b32 v57, v57, v59, vcc
    v_cmp_eq_u32 vcc, 2, v38
    s_nop 1
    v_cndmask_b32 v56, v56, v60, vcc
    v_cndmask_b32 v57, v57, v61, vcc
    v_cmp_eq_u32 vcc, 3, v38
    s_nop 1
    v_cndmask_b32 v56, v56, v62, vcc
    v_cndmask_b32 v57, v57, v63, vcc
    s_lshl_b32 s44, s21, 18
    s_lshl_b32 s45, s38, 12
    s_add_u32 s44, s44, s45
    s_lshl_b32 s45, s18, 8
    s_add_u32 s44, s44, s45
    s_add_u32 s44, s44, 50331648
    buffer_store_dwordx2 v[56:57], v39, s[4:7], s44 offen sc1
    s_lshl_b32 s46, s21, 14
    s_lshl_b32 s67, s38, 7
    s_add_u32 s46, s46, s67
    s_add_u32 s46, s46, 4096
    s_add_u32 s47, s46, 8192
    s_lshl_b32 s48, s21, 22
    s_lshl_b32 s49, s38, 16
    s_add_u32 s41, s48, s49
    v_lshrrev_b32 v16, 4, v1
    v_and_b32 v17, 15, v16
    v_lshrrev_b32 v16, 4, v16
    s_lshl_b32 s49, s16, 7
    s_add_u32 s50, s49, 151552
    s_and_b32 s49, s21, 1
    s_lshl_b32 s49, s49, 10
    s_add_u32 s49, s49, 151552
    v_lshlrev_b32 v11, 4, v16
    v_add_u32 v13, s50, v11
    v_add_u32 v11, s49, v11
    v_lshlrev_b32 v15, 2, v17
    v_add_u32 v9, s50, v15
    v_add_u32 v15, s49, v15
    s_lshr_b32 s49, s21, 1
    s_lshl_b32 s53, s49, 23
    s_lshl_b32 s50, s18, 18
    s_add_u32 s53, s53, s50
    s_add_u32 s53, s53, 33554432
    s_lshl_b32 s54, s38, 11
    s_add_u32 s52, s53, s54
    s_lshl_b32 s59, s49, 13
    s_lshl_b32 s67, s18, 9
    s_add_u32 s59, s59, s67
    s_lshl_b32 s67, s16, 7
    s_add_u32 s59, s59, s67
    s_add_u32 s59, s59, 69632
    s_lshl_b32 s61, s49, 15
    s_lshl_b32 s67, s17, 11
    s_add_u32 s61, s61, s67
    s_lshl_b32 s67, s18, 7
    s_add_u32 s61, s61, s67
    s_add_u32 s61, s61, 151552
    s_sub_u32 s60, s61, 151552
    s_lshl_b32 s60, s60, 5
    s_add_u32 s60, s60, 54525952
    s_lshl_b32 s62, s16, 12
    s_add_u32 s62, s62, 131072
    v_bfe_u32 v80, v8, 3, 1
    v_and_b32 v81, 7, v8
    v_lshrrev_b32 v82, 5, v8
    v_lshlrev_b32 v82, 1, v82
    v_xor_b32 v82, v82, v81
    v_xor_b32 v82, v82, v80
    v_lshlrev_b32 v82, 4, v82
    v_lshl_add_u32 v82, v81, 7, v82
    v_lshl_add_u32 v82, v80, 10, v82
    v_bfe_u32 v80, v8, 4, 1
    v_lshl_add_u32 v82, v80, 3, v82
    v_add_u32 v20, s76, v82
    v_xor_b32 v21, 16, v20
    v_xor_b32 v22, 64, v20
    v_xor_b32 v23, 80, v20
    v_add_u32 v80, s62, v2
    ds_read_b128 v[160:163], v80 offset:0
    ds_read_b128 v[164:167], v80 offset:256
    ds_read_b128 v[168:171], v80 offset:2048
    ds_read_b128 v[172:175], v80 offset:2304
    s_mov_b64 vcc, -1
    s_mov_b32 s48, 1
    s_or_b32 s20, s19, 0x80000000
    s_barrier
    ds_read_b64_tr_b16 v[32:33], v3 offset:0
    ds_read_b64_tr_b16 v[34:35], v3 offset:1024
    ds_read_b64_tr_b16 v[36:37], v4 offset:0
    ds_read_b64_tr_b16 v[38:39], v4 offset:1024
    ds_read_b64_tr_b16 v[40:41], v5 offset:0
    ds_read_b64_tr_b16 v[42:43], v5 offset:1024
    ds_read_b64_tr_b16 v[44:45], v6 offset:0
    ds_read_b64_tr_b16 v[46:47], v6 offset:1024
    ds_read_b64_tr_b16 v[48:49], v3 offset:4096
    ds_read_b64_tr_b16 v[50:51], v3 offset:5120
    ds_read_b64_tr_b16 v[52:53], v4 offset:4096
    ds_read_b64_tr_b16 v[54:55], v4 offset:5120
    ds_read_b64_tr_b16 v[56:57], v5 offset:4096
    ds_read_b64_tr_b16 v[58:59], v5 offset:5120
    s_branch c_g0
c_st1:
    s_waitcnt vmcnt(1)
    ds_read_b64 v[176:177], v20 offset:4096
    ds_read_b64 v[178:179], v21 offset:4096
    ds_read_b64 v[180:181], v20 offset:6144
    ds_read_b64 v[182:183], v21 offset:6144
    ds_read_b64 v[184:185], v22 offset:4096
    ds_read_b64 v[186:187], v23 offset:4096
    ds_read_b64 v[188:189], v22 offset:6144
    ds_read_b64 v[190:191], v23 offset:6144
    ds_read_b64 v[192:193], v20 offset:8192
    ds_read_b64 v[194:195], v21 offset:8192
    ds_read_b64 v[196:197], v20 offset:10240
    ds_read_b64 v[198:199], v21 offset:10240
    ds_read_b64 v[200:201], v22 offset:8192
    ds_read_b64 v[202:203], v23 offset:8192
    ds_read_b64 v[204:205], v22 offset:10240
    ds_read_b64 v[206:207], v23 offset:10240
    ds_read_b64 v[208:209], v20 offset:12288
    ds_read_b64 v[210:211], v21 offset:12288
    ds_read_b64 v[212:213], v20 offset:14336
    ds_read_b64 v[214:215], v21 offset:14336
    ds_read_b64 v[216:217], v22 offset:12288
    ds_read_b64 v[218:219], v23 offset:12288
    ds_read_b64 v[220:221], v22 offset:14336
    ds_read_b64 v[222:223], v23 offset:14336
    ds_read_b64 v[224:225], v20 offset:16384
    ds_read_b64 v[226:227], v21 offset:16384
    ds_read_b64 v[228:229], v20 offset:18432
    ds_read_b64 v[230:231], v21 offset:18432
    ds_read_b64 v[232:233], v22 offset:16384
    ds_read_b64 v[234:235], v23 offset:16384
    ds_read_b64 v[236:237], v22 offset:18432
    ds_read_b64 v[238:239], v23 offset:18432
    s_load_dword s68, s[34:35], 0
    s_mov_b32 s8, s34
    s_mov_b32 s9, s35
    s_mov_b32 s10, 256
    s_mov_b32 s11, 0x00020000
    s_mov_b32 s66, 0x10000
    v_mov_b32 v16, 0
    s_waitcnt lgkmcnt(0)
c_f0:
    s_cmp_eq_u32 s68, 10
    s_cbranch_scc1 c_f0_ok
    buffer_load_dword v17, v16, s[8:11], 0 offen offset:0 sc1
    s_waitcnt vmcnt(0)
    v_readfirstlane_b32 s68, v17
    s_sub_u32 s66, s66, 1
    s_cmp_lg_u32 s66, 0
    s_cbranch_scc1 c_f0
c_f0_ok:
    s_atomic_add s63, s[22:23], s46
    s_branch c_st2
c_cs1:
    s_waitcnt vmcnt(0)
    s_atomic_add s40, s[22:23], s47
    s_branch c_cs2
c_layer:
    s_mov_b64 vcc, 0
c_early2:
    s_barrier
    ds_read_b64_tr_b16 v[32:33], v3 offset:0
    ds_read_b64_tr_b16 v[34:35], v3 offset:1024
    ds_read_b64_tr_b16 v[36:37], v4 offset:0
    ds_read_b64_tr_b16 v[38:39], v4 offset:1024
    ds_read_b64_tr_b16 v[40:41], v5 offset:0
    ds_read_b64_tr_b16 v[42:43], v5 offset:1024
    ds_read_b64_tr_b16 v[44:45], v6 offset:0
    ds_read_b64_tr_b16 v[46:47], v6 offset:1024
    ds_read_b64_tr_b16 v[48:49], v3 offset:4096
    ds_read_b64_tr_b16 v[50:51], v3 offset:5120
    ds_read_b64_tr_b16 v[52:53], v4 offset:4096
    ds_read_b64_tr_b16 v[54:55], v4 offset:5120
    ds_read_b64_tr_b16 v[56:57], v5 offset:4096
    ds_read_b64_tr_b16 v[58:59], v5 offset:5120
c_g0:
    s_waitcnt lgkmcnt(10)
    v_mfma_f32_16x16x32_bf16 v[64:67], v[32:35], v[160:163], 0
    ds_read_b64_tr_b16 v[60:61], v6 offset:4096
    v_mfma_f32_16x16x32_bf16 v[68:71], v[32:35], v[164:167], 0
    ds_read_b64_tr_b16 v[62:63], v6 offset:5120
    v_mfma_f32_16x16x32_bf16 v[72:75], v[36:39], v[160:163], 0
    ds_read_b64_tr_b16 v[32:33], v3 offset:8192
    v_mfma_f32_16x16x32_bf16 v[76:79], v[36:39], v[164:167], 0
    ds_read_b64_tr_b16 v[34:35], v3 offset:9216
    s_waitcnt lgkmcnt(10)
    v_mfma_f32_16x16x32_bf16 v[80:83], v[40:43], v[160:163], 0
    ds_read_b64_tr_b16 v[36:37], v4 offset:8192
    v_mfma_f32_16x16x32_bf16 v[84:87], v[40:43], v[164:167], 0
    ds_read_b64_tr_b16 v[38:39], v4 offset:9216
    v_mfma_f32_16x16x32_bf16 v[88:91], v[44:47], v[160:163], 0
    ds_read_b64_tr_b16 v[40:41], v5 offset:8192
    v_mfma_f32_16x16x32_bf16 v[92:95], v[44:47], v[164:167], 0
    ds_read_b64_tr_b16 v[42:43], v5 offset:9216
    s_waitcnt lgkmcnt(10)
    v_mfma_f32_16x16x32_bf16 v[96:99], v[160:163], v[48:51], 0
    ds_read_b64_tr_b16 v[44:45], v6 offset:8192
    v_mfma_f32_16x16x32_bf16 v[100:103], v[164:167], v[48:51], 0
    ds_read_b64_tr_b16 v[46:47], v6 offset:9216
    v_mfma_f32_16x16x32_bf16 v[104:107], v[160:163], v[52:55], 0
    ds_read_b64_tr_b16 v[48:49], v3 offset:12288
    v_mfma_f32_16x16x32_bf16 v[108:111], v[164:167], v[52:55], 0
    ds_read_b64_tr_b16 v[50:51], v3 offset:13312
    s_waitcnt lgkmcnt(10)
    v_mfma_f32_16x16x32_bf16 v[112:115], v[160:163], v[56:59], 0
    ds_read_b64_tr_b16 v[52:53], v4 offset:12288
    v_mfma_f32_16x16x32_bf16 v[116:119], v[164:167], v[56:59], 0
    ds_read_b64_tr_b16 v[54:55], v4 offset:13312
    v_mfma_f32_16x16x32_bf16 v[120:123], v[160:163], v[60:63], 0
    ds_read_b64_tr_b16 v[56:57], v5 offset:12288
    v_mfma_f32_16x16x32_bf16 v[124:127], v[164:167], v[60:63], 0
    ds_read_b64_tr_b16 v[58:59], v5 offset:13312
    s_cmp_lg_u32 s48, 0
    s_cbranch_scc1 c_gate
    s_mov_b32 s66, 0x10000
    s_waitcnt lgkmcnt(0)
    s_and_b32 s68, s68, s19
    s_cmp_eq_u32 s68, s19
    s_cbranch_scc1 c_x_ok
c_x_poll:
    s_mov_b32 s68, 0
    s_atomic_add s68, s[22:23], s46 offset:0 glc
    s_sub_u32 s66, s66, 1
    s_cselect_b32 s67, s19, 0
    s_waitcnt lgkmcnt(0)
    s_and_b32 s68, s68, s19
    s_max_u32 s68, s68, s67
    s_cmp_lt_u32 s68, s19
    s_cbranch_scc1 c_x_poll
c_x_ok:
    s_add_u32 s42, s41, s85
    buffer_load_dwordx4 v[176:179], v2, s[4:7], s42 offen offset:0 sc1
    buffer_load_dwordx4 v[180:183], v2, s[4:7], s42 offen offset:256 sc1
    buffer_load_dwordx4 v[184:187], v2, s[4:7], s42 offen offset:2048 sc1
    buffer_load_dwordx4 v[188:191], v2, s[4:7], s42 offen offset:2304 sc1
    s_add_u32 s42, s41, s86
    buffer_load_dwordx4 v[192:195], v2, s[4:7], s42 offen offset:0 sc1
    buffer_load_dwordx4 v[196:199], v2, s[4:7], s42 offen offset:256 sc1
    buffer_load_dwordx4 v[200:203], v2, s[4:7], s42 offen offset:2048 sc1
    buffer_load_dwordx4 v[204:207], v2, s[4:7], s42 offen offset:2304 sc1
    s_add_u32 s42, s41, s87
    buffer_load_dwordx4 v[208:211], v2, s[4:7], s42 offen offset:0 sc1
    buffer_load_dwordx4 v[212:215], v2, s[4:7], s42 offen offset:256 sc1
    s_waitcnt vmcnt(10)
    s_atomic_add s40, s[22:23], s47
c_gate:
    s_waitcnt lgkmcnt(10)
    v_mfma_f32_16x16x32_bf16 v[128:131], v[32:35], v[160:163], 0
    ds_read_b64_tr_b16 v[60:61], v6 offset:12288
    v_mfma_f32_16x16x32_bf16 v[132:135], v[32:35], v[164:167], 0
    ds_read_b64_tr_b16 v[62:63], v6 offset:13312
    v_mfma_f32_16x16x32_bf16 v[136:139], v[36:39], v[160:163], 0
    ds_read_b64_tr_b16 v[32:33], v3 offset:16384
    v_mfma_f32_16x16x32_bf16 v[140:143], v[36:39], v[164:167], 0
    ds_read_b64_tr_b16 v[34:35], v3 offset:17408
    s_waitcnt lgkmcnt(10)
    v_mfma_f32_16x16x32_bf16 v[144:147], v[40:43], v[160:163], 0
    ds_read_b64_tr_b16 v[36:37], v4 offset:16384
    v_mfma_f32_16x16x32_bf16 v[148:151], v[40:43], v[164:167], 0
    ds_read_b64_tr_b16 v[38:39], v4 offset:17408
    v_mfma_f32_16x16x32_bf16 v[152:155], v[44:47], v[160:163], 0
    ds_read_b64_tr_b16 v[40:41], v5 offset:16384
    v_mfma_f32_16x16x32_bf16 v[156:159], v[44:47], v[164:167], 0
    ds_read_b64_tr_b16 v[42:43], v5 offset:17408
    s_waitcnt lgkmcnt(10)
    v_mfma_f32_16x16x32_bf16 v[64:67], v[48:51], v[168:171], v[64:67]
    ds_read_b64_tr_b16 v[44:45], v6 offset:16384
    v_mfma_f32_16x16x32_bf16 v[68:71], v[48:51], v[172:175], v[68:71]
    ds_read_b64_tr_b16 v[46:47], v6 offset:17408
    v_mfma_f32_16x16x32_bf16 v[72:75], v[52:55], v[168:171], v[72:75]
    ds_read_b64_tr_b16 v[48:49], v3 offset:20480
    v_mfma_f32_16x16x32_bf16 v[76:79], v[52:55], v[172:175], v[76:79]
    ds_read_b64_tr_b16 v[50:51], v3 offset:21504
    s_waitcnt lgkmcnt(10)
    v_mfma_f32_16x16x32_bf16 v[80:83], v[56:59], v[168:171], v[80:83]
    ds_read_b64_tr_b16 v[52:53], v4 offset:20480
    v_mfma_f32_16x16x32_bf16 v[84:87], v[56:59], v[172:175], v[84:87]
    ds_read_b64_tr_b16 v[54:55], v4 offset:21504
    v_mfma_f32_16x16x32_bf16 v[88:91], v[60:63], v[168:171], v[88:91]
    ds_read_b64_tr_b16 v[56:57], v5 offset:20480
    v_mfma_f32_16x16x32_bf16 v[92:95], v[60:63], v[172:175], v[92:95]
    ds_read_b64_tr_b16 v[58:59], v5 offset:21504
    s_waitcnt lgkmcnt(10)
    v_mfma_f32_16x16x32_bf16 v[96:99], v[168:171], v[32:35], v[96:99]
    ds_read_b64_tr_b16 v[60:61], v6 offset:20480
    v_mfma_f32_16x16x32_bf16 v[100:103], v[172:175], v[32:35], v[100:103]
    ds_read_b64_tr_b16 v[62:63], v6 offset:21504
    v_mfma_f32_16x16x32_bf16 v[104:107], v[168:171], v[36:39], v[104:107]
    ds_read_b64_tr_b16 v[32:33], v3 offset:24576
    v_mfma_f32_16x16x32_bf16 v[108:111], v[172:175], v[36:39], v[108:111]
    ds_read_b64_tr_b16 v[34:35], v3 offset:25600
    s_waitcnt lgkmcnt(10)
    v_mfma_f32_16x16x32_bf16 v[112:115], v[168:171], v[40:43], v[112:115]
    ds_read_b64_tr_b16 v[36:37], v4 offset:24576
    v_mfma_f32_16x16x32_bf16 v[116:119], v[172:175], v[40:43], v[116:119]
    ds_read_b64_tr_b16 v[38:39], v4 offset:25600
    v_mfma_f32_16x16x32_bf16 v[120:123], v[168:171], v[44:47], v[120:123]
    ds_read_b64_tr_b16 v[40:41], v5 offset:24576
    v_mfma_f32_16x16x32_bf16 v[124:127], v[172:175], v[44:47], v[124:127]
    ds_read_b64_tr_b16 v[42:43], v5 offset:25600
    s_waitcnt lgkmcnt(10)
    v_mfma_f32_16x16x32_bf16 v[128:131], v[48:51], v[168:171], v[128:131]
    ds_read_b64_tr_b16 v[44:45], v6 offset:24576
    v_mfma_f32_16x16x32_bf16 v[132:135], v[48:51], v[172:175], v[132:135]
    ds_read_b64_tr_b16 v[46:47], v6 offset:25600
    v_mfma_f32_16x16x32_bf16 v[136:139], v[52:55], v[168:171], v[136:139]
    ds_read_b64_tr_b16 v[48:49], v3 offset:28672
    v_mfma_f32_16x16x32_bf16 v[140:143], v[52:55], v[172:175], v[140:143]
    ds_read_b64_tr_b16 v[50:51], v3 offset:29696
    s_waitcnt lgkmcnt(10)
    v_mfma_f32_16x16x32_bf16 v[144:147], v[56:59], v[168:171], v[144:147]
    ds_read_b64_tr_b16 v[52:53], v4 offset:28672
    v_mfma_f32_16x16x32_bf16 v[148:151], v[56:59], v[172:175], v[148:151]
    ds_read_b64_tr_b16 v[54:55], v4 offset:29696
    v_mfma_f32_16x16x32_bf16 v[152:155], v[60:63], v[168:171], v[152:155]
    ds_read_b64_tr_b16 v[56:57], v5 offset:28672
    v_mfma_f32_16x16x32_bf16 v[156:159], v[60:63], v[172:175], v[156:159]
    ds_read_b64_tr_b16 v[58:59], v5 offset:29696
    s_cbranch_vccnz c_st1
c_st2:
    s_waitcnt vmcnt(8) lgkmcnt(10)
    v_mfma_f32_16x16x32_bf16 v[64:67], v[32:35], v[176:179], v[64:67]
    ds_read_b64_tr_b16 v[60:61], v6 offset:28672
    v_mfma_f32_16x16x32_bf16 v[68:71], v[32:35], v[180:183], v[68:71]
    ds_read_b64_tr_b16 v[62:63], v6 offset:29696
    s_barrier
    v_mfma_f32_16x16x32_bf16 v[72:75], v[36:39], v[176:179], v[72:75]
    ds_read_b64_tr_b16 v[32:33], v3 offset:32768
    v_mfma_f32_16x16x32_bf16 v[76:79], v[36:39], v[180:183], v[76:79]
    ds_read_b64_tr_b16 v[34:35], v3 offset:33792
    s_waitcnt lgkmcnt(10)
    v_mfma_f32_16x16x32_bf16 v[80:83], v[40:43], v[176:179], v[80:83]
    ds_read_b64_tr_b16 v[36:37], v4 offset:32768
    v_mfma_f32_16x16x32_bf16 v[84:87], v[40:43], v[180:183], v[84:87]
    ds_read_b64_tr_b16 v[38:39], v4 offset:33792
    v_mfma_f32_16x16x32_bf16 v[88:91], v[44:47], v[176:179], v[88:91]
    ds_read_b64_tr_b16 v[40:41], v5 offset:32768
    v_mfma_f32_16x16x32_bf16 v[92:95], v[44:47], v[180:183], v[92:95]
    ds_read_b64_tr_b16 v[42:43], v5 offset:33792
    s_waitcnt lgkmcnt(10)
    v_mfma_f32_16x16x32_bf16 v[96:99], v[176:179], v[48:51], v[96:99]
    ds_read_b64_tr_b16 v[44:45], v6 offset:32768
    v_mfma_f32_16x16x32_bf16 v[100:103], v[180:183], v[48:51], v[100:103]
    ds_read_b64_tr_b16 v[46:47], v6 offset:33792
    v_mfma_f32_16x16x32_bf16 v[104:107], v[176:179], v[52:55], v[104:107]
    ds_read_b64_tr_b16 v[48:49], v3 offset:36864
    v_mfma_f32_16x16x32_bf16 v[108:111], v[180:183], v[52:55], v[108:111]
    ds_read_b64_tr_b16 v[50:51], v3 offset:37888
    s_waitcnt lgkmcnt(10)
    v_mfma_f32_16x16x32_bf16 v[112:115], v[176:179], v[56:59], v[112:115]
    ds_read_b64_tr_b16 v[52:53], v4 offset:36864
    v_mfma_f32_16x16x32_bf16 v[116:119], v[180:183], v[56:59], v[116:119]
    ds_read_b64_tr_b16 v[54:55], v4 offset:37888
    v_mfma_f32_16x16x32_bf16 v[120:123], v[176:179], v[60:63], v[120:123]
    ds_read_b64_tr_b16 v[56:57], v5 offset:36864
    v_mfma_f32_16x16x32_bf16 v[124:127], v[180:183], v[60:63], v[124:127]
    ds_read_b64_tr_b16 v[58:59], v5 offset:37888
    s_waitcnt lgkmcnt(10)
    v_mfma_f32_16x16x32_bf16 v[128:131], v[32:35], v[176:179], v[128:131]
    ds_read_b64_tr_b16 v[60:61], v6 offset:36864
    v_mfma_f32_16x16x32_bf16 v[132:135], v[32:35], v[180:183], v[132:135]
    ds_read_b64_tr_b16 v[62:63], v6 offset:37888
    v_mfma_f32_16x16x32_bf16 v[136:139], v[36:39], v[176:179], v[136:139]
    ds_read_b64_tr_b16 v[32:33], v3 offset:40960
    v_mfma_f32_16x16x32_bf16 v[140:143], v[36:39], v[180:183], v[140:143]
    ds_read_b64_tr_b16 v[34:35], v3 offset:41984
    s_waitcnt lgkmcnt(10)
    v_mfma_f32_16x16x32_bf16 v[144:147], v[40:43], v[176:179], v[144:147]
    ds_read_b64_tr_b16 v[36:37], v4 offset:40960
    v_mfma_f32_16x16x32_bf16 v[148:151], v[40:43], v[180:183], v[148:151]
    ds_read_b64_tr_b16 v[38:39], v4 offset:41984
    v_mfma_f32_16x16x32_bf16 v[152:155], v[44:47], v[176:179], v[152:155]
    ds_read_b64_tr_b16 v[40:41], v5 offset:40960
    v_mfma_f32_16x16x32_bf16 v[156:159], v[44:47], v[180:183], v[156:159]
    ds_read_b64_tr_b16 v[42:43], v5 offset:41984
    s_waitcnt vmcnt(6) lgkmcnt(10)
    v_mfma_f32_16x16x32_bf16 v[64:67], v[48:51], v[184:187], v[64:67]
    s_add_u32 s42, s41, s87
    s_cbranch_vccnz xs1
    buffer_load_dwordx4 v[216:219], v2, s[4:7], s42 offen offset:2048 sc1
xs1:
    ds_read_b64_tr_b16 v[44:45], v6 offset:40960
    v_mfma_f32_16x16x32_bf16 v[68:71], v[48:51], v[188:191], v[68:71]
    ds_read_b64_tr_b16 v[46:47], v6 offset:41984
    v_mfma_f32_16x16x32_bf16 v[72:75], v[52:55], v[184:187], v[72:75]
    s_cbranch_vccnz xs2
    buffer_load_dwordx4 v[220:223], v2, s[4:7], s42 offen offset:2304 sc1
xs2:
    ds_read_b64_tr_b16 v[48:49], v3 offset:45056
    s_add_u32 s42, s41, s88
    v_mfma_f32_16x16x32_bf16 v[76:79], v[52:55], v[188:191], v[76:79]
    ds_read_b64_tr_b16 v[50:51], v3 offset:46080
    s_waitcnt lgkmcnt(10)
    v_mfma_f32_16x16x32_bf16 v[80:83], v[56:59], v[184:187], v[80:83]
    s_cbranch_vccnz xs3
    buffer_load_dwordx4 v[224:227], v2, s[4:7], s42 offen offset:0 sc1
xs3:
    ds_read_b64_tr_b16 v[52:53], v4 offset:45056
    v_mfma_f32_16x16x32_bf16 v[84:87], v[56:59], v[188:191], v[84:87]
    ds_read_b64_tr_b16 v[54:55], v4 offset:46080
    v_mfma_f32_16x16x32_bf16 v[88:91], v[60:63], v[184:187], v[88:91]
    s_cbranch_vccnz xs4
    buffer_load_dwordx4 v[228:231], v2, s[4:7], s42 offen offset:256 sc1
xs4:
    ds_read_b64_tr_b16 v[56:57], v5 offset:45056
    v_mfma_f32_16x16x32_bf16 v[92:95], v[60:63], v[188:191], v[92:95]
    ds_read_b64_tr_b16 v[58:59], v5 offset:46080
    s_waitcnt lgkmcnt(10)
    v_mfma_f32_16x16x32_bf16 v[96:99], v[184:187], v[32:35], v[96:99]
    ds_read_b64_tr_b16 v[60:61], v6 offset:45056
    s_cbranch_vccnz xs5
    buffer_load_dwordx4 v[232:235], v2, s[4:7], s42 offen offset:2048 sc1
xs5:
    s_cbranch_vccnz c_cs1
c_cs2:
    v_mfma_f32_16x16x32_bf16 v[100:103], v[188:191], v[32:35], v[100:103]
    ds_read_b64_tr_b16 v[62:63], v6 offset:46080
    v_mfma_f32_16x16x32_bf16 v[104:107], v[184:187], v[36:39], v[104:107]
    s_cbranch_vccnz xs6
    buffer_load_dwordx4 v[236:239], v2, s[4:7], s42 offen offset:2304 sc1
xs6:
    ds_read_b64_tr_b16 v[32:33], v3 offset:49152
    s_add_u32 s42, s41, s89
    v_mfma_f32_16x16x32_bf16 v[108:111], v[188:191], v[36:39], v[108:111]
    ds_read_b64_tr_b16 v[34:35], v3 offset:50176
    s_waitcnt lgkmcnt(10)
    v_mfma_f32_16x16x32_bf16 v[112:115], v[184:187], v[40:43], v[112:115]
    ds_read_b64_tr_b16 v[36:37], v4 offset:49152
    v_mfma_f32_16x16x32_bf16 v[116:119], v[188:191], v[40:43], v[116:119]
    ds_read_b64_tr_b16 v[38:39], v4 offset:50176
    v_mfma_f32_16x16x32_bf16 v[120:123], v[184:187], v[44:47], v[120:123]
    ds_read_b64_tr_b16 v[40:41], v5 offset:49152
    v_mfma_f32_16x16x32_bf16 v[124:127], v[188:191], v[44:47], v[124:127]
    ds_read_b64_tr_b16 v[42:43], v5 offset:50176
    s_waitcnt lgkmcnt(10)
    v_mfma_f32_16x16x32_bf16 v[128:131], v[48:51], v[184:187], v[128:131]
    ds_read_b64_tr_b16 v[44:45], v6 offset:49152
    v_mfma_f32_16x16x32_bf16 v[132:135], v[48:51], v[188:191], v[132:135]
    ds_read_b64_tr_b16 v[46:47], v6 offset:50176
    v_mfma_f32_16x16x32_bf16 v[136:139], v[52:55], v[184:187], v[136:139]
    ds_read_b64_tr_b16 v[48:49], v3 offset:53248
    v_mfma_f32_16x16x32_bf16 v[140:143], v[52:55], v[188:191], v[140:143]
    ds_read_b64_tr_b16 v[50:51], v3 offset:54272
    s_waitcnt lgkmcnt(10)
    v_mfma_f32_16x16x32_bf16 v[144:147], v[56:59], v[184:187], v[144:147]
    ds_read_b64_tr_b16 v[52:53], v4 offset:53248
    v_mfma_f32_16x16x32_bf16 v[148:151], v[56:59], v[188:191], v[148:151]
    ds_read_b64_tr_b16 v[54:55], v4 offset:54272
    v_mfma_f32_16x16x32_bf16 v[152:155], v[60:63], v[184:187], v[152:155]
    ds_read_b64_tr_b16 v[56:57], v5 offset:53248
    v_mfma_f32_16x16x32_bf16 v[156:159], v[60:63], v[188:191], v[156:159]
    ds_read_b64_tr_b16 v[58:59], v5 offset:54272
    s_waitcnt vmcnt(10) lgkmcnt(10)
    v_mfma_f32_16x16x32_bf16 v[64:67], v[32:35], v[192:195], v[64:67]
    ds_read_b64_tr_b16 v[60:61], v6 offset:53248
    v_mfma_f32_16x16x32_bf16 v[68:71], v[32:35], v[196:199], v[68:71]
    ds_read_b64_tr_b16 v[62:63], v6 offset:54272
    v_mfma_f32_16x16x32_bf16 v[72:75], v[36:39], v[192:195], v[72:75]
    ds_read_b64_tr_b16 v[32:33], v3 offset:57344
    v_mfma_f32_16x16x32_bf16 v[76:79], v[36:39], v[196:199], v[76:79]
    ds_read_b64_tr_b16 v[34:35], v3 offset:58368
    s_waitcnt lgkmcnt(10)
    v_mfma_f32_16x16x32_bf16 v[80:83], v[40:43], v[192:195], v[80:83]
    ds_read_b64_tr_b16 v[36:37], v4 offset:57344
    v_mfma_f32_16x16x32_bf16 v[84:87], v[40:43], v[196:199], v[84:87]
    ds_read_b64_tr_b16 v[38:39], v4 offset:58368
    v_mfma_f32_16x16x32_bf16 v[88:91], v[44:47], v[192:195], v[88:91]
    ds_read_b64_tr_b16 v[40:41], v5 offset:57344
    v_mfma_f32_16x16x32_bf16 v[92:95], v[44:47], v[196:199], v[92:95]
    ds_read_b64_tr_b16 v[42:43], v5 offset:58368
    s_waitcnt lgkmcnt(10)
    v_mfma_f32_16x16x32_bf16 v[96:99], v[192:195], v[48:51], v[96:99]
    ds_read_b64_tr_b16 v[44:45], v6 offset:57344
    v_mfma_f32_16x16x32_bf16 v[100:103], v[196:199], v[48:51], v[100:103]
    ds_read_b64_tr_b16 v[46:47], v6 offset:58368
    v_mfma_f32_16x16x32_bf16 v[104:107], v[192:195], v[52:55], v[104:107]
    ds_read_b64_tr_b16 v[48:49], v3 offset:61440
    v_mfma_f32_16x16x32_bf16 v[108:111], v[196:199], v[52:55], v[108:111]
    ds_read_b64_tr_b16 v[50:51], v3 offset:62464
    s_waitcnt lgkmcnt(10)
    v_mfma_f32_16x16x32_bf16 v[112:115], v[192:195], v[56:59], v[112:115]
    ds_read_b64_tr_b16 v[52:53], v4 offset:61440
    v_mfma_f32_16x16x32_bf16 v[116:119], v[196:199], v[56:59], v[116:119]
    ds_read_b64_tr_b16 v[54:55], v4 offset:62464
    v_mfma_f32_16x16x32_bf16 v[120:123], v[192:195], v[60:63], v[120:123]
    ds_read_b64_tr_b16 v[56:57], v5 offset:61440
    v_mfma_f32_16x16x32_bf16 v[124:127], v[196:199], v[60:63], v[124:127]
    ds_read_b64_tr_b16 v[58:59], v5 offset:62464
    s_waitcnt lgkmcnt(10)
    v_mfma_f32_16x16x32_bf16 v[128:131], v[32:35], v[192:195], v[128:131]
    ds_read_b64_tr_b16 v[60:61], v6 offset:61440
    v_mfma_f32_16x16x32_bf16 v[132:135], v[32:35], v[196:199], v[132:135]
    ds_read_b64_tr_b16 v[62:63], v6 offset:62464
    s_barrier
    v_xor_b32 v3, 0x10000, v3
    v_xor_b32 v4, 0x10000, v4
    v_xor_b32 v5, 0x10000, v5
    v_xor_b32 v6, 0x10000, v6
    v_mfma_f32_16x16x32_bf16 v[136:139], v[36:39], v[192:195], v[136:139]
    ds_read_b64_tr_b16 v[32:33], v3 offset:0
    v_mfma_f32_16x16x32_bf16 v[140:143], v[36:39], v[196:199], v[140:143]
    ds_read_b64_tr_b16 v[34:35], v3 offset:1024
    s_waitcnt lgkmcnt(10)
    v_mfma_f32_16x16x32_bf16 v[144:147], v[40:43], v[192:195], v[144:147]
    ds_read_b64_tr_b16 v[36:37], v4 offset:0
    v_mfma_f32_16x16x32_bf16 v[148:151], v[40:43], v[196:199], v[148:151]
    ds_read_b64_tr_b16 v[38:39], v4 offset:1024
    v_mfma_f32_16x16x32_bf16 v[152:155], v[44:47], v[192:195], v[152:155]
    ds_read_b64_tr_b16 v[40:41], v5 offset:0
    v_mfma_f32_16x16x32_bf16 v[156:159], v[44:47], v[196:199], v[156:159]
    ds_read_b64_tr_b16 v[42:43], v5 offset:1024
    s_waitcnt vmcnt(8) lgkmcnt(10)
    v_mfma_f32_16x16x32_bf16 v[64:67], v[48:51], v[200:203], v[64:67]
    ds_read_b64_tr_b16 v[44:45], v6 offset:0
    v_mfma_f32_16x16x32_bf16 v[68:71], v[48:51], v[204:207], v[68:71]
    ds_read_b64_tr_b16 v[46:47], v6 offset:1024
    v_mfma_f32_16x16x32_bf16 v[72:75], v[52:55], v[200:203], v[72:75]
    ds_read_b64_tr_b16 v[48:49], v3 offset:4096
    v_mfma_f32_16x16x32_bf16 v[76:79], v[52:55], v[204:207], v[76:79]
    ds_read_b64_tr_b16 v[50:51], v3 offset:5120
    s_waitcnt lgkmcnt(10)
    v_mfma_f32_16x16x32_bf16 v[80:83], v[56:59], v[200:203], v[80:83]
    ds_read_b64_tr_b16 v[52:53], v4 offset:4096
    v_mfma_f32_16x16x32_bf16 v[84:87], v[56:59], v[204:207], v[84:87]
    ds_read_b64_tr_b16 v[54:55], v4 offset:5120
    v_mfma_f32_16x16x32_bf16 v[88:91], v[60:63], v[200:203], v[88:91]
    ds_read_b64_tr_b16 v[56:57], v5 offset:4096
    v_mfma_f32_16x16x32_bf16 v[92:95], v[60:63], v[204:207], v[92:95]
    ds_read_b64_tr_b16 v[58:59], v5 offset:5120
    s_waitcnt lgkmcnt(10)
    v_mfma_f32_16x16x32_bf16 v[96:99], v[200:203], v[32:35], v[96:99]
    ds_read_b64_tr_b16 v[60:61], v6 offset:4096
    v_mfma_f32_16x16x32_bf16 v[100:103], v[204:207], v[32:35], v[100:103]
    ds_read_b64_tr_b16 v[62:63], v6 offset:5120
    v_mfma_f32_16x16x32_bf16 v[104:107], v[200:203], v[36:39], v[104:107]
    ds_read_b64_tr_b16 v[32:33], v3 offset:8192
    v_mfma_f32_16x16x32_bf16 v[108:111], v[204:207], v[36:39], v[108:111]
    ds_read_b64_tr_b16 v[34:35], v3 offset:9216
    s_waitcnt lgkmcnt(10)
    v_mfma_f32_16x16x32_bf16 v[112:115], v[200:203], v[40:43], v[112:115]
    ds_read_b64_tr_b16 v[36:37], v4 offset:8192
    v_mfma_f32_16x16x32_bf16 v[116:119], v[204:207], v[40:43], v[116:119]
    ds_read_b64_tr_b16 v[38:39], v4 offset:9216
    v_mfma_f32_16x16x32_bf16 v[120:123], v[200:203], v[44:47], v[120:123]
    ds_read_b64_tr_b16 v[40:41], v5 offset:8192
    v_mfma_f32_16x16x32_bf16 v[124:127], v[204:207], v[44:47], v[124:127]
    ds_read_b64_tr_b16 v[42:43], v5 offset:9216
    s_waitcnt lgkmcnt(10)
    v_mfma_f32_16x16x32_bf16 v[128:131], v[48:51], v[200:203], v[128:131]
    ds_read_b64_tr_b16 v[44:45], v6 offset:8192
    v_mfma_f32_16x16x32_bf16 v[132:135], v[48:51], v[204:207], v[132:135]
    ds_read_b64_tr_b16 v[46:47], v6 offset:9216
    v_mfma_f32_16x16x32_bf16 v[136:139], v[52:55], v[200:203], v[136:139]
    ds_read_b64_tr_b16 v[48:49], v3 offset:12288
    v_mfma_f32_16x16x32_bf16 v[140:143], v[52:55], v[204:207], v[140:143]
    ds_read_b64_tr_b16 v[50:51], v3 offset:13312
    s_waitcnt lgkmcnt(10)
    v_mfma_f32_16x16x32_bf16 v[144:147], v[56:59], v[200:203], v[144:147]
    ds_read_b64_tr_b16 v[52:53], v4 offset:12288
    v_mfma_f32_16x16x32_bf16 v[148:151], v[56:59], v[204:207], v[148:151]
    ds_read_b64_tr_b16 v[54:55], v4 offset:13312
    v_mfma_f32_16x16x32_bf16 v[152:155], v[60:63], v[200:203], v[152:155]
    ds_read_b64_tr_b16 v[56:57], v5 offset:12288
    v_mfma_f32_16x16x32_bf16 v[156:159], v[60:63], v[204:207], v[156:159]
    ds_read_b64_tr_b16 v[58:59], v5 offset:13312
    s_waitcnt vmcnt(6) lgkmcnt(10)
    v_mfma_f32_16x16x32_bf16 v[64:67], v[32:35], v[208:211], v[64:67]
    ds_read_b64_tr_b16 v[60:61], v6 offset:12288
    v_mfma_f32_16x16x32_bf16 v[68:71], v[32:35], v[212:215], v[68:71]
    ds_read_b64_tr_b16 v[62:63], v6 offset:13312
    v_mfma_f32_16x16x32_bf16 v[72:75], v[36:39], v[208:211], v[72:75]
    ds_read_b64_tr_b16 v[32:33], v3 offset:16384
    v_mfma_f32_16x16x32_bf16 v[76:79], v[36:39], v[212:215], v[76:79]
    ds_read_b64_tr_b16 v[34:35], v3 offset:17408
    s_waitcnt lgkmcnt(10)
    v_mfma_f32_16x16x32_bf16 v[80:83], v[40:43], v[208:211], v[80:83]
    ds_read_b64_tr_b16 v[36:37], v4 offset:16384
    v_mfma_f32_16x16x32_bf16 v[84:87], v[40:43], v[212:215], v[84:87]
    ds_read_b64_tr_b16 v[38:39], v4 offset:17408
    v_mfma_f32_16x16x32_bf16 v[88:91], v[44:47], v[208:211], v[88:91]
    ds_read_b64_tr_b16 v[40:41], v5 offset:16384
    v_mfma_f32_16x16x32_bf16 v[92:95], v[44:47], v[212:215], v[92:95]
    ds_read_b64_tr_b16 v[42:43], v5 offset:17408
    s_waitcnt lgkmcnt(10)
    v_mfma_f32_16x16x32_bf16 v[96:99], v[208:211], v[48:51], v[96:99]
    buffer_load_dwordx4 v[240:243], v2, s[4:7], s42 offen offset:0 sc1
    ds_read_b64_tr_b16 v[44:45], v6 offset:16384
    v_mfma_f32_16x16x32_bf16 v[100:103], v[212:215], v[48:51], v[100:103]
    ds_read_b64_tr_b16 v[46:47], v6 offset:17408
    v_mfma_f32_16x16x32_bf16 v[104:107], v[208:211], v[52:55], v[104:107]
    buffer_load_dwordx4 v[244:247], v2, s[4:7], s42 offen offset:256 sc1
    ds_read_b64_tr_b16 v[48:49], v3 offset:20480
    v_mfma_f32_16x16x32_bf16 v[108:111], v[212:215], v[52:55], v[108:111]
    ds_read_b64_tr_b16 v[50:51], v3 offset:21504
    s_waitcnt lgkmcnt(10)
    v_mfma_f32_16x16x32_bf16 v[112:115], v[208:211], v[56:59], v[112:115]
    buffer_load_dwordx4 v[248:251], v2, s[4:7], s42 offen offset:2048 sc1
    ds_read_b64_tr_b16 v[52:53], v4 offset:20480
    v_mfma_f32_16x16x32_bf16 v[116:119], v[212:215], v[56:59], v[116:119]
    ds_read_b64_tr_b16 v[54:55], v4 offset:21504
    v_mfma_f32_16x16x32_bf16 v[120:123], v[208:211], v[60:63], v[120:123]
    buffer_load_dwordx4 v[252:255], v2, s[4:7], s42 offen offset:2304 sc1
    ds_read_b64_tr_b16 v[56:57], v5 offset:20480
    s_add_u32 s42, s41, s90
    v_mfma_f32_16x16x32_bf16 v[124:127], v[212:215], v[60:63], v[124:127]
    ds_read_b64_tr_b16 v[58:59], v5 offset:21504
    s_waitcnt lgkmcnt(10)
    v_mfma_f32_16x16x32_bf16 v[128:131], v[32:35], v[208:211], v[128:131]
    ds_read_b64_tr_b16 v[60:61], v6 offset:20480
    buffer_load_dwordx4 v[160:163], v2, s[4:7], s42 offen offset:0 sc1
    v_mfma_f32_16x16x32_bf16 v[132:135], v[32:35], v[212:215], v[132:135]
    ds_read_b64_tr_b16 v[62:63], v6 offset:21504
    v_mfma_f32_16x16x32_bf16 v[136:139], v[36:39], v[208:211], v[136:139]
    buffer_load_dwordx4 v[164:167], v2, s[4:7], s42 offen offset:256 sc1
    ds_read_b64_tr_b16 v[32:33], v3 offset:24576
    v_mfma_f32_16x16x32_bf16 v[140:143], v[36:39], v[212:215], v[140:143]
    ds_read_b64_tr_b16 v[34:35], v3 offset:25600
    s_waitcnt lgkmcnt(10)
    v_mfma_f32_16x16x32_bf16 v[144:147], v[40:43], v[208:211], v[144:147]
    buffer_load_dwordx4 v[168:171], v2, s[4:7], s42 offen offset:2048 sc1
    ds_read_b64_tr_b16 v[36:37], v4 offset:24576
    v_mfma_f32_16x16x32_bf16 v[148:151], v[40:43], v[212:215], v[148:151]
    ds_read_b64_tr_b16 v[38:39], v4 offset:25600
    v_mfma_f32_16x16x32_bf16 v[152:155], v[44:47], v[208:211], v[152:155]
    buffer_load_dwordx4 v[172:175], v2, s[4:7], s42 offen offset:2304 sc1
    ds_read_b64_tr_b16 v[40:41], v5 offset:24576
    s_add_u32 s42, s41, s91
    v_mfma_f32_16x16x32_bf16 v[156:159], v[44:47], v[212:215], v[156:159]
    ds_read_b64_tr_b16 v[42:43], v5 offset:25600
    s_waitcnt vmcnt(12) lgkmcnt(10)
    v_mfma_f32_16x16x32_bf16 v[64:67], v[48:51], v[216:219], v[64:67]
    buffer_load_dwordx4 v[176:179], v2, s[4:7], s42 offen offset:0 sc1
    ds_read_b64_tr_b16 v[44:45], v6 offset:24576
    v_mfma_f32_16x16x32_bf16 v[68:71], v[48:51], v[220:223], v[68:71]
    ds_read_b64_tr_b16 v[46:47], v6 offset:25600
    v_mfma_f32_16x16x32_bf16 v[72:75], v[52:55], v[216:219], v[72:75]
    buffer_load_dwordx4 v[180:183], v2, s[4:7], s42 offen offset:256 sc1
    ds_read_b64_tr_b16 v[48:49], v3 offset:28672
    v_mfma_f32_16x16x32_bf16 v[76:79], v[52:55], v[220:223], v[76:79]
    ds_read_b64_tr_b16 v[50:51], v3 offset:29696
    s_waitcnt lgkmcnt(10)
    v_mfma_f32_16x16x32_bf16 v[80:83], v[56:59], v[216:219], v[80:83]
    buffer_load_dwordx4 v[184:187], v2, s[4:7], s42 offen offset:2048 sc1
    ds_read_b64_tr_b16 v[52:53], v4 offset:28672
    v_mfma_f32_16x16x32_bf16 v[84:87], v[56:59], v[220:223], v[84:87]
    ds_read_b64_tr_b16 v[54:55], v4 offset:29696
    v_mfma_f32_16x16x32_bf16 v[88:91], v[60:63], v[216:219], v[88:91]
    buffer_load_dwordx4 v[188:191], v2, s[4:7], s42 offen offset:2304 sc1
    ds_read_b64_tr_b16 v[56:57], v5 offset:28672
    s_add_u32 s42, s41, s92
    v_mfma_f32_16x16x32_bf16 v[92:95], v[60:63], v[220:223], v[92:95]
    ds_read_b64_tr_b16 v[58:59], v5 offset:29696
    s_waitcnt lgkmcnt(10)
    v_mfma_f32_16x16x32_bf16 v[96:99], v[216:219], v[32:35], v[96:99]
    ds_read_b64_tr_b16 v[60:61], v6 offset:28672
    v_mfma_f32_16x16x32_bf16 v[100:103], v[220:223], v[32:35], v[100:103]
    ds_read_b64_tr_b16 v[62:63], v6 offset:29696
    s_barrier
    v_mfma_f32_16x16x32_bf16 v[104:107], v[216:219], v[36:39], v[104:107]
    ds_read_b64_tr_b16 v[32:33], v3 offset:32768
    v_mfma_f32_16x16x32_bf16 v[108:111], v[220:223], v[36:39], v[108:111]
    ds_read_b64_tr_b16 v[34:35], v3 offset:33792
    s_waitcnt lgkmcnt(10)
    v_mfma_f32_16x16x32_bf16 v[112:115], v[216:219], v[40:43], v[112:115]
    ds_read_b64_tr_b16 v[36:37], v4 offset:32768
    v_mfma_f32_16x16x32_bf16 v[116:119], v[220:223], v[40:43], v[116:119]
    ds_read_b64_tr_b16 v[38:39], v4 offset:33792
    v_mfma_f32_16x16x32_bf16 v[120:123], v[216:219], v[44:47], v[120:123]
    ds_read_b64_tr_b16 v[40:41], v5 offset:32768
    v_mfma_f32_16x16x32_bf16 v[124:127], v[220:223], v[44:47], v[124:127]
    ds_read_b64_tr_b16 v[42:43], v5 offset:33792
    s_waitcnt lgkmcnt(10)
    v_mfma_f32_16x16x32_bf16 v[128:131], v[48:51], v[216:219], v[128:131]
    ds_read_b64_tr_b16 v[44:45], v6 offset:32768
    v_mfma_f32_16x16x32_bf16 v[132:135], v[48:51], v[220:223], v[132:135]
    ds_read_b64_tr_b16 v[46:47], v6 offset:33792
    v_mfma_f32_16x16x32_bf16 v[136:139], v[52:55], v[216:219], v[136:139]
    ds_read_b64_tr_b16 v[48:49], v3 offset:36864
    v_mfma_f32_16x16x32_bf16 v[140:143], v[52:55], v[220:223], v[140:143]
    ds_read_b64_tr_b16 v[50:51], v3 offset:37888
    s_waitcnt lgkmcnt(10)
    v_mfma_f32_16x16x32_bf16 v[144:147], v[56:59], v[216:219], v[144:147]
    ds_read_b64_tr_b16 v[52:53], v4 offset:36864
    v_mfma_f32_16x16x32_bf16 v[148:151], v[56:59], v[220:223], v[148:151]
    ds_read_b64_tr_b16 v[54:55], v4 offset:37888
    v_mfma_f32_16x16x32_bf16 v[152:155], v[60:63], v[216:219], v[152:155]
    ds_read_b64_tr_b16 v[56:57], v5 offset:36864
    v_mfma_f32_16x16x32_bf16 v[156:159], v[60:63], v[220:223], v[156:159]
    ds_read_b64_tr_b16 v[58:59], v5 offset:37888
    s_waitcnt vmcnt(14) lgkmcnt(10)
    v_mfma_f32_16x16x32_bf16 v[64:67], v[32:35], v[224:227], v[64:67]
    ds_read_b64_tr_b16 v[60:61], v6 offset:36864
    v_mfma_f32_16x16x32_bf16 v[68:71], v[32:35], v[228:231], v[68:71]
    ds_read_b64_tr_b16 v[62:63], v6 offset:37888
    v_mfma_f32_16x16x32_bf16 v[72:75], v[36:39], v[224:227], v[72:75]
    ds_read_b64_tr_b16 v[32:33], v3 offset:40960
    v_mfma_f32_16x16x32_bf16 v[76:79], v[36:39], v[228:231], v[76:79]
    ds_read_b64_tr_b16 v[34:35], v3 offset:41984
    s_waitcnt lgkmcnt(10)
    v_mfma_f32_16x16x32_bf16 v[80:83], v[40:43], v[224:227], v[80:83]
    ds_read_b64_tr_b16 v[36:37], v4 offset:40960
    v_mfma_f32_16x16x32_bf16 v[84:87], v[40:43], v[228:231], v[84:87]
    ds_read_b64_tr_b16 v[38:39], v4 offset:41984
    v_mfma_f32_16x16x32_bf16 v[88:91], v[44:47], v[224:227], v[88:91]
    ds_read_b64_tr_b16 v[40:41], v5 offset:40960
    v_mfma_f32_16x16x32_bf16 v[92:95], v[44:47], v[228:231], v[92:95]
    ds_read_b64_tr_b16 v[42:43], v5 offset:41984
    s_waitcnt lgkmcnt(10)
    v_mfma_f32_16x16x32_bf16 v[96:99], v[224:227], v[48:51], v[96:99]
    ds_read_b64_tr_b16 v[44:45], v6 offset:40960
    v_mfma_f32_16x16x32_bf16 v[100:103], v[228:231], v[48:51], v[100:103]
    ds_read_b64_tr_b16 v[46:47], v6 offset:41984
    v_mfma_f32_16x16x32_bf16 v[104:107], v[224:227], v[52:55], v[104:107]
    ds_read_b64_tr_b16 v[48:49], v3 offset:45056
    v_mfma_f32_16x16x32_bf16 v[108:111], v[228:231], v[52:55], v[108:111]
    ds_read_b64_tr_b16 v[50:51], v3 offset:46080
    s_waitcnt lgkmcnt(10)
    v_mfma_f32_16x16x32_bf16 v[112:115], v[224:227], v[56:59], v[112:115]
    ds_read_b64_tr_b16 v[52:53], v4 offset:45056
    v_mfma_f32_16x16x32_bf16 v[116:119], v[228:231], v[56:59], v[116:119]
    ds_read_b64_tr_b16 v[54:55], v4 offset:46080
    v_mfma_f32_16x16x32_bf16 v[120:123], v[224:227], v[60:63], v[120:123]
    ds_read_b64_tr_b16 v[56:57], v5 offset:45056
    v_mfma_f32_16x16x32_bf16 v[124:127], v[228:231], v[60:63], v[124:127]
    ds_read_b64_tr_b16 v[58:59], v5 offset:46080
    s_waitcnt lgkmcnt(10)
    v_mfma_f32_16x16x32_bf16 v[128:131], v[32:35], v[224:227], v[128:131]
    ds_read_b64_tr_b16 v[60:61], v6 offset:45056
    v_mfma_f32_16x16x32_bf16 v[132:135], v[32:35], v[228:231], v[132:135]
    ds_read_b64_tr_b16 v[62:63], v6 offset:46080
    v_mfma_f32_16x16x32_bf16 v[136:139], v[36:39], v[224:227], v[136:139]
    ds_read_b64_tr_b16 v[32:33], v3 offset:49152
    v_mfma_f32_16x16x32_bf16 v[140:143], v[36:39], v[228:231], v[140:143]
    ds_read_b64_tr_b16 v[34:35], v3 offset:50176
    s_waitcnt lgkmcnt(10)
    v_mfma_f32_16x16x32_bf16 v[144:147], v[40:43], v[224:227], v[144:147]
    ds_read_b64_tr_b16 v[36:37], v4 offset:49152
    v_mfma_f32_16x16x32_bf16 v[148:151], v[40:43], v[228:231], v[148:151]
    ds_read_b64_tr_b16 v[38:39], v4 offset:50176
    v_mfma_f32_16x16x32_bf16 v[152:155], v[44:47], v[224:227], v[152:155]
    ds_read_b64_tr_b16 v[40:41], v5 offset:49152
    v_mfma_f32_16x16x32_bf16 v[156:159], v[44:47], v[228:231], v[156:159]
    ds_read_b64_tr_b16 v[42:43], v5 offset:50176
    s_waitcnt vmcnt(12) lgkmcnt(10)
    v_mfma_f32_16x16x32_bf16 v[64:67], v[48:51], v[232:235], v[64:67]
    buffer_load_dwordx4 v[192:195], v2, s[4:7], s42 offen offset:0 sc1
    ds_read_b64_tr_b16 v[44:45], v6 offset:49152
    v_mfma_f32_16x16x32_bf16 v[68:71], v[48:51], v[236:239], v[68:71]
    ds_read_b64_tr_b16 v[46:47], v6 offset:50176
    v_mfma_f32_16x16x32_bf16 v[72:75], v[52:55], v[232:235], v[72:75]
    buffer_load_dwordx4 v[196:199], v2, s[4:7], s42 offen offset:256 sc1
    ds_read_b64_tr_b16 v[48:49], v3 offset:53248
    v_mfma_f32_16x16x32_bf16 v[76:79], v[52:55], v[236:239], v[76:79]
    ds_read_b64_tr_b16 v[50:51], v3 offset:54272
    s_waitcnt lgkmcnt(10)
    v_mfma_f32_16x16x32_bf16 v[80:83], v[56:59], v[232:235], v[80:83]
    buffer_load_dwordx4 v[200:203], v2, s[4:7], s42 offen offset:2048 sc1
    ds_read_b64_tr_b16 v[52:53], v4 offset:53248
    v_mfma_f32_16x16x32_bf16 v[84:87], v[56:59], v[236:239], v[84:87]
    ds_read_b64_tr_b16 v[54:55], v4 offset:54272
    v_mfma_f32_16x16x32_bf16 v[88:91], v[60:63], v[232:235], v[88:91]
    buffer_load_dwordx4 v[204:207], v2, s[4:7], s42 offen offset:2304 sc1
    ds_read_b64_tr_b16 v[56:57], v5 offset:53248
    s_add_u32 s42, s41, s93
    v_mfma_f32_16x16x32_bf16 v[92:95], v[60:63], v[236:239], v[92:95]
    ds_read_b64_tr_b16 v[58:59], v5 offset:54272
    s_waitcnt lgkmcnt(10)
    v_mfma_f32_16x16x32_bf16 v[96:99], v[232:235], v[32:35], v[96:99]
    ds_read_b64_tr_b16 v[60:61], v6 offset:53248
    buffer_load_dwordx4 v[208:211], v2, s[4:7], s42 offen offset:0 sc1
    v_mfma_f32_16x16x32_bf16 v[100:103], v[236:239], v[32:35], v[100:103]
    ds_read_b64_tr_b16 v[62:63], v6 offset:54272
    v_mfma_f32_16x16x32_bf16 v[104:107], v[232:235], v[36:39], v[104:107]
    ds_read_b64_tr_b16 v[32:33], v3 offset:57344
    v_mfma_f32_16x16x32_bf16 v[108:111], v[236:239], v[36:39], v[108:111]
    ds_read_b64_tr_b16 v[34:35], v3 offset:58368
    s_waitcnt lgkmcnt(10)
    v_mfma_f32_16x16x32_bf16 v[112:115], v[232:235], v[40:43], v[112:115]
    ds_read_b64_tr_b16 v[36:37], v4 offset:57344
    v_mfma_f32_16x16x32_bf16 v[116:119], v[236:239], v[40:43], v[116:119]
    ds_read_b64_tr_b16 v[38:39], v4 offset:58368
    v_mfma_f32_16x16x32_bf16 v[120:123], v[232:235], v[44:47], v[120:123]
    buffer_load_dwordx4 v[212:215], v2, s[4:7], s42 offen offset:256 sc1
    ds_read_b64_tr_b16 v[40:41], v5 offset:57344
    v_mfma_f32_16x16x32_bf16 v[124:127], v[236:239], v[44:47], v[124:127]
    ds_read_b64_tr_b16 v[42:43], v5 offset:58368
    s_waitcnt lgkmcnt(10)
    v_mfma_f32_16x16x32_bf16 v[128:131], v[48:51], v[232:235], v[128:131]
    ds_read_b64_tr_b16 v[44:45], v6 offset:57344
    v_mfma_f32_16x16x32_bf16 v[132:135], v[48:51], v[236:239], v[132:135]
    ds_read_b64_tr_b16 v[46:47], v6 offset:58368
    v_mfma_f32_16x16x32_bf16 v[136:139], v[52:55], v[232:235], v[136:139]
    ds_read_b64_tr_b16 v[48:49], v3 offset:61440
    v_mfma_f32_16x16x32_bf16 v[140:143], v[52:55], v[236:239], v[140:143]
    ds_read_b64_tr_b16 v[50:51], v3 offset:62464
    s_waitcnt lgkmcnt(10)
    v_mfma_f32_16x16x32_bf16 v[144:147], v[56:59], v[232:235], v[144:147]
    ds_read_b64_tr_b16 v[52:53], v4 offset:61440
    v_mfma_f32_16x16x32_bf16 v[148:151], v[56:59], v[236:239], v[148:151]
    ds_read_b64_tr_b16 v[54:55], v4 offset:62464
    v_mfma_f32_16x16x32_bf16 v[152:155], v[60:63], v[232:235], v[152:155]
    ds_read_b64_tr_b16 v[56:57], v5 offset:61440
    v_mfma_f32_16x16x32_bf16 v[156:159], v[60:63], v[236:239], v[156:159]
    ds_read_b64_tr_b16 v[58:59], v5 offset:62464
    s_waitcnt vmcnt(16) lgkmcnt(10)
    v_mfma_f32_16x16x32_bf16 v[64:67], v[32:35], v[240:243], v[64:67]
    ds_read_b64_tr_b16 v[60:61], v6 offset:61440
    v_mfma_f32_16x16x32_bf16 v[68:71], v[32:35], v[244:247], v[68:71]
    ds_read_b64_tr_b16 v[62:63], v6 offset:62464
    s_barrier
    v_xor_b32 v3, 0x10000, v3
    v_xor_b32 v4, 0x10000, v4
    v_xor_b32 v5, 0x10000, v5
    v_xor_b32 v6, 0x10000, v6
    v_mfma_f32_16x16x32_bf16 v[72:75], v[36:39], v[240:243], v[72:75]
    ds_read_b64_tr_b16 v[32:33], v3 offset:0
    v_mfma_f32_16x16x32_bf16 v[76:79], v[36:39], v[244:247], v[76:79]
    ds_read_b64_tr_b16 v[34:35], v3 offset:1024
    s_waitcnt lgkmcnt(10)
    v_mfma_f32_16x16x32_bf16 v[80:83], v[40:43], v[240:243], v[80:83]
    ds_read_b64_tr_b16 v[36:37], v4 offset:0
    v_mfma_f32_16x16x32_bf16 v[84:87], v[40:43], v[244:247], v[84:87]
    ds_read_b64_tr_b16 v[38:39], v4 offset:1024
    v_mfma_f32_16x16x32_bf16 v[88:91], v[44:47], v[240:243], v[88:91]
    ds_read_b64_tr_b16 v[40:41], v5 offset:0
    v_mfma_f32_16x16x32_bf16 v[92:95], v[44:47], v[244:247], v[92:95]
    ds_read_b64_tr_b16 v[42:43], v5 offset:1024
    s_waitcnt lgkmcnt(10)
    v_mfma_f32_16x16x32_bf16 v[96:99], v[240:243], v[48:51], v[96:99]
    ds_read_b64_tr_b16 v[44:45], v6 offset:0
    v_mfma_f32_16x16x32_bf16 v[100:103], v[244:247], v[48:51], v[100:103]
    ds_read_b64_tr_b16 v[46:47], v6 offset:1024
    v_mfma_f32_16x16x32_bf16 v[104:107], v[240:243], v[52:55], v[104:107]
    ds_read_b64_tr_b16 v[48:49], v3 offset:4096
    v_mfma_f32_16x16x32_bf16 v[108:111], v[244:247], v[52:55], v[108:111]
    ds_read_b64_tr_b16 v[50:51], v3 offset:5120
    s_waitcnt lgkmcnt(10)
    v_mfma_f32_16x16x32_bf16 v[112:115], v[240:243], v[56:59], v[112:115]
    ds_read_b64_tr_b16 v[52:53], v4 offset:4096
    v_mfma_f32_16x16x32_bf16 v[116:119], v[244:247], v[56:59], v[116:119]
    ds_read_b64_tr_b16 v[54:55], v4 offset:5120
    v_mfma_f32_16x16x32_bf16 v[120:123], v[240:243], v[60:63], v[120:123]
    ds_read_b64_tr_b16 v[56:57], v5 offset:4096
    v_mfma_f32_16x16x32_bf16 v[124:127], v[244:247], v[60:63], v[124:127]
    ds_read_b64_tr_b16 v[58:59], v5 offset:5120
    s_waitcnt lgkmcnt(10)
    v_mfma_f32_16x16x32_bf16 v[128:131], v[32:35], v[240:243], v[128:131]
    ds_read_b64_tr_b16 v[60:61], v6 offset:4096
    v_mfma_f32_16x16x32_bf16 v[132:135], v[32:35], v[244:247], v[132:135]
    ds_read_b64_tr_b16 v[62:63], v6 offset:5120
    v_mfma_f32_16x16x32_bf16 v[136:139], v[36:39], v[240:243], v[136:139]
    ds_read_b64_tr_b16 v[32:33], v3 offset:8192
    v_mfma_f32_16x16x32_bf16 v[140:143], v[36:39], v[244:247], v[140:143]
    ds_read_b64_tr_b16 v[34:35], v3 offset:9216
    s_waitcnt lgkmcnt(10)
    v_mfma_f32_16x16x32_bf16 v[144:147], v[40:43], v[240:243], v[144:147]
    ds_read_b64_tr_b16 v[36:37], v4 offset:8192
    v_mfma_f32_16x16x32_bf16 v[148:151], v[40:43], v[244:247], v[148:151]
    ds_read_b64_tr_b16 v[38:39], v4 offset:9216
    v_mfma_f32_16x16x32_bf16 v[152:155], v[44:47], v[240:243], v[152:155]
    ds_read_b64_tr_b16 v[40:41], v5 offset:8192
    v_mfma_f32_16x16x32_bf16 v[156:159], v[44:47], v[244:247], v[156:159]
    ds_read_b64_tr_b16 v[42:43], v5 offset:9216
    s_waitcnt vmcnt(14) lgkmcnt(10)
    v_mfma_f32_16x16x32_bf16 v[64:67], v[48:51], v[248:251], v[64:67]
    ds_read_b64_tr_b16 v[44:45], v6 offset:8192
    v_mfma_f32_16x16x32_bf16 v[68:71], v[48:51], v[252:255], v[68:71]
    ds_read_b64_tr_b16 v[46:47], v6 offset:9216
    v_mfma_f32_16x16x32_bf16 v[72:75], v[52:55], v[248:251], v[72:75]
    ds_read_b64_tr_b16 v[48:49], v3 offset:12288
    v_mfma_f32_16x16x32_bf16 v[76:79], v[52:55], v[252:255], v[76:79]
    ds_read_b64_tr_b16 v[50:51], v3 offset:13312
    s_waitcnt lgkmcnt(10)
    v_mfma_f32_16x16x32_bf16 v[80:83], v[56:59], v[248:251], v[80:83]
    ds_read_b64_tr_b16 v[52:53], v4 offset:12288
    v_mfma_f32_16x16x32_bf16 v[84:87], v[56:59], v[252:255], v[84:87]
    ds_read_b64_tr_b16 v[54:55], v4 offset:13312
    v_mfma_f32_16x16x32_bf16 v[88:91], v[60:63], v[248:251], v[88:91]
    ds_read_b64_tr_b16 v[56:57], v5 offset:12288
    v_mfma_f32_16x16x32_bf16 v[92:95], v[60:63], v[252:255], v[92:95]
    ds_read_b64_tr_b16 v[58:59], v5 offset:13312
    s_waitcnt lgkmcnt(10)
    v_mfma_f32_16x16x32_bf16 v[96:99], v[248:251], v[32:35], v[96:99]
    ds_read_b64_tr_b16 v[60:61], v6 offset:12288
    v_mfma_f32_16x16x32_bf16 v[100:103], v[252:255], v[32:35], v[100:103]
    ds_read_b64_tr_b16 v[62:63], v6 offset:13312
    v_mfma_f32_16x16x32_bf16 v[104:107], v[248:251], v[36:39], v[104:107]
    ds_read_b64_tr_b16 v[32:33], v3 offset:16384
    v_mfma_f32_16x16x32_bf16 v[108:111], v[252:255], v[36:39], v[108:111]
    ds_read_b64_tr_b16 v[34:35], v3 offset:17408
    s_waitcnt lgkmcnt(10)
    v_mfma_f32_16x16x32_bf16 v[112:115], v[248:251], v[40:43], v[112:115]
    ds_read_b64_tr_b16 v[36:37], v4 offset:16384
    v_mfma_f32_16x16x32_bf16 v[116:119], v[252:255], v[40:43], v[116:119]
    ds_read_b64_tr_b16 v[38:39], v4 offset:17408
    v_mfma_f32_16x16x32_bf16 v[120:123], v[248:251], v[44:47], v[120:123]
    ds_read_b64_tr_b16 v[40:41], v5 offset:16384
    v_mfma_f32_16x16x32_bf16 v[124:127], v[252:255], v[44:47], v[124:127]
    ds_read_b64_tr_b16 v[42:43], v5 offset:17408
    s_waitcnt lgkmcnt(10)
    v_mfma_f32_16x16x32_bf16 v[128:131], v[48:51], v[248:251], v[128:131]
    buffer_load_dwordx4 v[216:219], v2, s[4:7], s42 offen offset:2048 sc1
    ds_read_b64_tr_b16 v[44:45], v6 offset:16384
    v_mfma_f32_16x16x32_bf16 v[132:135], v[48:51], v[252:255], v[132:135]
    ds_read_b64_tr_b16 v[46:47], v6 offset:17408
    v_mfma_f32_16x16x32_bf16 v[136:139], v[52:55], v[248:251], v[136:139]
    buffer_load_dwordx4 v[220:223], v2, s[4:7], s42 offen offset:2304 sc1
    ds_read_b64_tr_b16 v[48:49], v3 offset:20480
    s_add_u32 s42, s41, s94
    v_mfma_f32_16x16x32_bf16 v[140:143], v[52:55], v[252:255], v[140:143]
    ds_read_b64_tr_b16 v[50:51], v3 offset:21504
    s_waitcnt lgkmcnt(10)
    v_mfma_f32_16x16x32_bf16 v[144:147], v[56:59], v[248:251], v[144:147]
    buffer_load_dwordx4 v[224:227], v2, s[4:7], s42 offen offset:0 sc1
    ds_read_b64_tr_b16 v[52:53], v4 offset:20480
    v_mfma_f32_16x16x32_bf16 v[148:151], v[56:59], v[252:255], v[148:151]
    ds_read_b64_tr_b16 v[54:55], v4 offset:21504
    v_mfma_f32_16x16x32_bf16 v[152:155], v[60:63], v[248:251], v[152:155]
    buffer_load_dwordx4 v[228:231], v2, s[4:7], s42 offen offset:256 sc1
    ds_read_b64_tr_b16 v[56:57], v5 offset:20480
    v_mfma_f32_16x16x32_bf16 v[156:159], v[60:63], v[252:255], v[156:159]
    ds_read_b64_tr_b16 v[58:59], v5 offset:21504
    s_waitcnt vmcnt(16) lgkmcnt(10)
    v_mfma_f32_16x16x32_bf16 v[64:67], v[32:35], v[160:163], v[64:67]
    ds_read_b64_tr_b16 v[60:61], v6 offset:20480
    buffer_load_dwordx4 v[232:235], v2, s[4:7], s42 offen offset:2048 sc1
    v_mfma_f32_16x16x32_bf16 v[68:71], v[32:35], v[164:167], v[68:71]
    ds_read_b64_tr_b16 v[62:63], v6 offset:21504
    v_mfma_f32_16x16x32_bf16 v[72:75], v[36:39], v[160:163], v[72:75]
    buffer_load_dwordx4 v[236:239], v2, s[4:7], s42 offen offset:2304 sc1
    ds_read_b64_tr_b16 v[32:33], v3 offset:24576
    s_add_u32 s42, s41, s95
    v_mfma_f32_16x16x32_bf16 v[76:79], v[36:39], v[164:167], v[76:79]
    ds_read_b64_tr_b16 v[34:35], v3 offset:25600
    s_waitcnt lgkmcnt(10)
    v_mfma_f32_16x16x32_bf16 v[80:83], v[40:43], v[160:163], v[80:83]
    ds_read_b64_tr_b16 v[36:37], v4 offset:24576
    v_mfma_f32_16x16x32_bf16 v[84:87], v[40:43], v[164:167], v[84:87]
    ds_read_b64_tr_b16 v[38:39], v4 offset:25600
    v_mfma_f32_16x16x32_bf16 v[88:91], v[44:47], v[160:163], v[88:91]
    ds_read_b64_tr_b16 v[40:41], v5 offset:24576
    v_mfma_f32_16x16x32_bf16 v[92:95], v[44:47], v[164:167], v[92:95]
    ds_read_b64_tr_b16 v[42:43], v5 offset:25600
    s_waitcnt lgkmcnt(10)
    v_mfma_f32_16x16x32_bf16 v[96:99], v[160:163], v[48:51], v[96:99]
    buffer_load_dwordx4 v[240:243], v2, s[4:7], s42 offen offset:0 sc1
    ds_read_b64_tr_b16 v[44:45], v6 offset:24576
    v_mfma_f32_16x16x32_bf16 v[100:103], v[164:167], v[48:51], v[100:103]
    ds_read_b64_tr_b16 v[46:47], v6 offset:25600
    v_mfma_f32_16x16x32_bf16 v[104:107], v[160:163], v[52:55], v[104:107]
    ds_read_b64_tr_b16 v[48:49], v3 offset:28672
    v_mfma_f32_16x16x32_bf16 v[108:111], v[164:167], v[52:55], v[108:111]
    ds_read_b64_tr_b16 v[50:51], v3 offset:29696
    s_waitcnt lgkmcnt(10)
    v_mfma_f32_16x16x32_bf16 v[112:115], v[160:163], v[56:59], v[112:115]
    ds_read_b64_tr_b16 v[52:53], v4 offset:28672
    v_mfma_f32_16x16x32_bf16 v[116:119], v[164:167], v[56:59], v[116:119]
    ds_read_b64_tr_b16 v[54:55], v4 offset:29696
    v_mfma_f32_16x16x32_bf16 v[120:123], v[160:163], v[60:63], v[120:123]
    ds_read_b64_tr_b16 v[56:57], v5 offset:28672
    v_mfma_f32_16x16x32_bf16 v[124:127], v[164:167], v[60:63], v[124:127]
    ds_read_b64_tr_b16 v[58:59], v5 offset:29696
    s_waitcnt lgkmcnt(10)
    v_mfma_f32_16x16x32_bf16 v[128:131], v[32:35], v[160:163], v[128:131]
    ds_read_b64_tr_b16 v[60:61], v6 offset:28672
    v_mfma_f32_16x16x32_bf16 v[132:135], v[32:35], v[164:167], v[132:135]
    ds_read_b64_tr_b16 v[62:63], v6 offset:29696
    s_barrier
    v_mfma_f32_16x16x32_bf16 v[136:139], v[36:39], v[160:163], v[136:139]
    ds_read_b64_tr_b16 v[32:33], v3 offset:32768
    v_mfma_f32_16x16x32_bf16 v[140:143], v[36:39], v[164:167], v[140:143]
    ds_read_b64_tr_b16 v[34:35], v3 offset:33792
    s_waitcnt lgkmcnt(10)
    v_mfma_f32_16x16x32_bf16 v[144:147], v[40:43], v[160:163], v[144:147]
    ds_read_b64_tr_b16 v[36:37], v4 offset:32768
    v_mfma_f32_16x16x32_bf16 v[148:151], v[40:43], v[164:167], v[148:151]
    ds_read_b64_tr_b16 v[38:39], v4 offset:33792
    v_mfma_f32_16x16x32_bf16 v[152:155], v[44:47], v[160:163], v[152:155]
    ds_read_b64_tr_b16 v[40:41], v5 offset:32768
    v_mfma_f32_16x16x32_bf16 v[156:159], v[44:47], v[164:167], v[156:159]
    ds_read_b64_tr_b16 v[42:43], v5 offset:33792
    s_waitcnt vmcnt(17) lgkmcnt(10)
    v_mfma_f32_16x16x32_bf16 v[64:67], v[48:51], v[168:171], v[64:67]
    ds_read_b64_tr_b16 v[44:45], v6 offset:32768
    v_mfma_f32_16x16x32_bf16 v[68:71], v[48:51], v[172:175], v[68:71]
    ds_read_b64_tr_b16 v[46:47], v6 offset:33792
    v_mfma_f32_16x16x32_bf16 v[72:75], v[52:55], v[168:171], v[72:75]
    ds_read_b64_tr_b16 v[48:49], v3 offset:36864
    v_mfma_f32_16x16x32_bf16 v[76:79], v[52:55], v[172:175], v[76:79]
    ds_read_b64_tr_b16 v[50:51], v3 offset:37888
    s_waitcnt lgkmcnt(10)
    v_mfma_f32_16x16x32_bf16 v[80:83], v[56:59], v[168:171], v[80:83]
    ds_read_b64_tr_b16 v[52:53], v4 offset:36864
    v_mfma_f32_16x16x32_bf16 v[84:87], v[56:59], v[172:175], v[84:87]
    ds_read_b64_tr_b16 v[54:55], v4 offset:37888
    v_mfma_f32_16x16x32_bf16 v[88:91], v[60:63], v[168:171], v[88:91]
    ds_read_b64_tr_b16 v[56:57], v5 offset:36864
    v_mfma_f32_16x16x32_bf16 v[92:95], v[60:63], v[172:175], v[92:95]
    ds_read_b64_tr_b16 v[58:59], v5 offset:37888
    s_waitcnt lgkmcnt(10)
    v_mfma_f32_16x16x32_bf16 v[96:99], v[168:171], v[32:35], v[96:99]
    ds_read_b64_tr_b16 v[60:61], v6 offset:36864
    v_mfma_f32_16x16x32_bf16 v[100:103], v[172:175], v[32:35], v[100:103]
    ds_read_b64_tr_b16 v[62:63], v6 offset:37888
    v_mfma_f32_16x16x32_bf16 v[104:107], v[168:171], v[36:39], v[104:107]
    ds_read_b64_tr_b16 v[32:33], v3 offset:40960
    v_mfma_f32_16x16x32_bf16 v[108:111], v[172:175], v[36:39], v[108:111]
    ds_read_b64_tr_b16 v[34:35], v3 offset:41984
    s_waitcnt lgkmcnt(10)
    v_mfma_f32_16x16x32_bf16 v[112:115], v[168:171], v[40:43], v[112:115]
    ds_read_b64_tr_b16 v[36:37], v4 offset:40960
    v_mfma_f32_16x16x32_bf16 v[116:119], v[172:175], v[40:43], v[116:119]
    ds_read_b64_tr_b16 v[38:39], v4 offset:41984
    v_mfma_f32_16x16x32_bf16 v[120:123], v[168:171], v[44:47], v[120:123]
    ds_read_b64_tr_b16 v[40:41], v5 offset:40960
    v_mfma_f32_16x16x32_bf16 v[124:127], v[172:175], v[44:47], v[124:127]
    ds_read_b64_tr_b16 v[42:43], v5 offset:41984
    s_waitcnt lgkmcnt(10)
    v_mfma_f32_16x16x32_bf16 v[128:131], v[48:51], v[168:171], v[128:131]
    ds_read_b64_tr_b16 v[44:45], v6 offset:40960
    v_mfma_f32_16x16x32_bf16 v[132:135], v[48:51], v[172:175], v[132:135]
    ds_read_b64_tr_b16 v[46:47], v6 offset:41984
    v_mfma_f32_16x16x32_bf16 v[136:139], v[52:55], v[168:171], v[136:139]
    ds_read_b64_tr_b16 v[48:49], v3 offset:45056
    v_mfma_f32_16x16x32_bf16 v[140:143], v[52:55], v[172:175], v[140:143]
    ds_read_b64_tr_b16 v[50:51], v3 offset:46080
    s_waitcnt lgkmcnt(10)
    v_mfma_f32_16x16x32_bf16 v[144:147], v[56:59], v[168:171], v[144:147]
    ds_read_b64_tr_b16 v[52:53], v4 offset:45056
    v_mfma_f32_16x16x32_bf16 v[148:151], v[56:59], v[172:175], v[148:151]
    ds_read_b64_tr_b16 v[54:55], v4 offset:46080
    v_mfma_f32_16x16x32_bf16 v[152:155], v[60:63], v[168:171], v[152:155]
    ds_read_b64_tr_b16 v[56:57], v5 offset:45056
    v_mfma_f32_16x16x32_bf16 v[156:159], v[60:63], v[172:175], v[156:159]
    ds_read_b64_tr_b16 v[58:59], v5 offset:46080
    s_waitcnt vmcnt(15) lgkmcnt(10)
    v_mfma_f32_16x16x32_bf16 v[64:67], v[32:35], v[176:179], v[64:67]
    ds_read_b64_tr_b16 v[60:61], v6 offset:45056
    v_mfma_f32_16x16x32_bf16 v[68:71], v[32:35], v[180:183], v[68:71]
    ds_read_b64_tr_b16 v[62:63], v6 offset:46080
    v_mfma_f32_16x16x32_bf16 v[72:75], v[36:39], v[176:179], v[72:75]
    ds_read_b64_tr_b16 v[32:33], v3 offset:49152
    v_mfma_f32_16x16x32_bf16 v[76:79], v[36:39], v[180:183], v[76:79]
    ds_read_b64_tr_b16 v[34:35], v3 offset:50176
    s_waitcnt lgkmcnt(10)
    v_mfma_f32_16x16x32_bf16 v[80:83], v[40:43], v[176:179], v[80:83]
    ds_read_b64_tr_b16 v[36:37], v4 offset:49152
    v_mfma_f32_16x16x32_bf16 v[84:87], v[40:43], v[180:183], v[84:87]
    ds_read_b64_tr_b16 v[38:39], v4 offset:50176
    v_mfma_f32_16x16x32_bf16 v[88:91], v[44:47], v[176:179], v[88:91]
    ds_read_b64_tr_b16 v[40:41], v5 offset:49152
    v_mfma_f32_16x16x32_bf16 v[92:95], v[44:47], v[180:183], v[92:95]
    ds_read_b64_tr_b16 v[42:43], v5 offset:50176
    s_waitcnt lgkmcnt(10)
    v_mfma_f32_16x16x32_bf16 v[96:99], v[176:179], v[48:51], v[96:99]
    buffer_load_dwordx4 v[244:247], v2, s[4:7], s42 offen offset:256 sc1
    ds_read_b64_tr_b16 v[44:45], v6 offset:49152
    v_mfma_f32_16x16x32_bf16 v[100:103], v[180:183], v[48:51], v[100:103]
    ds_read_b64_tr_b16 v[46:47], v6 offset:50176
    v_mfma_f32_16x16x32_bf16 v[104:107], v[176:179], v[52:55], v[104:107]
    buffer_load_dwordx4 v[248:251], v2, s[4:7], s42 offen offset:2048 sc1
    ds_read_b64_tr_b16 v[48:49], v3 offset:53248
    v_mfma_f32_16x16x32_bf16 v[108:111], v[180:183], v[52:55], v[108:111]
    ds_read_b64_tr_b16 v[50:51], v3 offset:54272
    s_waitcnt lgkmcnt(10)
    v_mfma_f32_16x16x32_bf16 v[112:115], v[176:179], v[56:59], v[112:115]
    buffer_load_dwordx4 v[252:255], v2, s[4:7], s42 offen offset:2304 sc1
    ds_read_b64_tr_b16 v[52:53], v4 offset:53248
    s_add_u32 s42, s41, s96
    v_mfma_f32_16x16x32_bf16 v[116:119], v[180:183], v[56:59], v[116:119]
    ds_read_b64_tr_b16 v[54:55], v4 offset:54272
    v_mfma_f32_16x16x32_bf16 v[120:123], v[176:179], v[60:63], v[120:123]
    buffer_load_dwordx4 v[160:163], v2, s[4:7], s42 offen offset:0 sc1
    ds_read_b64_tr_b16 v[56:57], v5 offset:53248
    v_mfma_f32_16x16x32_bf16 v[124:127], v[180:183], v[60:63], v[124:127]
    ds_read_b64_tr_b16 v[58:59], v5 offset:54272
    s_waitcnt lgkmcnt(10)
    v_mfma_f32_16x16x32_bf16 v[128:131], v[32:35], v[176:179], v[128:131]
    ds_read_b64_tr_b16 v[60:61], v6 offset:53248
    buffer_load_dwordx4 v[164:167], v2, s[4:7], s42 offen offset:256 sc1
    v_mfma_f32_16x16x32_bf16 v[132:135], v[32:35], v[180:183], v[132:135]
    ds_read_b64_tr_b16 v[62:63], v6 offset:54272
    v_mfma_f32_16x16x32_bf16 v[136:139], v[36:39], v[176:179], v[136:139]
    buffer_load_dwordx4 v[168:171], v2, s[4:7], s42 offen offset:2048 sc1
    ds_read_b64_tr_b16 v[32:33], v3 offset:57344
    v_mfma_f32_16x16x32_bf16 v[140:143], v[36:39], v[180:183], v[140:143]
    ds_read_b64_tr_b16 v[34:35], v3 offset:58368
    s_waitcnt lgkmcnt(10)
    v_mfma_f32_16x16x32_bf16 v[144:147], v[40:43], v[176:179], v[144:147]
    ds_read_b64_tr_b16 v[36:37], v4 offset:57344
    v_mfma_f32_16x16x32_bf16 v[148:151], v[40:43], v[180:183], v[148:151]
    ds_read_b64_tr_b16 v[38:39], v4 offset:58368
    v_mfma_f32_16x16x32_bf16 v[152:155], v[44:47], v[176:179], v[152:155]
    ds_read_b64_tr_b16 v[40:41], v5 offset:57344
    v_mfma_f32_16x16x32_bf16 v[156:159], v[44:47], v[180:183], v[156:159]
    ds_read_b64_tr_b16 v[42:43], v5 offset:58368
    s_waitcnt vmcnt(19) lgkmcnt(10)
    v_mfma_f32_16x16x32_bf16 v[64:67], v[48:51], v[184:187], v[64:67]
    ds_read_b64_tr_b16 v[44:45], v6 offset:57344
    v_mfma_f32_16x16x32_bf16 v[68:71], v[48:51], v[188:191], v[68:71]
    ds_read_b64_tr_b16 v[46:47], v6 offset:58368
    v_mfma_f32_16x16x32_bf16 v[72:75], v[52:55], v[184:187], v[72:75]
    ds_read_b64_tr_b16 v[48:49], v3 offset:61440
    v_mfma_f32_16x16x32_bf16 v[76:79], v[52:55], v[188:191], v[76:79]
    ds_read_b64_tr_b16 v[50:51], v3 offset:62464
    s_waitcnt lgkmcnt(10)
    v_mfma_f32_16x16x32_bf16 v[80:83], v[56:59], v[184:187], v[80:83]
    buffer_load_dwordx4 v[172:175], v2, s[4:7], s42 offen offset:2304 sc1
    ds_read_b64_tr_b16 v[52:53], v4 offset:61440
    s_add_u32 s42, s41, s97
    v_mfma_f32_16x16x32_bf16 v[84:87], v[56:59], v[188:191], v[84:87]
    ds_read_b64_tr_b16 v[54:55], v4 offset:62464
    v_mfma_f32_16x16x32_bf16 v[88:91], v[60:63], v[184:187], v[88:91]
    ds_read_b64_tr_b16 v[56:57], v5 offset:61440
    v_mfma_f32_16x16x32_bf16 v[92:95], v[60:63], v[188:191], v[92:95]
    ds_read_b64_tr_b16 v[58:59], v5 offset:62464
    s_waitcnt lgkmcnt(10)
    v_mfma_f32_16x16x32_bf16 v[96:99], v[184:187], v[32:35], v[96:99]
    ds_read_b64_tr_b16 v[60:61], v6 offset:61440
    v_mfma_f32_16x16x32_bf16 v[100:103], v[188:191], v[32:35], v[100:103]
    ds_read_b64_tr_b16 v[62:63], v6 offset:62464
    s_barrier
    v_xor_b32 v3, 0x10000, v3
    v_xor_b32 v4, 0x10000, v4
    v_xor_b32 v5, 0x10000, v5
    v_xor_b32 v6, 0x10000, v6
    v_mfma_f32_16x16x32_bf16 v[104:107], v[184:187], v[36:39], v[104:107]
    ds_read_b64_tr_b16 v[32:33], v3 offset:0
    v_mfma_f32_16x16x32_bf16 v[108:111], v[188:191], v[36:39], v[108:111]
    ds_read_b64_tr_b16 v[34:35], v3 offset:1024
    s_waitcnt lgkmcnt(10)
    v_mfma_f32_16x16x32_bf16 v[112:115], v[184:187], v[40:43], v[112:115]
    ds_read_b64_tr_b16 v[36:37], v4 offset:0
    v_mfma_f32_16x16x32_bf16 v[116:119], v[188:191], v[40:43], v[116:119]
    ds_read_b64_tr_b16 v[38:39], v4 offset:1024
    v_mfma_f32_16x16x32_bf16 v[120:123], v[184:187], v[44:47], v[120:123]
    ds_read_b64_tr_b16 v[40:41], v5 offset:0
    v_mfma_f32_16x16x32_bf16 v[124:127], v[188:191], v[44:47], v[124:127]
    ds_read_b64_tr_b16 v[42:43], v5 offset:1024
    s_waitcnt lgkmcnt(10)
    v_mfma_f32_16x16x32_bf16 v[128:131], v[48:51], v[184:187], v[128:131]
    ds_read_b64_tr_b16 v[44:45], v6 offset:0
    v_mfma_f32_16x16x32_bf16 v[132:135], v[48:51], v[188:191], v[132:135]
    ds_read_b64_tr_b16 v[46:47], v6 offset:1024
    v_mfma_f32_16x16x32_bf16 v[136:139], v[52:55], v[184:187], v[136:139]
    ds_read_b64_tr_b16 v[48:49], v3 offset:4096
    v_mfma_f32_16x16x32_bf16 v[140:143], v[52:55], v[188:191], v[140:143]
    ds_read_b64_tr_b16 v[50:51], v3 offset:5120
    s_waitcnt lgkmcnt(10)
    v_mfma_f32_16x16x32_bf16 v[144:147], v[56:59], v[184:187], v[144:147]
    ds_read_b64_tr_b16 v[52:53], v4 offset:4096
    v_mfma_f32_16x16x32_bf16 v[148:151], v[56:59], v[188:191], v[148:151]
    ds_read_b64_tr_b16 v[54:55], v4 offset:5120
    v_mfma_f32_16x16x32_bf16 v[152:155], v[60:63], v[184:187], v[152:155]
    ds_read_b64_tr_b16 v[56:57], v5 offset:4096
    v_mfma_f32_16x16x32_bf16 v[156:159], v[60:63], v[188:191], v[156:159]
    ds_read_b64_tr_b16 v[58:59], v5 offset:5120
    s_waitcnt vmcnt(18) lgkmcnt(10)
    v_mfma_f32_16x16x32_bf16 v[64:67], v[32:35], v[192:195], v[64:67]
    ds_read_b64_tr_b16 v[60:61], v6 offset:4096
    v_mfma_f32_16x16x32_bf16 v[68:71], v[32:35], v[196:199], v[68:71]
    ds_read_b64_tr_b16 v[62:63], v6 offset:5120
    v_mfma_f32_16x16x32_bf16 v[72:75], v[36:39], v[192:195], v[72:75]
    ds_read_b64_tr_b16 v[32:33], v3 offset:8192
    v_mfma_f32_16x16x32_bf16 v[76:79], v[36:39], v[196:199], v[76:79]
    ds_read_b64_tr_b16 v[34:35], v3 offset:9216
    s_waitcnt lgkmcnt(10)
    v_mfma_f32_16x16x32_bf16 v[80:83], v[40:43], v[192:195], v[80:83]
    ds_read_b64_tr_b16 v[36:37], v4 offset:8192
    v_mfma_f32_16x16x32_bf16 v[84:87], v[40:43], v[196:199], v[84:87]
    ds_read_b64_tr_b16 v[38:39], v4 offset:9216
    v_mfma_f32_16x16x32_bf16 v[88:91], v[44:47], v[192:195], v[88:91]
    ds_read_b64_tr_b16 v[40:41], v5 offset:8192
    v_mfma_f32_16x16x32_bf16 v[92:95], v[44:47], v[196:199], v[92:95]
    ds_read_b64_tr_b16 v[42:43], v5 offset:9216
    s_waitcnt lgkmcnt(10)
    v_mfma_f32_16x16x32_bf16 v[96:99], v[192:195], v[48:51], v[96:99]
    ds_read_b64_tr_b16 v[44:45], v6 offset:8192
    v_mfma_f32_16x16x32_bf16 v[100:103], v[196:199], v[48:51], v[100:103]
    ds_read_b64_tr_b16 v[46:47], v6 offset:9216
    v_mfma_f32_16x16x32_bf16 v[104:107], v[192:195], v[52:55], v[104:107]
    ds_read_b64_tr_b16 v[48:49], v3 offset:12288
    v_mfma_f32_16x16x32_bf16 v[108:111], v[196:199], v[52:55], v[108:111]
    ds_read_b64_tr_b16 v[50:51], v3 offset:13312
    s_waitcnt lgkmcnt(10)
    v_mfma_f32_16x16x32_bf16 v[112:115], v[192:195], v[56:59], v[112:115]
    ds_read_b64_tr_b16 v[52:53], v4 offset:12288
    v_mfma_f32_16x16x32_bf16 v[116:119], v[196:199], v[56:59], v[116:119]
    ds_read_b64_tr_b16 v[54:55], v4 offset:13312
    v_mfma_f32_16x16x32_bf16 v[120:123], v[192:195], v[60:63], v[120:123]
    ds_read_b64_tr_b16 v[56:57], v5 offset:12288
    v_mfma_f32_16x16x32_bf16 v[124:127], v[196:199], v[60:63], v[124:127]
    ds_read_b64_tr_b16 v[58:59], v5 offset:13312
    s_waitcnt lgkmcnt(10)
    v_mfma_f32_16x16x32_bf16 v[128:131], v[32:35], v[192:195], v[128:131]
    ds_read_b64_tr_b16 v[60:61], v6 offset:12288
    v_mfma_f32_16x16x32_bf16 v[132:135], v[32:35], v[196:199], v[132:135]
    ds_read_b64_tr_b16 v[62:63], v6 offset:13312
    v_mfma_f32_16x16x32_bf16 v[136:139], v[36:39], v[192:195], v[136:139]
    ds_read_b64_tr_b16 v[32:33], v3 offset:16384
    v_mfma_f32_16x16x32_bf16 v[140:143], v[36:39], v[196:199], v[140:143]
    ds_read_b64_tr_b16 v[34:35], v3 offset:17408
    s_waitcnt lgkmcnt(10)
    v_mfma_f32_16x16x32_bf16 v[144:147], v[40:43], v[192:195], v[144:147]
    ds_read_b64_tr_b16 v[36:37], v4 offset:16384
    v_mfma_f32_16x16x32_bf16 v[148:151], v[40:43], v[196:199], v[148:151]
    ds_read_b64_tr_b16 v[38:39], v4 offset:17408
    v_mfma_f32_16x16x32_bf16 v[152:155], v[44:47], v[192:195], v[152:155]
    ds_read_b64_tr_b16 v[40:41], v5 offset:16384
    v_mfma_f32_16x16x32_bf16 v[156:159], v[44:47], v[196:199], v[156:159]
    ds_read_b64_tr_b16 v[42:43], v5 offset:17408
    s_waitcnt vmcnt(16) lgkmcnt(10)
    v_mfma_f32_16x16x32_bf16 v[64:67], v[48:51], v[200:203], v[64:67]
    buffer_load_dwordx4 v[176:179], v2, s[4:7], s42 offen offset:0 sc1
    ds_read_b64_tr_b16 v[44:45], v6 offset:16384
    v_mfma_f32_16x16x32_bf16 v[68:71], v[48:51], v[204:207], v[68:71]
    ds_read_b64_tr_b16 v[46:47], v6 offset:17408
    v_mfma_f32_16x16x32_bf16 v[72:75], v[52:55], v[200:203], v[72:75]
    buffer_load_dwordx4 v[180:183], v2, s[4:7], s42 offen offset:256 sc1
    ds_read_b64_tr_b16 v[48:49], v3 offset:20480
    v_mfma_f32_16x16x32_bf16 v[76:79], v[52:55], v[204:207], v[76:79]
    ds_read_b64_tr_b16 v[50:51], v3 offset:21504
    s_waitcnt lgkmcnt(10)
    v_mfma_f32_16x16x32_bf16 v[80:83], v[56:59], v[200:203], v[80:83]
    buffer_load_dwordx4 v[184:187], v2, s[4:7], s42 offen offset:2048 sc1
    ds_read_b64_tr_b16 v[52:53], v4 offset:20480
    v_mfma_f32_16x16x32_bf16 v[84:87], v[56:59], v[204:207], v[84:87]
    ds_read_b64_tr_b16 v[54:55], v4 offset:21504
    v_mfma_f32_16x16x32_bf16 v[88:91], v[60:63], v[200:203], v[88:91]
    buffer_load_dwordx4 v[188:191], v2, s[4:7], s42 offen offset:2304 sc1
    ds_read_b64_tr_b16 v[56:57], v5 offset:20480
    s_add_u32 s42, s41, s98
    v_mfma_f32_16x16x32_bf16 v[92:95], v[60:63], v[204:207], v[92:95]
    ds_read_b64_tr_b16 v[58:59], v5 offset:21504
    s_waitcnt lgkmcnt(10)
    v_mfma_f32_16x16x32_bf16 v[96:99], v[200:203], v[32:35], v[96:99]
    ds_read_b64_tr_b16 v[60:61], v6 offset:20480
    buffer_load_dwordx4 v[192:195], v2, s[4:7], s42 offen offset:0 sc1
    v_mfma_f32_16x16x32_bf16 v[100:103], v[204:207], v[32:35], v[100:103]
    ds_read_b64_tr_b16 v[62:63], v6 offset:21504
    v_mfma_f32_16x16x32_bf16 v[104:107], v[200:203], v[36:39], v[104:107]
    ds_read_b64_tr_b16 v[32:33], v3 offset:24576
    v_mfma_f32_16x16x32_bf16 v[108:111], v[204:207], v[36:39], v[108:111]
    ds_read_b64_tr_b16 v[34:35], v3 offset:25600
    s_waitcnt lgkmcnt(10)
    v_mfma_f32_16x16x32_bf16 v[112:115], v[200:203], v[40:43], v[112:115]
    ds_read_b64_tr_b16 v[36:37], v4 offset:24576
    v_mfma_f32_16x16x32_bf16 v[116:119], v[204:207], v[40:43], v[116:119]
    ds_read_b64_tr_b16 v[38:39], v4 offset:25600
    v_mfma_f32_16x16x32_bf16 v[120:123], v[200:203], v[44:47], v[120:123]
    buffer_load_dwordx4 v[196:199], v2, s[4:7], s42 offen offset:256 sc1
    ds_read_b64_tr_b16 v[40:41], v5 offset:24576
    v_mfma_f32_16x16x32_bf16 v[124:127], v[204:207], v[44:47], v[124:127]
    ds_read_b64_tr_b16 v[42:43], v5 offset:25600
    s_waitcnt lgkmcnt(10)
    v_mfma_f32_16x16x32_bf16 v[128:131], v[48:51], v[200:203], v[128:131]
    ds_read_b64_tr_b16 v[44:45], v6 offset:24576
    v_mfma_f32_16x16x32_bf16 v[132:135], v[48:51], v[204:207], v[132:135]
    ds_read_b64_tr_b16 v[46:47], v6 offset:25600
    v_mfma_f32_16x16x32_bf16 v[136:139], v[52:55], v[200:203], v[136:139]
    ds_read_b64_tr_b16 v[48:49], v3 offset:28672
    v_mfma_f32_16x16x32_bf16 v[140:143], v[52:55], v[204:207], v[140:143]
    ds_read_b64_tr_b16 v[50:51], v3 offset:29696
    s_waitcnt lgkmcnt(10)
    v_mfma_f32_16x16x32_bf16 v[144:147], v[56:59], v[200:203], v[144:147]
    ds_read_b64_tr_b16 v[52:53], v4 offset:28672
    v_mfma_f32_16x16x32_bf16 v[148:151], v[56:59], v[204:207], v[148:151]
    ds_read_b64_tr_b16 v[54:55], v4 offset:29696
    v_mfma_f32_16x16x32_bf16 v[152:155], v[60:63], v[200:203], v[152:155]
    ds_read_b64_tr_b16 v[56:57], v5 offset:28672
    v_mfma_f32_16x16x32_bf16 v[156:159], v[60:63], v[204:207], v[156:159]
    ds_read_b64_tr_b16 v[58:59], v5 offset:29696
    s_waitcnt vmcnt(20) lgkmcnt(10)
    v_mfma_f32_16x16x32_bf16 v[64:67], v[32:35], v[208:211], v[64:67]
    ds_read_b64_tr_b16 v[60:61], v6 offset:28672
    v_mfma_f32_16x16x32_bf16 v[68:71], v[32:35], v[212:215], v[68:71]
    ds_read_b64_tr_b16 v[62:63], v6 offset:29696
    s_barrier
    v_mfma_f32_16x16x32_bf16 v[72:75], v[36:39], v[208:211], v[72:75]
    ds_read_b64_tr_b16 v[32:33], v3 offset:32768
    v_mfma_f32_16x16x32_bf16 v[76:79], v[36:39], v[212:215], v[76:79]
    ds_read_b64_tr_b16 v[34:35], v3 offset:33792
    s_waitcnt lgkmcnt(10)
    v_mfma_f32_16x16x32_bf16 v[80:83], v[40:43], v[208:211], v[80:83]
    ds_read_b64_tr_b16 v[36:37], v4 offset:32768
    v_mfma_f32_16x16x32_bf16 v[84:87], v[40:43], v[212:215], v[84:87]
    ds_read_b64_tr_b16 v[38:39], v4 offset:33792
    v_mfma_f32_16x16x32_bf16 v[88:91], v[44:47], v[208:211], v[88:91]
    ds_read_b64_tr_b16 v[40:41], v5 offset:32768
    v_mfma_f32_16x16x32_bf16 v[92:95], v[44:47], v[212:215], v[92:95]
    ds_read_b64_tr_b16 v[42:43], v5 offset:33792
    s_waitcnt lgkmcnt(10)
    v_mfma_f32_16x16x32_bf16 v[96:99], v[208:211], v[48:51], v[96:99]
    ds_read_b64_tr_b16 v[44:45], v6 offset:32768
    v_mfma_f32_16x16x32_bf16 v[100:103], v[212:215], v[48:51], v[100:103]
    ds_read_b64_tr_b16 v[46:47], v6 offset:33792
    v_mfma_f32_16x16x32_bf16 v[104:107], v[208:211], v[52:55], v[104:107]
    ds_read_b64_tr_b16 v[48:49], v3 offset:36864
    v_mfma_f32_16x16x32_bf16 v[108:111], v[212:215], v[52:55], v[108:111]
    ds_read_b64_tr_b16 v[50:51], v3 offset:37888
    s_waitcnt lgkmcnt(10)
    v_mfma_f32_16x16x32_bf16 v[112:115], v[208:211], v[56:59], v[112:115]
    ds_read_b64_tr_b16 v[52:53], v4 offset:36864
    v_mfma_f32_16x16x32_bf16 v[116:119], v[212:215], v[56:59], v[116:119]
    ds_read_b64_tr_b16 v[54:55], v4 offset:37888
    v_mfma_f32_16x16x32_bf16 v[120:123], v[208:211], v[60:63], v[120:123]
    ds_read_b64_tr_b16 v[56:57], v5 offset:36864
    v_mfma_f32_16x16x32_bf16 v[124:127], v[212:215], v[60:63], v[124:127]
    ds_read_b64_tr_b16 v[58:59], v5 offset:37888
    s_waitcnt lgkmcnt(10)
    v_mfma_f32_16x16x32_bf16 v[128:131], v[32:35], v[208:211], v[128:131]
    ds_read_b64_tr_b16 v[60:61], v6 offset:36864
    v_mfma_f32_16x16x32_bf16 v[132:135], v[32:35], v[212:215], v[132:135]
    ds_read_b64_tr_b16 v[62:63], v6 offset:37888
    v_mfma_f32_16x16x32_bf16 v[136:139], v[36:39], v[208:211], v[136:139]
    ds_read_b64_tr_b16 v[32:33], v3 offset:40960
    v_mfma_f32_16x16x32_bf16 v[140:143], v[36:39], v[212:215], v[140:143]
    ds_read_b64_tr_b16 v[34:35], v3 offset:41984
    s_waitcnt lgkmcnt(10)
    v_mfma_f32_16x16x32_bf16 v[144:147], v[40:43], v[208:211], v[144:147]
    ds_read_b64_tr_b16 v[36:37], v4 offset:40960
    v_mfma_f32_16x16x32_bf16 v[148:151], v[40:43], v[212:215], v[148:151]
    ds_read_b64_tr_b16 v[38:39], v4 offset:41984
    v_mfma_f32_16x16x32_bf16 v[152:155], v[44:47], v[208:211], v[152:155]
    ds_read_b64_tr_b16 v[40:41], v5 offset:40960
    v_mfma_f32_16x16x32_bf16 v[156:159], v[44:47], v[212:215], v[156:159]
    ds_read_b64_tr_b16 v[42:43], v5 offset:41984
    s_waitcnt vmcnt(18) lgkmcnt(10)
    v_mfma_f32_16x16x32_bf16 v[64:67], v[48:51], v[216:219], v[64:67]
    ds_read_b64_tr_b16 v[44:45], v6 offset:40960
    v_mfma_f32_16x16x32_bf16 v[68:71], v[48:51], v[220:223], v[68:71]
    ds_read_b64_tr_b16 v[46:47], v6 offset:41984
    v_mfma_f32_16x16x32_bf16 v[72:75], v[52:55], v[216:219], v[72:75]
    ds_read_b64_tr_b16 v[48:49], v3 offset:45056
    v_mfma_f32_16x16x32_bf16 v[76:79], v[52:55], v[220:223], v[76:79]
    ds_read_b64_tr_b16 v[50:51], v3 offset:46080
    s_waitcnt lgkmcnt(10)
    v_mfma_f32_16x16x32_bf16 v[80:83], v[56:59], v[216:219], v[80:83]
    ds_read_b64_tr_b16 v[52:53], v4 offset:45056
    v_mfma_f32_16x16x32_bf16 v[84:87], v[56:59], v[220:223], v[84:87]
    ds_read_b64_tr_b16 v[54:55], v4 offset:46080
    v_mfma_f32_16x16x32_bf16 v[88:91], v[60:63], v[216:219], v[88:91]
    ds_read_b64_tr_b16 v[56:57], v5 offset:45056
    v_mfma_f32_16x16x32_bf16 v[92:95], v[60:63], v[220:223], v[92:95]
    ds_read_b64_tr_b16 v[58:59], v5 offset:46080
    s_waitcnt lgkmcnt(10)
    v_mfma_f32_16x16x32_bf16 v[96:99], v[216:219], v[32:35], v[96:99]
    ds_read_b64_tr_b16 v[60:61], v6 offset:45056
    v_mfma_f32_16x16x32_bf16 v[100:103], v[220:223], v[32:35], v[100:103]
    ds_read_b64_tr_b16 v[62:63], v6 offset:46080
    v_mfma_f32_16x16x32_bf16 v[104:107], v[216:219], v[36:39], v[104:107]
    ds_read_b64_tr_b16 v[32:33], v3 offset:49152
    v_mfma_f32_16x16x32_bf16 v[108:111], v[220:223], v[36:39], v[108:111]
    ds_read_b64_tr_b16 v[34:35], v3 offset:50176
    s_waitcnt lgkmcnt(10)
    v_mfma_f32_16x16x32_bf16 v[112:115], v[216:219], v[40:43], v[112:115]
    ds_read_b64_tr_b16 v[36:37], v4 offset:49152
    v_mfma_f32_16x16x32_bf16 v[116:119], v[220:223], v[40:43], v[116:119]
    ds_read_b64_tr_b16 v[38:39], v4 offset:50176
    v_mfma_f32_16x16x32_bf16 v[120:123], v[216:219], v[44:47], v[120:123]
    ds_read_b64_tr_b16 v[40:41], v5 offset:49152
    v_mfma_f32_16x16x32_bf16 v[124:127], v[220:223], v[44:47], v[124:127]
    ds_read_b64_tr_b16 v[42:43], v5 offset:50176
    s_waitcnt lgkmcnt(10)
    v_mfma_f32_16x16x32_bf16 v[128:131], v[48:51], v[216:219], v[128:131]
    buffer_load_dwordx4 v[200:203], v2, s[4:7], s42 offen offset:2048 sc1
    ds_read_b64_tr_b16 v[44:45], v6 offset:49152
    v_mfma_f32_16x16x32_bf16 v[132:135], v[48:51], v[220:223], v[132:135]
    ds_read_b64_tr_b16 v[46:47], v6 offset:50176
    v_mfma_f32_16x16x32_bf16 v[136:139], v[52:55], v[216:219], v[136:139]
    buffer_load_dwordx4 v[204:207], v2, s[4:7], s42 offen offset:2304 sc1
    ds_read_b64_tr_b16 v[48:49], v3 offset:53248
    s_add_u32 s42, s41, s99
    v_mfma_f32_16x16x32_bf16 v[140:143], v[52:55], v[220:223], v[140:143]
    ds_read_b64_tr_b16 v[50:51], v3 offset:54272
    s_waitcnt lgkmcnt(10)
    v_mfma_f32_16x16x32_bf16 v[144:147], v[56:59], v[216:219], v[144:147]
    buffer_load_dwordx4 v[208:211], v2, s[4:7], s42 offen offset:0 sc1
    ds_read_b64_tr_b16 v[52:53], v4 offset:53248
    v_mfma_f32_16x16x32_bf16 v[148:151], v[56:59], v[220:223], v[148:151]
    ds_read_b64_tr_b16 v[54:55], v4 offset:54272
    v_mfma_f32_16x16x32_bf16 v[152:155], v[60:63], v[216:219], v[152:155]
    buffer_load_dwordx4 v[212:215], v2, s[4:7], s42 offen offset:256 sc1
    ds_read_b64_tr_b16 v[56:57], v5 offset:53248
    v_mfma_f32_16x16x32_bf16 v[156:159], v[60:63], v[220:223], v[156:159]
    ds_read_b64_tr_b16 v[58:59], v5 offset:54272
    s_waitcnt vmcnt(20) lgkmcnt(10)
    v_mfma_f32_16x16x32_bf16 v[64:67], v[32:35], v[224:227], v[64:67]
    ds_read_b64_tr_b16 v[60:61], v6 offset:53248
    buffer_load_dwordx4 v[216:219], v2, s[4:7], s42 offen offset:2048 sc1
    v_mfma_f32_16x16x32_bf16 v[68:71], v[32:35], v[228:231], v[68:71]
    ds_read_b64_tr_b16 v[62:63], v6 offset:54272
    v_mfma_f32_16x16x32_bf16 v[72:75], v[36:39], v[224:227], v[72:75]
    buffer_load_dwordx4 v[220:223], v2, s[4:7], s42 offen offset:2304 sc1
    ds_read_b64_tr_b16 v[32:33], v3 offset:57344
    v_mfma_f32_16x16x32_bf16 v[76:79], v[36:39], v[228:231], v[76:79]
    ds_read_b64_tr_b16 v[34:35], v3 offset:58368
    s_waitcnt lgkmcnt(10)
    v_mfma_f32_16x16x32_bf16 v[80:83], v[40:43], v[224:227], v[80:83]
    ds_read_b64_tr_b16 v[36:37], v4 offset:57344
    v_mfma_f32_16x16x32_bf16 v[84:87], v[40:43], v[228:231], v[84:87]
    ds_read_b64_tr_b16 v[38:39], v4 offset:58368
    v_mfma_f32_16x16x32_bf16 v[88:91], v[44:47], v[224:227], v[88:91]
    ds_read_b64_tr_b16 v[40:41], v5 offset:57344
    v_mfma_f32_16x16x32_bf16 v[92:95], v[44:47], v[228:231], v[92:95]
    ds_read_b64_tr_b16 v[42:43], v5 offset:58368
    s_waitcnt lgkmcnt(10)
    v_mfma_f32_16x16x32_bf16 v[96:99], v[224:227], v[48:51], v[96:99]
    ds_read_b64_tr_b16 v[44:45], v6 offset:57344
    v_mfma_f32_16x16x32_bf16 v[100:103], v[228:231], v[48:51], v[100:103]
    ds_read_b64_tr_b16 v[46:47], v6 offset:58368
    v_mfma_f32_16x16x32_bf16 v[104:107], v[224:227], v[52:55], v[104:107]
    ds_read_b64_tr_b16 v[48:49], v3 offset:61440
    v_mfma_f32_16x16x32_bf16 v[108:111], v[228:231], v[52:55], v[108:111]
    ds_read_b64_tr_b16 v[50:51], v3 offset:62464
    s_waitcnt lgkmcnt(10)
    v_mfma_f32_16x16x32_bf16 v[112:115], v[224:227], v[56:59], v[112:115]
    ds_read_b64_tr_b16 v[52:53], v4 offset:61440
    v_mfma_f32_16x16x32_bf16 v[116:119], v[228:231], v[56:59], v[116:119]
    ds_read_b64_tr_b16 v[54:55], v4 offset:62464
    v_mfma_f32_16x16x32_bf16 v[120:123], v[224:227], v[60:63], v[120:123]
    ds_read_b64_tr_b16 v[56:57], v5 offset:61440
    v_mfma_f32_16x16x32_bf16 v[124:127], v[228:231], v[60:63], v[124:127]
    ds_read_b64_tr_b16 v[58:59], v5 offset:62464
    s_waitcnt vmcnt(20) lgkmcnt(10)
    v_mfma_f32_16x16x32_bf16 v[64:67], v[32:35], v[232:235], v[64:67]
    ds_read_b64_tr_b16 v[60:61], v6 offset:61440
    v_mfma_f32_16x16x32_bf16 v[68:71], v[32:35], v[236:239], v[68:71]
    ds_read_b64_tr_b16 v[62:63], v6 offset:62464
    s_barrier
    v_xor_b32 v3, 0x10000, v3
    v_xor_b32 v4, 0x10000, v4
    v_xor_b32 v5, 0x10000, v5
    v_xor_b32 v6, 0x10000, v6
    v_mfma_f32_16x16x32_bf16 v[72:75], v[36:39], v[232:235], v[72:75]
    ds_read_b64_tr_b16 v[32:33], v3 offset:0
    v_mfma_f32_16x16x32_bf16 v[76:79], v[36:39], v[236:239], v[76:79]
    ds_read_b64_tr_b16 v[34:35], v3 offset:1024
    s_waitcnt lgkmcnt(10)
    v_mfma_f32_16x16x32_bf16 v[80:83], v[40:43], v[232:235], v[80:83]
    ds_read_b64_tr_b16 v[36:37], v4 offset:0
    v_mfma_f32_16x16x32_bf16 v[84:87], v[40:43], v[236:239], v[84:87]
    ds_read_b64_tr_b16 v[38:39], v4 offset:1024
    v_mfma_f32_16x16x32_bf16 v[88:91], v[44:47], v[232:235], v[88:91]
    ds_read_b64_tr_b16 v[40:41], v5 offset:0
    v_mfma_f32_16x16x32_bf16 v[92:95], v[44:47], v[236:239], v[92:95]
    ds_read_b64_tr_b16 v[42:43], v5 offset:1024
    s_waitcnt lgkmcnt(10)
    v_mfma_f32_16x16x32_bf16 v[96:99], v[232:235], v[48:51], v[96:99]
    ds_read_b64_tr_b16 v[44:45], v6 offset:0
    v_mfma_f32_16x16x32_bf16 v[100:103], v[236:239], v[48:51], v[100:103]
    ds_read_b64_tr_b16 v[46:47], v6 offset:1024
    v_mfma_f32_16x16x32_bf16 v[104:107], v[232:235], v[52:55], v[104:107]
    ds_read_b64_tr_b16 v[48:49], v3 offset:4096
    v_mfma_f32_16x16x32_bf16 v[108:111], v[236:239], v[52:55], v[108:111]
    ds_read_b64_tr_b16 v[50:51], v3 offset:5120
    s_waitcnt lgkmcnt(10)
    v_mfma_f32_16x16x32_bf16 v[112:115], v[232:235], v[56:59], v[112:115]
    ds_read_b64_tr_b16 v[52:53], v4 offset:4096
    v_mfma_f32_16x16x32_bf16 v[116:119], v[236:239], v[56:59], v[116:119]
    ds_read_b64_tr_b16 v[54:55], v4 offset:5120
    v_mfma_f32_16x16x32_bf16 v[120:123], v[232:235], v[60:63], v[120:123]
    ds_read_b64_tr_b16 v[56:57], v5 offset:4096
    v_mfma_f32_16x16x32_bf16 v[124:127], v[236:239], v[60:63], v[124:127]
    ds_read_b64_tr_b16 v[58:59], v5 offset:5120
    s_waitcnt vmcnt(18) lgkmcnt(10)
    v_mfma_f32_16x16x32_bf16 v[64:67], v[32:35], v[240:243], v[64:67]
    ds_read_b64_tr_b16 v[60:61], v6 offset:4096
    v_mfma_f32_16x16x32_bf16 v[68:71], v[32:35], v[244:247], v[68:71]
    ds_read_b64_tr_b16 v[62:63], v6 offset:5120
    v_mfma_f32_16x16x32_bf16 v[72:75], v[36:39], v[240:243], v[72:75]
    ds_read_b64_tr_b16 v[32:33], v3 offset:8192
    v_mfma_f32_16x16x32_bf16 v[76:79], v[36:39], v[244:247], v[76:79]
    ds_read_b64_tr_b16 v[34:35], v3 offset:9216
    s_waitcnt lgkmcnt(10)
    v_mfma_f32_16x16x32_bf16 v[80:83], v[40:43], v[240:243], v[80:83]
    ds_read_b64_tr_b16 v[36:37], v4 offset:8192
    v_mfma_f32_16x16x32_bf16 v[84:87], v[40:43], v[244:247], v[84:87]
    ds_read_b64_tr_b16 v[38:39], v4 offset:9216
    v_mfma_f32_16x16x32_bf16 v[88:91], v[44:47], v[240:243], v[88:91]
    ds_read_b64_tr_b16 v[40:41], v5 offset:8192
    v_mfma_f32_16x16x32_bf16 v[92:95], v[44:47], v[244:247], v[92:95]
    ds_read_b64_tr_b16 v[42:43], v5 offset:9216
    s_waitcnt lgkmcnt(10)
    v_mfma_f32_16x16x32_bf16 v[96:99], v[240:243], v[48:51], v[96:99]
    ds_read_b64_tr_b16 v[44:45], v6 offset:8192
    v_mfma_f32_16x16x32_bf16 v[100:103], v[244:247], v[48:51], v[100:103]
    ds_read_b64_tr_b16 v[46:47], v6 offset:9216
    v_mfma_f32_16x16x32_bf16 v[104:107], v[240:243], v[52:55], v[104:107]
    ds_read_b64_tr_b16 v[48:49], v3 offset:12288
    v_mfma_f32_16x16x32_bf16 v[108:111], v[244:247], v[52:55], v[108:111]
    ds_read_b64_tr_b16 v[50:51], v3 offset:13312
    s_waitcnt lgkmcnt(10)
    v_mfma_f32_16x16x32_bf16 v[112:115], v[240:243], v[56:59], v[112:115]
    ds_read_b64_tr_b16 v[52:53], v4 offset:12288
    v_mfma_f32_16x16x32_bf16 v[116:119], v[244:247], v[56:59], v[116:119]
    ds_read_b64_tr_b16 v[54:55], v4 offset:13312
    v_mfma_f32_16x16x32_bf16 v[120:123], v[240:243], v[60:63], v[120:123]
    ds_read_b64_tr_b16 v[56:57], v5 offset:12288
    v_mfma_f32_16x16x32_bf16 v[124:127], v[244:247], v[60:63], v[124:127]
    ds_read_b64_tr_b16 v[58:59], v5 offset:13312
    s_waitcnt vmcnt(16) lgkmcnt(10)
    v_mfma_f32_16x16x32_bf16 v[64:67], v[32:35], v[248:251], v[64:67]
    ds_read_b64_tr_b16 v[60:61], v6 offset:12288
    v_mfma_f32_16x16x32_bf16 v[68:71], v[32:35], v[252:255], v[68:71]
    ds_read_b64_tr_b16 v[62:63], v6 offset:13312
    v_mfma_f32_16x16x32_bf16 v[72:75], v[36:39], v[248:251], v[72:75]
    ds_read_b64_tr_b16 v[32:33], v3 offset:16384
    v_mfma_f32_16x16x32_bf16 v[76:79], v[36:39], v[252:255], v[76:79]
    ds_read_b64_tr_b16 v[34:35], v3 offset:17408
    s_waitcnt lgkmcnt(10)
    v_mfma_f32_16x16x32_bf16 v[80:83], v[40:43], v[248:251], v[80:83]
    ds_read_b64_tr_b16 v[36:37], v4 offset:16384
    v_mfma_f32_16x16x32_bf16 v[84:87], v[40:43], v[252:255], v[84:87]
    ds_read_b64_tr_b16 v[38:39], v4 offset:17408
    v_mfma_f32_16x16x32_bf16 v[88:91], v[44:47], v[248:251], v[88:91]
    ds_read_b64_tr_b16 v[40:41], v5 offset:16384
    v_mfma_f32_16x16x32_bf16 v[92:95], v[44:47], v[252:255], v[92:95]
    ds_read_b64_tr_b16 v[42:43], v5 offset:17408
    s_waitcnt lgkmcnt(10)
    v_mfma_f32_16x16x32_bf16 v[96:99], v[248:251], v[48:51], v[96:99]
    ds_read_b64_tr_b16 v[44:45], v6 offset:16384
    v_mfma_f32_16x16x32_bf16 v[100:103], v[252:255], v[48:51], v[100:103]
    ds_read_b64_tr_b16 v[46:47], v6 offset:17408
    v_mfma_f32_16x16x32_bf16 v[104:107], v[248:251], v[52:55], v[104:107]
    ds_read_b64_tr_b16 v[48:49], v3 offset:20480
    v_mfma_f32_16x16x32_bf16 v[108:111], v[252:255], v[52:55], v[108:111]
    ds_read_b64_tr_b16 v[50:51], v3 offset:21504
    s_waitcnt lgkmcnt(10)
    v_mfma_f32_16x16x32_bf16 v[112:115], v[248:251], v[56:59], v[112:115]
    ds_read_b64_tr_b16 v[52:53], v4 offset:20480
    v_mfma_f32_16x16x32_bf16 v[116:119], v[252:255], v[56:59], v[116:119]
    ds_read_b64_tr_b16 v[54:55], v4 offset:21504
    v_mfma_f32_16x16x32_bf16 v[120:123], v[248:251], v[60:63], v[120:123]
    ds_read_b64_tr_b16 v[56:57], v5 offset:20480
    v_mfma_f32_16x16x32_bf16 v[124:127], v[252:255], v[60:63], v[124:127]
    ds_read_b64_tr_b16 v[58:59], v5 offset:21504
    s_waitcnt vmcnt(14) lgkmcnt(10)
    v_mfma_f32_16x16x32_bf16 v[64:67], v[32:35], v[160:163], v[64:67]
    ds_read_b64_tr_b16 v[60:61], v6 offset:20480
    v_mfma_f32_16x16x32_bf16 v[68:71], v[32:35], v[164:167], v[68:71]
    ds_read_b64_tr_b16 v[62:63], v6 offset:21504
    v_mfma_f32_16x16x32_bf16 v[72:75], v[36:39], v[160:163], v[72:75]
    ds_read_b64_tr_b16 v[32:33], v3 offset:24576
    v_mfma_f32_16x16x32_bf16 v[76:79], v[36:39], v[164:167], v[76:79]
    ds_read_b64_tr_b16 v[34:35], v3 offset:25600
    s_waitcnt lgkmcnt(10)
    v_mfma_f32_16x16x32_bf16 v[80:83], v[40:43], v[160:163], v[80:83]
    ds_read_b64_tr_b16 v[36:37], v4 offset:24576
    v_mfma_f32_16x16x32_bf16 v[84:87], v[40:43], v[164:167], v[84:87]
    ds_read_b64_tr_b16 v[38:39], v4 offset:25600
    v_mfma_f32_16x16x32_bf16 v[88:91], v[44:47], v[160:163], v[88:91]
    ds_read_b64_tr_b16 v[40:41], v5 offset:24576
    v_mfma_f32_16x16x32_bf16 v[92:95], v[44:47], v[164:167], v[92:95]
    ds_read_b64_tr_b16 v[42:43], v5 offset:25600
    s_waitcnt vmcnt(12) lgkmcnt(10)
    v_mfma_f32_16x16x32_bf16 v[64:67], v[48:51], v[168:171], v[64:67]
    ds_read_b64_tr_b16 v[44:45], v6 offset:24576
    v_mfma_f32_16x16x32_bf16 v[68:71], v[48:51], v[172:175], v[68:71]
    ds_read_b64_tr_b16 v[46:47], v6 offset:25600
    v_mfma_f32_16x16x32_bf16 v[72:75], v[52:55], v[168:171], v[72:75]
    ds_read_b64_tr_b16 v[48:49], v3 offset:28672
    v_mfma_f32_16x16x32_bf16 v[76:79], v[52:55], v[172:175], v[76:79]
    ds_read_b64_tr_b16 v[50:51], v3 offset:29696
    s_waitcnt lgkmcnt(10)
    v_mfma_f32_16x16x32_bf16 v[80:83], v[56:59], v[168:171], v[80:83]
    ds_read_b64_tr_b16 v[52:53], v4 offset:28672
    v_mfma_f32_16x16x32_bf16 v[84:87], v[56:59], v[172:175], v[84:87]
    ds_read_b64_tr_b16 v[54:55], v4 offset:29696
    v_mfma_f32_16x16x32_bf16 v[88:91], v[60:63], v[168:171], v[88:91]
    ds_read_b64_tr_b16 v[56:57], v5 offset:28672
    v_mfma_f32_16x16x32_bf16 v[92:95], v[60:63], v[172:175], v[92:95]
    ds_read_b64_tr_b16 v[58:59], v5 offset:29696
    s_waitcnt vmcnt(10) lgkmcnt(10)
    v_mfma_f32_16x16x32_bf16 v[64:67], v[32:35], v[176:179], v[64:67]
    ds_read_b64_tr_b16 v[60:61], v6 offset:28672
    v_mfma_f32_16x16x32_bf16 v[68:71], v[32:35], v[180:183], v[68:71]
    ds_read_b64_tr_b16 v[62:63], v6 offset:29696
    s_barrier
    v_mfma_f32_16x16x32_bf16 v[72:75], v[36:39], v[176:179], v[72:75]
    ds_read_b64_tr_b16 v[32:33], v3 offset:32768
    v_mfma_f32_16x16x32_bf16 v[76:79], v[36:39], v[180:183], v[76:79]
    ds_read_b64_tr_b16 v[34:35], v3 offset:33792
    s_waitcnt lgkmcnt(10)
    v_mfma_f32_16x16x32_bf16 v[80:83], v[40:43], v[176:179], v[80:83]
    ds_read_b64_tr_b16 v[36:37], v4 offset:32768
    v_mfma_f32_16x16x32_bf16 v[84:87], v[40:43], v[180:183], v[84:87]
    ds_read_b64_tr_b16 v[38:39], v4 offset:33792
    v_mfma_f32_16x16x32_bf16 v[88:91], v[44:47], v[176:179], v[88:91]
    ds_read_b64_tr_b16 v[40:41], v5 offset:32768
    v_mfma_f32_16x16x32_bf16 v[92:95], v[44:47], v[180:183], v[92:95]
    ds_read_b64_tr_b16 v[42:43], v5 offset:33792
    s_waitcnt vmcnt(8) lgkmcnt(10)
    v_mfma_f32_16x16x32_bf16 v[64:67], v[48:51], v[184:187], v[64:67]
    ds_read_b64_tr_b16 v[44:45], v6 offset:32768
    v_mfma_f32_16x16x32_bf16 v[68:71], v[48:51], v[188:191], v[68:71]
    ds_read_b64_tr_b16 v[46:47], v6 offset:33792
    v_mfma_f32_16x16x32_bf16 v[72:75], v[52:55], v[184:187], v[72:75]
    ds_read_b64_tr_b16 v[48:49], v3 offset:36864
    v_mfma_f32_16x16x32_bf16 v[76:79], v[52:55], v[188:191], v[76:79]
    ds_read_b64_tr_b16 v[50:51], v3 offset:37888
    s_waitcnt lgkmcnt(10)
    v_mfma_f32_16x16x32_bf16 v[80:83], v[56:59], v[184:187], v[80:83]
    ds_read_b64_tr_b16 v[52:53], v4 offset:36864
    v_mfma_f32_16x16x32_bf16 v[84:87], v[56:59], v[188:191], v[84:87]
    ds_read_b64_tr_b16 v[54:55], v4 offset:37888
    v_mfma_f32_16x16x32_bf16 v[88:91], v[60:63], v[184:187], v[88:91]
    ds_read_b64_tr_b16 v[56:57], v5 offset:36864
    v_mfma_f32_16x16x32_bf16 v[92:95], v[60:63], v[188:191], v[92:95]
    ds_read_b64_tr_b16 v[58:59], v5 offset:37888
    s_waitcnt vmcnt(6) lgkmcnt(10)
    v_mfma_f32_16x16x32_bf16 v[64:67], v[32:35], v[192:195], v[64:67]
    ds_read_b64_tr_b16 v[60:61], v6 offset:36864
    v_mfma_f32_16x16x32_bf16 v[68:71], v[32:35], v[196:199], v[68:71]
    ds_read_b64_tr_b16 v[62:63], v6 offset:37888
    v_mfma_f32_16x16x32_bf16 v[72:75], v[36:39], v[192:195], v[72:75]
    ds_read_b64_tr_b16 v[32:33], v3 offset:40960
    v_mfma_f32_16x16x32_bf16 v[76:79], v[36:39], v[196:199], v[76:79]
    ds_read_b64_tr_b16 v[34:35], v3 offset:41984
    s_waitcnt lgkmcnt(10)
    v_mfma_f32_16x16x32_bf16 v[80:83], v[40:43], v[192:195], v[80:83]
    ds_read_b64_tr_b16 v[36:37], v4 offset:40960
    v_mfma_f32_16x16x32_bf16 v[84:87], v[40:43], v[196:199], v[84:87]
    ds_read_b64_tr_b16 v[38:39], v4 offset:41984
    v_mfma_f32_16x16x32_bf16 v[88:91], v[44:47], v[192:195], v[88:91]
    ds_read_b64_tr_b16 v[40:41], v5 offset:40960
    v_mfma_f32_16x16x32_bf16 v[92:95], v[44:47], v[196:199], v[92:95]
    ds_read_b64_tr_b16 v[42:43], v5 offset:41984
    s_waitcnt vmcnt(4) lgkmcnt(10)
    v_mfma_f32_16x16x32_bf16 v[64:67], v[48:51], v[200:203], v[64:67]
    ds_read_b64_tr_b16 v[44:45], v6 offset:40960
    v_mfma_f32_16x16x32_bf16 v[68:71], v[48:51], v[204:207], v[68:71]
    ds_read_b64_tr_b16 v[46:47], v6 offset:41984
    v_mfma_f32_16x16x32_bf16 v[72:75], v[52:55], v[200:203], v[72:75]
    ds_read_b64_tr_b16 v[48:49], v3 offset:45056
    v_mfma_f32_16x16x32_bf16 v[76:79], v[52:55], v[204:207], v[76:79]
    ds_read_b64_tr_b16 v[50:51], v3 offset:46080
    s_waitcnt lgkmcnt(10)
    v_mfma_f32_16x16x32_bf16 v[80:83], v[56:59], v[200:203], v[80:83]
    ds_read_b64_tr_b16 v[52:53], v4 offset:45056
    v_mfma_f32_16x16x32_bf16 v[84:87], v[56:59], v[204:207], v[84:87]
    ds_read_b64_tr_b16 v[54:55], v4 offset:46080
    v_mfma_f32_16x16x32_bf16 v[88:91], v[60:63], v[200:203], v[88:91]
    ds_read_b64_tr_b16 v[56:57], v5 offset:45056
    v_mfma_f32_16x16x32_bf16 v[92:95], v[60:63], v[204:207], v[92:95]
    ds_read_b64_tr_b16 v[58:59], v5 offset:46080
    s_waitcnt vmcnt(2) lgkmcnt(10)
    v_mfma_f32_16x16x32_bf16 v[64:67], v[32:35], v[208:211], v[64:67]
    ds_read_b64_tr_b16 v[60:61], v6 offset:45056
    v_mfma_f32_16x16x32_bf16 v[68:71], v[32:35], v[212:215], v[68:71]
    ds_read_b64_tr_b16 v[62:63], v6 offset:46080
    v_mfma_f32_16x16x32_bf16 v[72:75], v[36:39], v[208:211], v[72:75]
    ds_read_b64_tr_b16 v[32:33], v3 offset:49152
    ds_read_b32 v8, v9 offset:4096
    v_mfma_f32_16x16x32_bf16 v[76:79], v[36:39], v[212:215], v[76:79]
    ds_read_b64_tr_b16 v[34:35], v3 offset:50176
    ds_read_b32 v10, v9 offset:4608
    s_waitcnt lgkmcnt(12)
    v_mfma_f32_16x16x32_bf16 v[80:83], v[40:43], v[208:211], v[80:83]
    ds_read_b64_tr_b16 v[36:37], v4 offset:49152
    ds_read_b32 v12, v9 offset:4160
    v_mfma_f32_16x16x32_bf16 v[84:87], v[40:43], v[212:215], v[84:87]
    ds_read_b64_tr_b16 v[38:39], v4 offset:50176
    ds_read_b32 v14, v9 offset:4672
    v_mfma_f32_16x16x32_bf16 v[88:91], v[44:47], v[208:211], v[88:91]
    ds_read_b64_tr_b16 v[40:41], v5 offset:49152
    ds_read_b128 v[16:19], v11 offset:256
    v_mfma_f32_16x16x32_bf16 v[92:95], v[44:47], v[212:215], v[92:95]
    ds_read_b64_tr_b16 v[42:43], v5 offset:50176
    ds_read_b128 v[20:23], v11 offset:320
    s_waitcnt vmcnt(0) lgkmcnt(14)
    v_mfma_f32_16x16x32_bf16 v[64:67], v[48:51], v[216:219], v[64:67]
    ds_read_b64_tr_b16 v[44:45], v6 offset:49152
    ds_read_b128 v[24:27], v11 offset:384
    v_mfma_f32_16x16x32_bf16 v[68:71], v[48:51], v[220:223], v[68:71]
    ds_read_b64_tr_b16 v[46:47], v6 offset:50176
    ds_read_b128 v[28:31], v11 offset:448
    v_mfma_f32_16x16x32_bf16 v[72:75], v[52:55], v[216:219], v[72:75]
    ds_read_b64_tr_b16 v[48:49], v3 offset:53248
    v_mfma_f32_16x16x32_bf16 v[76:79], v[52:55], v[220:223], v[76:79]
    ds_read_b64_tr_b16 v[50:51], v3 offset:54272
    s_waitcnt lgkmcnt(14)
    v_mfma_f32_16x16x32_bf16 v[80:83], v[56:59], v[216:219], v[80:83]
    ds_read_b64_tr_b16 v[52:53], v4 offset:53248
    v_mfma_f32_16x16x32_bf16 v[84:87], v[56:59], v[220:223], v[84:87]
    ds_read_b64_tr_b16 v[54:55], v4 offset:54272
    v_mfma_f32_16x16x32_bf16 v[88:91], v[60:63], v[216:219], v[88:91]
    ds_read_b64_tr_b16 v[56:57], v5 offset:53248
    v_mfma_f32_16x16x32_bf16 v[92:95], v[60:63], v[220:223], v[92:95]
    ds_read_b64_tr_b16 v[58:59], v5 offset:54272
    s_bitcmp1_b32 s21, 0
    s_cbranch_scc1 c_B
    v_add_u32 v7, s62, v1
    s_waitcnt lgkmcnt(6)
    v_pk_fma_f32 v[68:69], v[12:13], v[16:17], v[68:69] op_sel_hi:[0,1,1] neg_lo:[1,0,0] neg_hi:[1,0,0]
    v_pk_fma_f32 v[70:71], v[12:13], v[18:19], v[70:71] op_sel_hi:[0,1,1] neg_lo:[1,0,0] neg_hi:[1,0,0]
    v_pk_fma_f32 v[76:77], v[12:13], v[20:21], v[76:77] op_sel_hi:[0,1,1] neg_lo:[1,0,0] neg_hi:[1,0,0]
    v_pk_fma_f32 v[78:79], v[12:13], v[22:23], v[78:79] op_sel_hi:[0,1,1] neg_lo:[1,0,0] neg_hi:[1,0,0]
    v_pk_mul_f32 v[68:69], v[14:15], v[68:69] op_sel_hi:[0,1]
    v_pk_mul_f32 v[70:71], v[14:15], v[70:71] op_sel_hi:[0,1]
    v_pk_mul_f32 v[76:77], v[14:15], v[76:77] op_sel_hi:[0,1]
    v_pk_mul_f32 v[78:79], v[14:15], v[78:79] op_sel_hi:[0,1]
    v_cvt_pk_bf16_f32 v68, v68, v69
    v_cvt_pk_bf16_f32 v69, v70, v71
    v_cvt_pk_bf16_f32 v70, v76, v77
    v_cvt_pk_bf16_f32 v71, v78, v79
    ds_write_b128 v7, v[68:71] offset:4096
    v_pk_fma_f32 v[64:65], v[8:9], v[16:17], v[64:65] op_sel_hi:[0,1,1] neg_lo:[1,0,0] neg_hi:[1,0,0]
    v_pk_fma_f32 v[66:67], v[8:9], v[18:19], v[66:67] op_sel_hi:[0,1,1] neg_lo:[1,0,0] neg_hi:[1,0,0]
    v_pk_fma_f32 v[72:73], v[8:9], v[20:21], v[72:73] op_sel_hi:[0,1,1] neg_lo:[1,0,0] neg_hi:[1,0,0]
    v_pk_fma_f32 v[74:75], v[8:9], v[22:23], v[74:75] op_sel_hi:[0,1,1] neg_lo:[1,0,0] neg_hi:[1,0,0]
    v_pk_mul_f32 v[64:65], v[10:11], v[64:65] op_sel_hi:[0,1]
    v_pk_mul_f32 v[66:67], v[10:11], v[66:67] op_sel_hi:[0,1]
    v_pk_mul_f32 v[72:73], v[10:11], v[72:73] op_sel_hi:[0,1]
    v_pk_mul_f32 v[74:75], v[10:11], v[74:75] op_sel_hi:[0,1]
    v_cvt_pk_bf16_f32 v64, v64, v65
    v_cvt_pk_bf16_f32 v65, v66, v67
    v_cvt_pk_bf16_f32 v66, v72, v73
    v_cvt_pk_bf16_f32 v67, v74, v75
    v_pk_fma_f32 v[84:85], v[12:13], v[24:25], v[84:85] op_sel_hi:[0,1,1] neg_lo:[1,0,0] neg_hi:[1,0,0]
    v_pk_fma_f32 v[86:87], v[12:13], v[26:27], v[86:87] op_sel_hi:[0,1,1] neg_lo:[1,0,0] neg_hi:[1,0,0]
    v_pk_fma_f32 v[92:93], v[12:13], v[28:29], v[92:93] op_sel_hi:[0,1,1] neg_lo:[1,0,0] neg_hi:[1,0,0]
    v_pk_fma_f32 v[94:95], v[12:13], v[30:31], v[94:95] op_sel_hi:[0,1,1] neg_lo:[1,0,0] neg_hi:[1,0,0]
    v_pk_mul_f32 v[84:85], v[14:15], v[84:85] op_sel_hi:[0,1]
    v_pk_mul_f32 v[86:87], v[14:15], v[86:87] op_sel_hi:[0,1]
    v_pk_mul_f32 v[92:93], v[14:15], v[92:93] op_sel_hi:[0,1]
    v_pk_mul_f32 v[94:95], v[14:15], v[94:95] op_sel_hi:[0,1]
    v_cvt_pk_bf16_f32 v84, v84, v85
    v_cvt_pk_bf16_f32 v85, v86, v87
    v_cvt_pk_bf16_f32 v86, v92, v93
    v_cvt_pk_bf16_f32 v87, v94, v95
    ds_write_b128 v7, v[84:87] offset:5120
    v_pk_fma_f32 v[80:81], v[8:9], v[24:25], v[80:81] op_sel_hi:[0,1,1] neg_lo:[1,0,0] neg_hi:[1,0,0]
    v_pk_fma_f32 v[82:83], v[8:9], v[26:27], v[82:83] op_sel_hi:[0,1,1] neg_lo:[1,0,0] neg_hi:[1,0,0]
    v_pk_fma_f32 v[88:89], v[8:9], v[28:29], v[88:89] op_sel_hi:[0,1,1] neg_lo:[1,0,0] neg_hi:[1,0,0]
    v_pk_fma_f32 v[90:91], v[8:9], v[30:31], v[90:91] op_sel_hi:[0,1,1] neg_lo:[1,0,0] neg_hi:[1,0,0]
    v_pk_mul_f32 v[80:81], v[10:11], v[80:81] op_sel_hi:[0,1]
    v_pk_mul_f32 v[82:83], v[10:11], v[82:83] op_sel_hi:[0,1]
    v_pk_mul_f32 v[88:89], v[10:11], v[88:89] op_sel_hi:[0,1]
    v_pk_mul_f32 v[90:91], v[10:11], v[90:91] op_sel_hi:[0,1]
    v_cvt_pk_bf16_f32 v80, v80, v81
    v_cvt_pk_bf16_f32 v81, v82, v83
    v_cvt_pk_bf16_f32 v82, v88, v89
    v_cvt_pk_bf16_f32 v83, v90, v91
    v_mfma_f32_16x16x32_bf16 v[96:99], v[160:163], v[32:35], v[96:99]
    ds_read_b64_tr_b16 v[60:61], v6 offset:53248
    v_mfma_f32_16x16x32_bf16 v[100:103], v[164:167], v[32:35], v[100:103]
    ds_read_b64_tr_b16 v[62:63], v6 offset:54272
    v_mfma_f32_16x16x32_bf16 v[104:107], v[160:163], v[36:39], v[104:107]
    ds_read_b64_tr_b16 v[32:33], v3 offset:57344
    v_mfma_f32_16x16x32_bf16 v[108:111], v[164:167], v[36:39], v[108:111]
    ds_read_b64_tr_b16 v[34:35], v3 offset:58368
    v_mfma_f32_16x16x32_bf16 v[112:115], v[160:163], v[40:43], v[112:115]
    ds_read_b64_tr_b16 v[36:37], v4 offset:57344
    v_mfma_f32_16x16x32_bf16 v[116:119], v[164:167], v[40:43], v[116:119]
    ds_read_b64_tr_b16 v[38:39], v4 offset:58368
    v_mfma_f32_16x16x32_bf16 v[120:123], v[160:163], v[44:47], v[120:123]
    ds_read_b64_tr_b16 v[40:41], v5 offset:57344
    v_mfma_f32_16x16x32_bf16 v[124:127], v[164:167], v[44:47], v[124:127]
    ds_read_b64_tr_b16 v[42:43], v5 offset:58368
    s_waitcnt lgkmcnt(12)
    v_mfma_f32_16x16x32_bf16 v[96:99], v[168:171], v[48:51], v[96:99]
    ds_read_b64_tr_b16 v[44:45], v6 offset:57344
    v_mfma_f32_16x16x32_bf16 v[100:103], v[172:175], v[48:51], v[100:103]
    ds_read_b64_tr_b16 v[46:47], v6 offset:58368
    v_mfma_f32_16x16x32_bf16 v[104:107], v[168:171], v[52:55], v[104:107]
    ds_read_b64_tr_b16 v[48:49], v3 offset:61440
    v_mfma_f32_16x16x32_bf16 v[108:111], v[172:175], v[52:55], v[108:111]
    ds_read_b64_tr_b16 v[50:51], v3 offset:62464
    s_waitcnt lgkmcnt(10)
    v_mfma_f32_16x16x32_bf16 v[112:115], v[168:171], v[56:59], v[112:115]
    ds_read_b64_tr_b16 v[52:53], v4 offset:61440
    v_mfma_f32_16x16x32_bf16 v[116:119], v[172:175], v[56:59], v[116:119]
    ds_read_b64_tr_b16 v[54:55], v4 offset:62464
    v_mfma_f32_16x16x32_bf16 v[120:123], v[168:171], v[60:63], v[120:123]
    ds_read_b64_tr_b16 v[56:57], v5 offset:61440
    v_mfma_f32_16x16x32_bf16 v[124:127], v[172:175], v[60:63], v[124:127]
    ds_read_b64_tr_b16 v[58:59], v5 offset:62464
    s_waitcnt lgkmcnt(10)
    v_mfma_f32_16x16x32_bf16 v[96:99], v[176:179], v[32:35], v[96:99]
    ds_read_b64_tr_b16 v[60:61], v6 offset:61440
    v_mfma_f32_16x16x32_bf16 v[100:103], v[180:183], v[32:35], v[100:103]
    ds_read_b64_tr_b16 v[62:63], v6 offset:62464
    s_barrier
    v_xor_b32 v3, 0x10000, v3
    v_xor_b32 v4, 0x10000, v4
    v_xor_b32 v5, 0x10000, v5
    v_xor_b32 v6, 0x10000, v6
    v_mfma_f32_16x16x32_bf16 v[104:107], v[176:179], v[36:39], v[104:107]
    ds_read_b64_tr_b16 v[32:33], v3 offset:0
    v_mfma_f32_16x16x32_bf16 v[108:111], v[180:183], v[36:39], v[108:111]
    ds_read_b64_tr_b16 v[34:35], v3 offset:1024
    s_waitcnt lgkmcnt(10)
    v_mfma_f32_16x16x32_bf16 v[112:115], v[176:179], v[40:43], v[112:115]
    ds_read_b64_tr_b16 v[36:37], v4 offset:0
    v_mfma_f32_16x16x32_bf16 v[116:119], v[180:183], v[40:43], v[116:119]
    ds_read_b64_tr_b16 v[38:39], v4 offset:1024
    v_mfma_f32_16x16x32_bf16 v[120:123], v[176:179], v[44:47], v[120:123]
    ds_read_b64_tr_b16 v[40:41], v5 offset:0
    v_mfma_f32_16x16x32_bf16 v[124:127], v[180:183], v[44:47], v[124:127]
    ds_read_b64_tr_b16 v[42:43], v5 offset:1024
    s_waitcnt lgkmcnt(10)
    v_mfma_f32_16x16x32_bf16 v[96:99], v[184:187], v[48:51], v[96:99]
    ds_read_b64_tr_b16 v[44:45], v6 offset:0
    v_mfma_f32_16x16x32_bf16 v[100:103], v[188:191], v[48:51], v[100:103]
    ds_read_b64_tr_b16 v[46:47], v6 offset:1024
    v_mfma_f32_16x16x32_bf16 v[104:107], v[184:187], v[52:55], v[104:107]
    ds_read_b64_tr_b16 v[48:49], v3 offset:4096
    v_mfma_f32_16x16x32_bf16 v[108:111], v[188:191], v[52:55], v[108:111]
    ds_read_b64_tr_b16 v[50:51], v3 offset:5120
    s_waitcnt lgkmcnt(10)
    v_mfma_f32_16x16x32_bf16 v[112:115], v[184:187], v[56:59], v[112:115]
    ds_read_b64_tr_b16 v[52:53], v4 offset:4096
    v_mfma_f32_16x16x32_bf16 v[116:119], v[188:191], v[56:59], v[116:119]
    ds_read_b64_tr_b16 v[54:55], v4 offset:5120
    v_mfma_f32_16x16x32_bf16 v[120:123], v[184:187], v[60:63], v[120:123]
    ds_read_b64_tr_b16 v[56:57], v5 offset:4096
    v_mfma_f32_16x16x32_bf16 v[124:127], v[188:191], v[60:63], v[124:127]
    ds_read_b64_tr_b16 v[58:59], v5 offset:5120
    s_waitcnt lgkmcnt(10)
    v_mfma_f32_16x16x32_bf16 v[96:99], v[192:195], v[32:35], v[96:99]
    ds_read_b64_tr_b16 v[60:61], v6 offset:4096
    v_mfma_f32_16x16x32_bf16 v[100:103], v[196:199], v[32:35], v[100:103]
    ds_read_b64_tr_b16 v[62:63], v6 offset:5120
    v_mfma_f32_16x16x32_bf16 v[104:107], v[192:195], v[36:39], v[104:107]
    ds_read_b64_tr_b16 v[32:33], v3 offset:8192
    v_mfma_f32_16x16x32_bf16 v[108:111], v[196:199], v[36:39], v[108:111]
    ds_read_b64_tr_b16 v[34:35], v3 offset:9216
    s_waitcnt lgkmcnt(10)
    v_mfma_f32_16x16x32_bf16 v[112:115], v[192:195], v[40:43], v[112:115]
    ds_read_b64_tr_b16 v[36:37], v4 offset:8192
    v_mfma_f32_16x16x32_bf16 v[116:119], v[196:199], v[40:43], v[116:119]
    ds_read_b64_tr_b16 v[38:39], v4 offset:9216
    v_mfma_f32_16x16x32_bf16 v[120:123], v[192:195], v[44:47], v[120:123]
    ds_read_b64_tr_b16 v[40:41], v5 offset:8192
    v_mfma_f32_16x16x32_bf16 v[124:127], v[196:199], v[44:47], v[124:127]
    ds_read_b64_tr_b16 v[42:43], v5 offset:9216
    s_waitcnt lgkmcnt(10)
    v_mfma_f32_16x16x32_bf16 v[96:99], v[200:203], v[48:51], v[96:99]
    ds_read_b64_tr_b16 v[44:45], v6 offset:8192
    v_mfma_f32_16x16x32_bf16 v[100:103], v[204:207], v[48:51], v[100:103]
    ds_read_b64_tr_b16 v[46:47], v6 offset:9216
    v_mfma_f32_16x16x32_bf16 v[104:107], v[200:203], v[52:55], v[104:107]
    ds_read_b64_tr_b16 v[48:49], v3 offset:12288
    v_mfma_f32_16x16x32_bf16 v[108:111], v[204:207], v[52:55], v[108:111]
    ds_read_b64_tr_b16 v[50:51], v3 offset:13312
    s_waitcnt lgkmcnt(10)
    v_mfma_f32_16x16x32_bf16 v[112:115], v[200:203], v[56:59], v[112:115]
    ds_read_b64_tr_b16 v[52:53], v4 offset:12288
    v_mfma_f32_16x16x32_bf16 v[116:119], v[204:207], v[56:59], v[116:119]
    ds_read_b64_tr_b16 v[54:55], v4 offset:13312
    v_mfma_f32_16x16x32_bf16 v[120:123], v[200:203], v[60:63], v[120:123]
    ds_read_b64_tr_b16 v[56:57], v5 offset:12288
    v_mfma_f32_16x16x32_bf16 v[124:127], v[204:207], v[60:63], v[124:127]
    ds_read_b64_tr_b16 v[58:59], v5 offset:13312
    s_waitcnt lgkmcnt(10)
    v_mfma_f32_16x16x32_bf16 v[96:99], v[208:211], v[32:35], v[96:99]
    ds_read_b64_tr_b16 v[60:61], v6 offset:12288
    v_mfma_f32_16x16x32_bf16 v[100:103], v[212:215], v[32:35], v[100:103]
    ds_read_b64_tr_b16 v[62:63], v6 offset:13312
    v_mfma_f32_16x16x32_bf16 v[104:107], v[208:211], v[36:39], v[104:107]
    ds_read_b64_tr_b16 v[32:33], v3 offset:16384
    ds_read_b128 v[16:19], v13 offset:4096
    v_mfma_f32_16x16x32_bf16 v[108:111], v[212:215], v[36:39], v[108:111]
    ds_read_b64_tr_b16 v[34:35], v3 offset:17408
    ds_read_b128 v[20:23], v13 offset:4608
    s_waitcnt lgkmcnt(12)
    v_mfma_f32_16x16x32_bf16 v[112:115], v[208:211], v[40:43], v[112:115]
    ds_read_b64_tr_b16 v[36:37], v4 offset:16384
    ds_read_b128 v[24:27], v13 offset:4160
    v_mfma_f32_16x16x32_bf16 v[116:119], v[212:215], v[40:43], v[116:119]
    ds_read_b64_tr_b16 v[38:39], v4 offset:17408
    ds_read_b128 v[28:31], v13 offset:4672
    v_mfma_f32_16x16x32_bf16 v[120:123], v[208:211], v[44:47], v[120:123]
    ds_read_b64_tr_b16 v[40:41], v5 offset:16384
    ds_read_b32 v8, v15 offset:512
    v_mfma_f32_16x16x32_bf16 v[124:127], v[212:215], v[44:47], v[124:127]
    ds_read_b64_tr_b16 v[42:43], v5 offset:17408
    ds_read_b32 v10, v15 offset:576
    s_waitcnt lgkmcnt(14)
    v_mfma_f32_16x16x32_bf16 v[96:99], v[216:219], v[48:51], v[96:99]
    ds_read_b64_tr_b16 v[44:45], v6 offset:16384
    ds_read_b32 v12, v15 offset:640
    v_mfma_f32_16x16x32_bf16 v[100:103], v[220:223], v[48:51], v[100:103]
    ds_read_b64_tr_b16 v[46:47], v6 offset:17408
    ds_read_b32 v14, v15 offset:704
    v_mfma_f32_16x16x32_bf16 v[104:107], v[216:219], v[52:55], v[104:107]
    ds_read_b64_tr_b16 v[48:49], v3 offset:20480
    v_mfma_f32_16x16x32_bf16 v[108:111], v[220:223], v[52:55], v[108:111]
    ds_read_b64_tr_b16 v[50:51], v3 offset:21504
    s_waitcnt lgkmcnt(14)
    v_mfma_f32_16x16x32_bf16 v[112:115], v[216:219], v[56:59], v[112:115]
    ds_read_b64_tr_b16 v[52:53], v4 offset:20480
    v_mfma_f32_16x16x32_bf16 v[116:119], v[220:223], v[56:59], v[116:119]
    ds_read_b64_tr_b16 v[54:55], v4 offset:21504
    v_mfma_f32_16x16x32_bf16 v[120:123], v[216:219], v[60:63], v[120:123]
    ds_read_b64_tr_b16 v[56:57], v5 offset:20480
    v_mfma_f32_16x16x32_bf16 v[124:127], v[220:223], v[60:63], v[124:127]
    ds_read_b64_tr_b16 v[58:59], v5 offset:21504
    s_waitcnt lgkmcnt(6)
    v_pk_fma_f32 v[100:101], v[8:9], v[24:25], v[100:101] op_sel_hi:[0,1,1] neg_lo:[1,0,0] neg_hi:[1,0,0]
    v_pk_fma_f32 v[102:103], v[8:9], v[26:27], v[102:103] op_sel_hi:[0,1,1] neg_lo:[1,0,0] neg_hi:[1,0,0]
    v_pk_fma_f32 v[108:109], v[10:11], v[24:25], v[108:109] op_sel_hi:[0,1,1] neg_lo:[1,0,0] neg_hi:[1,0,0]
    v_pk_fma_f32 v[110:111], v[10:11], v[26:27], v[110:111] op_sel_hi:[0,1,1] neg_lo:[1,0,0] neg_hi:[1,0,0]
    v_pk_mul_f32 v[100:101], v[28:29], v[100:101]
    v_pk_mul_f32 v[102:103], v[30:31], v[102:103]
    v_pk_mul_f32 v[108:109], v[28:29], v[108:109]
    v_pk_mul_f32 v[110:111], v[30:31], v[110:111]
    v_cvt_pk_bf16_f32 v74, v100, v101
    v_cvt_pk_bf16_f32 v75, v102, v103
    v_cvt_pk_bf16_f32 v78, v108, v109
    v_cvt_pk_bf16_f32 v79, v110, v111
    v_cvt_pk_bf16_f32 v100, v100, v101
    v_cvt_pk_bf16_f32 v101, v102, v103
    v_cvt_pk_bf16_f32 v102, v108, v109
    v_cvt_pk_bf16_f32 v103, v110, v111
    ds_write_b128 v7, v[100:103] offset:6144
    v_pk_fma_f32 v[116:117], v[12:13], v[24:25], v[116:117] op_sel_hi:[0,1,1] neg_lo:[1,0,0] neg_hi:[1,0,0]
    v_pk_fma_f32 v[118:119], v[12:13], v[26:27], v[118:119] op_sel_hi:[0,1,1] neg_lo:[1,0,0] neg_hi:[1,0,0]
    v_pk_fma_f32 v[124:125], v[14:15], v[24:25], v[124:125] op_sel_hi:[0,1,1] neg_lo:[1,0,0] neg_hi:[1,0,0]
    v_pk_fma_f32 v[126:127], v[14:15], v[26:27], v[126:127] op_sel_hi:[0,1,1] neg_lo:[1,0,0] neg_hi:[1,0,0]
    v_pk_mul_f32 v[116:117], v[28:29], v[116:117]
    v_pk_mul_f32 v[118:119], v[30:31], v[118:119]
    v_pk_mul_f32 v[124:125], v[28:29], v[124:125]
    v_pk_mul_f32 v[126:127], v[30:31], v[126:127]
    v_cvt_pk_bf16_f32 v90, v116, v117
    v_cvt_pk_bf16_f32 v91, v118, v119
    v_cvt_pk_bf16_f32 v94, v124, v125
    v_cvt_pk_bf16_f32 v95, v126, v127
    v_cvt_pk_bf16_f32 v116, v116, v117
    v_cvt_pk_bf16_f32 v117, v118, v119
    v_cvt_pk_bf16_f32 v118, v124, v125
    v_cvt_pk_bf16_f32 v119, v126, v127
    ds_write_b128 v7, v[116:119] offset:7168
    s_cmp_lg_u32 s16, 3
    s_cbranch_scc1 a_nh
    buffer_store_dwordx4 v[68:71], v1, s[4:7], s60 offen offset:0 sc1
    buffer_store_dwordx4 v[84:87], v1, s[4:7], s60 offen offset:1024 sc1
    buffer_store_dwordx4 v[100:103], v1, s[4:7], s60 offen offset:2048 sc1
    buffer_store_dwordx4 v[116:119], v1, s[4:7], s60 offen offset:3072 sc1
a_nh:
    v_pk_fma_f32 v[96:97], v[8:9], v[16:17], v[96:97] op_sel_hi:[0,1,1] neg_lo:[1,0,0] neg_hi:[1,0,0]
    v_pk_fma_f32 v[98:99], v[8:9], v[18:19], v[98:99] op_sel_hi:[0,1,1] neg_lo:[1,0,0] neg_hi:[1,0,0]
    v_pk_fma_f32 v[104:105], v[10:11], v[16:17], v[104:105] op_sel_hi:[0,1,1] neg_lo:[1,0,0] neg_hi:[1,0,0]
    v_pk_fma_f32 v[106:107], v[10:11], v[18:19], v[106:107] op_sel_hi:[0,1,1] neg_lo:[1,0,0] neg_hi:[1,0,0]
    v_pk_mul_f32 v[96:97], v[20:21], v[96:97]
    v_pk_mul_f32 v[98:99], v[22:23], v[98:99]
    v_pk_mul_f32 v[104:105], v[20:21], v[104:105]
    v_pk_mul_f32 v[106:107], v[22:23], v[106:107]
    v_cvt_pk_bf16_f32 v72, v96, v97
    v_cvt_pk_bf16_f32 v73, v98, v99
    v_cvt_pk_bf16_f32 v76, v104, v105
    v_cvt_pk_bf16_f32 v77, v106, v107
    v_pk_fma_f32 v[112:113], v[12:13], v[16:17], v[112:113] op_sel_hi:[0,1,1] neg_lo:[1,0,0] neg_hi:[1,0,0]
    v_pk_fma_f32 v[114:115], v[12:13], v[18:19], v[114:115] op_sel_hi:[0,1,1] neg_lo:[1,0,0] neg_hi:[1,0,0]
    v_pk_fma_f32 v[120:121], v[14:15], v[16:17], v[120:121] op_sel_hi:[0,1,1] neg_lo:[1,0,0] neg_hi:[1,0,0]
    v_pk_fma_f32 v[122:123], v[14:15], v[18:19], v[122:123] op_sel_hi:[0,1,1] neg_lo:[1,0,0] neg_hi:[1,0,0]
    v_pk_mul_f32 v[112:113], v[20:21], v[112:113]
    v_pk_mul_f32 v[114:115], v[22:23], v[114:115]
    v_pk_mul_f32 v[120:121], v[20:21], v[120:121]
    v_pk_mul_f32 v[122:123], v[22:23], v[122:123]
    v_cvt_pk_bf16_f32 v88, v112, v113
    v_cvt_pk_bf16_f32 v89, v114, v115
    v_cvt_pk_bf16_f32 v92, v120, v121
    v_cvt_pk_bf16_f32 v93, v122, v123
    v_mfma_f32_16x16x32_bf16 v[128:131], v[32:35], v[224:227], v[128:131]
    ds_read_b64_tr_b16 v[60:61], v6 offset:20480
    v_mfma_f32_16x16x32_bf16 v[132:135], v[32:35], v[228:231], v[132:135]
    ds_read_b64_tr_b16 v[62:63], v6 offset:21504
    v_mfma_f32_16x16x32_bf16 v[136:139], v[36:39], v[224:227], v[136:139]
    ds_read_b64_tr_b16 v[32:33], v3 offset:24576
    v_mfma_f32_16x16x32_bf16 v[140:143], v[36:39], v[228:231], v[140:143]
    ds_read_b64_tr_b16 v[34:35], v3 offset:25600
    v_mfma_f32_16x16x32_bf16 v[144:147], v[40:43], v[224:227], v[144:147]
    ds_read_b64_tr_b16 v[36:37], v4 offset:24576
    v_mfma_f32_16x16x32_bf16 v[148:151], v[40:43], v[228:231], v[148:151]
    ds_read_b64_tr_b16 v[38:39], v4 offset:25600
    v_mfma_f32_16x16x32_bf16 v[152:155], v[44:47], v[224:227], v[152:155]
    ds_read_b64_tr_b16 v[40:41], v5 offset:24576
    v_mfma_f32_16x16x32_bf16 v[156:159], v[44:47], v[228:231], v[156:159]
    ds_read_b64_tr_b16 v[42:43], v5 offset:25600
    s_waitcnt lgkmcnt(12)
    v_mfma_f32_16x16x32_bf16 v[128:131], v[48:51], v[232:235], v[128:131]
    ds_read_b64_tr_b16 v[44:45], v6 offset:24576
    v_mfma_f32_16x16x32_bf16 v[132:135], v[48:51], v[236:239], v[132:135]
    ds_read_b64_tr_b16 v[46:47], v6 offset:25600
    v_mfma_f32_16x16x32_bf16 v[136:139], v[52:55], v[232:235], v[136:139]
    ds_read_b64_tr_b16 v[48:49], v3 offset:28672
    v_mfma_f32_16x16x32_bf16 v[140:143], v[52:55], v[236:239], v[140:143]
    ds_read_b64_tr_b16 v[50:51], v3 offset:29696
    s_waitcnt lgkmcnt(10)
    v_mfma_f32_16x16x32_bf16 v[144:147], v[56:59], v[232:235], v[144:147]
    ds_read_b64_tr_b16 v[52:53], v4 offset:28672
    v_mfma_f32_16x16x32_bf16 v[148:151], v[56:59], v[236:239], v[148:151]
    ds_read_b64_tr_b16 v[54:55], v4 offset:29696
    v_mfma_f32_16x16x32_bf16 v[152:155], v[60:63], v[232:235], v[152:155]
    ds_read_b64_tr_b16 v[56:57], v5 offset:28672
    v_mfma_f32_16x16x32_bf16 v[156:159], v[60:63], v[236:239], v[156:159]
    ds_read_b64_tr_b16 v[58:59], v5 offset:29696
    s_waitcnt lgkmcnt(10)
    v_mfma_f32_16x16x32_bf16 v[128:131], v[32:35], v[240:243], v[128:131]
    ds_read_b64_tr_b16 v[60:61], v6 offset:28672
    v_mfma_f32_16x16x32_bf16 v[132:135], v[32:35], v[244:247], v[132:135]
    ds_read_b64_tr_b16 v[62:63], v6 offset:29696
    s_barrier
    v_mfma_f32_16x16x32_bf16 v[136:139], v[36:39], v[240:243], v[136:139]
    ds_read_b64_tr_b16 v[32:33], v3 offset:32768
    v_mfma_f32_16x16x32_bf16 v[140:143], v[36:39], v[244:247], v[140:143]
    ds_read_b64_tr_b16 v[34:35], v3 offset:33792
    s_waitcnt lgkmcnt(10)
    v_mfma_f32_16x16x32_bf16 v[144:147], v[40:43], v[240:243], v[144:147]
    ds_read_b64_tr_b16 v[36:37], v4 offset:32768
    v_mfma_f32_16x16x32_bf16 v[148:151], v[40:43], v[244:247], v[148:151]
    ds_read_b64_tr_b16 v[38:39], v4 offset:33792
    v_mfma_f32_16x16x32_bf16 v[152:155], v[44:47], v[240:243], v[152:155]
    ds_read_b64_tr_b16 v[40:41], v5 offset:32768
    v_mfma_f32_16x16x32_bf16 v[156:159], v[44:47], v[244:247], v[156:159]
    ds_read_b64_tr_b16 v[42:43], v5 offset:33792
    s_waitcnt lgkmcnt(10)
    v_mfma_f32_16x16x32_bf16 v[128:131], v[48:51], v[248:251], v[128:131]
    ds_read_b64_tr_b16 v[44:45], v6 offset:32768
    v_mfma_f32_16x16x32_bf16 v[132:135], v[48:51], v[252:255], v[132:135]
    ds_read_b64_tr_b16 v[46:47], v6 offset:33792
    v_mfma_f32_16x16x32_bf16 v[136:139], v[52:55], v[248:251], v[136:139]
    ds_read_b64_tr_b16 v[48:49], v3 offset:36864
    v_mfma_f32_16x16x32_bf16 v[140:143], v[52:55], v[252:255], v[140:143]
    ds_read_b64_tr_b16 v[50:51], v3 offset:37888
    s_waitcnt lgkmcnt(10)
    v_mfma_f32_16x16x32_bf16 v[144:147], v[56:59], v[248:251], v[144:147]
    ds_read_b64_tr_b16 v[52:53], v4 offset:36864
    v_mfma_f32_16x16x32_bf16 v[148:151], v[56:59], v[252:255], v[148:151]
    ds_read_b64_tr_b16 v[54:55], v4 offset:37888
    v_mfma_f32_16x16x32_bf16 v[152:155], v[60:63], v[248:251], v[152:155]
    ds_read_b64_tr_b16 v[56:57], v5 offset:36864
    v_mfma_f32_16x16x32_bf16 v[156:159], v[60:63], v[252:255], v[156:159]
    ds_read_b64_tr_b16 v[58:59], v5 offset:37888
    s_waitcnt lgkmcnt(10)
    v_mfma_f32_16x16x32_bf16 v[128:131], v[32:35], v[160:163], v[128:131]
    ds_read_b64_tr_b16 v[60:61], v6 offset:36864
    v_mfma_f32_16x16x32_bf16 v[132:135], v[32:35], v[164:167], v[132:135]
    ds_read_b64_tr_b16 v[62:63], v6 offset:37888
    v_mfma_f32_16x16x32_bf16 v[136:139], v[36:39], v[160:163], v[136:139]
    ds_read_b64_tr_b16 v[32:33], v3 offset:40960
    v_mfma_f32_16x16x32_bf16 v[140:143], v[36:39], v[164:167], v[140:143]
    ds_read_b64_tr_b16 v[34:35], v3 offset:41984
    s_waitcnt lgkmcnt(10)
    v_mfma_f32_16x16x32_bf16 v[144:147], v[40:43], v[160:163], v[144:147]
    ds_read_b64_tr_b16 v[36:37], v4 offset:40960
    v_mfma_f32_16x16x32_bf16 v[148:151], v[40:43], v[164:167], v[148:151]
    ds_read_b64_tr_b16 v[38:39], v4 offset:41984
    v_mfma_f32_16x16x32_bf16 v[152:155], v[44:47], v[160:163], v[152:155]
    ds_read_b64_tr_b16 v[40:41], v5 offset:40960
    v_mfma_f32_16x16x32_bf16 v[156:159], v[44:47], v[164:167], v[156:159]
    ds_read_b64_tr_b16 v[42:43], v5 offset:41984
    s_waitcnt lgkmcnt(10)
    v_mfma_f32_16x16x32_bf16 v[128:131], v[48:51], v[168:171], v[128:131]
    ds_read_b64_tr_b16 v[44:45], v6 offset:40960
    s_cmp_lg_u32 s16, 3
    s_cbranch_scc1 a_nopub
    s_waitcnt vmcnt(0)
    s_atomic_add s40, s[22:23], s61
a_nopub:
    v_mfma_f32_16x16x32_bf16 v[132:135], v[48:51], v[172:175], v[132:135]
    ds_read_b64_tr_b16 v[46:47], v6 offset:41984
    v_mfma_f32_16x16x32_bf16 v[136:139], v[52:55], v[168:171], v[136:139]
    ds_read_b64_tr_b16 v[48:49], v3 offset:45056
    v_mfma_f32_16x16x32_bf16 v[140:143], v[52:55], v[172:175], v[140:143]
    ds_read_b64_tr_b16 v[50:51], v3 offset:46080
    s_waitcnt lgkmcnt(10)
    v_mfma_f32_16x16x32_bf16 v[144:147], v[56:59], v[168:171], v[144:147]
    ds_read_b64_tr_b16 v[52:53], v4 offset:45056
    v_mfma_f32_16x16x32_bf16 v[148:151], v[56:59], v[172:175], v[148:151]
    ds_read_b64_tr_b16 v[54:55], v4 offset:46080
    v_mfma_f32_16x16x32_bf16 v[152:155], v[60:63], v[168:171], v[152:155]
    ds_read_b64_tr_b16 v[56:57], v5 offset:45056
    v_mfma_f32_16x16x32_bf16 v[156:159], v[60:63], v[172:175], v[156:159]
    ds_read_b64_tr_b16 v[58:59], v5 offset:46080
    s_waitcnt lgkmcnt(10)
    v_mfma_f32_16x16x32_bf16 v[128:131], v[32:35], v[176:179], v[128:131]
    ds_read_b64_tr_b16 v[60:61], v6 offset:45056
    v_mfma_f32_16x16x32_bf16 v[132:135], v[32:35], v[180:183], v[132:135]
    ds_read_b64_tr_b16 v[62:63], v6 offset:46080
    v_mfma_f32_16x16x32_bf16 v[136:139], v[36:39], v[176:179], v[136:139]
    ds_read_b64_tr_b16 v[32:33], v3 offset:49152
    v_mfma_f32_16x16x32_bf16 v[140:143], v[36:39], v[180:183], v[140:143]
    ds_read_b64_tr_b16 v[34:35], v3 offset:50176
    s_waitcnt lgkmcnt(10)
    v_mfma_f32_16x16x32_bf16 v[144:147], v[40:43], v[176:179], v[144:147]
    ds_read_b64_tr_b16 v[36:37], v4 offset:49152
    v_mfma_f32_16x16x32_bf16 v[148:151], v[40:43], v[180:183], v[148:151]
    ds_read_b64_tr_b16 v[38:39], v4 offset:50176
    v_mfma_f32_16x16x32_bf16 v[152:155], v[44:47], v[176:179], v[152:155]
    ds_read_b64_tr_b16 v[40:41], v5 offset:49152
    v_mfma_f32_16x16x32_bf16 v[156:159], v[44:47], v[180:183], v[156:159]
    ds_read_b64_tr_b16 v[42:43], v5 offset:50176
    s_waitcnt lgkmcnt(10)
    v_mfma_f32_16x16x32_bf16 v[128:131], v[48:51], v[184:187], v[128:131]
    ds_read_b64_tr_b16 v[44:45], v6 offset:49152
    ds_read_b32 v8, v9 offset:4096
    v_mfma_f32_16x16x32_bf16 v[132:135], v[48:51], v[188:191], v[132:135]
    ds_read_b64_tr_b16 v[46:47], v6 offset:50176
    ds_read_b32 v10, v9 offset:4608
    v_mfma_f32_16x16x32_bf16 v[136:139], v[52:55], v[184:187], v[136:139]
    ds_read_b64_tr_b16 v[48:49], v3 offset:53248
    ds_read_b32 v12, v9 offset:4160
    v_mfma_f32_16x16x32_bf16 v[140:143], v[52:55], v[188:191], v[140:143]
    ds_read_b64_tr_b16 v[50:51], v3 offset:54272
    ds_read_b32 v14, v9 offset:4672
    s_waitcnt lgkmcnt(14)
    v_mfma_f32_16x16x32_bf16 v[144:147], v[56:59], v[184:187], v[144:147]
    ds_read_b64_tr_b16 v[52:53], v4 offset:53248
    ds_read_b128 v[16:19], v11 offset:0
    v_mfma_f32_16x16x32_bf16 v[148:151], v[56:59], v[188:191], v[148:151]
    ds_read_b64_tr_b16 v[54:55], v4 offset:54272
    ds_read_b128 v[20:23], v11 offset:64
    v_mfma_f32_16x16x32_bf16 v[152:155], v[60:63], v[184:187], v[152:155]
    ds_read_b64_tr_b16 v[56:57], v5 offset:53248
    ds_read_b128 v[24:27], v11 offset:128
    v_mfma_f32_16x16x32_bf16 v[156:159], v[60:63], v[188:191], v[156:159]
    ds_read_b64_tr_b16 v[58:59], v5 offset:54272
    ds_read_b128 v[28:31], v11 offset:192
    s_waitcnt lgkmcnt(14)
    v_mfma_f32_16x16x32_bf16 v[128:131], v[32:35], v[192:195], v[128:131]
    ds_read_b64_tr_b16 v[60:61], v6 offset:53248
    v_add_u32 v13, 153600, v1
    v_mfma_f32_16x16x32_bf16 v[132:135], v[32:35], v[196:199], v[132:135]
    ds_read_b64_tr_b16 v[62:63], v6 offset:54272
    v_mfma_f32_16x16x32_bf16 v[136:139], v[36:39], v[192:195], v[136:139]
    ds_read_b64_tr_b16 v[32:33], v3 offset:57344
    v_mfma_f32_16x16x32_bf16 v[140:143], v[36:39], v[196:199], v[140:143]
    ds_read_b64_tr_b16 v[34:35], v3 offset:58368
    s_waitcnt lgkmcnt(14)
    v_mfma_f32_16x16x32_bf16 v[144:147], v[40:43], v[192:195], v[144:147]
    ds_read_b64_tr_b16 v[36:37], v4 offset:57344
    v_mfma_f32_16x16x32_bf16 v[148:151], v[40:43], v[196:199], v[148:151]
    ds_read_b64_tr_b16 v[38:39], v4 offset:58368
    v_mfma_f32_16x16x32_bf16 v[152:155], v[44:47], v[192:195], v[152:155]
    ds_read_b64_tr_b16 v[40:41], v5 offset:57344
    v_mfma_f32_16x16x32_bf16 v[156:159], v[44:47], v[196:199], v[156:159]
    ds_read_b64_tr_b16 v[42:43], v5 offset:58368
    s_waitcnt lgkmcnt(13)
    v_mfma_f32_16x16x32_bf16 v[128:131], v[48:51], v[200:203], v[128:131]
    ds_read_b64_tr_b16 v[44:45], v6 offset:57344
    s_waitcnt lgkmcnt(9)
    v_mfma_f32_16x16x32_bf16 v[132:135], v[48:51], v[204:207], v[132:135]
    ds_read_b64_tr_b16 v[46:47], v6 offset:58368
    v_mul_f32 v10, 0x3e8293ee, v10
    v_mfma_f32_16x16x32_bf16 v[136:139], v[52:55], v[200:203], v[136:139]
    ds_read_b64_tr_b16 v[48:49], v3 offset:61440
    v_mul_f32 v14, 0x3e8293ee, v14
    v_mfma_f32_16x16x32_bf16 v[140:143], v[52:55], v[204:207], v[140:143]
    ds_read_b64_tr_b16 v[50:51], v3 offset:62464
    ds_read_b128 v[120:123], v13 offset:0
    s_waitcnt lgkmcnt(11)
    v_mfma_f32_16x16x32_bf16 v[144:147], v[56:59], v[200:203], v[144:147]
    ds_read_b64_tr_b16 v[52:53], v4 offset:61440
    ds_read_b128 v[124:127], v13 offset:1024
    v_mfma_f32_16x16x32_bf16 v[148:151], v[56:59], v[204:207], v[148:151]
    ds_read_b64_tr_b16 v[54:55], v4 offset:62464
    v_mfma_f32_16x16x32_bf16 v[152:155], v[60:63], v[200:203], v[152:155]
    ds_read_b64_tr_b16 v[56:57], v5 offset:61440
    v_mfma_f32_16x16x32_bf16 v[156:159], v[60:63], v[204:207], v[156:159]
    ds_read_b64_tr_b16 v[58:59], v5 offset:62464
    s_waitcnt lgkmcnt(12)
    v_mfma_f32_16x16x32_bf16 v[128:131], v[32:35], v[208:211], v[128:131]
    ds_read_b64_tr_b16 v[60:61], v6 offset:61440
    v_mfma_f32_16x16x32_bf16 v[132:135], v[32:35], v[212:215], v[132:135]
    ds_read_b64_tr_b16 v[62:63], v6 offset:62464
    v_xor_b32 v3, 0x10000, v3
    v_xor_b32 v4, 0x10000, v4
    v_xor_b32 v5, 0x10000, v5
    v_xor_b32 v6, 0x10000, v6
    v_mfma_f32_16x16x32_bf16 v[136:139], v[36:39], v[208:211], v[136:139]
    v_mfma_f32_16x16x32_bf16 v[140:143], v[36:39], v[212:215], v[140:143]
    s_waitcnt lgkmcnt(10)
    v_mfma_f32_16x16x32_bf16 v[144:147], v[40:43], v[208:211], v[144:147]
    v_mfma_f32_16x16x32_bf16 v[148:151], v[40:43], v[212:215], v[148:151]
    v_mfma_f32_16x16x32_bf16 v[152:155], v[44:47], v[208:211], v[152:155]
    v_mfma_f32_16x16x32_bf16 v[156:159], v[44:47], v[212:215], v[156:159]
    s_waitcnt lgkmcnt(4)
    v_mfma_f32_16x16x32_bf16 v[128:131], v[48:51], v[216:219], v[128:131]
    v_mfma_f32_16x16x32_bf16 v[132:135], v[48:51], v[220:223], v[132:135]
    v_mfma_f32_16x16x32_bf16 v[136:139], v[52:55], v[216:219], v[136:139]
    v_mfma_f32_16x16x32_bf16 v[140:143], v[52:55], v[220:223], v[140:143]
    s_waitcnt lgkmcnt(0)
    v_mfma_f32_16x16x32_bf16 v[144:147], v[56:59], v[216:219], v[144:147]
    v_mfma_f32_16x16x32_bf16 v[148:151], v[56:59], v[220:223], v[148:151]
    v_mfma_f32_16x16x32_bf16 v[152:155], v[60:63], v[216:219], v[152:155]
    v_mfma_f32_16x16x32_bf16 v[156:159], v[60:63], v[220:223], v[156:159]
    s_lshl_b32 s44, s21, 22
    s_lshl_b32 s45, s38, 16
    s_add_u32 s44, s44, s45
    s_lshl_b32 s45, s18, 12
    s_add_u32 s44, s44, s45
    s_add_u32 s52, s44, 16777216
    v_pk_fma_f32 v[132:133], v[12:13], v[16:17], v[132:133] op_sel_hi:[0,1,1] neg_lo:[1,0,0] neg_hi:[1,0,0]
    v_pk_fma_f32 v[134:135], v[12:13], v[18:19], v[134:135] op_sel_hi:[0,1,1] neg_lo:[1,0,0] neg_hi:[1,0,0]
    v_pk_fma_f32 v[140:141], v[12:13], v[20:21], v[140:141] op_sel_hi:[0,1,1] neg_lo:[1,0,0] neg_hi:[1,0,0]
    v_pk_fma_f32 v[142:143], v[12:13], v[22:23], v[142:143] op_sel_hi:[0,1,1] neg_lo:[1,0,0] neg_hi:[1,0,0]
    v_pk_fma_f32 v[148:149], v[12:13], v[24:25], v[148:149] op_sel_hi:[0,1,1] neg_lo:[1,0,0] neg_hi:[1,0,0]
    v_pk_fma_f32 v[150:151], v[12:13], v[26:27], v[150:151] op_sel_hi:[0,1,1] neg_lo:[1,0,0] neg_hi:[1,0,0]
    v_pk_fma_f32 v[156:157], v[12:13], v[28:29], v[156:157] op_sel_hi:[0,1,1] neg_lo:[1,0,0] neg_hi:[1,0,0]
    v_pk_fma_f32 v[158:159], v[12:13], v[30:31], v[158:159] op_sel_hi:[0,1,1] neg_lo:[1,0,0] neg_hi:[1,0,0]
    v_pk_mul_f32 v[132:133], v[14:15], v[132:133] op_sel_hi:[0,1]
    v_pk_mul_f32 v[134:135], v[14:15], v[134:135] op_sel_hi:[0,1]
    v_pk_mul_f32 v[140:141], v[14:15], v[140:141] op_sel_hi:[0,1]
    v_pk_mul_f32 v[142:143], v[14:15], v[142:143] op_sel_hi:[0,1]
    v_pk_mul_f32 v[148:149], v[14:15], v[148:149] op_sel_hi:[0,1]
    v_pk_mul_f32 v[150:151], v[14:15], v[150:151] op_sel_hi:[0,1]
    v_pk_mul_f32 v[156:157], v[14:15], v[156:157] op_sel_hi:[0,1]
    v_pk_mul_f32 v[158:159], v[14:15], v[158:159] op_sel_hi:[0,1]
    v_cvt_pk_bf16_f32 v132, v132, v133
    v_cvt_pk_bf16_f32 v133, v134, v135
    v_cvt_pk_bf16_f32 v134, v140, v141
    v_cvt_pk_bf16_f32 v135, v142, v143
    v_cvt_pk_bf16_f32 v148, v148, v149
    v_cvt_pk_bf16_f32 v149, v150, v151
    v_cvt_pk_bf16_f32 v150, v156, v157
    v_cvt_pk_bf16_f32 v151, v158, v159
    v_mfma_f32_16x16x32_bf16 v[172:175], v[68:71], v[132:135], v[120:123]
    v_mfma_f32_16x16x32_bf16 v[168:171], v[64:67], v[132:135], v[124:127]
    v_mfma_f32_16x16x32_bf16 v[188:191], v[84:87], v[148:151], v[120:123]
    v_mfma_f32_16x16x32_bf16 v[184:187], v[80:83], v[148:151], v[124:127]
    v_pk_fma_f32 v[128:129], v[8:9], v[16:17], v[128:129] op_sel_hi:[0,1,1] neg_lo:[1,0,0] neg_hi:[1,0,0]
    v_pk_fma_f32 v[130:131], v[8:9], v[18:19], v[130:131] op_sel_hi:[0,1,1] neg_lo:[1,0,0] neg_hi:[1,0,0]
    v_pk_fma_f32 v[136:137], v[8:9], v[20:21], v[136:137] op_sel_hi:[0,1,1] neg_lo:[1,0,0] neg_hi:[1,0,0]
    v_pk_fma_f32 v[138:139], v[8:9], v[22:23], v[138:139] op_sel_hi:[0,1,1] neg_lo:[1,0,0] neg_hi:[1,0,0]
    v_pk_fma_f32 v[144:145], v[8:9], v[24:25], v[144:145] op_sel_hi:[0,1,1] neg_lo:[1,0,0] neg_hi:[1,0,0]
    v_pk_fma_f32 v[146:147], v[8:9], v[26:27], v[146:147] op_sel_hi:[0,1,1] neg_lo:[1,0,0] neg_hi:[1,0,0]
    v_pk_fma_f32 v[152:153], v[8:9], v[28:29], v[152:153] op_sel_hi:[0,1,1] neg_lo:[1,0,0] neg_hi:[1,0,0]
    v_pk_fma_f32 v[154:155], v[8:9], v[30:31], v[154:155] op_sel_hi:[0,1,1] neg_lo:[1,0,0] neg_hi:[1,0,0]
    v_pk_mul_f32 v[128:129], v[10:11], v[128:129] op_sel_hi:[0,1]
    v_pk_mul_f32 v[130:131], v[10:11], v[130:131] op_sel_hi:[0,1]
    v_pk_mul_f32 v[136:137], v[10:11], v[136:137] op_sel_hi:[0,1]
    v_pk_mul_f32 v[138:139], v[10:11], v[138:139] op_sel_hi:[0,1]
    v_pk_mul_f32 v[144:145], v[10:11], v[144:145] op_sel_hi:[0,1]
    v_pk_mul_f32 v[146:147], v[10:11], v[146:147] op_sel_hi:[0,1]
    v_pk_mul_f32 v[152:153], v[10:11], v[152:153] op_sel_hi:[0,1]
    v_pk_mul_f32 v[154:155], v[10:11], v[154:155] op_sel_hi:[0,1]
    v_cvt_pk_bf16_f32 v128, v128, v129
    v_cvt_pk_bf16_f32 v129, v130, v131
    v_cvt_pk_bf16_f32 v130, v136, v137
    v_cvt_pk_bf16_f32 v131, v138, v139
    v_cvt_pk_bf16_f32 v144, v144, v145
    v_cvt_pk_bf16_f32 v145, v146, v147
    v_cvt_pk_bf16_f32 v146, v152, v153
    v_cvt_pk_bf16_f32 v147, v154, v155
    v_mfma_f32_16x16x32_bf16 v[164:167], v[64:67], v[128:131], v[120:123]
    s_nop 0
    v_mfma_f32_16x16x32_bf16 v[180:183], v[80:83], v[144:147], v[120:123]
    v_mov_b32 v232, 0x3f803f80
    v_mov_b32 v233, 0x3f803f80
    v_mov_b32 v234, 0x3f803f80
    v_mov_b32 v235, 0x3f803f80
    v_exp_f32 v172, v172
    v_exp_f32 v173, v173
    v_exp_f32 v174, v174
    v_exp_f32 v175, v175
    v_exp_f32 v188, v188
    v_exp_f32 v189, v189
    v_exp_f32 v190, v190
    v_exp_f32 v191, v191
    s_mov_b32 s46, 1006632960
a_exp1:
    v_exp_f32 v168, v168
    v_exp_f32 v169, v169
    v_exp_f32 v170, v170
    v_exp_f32 v171, v171
    v_exp_f32 v184, v184
    v_exp_f32 v185, v185
    v_exp_f32 v186, v186
    v_exp_f32 v187, v187
    v_cvt_pk_bf16_f32 v200, v168, v169
    v_cvt_pk_bf16_f32 v201, v170, v171
    v_cvt_pk_bf16_f32 v202, v172, v173
    v_cvt_pk_bf16_f32 v203, v174, v175
    v_cvt_pk_bf16_f32 v204, v184, v185
    v_cvt_pk_bf16_f32 v205, v186, v187
    v_cvt_pk_bf16_f32 v206, v188, v189
    v_cvt_pk_bf16_f32 v207, v190, v191
    v_mfma_f32_16x16x32_bf16 v[16:19], v[232:235], v[200:203], 0
    s_nop 0
    v_mfma_f32_16x16x32_bf16 v[20:23], v[232:235], v[204:207], 0
    v_mfma_f32_16x16x32_bf16 v[40:43], v[72:75], v[200:203], 0
    v_mfma_f32_16x16x32_bf16 v[44:47], v[76:79], v[200:203], 0
    v_mfma_f32_16x16x32_bf16 v[56:59], v[88:91], v[204:207], 0
    v_mfma_f32_16x16x32_bf16 v[60:63], v[92:95], v[204:207], 0
    v_mov_b32 v218, v72
    v_mov_b32 v219, v73
    v_mov_b32 v222, v76
    v_mov_b32 v223, v77
    v_mov_b32 v226, v88
    v_mov_b32 v227, v89
    v_mov_b32 v230, v92
    v_mov_b32 v231, v93
    v_subrev_u32 v18, 0x21800000, v16
    v_subrev_u32 v22, 0x21800000, v20
    v_max_u32 v18, v18, v22
    v_cmp_le_u32 vcc, s46, v18
    v_rcp_f32 v16, v16
    v_rcp_f32 v20, v20
    s_cbranch_vccnz a_slow1
a_fin1:
    v_pk_mul_f32 v[40:41], v[16:17], v[40:41] op_sel_hi:[0,1]
    v_pk_mul_f32 v[42:43], v[16:17], v[42:43] op_sel_hi:[0,1]
    v_pk_mul_f32 v[44:45], v[16:17], v[44:45] op_sel_hi:[0,1]
    v_pk_mul_f32 v[46:47], v[16:17], v[46:47] op_sel_hi:[0,1]
    v_pk_mul_f32 v[56:57], v[20:21], v[56:57] op_sel_hi:[0,1]
    v_pk_mul_f32 v[58:59], v[20:21], v[58:59] op_sel_hi:[0,1]
    v_pk_mul_f32 v[60:61], v[20:21], v[60:61] op_sel_hi:[0,1]
    v_pk_mul_f32 v[62:63], v[20:21], v[62:63] op_sel_hi:[0,1]
    v_cvt_pk_bf16_f32 v40, v40, v41
    v_cvt_pk_bf16_f32 v41, v42, v43
    v_cvt_pk_bf16_f32 v42, v44, v45
    v_cvt_pk_bf16_f32 v43, v46, v47
    v_cvt_pk_bf16_f32 v56, v56, v57
    v_cvt_pk_bf16_f32 v57, v58, v59
    v_cvt_pk_bf16_f32 v58, v60, v61
    v_cvt_pk_bf16_f32 v59, v62, v63
    v_permlane32_swap_b32 v40, v42
    v_permlane32_swap_b32 v41, v43
    buffer_store_dwordx4 v[40:43], v2, s[4:7], s52 offen offset:256 sc1
    v_permlane32_swap_b32 v56, v58
    v_permlane32_swap_b32 v57, v59
    buffer_store_dwordx4 v[56:59], v2, s[4:7], s52 offen offset:2304 sc1
    s_cmp_lg_u32 s38, 0
    s_cbranch_scc1 a_hasprev
    v_mov_b32 v124, 0xf149f2ca
    v_mov_b32 v125, 0xf149f2ca
    v_mov_b32 v126, 0xf149f2ca
    v_mov_b32 v127, 0xf149f2ca
a_hasprev:
    s_waitcnt lgkmcnt(0)
    s_barrier
    ds_read_b128 v[192:195], v7 offset:0
    ds_read_b128 v[196:199], v7 offset:1024
    ds_read_b64 v[216:217], v7 offset:2048
    ds_read_b64 v[220:221], v7 offset:2056
    ds_read_b64 v[224:225], v7 offset:3072
    ds_read_b64 v[228:229], v7 offset:3080
    s_waitcnt lgkmcnt(4)
    v_mfma_f32_16x16x32_bf16 v[160:163], v[192:195], v[128:131], v[124:127]
    v_mfma_f32_16x16x32_bf16 v[176:179], v[196:199], v[144:147], v[124:127]
    v_exp_f32 v164, v164
    v_exp_f32 v165, v165
    v_exp_f32 v166, v166
    v_exp_f32 v167, v167
    v_exp_f32 v180, v180
    v_exp_f32 v181, v181
    v_exp_f32 v182, v182
    v_exp_f32 v183, v183
    s_waitcnt lgkmcnt(0)
    s_mov_b32 s46, 1006632960
a_exp0:
    v_exp_f32 v160, v160
    v_exp_f32 v161, v161
    v_exp_f32 v162, v162
    v_exp_f32 v163, v163
    v_exp_f32 v176, v176
    v_exp_f32 v177, v177
    v_exp_f32 v178, v178
    v_exp_f32 v179, v179
    v_cvt_pk_bf16_f32 v200, v160, v161
    v_cvt_pk_bf16_f32 v201, v162, v163
    v_cvt_pk_bf16_f32 v202, v164, v165
    v_cvt_pk_bf16_f32 v203, v166, v167
    v_cvt_pk_bf16_f32 v204, v176, v177
    v_cvt_pk_bf16_f32 v205, v178, v179
    v_cvt_pk_bf16_f32 v206, v180, v181
    v_cvt_pk_bf16_f32 v207, v182, v183
    v_mfma_f32_16x16x32_bf16 v[16:19], v[232:235], v[200:203], 0
    s_nop 0
    v_mfma_f32_16x16x32_bf16 v[20:23], v[232:235], v[204:207], 0
    v_mfma_f32_16x16x32_bf16 v[32:35], v[216:219], v[200:203], 0
    v_mfma_f32_16x16x32_bf16 v[36:39], v[220:223], v[200:203], 0
    v_mfma_f32_16x16x32_bf16 v[48:51], v[224:227], v[204:207], 0
    v_mfma_f32_16x16x32_bf16 v[52:55], v[228:231], v[204:207], 0
    s_nop 1
    v_subrev_u32 v18, 0x21800000, v16
    s_nop 0
    v_subrev_u32 v22, 0x21800000, v20
    v_max_u32 v18, v18, v22
    v_cmp_le_u32 vcc, s46, v18
    v_rcp_f32 v16, v16
    v_rcp_f32 v20, v20
    s_cbranch_vccnz a_slow0
a_fin0:
    v_pk_mul_f32 v[32:33], v[16:17], v[32:33] op_sel_hi:[0,1]
    v_pk_mul_f32 v[34:35], v[16:17], v[34:35] op_sel_hi:[0,1]
    v_pk_mul_f32 v[36:37], v[16:17], v[36:37] op_sel_hi:[0,1]
    v_pk_mul_f32 v[38:39], v[16:17], v[38:39] op_sel_hi:[0,1]
    v_pk_mul_f32 v[48:49], v[20:21], v[48:49] op_sel_hi:[0,1]
    v_pk_mul_f32 v[50:51], v[20:21], v[50:51] op_sel_hi:[0,1]
    v_pk_mul_f32 v[52:53], v[20:21], v[52:53] op_sel_hi:[0,1]
    v_pk_mul_f32 v[54:55], v[20:21], v[54:55] op_sel_hi:[0,1]
    v_cvt_pk_bf16_f32 v32, v32, v33
    v_cvt_pk_bf16_f32 v33, v34, v35
    v_cvt_pk_bf16_f32 v34, v36, v37
    v_cvt_pk_bf16_f32 v35, v38, v39
    v_cvt_pk_bf16_f32 v48, v48, v49
    v_cvt_pk_bf16_f32 v49, v50, v51
    v_cvt_pk_bf16_f32 v50, v52, v53
    v_cvt_pk_bf16_f32 v51, v54, v55
    v_permlane32_swap_b32 v32, v34
    v_permlane32_swap_b32 v33, v35
    buffer_store_dwordx4 v[32:35], v2, s[4:7], s52 offen offset:0 sc1
    v_permlane32_swap_b32 v48, v50
    v_permlane32_swap_b32 v49, v51
    buffer_store_dwordx4 v[48:51], v2, s[4:7], s52 offen offset:2048 sc1
    s_lshl_b32 s44, s21, 22
    s_lshl_b32 s45, s38, 16
    s_add_u32 s41, s44, s45
    s_lshl_b32 s45, s18, 12
    s_add_u32 s43, s41, s45
    s_and_b32 s45, s45, 0
    s_add_u32 s41, s41, s45
    s_add_u32 s41, s41, 16777216
    buffer_load_dwordx4 v[224:227], v2, s[4:7], s43 offen offset:0 sc1
    buffer_load_dwordx4 v[228:231], v2, s[4:7], s43 offen offset:256 sc1
    buffer_load_dwordx4 v[232:235], v2, s[4:7], s43 offen offset:2048 sc1
    buffer_load_dwordx4 v[236:239], v2, s[4:7], s43 offen offset:2304 sc1
    s_barrier
    s_lshl_b32 s47, s21, 14
    s_lshl_b32 s67, s38, 8
    s_add_u32 s47, s47, s67
    s_add_u32 s47, s47, 86144
    s_mov_b32 s68, 1
    s_waitcnt vmcnt(4)
    s_atomic_add s68, s[22:23], s47 glc
    s_mov_b32 s66, 0x10000
    s_waitcnt lgkmcnt(0)
    s_cmp_eq_u32 s68, 15
    s_cbranch_scc1 c_o_ok
c_o_poll:
    s_mov_b32 s68, 0
    s_atomic_add s68, s[22:23], s47 offset:0 glc
    s_sub_u32 s66, s66, 1
    s_cselect_b32 s67, 16, 0
    s_waitcnt lgkmcnt(0)
    s_max_u32 s68, s68, s67
    s_cmp_lt_u32 s68, 16
    s_cbranch_scc1 c_o_poll
c_o_ok:
    s_branch c_wo
a_slow1:
    s_cmp_eq_u32 s46, 0
    s_cbranch_scc1 a_fin1
    s_mov_b32 s46, 0
    v_mfma_f32_16x16x32_bf16 v[172:175], v[68:71], v[132:135], v[120:123]
    v_mfma_f32_16x16x32_bf16 v[168:171], v[64:67], v[132:135], v[124:127]
    v_mfma_f32_16x16x32_bf16 v[188:191], v[84:87], v[148:151], v[120:123]
    v_mfma_f32_16x16x32_bf16 v[184:187], v[80:83], v[148:151], v[124:127]
    s_nop 5
    v_max3_f32 v24, v168, v169, v170
    v_max3_f32 v24, v24, v171, v172
    v_max3_f32 v24, v24, v173, v174
    v_max_f32 v24, v24, v175
    v_max3_f32 v26, v184, v185, v186
    v_max3_f32 v26, v26, v187, v188
    v_max3_f32 v26, v26, v189, v190
    v_max_f32 v26, v26, v191
    v_mov_b32 v25, v24
    v_mov_b32 v27, v26
    s_nop 0
    v_permlane32_swap_b32 v24, v25
    v_permlane32_swap_b32 v26, v27
    v_max_f32 v24, v24, v25
    v_max_f32 v26, v26, v27
    v_mov_b32 v25, v24
    v_mov_b32 v27, v26
    s_nop 0
    v_permlane16_swap_b32 v24, v25
    v_permlane16_swap_b32 v26, v27
    v_max_f32 v24, v24, v25
    v_max_f32 v26, v26, v27
    v_sub_f32 v168, v168, v24
    v_sub_f32 v169, v169, v24
    v_sub_f32 v170, v170, v24
    v_sub_f32 v171, v171, v24
    v_sub_f32 v172, v172, v24
    v_sub_f32 v173, v173, v24
    v_sub_f32 v174, v174, v24
    v_sub_f32 v175, v175, v24
    v_sub_f32 v184, v184, v26
    v_sub_f32 v185, v185, v26
    v_sub_f32 v186, v186, v26
    v_sub_f32 v187, v187, v26
    v_sub_f32 v188, v188, v26
    v_sub_f32 v189, v189, v26
    v_sub_f32 v190, v190, v26
    v_sub_f32 v191, v191, v26
    v_exp_f32 v172, v172
    v_exp_f32 v173, v173
    v_exp_f32 v174, v174
    v_exp_f32 v175, v175
    v_exp_f32 v188, v188
    v_exp_f32 v189, v189
    v_exp_f32 v190, v190
    v_exp_f32 v191, v191
    s_branch a_exp1
a_slow0:
    s_cmp_eq_u32 s46, 0
    s_cbranch_scc1 a_fin0
    s_mov_b32 s46, 0
    v_mfma_f32_16x16x32_bf16 v[164:167], v[64:67], v[128:131], v[120:123]
    v_mfma_f32_16x16x32_bf16 v[160:163], v[192:195], v[128:131], v[124:127]
    v_mfma_f32_16x16x32_bf16 v[180:183], v[80:83], v[144:147], v[120:123]
    v_mfma_f32_16x16x32_bf16 v[176:179], v[196:199], v[144:147], v[124:127]
    s_nop 5
    v_max3_f32 v24, v160, v161, v162
    v_max3_f32 v24, v24, v163, v164
    v_max3_f32 v24, v24, v165, v166
    v_max_f32 v24, v24, v167
    v_max3_f32 v26, v176, v177, v178
    v_max3_f32 v26, v26, v179, v180
    v_max3_f32 v26, v26, v181, v182
    v_max_f32 v26, v26, v183
    v_mov_b32 v25, v24
    v_mov_b32 v27, v26
    s_nop 0
    v_permlane32_swap_b32 v24, v25
    v_permlane32_swap_b32 v26, v27
    v_max_f32 v24, v24, v25
    v_max_f32 v26, v26, v27
    v_mov_b32 v25, v24
    v_mov_b32 v27, v26
    s_nop 0
    v_permlane16_swap_b32 v24, v25
    v_permlane16_swap_b32 v26, v27
    v_max_f32 v24, v24, v25
    v_max_f32 v26, v26, v27
    v_sub_f32 v160, v160, v24
    v_sub_f32 v161, v161, v24
    v_sub_f32 v162, v162, v24
    v_sub_f32 v163, v163, v24
    v_sub_f32 v164, v164, v24
    v_sub_f32 v165, v165, v24
    v_sub_f32 v166, v166, v24
    v_sub_f32 v167, v167, v24
    v_sub_f32 v176, v176, v26
    v_sub_f32 v177, v177, v26
    v_sub_f32 v178, v178, v26
    v_sub_f32 v179, v179, v26
    v_sub_f32 v180, v180, v26
    v_sub_f32 v181, v181, v26
    v_sub_f32 v182, v182, v26
    v_sub_f32 v183, v183, v26
    v_exp_f32 v164, v164
    v_exp_f32 v165, v165
    v_exp_f32 v166, v166
    v_exp_f32 v167, v167
    v_exp_f32 v180, v180
    v_exp_f32 v181, v181
    v_exp_f32 v182, v182
    v_exp_f32 v183, v183
    s_branch a_exp0
c_B:
    s_waitcnt lgkmcnt(6)
    v_pk_fma_f32 v[64:65], v[8:9], v[16:17], v[64:65] op_sel_hi:[0,1,1] neg_lo:[1,0,0] neg_hi:[1,0,0]
    v_pk_fma_f32 v[66:67], v[8:9], v[18:19], v[66:67] op_sel_hi:[0,1,1] neg_lo:[1,0,0] neg_hi:[1,0,0]
    v_pk_fma_f32 v[72:73], v[8:9], v[20:21], v[72:73] op_sel_hi:[0,1,1] neg_lo:[1,0,0] neg_hi:[1,0,0]
    v_pk_fma_f32 v[74:75], v[8:9], v[22:23], v[74:75] op_sel_hi:[0,1,1] neg_lo:[1,0,0] neg_hi:[1,0,0]
    v_pk_mul_f32 v[64:65], v[10:11], v[64:65] op_sel_hi:[0,1]
    v_pk_mul_f32 v[66:67], v[10:11], v[66:67] op_sel_hi:[0,1]
    v_pk_mul_f32 v[72:73], v[10:11], v[72:73] op_sel_hi:[0,1]
    v_pk_mul_f32 v[74:75], v[10:11], v[74:75] op_sel_hi:[0,1]
    v_cvt_pk_bf16_f32 v64, v64, v65
    v_cvt_pk_bf16_f32 v65, v66, v67
    v_cvt_pk_bf16_f32 v66, v72, v73
    v_cvt_pk_bf16_f32 v67, v74, v75
    s_add_u32 s55, s52, 0
    buffer_store_dwordx4 v[64:67], v2, s[4:7], s55 offen offset:0 sc1
    v_pk_fma_f32 v[68:69], v[12:13], v[16:17], v[68:69] op_sel_hi:[0,1,1] neg_lo:[1,0,0] neg_hi:[1,0,0]
    v_pk_fma_f32 v[70:71], v[12:13], v[18:19], v[70:71] op_sel_hi:[0,1,1] neg_lo:[1,0,0] neg_hi:[1,0,0]
    v_pk_fma_f32 v[76:77], v[12:13], v[20:21], v[76:77] op_sel_hi:[0,1,1] neg_lo:[1,0,0] neg_hi:[1,0,0]
    v_pk_fma_f32 v[78:79], v[12:13], v[22:23], v[78:79] op_sel_hi:[0,1,1] neg_lo:[1,0,0] neg_hi:[1,0,0]
    v_pk_mul_f32 v[68:69], v[14:15], v[68:69] op_sel_hi:[0,1]
    v_pk_mul_f32 v[70:71], v[14:15], v[70:71] op_sel_hi:[0,1]
    v_pk_mul_f32 v[76:77], v[14:15], v[76:77] op_sel_hi:[0,1]
    v_pk_mul_f32 v[78:79], v[14:15], v[78:79] op_sel_hi:[0,1]
    v_cvt_pk_bf16_f32 v68, v68, v69
    v_cvt_pk_bf16_f32 v69, v70, v71
    v_cvt_pk_bf16_f32 v70, v76, v77
    v_cvt_pk_bf16_f32 v71, v78, v79
    buffer_store_dwordx4 v[68:71], v2, s[4:7], s55 offen offset:256 sc1
    v_pk_fma_f32 v[80:81], v[8:9], v[24:25], v[80:81] op_sel_hi:[0,1,1] neg_lo:[1,0,0] neg_hi:[1,0,0]
    v_pk_fma_f32 v[82:83], v[8:9], v[26:27], v[82:83] op_sel_hi:[0,1,1] neg_lo:[1,0,0] neg_hi:[1,0,0]
    v_pk_fma_f32 v[88:89], v[8:9], v[28:29], v[88:89] op_sel_hi:[0,1,1] neg_lo:[1,0,0] neg_hi:[1,0,0]
    v_pk_fma_f32 v[90:91], v[8:9], v[30:31], v[90:91] op_sel_hi:[0,1,1] neg_lo:[1,0,0] neg_hi:[1,0,0]
    v_pk_mul_f32 v[80:81], v[10:11], v[80:81] op_sel_hi:[0,1]
    v_pk_mul_f32 v[82:83], v[10:11], v[82:83] op_sel_hi:[0,1]
    v_pk_mul_f32 v[88:89], v[10:11], v[88:89] op_sel_hi:[0,1]
    v_pk_mul_f32 v[90:91], v[10:11], v[90:91] op_sel_hi:[0,1]
    v_cvt_pk_bf16_f32 v80, v80, v81
    v_cvt_pk_bf16_f32 v81, v82, v83
    v_cvt_pk_bf16_f32 v82, v88, v89
    v_cvt_pk_bf16_f32 v83, v90, v91
    s_add_u32 s55, s52, 131072
    buffer_store_dwordx4 v[80:83], v2, s[4:7], s55 offen offset:0 sc1
    v_pk_fma_f32 v[84:85], v[12:13], v[24:25], v[84:85] op_sel_hi:[0,1,1] neg_lo:[1,0,0] neg_hi:[1,0,0]
    v_pk_fma_f32 v[86:87], v[12:13], v[26:27], v[86:87] op_sel_hi:[0,1,1] neg_lo:[1,0,0] neg_hi:[1,0,0]
    v_pk_fma_f32 v[92:93], v[12:13], v[28:29], v[92:93] op_sel_hi:[0,1,1] neg_lo:[1,0,0] neg_hi:[1,0,0]
    v_pk_fma_f32 v[94:95], v[12:13], v[30:31], v[94:95] op_sel_hi:[0,1,1] neg_lo:[1,0,0] neg_hi:[1,0,0]
    v_pk_mul_f32 v[84:85], v[14:15], v[84:85] op_sel_hi:[0,1]
    v_pk_mul_f32 v[86:87], v[14:15], v[86:87] op_sel_hi:[0,1]
    v_pk_mul_f32 v[92:93], v[14:15], v[92:93] op_sel_hi:[0,1]
    v_pk_mul_f32 v[94:95], v[14:15], v[94:95] op_sel_hi:[0,1]
    v_cvt_pk_bf16_f32 v84, v84, v85
    v_cvt_pk_bf16_f32 v85, v86, v87
    v_cvt_pk_bf16_f32 v86, v92, v93
    v_cvt_pk_bf16_f32 v87, v94, v95
    buffer_store_dwordx4 v[84:87], v2, s[4:7], s55 offen offset:256 sc1
    v_mfma_f32_16x16x32_bf16 v[96:99], v[160:163], v[32:35], v[96:99]
    ds_read_b64_tr_b16 v[60:61], v6 offset:53248
    v_mfma_f32_16x16x32_bf16 v[100:103], v[164:167], v[32:35], v[100:103]
    ds_read_b64_tr_b16 v[62:63], v6 offset:54272
    v_mfma_f32_16x16x32_bf16 v[104:107], v[160:163], v[36:39], v[104:107]
    ds_read_b64_tr_b16 v[32:33], v3 offset:57344
    v_mfma_f32_16x16x32_bf16 v[108:111], v[164:167], v[36:39], v[108:111]
    ds_read_b64_tr_b16 v[34:35], v3 offset:58368
    v_mfma_f32_16x16x32_bf16 v[112:115], v[160:163], v[40:43], v[112:115]
    ds_read_b64_tr_b16 v[36:37], v4 offset:57344
    v_mfma_f32_16x16x32_bf16 v[116:119], v[164:167], v[40:43], v[116:119]
    ds_read_b64_tr_b16 v[38:39], v4 offset:58368
    v_mfma_f32_16x16x32_bf16 v[120:123], v[160:163], v[44:47], v[120:123]
    ds_read_b64_tr_b16 v[40:41], v5 offset:57344
    v_mfma_f32_16x16x32_bf16 v[124:127], v[164:167], v[44:47], v[124:127]
    ds_read_b64_tr_b16 v[42:43], v5 offset:58368
    s_waitcnt lgkmcnt(10)
    v_mfma_f32_16x16x32_bf16 v[96:99], v[168:171], v[48:51], v[96:99]
    ds_read_b64_tr_b16 v[44:45], v6 offset:57344
    v_mfma_f32_16x16x32_bf16 v[100:103], v[172:175], v[48:51], v[100:103]
    ds_read_b64_tr_b16 v[46:47], v6 offset:58368
    v_mfma_f32_16x16x32_bf16 v[104:107], v[168:171], v[52:55], v[104:107]
    ds_read_b64_tr_b16 v[48:49], v3 offset:61440
    v_mfma_f32_16x16x32_bf16 v[108:111], v[172:175], v[52:55], v[108:111]
    ds_read_b64_tr_b16 v[50:51], v3 offset:62464
    s_waitcnt lgkmcnt(10)
    v_mfma_f32_16x16x32_bf16 v[112:115], v[168:171], v[56:59], v[112:115]
    ds_read_b64_tr_b16 v[52:53], v4 offset:61440
    v_mfma_f32_16x16x32_bf16 v[116:119], v[172:175], v[56:59], v[116:119]
    ds_read_b64_tr_b16 v[54:55], v4 offset:62464
    v_mfma_f32_16x16x32_bf16 v[120:123], v[168:171], v[60:63], v[120:123]
    ds_read_b64_tr_b16 v[56:57], v5 offset:61440
    v_mfma_f32_16x16x32_bf16 v[124:127], v[172:175], v[60:63], v[124:127]
    ds_read_b64_tr_b16 v[58:59], v5 offset:62464
    s_waitcnt lgkmcnt(10)
    v_mfma_f32_16x16x32_bf16 v[96:99], v[176:179], v[32:35], v[96:99]
    ds_read_b64_tr_b16 v[60:61], v6 offset:61440
    v_mfma_f32_16x16x32_bf16 v[100:103], v[180:183], v[32:35], v[100:103]
    ds_read_b64_tr_b16 v[62:63], v6 offset:62464
    s_barrier
    v_xor_b32 v3, 0x10000, v3
    v_xor_b32 v4, 0x10000, v4
    v_xor_b32 v5, 0x10000, v5
    v_xor_b32 v6, 0x10000, v6
    v_mfma_f32_16x16x32_bf16 v[104:107], v[176:179], v[36:39], v[104:107]
    ds_read_b64_tr_b16 v[32:33], v3 offset:0
    v_mfma_f32_16x16x32_bf16 v[108:111], v[180:183], v[36:39], v[108:111]
    ds_read_b64_tr_b16 v[34:35], v3 offset:1024
    s_waitcnt lgkmcnt(10)
    v_mfma_f32_16x16x32_bf16 v[112:115], v[176:179], v[40:43], v[112:115]
    ds_read_b64_tr_b16 v[36:37], v4 offset:0
    v_mfma_f32_16x16x32_bf16 v[116:119], v[180:183], v[40:43], v[116:119]
    ds_read_b64_tr_b16 v[38:39], v4 offset:1024
    v_mfma_f32_16x16x32_bf16 v[120:123], v[176:179], v[44:47], v[120:123]
    ds_read_b64_tr_b16 v[40:41], v5 offset:0
    v_mfma_f32_16x16x32_bf16 v[124:127], v[180:183], v[44:47], v[124:127]
    ds_read_b64_tr_b16 v[42:43], v5 offset:1024
    s_waitcnt lgkmcnt(10)
    v_mfma_f32_16x16x32_bf16 v[96:99], v[184:187], v[48:51], v[96:99]
    ds_read_b64_tr_b16 v[44:45], v6 offset:0
    v_mfma_f32_16x16x32_bf16 v[100:103], v[188:191], v[48:51], v[100:103]
    ds_read_b64_tr_b16 v[46:47], v6 offset:1024
    v_mfma_f32_16x16x32_bf16 v[104:107], v[184:187], v[52:55], v[104:107]
    ds_read_b64_tr_b16 v[48:49], v3 offset:4096
    v_mfma_f32_16x16x32_bf16 v[108:111], v[188:191], v[52:55], v[108:111]
    ds_read_b64_tr_b16 v[50:51], v3 offset:5120
    s_waitcnt lgkmcnt(10)
    v_mfma_f32_16x16x32_bf16 v[112:115], v[184:187], v[56:59], v[112:115]
    ds_read_b64_tr_b16 v[52:53], v4 offset:4096
    v_mfma_f32_16x16x32_bf16 v[116:119], v[188:191], v[56:59], v[116:119]
    ds_read_b64_tr_b16 v[54:55], v4 offset:5120
    v_mfma_f32_16x16x32_bf16 v[120:123], v[184:187], v[60:63], v[120:123]
    ds_read_b64_tr_b16 v[56:57], v5 offset:4096
    v_mfma_f32_16x16x32_bf16 v[124:127], v[188:191], v[60:63], v[124:127]
    ds_read_b64_tr_b16 v[58:59], v5 offset:5120
    s_waitcnt lgkmcnt(10)
    v_mfma_f32_16x16x32_bf16 v[96:99], v[192:195], v[32:35], v[96:99]
    ds_read_b64_tr_b16 v[60:61], v6 offset:4096
    v_mfma_f32_16x16x32_bf16 v[100:103], v[196:199], v[32:35], v[100:103]
    ds_read_b64_tr_b16 v[62:63], v6 offset:5120
    v_mfma_f32_16x16x32_bf16 v[104:107], v[192:195], v[36:39], v[104:107]
    ds_read_b64_tr_b16 v[32:33], v3 offset:8192
    v_mfma_f32_16x16x32_bf16 v[108:111], v[196:199], v[36:39], v[108:111]
    ds_read_b64_tr_b16 v[34:35], v3 offset:9216
    s_waitcnt lgkmcnt(10)
    v_mfma_f32_16x16x32_bf16 v[112:115], v[192:195], v[40:43], v[112:115]
    ds_read_b64_tr_b16 v[36:37], v4 offset:8192
    v_mfma_f32_16x16x32_bf16 v[116:119], v[196:199], v[40:43], v[116:119]
    ds_read_b64_tr_b16 v[38:39], v4 offset:9216
    v_mfma_f32_16x16x32_bf16 v[120:123], v[192:195], v[44:47], v[120:123]
    ds_read_b64_tr_b16 v[40:41], v5 offset:8192
    v_mfma_f32_16x16x32_bf16 v[124:127], v[196:199], v[44:47], v[124:127]
    ds_read_b64_tr_b16 v[42:43], v5 offset:9216
    s_waitcnt lgkmcnt(10)
    v_mfma_f32_16x16x32_bf16 v[96:99], v[200:203], v[48:51], v[96:99]
    ds_read_b64_tr_b16 v[44:45], v6 offset:8192
    v_mfma_f32_16x16x32_bf16 v[100:103], v[204:207], v[48:51], v[100:103]
    ds_read_b64_tr_b16 v[46:47], v6 offset:9216
    v_mfma_f32_16x16x32_bf16 v[104:107], v[200:203], v[52:55], v[104:107]
    ds_read_b64_tr_b16 v[48:49], v3 offset:12288
    v_mfma_f32_16x16x32_bf16 v[108:111], v[204:207], v[52:55], v[108:111]
    ds_read_b64_tr_b16 v[50:51], v3 offset:13312
    s_waitcnt lgkmcnt(10)
    v_mfma_f32_16x16x32_bf16 v[112:115], v[200:203], v[56:59], v[112:115]
    ds_read_b64_tr_b16 v[52:53], v4 offset:12288
    v_mfma_f32_16x16x32_bf16 v[116:119], v[204:207], v[56:59], v[116:119]
    ds_read_b64_tr_b16 v[54:55], v4 offset:13312
    v_mfma_f32_16x16x32_bf16 v[120:123], v[200:203], v[60:63], v[120:123]
    ds_read_b64_tr_b16 v[56:57], v5 offset:12288
    v_mfma_f32_16x16x32_bf16 v[124:127], v[204:207], v[60:63], v[124:127]
    ds_read_b64_tr_b16 v[58:59], v5 offset:13312
    s_waitcnt lgkmcnt(10)
    v_mfma_f32_16x16x32_bf16 v[96:99], v[208:211], v[32:35], v[96:99]
    ds_read_b64_tr_b16 v[60:61], v6 offset:12288
    v_mfma_f32_16x16x32_bf16 v[100:103], v[212:215], v[32:35], v[100:103]
    ds_read_b64_tr_b16 v[62:63], v6 offset:13312
    v_mfma_f32_16x16x32_bf16 v[104:107], v[208:211], v[36:39], v[104:107]
    ds_read_b64_tr_b16 v[32:33], v3 offset:16384
    ds_read_b128 v[16:19], v13 offset:4096
    v_mfma_f32_16x16x32_bf16 v[108:111], v[212:215], v[36:39], v[108:111]
    ds_read_b64_tr_b16 v[34:35], v3 offset:17408
    ds_read_b128 v[20:23], v13 offset:4608
    s_waitcnt lgkmcnt(12)
    v_mfma_f32_16x16x32_bf16 v[112:115], v[208:211], v[40:43], v[112:115]
    ds_read_b64_tr_b16 v[36:37], v4 offset:16384
    ds_read_b128 v[24:27], v13 offset:4160
    v_mfma_f32_16x16x32_bf16 v[116:119], v[212:215], v[40:43], v[116:119]
    ds_read_b64_tr_b16 v[38:39], v4 offset:17408
    ds_read_b128 v[28:31], v13 offset:4672
    v_mfma_f32_16x16x32_bf16 v[120:123], v[208:211], v[44:47], v[120:123]
    ds_read_b64_tr_b16 v[40:41], v5 offset:16384
    ds_read_b32 v8, v15 offset:512
    v_mfma_f32_16x16x32_bf16 v[124:127], v[212:215], v[44:47], v[124:127]
    ds_read_b64_tr_b16 v[42:43], v5 offset:17408
    ds_read_b32 v10, v15 offset:576
    s_waitcnt lgkmcnt(14)
    v_mfma_f32_16x16x32_bf16 v[96:99], v[216:219], v[48:51], v[96:99]
    ds_read_b64_tr_b16 v[44:45], v6 offset:16384
    ds_read_b32 v12, v15 offset:640
    v_mfma_f32_16x16x32_bf16 v[100:103], v[220:223], v[48:51], v[100:103]
    ds_read_b64_tr_b16 v[46:47], v6 offset:17408
    ds_read_b32 v14, v15 offset:704
    v_mfma_f32_16x16x32_bf16 v[104:107], v[216:219], v[52:55], v[104:107]
    ds_read_b64_tr_b16 v[48:49], v3 offset:20480
    v_mfma_f32_16x16x32_bf16 v[108:111], v[220:223], v[52:55], v[108:111]
    ds_read_b64_tr_b16 v[50:51], v3 offset:21504
    s_waitcnt lgkmcnt(14)
    v_mfma_f32_16x16x32_bf16 v[112:115], v[216:219], v[56:59], v[112:115]
    ds_read_b64_tr_b16 v[52:53], v4 offset:20480
    v_mfma_f32_16x16x32_bf16 v[116:119], v[220:223], v[56:59], v[116:119]
    ds_read_b64_tr_b16 v[54:55], v4 offset:21504
    v_mfma_f32_16x16x32_bf16 v[120:123], v[216:219], v[60:63], v[120:123]
    ds_read_b64_tr_b16 v[56:57], v5 offset:20480
    v_mfma_f32_16x16x32_bf16 v[124:127], v[220:223], v[60:63], v[124:127]
    ds_read_b64_tr_b16 v[58:59], v5 offset:21504
    s_waitcnt lgkmcnt(6)
    v_pk_fma_f32 v[96:97], v[8:9], v[16:17], v[96:97] op_sel_hi:[0,1,1] neg_lo:[1,0,0] neg_hi:[1,0,0]
    v_pk_fma_f32 v[98:99], v[8:9], v[18:19], v[98:99] op_sel_hi:[0,1,1] neg_lo:[1,0,0] neg_hi:[1,0,0]
    v_pk_fma_f32 v[104:105], v[10:11], v[16:17], v[104:105] op_sel_hi:[0,1,1] neg_lo:[1,0,0] neg_hi:[1,0,0]
    v_pk_fma_f32 v[106:107], v[10:11], v[18:19], v[106:107] op_sel_hi:[0,1,1] neg_lo:[1,0,0] neg_hi:[1,0,0]
    v_pk_mul_f32 v[96:97], v[20:21], v[96:97]
    v_pk_mul_f32 v[98:99], v[22:23], v[98:99]
    v_pk_mul_f32 v[104:105], v[20:21], v[104:105]
    v_pk_mul_f32 v[106:107], v[22:23], v[106:107]
    v_cvt_pk_bf16_f32 v72, v96, v97
    v_cvt_pk_bf16_f32 v73, v98, v99
    v_cvt_pk_bf16_f32 v74, v104, v105
    v_cvt_pk_bf16_f32 v75, v106, v107
    s_add_u32 s56, s52, 4194304
    v_permlane16_swap_b32 v72, v74
    v_permlane16_swap_b32 v73, v75
    buffer_store_dwordx4 v[72:75], v1, s[4:7], s56 offen offset:0 sc1
    v_pk_fma_f32 v[112:113], v[12:13], v[16:17], v[112:113] op_sel_hi:[0,1,1] neg_lo:[1,0,0] neg_hi:[1,0,0]
    v_pk_fma_f32 v[114:115], v[12:13], v[18:19], v[114:115] op_sel_hi:[0,1,1] neg_lo:[1,0,0] neg_hi:[1,0,0]
    v_pk_fma_f32 v[120:121], v[14:15], v[16:17], v[120:121] op_sel_hi:[0,1,1] neg_lo:[1,0,0] neg_hi:[1,0,0]
    v_pk_fma_f32 v[122:123], v[14:15], v[18:19], v[122:123] op_sel_hi:[0,1,1] neg_lo:[1,0,0] neg_hi:[1,0,0]
    v_pk_mul_f32 v[112:113], v[20:21], v[112:113]
    v_pk_mul_f32 v[114:115], v[22:23], v[114:115]
    v_pk_mul_f32 v[120:121], v[20:21], v[120:121]
    v_pk_mul_f32 v[122:123], v[22:23], v[122:123]
    v_cvt_pk_bf16_f32 v88, v112, v113
    v_cvt_pk_bf16_f32 v89, v114, v115
    v_cvt_pk_bf16_f32 v90, v120, v121
    v_cvt_pk_bf16_f32 v91, v122, v123
    s_add_u32 s56, s52, 4325376
    v_permlane16_swap_b32 v88, v90
    v_permlane16_swap_b32 v89, v91
    buffer_store_dwordx4 v[88:91], v1, s[4:7], s56 offen offset:0 sc1
    v_pk_fma_f32 v[100:101], v[8:9], v[24:25], v[100:101] op_sel_hi:[0,1,1] neg_lo:[1,0,0] neg_hi:[1,0,0]
    v_pk_fma_f32 v[102:103], v[8:9], v[26:27], v[102:103] op_sel_hi:[0,1,1] neg_lo:[1,0,0] neg_hi:[1,0,0]
    v_pk_fma_f32 v[108:109], v[10:11], v[24:25], v[108:109] op_sel_hi:[0,1,1] neg_lo:[1,0,0] neg_hi:[1,0,0]
    v_pk_fma_f32 v[110:111], v[10:11], v[26:27], v[110:111] op_sel_hi:[0,1,1] neg_lo:[1,0,0] neg_hi:[1,0,0]
    v_pk_mul_f32 v[100:101], v[28:29], v[100:101]
    v_pk_mul_f32 v[102:103], v[30:31], v[102:103]
    v_pk_mul_f32 v[108:109], v[28:29], v[108:109]
    v_pk_mul_f32 v[110:111], v[30:31], v[110:111]
    v_cvt_pk_bf16_f32 v76, v100, v101
    v_cvt_pk_bf16_f32 v77, v102, v103
    v_cvt_pk_bf16_f32 v78, v108, v109
    v_cvt_pk_bf16_f32 v79, v110, v111
    s_add_u32 s56, s52, 4194304
    v_permlane16_swap_b32 v76, v78
    v_permlane16_swap_b32 v77, v79
    buffer_store_dwordx4 v[76:79], v1, s[4:7], s56 offen offset:1024 sc1
    v_pk_fma_f32 v[116:117], v[12:13], v[24:25], v[116:117] op_sel_hi:[0,1,1] neg_lo:[1,0,0] neg_hi:[1,0,0]
    v_pk_fma_f32 v[118:119], v[12:13], v[26:27], v[118:119] op_sel_hi:[0,1,1] neg_lo:[1,0,0] neg_hi:[1,0,0]
    v_pk_fma_f32 v[124:125], v[14:15], v[24:25], v[124:125] op_sel_hi:[0,1,1] neg_lo:[1,0,0] neg_hi:[1,0,0]
    v_pk_fma_f32 v[126:127], v[14:15], v[26:27], v[126:127] op_sel_hi:[0,1,1] neg_lo:[1,0,0] neg_hi:[1,0,0]
    v_pk_mul_f32 v[116:117], v[28:29], v[116:117]
    v_pk_mul_f32 v[118:119], v[30:31], v[118:119]
    v_pk_mul_f32 v[124:125], v[28:29], v[124:125]
    v_pk_mul_f32 v[126:127], v[30:31], v[126:127]
    v_cvt_pk_bf16_f32 v92, v116, v117
    v_cvt_pk_bf16_f32 v93, v118, v119
    v_cvt_pk_bf16_f32 v94, v124, v125
    v_cvt_pk_bf16_f32 v95, v126, v127
    s_add_u32 s56, s52, 4325376
    v_permlane16_swap_b32 v92, v94
    v_permlane16_swap_b32 v93, v95
    buffer_store_dwordx4 v[92:95], v1, s[4:7], s56 offen offset:1024 sc1
    v_mfma_f32_16x16x32_bf16 v[128:131], v[32:35], v[224:227], v[128:131]
    ds_read_b64_tr_b16 v[60:61], v6 offset:20480
    v_mfma_f32_16x16x32_bf16 v[132:135], v[32:35], v[228:231], v[132:135]
    ds_read_b64_tr_b16 v[62:63], v6 offset:21504
    v_mfma_f32_16x16x32_bf16 v[136:139], v[36:39], v[224:227], v[136:139]
    ds_read_b64_tr_b16 v[32:33], v3 offset:24576
    v_mfma_f32_16x16x32_bf16 v[140:143], v[36:39], v[228:231], v[140:143]
    ds_read_b64_tr_b16 v[34:35], v3 offset:25600
    v_mfma_f32_16x16x32_bf16 v[144:147], v[40:43], v[224:227], v[144:147]
    ds_read_b64_tr_b16 v[36:37], v4 offset:24576
    v_mfma_f32_16x16x32_bf16 v[148:151], v[40:43], v[228:231], v[148:151]
    ds_read_b64_tr_b16 v[38:39], v4 offset:25600
    v_mfma_f32_16x16x32_bf16 v[152:155], v[44:47], v[224:227], v[152:155]
    ds_read_b64_tr_b16 v[40:41], v5 offset:24576
    v_mfma_f32_16x16x32_bf16 v[156:159], v[44:47], v[228:231], v[156:159]
    ds_read_b64_tr_b16 v[42:43], v5 offset:25600
    s_waitcnt lgkmcnt(10)
    v_mfma_f32_16x16x32_bf16 v[128:131], v[48:51], v[232:235], v[128:131]
    ds_read_b64_tr_b16 v[44:45], v6 offset:24576
    v_mfma_f32_16x16x32_bf16 v[132:135], v[48:51], v[236:239], v[132:135]
    ds_read_b64_tr_b16 v[46:47], v6 offset:25600
    v_mfma_f32_16x16x32_bf16 v[136:139], v[52:55], v[232:235], v[136:139]
    ds_read_b64_tr_b16 v[48:49], v3 offset:28672
    v_mfma_f32_16x16x32_bf16 v[140:143], v[52:55], v[236:239], v[140:143]
    ds_read_b64_tr_b16 v[50:51], v3 offset:29696
    s_waitcnt lgkmcnt(10)
    v_mfma_f32_16x16x32_bf16 v[144:147], v[56:59], v[232:235], v[144:147]
    ds_read_b64_tr_b16 v[52:53], v4 offset:28672
    v_mfma_f32_16x16x32_bf16 v[148:151], v[56:59], v[236:239], v[148:151]
    ds_read_b64_tr_b16 v[54:55], v4 offset:29696
    v_mfma_f32_16x16x32_bf16 v[152:155], v[60:63], v[232:235], v[152:155]
    ds_read_b64_tr_b16 v[56:57], v5 offset:28672
    v_mfma_f32_16x16x32_bf16 v[156:159], v[60:63], v[236:239], v[156:159]
    ds_read_b64_tr_b16 v[58:59], v5 offset:29696
    s_waitcnt lgkmcnt(10)
    v_mfma_f32_16x16x32_bf16 v[128:131], v[32:35], v[240:243], v[128:131]
    ds_read_b64_tr_b16 v[60:61], v6 offset:28672
    v_mfma_f32_16x16x32_bf16 v[132:135], v[32:35], v[244:247], v[132:135]
    ds_read_b64_tr_b16 v[62:63], v6 offset:29696
    s_barrier
    v_mfma_f32_16x16x32_bf16 v[136:139], v[36:39], v[240:243], v[136:139]
    ds_read_b64_tr_b16 v[32:33], v3 offset:32768
    v_mfma_f32_16x16x32_bf16 v[140:143], v[36:39], v[244:247], v[140:143]
    ds_read_b64_tr_b16 v[34:35], v3 offset:33792
    s_waitcnt lgkmcnt(10)
    v_mfma_f32_16x16x32_bf16 v[144:147], v[40:43], v[240:243], v[144:147]
    ds_read_b64_tr_b16 v[36:37], v4 offset:32768
    v_mfma_f32_16x16x32_bf16 v[148:151], v[40:43], v[244:247], v[148:151]
    ds_read_b64_tr_b16 v[38:39], v4 offset:33792
    v_mfma_f32_16x16x32_bf16 v[152:155], v[44:47], v[240:243], v[152:155]
    ds_read_b64_tr_b16 v[40:41], v5 offset:32768
    v_mfma_f32_16x16x32_bf16 v[156:159], v[44:47], v[244:247], v[156:159]
    ds_read_b64_tr_b16 v[42:43], v5 offset:33792
    s_waitcnt lgkmcnt(10)
    v_mfma_f32_16x16x32_bf16 v[128:131], v[48:51], v[248:251], v[128:131]
    ds_read_b64_tr_b16 v[44:45], v6 offset:32768
    v_mfma_f32_16x16x32_bf16 v[132:135], v[48:51], v[252:255], v[132:135]
    ds_read_b64_tr_b16 v[46:47], v6 offset:33792
    v_mfma_f32_16x16x32_bf16 v[136:139], v[52:55], v[248:251], v[136:139]
    ds_read_b64_tr_b16 v[48:49], v3 offset:36864
    v_mfma_f32_16x16x32_bf16 v[140:143], v[52:55], v[252:255], v[140:143]
    ds_read_b64_tr_b16 v[50:51], v3 offset:37888
    s_waitcnt lgkmcnt(10)
    v_mfma_f32_16x16x32_bf16 v[144:147], v[56:59], v[248:251], v[144:147]
    ds_read_b64_tr_b16 v[52:53], v4 offset:36864
    v_mfma_f32_16x16x32_bf16 v[148:151], v[56:59], v[252:255], v[148:151]
    ds_read_b64_tr_b16 v[54:55], v4 offset:37888
    v_mfma_f32_16x16x32_bf16 v[152:155], v[60:63], v[248:251], v[152:155]
    ds_read_b64_tr_b16 v[56:57], v5 offset:36864
    v_mfma_f32_16x16x32_bf16 v[156:159], v[60:63], v[252:255], v[156:159]
    ds_read_b64_tr_b16 v[58:59], v5 offset:37888
    s_waitcnt lgkmcnt(10)
    v_mfma_f32_16x16x32_bf16 v[128:131], v[32:35], v[160:163], v[128:131]
    ds_read_b64_tr_b16 v[60:61], v6 offset:36864
    v_mfma_f32_16x16x32_bf16 v[132:135], v[32:35], v[164:167], v[132:135]
    ds_read_b64_tr_b16 v[62:63], v6 offset:37888
    v_mfma_f32_16x16x32_bf16 v[136:139], v[36:39], v[160:163], v[136:139]
    ds_read_b64_tr_b16 v[32:33], v3 offset:40960
    v_mfma_f32_16x16x32_bf16 v[140:143], v[36:39], v[164:167], v[140:143]
    ds_read_b64_tr_b16 v[34:35], v3 offset:41984
    s_waitcnt lgkmcnt(10)
    v_mfma_f32_16x16x32_bf16 v[144:147], v[40:43], v[160:163], v[144:147]
    ds_read_b64_tr_b16 v[36:37], v4 offset:40960
    v_mfma_f32_16x16x32_bf16 v[148:151], v[40:43], v[164:167], v[148:151]
    ds_read_b64_tr_b16 v[38:39], v4 offset:41984
    v_mfma_f32_16x16x32_bf16 v[152:155], v[44:47], v[160:163], v[152:155]
    ds_read_b64_tr_b16 v[40:41], v5 offset:40960
    v_mfma_f32_16x16x32_bf16 v[156:159], v[44:47], v[164:167], v[156:159]
    ds_read_b64_tr_b16 v[42:43], v5 offset:41984
    s_waitcnt lgkmcnt(10)
    v_mfma_f32_16x16x32_bf16 v[128:131], v[48:51], v[168:171], v[128:131]
    ds_read_b64_tr_b16 v[44:45], v6 offset:40960
    v_mfma_f32_16x16x32_bf16 v[132:135], v[48:51], v[172:175], v[132:135]
    ds_read_b64_tr_b16 v[46:47], v6 offset:41984
    v_mfma_f32_16x16x32_bf16 v[136:139], v[52:55], v[168:171], v[136:139]
    ds_read_b64_tr_b16 v[48:49], v3 offset:45056
    v_mfma_f32_16x16x32_bf16 v[140:143], v[52:55], v[172:175], v[140:143]
    ds_read_b64_tr_b16 v[50:51], v3 offset:46080
    s_waitcnt lgkmcnt(10)
    v_mfma_f32_16x16x32_bf16 v[144:147], v[56:59], v[168:171], v[144:147]
    ds_read_b64_tr_b16 v[52:53], v4 offset:45056
    v_mfma_f32_16x16x32_bf16 v[148:151], v[56:59], v[172:175], v[148:151]
    ds_read_b64_tr_b16 v[54:55], v4 offset:46080
    v_mfma_f32_16x16x32_bf16 v[152:155], v[60:63], v[168:171], v[152:155]
    ds_read_b64_tr_b16 v[56:57], v5 offset:45056
    v_mfma_f32_16x16x32_bf16 v[156:159], v[60:63], v[172:175], v[156:159]
    ds_read_b64_tr_b16 v[58:59], v5 offset:46080
    s_waitcnt lgkmcnt(10)
    v_mfma_f32_16x16x32_bf16 v[128:131], v[32:35], v[176:179], v[128:131]
    ds_read_b64_tr_b16 v[60:61], v6 offset:45056
    v_mfma_f32_16x16x32_bf16 v[132:135], v[32:35], v[180:183], v[132:135]
    ds_read_b64_tr_b16 v[62:63], v6 offset:46080
    v_mfma_f32_16x16x32_bf16 v[136:139], v[36:39], v[176:179], v[136:139]
    ds_read_b64_tr_b16 v[32:33], v3 offset:49152
    v_mfma_f32_16x16x32_bf16 v[140:143], v[36:39], v[180:183], v[140:143]
    ds_read_b64_tr_b16 v[34:35], v3 offset:50176
    s_waitcnt lgkmcnt(10)
    v_mfma_f32_16x16x32_bf16 v[144:147], v[40:43], v[176:179], v[144:147]
    ds_read_b64_tr_b16 v[36:37], v4 offset:49152
    v_mfma_f32_16x16x32_bf16 v[148:151], v[40:43], v[180:183], v[148:151]
    ds_read_b64_tr_b16 v[38:39], v4 offset:50176
    v_mfma_f32_16x16x32_bf16 v[152:155], v[44:47], v[176:179], v[152:155]
    ds_read_b64_tr_b16 v[40:41], v5 offset:49152
    v_mfma_f32_16x16x32_bf16 v[156:159], v[44:47], v[180:183], v[156:159]
    ds_read_b64_tr_b16 v[42:43], v5 offset:50176
    s_waitcnt lgkmcnt(10)
    v_mfma_f32_16x16x32_bf16 v[128:131], v[48:51], v[184:187], v[128:131]
    ds_read_b64_tr_b16 v[44:45], v6 offset:49152
    s_mov_b32 s68, 1
    s_waitcnt vmcnt(0)
    s_atomic_add s68, s[22:23], s59 glc
    s_mov_b32 s55, s52
    s_add_u32 s56, s52, 4194304
    ds_read_b32 v8, v9 offset:4096
    v_mfma_f32_16x16x32_bf16 v[132:135], v[48:51], v[188:191], v[132:135]
    ds_read_b64_tr_b16 v[46:47], v6 offset:50176
    buffer_load_dwordx4 v[64:67], v1, s[4:7], s55 offen offset:0 sc1
    ds_read_b32 v10, v9 offset:4608
    v_mfma_f32_16x16x32_bf16 v[136:139], v[52:55], v[184:187], v[136:139]
    ds_read_b64_tr_b16 v[48:49], v3 offset:53248
    buffer_load_dwordx4 v[68:71], v1, s[4:7], s55 offen offset:1024 sc1
    ds_read_b32 v12, v9 offset:4160
    v_mfma_f32_16x16x32_bf16 v[140:143], v[52:55], v[188:191], v[140:143]
    ds_read_b64_tr_b16 v[50:51], v3 offset:54272
    buffer_load_dwordx4 v[72:75], v1, s[4:7], s56 offen offset:0 sc1
    ds_read_b32 v14, v9 offset:4672
    s_waitcnt lgkmcnt(14)
    v_mfma_f32_16x16x32_bf16 v[144:147], v[56:59], v[184:187], v[144:147]
    ds_read_b64_tr_b16 v[52:53], v4 offset:53248
    buffer_load_dwordx4 v[76:79], v1, s[4:7], s56 offen offset:1024 sc1
    ds_read_b128 v[16:19], v11 offset:0
    v_mfma_f32_16x16x32_bf16 v[148:151], v[56:59], v[188:191], v[148:151]
    ds_read_b64_tr_b16 v[54:55], v4 offset:54272
    ds_read_b128 v[20:23], v11 offset:64
    v_mfma_f32_16x16x32_bf16 v[152:155], v[60:63], v[184:187], v[152:155]
    ds_read_b64_tr_b16 v[56:57], v5 offset:53248
    ds_read_b128 v[24:27], v11 offset:128
    v_mfma_f32_16x16x32_bf16 v[156:159], v[60:63], v[188:191], v[156:159]
    ds_read_b64_tr_b16 v[58:59], v5 offset:54272
    ds_read_b128 v[28:31], v11 offset:192
    s_waitcnt lgkmcnt(14)
    v_mfma_f32_16x16x32_bf16 v[128:131], v[32:35], v[192:195], v[128:131]
    ds_read_b64_tr_b16 v[60:61], v6 offset:53248
    v_mfma_f32_16x16x32_bf16 v[132:135], v[32:35], v[196:199], v[132:135]
    ds_read_b64_tr_b16 v[62:63], v6 offset:54272
    v_mfma_f32_16x16x32_bf16 v[136:139], v[36:39], v[192:195], v[136:139]
    ds_read_b64_tr_b16 v[32:33], v3 offset:57344
    v_mfma_f32_16x16x32_bf16 v[140:143], v[36:39], v[196:199], v[140:143]
    ds_read_b64_tr_b16 v[34:35], v3 offset:58368
    s_waitcnt lgkmcnt(14)
    v_mfma_f32_16x16x32_bf16 v[144:147], v[40:43], v[192:195], v[144:147]
    ds_read_b64_tr_b16 v[36:37], v4 offset:57344
    v_mfma_f32_16x16x32_bf16 v[148:151], v[40:43], v[196:199], v[148:151]
    ds_read_b64_tr_b16 v[38:39], v4 offset:58368
    v_mfma_f32_16x16x32_bf16 v[152:155], v[44:47], v[192:195], v[152:155]
    ds_read_b64_tr_b16 v[40:41], v5 offset:57344
    v_mfma_f32_16x16x32_bf16 v[156:159], v[44:47], v[196:199], v[156:159]
    ds_read_b64_tr_b16 v[42:43], v5 offset:58368
    s_waitcnt lgkmcnt(13)
    v_mfma_f32_16x16x32_bf16 v[128:131], v[48:51], v[200:203], v[128:131]
    ds_read_b64_tr_b16 v[44:45], v6 offset:57344
    s_waitcnt lgkmcnt(9)
    v_mfma_f32_16x16x32_bf16 v[132:135], v[48:51], v[204:207], v[132:135]
    ds_read_b64_tr_b16 v[46:47], v6 offset:58368
    v_mul_f32 v10, 0x3e8293ee, v10
    v_mfma_f32_16x16x32_bf16 v[136:139], v[52:55], v[200:203], v[136:139]
    ds_read_b64_tr_b16 v[48:49], v3 offset:61440
    v_mul_f32 v14, 0x3e8293ee, v14
    v_mfma_f32_16x16x32_bf16 v[140:143], v[52:55], v[204:207], v[140:143]
    ds_read_b64_tr_b16 v[50:51], v3 offset:62464
    s_lshl_b32 s44, s16, 11
    s_waitcnt lgkmcnt(10)
    v_mfma_f32_16x16x32_bf16 v[144:147], v[56:59], v[200:203], v[144:147]
    ds_read_b64_tr_b16 v[52:53], v4 offset:61440
    s_add_u32 s44, s44, 131072
    v_mfma_f32_16x16x32_bf16 v[148:151], v[56:59], v[204:207], v[148:151]
    ds_read_b64_tr_b16 v[54:55], v4 offset:62464
    v_add_u32 v13, s44, v2
    v_mfma_f32_16x16x32_bf16 v[152:155], v[60:63], v[200:203], v[152:155]
    ds_read_b64_tr_b16 v[56:57], v5 offset:61440
    v_mfma_f32_16x16x32_bf16 v[156:159], v[60:63], v[204:207], v[156:159]
    ds_read_b64_tr_b16 v[58:59], v5 offset:62464
    s_waitcnt lgkmcnt(10)
    v_mfma_f32_16x16x32_bf16 v[128:131], v[32:35], v[208:211], v[128:131]
    ds_read_b64_tr_b16 v[60:61], v6 offset:61440
    v_mfma_f32_16x16x32_bf16 v[132:135], v[32:35], v[212:215], v[132:135]
    ds_read_b64_tr_b16 v[62:63], v6 offset:62464
    v_xor_b32 v3, 0x10000, v3
    v_xor_b32 v4, 0x10000, v4
    v_xor_b32 v5, 0x10000, v5
    v_xor_b32 v6, 0x10000, v6
    v_mfma_f32_16x16x32_bf16 v[136:139], v[36:39], v[208:211], v[136:139]
    v_mfma_f32_16x16x32_bf16 v[140:143], v[36:39], v[212:215], v[140:143]
    s_waitcnt lgkmcnt(8)
    v_mfma_f32_16x16x32_bf16 v[144:147], v[40:43], v[208:211], v[144:147]
    v_mfma_f32_16x16x32_bf16 v[148:151], v[40:43], v[212:215], v[148:151]
    v_mfma_f32_16x16x32_bf16 v[152:155], v[44:47], v[208:211], v[152:155]
    v_mfma_f32_16x16x32_bf16 v[156:159], v[44:47], v[212:215], v[156:159]
    s_waitcnt lgkmcnt(4)
    v_mfma_f32_16x16x32_bf16 v[128:131], v[48:51], v[216:219], v[128:131]
    v_mfma_f32_16x16x32_bf16 v[132:135], v[48:51], v[220:223], v[132:135]
    v_mfma_f32_16x16x32_bf16 v[136:139], v[52:55], v[216:219], v[136:139]
    v_mfma_f32_16x16x32_bf16 v[140:143], v[52:55], v[220:223], v[140:143]
    s_waitcnt lgkmcnt(0)
    v_mfma_f32_16x16x32_bf16 v[144:147], v[56:59], v[216:219], v[144:147]
    v_mfma_f32_16x16x32_bf16 v[148:151], v[56:59], v[220:223], v[148:151]
    v_mfma_f32_16x16x32_bf16 v[152:155], v[60:63], v[216:219], v[152:155]
    v_mfma_f32_16x16x32_bf16 v[156:159], v[60:63], v[220:223], v[156:159]
    v_pk_fma_f32 v[128:129], v[8:9], v[16:17], v[128:129] op_sel_hi:[0,1,1] neg_lo:[1,0,0] neg_hi:[1,0,0]
    v_pk_fma_f32 v[130:131], v[8:9], v[18:19], v[130:131] op_sel_hi:[0,1,1] neg_lo:[1,0,0] neg_hi:[1,0,0]
    v_pk_fma_f32 v[136:137], v[8:9], v[20:21], v[136:137] op_sel_hi:[0,1,1] neg_lo:[1,0,0] neg_hi:[1,0,0]
    v_pk_fma_f32 v[138:139], v[8:9], v[22:23], v[138:139] op_sel_hi:[0,1,1] neg_lo:[1,0,0] neg_hi:[1,0,0]
    v_pk_mul_f32 v[128:129], v[10:11], v[128:129] op_sel_hi:[0,1]
    v_pk_mul_f32 v[130:131], v[10:11], v[130:131] op_sel_hi:[0,1]
    v_pk_mul_f32 v[136:137], v[10:11], v[136:137] op_sel_hi:[0,1]
    v_pk_mul_f32 v[138:139], v[10:11], v[138:139] op_sel_hi:[0,1]
    v_cvt_pk_bf16_f32 v128, v128, v129
    v_cvt_pk_bf16_f32 v129, v130, v131
    v_cvt_pk_bf16_f32 v130, v136, v137
    v_cvt_pk_bf16_f32 v131, v138, v139
    ds_write_b128 v13, v[128:131] offset:0
    v_pk_fma_f32 v[132:133], v[12:13], v[16:17], v[132:133] op_sel_hi:[0,1,1] neg_lo:[1,0,0] neg_hi:[1,0,0]
    v_pk_fma_f32 v[134:135], v[12:13], v[18:19], v[134:135] op_sel_hi:[0,1,1] neg_lo:[1,0,0] neg_hi:[1,0,0]
    v_pk_fma_f32 v[140:141], v[12:13], v[20:21], v[140:141] op_sel_hi:[0,1,1] neg_lo:[1,0,0] neg_hi:[1,0,0]
    v_pk_fma_f32 v[142:143], v[12:13], v[22:23], v[142:143] op_sel_hi:[0,1,1] neg_lo:[1,0,0] neg_hi:[1,0,0]
    v_pk_mul_f32 v[132:133], v[14:15], v[132:133] op_sel_hi:[0,1]
    v_pk_mul_f32 v[134:135], v[14:15], v[134:135] op_sel_hi:[0,1]
    v_pk_mul_f32 v[140:141], v[14:15], v[140:141] op_sel_hi:[0,1]
    v_pk_mul_f32 v[142:143], v[14:15], v[142:143] op_sel_hi:[0,1]
    v_cvt_pk_bf16_f32 v132, v132, v133
    v_cvt_pk_bf16_f32 v133, v134, v135
    v_cvt_pk_bf16_f32 v134, v140, v141
    v_cvt_pk_bf16_f32 v135, v142, v143
    ds_write_b128 v13, v[132:135] offset:256
    v_add_u32 v4, 131072, v1
    s_waitcnt lgkmcnt(0)
    s_cmp_eq_u32 s68, 15
    s_cselect_b32 s68, 16, 0
    s_cbranch_scc1 b_k2
    s_atomic_add s68, s[22:23], s59 glc
b_k2:
    s_barrier
    ds_read_b128 v[32:35], v4 offset:0
    ds_read_b128 v[36:39], v4 offset:1024
    ds_read_b128 v[40:43], v4 offset:2048
    ds_read_b128 v[44:47], v4 offset:3072
    ds_read_b128 v[48:51], v4 offset:4096
    ds_read_b128 v[52:55], v4 offset:5120
    ds_read_b128 v[56:59], v4 offset:6144
    ds_read_b128 v[60:63], v4 offset:7168
    v_pk_fma_f32 v[144:145], v[8:9], v[24:25], v[144:145] op_sel_hi:[0,1,1] neg_lo:[1,0,0] neg_hi:[1,0,0]
    v_pk_fma_f32 v[146:147], v[8:9], v[26:27], v[146:147] op_sel_hi:[0,1,1] neg_lo:[1,0,0] neg_hi:[1,0,0]
    v_pk_fma_f32 v[152:153], v[8:9], v[28:29], v[152:153] op_sel_hi:[0,1,1] neg_lo:[1,0,0] neg_hi:[1,0,0]
    v_pk_fma_f32 v[154:155], v[8:9], v[30:31], v[154:155] op_sel_hi:[0,1,1] neg_lo:[1,0,0] neg_hi:[1,0,0]
    v_pk_mul_f32 v[144:145], v[10:11], v[144:145] op_sel_hi:[0,1]
    v_pk_mul_f32 v[146:147], v[10:11], v[146:147] op_sel_hi:[0,1]
    v_pk_mul_f32 v[152:153], v[10:11], v[152:153] op_sel_hi:[0,1]
    v_pk_mul_f32 v[154:155], v[10:11], v[154:155] op_sel_hi:[0,1]
    v_cvt_pk_bf16_f32 v144, v144, v145
    v_cvt_pk_bf16_f32 v145, v146, v147
    v_cvt_pk_bf16_f32 v146, v152, v153
    v_cvt_pk_bf16_f32 v147, v154, v155
    ds_write_b128 v13, v[144:147] offset:8192
    s_waitcnt vmcnt(0) lgkmcnt(7)
    v_mfma_f32_32x32x16_bf16 v[192:207], v[64:67], v[32:35], 0
    v_mfma_f32_32x32x16_bf16 v[192:207], v[68:71], v[36:39], v[192:207]
    v_pk_fma_f32 v[148:149], v[12:13], v[24:25], v[148:149] op_sel_hi:[0,1,1] neg_lo:[1,0,0] neg_hi:[1,0,0]
    v_pk_fma_f32 v[150:151], v[12:13], v[26:27], v[150:151] op_sel_hi:[0,1,1] neg_lo:[1,0,0] neg_hi:[1,0,0]
    v_pk_fma_f32 v[156:157], v[12:13], v[28:29], v[156:157] op_sel_hi:[0,1,1] neg_lo:[1,0,0] neg_hi:[1,0,0]
    v_pk_fma_f32 v[158:159], v[12:13], v[30:31], v[158:159] op_sel_hi:[0,1,1] neg_lo:[1,0,0] neg_hi:[1,0,0]
    v_pk_mul_f32 v[148:149], v[14:15], v[148:149] op_sel_hi:[0,1]
    v_pk_mul_f32 v[150:151], v[14:15], v[150:151] op_sel_hi:[0,1]
    v_pk_mul_f32 v[156:157], v[14:15], v[156:157] op_sel_hi:[0,1]
    v_pk_mul_f32 v[158:159], v[14:15], v[158:159] op_sel_hi:[0,1]
    v_cvt_pk_bf16_f32 v148, v148, v149
    v_cvt_pk_bf16_f32 v149, v150, v151
    v_cvt_pk_bf16_f32 v150, v156, v157
    v_cvt_pk_bf16_f32 v151, v158, v159
    ds_write_b128 v13, v[148:151] offset:8448
    v_mov_b32 v9, 0xdddddddd
    v_bfe_u32 v10, v1, 4, 3
    v_mov_b32 v11, 0x3f803f80
    v_cmp_eq_u32 vcc, 0, v10
    v_cmp_eq_u32 s[44:45], 4, v10
    s_mov_b32 s57, 0
    v_cndmask_b32 v28, 0, v11, vcc
    v_cndmask_b32 v29, 0, v11, vcc
    v_cndmask_b32 v30, 0, v11, s[44:45]
    v_cndmask_b32 v31, 0, v11, s[44:45]
    v_mov_b32 v10, 0
    v_mov_b32 v11, 0
    s_mov_b32 s66, 0x10000
    s_waitcnt lgkmcnt(0)
    s_cmp_eq_u32 s68, 16
    s_cbranch_scc1 c_k_ok
c_k_poll:
    s_mov_b32 s68, 0
    s_atomic_add s68, s[22:23], s59 offset:0 glc
    s_sub_u32 s66, s66, 1
    s_cselect_b32 s67, 16, 0
    s_waitcnt lgkmcnt(0)
    s_max_u32 s68, s68, s67
    s_cmp_lt_u32 s68, 16
    s_cbranch_scc1 c_k_poll
c_k_ok:
    s_add_u32 s54, s54, 8192
    s_and_b32 s54, s54, 0x1ffff
    s_add_u32 s55, s53, s54
    s_add_u32 s56, s55, 4194304
    buffer_load_dwordx4 v[80:83], v1, s[4:7], s55 offen offset:0 sc1
    buffer_load_dwordx4 v[84:87], v1, s[4:7], s55 offen offset:1024 sc1
    buffer_load_dwordx4 v[88:91], v1, s[4:7], s56 offen offset:0 sc1
    buffer_load_dwordx4 v[92:95], v1, s[4:7], s56 offen offset:1024 sc1
    s_add_u32 s54, s54, 8192
    s_and_b32 s54, s54, 0x1ffff
    s_add_u32 s55, s53, s54
    s_add_u32 s56, s55, 4194304
    buffer_load_dwordx4 v[96:99], v1, s[4:7], s55 offen offset:0 sc1
    buffer_load_dwordx4 v[100:103], v1, s[4:7], s55 offen offset:1024 sc1
    buffer_load_dwordx4 v[104:107], v1, s[4:7], s56 offen offset:0 sc1
    buffer_load_dwordx4 v[108:111], v1, s[4:7], s56 offen offset:1024 sc1
    v_mfma_f32_32x32x16_bf16 v[208:223], v[64:67], v[40:43], 0
    s_add_u32 s54, s54, 8192
    s_and_b32 s54, s54, 0x1ffff
    s_add_u32 s55, s53, s54
    s_add_u32 s56, s55, 4194304
    v_exp_f32 v192, v192
    v_exp_f32 v193, v193
    v_exp_f32 v194, v194
    v_mfma_f32_32x32x8_bf16 v[128:143], v[10:11], v[10:11], 0
    v_mov_b32 v12, 0
    v_exp_f32 v195, v195
    v_exp_f32 v196, v196
    v_exp_f32 v197, v197
    v_mfma_f32_32x32x16_bf16 v[208:223], v[68:71], v[44:47], v[208:223]
    v_exp_f32 v198, v198
    v_exp_f32 v199, v199
    v_exp_f32 v200, v200
    v_mfma_f32_32x32x8_bf16 v[144:159], v[10:11], v[10:11], 0
    v_mov_b32 v16, 0
    v_exp_f32 v201, v201
    v_exp_f32 v202, v202
    v_mfma_f32_32x32x8_bf16 v[160:175], v[10:11], v[10:11], 0
    v_mov_b32 v20, 0
    s_lshl_b32 s44, s16, 12
    s_add_u32 s44, s44, 65536
    v_add_u32 v5, s44, v1
    s_lshl_b32 s44, s16, 8
    s_add_u32 s44, s44, 147456
    v_lshrrev_b32 v6, 2, v1
    v_add_u32 v6, s44, v6
    s_lshl_b32 s44, s21, 22
    s_lshl_b32 s45, s38, 16
    s_add_u32 s41, s44, s45
    s_lshl_b32 s45, s18, 12
    s_add_u32 s43, s41, s45
    s_and_b32 s45, s45, 0
    s_add_u32 s41, s41, s45
    s_add_u32 s41, s41, 16777216
    v_exp_f32 v203, v203
    v_exp_f32 v204, v204
    buffer_load_dwordx4 v[112:115], v1, s[4:7], s55 offen offset:0 sc1
    v_exp_f32 v205, v205
    v_mfma_f32_32x32x8_bf16 v[176:191], v[10:11], v[10:11], 0
    v_mov_b32 v24, 0
    v_exp_f32 v206, v206
    v_exp_f32 v207, v207
    v_mfma_f32_32x32x16_bf16 v[224:239], v[64:67], v[48:51], 0
    v_exp_f32 v208, v208
    v_exp_f32 v209, v209
    v_exp_f32 v210, v210
    v_smfmac_f32_32x32x32_bf16 v[128:143], v[72:75], v[192:199], v9
    v_exp_f32 v211, v211
    v_exp_f32 v212, v212
    v_exp_f32 v213, v213
    v_mfma_f32_32x32x16_bf16 v[224:239], v[68:71], v[52:55], v[224:239]
    v_exp_f32 v214, v214
    v_exp_f32 v215, v215
    v_exp_f32 v216, v216
    v_smfmac_f32_16x16x64_bf16 v[12:15], v[28:31], v[192:199], v9
    v_exp_f32 v217, v217
    v_smfmac_f32_32x32x32_bf16 v[128:143], v[76:79], v[200:207], v9
    v_exp_f32 v218, v218
    v_exp_f32 v219, v219
    v_exp_f32 v220, v220
    v_smfmac_f32_16x16x64_bf16 v[12:15], v[28:31], v[200:207], v9
    buffer_load_dwordx4 v[116:119], v1, s[4:7], s55 offen offset:1024 sc1
    v_exp_f32 v221, v221
    v_exp_f32 v222, v222
    v_exp_f32 v223, v223
b_head:
    s_mov_b32 s58, 3
b_loop:
    v_mfma_f32_32x32x16_bf16 v[240:255], v[64:67], v[56:59], 0
    v_exp_f32 v224, v224
    v_exp_f32 v225, v225
    v_exp_f32 v226, v226
    v_smfmac_f32_32x32x32_bf16 v[144:159], v[72:75], v[208:215], v9
    v_exp_f32 v227, v227
    v_exp_f32 v228, v228
    v_exp_f32 v229, v229
    v_mfma_f32_32x32x16_bf16 v[240:255], v[68:71], v[60:63], v[240:255]
    v_exp_f32 v230, v230
    v_exp_f32 v231, v231
    v_exp_f32 v232, v232
    v_smfmac_f32_16x16x64_bf16 v[16:19], v[28:31], v[208:215], v9
    v_exp_f32 v233, v233
    v_smfmac_f32_32x32x32_bf16 v[144:159], v[76:79], v[216:223], v9
    v_exp_f32 v234, v234
    v_exp_f32 v235, v235
    v_exp_f32 v236, v236
    v_smfmac_f32_16x16x64_bf16 v[16:19], v[28:31], v[216:223], v9
    buffer_load_dwordx4 v[120:123], v1, s[4:7], s56 offen offset:0 sc1
    v_exp_f32 v237, v237
    v_exp_f32 v238, v238
    v_exp_f32 v239, v239
    s_waitcnt vmcnt(7)
    v_mfma_f32_32x32x16_bf16 v[192:207], v[80:83], v[32:35], 0
    v_exp_f32 v240, v240
    v_exp_f32 v241, v241
    v_exp_f32 v242, v242
    v_smfmac_f32_32x32x32_bf16 v[160:175], v[72:75], v[224:231], v9
    v_exp_f32 v243, v243
    v_exp_f32 v244, v244
    v_exp_f32 v245, v245
    v_mfma_f32_32x32x16_bf16 v[192:207], v[84:87], v[36:39], v[192:207]
    v_exp_f32 v246, v246
    v_exp_f32 v247, v247
    v_exp_f32 v248, v248
    v_smfmac_f32_16x16x64_bf16 v[20:23], v[28:31], v[224:231], v9
    v_exp_f32 v249, v249
    v_smfmac_f32_32x32x32_bf16 v[160:175], v[76:79], v[232:239], v9
    v_exp_f32 v250, v250
    v_exp_f32 v251, v251
    v_exp_f32 v252, v252
    v_smfmac_f32_16x16x64_bf16 v[20:23], v[28:31], v[232:239], v9
    buffer_load_dwordx4 v[124:127], v1, s[4:7], s56 offen offset:1024 sc1
    v_exp_f32 v253, v253
    v_exp_f32 v254, v254
    v_exp_f32 v255, v255
    v_mfma_f32_32x32x16_bf16 v[208:223], v[80:83], v[40:43], 0
    s_add_u32 s54, s54, 8192
    s_and_b32 s54, s54, 0x1ffff
    s_add_u32 s55, s53, s54
    s_add_u32 s56, s55, 4194304
    v_exp_f32 v192, v192
    v_exp_f32 v193, v193
    v_exp_f32 v194, v194
    v_smfmac_f32_32x32x32_bf16 v[176:191], v[72:75], v[240:247], v9
    v_exp_f32 v195, v195
    v_exp_f32 v196, v196
    v_exp_f32 v197, v197
    v_mfma_f32_32x32x16_bf16 v[208:223], v[84:87], v[44:47], v[208:223]
    v_exp_f32 v198, v198
    v_exp_f32 v199, v199
    v_exp_f32 v200, v200
    v_smfmac_f32_16x16x64_bf16 v[24:27], v[28:31], v[240:247], v9
    v_exp_f32 v201, v201
    v_smfmac_f32_32x32x32_bf16 v[176:191], v[76:79], v[248:255], v9
    v_exp_f32 v202, v202
    v_exp_f32 v203, v203
    v_exp_f32 v204, v204
    v_smfmac_f32_16x16x64_bf16 v[24:27], v[28:31], v[248:255], v9
    buffer_load_dwordx4 v[64:67], v1, s[4:7], s55 offen offset:0 sc1
    v_exp_f32 v205, v205
    v_exp_f32 v206, v206
    v_exp_f32 v207, v207
    v_mfma_f32_32x32x16_bf16 v[224:239], v[80:83], v[48:51], 0
    v_exp_f32 v208, v208
    v_exp_f32 v209, v209
    v_exp_f32 v210, v210
    v_smfmac_f32_32x32x32_bf16 v[128:143], v[88:91], v[192:199], v9
    v_exp_f32 v211, v211
    v_exp_f32 v212, v212
    v_exp_f32 v213, v213
    v_mfma_f32_32x32x16_bf16 v[224:239], v[84:87], v[52:55], v[224:239]
    v_exp_f32 v214, v214
    v_exp_f32 v215, v215
    v_exp_f32 v216, v216
    v_smfmac_f32_16x16x64_bf16 v[12:15], v[28:31], v[192:199], v9
    v_exp_f32 v217, v217
    v_smfmac_f32_32x32x32_bf16 v[128:143], v[92:95], v[200:207], v9
    v_exp_f32 v218, v218
    v_exp_f32 v219, v219
    v_exp_f32 v220, v220
    v_smfmac_f32_16x16x64_bf16 v[12:15], v[28:31], v[200:207], v9
    buffer_load_dwordx4 v[68:71], v1, s[4:7], s55 offen offset:1024 sc1
    v_exp_f32 v221, v221
    v_exp_f32 v222, v222
    v_exp_f32 v223, v223
    v_mfma_f32_32x32x16_bf16 v[240:255], v[80:83], v[56:59], 0
    v_exp_f32 v224, v224
    v_exp_f32 v225, v225
    v_exp_f32 v226, v226
    v_smfmac_f32_32x32x32_bf16 v[144:159], v[88:91], v[208:215], v9
    v_exp_f32 v227, v227
    v_exp_f32 v228, v228
    v_exp_f32 v229, v229
    v_mfma_f32_32x32x16_bf16 v[240:255], v[84:87], v[60:63], v[240:255]
    v_exp_f32 v230, v230
    v_exp_f32 v231, v231
    v_exp_f32 v232, v232
    v_smfmac_f32_16x16x64_bf16 v[16:19], v[28:31], v[208:215], v9
    v_exp_f32 v233, v233
    v_smfmac_f32_32x32x32_bf16 v[144:159], v[92:95], v[216:223], v9
    v_exp_f32 v234, v234
    v_exp_f32 v235, v235
    v_exp_f32 v236, v236
    v_smfmac_f32_16x16x64_bf16 v[16:19], v[28:31], v[216:223], v9
    buffer_load_dwordx4 v[72:75], v1, s[4:7], s56 offen offset:0 sc1
    v_exp_f32 v237, v237
    v_exp_f32 v238, v238
    v_exp_f32 v239, v239
    s_waitcnt vmcnt(7)
    v_mfma_f32_32x32x16_bf16 v[192:207], v[96:99], v[32:35], 0
    v_exp_f32 v240, v240
    v_exp_f32 v241, v241
    v_exp_f32 v242, v242
    v_smfmac_f32_32x32x32_bf16 v[160:175], v[88:91], v[224:231], v9
    v_exp_f32 v243, v243
    v_exp_f32 v244, v244
    v_exp_f32 v245, v245
    v_mfma_f32_32x32x16_bf16 v[192:207], v[100:103], v[36:39], v[192:207]
    v_exp_f32 v246, v246
    v_exp_f32 v247, v247
    v_exp_f32 v248, v248
    v_smfmac_f32_16x16x64_bf16 v[20:23], v[28:31], v[224:231], v9
    v_exp_f32 v249, v249
    v_smfmac_f32_32x32x32_bf16 v[160:175], v[92:95], v[232:239], v9
    v_exp_f32 v250, v250
    v_exp_f32 v251, v251
    v_exp_f32 v252, v252
    v_smfmac_f32_16x16x64_bf16 v[20:23], v[28:31], v[232:239], v9
    buffer_load_dwordx4 v[76:79], v1, s[4:7], s56 offen offset:1024 sc1
    v_exp_f32 v253, v253
    v_exp_f32 v254, v254
    v_exp_f32 v255, v255
    v_mfma_f32_32x32x16_bf16 v[208:223], v[96:99], v[40:43], 0
    s_add_u32 s54, s54, 8192
    s_and_b32 s54, s54, 0x1ffff
    s_add_u32 s55, s53, s54
    s_add_u32 s56, s55, 4194304
    v_exp_f32 v192, v192
    v_exp_f32 v193, v193
    v_exp_f32 v194, v194
    v_smfmac_f32_32x32x32_bf16 v[176:191], v[88:91], v[240:247], v9
    v_exp_f32 v195, v195
    v_exp_f32 v196, v196
    v_exp_f32 v197, v197
    v_mfma_f32_32x32x16_bf16 v[208:223], v[100:103], v[44:47], v[208:223]
    v_exp_f32 v198, v198
    v_exp_f32 v199, v199
    v_exp_f32 v200, v200
    v_smfmac_f32_16x16x64_bf16 v[24:27], v[28:31], v[240:247], v9
    v_exp_f32 v201, v201
    v_smfmac_f32_32x32x32_bf16 v[176:191], v[92:95], v[248:255], v9
    v_exp_f32 v202, v202
    v_exp_f32 v203, v203
    v_exp_f32 v204, v204
    v_smfmac_f32_16x16x64_bf16 v[24:27], v[28:31], v[248:255], v9
    buffer_load_dwordx4 v[80:83], v1, s[4:7], s55 offen offset:0 sc1
    v_exp_f32 v205, v205
    v_exp_f32 v206, v206
    v_exp_f32 v207, v207
    v_mfma_f32_32x32x16_bf16 v[224:239], v[96:99], v[48:51], 0
    v_exp_f32 v208, v208
    v_exp_f32 v209, v209
    v_exp_f32 v210, v210
    v_smfmac_f32_32x32x32_bf16 v[128:143], v[104:107], v[192:199], v9
    v_exp_f32 v211, v211
    v_exp_f32 v212, v212
    v_exp_f32 v213, v213
    v_mfma_f32_32x32x16_bf16 v[224:239], v[100:103], v[52:55], v[224:239]
    v_exp_f32 v214, v214
    v_exp_f32 v215, v215
    v_exp_f32 v216, v216
    v_smfmac_f32_16x16x64_bf16 v[12:15], v[28:31], v[192:199], v9
    v_exp_f32 v217, v217
    v_smfmac_f32_32x32x32_bf16 v[128:143], v[108:111], v[200:207], v9
    v_exp_f32 v218, v218
    v_exp_f32 v219, v219
    v_exp_f32 v220, v220
    v_smfmac_f32_16x16x64_bf16 v[12:15], v[28:31], v[200:207], v9
    buffer_load_dwordx4 v[84:87], v1, s[4:7], s55 offen offset:1024 sc1
    v_exp_f32 v221, v221
    v_exp_f32 v222, v222
    v_exp_f32 v223, v223
    v_mfma_f32_32x32x16_bf16 v[240:255], v[96:99], v[56:59], 0
    v_exp_f32 v224, v224
    v_exp_f32 v225, v225
    v_exp_f32 v226, v226
    v_smfmac_f32_32x32x32_bf16 v[144:159], v[104:107], v[208:215], v9
    v_exp_f32 v227, v227
    v_exp_f32 v228, v228
    v_exp_f32 v229, v229
    v_mfma_f32_32x32x16_bf16 v[240:255], v[100:103], v[60:63], v[240:255]
    v_exp_f32 v230, v230
    v_exp_f32 v231, v231
    v_exp_f32 v232, v232
    v_smfmac_f32_16x16x64_bf16 v[16:19], v[28:31], v[208:215], v9
    v_exp_f32 v233, v233
    v_smfmac_f32_32x32x32_bf16 v[144:159], v[108:111], v[216:223], v9
    v_exp_f32 v234, v234
    v_exp_f32 v235, v235
    v_exp_f32 v236, v236
    v_smfmac_f32_16x16x64_bf16 v[16:19], v[28:31], v[216:223], v9
    buffer_load_dwordx4 v[88:91], v1, s[4:7], s56 offen offset:0 sc1
    v_exp_f32 v237, v237
    v_exp_f32 v238, v238
    v_exp_f32 v239, v239
    s_waitcnt vmcnt(7)
    v_mfma_f32_32x32x16_bf16 v[192:207], v[112:115], v[32:35], 0
    v_exp_f32 v240, v240
    v_exp_f32 v241, v241
    v_exp_f32 v242, v242
    v_smfmac_f32_32x32x32_bf16 v[160:175], v[104:107], v[224:231], v9
    v_exp_f32 v243, v243
    v_exp_f32 v244, v244
    v_exp_f32 v245, v245
    v_mfma_f32_32x32x16_bf16 v[192:207], v[116:119], v[36:39], v[192:207]
    v_exp_f32 v246, v246
    v_exp_f32 v247, v247
    v_exp_f32 v248, v248
    v_smfmac_f32_16x16x64_bf16 v[20:23], v[28:31], v[224:231], v9
    v_exp_f32 v249, v249
    v_smfmac_f32_32x32x32_bf16 v[160:175], v[108:111], v[232:239], v9
    v_exp_f32 v250, v250
    v_exp_f32 v251, v251
    v_exp_f32 v252, v252
    v_smfmac_f32_16x16x64_bf16 v[20:23], v[28:31], v[232:239], v9
    buffer_load_dwordx4 v[92:95], v1, s[4:7], s56 offen offset:1024 sc1
    v_exp_f32 v253, v253
    v_exp_f32 v254, v254
    v_exp_f32 v255, v255
    v_mfma_f32_32x32x16_bf16 v[208:223], v[112:115], v[40:43], 0
    s_add_u32 s54, s54, 8192
    s_and_b32 s54, s54, 0x1ffff
    s_add_u32 s55, s53, s54
    s_add_u32 s56, s55, 4194304
    v_exp_f32 v192, v192
    v_exp_f32 v193, v193
    v_exp_f32 v194, v194
    v_smfmac_f32_32x32x32_bf16 v[176:191], v[104:107], v[240:247], v9
    v_exp_f32 v195, v195
    v_exp_f32 v196, v196
    v_exp_f32 v197, v197
    v_mfma_f32_32x32x16_bf16 v[208:223], v[116:119], v[44:47], v[208:223]
    v_exp_f32 v198, v198
    v_exp_f32 v199, v199
    v_exp_f32 v200, v200
    v_smfmac_f32_16x16x64_bf16 v[24:27], v[28:31], v[240:247], v9
    v_exp_f32 v201, v201
    v_smfmac_f32_32x32x32_bf16 v[176:191], v[108:111], v[248:255], v9
    v_exp_f32 v202, v202
    v_exp_f32 v203, v203
    v_exp_f32 v204, v204
    v_smfmac_f32_16x16x64_bf16 v[24:27], v[28:31], v[248:255], v9
    buffer_load_dwordx4 v[96:99], v1, s[4:7], s55 offen offset:0 sc1
    v_exp_f32 v205, v205
    v_exp_f32 v206, v206
    v_exp_f32 v207, v207
    v_mfma_f32_32x32x16_bf16 v[224:239], v[112:115], v[48:51], 0
    v_exp_f32 v208, v208
    v_exp_f32 v209, v209
    v_exp_f32 v210, v210
    v_smfmac_f32_32x32x32_bf16 v[128:143], v[120:123], v[192:199], v9
    v_exp_f32 v211, v211
    v_exp_f32 v212, v212
    v_exp_f32 v213, v213
    v_mfma_f32_32x32x16_bf16 v[224:239], v[116:119], v[52:55], v[224:239]
    v_exp_f32 v214, v214
    v_exp_f32 v215, v215
    v_exp_f32 v216, v216
    v_smfmac_f32_16x16x64_bf16 v[12:15], v[28:31], v[192:199], v9
    v_exp_f32 v217, v217
    v_smfmac_f32_32x32x32_bf16 v[128:143], v[124:127], v[200:207], v9
    v_exp_f32 v218, v218
    v_exp_f32 v219, v219
    v_exp_f32 v220, v220
    v_smfmac_f32_16x16x64_bf16 v[12:15], v[28:31], v[200:207], v9
    buffer_load_dwordx4 v[100:103], v1, s[4:7], s55 offen offset:1024 sc1
    v_exp_f32 v221, v221
    v_exp_f32 v222, v222
    v_exp_f32 v223, v223
    v_mfma_f32_32x32x16_bf16 v[240:255], v[112:115], v[56:59], 0
    v_exp_f32 v224, v224
    v_exp_f32 v225, v225
    v_exp_f32 v226, v226
    v_smfmac_f32_32x32x32_bf16 v[144:159], v[120:123], v[208:215], v9
    v_exp_f32 v227, v227
    v_exp_f32 v228, v228
    v_exp_f32 v229, v229
    v_mfma_f32_32x32x16_bf16 v[240:255], v[116:119], v[60:63], v[240:255]
    v_exp_f32 v230, v230
    v_exp_f32 v231, v231
    v_exp_f32 v232, v232
    v_smfmac_f32_16x16x64_bf16 v[16:19], v[28:31], v[208:215], v9
    v_exp_f32 v233, v233
    v_smfmac_f32_32x32x32_bf16 v[144:159], v[124:127], v[216:223], v9
    v_exp_f32 v234, v234
    v_exp_f32 v235, v235
    v_exp_f32 v236, v236
    v_smfmac_f32_16x16x64_bf16 v[16:19], v[28:31], v[216:223], v9
    buffer_load_dwordx4 v[104:107], v1, s[4:7], s56 offen offset:0 sc1
    v_exp_f32 v237, v237
    v_exp_f32 v238, v238
    v_exp_f32 v239, v239
    s_waitcnt vmcnt(7)
    v_mfma_f32_32x32x16_bf16 v[192:207], v[64:67], v[32:35], 0
    v_exp_f32 v240, v240
    v_exp_f32 v241, v241
    v_exp_f32 v242, v242
    v_smfmac_f32_32x32x32_bf16 v[160:175], v[120:123], v[224:231], v9
    v_exp_f32 v243, v243
    v_exp_f32 v244, v244
    v_exp_f32 v245, v245
    v_mfma_f32_32x32x16_bf16 v[192:207], v[68:71], v[36:39], v[192:207]
    v_exp_f32 v246, v246
    v_exp_f32 v247, v247
    v_exp_f32 v248, v248
    v_smfmac_f32_16x16x64_bf16 v[20:23], v[28:31], v[224:231], v9
    v_exp_f32 v249, v249
    v_smfmac_f32_32x32x32_bf16 v[160:175], v[124:127], v[232:239], v9
    v_exp_f32 v250, v250
    v_exp_f32 v251, v251
    v_exp_f32 v252, v252
    v_smfmac_f32_16x16x64_bf16 v[20:23], v[28:31], v[232:239], v9
    buffer_load_dwordx4 v[108:111], v1, s[4:7], s56 offen offset:1024 sc1
    v_exp_f32 v253, v253
    v_exp_f32 v254, v254
    v_exp_f32 v255, v255
    v_mfma_f32_32x32x16_bf16 v[208:223], v[64:67], v[40:43], 0
    s_add_u32 s54, s54, 8192
    s_and_b32 s54, s54, 0x1ffff
    s_add_u32 s55, s53, s54
    s_add_u32 s56, s55, 4194304
    v_exp_f32 v192, v192
    v_exp_f32 v193, v193
    v_exp_f32 v194, v194
    v_smfmac_f32_32x32x32_bf16 v[176:191], v[120:123], v[240:247], v9
    v_exp_f32 v195, v195
    v_exp_f32 v196, v196
    v_exp_f32 v197, v197
    v_mfma_f32_32x32x16_bf16 v[208:223], v[68:71], v[44:47], v[208:223]
    v_exp_f32 v198, v198
    v_exp_f32 v199, v199
    v_exp_f32 v200, v200
    v_smfmac_f32_16x16x64_bf16 v[24:27], v[28:31], v[240:247], v9
    v_exp_f32 v201, v201
    v_smfmac_f32_32x32x32_bf16 v[176:191], v[124:127], v[248:255], v9
    v_exp_f32 v202, v202
    v_exp_f32 v203, v203
    v_exp_f32 v204, v204
    v_smfmac_f32_16x16x64_bf16 v[24:27], v[28:31], v[248:255], v9
    buffer_load_dwordx4 v[112:115], v1, s[4:7], s55 offen offset:0 sc1
    v_exp_f32 v205, v205
    v_exp_f32 v206, v206
    v_exp_f32 v207, v207
    v_mfma_f32_32x32x16_bf16 v[224:239], v[64:67], v[48:51], 0
    v_exp_f32 v208, v208
    v_exp_f32 v209, v209
    v_exp_f32 v210, v210
    v_smfmac_f32_32x32x32_bf16 v[128:143], v[72:75], v[192:199], v9
    v_exp_f32 v211, v211
    v_exp_f32 v212, v212
    v_exp_f32 v213, v213
    v_mfma_f32_32x32x16_bf16 v[224:239], v[68:71], v[52:55], v[224:239]
    v_exp_f32 v214, v214
    v_exp_f32 v215, v215
    v_exp_f32 v216, v216
    v_smfmac_f32_16x16x64_bf16 v[12:15], v[28:31], v[192:199], v9
    v_exp_f32 v217, v217
    v_smfmac_f32_32x32x32_bf16 v[128:143], v[76:79], v[200:207], v9
    v_exp_f32 v218, v218
    v_exp_f32 v219, v219
    v_exp_f32 v220, v220
    v_smfmac_f32_16x16x64_bf16 v[12:15], v[28:31], v[200:207], v9
    buffer_load_dwordx4 v[116:119], v1, s[4:7], s55 offen offset:1024 sc1
    v_exp_f32 v221, v221
    v_exp_f32 v222, v222
    v_exp_f32 v223, v223
    s_sub_u32 s58, s58, 1
    s_cmp_lg_u32 s58, 0
    s_cbranch_scc1 b_loop
    v_mfma_f32_32x32x16_bf16 v[240:255], v[64:67], v[56:59], 0
    v_exp_f32 v224, v224
    v_exp_f32 v225, v225
    v_exp_f32 v226, v226
    v_smfmac_f32_32x32x32_bf16 v[144:159], v[72:75], v[208:215], v9
    v_exp_f32 v227, v227
    v_exp_f32 v228, v228
    v_exp_f32 v229, v229
    v_mfma_f32_32x32x16_bf16 v[240:255], v[68:71], v[60:63], v[240:255]
    v_exp_f32 v230, v230
    v_exp_f32 v231, v231
    v_exp_f32 v232, v232
    v_smfmac_f32_16x16x64_bf16 v[16:19], v[28:31], v[208:215], v9
    v_exp_f32 v233, v233
    v_smfmac_f32_32x32x32_bf16 v[144:159], v[76:79], v[216:223], v9
    v_exp_f32 v234, v234
    v_exp_f32 v235, v235
    v_exp_f32 v236, v236
    v_smfmac_f32_16x16x64_bf16 v[16:19], v[28:31], v[216:223], v9
    buffer_load_dwordx4 v[120:123], v1, s[4:7], s56 offen offset:0 sc1
    v_exp_f32 v237, v237
    v_exp_f32 v238, v238
    v_exp_f32 v239, v239
    s_waitcnt vmcnt(7)
    v_mfma_f32_32x32x16_bf16 v[192:207], v[80:83], v[32:35], 0
    v_exp_f32 v240, v240
    v_exp_f32 v241, v241
    v_exp_f32 v242, v242
    v_smfmac_f32_32x32x32_bf16 v[160:175], v[72:75], v[224:231], v9
    v_exp_f32 v243, v243
    v_exp_f32 v244, v244
    v_exp_f32 v245, v245
    v_mfma_f32_32x32x16_bf16 v[192:207], v[84:87], v[36:39], v[192:207]
    v_exp_f32 v246, v246
    v_exp_f32 v247, v247
    v_exp_f32 v248, v248
    v_smfmac_f32_16x16x64_bf16 v[20:23], v[28:31], v[224:231], v9
    v_exp_f32 v249, v249
    v_smfmac_f32_32x32x32_bf16 v[160:175], v[76:79], v[232:239], v9
    v_exp_f32 v250, v250
    v_exp_f32 v251, v251
    v_exp_f32 v252, v252
    v_smfmac_f32_16x16x64_bf16 v[20:23], v[28:31], v[232:239], v9
    buffer_load_dwordx4 v[124:127], v1, s[4:7], s56 offen offset:1024 sc1
    v_exp_f32 v253, v253
    v_exp_f32 v254, v254
    v_exp_f32 v255, v255
    s_add_u32 s53, s53, 131072
    s_cmp_eq_u32 s57, 0
    s_cselect_b32 s53, s53, 2146435072
    v_mfma_f32_32x32x16_bf16 v[208:223], v[80:83], v[40:43], 0
    s_add_u32 s54, s54, 8192
    s_and_b32 s54, s54, 0x1ffff
    s_add_u32 s55, s53, s54
    s_add_u32 s56, s55, 4194304
    v_exp_f32 v192, v192
    v_exp_f32 v193, v193
    v_exp_f32 v194, v194
    v_smfmac_f32_32x32x32_bf16 v[176:191], v[72:75], v[240:247], v9
    v_exp_f32 v195, v195
    v_exp_f32 v196, v196
    v_exp_f32 v197, v197
    v_mfma_f32_32x32x16_bf16 v[208:223], v[84:87], v[44:47], v[208:223]
    v_exp_f32 v198, v198
    v_exp_f32 v199, v199
    v_exp_f32 v200, v200
    v_smfmac_f32_16x16x64_bf16 v[24:27], v[28:31], v[240:247], v9
    v_exp_f32 v201, v201
    v_smfmac_f32_32x32x32_bf16 v[176:191], v[76:79], v[248:255], v9
    v_exp_f32 v202, v202
    v_exp_f32 v203, v203
    v_exp_f32 v204, v204
    v_smfmac_f32_16x16x64_bf16 v[24:27], v[28:31], v[248:255], v9
    buffer_load_dwordx4 v[64:67], v1, s[4:7], s55 offen offset:0 sc1
    v_exp_f32 v205, v205
    v_exp_f32 v206, v206
    v_exp_f32 v207, v207
    v_mfma_f32_32x32x16_bf16 v[224:239], v[80:83], v[48:51], 0
    v_exp_f32 v208, v208
    v_exp_f32 v209, v209
    v_exp_f32 v210, v210
    v_smfmac_f32_32x32x32_bf16 v[128:143], v[88:91], v[192:199], v9
    v_exp_f32 v211, v211
    v_exp_f32 v212, v212
    v_exp_f32 v213, v213
    v_mfma_f32_32x32x16_bf16 v[224:239], v[84:87], v[52:55], v[224:239]
    v_exp_f32 v214, v214
    v_exp_f32 v215, v215
    v_exp_f32 v216, v216
    v_smfmac_f32_16x16x64_bf16 v[12:15], v[28:31], v[192:199], v9
    v_exp_f32 v217, v217
    v_smfmac_f32_32x32x32_bf16 v[128:143], v[92:95], v[200:207], v9
    v_exp_f32 v218, v218
    v_exp_f32 v219, v219
    v_exp_f32 v220, v220
    v_smfmac_f32_16x16x64_bf16 v[12:15], v[28:31], v[200:207], v9
    buffer_load_dwordx4 v[68:71], v1, s[4:7], s55 offen offset:1024 sc1
    v_exp_f32 v221, v221
    v_exp_f32 v222, v222
    v_exp_f32 v223, v223
    v_mfma_f32_32x32x16_bf16 v[240:255], v[80:83], v[56:59], 0
    v_exp_f32 v224, v224
    v_exp_f32 v225, v225
    v_exp_f32 v226, v226
    v_smfmac_f32_32x32x32_bf16 v[144:159], v[88:91], v[208:215], v9
    v_exp_f32 v227, v227
    v_exp_f32 v228, v228
    v_exp_f32 v229, v229
    v_mfma_f32_32x32x16_bf16 v[240:255], v[84:87], v[60:63], v[240:255]
    v_exp_f32 v230, v230
    v_exp_f32 v231, v231
    v_exp_f32 v232, v232
    v_smfmac_f32_16x16x64_bf16 v[16:19], v[28:31], v[208:215], v9
    v_exp_f32 v233, v233
    v_smfmac_f32_32x32x32_bf16 v[144:159], v[92:95], v[216:223], v9
    v_exp_f32 v234, v234
    v_exp_f32 v235, v235
    v_exp_f32 v236, v236
    v_smfmac_f32_16x16x64_bf16 v[16:19], v[28:31], v[216:223], v9
    buffer_load_dwordx4 v[72:75], v1, s[4:7], s56 offen offset:0 sc1
    v_exp_f32 v237, v237
    v_exp_f32 v238, v238
    v_exp_f32 v239, v239
    s_waitcnt vmcnt(7)
    v_mfma_f32_32x32x16_bf16 v[192:207], v[96:99], v[32:35], 0
    v_exp_f32 v240, v240
    v_exp_f32 v241, v241
    v_exp_f32 v242, v242
    v_smfmac_f32_32x32x32_bf16 v[160:175], v[88:91], v[224:231], v9
    v_exp_f32 v243, v243
    v_exp_f32 v244, v244
    v_exp_f32 v245, v245
    v_mfma_f32_32x32x16_bf16 v[192:207], v[100:103], v[36:39], v[192:207]
    v_exp_f32 v246, v246
    v_exp_f32 v247, v247
    v_exp_f32 v248, v248
    v_smfmac_f32_16x16x64_bf16 v[20:23], v[28:31], v[224:231], v9
    v_exp_f32 v249, v249
    v_smfmac_f32_32x32x32_bf16 v[160:175], v[92:95], v[232:239], v9
    v_exp_f32 v250, v250
    v_exp_f32 v251, v251
    v_exp_f32 v252, v252
    v_smfmac_f32_16x16x64_bf16 v[20:23], v[28:31], v[232:239], v9
    buffer_load_dwordx4 v[76:79], v1, s[4:7], s56 offen offset:1024 sc1
    v_exp_f32 v253, v253
    v_exp_f32 v254, v254
    v_exp_f32 v255, v255
    v_mfma_f32_32x32x16_bf16 v[208:223], v[96:99], v[40:43], 0
    s_add_u32 s54, s54, 8192
    s_and_b32 s54, s54, 0x1ffff
    s_add_u32 s55, s53, s54
    s_add_u32 s56, s55, 4194304
    v_exp_f32 v192, v192
    v_exp_f32 v193, v193
    v_exp_f32 v194, v194
    v_smfmac_f32_32x32x32_bf16 v[176:191], v[88:91], v[240:247], v9
    v_exp_f32 v195, v195
    v_exp_f32 v196, v196
    v_exp_f32 v197, v197
    v_mfma_f32_32x32x16_bf16 v[208:223], v[100:103], v[44:47], v[208:223]
    v_exp_f32 v198, v198
    v_exp_f32 v199, v199
    v_exp_f32 v200, v200
    v_smfmac_f32_16x16x64_bf16 v[24:27], v[28:31], v[240:247], v9
    v_exp_f32 v201, v201
    v_smfmac_f32_32x32x32_bf16 v[176:191], v[92:95], v[248:255], v9
    v_exp_f32 v202, v202
    v_exp_f32 v203, v203
    v_exp_f32 v204, v204
    v_smfmac_f32_16x16x64_bf16 v[24:27], v[28:31], v[248:255], v9
    buffer_load_dwordx4 v[80:83], v1, s[4:7], s55 offen offset:0 sc1
    v_exp_f32 v205, v205
    v_exp_f32 v206, v206
    v_exp_f32 v207, v207
    v_mfma_f32_32x32x16_bf16 v[224:239], v[96:99], v[48:51], 0
    v_exp_f32 v208, v208
    v_exp_f32 v209, v209
    v_exp_f32 v210, v210
    v_smfmac_f32_32x32x32_bf16 v[128:143], v[104:107], v[192:199], v9
    v_exp_f32 v211, v211
    v_exp_f32 v212, v212
    v_exp_f32 v213, v213
    v_mfma_f32_32x32x16_bf16 v[224:239], v[100:103], v[52:55], v[224:239]
    v_exp_f32 v214, v214
    v_exp_f32 v215, v215
    v_exp_f32 v216, v216
    v_smfmac_f32_16x16x64_bf16 v[12:15], v[28:31], v[192:199], v9
    v_exp_f32 v217, v217
    v_smfmac_f32_32x32x32_bf16 v[128:143], v[108:111], v[200:207], v9
    v_exp_f32 v218, v218
    v_exp_f32 v219, v219
    v_exp_f32 v220, v220
    v_smfmac_f32_16x16x64_bf16 v[12:15], v[28:31], v[200:207], v9
    buffer_load_dwordx4 v[84:87], v1, s[4:7], s55 offen offset:1024 sc1
    v_exp_f32 v221, v221
    v_exp_f32 v222, v222
    v_exp_f32 v223, v223
    v_mfma_f32_32x32x16_bf16 v[240:255], v[96:99], v[56:59], 0
    v_exp_f32 v224, v224
    v_exp_f32 v225, v225
    v_exp_f32 v226, v226
    v_smfmac_f32_32x32x32_bf16 v[144:159], v[104:107], v[208:215], v9
    v_exp_f32 v227, v227
    v_exp_f32 v228, v228
    v_exp_f32 v229, v229
    v_mfma_f32_32x32x16_bf16 v[240:255], v[100:103], v[60:63], v[240:255]
    v_exp_f32 v230, v230
    v_exp_f32 v231, v231
    v_exp_f32 v232, v232
    v_smfmac_f32_16x16x64_bf16 v[16:19], v[28:31], v[208:215], v9
    v_exp_f32 v233, v233
    v_smfmac_f32_32x32x32_bf16 v[144:159], v[108:111], v[216:223], v9
    v_exp_f32 v234, v234
    v_exp_f32 v235, v235
    v_exp_f32 v236, v236
    v_smfmac_f32_16x16x64_bf16 v[16:19], v[28:31], v[216:223], v9
    buffer_load_dwordx4 v[88:91], v1, s[4:7], s56 offen offset:0 sc1
    v_exp_f32 v237, v237
    v_exp_f32 v238, v238
    v_exp_f32 v239, v239
    s_waitcnt vmcnt(7)
    v_mfma_f32_32x32x16_bf16 v[192:207], v[112:115], v[32:35], 0
    v_exp_f32 v240, v240
    v_exp_f32 v241, v241
    v_exp_f32 v242, v242
    v_smfmac_f32_32x32x32_bf16 v[160:175], v[104:107], v[224:231], v9
    v_exp_f32 v243, v243
    v_exp_f32 v244, v244
    v_exp_f32 v245, v245
    v_mfma_f32_32x32x16_bf16 v[192:207], v[116:119], v[36:39], v[192:207]
    v_exp_f32 v246, v246
    v_exp_f32 v247, v247
    v_exp_f32 v248, v248
    v_smfmac_f32_16x16x64_bf16 v[20:23], v[28:31], v[224:231], v9
    v_exp_f32 v249, v249
    v_smfmac_f32_32x32x32_bf16 v[160:175], v[108:111], v[232:239], v9
    v_exp_f32 v250, v250
    v_exp_f32 v251, v251
    v_exp_f32 v252, v252
    v_smfmac_f32_16x16x64_bf16 v[20:23], v[28:31], v[232:239], v9
    buffer_load_dwordx4 v[92:95], v1, s[4:7], s56 offen offset:1024 sc1
    v_exp_f32 v253, v253
    v_exp_f32 v254, v254
    v_exp_f32 v255, v255
    s_barrier
    v_mfma_f32_32x32x16_bf16 v[208:223], v[112:115], v[40:43], 0
    s_add_u32 s54, s54, 8192
    s_and_b32 s54, s54, 0x1ffff
    s_add_u32 s55, s53, s54
    s_add_u32 s56, s55, 4194304
    ds_read_b128 v[32:35], v4 offset:8192
    ds_read_b128 v[36:39], v4 offset:9216
    v_exp_f32 v192, v192
    v_exp_f32 v193, v193
    v_exp_f32 v194, v194
    v_smfmac_f32_32x32x32_bf16 v[176:191], v[104:107], v[240:247], v9
    v_exp_f32 v195, v195
    v_exp_f32 v196, v196
    v_exp_f32 v197, v197
    v_mfma_f32_32x32x16_bf16 v[208:223], v[116:119], v[44:47], v[208:223]
    v_exp_f32 v198, v198
    v_exp_f32 v199, v199
    v_exp_f32 v200, v200
    v_smfmac_f32_16x16x64_bf16 v[24:27], v[28:31], v[240:247], v9
    v_exp_f32 v201, v201
    v_smfmac_f32_32x32x32_bf16 v[176:191], v[108:111], v[248:255], v9
    v_exp_f32 v202, v202
    v_exp_f32 v203, v203
    v_exp_f32 v204, v204
    v_smfmac_f32_16x16x64_bf16 v[24:27], v[28:31], v[248:255], v9
    buffer_load_dwordx4 v[96:99], v1, s[4:7], s55 offen offset:0 sc1
    v_exp_f32 v205, v205
    v_exp_f32 v206, v206
    v_exp_f32 v207, v207
    v_mfma_f32_32x32x16_bf16 v[224:239], v[112:115], v[48:51], 0
    ds_read_b128 v[40:43], v4 offset:10240
    ds_read_b128 v[44:47], v4 offset:11264
    v_exp_f32 v208, v208
    v_exp_f32 v209, v209
    v_exp_f32 v210, v210
    v_smfmac_f32_32x32x32_bf16 v[128:143], v[120:123], v[192:199], v9
    v_exp_f32 v211, v211
    v_exp_f32 v212, v212
    v_exp_f32 v213, v213
    v_mfma_f32_32x32x16_bf16 v[224:239], v[116:119], v[52:55], v[224:239]
    v_exp_f32 v214, v214
    v_exp_f32 v215, v215
    v_exp_f32 v216, v216
    v_smfmac_f32_16x16x64_bf16 v[12:15], v[28:31], v[192:199], v9
    v_exp_f32 v217, v217
    v_smfmac_f32_32x32x32_bf16 v[128:143], v[124:127], v[200:207], v9
    v_exp_f32 v218, v218
    v_exp_f32 v219, v219
    v_exp_f32 v220, v220
    v_smfmac_f32_16x16x64_bf16 v[12:15], v[28:31], v[200:207], v9
    buffer_load_dwordx4 v[100:103], v1, s[4:7], s55 offen offset:1024 sc1
    v_exp_f32 v221, v221
    v_exp_f32 v222, v222
    v_exp_f32 v223, v223
    v_mfma_f32_32x32x16_bf16 v[240:255], v[112:115], v[56:59], 0
    ds_read_b128 v[48:51], v4 offset:12288
    ds_read_b128 v[52:55], v4 offset:13312
    v_exp_f32 v224, v224
    v_exp_f32 v225, v225
    v_exp_f32 v226, v226
    v_smfmac_f32_32x32x32_bf16 v[144:159], v[120:123], v[208:215], v9
    v_exp_f32 v227, v227
    ds_write_b128 v5, v[128:131] offset:0
    v_exp_f32 v228, v228
    v_exp_f32 v229, v229
    v_mfma_f32_32x32x16_bf16 v[240:255], v[116:119], v[60:63], v[240:255]
    ds_write_b128 v5, v[132:135] offset:1024
    v_exp_f32 v230, v230
    v_exp_f32 v231, v231
    v_exp_f32 v232, v232
    v_smfmac_f32_16x16x64_bf16 v[16:19], v[28:31], v[208:215], v9
    ds_write_b32 v6, v12 offset:0
    v_exp_f32 v233, v233
    v_smfmac_f32_32x32x32_bf16 v[144:159], v[124:127], v[216:223], v9
    ds_write_b128 v5, v[136:139] offset:2048
    v_exp_f32 v234, v234
    v_exp_f32 v235, v235
    v_exp_f32 v236, v236
    v_smfmac_f32_16x16x64_bf16 v[16:19], v[28:31], v[216:223], v9
    buffer_load_dwordx4 v[104:107], v1, s[4:7], s56 offen offset:0 sc1
    ds_write_b128 v5, v[140:143] offset:3072
    v_exp_f32 v237, v237
    v_exp_f32 v238, v238
    v_exp_f32 v239, v239
    s_waitcnt vmcnt(7)
    s_waitcnt lgkmcnt(9)
    v_mfma_f32_32x32x16_bf16 v[192:207], v[64:67], v[32:35], 0
    ds_read_b128 v[56:59], v4 offset:14336
    ds_read_b128 v[60:63], v4 offset:15360
    v_exp_f32 v240, v240
    v_exp_f32 v241, v241
    v_exp_f32 v242, v242
    v_smfmac_f32_32x32x32_bf16 v[160:175], v[120:123], v[224:231], v9
    v_exp_f32 v243, v243
    ds_write_b128 v5, v[144:147] offset:16384
    v_exp_f32 v244, v244
    v_exp_f32 v245, v245
    v_mfma_f32_32x32x16_bf16 v[192:207], v[68:71], v[36:39], v[192:207]
    ds_write_b128 v5, v[148:151] offset:17408
    v_exp_f32 v246, v246
    v_exp_f32 v247, v247
    v_exp_f32 v248, v248
    s_waitcnt lgkmcnt(4)
    v_mfma_f32_32x32x8_bf16 v[128:143], v[10:11], v[10:11], 0
    v_mov_b32 v12, 0
    v_smfmac_f32_16x16x64_bf16 v[20:23], v[28:31], v[224:231], v9
    ds_write_b32 v6, v16 offset:1024
    v_exp_f32 v249, v249
    v_smfmac_f32_32x32x32_bf16 v[160:175], v[124:127], v[232:239], v9
    ds_write_b128 v5, v[152:155] offset:18432
    v_exp_f32 v250, v250
    v_exp_f32 v251, v251
    v_exp_f32 v252, v252
    v_smfmac_f32_16x16x64_bf16 v[20:23], v[28:31], v[232:239], v9
    buffer_load_dwordx4 v[108:111], v1, s[4:7], s56 offen offset:1024 sc1
    ds_write_b128 v5, v[156:159] offset:19456
    v_exp_f32 v253, v253
    v_exp_f32 v254, v254
    v_exp_f32 v255, v255
    s_cmp_lg_u32 s57, 0
    s_cbranch_scc1 b_tail
    v_mfma_f32_32x32x16_bf16 v[208:223], v[64:67], v[40:43], 0
    s_add_u32 s54, s54, 8192
    s_and_b32 s54, s54, 0x1ffff
    s_add_u32 s55, s53, s54
    s_add_u32 s56, s55, 4194304
    v_exp_f32 v192, v192
    v_exp_f32 v193, v193
    v_exp_f32 v194, v194
    v_smfmac_f32_32x32x32_bf16 v[176:191], v[120:123], v[240:247], v9
    v_exp_f32 v195, v195
    ds_write_b128 v5, v[160:163] offset:32768
    v_exp_f32 v196, v196
    v_exp_f32 v197, v197
    v_mfma_f32_32x32x16_bf16 v[208:223], v[68:71], v[44:47], v[208:223]
    ds_write_b128 v5, v[164:167] offset:33792
    v_exp_f32 v198, v198
    v_exp_f32 v199, v199
    v_exp_f32 v200, v200
    s_waitcnt lgkmcnt(2)
    v_mfma_f32_32x32x8_bf16 v[144:159], v[10:11], v[10:11], 0
    v_mov_b32 v16, 0
    v_smfmac_f32_16x16x64_bf16 v[24:27], v[28:31], v[240:247], v9
    ds_write_b32 v6, v20 offset:2048
    v_exp_f32 v201, v201
    v_smfmac_f32_32x32x32_bf16 v[176:191], v[124:127], v[248:255], v9
    ds_write_b128 v5, v[168:171] offset:34816
    v_exp_f32 v202, v202
    v_exp_f32 v203, v203
    v_exp_f32 v204, v204
    v_smfmac_f32_16x16x64_bf16 v[24:27], v[28:31], v[248:255], v9
    buffer_load_dwordx4 v[112:115], v1, s[4:7], s55 offen offset:0 sc1
    ds_write_b128 v5, v[172:175] offset:35840
    v_exp_f32 v205, v205
    v_exp_f32 v206, v206
    v_exp_f32 v207, v207
    v_mfma_f32_32x32x16_bf16 v[224:239], v[64:67], v[48:51], 0
    v_exp_f32 v208, v208
    v_exp_f32 v209, v209
    v_exp_f32 v210, v210
    v_smfmac_f32_32x32x32_bf16 v[128:143], v[72:75], v[192:199], v9
    v_exp_f32 v211, v211
    ds_write_b128 v5, v[176:179] offset:49152
    v_exp_f32 v212, v212
    v_exp_f32 v213, v213
    v_mfma_f32_32x32x16_bf16 v[224:239], v[68:71], v[52:55], v[224:239]
    ds_write_b128 v5, v[180:183] offset:50176
    v_exp_f32 v214, v214
    v_exp_f32 v215, v215
    v_exp_f32 v216, v216
    s_waitcnt lgkmcnt(2)
    v_mfma_f32_32x32x8_bf16 v[160:175], v[10:11], v[10:11], 0
    v_mov_b32 v20, 0
    v_smfmac_f32_16x16x64_bf16 v[12:15], v[28:31], v[192:199], v9
    ds_write_b32 v6, v24 offset:3072
    v_exp_f32 v217, v217
    v_smfmac_f32_32x32x32_bf16 v[128:143], v[76:79], v[200:207], v9
    ds_write_b128 v5, v[184:187] offset:51200
    v_exp_f32 v218, v218
    v_exp_f32 v219, v219
    v_exp_f32 v220, v220
    v_smfmac_f32_16x16x64_bf16 v[12:15], v[28:31], v[200:207], v9
    buffer_load_dwordx4 v[116:119], v1, s[4:7], s55 offen offset:1024 sc1
    ds_write_b128 v5, v[188:191] offset:52224
    v_exp_f32 v221, v221
    v_exp_f32 v222, v222
    v_exp_f32 v223, v223
    s_waitcnt lgkmcnt(0)
    v_mfma_f32_32x32x8_bf16 v[176:191], v[10:11], v[10:11], 0
    v_mov_b32 v24, 0
    s_barrier
    s_mov_b32 s57, 1
    s_branch b_head
b_tail:
    v_smfmac_f32_32x32x32_bf16 v[176:191], v[120:123], v[240:247], v9
    v_smfmac_f32_32x32x32_bf16 v[176:191], v[124:127], v[248:255], v9
    ds_write_b128 v5, v[160:163] offset:32768
    ds_write_b128 v5, v[164:167] offset:33792
    v_smfmac_f32_16x16x64_bf16 v[24:27], v[28:31], v[240:247], v9
    ds_write_b128 v5, v[168:171] offset:34816
    v_smfmac_f32_16x16x64_bf16 v[24:27], v[28:31], v[248:255], v9
    ds_write_b128 v5, v[172:175] offset:35840
    ds_write_b32 v6, v20 offset:2048
    s_nop 4
    ds_write_b128 v5, v[176:179] offset:49152
    ds_write_b128 v5, v[180:183] offset:50176
    ds_write_b128 v5, v[184:187] offset:51200
    ds_write_b128 v5, v[188:191] offset:52224
    s_nop 0
    ds_write_b32 v6, v24 offset:3072
    buffer_load_dwordx4 v[224:227], v2, s[4:7], s43 offen offset:0 sc1
    buffer_load_dwordx4 v[228:231], v2, s[4:7], s43 offen offset:256 sc1
    buffer_load_dwordx4 v[232:235], v2, s[4:7], s43 offen offset:2048 sc1
    buffer_load_dwordx4 v[236:239], v2, s[4:7], s43 offen offset:2304 sc1
    s_waitcnt lgkmcnt(0)
    s_barrier
    v_xor_b32 v4, 32, v3
    v_xor_b32 v5, 64, v3
    v_xor_b32 v6, 96, v3
c_wo:
    s_xor_b32 s42, s41, 0
    buffer_load_dwordx4 v[64:67], v2, s[4:7], s42 offen offset:0 sc1
    buffer_load_dwordx4 v[68:71], v2, s[4:7], s42 offen offset:256 sc1
    s_xor_b32 s42, s41, 4096
    buffer_load_dwordx4 v[72:75], v2, s[4:7], s42 offen offset:0 sc1
    buffer_load_dwordx4 v[76:79], v2, s[4:7], s42 offen offset:256 sc1
    s_xor_b32 s42, s41, 8192
    buffer_load_dwordx4 v[80:83], v2, s[4:7], s42 offen offset:0 sc1
    buffer_load_dwordx4 v[84:87], v2, s[4:7], s42 offen offset:256 sc1
    s_xor_b32 s42, s41, 12288
    buffer_load_dwordx4 v[88:91], v2, s[4:7], s42 offen offset:0 sc1
    buffer_load_dwordx4 v[92:95], v2, s[4:7], s42 offen offset:256 sc1
    s_xor_b32 s42, s41, 16384
    buffer_load_dwordx4 v[96:99], v2, s[4:7], s42 offen offset:0 sc1
    buffer_load_dwordx4 v[100:103], v2, s[4:7], s42 offen offset:256 sc1
    ds_read_b64_tr_b16 v[32:33], v3 offset:0
    ds_read_b64_tr_b16 v[34:35], v3 offset:1024
    ds_read_b64_tr_b16 v[36:37], v4 offset:0
    ds_read_b64_tr_b16 v[38:39], v4 offset:1024
    ds_read_b64_tr_b16 v[40:41], v5 offset:0
    ds_read_b64_tr_b16 v[42:43], v5 offset:1024
    ds_read_b64_tr_b16 v[44:45], v6 offset:0
    ds_read_b64_tr_b16 v[46:47], v6 offset:1024
    ds_read_b64_tr_b16 v[48:49], v3 offset:4096
    ds_read_b64_tr_b16 v[50:51], v3 offset:5120
    ds_read_b64_tr_b16 v[52:53], v4 offset:4096
    ds_read_b64_tr_b16 v[54:55], v4 offset:5120
    ds_read_b64_tr_b16 v[56:57], v5 offset:4096
    ds_read_b64_tr_b16 v[58:59], v5 offset:5120
    v_lshrrev_b32 v12, 4, v1
    v_and_b32 v13, 1, v12
    v_lshlrev_b32 v13, 4, v13
    v_mov_b32 v14, 0x3f80
    v_lshlrev_b32 v13, v13, v14
    v_lshrrev_b32 v14, 2, v12
    v_lshrrev_b32 v15, 4, v12
    v_xor_b32 v14, v14, v15
    v_and_b32 v14, 1, v14
    v_bfe_u32 v15, v12, 3, 1
    v_bfe_u32 v16, v12, 1, 1
    v_lshl_add_u32 v15, v15, 1, v16
    v_lshrrev_b32 v16, 5, v12
    v_lshl_add_u32 v15, v16, 2, v15
    v_lshl_add_u32 v15, v14, 3, v15
    v_cmp_eq_u32 vcc, 0, v15
    s_nop 1
    v_cndmask_b32 v240, 0, v13, vcc
    v_cmp_eq_u32 vcc, 1, v15
    s_nop 1
    v_cndmask_b32 v241, 0, v13, vcc
    v_cmp_eq_u32 vcc, 2, v15
    s_nop 1
    v_cndmask_b32 v242, 0, v13, vcc
    v_cmp_eq_u32 vcc, 3, v15
    s_nop 1
    v_cndmask_b32 v243, 0, v13, vcc
    v_cmp_eq_u32 vcc, 4, v15
    s_nop 1
    v_cndmask_b32 v244, 0, v13, vcc
    v_cmp_eq_u32 vcc, 5, v15
    s_nop 1
    v_cndmask_b32 v245, 0, v13, vcc
    v_cmp_eq_u32 vcc, 6, v15
    s_nop 1
    v_cndmask_b32 v246, 0, v13, vcc
    v_cmp_eq_u32 vcc, 7, v15
    s_nop 1
    v_cndmask_b32 v247, 0, v13, vcc
    s_waitcnt vmcnt(10)
    v_mfma_f32_16x16x32_bf16 v[128:131], v[240:243], v[224:227], 0
    v_mfma_f32_16x16x32_bf16 v[132:135], v[240:243], v[228:231], 0
    v_mfma_f32_16x16x32_bf16 v[136:139], v[244:247], v[224:227], 0
    v_mfma_f32_16x16x32_bf16 v[140:143], v[244:247], v[228:231], 0
    v_mfma_f32_16x16x32_bf16 v[144:147], v[240:243], v[232:235], 0
    v_mfma_f32_16x16x32_bf16 v[148:151], v[240:243], v[236:239], 0
    v_mfma_f32_16x16x32_bf16 v[152:155], v[244:247], v[232:235], 0
    v_mfma_f32_16x16x32_bf16 v[156:159], v[244:247], v[236:239], 0
    s_waitcnt vmcnt(8) lgkmcnt(10)
    v_mfma_f32_16x16x32_bf16 v[128:131], v[32:35], v[64:67], v[128:131]
    ds_read_b64_tr_b16 v[60:61], v6 offset:4096
    s_xor_b32 s42, s41, 20480
    buffer_load_dwordx4 v[104:107], v2, s[4:7], s42 offen offset:0 sc1
    v_mfma_f32_16x16x32_bf16 v[132:135], v[32:35], v[68:71], v[132:135]
    ds_read_b64_tr_b16 v[62:63], v6 offset:5120
    v_mfma_f32_16x16x32_bf16 v[136:139], v[36:39], v[64:67], v[136:139]
    ds_read_b64_tr_b16 v[32:33], v3 offset:8192
    v_mfma_f32_16x16x32_bf16 v[140:143], v[36:39], v[68:71], v[140:143]
    ds_read_b64_tr_b16 v[34:35], v3 offset:9216
    s_waitcnt lgkmcnt(10)
    v_mfma_f32_16x16x32_bf16 v[144:147], v[40:43], v[64:67], v[144:147]
    buffer_load_dwordx4 v[108:111], v2, s[4:7], s42 offen offset:256 sc1
    ds_read_b64_tr_b16 v[36:37], v4 offset:8192
    s_xor_b32 s42, s41, 24576
    v_mfma_f32_16x16x32_bf16 v[148:151], v[40:43], v[68:71], v[148:151]
    ds_read_b64_tr_b16 v[38:39], v4 offset:9216
    v_mfma_f32_16x16x32_bf16 v[152:155], v[44:47], v[64:67], v[152:155]
    ds_read_b64_tr_b16 v[40:41], v5 offset:8192
    v_mfma_f32_16x16x32_bf16 v[156:159], v[44:47], v[68:71], v[156:159]
    ds_read_b64_tr_b16 v[42:43], v5 offset:9216
    s_waitcnt vmcnt(8) lgkmcnt(10)
    v_mfma_f32_16x16x32_bf16 v[128:131], v[48:51], v[72:75], v[128:131]
    buffer_load_dwordx4 v[112:115], v2, s[4:7], s42 offen offset:0 sc1
    ds_read_b64_tr_b16 v[44:45], v6 offset:8192
    v_mfma_f32_16x16x32_bf16 v[132:135], v[48:51], v[76:79], v[132:135]
    ds_read_b64_tr_b16 v[46:47], v6 offset:9216
    v_mfma_f32_16x16x32_bf16 v[136:139], v[52:55], v[72:75], v[136:139]
    ds_read_b64_tr_b16 v[48:49], v3 offset:12288
    v_mfma_f32_16x16x32_bf16 v[140:143], v[52:55], v[76:79], v[140:143]
    ds_read_b64_tr_b16 v[50:51], v3 offset:13312
    s_waitcnt lgkmcnt(10)
    v_mfma_f32_16x16x32_bf16 v[144:147], v[56:59], v[72:75], v[144:147]
    buffer_load_dwordx4 v[116:119], v2, s[4:7], s42 offen offset:256 sc1
    ds_read_b64_tr_b16 v[52:53], v4 offset:12288
    s_xor_b32 s42, s41, 28672
    v_mfma_f32_16x16x32_bf16 v[148:151], v[56:59], v[76:79], v[148:151]
    ds_read_b64_tr_b16 v[54:55], v4 offset:13312
    v_mfma_f32_16x16x32_bf16 v[152:155], v[60:63], v[72:75], v[152:155]
    ds_read_b64_tr_b16 v[56:57], v5 offset:12288
    v_mfma_f32_16x16x32_bf16 v[156:159], v[60:63], v[76:79], v[156:159]
    ds_read_b64_tr_b16 v[58:59], v5 offset:13312
    s_waitcnt vmcnt(8) lgkmcnt(10)
    v_mfma_f32_16x16x32_bf16 v[128:131], v[32:35], v[80:83], v[128:131]
    ds_read_b64_tr_b16 v[60:61], v6 offset:12288
    buffer_load_dwordx4 v[120:123], v2, s[4:7], s42 offen offset:0 sc1
    v_mfma_f32_16x16x32_bf16 v[132:135], v[32:35], v[84:87], v[132:135]
    ds_read_b64_tr_b16 v[62:63], v6 offset:13312
    v_mfma_f32_16x16x32_bf16 v[136:139], v[36:39], v[80:83], v[136:139]
    ds_read_b64_tr_b16 v[32:33], v3 offset:16384
    v_mfma_f32_16x16x32_bf16 v[140:143], v[36:39], v[84:87], v[140:143]
    ds_read_b64_tr_b16 v[34:35], v3 offset:17408
    s_waitcnt lgkmcnt(10)
    v_mfma_f32_16x16x32_bf16 v[144:147], v[40:43], v[80:83], v[144:147]
    buffer_load_dwordx4 v[124:127], v2, s[4:7], s42 offen offset:256 sc1
    ds_read_b64_tr_b16 v[36:37], v4 offset:16384
    s_xor_b32 s42, s41, 32768
    v_mfma_f32_16x16x32_bf16 v[148:151], v[40:43], v[84:87], v[148:151]
    ds_read_b64_tr_b16 v[38:39], v4 offset:17408
    v_mfma_f32_16x16x32_bf16 v[152:155], v[44:47], v[80:83], v[152:155]
    ds_read_b64_tr_b16 v[40:41], v5 offset:16384
    v_mfma_f32_16x16x32_bf16 v[156:159], v[44:47], v[84:87], v[156:159]
    ds_read_b64_tr_b16 v[42:43], v5 offset:17408
    s_waitcnt vmcnt(8) lgkmcnt(10)
    v_mfma_f32_16x16x32_bf16 v[128:131], v[48:51], v[88:91], v[128:131]
    buffer_load_dwordx4 v[160:163], v2, s[4:7], s42 offen offset:0 sc1
    ds_read_b64_tr_b16 v[44:45], v6 offset:16384
    v_mfma_f32_16x16x32_bf16 v[132:135], v[48:51], v[92:95], v[132:135]
    ds_read_b64_tr_b16 v[46:47], v6 offset:17408
    v_mfma_f32_16x16x32_bf16 v[136:139], v[52:55], v[88:91], v[136:139]
    ds_read_b64_tr_b16 v[48:49], v3 offset:20480
    v_mfma_f32_16x16x32_bf16 v[140:143], v[52:55], v[92:95], v[140:143]
    ds_read_b64_tr_b16 v[50:51], v3 offset:21504
    s_waitcnt lgkmcnt(10)
    v_mfma_f32_16x16x32_bf16 v[144:147], v[56:59], v[88:91], v[144:147]
    buffer_load_dwordx4 v[164:167], v2, s[4:7], s42 offen offset:256 sc1
    ds_read_b64_tr_b16 v[52:53], v4 offset:20480
    s_xor_b32 s42, s41, 36864
    v_mfma_f32_16x16x32_bf16 v[148:151], v[56:59], v[92:95], v[148:151]
    ds_read_b64_tr_b16 v[54:55], v4 offset:21504
    v_mfma_f32_16x16x32_bf16 v[152:155], v[60:63], v[88:91], v[152:155]
    ds_read_b64_tr_b16 v[56:57], v5 offset:20480
    v_mfma_f32_16x16x32_bf16 v[156:159], v[60:63], v[92:95], v[156:159]
    ds_read_b64_tr_b16 v[58:59], v5 offset:21504
    s_waitcnt vmcnt(8) lgkmcnt(10)
    v_mfma_f32_16x16x32_bf16 v[128:131], v[32:35], v[96:99], v[128:131]
    ds_read_b64_tr_b16 v[60:61], v6 offset:20480
    buffer_load_dwordx4 v[168:171], v2, s[4:7], s42 offen offset:0 sc1
    v_mfma_f32_16x16x32_bf16 v[132:135], v[32:35], v[100:103], v[132:135]
    ds_read_b64_tr_b16 v[62:63], v6 offset:21504
    v_mfma_f32_16x16x32_bf16 v[136:139], v[36:39], v[96:99], v[136:139]
    ds_read_b64_tr_b16 v[32:33], v3 offset:24576
    v_mfma_f32_16x16x32_bf16 v[140:143], v[36:39], v[100:103], v[140:143]
    ds_read_b64_tr_b16 v[34:35], v3 offset:25600
    s_waitcnt lgkmcnt(10)
    v_mfma_f32_16x16x32_bf16 v[144:147], v[40:43], v[96:99], v[144:147]
    buffer_load_dwordx4 v[172:175], v2, s[4:7], s42 offen offset:256 sc1
    ds_read_b64_tr_b16 v[36:37], v4 offset:24576
    s_xor_b32 s42, s41, 40960
    v_mfma_f32_16x16x32_bf16 v[148:151], v[40:43], v[100:103], v[148:151]
    ds_read_b64_tr_b16 v[38:39], v4 offset:25600
    v_mfma_f32_16x16x32_bf16 v[152:155], v[44:47], v[96:99], v[152:155]
    ds_read_b64_tr_b16 v[40:41], v5 offset:24576
    v_mfma_f32_16x16x32_bf16 v[156:159], v[44:47], v[100:103], v[156:159]
    ds_read_b64_tr_b16 v[42:43], v5 offset:25600
    s_waitcnt vmcnt(8) lgkmcnt(10)
    v_mfma_f32_16x16x32_bf16 v[128:131], v[48:51], v[104:107], v[128:131]
    buffer_load_dwordx4 v[176:179], v2, s[4:7], s42 offen offset:0 sc1
    ds_read_b64_tr_b16 v[44:45], v6 offset:24576
    v_mfma_f32_16x16x32_bf16 v[132:135], v[48:51], v[108:111], v[132:135]
    ds_read_b64_tr_b16 v[46:47], v6 offset:25600
    v_mfma_f32_16x16x32_bf16 v[136:139], v[52:55], v[104:107], v[136:139]
    ds_read_b64_tr_b16 v[48:49], v3 offset:28672
    v_mfma_f32_16x16x32_bf16 v[140:143], v[52:55], v[108:111], v[140:143]
    ds_read_b64_tr_b16 v[50:51], v3 offset:29696
    s_waitcnt lgkmcnt(10)
    v_mfma_f32_16x16x32_bf16 v[144:147], v[56:59], v[104:107], v[144:147]
    buffer_load_dwordx4 v[180:183], v2, s[4:7], s42 offen offset:256 sc1
    ds_read_b64_tr_b16 v[52:53], v4 offset:28672
    s_xor_b32 s42, s41, 45056
    v_mfma_f32_16x16x32_bf16 v[148:151], v[56:59], v[108:111], v[148:151]
    ds_read_b64_tr_b16 v[54:55], v4 offset:29696
    v_mfma_f32_16x16x32_bf16 v[152:155], v[60:63], v[104:107], v[152:155]
    ds_read_b64_tr_b16 v[56:57], v5 offset:28672
    v_mfma_f32_16x16x32_bf16 v[156:159], v[60:63], v[108:111], v[156:159]
    ds_read_b64_tr_b16 v[58:59], v5 offset:29696
    s_waitcnt vmcnt(8) lgkmcnt(10)
    v_mfma_f32_16x16x32_bf16 v[128:131], v[32:35], v[112:115], v[128:131]
    ds_read_b64_tr_b16 v[60:61], v6 offset:28672
    buffer_load_dwordx4 v[184:187], v2, s[4:7], s42 offen offset:0 sc1
    v_mfma_f32_16x16x32_bf16 v[132:135], v[32:35], v[116:119], v[132:135]
    ds_read_b64_tr_b16 v[62:63], v6 offset:29696
    v_mfma_f32_16x16x32_bf16 v[136:139], v[36:39], v[112:115], v[136:139]
    ds_read_b64_tr_b16 v[32:33], v3 offset:32768
    v_mfma_f32_16x16x32_bf16 v[140:143], v[36:39], v[116:119], v[140:143]
    ds_read_b64_tr_b16 v[34:35], v3 offset:33792
    s_waitcnt lgkmcnt(10)
    v_mfma_f32_16x16x32_bf16 v[144:147], v[40:43], v[112:115], v[144:147]
    buffer_load_dwordx4 v[188:191], v2, s[4:7], s42 offen offset:256 sc1
    ds_read_b64_tr_b16 v[36:37], v4 offset:32768
    s_xor_b32 s42, s41, 49152
    v_mfma_f32_16x16x32_bf16 v[148:151], v[40:43], v[116:119], v[148:151]
    ds_read_b64_tr_b16 v[38:39], v4 offset:33792
    v_mfma_f32_16x16x32_bf16 v[152:155], v[44:47], v[112:115], v[152:155]
    ds_read_b64_tr_b16 v[40:41], v5 offset:32768
    v_mfma_f32_16x16x32_bf16 v[156:159], v[44:47], v[116:119], v[156:159]
    ds_read_b64_tr_b16 v[42:43], v5 offset:33792
    s_waitcnt vmcnt(8) lgkmcnt(10)
    v_mfma_f32_16x16x32_bf16 v[128:131], v[48:51], v[120:123], v[128:131]
    buffer_load_dwordx4 v[64:67], v2, s[4:7], s42 offen offset:0 sc1
    ds_read_b64_tr_b16 v[44:45], v6 offset:32768
    v_mfma_f32_16x16x32_bf16 v[132:135], v[48:51], v[124:127], v[132:135]
    ds_read_b64_tr_b16 v[46:47], v6 offset:33792
    v_mfma_f32_16x16x32_bf16 v[136:139], v[52:55], v[120:123], v[136:139]
    ds_read_b64_tr_b16 v[48:49], v3 offset:36864
    v_mfma_f32_16x16x32_bf16 v[140:143], v[52:55], v[124:127], v[140:143]
    ds_read_b64_tr_b16 v[50:51], v3 offset:37888
    s_waitcnt lgkmcnt(10)
    v_mfma_f32_16x16x32_bf16 v[144:147], v[56:59], v[120:123], v[144:147]
    buffer_load_dwordx4 v[68:71], v2, s[4:7], s42 offen offset:256 sc1
    ds_read_b64_tr_b16 v[52:53], v4 offset:36864
    s_xor_b32 s42, s41, 53248
    v_mfma_f32_16x16x32_bf16 v[148:151], v[56:59], v[124:127], v[148:151]
    ds_read_b64_tr_b16 v[54:55], v4 offset:37888
    v_mfma_f32_16x16x32_bf16 v[152:155], v[60:63], v[120:123], v[152:155]
    ds_read_b64_tr_b16 v[56:57], v5 offset:36864
    v_mfma_f32_16x16x32_bf16 v[156:159], v[60:63], v[124:127], v[156:159]
    ds_read_b64_tr_b16 v[58:59], v5 offset:37888
    s_waitcnt vmcnt(8) lgkmcnt(10)
    v_mfma_f32_16x16x32_bf16 v[128:131], v[32:35], v[160:163], v[128:131]
    ds_read_b64_tr_b16 v[60:61], v6 offset:36864
    buffer_load_dwordx4 v[72:75], v2, s[4:7], s42 offen offset:0 sc1
    v_mfma_f32_16x16x32_bf16 v[132:135], v[32:35], v[164:167], v[132:135]
    ds_read_b64_tr_b16 v[62:63], v6 offset:37888
    v_mfma_f32_16x16x32_bf16 v[136:139], v[36:39], v[160:163], v[136:139]
    ds_read_b64_tr_b16 v[32:33], v3 offset:40960
    v_mfma_f32_16x16x32_bf16 v[140:143], v[36:39], v[164:167], v[140:143]
    ds_read_b64_tr_b16 v[34:35], v3 offset:41984
    s_waitcnt lgkmcnt(10)
    v_mfma_f32_16x16x32_bf16 v[144:147], v[40:43], v[160:163], v[144:147]
    buffer_load_dwordx4 v[76:79], v2, s[4:7], s42 offen offset:256 sc1
    ds_read_b64_tr_b16 v[36:37], v4 offset:40960
    s_xor_b32 s42, s41, 57344
    v_mfma_f32_16x16x32_bf16 v[148:151], v[40:43], v[164:167], v[148:151]
    ds_read_b64_tr_b16 v[38:39], v4 offset:41984
    v_mfma_f32_16x16x32_bf16 v[152:155], v[44:47], v[160:163], v[152:155]
    ds_read_b64_tr_b16 v[40:41], v5 offset:40960
    v_mfma_f32_16x16x32_bf16 v[156:159], v[44:47], v[164:167], v[156:159]
    ds_read_b64_tr_b16 v[42:43], v5 offset:41984
    s_waitcnt vmcnt(8) lgkmcnt(10)
    v_mfma_f32_16x16x32_bf16 v[128:131], v[48:51], v[168:171], v[128:131]
    buffer_load_dwordx4 v[80:83], v2, s[4:7], s42 offen offset:0 sc1
    ds_read_b64_tr_b16 v[44:45], v6 offset:40960
    v_mfma_f32_16x16x32_bf16 v[132:135], v[48:51], v[172:175], v[132:135]
    ds_read_b64_tr_b16 v[46:47], v6 offset:41984
    v_mfma_f32_16x16x32_bf16 v[136:139], v[52:55], v[168:171], v[136:139]
    ds_read_b64_tr_b16 v[48:49], v3 offset:45056
    v_mfma_f32_16x16x32_bf16 v[140:143], v[52:55], v[172:175], v[140:143]
    ds_read_b64_tr_b16 v[50:51], v3 offset:46080
    s_waitcnt lgkmcnt(10)
    v_mfma_f32_16x16x32_bf16 v[144:147], v[56:59], v[168:171], v[144:147]
    buffer_load_dwordx4 v[84:87], v2, s[4:7], s42 offen offset:256 sc1
    ds_read_b64_tr_b16 v[52:53], v4 offset:45056
    s_xor_b32 s42, s41, 61440
    v_mfma_f32_16x16x32_bf16 v[148:151], v[56:59], v[172:175], v[148:151]
    ds_read_b64_tr_b16 v[54:55], v4 offset:46080
    v_mfma_f32_16x16x32_bf16 v[152:155], v[60:63], v[168:171], v[152:155]
    ds_read_b64_tr_b16 v[56:57], v5 offset:45056
    v_mfma_f32_16x16x32_bf16 v[156:159], v[60:63], v[172:175], v[156:159]
    ds_read_b64_tr_b16 v[58:59], v5 offset:46080
    s_waitcnt vmcnt(8) lgkmcnt(10)
    v_mfma_f32_16x16x32_bf16 v[128:131], v[32:35], v[176:179], v[128:131]
    ds_read_b64_tr_b16 v[60:61], v6 offset:45056
    buffer_load_dwordx4 v[88:91], v2, s[4:7], s42 offen offset:0 sc1
    v_mfma_f32_16x16x32_bf16 v[132:135], v[32:35], v[180:183], v[132:135]
    ds_read_b64_tr_b16 v[62:63], v6 offset:46080
    s_barrier
    v_mfma_f32_16x16x32_bf16 v[136:139], v[36:39], v[176:179], v[136:139]
    ds_read_b64_tr_b16 v[32:33], v3 offset:49152
    v_mfma_f32_16x16x32_bf16 v[140:143], v[36:39], v[180:183], v[140:143]
    ds_read_b64_tr_b16 v[34:35], v3 offset:50176
    s_waitcnt lgkmcnt(10)
    v_mfma_f32_16x16x32_bf16 v[144:147], v[40:43], v[176:179], v[144:147]
    buffer_load_dwordx4 v[92:95], v2, s[4:7], s42 offen offset:256 sc1
    ds_read_b64_tr_b16 v[36:37], v4 offset:49152
    s_xor_b32 s42, s41, 0
    v_mfma_f32_16x16x32_bf16 v[148:151], v[40:43], v[180:183], v[148:151]
    ds_read_b64_tr_b16 v[38:39], v4 offset:50176
    v_mfma_f32_16x16x32_bf16 v[152:155], v[44:47], v[176:179], v[152:155]
    ds_read_b64_tr_b16 v[40:41], v5 offset:49152
    v_mfma_f32_16x16x32_bf16 v[156:159], v[44:47], v[180:183], v[156:159]
    ds_read_b64_tr_b16 v[42:43], v5 offset:50176
    s_waitcnt vmcnt(8) lgkmcnt(10)
    v_mfma_f32_16x16x32_bf16 v[128:131], v[48:51], v[184:187], v[128:131]
    buffer_load_dwordx4 v[96:99], v2, s[4:7], s42 offen offset:2048 sc1
    ds_read_b64_tr_b16 v[44:45], v6 offset:49152
    v_mfma_f32_16x16x32_bf16 v[132:135], v[48:51], v[188:191], v[132:135]
    ds_read_b64_tr_b16 v[46:47], v6 offset:50176
    v_mfma_f32_16x16x32_bf16 v[136:139], v[52:55], v[184:187], v[136:139]
    ds_read_b64_tr_b16 v[48:49], v3 offset:53248
    v_mfma_f32_16x16x32_bf16 v[140:143], v[52:55], v[188:191], v[140:143]
    ds_read_b64_tr_b16 v[50:51], v3 offset:54272
    s_waitcnt lgkmcnt(10)
    v_mfma_f32_16x16x32_bf16 v[144:147], v[56:59], v[184:187], v[144:147]
    buffer_load_dwordx4 v[100:103], v2, s[4:7], s42 offen offset:2304 sc1
    ds_read_b64_tr_b16 v[52:53], v4 offset:53248
    s_xor_b32 s42, s41, 4096
    v_mfma_f32_16x16x32_bf16 v[148:151], v[56:59], v[188:191], v[148:151]
    ds_read_b64_tr_b16 v[54:55], v4 offset:54272
    v_mfma_f32_16x16x32_bf16 v[152:155], v[60:63], v[184:187], v[152:155]
    ds_read_b64_tr_b16 v[56:57], v5 offset:53248
    v_mfma_f32_16x16x32_bf16 v[156:159], v[60:63], v[188:191], v[156:159]
    ds_read_b64_tr_b16 v[58:59], v5 offset:54272
    s_waitcnt vmcnt(8) lgkmcnt(10)
    v_mfma_f32_16x16x32_bf16 v[128:131], v[32:35], v[64:67], v[128:131]
    ds_read_b64_tr_b16 v[60:61], v6 offset:53248
    buffer_load_dwordx4 v[104:107], v2, s[4:7], s42 offen offset:2048 sc1
    v_mfma_f32_16x16x32_bf16 v[132:135], v[32:35], v[68:71], v[132:135]
    ds_read_b64_tr_b16 v[62:63], v6 offset:54272
    v_mfma_f32_16x16x32_bf16 v[136:139], v[36:39], v[64:67], v[136:139]
    ds_read_b64_tr_b16 v[32:33], v3 offset:57344
    v_mfma_f32_16x16x32_bf16 v[140:143], v[36:39], v[68:71], v[140:143]
    ds_read_b64_tr_b16 v[34:35], v3 offset:58368
    s_waitcnt lgkmcnt(10)
    v_mfma_f32_16x16x32_bf16 v[144:147], v[40:43], v[64:67], v[144:147]
    buffer_load_dwordx4 v[108:111], v2, s[4:7], s42 offen offset:2304 sc1
    ds_read_b64_tr_b16 v[36:37], v4 offset:57344
    s_xor_b32 s42, s41, 8192
    v_mfma_f32_16x16x32_bf16 v[148:151], v[40:43], v[68:71], v[148:151]
    ds_read_b64_tr_b16 v[38:39], v4 offset:58368
    v_mfma_f32_16x16x32_bf16 v[152:155], v[44:47], v[64:67], v[152:155]
    ds_read_b64_tr_b16 v[40:41], v5 offset:57344
    v_mfma_f32_16x16x32_bf16 v[156:159], v[44:47], v[68:71], v[156:159]
    ds_read_b64_tr_b16 v[42:43], v5 offset:58368
    s_waitcnt vmcnt(8) lgkmcnt(10)
    v_mfma_f32_16x16x32_bf16 v[128:131], v[48:51], v[72:75], v[128:131]
    buffer_load_dwordx4 v[112:115], v2, s[4:7], s42 offen offset:2048 sc1
    ds_read_b64_tr_b16 v[44:45], v6 offset:57344
    v_mfma_f32_16x16x32_bf16 v[132:135], v[48:51], v[76:79], v[132:135]
    ds_read_b64_tr_b16 v[46:47], v6 offset:58368
    v_mfma_f32_16x16x32_bf16 v[136:139], v[52:55], v[72:75], v[136:139]
    ds_read_b64_tr_b16 v[48:49], v3 offset:61440
    v_mfma_f32_16x16x32_bf16 v[140:143], v[52:55], v[76:79], v[140:143]
    ds_read_b64_tr_b16 v[50:51], v3 offset:62464
    s_waitcnt lgkmcnt(10)
    v_mfma_f32_16x16x32_bf16 v[144:147], v[56:59], v[72:75], v[144:147]
    buffer_load_dwordx4 v[116:119], v2, s[4:7], s42 offen offset:2304 sc1
    ds_read_b64_tr_b16 v[52:53], v4 offset:61440
    s_xor_b32 s42, s41, 12288
    v_mfma_f32_16x16x32_bf16 v[148:151], v[56:59], v[76:79], v[148:151]
    ds_read_b64_tr_b16 v[54:55], v4 offset:62464
    v_mfma_f32_16x16x32_bf16 v[152:155], v[60:63], v[72:75], v[152:155]
    ds_read_b64_tr_b16 v[56:57], v5 offset:61440
    v_mfma_f32_16x16x32_bf16 v[156:159], v[60:63], v[76:79], v[156:159]
    ds_read_b64_tr_b16 v[58:59], v5 offset:62464
    s_waitcnt vmcnt(8) lgkmcnt(10)
    v_mfma_f32_16x16x32_bf16 v[128:131], v[32:35], v[80:83], v[128:131]
    ds_read_b64_tr_b16 v[60:61], v6 offset:61440
    buffer_load_dwordx4 v[120:123], v2, s[4:7], s42 offen offset:2048 sc1
    v_mfma_f32_16x16x32_bf16 v[132:135], v[32:35], v[84:87], v[132:135]
    ds_read_b64_tr_b16 v[62:63], v6 offset:62464
    v_xor_b32 v3, 0x10000, v3
    v_xor_b32 v4, 0x10000, v4
    v_xor_b32 v5, 0x10000, v5
    v_xor_b32 v6, 0x10000, v6
    v_mfma_f32_16x16x32_bf16 v[136:139], v[36:39], v[80:83], v[136:139]
    ds_read_b64_tr_b16 v[32:33], v3 offset:0
    v_mfma_f32_16x16x32_bf16 v[140:143], v[36:39], v[84:87], v[140:143]
    ds_read_b64_tr_b16 v[34:35], v3 offset:1024
    s_waitcnt lgkmcnt(10)
    v_mfma_f32_16x16x32_bf16 v[144:147], v[40:43], v[80:83], v[144:147]
    buffer_load_dwordx4 v[124:127], v2, s[4:7], s42 offen offset:2304 sc1
    ds_read_b64_tr_b16 v[36:37], v4 offset:0
    s_xor_b32 s42, s41, 16384
    v_mfma_f32_16x16x32_bf16 v[148:151], v[40:43], v[84:87], v[148:151]
    ds_read_b64_tr_b16 v[38:39], v4 offset:1024
    v_mfma_f32_16x16x32_bf16 v[152:155], v[44:47], v[80:83], v[152:155]
    ds_read_b64_tr_b16 v[40:41], v5 offset:0
    v_mfma_f32_16x16x32_bf16 v[156:159], v[44:47], v[84:87], v[156:159]
    ds_read_b64_tr_b16 v[42:43], v5 offset:1024
    s_waitcnt vmcnt(8) lgkmcnt(10)
    v_mfma_f32_16x16x32_bf16 v[128:131], v[48:51], v[88:91], v[128:131]
    buffer_load_dwordx4 v[160:163], v2, s[4:7], s42 offen offset:2048 sc1
    ds_read_b64_tr_b16 v[44:45], v6 offset:0
    v_mfma_f32_16x16x32_bf16 v[132:135], v[48:51], v[92:95], v[132:135]
    ds_read_b64_tr_b16 v[46:47], v6 offset:1024
    v_mfma_f32_16x16x32_bf16 v[136:139], v[52:55], v[88:91], v[136:139]
    ds_read_b64_tr_b16 v[48:49], v3 offset:4096
    v_mfma_f32_16x16x32_bf16 v[140:143], v[52:55], v[92:95], v[140:143]
    ds_read_b64_tr_b16 v[50:51], v3 offset:5120
    s_waitcnt lgkmcnt(10)
    v_mfma_f32_16x16x32_bf16 v[144:147], v[56:59], v[88:91], v[144:147]
    buffer_load_dwordx4 v[164:167], v2, s[4:7], s42 offen offset:2304 sc1
    ds_read_b64_tr_b16 v[52:53], v4 offset:4096
    s_xor_b32 s42, s41, 20480
    v_mfma_f32_16x16x32_bf16 v[148:151], v[56:59], v[92:95], v[148:151]
    ds_read_b64_tr_b16 v[54:55], v4 offset:5120
    v_mfma_f32_16x16x32_bf16 v[152:155], v[60:63], v[88:91], v[152:155]
    ds_read_b64_tr_b16 v[56:57], v5 offset:4096
    v_mfma_f32_16x16x32_bf16 v[156:159], v[60:63], v[92:95], v[156:159]
    ds_read_b64_tr_b16 v[58:59], v5 offset:5120
    s_waitcnt vmcnt(8) lgkmcnt(10)
    v_mfma_f32_16x16x32_bf16 v[128:131], v[32:35], v[96:99], v[128:131]
    ds_read_b64_tr_b16 v[60:61], v6 offset:4096
    buffer_load_dwordx4 v[168:171], v2, s[4:7], s42 offen offset:2048 sc1
    v_mfma_f32_16x16x32_bf16 v[132:135], v[32:35], v[100:103], v[132:135]
    ds_read_b64_tr_b16 v[62:63], v6 offset:5120
    v_mfma_f32_16x16x32_bf16 v[136:139], v[36:39], v[96:99], v[136:139]
    ds_read_b64_tr_b16 v[32:33], v3 offset:8192
    v_mfma_f32_16x16x32_bf16 v[140:143], v[36:39], v[100:103], v[140:143]
    ds_read_b64_tr_b16 v[34:35], v3 offset:9216
    s_waitcnt lgkmcnt(10)
    v_mfma_f32_16x16x32_bf16 v[144:147], v[40:43], v[96:99], v[144:147]
    buffer_load_dwordx4 v[172:175], v2, s[4:7], s42 offen offset:2304 sc1
    ds_read_b64_tr_b16 v[36:37], v4 offset:8192
    s_xor_b32 s42, s41, 24576
    v_mfma_f32_16x16x32_bf16 v[148:151], v[40:43], v[100:103], v[148:151]
    ds_read_b64_tr_b16 v[38:39], v4 offset:9216
    v_mfma_f32_16x16x32_bf16 v[152:155], v[44:47], v[96:99], v[152:155]
    ds_read_b64_tr_b16 v[40:41], v5 offset:8192
    v_mfma_f32_16x16x32_bf16 v[156:159], v[44:47], v[100:103], v[156:159]
    ds_read_b64_tr_b16 v[42:43], v5 offset:9216
    s_waitcnt vmcnt(8) lgkmcnt(10)
    v_mfma_f32_16x16x32_bf16 v[128:131], v[48:51], v[104:107], v[128:131]
    buffer_load_dwordx4 v[176:179], v2, s[4:7], s42 offen offset:2048 sc1
    ds_read_b64_tr_b16 v[44:45], v6 offset:8192
    v_mfma_f32_16x16x32_bf16 v[132:135], v[48:51], v[108:111], v[132:135]
    ds_read_b64_tr_b16 v[46:47], v6 offset:9216
    v_mfma_f32_16x16x32_bf16 v[136:139], v[52:55], v[104:107], v[136:139]
    ds_read_b64_tr_b16 v[48:49], v3 offset:12288
    v_mfma_f32_16x16x32_bf16 v[140:143], v[52:55], v[108:111], v[140:143]
    ds_read_b64_tr_b16 v[50:51], v3 offset:13312
    s_waitcnt lgkmcnt(10)
    v_mfma_f32_16x16x32_bf16 v[144:147], v[56:59], v[104:107], v[144:147]
    buffer_load_dwordx4 v[180:183], v2, s[4:7], s42 offen offset:2304 sc1
    ds_read_b64_tr_b16 v[52:53], v4 offset:12288
    s_xor_b32 s42, s41, 28672
    v_mfma_f32_16x16x32_bf16 v[148:151], v[56:59], v[108:111], v[148:151]
    ds_read_b64_tr_b16 v[54:55], v4 offset:13312
    v_mfma_f32_16x16x32_bf16 v[152:155], v[60:63], v[104:107], v[152:155]
    ds_read_b64_tr_b16 v[56:57], v5 offset:12288
    v_mfma_f32_16x16x32_bf16 v[156:159], v[60:63], v[108:111], v[156:159]
    ds_read_b64_tr_b16 v[58:59], v5 offset:13312
    s_waitcnt vmcnt(8) lgkmcnt(10)
    v_mfma_f32_16x16x32_bf16 v[128:131], v[32:35], v[112:115], v[128:131]
    ds_read_b64_tr_b16 v[60:61], v6 offset:12288
    buffer_load_dwordx4 v[184:187], v2, s[4:7], s42 offen offset:2048 sc1
    v_mfma_f32_16x16x32_bf16 v[132:135], v[32:35], v[116:119], v[132:135]
    ds_read_b64_tr_b16 v[62:63], v6 offset:13312
    v_mfma_f32_16x16x32_bf16 v[136:139], v[36:39], v[112:115], v[136:139]
    ds_read_b64_tr_b16 v[32:33], v3 offset:16384
    v_mfma_f32_16x16x32_bf16 v[140:143], v[36:39], v[116:119], v[140:143]
    ds_read_b64_tr_b16 v[34:35], v3 offset:17408
    s_waitcnt lgkmcnt(10)
    v_mfma_f32_16x16x32_bf16 v[144:147], v[40:43], v[112:115], v[144:147]
    buffer_load_dwordx4 v[188:191], v2, s[4:7], s42 offen offset:2304 sc1
    ds_read_b64_tr_b16 v[36:37], v4 offset:16384
    s_xor_b32 s42, s41, 32768
    v_mfma_f32_16x16x32_bf16 v[148:151], v[40:43], v[116:119], v[148:151]
    ds_read_b64_tr_b16 v[38:39], v4 offset:17408
    v_mfma_f32_16x16x32_bf16 v[152:155], v[44:47], v[112:115], v[152:155]
    ds_read_b64_tr_b16 v[40:41], v5 offset:16384
    v_mfma_f32_16x16x32_bf16 v[156:159], v[44:47], v[116:119], v[156:159]
    ds_read_b64_tr_b16 v[42:43], v5 offset:17408
    s_waitcnt vmcnt(8) lgkmcnt(10)
    v_mfma_f32_16x16x32_bf16 v[128:131], v[48:51], v[120:123], v[128:131]
    buffer_load_dwordx4 v[64:67], v2, s[4:7], s42 offen offset:2048 sc1
    ds_read_b64_tr_b16 v[44:45], v6 offset:16384
    v_mfma_f32_16x16x32_bf16 v[132:135], v[48:51], v[124:127], v[132:135]
    ds_read_b64_tr_b16 v[46:47], v6 offset:17408
    v_mfma_f32_16x16x32_bf16 v[136:139], v[52:55], v[120:123], v[136:139]
    ds_read_b64_tr_b16 v[48:49], v3 offset:20480
    v_mfma_f32_16x16x32_bf16 v[140:143], v[52:55], v[124:127], v[140:143]
    ds_read_b64_tr_b16 v[50:51], v3 offset:21504
    s_waitcnt lgkmcnt(10)
    v_mfma_f32_16x16x32_bf16 v[144:147], v[56:59], v[120:123], v[144:147]
    buffer_load_dwordx4 v[68:71], v2, s[4:7], s42 offen offset:2304 sc1
    ds_read_b64_tr_b16 v[52:53], v4 offset:20480
    s_xor_b32 s42, s41, 36864
    v_mfma_f32_16x16x32_bf16 v[148:151], v[56:59], v[124:127], v[148:151]
    ds_read_b64_tr_b16 v[54:55], v4 offset:21504
    v_mfma_f32_16x16x32_bf16 v[152:155], v[60:63], v[120:123], v[152:155]
    ds_read_b64_tr_b16 v[56:57], v5 offset:20480
    v_mfma_f32_16x16x32_bf16 v[156:159], v[60:63], v[124:127], v[156:159]
    ds_read_b64_tr_b16 v[58:59], v5 offset:21504
    s_waitcnt vmcnt(8) lgkmcnt(10)
    v_mfma_f32_16x16x32_bf16 v[128:131], v[32:35], v[160:163], v[128:131]
    ds_read_b64_tr_b16 v[60:61], v6 offset:20480
    buffer_load_dwordx4 v[72:75], v2, s[4:7], s42 offen offset:2048 sc1
    v_mfma_f32_16x16x32_bf16 v[132:135], v[32:35], v[164:167], v[132:135]
    ds_read_b64_tr_b16 v[62:63], v6 offset:21504
    v_mfma_f32_16x16x32_bf16 v[136:139], v[36:39], v[160:163], v[136:139]
    ds_read_b64_tr_b16 v[32:33], v3 offset:24576
    v_mfma_f32_16x16x32_bf16 v[140:143], v[36:39], v[164:167], v[140:143]
    ds_read_b64_tr_b16 v[34:35], v3 offset:25600
    s_waitcnt lgkmcnt(10)
    v_mfma_f32_16x16x32_bf16 v[144:147], v[40:43], v[160:163], v[144:147]
    buffer_load_dwordx4 v[76:79], v2, s[4:7], s42 offen offset:2304 sc1
    ds_read_b64_tr_b16 v[36:37], v4 offset:24576
    s_xor_b32 s42, s41, 40960
    v_mfma_f32_16x16x32_bf16 v[148:151], v[40:43], v[164:167], v[148:151]
    ds_read_b64_tr_b16 v[38:39], v4 offset:25600
    v_mfma_f32_16x16x32_bf16 v[152:155], v[44:47], v[160:163], v[152:155]
    ds_read_b64_tr_b16 v[40:41], v5 offset:24576
    v_mfma_f32_16x16x32_bf16 v[156:159], v[44:47], v[164:167], v[156:159]
    ds_read_b64_tr_b16 v[42:43], v5 offset:25600
    s_waitcnt vmcnt(8) lgkmcnt(10)
    v_mfma_f32_16x16x32_bf16 v[128:131], v[48:51], v[168:171], v[128:131]
    buffer_load_dwordx4 v[80:83], v2, s[4:7], s42 offen offset:2048 sc1
    ds_read_b64_tr_b16 v[44:45], v6 offset:24576
    v_mfma_f32_16x16x32_bf16 v[132:135], v[48:51], v[172:175], v[132:135]
    ds_read_b64_tr_b16 v[46:47], v6 offset:25600
    v_mfma_f32_16x16x32_bf16 v[136:139], v[52:55], v[168:171], v[136:139]
    ds_read_b64_tr_b16 v[48:49], v3 offset:28672
    v_mfma_f32_16x16x32_bf16 v[140:143], v[52:55], v[172:175], v[140:143]
    ds_read_b64_tr_b16 v[50:51], v3 offset:29696
    s_waitcnt lgkmcnt(10)
    v_mfma_f32_16x16x32_bf16 v[144:147], v[56:59], v[168:171], v[144:147]
    buffer_load_dwordx4 v[84:87], v2, s[4:7], s42 offen offset:2304 sc1
    ds_read_b64_tr_b16 v[52:53], v4 offset:28672
    s_xor_b32 s42, s41, 45056
    v_mfma_f32_16x16x32_bf16 v[148:151], v[56:59], v[172:175], v[148:151]
    ds_read_b64_tr_b16 v[54:55], v4 offset:29696
    v_mfma_f32_16x16x32_bf16 v[152:155], v[60:63], v[168:171], v[152:155]
    ds_read_b64_tr_b16 v[56:57], v5 offset:28672
    v_mfma_f32_16x16x32_bf16 v[156:159], v[60:63], v[172:175], v[156:159]
    ds_read_b64_tr_b16 v[58:59], v5 offset:29696
    s_waitcnt vmcnt(8) lgkmcnt(10)
    v_mfma_f32_16x16x32_bf16 v[128:131], v[32:35], v[176:179], v[128:131]
    ds_read_b64_tr_b16 v[60:61], v6 offset:28672
    buffer_load_dwordx4 v[88:91], v2, s[4:7], s42 offen offset:2048 sc1
    v_mfma_f32_16x16x32_bf16 v[132:135], v[32:35], v[180:183], v[132:135]
    ds_read_b64_tr_b16 v[62:63], v6 offset:29696
    v_mfma_f32_16x16x32_bf16 v[136:139], v[36:39], v[176:179], v[136:139]
    ds_read_b64_tr_b16 v[32:33], v3 offset:32768
    v_mfma_f32_16x16x32_bf16 v[140:143], v[36:39], v[180:183], v[140:143]
    ds_read_b64_tr_b16 v[34:35], v3 offset:33792
    s_waitcnt lgkmcnt(10)
    v_mfma_f32_16x16x32_bf16 v[144:147], v[40:43], v[176:179], v[144:147]
    buffer_load_dwordx4 v[92:95], v2, s[4:7], s42 offen offset:2304 sc1
    ds_read_b64_tr_b16 v[36:37], v4 offset:32768
    s_xor_b32 s42, s41, 49152
    v_mfma_f32_16x16x32_bf16 v[148:151], v[40:43], v[180:183], v[148:151]
    ds_read_b64_tr_b16 v[38:39], v4 offset:33792
    v_mfma_f32_16x16x32_bf16 v[152:155], v[44:47], v[176:179], v[152:155]
    ds_read_b64_tr_b16 v[40:41], v5 offset:32768
    v_mfma_f32_16x16x32_bf16 v[156:159], v[44:47], v[180:183], v[156:159]
    ds_read_b64_tr_b16 v[42:43], v5 offset:33792
    s_waitcnt vmcnt(8) lgkmcnt(10)
    v_mfma_f32_16x16x32_bf16 v[128:131], v[48:51], v[184:187], v[128:131]
    buffer_load_dwordx4 v[96:99], v2, s[4:7], s42 offen offset:2048 sc1
    ds_read_b64_tr_b16 v[44:45], v6 offset:32768
    v_mfma_f32_16x16x32_bf16 v[132:135], v[48:51], v[188:191], v[132:135]
    ds_read_b64_tr_b16 v[46:47], v6 offset:33792
    v_mfma_f32_16x16x32_bf16 v[136:139], v[52:55], v[184:187], v[136:139]
    ds_read_b64_tr_b16 v[48:49], v3 offset:36864
    v_mfma_f32_16x16x32_bf16 v[140:143], v[52:55], v[188:191], v[140:143]
    ds_read_b64_tr_b16 v[50:51], v3 offset:37888
    s_waitcnt lgkmcnt(10)
    v_mfma_f32_16x16x32_bf16 v[144:147], v[56:59], v[184:187], v[144:147]
    buffer_load_dwordx4 v[100:103], v2, s[4:7], s42 offen offset:2304 sc1
    ds_read_b64_tr_b16 v[52:53], v4 offset:36864
    s_xor_b32 s42, s41, 53248
    v_mfma_f32_16x16x32_bf16 v[148:151], v[56:59], v[188:191], v[148:151]
    ds_read_b64_tr_b16 v[54:55], v4 offset:37888
    v_mfma_f32_16x16x32_bf16 v[152:155], v[60:63], v[184:187], v[152:155]
    ds_read_b64_tr_b16 v[56:57], v5 offset:36864
    v_mfma_f32_16x16x32_bf16 v[156:159], v[60:63], v[188:191], v[156:159]
    ds_read_b64_tr_b16 v[58:59], v5 offset:37888
    s_waitcnt vmcnt(8) lgkmcnt(10)
    v_mfma_f32_16x16x32_bf16 v[128:131], v[32:35], v[64:67], v[128:131]
    ds_read_b64_tr_b16 v[60:61], v6 offset:36864
    buffer_load_dwordx4 v[104:107], v2, s[4:7], s42 offen offset:2048 sc1
    v_mfma_f32_16x16x32_bf16 v[132:135], v[32:35], v[68:71], v[132:135]
    ds_read_b64_tr_b16 v[62:63], v6 offset:37888
    v_mfma_f32_16x16x32_bf16 v[136:139], v[36:39], v[64:67], v[136:139]
    ds_read_b64_tr_b16 v[32:33], v3 offset:40960
    v_mfma_f32_16x16x32_bf16 v[140:143], v[36:39], v[68:71], v[140:143]
    ds_read_b64_tr_b16 v[34:35], v3 offset:41984
    s_waitcnt lgkmcnt(10)
    v_mfma_f32_16x16x32_bf16 v[144:147], v[40:43], v[64:67], v[144:147]
    buffer_load_dwordx4 v[108:111], v2, s[4:7], s42 offen offset:2304 sc1
    ds_read_b64_tr_b16 v[36:37], v4 offset:40960
    s_xor_b32 s42, s41, 57344
    v_mfma_f32_16x16x32_bf16 v[148:151], v[40:43], v[68:71], v[148:151]
    ds_read_b64_tr_b16 v[38:39], v4 offset:41984
    v_mfma_f32_16x16x32_bf16 v[152:155], v[44:47], v[64:67], v[152:155]
    ds_read_b64_tr_b16 v[40:41], v5 offset:40960
    v_mfma_f32_16x16x32_bf16 v[156:159], v[44:47], v[68:71], v[156:159]
    ds_read_b64_tr_b16 v[42:43], v5 offset:41984
    s_waitcnt vmcnt(8) lgkmcnt(10)
    v_mfma_f32_16x16x32_bf16 v[128:131], v[48:51], v[72:75], v[128:131]
    buffer_load_dwordx4 v[112:115], v2, s[4:7], s42 offen offset:2048 sc1
    ds_read_b64_tr_b16 v[44:45], v6 offset:40960
    v_mfma_f32_16x16x32_bf16 v[132:135], v[48:51], v[76:79], v[132:135]
    ds_read_b64_tr_b16 v[46:47], v6 offset:41984
    v_mfma_f32_16x16x32_bf16 v[136:139], v[52:55], v[72:75], v[136:139]
    ds_read_b64_tr_b16 v[48:49], v3 offset:45056
    v_mfma_f32_16x16x32_bf16 v[140:143], v[52:55], v[76:79], v[140:143]
    ds_read_b64_tr_b16 v[50:51], v3 offset:46080
    s_waitcnt lgkmcnt(10)
    v_mfma_f32_16x16x32_bf16 v[144:147], v[56:59], v[72:75], v[144:147]
    buffer_load_dwordx4 v[116:119], v2, s[4:7], s42 offen offset:2304 sc1
    ds_read_b64_tr_b16 v[52:53], v4 offset:45056
    s_xor_b32 s42, s41, 61440
    v_mfma_f32_16x16x32_bf16 v[148:151], v[56:59], v[76:79], v[148:151]
    ds_read_b64_tr_b16 v[54:55], v4 offset:46080
    v_mfma_f32_16x16x32_bf16 v[152:155], v[60:63], v[72:75], v[152:155]
    ds_read_b64_tr_b16 v[56:57], v5 offset:45056
    v_mfma_f32_16x16x32_bf16 v[156:159], v[60:63], v[76:79], v[156:159]
    ds_read_b64_tr_b16 v[58:59], v5 offset:46080
    s_waitcnt vmcnt(8) lgkmcnt(10)
    v_mfma_f32_16x16x32_bf16 v[128:131], v[32:35], v[80:83], v[128:131]
    ds_read_b64_tr_b16 v[60:61], v6 offset:45056
    buffer_load_dwordx4 v[120:123], v2, s[4:7], s42 offen offset:2048 sc1
    v_mfma_f32_16x16x32_bf16 v[132:135], v[32:35], v[84:87], v[132:135]
    ds_read_b64_tr_b16 v[62:63], v6 offset:46080
    v_mfma_f32_16x16x32_bf16 v[136:139], v[36:39], v[80:83], v[136:139]
    ds_read_b64_tr_b16 v[32:33], v3 offset:49152
    v_mfma_f32_16x16x32_bf16 v[140:143], v[36:39], v[84:87], v[140:143]
    ds_read_b64_tr_b16 v[34:35], v3 offset:50176
    s_waitcnt lgkmcnt(10)
    v_mfma_f32_16x16x32_bf16 v[144:147], v[40:43], v[80:83], v[144:147]
    buffer_load_dwordx4 v[124:127], v2, s[4:7], s42 offen offset:2304 sc1
    ds_read_b64_tr_b16 v[36:37], v4 offset:49152
    v_mfma_f32_16x16x32_bf16 v[148:151], v[40:43], v[84:87], v[148:151]
    ds_read_b64_tr_b16 v[38:39], v4 offset:50176
    v_mfma_f32_16x16x32_bf16 v[152:155], v[44:47], v[80:83], v[152:155]
    ds_read_b64_tr_b16 v[40:41], v5 offset:49152
    v_mfma_f32_16x16x32_bf16 v[156:159], v[44:47], v[84:87], v[156:159]
    ds_read_b64_tr_b16 v[42:43], v5 offset:50176
    s_waitcnt vmcnt(8) lgkmcnt(10)
    v_mfma_f32_16x16x32_bf16 v[128:131], v[48:51], v[88:91], v[128:131]
    ds_read_b64_tr_b16 v[44:45], v6 offset:49152
    v_mfma_f32_16x16x32_bf16 v[132:135], v[48:51], v[92:95], v[132:135]
    ds_read_b64_tr_b16 v[46:47], v6 offset:50176
    v_mfma_f32_16x16x32_bf16 v[136:139], v[52:55], v[88:91], v[136:139]
    ds_read_b64_tr_b16 v[48:49], v3 offset:53248
    v_mfma_f32_16x16x32_bf16 v[140:143], v[52:55], v[92:95], v[140:143]
    ds_read_b64_tr_b16 v[50:51], v3 offset:54272
    s_waitcnt lgkmcnt(10)
    v_mfma_f32_16x16x32_bf16 v[144:147], v[56:59], v[88:91], v[144:147]
    ds_read_b64_tr_b16 v[52:53], v4 offset:53248
    v_mfma_f32_16x16x32_bf16 v[148:151], v[56:59], v[92:95], v[148:151]
    ds_read_b64_tr_b16 v[54:55], v4 offset:54272
    v_mfma_f32_16x16x32_bf16 v[152:155], v[60:63], v[88:91], v[152:155]
    ds_read_b64_tr_b16 v[56:57], v5 offset:53248
    v_mfma_f32_16x16x32_bf16 v[156:159], v[60:63], v[92:95], v[156:159]
    ds_read_b64_tr_b16 v[58:59], v5 offset:54272
    s_waitcnt vmcnt(6) lgkmcnt(10)
    v_mfma_f32_16x16x32_bf16 v[128:131], v[32:35], v[96:99], v[128:131]
    ds_read_b64_tr_b16 v[60:61], v6 offset:53248
    v_mfma_f32_16x16x32_bf16 v[132:135], v[32:35], v[100:103], v[132:135]
    ds_read_b64_tr_b16 v[62:63], v6 offset:54272
    v_mfma_f32_16x16x32_bf16 v[136:139], v[36:39], v[96:99], v[136:139]
    ds_read_b64_tr_b16 v[32:33], v3 offset:57344
    v_mfma_f32_16x16x32_bf16 v[140:143], v[36:39], v[100:103], v[140:143]
    ds_read_b64_tr_b16 v[34:35], v3 offset:58368
    s_waitcnt lgkmcnt(10)
    v_mfma_f32_16x16x32_bf16 v[144:147], v[40:43], v[96:99], v[144:147]
    ds_read_b64_tr_b16 v[36:37], v4 offset:57344
    v_mfma_f32_16x16x32_bf16 v[148:151], v[40:43], v[100:103], v[148:151]
    ds_read_b64_tr_b16 v[38:39], v4 offset:58368
    v_mfma_f32_16x16x32_bf16 v[152:155], v[44:47], v[96:99], v[152:155]
    ds_read_b64_tr_b16 v[40:41], v5 offset:57344
    v_mfma_f32_16x16x32_bf16 v[156:159], v[44:47], v[100:103], v[156:159]
    ds_read_b64_tr_b16 v[42:43], v5 offset:58368
    s_waitcnt vmcnt(4) lgkmcnt(10)
    v_mfma_f32_16x16x32_bf16 v[128:131], v[48:51], v[104:107], v[128:131]
    ds_read_b64_tr_b16 v[44:45], v6 offset:57344
    v_mfma_f32_16x16x32_bf16 v[132:135], v[48:51], v[108:111], v[132:135]
    ds_read_b64_tr_b16 v[46:47], v6 offset:58368
    v_mfma_f32_16x16x32_bf16 v[136:139], v[52:55], v[104:107], v[136:139]
    ds_read_b64_tr_b16 v[48:49], v3 offset:61440
    v_mfma_f32_16x16x32_bf16 v[140:143], v[52:55], v[108:111], v[140:143]
    ds_read_b64_tr_b16 v[50:51], v3 offset:62464
    s_waitcnt lgkmcnt(10)
    v_mfma_f32_16x16x32_bf16 v[144:147], v[56:59], v[104:107], v[144:147]
    ds_read_b64_tr_b16 v[52:53], v4 offset:61440
    v_mfma_f32_16x16x32_bf16 v[148:151], v[56:59], v[108:111], v[148:151]
    ds_read_b64_tr_b16 v[54:55], v4 offset:62464
    v_mfma_f32_16x16x32_bf16 v[152:155], v[60:63], v[104:107], v[152:155]
    ds_read_b64_tr_b16 v[56:57], v5 offset:61440
    v_mfma_f32_16x16x32_bf16 v[156:159], v[60:63], v[108:111], v[156:159]
    ds_read_b64_tr_b16 v[58:59], v5 offset:62464
    s_waitcnt vmcnt(2) lgkmcnt(10)
    v_mfma_f32_16x16x32_bf16 v[128:131], v[32:35], v[112:115], v[128:131]
    ds_read_b64_tr_b16 v[60:61], v6 offset:61440
    v_mfma_f32_16x16x32_bf16 v[132:135], v[32:35], v[116:119], v[132:135]
    ds_read_b64_tr_b16 v[62:63], v6 offset:62464
    v_xor_b32 v3, 0x10000, v3
    v_xor_b32 v4, 0x10000, v4
    v_xor_b32 v5, 0x10000, v5
    v_xor_b32 v6, 0x10000, v6
    v_mfma_f32_16x16x32_bf16 v[136:139], v[36:39], v[112:115], v[136:139]
    v_mfma_f32_16x16x32_bf16 v[140:143], v[36:39], v[116:119], v[140:143]
    s_waitcnt lgkmcnt(8)
    v_mfma_f32_16x16x32_bf16 v[144:147], v[40:43], v[112:115], v[144:147]
    v_mfma_f32_16x16x32_bf16 v[148:151], v[40:43], v[116:119], v[148:151]
    v_mfma_f32_16x16x32_bf16 v[152:155], v[44:47], v[112:115], v[152:155]
    v_mfma_f32_16x16x32_bf16 v[156:159], v[44:47], v[116:119], v[156:159]
    s_waitcnt vmcnt(0) lgkmcnt(4)
    v_mfma_f32_16x16x32_bf16 v[128:131], v[48:51], v[120:123], v[128:131]
    v_mfma_f32_16x16x32_bf16 v[132:135], v[48:51], v[124:127], v[132:135]
    v_mfma_f32_16x16x32_bf16 v[136:139], v[52:55], v[120:123], v[136:139]
    v_mfma_f32_16x16x32_bf16 v[140:143], v[52:55], v[124:127], v[140:143]
    s_waitcnt lgkmcnt(0)
    v_mfma_f32_16x16x32_bf16 v[144:147], v[56:59], v[120:123], v[144:147]
    v_mfma_f32_16x16x32_bf16 v[148:151], v[56:59], v[124:127], v[148:151]
    v_mfma_f32_16x16x32_bf16 v[152:155], v[60:63], v[120:123], v[152:155]
    v_mfma_f32_16x16x32_bf16 v[156:159], v[60:63], v[124:127], v[156:159]
    s_cmp_eq_u32 s21, 3
    s_cbranch_scc1 c_final
    s_add_u32 s43, s43, 4194304
    v_cvt_pk_bf16_f32 v160, v128, v129
    v_cvt_pk_bf16_f32 v161, v130, v131
    v_cvt_pk_bf16_f32 v162, v136, v137
    v_cvt_pk_bf16_f32 v163, v138, v139
    v_cvt_pk_bf16_f32 v168, v144, v145
    v_cvt_pk_bf16_f32 v169, v146, v147
    v_cvt_pk_bf16_f32 v170, v152, v153
    v_cvt_pk_bf16_f32 v171, v154, v155
    v_permlane32_swap_b32 v160, v162
    v_permlane32_swap_b32 v161, v163
    buffer_store_dwordx4 v[160:163], v2, s[4:7], s43 offen offset:0 sc1
    v_permlane32_swap_b32 v168, v170
    v_permlane32_swap_b32 v169, v171
    buffer_store_dwordx4 v[168:171], v2, s[4:7], s43 offen offset:2048 sc1
    v_cvt_pk_bf16_f32 v164, v132, v133
    v_cvt_pk_bf16_f32 v165, v134, v135
    v_cvt_pk_bf16_f32 v166, v140, v141
    v_cvt_pk_bf16_f32 v167, v142, v143
    v_cvt_pk_bf16_f32 v172, v148, v149
    v_cvt_pk_bf16_f32 v173, v150, v151
    v_cvt_pk_bf16_f32 v174, v156, v157
    v_cvt_pk_bf16_f32 v175, v158, v159
    v_permlane32_swap_b32 v164, v166
    v_permlane32_swap_b32 v165, v167
    buffer_store_dwordx4 v[164:167], v2, s[4:7], s43 offen offset:256 sc1
    v_permlane32_swap_b32 v172, v174
    v_permlane32_swap_b32 v173, v175
    buffer_store_dwordx4 v[172:175], v2, s[4:7], s43 offen offset:2304 sc1
    s_barrier
    s_add_u32 s21, s21, 1
    v_mov_b32 v22, 0x3f803f80
    v_dot2_f32_bf16 v24, v160, v22, 0
    v_dot2_f32_bf16 v25, v160, v160, 0
    v_dot2_f32_bf16 v26, v164, v22, 0
    v_dot2_f32_bf16 v27, v164, v164, 0
    v_dot2_f32_bf16 v24, v161, v22, v24
    v_dot2_f32_bf16 v25, v161, v161, v25
    v_dot2_f32_bf16 v26, v165, v22, v26
    v_dot2_f32_bf16 v27, v165, v165, v27
    v_dot2_f32_bf16 v24, v162, v22, v24
    v_dot2_f32_bf16 v25, v162, v162, v25
    v_dot2_f32_bf16 v26, v166, v22, v26
    v_dot2_f32_bf16 v27, v166, v166, v27
    v_dot2_f32_bf16 v24, v163, v22, v24
    v_dot2_f32_bf16 v25, v163, v163, v25
    v_dot2_f32_bf16 v26, v167, v22, v26
    v_dot2_f32_bf16 v27, v167, v167, v27
    v_dot2_f32_bf16 v24, v168, v22, v24
    v_dot2_f32_bf16 v25, v168, v168, v25
    v_dot2_f32_bf16 v26, v172, v22, v26
    v_dot2_f32_bf16 v27, v172, v172, v27
    v_dot2_f32_bf16 v24, v169, v22, v24
    v_dot2_f32_bf16 v25, v169, v169, v25
    v_dot2_f32_bf16 v26, v173, v22, v26
    v_dot2_f32_bf16 v27, v173, v173, v27
    v_dot2_f32_bf16 v24, v170, v22, v24
    v_dot2_f32_bf16 v25, v170, v170, v25
    v_dot2_f32_bf16 v26, v174, v22, v26
    v_dot2_f32_bf16 v27, v174, v174, v27
    v_dot2_f32_bf16 v24, v171, v22, v24
    v_dot2_f32_bf16 v25, v171, v171, v25
    v_dot2_f32_bf16 v26, v175, v22, v26
    v_dot2_f32_bf16 v27, v175, v175, v27
    v_lshrrev_b32 v23, 1, v1
    v_and_b32 v23, 0xf8, v23
    s_nop 0
    v_permlane16_swap_b32 v24, v26
    v_permlane16_swap_b32 v25, v27
    v_pk_add_f32 v[24:25], v[24:25], v[26:27]
    v_mov_b32 v26, v24
    v_mov_b32 v27, v25
    s_nop 0
    v_permlane32_swap_b32 v24, v26
    v_permlane32_swap_b32 v25, v27
    v_pk_add_f32 v[24:25], v[24:25], v[26:27]
    s_lshl_b32 s44, s21, 18
    s_lshl_b32 s45, s38, 12
    s_add_u32 s44, s44, s45
    s_lshl_b32 s45, s18, 8
    s_add_u32 s44, s44, s45
    s_add_u32 s44, s44, 50331648
    buffer_store_dwordx2 v[24:25], v23, s[4:7], s44 offen sc1
    s_lshl_b32 s46, s21, 14
    s_lshl_b32 s67, s38, 7
    s_add_u32 s46, s46, s67
    s_add_u32 s46, s46, 4096
    s_add_u32 s47, s46, 8192
    s_lshl_b32 s48, s21, 22
    s_lshl_b32 s49, s38, 16
    s_add_u32 s41, s48, s49
    v_lshrrev_b32 v16, 4, v1
    v_and_b32 v17, 15, v16
    v_lshrrev_b32 v16, 4, v16
    s_lshl_b32 s49, s16, 7
    s_add_u32 s50, s49, 151552
    s_and_b32 s49, s21, 1
    s_lshl_b32 s49, s49, 10
    s_add_u32 s49, s49, 151552
    v_lshlrev_b32 v11, 4, v16
    v_add_u32 v13, s50, v11
    v_add_u32 v11, s49, v11
    v_lshlrev_b32 v15, 2, v17
    v_add_u32 v9, s50, v15
    v_add_u32 v15, s49, v15
    s_lshr_b32 s49, s21, 1
    s_lshl_b32 s53, s49, 23
    s_lshl_b32 s50, s18, 18
    s_add_u32 s53, s53, s50
    s_add_u32 s53, s53, 33554432
    s_lshl_b32 s54, s38, 11
    s_add_u32 s52, s53, s54
    s_lshl_b32 s59, s49, 13
    s_lshl_b32 s67, s18, 9
    s_add_u32 s59, s59, s67
    s_lshl_b32 s67, s16, 7
    s_add_u32 s59, s59, s67
    s_add_u32 s59, s59, 69632
    s_lshl_b32 s61, s49, 15
    s_lshl_b32 s67, s17, 11
    s_add_u32 s61, s61, s67
    s_lshl_b32 s67, s18, 7
    s_add_u32 s61, s61, s67
    s_add_u32 s61, s61, 151552
    s_sub_u32 s60, s61, 151552
    s_lshl_b32 s60, s60, 5
    s_add_u32 s60, s60, 54525952
    s_lshl_b32 s62, s16, 12
    s_add_u32 s62, s62, 131072
    s_mov_b32 s68, s63
    s_waitcnt vmcnt(1)
    s_atomic_add s68, s[22:23], s46 glc
    s_mov_b32 s48, 0
    s_branch c_layer
c_final:
    s_mov_b32 s8, s32
    s_mov_b32 s9, s33
    s_mov_b32 s10, 4194304
    s_mov_b32 s11, 0x00020000
    v_lshrrev_b32 v12, 4, v1
    s_mul_i32 s44, s16, 4608
    s_add_u32 s44, s44, 131072
    v_and_b32 v13, 15, v12
    v_mul_u32_u24 v13, 144, v13
    v_lshrrev_b32 v14, 4, v12
    v_lshl_add_u32 v13, v14, 3, v13
    v_add_u32 v13, s44, v13
    v_cvt_pk_bf16_f32 v128, v128, v129
    v_cvt_pk_bf16_f32 v129, v130, v131
    ds_write_b64 v13, v[128:129] offset:0
    v_cvt_pk_bf16_f32 v136, v136, v137
    v_cvt_pk_bf16_f32 v137, v138, v139
    ds_write_b64 v13, v[136:137] offset:32
    v_cvt_pk_bf16_f32 v144, v144, v145
    v_cvt_pk_bf16_f32 v145, v146, v147
    ds_write_b64 v13, v[144:145] offset:64
    v_cvt_pk_bf16_f32 v152, v152, v153
    v_cvt_pk_bf16_f32 v153, v154, v155
    ds_write_b64 v13, v[152:153] offset:96
    v_cvt_pk_bf16_f32 v132, v132, v133
    v_cvt_pk_bf16_f32 v133, v134, v135
    ds_write_b64 v13, v[132:133] offset:2304
    v_cvt_pk_bf16_f32 v140, v140, v141
    v_cvt_pk_bf16_f32 v141, v142, v143
    ds_write_b64 v13, v[140:141] offset:2336
    v_cvt_pk_bf16_f32 v148, v148, v149
    v_cvt_pk_bf16_f32 v149, v150, v151
    ds_write_b64 v13, v[148:149] offset:2368
    v_cvt_pk_bf16_f32 v156, v156, v157
    v_cvt_pk_bf16_f32 v157, v158, v159
    ds_write_b64 v13, v[156:157] offset:2400
    v_lshrrev_b32 v14, 3, v12
    v_and_b32 v15, 7, v12
    v_mul_u32_u24 v16, 144, v14
    v_lshl_add_u32 v16, v15, 4, v16
    v_add_u32 v16, s44, v16
    v_lshlrev_b32 v17, 11, v14
    v_lshl_add_u32 v17, v15, 4, v17
    ds_read_b128 v[32:35], v16 offset:0
    ds_read_b128 v[36:39], v16 offset:1152
    ds_read_b128 v[40:43], v16 offset:2304
    ds_read_b128 v[44:47], v16 offset:3456
    s_lshl_b32 s44, s38, 16
    s_lshl_b32 s45, s18, 7
    s_add_u32 s44, s44, s45
    s_waitcnt lgkmcnt(3)
    buffer_store_dwordx4 v[32:35], v17, s[8:11], s44 offen sc1
    s_add_u32 s44, s44, 16384
    s_waitcnt lgkmcnt(2)
    buffer_store_dwordx4 v[36:39], v17, s[8:11], s44 offen sc1
    s_add_u32 s44, s44, 16384
    s_waitcnt lgkmcnt(1)
    buffer_store_dwordx4 v[40:43], v17, s[8:11], s44 offen sc1
    s_add_u32 s44, s44, 16384
    s_waitcnt lgkmcnt(0)
    buffer_store_dwordx4 v[44:47], v17, s[8:11], s44 offen sc1
    s_endpgm
s_start:
    v_mov_b32 v14, 0
    v_mov_b32 v15, 0
    v_mov_b32 v20, 0
    v_mov_b32 v21, 0
    v_mov_b32 v22, 0
    s_mov_b32 s41, 0
    s_mov_b32 s42, 0
    s_mov_b32 s43, 0
    s_mov_b32 s62, 0
    s_cmp_eq_u32 s16, 4
    s_cbranch_scc1 h_start
    s_cmp_eq_u32 s16, 7
    s_cbranch_scc1 z_start
l_start:
    v_lshrrev_b32 v24, 4, v1
    v_lshrrev_b32 v25, 3, v24
    v_mul_u32_u24 v12, 6144, v25
    v_and_b32 v26, 2, v25
    v_lshrrev_b32 v25, 2, v25
    v_or_b32 v26, v26, v25
    v_bfe_u32 v25, v24, 1, 2
    v_xor_b32 v26, v26, v25
    v_lshl_add_u32 v12, v26, 5, v12
    v_and_b32 v26, 1, v24
    v_lshl_add_u32 v12, v26, 4, v12
    s_lshl_b32 s3, s18, 7
    v_add_u32 v12, s3, v12
    v_add_u32 v13, 48128, v12
    s_mul_i32 s84, s18, 393216
    s_cmp_lt_u32 s18, 4
    s_cselect_b32 s85, 4, 0
    s_mul_i32 s85, s85, 393216
    s_sub_u32 s3, s16, 5
    s_lshl_b32 s41, s3, 11
    s_mul_i32 s42, s3, 98304
    s_lshl_b32 s62, s3, 15
    v_add_u32 v14, s42, v12
    v_add_u32 v15, s42, v13
    s_bitcmp1_b32 s21, 0
    s_cselect_b32 s8, s28, s24
    s_cselect_b32 s9, s29, s25
    s_cselect_b32 s12, s30, s26
    s_cselect_b32 s13, s31, s27
    s_mov_b32 s10, 6291456
    s_mov_b32 s11, 0x00020000
    s_mov_b32 s14, 2097152
    s_mov_b32 s15, 0x00020000
    s_add_u32 m0, s41, 0
    s_add_u32 s44, s84, 2048
    buffer_load_dwordx4 v14, s[8:11], s44 offen offset:0 lds
    buffer_load_dwordx4 v15, s[8:11], s44 offen offset:1024 lds
    s_add_u32 m0, s41, 4096
    s_add_u32 s44, s84, 4096
    buffer_load_dwordx4 v14, s[8:11], s44 offen offset:0 lds
    buffer_load_dwordx4 v15, s[8:11], s44 offen offset:1024 lds
    s_add_u32 m0, s41, 8192
    s_add_u32 s44, s84, 0
    buffer_load_dwordx4 v14, s[8:11], s44 offen offset:0 lds
    buffer_load_dwordx4 v15, s[8:11], s44 offen offset:1024 lds
    s_add_u32 m0, s41, 12288
    s_add_u32 s44, s84, 198656
    buffer_load_dwordx4 v14, s[8:11], s44 offen offset:0 lds
    buffer_load_dwordx4 v15, s[8:11], s44 offen offset:1024 lds
    s_add_u32 m0, s41, 16384
    s_add_u32 s44, s84, 200704
    buffer_load_dwordx4 v14, s[8:11], s44 offen offset:0 lds
    buffer_load_dwordx4 v15, s[8:11], s44 offen offset:1024 lds
    s_add_u32 m0, s41, 20480
    s_add_u32 s44, s84, 196608
    buffer_load_dwordx4 v14, s[8:11], s44 offen offset:0 lds
    buffer_load_dwordx4 v15, s[8:11], s44 offen offset:1024 lds
    s_add_u32 m0, s41, 24576
    s_add_u32 s44, s85, 2048
    buffer_load_dwordx4 v14, s[8:11], s44 offen offset:0 lds
    buffer_load_dwordx4 v15, s[8:11], s44 offen offset:1024 lds
    s_add_u32 m0, s41, 28672
    s_add_u32 s44, s85, 4096
    buffer_load_dwordx4 v14, s[8:11], s44 offen offset:0 lds
    buffer_load_dwordx4 v15, s[8:11], s44 offen offset:1024 lds
    s_cmp_lt_u32 s18, 4
    s_cselect_b32 s86, 5, 1
    s_mul_i32 s86, s86, 393216
    s_cmp_lt_u32 s18, 4
    s_cselect_b32 s87, 6, 2
    s_mul_i32 s87, s87, 393216
    s_cmp_lt_u32 s18, 4
    s_cselect_b32 s88, 7, 3
    s_mul_i32 s88, s88, 393216
    s_cmp_lt_u32 s18, 8
    s_cselect_b32 s89, 8, 4
    s_mul_i32 s89, s89, 393216
    s_cmp_lt_u32 s18, 8
    s_cselect_b32 s90, 9, 5
    s_mul_i32 s90, s90, 393216
    s_cmp_lt_u32 s18, 8
    s_cselect_b32 s91, 10, 6
    s_mul_i32 s91, s91, 393216
    s_cmp_lt_u32 s18, 8
    s_cselect_b32 s92, 11, 7
    s_mul_i32 s92, s92, 393216
    s_cmp_lt_u32 s18, 12
    s_cselect_b32 s93, 12, 8
    s_mul_i32 s93, s93, 393216
    s_cmp_lt_u32 s18, 12
    s_cselect_b32 s94, 13, 9
    s_mul_i32 s94, s94, 393216
    s_cmp_lt_u32 s18, 12
    s_cselect_b32 s95, 14, 10
    s_mul_i32 s95, s95, 393216
    s_cmp_lt_u32 s18, 12
    s_cselect_b32 s96, 15, 11
    s_mul_i32 s96, s96, 393216
    s_xor_b32 s97, s18, 1
    s_mul_i32 s97, s97, 393216
    s_xor_b32 s98, s18, 2
    s_mul_i32 s98, s98, 393216
    s_xor_b32 s99, s18, 3
    s_mul_i32 s99, s99, 393216
    v_lshrrev_b32 v24, 4, v1
    v_lshrrev_b32 v25, 3, v24
    v_mul_u32_u24 v16, 2048, v25
    v_and_b32 v26, 2, v25
    v_lshrrev_b32 v25, 2, v25
    v_or_b32 v26, v26, v25
    v_bfe_u32 v25, v24, 1, 2
    v_xor_b32 v26, v26, v25
    v_lshl_add_u32 v16, v26, 5, v16
    v_and_b32 v26, 1, v24
    v_lshl_add_u32 v16, v26, 4, v16
    s_lshl_b32 s3, s18, 7
    v_add_u32 v16, s3, v16
    v_add_u32 v17, 15360, v16
    v_add_u32 v18, 30720, v16
    v_add_u32 v19, 46080, v16
    s_and_b32 s3, s16, 3
    s_mul_i32 s3, s3, 49152
    v_add_u32 v11, s3, v12
    s_and_b32 s3, s16, 3
    s_lshl_b32 s3, s3, 10
    v_add_u32 v9, s3, v1
    v_add_u32 v10, 0x10000, v9
    s_waitcnt vmcnt(0)
    s_barrier
    s_add_u32 m0, s41, 32768
    s_add_u32 s44, s85, 0
    buffer_load_dwordx4 v14, s[8:11], s44 offen offset:0 lds
    buffer_load_dwordx4 v15, s[8:11], s44 offen offset:1024 lds
    s_add_u32 m0, s41, 36864
    s_add_u32 s44, s85, 198656
    buffer_load_dwordx4 v14, s[8:11], s44 offen offset:0 lds
    buffer_load_dwordx4 v15, s[8:11], s44 offen offset:1024 lds
    s_add_u32 m0, s41, 40960
    s_add_u32 s44, s85, 200704
    buffer_load_dwordx4 v14, s[8:11], s44 offen offset:0 lds
    buffer_load_dwordx4 v15, s[8:11], s44 offen offset:1024 lds
    s_add_u32 m0, s41, 45056
    s_add_u32 s44, s85, 196608
    buffer_load_dwordx4 v14, s[8:11], s44 offen offset:0 lds
    buffer_load_dwordx4 v15, s[8:11], s44 offen offset:1024 lds
    s_add_u32 m0, s41, 49152
    s_add_u32 s44, s86, 2048
    buffer_load_dwordx4 v14, s[8:11], s44 offen offset:0 lds
    buffer_load_dwordx4 v15, s[8:11], s44 offen offset:1024 lds
    s_add_u32 m0, s41, 53248
    s_add_u32 s44, s86, 4096
    buffer_load_dwordx4 v14, s[8:11], s44 offen offset:0 lds
    buffer_load_dwordx4 v15, s[8:11], s44 offen offset:1024 lds
    s_add_u32 m0, s41, 57344
    s_add_u32 s44, s86, 0
    buffer_load_dwordx4 v14, s[8:11], s44 offen offset:0 lds
    buffer_load_dwordx4 v15, s[8:11], s44 offen offset:1024 lds
    s_add_u32 m0, s41, 61440
    s_add_u32 s44, s86, 198656
    buffer_load_dwordx4 v14, s[8:11], s44 offen offset:0 lds
    buffer_load_dwordx4 v15, s[8:11], s44 offen offset:1024 lds
    s_waitcnt vmcnt(0)
    s_barrier
    s_add_u32 m0, s41, 65536
    s_add_u32 s44, s86, 200704
    buffer_load_dwordx4 v14, s[8:11], s44 offen offset:0 lds
    buffer_load_dwordx4 v15, s[8:11], s44 offen offset:1024 lds
    s_add_u32 m0, s41, 69632
    s_add_u32 s44, s86, 196608
    buffer_load_dwordx4 v14, s[8:11], s44 offen offset:0 lds
    buffer_load_dwordx4 v15, s[8:11], s44 offen offset:1024 lds
    s_add_u32 m0, s41, 73728
    s_add_u32 s44, s87, 2048
    buffer_load_dwordx4 v14, s[8:11], s44 offen offset:0 lds
    buffer_load_dwordx4 v15, s[8:11], s44 offen offset:1024 lds
    s_add_u32 m0, s41, 77824
    s_add_u32 s44, s87, 4096
    buffer_load_dwordx4 v14, s[8:11], s44 offen offset:0 lds
    buffer_load_dwordx4 v15, s[8:11], s44 offen offset:1024 lds
    s_add_u32 m0, s41, 81920
    s_add_u32 s44, s87, 0
    buffer_load_dwordx4 v14, s[8:11], s44 offen offset:0 lds
    buffer_load_dwordx4 v15, s[8:11], s44 offen offset:1024 lds
    s_add_u32 m0, s41, 86016
    s_add_u32 s44, s87, 198656
    buffer_load_dwordx4 v14, s[8:11], s44 offen offset:0 lds
    buffer_load_dwordx4 v15, s[8:11], s44 offen offset:1024 lds
    s_add_u32 m0, s41, 90112
    s_add_u32 s44, s87, 200704
    buffer_load_dwordx4 v14, s[8:11], s44 offen offset:0 lds
    buffer_load_dwordx4 v15, s[8:11], s44 offen offset:1024 lds
    s_add_u32 m0, s41, 94208
    s_add_u32 s44, s87, 196608
    buffer_load_dwordx4 v14, s[8:11], s44 offen offset:0 lds
    buffer_load_dwordx4 v15, s[8:11], s44 offen offset:1024 lds
    s_add_u32 m0, s41, 98304
    s_add_u32 s44, s88, 2048
    buffer_load_dwordx4 v14, s[8:11], s44 offen offset:0 lds
    buffer_load_dwordx4 v15, s[8:11], s44 offen offset:1024 lds
    s_add_u32 m0, s41, 102400
    s_add_u32 s44, s88, 4096
    buffer_load_dwordx4 v14, s[8:11], s44 offen offset:0 lds
    buffer_load_dwordx4 v15, s[8:11], s44 offen offset:1024 lds
    s_add_u32 m0, s41, 106496
    s_add_u32 s44, s88, 0
    buffer_load_dwordx4 v14, s[8:11], s44 offen offset:0 lds
    buffer_load_dwordx4 v15, s[8:11], s44 offen offset:1024 lds
    s_add_u32 m0, s41, 110592
    s_add_u32 s44, s88, 198656
    buffer_load_dwordx4 v14, s[8:11], s44 offen offset:0 lds
    buffer_load_dwordx4 v15, s[8:11], s44 offen offset:1024 lds
    s_add_u32 m0, s41, 114688
    s_add_u32 s44, s88, 200704
    buffer_load_dwordx4 v14, s[8:11], s44 offen offset:0 lds
    buffer_load_dwordx4 v15, s[8:11], s44 offen offset:1024 lds
    s_add_u32 m0, s41, 118784
    s_add_u32 s44, s88, 196608
    buffer_load_dwordx4 v14, s[8:11], s44 offen offset:0 lds
    buffer_load_dwordx4 v15, s[8:11], s44 offen offset:1024 lds
    s_add_u32 m0, s41, 122880
    s_add_u32 s44, s89, 2048
    buffer_load_dwordx4 v14, s[8:11], s44 offen offset:0 lds
    buffer_load_dwordx4 v15, s[8:11], s44 offen offset:1024 lds
    s_add_u32 m0, s41, 126976
    s_add_u32 s44, s89, 4096
    buffer_load_dwordx4 v14, s[8:11], s44 offen offset:0 lds
    buffer_load_dwordx4 v15, s[8:11], s44 offen offset:1024 lds
    s_add_u32 m0, s41, 0
    s_add_u32 s44, s89, 0
    buffer_load_dwordx4 v14, s[8:11], s44 offen offset:0 lds
    buffer_load_dwordx4 v15, s[8:11], s44 offen offset:1024 lds
    s_add_u32 m0, s41, 4096
    s_add_u32 s44, s89, 198656
    buffer_load_dwordx4 v14, s[8:11], s44 offen offset:0 lds
    buffer_load_dwordx4 v15, s[8:11], s44 offen offset:1024 lds
    s_add_u32 m0, s41, 8192
    s_add_u32 s44, s89, 200704
    buffer_load_dwordx4 v14, s[8:11], s44 offen offset:0 lds
    buffer_load_dwordx4 v15, s[8:11], s44 offen offset:1024 lds
    s_add_u32 m0, s41, 12288
    s_add_u32 s44, s89, 196608
    buffer_load_dwordx4 v14, s[8:11], s44 offen offset:0 lds
    buffer_load_dwordx4 v15, s[8:11], s44 offen offset:1024 lds
    s_waitcnt vmcnt(24)
    s_branch l_join
l_layer:
    s_waitcnt lgkmcnt(0)
    s_barrier
    s_add_u32 m0, s41, 0
    s_add_u32 s44, s89, 0
    buffer_load_dwordx4 v14, s[8:11], s44 offen offset:0 lds
    buffer_load_dwordx4 v15, s[8:11], s44 offen offset:1024 lds
    s_add_u32 m0, s41, 4096
    s_add_u32 s44, s89, 198656
    buffer_load_dwordx4 v14, s[8:11], s44 offen offset:0 lds
    buffer_load_dwordx4 v15, s[8:11], s44 offen offset:1024 lds
    s_add_u32 m0, s41, 8192
    s_add_u32 s44, s89, 200704
    buffer_load_dwordx4 v14, s[8:11], s44 offen offset:0 lds
    buffer_load_dwordx4 v15, s[8:11], s44 offen offset:1024 lds
    s_add_u32 m0, s41, 12288
    s_add_u32 s44, s89, 196608
    buffer_load_dwordx4 v14, s[8:11], s44 offen offset:0 lds
    buffer_load_dwordx4 v15, s[8:11], s44 offen offset:1024 lds
l_join:
    s_barrier
    s_add_u32 m0, s41, 16384
    s_add_u32 s44, s90, 2048
    buffer_load_dwordx4 v14, s[8:11], s44 offen offset:0 lds
    buffer_load_dwordx4 v15, s[8:11], s44 offen offset:1024 lds
    s_add_u32 m0, s41, 20480
    s_add_u32 s44, s90, 4096
    buffer_load_dwordx4 v14, s[8:11], s44 offen offset:0 lds
    buffer_load_dwordx4 v15, s[8:11], s44 offen offset:1024 lds
    s_add_u32 m0, s41, 24576
    s_add_u32 s44, s90, 0
    buffer_load_dwordx4 v14, s[8:11], s44 offen offset:0 lds
    buffer_load_dwordx4 v15, s[8:11], s44 offen offset:1024 lds
    s_add_u32 m0, s41, 28672
    s_add_u32 s44, s90, 198656
    buffer_load_dwordx4 v14, s[8:11], s44 offen offset:0 lds
    buffer_load_dwordx4 v15, s[8:11], s44 offen offset:1024 lds
    s_add_u32 m0, s41, 32768
    s_add_u32 s44, s90, 200704
    buffer_load_dwordx4 v14, s[8:11], s44 offen offset:0 lds
    buffer_load_dwordx4 v15, s[8:11], s44 offen offset:1024 lds
    s_add_u32 m0, s41, 36864
    s_add_u32 s44, s90, 196608
    buffer_load_dwordx4 v14, s[8:11], s44 offen offset:0 lds
    buffer_load_dwordx4 v15, s[8:11], s44 offen offset:1024 lds
    s_add_u32 m0, s41, 40960
    s_add_u32 s44, s91, 2048
    buffer_load_dwordx4 v14, s[8:11], s44 offen offset:0 lds
    buffer_load_dwordx4 v15, s[8:11], s44 offen offset:1024 lds
    s_add_u32 m0, s41, 45056
    s_add_u32 s44, s91, 4096
    buffer_load_dwordx4 v14, s[8:11], s44 offen offset:0 lds
    buffer_load_dwordx4 v15, s[8:11], s44 offen offset:1024 lds
    s_waitcnt vmcnt(24)
    s_barrier
    s_add_u32 m0, s41, 49152
    s_add_u32 s44, s91, 0
    buffer_load_dwordx4 v14, s[8:11], s44 offen offset:0 lds
    buffer_load_dwordx4 v15, s[8:11], s44 offen offset:1024 lds
    s_add_u32 m0, s41, 53248
    s_add_u32 s44, s91, 198656
    buffer_load_dwordx4 v14, s[8:11], s44 offen offset:0 lds
    buffer_load_dwordx4 v15, s[8:11], s44 offen offset:1024 lds
    s_add_u32 m0, s41, 57344
    s_add_u32 s44, s91, 200704
    buffer_load_dwordx4 v14, s[8:11], s44 offen offset:0 lds
    buffer_load_dwordx4 v15, s[8:11], s44 offen offset:1024 lds
    s_add_u32 m0, s41, 61440
    s_add_u32 s44, s91, 196608
    buffer_load_dwordx4 v14, s[8:11], s44 offen offset:0 lds
    buffer_load_dwordx4 v15, s[8:11], s44 offen offset:1024 lds
    s_waitcnt vmcnt(16)
    s_barrier
    s_add_u32 m0, s41, 65536
    s_add_u32 s44, s92, 2048
    buffer_load_dwordx4 v14, s[8:11], s44 offen offset:0 lds
    buffer_load_dwordx4 v15, s[8:11], s44 offen offset:1024 lds
    s_add_u32 m0, s41, 69632
    s_add_u32 s44, s92, 4096
    buffer_load_dwordx4 v14, s[8:11], s44 offen offset:0 lds
    buffer_load_dwordx4 v15, s[8:11], s44 offen offset:1024 lds
    s_add_u32 m0, s41, 73728
    s_add_u32 s44, s92, 0
    buffer_load_dwordx4 v14, s[8:11], s44 offen offset:0 lds
    buffer_load_dwordx4 v15, s[8:11], s44 offen offset:1024 lds
    s_add_u32 m0, s41, 77824
    s_add_u32 s44, s92, 198656
    buffer_load_dwordx4 v14, s[8:11], s44 offen offset:0 lds
    buffer_load_dwordx4 v15, s[8:11], s44 offen offset:1024 lds
    s_add_u32 m0, s41, 81920
    s_add_u32 s44, s92, 200704
    buffer_load_dwordx4 v14, s[8:11], s44 offen offset:0 lds
    buffer_load_dwordx4 v15, s[8:11], s44 offen offset:1024 lds
    s_add_u32 m0, s41, 86016
    s_add_u32 s44, s92, 196608
    buffer_load_dwordx4 v14, s[8:11], s44 offen offset:0 lds
    buffer_load_dwordx4 v15, s[8:11], s44 offen offset:1024 lds
    s_add_u32 m0, s41, 90112
    s_add_u32 s44, s93, 2048
    buffer_load_dwordx4 v14, s[8:11], s44 offen offset:0 lds
    buffer_load_dwordx4 v15, s[8:11], s44 offen offset:1024 lds
    s_add_u32 m0, s41, 94208
    s_add_u32 s44, s93, 4096
    buffer_load_dwordx4 v14, s[8:11], s44 offen offset:0 lds
    buffer_load_dwordx4 v15, s[8:11], s44 offen offset:1024 lds
    s_waitcnt vmcnt(16)
    s_barrier
    s_add_u32 m0, s41, 98304
    s_add_u32 s44, s93, 0
    buffer_load_dwordx4 v14, s[8:11], s44 offen offset:0 lds
    buffer_load_dwordx4 v15, s[8:11], s44 offen offset:1024 lds
    s_add_u32 m0, s41, 102400
    s_add_u32 s44, s93, 198656
    buffer_load_dwordx4 v14, s[8:11], s44 offen offset:0 lds
    buffer_load_dwordx4 v15, s[8:11], s44 offen offset:1024 lds
    s_add_u32 m0, s41, 106496
    s_add_u32 s44, s93, 200704
    buffer_load_dwordx4 v14, s[8:11], s44 offen offset:0 lds
    buffer_load_dwordx4 v15, s[8:11], s44 offen offset:1024 lds
    s_add_u32 m0, s41, 110592
    s_add_u32 s44, s93, 196608
    buffer_load_dwordx4 v14, s[8:11], s44 offen offset:0 lds
    buffer_load_dwordx4 v15, s[8:11], s44 offen offset:1024 lds
    s_add_u32 m0, s41, 114688
    s_add_u32 s44, s94, 2048
    buffer_load_dwordx4 v14, s[8:11], s44 offen offset:0 lds
    buffer_load_dwordx4 v15, s[8:11], s44 offen offset:1024 lds
    s_add_u32 m0, s41, 118784
    s_add_u32 s44, s94, 4096
    buffer_load_dwordx4 v14, s[8:11], s44 offen offset:0 lds
    buffer_load_dwordx4 v15, s[8:11], s44 offen offset:1024 lds
    s_add_u32 m0, s41, 122880
    s_add_u32 s44, s94, 198656
    buffer_load_dwordx4 v14, s[8:11], s44 offen offset:0 lds
    buffer_load_dwordx4 v15, s[8:11], s44 offen offset:1024 lds
    s_add_u32 m0, s41, 126976
    s_add_u32 s44, s94, 200704
    buffer_load_dwordx4 v14, s[8:11], s44 offen offset:0 lds
    buffer_load_dwordx4 v15, s[8:11], s44 offen offset:1024 lds
    s_waitcnt vmcnt(16)
    s_barrier
    s_add_u32 m0, s41, 0
    s_add_u32 s44, s95, 2048
    buffer_load_dwordx4 v14, s[8:11], s44 offen offset:0 lds
    buffer_load_dwordx4 v15, s[8:11], s44 offen offset:1024 lds
    s_add_u32 m0, s41, 4096
    s_add_u32 s44, s95, 4096
    buffer_load_dwordx4 v14, s[8:11], s44 offen offset:0 lds
    buffer_load_dwordx4 v15, s[8:11], s44 offen offset:1024 lds
    s_add_u32 m0, s41, 8192
    s_add_u32 s44, s95, 198656
    buffer_load_dwordx4 v14, s[8:11], s44 offen offset:0 lds
    buffer_load_dwordx4 v15, s[8:11], s44 offen offset:1024 lds
    s_add_u32 m0, s41, 12288
    s_add_u32 s44, s95, 200704
    buffer_load_dwordx4 v14, s[8:11], s44 offen offset:0 lds
    buffer_load_dwordx4 v15, s[8:11], s44 offen offset:1024 lds
    s_add_u32 m0, s41, 16384
    s_add_u32 s44, s96, 2048
    buffer_load_dwordx4 v14, s[8:11], s44 offen offset:0 lds
    buffer_load_dwordx4 v15, s[8:11], s44 offen offset:1024 lds
    s_add_u32 m0, s41, 20480
    s_add_u32 s44, s96, 198656
    buffer_load_dwordx4 v14, s[8:11], s44 offen offset:0 lds
    buffer_load_dwordx4 v15, s[8:11], s44 offen offset:1024 lds
    s_add_u32 m0, s41, 24576
    s_add_u32 s44, s97, 2048
    buffer_load_dwordx4 v14, s[8:11], s44 offen offset:0 lds
    buffer_load_dwordx4 v15, s[8:11], s44 offen offset:1024 lds
    s_add_u32 m0, s41, 28672
    s_add_u32 s44, s97, 198656
    buffer_load_dwordx4 v14, s[8:11], s44 offen offset:0 lds
    buffer_load_dwordx4 v15, s[8:11], s44 offen offset:1024 lds
    s_waitcnt vmcnt(16)
    s_barrier
    s_add_u32 m0, s41, 32768
    s_add_u32 s44, s98, 2048
    buffer_load_dwordx4 v14, s[8:11], s44 offen offset:0 lds
    buffer_load_dwordx4 v15, s[8:11], s44 offen offset:1024 lds
    s_add_u32 m0, s41, 36864
    s_add_u32 s44, s98, 198656
    buffer_load_dwordx4 v14, s[8:11], s44 offen offset:0 lds
    buffer_load_dwordx4 v15, s[8:11], s44 offen offset:1024 lds
    s_add_u32 m0, s41, 40960
    s_add_u32 s44, s99, 2048
    buffer_load_dwordx4 v14, s[8:11], s44 offen offset:0 lds
    buffer_load_dwordx4 v15, s[8:11], s44 offen offset:1024 lds
    s_add_u32 m0, s41, 45056
    s_add_u32 s44, s99, 198656
    buffer_load_dwordx4 v14, s[8:11], s44 offen offset:0 lds
    buffer_load_dwordx4 v15, s[8:11], s44 offen offset:1024 lds
    s_add_u32 m0, s41, 49152
    s_add_u32 s44, s96, 4096
    buffer_load_dwordx4 v14, s[8:11], s44 offen offset:0 lds
    buffer_load_dwordx4 v15, s[8:11], s44 offen offset:1024 lds
    s_add_u32 m0, s41, 53248
    s_add_u32 s44, s96, 200704
    buffer_load_dwordx4 v14, s[8:11], s44 offen offset:0 lds
    buffer_load_dwordx4 v15, s[8:11], s44 offen offset:1024 lds
    s_add_u32 m0, s41, 57344
    s_add_u32 s44, s97, 4096
    buffer_load_dwordx4 v14, s[8:11], s44 offen offset:0 lds
    buffer_load_dwordx4 v15, s[8:11], s44 offen offset:1024 lds
    s_add_u32 m0, s41, 61440
    s_add_u32 s44, s97, 200704
    buffer_load_dwordx4 v14, s[8:11], s44 offen offset:0 lds
    buffer_load_dwordx4 v15, s[8:11], s44 offen offset:1024 lds
    s_waitcnt vmcnt(16)
    s_barrier
    s_add_u32 m0, s41, 65536
    s_add_u32 s44, s98, 4096
    buffer_load_dwordx4 v14, s[8:11], s44 offen offset:0 lds
    buffer_load_dwordx4 v15, s[8:11], s44 offen offset:1024 lds
    s_add_u32 m0, s41, 69632
    s_add_u32 s44, s98, 200704
    buffer_load_dwordx4 v14, s[8:11], s44 offen offset:0 lds
    buffer_load_dwordx4 v15, s[8:11], s44 offen offset:1024 lds
    s_add_u32 m0, s41, 73728
    s_add_u32 s44, s99, 4096
    buffer_load_dwordx4 v14, s[8:11], s44 offen offset:0 lds
    buffer_load_dwordx4 v15, s[8:11], s44 offen offset:1024 lds
    s_add_u32 m0, s41, 77824
    s_add_u32 s44, s99, 200704
    buffer_load_dwordx4 v14, s[8:11], s44 offen offset:0 lds
    buffer_load_dwordx4 v15, s[8:11], s44 offen offset:1024 lds
    s_add_u32 m0, s41, 81920
    s_add_u32 s44, s94, 0
    buffer_load_dwordx4 v14, s[8:11], s44 offen offset:0 lds
    buffer_load_dwordx4 v15, s[8:11], s44 offen offset:1024 lds
    s_add_u32 m0, s41, 86016
    s_add_u32 s44, s94, 196608
    buffer_load_dwordx4 v14, s[8:11], s44 offen offset:0 lds
    buffer_load_dwordx4 v15, s[8:11], s44 offen offset:1024 lds
    s_add_u32 m0, s41, 90112
    s_add_u32 s44, s95, 0
    buffer_load_dwordx4 v14, s[8:11], s44 offen offset:0 lds
    buffer_load_dwordx4 v15, s[8:11], s44 offen offset:1024 lds
    s_add_u32 m0, s41, 94208
    s_add_u32 s44, s95, 196608
    buffer_load_dwordx4 v14, s[8:11], s44 offen offset:0 lds
    buffer_load_dwordx4 v15, s[8:11], s44 offen offset:1024 lds
    s_waitcnt vmcnt(16)
    s_barrier
    s_add_u32 m0, s41, 98304
    s_add_u32 s44, s96, 0
    buffer_load_dwordx4 v14, s[8:11], s44 offen offset:0 lds
    buffer_load_dwordx4 v15, s[8:11], s44 offen offset:1024 lds
    s_add_u32 m0, s41, 102400
    s_add_u32 s44, s96, 196608
    buffer_load_dwordx4 v14, s[8:11], s44 offen offset:0 lds
    buffer_load_dwordx4 v15, s[8:11], s44 offen offset:1024 lds
    s_add_u32 m0, s41, 106496
    s_add_u32 s44, s97, 0
    buffer_load_dwordx4 v14, s[8:11], s44 offen offset:0 lds
    buffer_load_dwordx4 v15, s[8:11], s44 offen offset:1024 lds
    s_add_u32 m0, s41, 110592
    s_add_u32 s44, s97, 196608
    buffer_load_dwordx4 v14, s[8:11], s44 offen offset:0 lds
    buffer_load_dwordx4 v15, s[8:11], s44 offen offset:1024 lds
    s_add_u32 m0, s41, 114688
    s_add_u32 s44, s98, 0
    buffer_load_dwordx4 v14, s[8:11], s44 offen offset:0 lds
    buffer_load_dwordx4 v15, s[8:11], s44 offen offset:1024 lds
    s_add_u32 m0, s41, 118784
    s_add_u32 s44, s98, 196608
    buffer_load_dwordx4 v14, s[8:11], s44 offen offset:0 lds
    buffer_load_dwordx4 v15, s[8:11], s44 offen offset:1024 lds
    s_add_u32 m0, s41, 122880
    s_add_u32 s44, s99, 0
    buffer_load_dwordx4 v14, s[8:11], s44 offen offset:0 lds
    buffer_load_dwordx4 v15, s[8:11], s44 offen offset:1024 lds
    s_add_u32 m0, s41, 126976
    s_add_u32 s44, s99, 196608
    buffer_load_dwordx4 v14, s[8:11], s44 offen offset:0 lds
    buffer_load_dwordx4 v15, s[8:11], s44 offen offset:1024 lds
    s_waitcnt vmcnt(16)
    s_barrier
    v_lshrrev_b32 v28, 4, v1
    v_and_b32 v29, 7, v28
    v_lshrrev_b32 v28, 3, v28
    v_mul_u32_u24 v28, 2048, v28
    v_lshl_add_u32 v28, v29, 4, v28
    s_and_b32 s3, s18, 12
    s_or_b32 s3, s3, 3
    s_lshl_b32 s3, s3, 7
    v_add_u32 v28, s3, v28
    s_lshr_b32 s3, s2, 3
    s_lshl_b32 s3, s3, 2
    s_and_b32 s60, s16, 3
    s_add_u32 s60, s60, s3
    s_lshl_b32 s61, s60, 14
    buffer_load_dwordx4 v[144:147], v28, s[12:15], s61 offen
    s_bitcmp0_b32 s21, 0
    s_cselect_b32 s56, s28, s24
    s_cselect_b32 s57, s29, s25
    s_mov_b32 s58, 6291456
    s_mov_b32 s59, 0x00020000
    v_lshrrev_b32 v28, 4, v1
    v_and_b32 v29, 7, v28
    v_lshrrev_b32 v28, 3, v28
    v_mul_u32_u24 v28, 6144, v28
    v_lshl_add_u32 v28, v29, 4, v28
    s_and_b32 s3, s18, 12
    s_or_b32 s3, s3, 3
    s_lshl_b32 s3, s3, 7
    v_add_u32 v28, s3, v28
    s_lshr_b32 s3, s2, 3
    s_lshl_b32 s3, s3, 2
    s_and_b32 s60, s16, 3
    s_add_u32 s60, s60, s3
    s_and_b32 s3, s60, 31
    s_mul_i32 s3, s3, 49152
    s_lshr_b32 s61, s60, 5
    s_min_u32 s61, s61, 2
    s_lshl_b32 s61, s61, 11
    s_add_u32 s61, s61, s3
    s_cmp_lt_u32 s18, 4
    s_cselect_b32 s3, 1572864, 0
    s_add_u32 s61, s61, s3
    buffer_load_dwordx4 v[148:151], v28, s[56:59], s61 offen
    s_waitcnt vmcnt(2)
    s_cmp_lg_u32 s21, 2
    s_cbranch_scc1 l_pe
    s_bitcmp0_b32 s21, 0
    s_cselect_b32 s56, s28, s24
    s_cselect_b32 s57, s29, s25
    s_mov_b32 s58, 6291456
    s_mov_b32 s59, 0x00020000
    s_add_u32 s61, s84, 2048
    buffer_load_dwordx4 v[160:163], v11, s[56:59], s61 offen
    s_add_u32 s61, s84, 4096
    buffer_load_dwordx4 v[164:167], v11, s[56:59], s61 offen
    s_add_u32 s61, s84, 0
    buffer_load_dwordx4 v[168:171], v11, s[56:59], s61 offen
    s_add_u32 s61, s84, 198656
    buffer_load_dwordx4 v[172:175], v11, s[56:59], s61 offen
    s_add_u32 s61, s84, 200704
    buffer_load_dwordx4 v[176:179], v11, s[56:59], s61 offen
    s_add_u32 s61, s84, 196608
    buffer_load_dwordx4 v[180:183], v11, s[56:59], s61 offen
    s_add_u32 s61, s85, 2048
    buffer_load_dwordx4 v[184:187], v11, s[56:59], s61 offen
    s_add_u32 s61, s85, 4096
    buffer_load_dwordx4 v[188:191], v11, s[56:59], s61 offen
    s_add_u32 s61, s85, 0
    buffer_load_dwordx4 v[192:195], v11, s[56:59], s61 offen
    s_add_u32 s61, s85, 198656
    buffer_load_dwordx4 v[196:199], v11, s[56:59], s61 offen
l_pe:
    s_barrier
    s_bitcmp1_b32 s21, 0
    s_cbranch_scc1 s_B
    s_add_u32 m0, s41, 0
    s_xor_b32 s44, s62, 0
    buffer_load_dwordx4 v16, s[12:15], s44 offen offset:0 lds
    buffer_load_dwordx4 v17, s[12:15], s44 offen offset:1024 lds
    s_add_u32 m0, s41, 4096
    s_xor_b32 s44, s62, 131072
    buffer_load_dwordx4 v16, s[12:15], s44 offen offset:0 lds
    buffer_load_dwordx4 v17, s[12:15], s44 offen offset:1024 lds
    s_add_u32 m0, s41, 8192
    s_xor_b32 s44, s62, 262144
    buffer_load_dwordx4 v16, s[12:15], s44 offen offset:0 lds
    buffer_load_dwordx4 v17, s[12:15], s44 offen offset:1024 lds
    s_add_u32 m0, s41, 12288
    s_xor_b32 s44, s62, 393216
    buffer_load_dwordx4 v16, s[12:15], s44 offen offset:0 lds
    buffer_load_dwordx4 v17, s[12:15], s44 offen offset:1024 lds
    s_add_u32 m0, s41, 16384
    s_xor_b32 s44, s62, 524288
    buffer_load_dwordx4 v16, s[12:15], s44 offen offset:0 lds
    buffer_load_dwordx4 v17, s[12:15], s44 offen offset:1024 lds
    s_add_u32 m0, s41, 20480
    s_xor_b32 s44, s62, 655360
    buffer_load_dwordx4 v16, s[12:15], s44 offen offset:0 lds
    buffer_load_dwordx4 v17, s[12:15], s44 offen offset:1024 lds
    s_add_u32 m0, s41, 24576
    s_xor_b32 s44, s62, 786432
    buffer_load_dwordx4 v16, s[12:15], s44 offen offset:0 lds
    buffer_load_dwordx4 v17, s[12:15], s44 offen offset:1024 lds
    s_add_u32 m0, s41, 28672
    s_xor_b32 s44, s62, 917504
    buffer_load_dwordx4 v16, s[12:15], s44 offen offset:0 lds
    buffer_load_dwordx4 v17, s[12:15], s44 offen offset:1024 lds
    s_add_u32 m0, s41, 32768
    s_xor_b32 s44, s62, 1048576
    buffer_load_dwordx4 v16, s[12:15], s44 offen offset:0 lds
    buffer_load_dwordx4 v17, s[12:15], s44 offen offset:1024 lds
    s_add_u32 m0, s41, 36864
    s_xor_b32 s44, s62, 1179648
    buffer_load_dwordx4 v16, s[12:15], s44 offen offset:0 lds
    buffer_load_dwordx4 v17, s[12:15], s44 offen offset:1024 lds
    s_add_u32 m0, s41, 40960
    s_xor_b32 s44, s62, 1310720
    buffer_load_dwordx4 v16, s[12:15], s44 offen offset:0 lds
    buffer_load_dwordx4 v17, s[12:15], s44 offen offset:1024 lds
    s_add_u32 m0, s41, 45056
    s_xor_b32 s44, s62, 1441792
    buffer_load_dwordx4 v16, s[12:15], s44 offen offset:0 lds
    buffer_load_dwordx4 v17, s[12:15], s44 offen offset:1024 lds
    s_add_u32 m0, s41, 49152
    s_xor_b32 s44, s62, 1572864
    buffer_load_dwordx4 v16, s[12:15], s44 offen offset:0 lds
    buffer_load_dwordx4 v17, s[12:15], s44 offen offset:1024 lds
    s_add_u32 m0, s41, 53248
    s_xor_b32 s44, s62, 1703936
    buffer_load_dwordx4 v16, s[12:15], s44 offen offset:0 lds
    buffer_load_dwordx4 v17, s[12:15], s44 offen offset:1024 lds
    s_add_u32 m0, s41, 57344
    s_xor_b32 s44, s62, 1835008
    buffer_load_dwordx4 v16, s[12:15], s44 offen offset:0 lds
    buffer_load_dwordx4 v17, s[12:15], s44 offen offset:1024 lds
    s_add_u32 m0, s41, 61440
    s_xor_b32 s44, s62, 1966080
    buffer_load_dwordx4 v16, s[12:15], s44 offen offset:0 lds
    buffer_load_dwordx4 v17, s[12:15], s44 offen offset:1024 lds
    s_branch s_tail
h_start:
    v_mov_b32 v20, 0
    v_mov_b32 v21, 0
    v_mov_b32 v22, 0
    v_mov_b32 v23, 0
    s_cmp_lt_u32 s2, 10
    s_cbranch_scc0 h_z0
    s_load_dword s101, s[34:35], 192
    s_lshl_b32 s44, s2, 11
    s_mov_b32 s45, 0
    s_mov_b32 s46, 0
    s_mov_b32 s47, 0
    s_mov_b32 s48, 0
    s_mov_b32 s49, 0
    s_mov_b32 s50, 0
    s_mov_b32 s51, 0
    s_mov_b32 s52, 0
    s_mov_b32 s53, 0
    s_mov_b32 s54, 0
    s_mov_b32 s55, 0
    s_mov_b32 s56, 0
    s_mov_b32 s57, 0
    s_mov_b32 s58, 0
    s_mov_b32 s59, 0
    s_mov_b32 s60, 0
    s_atomic_swap s45, s[22:23], s44 offset:0 glc
    s_atomic_swap s46, s[22:23], s44 offset:128 glc
    s_atomic_swap s47, s[22:23], s44 offset:256 glc
    s_atomic_swap s48, s[22:23], s44 offset:384 glc
    s_atomic_swap s49, s[22:23], s44 offset:512 glc
    s_atomic_swap s50, s[22:23], s44 offset:640 glc
    s_atomic_swap s51, s[22:23], s44 offset:768 glc
    s_atomic_swap s52, s[22:23], s44 offset:896 glc
    s_atomic_swap s53, s[22:23], s44 offset:1024 glc
    s_atomic_swap s54, s[22:23], s44 offset:1152 glc
    s_atomic_swap s55, s[22:23], s44 offset:1280 glc
    s_atomic_swap s56, s[22:23], s44 offset:1408 glc
    s_atomic_swap s57, s[22:23], s44 offset:1536 glc
    s_atomic_swap s58, s[22:23], s44 offset:1664 glc
    s_atomic_swap s59, s[22:23], s44 offset:1792 glc
    s_atomic_swap s60, s[22:23], s44 offset:1920 glc
    s_waitcnt lgkmcnt(0)
    s_atomic_add s40, s[34:35], 0
h_z0:
    v_lshrrev_b32 v24, 4, v1
    v_lshrrev_b32 v25, 3, v24
    v_mul_u32_u24 v12, 6144, v25
    v_and_b32 v26, 2, v25
    v_lshrrev_b32 v25, 2, v25
    v_or_b32 v26, v26, v25
    v_bfe_u32 v25, v24, 1, 2
    v_xor_b32 v26, v26, v25
    v_lshl_add_u32 v12, v26, 5, v12
    v_and_b32 v26, 1, v24
    v_lshl_add_u32 v12, v26, 4, v12
    s_lshl_b32 s3, s18, 7
    v_add_u32 v12, s3, v12
    v_add_u32 v13, 48128, v12
    s_mul_i32 s84, s18, 393216
    s_cmp_lt_u32 s18, 4
    s_cselect_b32 s85, 4, 0
    s_mul_i32 s85, s85, 393216
    s_cmp_lt_u32 s18, 4
    s_cselect_b32 s86, 5, 1
    s_mul_i32 s86, s86, 393216
    s_cmp_lt_u32 s18, 4
    s_cselect_b32 s87, 6, 2
    s_mul_i32 s87, s87, 393216
    s_cmp_lt_u32 s18, 4
    s_cselect_b32 s88, 7, 3
    s_mul_i32 s88, s88, 393216
    s_cmp_lt_u32 s18, 8
    s_cselect_b32 s89, 8, 4
    s_mul_i32 s89, s89, 393216
    s_cmp_lt_u32 s18, 8
    s_cselect_b32 s90, 9, 5
    s_mul_i32 s90, s90, 393216
    s_cmp_lt_u32 s18, 8
    s_cselect_b32 s91, 10, 6
    s_mul_i32 s91, s91, 393216
    s_cmp_lt_u32 s18, 8
    s_cselect_b32 s92, 11, 7
    s_mul_i32 s92, s92, 393216
    s_cmp_lt_u32 s18, 12
    s_cselect_b32 s93, 12, 8
    s_mul_i32 s93, s93, 393216
    s_cmp_lt_u32 s18, 12
    s_cselect_b32 s94, 13, 9
    s_mul_i32 s94, s94, 393216
    s_cmp_lt_u32 s18, 12
    s_cselect_b32 s95, 14, 10
    s_mul_i32 s95, s95, 393216
    s_cmp_lt_u32 s18, 12
    s_cselect_b32 s96, 15, 11
    s_mul_i32 s96, s96, 393216
    s_xor_b32 s97, s18, 1
    s_mul_i32 s97, s97, 393216
    s_xor_b32 s98, s18, 2
    s_mul_i32 s98, s98, 393216
    s_xor_b32 s99, s18, 3
    s_mul_i32 s99, s99, 393216
    v_lshrrev_b32 v24, 4, v1
    v_lshrrev_b32 v25, 3, v24
    v_mul_u32_u24 v16, 2048, v25
    v_and_b32 v26, 2, v25
    v_lshrrev_b32 v25, 2, v25
    v_or_b32 v26, v26, v25
    v_bfe_u32 v25, v24, 1, 2
    v_xor_b32 v26, v26, v25
    v_lshl_add_u32 v16, v26, 5, v16
    v_and_b32 v26, 1, v24
    v_lshl_add_u32 v16, v26, 4, v16
    s_lshl_b32 s3, s18, 7
    v_add_u32 v16, s3, v16
    v_add_u32 v17, 15360, v16
    v_add_u32 v18, 30720, v16
    v_add_u32 v19, 46080, v16
    s_and_b32 s3, s16, 3
    s_mul_i32 s3, s3, 49152
    v_add_u32 v11, s3, v12
    s_and_b32 s3, s16, 3
    s_lshl_b32 s3, s3, 10
    v_add_u32 v9, s3, v1
    v_add_u32 v10, 0x10000, v9
    v_lshrrev_b32 v24, 4, v1
    v_and_b32 v25, 15, v24
    v_lshrrev_b32 v24, 4, v24
    v_lshlrev_b32 v24, 2, v24
    v_sub_u32 v24, v25, v24
    v_mov_b32 v25, 0xf149f2ca
    v_add_u32 v26, 0x0, v24
    v_and_b32 v26, 0xfffffff1, v26
    v_cmp_eq_u32 vcc, 0, v26
    s_nop 1
    v_cndmask_b32 v32, v25, 0, vcc
    v_add_u32 v26, 0xffffffff, v24
    v_and_b32 v26, 0xfffffff1, v26
    v_cmp_eq_u32 vcc, 0, v26
    s_nop 1
    v_cndmask_b32 v33, v25, 0, vcc
    v_add_u32 v26, 0xfffffffe, v24
    v_and_b32 v26, 0xfffffff1, v26
    v_cmp_eq_u32 vcc, 0, v26
    s_nop 1
    v_cndmask_b32 v34, v25, 0, vcc
    v_add_u32 v26, 0xfffffffd, v24
    v_and_b32 v26, 0xfffffff1, v26
    v_cmp_eq_u32 vcc, 0, v26
    s_nop 1
    v_cndmask_b32 v35, v25, 0, vcc
    v_add_u32 v26, 0x10, v24
    v_and_b32 v26, 0xfffffff1, v26
    v_cmp_eq_u32 vcc, 0, v26
    s_nop 1
    v_cndmask_b32 v36, v25, 0, vcc
    v_add_u32 v26, 0xf, v24
    v_and_b32 v26, 0xfffffff1, v26
    v_cmp_eq_u32 vcc, 0, v26
    s_nop 1
    v_cndmask_b32 v37, v25, 0, vcc
    v_add_u32 v26, 0xe, v24
    v_and_b32 v26, 0xfffffff1, v26
    v_cmp_eq_u32 vcc, 0, v26
    s_nop 1
    v_cndmask_b32 v38, v25, 0, vcc
    v_add_u32 v26, 0xd, v24
    v_and_b32 v26, 0xfffffff1, v26
    v_cmp_eq_u32 vcc, 0, v26
    s_nop 1
    v_cndmask_b32 v39, v25, 0, vcc
    v_add_u32 v24, 153600, v1
    ds_write_b128 v24, v[32:35] offset:0
    ds_write_b128 v24, v[36:39] offset:1024
    s_waitcnt lgkmcnt(0)
    s_lshl_b32 s44, s21, 14
    s_lshl_b32 s67, s17, 9
    s_add_u32 s44, s44, s67
    s_add_u32 s44, s44, 4096
    s_barrier
    s_barrier
    s_mov_b32 s66, 0x10000
h_s0_poll:
    s_mov_b32 s68, 0
    s_mov_b32 s69, 0
    s_mov_b32 s70, 0
    s_mov_b32 s71, 0
    s_atomic_add s68, s[22:23], s44 offset:0 glc
    s_atomic_add s69, s[22:23], s44 offset:128 glc
    s_atomic_add s70, s[22:23], s44 offset:256 glc
    s_atomic_add s71, s[22:23], s44 offset:384 glc
    s_sub_u32 s66, s66, 1
    s_cselect_b32 s67, 67372036, 0
    s_waitcnt lgkmcnt(0)
    s_and_b32 s68, s68, s69
    s_and_b32 s68, s68, s70
    s_and_b32 s68, s68, s71
    s_max_u32 s68, s68, s67
    s_cmp_lt_u32 s68, 67372036
    s_cbranch_scc1 h_s0_poll
h_s0_ok:
    s_lshr_b32 s3, s2, 3
    s_cmp_eq_u32 s3, 2
    s_cbranch_scc0 h_g4
    s_barrier
    s_mul_i32 s44, s2, 24576
    s_add_u32 s44, s44, 58347520
    s_mov_b32 s45, 24
h_zloop:
    buffer_store_dwordx4 v[20:23], v1, s[4:7], s44 offen sc1
    s_add_u32 s44, s44, 1024
    s_sub_u32 s45, s45, 1
    s_cmp_lg_u32 s45, 0
    s_cbranch_scc1 h_zloop
    s_branch h_g4b
h_layer:
    s_waitcnt lgkmcnt(0)
    s_barrier
h_g4:
    s_barrier
h_g4b:
    s_lshl_b32 s44, s21, 14
    s_lshl_b32 s67, s17, 9
    s_add_u32 s44, s44, s67
    s_add_u32 s44, s44, 12288
    s_mov_b32 s66, 0x10000
h_s_poll:
    s_mov_b32 s68, 0
    s_mov_b32 s69, 0
    s_mov_b32 s70, 0
    s_mov_b32 s71, 0
    s_atomic_add s68, s[22:23], s44 offset:0 glc
    s_atomic_add s69, s[22:23], s44 offset:128 glc
    s_atomic_add s70, s[22:23], s44 offset:256 glc
    s_atomic_add s71, s[22:23], s44 offset:384 glc
    s_sub_u32 s66, s66, 1
    s_cselect_b32 s67, 16, 0
    s_waitcnt lgkmcnt(0)
    s_and_b32 s68, s68, s69
    s_and_b32 s68, s68, s70
    s_and_b32 s68, s68, s71
    s_max_u32 s68, s68, s67
    s_cmp_lt_u32 s68, 16
    s_cbranch_scc1 h_s_poll
h_s_ok:
    s_barrier
    s_lshl_b32 s44, s21, 18
    s_lshl_b32 s45, s17, 14
    s_add_u32 s44, s44, s45
    s_add_u32 s44, s44, 50331648
    buffer_load_dwordx4 v[32:35], v1, s[4:7], s44 offen offset:0 sc1
    buffer_load_dwordx4 v[36:39], v1, s[4:7], s44 offen offset:1024 sc1
    buffer_load_dwordx4 v[40:43], v1, s[4:7], s44 offen offset:2048 sc1
    buffer_load_dwordx4 v[44:47], v1, s[4:7], s44 offen offset:3072 sc1
    s_add_u32 s44, s44, 4096
    buffer_load_dwordx4 v[48:51], v1, s[4:7], s44 offen offset:0 sc1
    buffer_load_dwordx4 v[52:55], v1, s[4:7], s44 offen offset:1024 sc1
    buffer_load_dwordx4 v[56:59], v1, s[4:7], s44 offen offset:2048 sc1
    buffer_load_dwordx4 v[60:63], v1, s[4:7], s44 offen offset:3072 sc1
    s_add_u32 s44, s44, 4096
    buffer_load_dwordx4 v[64:67], v1, s[4:7], s44 offen offset:0 sc1
    buffer_load_dwordx4 v[68:71], v1, s[4:7], s44 offen offset:1024 sc1
    buffer_load_dwordx4 v[72:75], v1, s[4:7], s44 offen offset:2048 sc1
    buffer_load_dwordx4 v[76:79], v1, s[4:7], s44 offen offset:3072 sc1
    s_add_u32 s44, s44, 4096
    buffer_load_dwordx4 v[80:83], v1, s[4:7], s44 offen offset:0 sc1
    buffer_load_dwordx4 v[84:87], v1, s[4:7], s44 offen offset:1024 sc1
    buffer_load_dwordx4 v[88:91], v1, s[4:7], s44 offen offset:2048 sc1
    buffer_load_dwordx4 v[92:95], v1, s[4:7], s44 offen offset:3072 sc1
    s_barrier
    s_cmp_ge_u32 s21, 2
    s_cbranch_scc1 h_c_ok
    s_lshl_b32 s44, s21, 11
    s_lshl_b32 s67, s18, 7
    s_add_u32 s44, s44, s67
    s_add_u32 s44, s44, 0
    s_mov_b32 s66, 0x10000
h_c_poll:
    s_mov_b32 s68, 0
    s_atomic_add s68, s[22:23], s44 offset:0 glc
    s_sub_u32 s66, s66, 1
    s_cselect_b32 s67, 48, 0
    s_waitcnt lgkmcnt(0)
    s_max_u32 s68, s68, s67
    s_cmp_lt_u32 s68, 48
    s_cbranch_scc1 h_c_poll
h_c_ok:
    s_waitcnt vmcnt(0)
    s_lshl_b32 s3, s21, 8
    s_add_u32 s3, s3, s2
    s_lshr_b32 s3, s3, 3
    s_cmp_eq_u32 s3, 2
    s_cbranch_scc0 h_nf1
    s_atomic_add s40, s[34:35], 128
h_nf1:
    s_barrier
    s_cmp_ge_u32 s21, 2
    s_cbranch_scc1 h_cs1
    s_lshl_b32 s44, s21, 18
    s_lshl_b32 s45, s18, 14
    s_add_u32 s44, s44, s45
    s_add_u32 s44, s44, 52428800
    buffer_load_dwordx4 v[96:99], v1, s[4:7], s44 offen offset:0 sc1
    buffer_load_dwordx4 v[100:103], v1, s[4:7], s44 offen offset:1024 sc1
    buffer_load_dwordx4 v[104:107], v1, s[4:7], s44 offen offset:2048 sc1
    buffer_load_dwordx4 v[108:111], v1, s[4:7], s44 offen offset:3072 sc1
    s_add_u32 s44, s44, 4096
    buffer_load_dwordx4 v[112:115], v1, s[4:7], s44 offen offset:0 sc1
    buffer_load_dwordx4 v[116:119], v1, s[4:7], s44 offen offset:1024 sc1
    buffer_load_dwordx4 v[120:123], v1, s[4:7], s44 offen offset:2048 sc1
    buffer_load_dwordx4 v[124:127], v1, s[4:7], s44 offen offset:3072 sc1
    s_add_u32 s44, s44, 4096
    buffer_load_dwordx4 v[128:131], v1, s[4:7], s44 offen offset:0 sc1
    buffer_load_dwordx4 v[132:135], v1, s[4:7], s44 offen offset:1024 sc1
    buffer_load_dwordx4 v[136:139], v1, s[4:7], s44 offen offset:2048 sc1
    buffer_load_dwordx4 v[140:143], v1, s[4:7], s44 offen offset:3072 sc1
    s_add_u32 s44, s44, 4096
    buffer_load_dwordx4 v[144:147], v1, s[4:7], s44 offen offset:0 sc1
    buffer_load_dwordx4 v[148:151], v1, s[4:7], s44 offen offset:1024 sc1
    buffer_load_dwordx4 v[152:155], v1, s[4:7], s44 offen offset:2048 sc1
    buffer_load_dwordx4 v[156:159], v1, s[4:7], s44 offen offset:3072 sc1
h_cs1:
    v_add_f32 v32, v32, v36
    v_add_f32 v33, v33, v37
    v_add_f32 v34, v34, v38
    v_add_f32 v35, v35, v39
    v_add_f32 v48, v48, v52
    v_add_f32 v49, v49, v53
    v_add_f32 v50, v50, v54
    v_add_f32 v51, v51, v55
    v_add_f32 v64, v64, v68
    v_add_f32 v65, v65, v69
    v_add_f32 v66, v66, v70
    v_add_f32 v67, v67, v71
    v_add_f32 v80, v80, v84
    v_add_f32 v81, v81, v85
    v_add_f32 v82, v82, v86
    v_add_f32 v83, v83, v87
    v_add_f32 v32, v32, v40
    v_add_f32 v33, v33, v41
    v_add_f32 v34, v34, v42
    v_add_f32 v35, v35, v43
    v_add_f32 v48, v48, v56
    v_add_f32 v49, v49, v57
    v_add_f32 v50, v50, v58
    v_add_f32 v51, v51, v59
    v_add_f32 v64, v64, v72
    v_add_f32 v65, v65, v73
    v_add_f32 v66, v66, v74
    v_add_f32 v67, v67, v75
    v_add_f32 v80, v80, v88
    v_add_f32 v81, v81, v89
    v_add_f32 v82, v82, v90
    v_add_f32 v83, v83, v91
    s_barrier
    v_add_f32 v32, v32, v44
    v_add_f32 v33, v33, v45
    v_add_f32 v34, v34, v46
    v_add_f32 v35, v35, v47
    v_add_f32 v48, v48, v60
    v_add_f32 v49, v49, v61
    v_add_f32 v50, v50, v62
    v_add_f32 v51, v51, v63
    v_add_f32 v64, v64, v76
    v_add_f32 v65, v65, v77
    v_add_f32 v66, v66, v78
    v_add_f32 v67, v67, v79
    v_add_f32 v80, v80, v92
    v_add_f32 v81, v81, v93
    v_add_f32 v82, v82, v94
    v_add_f32 v83, v83, v95
    v_permlane32_swap_b32 v32, v64
    v_permlane32_swap_b32 v33, v65
    v_permlane32_swap_b32 v34, v66
    v_permlane32_swap_b32 v35, v67
    v_add_f32 v32, v32, v64
    v_add_f32 v33, v33, v65
    v_add_f32 v34, v34, v66
    v_add_f32 v35, v35, v67
    v_permlane32_swap_b32 v48, v80
    v_permlane32_swap_b32 v49, v81
    v_permlane32_swap_b32 v50, v82
    v_permlane32_swap_b32 v51, v83
    v_add_f32 v48, v48, v80
    v_add_f32 v49, v49, v81
    v_add_f32 v50, v50, v82
    v_add_f32 v51, v51, v83
    v_permlane16_swap_b32 v32, v48
    v_permlane16_swap_b32 v33, v49
    v_permlane16_swap_b32 v34, v50
    v_permlane16_swap_b32 v35, v51
    v_add_f32 v32, v32, v48
    v_add_f32 v33, v33, v49
    v_add_f32 v34, v34, v50
    v_add_f32 v35, v35, v51
    s_barrier
    v_mul_f32 v32, 0x3a800000, v32
    v_mul_f32 v33, 0x3a800000, v33
    v_mul_f32 v34, 0x3a800000, v34
    v_mul_f32 v35, 0x3a800000, v35
    v_fma_f32 v33, -v32, v32, v33
    v_fma_f32 v35, -v34, v34, v35
    v_max_f32 v33, 0, v33
    v_max_f32 v35, 0, v35
    v_add_f32 v33, 0x3727c5ac, v33
    v_add_f32 v35, 0x3727c5ac, v35
    v_rsq_f32 v33, v33
    v_rsq_f32 v35, v35
    v_lshrrev_b32 v26, 1, v1
    v_add_u32 v26, 155648, v26
    ds_write2_b32 v26, v32, v34 offset0:0 offset1:1
    ds_write2_b32 v26, v33, v35 offset0:128 offset1:129
    s_barrier
    s_cmp_ge_u32 s21, 2
    s_cbranch_scc1 h_cs_done
    s_waitcnt vmcnt(0)
    v_add_f32 v96, v96, v100
    v_add_f32 v97, v97, v101
    v_add_f32 v98, v98, v102
    v_add_f32 v99, v99, v103
    v_add_f32 v96, v96, v104
    v_add_f32 v97, v97, v105
    v_add_f32 v98, v98, v106
    v_add_f32 v99, v99, v107
    v_add_f32 v96, v96, v108
    v_add_f32 v97, v97, v109
    v_add_f32 v98, v98, v110
    v_add_f32 v99, v99, v111
    v_add_f32 v96, v96, v112
    v_add_f32 v97, v97, v113
    v_add_f32 v98, v98, v114
    v_add_f32 v99, v99, v115
    v_add_f32 v96, v96, v116
    v_add_f32 v97, v97, v117
    v_add_f32 v98, v98, v118
    v_add_f32 v99, v99, v119
    v_add_f32 v96, v96, v120
    v_add_f32 v97, v97, v121
    v_add_f32 v98, v98, v122
    v_add_f32 v99, v99, v123
    v_add_f32 v96, v96, v124
    v_add_f32 v97, v97, v125
    v_add_f32 v98, v98, v126
    v_add_f32 v99, v99, v127
    v_add_f32 v96, v96, v128
    v_add_f32 v97, v97, v129
    v_add_f32 v98, v98, v130
    v_add_f32 v99, v99, v131
    v_add_f32 v96, v96, v132
    v_add_f32 v97, v97, v133
    v_add_f32 v98, v98, v134
    v_add_f32 v99, v99, v135
    v_add_f32 v96, v96, v136
    v_add_f32 v97, v97, v137
    v_add_f32 v98, v98, v138
    v_add_f32 v99, v99, v139
    v_add_f32 v96, v96, v140
    v_add_f32 v97, v97, v141
    v_add_f32 v98, v98, v142
    v_add_f32 v99, v99, v143
    v_add_f32 v96, v96, v144
    v_add_f32 v97, v97, v145
    v_add_f32 v98, v98, v146
    v_add_f32 v99, v99, v147
    v_add_f32 v96, v96, v148
    v_add_f32 v97, v97, v149
    v_add_f32 v98, v98, v150
    v_add_f32 v99, v99, v151
    v_add_f32 v96, v96, v152
    v_add_f32 v97, v97, v153
    v_add_f32 v98, v98, v154
    v_add_f32 v99, v99, v155
    v_add_f32 v96, v96, v156
    v_add_f32 v97, v97, v157
    v_add_f32 v98, v98, v158
    v_add_f32 v99, v99, v159
    s_lshl_b32 s44, s21, 10
    s_add_u32 s44, s44, 151552
    v_add_u32 v24, s44, v1
    ds_write_b128 v24, v[96:99]
h_cs_done:
    s_waitcnt lgkmcnt(0)
    s_barrier
    s_cmp_lg_u32 s21, 0
    s_cbranch_scc1 h_f1_ok
    s_load_dword s68, s[34:35], 128
    s_mov_b32 s8, s34
    s_mov_b32 s9, s35
    s_mov_b32 s10, 256
    s_mov_b32 s11, 0x00020000
    s_mov_b32 s66, 0x10000
    v_mov_b32 v24, 0
    s_waitcnt lgkmcnt(0)
h_f1:
    s_cmp_eq_u32 s68, 8
    s_cbranch_scc1 h_f1_ok
    buffer_load_dword v25, v24, s[8:11], 0 offen offset:128 sc1
    s_waitcnt vmcnt(0)
    v_readfirstlane_b32 s68, v25
    s_sub_u32 s66, s66, 1
    s_cmp_lg_u32 s66, 0
    s_cbranch_scc1 h_f1
h_f1_ok:
    s_barrier
    s_bitcmp1_b32 s21, 0
    s_cselect_b32 s8, s28, s24
    s_cselect_b32 s9, s29, s25
    s_cselect_b32 s12, s30, s26
    s_cselect_b32 s13, s31, s27
    s_mov_b32 s10, 6291456
    s_mov_b32 s11, 0x00020000
    s_mov_b32 s14, 2097152
    s_mov_b32 s15, 0x00020000
    v_lshrrev_b32 v28, 4, v1
    v_and_b32 v29, 7, v28
    v_lshrrev_b32 v28, 3, v28
    v_mul_u32_u24 v28, 2048, v28
    v_lshl_add_u32 v28, v29, 4, v28
    s_and_b32 s3, s18, 12
    s_or_b32 s3, s3, 3
    s_lshl_b32 s3, s3, 7
    v_add_u32 v28, s3, v28
    s_lshr_b32 s3, s2, 3
    s_lshl_b32 s3, s3, 2
    s_and_b32 s60, s16, 3
    s_add_u32 s60, s60, s3
    s_lshl_b32 s61, s60, 14
    buffer_load_dwordx4 v[144:147], v28, s[12:15], s61 offen
    s_bitcmp0_b32 s21, 0
    s_cselect_b32 s56, s28, s24
    s_cselect_b32 s57, s29, s25
    s_mov_b32 s58, 6291456
    s_mov_b32 s59, 0x00020000
    v_lshrrev_b32 v28, 4, v1
    v_and_b32 v29, 7, v28
    v_lshrrev_b32 v28, 3, v28
    v_mul_u32_u24 v28, 6144, v28
    v_lshl_add_u32 v28, v29, 4, v28
    s_and_b32 s3, s18, 12
    s_or_b32 s3, s3, 3
    s_lshl_b32 s3, s3, 7
    v_add_u32 v28, s3, v28
    s_lshr_b32 s3, s2, 3
    s_lshl_b32 s3, s3, 2
    s_and_b32 s60, s16, 3
    s_add_u32 s60, s60, s3
    s_and_b32 s3, s60, 31
    s_mul_i32 s3, s3, 49152
    s_lshr_b32 s61, s60, 5
    s_min_u32 s61, s61, 2
    s_lshl_b32 s61, s61, 11
    s_add_u32 s61, s61, s3
    s_cmp_lt_u32 s18, 4
    s_cselect_b32 s3, 1572864, 0
    s_add_u32 s61, s61, s3
    buffer_load_dwordx4 v[148:151], v28, s[56:59], s61 offen
    s_cmp_lg_u32 s21, 2
    s_cbranch_scc1 h_pe
    s_bitcmp0_b32 s21, 0
    s_cselect_b32 s56, s28, s24
    s_cselect_b32 s57, s29, s25
    s_mov_b32 s58, 6291456
    s_mov_b32 s59, 0x00020000
    s_add_u32 s61, s84, 2048
    buffer_load_dwordx4 v[160:163], v11, s[56:59], s61 offen
    s_add_u32 s61, s84, 4096
    buffer_load_dwordx4 v[164:167], v11, s[56:59], s61 offen
    s_add_u32 s61, s84, 0
    buffer_load_dwordx4 v[168:171], v11, s[56:59], s61 offen
    s_add_u32 s61, s84, 198656
    buffer_load_dwordx4 v[172:175], v11, s[56:59], s61 offen
    s_add_u32 s61, s84, 200704
    buffer_load_dwordx4 v[176:179], v11, s[56:59], s61 offen
    s_add_u32 s61, s84, 196608
    buffer_load_dwordx4 v[180:183], v11, s[56:59], s61 offen
    s_add_u32 s61, s85, 2048
    buffer_load_dwordx4 v[184:187], v11, s[56:59], s61 offen
    s_add_u32 s61, s85, 4096
    buffer_load_dwordx4 v[188:191], v11, s[56:59], s61 offen
    s_add_u32 s61, s85, 0
    buffer_load_dwordx4 v[192:195], v11, s[56:59], s61 offen
    s_add_u32 s61, s85, 198656
    buffer_load_dwordx4 v[196:199], v11, s[56:59], s61 offen
h_pe:
    s_barrier
    s_branch s_tail
z_start:
    v_lshrrev_b32 v24, 4, v1
    v_lshrrev_b32 v25, 3, v24
    v_mul_u32_u24 v20, 6144, v25
    v_and_b32 v25, 7, v24
    v_lshl_add_u32 v20, v25, 4, v20
    s_add_u32 s3, s18, 2
    s_and_b32 s3, s3, 15
    s_lshl_b32 s3, s3, 7
    s_add_u32 s3, s3, 4096
    v_add_u32 v22, s3, v20
    s_add_u32 s3, s18, 1
    s_and_b32 s3, s3, 15
    s_lshl_b32 s3, s3, 7
    s_add_u32 s3, s3, 2048
    v_add_u32 v21, s3, v20
    s_add_u32 s3, s18, 0
    s_and_b32 s3, s3, 15
    s_lshl_b32 s3, s3, 7
    s_add_u32 s3, s3, 0
    v_add_u32 v20, s3, v20
    s_waitcnt lgkmcnt(0)
    s_mov_b32 s8, s24
    s_mov_b32 s9, s25
    s_mov_b32 s10, 6291456
    s_mov_b32 s11, 0x00020000
    s_mul_i32 s44, s17, 393216
    buffer_load_dwordx4 v[32:35], v20, s[8:11], s44 offen
    buffer_load_dwordx4 v[64:67], v21, s[8:11], s44 offen
    buffer_load_dwordx4 v[96:99], v22, s[8:11], s44 offen
    s_add_u32 s44, s44, 49152
    buffer_load_dwordx4 v[36:39], v20, s[8:11], s44 offen
    buffer_load_dwordx4 v[68:71], v21, s[8:11], s44 offen
    buffer_load_dwordx4 v[100:103], v22, s[8:11], s44 offen
    s_add_u32 s44, s44, 49152
    buffer_load_dwordx4 v[40:43], v20, s[8:11], s44 offen
    buffer_load_dwordx4 v[72:75], v21, s[8:11], s44 offen
    buffer_load_dwordx4 v[104:107], v22, s[8:11], s44 offen
    s_add_u32 s44, s44, 49152
    buffer_load_dwordx4 v[44:47], v20, s[8:11], s44 offen
    buffer_load_dwordx4 v[76:79], v21, s[8:11], s44 offen
    buffer_load_dwordx4 v[108:111], v22, s[8:11], s44 offen
    s_add_u32 s44, s44, 49152
    buffer_load_dwordx4 v[48:51], v20, s[8:11], s44 offen
    buffer_load_dwordx4 v[80:83], v21, s[8:11], s44 offen
    buffer_load_dwordx4 v[112:115], v22, s[8:11], s44 offen
    s_add_u32 s44, s44, 49152
    buffer_load_dwordx4 v[52:55], v20, s[8:11], s44 offen
    buffer_load_dwordx4 v[84:87], v21, s[8:11], s44 offen
    buffer_load_dwordx4 v[116:119], v22, s[8:11], s44 offen
    s_add_u32 s44, s44, 49152
    buffer_load_dwordx4 v[56:59], v20, s[8:11], s44 offen
    buffer_load_dwordx4 v[88:91], v21, s[8:11], s44 offen
    buffer_load_dwordx4 v[120:123], v22, s[8:11], s44 offen
    s_add_u32 s44, s44, 49152
    buffer_load_dwordx4 v[60:63], v20, s[8:11], s44 offen
    buffer_load_dwordx4 v[92:95], v21, s[8:11], s44 offen
    buffer_load_dwordx4 v[124:127], v22, s[8:11], s44 offen
    v_lshrrev_b32 v24, 4, v1
    v_lshrrev_b32 v25, 3, v24
    v_mul_u32_u24 v12, 6144, v25
    v_and_b32 v26, 2, v25
    v_lshrrev_b32 v25, 2, v25
    v_or_b32 v26, v26, v25
    v_bfe_u32 v25, v24, 1, 2
    v_xor_b32 v26, v26, v25
    v_lshl_add_u32 v12, v26, 5, v12
    v_and_b32 v26, 1, v24
    v_lshl_add_u32 v12, v26, 4, v12
    s_lshl_b32 s3, s18, 7
    v_add_u32 v12, s3, v12
    v_add_u32 v13, 48128, v12
    s_mul_i32 s84, s18, 393216
    s_cmp_lt_u32 s18, 4
    s_cselect_b32 s85, 4, 0
    s_mul_i32 s85, s85, 393216
    s_cmp_lt_u32 s18, 4
    s_cselect_b32 s86, 5, 1
    s_mul_i32 s86, s86, 393216
    s_cmp_lt_u32 s18, 4
    s_cselect_b32 s87, 6, 2
    s_mul_i32 s87, s87, 393216
    s_cmp_lt_u32 s18, 4
    s_cselect_b32 s88, 7, 3
    s_mul_i32 s88, s88, 393216
    s_cmp_lt_u32 s18, 8
    s_cselect_b32 s89, 8, 4
    s_mul_i32 s89, s89, 393216
    s_cmp_lt_u32 s18, 8
    s_cselect_b32 s90, 9, 5
    s_mul_i32 s90, s90, 393216
    s_cmp_lt_u32 s18, 8
    s_cselect_b32 s91, 10, 6
    s_mul_i32 s91, s91, 393216
    s_cmp_lt_u32 s18, 8
    s_cselect_b32 s92, 11, 7
    s_mul_i32 s92, s92, 393216
    s_cmp_lt_u32 s18, 12
    s_cselect_b32 s93, 12, 8
    s_mul_i32 s93, s93, 393216
    s_cmp_lt_u32 s18, 12
    s_cselect_b32 s94, 13, 9
    s_mul_i32 s94, s94, 393216
    s_cmp_lt_u32 s18, 12
    s_cselect_b32 s95, 14, 10
    s_mul_i32 s95, s95, 393216
    s_cmp_lt_u32 s18, 12
    s_cselect_b32 s96, 15, 11
    s_mul_i32 s96, s96, 393216
    s_xor_b32 s97, s18, 1
    s_mul_i32 s97, s97, 393216
    s_xor_b32 s98, s18, 2
    s_mul_i32 s98, s98, 393216
    s_xor_b32 s99, s18, 3
    s_mul_i32 s99, s99, 393216
    v_lshrrev_b32 v24, 4, v1
    v_lshrrev_b32 v25, 3, v24
    v_mul_u32_u24 v16, 2048, v25
    v_and_b32 v26, 2, v25
    v_lshrrev_b32 v25, 2, v25
    v_or_b32 v26, v26, v25
    v_bfe_u32 v25, v24, 1, 2
    v_xor_b32 v26, v26, v25
    v_lshl_add_u32 v16, v26, 5, v16
    v_and_b32 v26, 1, v24
    v_lshl_add_u32 v16, v26, 4, v16
    s_lshl_b32 s3, s18, 7
    v_add_u32 v16, s3, v16
    v_add_u32 v17, 15360, v16
    v_add_u32 v18, 30720, v16
    v_add_u32 v19, 46080, v16
    s_and_b32 s3, s16, 3
    s_mul_i32 s3, s3, 49152
    v_add_u32 v11, s3, v12
    s_and_b32 s3, s16, 3
    s_lshl_b32 s3, s3, 10
    v_add_u32 v9, s3, v1
    v_add_u32 v10, 0x10000, v9
    s_barrier
    v_lshrrev_b32 v24, 4, v1
    v_and_b32 v25, 1, v24
    v_lshlrev_b32 v25, 4, v25
    v_mov_b32 v26, 0x3f80
    v_lshlrev_b32 v25, v25, v26
    v_bfe_u32 v26, v24, 1, 2
    v_cmp_eq_u32 vcc, 0, v26
    s_nop 1
    v_cndmask_b32 v140, 0, v25, vcc
    v_cmp_eq_u32 vcc, 1, v26
    s_nop 1
    v_cndmask_b32 v141, 0, v25, vcc
    v_cmp_eq_u32 vcc, 2, v26
    s_nop 1
    v_cndmask_b32 v142, 0, v25, vcc
    v_cmp_eq_u32 vcc, 3, v26
    s_nop 1
    v_cndmask_b32 v143, 0, v25, vcc
    v_bfe_u32 v25, v24, 3, 1
    v_lshrrev_b32 v26, 5, v24
    v_lshl_add_u32 v26, v26, 1, v25
    v_lshlrev_b32 v25, 8, v26
    v_and_b32 v27, 7, v24
    v_lshl_add_u32 v25, v27, 5, v25
    v_bfe_u32 v27, v24, 4, 1
    v_lshl_add_u32 v25, v27, 4, v25
    v_add_u32 v27, s18, v26
    v_and_b32 v27, 15, v27
    v_lshl_add_u32 v25, v27, 14, v25
    s_lshl_b32 s44, s17, 10
    s_add_u32 s44, s44, 52428800
    s_waitcnt vmcnt(21)
    v_mfma_f32_16x16x32_bf16 v[128:131], v[140:143], v[32:35], 0
    v_mfma_f32_16x16x32_bf16 v[132:135], v[140:143], v[64:67], 0
    v_mfma_f32_16x16x32_bf16 v[136:139], v[140:143], v[96:99], 0
    s_waitcnt vmcnt(18)
    v_mfma_f32_16x16x32_bf16 v[128:131], v[140:143], v[36:39], v[128:131]
    v_mfma_f32_16x16x32_bf16 v[132:135], v[140:143], v[68:71], v[132:135]
    v_mfma_f32_16x16x32_bf16 v[136:139], v[140:143], v[100:103], v[136:139]
    s_waitcnt vmcnt(15)
    v_mfma_f32_16x16x32_bf16 v[128:131], v[140:143], v[40:43], v[128:131]
    v_mfma_f32_16x16x32_bf16 v[132:135], v[140:143], v[72:75], v[132:135]
    v_mfma_f32_16x16x32_bf16 v[136:139], v[140:143], v[104:107], v[136:139]
    s_waitcnt vmcnt(12)
    v_mfma_f32_16x16x32_bf16 v[128:131], v[140:143], v[44:47], v[128:131]
    v_mfma_f32_16x16x32_bf16 v[132:135], v[140:143], v[76:79], v[132:135]
    v_mfma_f32_16x16x32_bf16 v[136:139], v[140:143], v[108:111], v[136:139]
    s_waitcnt vmcnt(9)
    v_mfma_f32_16x16x32_bf16 v[128:131], v[140:143], v[48:51], v[128:131]
    v_mfma_f32_16x16x32_bf16 v[132:135], v[140:143], v[80:83], v[132:135]
    v_mfma_f32_16x16x32_bf16 v[136:139], v[140:143], v[112:115], v[136:139]
    s_waitcnt vmcnt(6)
    v_mfma_f32_16x16x32_bf16 v[128:131], v[140:143], v[52:55], v[128:131]
    v_mfma_f32_16x16x32_bf16 v[132:135], v[140:143], v[84:87], v[132:135]
    v_mfma_f32_16x16x32_bf16 v[136:139], v[140:143], v[116:119], v[136:139]
    s_waitcnt vmcnt(3)
    v_mfma_f32_16x16x32_bf16 v[128:131], v[140:143], v[56:59], v[128:131]
    v_mfma_f32_16x16x32_bf16 v[132:135], v[140:143], v[88:91], v[132:135]
    v_mfma_f32_16x16x32_bf16 v[136:139], v[140:143], v[120:123], v[136:139]
    s_waitcnt vmcnt(0)
    v_mfma_f32_16x16x32_bf16 v[128:131], v[140:143], v[60:63], v[128:131]
    v_mfma_f32_16x16x32_bf16 v[132:135], v[140:143], v[92:95], v[132:135]
    v_mfma_f32_16x16x32_bf16 v[136:139], v[140:143], v[124:127], v[136:139]
    s_barrier
    v_lshrrev_b32 v28, 4, v1
    v_and_b32 v29, 7, v28
    v_lshrrev_b32 v28, 3, v28
    v_mul_u32_u24 v28, 6144, v28
    v_lshl_add_u32 v28, v29, 4, v28
    s_and_b32 s3, s18, 12
    s_or_b32 s3, s3, 3
    s_lshl_b32 s3, s3, 7
    v_add_u32 v28, s3, v28
    s_lshr_b32 s3, s2, 3
    s_lshl_b32 s3, s3, 2
    s_and_b32 s60, s16, 3
    s_add_u32 s60, s60, s3
    s_lshr_b32 s60, s60, 2
    s_mul_i32 s60, s60, 49152
    s_cmp_lt_u32 s18, 4
    s_cselect_b32 s3, 0, 1
    s_mul_i32 s3, s3, 1572864
    s_add_u32 s3, s3, s60
    s_add_u32 s61, s3, 0
    buffer_load_dwordx4 v[160:163], v28, s[8:11], s61 offen
    s_add_u32 s61, s3, 2048
    buffer_load_dwordx4 v[164:167], v28, s[8:11], s61 offen
    s_add_u32 s61, s3, 4096
    buffer_load_dwordx4 v[168:171], v28, s[8:11], s61 offen
    s_add_u32 s3, s60, 3145728
    s_add_u32 s61, s3, 0
    buffer_load_dwordx4 v[172:175], v28, s[8:11], s61 offen
    s_add_u32 s61, s3, 2048
    buffer_load_dwordx4 v[176:179], v28, s[8:11], s61 offen
    s_add_u32 s61, s3, 4096
    buffer_load_dwordx4 v[180:183], v28, s[8:11], s61 offen
    s_add_u32 s3, s60, 4718592
    s_add_u32 s61, s3, 0
    buffer_load_dwordx4 v[184:187], v28, s[8:11], s61 offen
    s_add_u32 s61, s3, 2048
    buffer_load_dwordx4 v[188:191], v28, s[8:11], s61 offen
    s_add_u32 s61, s3, 4096
    buffer_load_dwordx4 v[192:195], v28, s[8:11], s61 offen
    v_add_f32_dpp v128, v128, v128 row_ror:8 row_mask:0xf bank_mask:0xf
    v_add_f32_dpp v129, v129, v129 row_ror:8 row_mask:0xf bank_mask:0xf
    v_add_f32_dpp v130, v130, v130 row_ror:8 row_mask:0xf bank_mask:0xf
    v_add_f32_dpp v131, v131, v131 row_ror:8 row_mask:0xf bank_mask:0xf
    v_add_f32_dpp v132, v132, v132 row_ror:8 row_mask:0xf bank_mask:0xf
    v_add_f32_dpp v133, v133, v133 row_ror:8 row_mask:0xf bank_mask:0xf
    v_add_f32_dpp v134, v134, v134 row_ror:8 row_mask:0xf bank_mask:0xf
    v_add_f32_dpp v135, v135, v135 row_ror:8 row_mask:0xf bank_mask:0xf
    v_add_f32_dpp v136, v136, v136 row_ror:8 row_mask:0xf bank_mask:0xf
    v_add_f32_dpp v137, v137, v137 row_ror:8 row_mask:0xf bank_mask:0xf
    v_add_f32_dpp v138, v138, v138 row_ror:8 row_mask:0xf bank_mask:0xf
    v_add_f32_dpp v139, v139, v139 row_ror:8 row_mask:0xf bank_mask:0xf
    v_cmp_le_u32 vcc, 1, v26
    s_nop 1
    v_cndmask_b32 v128, v128, v132, vcc
    v_cndmask_b32 v129, v129, v133, vcc
    v_cndmask_b32 v130, v130, v134, vcc
    v_cndmask_b32 v131, v131, v135, vcc
    v_cmp_le_u32 vcc, 2, v26
    s_nop 1
    v_cndmask_b32 v128, v128, v136, vcc
    v_cndmask_b32 v129, v129, v137, vcc
    v_cndmask_b32 v130, v130, v138, vcc
    v_cndmask_b32 v131, v131, v139, vcc
    buffer_store_dwordx4 v[128:131], v25, s[4:7], s44 offen sc1
    s_barrier
    s_barrier
    s_waitcnt vmcnt(0)
    s_add_u32 s44, s18, 0
    s_and_b32 s44, s44, 15
    s_lshl_b32 s44, s44, 7
    s_add_u32 s44, s44, 0
    s_atomic_add s40, s[22:23], s44
    s_add_u32 s45, s18, 1
    s_and_b32 s45, s45, 15
    s_lshl_b32 s45, s45, 7
    s_add_u32 s45, s45, 0
    s_atomic_add s40, s[22:23], s45
    s_add_u32 s46, s18, 2
    s_and_b32 s46, s46, 15
    s_lshl_b32 s46, s46, 7
    s_add_u32 s46, s46, 0
    s_atomic_add s40, s[22:23], s46
    s_barrier
    s_barrier
    s_barrier
    s_barrier
    s_barrier
    s_barrier
    s_mov_b32 s12, s26
    s_mov_b32 s13, s27
    s_mov_b32 s14, 2097152
    s_mov_b32 s15, 0x00020000
    s_lshl_b32 s44, s2, 13
    buffer_load_dwordx4 v[160:163], v1, s[12:15], s44 offen offset:0
    buffer_load_dwordx4 v[164:167], v1, s[12:15], s44 offen offset:1024
    buffer_load_dwordx4 v[168:171], v1, s[12:15], s44 offen offset:2048
    buffer_load_dwordx4 v[172:175], v1, s[12:15], s44 offen offset:3072
    s_add_u32 s44, s44, 4096
    buffer_load_dwordx4 v[176:179], v1, s[12:15], s44 offen offset:0
    buffer_load_dwordx4 v[180:183], v1, s[12:15], s44 offen offset:1024
    buffer_load_dwordx4 v[184:187], v1, s[12:15], s44 offen offset:2048
    buffer_load_dwordx4 v[188:191], v1, s[12:15], s44 offen offset:3072
    s_mov_b32 s8, s28
    s_mov_b32 s9, s29
    s_mov_b32 s10, 6291456
    s_mov_b32 s11, 0x00020000
    s_mul_i32 s44, s17, 393216
    buffer_load_dwordx4 v[32:35], v20, s[8:11], s44 offen
    buffer_load_dwordx4 v[64:67], v21, s[8:11], s44 offen
    buffer_load_dwordx4 v[96:99], v22, s[8:11], s44 offen
    s_add_u32 s44, s44, 49152
    buffer_load_dwordx4 v[36:39], v20, s[8:11], s44 offen
    buffer_load_dwordx4 v[68:71], v21, s[8:11], s44 offen
    buffer_load_dwordx4 v[100:103], v22, s[8:11], s44 offen
    s_add_u32 s44, s44, 49152
    buffer_load_dwordx4 v[40:43], v20, s[8:11], s44 offen
    buffer_load_dwordx4 v[72:75], v21, s[8:11], s44 offen
    buffer_load_dwordx4 v[104:107], v22, s[8:11], s44 offen
    s_add_u32 s44, s44, 49152
    s_barrier
    buffer_load_dwordx4 v[44:47], v20, s[8:11], s44 offen
    buffer_load_dwordx4 v[76:79], v21, s[8:11], s44 offen
    buffer_load_dwordx4 v[108:111], v22, s[8:11], s44 offen
    s_add_u32 s44, s44, 49152
    buffer_load_dwordx4 v[48:51], v20, s[8:11], s44 offen
    buffer_load_dwordx4 v[80:83], v21, s[8:11], s44 offen
    buffer_load_dwordx4 v[112:115], v22, s[8:11], s44 offen
    s_add_u32 s44, s44, 49152
    buffer_load_dwordx4 v[52:55], v20, s[8:11], s44 offen
    buffer_load_dwordx4 v[84:87], v21, s[8:11], s44 offen
    buffer_load_dwordx4 v[116:119], v22, s[8:11], s44 offen
    s_add_u32 s44, s44, 49152
    buffer_load_dwordx4 v[56:59], v20, s[8:11], s44 offen
    buffer_load_dwordx4 v[88:91], v21, s[8:11], s44 offen
    buffer_load_dwordx4 v[120:123], v22, s[8:11], s44 offen
    s_add_u32 s44, s44, 49152
    buffer_load_dwordx4 v[60:63], v20, s[8:11], s44 offen
    buffer_load_dwordx4 v[92:95], v21, s[8:11], s44 offen
    buffer_load_dwordx4 v[124:127], v22, s[8:11], s44 offen
    s_barrier
    s_bitcmp1_b32 s21, 0
    s_cselect_b32 s8, s28, s24
    s_cselect_b32 s9, s29, s25
    s_cselect_b32 s12, s30, s26
    s_cselect_b32 s13, s31, s27
    s_mov_b32 s10, 6291456
    s_mov_b32 s11, 0x00020000
    s_mov_b32 s14, 2097152
    s_mov_b32 s15, 0x00020000
    s_branch s_tail
z_layer:
    s_waitcnt lgkmcnt(0)
    v_lshrrev_b32 v28, 4, v1
    v_and_b32 v29, 7, v28
    v_lshrrev_b32 v28, 3, v28
    v_mul_u32_u24 v28, 6144, v28
    v_lshl_add_u32 v28, v29, 4, v28
    s_and_b32 s3, s18, 12
    s_or_b32 s3, s3, 3
    s_lshl_b32 s3, s3, 7
    v_add_u32 v28, s3, v28
    s_lshr_b32 s3, s2, 3
    s_lshl_b32 s3, s3, 2
    s_and_b32 s60, s16, 3
    s_add_u32 s60, s60, s3
    s_lshr_b32 s60, s60, 2
    s_mul_i32 s60, s60, 49152
    s_cmp_lt_u32 s18, 4
    s_cselect_b32 s3, 0, 1
    s_mul_i32 s3, s3, 1572864
    s_add_u32 s3, s3, s60
    s_add_u32 s61, s3, 0
    buffer_load_dwordx4 v[160:163], v28, s[8:11], s61 offen
    s_add_u32 s61, s3, 2048
    buffer_load_dwordx4 v[164:167], v28, s[8:11], s61 offen
    s_add_u32 s61, s3, 4096
    buffer_load_dwordx4 v[168:171], v28, s[8:11], s61 offen
    s_add_u32 s3, s60, 3145728
    s_add_u32 s61, s3, 0
    buffer_load_dwordx4 v[172:175], v28, s[8:11], s61 offen
    s_add_u32 s61, s3, 2048
    buffer_load_dwordx4 v[176:179], v28, s[8:11], s61 offen
    s_add_u32 s61, s3, 4096
    buffer_load_dwordx4 v[180:183], v28, s[8:11], s61 offen
    s_add_u32 s3, s60, 4718592
    s_add_u32 s61, s3, 0
    buffer_load_dwordx4 v[184:187], v28, s[8:11], s61 offen
    s_add_u32 s61, s3, 2048
    buffer_load_dwordx4 v[188:191], v28, s[8:11], s61 offen
    s_add_u32 s61, s3, 4096
    buffer_load_dwordx4 v[192:195], v28, s[8:11], s61 offen
    s_barrier
    s_barrier
    s_barrier
    s_barrier
    s_barrier
    s_barrier
    s_barrier
    s_barrier
    s_barrier
    s_barrier
    v_lshrrev_b32 v28, 4, v1
    v_and_b32 v29, 7, v28
    v_lshrrev_b32 v28, 3, v28
    v_mul_u32_u24 v28, 2048, v28
    v_lshl_add_u32 v28, v29, 4, v28
    s_and_b32 s3, s18, 12
    s_or_b32 s3, s3, 3
    s_lshl_b32 s3, s3, 7
    v_add_u32 v28, s3, v28
    s_lshr_b32 s3, s2, 3
    s_lshl_b32 s3, s3, 2
    s_and_b32 s60, s16, 3
    s_add_u32 s60, s60, s3
    s_lshl_b32 s61, s60, 14
    buffer_load_dwordx4 v[144:147], v28, s[12:15], s61 offen
    s_bitcmp0_b32 s21, 0
    s_cselect_b32 s56, s28, s24
    s_cselect_b32 s57, s29, s25
    s_mov_b32 s58, 6291456
    s_mov_b32 s59, 0x00020000
    v_lshrrev_b32 v28, 4, v1
    v_and_b32 v29, 7, v28
    v_lshrrev_b32 v28, 3, v28
    v_mul_u32_u24 v28, 6144, v28
    v_lshl_add_u32 v28, v29, 4, v28
    s_and_b32 s3, s18, 12
    s_or_b32 s3, s3, 3
    s_lshl_b32 s3, s3, 7
    v_add_u32 v28, s3, v28
    s_lshr_b32 s3, s2, 3
    s_lshl_b32 s3, s3, 2
    s_and_b32 s60, s16, 3
    s_add_u32 s60, s60, s3
    s_and_b32 s3, s60, 31
    s_mul_i32 s3, s3, 49152
    s_lshr_b32 s61, s60, 5
    s_min_u32 s61, s61, 2
    s_lshl_b32 s61, s61, 11
    s_add_u32 s61, s61, s3
    s_cmp_lt_u32 s18, 4
    s_cselect_b32 s3, 1572864, 0
    s_add_u32 s61, s61, s3
    buffer_load_dwordx4 v[148:151], v28, s[56:59], s61 offen
    s_cmp_lg_u32 s21, 2
    s_cbranch_scc1 z_pe
    s_bitcmp0_b32 s21, 0
    s_cselect_b32 s56, s28, s24
    s_cselect_b32 s57, s29, s25
    s_mov_b32 s58, 6291456
    s_mov_b32 s59, 0x00020000
    s_add_u32 s61, s84, 2048
    buffer_load_dwordx4 v[160:163], v11, s[56:59], s61 offen
    s_add_u32 s61, s84, 4096
    buffer_load_dwordx4 v[164:167], v11, s[56:59], s61 offen
    s_add_u32 s61, s84, 0
    buffer_load_dwordx4 v[168:171], v11, s[56:59], s61 offen
    s_add_u32 s61, s84, 198656
    buffer_load_dwordx4 v[172:175], v11, s[56:59], s61 offen
    s_add_u32 s61, s84, 200704
    buffer_load_dwordx4 v[176:179], v11, s[56:59], s61 offen
    s_add_u32 s61, s84, 196608
    buffer_load_dwordx4 v[180:183], v11, s[56:59], s61 offen
    s_add_u32 s61, s85, 2048
    buffer_load_dwordx4 v[184:187], v11, s[56:59], s61 offen
    s_add_u32 s61, s85, 4096
    buffer_load_dwordx4 v[188:191], v11, s[56:59], s61 offen
    s_add_u32 s61, s85, 0
    buffer_load_dwordx4 v[192:195], v11, s[56:59], s61 offen
    s_add_u32 s61, s85, 198656
    buffer_load_dwordx4 v[196:199], v11, s[56:59], s61 offen
z_pe:
    s_barrier
    s_branch s_tail
s_tail:
    s_bitcmp1_b32 s21, 0
    s_cbranch_scc1 s_B
    s_cmp_lg_u32 s16, 4
    s_cbranch_scc1 s_a1
    s_mov_b32 s45, 2146435072
    s_cmp_eq_u32 s17, 0
    s_cbranch_scc1 s_a0
    s_lshr_b32 s46, s21, 1
    s_lshl_b32 s44, s46, 15
    s_lshl_b32 s67, s17, 11
    s_add_u32 s44, s44, s67
    s_lshl_b32 s67, s18, 7
    s_add_u32 s44, s44, s67
    s_add_u32 s44, s44, 149504
    s_sub_u32 s45, s44, 151552
    s_lshl_b32 s45, s45, 5
    s_add_u32 s45, s45, 54525952
    s_mov_b32 s66, 0x10000
s_h_poll:
    s_mov_b32 s68, 0
    s_atomic_add s68, s[22:23], s44 offset:0 glc
    s_sub_u32 s66, s66, 1
    s_cselect_b32 s67, 1, 0
    s_waitcnt lgkmcnt(0)
    s_max_u32 s68, s68, s67
    s_cmp_lt_u32 s68, 1
    s_cbranch_scc1 s_h_poll
s_h_ok:
s_a0:
    s_mov_b32 m0, 131072
    s_nop 0
    buffer_load_dwordx4 v1, s[4:7], s45 offen offset:0 sc1 lds
    buffer_load_dwordx4 v1, s[4:7], s45 offen offset:1024 sc1 lds
    buffer_load_dwordx4 v1, s[4:7], s45 offen offset:2048 sc1 lds
    buffer_load_dwordx4 v1, s[4:7], s45 offen offset:3072 sc1 lds
    s_waitcnt vmcnt(0)
s_a1:
    s_barrier
    s_waitcnt vmcnt(0)
    s_barrier
    s_sub_u32 s3, s16, 5
    s_cmp_gt_u32 s3, 1
    s_cbranch_scc1 s_a2
    s_add_u32 m0, s41, 65536
    s_xor_b32 s44, s62, 65536
    buffer_load_dwordx4 v16, s[12:15], s44 offen offset:0 lds
    buffer_load_dwordx4 v17, s[12:15], s44 offen offset:1024 lds
    s_add_u32 m0, s41, 69632
    s_xor_b32 s44, s62, 196608
    buffer_load_dwordx4 v16, s[12:15], s44 offen offset:0 lds
    buffer_load_dwordx4 v17, s[12:15], s44 offen offset:1024 lds
    s_add_u32 m0, s41, 73728
    s_xor_b32 s44, s62, 327680
    buffer_load_dwordx4 v16, s[12:15], s44 offen offset:0 lds
    buffer_load_dwordx4 v17, s[12:15], s44 offen offset:1024 lds
    s_add_u32 m0, s41, 77824
    s_xor_b32 s44, s62, 458752
    buffer_load_dwordx4 v16, s[12:15], s44 offen offset:0 lds
    buffer_load_dwordx4 v17, s[12:15], s44 offen offset:1024 lds
    s_add_u32 m0, s41, 81920
    s_xor_b32 s44, s62, 589824
    buffer_load_dwordx4 v16, s[12:15], s44 offen offset:0 lds
    buffer_load_dwordx4 v17, s[12:15], s44 offen offset:1024 lds
    s_add_u32 m0, s41, 86016
    s_xor_b32 s44, s62, 720896
    buffer_load_dwordx4 v16, s[12:15], s44 offen offset:0 lds
    buffer_load_dwordx4 v17, s[12:15], s44 offen offset:1024 lds
    s_add_u32 m0, s41, 90112
    s_xor_b32 s44, s62, 851968
    buffer_load_dwordx4 v16, s[12:15], s44 offen offset:0 lds
    buffer_load_dwordx4 v17, s[12:15], s44 offen offset:1024 lds
    s_add_u32 m0, s41, 94208
    s_xor_b32 s44, s62, 983040
    buffer_load_dwordx4 v16, s[12:15], s44 offen offset:0 lds
    buffer_load_dwordx4 v17, s[12:15], s44 offen offset:1024 lds
    s_add_u32 m0, s41, 98304
    s_xor_b32 s44, s62, 1114112
    buffer_load_dwordx4 v16, s[12:15], s44 offen offset:0 lds
    buffer_load_dwordx4 v17, s[12:15], s44 offen offset:1024 lds
    s_add_u32 m0, s41, 102400
    s_xor_b32 s44, s62, 1245184
    buffer_load_dwordx4 v16, s[12:15], s44 offen offset:0 lds
    buffer_load_dwordx4 v17, s[12:15], s44 offen offset:1024 lds
    s_add_u32 m0, s41, 106496
    s_xor_b32 s44, s62, 1376256
    buffer_load_dwordx4 v16, s[12:15], s44 offen offset:0 lds
    buffer_load_dwordx4 v17, s[12:15], s44 offen offset:1024 lds
    s_add_u32 m0, s41, 110592
    s_xor_b32 s44, s62, 1507328
    buffer_load_dwordx4 v16, s[12:15], s44 offen offset:0 lds
    buffer_load_dwordx4 v17, s[12:15], s44 offen offset:1024 lds
    s_add_u32 m0, s41, 114688
    s_xor_b32 s44, s62, 1638400
    buffer_load_dwordx4 v16, s[12:15], s44 offen offset:0 lds
    buffer_load_dwordx4 v17, s[12:15], s44 offen offset:1024 lds
    s_add_u32 m0, s41, 118784
    s_xor_b32 s44, s62, 1769472
    buffer_load_dwordx4 v16, s[12:15], s44 offen offset:0 lds
    buffer_load_dwordx4 v17, s[12:15], s44 offen offset:1024 lds
    s_add_u32 m0, s41, 122880
    s_xor_b32 s44, s62, 1900544
    buffer_load_dwordx4 v16, s[12:15], s44 offen offset:0 lds
    buffer_load_dwordx4 v17, s[12:15], s44 offen offset:1024 lds
    s_add_u32 m0, s41, 126976
    s_xor_b32 s44, s62, 2031616
    buffer_load_dwordx4 v16, s[12:15], s44 offen offset:0 lds
    buffer_load_dwordx4 v17, s[12:15], s44 offen offset:1024 lds
s_a2:
    s_cmp_eq_u32 s21, 2
    s_cbranch_scc1 s_a3
    s_bitcmp0_b32 s21, 0
    s_cselect_b32 s56, s28, s24
    s_cselect_b32 s57, s29, s25
    s_mov_b32 s58, 6291456
    s_mov_b32 s59, 0x00020000
    s_add_u32 s61, s84, 2048
    buffer_load_dwordx4 v[160:163], v11, s[56:59], s61 offen
    s_add_u32 s61, s84, 4096
    buffer_load_dwordx4 v[164:167], v11, s[56:59], s61 offen
    s_add_u32 s61, s84, 0
    buffer_load_dwordx4 v[168:171], v11, s[56:59], s61 offen
    s_add_u32 s61, s84, 198656
    buffer_load_dwordx4 v[172:175], v11, s[56:59], s61 offen
    s_add_u32 s61, s84, 200704
    buffer_load_dwordx4 v[176:179], v11, s[56:59], s61 offen
    s_add_u32 s61, s84, 196608
    buffer_load_dwordx4 v[180:183], v11, s[56:59], s61 offen
    s_add_u32 s61, s85, 2048
    buffer_load_dwordx4 v[184:187], v11, s[56:59], s61 offen
    s_add_u32 s61, s85, 4096
    buffer_load_dwordx4 v[188:191], v11, s[56:59], s61 offen
    s_add_u32 s61, s85, 0
    buffer_load_dwordx4 v[192:195], v11, s[56:59], s61 offen
    s_add_u32 s61, s85, 198656
    buffer_load_dwordx4 v[196:199], v11, s[56:59], s61 offen
s_a3:
    s_bitcmp0_b32 s21, 0
    s_cselect_b32 s56, s28, s24
    s_cselect_b32 s57, s29, s25
    s_mov_b32 s58, 6291456
    s_mov_b32 s59, 0x00020000
    s_add_u32 s61, s85, 200704
    buffer_load_dwordx4 v[200:203], v11, s[56:59], s61 offen
    s_add_u32 s61, s85, 196608
    buffer_load_dwordx4 v[204:207], v11, s[56:59], s61 offen
    s_add_u32 s61, s86, 2048
    buffer_load_dwordx4 v[208:211], v11, s[56:59], s61 offen
    s_add_u32 s61, s86, 4096
    buffer_load_dwordx4 v[212:215], v11, s[56:59], s61 offen
    s_add_u32 s61, s86, 0
    buffer_load_dwordx4 v[216:219], v11, s[56:59], s61 offen
    s_add_u32 s61, s86, 198656
    buffer_load_dwordx4 v[220:223], v11, s[56:59], s61 offen
    s_add_u32 s61, s86, 200704
    buffer_load_dwordx4 v[224:227], v11, s[56:59], s61 offen
    s_add_u32 s61, s86, 196608
    buffer_load_dwordx4 v[228:231], v11, s[56:59], s61 offen
    s_add_u32 s61, s87, 2048
    buffer_load_dwordx4 v[232:235], v11, s[56:59], s61 offen
    s_add_u32 s61, s87, 4096
    buffer_load_dwordx4 v[236:239], v11, s[56:59], s61 offen
    s_add_u32 s61, s87, 0
    buffer_load_dwordx4 v[240:243], v11, s[56:59], s61 offen
    s_add_u32 s61, s87, 198656
    buffer_load_dwordx4 v[244:247], v11, s[56:59], s61 offen
    s_add_u32 s61, s87, 200704
    buffer_load_dwordx4 v[248:251], v11, s[56:59], s61 offen
    s_add_u32 s61, s87, 196608
    buffer_load_dwordx4 v[252:255], v11, s[56:59], s61 offen
    s_waitcnt vmcnt(0)
    s_lshl_b32 s3, s21, 3
    s_add_u32 s3, s3, s16
    s_cmp_lg_u32 s3, 7
    s_cbranch_scc1 s_g3
    v_lshrrev_b32 v24, 4, v1
    v_and_b32 v25, 1, v24
    v_lshlrev_b32 v25, 4, v25
    v_mov_b32 v26, 0x3f80
    v_lshlrev_b32 v25, v25, v26
    v_bfe_u32 v26, v24, 1, 2
    v_cmp_eq_u32 vcc, 0, v26
    s_nop 1
    v_cndmask_b32 v140, 0, v25, vcc
    v_cmp_eq_u32 vcc, 1, v26
    s_nop 1
    v_cndmask_b32 v141, 0, v25, vcc
    v_cmp_eq_u32 vcc, 2, v26
    s_nop 1
    v_cndmask_b32 v142, 0, v25, vcc
    v_cmp_eq_u32 vcc, 3, v26
    s_nop 1
    v_cndmask_b32 v143, 0, v25, vcc
    v_bfe_u32 v25, v24, 3, 1
    v_lshrrev_b32 v26, 5, v24
    v_lshl_add_u32 v26, v26, 1, v25
    v_lshlrev_b32 v25, 8, v26
    v_and_b32 v27, 7, v24
    v_lshl_add_u32 v25, v27, 5, v25
    v_bfe_u32 v27, v24, 4, 1
    v_lshl_add_u32 v25, v27, 4, v25
    v_add_u32 v27, s18, v26
    v_and_b32 v27, 15, v27
    v_lshl_add_u32 v25, v27, 14, v25
    s_lshl_b32 s44, s17, 10
    s_add_u32 s44, s44, 52690944
    v_mfma_f32_16x16x32_bf16 v[128:131], v[140:143], v[32:35], 0
    v_mfma_f32_16x16x32_bf16 v[132:135], v[140:143], v[64:67], 0
    v_mfma_f32_16x16x32_bf16 v[136:139], v[140:143], v[96:99], 0
    v_mfma_f32_16x16x32_bf16 v[128:131], v[140:143], v[36:39], v[128:131]
    v_mfma_f32_16x16x32_bf16 v[132:135], v[140:143], v[68:71], v[132:135]
    v_mfma_f32_16x16x32_bf16 v[136:139], v[140:143], v[100:103], v[136:139]
    v_mfma_f32_16x16x32_bf16 v[128:131], v[140:143], v[40:43], v[128:131]
    v_mfma_f32_16x16x32_bf16 v[132:135], v[140:143], v[72:75], v[132:135]
    v_mfma_f32_16x16x32_bf16 v[136:139], v[140:143], v[104:107], v[136:139]
    v_mfma_f32_16x16x32_bf16 v[128:131], v[140:143], v[44:47], v[128:131]
    v_mfma_f32_16x16x32_bf16 v[132:135], v[140:143], v[76:79], v[132:135]
    v_mfma_f32_16x16x32_bf16 v[136:139], v[140:143], v[108:111], v[136:139]
    v_mfma_f32_16x16x32_bf16 v[128:131], v[140:143], v[48:51], v[128:131]
    v_mfma_f32_16x16x32_bf16 v[132:135], v[140:143], v[80:83], v[132:135]
    v_mfma_f32_16x16x32_bf16 v[136:139], v[140:143], v[112:115], v[136:139]
    v_mfma_f32_16x16x32_bf16 v[128:131], v[140:143], v[52:55], v[128:131]
    v_mfma_f32_16x16x32_bf16 v[132:135], v[140:143], v[84:87], v[132:135]
    v_mfma_f32_16x16x32_bf16 v[136:139], v[140:143], v[116:119], v[136:139]
    v_mfma_f32_16x16x32_bf16 v[128:131], v[140:143], v[56:59], v[128:131]
    v_mfma_f32_16x16x32_bf16 v[132:135], v[140:143], v[88:91], v[132:135]
    v_mfma_f32_16x16x32_bf16 v[136:139], v[140:143], v[120:123], v[136:139]
    v_mfma_f32_16x16x32_bf16 v[128:131], v[140:143], v[60:63], v[128:131]
    v_mfma_f32_16x16x32_bf16 v[132:135], v[140:143], v[92:95], v[132:135]
    v_mfma_f32_16x16x32_bf16 v[136:139], v[140:143], v[124:127], v[136:139]
    s_nop 5
    v_add_f32_dpp v128, v128, v128 row_ror:8 row_mask:0xf bank_mask:0xf
    v_add_f32_dpp v129, v129, v129 row_ror:8 row_mask:0xf bank_mask:0xf
    v_add_f32_dpp v130, v130, v130 row_ror:8 row_mask:0xf bank_mask:0xf
    v_add_f32_dpp v131, v131, v131 row_ror:8 row_mask:0xf bank_mask:0xf
    v_add_f32_dpp v132, v132, v132 row_ror:8 row_mask:0xf bank_mask:0xf
    v_add_f32_dpp v133, v133, v133 row_ror:8 row_mask:0xf bank_mask:0xf
    v_add_f32_dpp v134, v134, v134 row_ror:8 row_mask:0xf bank_mask:0xf
    v_add_f32_dpp v135, v135, v135 row_ror:8 row_mask:0xf bank_mask:0xf
    v_add_f32_dpp v136, v136, v136 row_ror:8 row_mask:0xf bank_mask:0xf
    v_add_f32_dpp v137, v137, v137 row_ror:8 row_mask:0xf bank_mask:0xf
    v_add_f32_dpp v138, v138, v138 row_ror:8 row_mask:0xf bank_mask:0xf
    v_add_f32_dpp v139, v139, v139 row_ror:8 row_mask:0xf bank_mask:0xf
    v_cmp_le_u32 vcc, 1, v26
    s_nop 1
    v_cndmask_b32 v128, v128, v132, vcc
    v_cndmask_b32 v129, v129, v133, vcc
    v_cndmask_b32 v130, v130, v134, vcc
    v_cndmask_b32 v131, v131, v135, vcc
    v_cmp_le_u32 vcc, 2, v26
    s_nop 1
    v_cndmask_b32 v128, v128, v136, vcc
    v_cndmask_b32 v129, v129, v137, vcc
    v_cndmask_b32 v130, v130, v138, vcc
    v_cndmask_b32 v131, v131, v139, vcc
    buffer_store_dwordx4 v[128:131], v25, s[4:7], s44 offen sc1
    s_waitcnt vmcnt(0)
    s_add_u32 s44, s18, 0
    s_and_b32 s44, s44, 15
    s_lshl_b32 s44, s44, 7
    s_add_u32 s44, s44, 2048
    s_atomic_add s40, s[22:23], s44
    s_add_u32 s45, s18, 1
    s_and_b32 s45, s45, 15
    s_lshl_b32 s45, s45, 7
    s_add_u32 s45, s45, 2048
    s_atomic_add s40, s[22:23], s45
    s_add_u32 s46, s18, 2
    s_and_b32 s46, s46, 15
    s_lshl_b32 s46, s46, 7
    s_add_u32 s46, s46, 2048
    s_atomic_add s40, s[22:23], s46
    s_branch s_g3
s_B:
    s_barrier
    s_cmp_eq_u32 s21, 3
    s_cbranch_scc1 s_nopf
    s_bitcmp0_b32 s21, 0
    s_cselect_b32 s56, s28, s24
    s_cselect_b32 s57, s29, s25
    s_mov_b32 s58, 6291456
    s_mov_b32 s59, 0x00020000
    s_add_u32 s61, s84, 2048
    buffer_load_dwordx4 v[160:163], v11, s[56:59], s61 offen
    s_add_u32 s61, s84, 4096
    buffer_load_dwordx4 v[164:167], v11, s[56:59], s61 offen
    s_add_u32 s61, s84, 0
    buffer_load_dwordx4 v[168:171], v11, s[56:59], s61 offen
    s_add_u32 s61, s84, 198656
    buffer_load_dwordx4 v[172:175], v11, s[56:59], s61 offen
    s_waitcnt vmcnt(2)
    s_add_u32 s61, s84, 200704
    buffer_load_dwordx4 v[176:179], v11, s[56:59], s61 offen
    s_add_u32 s61, s84, 196608
    buffer_load_dwordx4 v[180:183], v11, s[56:59], s61 offen
    s_add_u32 s61, s85, 2048
    buffer_load_dwordx4 v[184:187], v11, s[56:59], s61 offen
    s_add_u32 s61, s85, 4096
    buffer_load_dwordx4 v[188:191], v11, s[56:59], s61 offen
    s_waitcnt vmcnt(2)
    s_add_u32 s61, s85, 0
    buffer_load_dwordx4 v[192:195], v11, s[56:59], s61 offen
    s_add_u32 s61, s85, 198656
    buffer_load_dwordx4 v[196:199], v11, s[56:59], s61 offen
    s_add_u32 s61, s85, 200704
    buffer_load_dwordx4 v[200:203], v11, s[56:59], s61 offen
    s_add_u32 s61, s85, 196608
    buffer_load_dwordx4 v[204:207], v11, s[56:59], s61 offen
    s_waitcnt vmcnt(2)
    s_add_u32 s61, s86, 2048
    buffer_load_dwordx4 v[208:211], v11, s[56:59], s61 offen
    s_add_u32 s61, s86, 4096
    buffer_load_dwordx4 v[212:215], v11, s[56:59], s61 offen
    s_add_u32 s61, s86, 0
    buffer_load_dwordx4 v[216:219], v11, s[56:59], s61 offen
    s_add_u32 s61, s86, 198656
    buffer_load_dwordx4 v[220:223], v11, s[56:59], s61 offen
    s_waitcnt vmcnt(2)
    s_add_u32 s61, s86, 200704
    buffer_load_dwordx4 v[224:227], v11, s[56:59], s61 offen
    s_add_u32 s61, s86, 196608
    buffer_load_dwordx4 v[228:231], v11, s[56:59], s61 offen
    s_add_u32 s61, s87, 2048
    buffer_load_dwordx4 v[232:235], v11, s[56:59], s61 offen
    s_add_u32 s61, s87, 4096
    buffer_load_dwordx4 v[236:239], v11, s[56:59], s61 offen
    s_waitcnt vmcnt(2)
    s_add_u32 s61, s87, 0
    buffer_load_dwordx4 v[240:243], v11, s[56:59], s61 offen
    s_add_u32 s61, s87, 198656
    buffer_load_dwordx4 v[244:247], v11, s[56:59], s61 offen
    s_add_u32 s61, s87, 200704
    buffer_load_dwordx4 v[248:251], v11, s[56:59], s61 offen
    s_add_u32 s61, s87, 196608
    buffer_load_dwordx4 v[252:255], v11, s[56:59], s61 offen
    s_waitcnt vmcnt(2)
    s_lshl_b32 s3, s2, 2
    s_and_b32 s60, s16, 3
    s_add_u32 s60, s60, s3
    s_lshl_b32 s60, s60, 11
    buffer_load_dwordx4 v[96:99], v1, s[12:15], s60 offen offset:0
    buffer_load_dwordx4 v[100:103], v1, s[12:15], s60 offen offset:1024
s_nopf:
    s_setprio 3
    s_mov_b32 s52, 0
    s_lshl_b32 s44, s16, 14
    v_add_u32 v24, s44, v1
    s_and_b32 s3, s16, 3
    s_lshl_b32 s44, s3, 10
    s_add_u32 s44, s44, 147456
    v_lshrrev_b32 v25, 2, v1
    v_add_u32 v25, s44, v25
    s_lshl_b32 s53, s21, 22
    s_lshl_b32 s44, s38, 16
    s_add_u32 s53, s53, s44
    s_lshl_b32 s44, s18, 12
    s_add_u32 s53, s53, s44
    s_add_u32 s53, s53, 16777216
    s_lshl_b32 s54, s21, 14
    s_lshl_b32 s67, s38, 8
    s_add_u32 s54, s54, s67
    s_add_u32 s54, s54, 86016
s_bhead:
    s_barrier
    s_waitcnt vmcnt(0) lgkmcnt(0)
    s_barrier
    ds_read_b32 v28, v25 offset:0
    ds_read_b32 v29, v25 offset:256
    ds_read_b32 v30, v25 offset:512
    ds_read_b32 v31, v25 offset:768
    ds_read_b128 v[32:35], v24 offset:0
    ds_read_b128 v[36:39], v24 offset:1024
    ds_read_b128 v[40:43], v24 offset:2048
    ds_read_b128 v[44:47], v24 offset:3072
    ds_read_b128 v[48:51], v24 offset:4096
    ds_read_b128 v[52:55], v24 offset:5120
    ds_read_b128 v[56:59], v24 offset:6144
    ds_read_b128 v[60:63], v24 offset:7168
    ds_read_b128 v[64:67], v24 offset:8192
    ds_read_b128 v[68:71], v24 offset:9216
    ds_read_b128 v[72:75], v24 offset:10240
    ds_read_b128 v[76:79], v24 offset:11264
    ds_read_b128 v[80:83], v24 offset:12288
    ds_read_b128 v[84:87], v24 offset:13312
    ds_read_b128 v[88:91], v24 offset:14336
    ds_read_b128 v[92:95], v24 offset:15360
    s_waitcnt lgkmcnt(14)
    v_add_f32 v28, v28, v29
    v_add_f32 v30, v30, v31
    v_add_f32 v28, v28, v30
    v_mov_b32 v29, 0x5d800000
    v_mov_b32 v30, 0x21800000
    v_cmp_nlt_f32 s[44:45], v28, v29
    v_cmp_ngt_f32 vcc, v28, v30
    v_rcp_f32 v28, v28
    s_or_b64 vcc, vcc, s[44:45]
    s_waitcnt lgkmcnt(8)
    v_pk_add_f32 v[32:33], v[32:33], v[48:49]
    v_pk_add_f32 v[34:35], v[34:35], v[50:51]
    v_pk_add_f32 v[36:37], v[36:37], v[52:53]
    v_pk_add_f32 v[38:39], v[38:39], v[54:55]
    v_pk_add_f32 v[40:41], v[40:41], v[56:57]
    v_pk_add_f32 v[42:43], v[42:43], v[58:59]
    v_pk_add_f32 v[44:45], v[44:45], v[60:61]
    v_pk_add_f32 v[46:47], v[46:47], v[62:63]
    s_waitcnt lgkmcnt(4)
    v_pk_add_f32 v[32:33], v[32:33], v[64:65]
    v_pk_add_f32 v[34:35], v[34:35], v[66:67]
    v_pk_add_f32 v[36:37], v[36:37], v[68:69]
    v_pk_add_f32 v[38:39], v[38:39], v[70:71]
    v_pk_add_f32 v[40:41], v[40:41], v[72:73]
    v_pk_add_f32 v[42:43], v[42:43], v[74:75]
    v_pk_add_f32 v[44:45], v[44:45], v[76:77]
    v_pk_add_f32 v[46:47], v[46:47], v[78:79]
    s_waitcnt lgkmcnt(0)
    v_pk_add_f32 v[32:33], v[32:33], v[80:81]
    v_pk_add_f32 v[34:35], v[34:35], v[82:83]
    v_pk_add_f32 v[36:37], v[36:37], v[84:85]
    v_pk_add_f32 v[38:39], v[38:39], v[86:87]
    v_pk_add_f32 v[40:41], v[40:41], v[88:89]
    v_pk_add_f32 v[42:43], v[42:43], v[90:91]
    v_pk_add_f32 v[44:45], v[44:45], v[92:93]
    v_pk_add_f32 v[46:47], v[46:47], v[94:95]
    s_cbranch_vccnz s_slow
s_fin:
    v_pk_mul_f32 v[32:33], v[28:29], v[32:33] op_sel_hi:[0,1]
    v_pk_mul_f32 v[34:35], v[28:29], v[34:35] op_sel_hi:[0,1]
    v_pk_mul_f32 v[36:37], v[28:29], v[36:37] op_sel_hi:[0,1]
    v_pk_mul_f32 v[38:39], v[28:29], v[38:39] op_sel_hi:[0,1]
    v_pk_mul_f32 v[40:41], v[28:29], v[40:41] op_sel_hi:[0,1]
    v_pk_mul_f32 v[42:43], v[28:29], v[42:43] op_sel_hi:[0,1]
    v_pk_mul_f32 v[44:45], v[28:29], v[44:45] op_sel_hi:[0,1]
    v_pk_mul_f32 v[46:47], v[28:29], v[46:47] op_sel_hi:[0,1]
    v_cvt_pk_bf16_f32 v32, v32, v33
    v_cvt_pk_bf16_f32 v33, v34, v35
    v_cvt_pk_bf16_f32 v34, v36, v37
    v_cvt_pk_bf16_f32 v35, v38, v39
    v_cvt_pk_bf16_f32 v36, v40, v41
    v_cvt_pk_bf16_f32 v37, v42, v43
    v_cvt_pk_bf16_f32 v38, v44, v45
    v_cvt_pk_bf16_f32 v39, v46, v47
    buffer_store_dwordx4 v[32:35], v1, s[4:7], s53 offen offset:0 sc1
    buffer_store_dwordx4 v[36:39], v1, s[4:7], s53 offen offset:1024 sc1
    s_cmp_lg_u32 s52, 0
    s_cbranch_scc1 s_b2
    s_waitcnt vmcnt(0)
    s_atomic_add s40, s[22:23], s54
    s_mov_b32 s52, 1
    s_add_u32 s53, s53, 2048
    s_waitcnt lgkmcnt(0)
    s_add_u32 s54, s54, 128
    s_setprio 0
    s_and_b32 s3, s16, 3
    s_lshl_b32 s46, s3, 19
    s_lshl_b32 s45, s3, 14
    s_and_b32 s3, s18, 0
    s_lshl_b32 s3, s3, 17
    s_xor_b32 s46, s46, s3
    s_add_u32 m0, s45, 0
    s_xor_b32 s44, s46, 0
    buffer_load_dwordx4 v16, s[12:15], s44 offen offset:0 lds
    buffer_load_dwordx4 v17, s[12:15], s44 offen offset:1024 lds
    buffer_load_dwordx4 v18, s[12:15], s44 offen offset:2048 lds
    buffer_load_dwordx4 v19, s[12:15], s44 offen offset:3072 lds
    s_add_u32 s44, s44, 65536
    s_waitcnt vmcnt(2)
    buffer_load_dwordx4 v[96:99], v16, s[12:15], s44 offen offset:0
    buffer_load_dwordx4 v[100:103], v17, s[12:15], s44 offen offset:1024
    buffer_load_dwordx4 v[104:107], v18, s[12:15], s44 offen offset:2048
    buffer_load_dwordx4 v[108:111], v19, s[12:15], s44 offen offset:3072
    s_waitcnt vmcnt(2)
    s_add_u32 m0, s45, 4096
    s_xor_b32 s44, s46, 131072
    buffer_load_dwordx4 v16, s[12:15], s44 offen offset:0 lds
    buffer_load_dwordx4 v17, s[12:15], s44 offen offset:1024 lds
    buffer_load_dwordx4 v18, s[12:15], s44 offen offset:2048 lds
    buffer_load_dwordx4 v19, s[12:15], s44 offen offset:3072 lds
    s_add_u32 s44, s44, 65536
    s_waitcnt vmcnt(2)
    buffer_load_dwordx4 v[112:115], v16, s[12:15], s44 offen offset:0
    buffer_load_dwordx4 v[116:119], v17, s[12:15], s44 offen offset:1024
    buffer_load_dwordx4 v[120:123], v18, s[12:15], s44 offen offset:2048
    buffer_load_dwordx4 v[124:127], v19, s[12:15], s44 offen offset:3072
    s_waitcnt vmcnt(2)
    s_add_u32 m0, s45, 8192
    s_xor_b32 s44, s46, 262144
    buffer_load_dwordx4 v16, s[12:15], s44 offen offset:0 lds
    buffer_load_dwordx4 v17, s[12:15], s44 offen offset:1024 lds
    buffer_load_dwordx4 v18, s[12:15], s44 offen offset:2048 lds
    buffer_load_dwordx4 v19, s[12:15], s44 offen offset:3072 lds
    s_add_u32 s44, s44, 65536
    s_waitcnt vmcnt(2)
    buffer_load_dwordx4 v[128:131], v16, s[12:15], s44 offen offset:0
    buffer_load_dwordx4 v[132:135], v17, s[12:15], s44 offen offset:1024
    buffer_load_dwordx4 v[136:139], v18, s[12:15], s44 offen offset:2048
    buffer_load_dwordx4 v[140:143], v19, s[12:15], s44 offen offset:3072
    s_waitcnt vmcnt(2)
    s_add_u32 m0, s45, 12288
    s_xor_b32 s44, s46, 393216
    buffer_load_dwordx4 v16, s[12:15], s44 offen offset:0 lds
    buffer_load_dwordx4 v17, s[12:15], s44 offen offset:1024 lds
    buffer_load_dwordx4 v18, s[12:15], s44 offen offset:2048 lds
    buffer_load_dwordx4 v19, s[12:15], s44 offen offset:3072 lds
    s_add_u32 s44, s44, 65536
    s_waitcnt vmcnt(2)
    buffer_load_dwordx4 v[144:147], v16, s[12:15], s44 offen offset:0
    buffer_load_dwordx4 v[148:151], v17, s[12:15], s44 offen offset:1024
    buffer_load_dwordx4 v[152:155], v18, s[12:15], s44 offen offset:2048
    buffer_load_dwordx4 v[156:159], v19, s[12:15], s44 offen offset:3072
    s_waitcnt vmcnt(2)
    s_setprio 3
    s_sub_u32 s44, s54, 128
    s_mov_b32 s66, 0x10000
s_o0_poll:
    s_mov_b32 s68, 0
    s_atomic_add s68, s[22:23], s44 offset:0 glc
    s_sub_u32 s66, s66, 1
    s_cselect_b32 s67, 16, 0
    s_waitcnt lgkmcnt(0)
    s_max_u32 s68, s68, s67
    s_cmp_lt_u32 s68, 16
    s_cbranch_scc1 s_o0_poll
s_o0_ok:
    s_branch s_bhead
s_b2:
    ds_write_b128 v24, v[96:99] offset:0
    ds_write_b128 v24, v[100:103] offset:1024
    ds_write_b128 v24, v[104:107] offset:2048
    ds_write_b128 v24, v[108:111] offset:3072
    ds_write_b128 v24, v[112:115] offset:4096
    ds_write_b128 v24, v[116:119] offset:5120
    ds_write_b128 v24, v[120:123] offset:6144
    ds_write_b128 v24, v[124:127] offset:7168
    ds_write_b128 v24, v[128:131] offset:8192
    ds_write_b128 v24, v[132:135] offset:9216
    ds_write_b128 v24, v[136:139] offset:10240
    ds_write_b128 v24, v[140:143] offset:11264
    ds_write_b128 v24, v[144:147] offset:12288
    ds_write_b128 v24, v[148:151] offset:13312
    ds_write_b128 v24, v[152:155] offset:14336
    ds_write_b128 v24, v[156:159] offset:15360
    s_mov_b32 s68, 1
    s_waitcnt vmcnt(0)
    s_atomic_add s68, s[22:23], s54 glc
    s_mov_b32 s66, 0x10000
    s_waitcnt lgkmcnt(0)
    s_cmp_eq_u32 s68, 15
    s_cbranch_scc1 s_o1_ok
s_o1_poll:
    s_mov_b32 s68, 0
    s_atomic_add s68, s[22:23], s54 offset:0 glc
    s_sub_u32 s66, s66, 1
    s_cselect_b32 s67, 16, 0
    s_waitcnt lgkmcnt(0)
    s_max_u32 s68, s68, s67
    s_cmp_lt_u32 s68, 16
    s_cbranch_scc1 s_o1_poll
s_o1_ok:
s_b3:
    s_setprio 0
    s_waitcnt lgkmcnt(0)
s_g3:
    s_barrier
    s_cmp_eq_u32 s21, 3
    s_cbranch_scc1 s_end
    s_barrier
    ds_write_b128 v9, v[160:163] offset:0
    ds_write_b128 v9, v[164:167] offset:4096
    ds_write_b128 v9, v[168:171] offset:8192
    ds_write_b128 v9, v[172:175] offset:12288
    ds_write_b128 v9, v[176:179] offset:16384
    ds_write_b128 v9, v[180:183] offset:20480
    ds_write_b128 v9, v[184:187] offset:24576
    ds_write_b128 v9, v[188:191] offset:28672
    s_add_u32 s21, s21, 1
    s_bitcmp1_b32 s21, 0
    s_cselect_b32 s8, s28, s24
    s_cselect_b32 s9, s29, s25
    s_cselect_b32 s12, s30, s26
    s_cselect_b32 s13, s31, s27
    s_mov_b32 s10, 6291456
    s_mov_b32 s11, 0x00020000
    s_mov_b32 s14, 2097152
    s_mov_b32 s15, 0x00020000
    s_sub_u32 s3, s16, 5
    s_cmp_gt_u32 s3, 1
    s_cbranch_scc1 s_n67
    s_add_u32 m0, s41, 98304
    s_add_u32 s44, s88, 2048
    buffer_load_dwordx4 v14, s[8:11], s44 offen offset:0 lds
    buffer_load_dwordx4 v15, s[8:11], s44 offen offset:1024 lds
    s_add_u32 m0, s41, 102400
    s_add_u32 s44, s88, 4096
    buffer_load_dwordx4 v14, s[8:11], s44 offen offset:0 lds
    buffer_load_dwordx4 v15, s[8:11], s44 offen offset:1024 lds
    s_add_u32 m0, s41, 106496
    s_add_u32 s44, s88, 0
    buffer_load_dwordx4 v14, s[8:11], s44 offen offset:0 lds
    buffer_load_dwordx4 v15, s[8:11], s44 offen offset:1024 lds
    s_add_u32 m0, s41, 110592
    s_add_u32 s44, s88, 198656
    buffer_load_dwordx4 v14, s[8:11], s44 offen offset:0 lds
    buffer_load_dwordx4 v15, s[8:11], s44 offen offset:1024 lds
    s_add_u32 m0, s41, 114688
    s_add_u32 s44, s88, 200704
    buffer_load_dwordx4 v14, s[8:11], s44 offen offset:0 lds
    buffer_load_dwordx4 v15, s[8:11], s44 offen offset:1024 lds
    s_add_u32 m0, s41, 118784
    s_add_u32 s44, s88, 196608
    buffer_load_dwordx4 v14, s[8:11], s44 offen offset:0 lds
    buffer_load_dwordx4 v15, s[8:11], s44 offen offset:1024 lds
    s_add_u32 m0, s41, 122880
    s_add_u32 s44, s89, 2048
    buffer_load_dwordx4 v14, s[8:11], s44 offen offset:0 lds
    buffer_load_dwordx4 v15, s[8:11], s44 offen offset:1024 lds
    s_add_u32 m0, s41, 126976
    s_add_u32 s44, s89, 4096
    buffer_load_dwordx4 v14, s[8:11], s44 offen offset:0 lds
    buffer_load_dwordx4 v15, s[8:11], s44 offen offset:1024 lds
s_n67:
    s_waitcnt lgkmcnt(0)
    s_barrier
    ds_write_b128 v9, v[192:195] offset:32768
    ds_write_b128 v9, v[196:199] offset:36864
    ds_write_b128 v9, v[200:203] offset:40960
    ds_write_b128 v9, v[204:207] offset:45056
    ds_write_b128 v9, v[208:211] offset:49152
    ds_write_b128 v9, v[212:215] offset:53248
    ds_write_b128 v9, v[216:219] offset:57344
    ds_write_b128 v9, v[220:223] offset:61440
    ds_write_b128 v10, v[224:227] offset:0
    ds_write_b128 v10, v[228:231] offset:4096
    ds_write_b128 v10, v[232:235] offset:8192
    ds_write_b128 v10, v[236:239] offset:12288
    ds_write_b128 v10, v[240:243] offset:16384
    ds_write_b128 v10, v[244:247] offset:20480
    ds_write_b128 v10, v[248:251] offset:24576
    ds_write_b128 v10, v[252:255] offset:28672
    s_cmp_eq_u32 s16, 4
    s_cbranch_scc1 h_layer
    s_cmp_eq_u32 s16, 7
    s_cbranch_scc1 z_layer
    s_branch l_layer
s_end:
    s_lshl_b32 s3, s2, 3
    s_add_u32 s3, s3, s16
    s_cmp_lg_u32 s3, 7
    s_cbranch_scc1 k_exit
    s_mov_b32 s8, s34
    s_mov_b32 s9, s35
    s_mov_b32 s10, 256
    s_mov_b32 s11, 0x00020000
    v_lshrrev_b32 v24, 2, v1
    v_mov_b32 v25, 0
    buffer_store_dword v25, v24, s[8:11], 0 offen sc1
    s_branch k_exit
s_slow:
    s_and_b32 s3, s16, 3
    s_lshl_b32 s44, s3, 11
    s_lshl_b32 s45, s52, 13
    s_add_u32 s44, s44, s45
    s_add_u32 s44, s44, 131072
    v_add_u32 v26, s44, v1
    ds_read_b128 v[48:51], v26 offset:0
    ds_read_b128 v[52:55], v26 offset:1024
    s_lshr_b32 s55, s21, 1
    s_lshl_b32 s55, s55, 23
    s_lshl_b32 s44, s18, 18
    s_add_u32 s55, s55, s44
    s_lshl_b32 s44, s52, 17
    s_add_u32 s55, s55, s44
    s_add_u32 s55, s55, 33554432
    s_waitcnt lgkmcnt(0)
    v_mov_b32 v26, 0xff800000
    s_mov_b32 s61, 0
s_slow1:
    s_add_u32 s44, s55, s61
    buffer_load_dwordx4 v[56:59], v1, s[4:7], s44 offen offset:0 sc1
    buffer_load_dwordx4 v[60:63], v1, s[4:7], s44 offen offset:1024 sc1
    s_waitcnt vmcnt(0)
    v_mfma_f32_32x32x16_bf16 v[72:87], v[56:59], v[48:51], 0
    v_mfma_f32_32x32x16_bf16 v[72:87], v[60:63], v[52:55], v[72:87]
    s_nop 11
    v_max3_f32 v26, v26, v72, v73
    v_max3_f32 v26, v26, v74, v75
    v_max3_f32 v26, v26, v76, v77
    v_max3_f32 v26, v26, v78, v79
    v_max3_f32 v26, v26, v80, v81
    v_max3_f32 v26, v26, v82, v83
    v_max3_f32 v26, v26, v84, v85
    v_max3_f32 v26, v26, v86, v87
    s_add_u32 s61, s61, 2048
    s_cmp_lt_u32 s61, 131072
    s_cbranch_scc1 s_slow1
    v_mov_b32 v27, v26
    s_nop 1
    v_permlane32_swap_b32 v26, v27
    v_max_f32 v26, v26, v27
    v_mov_b32 v32, 0
    v_mov_b32 v33, 0
    v_mov_b32 v34, 0
    v_mov_b32 v35, 0
    v_mov_b32 v36, 0
    v_mov_b32 v37, 0
    v_mov_b32 v38, 0
    v_mov_b32 v39, 0
    v_mov_b32 v40, 0
    v_mov_b32 v41, 0
    v_mov_b32 v42, 0
    v_mov_b32 v43, 0
    v_mov_b32 v44, 0
    v_mov_b32 v45, 0
    v_mov_b32 v46, 0
    v_mov_b32 v47, 0
    v_mov_b32 v28, 0
    v_mov_b32 v29, 0xdddddddd
    s_mov_b32 s3, 0xffff0000
    s_mov_b32 s61, 0
s_slow2:
    s_add_u32 s44, s55, s61
    buffer_load_dwordx4 v[56:59], v1, s[4:7], s44 offen offset:0 sc1
    buffer_load_dwordx4 v[60:63], v1, s[4:7], s44 offen offset:1024 sc1
    s_add_u32 s44, s44, 4194304
    buffer_load_dwordx4 v[64:67], v1, s[4:7], s44 offen offset:0 sc1
    buffer_load_dwordx4 v[68:71], v1, s[4:7], s44 offen offset:1024 sc1
    s_waitcnt vmcnt(0)
    v_mfma_f32_32x32x16_bf16 v[72:87], v[56:59], v[48:51], 0
    v_mfma_f32_32x32x16_bf16 v[72:87], v[60:63], v[52:55], v[72:87]
    s_nop 11
    v_sub_f32 v72, v72, v26
    v_sub_f32 v73, v73, v26
    v_sub_f32 v74, v74, v26
    v_sub_f32 v75, v75, v26
    v_sub_f32 v76, v76, v26
    v_sub_f32 v77, v77, v26
    v_sub_f32 v78, v78, v26
    v_sub_f32 v79, v79, v26
    v_sub_f32 v80, v80, v26
    v_sub_f32 v81, v81, v26
    v_sub_f32 v82, v82, v26
    v_sub_f32 v83, v83, v26
    v_sub_f32 v84, v84, v26
    v_sub_f32 v85, v85, v26
    v_sub_f32 v86, v86, v26
    v_sub_f32 v87, v87, v26
    v_exp_f32 v72, v72
    v_exp_f32 v73, v73
    v_exp_f32 v74, v74
    v_exp_f32 v75, v75
    v_exp_f32 v76, v76
    v_exp_f32 v77, v77
    v_exp_f32 v78, v78
    v_exp_f32 v79, v79
    v_exp_f32 v80, v80
    v_exp_f32 v81, v81
    v_exp_f32 v82, v82
    v_exp_f32 v83, v83
    v_exp_f32 v84, v84
    v_exp_f32 v85, v85
    v_exp_f32 v86, v86
    v_exp_f32 v87, v87
    v_and_b32 v72, s3, v72
    v_and_b32 v73, s3, v73
    v_and_b32 v74, s3, v74
    v_and_b32 v75, s3, v75
    v_and_b32 v76, s3, v76
    v_and_b32 v77, s3, v77
    v_and_b32 v78, s3, v78
    v_and_b32 v79, s3, v79
    v_and_b32 v80, s3, v80
    v_and_b32 v81, s3, v81
    v_and_b32 v82, s3, v82
    v_and_b32 v83, s3, v83
    v_and_b32 v84, s3, v84
    v_and_b32 v85, s3, v85
    v_and_b32 v86, s3, v86
    v_and_b32 v87, s3, v87
    v_add_f32 v28, v28, v72
    v_add_f32 v28, v28, v73
    v_add_f32 v28, v28, v74
    v_add_f32 v28, v28, v75
    v_add_f32 v28, v28, v76
    v_add_f32 v28, v28, v77
    v_add_f32 v28, v28, v78
    v_add_f32 v28, v28, v79
    v_add_f32 v28, v28, v80
    v_add_f32 v28, v28, v81
    v_add_f32 v28, v28, v82
    v_add_f32 v28, v28, v83
    v_add_f32 v28, v28, v84
    v_add_f32 v28, v28, v85
    v_add_f32 v28, v28, v86
    v_add_f32 v28, v28, v87
    v_smfmac_f32_32x32x32_bf16 v[32:47], v[64:67], v[72:79], v29
    v_smfmac_f32_32x32x32_bf16 v[32:47], v[68:71], v[80:87], v29
    s_add_u32 s61, s61, 2048
    s_cmp_lt_u32 s61, 131072
    s_cbranch_scc1 s_slow2
    v_mov_b32 v29, v28
    s_nop 1
    v_permlane32_swap_b32 v28, v29
    v_add_f32 v28, v28, v29
    v_rcp_f32 v28, v28
    s_nop 7
    s_branch s_fin
k_exit:
    s_endpgm
.if k_exit - interleave_layers__sliding_local_dilated__softmax_full_mha__prompt_kernel < 49152
.error "code prefetch reads past the end of the code"
.endif
.section .rodata,"a"
.p2align 6
.amdhsa_kernel interleave_layers__sliding_local_dilated__softmax_full_mha__prompt_kernel
  .amdhsa_next_free_vgpr 256
  .amdhsa_next_free_sgpr 102
  .amdhsa_accum_offset 256
  .amdhsa_group_segment_fixed_size 0
  .amdhsa_kernarg_size 72
  .amdhsa_user_sgpr_count 2
  .amdhsa_user_sgpr_kernarg_segment_ptr 1
  .amdhsa_system_sgpr_workgroup_id_x 1
.end_amdhsa_kernel
```

```asm
; @launch grid=(256,1,1) block=(512,1,1) lds=156736
.amdgcn_target "amdgcn-amd-amdhsa--gfx950"
.text
.globl interleave_layers__sliding_local_dilated__softmax_full_mha__prompt_kernel
.type interleave_layers__sliding_local_dilated__softmax_full_mha__prompt_kernel,@function
.p2align 8
interleave_layers__sliding_local_dilated__softmax_full_mha__prompt_kernel:
    s_cmp_ge_u32 s2, 256
    s_cbranch_scc1 k_exit
    s_load_dwordx2 s[36:37], s[0:1], 0
    s_load_dwordx4 s[24:27], s[0:1], 8
    s_load_dwordx8 s[28:35], s[0:1], 32
    s_load_dwordx2 s[44:45], s[0:1], 64
    v_lshrrev_b32 v2, 6, v0
    v_and_b32 v0, 63, v0
    v_readfirstlane_b32 s16, v2
    v_lshlrev_b32 v1, 4, v0
    s_mov_b32 s21, 0
    s_mov_b32 s40, 1
    s_and_b32 s3, s2, 1
    s_lshl_b32 s3, s3, 3
    s_bfe_u32 s17, s2, 0x30003
    s_add_u32 s17, s17, s3
    s_bfe_u32 s3, s2, 0x20001
    s_lshl_b32 s3, s3, 2
    s_lshr_b32 s18, s2, 6
    s_add_u32 s18, s18, s3
    s_and_b32 s3, s16, 3
    s_lshl_b32 s38, s17, 2
    s_add_u32 s38, s38, s3
    v_lshrrev_b32 v32, 3, v0
    v_and_b32 v33, 7, v0
    v_lshlrev_b32 v34, 11, v32
    v_lshl_add_u32 v34, v33, 4, v34
    s_lshl_b32 s46, s38, 16
    s_lshl_b32 s47, s18, 7
    s_add_u32 s46, s46, s47
    s_getpc_b64 s[76:77]
e_pc:
    s_sub_u32 s76, s76, e_pc - interleave_layers__sliding_local_dilated__softmax_full_mha__prompt_kernel
    s_subb_u32 s77, s77, 0
    s_and_b32 s3, s2, 0xf8
    s_add_u32 s3, s3, s16
    s_lshl_b32 s3, s3, 6
    s_add_u32 s78, s3, 49152
    s_min_u32 s78, s78, k_exit - interleave_layers__sliding_local_dilated__softmax_full_mha__prompt_kernel
    s_waitcnt lgkmcnt(0)
    s_mov_b32 s8, s36
    s_mov_b32 s9, s37
    s_mov_b32 s10, 4194304
    s_mov_b32 s11, 0x00020000
    s_cmp_gt_u32 s16, 3
    s_cbranch_scc1 e_side
    buffer_load_dwordx4 v[40:43], v34, s[8:11], s46 offen
    s_add_u32 s46, s46, 16384
    buffer_load_dwordx4 v[44:47], v34, s[8:11], s46 offen
    s_add_u32 s46, s46, 16384
    buffer_load_dwordx4 v[48:51], v34, s[8:11], s46 offen
    s_add_u32 s46, s46, 16384
    buffer_load_dwordx4 v[52:55], v34, s[8:11], s46 offen
e_side:
    s_load_dword s80, s[76:77], s3 offset:0
    s_load_dword s81, s[76:77], s3 offset:16384
    s_load_dword s82, s[76:77], s3 offset:32768
    s_load_dword s83, s[76:77], s78
    s_mov_b32 s4, s44
    s_mov_b32 s5, s45
    s_mov_b32 s6, 67108864
    s_mov_b32 s7, 0x00020000
    s_add_u32 s22, s44, 58720256
    s_addc_u32 s23, s45, 0
    s_load_dword s100, s[22:23], 217088
    s_cmp_gt_u32 s16, 3
    s_cbranch_scc1 s_start
    v_lshrrev_b32 v8, 4, v1
    s_lshl_b32 s44, s38, 16
    v_xor_b32 v88, v33, v32
    v_lshlrev_b32 v88, 4, v88
    v_lshl_add_u32 v88, v32, 11, v88
    v_xor_b32 v89, 16, v88
    v_add_u32 v89, 15360, v89
    v_add_u32 v90, 30720, v88
    v_add_u32 v91, 30720, v89
    s_mul_i32 s76, s16, 16384
    s_add_u32 s76, s76, 61440
    s_lshl_b32 s77, s38, 16
    s_mul_i32 s84, s18, 4096
    s_cmp_lt_u32 s18, 4
    s_cselect_b32 s85, 4, 0
    s_mul_i32 s85, s85, 4096
    s_cmp_lt_u32 s18, 4
    s_cselect_b32 s86, 5, 1
    s_mul_i32 s86, s86, 4096
    s_cmp_lt_u32 s18, 4
    s_cselect_b32 s87, 6, 2
    s_mul_i32 s87, s87, 4096
    s_cmp_lt_u32 s18, 4
    s_cselect_b32 s88, 7, 3
    s_mul_i32 s88, s88, 4096
    s_cmp_lt_u32 s18, 8
    s_cselect_b32 s89, 8, 4
    s_mul_i32 s89, s89, 4096
    s_cmp_lt_u32 s18, 8
    s_cselect_b32 s90, 9, 5
    s_mul_i32 s90, s90, 4096
    s_cmp_lt_u32 s18, 8
    s_cselect_b32 s91, 10, 6
    s_mul_i32 s91, s91, 4096
    s_cmp_lt_u32 s18, 8
    s_cselect_b32 s92, 11, 7
    s_mul_i32 s92, s92, 4096
    s_cmp_lt_u32 s18, 12
    s_cselect_b32 s93, 12, 8
    s_mul_i32 s93, s93, 4096
    s_cmp_lt_u32 s18, 12
    s_cselect_b32 s94, 13, 9
    s_mul_i32 s94, s94, 4096
    s_cmp_lt_u32 s18, 12
    s_cselect_b32 s95, 14, 10
    s_mul_i32 s95, s95, 4096
    s_cmp_lt_u32 s18, 12
    s_cselect_b32 s96, 15, 11
    s_mul_i32 s96, s96, 4096
    s_xor_b32 s97, s18, 1
    s_mul_i32 s97, s97, 4096
    s_xor_b32 s98, s18, 2
    s_mul_i32 s98, s98, 4096
    s_xor_b32 s99, s18, 3
    s_mul_i32 s99, s99, 4096
    s_lshr_b32 s3, s18, 2
    s_lshl_b32 s3, s3, 3
    s_lshl_b32 s63, 1, s3
    s_lshl_b32 s3, s63, 2
    s_andn2_b32 s19, 67372036, s3
    v_lshrrev_b32 v12, 4, v1
    v_and_b32 v13, 15, v12
    v_bfe_u32 v14, v12, 4, 1
    v_lshrrev_b32 v12, 5, v12
    v_lshl_add_u32 v2, v14, 5, v13
    v_lshlrev_b32 v2, 4, v2
    v_lshl_add_u32 v2, v12, 10, v2
    v_lshrrev_b32 v15, 2, v13
    v_lshl_add_u32 v15, v14, 2, v15
    v_lshlrev_b32 v3, 7, v15
    v_lshl_add_u32 v3, v12, 11, v3
    v_and_b32 v15, 3, v13
    v_lshl_add_u32 v3, v15, 3, v3
    v_lshrrev_b32 v15, 3, v13
    v_lshl_add_u32 v15, v15, 1, v14
    v_lshl_add_u32 v3, v15, 5, v3
    v_xor_b32 v4, 32, v3
    v_xor_b32 v5, 64, v3
    v_xor_b32 v6, 96, v3
    s_lshl_b32 s45, s16, 12
    s_add_u32 s45, s45, 131072
    v_lshrrev_b32 v35, 1, v33
    v_lshlrev_b32 v35, 10, v35
    v_lshl_add_u32 v35, v32, 4, v35
    v_and_b32 v36, 1, v33
    v_lshl_add_u32 v35, v36, 3, v35
    v_add_u32 v35, s45, v35
    v_add_u32 v36, s45, v1
    v_mov_b32 v37, 0x3f803f80
    v_and_b32 v38, 3, v8
    v_lshl_add_u32 v39, v38, 3, v32
    v_lshlrev_b32 v39, 3, v39
    v_mov_b32 v56, 0
    v_mov_b32 v57, 0
    v_mov_b32 v58, 0
    v_mov_b32 v59, 0
    v_mov_b32 v60, 0
    v_mov_b32 v61, 0
    v_mov_b32 v62, 0
    v_mov_b32 v63, 0
    s_waitcnt vmcnt(3)
    ds_write_b64 v35, v[40:41] offset:0
    ds_write_b64 v35, v[42:43] offset:512
    s_waitcnt vmcnt(2)
    ds_write_b64 v35, v[44:45] offset:128
    ds_write_b64 v35, v[46:47] offset:640
    s_waitcnt vmcnt(1)
    ds_write_b64 v35, v[48:49] offset:256
    ds_write_b64 v35, v[50:51] offset:768
    s_waitcnt vmcnt(0)
    ds_write_b64 v35, v[52:53] offset:384
    ds_write_b64 v35, v[54:55] offset:896
    ds_read_b128 v[64:67], v36 offset:0
    ds_read_b128 v[68:71], v36 offset:1024
    ds_read_b128 v[72:75], v36 offset:2048
    ds_read_b128 v[76:79], v36 offset:3072
    s_lshl_b32 s45, s18, 12
    s_add_u32 s46, s44, s45
    s_waitcnt lgkmcnt(3)
    buffer_store_dwordx4 v[64:67], v1, s[4:7], s46 offen offset:0 sc1
    s_waitcnt lgkmcnt(2)
    buffer_store_dwordx4 v[68:71], v1, s[4:7], s46 offen offset:1024 sc1
    s_waitcnt lgkmcnt(1)
    buffer_store_dwordx4 v[72:75], v1, s[4:7], s46 offen offset:2048 sc1
    s_waitcnt lgkmcnt(0)
    buffer_store_dwordx4 v[76:79], v1, s[4:7], s46 offen offset:3072 sc1
    s_add_u32 m0, s76, 4096
    s_lshr_b32 s78, s85, 5
    s_add_u32 s78, s78, s77
    buffer_load_dwordx4 v88, s[8:11], s78 offen offset:0 lds
    buffer_load_dwordx4 v89, s[8:11], s78 offen offset:1024 lds
    buffer_load_dwordx4 v90, s[8:11], s78 offen offset:2048 lds
    buffer_load_dwordx4 v91, s[8:11], s78 offen offset:3072 lds
    s_add_u32 m0, s76, 8192
    s_lshr_b32 s78, s86, 5
    s_add_u32 s78, s78, s77
    buffer_load_dwordx4 v88, s[8:11], s78 offen offset:0 lds
    buffer_load_dwordx4 v89, s[8:11], s78 offen offset:1024 lds
    buffer_load_dwordx4 v90, s[8:11], s78 offen offset:2048 lds
    buffer_load_dwordx4 v91, s[8:11], s78 offen offset:3072 lds
    s_add_u32 m0, s76, 12288
    s_lshr_b32 s78, s87, 5
    s_add_u32 s78, s78, s77
    buffer_load_dwordx4 v88, s[8:11], s78 offen offset:0 lds
    buffer_load_dwordx4 v89, s[8:11], s78 offen offset:1024 lds
    buffer_load_dwordx4 v90, s[8:11], s78 offen offset:2048 lds
    buffer_load_dwordx4 v91, s[8:11], s78 offen offset:3072 lds
    s_add_u32 m0, s76, 16384
    s_lshr_b32 s78, s88, 5
    s_add_u32 s78, s78, s77
    buffer_load_dwordx4 v88, s[8:11], s78 offen offset:0 lds
    buffer_load_dwordx4 v89, s[8:11], s78 offen offset:1024 lds
    buffer_load_dwordx4 v90, s[8:11], s78 offen offset:2048 lds
    buffer_load_dwordx4 v91, s[8:11], s78 offen offset:3072 lds
    v_dot2_f32_bf16 v56, v40, v37, v56
    v_dot2_f32_bf16 v57, v40, v40, v57
    v_dot2_f32_bf16 v58, v44, v37, v58
    v_dot2_f32_bf16 v59, v44, v44, v59
    v_dot2_f32_bf16 v60, v48, v37, v60
    v_dot2_f32_bf16 v61, v48, v48, v61
    v_dot2_f32_bf16 v62, v52, v37, v62
    v_dot2_f32_bf16 v63, v52, v52, v63
    v_dot2_f32_bf16 v56, v41, v37, v56
    v_dot2_f32_bf16 v57, v41, v41, v57
    v_dot2_f32_bf16 v58, v45, v37, v58
    v_dot2_f32_bf16 v59, v45, v45, v59
    v_dot2_f32_bf16 v60, v49, v37, v60
    v_dot2_f32_bf16 v61, v49, v49, v61
    v_dot2_f32_bf16 v62, v53, v37, v62
    v_dot2_f32_bf16 v63, v53, v53, v63
    v_dot2_f32_bf16 v56, v42, v37, v56
    v_dot2_f32_bf16 v57, v42, v42, v57
    v_dot2_f32_bf16 v58, v46, v37, v58
    v_dot2_f32_bf16 v59, v46, v46, v59
    v_dot2_f32_bf16 v60, v50, v37, v60
    v_dot2_f32_bf16 v61, v50, v50, v61
    v_dot2_f32_bf16 v62, v54, v37, v62
    v_dot2_f32_bf16 v63, v54, v54, v63
    v_dot2_f32_bf16 v56, v43, v37, v56
    v_dot2_f32_bf16 v57, v43, v43, v57
    v_dot2_f32_bf16 v58, v47, v37, v58
    v_dot2_f32_bf16 v59, v47, v47, v59
    v_dot2_f32_bf16 v60, v51, v37, v60
    v_dot2_f32_bf16 v61, v51, v51, v61
    v_dot2_f32_bf16 v62, v55, v37, v62
    v_dot2_f32_bf16 v63, v55, v55, v63
    s_nop 2
    v_add_f32_dpp v56, v56, v56 quad_perm:[1,0,3,2] row_mask:0xf bank_mask:0xf
    v_add_f32_dpp v57, v57, v57 quad_perm:[1,0,3,2] row_mask:0xf bank_mask:0xf
    v_add_f32_dpp v58, v58, v58 quad_perm:[1,0,3,2] row_mask:0xf bank_mask:0xf
    v_add_f32_dpp v59, v59, v59 quad_perm:[1,0,3,2] row_mask:0xf bank_mask:0xf
    v_add_f32_dpp v60, v60, v60 quad_perm:[1,0,3,2] row_mask:0xf bank_mask:0xf
    v_add_f32_dpp v61, v61, v61 quad_perm:[1,0,3,2] row_mask:0xf bank_mask:0xf
    v_add_f32_dpp v62, v62, v62 quad_perm:[1,0,3,2] row_mask:0xf bank_mask:0xf
    v_add_f32_dpp v63, v63, v63 quad_perm:[1,0,3,2] row_mask:0xf bank_mask:0xf
    v_add_f32_dpp v56, v56, v56 quad_perm:[2,3,0,1] row_mask:0xf bank_mask:0xf
    v_add_f32_dpp v57, v57, v57 quad_perm:[2,3,0,1] row_mask:0xf bank_mask:0xf
    v_add_f32_dpp v58, v58, v58 quad_perm:[2,3,0,1] row_mask:0xf bank_mask:0xf
    v_add_f32_dpp v59, v59, v59 quad_perm:[2,3,0,1] row_mask:0xf bank_mask:0xf
    v_add_f32_dpp v60, v60, v60 quad_perm:[2,3,0,1] row_mask:0xf bank_mask:0xf
    v_add_f32_dpp v61, v61, v61 quad_perm:[2,3,0,1] row_mask:0xf bank_mask:0xf
    v_add_f32_dpp v62, v62, v62 quad_perm:[2,3,0,1] row_mask:0xf bank_mask:0xf
    v_add_f32_dpp v63, v63, v63 quad_perm:[2,3,0,1] row_mask:0xf bank_mask:0xf
    v_add_f32_dpp v56, v56, v56 row_half_mirror row_mask:0xf bank_mask:0xf
    v_add_f32_dpp v57, v57, v57 row_half_mirror row_mask:0xf bank_mask:0xf
    v_add_f32_dpp v58, v58, v58 row_half_mirror row_mask:0xf bank_mask:0xf
    v_add_f32_dpp v59, v59, v59 row_half_mirror row_mask:0xf bank_mask:0xf
    v_add_f32_dpp v60, v60, v60 row_half_mirror row_mask:0xf bank_mask:0xf
    v_add_f32_dpp v61, v61, v61 row_half_mirror row_mask:0xf bank_mask:0xf
    v_add_f32_dpp v62, v62, v62 row_half_mirror row_mask:0xf bank_mask:0xf
    v_add_f32_dpp v63, v63, v63 row_half_mirror row_mask:0xf bank_mask:0xf
    v_cmp_eq_u32 vcc, 1, v38
    s_nop 1
    v_cndmask_b32 v56, v56, v58, vcc
    v_cndmask_b32 v57, v57, v59, vcc
    v_cmp_eq_u32 vcc, 2, v38
    s_nop 1
    v_cndmask_b32 v56, v56, v60, vcc
    v_cndmask_b32 v57, v57, v61, vcc
    v_cmp_eq_u32 vcc, 3, v38
    s_nop 1
    v_cndmask_b32 v56, v56, v62, vcc
    v_cndmask_b32 v57, v57, v63, vcc
    s_lshl_b32 s44, s21, 18
    s_lshl_b32 s45, s38, 12
    s_add_u32 s44, s44, s45
    s_lshl_b32 s45, s18, 8
    s_add_u32 s44, s44, s45
    s_add_u32 s44, s44, 50331648
    buffer_store_dwordx2 v[56:57], v39, s[4:7], s44 offen sc1
    s_lshl_b32 s46, s21, 14
    s_lshl_b32 s67, s38, 7
    s_add_u32 s46, s46, s67
    s_add_u32 s46, s46, 4096
    s_add_u32 s47, s46, 8192
    s_lshl_b32 s48, s21, 22
    s_lshl_b32 s49, s38, 16
    s_add_u32 s41, s48, s49
    v_lshrrev_b32 v16, 4, v1
    v_and_b32 v17, 15, v16
    v_lshrrev_b32 v16, 4, v16
    s_lshl_b32 s49, s16, 7
    s_add_u32 s50, s49, 151552
    s_and_b32 s49, s21, 1
    s_lshl_b32 s49, s49, 10
    s_add_u32 s49, s49, 151552
    v_lshlrev_b32 v11, 4, v16
    v_add_u32 v13, s50, v11
    v_add_u32 v11, s49, v11
    v_lshlrev_b32 v15, 2, v17
    v_add_u32 v9, s50, v15
    v_add_u32 v15, s49, v15
    s_lshr_b32 s49, s21, 1
    s_lshl_b32 s53, s49, 23
    s_lshl_b32 s50, s18, 18
    s_add_u32 s53, s53, s50
    s_add_u32 s53, s53, 33554432
    s_lshl_b32 s54, s38, 11
    s_add_u32 s52, s53, s54
    s_lshl_b32 s59, s49, 13
    s_lshl_b32 s67, s18, 9
    s_add_u32 s59, s59, s67
    s_lshl_b32 s67, s16, 7
    s_add_u32 s59, s59, s67
    s_add_u32 s59, s59, 69632
    s_lshl_b32 s61, s49, 15
    s_lshl_b32 s67, s17, 11
    s_add_u32 s61, s61, s67
    s_lshl_b32 s67, s18, 7
    s_add_u32 s61, s61, s67
    s_add_u32 s61, s61, 151552
    s_sub_u32 s60, s61, 151552
    s_lshl_b32 s60, s60, 5
    s_add_u32 s60, s60, 54525952
    s_lshl_b32 s62, s16, 12
    s_add_u32 s62, s62, 131072
    v_bfe_u32 v80, v8, 3, 1
    v_and_b32 v81, 7, v8
    v_lshrrev_b32 v82, 5, v8
    v_lshlrev_b32 v82, 1, v82
    v_xor_b32 v82, v82, v81
    v_xor_b32 v82, v82, v80
    v_lshlrev_b32 v82, 4, v82
    v_lshl_add_u32 v82, v81, 7, v82
    v_lshl_add_u32 v82, v80, 10, v82
    v_bfe_u32 v80, v8, 4, 1
    v_lshl_add_u32 v82, v80, 3, v82
    v_add_u32 v20, s76, v82
    v_xor_b32 v21, 16, v20
    v_xor_b32 v22, 64, v20
    v_xor_b32 v23, 80, v20
    v_add_u32 v80, s62, v2
    ds_read_b128 v[160:163], v80 offset:0
    ds_read_b128 v[164:167], v80 offset:256
    ds_read_b128 v[168:171], v80 offset:2048
    ds_read_b128 v[172:175], v80 offset:2304
    s_mov_b64 vcc, -1
    s_mov_b32 s48, 1
    s_or_b32 s20, s19, 0x80000000
    s_barrier
    ds_read_b64_tr_b16 v[32:33], v3 offset:0
    ds_read_b64_tr_b16 v[34:35], v3 offset:1024
    ds_read_b64_tr_b16 v[36:37], v4 offset:0
    ds_read_b64_tr_b16 v[38:39], v4 offset:1024
    ds_read_b64_tr_b16 v[40:41], v5 offset:0
    ds_read_b64_tr_b16 v[42:43], v5 offset:1024
    ds_read_b64_tr_b16 v[44:45], v6 offset:0
    ds_read_b64_tr_b16 v[46:47], v6 offset:1024
    ds_read_b64_tr_b16 v[48:49], v3 offset:4096
    ds_read_b64_tr_b16 v[50:51], v3 offset:5120
    ds_read_b64_tr_b16 v[52:53], v4 offset:4096
    ds_read_b64_tr_b16 v[54:55], v4 offset:5120
    ds_read_b64_tr_b16 v[56:57], v5 offset:4096
    ds_read_b64_tr_b16 v[58:59], v5 offset:5120
    s_branch c_g0
c_st1:
    s_waitcnt vmcnt(1)
    ds_read_b64 v[176:177], v20 offset:4096
    ds_read_b64 v[178:179], v21 offset:4096
    ds_read_b64 v[180:181], v20 offset:6144
    ds_read_b64 v[182:183], v21 offset:6144
    ds_read_b64 v[184:185], v22 offset:4096
    ds_read_b64 v[186:187], v23 offset:4096
    ds_read_b64 v[188:189], v22 offset:6144
    ds_read_b64 v[190:191], v23 offset:6144
    ds_read_b64 v[192:193], v20 offset:8192
    ds_read_b64 v[194:195], v21 offset:8192
    ds_read_b64 v[196:197], v20 offset:10240
    ds_read_b64 v[198:199], v21 offset:10240
    ds_read_b64 v[200:201], v22 offset:8192
    ds_read_b64 v[202:203], v23 offset:8192
    ds_read_b64 v[204:205], v22 offset:10240
    ds_read_b64 v[206:207], v23 offset:10240
    ds_read_b64 v[208:209], v20 offset:12288
    ds_read_b64 v[210:211], v21 offset:12288
    ds_read_b64 v[212:213], v20 offset:14336
    ds_read_b64 v[214:215], v21 offset:14336
    ds_read_b64 v[216:217], v22 offset:12288
    ds_read_b64 v[218:219], v23 offset:12288
    ds_read_b64 v[220:221], v22 offset:14336
    ds_read_b64 v[222:223], v23 offset:14336
    ds_read_b64 v[224:225], v20 offset:16384
    ds_read_b64 v[226:227], v21 offset:16384
    ds_read_b64 v[228:229], v20 offset:18432
    ds_read_b64 v[230:231], v21 offset:18432
    ds_read_b64 v[232:233], v22 offset:16384
    ds_read_b64 v[234:235], v23 offset:16384
    ds_read_b64 v[236:237], v22 offset:18432
    ds_read_b64 v[238:239], v23 offset:18432
    s_load_dword s68, s[34:35], 0
    s_mov_b32 s8, s34
    s_mov_b32 s9, s35
    s_mov_b32 s10, 256
    s_mov_b32 s11, 0x00020000
    s_mov_b32 s66, 0x10000
    v_mov_b32 v16, 0
    s_waitcnt lgkmcnt(0)
c_f0:
    s_cmp_eq_u32 s68, 10
    s_cbranch_scc1 c_f0_ok
    buffer_load_dword v17, v16, s[8:11], 0 offen offset:0 sc1
    s_waitcnt vmcnt(0)
    v_readfirstlane_b32 s68, v17
    s_sub_u32 s66, s66, 1
    s_cmp_lg_u32 s66, 0
    s_cbranch_scc1 c_f0
c_f0_ok:
    s_atomic_add s63, s[22:23], s46
    s_branch c_st2
c_cs1:
    s_waitcnt vmcnt(0)
    s_atomic_add s40, s[22:23], s47
    s_branch c_cs2
c_layer:
    s_mov_b64 vcc, 0
c_early2:
    s_barrier
    ds_read_b64_tr_b16 v[32:33], v3 offset:0
    ds_read_b64_tr_b16 v[34:35], v3 offset:1024
    ds_read_b64_tr_b16 v[36:37], v4 offset:0
    ds_read_b64_tr_b16 v[38:39], v4 offset:1024
    ds_read_b64_tr_b16 v[40:41], v5 offset:0
    ds_read_b64_tr_b16 v[42:43], v5 offset:1024
    ds_read_b64_tr_b16 v[44:45], v6 offset:0
    ds_read_b64_tr_b16 v[46:47], v6 offset:1024
    ds_read_b64_tr_b16 v[48:49], v3 offset:4096
    ds_read_b64_tr_b16 v[50:51], v3 offset:5120
    ds_read_b64_tr_b16 v[52:53], v4 offset:4096
    ds_read_b64_tr_b16 v[54:55], v4 offset:5120
    ds_read_b64_tr_b16 v[56:57], v5 offset:4096
    ds_read_b64_tr_b16 v[58:59], v5 offset:5120
c_g0:
    s_waitcnt lgkmcnt(10)
    v_mfma_f32_16x16x32_bf16 v[64:67], v[32:35], v[160:163], 0
    ds_read_b64_tr_b16 v[60:61], v6 offset:4096
    v_mfma_f32_16x16x32_bf16 v[68:71], v[32:35], v[164:167], 0
    ds_read_b64_tr_b16 v[62:63], v6 offset:5120
    v_mfma_f32_16x16x32_bf16 v[72:75], v[36:39], v[160:163], 0
    ds_read_b64_tr_b16 v[32:33], v3 offset:8192
    v_mfma_f32_16x16x32_bf16 v[76:79], v[36:39], v[164:167], 0
    ds_read_b64_tr_b16 v[34:35], v3 offset:9216
    s_waitcnt lgkmcnt(10)
    v_mfma_f32_16x16x32_bf16 v[80:83], v[40:43], v[160:163], 0
    ds_read_b64_tr_b16 v[36:37], v4 offset:8192
    v_mfma_f32_16x16x32_bf16 v[84:87], v[40:43], v[164:167], 0
    ds_read_b64_tr_b16 v[38:39], v4 offset:9216
    v_mfma_f32_16x16x32_bf16 v[88:91], v[44:47], v[160:163], 0
    ds_read_b64_tr_b16 v[40:41], v5 offset:8192
    v_mfma_f32_16x16x32_bf16 v[92:95], v[44:47], v[164:167], 0
    ds_read_b64_tr_b16 v[42:43], v5 offset:9216
    s_waitcnt lgkmcnt(10)
    v_mfma_f32_16x16x32_bf16 v[96:99], v[160:163], v[48:51], 0
    ds_read_b64_tr_b16 v[44:45], v6 offset:8192
    v_mfma_f32_16x16x32_bf16 v[100:103], v[164:167], v[48:51], 0
    ds_read_b64_tr_b16 v[46:47], v6 offset:9216
    v_mfma_f32_16x16x32_bf16 v[104:107], v[160:163], v[52:55], 0
    ds_read_b64_tr_b16 v[48:49], v3 offset:12288
    v_mfma_f32_16x16x32_bf16 v[108:111], v[164:167], v[52:55], 0
    ds_read_b64_tr_b16 v[50:51], v3 offset:13312
    s_waitcnt lgkmcnt(10)
    v_mfma_f32_16x16x32_bf16 v[112:115], v[160:163], v[56:59], 0
    ds_read_b64_tr_b16 v[52:53], v4 offset:12288
    v_mfma_f32_16x16x32_bf16 v[116:119], v[164:167], v[56:59], 0
    ds_read_b64_tr_b16 v[54:55], v4 offset:13312
    v_mfma_f32_16x16x32_bf16 v[120:123], v[160:163], v[60:63], 0
    ds_read_b64_tr_b16 v[56:57], v5 offset:12288
    v_mfma_f32_16x16x32_bf16 v[124:127], v[164:167], v[60:63], 0
    ds_read_b64_tr_b16 v[58:59], v5 offset:13312
    s_cmp_lg_u32 s48, 0
    s_cbranch_scc1 c_gate
    s_mov_b32 s66, 0x10000
    s_waitcnt lgkmcnt(0)
    s_and_b32 s68, s68, s19
    s_cmp_eq_u32 s68, s19
    s_cbranch_scc1 c_x_ok
c_x_poll:
    s_mov_b32 s68, 0
    s_atomic_add s68, s[22:23], s46 offset:0 glc
    s_sub_u32 s66, s66, 1
    s_cselect_b32 s67, s19, 0
    s_waitcnt lgkmcnt(0)
    s_and_b32 s68, s68, s19
    s_max_u32 s68, s68, s67
    s_cmp_lt_u32 s68, s19
    s_cbranch_scc1 c_x_poll
c_x_ok:
    s_add_u32 s42, s41, s85
    buffer_load_dwordx4 v[176:179], v2, s[4:7], s42 offen offset:0 sc1
    buffer_load_dwordx4 v[180:183], v2, s[4:7], s42 offen offset:256 sc1
    buffer_load_dwordx4 v[184:187], v2, s[4:7], s42 offen offset:2048 sc1
    buffer_load_dwordx4 v[188:191], v2, s[4:7], s42 offen offset:2304 sc1
    s_add_u32 s42, s41, s86
    buffer_load_dwordx4 v[192:195], v2, s[4:7], s42 offen offset:0 sc1
    buffer_load_dwordx4 v[196:199], v2, s[4:7], s42 offen offset:256 sc1
    buffer_load_dwordx4 v[200:203], v2, s[4:7], s42 offen offset:2048 sc1
    buffer_load_dwordx4 v[204:207], v2, s[4:7], s42 offen offset:2304 sc1
    s_add_u32 s42, s41, s87
    buffer_load_dwordx4 v[208:211], v2, s[4:7], s42 offen offset:0 sc1
    buffer_load_dwordx4 v[212:215], v2, s[4:7], s42 offen offset:256 sc1
    s_waitcnt vmcnt(10)
    s_atomic_add s40, s[22:23], s47
c_gate:
    s_waitcnt lgkmcnt(10)
    v_mfma_f32_16x16x32_bf16 v[128:131], v[32:35], v[160:163], 0
    ds_read_b64_tr_b16 v[60:61], v6 offset:12288
    v_mfma_f32_16x16x32_bf16 v[132:135], v[32:35], v[164:167], 0
    ds_read_b64_tr_b16 v[62:63], v6 offset:13312
    v_mfma_f32_16x16x32_bf16 v[136:139], v[36:39], v[160:163], 0
    ds_read_b64_tr_b16 v[32:33], v3 offset:16384
    v_mfma_f32_16x16x32_bf16 v[140:143], v[36:39], v[164:167], 0
    ds_read_b64_tr_b16 v[34:35], v3 offset:17408
    s_waitcnt lgkmcnt(10)
    v_mfma_f32_16x16x32_bf16 v[144:147], v[40:43], v[160:163], 0
    ds_read_b64_tr_b16 v[36:37], v4 offset:16384
    v_mfma_f32_16x16x32_bf16 v[148:151], v[40:43], v[164:167], 0
    ds_read_b64_tr_b16 v[38:39], v4 offset:17408
    v_mfma_f32_16x16x32_bf16 v[152:155], v[44:47], v[160:163], 0
    ds_read_b64_tr_b16 v[40:41], v5 offset:16384
    v_mfma_f32_16x16x32_bf16 v[156:159], v[44:47], v[164:167], 0
    ds_read_b64_tr_b16 v[42:43], v5 offset:17408
    s_waitcnt lgkmcnt(10)
    v_mfma_f32_16x16x32_bf16 v[64:67], v[48:51], v[168:171], v[64:67]
    ds_read_b64_tr_b16 v[44:45], v6 offset:16384
    v_mfma_f32_16x16x32_bf16 v[68:71], v[48:51], v[172:175], v[68:71]
    ds_read_b64_tr_b16 v[46:47], v6 offset:17408
    v_mfma_f32_16x16x32_bf16 v[72:75], v[52:55], v[168:171], v[72:75]
    ds_read_b64_tr_b16 v[48:49], v3 offset:20480
    v_mfma_f32_16x16x32_bf16 v[76:79], v[52:55], v[172:175], v[76:79]
    ds_read_b64_tr_b16 v[50:51], v3 offset:21504
    s_waitcnt lgkmcnt(10)
    v_mfma_f32_16x16x32_bf16 v[80:83], v[56:59], v[168:171], v[80:83]
    ds_read_b64_tr_b16 v[52:53], v4 offset:20480
    v_mfma_f32_16x16x32_bf16 v[84:87], v[56:59], v[172:175], v[84:87]
    ds_read_b64_tr_b16 v[54:55], v4 offset:21504
    v_mfma_f32_16x16x32_bf16 v[88:91], v[60:63], v[168:171], v[88:91]
    ds_read_b64_tr_b16 v[56:57], v5 offset:20480
    v_mfma_f32_16x16x32_bf16 v[92:95], v[60:63], v[172:175], v[92:95]
    ds_read_b64_tr_b16 v[58:59], v5 offset:21504
    s_waitcnt lgkmcnt(10)
    v_mfma_f32_16x16x32_bf16 v[96:99], v[168:171], v[32:35], v[96:99]
    ds_read_b64_tr_b16 v[60:61], v6 offset:20480
    v_mfma_f32_16x16x32_bf16 v[100:103], v[172:175], v[32:35], v[100:103]
    ds_read_b64_tr_b16 v[62:63], v6 offset:21504
    v_mfma_f32_16x16x32_bf16 v[104:107], v[168:171], v[36:39], v[104:107]
    ds_read_b64_tr_b16 v[32:33], v3 offset:24576
    v_mfma_f32_16x16x32_bf16 v[108:111], v[172:175], v[36:39], v[108:111]
    ds_read_b64_tr_b16 v[34:35], v3 offset:25600
    s_waitcnt lgkmcnt(10)
    v_mfma_f32_16x16x32_bf16 v[112:115], v[168:171], v[40:43], v[112:115]
    ds_read_b64_tr_b16 v[36:37], v4 offset:24576
    v_mfma_f32_16x16x32_bf16 v[116:119], v[172:175], v[40:43], v[116:119]
    ds_read_b64_tr_b16 v[38:39], v4 offset:25600
    v_mfma_f32_16x16x32_bf16 v[120:123], v[168:171], v[44:47], v[120:123]
    ds_read_b64_tr_b16 v[40:41], v5 offset:24576
    v_mfma_f32_16x16x32_bf16 v[124:127], v[172:175], v[44:47], v[124:127]
    ds_read_b64_tr_b16 v[42:43], v5 offset:25600
    s_waitcnt lgkmcnt(10)
    v_mfma_f32_16x16x32_bf16 v[128:131], v[48:51], v[168:171], v[128:131]
    ds_read_b64_tr_b16 v[44:45], v6 offset:24576
    v_mfma_f32_16x16x32_bf16 v[132:135], v[48:51], v[172:175], v[132:135]
    ds_read_b64_tr_b16 v[46:47], v6 offset:25600
    v_mfma_f32_16x16x32_bf16 v[136:139], v[52:55], v[168:171], v[136:139]
    ds_read_b64_tr_b16 v[48:49], v3 offset:28672
    v_mfma_f32_16x16x32_bf16 v[140:143], v[52:55], v[172:175], v[140:143]
    ds_read_b64_tr_b16 v[50:51], v3 offset:29696
    s_waitcnt lgkmcnt(10)
    v_mfma_f32_16x16x32_bf16 v[144:147], v[56:59], v[168:171], v[144:147]
    ds_read_b64_tr_b16 v[52:53], v4 offset:28672
    v_mfma_f32_16x16x32_bf16 v[148:151], v[56:59], v[172:175], v[148:151]
    ds_read_b64_tr_b16 v[54:55], v4 offset:29696
    v_mfma_f32_16x16x32_bf16 v[152:155], v[60:63], v[168:171], v[152:155]
    ds_read_b64_tr_b16 v[56:57], v5 offset:28672
    v_mfma_f32_16x16x32_bf16 v[156:159], v[60:63], v[172:175], v[156:159]
    ds_read_b64_tr_b16 v[58:59], v5 offset:29696
    s_cbranch_vccnz c_st1
c_st2:
    s_waitcnt vmcnt(8) lgkmcnt(10)
    v_mfma_f32_16x16x32_bf16 v[64:67], v[32:35], v[176:179], v[64:67]
    ds_read_b64_tr_b16 v[60:61], v6 offset:28672
    v_mfma_f32_16x16x32_bf16 v[68:71], v[32:35], v[180:183], v[68:71]
    ds_read_b64_tr_b16 v[62:63], v6 offset:29696
    s_barrier
    v_mfma_f32_16x16x32_bf16 v[72:75], v[36:39], v[176:179], v[72:75]
    ds_read_b64_tr_b16 v[32:33], v3 offset:32768
    v_mfma_f32_16x16x32_bf16 v[76:79], v[36:39], v[180:183], v[76:79]
    ds_read_b64_tr_b16 v[34:35], v3 offset:33792
    s_waitcnt lgkmcnt(10)
    v_mfma_f32_16x16x32_bf16 v[80:83], v[40:43], v[176:179], v[80:83]
    ds_read_b64_tr_b16 v[36:37], v4 offset:32768
    v_mfma_f32_16x16x32_bf16 v[84:87], v[40:43], v[180:183], v[84:87]
    ds_read_b64_tr_b16 v[38:39], v4 offset:33792
    v_mfma_f32_16x16x32_bf16 v[88:91], v[44:47], v[176:179], v[88:91]
    ds_read_b64_tr_b16 v[40:41], v5 offset:32768
    v_mfma_f32_16x16x32_bf16 v[92:95], v[44:47], v[180:183], v[92:95]
    ds_read_b64_tr_b16 v[42:43], v5 offset:33792
    s_waitcnt lgkmcnt(10)
    v_mfma_f32_16x16x32_bf16 v[96:99], v[176:179], v[48:51], v[96:99]
    ds_read_b64_tr_b16 v[44:45], v6 offset:32768
    v_mfma_f32_16x16x32_bf16 v[100:103], v[180:183], v[48:51], v[100:103]
    ds_read_b64_tr_b16 v[46:47], v6 offset:33792
    v_mfma_f32_16x16x32_bf16 v[104:107], v[176:179], v[52:55], v[104:107]
    ds_read_b64_tr_b16 v[48:49], v3 offset:36864
    v_mfma_f32_16x16x32_bf16 v[108:111], v[180:183], v[52:55], v[108:111]
    ds_read_b64_tr_b16 v[50:51], v3 offset:37888
    s_waitcnt lgkmcnt(10)
    v_mfma_f32_16x16x32_bf16 v[112:115], v[176:179], v[56:59], v[112:115]
    ds_read_b64_tr_b16 v[52:53], v4 offset:36864
    v_mfma_f32_16x16x32_bf16 v[116:119], v[180:183], v[56:59], v[116:119]
    ds_read_b64_tr_b16 v[54:55], v4 offset:37888
    v_mfma_f32_16x16x32_bf16 v[120:123], v[176:179], v[60:63], v[120:123]
    ds_read_b64_tr_b16 v[56:57], v5 offset:36864
    v_mfma_f32_16x16x32_bf16 v[124:127], v[180:183], v[60:63], v[124:127]
    ds_read_b64_tr_b16 v[58:59], v5 offset:37888
    s_waitcnt lgkmcnt(10)
    v_mfma_f32_16x16x32_bf16 v[128:131], v[32:35], v[176:179], v[128:131]
    ds_read_b64_tr_b16 v[60:61], v6 offset:36864
    v_mfma_f32_16x16x32_bf16 v[132:135], v[32:35], v[180:183], v[132:135]
    ds_read_b64_tr_b16 v[62:63], v6 offset:37888
    v_mfma_f32_16x16x32_bf16 v[136:139], v[36:39], v[176:179], v[136:139]
    ds_read_b64_tr_b16 v[32:33], v3 offset:40960
    v_mfma_f32_16x16x32_bf16 v[140:143], v[36:39], v[180:183], v[140:143]
    ds_read_b64_tr_b16 v[34:35], v3 offset:41984
    s_waitcnt lgkmcnt(10)
    v_mfma_f32_16x16x32_bf16 v[144:147], v[40:43], v[176:179], v[144:147]
    ds_read_b64_tr_b16 v[36:37], v4 offset:40960
    v_mfma_f32_16x16x32_bf16 v[148:151], v[40:43], v[180:183], v[148:151]
    ds_read_b64_tr_b16 v[38:39], v4 offset:41984
    v_mfma_f32_16x16x32_bf16 v[152:155], v[44:47], v[176:179], v[152:155]
    ds_read_b64_tr_b16 v[40:41], v5 offset:40960
    v_mfma_f32_16x16x32_bf16 v[156:159], v[44:47], v[180:183], v[156:159]
    ds_read_b64_tr_b16 v[42:43], v5 offset:41984
    s_waitcnt vmcnt(6) lgkmcnt(10)
    v_mfma_f32_16x16x32_bf16 v[64:67], v[48:51], v[184:187], v[64:67]
    s_add_u32 s42, s41, s87
    s_cbranch_vccnz xs1
    buffer_load_dwordx4 v[216:219], v2, s[4:7], s42 offen offset:2048 sc1
xs1:
    ds_read_b64_tr_b16 v[44:45], v6 offset:40960
    v_mfma_f32_16x16x32_bf16 v[68:71], v[48:51], v[188:191], v[68:71]
    ds_read_b64_tr_b16 v[46:47], v6 offset:41984
    v_mfma_f32_16x16x32_bf16 v[72:75], v[52:55], v[184:187], v[72:75]
    s_cbranch_vccnz xs2
    buffer_load_dwordx4 v[220:223], v2, s[4:7], s42 offen offset:2304 sc1
xs2:
    ds_read_b64_tr_b16 v[48:49], v3 offset:45056
    s_add_u32 s42, s41, s88
    v_mfma_f32_16x16x32_bf16 v[76:79], v[52:55], v[188:191], v[76:79]
    ds_read_b64_tr_b16 v[50:51], v3 offset:46080
    s_waitcnt lgkmcnt(10)
    v_mfma_f32_16x16x32_bf16 v[80:83], v[56:59], v[184:187], v[80:83]
    s_cbranch_vccnz xs3
    buffer_load_dwordx4 v[224:227], v2, s[4:7], s42 offen offset:0 sc1
xs3:
    ds_read_b64_tr_b16 v[52:53], v4 offset:45056
    v_mfma_f32_16x16x32_bf16 v[84:87], v[56:59], v[188:191], v[84:87]
    ds_read_b64_tr_b16 v[54:55], v4 offset:46080
    v_mfma_f32_16x16x32_bf16 v[88:91], v[60:63], v[184:187], v[88:91]
    s_cbranch_vccnz xs4
    buffer_load_dwordx4 v[228:231], v2, s[4:7], s42 offen offset:256 sc1
xs4:
    ds_read_b64_tr_b16 v[56:57], v5 offset:45056
    v_mfma_f32_16x16x32_bf16 v[92:95], v[60:63], v[188:191], v[92:95]
    ds_read_b64_tr_b16 v[58:59], v5 offset:46080
    s_waitcnt lgkmcnt(10)
    v_mfma_f32_16x16x32_bf16 v[96:99], v[184:187], v[32:35], v[96:99]
    ds_read_b64_tr_b16 v[60:61], v6 offset:45056
    s_cbranch_vccnz xs5
    buffer_load_dwordx4 v[232:235], v2, s[4:7], s42 offen offset:2048 sc1
xs5:
    s_cbranch_vccnz c_cs1
c_cs2:
    v_mfma_f32_16x16x32_bf16 v[100:103], v[188:191], v[32:35], v[100:103]
    ds_read_b64_tr_b16 v[62:63], v6 offset:46080
    v_mfma_f32_16x16x32_bf16 v[104:107], v[184:187], v[36:39], v[104:107]
    s_cbranch_vccnz xs6
    buffer_load_dwordx4 v[236:239], v2, s[4:7], s42 offen offset:2304 sc1
xs6:
    ds_read_b64_tr_b16 v[32:33], v3 offset:49152
    s_add_u32 s42, s41, s89
    v_mfma_f32_16x16x32_bf16 v[108:111], v[188:191], v[36:39], v[108:111]
    ds_read_b64_tr_b16 v[34:35], v3 offset:50176
    s_waitcnt lgkmcnt(10)
    v_mfma_f32_16x16x32_bf16 v[112:115], v[184:187], v[40:43], v[112:115]
    ds_read_b64_tr_b16 v[36:37], v4 offset:49152
    v_mfma_f32_16x16x32_bf16 v[116:119], v[188:191], v[40:43], v[116:119]
    ds_read_b64_tr_b16 v[38:39], v4 offset:50176
    v_mfma_f32_16x16x32_bf16 v[120:123], v[184:187], v[44:47], v[120:123]
    ds_read_b64_tr_b16 v[40:41], v5 offset:49152
    v_mfma_f32_16x16x32_bf16 v[124:127], v[188:191], v[44:47], v[124:127]
    ds_read_b64_tr_b16 v[42:43], v5 offset:50176
    s_waitcnt lgkmcnt(10)
    v_mfma_f32_16x16x32_bf16 v[128:131], v[48:51], v[184:187], v[128:131]
    ds_read_b64_tr_b16 v[44:45], v6 offset:49152
    v_mfma_f32_16x16x32_bf16 v[132:135], v[48:51], v[188:191], v[132:135]
    ds_read_b64_tr_b16 v[46:47], v6 offset:50176
    v_mfma_f32_16x16x32_bf16 v[136:139], v[52:55], v[184:187], v[136:139]
    ds_read_b64_tr_b16 v[48:49], v3 offset:53248
    v_mfma_f32_16x16x32_bf16 v[140:143], v[52:55], v[188:191], v[140:143]
    ds_read_b64_tr_b16 v[50:51], v3 offset:54272
    s_waitcnt lgkmcnt(10)
    v_mfma_f32_16x16x32_bf16 v[144:147], v[56:59], v[184:187], v[144:147]
    ds_read_b64_tr_b16 v[52:53], v4 offset:53248
    v_mfma_f32_16x16x32_bf16 v[148:151], v[56:59], v[188:191], v[148:151]
    ds_read_b64_tr_b16 v[54:55], v4 offset:54272
    v_mfma_f32_16x16x32_bf16 v[152:155], v[60:63], v[184:187], v[152:155]
    ds_read_b64_tr_b16 v[56:57], v5 offset:53248
    v_mfma_f32_16x16x32_bf16 v[156:159], v[60:63], v[188:191], v[156:159]
    ds_read_b64_tr_b16 v[58:59], v5 offset:54272
    s_waitcnt vmcnt(10) lgkmcnt(10)
    v_mfma_f32_16x16x32_bf16 v[64:67], v[32:35], v[192:195], v[64:67]
    ds_read_b64_tr_b16 v[60:61], v6 offset:53248
    v_mfma_f32_16x16x32_bf16 v[68:71], v[32:35], v[196:199], v[68:71]
    ds_read_b64_tr_b16 v[62:63], v6 offset:54272
    v_mfma_f32_16x16x32_bf16 v[72:75], v[36:39], v[192:195], v[72:75]
    ds_read_b64_tr_b16 v[32:33], v3 offset:57344
    v_mfma_f32_16x16x32_bf16 v[76:79], v[36:39], v[196:199], v[76:79]
    ds_read_b64_tr_b16 v[34:35], v3 offset:58368
    s_waitcnt lgkmcnt(10)
    v_mfma_f32_16x16x32_bf16 v[80:83], v[40:43], v[192:195], v[80:83]
    ds_read_b64_tr_b16 v[36:37], v4 offset:57344
    v_mfma_f32_16x16x32_bf16 v[84:87], v[40:43], v[196:199], v[84:87]
    ds_read_b64_tr_b16 v[38:39], v4 offset:58368
    v_mfma_f32_16x16x32_bf16 v[88:91], v[44:47], v[192:195], v[88:91]
    ds_read_b64_tr_b16 v[40:41], v5 offset:57344
    v_mfma_f32_16x16x32_bf16 v[92:95], v[44:47], v[196:199], v[92:95]
    ds_read_b64_tr_b16 v[42:43], v5 offset:58368
    s_waitcnt lgkmcnt(10)
    v_mfma_f32_16x16x32_bf16 v[96:99], v[192:195], v[48:51], v[96:99]
    ds_read_b64_tr_b16 v[44:45], v6 offset:57344
    v_mfma_f32_16x16x32_bf16 v[100:103], v[196:199], v[48:51], v[100:103]
    ds_read_b64_tr_b16 v[46:47], v6 offset:58368
    v_mfma_f32_16x16x32_bf16 v[104:107], v[192:195], v[52:55], v[104:107]
    ds_read_b64_tr_b16 v[48:49], v3 offset:61440
    v_mfma_f32_16x16x32_bf16 v[108:111], v[196:199], v[52:55], v[108:111]
    ds_read_b64_tr_b16 v[50:51], v3 offset:62464
    s_waitcnt lgkmcnt(10)
    v_mfma_f32_16x16x32_bf16 v[112:115], v[192:195], v[56:59], v[112:115]
    ds_read_b64_tr_b16 v[52:53], v4 offset:61440
    v_mfma_f32_16x16x32_bf16 v[116:119], v[196:199], v[56:59], v[116:119]
    ds_read_b64_tr_b16 v[54:55], v4 offset:62464
    v_mfma_f32_16x16x32_bf16 v[120:123], v[192:195], v[60:63], v[120:123]
    ds_read_b64_tr_b16 v[56:57], v5 offset:61440
    v_mfma_f32_16x16x32_bf16 v[124:127], v[196:199], v[60:63], v[124:127]
    ds_read_b64_tr_b16 v[58:59], v5 offset:62464
    s_waitcnt lgkmcnt(10)
    v_mfma_f32_16x16x32_bf16 v[128:131], v[32:35], v[192:195], v[128:131]
    ds_read_b64_tr_b16 v[60:61], v6 offset:61440
    v_mfma_f32_16x16x32_bf16 v[132:135], v[32:35], v[196:199], v[132:135]
    ds_read_b64_tr_b16 v[62:63], v6 offset:62464
    s_barrier
    v_xor_b32 v3, 0x10000, v3
    v_xor_b32 v4, 0x10000, v4
    v_xor_b32 v5, 0x10000, v5
    v_xor_b32 v6, 0x10000, v6
    v_mfma_f32_16x16x32_bf16 v[136:139], v[36:39], v[192:195], v[136:139]
    ds_read_b64_tr_b16 v[32:33], v3 offset:0
    v_mfma_f32_16x16x32_bf16 v[140:143], v[36:39], v[196:199], v[140:143]
    ds_read_b64_tr_b16 v[34:35], v3 offset:1024
    s_waitcnt lgkmcnt(10)
    v_mfma_f32_16x16x32_bf16 v[144:147], v[40:43], v[192:195], v[144:147]
    ds_read_b64_tr_b16 v[36:37], v4 offset:0
    v_mfma_f32_16x16x32_bf16 v[148:151], v[40:43], v[196:199], v[148:151]
    ds_read_b64_tr_b16 v[38:39], v4 offset:1024
    v_mfma_f32_16x16x32_bf16 v[152:155], v[44:47], v[192:195], v[152:155]
    ds_read_b64_tr_b16 v[40:41], v5 offset:0
    v_mfma_f32_16x16x32_bf16 v[156:159], v[44:47], v[196:199], v[156:159]
    ds_read_b64_tr_b16 v[42:43], v5 offset:1024
    s_waitcnt vmcnt(8) lgkmcnt(10)
    v_mfma_f32_16x16x32_bf16 v[64:67], v[48:51], v[200:203], v[64:67]
    ds_read_b64_tr_b16 v[44:45], v6 offset:0
    v_mfma_f32_16x16x32_bf16 v[68:71], v[48:51], v[204:207], v[68:71]
    ds_read_b64_tr_b16 v[46:47], v6 offset:1024
    v_mfma_f32_16x16x32_bf16 v[72:75], v[52:55], v[200:203], v[72:75]
    ds_read_b64_tr_b16 v[48:49], v3 offset:4096
    v_mfma_f32_16x16x32_bf16 v[76:79], v[52:55], v[204:207], v[76:79]
    ds_read_b64_tr_b16 v[50:51], v3 offset:5120
    s_waitcnt lgkmcnt(10)
    v_mfma_f32_16x16x32_bf16 v[80:83], v[56:59], v[200:203], v[80:83]
    ds_read_b64_tr_b16 v[52:53], v4 offset:4096
    v_mfma_f32_16x16x32_bf16 v[84:87], v[56:59], v[204:207], v[84:87]
    ds_read_b64_tr_b16 v[54:55], v4 offset:5120
    v_mfma_f32_16x16x32_bf16 v[88:91], v[60:63], v[200:203], v[88:91]
    ds_read_b64_tr_b16 v[56:57], v5 offset:4096
    v_mfma_f32_16x16x32_bf16 v[92:95], v[60:63], v[204:207], v[92:95]
    ds_read_b64_tr_b16 v[58:59], v5 offset:5120
    s_waitcnt lgkmcnt(10)
    v_mfma_f32_16x16x32_bf16 v[96:99], v[200:203], v[32:35], v[96:99]
    ds_read_b64_tr_b16 v[60:61], v6 offset:4096
    v_mfma_f32_16x16x32_bf16 v[100:103], v[204:207], v[32:35], v[100:103]
    ds_read_b64_tr_b16 v[62:63], v6 offset:5120
    v_mfma_f32_16x16x32_bf16 v[104:107], v[200:203], v[36:39], v[104:107]
    ds_read_b64_tr_b16 v[32:33], v3 offset:8192
    v_mfma_f32_16x16x32_bf16 v[108:111], v[204:207], v[36:39], v[108:111]
    ds_read_b64_tr_b16 v[34:35], v3 offset:9216
    s_waitcnt lgkmcnt(10)
    v_mfma_f32_16x16x32_bf16 v[112:115], v[200:203], v[40:43], v[112:115]
    ds_read_b64_tr_b16 v[36:37], v4 offset:8192
    v_mfma_f32_16x16x32_bf16 v[116:119], v[204:207], v[40:43], v[116:119]
    ds_read_b64_tr_b16 v[38:39], v4 offset:9216
    v_mfma_f32_16x16x32_bf16 v[120:123], v[200:203], v[44:47], v[120:123]
    ds_read_b64_tr_b16 v[40:41], v5 offset:8192
    v_mfma_f32_16x16x32_bf16 v[124:127], v[204:207], v[44:47], v[124:127]
    ds_read_b64_tr_b16 v[42:43], v5 offset:9216
    s_waitcnt lgkmcnt(10)
    v_mfma_f32_16x16x32_bf16 v[128:131], v[48:51], v[200:203], v[128:131]
    ds_read_b64_tr_b16 v[44:45], v6 offset:8192
    v_mfma_f32_16x16x32_bf16 v[132:135], v[48:51], v[204:207], v[132:135]
    ds_read_b64_tr_b16 v[46:47], v6 offset:9216
    v_mfma_f32_16x16x32_bf16 v[136:139], v[52:55], v[200:203], v[136:139]
    ds_read_b64_tr_b16 v[48:49], v3 offset:12288
    v_mfma_f32_16x16x32_bf16 v[140:143], v[52:55], v[204:207], v[140:143]
    ds_read_b64_tr_b16 v[50:51], v3 offset:13312
    s_waitcnt lgkmcnt(10)
    v_mfma_f32_16x16x32_bf16 v[144:147], v[56:59], v[200:203], v[144:147]
    ds_read_b64_tr_b16 v[52:53], v4 offset:12288
    v_mfma_f32_16x16x32_bf16 v[148:151], v[56:59], v[204:207], v[148:151]
    ds_read_b64_tr_b16 v[54:55], v4 offset:13312
    v_mfma_f32_16x16x32_bf16 v[152:155], v[60:63], v[200:203], v[152:155]
    ds_read_b64_tr_b16 v[56:57], v5 offset:12288
    v_mfma_f32_16x16x32_bf16 v[156:159], v[60:63], v[204:207], v[156:159]
    ds_read_b64_tr_b16 v[58:59], v5 offset:13312
    s_waitcnt vmcnt(6) lgkmcnt(10)
    v_mfma_f32_16x16x32_bf16 v[64:67], v[32:35], v[208:211], v[64:67]
    ds_read_b64_tr_b16 v[60:61], v6 offset:12288
    v_mfma_f32_16x16x32_bf16 v[68:71], v[32:35], v[212:215], v[68:71]
    ds_read_b64_tr_b16 v[62:63], v6 offset:13312
    v_mfma_f32_16x16x32_bf16 v[72:75], v[36:39], v[208:211], v[72:75]
    ds_read_b64_tr_b16 v[32:33], v3 offset:16384
    v_mfma_f32_16x16x32_bf16 v[76:79], v[36:39], v[212:215], v[76:79]
    ds_read_b64_tr_b16 v[34:35], v3 offset:17408
    s_waitcnt lgkmcnt(10)
    v_mfma_f32_16x16x32_bf16 v[80:83], v[40:43], v[208:211], v[80:83]
    ds_read_b64_tr_b16 v[36:37], v4 offset:16384
    v_mfma_f32_16x16x32_bf16 v[84:87], v[40:43], v[212:215], v[84:87]
    ds_read_b64_tr_b16 v[38:39], v4 offset:17408
    v_mfma_f32_16x16x32_bf16 v[88:91], v[44:47], v[208:211], v[88:91]
    ds_read_b64_tr_b16 v[40:41], v5 offset:16384
    v_mfma_f32_16x16x32_bf16 v[92:95], v[44:47], v[212:215], v[92:95]
    ds_read_b64_tr_b16 v[42:43], v5 offset:17408
    s_waitcnt lgkmcnt(10)
    v_mfma_f32_16x16x32_bf16 v[96:99], v[208:211], v[48:51], v[96:99]
    buffer_load_dwordx4 v[240:243], v2, s[4:7], s42 offen offset:0 sc1
    ds_read_b64_tr_b16 v[44:45], v6 offset:16384
    v_mfma_f32_16x16x32_bf16 v[100:103], v[212:215], v[48:51], v[100:103]
    ds_read_b64_tr_b16 v[46:47], v6 offset:17408
    v_mfma_f32_16x16x32_bf16 v[104:107], v[208:211], v[52:55], v[104:107]
    buffer_load_dwordx4 v[244:247], v2, s[4:7], s42 offen offset:256 sc1
    ds_read_b64_tr_b16 v[48:49], v3 offset:20480
    v_mfma_f32_16x16x32_bf16 v[108:111], v[212:215], v[52:55], v[108:111]
    ds_read_b64_tr_b16 v[50:51], v3 offset:21504
    s_waitcnt lgkmcnt(10)
    v_mfma_f32_16x16x32_bf16 v[112:115], v[208:211], v[56:59], v[112:115]
    buffer_load_dwordx4 v[248:251], v2, s[4:7], s42 offen offset:2048 sc1
    ds_read_b64_tr_b16 v[52:53], v4 offset:20480
    v_mfma_f32_16x16x32_bf16 v[116:119], v[212:215], v[56:59], v[116:119]
    ds_read_b64_tr_b16 v[54:55], v4 offset:21504
    v_mfma_f32_16x16x32_bf16 v[120:123], v[208:211], v[60:63], v[120:123]
    buffer_load_dwordx4 v[252:255], v2, s[4:7], s42 offen offset:2304 sc1
    ds_read_b64_tr_b16 v[56:57], v5 offset:20480
    s_add_u32 s42, s41, s90
    v_mfma_f32_16x16x32_bf16 v[124:127], v[212:215], v[60:63], v[124:127]
    ds_read_b64_tr_b16 v[58:59], v5 offset:21504
    s_waitcnt lgkmcnt(10)
    v_mfma_f32_16x16x32_bf16 v[128:131], v[32:35], v[208:211], v[128:131]
    ds_read_b64_tr_b16 v[60:61], v6 offset:20480
    buffer_load_dwordx4 v[160:163], v2, s[4:7], s42 offen offset:0 sc1
    v_mfma_f32_16x16x32_bf16 v[132:135], v[32:35], v[212:215], v[132:135]
    ds_read_b64_tr_b16 v[62:63], v6 offset:21504
    v_mfma_f32_16x16x32_bf16 v[136:139], v[36:39], v[208:211], v[136:139]
    buffer_load_dwordx4 v[164:167], v2, s[4:7], s42 offen offset:256 sc1
    ds_read_b64_tr_b16 v[32:33], v3 offset:24576
    v_mfma_f32_16x16x32_bf16 v[140:143], v[36:39], v[212:215], v[140:143]
    ds_read_b64_tr_b16 v[34:35], v3 offset:25600
    s_waitcnt lgkmcnt(10)
    v_mfma_f32_16x16x32_bf16 v[144:147], v[40:43], v[208:211], v[144:147]
    buffer_load_dwordx4 v[168:171], v2, s[4:7], s42 offen offset:2048 sc1
    ds_read_b64_tr_b16 v[36:37], v4 offset:24576
    v_mfma_f32_16x16x32_bf16 v[148:151], v[40:43], v[212:215], v[148:151]
    ds_read_b64_tr_b16 v[38:39], v4 offset:25600
    v_mfma_f32_16x16x32_bf16 v[152:155], v[44:47], v[208:211], v[152:155]
    buffer_load_dwordx4 v[172:175], v2, s[4:7], s42 offen offset:2304 sc1
    ds_read_b64_tr_b16 v[40:41], v5 offset:24576
    s_add_u32 s42, s41, s91
    v_mfma_f32_16x16x32_bf16 v[156:159], v[44:47], v[212:215], v[156:159]
    ds_read_b64_tr_b16 v[42:43], v5 offset:25600
    s_waitcnt vmcnt(12) lgkmcnt(10)
    v_mfma_f32_16x16x32_bf16 v[64:67], v[48:51], v[216:219], v[64:67]
    buffer_load_dwordx4 v[176:179], v2, s[4:7], s42 offen offset:0 sc1
    ds_read_b64_tr_b16 v[44:45], v6 offset:24576
    v_mfma_f32_16x16x32_bf16 v[68:71], v[48:51], v[220:223], v[68:71]
    ds_read_b64_tr_b16 v[46:47], v6 offset:25600
    v_mfma_f32_16x16x32_bf16 v[72:75], v[52:55], v[216:219], v[72:75]
    buffer_load_dwordx4 v[180:183], v2, s[4:7], s42 offen offset:256 sc1
    ds_read_b64_tr_b16 v[48:49], v3 offset:28672
    v_mfma_f32_16x16x32_bf16 v[76:79], v[52:55], v[220:223], v[76:79]
    ds_read_b64_tr_b16 v[50:51], v3 offset:29696
    s_waitcnt lgkmcnt(10)
    v_mfma_f32_16x16x32_bf16 v[80:83], v[56:59], v[216:219], v[80:83]
    buffer_load_dwordx4 v[184:187], v2, s[4:7], s42 offen offset:2048 sc1
    ds_read_b64_tr_b16 v[52:53], v4 offset:28672
    v_mfma_f32_16x16x32_bf16 v[84:87], v[56:59], v[220:223], v[84:87]
    ds_read_b64_tr_b16 v[54:55], v4 offset:29696
    v_mfma_f32_16x16x32_bf16 v[88:91], v[60:63], v[216:219], v[88:91]
    buffer_load_dwordx4 v[188:191], v2, s[4:7], s42 offen offset:2304 sc1
    ds_read_b64_tr_b16 v[56:57], v5 offset:28672
    s_add_u32 s42, s41, s92
    v_mfma_f32_16x16x32_bf16 v[92:95], v[60:63], v[220:223], v[92:95]
    ds_read_b64_tr_b16 v[58:59], v5 offset:29696
    s_waitcnt lgkmcnt(10)
    v_mfma_f32_16x16x32_bf16 v[96:99], v[216:219], v[32:35], v[96:99]
    ds_read_b64_tr_b16 v[60:61], v6 offset:28672
    v_mfma_f32_16x16x32_bf16 v[100:103], v[220:223], v[32:35], v[100:103]
    ds_read_b64_tr_b16 v[62:63], v6 offset:29696
    s_barrier
    v_mfma_f32_16x16x32_bf16 v[104:107], v[216:219], v[36:39], v[104:107]
    ds_read_b64_tr_b16 v[32:33], v3 offset:32768
    v_mfma_f32_16x16x32_bf16 v[108:111], v[220:223], v[36:39], v[108:111]
    ds_read_b64_tr_b16 v[34:35], v3 offset:33792
    s_waitcnt lgkmcnt(10)
    v_mfma_f32_16x16x32_bf16 v[112:115], v[216:219], v[40:43], v[112:115]
    ds_read_b64_tr_b16 v[36:37], v4 offset:32768
    v_mfma_f32_16x16x32_bf16 v[116:119], v[220:223], v[40:43], v[116:119]
    ds_read_b64_tr_b16 v[38:39], v4 offset:33792
    v_mfma_f32_16x16x32_bf16 v[120:123], v[216:219], v[44:47], v[120:123]
    ds_read_b64_tr_b16 v[40:41], v5 offset:32768
    v_mfma_f32_16x16x32_bf16 v[124:127], v[220:223], v[44:47], v[124:127]
    ds_read_b64_tr_b16 v[42:43], v5 offset:33792
    s_waitcnt lgkmcnt(10)
    v_mfma_f32_16x16x32_bf16 v[128:131], v[48:51], v[216:219], v[128:131]
    ds_read_b64_tr_b16 v[44:45], v6 offset:32768
    v_mfma_f32_16x16x32_bf16 v[132:135], v[48:51], v[220:223], v[132:135]
    ds_read_b64_tr_b16 v[46:47], v6 offset:33792
    v_mfma_f32_16x16x32_bf16 v[136:139], v[52:55], v[216:219], v[136:139]
    ds_read_b64_tr_b16 v[48:49], v3 offset:36864
    v_mfma_f32_16x16x32_bf16 v[140:143], v[52:55], v[220:223], v[140:143]
    ds_read_b64_tr_b16 v[50:51], v3 offset:37888
    s_waitcnt lgkmcnt(10)
    v_mfma_f32_16x16x32_bf16 v[144:147], v[56:59], v[216:219], v[144:147]
    ds_read_b64_tr_b16 v[52:53], v4 offset:36864
    v_mfma_f32_16x16x32_bf16 v[148:151], v[56:59], v[220:223], v[148:151]
    ds_read_b64_tr_b16 v[54:55], v4 offset:37888
    v_mfma_f32_16x16x32_bf16 v[152:155], v[60:63], v[216:219], v[152:155]
    ds_read_b64_tr_b16 v[56:57], v5 offset:36864
    v_mfma_f32_16x16x32_bf16 v[156:159], v[60:63], v[220:223], v[156:159]
    ds_read_b64_tr_b16 v[58:59], v5 offset:37888
    s_waitcnt vmcnt(14) lgkmcnt(10)
    v_mfma_f32_16x16x32_bf16 v[64:67], v[32:35], v[224:227], v[64:67]
    ds_read_b64_tr_b16 v[60:61], v6 offset:36864
    v_mfma_f32_16x16x32_bf16 v[68:71], v[32:35], v[228:231], v[68:71]
    ds_read_b64_tr_b16 v[62:63], v6 offset:37888
    v_mfma_f32_16x16x32_bf16 v[72:75], v[36:39], v[224:227], v[72:75]
    ds_read_b64_tr_b16 v[32:33], v3 offset:40960
    v_mfma_f32_16x16x32_bf16 v[76:79], v[36:39], v[228:231], v[76:79]
    ds_read_b64_tr_b16 v[34:35], v3 offset:41984
    s_waitcnt lgkmcnt(10)
    v_mfma_f32_16x16x32_bf16 v[80:83], v[40:43], v[224:227], v[80:83]
    ds_read_b64_tr_b16 v[36:37], v4 offset:40960
    v_mfma_f32_16x16x32_bf16 v[84:87], v[40:43], v[228:231], v[84:87]
    ds_read_b64_tr_b16 v[38:39], v4 offset:41984
    v_mfma_f32_16x16x32_bf16 v[88:91], v[44:47], v[224:227], v[88:91]
    ds_read_b64_tr_b16 v[40:41], v5 offset:40960
    v_mfma_f32_16x16x32_bf16 v[92:95], v[44:47], v[228:231], v[92:95]
    ds_read_b64_tr_b16 v[42:43], v5 offset:41984
    s_waitcnt lgkmcnt(10)
    v_mfma_f32_16x16x32_bf16 v[96:99], v[224:227], v[48:51], v[96:99]
    ds_read_b64_tr_b16 v[44:45], v6 offset:40960
    v_mfma_f32_16x16x32_bf16 v[100:103], v[228:231], v[48:51], v[100:103]
    ds_read_b64_tr_b16 v[46:47], v6 offset:41984
    v_mfma_f32_16x16x32_bf16 v[104:107], v[224:227], v[52:55], v[104:107]
    ds_read_b64_tr_b16 v[48:49], v3 offset:45056
    v_mfma_f32_16x16x32_bf16 v[108:111], v[228:231], v[52:55], v[108:111]
    ds_read_b64_tr_b16 v[50:51], v3 offset:46080
    s_waitcnt lgkmcnt(10)
    v_mfma_f32_16x16x32_bf16 v[112:115], v[224:227], v[56:59], v[112:115]
    ds_read_b64_tr_b16 v[52:53], v4 offset:45056
    v_mfma_f32_16x16x32_bf16 v[116:119], v[228:231], v[56:59], v[116:119]
    ds_read_b64_tr_b16 v[54:55], v4 offset:46080
    v_mfma_f32_16x16x32_bf16 v[120:123], v[224:227], v[60:63], v[120:123]
    ds_read_b64_tr_b16 v[56:57], v5 offset:45056
    v_mfma_f32_16x16x32_bf16 v[124:127], v[228:231], v[60:63], v[124:127]
    ds_read_b64_tr_b16 v[58:59], v5 offset:46080
    s_waitcnt lgkmcnt(10)
    v_mfma_f32_16x16x32_bf16 v[128:131], v[32:35], v[224:227], v[128:131]
    ds_read_b64_tr_b16 v[60:61], v6 offset:45056
    v_mfma_f32_16x16x32_bf16 v[132:135], v[32:35], v[228:231], v[132:135]
    ds_read_b64_tr_b16 v[62:63], v6 offset:46080
    v_mfma_f32_16x16x32_bf16 v[136:139], v[36:39], v[224:227], v[136:139]
    ds_read_b64_tr_b16 v[32:33], v3 offset:49152
    v_mfma_f32_16x16x32_bf16 v[140:143], v[36:39], v[228:231], v[140:143]
    ds_read_b64_tr_b16 v[34:35], v3 offset:50176
    s_waitcnt lgkmcnt(10)
    v_mfma_f32_16x16x32_bf16 v[144:147], v[40:43], v[224:227], v[144:147]
    ds_read_b64_tr_b16 v[36:37], v4 offset:49152
    v_mfma_f32_16x16x32_bf16 v[148:151], v[40:43], v[228:231], v[148:151]
    ds_read_b64_tr_b16 v[38:39], v4 offset:50176
    v_mfma_f32_16x16x32_bf16 v[152:155], v[44:47], v[224:227], v[152:155]
    ds_read_b64_tr_b16 v[40:41], v5 offset:49152
    v_mfma_f32_16x16x32_bf16 v[156:159], v[44:47], v[228:231], v[156:159]
    ds_read_b64_tr_b16 v[42:43], v5 offset:50176
    s_waitcnt vmcnt(12) lgkmcnt(10)
    v_mfma_f32_16x16x32_bf16 v[64:67], v[48:51], v[232:235], v[64:67]
    buffer_load_dwordx4 v[192:195], v2, s[4:7], s42 offen offset:0 sc1
    ds_read_b64_tr_b16 v[44:45], v6 offset:49152
    v_mfma_f32_16x16x32_bf16 v[68:71], v[48:51], v[236:239], v[68:71]
    ds_read_b64_tr_b16 v[46:47], v6 offset:50176
    v_mfma_f32_16x16x32_bf16 v[72:75], v[52:55], v[232:235], v[72:75]
    buffer_load_dwordx4 v[196:199], v2, s[4:7], s42 offen offset:256 sc1
    ds_read_b64_tr_b16 v[48:49], v3 offset:53248
    v_mfma_f32_16x16x32_bf16 v[76:79], v[52:55], v[236:239], v[76:79]
    ds_read_b64_tr_b16 v[50:51], v3 offset:54272
    s_waitcnt lgkmcnt(10)
    v_mfma_f32_16x16x32_bf16 v[80:83], v[56:59], v[232:235], v[80:83]
    buffer_load_dwordx4 v[200:203], v2, s[4:7], s42 offen offset:2048 sc1
    ds_read_b64_tr_b16 v[52:53], v4 offset:53248
    v_mfma_f32_16x16x32_bf16 v[84:87], v[56:59], v[236:239], v[84:87]
    ds_read_b64_tr_b16 v[54:55], v4 offset:54272
    v_mfma_f32_16x16x32_bf16 v[88:91], v[60:63], v[232:235], v[88:91]
    buffer_load_dwordx4 v[204:207], v2, s[4:7], s42 offen offset:2304 sc1
    ds_read_b64_tr_b16 v[56:57], v5 offset:53248
    s_add_u32 s42, s41, s93
    v_mfma_f32_16x16x32_bf16 v[92:95], v[60:63], v[236:239], v[92:95]
    ds_read_b64_tr_b16 v[58:59], v5 offset:54272
    s_waitcnt lgkmcnt(10)
    v_mfma_f32_16x16x32_bf16 v[96:99], v[232:235], v[32:35], v[96:99]
    ds_read_b64_tr_b16 v[60:61], v6 offset:53248
    buffer_load_dwordx4 v[208:211], v2, s[4:7], s42 offen offset:0 sc1
    v_mfma_f32_16x16x32_bf16 v[100:103], v[236:239], v[32:35], v[100:103]
    ds_read_b64_tr_b16 v[62:63], v6 offset:54272
    v_mfma_f32_16x16x32_bf16 v[104:107], v[232:235], v[36:39], v[104:107]
    ds_read_b64_tr_b16 v[32:33], v3 offset:57344
    v_mfma_f32_16x16x32_bf16 v[108:111], v[236:239], v[36:39], v[108:111]
    ds_read_b64_tr_b16 v[34:35], v3 offset:58368
    s_waitcnt lgkmcnt(10)
    v_mfma_f32_16x16x32_bf16 v[112:115], v[232:235], v[40:43], v[112:115]
    ds_read_b64_tr_b16 v[36:37], v4 offset:57344
    v_mfma_f32_16x16x32_bf16 v[116:119], v[236:239], v[40:43], v[116:119]
    ds_read_b64_tr_b16 v[38:39], v4 offset:58368
    v_mfma_f32_16x16x32_bf16 v[120:123], v[232:235], v[44:47], v[120:123]
    buffer_load_dwordx4 v[212:215], v2, s[4:7], s42 offen offset:256 sc1
    ds_read_b64_tr_b16 v[40:41], v5 offset:57344
    v_mfma_f32_16x16x32_bf16 v[124:127], v[236:239], v[44:47], v[124:127]
    ds_read_b64_tr_b16 v[42:43], v5 offset:58368
    s_waitcnt lgkmcnt(10)
    v_mfma_f32_16x16x32_bf16 v[128:131], v[48:51], v[232:235], v[128:131]
    ds_read_b64_tr_b16 v[44:45], v6 offset:57344
    v_mfma_f32_16x16x32_bf16 v[132:135], v[48:51], v[236:239], v[132:135]
    ds_read_b64_tr_b16 v[46:47], v6 offset:58368
    v_mfma_f32_16x16x32_bf16 v[136:139], v[52:55], v[232:235], v[136:139]
    ds_read_b64_tr_b16 v[48:49], v3 offset:61440
    v_mfma_f32_16x16x32_bf16 v[140:143], v[52:55], v[236:239], v[140:143]
    ds_read_b64_tr_b16 v[50:51], v3 offset:62464
    s_waitcnt lgkmcnt(10)
    v_mfma_f32_16x16x32_bf16 v[144:147], v[56:59], v[232:235], v[144:147]
    ds_read_b64_tr_b16 v[52:53], v4 offset:61440
    v_mfma_f32_16x16x32_bf16 v[148:151], v[56:59], v[236:239], v[148:151]
    ds_read_b64_tr_b16 v[54:55], v4 offset:62464
    v_mfma_f32_16x16x32_bf16 v[152:155], v[60:63], v[232:235], v[152:155]
    ds_read_b64_tr_b16 v[56:57], v5 offset:61440
    v_mfma_f32_16x16x32_bf16 v[156:159], v[60:63], v[236:239], v[156:159]
    ds_read_b64_tr_b16 v[58:59], v5 offset:62464
    s_waitcnt vmcnt(16) lgkmcnt(10)
    v_mfma_f32_16x16x32_bf16 v[64:67], v[32:35], v[240:243], v[64:67]
    ds_read_b64_tr_b16 v[60:61], v6 offset:61440
    v_mfma_f32_16x16x32_bf16 v[68:71], v[32:35], v[244:247], v[68:71]
    ds_read_b64_tr_b16 v[62:63], v6 offset:62464
    s_barrier
    v_xor_b32 v3, 0x10000, v3
    v_xor_b32 v4, 0x10000, v4
    v_xor_b32 v5, 0x10000, v5
    v_xor_b32 v6, 0x10000, v6
    v_mfma_f32_16x16x32_bf16 v[72:75], v[36:39], v[240:243], v[72:75]
    ds_read_b64_tr_b16 v[32:33], v3 offset:0
    v_mfma_f32_16x16x32_bf16 v[76:79], v[36:39], v[244:247], v[76:79]
    ds_read_b64_tr_b16 v[34:35], v3 offset:1024
    s_waitcnt lgkmcnt(10)
    v_mfma_f32_16x16x32_bf16 v[80:83], v[40:43], v[240:243], v[80:83]
    ds_read_b64_tr_b16 v[36:37], v4 offset:0
    v_mfma_f32_16x16x32_bf16 v[84:87], v[40:43], v[244:247], v[84:87]
    ds_read_b64_tr_b16 v[38:39], v4 offset:1024
    v_mfma_f32_16x16x32_bf16 v[88:91], v[44:47], v[240:243], v[88:91]
    ds_read_b64_tr_b16 v[40:41], v5 offset:0
    v_mfma_f32_16x16x32_bf16 v[92:95], v[44:47], v[244:247], v[92:95]
    ds_read_b64_tr_b16 v[42:43], v5 offset:1024
    s_waitcnt lgkmcnt(10)
    v_mfma_f32_16x16x32_bf16 v[96:99], v[240:243], v[48:51], v[96:99]
    ds_read_b64_tr_b16 v[44:45], v6 offset:0
    v_mfma_f32_16x16x32_bf16 v[100:103], v[244:247], v[48:51], v[100:103]
    ds_read_b64_tr_b16 v[46:47], v6 offset:1024
    v_mfma_f32_16x16x32_bf16 v[104:107], v[240:243], v[52:55], v[104:107]
    ds_read_b64_tr_b16 v[48:49], v3 offset:4096
    v_mfma_f32_16x16x32_bf16 v[108:111], v[244:247], v[52:55], v[108:111]
    ds_read_b64_tr_b16 v[50:51], v3 offset:5120
    s_waitcnt lgkmcnt(10)
    v_mfma_f32_16x16x32_bf16 v[112:115], v[240:243], v[56:59], v[112:115]
    ds_read_b64_tr_b16 v[52:53], v4 offset:4096
    v_mfma_f32_16x16x32_bf16 v[116:119], v[244:247], v[56:59], v[116:119]
    ds_read_b64_tr_b16 v[54:55], v4 offset:5120
    v_mfma_f32_16x16x32_bf16 v[120:123], v[240:243], v[60:63], v[120:123]
    ds_read_b64_tr_b16 v[56:57], v5 offset:4096
    v_mfma_f32_16x16x32_bf16 v[124:127], v[244:247], v[60:63], v[124:127]
    ds_read_b64_tr_b16 v[58:59], v5 offset:5120
    s_waitcnt lgkmcnt(10)
    v_mfma_f32_16x16x32_bf16 v[128:131], v[32:35], v[240:243], v[128:131]
    ds_read_b64_tr_b16 v[60:61], v6 offset:4096
    v_mfma_f32_16x16x32_bf16 v[132:135], v[32:35], v[244:247], v[132:135]
    ds_read_b64_tr_b16 v[62:63], v6 offset:5120
    v_mfma_f32_16x16x32_bf16 v[136:139], v[36:39], v[240:243], v[136:139]
    ds_read_b64_tr_b16 v[32:33], v3 offset:8192
    v_mfma_f32_16x16x32_bf16 v[140:143], v[36:39], v[244:247], v[140:143]
    ds_read_b64_tr_b16 v[34:35], v3 offset:9216
    s_waitcnt lgkmcnt(10)
    v_mfma_f32_16x16x32_bf16 v[144:147], v[40:43], v[240:243], v[144:147]
    ds_read_b64_tr_b16 v[36:37], v4 offset:8192
    v_mfma_f32_16x16x32_bf16 v[148:151], v[40:43], v[244:247], v[148:151]
    ds_read_b64_tr_b16 v[38:39], v4 offset:9216
    v_mfma_f32_16x16x32_bf16 v[152:155], v[44:47], v[240:243], v[152:155]
    ds_read_b64_tr_b16 v[40:41], v5 offset:8192
    v_mfma_f32_16x16x32_bf16 v[156:159], v[44:47], v[244:247], v[156:159]
    ds_read_b64_tr_b16 v[42:43], v5 offset:9216
    s_waitcnt vmcnt(14) lgkmcnt(10)
    v_mfma_f32_16x16x32_bf16 v[64:67], v[48:51], v[248:251], v[64:67]
    ds_read_b64_tr_b16 v[44:45], v6 offset:8192
    v_mfma_f32_16x16x32_bf16 v[68:71], v[48:51], v[252:255], v[68:71]
    ds_read_b64_tr_b16 v[46:47], v6 offset:9216
    v_mfma_f32_16x16x32_bf16 v[72:75], v[52:55], v[248:251], v[72:75]
    ds_read_b64_tr_b16 v[48:49], v3 offset:12288
    v_mfma_f32_16x16x32_bf16 v[76:79], v[52:55], v[252:255], v[76:79]
    ds_read_b64_tr_b16 v[50:51], v3 offset:13312
    s_waitcnt lgkmcnt(10)
    v_mfma_f32_16x16x32_bf16 v[80:83], v[56:59], v[248:251], v[80:83]
    ds_read_b64_tr_b16 v[52:53], v4 offset:12288
    v_mfma_f32_16x16x32_bf16 v[84:87], v[56:59], v[252:255], v[84:87]
    ds_read_b64_tr_b16 v[54:55], v4 offset:13312
    v_mfma_f32_16x16x32_bf16 v[88:91], v[60:63], v[248:251], v[88:91]
    ds_read_b64_tr_b16 v[56:57], v5 offset:12288
    v_mfma_f32_16x16x32_bf16 v[92:95], v[60:63], v[252:255], v[92:95]
    ds_read_b64_tr_b16 v[58:59], v5 offset:13312
    s_waitcnt lgkmcnt(10)
    v_mfma_f32_16x16x32_bf16 v[96:99], v[248:251], v[32:35], v[96:99]
    ds_read_b64_tr_b16 v[60:61], v6 offset:12288
    v_mfma_f32_16x16x32_bf16 v[100:103], v[252:255], v[32:35], v[100:103]
    ds_read_b64_tr_b16 v[62:63], v6 offset:13312
    v_mfma_f32_16x16x32_bf16 v[104:107], v[248:251], v[36:39], v[104:107]
    ds_read_b64_tr_b16 v[32:33], v3 offset:16384
    v_mfma_f32_16x16x32_bf16 v[108:111], v[252:255], v[36:39], v[108:111]
    ds_read_b64_tr_b16 v[34:35], v3 offset:17408
    s_waitcnt lgkmcnt(10)
    v_mfma_f32_16x16x32_bf16 v[112:115], v[248:251], v[40:43], v[112:115]
    ds_read_b64_tr_b16 v[36:37], v4 offset:16384
    v_mfma_f32_16x16x32_bf16 v[116:119], v[252:255], v[40:43], v[116:119]
    ds_read_b64_tr_b16 v[38:39], v4 offset:17408
    v_mfma_f32_16x16x32_bf16 v[120:123], v[248:251], v[44:47], v[120:123]
    ds_read_b64_tr_b16 v[40:41], v5 offset:16384
    v_mfma_f32_16x16x32_bf16 v[124:127], v[252:255], v[44:47], v[124:127]
    ds_read_b64_tr_b16 v[42:43], v5 offset:17408
    s_waitcnt lgkmcnt(10)
    v_mfma_f32_16x16x32_bf16 v[128:131], v[48:51], v[248:251], v[128:131]
    buffer_load_dwordx4 v[216:219], v2, s[4:7], s42 offen offset:2048 sc1
    ds_read_b64_tr_b16 v[44:45], v6 offset:16384
    v_mfma_f32_16x16x32_bf16 v[132:135], v[48:51], v[252:255], v[132:135]
    ds_read_b64_tr_b16 v[46:47], v6 offset:17408
    v_mfma_f32_16x16x32_bf16 v[136:139], v[52:55], v[248:251], v[136:139]
    buffer_load_dwordx4 v[220:223], v2, s[4:7], s42 offen offset:2304 sc1
    ds_read_b64_tr_b16 v[48:49], v3 offset:20480
    s_add_u32 s42, s41, s94
    v_mfma_f32_16x16x32_bf16 v[140:143], v[52:55], v[252:255], v[140:143]
    ds_read_b64_tr_b16 v[50:51], v3 offset:21504
    s_waitcnt lgkmcnt(10)
    v_mfma_f32_16x16x32_bf16 v[144:147], v[56:59], v[248:251], v[144:147]
    buffer_load_dwordx4 v[224:227], v2, s[4:7], s42 offen offset:0 sc1
    ds_read_b64_tr_b16 v[52:53], v4 offset:20480
    v_mfma_f32_16x16x32_bf16 v[148:151], v[56:59], v[252:255], v[148:151]
    ds_read_b64_tr_b16 v[54:55], v4 offset:21504
    v_mfma_f32_16x16x32_bf16 v[152:155], v[60:63], v[248:251], v[152:155]
    buffer_load_dwordx4 v[228:231], v2, s[4:7], s42 offen offset:256 sc1
    ds_read_b64_tr_b16 v[56:57], v5 offset:20480
    v_mfma_f32_16x16x32_bf16 v[156:159], v[60:63], v[252:255], v[156:159]
    ds_read_b64_tr_b16 v[58:59], v5 offset:21504
    s_waitcnt vmcnt(16) lgkmcnt(10)
    v_mfma_f32_16x16x32_bf16 v[64:67], v[32:35], v[160:163], v[64:67]
    ds_read_b64_tr_b16 v[60:61], v6 offset:20480
    buffer_load_dwordx4 v[232:235], v2, s[4:7], s42 offen offset:2048 sc1
    v_mfma_f32_16x16x32_bf16 v[68:71], v[32:35], v[164:167], v[68:71]
    ds_read_b64_tr_b16 v[62:63], v6 offset:21504
    v_mfma_f32_16x16x32_bf16 v[72:75], v[36:39], v[160:163], v[72:75]
    buffer_load_dwordx4 v[236:239], v2, s[4:7], s42 offen offset:2304 sc1
    ds_read_b64_tr_b16 v[32:33], v3 offset:24576
    s_add_u32 s42, s41, s95
    v_mfma_f32_16x16x32_bf16 v[76:79], v[36:39], v[164:167], v[76:79]
    ds_read_b64_tr_b16 v[34:35], v3 offset:25600
    s_waitcnt lgkmcnt(10)
    v_mfma_f32_16x16x32_bf16 v[80:83], v[40:43], v[160:163], v[80:83]
    ds_read_b64_tr_b16 v[36:37], v4 offset:24576
    v_mfma_f32_16x16x32_bf16 v[84:87], v[40:43], v[164:167], v[84:87]
    ds_read_b64_tr_b16 v[38:39], v4 offset:25600
    v_mfma_f32_16x16x32_bf16 v[88:91], v[44:47], v[160:163], v[88:91]
    ds_read_b64_tr_b16 v[40:41], v5 offset:24576
    v_mfma_f32_16x16x32_bf16 v[92:95], v[44:47], v[164:167], v[92:95]
    ds_read_b64_tr_b16 v[42:43], v5 offset:25600
    s_waitcnt lgkmcnt(10)
    v_mfma_f32_16x16x32_bf16 v[96:99], v[160:163], v[48:51], v[96:99]
    buffer_load_dwordx4 v[240:243], v2, s[4:7], s42 offen offset:0 sc1
    ds_read_b64_tr_b16 v[44:45], v6 offset:24576
    v_mfma_f32_16x16x32_bf16 v[100:103], v[164:167], v[48:51], v[100:103]
    ds_read_b64_tr_b16 v[46:47], v6 offset:25600
    v_mfma_f32_16x16x32_bf16 v[104:107], v[160:163], v[52:55], v[104:107]
    ds_read_b64_tr_b16 v[48:49], v3 offset:28672
    v_mfma_f32_16x16x32_bf16 v[108:111], v[164:167], v[52:55], v[108:111]
    ds_read_b64_tr_b16 v[50:51], v3 offset:29696
    s_waitcnt lgkmcnt(10)
    v_mfma_f32_16x16x32_bf16 v[112:115], v[160:163], v[56:59], v[112:115]
    ds_read_b64_tr_b16 v[52:53], v4 offset:28672
    v_mfma_f32_16x16x32_bf16 v[116:119], v[164:167], v[56:59], v[116:119]
    ds_read_b64_tr_b16 v[54:55], v4 offset:29696
    v_mfma_f32_16x16x32_bf16 v[120:123], v[160:163], v[60:63], v[120:123]
    ds_read_b64_tr_b16 v[56:57], v5 offset:28672
    v_mfma_f32_16x16x32_bf16 v[124:127], v[164:167], v[60:63], v[124:127]
    ds_read_b64_tr_b16 v[58:59], v5 offset:29696
    s_waitcnt lgkmcnt(10)
    v_mfma_f32_16x16x32_bf16 v[128:131], v[32:35], v[160:163], v[128:131]
    ds_read_b64_tr_b16 v[60:61], v6 offset:28672
    v_mfma_f32_16x16x32_bf16 v[132:135], v[32:35], v[164:167], v[132:135]
    ds_read_b64_tr_b16 v[62:63], v6 offset:29696
    s_barrier
    v_mfma_f32_16x16x32_bf16 v[136:139], v[36:39], v[160:163], v[136:139]
    ds_read_b64_tr_b16 v[32:33], v3 offset:32768
    v_mfma_f32_16x16x32_bf16 v[140:143], v[36:39], v[164:167], v[140:143]
    ds_read_b64_tr_b16 v[34:35], v3 offset:33792
    s_waitcnt lgkmcnt(10)
    v_mfma_f32_16x16x32_bf16 v[144:147], v[40:43], v[160:163], v[144:147]
    ds_read_b64_tr_b16 v[36:37], v4 offset:32768
    v_mfma_f32_16x16x32_bf16 v[148:151], v[40:43], v[164:167], v[148:151]
    ds_read_b64_tr_b16 v[38:39], v4 offset:33792
    v_mfma_f32_16x16x32_bf16 v[152:155], v[44:47], v[160:163], v[152:155]
    ds_read_b64_tr_b16 v[40:41], v5 offset:32768
    v_mfma_f32_16x16x32_bf16 v[156:159], v[44:47], v[164:167], v[156:159]
    ds_read_b64_tr_b16 v[42:43], v5 offset:33792
    s_waitcnt vmcnt(17) lgkmcnt(10)
    v_mfma_f32_16x16x32_bf16 v[64:67], v[48:51], v[168:171], v[64:67]
    ds_read_b64_tr_b16 v[44:45], v6 offset:32768
    v_mfma_f32_16x16x32_bf16 v[68:71], v[48:51], v[172:175], v[68:71]
    ds_read_b64_tr_b16 v[46:47], v6 offset:33792
    v_mfma_f32_16x16x32_bf16 v[72:75], v[52:55], v[168:171], v[72:75]
    ds_read_b64_tr_b16 v[48:49], v3 offset:36864
    v_mfma_f32_16x16x32_bf16 v[76:79], v[52:55], v[172:175], v[76:79]
    ds_read_b64_tr_b16 v[50:51], v3 offset:37888
    s_waitcnt lgkmcnt(10)
    v_mfma_f32_16x16x32_bf16 v[80:83], v[56:59], v[168:171], v[80:83]
    ds_read_b64_tr_b16 v[52:53], v4 offset:36864
    v_mfma_f32_16x16x32_bf16 v[84:87], v[56:59], v[172:175], v[84:87]
    ds_read_b64_tr_b16 v[54:55], v4 offset:37888
    v_mfma_f32_16x16x32_bf16 v[88:91], v[60:63], v[168:171], v[88:91]
    ds_read_b64_tr_b16 v[56:57], v5 offset:36864
    v_mfma_f32_16x16x32_bf16 v[92:95], v[60:63], v[172:175], v[92:95]
    ds_read_b64_tr_b16 v[58:59], v5 offset:37888
    s_waitcnt lgkmcnt(10)
    v_mfma_f32_16x16x32_bf16 v[96:99], v[168:171], v[32:35], v[96:99]
    ds_read_b64_tr_b16 v[60:61], v6 offset:36864
    v_mfma_f32_16x16x32_bf16 v[100:103], v[172:175], v[32:35], v[100:103]
    ds_read_b64_tr_b16 v[62:63], v6 offset:37888
    v_mfma_f32_16x16x32_bf16 v[104:107], v[168:171], v[36:39], v[104:107]
    ds_read_b64_tr_b16 v[32:33], v3 offset:40960
    v_mfma_f32_16x16x32_bf16 v[108:111], v[172:175], v[36:39], v[108:111]
    ds_read_b64_tr_b16 v[34:35], v3 offset:41984
    s_waitcnt lgkmcnt(10)
    v_mfma_f32_16x16x32_bf16 v[112:115], v[168:171], v[40:43], v[112:115]
    ds_read_b64_tr_b16 v[36:37], v4 offset:40960
    v_mfma_f32_16x16x32_bf16 v[116:119], v[172:175], v[40:43], v[116:119]
    ds_read_b64_tr_b16 v[38:39], v4 offset:41984
    v_mfma_f32_16x16x32_bf16 v[120:123], v[168:171], v[44:47], v[120:123]
    ds_read_b64_tr_b16 v[40:41], v5 offset:40960
    v_mfma_f32_16x16x32_bf16 v[124:127], v[172:175], v[44:47], v[124:127]
    ds_read_b64_tr_b16 v[42:43], v5 offset:41984
    s_waitcnt lgkmcnt(10)
    v_mfma_f32_16x16x32_bf16 v[128:131], v[48:51], v[168:171], v[128:131]
    ds_read_b64_tr_b16 v[44:45], v6 offset:40960
    v_mfma_f32_16x16x32_bf16 v[132:135], v[48:51], v[172:175], v[132:135]
    ds_read_b64_tr_b16 v[46:47], v6 offset:41984
    v_mfma_f32_16x16x32_bf16 v[136:139], v[52:55], v[168:171], v[136:139]
    ds_read_b64_tr_b16 v[48:49], v3 offset:45056
    v_mfma_f32_16x16x32_bf16 v[140:143], v[52:55], v[172:175], v[140:143]
    ds_read_b64_tr_b16 v[50:51], v3 offset:46080
    s_waitcnt lgkmcnt(10)
    v_mfma_f32_16x16x32_bf16 v[144:147], v[56:59], v[168:171], v[144:147]
    ds_read_b64_tr_b16 v[52:53], v4 offset:45056
    v_mfma_f32_16x16x32_bf16 v[148:151], v[56:59], v[172:175], v[148:151]
    ds_read_b64_tr_b16 v[54:55], v4 offset:46080
    v_mfma_f32_16x16x32_bf16 v[152:155], v[60:63], v[168:171], v[152:155]
    ds_read_b64_tr_b16 v[56:57], v5 offset:45056
    v_mfma_f32_16x16x32_bf16 v[156:159], v[60:63], v[172:175], v[156:159]
    ds_read_b64_tr_b16 v[58:59], v5 offset:46080
    s_waitcnt vmcnt(15) lgkmcnt(10)
    v_mfma_f32_16x16x32_bf16 v[64:67], v[32:35], v[176:179], v[64:67]
    ds_read_b64_tr_b16 v[60:61], v6 offset:45056
    v_mfma_f32_16x16x32_bf16 v[68:71], v[32:35], v[180:183], v[68:71]
    ds_read_b64_tr_b16 v[62:63], v6 offset:46080
    v_mfma_f32_16x16x32_bf16 v[72:75], v[36:39], v[176:179], v[72:75]
    ds_read_b64_tr_b16 v[32:33], v3 offset:49152
    v_mfma_f32_16x16x32_bf16 v[76:79], v[36:39], v[180:183], v[76:79]
    ds_read_b64_tr_b16 v[34:35], v3 offset:50176
    s_waitcnt lgkmcnt(10)
    v_mfma_f32_16x16x32_bf16 v[80:83], v[40:43], v[176:179], v[80:83]
    ds_read_b64_tr_b16 v[36:37], v4 offset:49152
    v_mfma_f32_16x16x32_bf16 v[84:87], v[40:43], v[180:183], v[84:87]
    ds_read_b64_tr_b16 v[38:39], v4 offset:50176
    v_mfma_f32_16x16x32_bf16 v[88:91], v[44:47], v[176:179], v[88:91]
    ds_read_b64_tr_b16 v[40:41], v5 offset:49152
    v_mfma_f32_16x16x32_bf16 v[92:95], v[44:47], v[180:183], v[92:95]
    ds_read_b64_tr_b16 v[42:43], v5 offset:50176
    s_waitcnt lgkmcnt(10)
    v_mfma_f32_16x16x32_bf16 v[96:99], v[176:179], v[48:51], v[96:99]
    buffer_load_dwordx4 v[244:247], v2, s[4:7], s42 offen offset:256 sc1
    ds_read_b64_tr_b16 v[44:45], v6 offset:49152
    v_mfma_f32_16x16x32_bf16 v[100:103], v[180:183], v[48:51], v[100:103]
    ds_read_b64_tr_b16 v[46:47], v6 offset:50176
    v_mfma_f32_16x16x32_bf16 v[104:107], v[176:179], v[52:55], v[104:107]
    buffer_load_dwordx4 v[248:251], v2, s[4:7], s42 offen offset:2048 sc1
    ds_read_b64_tr_b16 v[48:49], v3 offset:53248
    v_mfma_f32_16x16x32_bf16 v[108:111], v[180:183], v[52:55], v[108:111]
    ds_read_b64_tr_b16 v[50:51], v3 offset:54272
    s_waitcnt lgkmcnt(10)
    v_mfma_f32_16x16x32_bf16 v[112:115], v[176:179], v[56:59], v[112:115]
    buffer_load_dwordx4 v[252:255], v2, s[4:7], s42 offen offset:2304 sc1
    ds_read_b64_tr_b16 v[52:53], v4 offset:53248
    s_add_u32 s42, s41, s96
    v_mfma_f32_16x16x32_bf16 v[116:119], v[180:183], v[56:59], v[116:119]
    ds_read_b64_tr_b16 v[54:55], v4 offset:54272
    v_mfma_f32_16x16x32_bf16 v[120:123], v[176:179], v[60:63], v[120:123]
    buffer_load_dwordx4 v[160:163], v2, s[4:7], s42 offen offset:0 sc1
    ds_read_b64_tr_b16 v[56:57], v5 offset:53248
    v_mfma_f32_16x16x32_bf16 v[124:127], v[180:183], v[60:63], v[124:127]
    ds_read_b64_tr_b16 v[58:59], v5 offset:54272
    s_waitcnt lgkmcnt(10)
    v_mfma_f32_16x16x32_bf16 v[128:131], v[32:35], v[176:179], v[128:131]
    ds_read_b64_tr_b16 v[60:61], v6 offset:53248
    buffer_load_dwordx4 v[164:167], v2, s[4:7], s42 offen offset:256 sc1
    v_mfma_f32_16x16x32_bf16 v[132:135], v[32:35], v[180:183], v[132:135]
    ds_read_b64_tr_b16 v[62:63], v6 offset:54272
    v_mfma_f32_16x16x32_bf16 v[136:139], v[36:39], v[176:179], v[136:139]
    buffer_load_dwordx4 v[168:171], v2, s[4:7], s42 offen offset:2048 sc1
    ds_read_b64_tr_b16 v[32:33], v3 offset:57344
    v_mfma_f32_16x16x32_bf16 v[140:143], v[36:39], v[180:183], v[140:143]
    ds_read_b64_tr_b16 v[34:35], v3 offset:58368
    s_waitcnt lgkmcnt(10)
    v_mfma_f32_16x16x32_bf16 v[144:147], v[40:43], v[176:179], v[144:147]
    ds_read_b64_tr_b16 v[36:37], v4 offset:57344
    v_mfma_f32_16x16x32_bf16 v[148:151], v[40:43], v[180:183], v[148:151]
    ds_read_b64_tr_b16 v[38:39], v4 offset:58368
    v_mfma_f32_16x16x32_bf16 v[152:155], v[44:47], v[176:179], v[152:155]
    ds_read_b64_tr_b16 v[40:41], v5 offset:57344
    v_mfma_f32_16x16x32_bf16 v[156:159], v[44:47], v[180:183], v[156:159]
    ds_read_b64_tr_b16 v[42:43], v5 offset:58368
    s_waitcnt vmcnt(19) lgkmcnt(10)
    v_mfma_f32_16x16x32_bf16 v[64:67], v[48:51], v[184:187], v[64:67]
    ds_read_b64_tr_b16 v[44:45], v6 offset:57344
    v_mfma_f32_16x16x32_bf16 v[68:71], v[48:51], v[188:191], v[68:71]
    ds_read_b64_tr_b16 v[46:47], v6 offset:58368
    v_mfma_f32_16x16x32_bf16 v[72:75], v[52:55], v[184:187], v[72:75]
    ds_read_b64_tr_b16 v[48:49], v3 offset:61440
    v_mfma_f32_16x16x32_bf16 v[76:79], v[52:55], v[188:191], v[76:79]
    ds_read_b64_tr_b16 v[50:51], v3 offset:62464
    s_waitcnt lgkmcnt(10)
    v_mfma_f32_16x16x32_bf16 v[80:83], v[56:59], v[184:187], v[80:83]
    buffer_load_dwordx4 v[172:175], v2, s[4:7], s42 offen offset:2304 sc1
    ds_read_b64_tr_b16 v[52:53], v4 offset:61440
    s_add_u32 s42, s41, s97
    v_mfma_f32_16x16x32_bf16 v[84:87], v[56:59], v[188:191], v[84:87]
    ds_read_b64_tr_b16 v[54:55], v4 offset:62464
    v_mfma_f32_16x16x32_bf16 v[88:91], v[60:63], v[184:187], v[88:91]
    ds_read_b64_tr_b16 v[56:57], v5 offset:61440
    v_mfma_f32_16x16x32_bf16 v[92:95], v[60:63], v[188:191], v[92:95]
    ds_read_b64_tr_b16 v[58:59], v5 offset:62464
    s_waitcnt lgkmcnt(10)
    v_mfma_f32_16x16x32_bf16 v[96:99], v[184:187], v[32:35], v[96:99]
    ds_read_b64_tr_b16 v[60:61], v6 offset:61440
    v_mfma_f32_16x16x32_bf16 v[100:103], v[188:191], v[32:35], v[100:103]
    ds_read_b64_tr_b16 v[62:63], v6 offset:62464
    s_barrier
    v_xor_b32 v3, 0x10000, v3
    v_xor_b32 v4, 0x10000, v4
    v_xor_b32 v5, 0x10000, v5
    v_xor_b32 v6, 0x10000, v6
    v_mfma_f32_16x16x32_bf16 v[104:107], v[184:187], v[36:39], v[104:107]
    ds_read_b64_tr_b16 v[32:33], v3 offset:0
    v_mfma_f32_16x16x32_bf16 v[108:111], v[188:191], v[36:39], v[108:111]
    ds_read_b64_tr_b16 v[34:35], v3 offset:1024
    s_waitcnt lgkmcnt(10)
    v_mfma_f32_16x16x32_bf16 v[112:115], v[184:187], v[40:43], v[112:115]
    ds_read_b64_tr_b16 v[36:37], v4 offset:0
    v_mfma_f32_16x16x32_bf16 v[116:119], v[188:191], v[40:43], v[116:119]
    ds_read_b64_tr_b16 v[38:39], v4 offset:1024
    v_mfma_f32_16x16x32_bf16 v[120:123], v[184:187], v[44:47], v[120:123]
    ds_read_b64_tr_b16 v[40:41], v5 offset:0
    v_mfma_f32_16x16x32_bf16 v[124:127], v[188:191], v[44:47], v[124:127]
    ds_read_b64_tr_b16 v[42:43], v5 offset:1024
    s_waitcnt lgkmcnt(10)
    v_mfma_f32_16x16x32_bf16 v[128:131], v[48:51], v[184:187], v[128:131]
    ds_read_b64_tr_b16 v[44:45], v6 offset:0
    v_mfma_f32_16x16x32_bf16 v[132:135], v[48:51], v[188:191], v[132:135]
    ds_read_b64_tr_b16 v[46:47], v6 offset:1024
    v_mfma_f32_16x16x32_bf16 v[136:139], v[52:55], v[184:187], v[136:139]
    ds_read_b64_tr_b16 v[48:49], v3 offset:4096
    v_mfma_f32_16x16x32_bf16 v[140:143], v[52:55], v[188:191], v[140:143]
    ds_read_b64_tr_b16 v[50:51], v3 offset:5120
    s_waitcnt lgkmcnt(10)
    v_mfma_f32_16x16x32_bf16 v[144:147], v[56:59], v[184:187], v[144:147]
    ds_read_b64_tr_b16 v[52:53], v4 offset:4096
    v_mfma_f32_16x16x32_bf16 v[148:151], v[56:59], v[188:191], v[148:151]
    ds_read_b64_tr_b16 v[54:55], v4 offset:5120
    v_mfma_f32_16x16x32_bf16 v[152:155], v[60:63], v[184:187], v[152:155]
    ds_read_b64_tr_b16 v[56:57], v5 offset:4096
    v_mfma_f32_16x16x32_bf16 v[156:159], v[60:63], v[188:191], v[156:159]
    ds_read_b64_tr_b16 v[58:59], v5 offset:5120
    s_waitcnt vmcnt(18) lgkmcnt(10)
    v_mfma_f32_16x16x32_bf16 v[64:67], v[32:35], v[192:195], v[64:67]
    ds_read_b64_tr_b16 v[60:61], v6 offset:4096
    v_mfma_f32_16x16x32_bf16 v[68:71], v[32:35], v[196:199], v[68:71]
    ds_read_b64_tr_b16 v[62:63], v6 offset:5120
    v_mfma_f32_16x16x32_bf16 v[72:75], v[36:39], v[192:195], v[72:75]
    ds_read_b64_tr_b16 v[32:33], v3 offset:8192
    v_mfma_f32_16x16x32_bf16 v[76:79], v[36:39], v[196:199], v[76:79]
    ds_read_b64_tr_b16 v[34:35], v3 offset:9216
    s_waitcnt lgkmcnt(10)
    v_mfma_f32_16x16x32_bf16 v[80:83], v[40:43], v[192:195], v[80:83]
    ds_read_b64_tr_b16 v[36:37], v4 offset:8192
    v_mfma_f32_16x16x32_bf16 v[84:87], v[40:43], v[196:199], v[84:87]
    ds_read_b64_tr_b16 v[38:39], v4 offset:9216
    v_mfma_f32_16x16x32_bf16 v[88:91], v[44:47], v[192:195], v[88:91]
    ds_read_b64_tr_b16 v[40:41], v5 offset:8192
    v_mfma_f32_16x16x32_bf16 v[92:95], v[44:47], v[196:199], v[92:95]
    ds_read_b64_tr_b16 v[42:43], v5 offset:9216
    s_waitcnt lgkmcnt(10)
    v_mfma_f32_16x16x32_bf16 v[96:99], v[192:195], v[48:51], v[96:99]
    ds_read_b64_tr_b16 v[44:45], v6 offset:8192
    v_mfma_f32_16x16x32_bf16 v[100:103], v[196:199], v[48:51], v[100:103]
    ds_read_b64_tr_b16 v[46:47], v6 offset:9216
    v_mfma_f32_16x16x32_bf16 v[104:107], v[192:195], v[52:55], v[104:107]
    ds_read_b64_tr_b16 v[48:49], v3 offset:12288
    v_mfma_f32_16x16x32_bf16 v[108:111], v[196:199], v[52:55], v[108:111]
    ds_read_b64_tr_b16 v[50:51], v3 offset:13312
    s_waitcnt lgkmcnt(10)
    v_mfma_f32_16x16x32_bf16 v[112:115], v[192:195], v[56:59], v[112:115]
    ds_read_b64_tr_b16 v[52:53], v4 offset:12288
    v_mfma_f32_16x16x32_bf16 v[116:119], v[196:199], v[56:59], v[116:119]
    ds_read_b64_tr_b16 v[54:55], v4 offset:13312
    v_mfma_f32_16x16x32_bf16 v[120:123], v[192:195], v[60:63], v[120:123]
    ds_read_b64_tr_b16 v[56:57], v5 offset:12288
    v_mfma_f32_16x16x32_bf16 v[124:127], v[196:199], v[60:63], v[124:127]
    ds_read_b64_tr_b16 v[58:59], v5 offset:13312
    s_waitcnt lgkmcnt(10)
    v_mfma_f32_16x16x32_bf16 v[128:131], v[32:35], v[192:195], v[128:131]
    ds_read_b64_tr_b16 v[60:61], v6 offset:12288
    v_mfma_f32_16x16x32_bf16 v[132:135], v[32:35], v[196:199], v[132:135]
    ds_read_b64_tr_b16 v[62:63], v6 offset:13312
    v_mfma_f32_16x16x32_bf16 v[136:139], v[36:39], v[192:195], v[136:139]
    ds_read_b64_tr_b16 v[32:33], v3 offset:16384
    v_mfma_f32_16x16x32_bf16 v[140:143], v[36:39], v[196:199], v[140:143]
    ds_read_b64_tr_b16 v[34:35], v3 offset:17408
    s_waitcnt lgkmcnt(10)
    v_mfma_f32_16x16x32_bf16 v[144:147], v[40:43], v[192:195], v[144:147]
    ds_read_b64_tr_b16 v[36:37], v4 offset:16384
    v_mfma_f32_16x16x32_bf16 v[148:151], v[40:43], v[196:199], v[148:151]
    ds_read_b64_tr_b16 v[38:39], v4 offset:17408
    v_mfma_f32_16x16x32_bf16 v[152:155], v[44:47], v[192:195], v[152:155]
    ds_read_b64_tr_b16 v[40:41], v5 offset:16384
    v_mfma_f32_16x16x32_bf16 v[156:159], v[44:47], v[196:199], v[156:159]
    ds_read_b64_tr_b16 v[42:43], v5 offset:17408
    s_waitcnt vmcnt(16) lgkmcnt(10)
    v_mfma_f32_16x16x32_bf16 v[64:67], v[48:51], v[200:203], v[64:67]
    buffer_load_dwordx4 v[176:179], v2, s[4:7], s42 offen offset:0 sc1
    ds_read_b64_tr_b16 v[44:45], v6 offset:16384
    v_mfma_f32_16x16x32_bf16 v[68:71], v[48:51], v[204:207], v[68:71]
    ds_read_b64_tr_b16 v[46:47], v6 offset:17408
    v_mfma_f32_16x16x32_bf16 v[72:75], v[52:55], v[200:203], v[72:75]
    buffer_load_dwordx4 v[180:183], v2, s[4:7], s42 offen offset:256 sc1
    ds_read_b64_tr_b16 v[48:49], v3 offset:20480
    v_mfma_f32_16x16x32_bf16 v[76:79], v[52:55], v[204:207], v[76:79]
    ds_read_b64_tr_b16 v[50:51], v3 offset:21504
    s_waitcnt lgkmcnt(10)
    v_mfma_f32_16x16x32_bf16 v[80:83], v[56:59], v[200:203], v[80:83]
    buffer_load_dwordx4 v[184:187], v2, s[4:7], s42 offen offset:2048 sc1
    ds_read_b64_tr_b16 v[52:53], v4 offset:20480
    v_mfma_f32_16x16x32_bf16 v[84:87], v[56:59], v[204:207], v[84:87]
    ds_read_b64_tr_b16 v[54:55], v4 offset:21504
    v_mfma_f32_16x16x32_bf16 v[88:91], v[60:63], v[200:203], v[88:91]
    buffer_load_dwordx4 v[188:191], v2, s[4:7], s42 offen offset:2304 sc1
    ds_read_b64_tr_b16 v[56:57], v5 offset:20480
    s_add_u32 s42, s41, s98
    v_mfma_f32_16x16x32_bf16 v[92:95], v[60:63], v[204:207], v[92:95]
    ds_read_b64_tr_b16 v[58:59], v5 offset:21504
    s_waitcnt lgkmcnt(10)
    v_mfma_f32_16x16x32_bf16 v[96:99], v[200:203], v[32:35], v[96:99]
    ds_read_b64_tr_b16 v[60:61], v6 offset:20480
    buffer_load_dwordx4 v[192:195], v2, s[4:7], s42 offen offset:0 sc1
    v_mfma_f32_16x16x32_bf16 v[100:103], v[204:207], v[32:35], v[100:103]
    ds_read_b64_tr_b16 v[62:63], v6 offset:21504
    v_mfma_f32_16x16x32_bf16 v[104:107], v[200:203], v[36:39], v[104:107]
    ds_read_b64_tr_b16 v[32:33], v3 offset:24576
    v_mfma_f32_16x16x32_bf16 v[108:111], v[204:207], v[36:39], v[108:111]
    ds_read_b64_tr_b16 v[34:35], v3 offset:25600
    s_waitcnt lgkmcnt(10)
    v_mfma_f32_16x16x32_bf16 v[112:115], v[200:203], v[40:43], v[112:115]
    ds_read_b64_tr_b16 v[36:37], v4 offset:24576
    v_mfma_f32_16x16x32_bf16 v[116:119], v[204:207], v[40:43], v[116:119]
    ds_read_b64_tr_b16 v[38:39], v4 offset:25600
    v_mfma_f32_16x16x32_bf16 v[120:123], v[200:203], v[44:47], v[120:123]
    buffer_load_dwordx4 v[196:199], v2, s[4:7], s42 offen offset:256 sc1
    ds_read_b64_tr_b16 v[40:41], v5 offset:24576
    v_mfma_f32_16x16x32_bf16 v[124:127], v[204:207], v[44:47], v[124:127]
    ds_read_b64_tr_b16 v[42:43], v5 offset:25600
    s_waitcnt lgkmcnt(10)
    v_mfma_f32_16x16x32_bf16 v[128:131], v[48:51], v[200:203], v[128:131]
    ds_read_b64_tr_b16 v[44:45], v6 offset:24576
    v_mfma_f32_16x16x32_bf16 v[132:135], v[48:51], v[204:207], v[132:135]
    ds_read_b64_tr_b16 v[46:47], v6 offset:25600
    v_mfma_f32_16x16x32_bf16 v[136:139], v[52:55], v[200:203], v[136:139]
    ds_read_b64_tr_b16 v[48:49], v3 offset:28672
    v_mfma_f32_16x16x32_bf16 v[140:143], v[52:55], v[204:207], v[140:143]
    ds_read_b64_tr_b16 v[50:51], v3 offset:29696
    s_waitcnt lgkmcnt(10)
    v_mfma_f32_16x16x32_bf16 v[144:147], v[56:59], v[200:203], v[144:147]
    ds_read_b64_tr_b16 v[52:53], v4 offset:28672
    v_mfma_f32_16x16x32_bf16 v[148:151], v[56:59], v[204:207], v[148:151]
    ds_read_b64_tr_b16 v[54:55], v4 offset:29696
    v_mfma_f32_16x16x32_bf16 v[152:155], v[60:63], v[200:203], v[152:155]
    ds_read_b64_tr_b16 v[56:57], v5 offset:28672
    v_mfma_f32_16x16x32_bf16 v[156:159], v[60:63], v[204:207], v[156:159]
    ds_read_b64_tr_b16 v[58:59], v5 offset:29696
    s_waitcnt vmcnt(20) lgkmcnt(10)
    v_mfma_f32_16x16x32_bf16 v[64:67], v[32:35], v[208:211], v[64:67]
    ds_read_b64_tr_b16 v[60:61], v6 offset:28672
    v_mfma_f32_16x16x32_bf16 v[68:71], v[32:35], v[212:215], v[68:71]
    ds_read_b64_tr_b16 v[62:63], v6 offset:29696
    s_barrier
    v_mfma_f32_16x16x32_bf16 v[72:75], v[36:39], v[208:211], v[72:75]
    ds_read_b64_tr_b16 v[32:33], v3 offset:32768
    v_mfma_f32_16x16x32_bf16 v[76:79], v[36:39], v[212:215], v[76:79]
    ds_read_b64_tr_b16 v[34:35], v3 offset:33792
    s_waitcnt lgkmcnt(10)
    v_mfma_f32_16x16x32_bf16 v[80:83], v[40:43], v[208:211], v[80:83]
    ds_read_b64_tr_b16 v[36:37], v4 offset:32768
    v_mfma_f32_16x16x32_bf16 v[84:87], v[40:43], v[212:215], v[84:87]
    ds_read_b64_tr_b16 v[38:39], v4 offset:33792
    v_mfma_f32_16x16x32_bf16 v[88:91], v[44:47], v[208:211], v[88:91]
    ds_read_b64_tr_b16 v[40:41], v5 offset:32768
    v_mfma_f32_16x16x32_bf16 v[92:95], v[44:47], v[212:215], v[92:95]
    ds_read_b64_tr_b16 v[42:43], v5 offset:33792
    s_waitcnt lgkmcnt(10)
    v_mfma_f32_16x16x32_bf16 v[96:99], v[208:211], v[48:51], v[96:99]
    ds_read_b64_tr_b16 v[44:45], v6 offset:32768
    v_mfma_f32_16x16x32_bf16 v[100:103], v[212:215], v[48:51], v[100:103]
    ds_read_b64_tr_b16 v[46:47], v6 offset:33792
    v_mfma_f32_16x16x32_bf16 v[104:107], v[208:211], v[52:55], v[104:107]
    ds_read_b64_tr_b16 v[48:49], v3 offset:36864
    v_mfma_f32_16x16x32_bf16 v[108:111], v[212:215], v[52:55], v[108:111]
    ds_read_b64_tr_b16 v[50:51], v3 offset:37888
    s_waitcnt lgkmcnt(10)
    v_mfma_f32_16x16x32_bf16 v[112:115], v[208:211], v[56:59], v[112:115]
    ds_read_b64_tr_b16 v[52:53], v4 offset:36864
    v_mfma_f32_16x16x32_bf16 v[116:119], v[212:215], v[56:59], v[116:119]
    ds_read_b64_tr_b16 v[54:55], v4 offset:37888
    v_mfma_f32_16x16x32_bf16 v[120:123], v[208:211], v[60:63], v[120:123]
    ds_read_b64_tr_b16 v[56:57], v5 offset:36864
    v_mfma_f32_16x16x32_bf16 v[124:127], v[212:215], v[60:63], v[124:127]
    ds_read_b64_tr_b16 v[58:59], v5 offset:37888
    s_waitcnt lgkmcnt(10)
    v_mfma_f32_16x16x32_bf16 v[128:131], v[32:35], v[208:211], v[128:131]
    ds_read_b64_tr_b16 v[60:61], v6 offset:36864
    v_mfma_f32_16x16x32_bf16 v[132:135], v[32:35], v[212:215], v[132:135]
    ds_read_b64_tr_b16 v[62:63], v6 offset:37888
    v_mfma_f32_16x16x32_bf16 v[136:139], v[36:39], v[208:211], v[136:139]
    ds_read_b64_tr_b16 v[32:33], v3 offset:40960
    v_mfma_f32_16x16x32_bf16 v[140:143], v[36:39], v[212:215], v[140:143]
    ds_read_b64_tr_b16 v[34:35], v3 offset:41984
    s_waitcnt lgkmcnt(10)
    v_mfma_f32_16x16x32_bf16 v[144:147], v[40:43], v[208:211], v[144:147]
    ds_read_b64_tr_b16 v[36:37], v4 offset:40960
    v_mfma_f32_16x16x32_bf16 v[148:151], v[40:43], v[212:215], v[148:151]
    ds_read_b64_tr_b16 v[38:39], v4 offset:41984
    v_mfma_f32_16x16x32_bf16 v[152:155], v[44:47], v[208:211], v[152:155]
    ds_read_b64_tr_b16 v[40:41], v5 offset:40960
    v_mfma_f32_16x16x32_bf16 v[156:159], v[44:47], v[212:215], v[156:159]
    ds_read_b64_tr_b16 v[42:43], v5 offset:41984
    s_waitcnt vmcnt(18) lgkmcnt(10)
    v_mfma_f32_16x16x32_bf16 v[64:67], v[48:51], v[216:219], v[64:67]
    ds_read_b64_tr_b16 v[44:45], v6 offset:40960
    v_mfma_f32_16x16x32_bf16 v[68:71], v[48:51], v[220:223], v[68:71]
    ds_read_b64_tr_b16 v[46:47], v6 offset:41984
    v_mfma_f32_16x16x32_bf16 v[72:75], v[52:55], v[216:219], v[72:75]
    ds_read_b64_tr_b16 v[48:49], v3 offset:45056
    v_mfma_f32_16x16x32_bf16 v[76:79], v[52:55], v[220:223], v[76:79]
    ds_read_b64_tr_b16 v[50:51], v3 offset:46080
    s_waitcnt lgkmcnt(10)
    v_mfma_f32_16x16x32_bf16 v[80:83], v[56:59], v[216:219], v[80:83]
    ds_read_b64_tr_b16 v[52:53], v4 offset:45056
    v_mfma_f32_16x16x32_bf16 v[84:87], v[56:59], v[220:223], v[84:87]
    ds_read_b64_tr_b16 v[54:55], v4 offset:46080
    v_mfma_f32_16x16x32_bf16 v[88:91], v[60:63], v[216:219], v[88:91]
    ds_read_b64_tr_b16 v[56:57], v5 offset:45056
    v_mfma_f32_16x16x32_bf16 v[92:95], v[60:63], v[220:223], v[92:95]
    ds_read_b64_tr_b16 v[58:59], v5 offset:46080
    s_waitcnt lgkmcnt(10)
    v_mfma_f32_16x16x32_bf16 v[96:99], v[216:219], v[32:35], v[96:99]
    ds_read_b64_tr_b16 v[60:61], v6 offset:45056
    v_mfma_f32_16x16x32_bf16 v[100:103], v[220:223], v[32:35], v[100:103]
    ds_read_b64_tr_b16 v[62:63], v6 offset:46080
    v_mfma_f32_16x16x32_bf16 v[104:107], v[216:219], v[36:39], v[104:107]
    ds_read_b64_tr_b16 v[32:33], v3 offset:49152
    v_mfma_f32_16x16x32_bf16 v[108:111], v[220:223], v[36:39], v[108:111]
    ds_read_b64_tr_b16 v[34:35], v3 offset:50176
    s_waitcnt lgkmcnt(10)
    v_mfma_f32_16x16x32_bf16 v[112:115], v[216:219], v[40:43], v[112:115]
    ds_read_b64_tr_b16 v[36:37], v4 offset:49152
    v_mfma_f32_16x16x32_bf16 v[116:119], v[220:223], v[40:43], v[116:119]
    ds_read_b64_tr_b16 v[38:39], v4 offset:50176
    v_mfma_f32_16x16x32_bf16 v[120:123], v[216:219], v[44:47], v[120:123]
    ds_read_b64_tr_b16 v[40:41], v5 offset:49152
    v_mfma_f32_16x16x32_bf16 v[124:127], v[220:223], v[44:47], v[124:127]
    ds_read_b64_tr_b16 v[42:43], v5 offset:50176
    s_waitcnt lgkmcnt(10)
    v_mfma_f32_16x16x32_bf16 v[128:131], v[48:51], v[216:219], v[128:131]
    buffer_load_dwordx4 v[200:203], v2, s[4:7], s42 offen offset:2048 sc1
    ds_read_b64_tr_b16 v[44:45], v6 offset:49152
    v_mfma_f32_16x16x32_bf16 v[132:135], v[48:51], v[220:223], v[132:135]
    ds_read_b64_tr_b16 v[46:47], v6 offset:50176
    v_mfma_f32_16x16x32_bf16 v[136:139], v[52:55], v[216:219], v[136:139]
    buffer_load_dwordx4 v[204:207], v2, s[4:7], s42 offen offset:2304 sc1
    ds_read_b64_tr_b16 v[48:49], v3 offset:53248
    s_add_u32 s42, s41, s99
    v_mfma_f32_16x16x32_bf16 v[140:143], v[52:55], v[220:223], v[140:143]
    ds_read_b64_tr_b16 v[50:51], v3 offset:54272
    s_waitcnt lgkmcnt(10)
    v_mfma_f32_16x16x32_bf16 v[144:147], v[56:59], v[216:219], v[144:147]
    buffer_load_dwordx4 v[208:211], v2, s[4:7], s42 offen offset:0 sc1
    ds_read_b64_tr_b16 v[52:53], v4 offset:53248
    v_mfma_f32_16x16x32_bf16 v[148:151], v[56:59], v[220:223], v[148:151]
    ds_read_b64_tr_b16 v[54:55], v4 offset:54272
    v_mfma_f32_16x16x32_bf16 v[152:155], v[60:63], v[216:219], v[152:155]
    buffer_load_dwordx4 v[212:215], v2, s[4:7], s42 offen offset:256 sc1
    ds_read_b64_tr_b16 v[56:57], v5 offset:53248
    v_mfma_f32_16x16x32_bf16 v[156:159], v[60:63], v[220:223], v[156:159]
    ds_read_b64_tr_b16 v[58:59], v5 offset:54272
    s_waitcnt vmcnt(20) lgkmcnt(10)
    v_mfma_f32_16x16x32_bf16 v[64:67], v[32:35], v[224:227], v[64:67]
    ds_read_b64_tr_b16 v[60:61], v6 offset:53248
    buffer_load_dwordx4 v[216:219], v2, s[4:7], s42 offen offset:2048 sc1
    v_mfma_f32_16x16x32_bf16 v[68:71], v[32:35], v[228:231], v[68:71]
    ds_read_b64_tr_b16 v[62:63], v6 offset:54272
    v_mfma_f32_16x16x32_bf16 v[72:75], v[36:39], v[224:227], v[72:75]
    buffer_load_dwordx4 v[220:223], v2, s[4:7], s42 offen offset:2304 sc1
    ds_read_b64_tr_b16 v[32:33], v3 offset:57344
    v_mfma_f32_16x16x32_bf16 v[76:79], v[36:39], v[228:231], v[76:79]
    ds_read_b64_tr_b16 v[34:35], v3 offset:58368
    s_waitcnt lgkmcnt(10)
    v_mfma_f32_16x16x32_bf16 v[80:83], v[40:43], v[224:227], v[80:83]
    ds_read_b64_tr_b16 v[36:37], v4 offset:57344
    v_mfma_f32_16x16x32_bf16 v[84:87], v[40:43], v[228:231], v[84:87]
    ds_read_b64_tr_b16 v[38:39], v4 offset:58368
    v_mfma_f32_16x16x32_bf16 v[88:91], v[44:47], v[224:227], v[88:91]
    ds_read_b64_tr_b16 v[40:41], v5 offset:57344
    v_mfma_f32_16x16x32_bf16 v[92:95], v[44:47], v[228:231], v[92:95]
    ds_read_b64_tr_b16 v[42:43], v5 offset:58368
    s_waitcnt lgkmcnt(10)
    v_mfma_f32_16x16x32_bf16 v[96:99], v[224:227], v[48:51], v[96:99]
    ds_read_b64_tr_b16 v[44:45], v6 offset:57344
    v_mfma_f32_16x16x32_bf16 v[100:103], v[228:231], v[48:51], v[100:103]
    ds_read_b64_tr_b16 v[46:47], v6 offset:58368
    v_mfma_f32_16x16x32_bf16 v[104:107], v[224:227], v[52:55], v[104:107]
    ds_read_b64_tr_b16 v[48:49], v3 offset:61440
    v_mfma_f32_16x16x32_bf16 v[108:111], v[228:231], v[52:55], v[108:111]
    ds_read_b64_tr_b16 v[50:51], v3 offset:62464
    s_waitcnt lgkmcnt(10)
    v_mfma_f32_16x16x32_bf16 v[112:115], v[224:227], v[56:59], v[112:115]
    ds_read_b64_tr_b16 v[52:53], v4 offset:61440
    v_mfma_f32_16x16x32_bf16 v[116:119], v[228:231], v[56:59], v[116:119]
    ds_read_b64_tr_b16 v[54:55], v4 offset:62464
    v_mfma_f32_16x16x32_bf16 v[120:123], v[224:227], v[60:63], v[120:123]
    ds_read_b64_tr_b16 v[56:57], v5 offset:61440
    v_mfma_f32_16x16x32_bf16 v[124:127], v[228:231], v[60:63], v[124:127]
    ds_read_b64_tr_b16 v[58:59], v5 offset:62464
    s_waitcnt vmcnt(20) lgkmcnt(10)
    v_mfma_f32_16x16x32_bf16 v[64:67], v[32:35], v[232:235], v[64:67]
    ds_read_b64_tr_b16 v[60:61], v6 offset:61440
    v_mfma_f32_16x16x32_bf16 v[68:71], v[32:35], v[236:239], v[68:71]
    ds_read_b64_tr_b16 v[62:63], v6 offset:62464
    s_barrier
    v_xor_b32 v3, 0x10000, v3
    v_xor_b32 v4, 0x10000, v4
    v_xor_b32 v5, 0x10000, v5
    v_xor_b32 v6, 0x10000, v6
    v_mfma_f32_16x16x32_bf16 v[72:75], v[36:39], v[232:235], v[72:75]
    ds_read_b64_tr_b16 v[32:33], v3 offset:0
    v_mfma_f32_16x16x32_bf16 v[76:79], v[36:39], v[236:239], v[76:79]
    ds_read_b64_tr_b16 v[34:35], v3 offset:1024
    s_waitcnt lgkmcnt(10)
    v_mfma_f32_16x16x32_bf16 v[80:83], v[40:43], v[232:235], v[80:83]
    ds_read_b64_tr_b16 v[36:37], v4 offset:0
    v_mfma_f32_16x16x32_bf16 v[84:87], v[40:43], v[236:239], v[84:87]
    ds_read_b64_tr_b16 v[38:39], v4 offset:1024
    v_mfma_f32_16x16x32_bf16 v[88:91], v[44:47], v[232:235], v[88:91]
    ds_read_b64_tr_b16 v[40:41], v5 offset:0
    v_mfma_f32_16x16x32_bf16 v[92:95], v[44:47], v[236:239], v[92:95]
    ds_read_b64_tr_b16 v[42:43], v5 offset:1024
    s_waitcnt lgkmcnt(10)
    v_mfma_f32_16x16x32_bf16 v[96:99], v[232:235], v[48:51], v[96:99]
    ds_read_b64_tr_b16 v[44:45], v6 offset:0
    v_mfma_f32_16x16x32_bf16 v[100:103], v[236:239], v[48:51], v[100:103]
    ds_read_b64_tr_b16 v[46:47], v6 offset:1024
    v_mfma_f32_16x16x32_bf16 v[104:107], v[232:235], v[52:55], v[104:107]
    ds_read_b64_tr_b16 v[48:49], v3 offset:4096
    v_mfma_f32_16x16x32_bf16 v[108:111], v[236:239], v[52:55], v[108:111]
    ds_read_b64_tr_b16 v[50:51], v3 offset:5120
    s_waitcnt lgkmcnt(10)
    v_mfma_f32_16x16x32_bf16 v[112:115], v[232:235], v[56:59], v[112:115]
    ds_read_b64_tr_b16 v[52:53], v4 offset:4096
    v_mfma_f32_16x16x32_bf16 v[116:119], v[236:239], v[56:59], v[116:119]
    ds_read_b64_tr_b16 v[54:55], v4 offset:5120
    v_mfma_f32_16x16x32_bf16 v[120:123], v[232:235], v[60:63], v[120:123]
    ds_read_b64_tr_b16 v[56:57], v5 offset:4096
    v_mfma_f32_16x16x32_bf16 v[124:127], v[236:239], v[60:63], v[124:127]
    ds_read_b64_tr_b16 v[58:59], v5 offset:5120
    s_waitcnt vmcnt(18) lgkmcnt(10)
    v_mfma_f32_16x16x32_bf16 v[64:67], v[32:35], v[240:243], v[64:67]
    ds_read_b64_tr_b16 v[60:61], v6 offset:4096
    v_mfma_f32_16x16x32_bf16 v[68:71], v[32:35], v[244:247], v[68:71]
    ds_read_b64_tr_b16 v[62:63], v6 offset:5120
    v_mfma_f32_16x16x32_bf16 v[72:75], v[36:39], v[240:243], v[72:75]
    ds_read_b64_tr_b16 v[32:33], v3 offset:8192
    v_mfma_f32_16x16x32_bf16 v[76:79], v[36:39], v[244:247], v[76:79]
    ds_read_b64_tr_b16 v[34:35], v3 offset:9216
    s_waitcnt lgkmcnt(10)
    v_mfma_f32_16x16x32_bf16 v[80:83], v[40:43], v[240:243], v[80:83]
    ds_read_b64_tr_b16 v[36:37], v4 offset:8192
    v_mfma_f32_16x16x32_bf16 v[84:87], v[40:43], v[244:247], v[84:87]
    ds_read_b64_tr_b16 v[38:39], v4 offset:9216
    v_mfma_f32_16x16x32_bf16 v[88:91], v[44:47], v[240:243], v[88:91]
    ds_read_b64_tr_b16 v[40:41], v5 offset:8192
    v_mfma_f32_16x16x32_bf16 v[92:95], v[44:47], v[244:247], v[92:95]
    ds_read_b64_tr_b16 v[42:43], v5 offset:9216
    s_waitcnt lgkmcnt(10)
    v_mfma_f32_16x16x32_bf16 v[96:99], v[240:243], v[48:51], v[96:99]
    ds_read_b64_tr_b16 v[44:45], v6 offset:8192
    v_mfma_f32_16x16x32_bf16 v[100:103], v[244:247], v[48:51], v[100:103]
    ds_read_b64_tr_b16 v[46:47], v6 offset:9216
    v_mfma_f32_16x16x32_bf16 v[104:107], v[240:243], v[52:55], v[104:107]
    ds_read_b64_tr_b16 v[48:49], v3 offset:12288
    v_mfma_f32_16x16x32_bf16 v[108:111], v[244:247], v[52:55], v[108:111]
    ds_read_b64_tr_b16 v[50:51], v3 offset:13312
    s_waitcnt lgkmcnt(10)
    v_mfma_f32_16x16x32_bf16 v[112:115], v[240:243], v[56:59], v[112:115]
    ds_read_b64_tr_b16 v[52:53], v4 offset:12288
    v_mfma_f32_16x16x32_bf16 v[116:119], v[244:247], v[56:59], v[116:119]
    ds_read_b64_tr_b16 v[54:55], v4 offset:13312
    v_mfma_f32_16x16x32_bf16 v[120:123], v[240:243], v[60:63], v[120:123]
    ds_read_b64_tr_b16 v[56:57], v5 offset:12288
    v_mfma_f32_16x16x32_bf16 v[124:127], v[244:247], v[60:63], v[124:127]
    ds_read_b64_tr_b16 v[58:59], v5 offset:13312
    s_waitcnt vmcnt(16) lgkmcnt(10)
    v_mfma_f32_16x16x32_bf16 v[64:67], v[32:35], v[248:251], v[64:67]
    ds_read_b64_tr_b16 v[60:61], v6 offset:12288
    v_mfma_f32_16x16x32_bf16 v[68:71], v[32:35], v[252:255], v[68:71]
    ds_read_b64_tr_b16 v[62:63], v6 offset:13312
    v_mfma_f32_16x16x32_bf16 v[72:75], v[36:39], v[248:251], v[72:75]
    ds_read_b64_tr_b16 v[32:33], v3 offset:16384
    v_mfma_f32_16x16x32_bf16 v[76:79], v[36:39], v[252:255], v[76:79]
    ds_read_b64_tr_b16 v[34:35], v3 offset:17408
    s_waitcnt lgkmcnt(10)
    v_mfma_f32_16x16x32_bf16 v[80:83], v[40:43], v[248:251], v[80:83]
    ds_read_b64_tr_b16 v[36:37], v4 offset:16384
    v_mfma_f32_16x16x32_bf16 v[84:87], v[40:43], v[252:255], v[84:87]
    ds_read_b64_tr_b16 v[38:39], v4 offset:17408
    v_mfma_f32_16x16x32_bf16 v[88:91], v[44:47], v[248:251], v[88:91]
    ds_read_b64_tr_b16 v[40:41], v5 offset:16384
    v_mfma_f32_16x16x32_bf16 v[92:95], v[44:47], v[252:255], v[92:95]
    ds_read_b64_tr_b16 v[42:43], v5 offset:17408
    s_waitcnt lgkmcnt(10)
    v_mfma_f32_16x16x32_bf16 v[96:99], v[248:251], v[48:51], v[96:99]
    ds_read_b64_tr_b16 v[44:45], v6 offset:16384
    v_mfma_f32_16x16x32_bf16 v[100:103], v[252:255], v[48:51], v[100:103]
    ds_read_b64_tr_b16 v[46:47], v6 offset:17408
    v_mfma_f32_16x16x32_bf16 v[104:107], v[248:251], v[52:55], v[104:107]
    ds_read_b64_tr_b16 v[48:49], v3 offset:20480
    v_mfma_f32_16x16x32_bf16 v[108:111], v[252:255], v[52:55], v[108:111]
    ds_read_b64_tr_b16 v[50:51], v3 offset:21504
    s_waitcnt lgkmcnt(10)
    v_mfma_f32_16x16x32_bf16 v[112:115], v[248:251], v[56:59], v[112:115]
    ds_read_b64_tr_b16 v[52:53], v4 offset:20480
    v_mfma_f32_16x16x32_bf16 v[116:119], v[252:255], v[56:59], v[116:119]
    ds_read_b64_tr_b16 v[54:55], v4 offset:21504
    v_mfma_f32_16x16x32_bf16 v[120:123], v[248:251], v[60:63], v[120:123]
    ds_read_b64_tr_b16 v[56:57], v5 offset:20480
    v_mfma_f32_16x16x32_bf16 v[124:127], v[252:255], v[60:63], v[124:127]
    ds_read_b64_tr_b16 v[58:59], v5 offset:21504
    s_waitcnt vmcnt(14) lgkmcnt(10)
    v_mfma_f32_16x16x32_bf16 v[64:67], v[32:35], v[160:163], v[64:67]
    ds_read_b64_tr_b16 v[60:61], v6 offset:20480
    v_mfma_f32_16x16x32_bf16 v[68:71], v[32:35], v[164:167], v[68:71]
    ds_read_b64_tr_b16 v[62:63], v6 offset:21504
    v_mfma_f32_16x16x32_bf16 v[72:75], v[36:39], v[160:163], v[72:75]
    ds_read_b64_tr_b16 v[32:33], v3 offset:24576
    v_mfma_f32_16x16x32_bf16 v[76:79], v[36:39], v[164:167], v[76:79]
    ds_read_b64_tr_b16 v[34:35], v3 offset:25600
    s_waitcnt lgkmcnt(10)
    v_mfma_f32_16x16x32_bf16 v[80:83], v[40:43], v[160:163], v[80:83]
    ds_read_b64_tr_b16 v[36:37], v4 offset:24576
    v_mfma_f32_16x16x32_bf16 v[84:87], v[40:43], v[164:167], v[84:87]
    ds_read_b64_tr_b16 v[38:39], v4 offset:25600
    v_mfma_f32_16x16x32_bf16 v[88:91], v[44:47], v[160:163], v[88:91]
    ds_read_b64_tr_b16 v[40:41], v5 offset:24576
    v_mfma_f32_16x16x32_bf16 v[92:95], v[44:47], v[164:167], v[92:95]
    ds_read_b64_tr_b16 v[42:43], v5 offset:25600
    s_waitcnt vmcnt(12) lgkmcnt(10)
    v_mfma_f32_16x16x32_bf16 v[64:67], v[48:51], v[168:171], v[64:67]
    ds_read_b64_tr_b16 v[44:45], v6 offset:24576
    v_mfma_f32_16x16x32_bf16 v[68:71], v[48:51], v[172:175], v[68:71]
    ds_read_b64_tr_b16 v[46:47], v6 offset:25600
    v_mfma_f32_16x16x32_bf16 v[72:75], v[52:55], v[168:171], v[72:75]
    ds_read_b64_tr_b16 v[48:49], v3 offset:28672
    v_mfma_f32_16x16x32_bf16 v[76:79], v[52:55], v[172:175], v[76:79]
    ds_read_b64_tr_b16 v[50:51], v3 offset:29696
    s_waitcnt lgkmcnt(10)
    v_mfma_f32_16x16x32_bf16 v[80:83], v[56:59], v[168:171], v[80:83]
    ds_read_b64_tr_b16 v[52:53], v4 offset:28672
    v_mfma_f32_16x16x32_bf16 v[84:87], v[56:59], v[172:175], v[84:87]
    ds_read_b64_tr_b16 v[54:55], v4 offset:29696
    v_mfma_f32_16x16x32_bf16 v[88:91], v[60:63], v[168:171], v[88:91]
    ds_read_b64_tr_b16 v[56:57], v5 offset:28672
    v_mfma_f32_16x16x32_bf16 v[92:95], v[60:63], v[172:175], v[92:95]
    ds_read_b64_tr_b16 v[58:59], v5 offset:29696
    s_waitcnt vmcnt(10) lgkmcnt(10)
    v_mfma_f32_16x16x32_bf16 v[64:67], v[32:35], v[176:179], v[64:67]
    ds_read_b64_tr_b16 v[60:61], v6 offset:28672
    v_mfma_f32_16x16x32_bf16 v[68:71], v[32:35], v[180:183], v[68:71]
    ds_read_b64_tr_b16 v[62:63], v6 offset:29696
    s_barrier
    v_mfma_f32_16x16x32_bf16 v[72:75], v[36:39], v[176:179], v[72:75]
    ds_read_b64_tr_b16 v[32:33], v3 offset:32768
    v_mfma_f32_16x16x32_bf16 v[76:79], v[36:39], v[180:183], v[76:79]
    ds_read_b64_tr_b16 v[34:35], v3 offset:33792
    s_waitcnt lgkmcnt(10)
    v_mfma_f32_16x16x32_bf16 v[80:83], v[40:43], v[176:179], v[80:83]
    ds_read_b64_tr_b16 v[36:37], v4 offset:32768
    v_mfma_f32_16x16x32_bf16 v[84:87], v[40:43], v[180:183], v[84:87]
    ds_read_b64_tr_b16 v[38:39], v4 offset:33792
    v_mfma_f32_16x16x32_bf16 v[88:91], v[44:47], v[176:179], v[88:91]
    ds_read_b64_tr_b16 v[40:41], v5 offset:32768
    v_mfma_f32_16x16x32_bf16 v[92:95], v[44:47], v[180:183], v[92:95]
    ds_read_b64_tr_b16 v[42:43], v5 offset:33792
    s_waitcnt vmcnt(8) lgkmcnt(10)
    v_mfma_f32_16x16x32_bf16 v[64:67], v[48:51], v[184:187], v[64:67]
    ds_read_b64_tr_b16 v[44:45], v6 offset:32768
    v_mfma_f32_16x16x32_bf16 v[68:71], v[48:51], v[188:191], v[68:71]
    ds_read_b64_tr_b16 v[46:47], v6 offset:33792
    v_mfma_f32_16x16x32_bf16 v[72:75], v[52:55], v[184:187], v[72:75]
    ds_read_b64_tr_b16 v[48:49], v3 offset:36864
    v_mfma_f32_16x16x32_bf16 v[76:79], v[52:55], v[188:191], v[76:79]
    ds_read_b64_tr_b16 v[50:51], v3 offset:37888
    s_waitcnt lgkmcnt(10)
    v_mfma_f32_16x16x32_bf16 v[80:83], v[56:59], v[184:187], v[80:83]
    ds_read_b64_tr_b16 v[52:53], v4 offset:36864
    v_mfma_f32_16x16x32_bf16 v[84:87], v[56:59], v[188:191], v[84:87]
    ds_read_b64_tr_b16 v[54:55], v4 offset:37888
    v_mfma_f32_16x16x32_bf16 v[88:91], v[60:63], v[184:187], v[88:91]
    ds_read_b64_tr_b16 v[56:57], v5 offset:36864
    v_mfma_f32_16x16x32_bf16 v[92:95], v[60:63], v[188:191], v[92:95]
    ds_read_b64_tr_b16 v[58:59], v5 offset:37888
    s_waitcnt vmcnt(6) lgkmcnt(10)
    v_mfma_f32_16x16x32_bf16 v[64:67], v[32:35], v[192:195], v[64:67]
    ds_read_b64_tr_b16 v[60:61], v6 offset:36864
    v_mfma_f32_16x16x32_bf16 v[68:71], v[32:35], v[196:199], v[68:71]
    ds_read_b64_tr_b16 v[62:63], v6 offset:37888
    v_mfma_f32_16x16x32_bf16 v[72:75], v[36:39], v[192:195], v[72:75]
    ds_read_b64_tr_b16 v[32:33], v3 offset:40960
    v_mfma_f32_16x16x32_bf16 v[76:79], v[36:39], v[196:199], v[76:79]
    ds_read_b64_tr_b16 v[34:35], v3 offset:41984
    s_waitcnt lgkmcnt(10)
    v_mfma_f32_16x16x32_bf16 v[80:83], v[40:43], v[192:195], v[80:83]
    ds_read_b64_tr_b16 v[36:37], v4 offset:40960
    v_mfma_f32_16x16x32_bf16 v[84:87], v[40:43], v[196:199], v[84:87]
    ds_read_b64_tr_b16 v[38:39], v4 offset:41984
    v_mfma_f32_16x16x32_bf16 v[88:91], v[44:47], v[192:195], v[88:91]
    ds_read_b64_tr_b16 v[40:41], v5 offset:40960
    v_mfma_f32_16x16x32_bf16 v[92:95], v[44:47], v[196:199], v[92:95]
    ds_read_b64_tr_b16 v[42:43], v5 offset:41984
    s_waitcnt vmcnt(4) lgkmcnt(10)
    v_mfma_f32_16x16x32_bf16 v[64:67], v[48:51], v[200:203], v[64:67]
    ds_read_b64_tr_b16 v[44:45], v6 offset:40960
    v_mfma_f32_16x16x32_bf16 v[68:71], v[48:51], v[204:207], v[68:71]
    ds_read_b64_tr_b16 v[46:47], v6 offset:41984
    v_mfma_f32_16x16x32_bf16 v[72:75], v[52:55], v[200:203], v[72:75]
    ds_read_b64_tr_b16 v[48:49], v3 offset:45056
    v_mfma_f32_16x16x32_bf16 v[76:79], v[52:55], v[204:207], v[76:79]
    ds_read_b64_tr_b16 v[50:51], v3 offset:46080
    s_waitcnt lgkmcnt(10)
    v_mfma_f32_16x16x32_bf16 v[80:83], v[56:59], v[200:203], v[80:83]
    ds_read_b64_tr_b16 v[52:53], v4 offset:45056
    v_mfma_f32_16x16x32_bf16 v[84:87], v[56:59], v[204:207], v[84:87]
    ds_read_b64_tr_b16 v[54:55], v4 offset:46080
    v_mfma_f32_16x16x32_bf16 v[88:91], v[60:63], v[200:203], v[88:91]
    ds_read_b64_tr_b16 v[56:57], v5 offset:45056
    v_mfma_f32_16x16x32_bf16 v[92:95], v[60:63], v[204:207], v[92:95]
    ds_read_b64_tr_b16 v[58:59], v5 offset:46080
    s_waitcnt vmcnt(2) lgkmcnt(10)
    v_mfma_f32_16x16x32_bf16 v[64:67], v[32:35], v[208:211], v[64:67]
    ds_read_b64_tr_b16 v[60:61], v6 offset:45056
    v_mfma_f32_16x16x32_bf16 v[68:71], v[32:35], v[212:215], v[68:71]
    ds_read_b64_tr_b16 v[62:63], v6 offset:46080
    v_mfma_f32_16x16x32_bf16 v[72:75], v[36:39], v[208:211], v[72:75]
    ds_read_b64_tr_b16 v[32:33], v3 offset:49152
    ds_read_b32 v8, v9 offset:4096
    v_mfma_f32_16x16x32_bf16 v[76:79], v[36:39], v[212:215], v[76:79]
    ds_read_b64_tr_b16 v[34:35], v3 offset:50176
    ds_read_b32 v10, v9 offset:4608
    s_waitcnt lgkmcnt(12)
    v_mfma_f32_16x16x32_bf16 v[80:83], v[40:43], v[208:211], v[80:83]
    ds_read_b64_tr_b16 v[36:37], v4 offset:49152
    ds_read_b32 v12, v9 offset:4160
    v_mfma_f32_16x16x32_bf16 v[84:87], v[40:43], v[212:215], v[84:87]
    ds_read_b64_tr_b16 v[38:39], v4 offset:50176
    ds_read_b32 v14, v9 offset:4672
    v_mfma_f32_16x16x32_bf16 v[88:91], v[44:47], v[208:211], v[88:91]
    ds_read_b64_tr_b16 v[40:41], v5 offset:49152
    ds_read_b128 v[16:19], v11 offset:256
    v_mfma_f32_16x16x32_bf16 v[92:95], v[44:47], v[212:215], v[92:95]
    ds_read_b64_tr_b16 v[42:43], v5 offset:50176
    ds_read_b128 v[20:23], v11 offset:320
    s_waitcnt vmcnt(0) lgkmcnt(14)
    v_mfma_f32_16x16x32_bf16 v[64:67], v[48:51], v[216:219], v[64:67]
    ds_read_b64_tr_b16 v[44:45], v6 offset:49152
    ds_read_b128 v[24:27], v11 offset:384
    v_mfma_f32_16x16x32_bf16 v[68:71], v[48:51], v[220:223], v[68:71]
    ds_read_b64_tr_b16 v[46:47], v6 offset:50176
    ds_read_b128 v[28:31], v11 offset:448
    v_mfma_f32_16x16x32_bf16 v[72:75], v[52:55], v[216:219], v[72:75]
    ds_read_b64_tr_b16 v[48:49], v3 offset:53248
    v_mfma_f32_16x16x32_bf16 v[76:79], v[52:55], v[220:223], v[76:79]
    ds_read_b64_tr_b16 v[50:51], v3 offset:54272
    s_waitcnt lgkmcnt(14)
    v_mfma_f32_16x16x32_bf16 v[80:83], v[56:59], v[216:219], v[80:83]
    ds_read_b64_tr_b16 v[52:53], v4 offset:53248
    v_mfma_f32_16x16x32_bf16 v[84:87], v[56:59], v[220:223], v[84:87]
    ds_read_b64_tr_b16 v[54:55], v4 offset:54272
    v_mfma_f32_16x16x32_bf16 v[88:91], v[60:63], v[216:219], v[88:91]
    ds_read_b64_tr_b16 v[56:57], v5 offset:53248
    v_mfma_f32_16x16x32_bf16 v[92:95], v[60:63], v[220:223], v[92:95]
    ds_read_b64_tr_b16 v[58:59], v5 offset:54272
    s_bitcmp1_b32 s21, 0
    s_cbranch_scc1 c_B
    v_add_u32 v7, s62, v1
    s_waitcnt lgkmcnt(6)
    v_pk_fma_f32 v[68:69], v[12:13], v[16:17], v[68:69] op_sel_hi:[0,1,1] neg_lo:[1,0,0] neg_hi:[1,0,0]
    v_pk_fma_f32 v[70:71], v[12:13], v[18:19], v[70:71] op_sel_hi:[0,1,1] neg_lo:[1,0,0] neg_hi:[1,0,0]
    v_pk_fma_f32 v[76:77], v[12:13], v[20:21], v[76:77] op_sel_hi:[0,1,1] neg_lo:[1,0,0] neg_hi:[1,0,0]
    v_pk_fma_f32 v[78:79], v[12:13], v[22:23], v[78:79] op_sel_hi:[0,1,1] neg_lo:[1,0,0] neg_hi:[1,0,0]
    v_pk_mul_f32 v[68:69], v[14:15], v[68:69] op_sel_hi:[0,1]
    v_pk_mul_f32 v[70:71], v[14:15], v[70:71] op_sel_hi:[0,1]
    v_pk_mul_f32 v[76:77], v[14:15], v[76:77] op_sel_hi:[0,1]
    v_pk_mul_f32 v[78:79], v[14:15], v[78:79] op_sel_hi:[0,1]
    v_cvt_pk_bf16_f32 v68, v68, v69
    v_cvt_pk_bf16_f32 v69, v70, v71
    v_cvt_pk_bf16_f32 v70, v76, v77
    v_cvt_pk_bf16_f32 v71, v78, v79
    ds_write_b128 v7, v[68:71] offset:4096
    v_pk_fma_f32 v[64:65], v[8:9], v[16:17], v[64:65] op_sel_hi:[0,1,1] neg_lo:[1,0,0] neg_hi:[1,0,0]
    v_pk_fma_f32 v[66:67], v[8:9], v[18:19], v[66:67] op_sel_hi:[0,1,1] neg_lo:[1,0,0] neg_hi:[1,0,0]
    v_pk_fma_f32 v[72:73], v[8:9], v[20:21], v[72:73] op_sel_hi:[0,1,1] neg_lo:[1,0,0] neg_hi:[1,0,0]
    v_pk_fma_f32 v[74:75], v[8:9], v[22:23], v[74:75] op_sel_hi:[0,1,1] neg_lo:[1,0,0] neg_hi:[1,0,0]
    v_pk_mul_f32 v[64:65], v[10:11], v[64:65] op_sel_hi:[0,1]
    v_pk_mul_f32 v[66:67], v[10:11], v[66:67] op_sel_hi:[0,1]
    v_pk_mul_f32 v[72:73], v[10:11], v[72:73] op_sel_hi:[0,1]
    v_pk_mul_f32 v[74:75], v[10:11], v[74:75] op_sel_hi:[0,1]
    v_cvt_pk_bf16_f32 v64, v64, v65
    v_cvt_pk_bf16_f32 v65, v66, v67
    v_cvt_pk_bf16_f32 v66, v72, v73
    v_cvt_pk_bf16_f32 v67, v74, v75
    v_pk_fma_f32 v[84:85], v[12:13], v[24:25], v[84:85] op_sel_hi:[0,1,1] neg_lo:[1,0,0] neg_hi:[1,0,0]
    v_pk_fma_f32 v[86:87], v[12:13], v[26:27], v[86:87] op_sel_hi:[0,1,1] neg_lo:[1,0,0] neg_hi:[1,0,0]
    v_pk_fma_f32 v[92:93], v[12:13], v[28:29], v[92:93] op_sel_hi:[0,1,1] neg_lo:[1,0,0] neg_hi:[1,0,0]
    v_pk_fma_f32 v[94:95], v[12:13], v[30:31], v[94:95] op_sel_hi:[0,1,1] neg_lo:[1,0,0] neg_hi:[1,0,0]
    v_pk_mul_f32 v[84:85], v[14:15], v[84:85] op_sel_hi:[0,1]
    v_pk_mul_f32 v[86:87], v[14:15], v[86:87] op_sel_hi:[0,1]
    v_pk_mul_f32 v[92:93], v[14:15], v[92:93] op_sel_hi:[0,1]
    v_pk_mul_f32 v[94:95], v[14:15], v[94:95] op_sel_hi:[0,1]
    v_cvt_pk_bf16_f32 v84, v84, v85
    v_cvt_pk_bf16_f32 v85, v86, v87
    v_cvt_pk_bf16_f32 v86, v92, v93
    v_cvt_pk_bf16_f32 v87, v94, v95
    ds_write_b128 v7, v[84:87] offset:5120
    v_pk_fma_f32 v[80:81], v[8:9], v[24:25], v[80:81] op_sel_hi:[0,1,1] neg_lo:[1,0,0] neg_hi:[1,0,0]
    v_pk_fma_f32 v[82:83], v[8:9], v[26:27], v[82:83] op_sel_hi:[0,1,1] neg_lo:[1,0,0] neg_hi:[1,0,0]
    v_pk_fma_f32 v[88:89], v[8:9], v[28:29], v[88:89] op_sel_hi:[0,1,1] neg_lo:[1,0,0] neg_hi:[1,0,0]
    v_pk_fma_f32 v[90:91], v[8:9], v[30:31], v[90:91] op_sel_hi:[0,1,1] neg_lo:[1,0,0] neg_hi:[1,0,0]
    v_pk_mul_f32 v[80:81], v[10:11], v[80:81] op_sel_hi:[0,1]
    v_pk_mul_f32 v[82:83], v[10:11], v[82:83] op_sel_hi:[0,1]
    v_pk_mul_f32 v[88:89], v[10:11], v[88:89] op_sel_hi:[0,1]
    v_pk_mul_f32 v[90:91], v[10:11], v[90:91] op_sel_hi:[0,1]
    v_cvt_pk_bf16_f32 v80, v80, v81
    v_cvt_pk_bf16_f32 v81, v82, v83
    v_cvt_pk_bf16_f32 v82, v88, v89
    v_cvt_pk_bf16_f32 v83, v90, v91
    v_mfma_f32_16x16x32_bf16 v[96:99], v[160:163], v[32:35], v[96:99]
    ds_read_b64_tr_b16 v[60:61], v6 offset:53248
    v_mfma_f32_16x16x32_bf16 v[100:103], v[164:167], v[32:35], v[100:103]
    ds_read_b64_tr_b16 v[62:63], v6 offset:54272
    v_mfma_f32_16x16x32_bf16 v[104:107], v[160:163], v[36:39], v[104:107]
    ds_read_b64_tr_b16 v[32:33], v3 offset:57344
    v_mfma_f32_16x16x32_bf16 v[108:111], v[164:167], v[36:39], v[108:111]
    ds_read_b64_tr_b16 v[34:35], v3 offset:58368
    v_mfma_f32_16x16x32_bf16 v[112:115], v[160:163], v[40:43], v[112:115]
    ds_read_b64_tr_b16 v[36:37], v4 offset:57344
    v_mfma_f32_16x16x32_bf16 v[116:119], v[164:167], v[40:43], v[116:119]
    ds_read_b64_tr_b16 v[38:39], v4 offset:58368
    v_mfma_f32_16x16x32_bf16 v[120:123], v[160:163], v[44:47], v[120:123]
    ds_read_b64_tr_b16 v[40:41], v5 offset:57344
    v_mfma_f32_16x16x32_bf16 v[124:127], v[164:167], v[44:47], v[124:127]
    ds_read_b64_tr_b16 v[42:43], v5 offset:58368
    s_waitcnt lgkmcnt(12)
    v_mfma_f32_16x16x32_bf16 v[96:99], v[168:171], v[48:51], v[96:99]
    ds_read_b64_tr_b16 v[44:45], v6 offset:57344
    v_mfma_f32_16x16x32_bf16 v[100:103], v[172:175], v[48:51], v[100:103]
    ds_read_b64_tr_b16 v[46:47], v6 offset:58368
    v_mfma_f32_16x16x32_bf16 v[104:107], v[168:171], v[52:55], v[104:107]
    ds_read_b64_tr_b16 v[48:49], v3 offset:61440
    v_mfma_f32_16x16x32_bf16 v[108:111], v[172:175], v[52:55], v[108:111]
    ds_read_b64_tr_b16 v[50:51], v3 offset:62464
    s_waitcnt lgkmcnt(10)
    v_mfma_f32_16x16x32_bf16 v[112:115], v[168:171], v[56:59], v[112:115]
    ds_read_b64_tr_b16 v[52:53], v4 offset:61440
    v_mfma_f32_16x16x32_bf16 v[116:119], v[172:175], v[56:59], v[116:119]
    ds_read_b64_tr_b16 v[54:55], v4 offset:62464
    v_mfma_f32_16x16x32_bf16 v[120:123], v[168:171], v[60:63], v[120:123]
    ds_read_b64_tr_b16 v[56:57], v5 offset:61440
    v_mfma_f32_16x16x32_bf16 v[124:127], v[172:175], v[60:63], v[124:127]
    ds_read_b64_tr_b16 v[58:59], v5 offset:62464
    s_waitcnt lgkmcnt(10)
    v_mfma_f32_16x16x32_bf16 v[96:99], v[176:179], v[32:35], v[96:99]
    ds_read_b64_tr_b16 v[60:61], v6 offset:61440
    v_mfma_f32_16x16x32_bf16 v[100:103], v[180:183], v[32:35], v[100:103]
    ds_read_b64_tr_b16 v[62:63], v6 offset:62464
    s_barrier
    v_xor_b32 v3, 0x10000, v3
    v_xor_b32 v4, 0x10000, v4
    v_xor_b32 v5, 0x10000, v5
    v_xor_b32 v6, 0x10000, v6
    v_mfma_f32_16x16x32_bf16 v[104:107], v[176:179], v[36:39], v[104:107]
    ds_read_b64_tr_b16 v[32:33], v3 offset:0
    v_mfma_f32_16x16x32_bf16 v[108:111], v[180:183], v[36:39], v[108:111]
    ds_read_b64_tr_b16 v[34:35], v3 offset:1024
    s_waitcnt lgkmcnt(10)
    v_mfma_f32_16x16x32_bf16 v[112:115], v[176:179], v[40:43], v[112:115]
    ds_read_b64_tr_b16 v[36:37], v4 offset:0
    v_mfma_f32_16x16x32_bf16 v[116:119], v[180:183], v[40:43], v[116:119]
    ds_read_b64_tr_b16 v[38:39], v4 offset:1024
    v_mfma_f32_16x16x32_bf16 v[120:123], v[176:179], v[44:47], v[120:123]
    ds_read_b64_tr_b16 v[40:41], v5 offset:0
    v_mfma_f32_16x16x32_bf16 v[124:127], v[180:183], v[44:47], v[124:127]
    ds_read_b64_tr_b16 v[42:43], v5 offset:1024
    s_waitcnt lgkmcnt(10)
    v_mfma_f32_16x16x32_bf16 v[96:99], v[184:187], v[48:51], v[96:99]
    ds_read_b64_tr_b16 v[44:45], v6 offset:0
    v_mfma_f32_16x16x32_bf16 v[100:103], v[188:191], v[48:51], v[100:103]
    ds_read_b64_tr_b16 v[46:47], v6 offset:1024
    v_mfma_f32_16x16x32_bf16 v[104:107], v[184:187], v[52:55], v[104:107]
    ds_read_b64_tr_b16 v[48:49], v3 offset:4096
    v_mfma_f32_16x16x32_bf16 v[108:111], v[188:191], v[52:55], v[108:111]
    ds_read_b64_tr_b16 v[50:51], v3 offset:5120
    s_waitcnt lgkmcnt(10)
    v_mfma_f32_16x16x32_bf16 v[112:115], v[184:187], v[56:59], v[112:115]
    ds_read_b64_tr_b16 v[52:53], v4 offset:4096
    v_mfma_f32_16x16x32_bf16 v[116:119], v[188:191], v[56:59], v[116:119]
    ds_read_b64_tr_b16 v[54:55], v4 offset:5120
    v_mfma_f32_16x16x32_bf16 v[120:123], v[184:187], v[60:63], v[120:123]
    ds_read_b64_tr_b16 v[56:57], v5 offset:4096
    v_mfma_f32_16x16x32_bf16 v[124:127], v[188:191], v[60:63], v[124:127]
    ds_read_b64_tr_b16 v[58:59], v5 offset:5120
    s_waitcnt lgkmcnt(10)
    v_mfma_f32_16x16x32_bf16 v[96:99], v[192:195], v[32:35], v[96:99]
    ds_read_b64_tr_b16 v[60:61], v6 offset:4096
    v_mfma_f32_16x16x32_bf16 v[100:103], v[196:199], v[32:35], v[100:103]
    ds_read_b64_tr_b16 v[62:63], v6 offset:5120
    v_mfma_f32_16x16x32_bf16 v[104:107], v[192:195], v[36:39], v[104:107]
    ds_read_b64_tr_b16 v[32:33], v3 offset:8192
    v_mfma_f32_16x16x32_bf16 v[108:111], v[196:199], v[36:39], v[108:111]
    ds_read_b64_tr_b16 v[34:35], v3 offset:9216
    s_waitcnt lgkmcnt(10)
    v_mfma_f32_16x16x32_bf16 v[112:115], v[192:195], v[40:43], v[112:115]
    ds_read_b64_tr_b16 v[36:37], v4 offset:8192
    v_mfma_f32_16x16x32_bf16 v[116:119], v[196:199], v[40:43], v[116:119]
    ds_read_b64_tr_b16 v[38:39], v4 offset:9216
    v_mfma_f32_16x16x32_bf16 v[120:123], v[192:195], v[44:47], v[120:123]
    ds_read_b64_tr_b16 v[40:41], v5 offset:8192
    v_mfma_f32_16x16x32_bf16 v[124:127], v[196:199], v[44:47], v[124:127]
    ds_read_b64_tr_b16 v[42:43], v5 offset:9216
    s_waitcnt lgkmcnt(10)
    v_mfma_f32_16x16x32_bf16 v[96:99], v[200:203], v[48:51], v[96:99]
    ds_read_b64_tr_b16 v[44:45], v6 offset:8192
    v_mfma_f32_16x16x32_bf16 v[100:103], v[204:207], v[48:51], v[100:103]
    ds_read_b64_tr_b16 v[46:47], v6 offset:9216
    v_mfma_f32_16x16x32_bf16 v[104:107], v[200:203], v[52:55], v[104:107]
    ds_read_b64_tr_b16 v[48:49], v3 offset:12288
    v_mfma_f32_16x16x32_bf16 v[108:111], v[204:207], v[52:55], v[108:111]
    ds_read_b64_tr_b16 v[50:51], v3 offset:13312
    s_waitcnt lgkmcnt(10)
    v_mfma_f32_16x16x32_bf16 v[112:115], v[200:203], v[56:59], v[112:115]
    ds_read_b64_tr_b16 v[52:53], v4 offset:12288
    v_mfma_f32_16x16x32_bf16 v[116:119], v[204:207], v[56:59], v[116:119]
    ds_read_b64_tr_b16 v[54:55], v4 offset:13312
    v_mfma_f32_16x16x32_bf16 v[120:123], v[200:203], v[60:63], v[120:123]
    ds_read_b64_tr_b16 v[56:57], v5 offset:12288
    v_mfma_f32_16x16x32_bf16 v[124:127], v[204:207], v[60:63], v[124:127]
    ds_read_b64_tr_b16 v[58:59], v5 offset:13312
    s_waitcnt lgkmcnt(10)
    v_mfma_f32_16x16x32_bf16 v[96:99], v[208:211], v[32:35], v[96:99]
    ds_read_b64_tr_b16 v[60:61], v6 offset:12288
    v_mfma_f32_16x16x32_bf16 v[100:103], v[212:215], v[32:35], v[100:103]
    ds_read_b64_tr_b16 v[62:63], v6 offset:13312
    v_mfma_f32_16x16x32_bf16 v[104:107], v[208:211], v[36:39], v[104:107]
    ds_read_b64_tr_b16 v[32:33], v3 offset:16384
    ds_read_b128 v[16:19], v13 offset:4096
    v_mfma_f32_16x16x32_bf16 v[108:111], v[212:215], v[36:39], v[108:111]
    ds_read_b64_tr_b16 v[34:35], v3 offset:17408
    ds_read_b128 v[20:23], v13 offset:4608
    s_waitcnt lgkmcnt(12)
    v_mfma_f32_16x16x32_bf16 v[112:115], v[208:211], v[40:43], v[112:115]
    ds_read_b64_tr_b16 v[36:37], v4 offset:16384
    ds_read_b128 v[24:27], v13 offset:4160
    v_mfma_f32_16x16x32_bf16 v[116:119], v[212:215], v[40:43], v[116:119]
    ds_read_b64_tr_b16 v[38:39], v4 offset:17408
    ds_read_b128 v[28:31], v13 offset:4672
    v_mfma_f32_16x16x32_bf16 v[120:123], v[208:211], v[44:47], v[120:123]
    ds_read_b64_tr_b16 v[40:41], v5 offset:16384
    ds_read_b32 v8, v15 offset:512
    v_mfma_f32_16x16x32_bf16 v[124:127], v[212:215], v[44:47], v[124:127]
    ds_read_b64_tr_b16 v[42:43], v5 offset:17408
    ds_read_b32 v10, v15 offset:576
    s_waitcnt lgkmcnt(14)
    v_mfma_f32_16x16x32_bf16 v[96:99], v[216:219], v[48:51], v[96:99]
    ds_read_b64_tr_b16 v[44:45], v6 offset:16384
    ds_read_b32 v12, v15 offset:640
    v_mfma_f32_16x16x32_bf16 v[100:103], v[220:223], v[48:51], v[100:103]
    ds_read_b64_tr_b16 v[46:47], v6 offset:17408
    ds_read_b32 v14, v15 offset:704
    v_mfma_f32_16x16x32_bf16 v[104:107], v[216:219], v[52:55], v[104:107]
    ds_read_b64_tr_b16 v[48:49], v3 offset:20480
    v_mfma_f32_16x16x32_bf16 v[108:111], v[220:223], v[52:55], v[108:111]
    ds_read_b64_tr_b16 v[50:51], v3 offset:21504
    s_waitcnt lgkmcnt(14)
    v_mfma_f32_16x16x32_bf16 v[112:115], v[216:219], v[56:59], v[112:115]
    ds_read_b64_tr_b16 v[52:53], v4 offset:20480
    v_mfma_f32_16x16x32_bf16 v[116:119], v[220:223], v[56:59], v[116:119]
    ds_read_b64_tr_b16 v[54:55], v4 offset:21504
    v_mfma_f32_16x16x32_bf16 v[120:123], v[216:219], v[60:63], v[120:123]
    ds_read_b64_tr_b16 v[56:57], v5 offset:20480
    v_mfma_f32_16x16x32_bf16 v[124:127], v[220:223], v[60:63], v[124:127]
    ds_read_b64_tr_b16 v[58:59], v5 offset:21504
    s_waitcnt lgkmcnt(6)
    v_pk_fma_f32 v[100:101], v[8:9], v[24:25], v[100:101] op_sel_hi:[0,1,1] neg_lo:[1,0,0] neg_hi:[1,0,0]
    v_pk_fma_f32 v[102:103], v[8:9], v[26:27], v[102:103] op_sel_hi:[0,1,1] neg_lo:[1,0,0] neg_hi:[1,0,0]
    v_pk_fma_f32 v[108:109], v[10:11], v[24:25], v[108:109] op_sel_hi:[0,1,1] neg_lo:[1,0,0] neg_hi:[1,0,0]
    v_pk_fma_f32 v[110:111], v[10:11], v[26:27], v[110:111] op_sel_hi:[0,1,1] neg_lo:[1,0,0] neg_hi:[1,0,0]
    v_pk_mul_f32 v[100:101], v[28:29], v[100:101]
    v_pk_mul_f32 v[102:103], v[30:31], v[102:103]
    v_pk_mul_f32 v[108:109], v[28:29], v[108:109]
    v_pk_mul_f32 v[110:111], v[30:31], v[110:111]
    v_cvt_pk_bf16_f32 v74, v100, v101
    v_cvt_pk_bf16_f32 v75, v102, v103
    v_cvt_pk_bf16_f32 v78, v108, v109
    v_cvt_pk_bf16_f32 v79, v110, v111
    v_cvt_pk_bf16_f32 v100, v100, v101
    v_cvt_pk_bf16_f32 v101, v102, v103
    v_cvt_pk_bf16_f32 v102, v108, v109
    v_cvt_pk_bf16_f32 v103, v110, v111
    ds_write_b128 v7, v[100:103] offset:6144
    v_pk_fma_f32 v[116:117], v[12:13], v[24:25], v[116:117] op_sel_hi:[0,1,1] neg_lo:[1,0,0] neg_hi:[1,0,0]
    v_pk_fma_f32 v[118:119], v[12:13], v[26:27], v[118:119] op_sel_hi:[0,1,1] neg_lo:[1,0,0] neg_hi:[1,0,0]
    v_pk_fma_f32 v[124:125], v[14:15], v[24:25], v[124:125] op_sel_hi:[0,1,1] neg_lo:[1,0,0] neg_hi:[1,0,0]
    v_pk_fma_f32 v[126:127], v[14:15], v[26:27], v[126:127] op_sel_hi:[0,1,1] neg_lo:[1,0,0] neg_hi:[1,0,0]
    v_pk_mul_f32 v[116:117], v[28:29], v[116:117]
    v_pk_mul_f32 v[118:119], v[30:31], v[118:119]
    v_pk_mul_f32 v[124:125], v[28:29], v[124:125]
    v_pk_mul_f32 v[126:127], v[30:31], v[126:127]
    v_cvt_pk_bf16_f32 v90, v116, v117
    v_cvt_pk_bf16_f32 v91, v118, v119
    v_cvt_pk_bf16_f32 v94, v124, v125
    v_cvt_pk_bf16_f32 v95, v126, v127
    v_cvt_pk_bf16_f32 v116, v116, v117
    v_cvt_pk_bf16_f32 v117, v118, v119
    v_cvt_pk_bf16_f32 v118, v124, v125
    v_cvt_pk_bf16_f32 v119, v126, v127
    ds_write_b128 v7, v[116:119] offset:7168
    s_cmp_lg_u32 s16, 3
    s_cbranch_scc1 a_nh
    buffer_store_dwordx4 v[68:71], v1, s[4:7], s60 offen offset:0 sc1
    buffer_store_dwordx4 v[84:87], v1, s[4:7], s60 offen offset:1024 sc1
    buffer_store_dwordx4 v[100:103], v1, s[4:7], s60 offen offset:2048 sc1
    buffer_store_dwordx4 v[116:119], v1, s[4:7], s60 offen offset:3072 sc1
a_nh:
    v_pk_fma_f32 v[96:97], v[8:9], v[16:17], v[96:97] op_sel_hi:[0,1,1] neg_lo:[1,0,0] neg_hi:[1,0,0]
    v_pk_fma_f32 v[98:99], v[8:9], v[18:19], v[98:99] op_sel_hi:[0,1,1] neg_lo:[1,0,0] neg_hi:[1,0,0]
    v_pk_fma_f32 v[104:105], v[10:11], v[16:17], v[104:105] op_sel_hi:[0,1,1] neg_lo:[1,0,0] neg_hi:[1,0,0]
    v_pk_fma_f32 v[106:107], v[10:11], v[18:19], v[106:107] op_sel_hi:[0,1,1] neg_lo:[1,0,0] neg_hi:[1,0,0]
    v_pk_mul_f32 v[96:97], v[20:21], v[96:97]
    v_pk_mul_f32 v[98:99], v[22:23], v[98:99]
    v_pk_mul_f32 v[104:105], v[20:21], v[104:105]
    v_pk_mul_f32 v[106:107], v[22:23], v[106:107]
    v_cvt_pk_bf16_f32 v72, v96, v97
    v_cvt_pk_bf16_f32 v73, v98, v99
    v_cvt_pk_bf16_f32 v76, v104, v105
    v_cvt_pk_bf16_f32 v77, v106, v107
    v_pk_fma_f32 v[112:113], v[12:13], v[16:17], v[112:113] op_sel_hi:[0,1,1] neg_lo:[1,0,0] neg_hi:[1,0,0]
    v_pk_fma_f32 v[114:115], v[12:13], v[18:19], v[114:115] op_sel_hi:[0,1,1] neg_lo:[1,0,0] neg_hi:[1,0,0]
    v_pk_fma_f32 v[120:121], v[14:15], v[16:17], v[120:121] op_sel_hi:[0,1,1] neg_lo:[1,0,0] neg_hi:[1,0,0]
    v_pk_fma_f32 v[122:123], v[14:15], v[18:19], v[122:123] op_sel_hi:[0,1,1] neg_lo:[1,0,0] neg_hi:[1,0,0]
    v_pk_mul_f32 v[112:113], v[20:21], v[112:113]
    v_pk_mul_f32 v[114:115], v[22:23], v[114:115]
    v_pk_mul_f32 v[120:121], v[20:21], v[120:121]
    v_pk_mul_f32 v[122:123], v[22:23], v[122:123]
    v_cvt_pk_bf16_f32 v88, v112, v113
    v_cvt_pk_bf16_f32 v89, v114, v115
    v_cvt_pk_bf16_f32 v92, v120, v121
    v_cvt_pk_bf16_f32 v93, v122, v123
    v_mfma_f32_16x16x32_bf16 v[128:131], v[32:35], v[224:227], v[128:131]
    ds_read_b64_tr_b16 v[60:61], v6 offset:20480
    v_mfma_f32_16x16x32_bf16 v[132:135], v[32:35], v[228:231], v[132:135]
    ds_read_b64_tr_b16 v[62:63], v6 offset:21504
    v_mfma_f32_16x16x32_bf16 v[136:139], v[36:39], v[224:227], v[136:139]
    ds_read_b64_tr_b16 v[32:33], v3 offset:24576
    v_mfma_f32_16x16x32_bf16 v[140:143], v[36:39], v[228:231], v[140:143]
    ds_read_b64_tr_b16 v[34:35], v3 offset:25600
    v_mfma_f32_16x16x32_bf16 v[144:147], v[40:43], v[224:227], v[144:147]
    ds_read_b64_tr_b16 v[36:37], v4 offset:24576
    v_mfma_f32_16x16x32_bf16 v[148:151], v[40:43], v[228:231], v[148:151]
    ds_read_b64_tr_b16 v[38:39], v4 offset:25600
    v_mfma_f32_16x16x32_bf16 v[152:155], v[44:47], v[224:227], v[152:155]
    ds_read_b64_tr_b16 v[40:41], v5 offset:24576
    v_mfma_f32_16x16x32_bf16 v[156:159], v[44:47], v[228:231], v[156:159]
    ds_read_b64_tr_b16 v[42:43], v5 offset:25600
    s_waitcnt lgkmcnt(12)
    v_mfma_f32_16x16x32_bf16 v[128:131], v[48:51], v[232:235], v[128:131]
    ds_read_b64_tr_b16 v[44:45], v6 offset:24576
    v_mfma_f32_16x16x32_bf16 v[132:135], v[48:51], v[236:239], v[132:135]
    ds_read_b64_tr_b16 v[46:47], v6 offset:25600
    v_mfma_f32_16x16x32_bf16 v[136:139], v[52:55], v[232:235], v[136:139]
    ds_read_b64_tr_b16 v[48:49], v3 offset:28672
    v_mfma_f32_16x16x32_bf16 v[140:143], v[52:55], v[236:239], v[140:143]
    ds_read_b64_tr_b16 v[50:51], v3 offset:29696
    s_waitcnt lgkmcnt(10)
    v_mfma_f32_16x16x32_bf16 v[144:147], v[56:59], v[232:235], v[144:147]
    ds_read_b64_tr_b16 v[52:53], v4 offset:28672
    v_mfma_f32_16x16x32_bf16 v[148:151], v[56:59], v[236:239], v[148:151]
    ds_read_b64_tr_b16 v[54:55], v4 offset:29696
    v_mfma_f32_16x16x32_bf16 v[152:155], v[60:63], v[232:235], v[152:155]
    ds_read_b64_tr_b16 v[56:57], v5 offset:28672
    v_mfma_f32_16x16x32_bf16 v[156:159], v[60:63], v[236:239], v[156:159]
    ds_read_b64_tr_b16 v[58:59], v5 offset:29696
    s_waitcnt lgkmcnt(10)
    v_mfma_f32_16x16x32_bf16 v[128:131], v[32:35], v[240:243], v[128:131]
    ds_read_b64_tr_b16 v[60:61], v6 offset:28672
    v_mfma_f32_16x16x32_bf16 v[132:135], v[32:35], v[244:247], v[132:135]
    ds_read_b64_tr_b16 v[62:63], v6 offset:29696
    s_barrier
    v_mfma_f32_16x16x32_bf16 v[136:139], v[36:39], v[240:243], v[136:139]
    ds_read_b64_tr_b16 v[32:33], v3 offset:32768
    v_mfma_f32_16x16x32_bf16 v[140:143], v[36:39], v[244:247], v[140:143]
    ds_read_b64_tr_b16 v[34:35], v3 offset:33792
    s_waitcnt lgkmcnt(10)
    v_mfma_f32_16x16x32_bf16 v[144:147], v[40:43], v[240:243], v[144:147]
    ds_read_b64_tr_b16 v[36:37], v4 offset:32768
    v_mfma_f32_16x16x32_bf16 v[148:151], v[40:43], v[244:247], v[148:151]
    ds_read_b64_tr_b16 v[38:39], v4 offset:33792
    v_mfma_f32_16x16x32_bf16 v[152:155], v[44:47], v[240:243], v[152:155]
    ds_read_b64_tr_b16 v[40:41], v5 offset:32768
    v_mfma_f32_16x16x32_bf16 v[156:159], v[44:47], v[244:247], v[156:159]
    ds_read_b64_tr_b16 v[42:43], v5 offset:33792
    s_waitcnt lgkmcnt(10)
    v_mfma_f32_16x16x32_bf16 v[128:131], v[48:51], v[248:251], v[128:131]
    ds_read_b64_tr_b16 v[44:45], v6 offset:32768
    v_mfma_f32_16x16x32_bf16 v[132:135], v[48:51], v[252:255], v[132:135]
    ds_read_b64_tr_b16 v[46:47], v6 offset:33792
    v_mfma_f32_16x16x32_bf16 v[136:139], v[52:55], v[248:251], v[136:139]
    ds_read_b64_tr_b16 v[48:49], v3 offset:36864
    v_mfma_f32_16x16x32_bf16 v[140:143], v[52:55], v[252:255], v[140:143]
    ds_read_b64_tr_b16 v[50:51], v3 offset:37888
    s_waitcnt lgkmcnt(10)
    v_mfma_f32_16x16x32_bf16 v[144:147], v[56:59], v[248:251], v[144:147]
    ds_read_b64_tr_b16 v[52:53], v4 offset:36864
    v_mfma_f32_16x16x32_bf16 v[148:151], v[56:59], v[252:255], v[148:151]
    ds_read_b64_tr_b16 v[54:55], v4 offset:37888
    v_mfma_f32_16x16x32_bf16 v[152:155], v[60:63], v[248:251], v[152:155]
    ds_read_b64_tr_b16 v[56:57], v5 offset:36864
    v_mfma_f32_16x16x32_bf16 v[156:159], v[60:63], v[252:255], v[156:159]
    ds_read_b64_tr_b16 v[58:59], v5 offset:37888
    s_waitcnt lgkmcnt(10)
    v_mfma_f32_16x16x32_bf16 v[128:131], v[32:35], v[160:163], v[128:131]
    ds_read_b64_tr_b16 v[60:61], v6 offset:36864
    v_mfma_f32_16x16x32_bf16 v[132:135], v[32:35], v[164:167], v[132:135]
    ds_read_b64_tr_b16 v[62:63], v6 offset:37888
    v_mfma_f32_16x16x32_bf16 v[136:139], v[36:39], v[160:163], v[136:139]
    ds_read_b64_tr_b16 v[32:33], v3 offset:40960
    v_mfma_f32_16x16x32_bf16 v[140:143], v[36:39], v[164:167], v[140:143]
    ds_read_b64_tr_b16 v[34:35], v3 offset:41984
    s_waitcnt lgkmcnt(10)
    v_mfma_f32_16x16x32_bf16 v[144:147], v[40:43], v[160:163], v[144:147]
    ds_read_b64_tr_b16 v[36:37], v4 offset:40960
    v_mfma_f32_16x16x32_bf16 v[148:151], v[40:43], v[164:167], v[148:151]
    ds_read_b64_tr_b16 v[38:39], v4 offset:41984
    v_mfma_f32_16x16x32_bf16 v[152:155], v[44:47], v[160:163], v[152:155]
    ds_read_b64_tr_b16 v[40:41], v5 offset:40960
    v_mfma_f32_16x16x32_bf16 v[156:159], v[44:47], v[164:167], v[156:159]
    ds_read_b64_tr_b16 v[42:43], v5 offset:41984
    s_waitcnt lgkmcnt(10)
    v_mfma_f32_16x16x32_bf16 v[128:131], v[48:51], v[168:171], v[128:131]
    ds_read_b64_tr_b16 v[44:45], v6 offset:40960
    s_cmp_lg_u32 s16, 3
    s_cbranch_scc1 a_nopub
    s_waitcnt vmcnt(0)
    s_atomic_add s40, s[22:23], s61
a_nopub:
    v_mfma_f32_16x16x32_bf16 v[132:135], v[48:51], v[172:175], v[132:135]
    ds_read_b64_tr_b16 v[46:47], v6 offset:41984
    v_mfma_f32_16x16x32_bf16 v[136:139], v[52:55], v[168:171], v[136:139]
    ds_read_b64_tr_b16 v[48:49], v3 offset:45056
    v_mfma_f32_16x16x32_bf16 v[140:143], v[52:55], v[172:175], v[140:143]
    ds_read_b64_tr_b16 v[50:51], v3 offset:46080
    s_waitcnt lgkmcnt(10)
    v_mfma_f32_16x16x32_bf16 v[144:147], v[56:59], v[168:171], v[144:147]
    ds_read_b64_tr_b16 v[52:53], v4 offset:45056
    v_mfma_f32_16x16x32_bf16 v[148:151], v[56:59], v[172:175], v[148:151]
    ds_read_b64_tr_b16 v[54:55], v4 offset:46080
    v_mfma_f32_16x16x32_bf16 v[152:155], v[60:63], v[168:171], v[152:155]
    ds_read_b64_tr_b16 v[56:57], v5 offset:45056
    v_mfma_f32_16x16x32_bf16 v[156:159], v[60:63], v[172:175], v[156:159]
    ds_read_b64_tr_b16 v[58:59], v5 offset:46080
    s_waitcnt lgkmcnt(10)
    v_mfma_f32_16x16x32_bf16 v[128:131], v[32:35], v[176:179], v[128:131]
    ds_read_b64_tr_b16 v[60:61], v6 offset:45056
    v_mfma_f32_16x16x32_bf16 v[132:135], v[32:35], v[180:183], v[132:135]
    ds_read_b64_tr_b16 v[62:63], v6 offset:46080
    v_mfma_f32_16x16x32_bf16 v[136:139], v[36:39], v[176:179], v[136:139]
    ds_read_b64_tr_b16 v[32:33], v3 offset:49152
    v_mfma_f32_16x16x32_bf16 v[140:143], v[36:39], v[180:183], v[140:143]
    ds_read_b64_tr_b16 v[34:35], v3 offset:50176
    s_waitcnt lgkmcnt(10)
    v_mfma_f32_16x16x32_bf16 v[144:147], v[40:43], v[176:179], v[144:147]
    ds_read_b64_tr_b16 v[36:37], v4 offset:49152
    v_mfma_f32_16x16x32_bf16 v[148:151], v[40:43], v[180:183], v[148:151]
    ds_read_b64_tr_b16 v[38:39], v4 offset:50176
    v_mfma_f32_16x16x32_bf16 v[152:155], v[44:47], v[176:179], v[152:155]
    ds_read_b64_tr_b16 v[40:41], v5 offset:49152
    v_mfma_f32_16x16x32_bf16 v[156:159], v[44:47], v[180:183], v[156:159]
    ds_read_b64_tr_b16 v[42:43], v5 offset:50176
    s_waitcnt lgkmcnt(10)
    v_mfma_f32_16x16x32_bf16 v[128:131], v[48:51], v[184:187], v[128:131]
    ds_read_b64_tr_b16 v[44:45], v6 offset:49152
    ds_read_b32 v8, v9 offset:4096
    v_mfma_f32_16x16x32_bf16 v[132:135], v[48:51], v[188:191], v[132:135]
    ds_read_b64_tr_b16 v[46:47], v6 offset:50176
    ds_read_b32 v10, v9 offset:4608
    v_mfma_f32_16x16x32_bf16 v[136:139], v[52:55], v[184:187], v[136:139]
    ds_read_b64_tr_b16 v[48:49], v3 offset:53248
    ds_read_b32 v12, v9 offset:4160
    v_mfma_f32_16x16x32_bf16 v[140:143], v[52:55], v[188:191], v[140:143]
    ds_read_b64_tr_b16 v[50:51], v3 offset:54272
    ds_read_b32 v14, v9 offset:4672
    s_waitcnt lgkmcnt(14)
    v_mfma_f32_16x16x32_bf16 v[144:147], v[56:59], v[184:187], v[144:147]
    ds_read_b64_tr_b16 v[52:53], v4 offset:53248
    ds_read_b128 v[16:19], v11 offset:0
    v_mfma_f32_16x16x32_bf16 v[148:151], v[56:59], v[188:191], v[148:151]
    ds_read_b64_tr_b16 v[54:55], v4 offset:54272
    ds_read_b128 v[20:23], v11 offset:64
    v_mfma_f32_16x16x32_bf16 v[152:155], v[60:63], v[184:187], v[152:155]
    ds_read_b64_tr_b16 v[56:57], v5 offset:53248
    ds_read_b128 v[24:27], v11 offset:128
    v_mfma_f32_16x16x32_bf16 v[156:159], v[60:63], v[188:191], v[156:159]
    ds_read_b64_tr_b16 v[58:59], v5 offset:54272
    ds_read_b128 v[28:31], v11 offset:192
    s_waitcnt lgkmcnt(14)
    v_mfma_f32_16x16x32_bf16 v[128:131], v[32:35], v[192:195], v[128:131]
    ds_read_b64_tr_b16 v[60:61], v6 offset:53248
    v_add_u32 v13, 153600, v1
    v_mfma_f32_16x16x32_bf16 v[132:135], v[32:35], v[196:199], v[132:135]
    ds_read_b64_tr_b16 v[62:63], v6 offset:54272
    v_mfma_f32_16x16x32_bf16 v[136:139], v[36:39], v[192:195], v[136:139]
    ds_read_b64_tr_b16 v[32:33], v3 offset:57344
    v_mfma_f32_16x16x32_bf16 v[140:143], v[36:39], v[196:199], v[140:143]
    ds_read_b64_tr_b16 v[34:35], v3 offset:58368
    s_waitcnt lgkmcnt(14)
    v_mfma_f32_16x16x32_bf16 v[144:147], v[40:43], v[192:195], v[144:147]
    ds_read_b64_tr_b16 v[36:37], v4 offset:57344
    v_mfma_f32_16x16x32_bf16 v[148:151], v[40:43], v[196:199], v[148:151]
    ds_read_b64_tr_b16 v[38:39], v4 offset:58368
    v_mfma_f32_16x16x32_bf16 v[152:155], v[44:47], v[192:195], v[152:155]
    ds_read_b64_tr_b16 v[40:41], v5 offset:57344
    v_mfma_f32_16x16x32_bf16 v[156:159], v[44:47], v[196:199], v[156:159]
    ds_read_b64_tr_b16 v[42:43], v5 offset:58368
    s_waitcnt lgkmcnt(13)
    v_mfma_f32_16x16x32_bf16 v[128:131], v[48:51], v[200:203], v[128:131]
    ds_read_b64_tr_b16 v[44:45], v6 offset:57344
    s_waitcnt lgkmcnt(9)
    v_mfma_f32_16x16x32_bf16 v[132:135], v[48:51], v[204:207], v[132:135]
    ds_read_b64_tr_b16 v[46:47], v6 offset:58368
    v_mul_f32 v10, 0x3e8293ee, v10
    v_mfma_f32_16x16x32_bf16 v[136:139], v[52:55], v[200:203], v[136:139]
    ds_read_b64_tr_b16 v[48:49], v3 offset:61440
    v_mul_f32 v14, 0x3e8293ee, v14
    v_mfma_f32_16x16x32_bf16 v[140:143], v[52:55], v[204:207], v[140:143]
    ds_read_b64_tr_b16 v[50:51], v3 offset:62464
    ds_read_b128 v[120:123], v13 offset:0
    s_waitcnt lgkmcnt(11)
    v_mfma_f32_16x16x32_bf16 v[144:147], v[56:59], v[200:203], v[144:147]
    ds_read_b64_tr_b16 v[52:53], v4 offset:61440
    ds_read_b128 v[124:127], v13 offset:1024
    v_mfma_f32_16x16x32_bf16 v[148:151], v[56:59], v[204:207], v[148:151]
    ds_read_b64_tr_b16 v[54:55], v4 offset:62464
    v_mfma_f32_16x16x32_bf16 v[152:155], v[60:63], v[200:203], v[152:155]
    ds_read_b64_tr_b16 v[56:57], v5 offset:61440
    v_mfma_f32_16x16x32_bf16 v[156:159], v[60:63], v[204:207], v[156:159]
    ds_read_b64_tr_b16 v[58:59], v5 offset:62464
    s_waitcnt lgkmcnt(12)
    v_mfma_f32_16x16x32_bf16 v[128:131], v[32:35], v[208:211], v[128:131]
    ds_read_b64_tr_b16 v[60:61], v6 offset:61440
    v_mfma_f32_16x16x32_bf16 v[132:135], v[32:35], v[212:215], v[132:135]
    ds_read_b64_tr_b16 v[62:63], v6 offset:62464
    v_xor_b32 v3, 0x10000, v3
    v_xor_b32 v4, 0x10000, v4
    v_xor_b32 v5, 0x10000, v5
    v_xor_b32 v6, 0x10000, v6
    v_mfma_f32_16x16x32_bf16 v[136:139], v[36:39], v[208:211], v[136:139]
    v_mfma_f32_16x16x32_bf16 v[140:143], v[36:39], v[212:215], v[140:143]
    s_waitcnt lgkmcnt(10)
    v_mfma_f32_16x16x32_bf16 v[144:147], v[40:43], v[208:211], v[144:147]
    v_mfma_f32_16x16x32_bf16 v[148:151], v[40:43], v[212:215], v[148:151]
    v_mfma_f32_16x16x32_bf16 v[152:155], v[44:47], v[208:211], v[152:155]
    v_mfma_f32_16x16x32_bf16 v[156:159], v[44:47], v[212:215], v[156:159]
    s_waitcnt lgkmcnt(4)
    v_mfma_f32_16x16x32_bf16 v[128:131], v[48:51], v[216:219], v[128:131]
    v_mfma_f32_16x16x32_bf16 v[132:135], v[48:51], v[220:223], v[132:135]
    v_mfma_f32_16x16x32_bf16 v[136:139], v[52:55], v[216:219], v[136:139]
    v_mfma_f32_16x16x32_bf16 v[140:143], v[52:55], v[220:223], v[140:143]
    s_waitcnt lgkmcnt(0)
    v_mfma_f32_16x16x32_bf16 v[144:147], v[56:59], v[216:219], v[144:147]
    v_mfma_f32_16x16x32_bf16 v[148:151], v[56:59], v[220:223], v[148:151]
    v_mfma_f32_16x16x32_bf16 v[152:155], v[60:63], v[216:219], v[152:155]
    v_mfma_f32_16x16x32_bf16 v[156:159], v[60:63], v[220:223], v[156:159]
    s_lshl_b32 s44, s21, 22
    s_lshl_b32 s45, s38, 16
    s_add_u32 s44, s44, s45
    s_lshl_b32 s45, s18, 12
    s_add_u32 s44, s44, s45
    s_add_u32 s52, s44, 16777216
    v_pk_fma_f32 v[132:133], v[12:13], v[16:17], v[132:133] op_sel_hi:[0,1,1] neg_lo:[1,0,0] neg_hi:[1,0,0]
    v_pk_fma_f32 v[134:135], v[12:13], v[18:19], v[134:135] op_sel_hi:[0,1,1] neg_lo:[1,0,0] neg_hi:[1,0,0]
    v_pk_fma_f32 v[140:141], v[12:13], v[20:21], v[140:141] op_sel_hi:[0,1,1] neg_lo:[1,0,0] neg_hi:[1,0,0]
    v_pk_fma_f32 v[142:143], v[12:13], v[22:23], v[142:143] op_sel_hi:[0,1,1] neg_lo:[1,0,0] neg_hi:[1,0,0]
    v_pk_fma_f32 v[148:149], v[12:13], v[24:25], v[148:149] op_sel_hi:[0,1,1] neg_lo:[1,0,0] neg_hi:[1,0,0]
    v_pk_fma_f32 v[150:151], v[12:13], v[26:27], v[150:151] op_sel_hi:[0,1,1] neg_lo:[1,0,0] neg_hi:[1,0,0]
    v_pk_fma_f32 v[156:157], v[12:13], v[28:29], v[156:157] op_sel_hi:[0,1,1] neg_lo:[1,0,0] neg_hi:[1,0,0]
    v_pk_fma_f32 v[158:159], v[12:13], v[30:31], v[158:159] op_sel_hi:[0,1,1] neg_lo:[1,0,0] neg_hi:[1,0,0]
    v_pk_mul_f32 v[132:133], v[14:15], v[132:133] op_sel_hi:[0,1]
    v_pk_mul_f32 v[134:135], v[14:15], v[134:135] op_sel_hi:[0,1]
    v_pk_mul_f32 v[140:141], v[14:15], v[140:141] op_sel_hi:[0,1]
    v_pk_mul_f32 v[142:143], v[14:15], v[142:143] op_sel_hi:[0,1]
    v_pk_mul_f32 v[148:149], v[14:15], v[148:149] op_sel_hi:[0,1]
    v_pk_mul_f32 v[150:151], v[14:15], v[150:151] op_sel_hi:[0,1]
    v_pk_mul_f32 v[156:157], v[14:15], v[156:157] op_sel_hi:[0,1]
    v_pk_mul_f32 v[158:159], v[14:15], v[158:159] op_sel_hi:[0,1]
    v_cvt_pk_bf16_f32 v132, v132, v133
    v_cvt_pk_bf16_f32 v133, v134, v135
    v_cvt_pk_bf16_f32 v134, v140, v141
    v_cvt_pk_bf16_f32 v135, v142, v143
    v_cvt_pk_bf16_f32 v148, v148, v149
    v_cvt_pk_bf16_f32 v149, v150, v151
    v_cvt_pk_bf16_f32 v150, v156, v157
    v_cvt_pk_bf16_f32 v151, v158, v159
    v_mfma_f32_16x16x32_bf16 v[172:175], v[68:71], v[132:135], v[120:123]
    v_mfma_f32_16x16x32_bf16 v[168:171], v[64:67], v[132:135], v[124:127]
    v_mfma_f32_16x16x32_bf16 v[188:191], v[84:87], v[148:151], v[120:123]
    v_mfma_f32_16x16x32_bf16 v[184:187], v[80:83], v[148:151], v[124:127]
    v_pk_fma_f32 v[128:129], v[8:9], v[16:17], v[128:129] op_sel_hi:[0,1,1] neg_lo:[1,0,0] neg_hi:[1,0,0]
    v_pk_fma_f32 v[130:131], v[8:9], v[18:19], v[130:131] op_sel_hi:[0,1,1] neg_lo:[1,0,0] neg_hi:[1,0,0]
    v_pk_fma_f32 v[136:137], v[8:9], v[20:21], v[136:137] op_sel_hi:[0,1,1] neg_lo:[1,0,0] neg_hi:[1,0,0]
    v_pk_fma_f32 v[138:139], v[8:9], v[22:23], v[138:139] op_sel_hi:[0,1,1] neg_lo:[1,0,0] neg_hi:[1,0,0]
    v_pk_fma_f32 v[144:145], v[8:9], v[24:25], v[144:145] op_sel_hi:[0,1,1] neg_lo:[1,0,0] neg_hi:[1,0,0]
    v_pk_fma_f32 v[146:147], v[8:9], v[26:27], v[146:147] op_sel_hi:[0,1,1] neg_lo:[1,0,0] neg_hi:[1,0,0]
    v_pk_fma_f32 v[152:153], v[8:9], v[28:29], v[152:153] op_sel_hi:[0,1,1] neg_lo:[1,0,0] neg_hi:[1,0,0]
    v_pk_fma_f32 v[154:155], v[8:9], v[30:31], v[154:155] op_sel_hi:[0,1,1] neg_lo:[1,0,0] neg_hi:[1,0,0]
    v_pk_mul_f32 v[128:129], v[10:11], v[128:129] op_sel_hi:[0,1]
    v_pk_mul_f32 v[130:131], v[10:11], v[130:131] op_sel_hi:[0,1]
    v_pk_mul_f32 v[136:137], v[10:11], v[136:137] op_sel_hi:[0,1]
    v_pk_mul_f32 v[138:139], v[10:11], v[138:139] op_sel_hi:[0,1]
    v_pk_mul_f32 v[144:145], v[10:11], v[144:145] op_sel_hi:[0,1]
    v_pk_mul_f32 v[146:147], v[10:11], v[146:147] op_sel_hi:[0,1]
    v_pk_mul_f32 v[152:153], v[10:11], v[152:153] op_sel_hi:[0,1]
    v_pk_mul_f32 v[154:155], v[10:11], v[154:155] op_sel_hi:[0,1]
    v_cvt_pk_bf16_f32 v128, v128, v129
    v_cvt_pk_bf16_f32 v129, v130, v131
    v_cvt_pk_bf16_f32 v130, v136, v137
    v_cvt_pk_bf16_f32 v131, v138, v139
    v_cvt_pk_bf16_f32 v144, v144, v145
    v_cvt_pk_bf16_f32 v145, v146, v147
    v_cvt_pk_bf16_f32 v146, v152, v153
    v_cvt_pk_bf16_f32 v147, v154, v155
    v_mfma_f32_16x16x32_bf16 v[164:167], v[64:67], v[128:131], v[120:123]
    s_nop 0
    v_mfma_f32_16x16x32_bf16 v[180:183], v[80:83], v[144:147], v[120:123]
    v_mov_b32 v232, 0x3f803f80
    v_mov_b32 v233, 0x3f803f80
    v_mov_b32 v234, 0x3f803f80
    v_mov_b32 v235, 0x3f803f80
    v_exp_f32 v172, v172
    v_exp_f32 v173, v173
    v_exp_f32 v174, v174
    v_exp_f32 v175, v175
    v_exp_f32 v188, v188
    v_exp_f32 v189, v189
    v_exp_f32 v190, v190
    v_exp_f32 v191, v191
    s_mov_b32 s46, 1006632960
a_exp1:
    v_exp_f32 v168, v168
    v_exp_f32 v169, v169
    v_exp_f32 v170, v170
    v_exp_f32 v171, v171
    v_exp_f32 v184, v184
    v_exp_f32 v185, v185
    v_exp_f32 v186, v186
    v_exp_f32 v187, v187
    v_cvt_pk_bf16_f32 v200, v168, v169
    v_cvt_pk_bf16_f32 v201, v170, v171
    v_cvt_pk_bf16_f32 v202, v172, v173
    v_cvt_pk_bf16_f32 v203, v174, v175
    v_cvt_pk_bf16_f32 v204, v184, v185
    v_cvt_pk_bf16_f32 v205, v186, v187
    v_cvt_pk_bf16_f32 v206, v188, v189
    v_cvt_pk_bf16_f32 v207, v190, v191
    v_mfma_f32_16x16x32_bf16 v[16:19], v[232:235], v[200:203], 0
    s_nop 0
    v_mfma_f32_16x16x32_bf16 v[20:23], v[232:235], v[204:207], 0
    v_mfma_f32_16x16x32_bf16 v[40:43], v[72:75], v[200:203], 0
    v_mfma_f32_16x16x32_bf16 v[44:47], v[76:79], v[200:203], 0
    v_mfma_f32_16x16x32_bf16 v[56:59], v[88:91], v[204:207], 0
    v_mfma_f32_16x16x32_bf16 v[60:63], v[92:95], v[204:207], 0
    v_mov_b32 v218, v72
    v_mov_b32 v219, v73
    v_mov_b32 v222, v76
    v_mov_b32 v223, v77
    v_mov_b32 v226, v88
    v_mov_b32 v227, v89
    v_mov_b32 v230, v92
    v_mov_b32 v231, v93
    v_subrev_u32 v18, 0x21800000, v16
    v_subrev_u32 v22, 0x21800000, v20
    v_max_u32 v18, v18, v22
    v_cmp_le_u32 vcc, s46, v18
    v_rcp_f32 v16, v16
    v_rcp_f32 v20, v20
    s_cbranch_vccnz a_slow1
a_fin1:
    v_pk_mul_f32 v[40:41], v[16:17], v[40:41] op_sel_hi:[0,1]
    v_pk_mul_f32 v[42:43], v[16:17], v[42:43] op_sel_hi:[0,1]
    v_pk_mul_f32 v[44:45], v[16:17], v[44:45] op_sel_hi:[0,1]
    v_pk_mul_f32 v[46:47], v[16:17], v[46:47] op_sel_hi:[0,1]
    v_pk_mul_f32 v[56:57], v[20:21], v[56:57] op_sel_hi:[0,1]
    v_pk_mul_f32 v[58:59], v[20:21], v[58:59] op_sel_hi:[0,1]
    v_pk_mul_f32 v[60:61], v[20:21], v[60:61] op_sel_hi:[0,1]
    v_pk_mul_f32 v[62:63], v[20:21], v[62:63] op_sel_hi:[0,1]
    v_cvt_pk_bf16_f32 v40, v40, v41
    v_cvt_pk_bf16_f32 v41, v42, v43
    v_cvt_pk_bf16_f32 v42, v44, v45
    v_cvt_pk_bf16_f32 v43, v46, v47
    v_cvt_pk_bf16_f32 v56, v56, v57
    v_cvt_pk_bf16_f32 v57, v58, v59
    v_cvt_pk_bf16_f32 v58, v60, v61
    v_cvt_pk_bf16_f32 v59, v62, v63
    v_permlane32_swap_b32 v40, v42
    v_permlane32_swap_b32 v41, v43
    buffer_store_dwordx4 v[40:43], v2, s[4:7], s52 offen offset:256 sc1
    v_permlane32_swap_b32 v56, v58
    v_permlane32_swap_b32 v57, v59
    buffer_store_dwordx4 v[56:59], v2, s[4:7], s52 offen offset:2304 sc1
    s_cmp_lg_u32 s38, 0
    s_cbranch_scc1 a_hasprev
    v_mov_b32 v124, 0xf149f2ca
    v_mov_b32 v125, 0xf149f2ca
    v_mov_b32 v126, 0xf149f2ca
    v_mov_b32 v127, 0xf149f2ca
a_hasprev:
    s_waitcnt lgkmcnt(0)
    s_barrier
    ds_read_b128 v[192:195], v7 offset:0
    ds_read_b128 v[196:199], v7 offset:1024
    ds_read_b64 v[216:217], v7 offset:2048
    ds_read_b64 v[220:221], v7 offset:2056
    ds_read_b64 v[224:225], v7 offset:3072
    ds_read_b64 v[228:229], v7 offset:3080
    s_waitcnt lgkmcnt(4)
    v_mfma_f32_16x16x32_bf16 v[160:163], v[192:195], v[128:131], v[124:127]
    v_mfma_f32_16x16x32_bf16 v[176:179], v[196:199], v[144:147], v[124:127]
    v_exp_f32 v164, v164
    v_exp_f32 v165, v165
    v_exp_f32 v166, v166
    v_exp_f32 v167, v167
    v_exp_f32 v180, v180
    v_exp_f32 v181, v181
    v_exp_f32 v182, v182
    v_exp_f32 v183, v183
    s_waitcnt lgkmcnt(0)
    s_mov_b32 s46, 1006632960
a_exp0:
    v_exp_f32 v160, v160
    v_exp_f32 v161, v161
    v_exp_f32 v162, v162
    v_exp_f32 v163, v163
    v_exp_f32 v176, v176
    v_exp_f32 v177, v177
    v_exp_f32 v178, v178
    v_exp_f32 v179, v179
    v_cvt_pk_bf16_f32 v200, v160, v161
    v_cvt_pk_bf16_f32 v201, v162, v163
    v_cvt_pk_bf16_f32 v202, v164, v165
    v_cvt_pk_bf16_f32 v203, v166, v167
    v_cvt_pk_bf16_f32 v204, v176, v177
    v_cvt_pk_bf16_f32 v205, v178, v179
    v_cvt_pk_bf16_f32 v206, v180, v181
    v_cvt_pk_bf16_f32 v207, v182, v183
    v_mfma_f32_16x16x32_bf16 v[16:19], v[232:235], v[200:203], 0
    s_nop 0
    v_mfma_f32_16x16x32_bf16 v[20:23], v[232:235], v[204:207], 0
    v_mfma_f32_16x16x32_bf16 v[32:35], v[216:219], v[200:203], 0
    v_mfma_f32_16x16x32_bf16 v[36:39], v[220:223], v[200:203], 0
    v_mfma_f32_16x16x32_bf16 v[48:51], v[224:227], v[204:207], 0
    v_mfma_f32_16x16x32_bf16 v[52:55], v[228:231], v[204:207], 0
    s_nop 1
    v_subrev_u32 v18, 0x21800000, v16
    s_nop 0
    v_subrev_u32 v22, 0x21800000, v20
    v_max_u32 v18, v18, v22
    v_cmp_le_u32 vcc, s46, v18
    v_rcp_f32 v16, v16
    v_rcp_f32 v20, v20
    s_cbranch_vccnz a_slow0
a_fin0:
    v_pk_mul_f32 v[32:33], v[16:17], v[32:33] op_sel_hi:[0,1]
    v_pk_mul_f32 v[34:35], v[16:17], v[34:35] op_sel_hi:[0,1]
    v_pk_mul_f32 v[36:37], v[16:17], v[36:37] op_sel_hi:[0,1]
    v_pk_mul_f32 v[38:39], v[16:17], v[38:39] op_sel_hi:[0,1]
    v_pk_mul_f32 v[48:49], v[20:21], v[48:49] op_sel_hi:[0,1]
    v_pk_mul_f32 v[50:51], v[20:21], v[50:51] op_sel_hi:[0,1]
    v_pk_mul_f32 v[52:53], v[20:21], v[52:53] op_sel_hi:[0,1]
    v_pk_mul_f32 v[54:55], v[20:21], v[54:55] op_sel_hi:[0,1]
    v_cvt_pk_bf16_f32 v32, v32, v33
    v_cvt_pk_bf16_f32 v33, v34, v35
    v_cvt_pk_bf16_f32 v34, v36, v37
    v_cvt_pk_bf16_f32 v35, v38, v39
    v_cvt_pk_bf16_f32 v48, v48, v49
    v_cvt_pk_bf16_f32 v49, v50, v51
    v_cvt_pk_bf16_f32 v50, v52, v53
    v_cvt_pk_bf16_f32 v51, v54, v55
    v_permlane32_swap_b32 v32, v34
    v_permlane32_swap_b32 v33, v35
    buffer_store_dwordx4 v[32:35], v2, s[4:7], s52 offen offset:0 sc1
    v_permlane32_swap_b32 v48, v50
    v_permlane32_swap_b32 v49, v51
    buffer_store_dwordx4 v[48:51], v2, s[4:7], s52 offen offset:2048 sc1
    s_lshl_b32 s44, s21, 22
    s_lshl_b32 s45, s38, 16
    s_add_u32 s41, s44, s45
    s_lshl_b32 s45, s18, 12
    s_add_u32 s43, s41, s45
    s_and_b32 s45, s45, 0
    s_add_u32 s41, s41, s45
    s_add_u32 s41, s41, 16777216
    buffer_load_dwordx4 v[224:227], v2, s[4:7], s43 offen offset:0 sc1
    buffer_load_dwordx4 v[228:231], v2, s[4:7], s43 offen offset:256 sc1
    buffer_load_dwordx4 v[232:235], v2, s[4:7], s43 offen offset:2048 sc1
    buffer_load_dwordx4 v[236:239], v2, s[4:7], s43 offen offset:2304 sc1
    s_barrier
    s_lshl_b32 s47, s21, 14
    s_lshl_b32 s67, s38, 8
    s_add_u32 s47, s47, s67
    s_add_u32 s47, s47, 86144
    s_mov_b32 s68, 1
    s_waitcnt vmcnt(4)
    s_atomic_add s68, s[22:23], s47 glc
    s_mov_b32 s66, 0x10000
    s_waitcnt lgkmcnt(0)
    s_cmp_eq_u32 s68, 15
    s_cbranch_scc1 c_o_ok
c_o_poll:
    s_mov_b32 s68, 0
    s_atomic_add s68, s[22:23], s47 offset:0 glc
    s_sub_u32 s66, s66, 1
    s_cselect_b32 s67, 16, 0
    s_waitcnt lgkmcnt(0)
    s_max_u32 s68, s68, s67
    s_cmp_lt_u32 s68, 16
    s_cbranch_scc1 c_o_poll
c_o_ok:
    s_branch c_wo
a_slow1:
    s_cmp_eq_u32 s46, 0
    s_cbranch_scc1 a_fin1
    s_mov_b32 s46, 0
    v_mfma_f32_16x16x32_bf16 v[172:175], v[68:71], v[132:135], v[120:123]
    v_mfma_f32_16x16x32_bf16 v[168:171], v[64:67], v[132:135], v[124:127]
    v_mfma_f32_16x16x32_bf16 v[188:191], v[84:87], v[148:151], v[120:123]
    v_mfma_f32_16x16x32_bf16 v[184:187], v[80:83], v[148:151], v[124:127]
    s_nop 5
    v_max3_f32 v24, v168, v169, v170
    v_max3_f32 v24, v24, v171, v172
    v_max3_f32 v24, v24, v173, v174
    v_max_f32 v24, v24, v175
    v_max3_f32 v26, v184, v185, v186
    v_max3_f32 v26, v26, v187, v188
    v_max3_f32 v26, v26, v189, v190
    v_max_f32 v26, v26, v191
    v_mov_b32 v25, v24
    v_mov_b32 v27, v26
    s_nop 0
    v_permlane32_swap_b32 v24, v25
    v_permlane32_swap_b32 v26, v27
    v_max_f32 v24, v24, v25
    v_max_f32 v26, v26, v27
    v_mov_b32 v25, v24
    v_mov_b32 v27, v26
    s_nop 0
    v_permlane16_swap_b32 v24, v25
    v_permlane16_swap_b32 v26, v27
    v_max_f32 v24, v24, v25
    v_max_f32 v26, v26, v27
    v_sub_f32 v168, v168, v24
    v_sub_f32 v169, v169, v24
    v_sub_f32 v170, v170, v24
    v_sub_f32 v171, v171, v24
    v_sub_f32 v172, v172, v24
    v_sub_f32 v173, v173, v24
    v_sub_f32 v174, v174, v24
    v_sub_f32 v175, v175, v24
    v_sub_f32 v184, v184, v26
    v_sub_f32 v185, v185, v26
    v_sub_f32 v186, v186, v26
    v_sub_f32 v187, v187, v26
    v_sub_f32 v188, v188, v26
    v_sub_f32 v189, v189, v26
    v_sub_f32 v190, v190, v26
    v_sub_f32 v191, v191, v26
    v_exp_f32 v172, v172
    v_exp_f32 v173, v173
    v_exp_f32 v174, v174
    v_exp_f32 v175, v175
    v_exp_f32 v188, v188
    v_exp_f32 v189, v189
    v_exp_f32 v190, v190
    v_exp_f32 v191, v191
    s_branch a_exp1
a_slow0:
    s_cmp_eq_u32 s46, 0
    s_cbranch_scc1 a_fin0
    s_mov_b32 s46, 0
    v_mfma_f32_16x16x32_bf16 v[164:167], v[64:67], v[128:131], v[120:123]
    v_mfma_f32_16x16x32_bf16 v[160:163], v[192:195], v[128:131], v[124:127]
    v_mfma_f32_16x16x32_bf16 v[180:183], v[80:83], v[144:147], v[120:123]
    v_mfma_f32_16x16x32_bf16 v[176:179], v[196:199], v[144:147], v[124:127]
    s_nop 5
    v_max3_f32 v24, v160, v161, v162
    v_max3_f32 v24, v24, v163, v164
    v_max3_f32 v24, v24, v165, v166
    v_max_f32 v24, v24, v167
    v_max3_f32 v26, v176, v177, v178
    v_max3_f32 v26, v26, v179, v180
    v_max3_f32 v26, v26, v181, v182
    v_max_f32 v26, v26, v183
    v_mov_b32 v25, v24
    v_mov_b32 v27, v26
    s_nop 0
    v_permlane32_swap_b32 v24, v25
    v_permlane32_swap_b32 v26, v27
    v_max_f32 v24, v24, v25
    v_max_f32 v26, v26, v27
    v_mov_b32 v25, v24
    v_mov_b32 v27, v26
    s_nop 0
    v_permlane16_swap_b32 v24, v25
    v_permlane16_swap_b32 v26, v27
    v_max_f32 v24, v24, v25
    v_max_f32 v26, v26, v27
    v_sub_f32 v160, v160, v24
    v_sub_f32 v161, v161, v24
    v_sub_f32 v162, v162, v24
    v_sub_f32 v163, v163, v24
    v_sub_f32 v164, v164, v24
    v_sub_f32 v165, v165, v24
    v_sub_f32 v166, v166, v24
    v_sub_f32 v167, v167, v24
    v_sub_f32 v176, v176, v26
    v_sub_f32 v177, v177, v26
    v_sub_f32 v178, v178, v26
    v_sub_f32 v179, v179, v26
    v_sub_f32 v180, v180, v26
    v_sub_f32 v181, v181, v26
    v_sub_f32 v182, v182, v26
    v_sub_f32 v183, v183, v26
    v_exp_f32 v164, v164
    v_exp_f32 v165, v165
    v_exp_f32 v166, v166
    v_exp_f32 v167, v167
    v_exp_f32 v180, v180
    v_exp_f32 v181, v181
    v_exp_f32 v182, v182
    v_exp_f32 v183, v183
    s_branch a_exp0
c_B:
    s_waitcnt lgkmcnt(6)
    v_pk_fma_f32 v[64:65], v[8:9], v[16:17], v[64:65] op_sel_hi:[0,1,1] neg_lo:[1,0,0] neg_hi:[1,0,0]
    v_pk_fma_f32 v[66:67], v[8:9], v[18:19], v[66:67] op_sel_hi:[0,1,1] neg_lo:[1,0,0] neg_hi:[1,0,0]
    v_pk_fma_f32 v[72:73], v[8:9], v[20:21], v[72:73] op_sel_hi:[0,1,1] neg_lo:[1,0,0] neg_hi:[1,0,0]
    v_pk_fma_f32 v[74:75], v[8:9], v[22:23], v[74:75] op_sel_hi:[0,1,1] neg_lo:[1,0,0] neg_hi:[1,0,0]
    v_pk_mul_f32 v[64:65], v[10:11], v[64:65] op_sel_hi:[0,1]
    v_pk_mul_f32 v[66:67], v[10:11], v[66:67] op_sel_hi:[0,1]
    v_pk_mul_f32 v[72:73], v[10:11], v[72:73] op_sel_hi:[0,1]
    v_pk_mul_f32 v[74:75], v[10:11], v[74:75] op_sel_hi:[0,1]
    v_cvt_pk_bf16_f32 v64, v64, v65
    v_cvt_pk_bf16_f32 v65, v66, v67
    v_cvt_pk_bf16_f32 v66, v72, v73
    v_cvt_pk_bf16_f32 v67, v74, v75
    s_add_u32 s55, s52, 0
    buffer_store_dwordx4 v[64:67], v2, s[4:7], s55 offen offset:0 sc1
    v_pk_fma_f32 v[68:69], v[12:13], v[16:17], v[68:69] op_sel_hi:[0,1,1] neg_lo:[1,0,0] neg_hi:[1,0,0]
    v_pk_fma_f32 v[70:71], v[12:13], v[18:19], v[70:71] op_sel_hi:[0,1,1] neg_lo:[1,0,0] neg_hi:[1,0,0]
    v_pk_fma_f32 v[76:77], v[12:13], v[20:21], v[76:77] op_sel_hi:[0,1,1] neg_lo:[1,0,0] neg_hi:[1,0,0]
    v_pk_fma_f32 v[78:79], v[12:13], v[22:23], v[78:79] op_sel_hi:[0,1,1] neg_lo:[1,0,0] neg_hi:[1,0,0]
    v_pk_mul_f32 v[68:69], v[14:15], v[68:69] op_sel_hi:[0,1]
    v_pk_mul_f32 v[70:71], v[14:15], v[70:71] op_sel_hi:[0,1]
    v_pk_mul_f32 v[76:77], v[14:15], v[76:77] op_sel_hi:[0,1]
    v_pk_mul_f32 v[78:79], v[14:15], v[78:79] op_sel_hi:[0,1]
    v_cvt_pk_bf16_f32 v68, v68, v69
    v_cvt_pk_bf16_f32 v69, v70, v71
    v_cvt_pk_bf16_f32 v70, v76, v77
    v_cvt_pk_bf16_f32 v71, v78, v79
    buffer_store_dwordx4 v[68:71], v2, s[4:7], s55 offen offset:256 sc1
    v_pk_fma_f32 v[80:81], v[8:9], v[24:25], v[80:81] op_sel_hi:[0,1,1] neg_lo:[1,0,0] neg_hi:[1,0,0]
    v_pk_fma_f32 v[82:83], v[8:9], v[26:27], v[82:83] op_sel_hi:[0,1,1] neg_lo:[1,0,0] neg_hi:[1,0,0]
    v_pk_fma_f32 v[88:89], v[8:9], v[28:29], v[88:89] op_sel_hi:[0,1,1] neg_lo:[1,0,0] neg_hi:[1,0,0]
    v_pk_fma_f32 v[90:91], v[8:9], v[30:31], v[90:91] op_sel_hi:[0,1,1] neg_lo:[1,0,0] neg_hi:[1,0,0]
    v_pk_mul_f32 v[80:81], v[10:11], v[80:81] op_sel_hi:[0,1]
    v_pk_mul_f32 v[82:83], v[10:11], v[82:83] op_sel_hi:[0,1]
    v_pk_mul_f32 v[88:89], v[10:11], v[88:89] op_sel_hi:[0,1]
    v_pk_mul_f32 v[90:91], v[10:11], v[90:91] op_sel_hi:[0,1]
    v_cvt_pk_bf16_f32 v80, v80, v81
    v_cvt_pk_bf16_f32 v81, v82, v83
    v_cvt_pk_bf16_f32 v82, v88, v89
    v_cvt_pk_bf16_f32 v83, v90, v91
    s_add_u32 s55, s52, 131072
    buffer_store_dwordx4 v[80:83], v2, s[4:7], s55 offen offset:0 sc1
    v_pk_fma_f32 v[84:85], v[12:13], v[24:25], v[84:85] op_sel_hi:[0,1,1] neg_lo:[1,0,0] neg_hi:[1,0,0]
    v_pk_fma_f32 v[86:87], v[12:13], v[26:27], v[86:87] op_sel_hi:[0,1,1] neg_lo:[1,0,0] neg_hi:[1,0,0]
    v_pk_fma_f32 v[92:93], v[12:13], v[28:29], v[92:93] op_sel_hi:[0,1,1] neg_lo:[1,0,0] neg_hi:[1,0,0]
    v_pk_fma_f32 v[94:95], v[12:13], v[30:31], v[94:95] op_sel_hi:[0,1,1] neg_lo:[1,0,0] neg_hi:[1,0,0]
    v_pk_mul_f32 v[84:85], v[14:15], v[84:85] op_sel_hi:[0,1]
    v_pk_mul_f32 v[86:87], v[14:15], v[86:87] op_sel_hi:[0,1]
    v_pk_mul_f32 v[92:93], v[14:15], v[92:93] op_sel_hi:[0,1]
    v_pk_mul_f32 v[94:95], v[14:15], v[94:95] op_sel_hi:[0,1]
    v_cvt_pk_bf16_f32 v84, v84, v85
    v_cvt_pk_bf16_f32 v85, v86, v87
    v_cvt_pk_bf16_f32 v86, v92, v93
    v_cvt_pk_bf16_f32 v87, v94, v95
    buffer_store_dwordx4 v[84:87], v2, s[4:7], s55 offen offset:256 sc1
    v_mfma_f32_16x16x32_bf16 v[96:99], v[160:163], v[32:35], v[96:99]
    ds_read_b64_tr_b16 v[60:61], v6 offset:53248
    v_mfma_f32_16x16x32_bf16 v[100:103], v[164:167], v[32:35], v[100:103]
    ds_read_b64_tr_b16 v[62:63], v6 offset:54272
    v_mfma_f32_16x16x32_bf16 v[104:107], v[160:163], v[36:39], v[104:107]
    ds_read_b64_tr_b16 v[32:33], v3 offset:57344
    v_mfma_f32_16x16x32_bf16 v[108:111], v[164:167], v[36:39], v[108:111]
    ds_read_b64_tr_b16 v[34:35], v3 offset:58368
    v_mfma_f32_16x16x32_bf16 v[112:115], v[160:163], v[40:43], v[112:115]
    ds_read_b64_tr_b16 v[36:37], v4 offset:57344
    v_mfma_f32_16x16x32_bf16 v[116:119], v[164:167], v[40:43], v[116:119]
    ds_read_b64_tr_b16 v[38:39], v4 offset:58368
    v_mfma_f32_16x16x32_bf16 v[120:123], v[160:163], v[44:47], v[120:123]
    ds_read_b64_tr_b16 v[40:41], v5 offset:57344
    v_mfma_f32_16x16x32_bf16 v[124:127], v[164:167], v[44:47], v[124:127]
    ds_read_b64_tr_b16 v[42:43], v5 offset:58368
    s_waitcnt lgkmcnt(10)
    v_mfma_f32_16x16x32_bf16 v[96:99], v[168:171], v[48:51], v[96:99]
    ds_read_b64_tr_b16 v[44:45], v6 offset:57344
    v_mfma_f32_16x16x32_bf16 v[100:103], v[172:175], v[48:51], v[100:103]
    ds_read_b64_tr_b16 v[46:47], v6 offset:58368
    v_mfma_f32_16x16x32_bf16 v[104:107], v[168:171], v[52:55], v[104:107]
    ds_read_b64_tr_b16 v[48:49], v3 offset:61440
    v_mfma_f32_16x16x32_bf16 v[108:111], v[172:175], v[52:55], v[108:111]
    ds_read_b64_tr_b16 v[50:51], v3 offset:62464
    s_waitcnt lgkmcnt(10)
    v_mfma_f32_16x16x32_bf16 v[112:115], v[168:171], v[56:59], v[112:115]
    ds_read_b64_tr_b16 v[52:53], v4 offset:61440
    v_mfma_f32_16x16x32_bf16 v[116:119], v[172:175], v[56:59], v[116:119]
    ds_read_b64_tr_b16 v[54:55], v4 offset:62464
    v_mfma_f32_16x16x32_bf16 v[120:123], v[168:171], v[60:63], v[120:123]
    ds_read_b64_tr_b16 v[56:57], v5 offset:61440
    v_mfma_f32_16x16x32_bf16 v[124:127], v[172:175], v[60:63], v[124:127]
    ds_read_b64_tr_b16 v[58:59], v5 offset:62464
    s_waitcnt lgkmcnt(10)
    v_mfma_f32_16x16x32_bf16 v[96:99], v[176:179], v[32:35], v[96:99]
    ds_read_b64_tr_b16 v[60:61], v6 offset:61440
    v_mfma_f32_16x16x32_bf16 v[100:103], v[180:183], v[32:35], v[100:103]
    ds_read_b64_tr_b16 v[62:63], v6 offset:62464
    s_barrier
    v_xor_b32 v3, 0x10000, v3
    v_xor_b32 v4, 0x10000, v4
    v_xor_b32 v5, 0x10000, v5
    v_xor_b32 v6, 0x10000, v6
    v_mfma_f32_16x16x32_bf16 v[104:107], v[176:179], v[36:39], v[104:107]
    ds_read_b64_tr_b16 v[32:33], v3 offset:0
    v_mfma_f32_16x16x32_bf16 v[108:111], v[180:183], v[36:39], v[108:111]
    ds_read_b64_tr_b16 v[34:35], v3 offset:1024
    s_waitcnt lgkmcnt(10)
    v_mfma_f32_16x16x32_bf16 v[112:115], v[176:179], v[40:43], v[112:115]
    ds_read_b64_tr_b16 v[36:37], v4 offset:0
    v_mfma_f32_16x16x32_bf16 v[116:119], v[180:183], v[40:43], v[116:119]
    ds_read_b64_tr_b16 v[38:39], v4 offset:1024
    v_mfma_f32_16x16x32_bf16 v[120:123], v[176:179], v[44:47], v[120:123]
    ds_read_b64_tr_b16 v[40:41], v5 offset:0
    v_mfma_f32_16x16x32_bf16 v[124:127], v[180:183], v[44:47], v[124:127]
    ds_read_b64_tr_b16 v[42:43], v5 offset:1024
    s_waitcnt lgkmcnt(10)
    v_mfma_f32_16x16x32_bf16 v[96:99], v[184:187], v[48:51], v[96:99]
    ds_read_b64_tr_b16 v[44:45], v6 offset:0
    v_mfma_f32_16x16x32_bf16 v[100:103], v[188:191], v[48:51], v[100:103]
    ds_read_b64_tr_b16 v[46:47], v6 offset:1024
    v_mfma_f32_16x16x32_bf16 v[104:107], v[184:187], v[52:55], v[104:107]
    ds_read_b64_tr_b16 v[48:49], v3 offset:4096
    v_mfma_f32_16x16x32_bf16 v[108:111], v[188:191], v[52:55], v[108:111]
    ds_read_b64_tr_b16 v[50:51], v3 offset:5120
    s_waitcnt lgkmcnt(10)
    v_mfma_f32_16x16x32_bf16 v[112:115], v[184:187], v[56:59], v[112:115]
    ds_read_b64_tr_b16 v[52:53], v4 offset:4096
    v_mfma_f32_16x16x32_bf16 v[116:119], v[188:191], v[56:59], v[116:119]
    ds_read_b64_tr_b16 v[54:55], v4 offset:5120
    v_mfma_f32_16x16x32_bf16 v[120:123], v[184:187], v[60:63], v[120:123]
    ds_read_b64_tr_b16 v[56:57], v5 offset:4096
    v_mfma_f32_16x16x32_bf16 v[124:127], v[188:191], v[60:63], v[124:127]
    ds_read_b64_tr_b16 v[58:59], v5 offset:5120
    s_waitcnt lgkmcnt(10)
    v_mfma_f32_16x16x32_bf16 v[96:99], v[192:195], v[32:35], v[96:99]
    ds_read_b64_tr_b16 v[60:61], v6 offset:4096
    v_mfma_f32_16x16x32_bf16 v[100:103], v[196:199], v[32:35], v[100:103]
    ds_read_b64_tr_b16 v[62:63], v6 offset:5120
    v_mfma_f32_16x16x32_bf16 v[104:107], v[192:195], v[36:39], v[104:107]
    ds_read_b64_tr_b16 v[32:33], v3 offset:8192
    v_mfma_f32_16x16x32_bf16 v[108:111], v[196:199], v[36:39], v[108:111]
    ds_read_b64_tr_b16 v[34:35], v3 offset:9216
    s_waitcnt lgkmcnt(10)
    v_mfma_f32_16x16x32_bf16 v[112:115], v[192:195], v[40:43], v[112:115]
    ds_read_b64_tr_b16 v[36:37], v4 offset:8192
    v_mfma_f32_16x16x32_bf16 v[116:119], v[196:199], v[40:43], v[116:119]
    ds_read_b64_tr_b16 v[38:39], v4 offset:9216
    v_mfma_f32_16x16x32_bf16 v[120:123], v[192:195], v[44:47], v[120:123]
    ds_read_b64_tr_b16 v[40:41], v5 offset:8192
    v_mfma_f32_16x16x32_bf16 v[124:127], v[196:199], v[44:47], v[124:127]
    ds_read_b64_tr_b16 v[42:43], v5 offset:9216
    s_waitcnt lgkmcnt(10)
    v_mfma_f32_16x16x32_bf16 v[96:99], v[200:203], v[48:51], v[96:99]
    ds_read_b64_tr_b16 v[44:45], v6 offset:8192
    v_mfma_f32_16x16x32_bf16 v[100:103], v[204:207], v[48:51], v[100:103]
    ds_read_b64_tr_b16 v[46:47], v6 offset:9216
    v_mfma_f32_16x16x32_bf16 v[104:107], v[200:203], v[52:55], v[104:107]
    ds_read_b64_tr_b16 v[48:49], v3 offset:12288
    v_mfma_f32_16x16x32_bf16 v[108:111], v[204:207], v[52:55], v[108:111]
    ds_read_b64_tr_b16 v[50:51], v3 offset:13312
    s_waitcnt lgkmcnt(10)
    v_mfma_f32_16x16x32_bf16 v[112:115], v[200:203], v[56:59], v[112:115]
    ds_read_b64_tr_b16 v[52:53], v4 offset:12288
    v_mfma_f32_16x16x32_bf16 v[116:119], v[204:207], v[56:59], v[116:119]
    ds_read_b64_tr_b16 v[54:55], v4 offset:13312
    v_mfma_f32_16x16x32_bf16 v[120:123], v[200:203], v[60:63], v[120:123]
    ds_read_b64_tr_b16 v[56:57], v5 offset:12288
    v_mfma_f32_16x16x32_bf16 v[124:127], v[204:207], v[60:63], v[124:127]
    ds_read_b64_tr_b16 v[58:59], v5 offset:13312
    s_waitcnt lgkmcnt(10)
    v_mfma_f32_16x16x32_bf16 v[96:99], v[208:211], v[32:35], v[96:99]
    ds_read_b64_tr_b16 v[60:61], v6 offset:12288
    v_mfma_f32_16x16x32_bf16 v[100:103], v[212:215], v[32:35], v[100:103]
    ds_read_b64_tr_b16 v[62:63], v6 offset:13312
    v_mfma_f32_16x16x32_bf16 v[104:107], v[208:211], v[36:39], v[104:107]
    ds_read_b64_tr_b16 v[32:33], v3 offset:16384
    ds_read_b128 v[16:19], v13 offset:4096
    v_mfma_f32_16x16x32_bf16 v[108:111], v[212:215], v[36:39], v[108:111]
    ds_read_b64_tr_b16 v[34:35], v3 offset:17408
    ds_read_b128 v[20:23], v13 offset:4608
    s_waitcnt lgkmcnt(12)
    v_mfma_f32_16x16x32_bf16 v[112:115], v[208:211], v[40:43], v[112:115]
    ds_read_b64_tr_b16 v[36:37], v4 offset:16384
    ds_read_b128 v[24:27], v13 offset:4160
    v_mfma_f32_16x16x32_bf16 v[116:119], v[212:215], v[40:43], v[116:119]
    ds_read_b64_tr_b16 v[38:39], v4 offset:17408
    ds_read_b128 v[28:31], v13 offset:4672
    v_mfma_f32_16x16x32_bf16 v[120:123], v[208:211], v[44:47], v[120:123]
    ds_read_b64_tr_b16 v[40:41], v5 offset:16384
    ds_read_b32 v8, v15 offset:512
    v_mfma_f32_16x16x32_bf16 v[124:127], v[212:215], v[44:47], v[124:127]
    ds_read_b64_tr_b16 v[42:43], v5 offset:17408
    ds_read_b32 v10, v15 offset:576
    s_waitcnt lgkmcnt(14)
    v_mfma_f32_16x16x32_bf16 v[96:99], v[216:219], v[48:51], v[96:99]
    ds_read_b64_tr_b16 v[44:45], v6 offset:16384
    ds_read_b32 v12, v15 offset:640
    v_mfma_f32_16x16x32_bf16 v[100:103], v[220:223], v[48:51], v[100:103]
    ds_read_b64_tr_b16 v[46:47], v6 offset:17408
    ds_read_b32 v14, v15 offset:704
    v_mfma_f32_16x16x32_bf16 v[104:107], v[216:219], v[52:55], v[104:107]
    ds_read_b64_tr_b16 v[48:49], v3 offset:20480
    v_mfma_f32_16x16x32_bf16 v[108:111], v[220:223], v[52:55], v[108:111]
    ds_read_b64_tr_b16 v[50:51], v3 offset:21504
    s_waitcnt lgkmcnt(14)
    v_mfma_f32_16x16x32_bf16 v[112:115], v[216:219], v[56:59], v[112:115]
    ds_read_b64_tr_b16 v[52:53], v4 offset:20480
    v_mfma_f32_16x16x32_bf16 v[116:119], v[220:223], v[56:59], v[116:119]
    ds_read_b64_tr_b16 v[54:55], v4 offset:21504
    v_mfma_f32_16x16x32_bf16 v[120:123], v[216:219], v[60:63], v[120:123]
    ds_read_b64_tr_b16 v[56:57], v5 offset:20480
    v_mfma_f32_16x16x32_bf16 v[124:127], v[220:223], v[60:63], v[124:127]
    ds_read_b64_tr_b16 v[58:59], v5 offset:21504
    s_waitcnt lgkmcnt(6)
    v_pk_fma_f32 v[96:97], v[8:9], v[16:17], v[96:97] op_sel_hi:[0,1,1] neg_lo:[1,0,0] neg_hi:[1,0,0]
    v_pk_fma_f32 v[98:99], v[8:9], v[18:19], v[98:99] op_sel_hi:[0,1,1] neg_lo:[1,0,0] neg_hi:[1,0,0]
    v_pk_fma_f32 v[104:105], v[10:11], v[16:17], v[104:105] op_sel_hi:[0,1,1] neg_lo:[1,0,0] neg_hi:[1,0,0]
    v_pk_fma_f32 v[106:107], v[10:11], v[18:19], v[106:107] op_sel_hi:[0,1,1] neg_lo:[1,0,0] neg_hi:[1,0,0]
    v_pk_mul_f32 v[96:97], v[20:21], v[96:97]
    v_pk_mul_f32 v[98:99], v[22:23], v[98:99]
    v_pk_mul_f32 v[104:105], v[20:21], v[104:105]
    v_pk_mul_f32 v[106:107], v[22:23], v[106:107]
    v_cvt_pk_bf16_f32 v72, v96, v97
    v_cvt_pk_bf16_f32 v73, v98, v99
    v_cvt_pk_bf16_f32 v74, v104, v105
    v_cvt_pk_bf16_f32 v75, v106, v107
    s_add_u32 s56, s52, 4194304
    v_permlane16_swap_b32 v72, v74
    v_permlane16_swap_b32 v73, v75
    buffer_store_dwordx4 v[72:75], v1, s[4:7], s56 offen offset:0 sc1
    v_pk_fma_f32 v[112:113], v[12:13], v[16:17], v[112:113] op_sel_hi:[0,1,1] neg_lo:[1,0,0] neg_hi:[1,0,0]
    v_pk_fma_f32 v[114:115], v[12:13], v[18:19], v[114:115] op_sel_hi:[0,1,1] neg_lo:[1,0,0] neg_hi:[1,0,0]
    v_pk_fma_f32 v[120:121], v[14:15], v[16:17], v[120:121] op_sel_hi:[0,1,1] neg_lo:[1,0,0] neg_hi:[1,0,0]
    v_pk_fma_f32 v[122:123], v[14:15], v[18:19], v[122:123] op_sel_hi:[0,1,1] neg_lo:[1,0,0] neg_hi:[1,0,0]
    v_pk_mul_f32 v[112:113], v[20:21], v[112:113]
    v_pk_mul_f32 v[114:115], v[22:23], v[114:115]
    v_pk_mul_f32 v[120:121], v[20:21], v[120:121]
    v_pk_mul_f32 v[122:123], v[22:23], v[122:123]
    v_cvt_pk_bf16_f32 v88, v112, v113
    v_cvt_pk_bf16_f32 v89, v114, v115
    v_cvt_pk_bf16_f32 v90, v120, v121
    v_cvt_pk_bf16_f32 v91, v122, v123
    s_add_u32 s56, s52, 4325376
    v_permlane16_swap_b32 v88, v90
    v_permlane16_swap_b32 v89, v91
    buffer_store_dwordx4 v[88:91], v1, s[4:7], s56 offen offset:0 sc1
    v_pk_fma_f32 v[100:101], v[8:9], v[24:25], v[100:101] op_sel_hi:[0,1,1] neg_lo:[1,0,0] neg_hi:[1,0,0]
    v_pk_fma_f32 v[102:103], v[8:9], v[26:27], v[102:103] op_sel_hi:[0,1,1] neg_lo:[1,0,0] neg_hi:[1,0,0]
    v_pk_fma_f32 v[108:109], v[10:11], v[24:25], v[108:109] op_sel_hi:[0,1,1] neg_lo:[1,0,0] neg_hi:[1,0,0]
    v_pk_fma_f32 v[110:111], v[10:11], v[26:27], v[110:111] op_sel_hi:[0,1,1] neg_lo:[1,0,0] neg_hi:[1,0,0]
    v_pk_mul_f32 v[100:101], v[28:29], v[100:101]
    v_pk_mul_f32 v[102:103], v[30:31], v[102:103]
    v_pk_mul_f32 v[108:109], v[28:29], v[108:109]
    v_pk_mul_f32 v[110:111], v[30:31], v[110:111]
    v_cvt_pk_bf16_f32 v76, v100, v101
    v_cvt_pk_bf16_f32 v77, v102, v103
    v_cvt_pk_bf16_f32 v78, v108, v109
    v_cvt_pk_bf16_f32 v79, v110, v111
    s_add_u32 s56, s52, 4194304
    v_permlane16_swap_b32 v76, v78
    v_permlane16_swap_b32 v77, v79
    buffer_store_dwordx4 v[76:79], v1, s[4:7], s56 offen offset:1024 sc1
    v_pk_fma_f32 v[116:117], v[12:13], v[24:25], v[116:117] op_sel_hi:[0,1,1] neg_lo:[1,0,0] neg_hi:[1,0,0]
    v_pk_fma_f32 v[118:119], v[12:13], v[26:27], v[118:119] op_sel_hi:[0,1,1] neg_lo:[1,0,0] neg_hi:[1,0,0]
    v_pk_fma_f32 v[124:125], v[14:15], v[24:25], v[124:125] op_sel_hi:[0,1,1] neg_lo:[1,0,0] neg_hi:[1,0,0]
    v_pk_fma_f32 v[126:127], v[14:15], v[26:27], v[126:127] op_sel_hi:[0,1,1] neg_lo:[1,0,0] neg_hi:[1,0,0]
    v_pk_mul_f32 v[116:117], v[28:29], v[116:117]
    v_pk_mul_f32 v[118:119], v[30:31], v[118:119]
    v_pk_mul_f32 v[124:125], v[28:29], v[124:125]
    v_pk_mul_f32 v[126:127], v[30:31], v[126:127]
    v_cvt_pk_bf16_f32 v92, v116, v117
    v_cvt_pk_bf16_f32 v93, v118, v119
    v_cvt_pk_bf16_f32 v94, v124, v125
    v_cvt_pk_bf16_f32 v95, v126, v127
    s_add_u32 s56, s52, 4325376
    v_permlane16_swap_b32 v92, v94
    v_permlane16_swap_b32 v93, v95
    buffer_store_dwordx4 v[92:95], v1, s[4:7], s56 offen offset:1024 sc1
    v_mfma_f32_16x16x32_bf16 v[128:131], v[32:35], v[224:227], v[128:131]
    ds_read_b64_tr_b16 v[60:61], v6 offset:20480
    v_mfma_f32_16x16x32_bf16 v[132:135], v[32:35], v[228:231], v[132:135]
    ds_read_b64_tr_b16 v[62:63], v6 offset:21504
    v_mfma_f32_16x16x32_bf16 v[136:139], v[36:39], v[224:227], v[136:139]
    ds_read_b64_tr_b16 v[32:33], v3 offset:24576
    v_mfma_f32_16x16x32_bf16 v[140:143], v[36:39], v[228:231], v[140:143]
    ds_read_b64_tr_b16 v[34:35], v3 offset:25600
    v_mfma_f32_16x16x32_bf16 v[144:147], v[40:43], v[224:227], v[144:147]
    ds_read_b64_tr_b16 v[36:37], v4 offset:24576
    v_mfma_f32_16x16x32_bf16 v[148:151], v[40:43], v[228:231], v[148:151]
    ds_read_b64_tr_b16 v[38:39], v4 offset:25600
    v_mfma_f32_16x16x32_bf16 v[152:155], v[44:47], v[224:227], v[152:155]
    ds_read_b64_tr_b16 v[40:41], v5 offset:24576
    v_mfma_f32_16x16x32_bf16 v[156:159], v[44:47], v[228:231], v[156:159]
    ds_read_b64_tr_b16 v[42:43], v5 offset:25600
    s_waitcnt lgkmcnt(10)
    v_mfma_f32_16x16x32_bf16 v[128:131], v[48:51], v[232:235], v[128:131]
    ds_read_b64_tr_b16 v[44:45], v6 offset:24576
    v_mfma_f32_16x16x32_bf16 v[132:135], v[48:51], v[236:239], v[132:135]
    ds_read_b64_tr_b16 v[46:47], v6 offset:25600
    v_mfma_f32_16x16x32_bf16 v[136:139], v[52:55], v[232:235], v[136:139]
    ds_read_b64_tr_b16 v[48:49], v3 offset:28672
    v_mfma_f32_16x16x32_bf16 v[140:143], v[52:55], v[236:239], v[140:143]
    ds_read_b64_tr_b16 v[50:51], v3 offset:29696
    s_waitcnt lgkmcnt(10)
    v_mfma_f32_16x16x32_bf16 v[144:147], v[56:59], v[232:235], v[144:147]
    ds_read_b64_tr_b16 v[52:53], v4 offset:28672
    v_mfma_f32_16x16x32_bf16 v[148:151], v[56:59], v[236:239], v[148:151]
    ds_read_b64_tr_b16 v[54:55], v4 offset:29696
    v_mfma_f32_16x16x32_bf16 v[152:155], v[60:63], v[232:235], v[152:155]
    ds_read_b64_tr_b16 v[56:57], v5 offset:28672
    v_mfma_f32_16x16x32_bf16 v[156:159], v[60:63], v[236:239], v[156:159]
    ds_read_b64_tr_b16 v[58:59], v5 offset:29696
    s_waitcnt lgkmcnt(10)
    v_mfma_f32_16x16x32_bf16 v[128:131], v[32:35], v[240:243], v[128:131]
    ds_read_b64_tr_b16 v[60:61], v6 offset:28672
    v_mfma_f32_16x16x32_bf16 v[132:135], v[32:35], v[244:247], v[132:135]
    ds_read_b64_tr_b16 v[62:63], v6 offset:29696
    s_barrier
    v_mfma_f32_16x16x32_bf16 v[136:139], v[36:39], v[240:243], v[136:139]
    ds_read_b64_tr_b16 v[32:33], v3 offset:32768
    v_mfma_f32_16x16x32_bf16 v[140:143], v[36:39], v[244:247], v[140:143]
    ds_read_b64_tr_b16 v[34:35], v3 offset:33792
    s_waitcnt lgkmcnt(10)
    v_mfma_f32_16x16x32_bf16 v[144:147], v[40:43], v[240:243], v[144:147]
    ds_read_b64_tr_b16 v[36:37], v4 offset:32768
    v_mfma_f32_16x16x32_bf16 v[148:151], v[40:43], v[244:247], v[148:151]
    ds_read_b64_tr_b16 v[38:39], v4 offset:33792
    v_mfma_f32_16x16x32_bf16 v[152:155], v[44:47], v[240:243], v[152:155]
    ds_read_b64_tr_b16 v[40:41], v5 offset:32768
    v_mfma_f32_16x16x32_bf16 v[156:159], v[44:47], v[244:247], v[156:159]
    ds_read_b64_tr_b16 v[42:43], v5 offset:33792
    s_waitcnt lgkmcnt(10)
    v_mfma_f32_16x16x32_bf16 v[128:131], v[48:51], v[248:251], v[128:131]
    ds_read_b64_tr_b16 v[44:45], v6 offset:32768
    v_mfma_f32_16x16x32_bf16 v[132:135], v[48:51], v[252:255], v[132:135]
    ds_read_b64_tr_b16 v[46:47], v6 offset:33792
    v_mfma_f32_16x16x32_bf16 v[136:139], v[52:55], v[248:251], v[136:139]
    ds_read_b64_tr_b16 v[48:49], v3 offset:36864
    v_mfma_f32_16x16x32_bf16 v[140:143], v[52:55], v[252:255], v[140:143]
    ds_read_b64_tr_b16 v[50:51], v3 offset:37888
    s_waitcnt lgkmcnt(10)
    v_mfma_f32_16x16x32_bf16 v[144:147], v[56:59], v[248:251], v[144:147]
    ds_read_b64_tr_b16 v[52:53], v4 offset:36864
    v_mfma_f32_16x16x32_bf16 v[148:151], v[56:59], v[252:255], v[148:151]
    ds_read_b64_tr_b16 v[54:55], v4 offset:37888
    v_mfma_f32_16x16x32_bf16 v[152:155], v[60:63], v[248:251], v[152:155]
    ds_read_b64_tr_b16 v[56:57], v5 offset:36864
    v_mfma_f32_16x16x32_bf16 v[156:159], v[60:63], v[252:255], v[156:159]
    ds_read_b64_tr_b16 v[58:59], v5 offset:37888
    s_waitcnt lgkmcnt(10)
    v_mfma_f32_16x16x32_bf16 v[128:131], v[32:35], v[160:163], v[128:131]
    ds_read_b64_tr_b16 v[60:61], v6 offset:36864
    v_mfma_f32_16x16x32_bf16 v[132:135], v[32:35], v[164:167], v[132:135]
    ds_read_b64_tr_b16 v[62:63], v6 offset:37888
    v_mfma_f32_16x16x32_bf16 v[136:139], v[36:39], v[160:163], v[136:139]
    ds_read_b64_tr_b16 v[32:33], v3 offset:40960
    v_mfma_f32_16x16x32_bf16 v[140:143], v[36:39], v[164:167], v[140:143]
    ds_read_b64_tr_b16 v[34:35], v3 offset:41984
    s_waitcnt lgkmcnt(10)
    v_mfma_f32_16x16x32_bf16 v[144:147], v[40:43], v[160:163], v[144:147]
    ds_read_b64_tr_b16 v[36:37], v4 offset:40960
    v_mfma_f32_16x16x32_bf16 v[148:151], v[40:43], v[164:167], v[148:151]
    ds_read_b64_tr_b16 v[38:39], v4 offset:41984
    v_mfma_f32_16x16x32_bf16 v[152:155], v[44:47], v[160:163], v[152:155]
    ds_read_b64_tr_b16 v[40:41], v5 offset:40960
    v_mfma_f32_16x16x32_bf16 v[156:159], v[44:47], v[164:167], v[156:159]
    ds_read_b64_tr_b16 v[42:43], v5 offset:41984
    s_waitcnt lgkmcnt(10)
    v_mfma_f32_16x16x32_bf16 v[128:131], v[48:51], v[168:171], v[128:131]
    ds_read_b64_tr_b16 v[44:45], v6 offset:40960
    v_mfma_f32_16x16x32_bf16 v[132:135], v[48:51], v[172:175], v[132:135]
    ds_read_b64_tr_b16 v[46:47], v6 offset:41984
    v_mfma_f32_16x16x32_bf16 v[136:139], v[52:55], v[168:171], v[136:139]
    ds_read_b64_tr_b16 v[48:49], v3 offset:45056
    v_mfma_f32_16x16x32_bf16 v[140:143], v[52:55], v[172:175], v[140:143]
    ds_read_b64_tr_b16 v[50:51], v3 offset:46080
    s_waitcnt lgkmcnt(10)
    v_mfma_f32_16x16x32_bf16 v[144:147], v[56:59], v[168:171], v[144:147]
    ds_read_b64_tr_b16 v[52:53], v4 offset:45056
    v_mfma_f32_16x16x32_bf16 v[148:151], v[56:59], v[172:175], v[148:151]
    ds_read_b64_tr_b16 v[54:55], v4 offset:46080
    v_mfma_f32_16x16x32_bf16 v[152:155], v[60:63], v[168:171], v[152:155]
    ds_read_b64_tr_b16 v[56:57], v5 offset:45056
    v_mfma_f32_16x16x32_bf16 v[156:159], v[60:63], v[172:175], v[156:159]
    ds_read_b64_tr_b16 v[58:59], v5 offset:46080
    s_waitcnt lgkmcnt(10)
    v_mfma_f32_16x16x32_bf16 v[128:131], v[32:35], v[176:179], v[128:131]
    ds_read_b64_tr_b16 v[60:61], v6 offset:45056
    v_mfma_f32_16x16x32_bf16 v[132:135], v[32:35], v[180:183], v[132:135]
    ds_read_b64_tr_b16 v[62:63], v6 offset:46080
    v_mfma_f32_16x16x32_bf16 v[136:139], v[36:39], v[176:179], v[136:139]
    ds_read_b64_tr_b16 v[32:33], v3 offset:49152
    v_mfma_f32_16x16x32_bf16 v[140:143], v[36:39], v[180:183], v[140:143]
    ds_read_b64_tr_b16 v[34:35], v3 offset:50176
    s_waitcnt lgkmcnt(10)
    v_mfma_f32_16x16x32_bf16 v[144:147], v[40:43], v[176:179], v[144:147]
    ds_read_b64_tr_b16 v[36:37], v4 offset:49152
    v_mfma_f32_16x16x32_bf16 v[148:151], v[40:43], v[180:183], v[148:151]
    ds_read_b64_tr_b16 v[38:39], v4 offset:50176
    v_mfma_f32_16x16x32_bf16 v[152:155], v[44:47], v[176:179], v[152:155]
    ds_read_b64_tr_b16 v[40:41], v5 offset:49152
    v_mfma_f32_16x16x32_bf16 v[156:159], v[44:47], v[180:183], v[156:159]
    ds_read_b64_tr_b16 v[42:43], v5 offset:50176
    s_waitcnt lgkmcnt(10)
    v_mfma_f32_16x16x32_bf16 v[128:131], v[48:51], v[184:187], v[128:131]
    ds_read_b64_tr_b16 v[44:45], v6 offset:49152
    s_mov_b32 s68, 1
    s_waitcnt vmcnt(0)
    s_atomic_add s68, s[22:23], s59 glc
    s_mov_b32 s55, s52
    s_add_u32 s56, s52, 4194304
    ds_read_b32 v8, v9 offset:4096
    v_mfma_f32_16x16x32_bf16 v[132:135], v[48:51], v[188:191], v[132:135]
    ds_read_b64_tr_b16 v[46:47], v6 offset:50176
    buffer_load_dwordx4 v[64:67], v1, s[4:7], s55 offen offset:0 sc1
    ds_read_b32 v10, v9 offset:4608
    v_mfma_f32_16x16x32_bf16 v[136:139], v[52:55], v[184:187], v[136:139]
    ds_read_b64_tr_b16 v[48:49], v3 offset:53248
    buffer_load_dwordx4 v[68:71], v1, s[4:7], s55 offen offset:1024 sc1
    ds_read_b32 v12, v9 offset:4160
    v_mfma_f32_16x16x32_bf16 v[140:143], v[52:55], v[188:191], v[140:143]
    ds_read_b64_tr_b16 v[50:51], v3 offset:54272
    buffer_load_dwordx4 v[72:75], v1, s[4:7], s56 offen offset:0 sc1
    ds_read_b32 v14, v9 offset:4672
    s_waitcnt lgkmcnt(14)
    v_mfma_f32_16x16x32_bf16 v[144:147], v[56:59], v[184:187], v[144:147]
    ds_read_b64_tr_b16 v[52:53], v4 offset:53248
    buffer_load_dwordx4 v[76:79], v1, s[4:7], s56 offen offset:1024 sc1
    ds_read_b128 v[16:19], v11 offset:0
    v_mfma_f32_16x16x32_bf16 v[148:151], v[56:59], v[188:191], v[148:151]
    ds_read_b64_tr_b16 v[54:55], v4 offset:54272
    ds_read_b128 v[20:23], v11 offset:64
    v_mfma_f32_16x16x32_bf16 v[152:155], v[60:63], v[184:187], v[152:155]
    ds_read_b64_tr_b16 v[56:57], v5 offset:53248
    ds_read_b128 v[24:27], v11 offset:128
    v_mfma_f32_16x16x32_bf16 v[156:159], v[60:63], v[188:191], v[156:159]
    ds_read_b64_tr_b16 v[58:59], v5 offset:54272
    ds_read_b128 v[28:31], v11 offset:192
    s_waitcnt lgkmcnt(14)
    v_mfma_f32_16x16x32_bf16 v[128:131], v[32:35], v[192:195], v[128:131]
    ds_read_b64_tr_b16 v[60:61], v6 offset:53248
    v_mfma_f32_16x16x32_bf16 v[132:135], v[32:35], v[196:199], v[132:135]
    ds_read_b64_tr_b16 v[62:63], v6 offset:54272
    v_mfma_f32_16x16x32_bf16 v[136:139], v[36:39], v[192:195], v[136:139]
    ds_read_b64_tr_b16 v[32:33], v3 offset:57344
    v_mfma_f32_16x16x32_bf16 v[140:143], v[36:39], v[196:199], v[140:143]
    ds_read_b64_tr_b16 v[34:35], v3 offset:58368
    s_waitcnt lgkmcnt(14)
    v_mfma_f32_16x16x32_bf16 v[144:147], v[40:43], v[192:195], v[144:147]
    ds_read_b64_tr_b16 v[36:37], v4 offset:57344
    v_mfma_f32_16x16x32_bf16 v[148:151], v[40:43], v[196:199], v[148:151]
    ds_read_b64_tr_b16 v[38:39], v4 offset:58368
    v_mfma_f32_16x16x32_bf16 v[152:155], v[44:47], v[192:195], v[152:155]
    ds_read_b64_tr_b16 v[40:41], v5 offset:57344
    v_mfma_f32_16x16x32_bf16 v[156:159], v[44:47], v[196:199], v[156:159]
    ds_read_b64_tr_b16 v[42:43], v5 offset:58368
    s_waitcnt lgkmcnt(13)
    v_mfma_f32_16x16x32_bf16 v[128:131], v[48:51], v[200:203], v[128:131]
    ds_read_b64_tr_b16 v[44:45], v6 offset:57344
    s_waitcnt lgkmcnt(9)
    v_mfma_f32_16x16x32_bf16 v[132:135], v[48:51], v[204:207], v[132:135]
    ds_read_b64_tr_b16 v[46:47], v6 offset:58368
    v_mul_f32 v10, 0x3e8293ee, v10
    v_mfma_f32_16x16x32_bf16 v[136:139], v[52:55], v[200:203], v[136:139]
    ds_read_b64_tr_b16 v[48:49], v3 offset:61440
    v_mul_f32 v14, 0x3e8293ee, v14
    v_mfma_f32_16x16x32_bf16 v[140:143], v[52:55], v[204:207], v[140:143]
    ds_read_b64_tr_b16 v[50:51], v3 offset:62464
    s_lshl_b32 s44, s16, 11
    s_waitcnt lgkmcnt(10)
    v_mfma_f32_16x16x32_bf16 v[144:147], v[56:59], v[200:203], v[144:147]
    ds_read_b64_tr_b16 v[52:53], v4 offset:61440
    s_add_u32 s44, s44, 131072
    v_mfma_f32_16x16x32_bf16 v[148:151], v[56:59], v[204:207], v[148:151]
    ds_read_b64_tr_b16 v[54:55], v4 offset:62464
    v_add_u32 v13, s44, v2
    v_mfma_f32_16x16x32_bf16 v[152:155], v[60:63], v[200:203], v[152:155]
    ds_read_b64_tr_b16 v[56:57], v5 offset:61440
    v_mfma_f32_16x16x32_bf16 v[156:159], v[60:63], v[204:207], v[156:159]
    ds_read_b64_tr_b16 v[58:59], v5 offset:62464
    s_waitcnt lgkmcnt(10)
    v_mfma_f32_16x16x32_bf16 v[128:131], v[32:35], v[208:211], v[128:131]
    ds_read_b64_tr_b16 v[60:61], v6 offset:61440
    v_mfma_f32_16x16x32_bf16 v[132:135], v[32:35], v[212:215], v[132:135]
    ds_read_b64_tr_b16 v[62:63], v6 offset:62464
    v_xor_b32 v3, 0x10000, v3
    v_xor_b32 v4, 0x10000, v4
    v_xor_b32 v5, 0x10000, v5
    v_xor_b32 v6, 0x10000, v6
    v_mfma_f32_16x16x32_bf16 v[136:139], v[36:39], v[208:211], v[136:139]
    v_mfma_f32_16x16x32_bf16 v[140:143], v[36:39], v[212:215], v[140:143]
    s_waitcnt lgkmcnt(8)
    v_mfma_f32_16x16x32_bf16 v[144:147], v[40:43], v[208:211], v[144:147]
    v_mfma_f32_16x16x32_bf16 v[148:151], v[40:43], v[212:215], v[148:151]
    v_mfma_f32_16x16x32_bf16 v[152:155], v[44:47], v[208:211], v[152:155]
    v_mfma_f32_16x16x32_bf16 v[156:159], v[44:47], v[212:215], v[156:159]
    s_waitcnt lgkmcnt(4)
    v_mfma_f32_16x16x32_bf16 v[128:131], v[48:51], v[216:219], v[128:131]
    v_mfma_f32_16x16x32_bf16 v[132:135], v[48:51], v[220:223], v[132:135]
    v_mfma_f32_16x16x32_bf16 v[136:139], v[52:55], v[216:219], v[136:139]
    v_mfma_f32_16x16x32_bf16 v[140:143], v[52:55], v[220:223], v[140:143]
    s_waitcnt lgkmcnt(0)
    v_mfma_f32_16x16x32_bf16 v[144:147], v[56:59], v[216:219], v[144:147]
    v_mfma_f32_16x16x32_bf16 v[148:151], v[56:59], v[220:223], v[148:151]
    v_mfma_f32_16x16x32_bf16 v[152:155], v[60:63], v[216:219], v[152:155]
    v_mfma_f32_16x16x32_bf16 v[156:159], v[60:63], v[220:223], v[156:159]
    v_pk_fma_f32 v[128:129], v[8:9], v[16:17], v[128:129] op_sel_hi:[0,1,1] neg_lo:[1,0,0] neg_hi:[1,0,0]
    v_pk_fma_f32 v[130:131], v[8:9], v[18:19], v[130:131] op_sel_hi:[0,1,1] neg_lo:[1,0,0] neg_hi:[1,0,0]
    v_pk_fma_f32 v[136:137], v[8:9], v[20:21], v[136:137] op_sel_hi:[0,1,1] neg_lo:[1,0,0] neg_hi:[1,0,0]
    v_pk_fma_f32 v[138:139], v[8:9], v[22:23], v[138:139] op_sel_hi:[0,1,1] neg_lo:[1,0,0] neg_hi:[1,0,0]
    v_pk_mul_f32 v[128:129], v[10:11], v[128:129] op_sel_hi:[0,1]
    v_pk_mul_f32 v[130:131], v[10:11], v[130:131] op_sel_hi:[0,1]
    v_pk_mul_f32 v[136:137], v[10:11], v[136:137] op_sel_hi:[0,1]
    v_pk_mul_f32 v[138:139], v[10:11], v[138:139] op_sel_hi:[0,1]
    v_cvt_pk_bf16_f32 v128, v128, v129
    v_cvt_pk_bf16_f32 v129, v130, v131
    v_cvt_pk_bf16_f32 v130, v136, v137
    v_cvt_pk_bf16_f32 v131, v138, v139
    ds_write_b128 v13, v[128:131] offset:0
    v_pk_fma_f32 v[132:133], v[12:13], v[16:17], v[132:133] op_sel_hi:[0,1,1] neg_lo:[1,0,0] neg_hi:[1,0,0]
    v_pk_fma_f32 v[134:135], v[12:13], v[18:19], v[134:135] op_sel_hi:[0,1,1] neg_lo:[1,0,0] neg_hi:[1,0,0]
    v_pk_fma_f32 v[140:141], v[12:13], v[20:21], v[140:141] op_sel_hi:[0,1,1] neg_lo:[1,0,0] neg_hi:[1,0,0]
    v_pk_fma_f32 v[142:143], v[12:13], v[22:23], v[142:143] op_sel_hi:[0,1,1] neg_lo:[1,0,0] neg_hi:[1,0,0]
    v_pk_mul_f32 v[132:133], v[14:15], v[132:133] op_sel_hi:[0,1]
    v_pk_mul_f32 v[134:135], v[14:15], v[134:135] op_sel_hi:[0,1]
    v_pk_mul_f32 v[140:141], v[14:15], v[140:141] op_sel_hi:[0,1]
    v_pk_mul_f32 v[142:143], v[14:15], v[142:143] op_sel_hi:[0,1]
    v_cvt_pk_bf16_f32 v132, v132, v133
    v_cvt_pk_bf16_f32 v133, v134, v135
    v_cvt_pk_bf16_f32 v134, v140, v141
    v_cvt_pk_bf16_f32 v135, v142, v143
    ds_write_b128 v13, v[132:135] offset:256
    v_add_u32 v4, 131072, v1
    s_waitcnt lgkmcnt(0)
    s_cmp_eq_u32 s68, 15
    s_cselect_b32 s68, 16, 0
    s_cbranch_scc1 b_k2
    s_atomic_add s68, s[22:23], s59 glc
b_k2:
    s_barrier
    ds_read_b128 v[32:35], v4 offset:0
    ds_read_b128 v[36:39], v4 offset:1024
    ds_read_b128 v[40:43], v4 offset:2048
    ds_read_b128 v[44:47], v4 offset:3072
    ds_read_b128 v[48:51], v4 offset:4096
    ds_read_b128 v[52:55], v4 offset:5120
    ds_read_b128 v[56:59], v4 offset:6144
    ds_read_b128 v[60:63], v4 offset:7168
    v_pk_fma_f32 v[144:145], v[8:9], v[24:25], v[144:145] op_sel_hi:[0,1,1] neg_lo:[1,0,0] neg_hi:[1,0,0]
    v_pk_fma_f32 v[146:147], v[8:9], v[26:27], v[146:147] op_sel_hi:[0,1,1] neg_lo:[1,0,0] neg_hi:[1,0,0]
    v_pk_fma_f32 v[152:153], v[8:9], v[28:29], v[152:153] op_sel_hi:[0,1,1] neg_lo:[1,0,0] neg_hi:[1,0,0]
    v_pk_fma_f32 v[154:155], v[8:9], v[30:31], v[154:155] op_sel_hi:[0,1,1] neg_lo:[1,0,0] neg_hi:[1,0,0]
    v_pk_mul_f32 v[144:145], v[10:11], v[144:145] op_sel_hi:[0,1]
    v_pk_mul_f32 v[146:147], v[10:11], v[146:147] op_sel_hi:[0,1]
    v_pk_mul_f32 v[152:153], v[10:11], v[152:153] op_sel_hi:[0,1]
    v_pk_mul_f32 v[154:155], v[10:11], v[154:155] op_sel_hi:[0,1]
    v_cvt_pk_bf16_f32 v144, v144, v145
    v_cvt_pk_bf16_f32 v145, v146, v147
    v_cvt_pk_bf16_f32 v146, v152, v153
    v_cvt_pk_bf16_f32 v147, v154, v155
    ds_write_b128 v13, v[144:147] offset:8192
    s_waitcnt vmcnt(0) lgkmcnt(7)
    v_mfma_f32_32x32x16_bf16 v[192:207], v[64:67], v[32:35], 0
    v_mfma_f32_32x32x16_bf16 v[192:207], v[68:71], v[36:39], v[192:207]
    v_pk_fma_f32 v[148:149], v[12:13], v[24:25], v[148:149] op_sel_hi:[0,1,1] neg_lo:[1,0,0] neg_hi:[1,0,0]
    v_pk_fma_f32 v[150:151], v[12:13], v[26:27], v[150:151] op_sel_hi:[0,1,1] neg_lo:[1,0,0] neg_hi:[1,0,0]
    v_pk_fma_f32 v[156:157], v[12:13], v[28:29], v[156:157] op_sel_hi:[0,1,1] neg_lo:[1,0,0] neg_hi:[1,0,0]
    v_pk_fma_f32 v[158:159], v[12:13], v[30:31], v[158:159] op_sel_hi:[0,1,1] neg_lo:[1,0,0] neg_hi:[1,0,0]
    v_pk_mul_f32 v[148:149], v[14:15], v[148:149] op_sel_hi:[0,1]
    v_pk_mul_f32 v[150:151], v[14:15], v[150:151] op_sel_hi:[0,1]
    v_pk_mul_f32 v[156:157], v[14:15], v[156:157] op_sel_hi:[0,1]
    v_pk_mul_f32 v[158:159], v[14:15], v[158:159] op_sel_hi:[0,1]
    v_cvt_pk_bf16_f32 v148, v148, v149
    v_cvt_pk_bf16_f32 v149, v150, v151
    v_cvt_pk_bf16_f32 v150, v156, v157
    v_cvt_pk_bf16_f32 v151, v158, v159
    ds_write_b128 v13, v[148:151] offset:8448
    v_mov_b32 v9, 0xdddddddd
    v_bfe_u32 v10, v1, 4, 3
    v_mov_b32 v11, 0x3f803f80
    v_cmp_eq_u32 vcc, 0, v10
    v_cmp_eq_u32 s[44:45], 4, v10
    s_mov_b32 s57, 0
    v_cndmask_b32 v28, 0, v11, vcc
    v_cndmask_b32 v29, 0, v11, vcc
    v_cndmask_b32 v30, 0, v11, s[44:45]
    v_cndmask_b32 v31, 0, v11, s[44:45]
    v_mov_b32 v10, 0
    v_mov_b32 v11, 0
    s_mov_b32 s66, 0x10000
    s_waitcnt lgkmcnt(0)
    s_cmp_eq_u32 s68, 16
    s_cbranch_scc1 c_k_ok
c_k_poll:
    s_mov_b32 s68, 0
    s_atomic_add s68, s[22:23], s59 offset:0 glc
    s_sub_u32 s66, s66, 1
    s_cselect_b32 s67, 16, 0
    s_waitcnt lgkmcnt(0)
    s_max_u32 s68, s68, s67
    s_cmp_lt_u32 s68, 16
    s_cbranch_scc1 c_k_poll
c_k_ok:
    s_add_u32 s54, s54, 8192
    s_and_b32 s54, s54, 0x1ffff
    s_add_u32 s55, s53, s54
    s_add_u32 s56, s55, 4194304
    buffer_load_dwordx4 v[80:83], v1, s[4:7], s55 offen offset:0 sc1
    buffer_load_dwordx4 v[84:87], v1, s[4:7], s55 offen offset:1024 sc1
    buffer_load_dwordx4 v[88:91], v1, s[4:7], s56 offen offset:0 sc1
    buffer_load_dwordx4 v[92:95], v1, s[4:7], s56 offen offset:1024 sc1
    s_add_u32 s54, s54, 8192
    s_and_b32 s54, s54, 0x1ffff
    s_add_u32 s55, s53, s54
    s_add_u32 s56, s55, 4194304
    buffer_load_dwordx4 v[96:99], v1, s[4:7], s55 offen offset:0 sc1
    buffer_load_dwordx4 v[100:103], v1, s[4:7], s55 offen offset:1024 sc1
    buffer_load_dwordx4 v[104:107], v1, s[4:7], s56 offen offset:0 sc1
    buffer_load_dwordx4 v[108:111], v1, s[4:7], s56 offen offset:1024 sc1
    v_mfma_f32_32x32x16_bf16 v[208:223], v[64:67], v[40:43], 0
    s_add_u32 s54, s54, 8192
    s_and_b32 s54, s54, 0x1ffff
    s_add_u32 s55, s53, s54
    s_add_u32 s56, s55, 4194304
    v_exp_f32 v192, v192
    v_exp_f32 v193, v193
    v_exp_f32 v194, v194
    v_mfma_f32_32x32x8_bf16 v[128:143], v[10:11], v[10:11], 0
    v_mov_b32 v12, 0
    v_exp_f32 v195, v195
    v_exp_f32 v196, v196
    v_exp_f32 v197, v197
    v_mfma_f32_32x32x16_bf16 v[208:223], v[68:71], v[44:47], v[208:223]
    v_exp_f32 v198, v198
    v_exp_f32 v199, v199
    v_exp_f32 v200, v200
    v_mfma_f32_32x32x8_bf16 v[144:159], v[10:11], v[10:11], 0
    v_mov_b32 v16, 0
    buffer_load_dwordx4 v[112:115], v1, s[4:7], s55 offen offset:0 sc1
    v_exp_f32 v201, v201
    v_exp_f32 v202, v202
    v_mfma_f32_32x32x8_bf16 v[160:175], v[10:11], v[10:11], 0
    v_mov_b32 v20, 0
    s_lshl_b32 s44, s16, 12
    s_add_u32 s44, s44, 65536
    v_add_u32 v5, s44, v1
    s_lshl_b32 s44, s16, 8
    s_add_u32 s44, s44, 147456
    v_lshrrev_b32 v6, 2, v1
    v_add_u32 v6, s44, v6
    s_lshl_b32 s44, s21, 22
    s_lshl_b32 s45, s38, 16
    s_add_u32 s41, s44, s45
    s_lshl_b32 s45, s18, 12
    s_add_u32 s43, s41, s45
    s_and_b32 s45, s45, 0
    s_add_u32 s41, s41, s45
    s_add_u32 s41, s41, 16777216
    v_exp_f32 v203, v203
    v_exp_f32 v204, v204
    v_exp_f32 v205, v205
    v_mfma_f32_32x32x8_bf16 v[176:191], v[10:11], v[10:11], 0
    v_mov_b32 v24, 0
    v_exp_f32 v206, v206
    v_exp_f32 v207, v207
    v_mfma_f32_32x32x16_bf16 v[224:239], v[64:67], v[48:51], 0
    v_exp_f32 v208, v208
    v_exp_f32 v209, v209
    v_exp_f32 v210, v210
    v_smfmac_f32_32x32x32_bf16 v[128:143], v[72:75], v[192:199], v9
    v_exp_f32 v211, v211
    v_exp_f32 v212, v212
    v_exp_f32 v213, v213
    v_mfma_f32_32x32x16_bf16 v[224:239], v[68:71], v[52:55], v[224:239]
    v_exp_f32 v214, v214
    v_exp_f32 v215, v215
    v_exp_f32 v216, v216
    v_smfmac_f32_16x16x64_bf16 v[12:15], v[28:31], v[192:199], v9
    buffer_load_dwordx4 v[116:119], v1, s[4:7], s55 offen offset:1024 sc1
    v_exp_f32 v217, v217
    v_smfmac_f32_32x32x32_bf16 v[128:143], v[76:79], v[200:207], v9
    v_exp_f32 v218, v218
    v_exp_f32 v219, v219
    v_exp_f32 v220, v220
    v_smfmac_f32_16x16x64_bf16 v[12:15], v[28:31], v[200:207], v9
    v_exp_f32 v221, v221
    v_exp_f32 v222, v222
    v_exp_f32 v223, v223
b_head:
    s_mov_b32 s58, 3
b_loop:
    v_mfma_f32_32x32x16_bf16 v[240:255], v[64:67], v[56:59], 0
    v_exp_f32 v224, v224
    v_exp_f32 v225, v225
    v_exp_f32 v226, v226
    v_smfmac_f32_32x32x32_bf16 v[144:159], v[72:75], v[208:215], v9
    v_exp_f32 v227, v227
    v_exp_f32 v228, v228
    v_exp_f32 v229, v229
    v_mfma_f32_32x32x16_bf16 v[240:255], v[68:71], v[60:63], v[240:255]
    v_exp_f32 v230, v230
    v_exp_f32 v231, v231
    v_exp_f32 v232, v232
    v_smfmac_f32_16x16x64_bf16 v[16:19], v[28:31], v[208:215], v9
    buffer_load_dwordx4 v[120:123], v1, s[4:7], s56 offen offset:0 sc1
    v_exp_f32 v233, v233
    v_smfmac_f32_32x32x32_bf16 v[144:159], v[76:79], v[216:223], v9
    v_exp_f32 v234, v234
    v_exp_f32 v235, v235
    v_exp_f32 v236, v236
    v_smfmac_f32_16x16x64_bf16 v[16:19], v[28:31], v[216:223], v9
    v_exp_f32 v237, v237
    v_exp_f32 v238, v238
    v_exp_f32 v239, v239
    s_waitcnt vmcnt(7)
    v_mfma_f32_32x32x16_bf16 v[192:207], v[80:83], v[32:35], 0
    v_exp_f32 v240, v240
    v_exp_f32 v241, v241
    v_exp_f32 v242, v242
    v_smfmac_f32_32x32x32_bf16 v[160:175], v[72:75], v[224:231], v9
    v_exp_f32 v243, v243
    v_exp_f32 v244, v244
    v_exp_f32 v245, v245
    v_mfma_f32_32x32x16_bf16 v[192:207], v[84:87], v[36:39], v[192:207]
    v_exp_f32 v246, v246
    v_exp_f32 v247, v247
    v_exp_f32 v248, v248
    v_smfmac_f32_16x16x64_bf16 v[20:23], v[28:31], v[224:231], v9
    buffer_load_dwordx4 v[124:127], v1, s[4:7], s56 offen offset:1024 sc1
    v_exp_f32 v249, v249
    v_smfmac_f32_32x32x32_bf16 v[160:175], v[76:79], v[232:239], v9
    v_exp_f32 v250, v250
    v_exp_f32 v251, v251
    v_exp_f32 v252, v252
    v_smfmac_f32_16x16x64_bf16 v[20:23], v[28:31], v[232:239], v9
    v_exp_f32 v253, v253
    v_exp_f32 v254, v254
    v_exp_f32 v255, v255
    v_mfma_f32_32x32x16_bf16 v[208:223], v[80:83], v[40:43], 0
    s_add_u32 s54, s54, 8192
    s_and_b32 s54, s54, 0x1ffff
    s_add_u32 s55, s53, s54
    s_add_u32 s56, s55, 4194304
    v_exp_f32 v192, v192
    v_exp_f32 v193, v193
    v_exp_f32 v194, v194
    v_smfmac_f32_32x32x32_bf16 v[176:191], v[72:75], v[240:247], v9
    v_exp_f32 v195, v195
    v_exp_f32 v196, v196
    v_exp_f32 v197, v197
    v_mfma_f32_32x32x16_bf16 v[208:223], v[84:87], v[44:47], v[208:223]
    v_exp_f32 v198, v198
    v_exp_f32 v199, v199
    v_exp_f32 v200, v200
    v_smfmac_f32_16x16x64_bf16 v[24:27], v[28:31], v[240:247], v9
    buffer_load_dwordx4 v[64:67], v1, s[4:7], s55 offen offset:0 sc1
    v_exp_f32 v201, v201
    v_smfmac_f32_32x32x32_bf16 v[176:191], v[76:79], v[248:255], v9
    v_exp_f32 v202, v202
    v_exp_f32 v203, v203
    v_exp_f32 v204, v204
    v_smfmac_f32_16x16x64_bf16 v[24:27], v[28:31], v[248:255], v9
    v_exp_f32 v205, v205
    v_exp_f32 v206, v206
    v_exp_f32 v207, v207
    v_mfma_f32_32x32x16_bf16 v[224:239], v[80:83], v[48:51], 0
    v_exp_f32 v208, v208
    v_exp_f32 v209, v209
    v_exp_f32 v210, v210
    v_smfmac_f32_32x32x32_bf16 v[128:143], v[88:91], v[192:199], v9
    v_exp_f32 v211, v211
    v_exp_f32 v212, v212
    v_exp_f32 v213, v213
    v_mfma_f32_32x32x16_bf16 v[224:239], v[84:87], v[52:55], v[224:239]
    v_exp_f32 v214, v214
    v_exp_f32 v215, v215
    v_exp_f32 v216, v216
    v_smfmac_f32_16x16x64_bf16 v[12:15], v[28:31], v[192:199], v9
    buffer_load_dwordx4 v[68:71], v1, s[4:7], s55 offen offset:1024 sc1
    v_exp_f32 v217, v217
    v_smfmac_f32_32x32x32_bf16 v[128:143], v[92:95], v[200:207], v9
    v_exp_f32 v218, v218
    v_exp_f32 v219, v219
    v_exp_f32 v220, v220
    v_smfmac_f32_16x16x64_bf16 v[12:15], v[28:31], v[200:207], v9
    v_exp_f32 v221, v221
    v_exp_f32 v222, v222
    v_exp_f32 v223, v223
    v_mfma_f32_32x32x16_bf16 v[240:255], v[80:83], v[56:59], 0
    v_exp_f32 v224, v224
    v_exp_f32 v225, v225
    v_exp_f32 v226, v226
    v_smfmac_f32_32x32x32_bf16 v[144:159], v[88:91], v[208:215], v9
    v_exp_f32 v227, v227
    v_exp_f32 v228, v228
    v_exp_f32 v229, v229
    v_mfma_f32_32x32x16_bf16 v[240:255], v[84:87], v[60:63], v[240:255]
    v_exp_f32 v230, v230
    v_exp_f32 v231, v231
    v_exp_f32 v232, v232
    v_smfmac_f32_16x16x64_bf16 v[16:19], v[28:31], v[208:215], v9
    buffer_load_dwordx4 v[72:75], v1, s[4:7], s56 offen offset:0 sc1
    v_exp_f32 v233, v233
    v_smfmac_f32_32x32x32_bf16 v[144:159], v[92:95], v[216:223], v9
    v_exp_f32 v234, v234
    v_exp_f32 v235, v235
    v_exp_f32 v236, v236
    v_smfmac_f32_16x16x64_bf16 v[16:19], v[28:31], v[216:223], v9
    v_exp_f32 v237, v237
    v_exp_f32 v238, v238
    v_exp_f32 v239, v239
    s_waitcnt vmcnt(7)
    v_mfma_f32_32x32x16_bf16 v[192:207], v[96:99], v[32:35], 0
    v_exp_f32 v240, v240
    v_exp_f32 v241, v241
    v_exp_f32 v242, v242
    v_smfmac_f32_32x32x32_bf16 v[160:175], v[88:91], v[224:231], v9
    v_exp_f32 v243, v243
    v_exp_f32 v244, v244
    v_exp_f32 v245, v245
    v_mfma_f32_32x32x16_bf16 v[192:207], v[100:103], v[36:39], v[192:207]
    v_exp_f32 v246, v246
    v_exp_f32 v247, v247
    v_exp_f32 v248, v248
    v_smfmac_f32_16x16x64_bf16 v[20:23], v[28:31], v[224:231], v9
    buffer_load_dwordx4 v[76:79], v1, s[4:7], s56 offen offset:1024 sc1
    v_exp_f32 v249, v249
    v_smfmac_f32_32x32x32_bf16 v[160:175], v[92:95], v[232:239], v9
    v_exp_f32 v250, v250
    v_exp_f32 v251, v251
    v_exp_f32 v252, v252
    v_smfmac_f32_16x16x64_bf16 v[20:23], v[28:31], v[232:239], v9
    v_exp_f32 v253, v253
    v_exp_f32 v254, v254
    v_exp_f32 v255, v255
    v_mfma_f32_32x32x16_bf16 v[208:223], v[96:99], v[40:43], 0
    s_add_u32 s54, s54, 8192
    s_and_b32 s54, s54, 0x1ffff
    s_add_u32 s55, s53, s54
    s_add_u32 s56, s55, 4194304
    v_exp_f32 v192, v192
    v_exp_f32 v193, v193
    v_exp_f32 v194, v194
    v_smfmac_f32_32x32x32_bf16 v[176:191], v[88:91], v[240:247], v9
    v_exp_f32 v195, v195
    v_exp_f32 v196, v196
    v_exp_f32 v197, v197
    v_mfma_f32_32x32x16_bf16 v[208:223], v[100:103], v[44:47], v[208:223]
    v_exp_f32 v198, v198
    v_exp_f32 v199, v199
    v_exp_f32 v200, v200
    v_smfmac_f32_16x16x64_bf16 v[24:27], v[28:31], v[240:247], v9
    buffer_load_dwordx4 v[80:83], v1, s[4:7], s55 offen offset:0 sc1
    v_exp_f32 v201, v201
    v_smfmac_f32_32x32x32_bf16 v[176:191], v[92:95], v[248:255], v9
    v_exp_f32 v202, v202
    v_exp_f32 v203, v203
    v_exp_f32 v204, v204
    v_smfmac_f32_16x16x64_bf16 v[24:27], v[28:31], v[248:255], v9
    v_exp_f32 v205, v205
    v_exp_f32 v206, v206
    v_exp_f32 v207, v207
    v_mfma_f32_32x32x16_bf16 v[224:239], v[96:99], v[48:51], 0
    v_exp_f32 v208, v208
    v_exp_f32 v209, v209
    v_exp_f32 v210, v210
    v_smfmac_f32_32x32x32_bf16 v[128:143], v[104:107], v[192:199], v9
    v_exp_f32 v211, v211
    v_exp_f32 v212, v212
    v_exp_f32 v213, v213
    v_mfma_f32_32x32x16_bf16 v[224:239], v[100:103], v[52:55], v[224:239]
    v_exp_f32 v214, v214
    v_exp_f32 v215, v215
    v_exp_f32 v216, v216
    v_smfmac_f32_16x16x64_bf16 v[12:15], v[28:31], v[192:199], v9
    buffer_load_dwordx4 v[84:87], v1, s[4:7], s55 offen offset:1024 sc1
    v_exp_f32 v217, v217
    v_smfmac_f32_32x32x32_bf16 v[128:143], v[108:111], v[200:207], v9
    v_exp_f32 v218, v218
    v_exp_f32 v219, v219
    v_exp_f32 v220, v220
    v_smfmac_f32_16x16x64_bf16 v[12:15], v[28:31], v[200:207], v9
    v_exp_f32 v221, v221
    v_exp_f32 v222, v222
    v_exp_f32 v223, v223
    v_mfma_f32_32x32x16_bf16 v[240:255], v[96:99], v[56:59], 0
    v_exp_f32 v224, v224
    v_exp_f32 v225, v225
    v_exp_f32 v226, v226
    v_smfmac_f32_32x32x32_bf16 v[144:159], v[104:107], v[208:215], v9
    v_exp_f32 v227, v227
    v_exp_f32 v228, v228
    v_exp_f32 v229, v229
    v_mfma_f32_32x32x16_bf16 v[240:255], v[100:103], v[60:63], v[240:255]
    v_exp_f32 v230, v230
    v_exp_f32 v231, v231
    v_exp_f32 v232, v232
    v_smfmac_f32_16x16x64_bf16 v[16:19], v[28:31], v[208:215], v9
    buffer_load_dwordx4 v[88:91], v1, s[4:7], s56 offen offset:0 sc1
    v_exp_f32 v233, v233
    v_smfmac_f32_32x32x32_bf16 v[144:159], v[108:111], v[216:223], v9
    v_exp_f32 v234, v234
    v_exp_f32 v235, v235
    v_exp_f32 v236, v236
    v_smfmac_f32_16x16x64_bf16 v[16:19], v[28:31], v[216:223], v9
    v_exp_f32 v237, v237
    v_exp_f32 v238, v238
    v_exp_f32 v239, v239
    s_waitcnt vmcnt(7)
    v_mfma_f32_32x32x16_bf16 v[192:207], v[112:115], v[32:35], 0
    v_exp_f32 v240, v240
    v_exp_f32 v241, v241
    v_exp_f32 v242, v242
    v_smfmac_f32_32x32x32_bf16 v[160:175], v[104:107], v[224:231], v9
    v_exp_f32 v243, v243
    v_exp_f32 v244, v244
    v_exp_f32 v245, v245
    v_mfma_f32_32x32x16_bf16 v[192:207], v[116:119], v[36:39], v[192:207]
    v_exp_f32 v246, v246
    v_exp_f32 v247, v247
    v_exp_f32 v248, v248
    v_smfmac_f32_16x16x64_bf16 v[20:23], v[28:31], v[224:231], v9
    buffer_load_dwordx4 v[92:95], v1, s[4:7], s56 offen offset:1024 sc1
    v_exp_f32 v249, v249
    v_smfmac_f32_32x32x32_bf16 v[160:175], v[108:111], v[232:239], v9
    v_exp_f32 v250, v250
    v_exp_f32 v251, v251
    v_exp_f32 v252, v252
    v_smfmac_f32_16x16x64_bf16 v[20:23], v[28:31], v[232:239], v9
    v_exp_f32 v253, v253
    v_exp_f32 v254, v254
    v_exp_f32 v255, v255
    v_mfma_f32_32x32x16_bf16 v[208:223], v[112:115], v[40:43], 0
    s_add_u32 s54, s54, 8192
    s_and_b32 s54, s54, 0x1ffff
    s_add_u32 s55, s53, s54
    s_add_u32 s56, s55, 4194304
    v_exp_f32 v192, v192
    v_exp_f32 v193, v193
    v_exp_f32 v194, v194
    v_smfmac_f32_32x32x32_bf16 v[176:191], v[104:107], v[240:247], v9
    v_exp_f32 v195, v195
    v_exp_f32 v196, v196
    v_exp_f32 v197, v197
    v_mfma_f32_32x32x16_bf16 v[208:223], v[116:119], v[44:47], v[208:223]
    v_exp_f32 v198, v198
    v_exp_f32 v199, v199
    v_exp_f32 v200, v200
    v_smfmac_f32_16x16x64_bf16 v[24:27], v[28:31], v[240:247], v9
    buffer_load_dwordx4 v[96:99], v1, s[4:7], s55 offen offset:0 sc1
    v_exp_f32 v201, v201
    v_smfmac_f32_32x32x32_bf16 v[176:191], v[108:111], v[248:255], v9
    v_exp_f32 v202, v202
    v_exp_f32 v203, v203
    v_exp_f32 v204, v204
    v_smfmac_f32_16x16x64_bf16 v[24:27], v[28:31], v[248:255], v9
    v_exp_f32 v205, v205
    v_exp_f32 v206, v206
    v_exp_f32 v207, v207
    v_mfma_f32_32x32x16_bf16 v[224:239], v[112:115], v[48:51], 0
    v_exp_f32 v208, v208
    v_exp_f32 v209, v209
    v_exp_f32 v210, v210
    v_smfmac_f32_32x32x32_bf16 v[128:143], v[120:123], v[192:199], v9
    v_exp_f32 v211, v211
    v_exp_f32 v212, v212
    v_exp_f32 v213, v213
    v_mfma_f32_32x32x16_bf16 v[224:239], v[116:119], v[52:55], v[224:239]
    v_exp_f32 v214, v214
    v_exp_f32 v215, v215
    v_exp_f32 v216, v216
    v_smfmac_f32_16x16x64_bf16 v[12:15], v[28:31], v[192:199], v9
    buffer_load_dwordx4 v[100:103], v1, s[4:7], s55 offen offset:1024 sc1
    v_exp_f32 v217, v217
    v_smfmac_f32_32x32x32_bf16 v[128:143], v[124:127], v[200:207], v9
    v_exp_f32 v218, v218
    v_exp_f32 v219, v219
    v_exp_f32 v220, v220
    v_smfmac_f32_16x16x64_bf16 v[12:15], v[28:31], v[200:207], v9
    v_exp_f32 v221, v221
    v_exp_f32 v222, v222
    v_exp_f32 v223, v223
    v_mfma_f32_32x32x16_bf16 v[240:255], v[112:115], v[56:59], 0
    v_exp_f32 v224, v224
    v_exp_f32 v225, v225
    v_exp_f32 v226, v226
    v_smfmac_f32_32x32x32_bf16 v[144:159], v[120:123], v[208:215], v9
    v_exp_f32 v227, v227
    v_exp_f32 v228, v228
    v_exp_f32 v229, v229
    v_mfma_f32_32x32x16_bf16 v[240:255], v[116:119], v[60:63], v[240:255]
    v_exp_f32 v230, v230
    v_exp_f32 v231, v231
    v_exp_f32 v232, v232
    v_smfmac_f32_16x16x64_bf16 v[16:19], v[28:31], v[208:215], v9
    buffer_load_dwordx4 v[104:107], v1, s[4:7], s56 offen offset:0 sc1
    v_exp_f32 v233, v233
    v_smfmac_f32_32x32x32_bf16 v[144:159], v[124:127], v[216:223], v9
    v_exp_f32 v234, v234
    v_exp_f32 v235, v235
    v_exp_f32 v236, v236
    v_smfmac_f32_16x16x64_bf16 v[16:19], v[28:31], v[216:223], v9
    v_exp_f32 v237, v237
    v_exp_f32 v238, v238
    v_exp_f32 v239, v239
    s_waitcnt vmcnt(7)
    v_mfma_f32_32x32x16_bf16 v[192:207], v[64:67], v[32:35], 0
    v_exp_f32 v240, v240
    v_exp_f32 v241, v241
    v_exp_f32 v242, v242
    v_smfmac_f32_32x32x32_bf16 v[160:175], v[120:123], v[224:231], v9
    v_exp_f32 v243, v243
    v_exp_f32 v244, v244
    v_exp_f32 v245, v245
    v_mfma_f32_32x32x16_bf16 v[192:207], v[68:71], v[36:39], v[192:207]
    v_exp_f32 v246, v246
    v_exp_f32 v247, v247
    v_exp_f32 v248, v248
    v_smfmac_f32_16x16x64_bf16 v[20:23], v[28:31], v[224:231], v9
    buffer_load_dwordx4 v[108:111], v1, s[4:7], s56 offen offset:1024 sc1
    v_exp_f32 v249, v249
    v_smfmac_f32_32x32x32_bf16 v[160:175], v[124:127], v[232:239], v9
    v_exp_f32 v250, v250
    v_exp_f32 v251, v251
    v_exp_f32 v252, v252
    v_smfmac_f32_16x16x64_bf16 v[20:23], v[28:31], v[232:239], v9
    v_exp_f32 v253, v253
    v_exp_f32 v254, v254
    v_exp_f32 v255, v255
    v_mfma_f32_32x32x16_bf16 v[208:223], v[64:67], v[40:43], 0
    s_add_u32 s54, s54, 8192
    s_and_b32 s54, s54, 0x1ffff
    s_add_u32 s55, s53, s54
    s_add_u32 s56, s55, 4194304
    v_exp_f32 v192, v192
    v_exp_f32 v193, v193
    v_exp_f32 v194, v194
    v_smfmac_f32_32x32x32_bf16 v[176:191], v[120:123], v[240:247], v9
    v_exp_f32 v195, v195
    v_exp_f32 v196, v196
    v_exp_f32 v197, v197
    v_mfma_f32_32x32x16_bf16 v[208:223], v[68:71], v[44:47], v[208:223]
    v_exp_f32 v198, v198
    v_exp_f32 v199, v199
    v_exp_f32 v200, v200
    v_smfmac_f32_16x16x64_bf16 v[24:27], v[28:31], v[240:247], v9
    buffer_load_dwordx4 v[112:115], v1, s[4:7], s55 offen offset:0 sc1
    v_exp_f32 v201, v201
    v_smfmac_f32_32x32x32_bf16 v[176:191], v[124:127], v[248:255], v9
    v_exp_f32 v202, v202
    v_exp_f32 v203, v203
    v_exp_f32 v204, v204
    v_smfmac_f32_16x16x64_bf16 v[24:27], v[28:31], v[248:255], v9
    v_exp_f32 v205, v205
    v_exp_f32 v206, v206
    v_exp_f32 v207, v207
    v_mfma_f32_32x32x16_bf16 v[224:239], v[64:67], v[48:51], 0
    v_exp_f32 v208, v208
    v_exp_f32 v209, v209
    v_exp_f32 v210, v210
    v_smfmac_f32_32x32x32_bf16 v[128:143], v[72:75], v[192:199], v9
    v_exp_f32 v211, v211
    v_exp_f32 v212, v212
    v_exp_f32 v213, v213
    v_mfma_f32_32x32x16_bf16 v[224:239], v[68:71], v[52:55], v[224:239]
    v_exp_f32 v214, v214
    v_exp_f32 v215, v215
    v_exp_f32 v216, v216
    v_smfmac_f32_16x16x64_bf16 v[12:15], v[28:31], v[192:199], v9
    buffer_load_dwordx4 v[116:119], v1, s[4:7], s55 offen offset:1024 sc1
    v_exp_f32 v217, v217
    v_smfmac_f32_32x32x32_bf16 v[128:143], v[76:79], v[200:207], v9
    v_exp_f32 v218, v218
    v_exp_f32 v219, v219
    v_exp_f32 v220, v220
    v_smfmac_f32_16x16x64_bf16 v[12:15], v[28:31], v[200:207], v9
    v_exp_f32 v221, v221
    v_exp_f32 v222, v222
    v_exp_f32 v223, v223
    s_sub_u32 s58, s58, 1
    s_cmp_lg_u32 s58, 0
    s_cbranch_scc1 b_loop
    v_mfma_f32_32x32x16_bf16 v[240:255], v[64:67], v[56:59], 0
    v_exp_f32 v224, v224
    v_exp_f32 v225, v225
    v_exp_f32 v226, v226
    v_smfmac_f32_32x32x32_bf16 v[144:159], v[72:75], v[208:215], v9
    v_exp_f32 v227, v227
    v_exp_f32 v228, v228
    v_exp_f32 v229, v229
    v_mfma_f32_32x32x16_bf16 v[240:255], v[68:71], v[60:63], v[240:255]
    v_exp_f32 v230, v230
    v_exp_f32 v231, v231
    v_exp_f32 v232, v232
    v_smfmac_f32_16x16x64_bf16 v[16:19], v[28:31], v[208:215], v9
    buffer_load_dwordx4 v[120:123], v1, s[4:7], s56 offen offset:0 sc1
    v_exp_f32 v233, v233
    v_smfmac_f32_32x32x32_bf16 v[144:159], v[76:79], v[216:223], v9
    v_exp_f32 v234, v234
    v_exp_f32 v235, v235
    v_exp_f32 v236, v236
    v_smfmac_f32_16x16x64_bf16 v[16:19], v[28:31], v[216:223], v9
    v_exp_f32 v237, v237
    v_exp_f32 v238, v238
    v_exp_f32 v239, v239
    s_waitcnt vmcnt(7)
    v_mfma_f32_32x32x16_bf16 v[192:207], v[80:83], v[32:35], 0
    v_exp_f32 v240, v240
    v_exp_f32 v241, v241
    v_exp_f32 v242, v242
    v_smfmac_f32_32x32x32_bf16 v[160:175], v[72:75], v[224:231], v9
    v_exp_f32 v243, v243
    v_exp_f32 v244, v244
    v_exp_f32 v245, v245
    v_mfma_f32_32x32x16_bf16 v[192:207], v[84:87], v[36:39], v[192:207]
    v_exp_f32 v246, v246
    v_exp_f32 v247, v247
    v_exp_f32 v248, v248
    v_smfmac_f32_16x16x64_bf16 v[20:23], v[28:31], v[224:231], v9
    buffer_load_dwordx4 v[124:127], v1, s[4:7], s56 offen offset:1024 sc1
    v_exp_f32 v249, v249
    v_smfmac_f32_32x32x32_bf16 v[160:175], v[76:79], v[232:239], v9
    v_exp_f32 v250, v250
    v_exp_f32 v251, v251
    v_exp_f32 v252, v252
    v_smfmac_f32_16x16x64_bf16 v[20:23], v[28:31], v[232:239], v9
    v_exp_f32 v253, v253
    v_exp_f32 v254, v254
    v_exp_f32 v255, v255
    s_add_u32 s53, s53, 131072
    s_cmp_eq_u32 s57, 0
    s_cselect_b32 s53, s53, 2146435072
    v_mfma_f32_32x32x16_bf16 v[208:223], v[80:83], v[40:43], 0
    s_add_u32 s54, s54, 8192
    s_and_b32 s54, s54, 0x1ffff
    s_add_u32 s55, s53, s54
    s_add_u32 s56, s55, 4194304
    v_exp_f32 v192, v192
    v_exp_f32 v193, v193
    v_exp_f32 v194, v194
    v_smfmac_f32_32x32x32_bf16 v[176:191], v[72:75], v[240:247], v9
    v_exp_f32 v195, v195
    v_exp_f32 v196, v196
    v_exp_f32 v197, v197
    v_mfma_f32_32x32x16_bf16 v[208:223], v[84:87], v[44:47], v[208:223]
    v_exp_f32 v198, v198
    v_exp_f32 v199, v199
    v_exp_f32 v200, v200
    v_smfmac_f32_16x16x64_bf16 v[24:27], v[28:31], v[240:247], v9
    buffer_load_dwordx4 v[64:67], v1, s[4:7], s55 offen offset:0 sc1
    v_exp_f32 v201, v201
    v_smfmac_f32_32x32x32_bf16 v[176:191], v[76:79], v[248:255], v9
    v_exp_f32 v202, v202
    v_exp_f32 v203, v203
    v_exp_f32 v204, v204
    v_smfmac_f32_16x16x64_bf16 v[24:27], v[28:31], v[248:255], v9
    v_exp_f32 v205, v205
    v_exp_f32 v206, v206
    v_exp_f32 v207, v207
    v_mfma_f32_32x32x16_bf16 v[224:239], v[80:83], v[48:51], 0
    v_exp_f32 v208, v208
    v_exp_f32 v209, v209
    v_exp_f32 v210, v210
    v_smfmac_f32_32x32x32_bf16 v[128:143], v[88:91], v[192:199], v9
    v_exp_f32 v211, v211
    v_exp_f32 v212, v212
    v_exp_f32 v213, v213
    v_mfma_f32_32x32x16_bf16 v[224:239], v[84:87], v[52:55], v[224:239]
    v_exp_f32 v214, v214
    v_exp_f32 v215, v215
    v_exp_f32 v216, v216
    v_smfmac_f32_16x16x64_bf16 v[12:15], v[28:31], v[192:199], v9
    buffer_load_dwordx4 v[68:71], v1, s[4:7], s55 offen offset:1024 sc1
    v_exp_f32 v217, v217
    v_smfmac_f32_32x32x32_bf16 v[128:143], v[92:95], v[200:207], v9
    v_exp_f32 v218, v218
    v_exp_f32 v219, v219
    v_exp_f32 v220, v220
    v_smfmac_f32_16x16x64_bf16 v[12:15], v[28:31], v[200:207], v9
    v_exp_f32 v221, v221
    v_exp_f32 v222, v222
    v_exp_f32 v223, v223
    v_mfma_f32_32x32x16_bf16 v[240:255], v[80:83], v[56:59], 0
    v_exp_f32 v224, v224
    v_exp_f32 v225, v225
    v_exp_f32 v226, v226
    v_smfmac_f32_32x32x32_bf16 v[144:159], v[88:91], v[208:215], v9
    v_exp_f32 v227, v227
    v_exp_f32 v228, v228
    v_exp_f32 v229, v229
    v_mfma_f32_32x32x16_bf16 v[240:255], v[84:87], v[60:63], v[240:255]
    v_exp_f32 v230, v230
    v_exp_f32 v231, v231
    v_exp_f32 v232, v232
    v_smfmac_f32_16x16x64_bf16 v[16:19], v[28:31], v[208:215], v9
    buffer_load_dwordx4 v[72:75], v1, s[4:7], s56 offen offset:0 sc1
    v_exp_f32 v233, v233
    v_smfmac_f32_32x32x32_bf16 v[144:159], v[92:95], v[216:223], v9
    v_exp_f32 v234, v234
    v_exp_f32 v235, v235
    v_exp_f32 v236, v236
    v_smfmac_f32_16x16x64_bf16 v[16:19], v[28:31], v[216:223], v9
    v_exp_f32 v237, v237
    v_exp_f32 v238, v238
    v_exp_f32 v239, v239
    s_waitcnt vmcnt(7)
    v_mfma_f32_32x32x16_bf16 v[192:207], v[96:99], v[32:35], 0
    v_exp_f32 v240, v240
    v_exp_f32 v241, v241
    v_exp_f32 v242, v242
    v_smfmac_f32_32x32x32_bf16 v[160:175], v[88:91], v[224:231], v9
    v_exp_f32 v243, v243
    v_exp_f32 v244, v244
    v_exp_f32 v245, v245
    v_mfma_f32_32x32x16_bf16 v[192:207], v[100:103], v[36:39], v[192:207]
    v_exp_f32 v246, v246
    v_exp_f32 v247, v247
    v_exp_f32 v248, v248
    v_smfmac_f32_16x16x64_bf16 v[20:23], v[28:31], v[224:231], v9
    buffer_load_dwordx4 v[76:79], v1, s[4:7], s56 offen offset:1024 sc1
    v_exp_f32 v249, v249
    v_smfmac_f32_32x32x32_bf16 v[160:175], v[92:95], v[232:239], v9
    v_exp_f32 v250, v250
    v_exp_f32 v251, v251
    v_exp_f32 v252, v252
    v_smfmac_f32_16x16x64_bf16 v[20:23], v[28:31], v[232:239], v9
    v_exp_f32 v253, v253
    v_exp_f32 v254, v254
    v_exp_f32 v255, v255
    v_mfma_f32_32x32x16_bf16 v[208:223], v[96:99], v[40:43], 0
    s_add_u32 s54, s54, 8192
    s_and_b32 s54, s54, 0x1ffff
    s_add_u32 s55, s53, s54
    s_add_u32 s56, s55, 4194304
    v_exp_f32 v192, v192
    v_exp_f32 v193, v193
    v_exp_f32 v194, v194
    v_smfmac_f32_32x32x32_bf16 v[176:191], v[88:91], v[240:247], v9
    v_exp_f32 v195, v195
    v_exp_f32 v196, v196
    v_exp_f32 v197, v197
    v_mfma_f32_32x32x16_bf16 v[208:223], v[100:103], v[44:47], v[208:223]
    v_exp_f32 v198, v198
    v_exp_f32 v199, v199
    v_exp_f32 v200, v200
    v_smfmac_f32_16x16x64_bf16 v[24:27], v[28:31], v[240:247], v9
    buffer_load_dwordx4 v[80:83], v1, s[4:7], s55 offen offset:0 sc1
    v_exp_f32 v201, v201
    v_smfmac_f32_32x32x32_bf16 v[176:191], v[92:95], v[248:255], v9
    v_exp_f32 v202, v202
    v_exp_f32 v203, v203
    v_exp_f32 v204, v204
    v_smfmac_f32_16x16x64_bf16 v[24:27], v[28:31], v[248:255], v9
    v_exp_f32 v205, v205
    v_exp_f32 v206, v206
    v_exp_f32 v207, v207
    v_mfma_f32_32x32x16_bf16 v[224:239], v[96:99], v[48:51], 0
    v_exp_f32 v208, v208
    v_exp_f32 v209, v209
    v_exp_f32 v210, v210
    v_smfmac_f32_32x32x32_bf16 v[128:143], v[104:107], v[192:199], v9
    v_exp_f32 v211, v211
    v_exp_f32 v212, v212
    v_exp_f32 v213, v213
    v_mfma_f32_32x32x16_bf16 v[224:239], v[100:103], v[52:55], v[224:239]
    v_exp_f32 v214, v214
    v_exp_f32 v215, v215
    v_exp_f32 v216, v216
    v_smfmac_f32_16x16x64_bf16 v[12:15], v[28:31], v[192:199], v9
    buffer_load_dwordx4 v[84:87], v1, s[4:7], s55 offen offset:1024 sc1
    v_exp_f32 v217, v217
    v_smfmac_f32_32x32x32_bf16 v[128:143], v[108:111], v[200:207], v9
    v_exp_f32 v218, v218
    v_exp_f32 v219, v219
    v_exp_f32 v220, v220
    v_smfmac_f32_16x16x64_bf16 v[12:15], v[28:31], v[200:207], v9
    v_exp_f32 v221, v221
    v_exp_f32 v222, v222
    v_exp_f32 v223, v223
    v_mfma_f32_32x32x16_bf16 v[240:255], v[96:99], v[56:59], 0
    v_exp_f32 v224, v224
    v_exp_f32 v225, v225
    v_exp_f32 v226, v226
    v_smfmac_f32_32x32x32_bf16 v[144:159], v[104:107], v[208:215], v9
    v_exp_f32 v227, v227
    v_exp_f32 v228, v228
    v_exp_f32 v229, v229
    v_mfma_f32_32x32x16_bf16 v[240:255], v[100:103], v[60:63], v[240:255]
    v_exp_f32 v230, v230
    v_exp_f32 v231, v231
    v_exp_f32 v232, v232
    v_smfmac_f32_16x16x64_bf16 v[16:19], v[28:31], v[208:215], v9
    buffer_load_dwordx4 v[88:91], v1, s[4:7], s56 offen offset:0 sc1
    v_exp_f32 v233, v233
    v_smfmac_f32_32x32x32_bf16 v[144:159], v[108:111], v[216:223], v9
    v_exp_f32 v234, v234
    v_exp_f32 v235, v235
    v_exp_f32 v236, v236
    v_smfmac_f32_16x16x64_bf16 v[16:19], v[28:31], v[216:223], v9
    v_exp_f32 v237, v237
    v_exp_f32 v238, v238
    v_exp_f32 v239, v239
    s_waitcnt vmcnt(7)
    v_mfma_f32_32x32x16_bf16 v[192:207], v[112:115], v[32:35], 0
    v_exp_f32 v240, v240
    v_exp_f32 v241, v241
    v_exp_f32 v242, v242
    v_smfmac_f32_32x32x32_bf16 v[160:175], v[104:107], v[224:231], v9
    v_exp_f32 v243, v243
    v_exp_f32 v244, v244
    v_exp_f32 v245, v245
    v_mfma_f32_32x32x16_bf16 v[192:207], v[116:119], v[36:39], v[192:207]
    v_exp_f32 v246, v246
    v_exp_f32 v247, v247
    v_exp_f32 v248, v248
    v_smfmac_f32_16x16x64_bf16 v[20:23], v[28:31], v[224:231], v9
    buffer_load_dwordx4 v[92:95], v1, s[4:7], s56 offen offset:1024 sc1
    v_exp_f32 v249, v249
    v_smfmac_f32_32x32x32_bf16 v[160:175], v[108:111], v[232:239], v9
    v_exp_f32 v250, v250
    v_exp_f32 v251, v251
    v_exp_f32 v252, v252
    v_smfmac_f32_16x16x64_bf16 v[20:23], v[28:31], v[232:239], v9
    v_exp_f32 v253, v253
    v_exp_f32 v254, v254
    v_exp_f32 v255, v255
    s_barrier
    v_mfma_f32_32x32x16_bf16 v[208:223], v[112:115], v[40:43], 0
    s_add_u32 s54, s54, 8192
    s_and_b32 s54, s54, 0x1ffff
    s_add_u32 s55, s53, s54
    s_add_u32 s56, s55, 4194304
    ds_read_b128 v[32:35], v4 offset:8192
    ds_read_b128 v[36:39], v4 offset:9216
    v_exp_f32 v192, v192
    v_exp_f32 v193, v193
    v_exp_f32 v194, v194
    v_smfmac_f32_32x32x32_bf16 v[176:191], v[104:107], v[240:247], v9
    v_exp_f32 v195, v195
    v_exp_f32 v196, v196
    v_exp_f32 v197, v197
    v_mfma_f32_32x32x16_bf16 v[208:223], v[116:119], v[44:47], v[208:223]
    v_exp_f32 v198, v198
    v_exp_f32 v199, v199
    v_exp_f32 v200, v200
    v_smfmac_f32_16x16x64_bf16 v[24:27], v[28:31], v[240:247], v9
    buffer_load_dwordx4 v[96:99], v1, s[4:7], s55 offen offset:0 sc1
    v_exp_f32 v201, v201
    v_smfmac_f32_32x32x32_bf16 v[176:191], v[108:111], v[248:255], v9
    v_exp_f32 v202, v202
    v_exp_f32 v203, v203
    v_exp_f32 v204, v204
    v_smfmac_f32_16x16x64_bf16 v[24:27], v[28:31], v[248:255], v9
    v_exp_f32 v205, v205
    v_exp_f32 v206, v206
    v_exp_f32 v207, v207
    v_mfma_f32_32x32x16_bf16 v[224:239], v[112:115], v[48:51], 0
    ds_read_b128 v[40:43], v4 offset:10240
    ds_read_b128 v[44:47], v4 offset:11264
    v_exp_f32 v208, v208
    v_exp_f32 v209, v209
    v_exp_f32 v210, v210
    v_smfmac_f32_32x32x32_bf16 v[128:143], v[120:123], v[192:199], v9
    v_exp_f32 v211, v211
    v_exp_f32 v212, v212
    v_exp_f32 v213, v213
    v_mfma_f32_32x32x16_bf16 v[224:239], v[116:119], v[52:55], v[224:239]
    v_exp_f32 v214, v214
    v_exp_f32 v215, v215
    v_exp_f32 v216, v216
    v_smfmac_f32_16x16x64_bf16 v[12:15], v[28:31], v[192:199], v9
    buffer_load_dwordx4 v[100:103], v1, s[4:7], s55 offen offset:1024 sc1
    v_exp_f32 v217, v217
    v_smfmac_f32_32x32x32_bf16 v[128:143], v[124:127], v[200:207], v9
    v_exp_f32 v218, v218
    v_exp_f32 v219, v219
    v_exp_f32 v220, v220
    v_smfmac_f32_16x16x64_bf16 v[12:15], v[28:31], v[200:207], v9
    v_exp_f32 v221, v221
    v_exp_f32 v222, v222
    v_exp_f32 v223, v223
    v_mfma_f32_32x32x16_bf16 v[240:255], v[112:115], v[56:59], 0
    ds_read_b128 v[48:51], v4 offset:12288
    ds_read_b128 v[52:55], v4 offset:13312
    v_exp_f32 v224, v224
    v_exp_f32 v225, v225
    v_exp_f32 v226, v226
    v_smfmac_f32_32x32x32_bf16 v[144:159], v[120:123], v[208:215], v9
    ds_write_b128 v5, v[128:131] offset:0
    v_exp_f32 v227, v227
    v_exp_f32 v228, v228
    v_exp_f32 v229, v229
    v_mfma_f32_32x32x16_bf16 v[240:255], v[116:119], v[60:63], v[240:255]
    ds_write_b128 v5, v[132:135] offset:1024
    v_exp_f32 v230, v230
    v_exp_f32 v231, v231
    v_exp_f32 v232, v232
    v_smfmac_f32_16x16x64_bf16 v[16:19], v[28:31], v[208:215], v9
    buffer_load_dwordx4 v[104:107], v1, s[4:7], s56 offen offset:0 sc1
    ds_write_b32 v6, v12 offset:0
    v_exp_f32 v233, v233
    v_smfmac_f32_32x32x32_bf16 v[144:159], v[124:127], v[216:223], v9
    ds_write_b128 v5, v[136:139] offset:2048
    v_exp_f32 v234, v234
    v_exp_f32 v235, v235
    v_exp_f32 v236, v236
    v_smfmac_f32_16x16x64_bf16 v[16:19], v[28:31], v[216:223], v9
    ds_write_b128 v5, v[140:143] offset:3072
    v_exp_f32 v237, v237
    v_exp_f32 v238, v238
    v_exp_f32 v239, v239
    s_waitcnt vmcnt(7)
    s_waitcnt lgkmcnt(9)
    v_mfma_f32_32x32x16_bf16 v[192:207], v[64:67], v[32:35], 0
    ds_read_b128 v[56:59], v4 offset:14336
    ds_read_b128 v[60:63], v4 offset:15360
    v_exp_f32 v240, v240
    v_exp_f32 v241, v241
    v_exp_f32 v242, v242
    v_smfmac_f32_32x32x32_bf16 v[160:175], v[120:123], v[224:231], v9
    ds_write_b128 v5, v[144:147] offset:16384
    v_exp_f32 v243, v243
    v_exp_f32 v244, v244
    v_exp_f32 v245, v245
    v_mfma_f32_32x32x16_bf16 v[192:207], v[68:71], v[36:39], v[192:207]
    ds_write_b128 v5, v[148:151] offset:17408
    v_exp_f32 v246, v246
    v_exp_f32 v247, v247
    v_exp_f32 v248, v248
    v_smfmac_f32_16x16x64_bf16 v[20:23], v[28:31], v[224:231], v9
    buffer_load_dwordx4 v[108:111], v1, s[4:7], s56 offen offset:1024 sc1
    ds_write_b32 v6, v16 offset:1024
    v_exp_f32 v249, v249
    v_smfmac_f32_32x32x32_bf16 v[160:175], v[124:127], v[232:239], v9
    ds_write_b128 v5, v[152:155] offset:18432
    v_exp_f32 v250, v250
    v_exp_f32 v251, v251
    v_exp_f32 v252, v252
    v_smfmac_f32_16x16x64_bf16 v[20:23], v[28:31], v[232:239], v9
    ds_write_b128 v5, v[156:159] offset:19456
    v_exp_f32 v253, v253
    s_waitcnt lgkmcnt(7)
    v_mfma_f32_32x32x8_bf16 v[128:143], v[10:11], v[10:11], 0
    v_mov_b32 v12, 0
    v_exp_f32 v254, v254
    v_exp_f32 v255, v255
    s_cmp_lg_u32 s57, 0
    s_cbranch_scc1 b_tail
    v_mfma_f32_32x32x16_bf16 v[208:223], v[64:67], v[40:43], 0
    s_add_u32 s54, s54, 8192
    s_and_b32 s54, s54, 0x1ffff
    s_add_u32 s55, s53, s54
    s_add_u32 s56, s55, 4194304
    v_exp_f32 v192, v192
    v_exp_f32 v193, v193
    v_exp_f32 v194, v194
    v_smfmac_f32_32x32x32_bf16 v[176:191], v[120:123], v[240:247], v9
    ds_write_b128 v5, v[160:163] offset:32768
    v_exp_f32 v195, v195
    v_exp_f32 v196, v196
    v_exp_f32 v197, v197
    v_mfma_f32_32x32x16_bf16 v[208:223], v[68:71], v[44:47], v[208:223]
    ds_write_b128 v5, v[164:167] offset:33792
    v_exp_f32 v198, v198
    v_exp_f32 v199, v199
    v_exp_f32 v200, v200
    v_smfmac_f32_16x16x64_bf16 v[24:27], v[28:31], v[240:247], v9
    buffer_load_dwordx4 v[112:115], v1, s[4:7], s55 offen offset:0 sc1
    ds_write_b32 v6, v20 offset:2048
    v_exp_f32 v201, v201
    v_smfmac_f32_32x32x32_bf16 v[176:191], v[124:127], v[248:255], v9
    ds_write_b128 v5, v[168:171] offset:34816
    v_exp_f32 v202, v202
    v_exp_f32 v203, v203
    v_exp_f32 v204, v204
    v_smfmac_f32_16x16x64_bf16 v[24:27], v[28:31], v[248:255], v9
    ds_write_b128 v5, v[172:175] offset:35840
    v_exp_f32 v205, v205
    s_waitcnt lgkmcnt(5)
    v_mfma_f32_32x32x8_bf16 v[144:159], v[10:11], v[10:11], 0
    v_mov_b32 v16, 0
    v_exp_f32 v206, v206
    v_exp_f32 v207, v207
    v_mfma_f32_32x32x16_bf16 v[224:239], v[64:67], v[48:51], 0
    v_exp_f32 v208, v208
    v_exp_f32 v209, v209
    v_exp_f32 v210, v210
    v_smfmac_f32_32x32x32_bf16 v[128:143], v[72:75], v[192:199], v9
    ds_write_b128 v5, v[176:179] offset:49152
    v_exp_f32 v211, v211
    v_exp_f32 v212, v212
    v_exp_f32 v213, v213
    v_mfma_f32_32x32x16_bf16 v[224:239], v[68:71], v[52:55], v[224:239]
    ds_write_b128 v5, v[180:183] offset:50176
    v_exp_f32 v214, v214
    v_exp_f32 v215, v215
    v_exp_f32 v216, v216
    v_smfmac_f32_16x16x64_bf16 v[12:15], v[28:31], v[192:199], v9
    buffer_load_dwordx4 v[116:119], v1, s[4:7], s55 offen offset:1024 sc1
    ds_write_b32 v6, v24 offset:3072
    v_exp_f32 v217, v217
    v_smfmac_f32_32x32x32_bf16 v[128:143], v[76:79], v[200:207], v9
    ds_write_b128 v5, v[184:187] offset:51200
    v_exp_f32 v218, v218
    v_exp_f32 v219, v219
    v_exp_f32 v220, v220
    v_smfmac_f32_16x16x64_bf16 v[12:15], v[28:31], v[200:207], v9
    ds_write_b128 v5, v[188:191] offset:52224
    v_exp_f32 v221, v221
    s_waitcnt lgkmcnt(5)
    v_mfma_f32_32x32x8_bf16 v[160:175], v[10:11], v[10:11], 0
    v_mov_b32 v20, 0
    v_exp_f32 v222, v222
    v_exp_f32 v223, v223
    s_waitcnt lgkmcnt(0)
    v_mfma_f32_32x32x8_bf16 v[176:191], v[10:11], v[10:11], 0
    v_mov_b32 v24, 0
    s_barrier
    s_mov_b32 s57, 1
    s_branch b_head
b_tail:
    v_smfmac_f32_32x32x32_bf16 v[176:191], v[120:123], v[240:247], v9
    v_smfmac_f32_32x32x32_bf16 v[176:191], v[124:127], v[248:255], v9
    s_nop 0
    ds_write_b128 v5, v[160:163] offset:32768
    ds_write_b128 v5, v[164:167] offset:33792
    v_smfmac_f32_16x16x64_bf16 v[24:27], v[28:31], v[240:247], v9
    ds_write_b128 v5, v[168:171] offset:34816
    v_smfmac_f32_16x16x64_bf16 v[24:27], v[28:31], v[248:255], v9
    ds_write_b128 v5, v[172:175] offset:35840
    ds_write_b32 v6, v20 offset:2048
    s_nop 3
    ds_write_b128 v5, v[176:179] offset:49152
    ds_write_b128 v5, v[180:183] offset:50176
    ds_write_b128 v5, v[184:187] offset:51200
    ds_write_b128 v5, v[188:191] offset:52224
    s_nop 1
    ds_write_b32 v6, v24 offset:3072
    buffer_load_dwordx4 v[224:227], v2, s[4:7], s43 offen offset:0 sc1
    buffer_load_dwordx4 v[228:231], v2, s[4:7], s43 offen offset:256 sc1
    buffer_load_dwordx4 v[232:235], v2, s[4:7], s43 offen offset:2048 sc1
    buffer_load_dwordx4 v[236:239], v2, s[4:7], s43 offen offset:2304 sc1
    s_waitcnt lgkmcnt(0)
    s_barrier
    v_xor_b32 v4, 32, v3
    v_xor_b32 v5, 64, v3
    v_xor_b32 v6, 96, v3
c_wo:
    s_xor_b32 s42, s41, 0
    buffer_load_dwordx4 v[64:67], v2, s[4:7], s42 offen offset:0 sc1
    buffer_load_dwordx4 v[68:71], v2, s[4:7], s42 offen offset:256 sc1
    s_xor_b32 s42, s41, 4096
    buffer_load_dwordx4 v[72:75], v2, s[4:7], s42 offen offset:0 sc1
    buffer_load_dwordx4 v[76:79], v2, s[4:7], s42 offen offset:256 sc1
    s_xor_b32 s42, s41, 8192
    buffer_load_dwordx4 v[80:83], v2, s[4:7], s42 offen offset:0 sc1
    buffer_load_dwordx4 v[84:87], v2, s[4:7], s42 offen offset:256 sc1
    s_xor_b32 s42, s41, 12288
    buffer_load_dwordx4 v[88:91], v2, s[4:7], s42 offen offset:0 sc1
    buffer_load_dwordx4 v[92:95], v2, s[4:7], s42 offen offset:256 sc1
    s_xor_b32 s42, s41, 16384
    buffer_load_dwordx4 v[96:99], v2, s[4:7], s42 offen offset:0 sc1
    buffer_load_dwordx4 v[100:103], v2, s[4:7], s42 offen offset:256 sc1
    ds_read_b64_tr_b16 v[32:33], v3 offset:0
    ds_read_b64_tr_b16 v[34:35], v3 offset:1024
    ds_read_b64_tr_b16 v[36:37], v4 offset:0
    ds_read_b64_tr_b16 v[38:39], v4 offset:1024
    ds_read_b64_tr_b16 v[40:41], v5 offset:0
    ds_read_b64_tr_b16 v[42:43], v5 offset:1024
    ds_read_b64_tr_b16 v[44:45], v6 offset:0
    ds_read_b64_tr_b16 v[46:47], v6 offset:1024
    ds_read_b64_tr_b16 v[48:49], v3 offset:4096
    ds_read_b64_tr_b16 v[50:51], v3 offset:5120
    ds_read_b64_tr_b16 v[52:53], v4 offset:4096
    ds_read_b64_tr_b16 v[54:55], v4 offset:5120
    ds_read_b64_tr_b16 v[56:57], v5 offset:4096
    ds_read_b64_tr_b16 v[58:59], v5 offset:5120
    v_lshrrev_b32 v12, 4, v1
    v_and_b32 v13, 1, v12
    v_lshlrev_b32 v13, 4, v13
    v_mov_b32 v14, 0x3f80
    v_lshlrev_b32 v13, v13, v14
    v_lshrrev_b32 v14, 2, v12
    v_lshrrev_b32 v15, 4, v12
    v_xor_b32 v14, v14, v15
    v_and_b32 v14, 1, v14
    v_bfe_u32 v15, v12, 3, 1
    v_bfe_u32 v16, v12, 1, 1
    v_lshl_add_u32 v15, v15, 1, v16
    v_lshrrev_b32 v16, 5, v12
    v_lshl_add_u32 v15, v16, 2, v15
    v_lshl_add_u32 v15, v14, 3, v15
    v_cmp_eq_u32 vcc, 0, v15
    s_nop 1
    v_cndmask_b32 v240, 0, v13, vcc
    v_cmp_eq_u32 vcc, 1, v15
    s_nop 1
    v_cndmask_b32 v241, 0, v13, vcc
    v_cmp_eq_u32 vcc, 2, v15
    s_nop 1
    v_cndmask_b32 v242, 0, v13, vcc
    v_cmp_eq_u32 vcc, 3, v15
    s_nop 1
    v_cndmask_b32 v243, 0, v13, vcc
    v_cmp_eq_u32 vcc, 4, v15
    s_nop 1
    v_cndmask_b32 v244, 0, v13, vcc
    v_cmp_eq_u32 vcc, 5, v15
    s_nop 1
    v_cndmask_b32 v245, 0, v13, vcc
    v_cmp_eq_u32 vcc, 6, v15
    s_nop 1
    v_cndmask_b32 v246, 0, v13, vcc
    v_cmp_eq_u32 vcc, 7, v15
    s_nop 1
    v_cndmask_b32 v247, 0, v13, vcc
    s_waitcnt vmcnt(10)
    v_mfma_f32_16x16x32_bf16 v[128:131], v[240:243], v[224:227], 0
    v_mfma_f32_16x16x32_bf16 v[132:135], v[240:243], v[228:231], 0
    v_mfma_f32_16x16x32_bf16 v[136:139], v[244:247], v[224:227], 0
    v_mfma_f32_16x16x32_bf16 v[140:143], v[244:247], v[228:231], 0
    v_mfma_f32_16x16x32_bf16 v[144:147], v[240:243], v[232:235], 0
    v_mfma_f32_16x16x32_bf16 v[148:151], v[240:243], v[236:239], 0
    v_mfma_f32_16x16x32_bf16 v[152:155], v[244:247], v[232:235], 0
    v_mfma_f32_16x16x32_bf16 v[156:159], v[244:247], v[236:239], 0
    s_waitcnt vmcnt(8) lgkmcnt(10)
    v_mfma_f32_16x16x32_bf16 v[128:131], v[32:35], v[64:67], v[128:131]
    ds_read_b64_tr_b16 v[60:61], v6 offset:4096
    s_xor_b32 s42, s41, 20480
    buffer_load_dwordx4 v[104:107], v2, s[4:7], s42 offen offset:0 sc1
    v_mfma_f32_16x16x32_bf16 v[132:135], v[32:35], v[68:71], v[132:135]
    ds_read_b64_tr_b16 v[62:63], v6 offset:5120
    v_mfma_f32_16x16x32_bf16 v[136:139], v[36:39], v[64:67], v[136:139]
    ds_read_b64_tr_b16 v[32:33], v3 offset:8192
    v_mfma_f32_16x16x32_bf16 v[140:143], v[36:39], v[68:71], v[140:143]
    ds_read_b64_tr_b16 v[34:35], v3 offset:9216
    s_waitcnt lgkmcnt(10)
    v_mfma_f32_16x16x32_bf16 v[144:147], v[40:43], v[64:67], v[144:147]
    buffer_load_dwordx4 v[108:111], v2, s[4:7], s42 offen offset:256 sc1
    ds_read_b64_tr_b16 v[36:37], v4 offset:8192
    s_xor_b32 s42, s41, 24576
    v_mfma_f32_16x16x32_bf16 v[148:151], v[40:43], v[68:71], v[148:151]
    ds_read_b64_tr_b16 v[38:39], v4 offset:9216
    v_mfma_f32_16x16x32_bf16 v[152:155], v[44:47], v[64:67], v[152:155]
    ds_read_b64_tr_b16 v[40:41], v5 offset:8192
    v_mfma_f32_16x16x32_bf16 v[156:159], v[44:47], v[68:71], v[156:159]
    ds_read_b64_tr_b16 v[42:43], v5 offset:9216
    s_waitcnt vmcnt(8) lgkmcnt(10)
    v_mfma_f32_16x16x32_bf16 v[128:131], v[48:51], v[72:75], v[128:131]
    buffer_load_dwordx4 v[112:115], v2, s[4:7], s42 offen offset:0 sc1
    ds_read_b64_tr_b16 v[44:45], v6 offset:8192
    v_mfma_f32_16x16x32_bf16 v[132:135], v[48:51], v[76:79], v[132:135]
    ds_read_b64_tr_b16 v[46:47], v6 offset:9216
    v_mfma_f32_16x16x32_bf16 v[136:139], v[52:55], v[72:75], v[136:139]
    ds_read_b64_tr_b16 v[48:49], v3 offset:12288
    v_mfma_f32_16x16x32_bf16 v[140:143], v[52:55], v[76:79], v[140:143]
    ds_read_b64_tr_b16 v[50:51], v3 offset:13312
    s_waitcnt lgkmcnt(10)
    v_mfma_f32_16x16x32_bf16 v[144:147], v[56:59], v[72:75], v[144:147]
    buffer_load_dwordx4 v[116:119], v2, s[4:7], s42 offen offset:256 sc1
    ds_read_b64_tr_b16 v[52:53], v4 offset:12288
    s_xor_b32 s42, s41, 28672
    v_mfma_f32_16x16x32_bf16 v[148:151], v[56:59], v[76:79], v[148:151]
    ds_read_b64_tr_b16 v[54:55], v4 offset:13312
    v_mfma_f32_16x16x32_bf16 v[152:155], v[60:63], v[72:75], v[152:155]
    ds_read_b64_tr_b16 v[56:57], v5 offset:12288
    v_mfma_f32_16x16x32_bf16 v[156:159], v[60:63], v[76:79], v[156:159]
    ds_read_b64_tr_b16 v[58:59], v5 offset:13312
    s_waitcnt vmcnt(8) lgkmcnt(10)
    v_mfma_f32_16x16x32_bf16 v[128:131], v[32:35], v[80:83], v[128:131]
    ds_read_b64_tr_b16 v[60:61], v6 offset:12288
    buffer_load_dwordx4 v[120:123], v2, s[4:7], s42 offen offset:0 sc1
    v_mfma_f32_16x16x32_bf16 v[132:135], v[32:35], v[84:87], v[132:135]
    ds_read_b64_tr_b16 v[62:63], v6 offset:13312
    v_mfma_f32_16x16x32_bf16 v[136:139], v[36:39], v[80:83], v[136:139]
    ds_read_b64_tr_b16 v[32:33], v3 offset:16384
    v_mfma_f32_16x16x32_bf16 v[140:143], v[36:39], v[84:87], v[140:143]
    ds_read_b64_tr_b16 v[34:35], v3 offset:17408
    s_waitcnt lgkmcnt(10)
    v_mfma_f32_16x16x32_bf16 v[144:147], v[40:43], v[80:83], v[144:147]
    buffer_load_dwordx4 v[124:127], v2, s[4:7], s42 offen offset:256 sc1
    ds_read_b64_tr_b16 v[36:37], v4 offset:16384
    s_xor_b32 s42, s41, 32768
    v_mfma_f32_16x16x32_bf16 v[148:151], v[40:43], v[84:87], v[148:151]
    ds_read_b64_tr_b16 v[38:39], v4 offset:17408
    v_mfma_f32_16x16x32_bf16 v[152:155], v[44:47], v[80:83], v[152:155]
    ds_read_b64_tr_b16 v[40:41], v5 offset:16384
    v_mfma_f32_16x16x32_bf16 v[156:159], v[44:47], v[84:87], v[156:159]
    ds_read_b64_tr_b16 v[42:43], v5 offset:17408
    s_waitcnt vmcnt(8) lgkmcnt(10)
    v_mfma_f32_16x16x32_bf16 v[128:131], v[48:51], v[88:91], v[128:131]
    buffer_load_dwordx4 v[160:163], v2, s[4:7], s42 offen offset:0 sc1
    ds_read_b64_tr_b16 v[44:45], v6 offset:16384
    v_mfma_f32_16x16x32_bf16 v[132:135], v[48:51], v[92:95], v[132:135]
    ds_read_b64_tr_b16 v[46:47], v6 offset:17408
    v_mfma_f32_16x16x32_bf16 v[136:139], v[52:55], v[88:91], v[136:139]
    ds_read_b64_tr_b16 v[48:49], v3 offset:20480
    v_mfma_f32_16x16x32_bf16 v[140:143], v[52:55], v[92:95], v[140:143]
    ds_read_b64_tr_b16 v[50:51], v3 offset:21504
    s_waitcnt lgkmcnt(10)
    v_mfma_f32_16x16x32_bf16 v[144:147], v[56:59], v[88:91], v[144:147]
    buffer_load_dwordx4 v[164:167], v2, s[4:7], s42 offen offset:256 sc1
    ds_read_b64_tr_b16 v[52:53], v4 offset:20480
    s_xor_b32 s42, s41, 36864
    v_mfma_f32_16x16x32_bf16 v[148:151], v[56:59], v[92:95], v[148:151]
    ds_read_b64_tr_b16 v[54:55], v4 offset:21504
    v_mfma_f32_16x16x32_bf16 v[152:155], v[60:63], v[88:91], v[152:155]
    ds_read_b64_tr_b16 v[56:57], v5 offset:20480
    v_mfma_f32_16x16x32_bf16 v[156:159], v[60:63], v[92:95], v[156:159]
    ds_read_b64_tr_b16 v[58:59], v5 offset:21504
    s_waitcnt vmcnt(8) lgkmcnt(10)
    v_mfma_f32_16x16x32_bf16 v[128:131], v[32:35], v[96:99], v[128:131]
    ds_read_b64_tr_b16 v[60:61], v6 offset:20480
    buffer_load_dwordx4 v[168:171], v2, s[4:7], s42 offen offset:0 sc1
    v_mfma_f32_16x16x32_bf16 v[132:135], v[32:35], v[100:103], v[132:135]
    ds_read_b64_tr_b16 v[62:63], v6 offset:21504
    v_mfma_f32_16x16x32_bf16 v[136:139], v[36:39], v[96:99], v[136:139]
    ds_read_b64_tr_b16 v[32:33], v3 offset:24576
    v_mfma_f32_16x16x32_bf16 v[140:143], v[36:39], v[100:103], v[140:143]
    ds_read_b64_tr_b16 v[34:35], v3 offset:25600
    s_waitcnt lgkmcnt(10)
    v_mfma_f32_16x16x32_bf16 v[144:147], v[40:43], v[96:99], v[144:147]
    buffer_load_dwordx4 v[172:175], v2, s[4:7], s42 offen offset:256 sc1
    ds_read_b64_tr_b16 v[36:37], v4 offset:24576
    s_xor_b32 s42, s41, 40960
    v_mfma_f32_16x16x32_bf16 v[148:151], v[40:43], v[100:103], v[148:151]
    ds_read_b64_tr_b16 v[38:39], v4 offset:25600
    v_mfma_f32_16x16x32_bf16 v[152:155], v[44:47], v[96:99], v[152:155]
    ds_read_b64_tr_b16 v[40:41], v5 offset:24576
    v_mfma_f32_16x16x32_bf16 v[156:159], v[44:47], v[100:103], v[156:159]
    ds_read_b64_tr_b16 v[42:43], v5 offset:25600
    s_waitcnt vmcnt(8) lgkmcnt(10)
    v_mfma_f32_16x16x32_bf16 v[128:131], v[48:51], v[104:107], v[128:131]
    buffer_load_dwordx4 v[176:179], v2, s[4:7], s42 offen offset:0 sc1
    ds_read_b64_tr_b16 v[44:45], v6 offset:24576
    v_mfma_f32_16x16x32_bf16 v[132:135], v[48:51], v[108:111], v[132:135]
    ds_read_b64_tr_b16 v[46:47], v6 offset:25600
    v_mfma_f32_16x16x32_bf16 v[136:139], v[52:55], v[104:107], v[136:139]
    ds_read_b64_tr_b16 v[48:49], v3 offset:28672
    v_mfma_f32_16x16x32_bf16 v[140:143], v[52:55], v[108:111], v[140:143]
    ds_read_b64_tr_b16 v[50:51], v3 offset:29696
    s_waitcnt lgkmcnt(10)
    v_mfma_f32_16x16x32_bf16 v[144:147], v[56:59], v[104:107], v[144:147]
    buffer_load_dwordx4 v[180:183], v2, s[4:7], s42 offen offset:256 sc1
    ds_read_b64_tr_b16 v[52:53], v4 offset:28672
    s_xor_b32 s42, s41, 45056
    v_mfma_f32_16x16x32_bf16 v[148:151], v[56:59], v[108:111], v[148:151]
    ds_read_b64_tr_b16 v[54:55], v4 offset:29696
    v_mfma_f32_16x16x32_bf16 v[152:155], v[60:63], v[104:107], v[152:155]
    ds_read_b64_tr_b16 v[56:57], v5 offset:28672
    v_mfma_f32_16x16x32_bf16 v[156:159], v[60:63], v[108:111], v[156:159]
    ds_read_b64_tr_b16 v[58:59], v5 offset:29696
    s_waitcnt vmcnt(8) lgkmcnt(10)
    v_mfma_f32_16x16x32_bf16 v[128:131], v[32:35], v[112:115], v[128:131]
    ds_read_b64_tr_b16 v[60:61], v6 offset:28672
    buffer_load_dwordx4 v[184:187], v2, s[4:7], s42 offen offset:0 sc1
    v_mfma_f32_16x16x32_bf16 v[132:135], v[32:35], v[116:119], v[132:135]
    ds_read_b64_tr_b16 v[62:63], v6 offset:29696
    v_mfma_f32_16x16x32_bf16 v[136:139], v[36:39], v[112:115], v[136:139]
    ds_read_b64_tr_b16 v[32:33], v3 offset:32768
    v_mfma_f32_16x16x32_bf16 v[140:143], v[36:39], v[116:119], v[140:143]
    ds_read_b64_tr_b16 v[34:35], v3 offset:33792
    s_waitcnt lgkmcnt(10)
    v_mfma_f32_16x16x32_bf16 v[144:147], v[40:43], v[112:115], v[144:147]
    buffer_load_dwordx4 v[188:191], v2, s[4:7], s42 offen offset:256 sc1
    ds_read_b64_tr_b16 v[36:37], v4 offset:32768
    s_xor_b32 s42, s41, 49152
    v_mfma_f32_16x16x32_bf16 v[148:151], v[40:43], v[116:119], v[148:151]
    ds_read_b64_tr_b16 v[38:39], v4 offset:33792
    v_mfma_f32_16x16x32_bf16 v[152:155], v[44:47], v[112:115], v[152:155]
    ds_read_b64_tr_b16 v[40:41], v5 offset:32768
    v_mfma_f32_16x16x32_bf16 v[156:159], v[44:47], v[116:119], v[156:159]
    ds_read_b64_tr_b16 v[42:43], v5 offset:33792
    s_waitcnt vmcnt(8) lgkmcnt(10)
    v_mfma_f32_16x16x32_bf16 v[128:131], v[48:51], v[120:123], v[128:131]
    buffer_load_dwordx4 v[64:67], v2, s[4:7], s42 offen offset:0 sc1
    ds_read_b64_tr_b16 v[44:45], v6 offset:32768
    v_mfma_f32_16x16x32_bf16 v[132:135], v[48:51], v[124:127], v[132:135]
    ds_read_b64_tr_b16 v[46:47], v6 offset:33792
    v_mfma_f32_16x16x32_bf16 v[136:139], v[52:55], v[120:123], v[136:139]
    ds_read_b64_tr_b16 v[48:49], v3 offset:36864
    v_mfma_f32_16x16x32_bf16 v[140:143], v[52:55], v[124:127], v[140:143]
    ds_read_b64_tr_b16 v[50:51], v3 offset:37888
    s_waitcnt lgkmcnt(10)
    v_mfma_f32_16x16x32_bf16 v[144:147], v[56:59], v[120:123], v[144:147]
    buffer_load_dwordx4 v[68:71], v2, s[4:7], s42 offen offset:256 sc1
    ds_read_b64_tr_b16 v[52:53], v4 offset:36864
    s_xor_b32 s42, s41, 53248
    v_mfma_f32_16x16x32_bf16 v[148:151], v[56:59], v[124:127], v[148:151]
    ds_read_b64_tr_b16 v[54:55], v4 offset:37888
    v_mfma_f32_16x16x32_bf16 v[152:155], v[60:63], v[120:123], v[152:155]
    ds_read_b64_tr_b16 v[56:57], v5 offset:36864
    v_mfma_f32_16x16x32_bf16 v[156:159], v[60:63], v[124:127], v[156:159]
    ds_read_b64_tr_b16 v[58:59], v5 offset:37888
    s_waitcnt vmcnt(8) lgkmcnt(10)
    v_mfma_f32_16x16x32_bf16 v[128:131], v[32:35], v[160:163], v[128:131]
    ds_read_b64_tr_b16 v[60:61], v6 offset:36864
    buffer_load_dwordx4 v[72:75], v2, s[4:7], s42 offen offset:0 sc1
    v_mfma_f32_16x16x32_bf16 v[132:135], v[32:35], v[164:167], v[132:135]
    ds_read_b64_tr_b16 v[62:63], v6 offset:37888
    v_mfma_f32_16x16x32_bf16 v[136:139], v[36:39], v[160:163], v[136:139]
    ds_read_b64_tr_b16 v[32:33], v3 offset:40960
    v_mfma_f32_16x16x32_bf16 v[140:143], v[36:39], v[164:167], v[140:143]
    ds_read_b64_tr_b16 v[34:35], v3 offset:41984
    s_waitcnt lgkmcnt(10)
    v_mfma_f32_16x16x32_bf16 v[144:147], v[40:43], v[160:163], v[144:147]
    buffer_load_dwordx4 v[76:79], v2, s[4:7], s42 offen offset:256 sc1
    ds_read_b64_tr_b16 v[36:37], v4 offset:40960
    s_xor_b32 s42, s41, 57344
    v_mfma_f32_16x16x32_bf16 v[148:151], v[40:43], v[164:167], v[148:151]
    ds_read_b64_tr_b16 v[38:39], v4 offset:41984
    v_mfma_f32_16x16x32_bf16 v[152:155], v[44:47], v[160:163], v[152:155]
    ds_read_b64_tr_b16 v[40:41], v5 offset:40960
    v_mfma_f32_16x16x32_bf16 v[156:159], v[44:47], v[164:167], v[156:159]
    ds_read_b64_tr_b16 v[42:43], v5 offset:41984
    s_waitcnt vmcnt(8) lgkmcnt(10)
    v_mfma_f32_16x16x32_bf16 v[128:131], v[48:51], v[168:171], v[128:131]
    buffer_load_dwordx4 v[80:83], v2, s[4:7], s42 offen offset:0 sc1
    ds_read_b64_tr_b16 v[44:45], v6 offset:40960
    v_mfma_f32_16x16x32_bf16 v[132:135], v[48:51], v[172:175], v[132:135]
    ds_read_b64_tr_b16 v[46:47], v6 offset:41984
    v_mfma_f32_16x16x32_bf16 v[136:139], v[52:55], v[168:171], v[136:139]
    ds_read_b64_tr_b16 v[48:49], v3 offset:45056
    v_mfma_f32_16x16x32_bf16 v[140:143], v[52:55], v[172:175], v[140:143]
    ds_read_b64_tr_b16 v[50:51], v3 offset:46080
    s_waitcnt lgkmcnt(10)
    v_mfma_f32_16x16x32_bf16 v[144:147], v[56:59], v[168:171], v[144:147]
    buffer_load_dwordx4 v[84:87], v2, s[4:7], s42 offen offset:256 sc1
    ds_read_b64_tr_b16 v[52:53], v4 offset:45056
    s_xor_b32 s42, s41, 61440
    v_mfma_f32_16x16x32_bf16 v[148:151], v[56:59], v[172:175], v[148:151]
    ds_read_b64_tr_b16 v[54:55], v4 offset:46080
    v_mfma_f32_16x16x32_bf16 v[152:155], v[60:63], v[168:171], v[152:155]
    ds_read_b64_tr_b16 v[56:57], v5 offset:45056
    v_mfma_f32_16x16x32_bf16 v[156:159], v[60:63], v[172:175], v[156:159]
    ds_read_b64_tr_b16 v[58:59], v5 offset:46080
    s_waitcnt vmcnt(8) lgkmcnt(10)
    v_mfma_f32_16x16x32_bf16 v[128:131], v[32:35], v[176:179], v[128:131]
    ds_read_b64_tr_b16 v[60:61], v6 offset:45056
    buffer_load_dwordx4 v[88:91], v2, s[4:7], s42 offen offset:0 sc1
    v_mfma_f32_16x16x32_bf16 v[132:135], v[32:35], v[180:183], v[132:135]
    ds_read_b64_tr_b16 v[62:63], v6 offset:46080
    s_barrier
    v_mfma_f32_16x16x32_bf16 v[136:139], v[36:39], v[176:179], v[136:139]
    ds_read_b64_tr_b16 v[32:33], v3 offset:49152
    v_mfma_f32_16x16x32_bf16 v[140:143], v[36:39], v[180:183], v[140:143]
    ds_read_b64_tr_b16 v[34:35], v3 offset:50176
    s_waitcnt lgkmcnt(10)
    v_mfma_f32_16x16x32_bf16 v[144:147], v[40:43], v[176:179], v[144:147]
    buffer_load_dwordx4 v[92:95], v2, s[4:7], s42 offen offset:256 sc1
    ds_read_b64_tr_b16 v[36:37], v4 offset:49152
    s_xor_b32 s42, s41, 0
    v_mfma_f32_16x16x32_bf16 v[148:151], v[40:43], v[180:183], v[148:151]
    ds_read_b64_tr_b16 v[38:39], v4 offset:50176
    v_mfma_f32_16x16x32_bf16 v[152:155], v[44:47], v[176:179], v[152:155]
    ds_read_b64_tr_b16 v[40:41], v5 offset:49152
    v_mfma_f32_16x16x32_bf16 v[156:159], v[44:47], v[180:183], v[156:159]
    ds_read_b64_tr_b16 v[42:43], v5 offset:50176
    s_waitcnt vmcnt(8) lgkmcnt(10)
    v_mfma_f32_16x16x32_bf16 v[128:131], v[48:51], v[184:187], v[128:131]
    buffer_load_dwordx4 v[96:99], v2, s[4:7], s42 offen offset:2048 sc1
    ds_read_b64_tr_b16 v[44:45], v6 offset:49152
    v_mfma_f32_16x16x32_bf16 v[132:135], v[48:51], v[188:191], v[132:135]
    ds_read_b64_tr_b16 v[46:47], v6 offset:50176
    v_mfma_f32_16x16x32_bf16 v[136:139], v[52:55], v[184:187], v[136:139]
    ds_read_b64_tr_b16 v[48:49], v3 offset:53248
    v_mfma_f32_16x16x32_bf16 v[140:143], v[52:55], v[188:191], v[140:143]
    ds_read_b64_tr_b16 v[50:51], v3 offset:54272
    s_waitcnt lgkmcnt(10)
    v_mfma_f32_16x16x32_bf16 v[144:147], v[56:59], v[184:187], v[144:147]
    buffer_load_dwordx4 v[100:103], v2, s[4:7], s42 offen offset:2304 sc1
    ds_read_b64_tr_b16 v[52:53], v4 offset:53248
    s_xor_b32 s42, s41, 4096
    v_mfma_f32_16x16x32_bf16 v[148:151], v[56:59], v[188:191], v[148:151]
    ds_read_b64_tr_b16 v[54:55], v4 offset:54272
    v_mfma_f32_16x16x32_bf16 v[152:155], v[60:63], v[184:187], v[152:155]
    ds_read_b64_tr_b16 v[56:57], v5 offset:53248
    v_mfma_f32_16x16x32_bf16 v[156:159], v[60:63], v[188:191], v[156:159]
    ds_read_b64_tr_b16 v[58:59], v5 offset:54272
    s_waitcnt vmcnt(8) lgkmcnt(10)
    v_mfma_f32_16x16x32_bf16 v[128:131], v[32:35], v[64:67], v[128:131]
    ds_read_b64_tr_b16 v[60:61], v6 offset:53248
    buffer_load_dwordx4 v[104:107], v2, s[4:7], s42 offen offset:2048 sc1
    v_mfma_f32_16x16x32_bf16 v[132:135], v[32:35], v[68:71], v[132:135]
    ds_read_b64_tr_b16 v[62:63], v6 offset:54272
    v_mfma_f32_16x16x32_bf16 v[136:139], v[36:39], v[64:67], v[136:139]
    ds_read_b64_tr_b16 v[32:33], v3 offset:57344
    v_mfma_f32_16x16x32_bf16 v[140:143], v[36:39], v[68:71], v[140:143]
    ds_read_b64_tr_b16 v[34:35], v3 offset:58368
    s_waitcnt lgkmcnt(10)
    v_mfma_f32_16x16x32_bf16 v[144:147], v[40:43], v[64:67], v[144:147]
    buffer_load_dwordx4 v[108:111], v2, s[4:7], s42 offen offset:2304 sc1
    ds_read_b64_tr_b16 v[36:37], v4 offset:57344
    s_xor_b32 s42, s41, 8192
    v_mfma_f32_16x16x32_bf16 v[148:151], v[40:43], v[68:71], v[148:151]
    ds_read_b64_tr_b16 v[38:39], v4 offset:58368
    v_mfma_f32_16x16x32_bf16 v[152:155], v[44:47], v[64:67], v[152:155]
    ds_read_b64_tr_b16 v[40:41], v5 offset:57344
    v_mfma_f32_16x16x32_bf16 v[156:159], v[44:47], v[68:71], v[156:159]
    ds_read_b64_tr_b16 v[42:43], v5 offset:58368
    s_waitcnt vmcnt(8) lgkmcnt(10)
    v_mfma_f32_16x16x32_bf16 v[128:131], v[48:51], v[72:75], v[128:131]
    buffer_load_dwordx4 v[112:115], v2, s[4:7], s42 offen offset:2048 sc1
    ds_read_b64_tr_b16 v[44:45], v6 offset:57344
    v_mfma_f32_16x16x32_bf16 v[132:135], v[48:51], v[76:79], v[132:135]
    ds_read_b64_tr_b16 v[46:47], v6 offset:58368
    v_mfma_f32_16x16x32_bf16 v[136:139], v[52:55], v[72:75], v[136:139]
    ds_read_b64_tr_b16 v[48:49], v3 offset:61440
    v_mfma_f32_16x16x32_bf16 v[140:143], v[52:55], v[76:79], v[140:143]
    ds_read_b64_tr_b16 v[50:51], v3 offset:62464
    s_waitcnt lgkmcnt(10)
    v_mfma_f32_16x16x32_bf16 v[144:147], v[56:59], v[72:75], v[144:147]
    buffer_load_dwordx4 v[116:119], v2, s[4:7], s42 offen offset:2304 sc1
    ds_read_b64_tr_b16 v[52:53], v4 offset:61440
    s_xor_b32 s42, s41, 12288
    v_mfma_f32_16x16x32_bf16 v[148:151], v[56:59], v[76:79], v[148:151]
    ds_read_b64_tr_b16 v[54:55], v4 offset:62464
    v_mfma_f32_16x16x32_bf16 v[152:155], v[60:63], v[72:75], v[152:155]
    ds_read_b64_tr_b16 v[56:57], v5 offset:61440
    v_mfma_f32_16x16x32_bf16 v[156:159], v[60:63], v[76:79], v[156:159]
    ds_read_b64_tr_b16 v[58:59], v5 offset:62464
    s_waitcnt vmcnt(8) lgkmcnt(10)
    v_mfma_f32_16x16x32_bf16 v[128:131], v[32:35], v[80:83], v[128:131]
    ds_read_b64_tr_b16 v[60:61], v6 offset:61440
    buffer_load_dwordx4 v[120:123], v2, s[4:7], s42 offen offset:2048 sc1
    v_mfma_f32_16x16x32_bf16 v[132:135], v[32:35], v[84:87], v[132:135]
    ds_read_b64_tr_b16 v[62:63], v6 offset:62464
    v_xor_b32 v3, 0x10000, v3
    v_xor_b32 v4, 0x10000, v4
    v_xor_b32 v5, 0x10000, v5
    v_xor_b32 v6, 0x10000, v6
    v_mfma_f32_16x16x32_bf16 v[136:139], v[36:39], v[80:83], v[136:139]
    ds_read_b64_tr_b16 v[32:33], v3 offset:0
    v_mfma_f32_16x16x32_bf16 v[140:143], v[36:39], v[84:87], v[140:143]
    ds_read_b64_tr_b16 v[34:35], v3 offset:1024
    s_waitcnt lgkmcnt(10)
    v_mfma_f32_16x16x32_bf16 v[144:147], v[40:43], v[80:83], v[144:147]
    buffer_load_dwordx4 v[124:127], v2, s[4:7], s42 offen offset:2304 sc1
    ds_read_b64_tr_b16 v[36:37], v4 offset:0
    s_xor_b32 s42, s41, 16384
    v_mfma_f32_16x16x32_bf16 v[148:151], v[40:43], v[84:87], v[148:151]
    ds_read_b64_tr_b16 v[38:39], v4 offset:1024
    v_mfma_f32_16x16x32_bf16 v[152:155], v[44:47], v[80:83], v[152:155]
    ds_read_b64_tr_b16 v[40:41], v5 offset:0
    v_mfma_f32_16x16x32_bf16 v[156:159], v[44:47], v[84:87], v[156:159]
    ds_read_b64_tr_b16 v[42:43], v5 offset:1024
    s_waitcnt vmcnt(8) lgkmcnt(10)
    v_mfma_f32_16x16x32_bf16 v[128:131], v[48:51], v[88:91], v[128:131]
    buffer_load_dwordx4 v[160:163], v2, s[4:7], s42 offen offset:2048 sc1
    ds_read_b64_tr_b16 v[44:45], v6 offset:0
    v_mfma_f32_16x16x32_bf16 v[132:135], v[48:51], v[92:95], v[132:135]
    ds_read_b64_tr_b16 v[46:47], v6 offset:1024
    v_mfma_f32_16x16x32_bf16 v[136:139], v[52:55], v[88:91], v[136:139]
    ds_read_b64_tr_b16 v[48:49], v3 offset:4096
    v_mfma_f32_16x16x32_bf16 v[140:143], v[52:55], v[92:95], v[140:143]
    ds_read_b64_tr_b16 v[50:51], v3 offset:5120
    s_waitcnt lgkmcnt(10)
    v_mfma_f32_16x16x32_bf16 v[144:147], v[56:59], v[88:91], v[144:147]
    buffer_load_dwordx4 v[164:167], v2, s[4:7], s42 offen offset:2304 sc1
    ds_read_b64_tr_b16 v[52:53], v4 offset:4096
    s_xor_b32 s42, s41, 20480
    v_mfma_f32_16x16x32_bf16 v[148:151], v[56:59], v[92:95], v[148:151]
    ds_read_b64_tr_b16 v[54:55], v4 offset:5120
    v_mfma_f32_16x16x32_bf16 v[152:155], v[60:63], v[88:91], v[152:155]
    ds_read_b64_tr_b16 v[56:57], v5 offset:4096
    v_mfma_f32_16x16x32_bf16 v[156:159], v[60:63], v[92:95], v[156:159]
    ds_read_b64_tr_b16 v[58:59], v5 offset:5120
    s_waitcnt vmcnt(8) lgkmcnt(10)
    v_mfma_f32_16x16x32_bf16 v[128:131], v[32:35], v[96:99], v[128:131]
    ds_read_b64_tr_b16 v[60:61], v6 offset:4096
    buffer_load_dwordx4 v[168:171], v2, s[4:7], s42 offen offset:2048 sc1
    v_mfma_f32_16x16x32_bf16 v[132:135], v[32:35], v[100:103], v[132:135]
    ds_read_b64_tr_b16 v[62:63], v6 offset:5120
    v_mfma_f32_16x16x32_bf16 v[136:139], v[36:39], v[96:99], v[136:139]
    ds_read_b64_tr_b16 v[32:33], v3 offset:8192
    v_mfma_f32_16x16x32_bf16 v[140:143], v[36:39], v[100:103], v[140:143]
    ds_read_b64_tr_b16 v[34:35], v3 offset:9216
    s_waitcnt lgkmcnt(10)
    v_mfma_f32_16x16x32_bf16 v[144:147], v[40:43], v[96:99], v[144:147]
    buffer_load_dwordx4 v[172:175], v2, s[4:7], s42 offen offset:2304 sc1
    ds_read_b64_tr_b16 v[36:37], v4 offset:8192
    s_xor_b32 s42, s41, 24576
    v_mfma_f32_16x16x32_bf16 v[148:151], v[40:43], v[100:103], v[148:151]
    ds_read_b64_tr_b16 v[38:39], v4 offset:9216
    v_mfma_f32_16x16x32_bf16 v[152:155], v[44:47], v[96:99], v[152:155]
    ds_read_b64_tr_b16 v[40:41], v5 offset:8192
    v_mfma_f32_16x16x32_bf16 v[156:159], v[44:47], v[100:103], v[156:159]
    ds_read_b64_tr_b16 v[42:43], v5 offset:9216
    s_waitcnt vmcnt(8) lgkmcnt(10)
    v_mfma_f32_16x16x32_bf16 v[128:131], v[48:51], v[104:107], v[128:131]
    buffer_load_dwordx4 v[176:179], v2, s[4:7], s42 offen offset:2048 sc1
    ds_read_b64_tr_b16 v[44:45], v6 offset:8192
    v_mfma_f32_16x16x32_bf16 v[132:135], v[48:51], v[108:111], v[132:135]
    ds_read_b64_tr_b16 v[46:47], v6 offset:9216
    v_mfma_f32_16x16x32_bf16 v[136:139], v[52:55], v[104:107], v[136:139]
    ds_read_b64_tr_b16 v[48:49], v3 offset:12288
    v_mfma_f32_16x16x32_bf16 v[140:143], v[52:55], v[108:111], v[140:143]
    ds_read_b64_tr_b16 v[50:51], v3 offset:13312
    s_waitcnt lgkmcnt(10)
    v_mfma_f32_16x16x32_bf16 v[144:147], v[56:59], v[104:107], v[144:147]
    buffer_load_dwordx4 v[180:183], v2, s[4:7], s42 offen offset:2304 sc1
    ds_read_b64_tr_b16 v[52:53], v4 offset:12288
    s_xor_b32 s42, s41, 28672
    v_mfma_f32_16x16x32_bf16 v[148:151], v[56:59], v[108:111], v[148:151]
    ds_read_b64_tr_b16 v[54:55], v4 offset:13312
    v_mfma_f32_16x16x32_bf16 v[152:155], v[60:63], v[104:107], v[152:155]
    ds_read_b64_tr_b16 v[56:57], v5 offset:12288
    v_mfma_f32_16x16x32_bf16 v[156:159], v[60:63], v[108:111], v[156:159]
    ds_read_b64_tr_b16 v[58:59], v5 offset:13312
    s_waitcnt vmcnt(8) lgkmcnt(10)
    v_mfma_f32_16x16x32_bf16 v[128:131], v[32:35], v[112:115], v[128:131]
    ds_read_b64_tr_b16 v[60:61], v6 offset:12288
    buffer_load_dwordx4 v[184:187], v2, s[4:7], s42 offen offset:2048 sc1
    v_mfma_f32_16x16x32_bf16 v[132:135], v[32:35], v[116:119], v[132:135]
    ds_read_b64_tr_b16 v[62:63], v6 offset:13312
    v_mfma_f32_16x16x32_bf16 v[136:139], v[36:39], v[112:115], v[136:139]
    ds_read_b64_tr_b16 v[32:33], v3 offset:16384
    v_mfma_f32_16x16x32_bf16 v[140:143], v[36:39], v[116:119], v[140:143]
    ds_read_b64_tr_b16 v[34:35], v3 offset:17408
    s_waitcnt lgkmcnt(10)
    v_mfma_f32_16x16x32_bf16 v[144:147], v[40:43], v[112:115], v[144:147]
    buffer_load_dwordx4 v[188:191], v2, s[4:7], s42 offen offset:2304 sc1
    ds_read_b64_tr_b16 v[36:37], v4 offset:16384
    s_xor_b32 s42, s41, 32768
    v_mfma_f32_16x16x32_bf16 v[148:151], v[40:43], v[116:119], v[148:151]
    ds_read_b64_tr_b16 v[38:39], v4 offset:17408
    v_mfma_f32_16x16x32_bf16 v[152:155], v[44:47], v[112:115], v[152:155]
    ds_read_b64_tr_b16 v[40:41], v5 offset:16384
    v_mfma_f32_16x16x32_bf16 v[156:159], v[44:47], v[116:119], v[156:159]
    ds_read_b64_tr_b16 v[42:43], v5 offset:17408
    s_waitcnt vmcnt(8) lgkmcnt(10)
    v_mfma_f32_16x16x32_bf16 v[128:131], v[48:51], v[120:123], v[128:131]
    buffer_load_dwordx4 v[64:67], v2, s[4:7], s42 offen offset:2048 sc1
    ds_read_b64_tr_b16 v[44:45], v6 offset:16384
    v_mfma_f32_16x16x32_bf16 v[132:135], v[48:51], v[124:127], v[132:135]
    ds_read_b64_tr_b16 v[46:47], v6 offset:17408
    v_mfma_f32_16x16x32_bf16 v[136:139], v[52:55], v[120:123], v[136:139]
    ds_read_b64_tr_b16 v[48:49], v3 offset:20480
    v_mfma_f32_16x16x32_bf16 v[140:143], v[52:55], v[124:127], v[140:143]
    ds_read_b64_tr_b16 v[50:51], v3 offset:21504
    s_waitcnt lgkmcnt(10)
    v_mfma_f32_16x16x32_bf16 v[144:147], v[56:59], v[120:123], v[144:147]
    buffer_load_dwordx4 v[68:71], v2, s[4:7], s42 offen offset:2304 sc1
    ds_read_b64_tr_b16 v[52:53], v4 offset:20480
    s_xor_b32 s42, s41, 36864
    v_mfma_f32_16x16x32_bf16 v[148:151], v[56:59], v[124:127], v[148:151]
    ds_read_b64_tr_b16 v[54:55], v4 offset:21504
    v_mfma_f32_16x16x32_bf16 v[152:155], v[60:63], v[120:123], v[152:155]
    ds_read_b64_tr_b16 v[56:57], v5 offset:20480
    v_mfma_f32_16x16x32_bf16 v[156:159], v[60:63], v[124:127], v[156:159]
    ds_read_b64_tr_b16 v[58:59], v5 offset:21504
    s_waitcnt vmcnt(8) lgkmcnt(10)
    v_mfma_f32_16x16x32_bf16 v[128:131], v[32:35], v[160:163], v[128:131]
    ds_read_b64_tr_b16 v[60:61], v6 offset:20480
    buffer_load_dwordx4 v[72:75], v2, s[4:7], s42 offen offset:2048 sc1
    v_mfma_f32_16x16x32_bf16 v[132:135], v[32:35], v[164:167], v[132:135]
    ds_read_b64_tr_b16 v[62:63], v6 offset:21504
    v_mfma_f32_16x16x32_bf16 v[136:139], v[36:39], v[160:163], v[136:139]
    ds_read_b64_tr_b16 v[32:33], v3 offset:24576
    v_mfma_f32_16x16x32_bf16 v[140:143], v[36:39], v[164:167], v[140:143]
    ds_read_b64_tr_b16 v[34:35], v3 offset:25600
    s_waitcnt lgkmcnt(10)
    v_mfma_f32_16x16x32_bf16 v[144:147], v[40:43], v[160:163], v[144:147]
    buffer_load_dwordx4 v[76:79], v2, s[4:7], s42 offen offset:2304 sc1
    ds_read_b64_tr_b16 v[36:37], v4 offset:24576
    s_xor_b32 s42, s41, 40960
    v_mfma_f32_16x16x32_bf16 v[148:151], v[40:43], v[164:167], v[148:151]
    ds_read_b64_tr_b16 v[38:39], v4 offset:25600
    v_mfma_f32_16x16x32_bf16 v[152:155], v[44:47], v[160:163], v[152:155]
    ds_read_b64_tr_b16 v[40:41], v5 offset:24576
    v_mfma_f32_16x16x32_bf16 v[156:159], v[44:47], v[164:167], v[156:159]
    ds_read_b64_tr_b16 v[42:43], v5 offset:25600
    s_waitcnt vmcnt(8) lgkmcnt(10)
    v_mfma_f32_16x16x32_bf16 v[128:131], v[48:51], v[168:171], v[128:131]
    buffer_load_dwordx4 v[80:83], v2, s[4:7], s42 offen offset:2048 sc1
    ds_read_b64_tr_b16 v[44:45], v6 offset:24576
    v_mfma_f32_16x16x32_bf16 v[132:135], v[48:51], v[172:175], v[132:135]
    ds_read_b64_tr_b16 v[46:47], v6 offset:25600
    v_mfma_f32_16x16x32_bf16 v[136:139], v[52:55], v[168:171], v[136:139]
    ds_read_b64_tr_b16 v[48:49], v3 offset:28672
    v_mfma_f32_16x16x32_bf16 v[140:143], v[52:55], v[172:175], v[140:143]
    ds_read_b64_tr_b16 v[50:51], v3 offset:29696
    s_waitcnt lgkmcnt(10)
    v_mfma_f32_16x16x32_bf16 v[144:147], v[56:59], v[168:171], v[144:147]
    buffer_load_dwordx4 v[84:87], v2, s[4:7], s42 offen offset:2304 sc1
    ds_read_b64_tr_b16 v[52:53], v4 offset:28672
    s_xor_b32 s42, s41, 45056
    v_mfma_f32_16x16x32_bf16 v[148:151], v[56:59], v[172:175], v[148:151]
    ds_read_b64_tr_b16 v[54:55], v4 offset:29696
    v_mfma_f32_16x16x32_bf16 v[152:155], v[60:63], v[168:171], v[152:155]
    ds_read_b64_tr_b16 v[56:57], v5 offset:28672
    v_mfma_f32_16x16x32_bf16 v[156:159], v[60:63], v[172:175], v[156:159]
    ds_read_b64_tr_b16 v[58:59], v5 offset:29696
    s_waitcnt vmcnt(8) lgkmcnt(10)
    v_mfma_f32_16x16x32_bf16 v[128:131], v[32:35], v[176:179], v[128:131]
    ds_read_b64_tr_b16 v[60:61], v6 offset:28672
    buffer_load_dwordx4 v[88:91], v2, s[4:7], s42 offen offset:2048 sc1
    v_mfma_f32_16x16x32_bf16 v[132:135], v[32:35], v[180:183], v[132:135]
    ds_read_b64_tr_b16 v[62:63], v6 offset:29696
    v_mfma_f32_16x16x32_bf16 v[136:139], v[36:39], v[176:179], v[136:139]
    ds_read_b64_tr_b16 v[32:33], v3 offset:32768
    v_mfma_f32_16x16x32_bf16 v[140:143], v[36:39], v[180:183], v[140:143]
    ds_read_b64_tr_b16 v[34:35], v3 offset:33792
    s_waitcnt lgkmcnt(10)
    v_mfma_f32_16x16x32_bf16 v[144:147], v[40:43], v[176:179], v[144:147]
    buffer_load_dwordx4 v[92:95], v2, s[4:7], s42 offen offset:2304 sc1
    ds_read_b64_tr_b16 v[36:37], v4 offset:32768
    s_xor_b32 s42, s41, 49152
    v_mfma_f32_16x16x32_bf16 v[148:151], v[40:43], v[180:183], v[148:151]
    ds_read_b64_tr_b16 v[38:39], v4 offset:33792
    v_mfma_f32_16x16x32_bf16 v[152:155], v[44:47], v[176:179], v[152:155]
    ds_read_b64_tr_b16 v[40:41], v5 offset:32768
    v_mfma_f32_16x16x32_bf16 v[156:159], v[44:47], v[180:183], v[156:159]
    ds_read_b64_tr_b16 v[42:43], v5 offset:33792
    s_waitcnt vmcnt(8) lgkmcnt(10)
    v_mfma_f32_16x16x32_bf16 v[128:131], v[48:51], v[184:187], v[128:131]
    buffer_load_dwordx4 v[96:99], v2, s[4:7], s42 offen offset:2048 sc1
    ds_read_b64_tr_b16 v[44:45], v6 offset:32768
    v_mfma_f32_16x16x32_bf16 v[132:135], v[48:51], v[188:191], v[132:135]
    ds_read_b64_tr_b16 v[46:47], v6 offset:33792
    v_mfma_f32_16x16x32_bf16 v[136:139], v[52:55], v[184:187], v[136:139]
    ds_read_b64_tr_b16 v[48:49], v3 offset:36864
    v_mfma_f32_16x16x32_bf16 v[140:143], v[52:55], v[188:191], v[140:143]
    ds_read_b64_tr_b16 v[50:51], v3 offset:37888
    s_waitcnt lgkmcnt(10)
    v_mfma_f32_16x16x32_bf16 v[144:147], v[56:59], v[184:187], v[144:147]
    buffer_load_dwordx4 v[100:103], v2, s[4:7], s42 offen offset:2304 sc1
    ds_read_b64_tr_b16 v[52:53], v4 offset:36864
    s_xor_b32 s42, s41, 53248
    v_mfma_f32_16x16x32_bf16 v[148:151], v[56:59], v[188:191], v[148:151]
    ds_read_b64_tr_b16 v[54:55], v4 offset:37888
    v_mfma_f32_16x16x32_bf16 v[152:155], v[60:63], v[184:187], v[152:155]
    ds_read_b64_tr_b16 v[56:57], v5 offset:36864
    v_mfma_f32_16x16x32_bf16 v[156:159], v[60:63], v[188:191], v[156:159]
    ds_read_b64_tr_b16 v[58:59], v5 offset:37888
    s_waitcnt vmcnt(8) lgkmcnt(10)
    v_mfma_f32_16x16x32_bf16 v[128:131], v[32:35], v[64:67], v[128:131]
    ds_read_b64_tr_b16 v[60:61], v6 offset:36864
    buffer_load_dwordx4 v[104:107], v2, s[4:7], s42 offen offset:2048 sc1
    v_mfma_f32_16x16x32_bf16 v[132:135], v[32:35], v[68:71], v[132:135]
    ds_read_b64_tr_b16 v[62:63], v6 offset:37888
    v_mfma_f32_16x16x32_bf16 v[136:139], v[36:39], v[64:67], v[136:139]
    ds_read_b64_tr_b16 v[32:33], v3 offset:40960
    v_mfma_f32_16x16x32_bf16 v[140:143], v[36:39], v[68:71], v[140:143]
    ds_read_b64_tr_b16 v[34:35], v3 offset:41984
    s_waitcnt lgkmcnt(10)
    v_mfma_f32_16x16x32_bf16 v[144:147], v[40:43], v[64:67], v[144:147]
    buffer_load_dwordx4 v[108:111], v2, s[4:7], s42 offen offset:2304 sc1
    ds_read_b64_tr_b16 v[36:37], v4 offset:40960
    s_xor_b32 s42, s41, 57344
    v_mfma_f32_16x16x32_bf16 v[148:151], v[40:43], v[68:71], v[148:151]
    ds_read_b64_tr_b16 v[38:39], v4 offset:41984
    v_mfma_f32_16x16x32_bf16 v[152:155], v[44:47], v[64:67], v[152:155]
    ds_read_b64_tr_b16 v[40:41], v5 offset:40960
    v_mfma_f32_16x16x32_bf16 v[156:159], v[44:47], v[68:71], v[156:159]
    ds_read_b64_tr_b16 v[42:43], v5 offset:41984
    s_waitcnt vmcnt(8) lgkmcnt(10)
    v_mfma_f32_16x16x32_bf16 v[128:131], v[48:51], v[72:75], v[128:131]
    buffer_load_dwordx4 v[112:115], v2, s[4:7], s42 offen offset:2048 sc1
    ds_read_b64_tr_b16 v[44:45], v6 offset:40960
    v_mfma_f32_16x16x32_bf16 v[132:135], v[48:51], v[76:79], v[132:135]
    ds_read_b64_tr_b16 v[46:47], v6 offset:41984
    v_mfma_f32_16x16x32_bf16 v[136:139], v[52:55], v[72:75], v[136:139]
    ds_read_b64_tr_b16 v[48:49], v3 offset:45056
    v_mfma_f32_16x16x32_bf16 v[140:143], v[52:55], v[76:79], v[140:143]
    ds_read_b64_tr_b16 v[50:51], v3 offset:46080
    s_waitcnt lgkmcnt(10)
    v_mfma_f32_16x16x32_bf16 v[144:147], v[56:59], v[72:75], v[144:147]
    buffer_load_dwordx4 v[116:119], v2, s[4:7], s42 offen offset:2304 sc1
    ds_read_b64_tr_b16 v[52:53], v4 offset:45056
    s_xor_b32 s42, s41, 61440
    v_mfma_f32_16x16x32_bf16 v[148:151], v[56:59], v[76:79], v[148:151]
    ds_read_b64_tr_b16 v[54:55], v4 offset:46080
    v_mfma_f32_16x16x32_bf16 v[152:155], v[60:63], v[72:75], v[152:155]
    ds_read_b64_tr_b16 v[56:57], v5 offset:45056
    v_mfma_f32_16x16x32_bf16 v[156:159], v[60:63], v[76:79], v[156:159]
    ds_read_b64_tr_b16 v[58:59], v5 offset:46080
    s_waitcnt vmcnt(8) lgkmcnt(10)
    v_mfma_f32_16x16x32_bf16 v[128:131], v[32:35], v[80:83], v[128:131]
    ds_read_b64_tr_b16 v[60:61], v6 offset:45056
    buffer_load_dwordx4 v[120:123], v2, s[4:7], s42 offen offset:2048 sc1
    v_mfma_f32_16x16x32_bf16 v[132:135], v[32:35], v[84:87], v[132:135]
    ds_read_b64_tr_b16 v[62:63], v6 offset:46080
    v_mfma_f32_16x16x32_bf16 v[136:139], v[36:39], v[80:83], v[136:139]
    ds_read_b64_tr_b16 v[32:33], v3 offset:49152
    v_mfma_f32_16x16x32_bf16 v[140:143], v[36:39], v[84:87], v[140:143]
    ds_read_b64_tr_b16 v[34:35], v3 offset:50176
    s_waitcnt lgkmcnt(10)
    v_mfma_f32_16x16x32_bf16 v[144:147], v[40:43], v[80:83], v[144:147]
    buffer_load_dwordx4 v[124:127], v2, s[4:7], s42 offen offset:2304 sc1
    ds_read_b64_tr_b16 v[36:37], v4 offset:49152
    v_mfma_f32_16x16x32_bf16 v[148:151], v[40:43], v[84:87], v[148:151]
    ds_read_b64_tr_b16 v[38:39], v4 offset:50176
    v_mfma_f32_16x16x32_bf16 v[152:155], v[44:47], v[80:83], v[152:155]
    ds_read_b64_tr_b16 v[40:41], v5 offset:49152
    v_mfma_f32_16x16x32_bf16 v[156:159], v[44:47], v[84:87], v[156:159]
    ds_read_b64_tr_b16 v[42:43], v5 offset:50176
    s_waitcnt vmcnt(8) lgkmcnt(10)
    v_mfma_f32_16x16x32_bf16 v[128:131], v[48:51], v[88:91], v[128:131]
    ds_read_b64_tr_b16 v[44:45], v6 offset:49152
    v_mfma_f32_16x16x32_bf16 v[132:135], v[48:51], v[92:95], v[132:135]
    ds_read_b64_tr_b16 v[46:47], v6 offset:50176
    v_mfma_f32_16x16x32_bf16 v[136:139], v[52:55], v[88:91], v[136:139]
    ds_read_b64_tr_b16 v[48:49], v3 offset:53248
    v_mfma_f32_16x16x32_bf16 v[140:143], v[52:55], v[92:95], v[140:143]
    ds_read_b64_tr_b16 v[50:51], v3 offset:54272
    s_waitcnt lgkmcnt(10)
    v_mfma_f32_16x16x32_bf16 v[144:147], v[56:59], v[88:91], v[144:147]
    ds_read_b64_tr_b16 v[52:53], v4 offset:53248
    v_mfma_f32_16x16x32_bf16 v[148:151], v[56:59], v[92:95], v[148:151]
    ds_read_b64_tr_b16 v[54:55], v4 offset:54272
    v_mfma_f32_16x16x32_bf16 v[152:155], v[60:63], v[88:91], v[152:155]
    ds_read_b64_tr_b16 v[56:57], v5 offset:53248
    v_mfma_f32_16x16x32_bf16 v[156:159], v[60:63], v[92:95], v[156:159]
    ds_read_b64_tr_b16 v[58:59], v5 offset:54272
    s_waitcnt vmcnt(6) lgkmcnt(10)
    v_mfma_f32_16x16x32_bf16 v[128:131], v[32:35], v[96:99], v[128:131]
    ds_read_b64_tr_b16 v[60:61], v6 offset:53248
    v_mfma_f32_16x16x32_bf16 v[132:135], v[32:35], v[100:103], v[132:135]
    ds_read_b64_tr_b16 v[62:63], v6 offset:54272
    v_mfma_f32_16x16x32_bf16 v[136:139], v[36:39], v[96:99], v[136:139]
    ds_read_b64_tr_b16 v[32:33], v3 offset:57344
    v_mfma_f32_16x16x32_bf16 v[140:143], v[36:39], v[100:103], v[140:143]
    ds_read_b64_tr_b16 v[34:35], v3 offset:58368
    s_waitcnt lgkmcnt(10)
    v_mfma_f32_16x16x32_bf16 v[144:147], v[40:43], v[96:99], v[144:147]
    ds_read_b64_tr_b16 v[36:37], v4 offset:57344
    v_mfma_f32_16x16x32_bf16 v[148:151], v[40:43], v[100:103], v[148:151]
    ds_read_b64_tr_b16 v[38:39], v4 offset:58368
    v_mfma_f32_16x16x32_bf16 v[152:155], v[44:47], v[96:99], v[152:155]
    ds_read_b64_tr_b16 v[40:41], v5 offset:57344
    v_mfma_f32_16x16x32_bf16 v[156:159], v[44:47], v[100:103], v[156:159]
    ds_read_b64_tr_b16 v[42:43], v5 offset:58368
    s_waitcnt vmcnt(4) lgkmcnt(10)
    v_mfma_f32_16x16x32_bf16 v[128:131], v[48:51], v[104:107], v[128:131]
    ds_read_b64_tr_b16 v[44:45], v6 offset:57344
    v_mfma_f32_16x16x32_bf16 v[132:135], v[48:51], v[108:111], v[132:135]
    ds_read_b64_tr_b16 v[46:47], v6 offset:58368
    v_mfma_f32_16x16x32_bf16 v[136:139], v[52:55], v[104:107], v[136:139]
    ds_read_b64_tr_b16 v[48:49], v3 offset:61440
    v_mfma_f32_16x16x32_bf16 v[140:143], v[52:55], v[108:111], v[140:143]
    ds_read_b64_tr_b16 v[50:51], v3 offset:62464
    s_waitcnt lgkmcnt(10)
    v_mfma_f32_16x16x32_bf16 v[144:147], v[56:59], v[104:107], v[144:147]
    ds_read_b64_tr_b16 v[52:53], v4 offset:61440
    v_mfma_f32_16x16x32_bf16 v[148:151], v[56:59], v[108:111], v[148:151]
    ds_read_b64_tr_b16 v[54:55], v4 offset:62464
    v_mfma_f32_16x16x32_bf16 v[152:155], v[60:63], v[104:107], v[152:155]
    ds_read_b64_tr_b16 v[56:57], v5 offset:61440
    v_mfma_f32_16x16x32_bf16 v[156:159], v[60:63], v[108:111], v[156:159]
    ds_read_b64_tr_b16 v[58:59], v5 offset:62464
    s_waitcnt vmcnt(2) lgkmcnt(10)
    v_mfma_f32_16x16x32_bf16 v[128:131], v[32:35], v[112:115], v[128:131]
    ds_read_b64_tr_b16 v[60:61], v6 offset:61440
    v_mfma_f32_16x16x32_bf16 v[132:135], v[32:35], v[116:119], v[132:135]
    ds_read_b64_tr_b16 v[62:63], v6 offset:62464
    v_xor_b32 v3, 0x10000, v3
    v_xor_b32 v4, 0x10000, v4
    v_xor_b32 v5, 0x10000, v5
    v_xor_b32 v6, 0x10000, v6
    v_mfma_f32_16x16x32_bf16 v[136:139], v[36:39], v[112:115], v[136:139]
    v_mfma_f32_16x16x32_bf16 v[140:143], v[36:39], v[116:119], v[140:143]
    s_waitcnt lgkmcnt(8)
    v_mfma_f32_16x16x32_bf16 v[144:147], v[40:43], v[112:115], v[144:147]
    v_mfma_f32_16x16x32_bf16 v[148:151], v[40:43], v[116:119], v[148:151]
    v_mfma_f32_16x16x32_bf16 v[152:155], v[44:47], v[112:115], v[152:155]
    v_mfma_f32_16x16x32_bf16 v[156:159], v[44:47], v[116:119], v[156:159]
    s_waitcnt vmcnt(0) lgkmcnt(4)
    v_mfma_f32_16x16x32_bf16 v[128:131], v[48:51], v[120:123], v[128:131]
    v_mfma_f32_16x16x32_bf16 v[132:135], v[48:51], v[124:127], v[132:135]
    v_mfma_f32_16x16x32_bf16 v[136:139], v[52:55], v[120:123], v[136:139]
    v_mfma_f32_16x16x32_bf16 v[140:143], v[52:55], v[124:127], v[140:143]
    s_waitcnt lgkmcnt(0)
    v_mfma_f32_16x16x32_bf16 v[144:147], v[56:59], v[120:123], v[144:147]
    v_mfma_f32_16x16x32_bf16 v[148:151], v[56:59], v[124:127], v[148:151]
    v_mfma_f32_16x16x32_bf16 v[152:155], v[60:63], v[120:123], v[152:155]
    v_mfma_f32_16x16x32_bf16 v[156:159], v[60:63], v[124:127], v[156:159]
    s_cmp_eq_u32 s21, 3
    s_cbranch_scc1 c_final
    s_add_u32 s43, s43, 4194304
    v_cvt_pk_bf16_f32 v160, v128, v129
    v_cvt_pk_bf16_f32 v161, v130, v131
    v_cvt_pk_bf16_f32 v162, v136, v137
    v_cvt_pk_bf16_f32 v163, v138, v139
    v_cvt_pk_bf16_f32 v168, v144, v145
    v_cvt_pk_bf16_f32 v169, v146, v147
    v_cvt_pk_bf16_f32 v170, v152, v153
    v_cvt_pk_bf16_f32 v171, v154, v155
    v_permlane32_swap_b32 v160, v162
    v_permlane32_swap_b32 v161, v163
    buffer_store_dwordx4 v[160:163], v2, s[4:7], s43 offen offset:0 sc1
    v_permlane32_swap_b32 v168, v170
    v_permlane32_swap_b32 v169, v171
    buffer_store_dwordx4 v[168:171], v2, s[4:7], s43 offen offset:2048 sc1
    v_cvt_pk_bf16_f32 v164, v132, v133
    v_cvt_pk_bf16_f32 v165, v134, v135
    v_cvt_pk_bf16_f32 v166, v140, v141
    v_cvt_pk_bf16_f32 v167, v142, v143
    v_cvt_pk_bf16_f32 v172, v148, v149
    v_cvt_pk_bf16_f32 v173, v150, v151
    v_cvt_pk_bf16_f32 v174, v156, v157
    v_cvt_pk_bf16_f32 v175, v158, v159
    v_permlane32_swap_b32 v164, v166
    v_permlane32_swap_b32 v165, v167
    buffer_store_dwordx4 v[164:167], v2, s[4:7], s43 offen offset:256 sc1
    v_permlane32_swap_b32 v172, v174
    v_permlane32_swap_b32 v173, v175
    buffer_store_dwordx4 v[172:175], v2, s[4:7], s43 offen offset:2304 sc1
    s_barrier
    s_add_u32 s21, s21, 1
    v_mov_b32 v22, 0x3f803f80
    v_dot2_f32_bf16 v24, v160, v22, 0
    v_dot2_f32_bf16 v25, v160, v160, 0
    v_dot2_f32_bf16 v26, v164, v22, 0
    v_dot2_f32_bf16 v27, v164, v164, 0
    v_dot2_f32_bf16 v24, v161, v22, v24
    v_dot2_f32_bf16 v25, v161, v161, v25
    v_dot2_f32_bf16 v26, v165, v22, v26
    v_dot2_f32_bf16 v27, v165, v165, v27
    v_dot2_f32_bf16 v24, v162, v22, v24
    v_dot2_f32_bf16 v25, v162, v162, v25
    v_dot2_f32_bf16 v26, v166, v22, v26
    v_dot2_f32_bf16 v27, v166, v166, v27
    v_dot2_f32_bf16 v24, v163, v22, v24
    v_dot2_f32_bf16 v25, v163, v163, v25
    v_dot2_f32_bf16 v26, v167, v22, v26
    v_dot2_f32_bf16 v27, v167, v167, v27
    v_dot2_f32_bf16 v24, v168, v22, v24
    v_dot2_f32_bf16 v25, v168, v168, v25
    v_dot2_f32_bf16 v26, v172, v22, v26
    v_dot2_f32_bf16 v27, v172, v172, v27
    v_dot2_f32_bf16 v24, v169, v22, v24
    v_dot2_f32_bf16 v25, v169, v169, v25
    v_dot2_f32_bf16 v26, v173, v22, v26
    v_dot2_f32_bf16 v27, v173, v173, v27
    v_dot2_f32_bf16 v24, v170, v22, v24
    v_dot2_f32_bf16 v25, v170, v170, v25
    v_dot2_f32_bf16 v26, v174, v22, v26
    v_dot2_f32_bf16 v27, v174, v174, v27
    v_dot2_f32_bf16 v24, v171, v22, v24
    v_dot2_f32_bf16 v25, v171, v171, v25
    v_dot2_f32_bf16 v26, v175, v22, v26
    v_dot2_f32_bf16 v27, v175, v175, v27
    v_lshrrev_b32 v23, 1, v1
    v_and_b32 v23, 0xf8, v23
    s_nop 0
    v_permlane16_swap_b32 v24, v26
    v_permlane16_swap_b32 v25, v27
    v_pk_add_f32 v[24:25], v[24:25], v[26:27]
    v_mov_b32 v26, v24
    v_mov_b32 v27, v25
    s_nop 0
    v_permlane32_swap_b32 v24, v26
    v_permlane32_swap_b32 v25, v27
    v_pk_add_f32 v[24:25], v[24:25], v[26:27]
    s_lshl_b32 s44, s21, 18
    s_lshl_b32 s45, s38, 12
    s_add_u32 s44, s44, s45
    s_lshl_b32 s45, s18, 8
    s_add_u32 s44, s44, s45
    s_add_u32 s44, s44, 50331648
    buffer_store_dwordx2 v[24:25], v23, s[4:7], s44 offen sc1
    s_lshl_b32 s46, s21, 14
    s_lshl_b32 s67, s38, 7
    s_add_u32 s46, s46, s67
    s_add_u32 s46, s46, 4096
    s_add_u32 s47, s46, 8192
    s_lshl_b32 s48, s21, 22
    s_lshl_b32 s49, s38, 16
    s_add_u32 s41, s48, s49
    v_lshrrev_b32 v16, 4, v1
    v_and_b32 v17, 15, v16
    v_lshrrev_b32 v16, 4, v16
    s_lshl_b32 s49, s16, 7
    s_add_u32 s50, s49, 151552
    s_and_b32 s49, s21, 1
    s_lshl_b32 s49, s49, 10
    s_add_u32 s49, s49, 151552
    v_lshlrev_b32 v11, 4, v16
    v_add_u32 v13, s50, v11
    v_add_u32 v11, s49, v11
    v_lshlrev_b32 v15, 2, v17
    v_add_u32 v9, s50, v15
    v_add_u32 v15, s49, v15
    s_lshr_b32 s49, s21, 1
    s_lshl_b32 s53, s49, 23
    s_lshl_b32 s50, s18, 18
    s_add_u32 s53, s53, s50
    s_add_u32 s53, s53, 33554432
    s_lshl_b32 s54, s38, 11
    s_add_u32 s52, s53, s54
    s_lshl_b32 s59, s49, 13
    s_lshl_b32 s67, s18, 9
    s_add_u32 s59, s59, s67
    s_lshl_b32 s67, s16, 7
    s_add_u32 s59, s59, s67
    s_add_u32 s59, s59, 69632
    s_lshl_b32 s61, s49, 15
    s_lshl_b32 s67, s17, 11
    s_add_u32 s61, s61, s67
    s_lshl_b32 s67, s18, 7
    s_add_u32 s61, s61, s67
    s_add_u32 s61, s61, 151552
    s_sub_u32 s60, s61, 151552
    s_lshl_b32 s60, s60, 5
    s_add_u32 s60, s60, 54525952
    s_lshl_b32 s62, s16, 12
    s_add_u32 s62, s62, 131072
    s_mov_b32 s68, s63
    s_waitcnt vmcnt(1)
    s_atomic_add s68, s[22:23], s46 glc
    s_mov_b32 s48, 0
    s_branch c_layer
c_final:
    s_mov_b32 s8, s32
    s_mov_b32 s9, s33
    s_mov_b32 s10, 4194304
    s_mov_b32 s11, 0x00020000
    v_lshrrev_b32 v12, 4, v1
    s_mul_i32 s44, s16, 4608
    s_add_u32 s44, s44, 131072
    v_and_b32 v13, 15, v12
    v_mul_u32_u24 v13, 144, v13
    v_lshrrev_b32 v14, 4, v12
    v_lshl_add_u32 v13, v14, 3, v13
    v_add_u32 v13, s44, v13
    v_cvt_pk_bf16_f32 v128, v128, v129
    v_cvt_pk_bf16_f32 v129, v130, v131
    ds_write_b64 v13, v[128:129] offset:0
    v_cvt_pk_bf16_f32 v136, v136, v137
    v_cvt_pk_bf16_f32 v137, v138, v139
    ds_write_b64 v13, v[136:137] offset:32
    v_cvt_pk_bf16_f32 v144, v144, v145
    v_cvt_pk_bf16_f32 v145, v146, v147
    ds_write_b64 v13, v[144:145] offset:64
    v_cvt_pk_bf16_f32 v152, v152, v153
    v_cvt_pk_bf16_f32 v153, v154, v155
    ds_write_b64 v13, v[152:153] offset:96
    v_cvt_pk_bf16_f32 v132, v132, v133
    v_cvt_pk_bf16_f32 v133, v134, v135
    ds_write_b64 v13, v[132:133] offset:2304
    v_cvt_pk_bf16_f32 v140, v140, v141
    v_cvt_pk_bf16_f32 v141, v142, v143
    ds_write_b64 v13, v[140:141] offset:2336
    v_cvt_pk_bf16_f32 v148, v148, v149
    v_cvt_pk_bf16_f32 v149, v150, v151
    ds_write_b64 v13, v[148:149] offset:2368
    v_cvt_pk_bf16_f32 v156, v156, v157
    v_cvt_pk_bf16_f32 v157, v158, v159
    ds_write_b64 v13, v[156:157] offset:2400
    v_lshrrev_b32 v14, 3, v12
    v_and_b32 v15, 7, v12
    v_mul_u32_u24 v16, 144, v14
    v_lshl_add_u32 v16, v15, 4, v16
    v_add_u32 v16, s44, v16
    v_lshlrev_b32 v17, 11, v14
    v_lshl_add_u32 v17, v15, 4, v17
    ds_read_b128 v[32:35], v16 offset:0
    ds_read_b128 v[36:39], v16 offset:1152
    ds_read_b128 v[40:43], v16 offset:2304
    ds_read_b128 v[44:47], v16 offset:3456
    s_lshl_b32 s44, s38, 16
    s_lshl_b32 s45, s18, 7
    s_add_u32 s44, s44, s45
    s_waitcnt lgkmcnt(3)
    buffer_store_dwordx4 v[32:35], v17, s[8:11], s44 offen sc1
    s_add_u32 s44, s44, 16384
    s_waitcnt lgkmcnt(2)
    buffer_store_dwordx4 v[36:39], v17, s[8:11], s44 offen sc1
    s_add_u32 s44, s44, 16384
    s_waitcnt lgkmcnt(1)
    buffer_store_dwordx4 v[40:43], v17, s[8:11], s44 offen sc1
    s_add_u32 s44, s44, 16384
    s_waitcnt lgkmcnt(0)
    buffer_store_dwordx4 v[44:47], v17, s[8:11], s44 offen sc1
    s_endpgm
s_start:
    v_mov_b32 v14, 0
    v_mov_b32 v15, 0
    v_mov_b32 v20, 0
    v_mov_b32 v21, 0
    v_mov_b32 v22, 0
    s_mov_b32 s41, 0
    s_mov_b32 s42, 0
    s_mov_b32 s43, 0
    s_mov_b32 s62, 0
    s_cmp_eq_u32 s16, 4
    s_cbranch_scc1 h_start
    s_cmp_eq_u32 s16, 7
    s_cbranch_scc1 z_start
l_start:
    v_lshrrev_b32 v24, 4, v1
    v_lshrrev_b32 v25, 3, v24
    v_mul_u32_u24 v12, 6144, v25
    v_and_b32 v26, 2, v25
    v_lshrrev_b32 v25, 2, v25
    v_or_b32 v26, v26, v25
    v_bfe_u32 v25, v24, 1, 2
    v_xor_b32 v26, v26, v25
    v_lshl_add_u32 v12, v26, 5, v12
    v_and_b32 v26, 1, v24
    v_lshl_add_u32 v12, v26, 4, v12
    s_lshl_b32 s3, s18, 7
    v_add_u32 v12, s3, v12
    v_add_u32 v13, 48128, v12
    s_mul_i32 s84, s18, 393216
    s_cmp_lt_u32 s18, 4
    s_cselect_b32 s85, 4, 0
    s_mul_i32 s85, s85, 393216
    s_sub_u32 s3, s16, 5
    s_lshl_b32 s41, s3, 11
    s_mul_i32 s42, s3, 98304
    s_lshl_b32 s62, s3, 15
    v_add_u32 v14, s42, v12
    v_add_u32 v15, s42, v13
    s_bitcmp1_b32 s21, 0
    s_cselect_b32 s8, s28, s24
    s_cselect_b32 s9, s29, s25
    s_cselect_b32 s12, s30, s26
    s_cselect_b32 s13, s31, s27
    s_mov_b32 s10, 6291456
    s_mov_b32 s11, 0x00020000
    s_mov_b32 s14, 2097152
    s_mov_b32 s15, 0x00020000
    s_add_u32 m0, s41, 0
    s_add_u32 s44, s84, 2048
    buffer_load_dwordx4 v14, s[8:11], s44 offen offset:0 lds
    buffer_load_dwordx4 v15, s[8:11], s44 offen offset:1024 lds
    s_add_u32 m0, s41, 4096
    s_add_u32 s44, s84, 4096
    buffer_load_dwordx4 v14, s[8:11], s44 offen offset:0 lds
    buffer_load_dwordx4 v15, s[8:11], s44 offen offset:1024 lds
    s_add_u32 m0, s41, 8192
    s_add_u32 s44, s84, 0
    buffer_load_dwordx4 v14, s[8:11], s44 offen offset:0 lds
    buffer_load_dwordx4 v15, s[8:11], s44 offen offset:1024 lds
    s_add_u32 m0, s41, 12288
    s_add_u32 s44, s84, 198656
    buffer_load_dwordx4 v14, s[8:11], s44 offen offset:0 lds
    buffer_load_dwordx4 v15, s[8:11], s44 offen offset:1024 lds
    s_add_u32 m0, s41, 16384
    s_add_u32 s44, s84, 200704
    buffer_load_dwordx4 v14, s[8:11], s44 offen offset:0 lds
    buffer_load_dwordx4 v15, s[8:11], s44 offen offset:1024 lds
    s_add_u32 m0, s41, 20480
    s_add_u32 s44, s84, 196608
    buffer_load_dwordx4 v14, s[8:11], s44 offen offset:0 lds
    buffer_load_dwordx4 v15, s[8:11], s44 offen offset:1024 lds
    s_add_u32 m0, s41, 24576
    s_add_u32 s44, s85, 2048
    buffer_load_dwordx4 v14, s[8:11], s44 offen offset:0 lds
    buffer_load_dwordx4 v15, s[8:11], s44 offen offset:1024 lds
    s_add_u32 m0, s41, 28672
    s_add_u32 s44, s85, 4096
    buffer_load_dwordx4 v14, s[8:11], s44 offen offset:0 lds
    buffer_load_dwordx4 v15, s[8:11], s44 offen offset:1024 lds
    s_cmp_lt_u32 s18, 4
    s_cselect_b32 s86, 5, 1
    s_mul_i32 s86, s86, 393216
    s_cmp_lt_u32 s18, 4
    s_cselect_b32 s87, 6, 2
    s_mul_i32 s87, s87, 393216
    s_cmp_lt_u32 s18, 4
    s_cselect_b32 s88, 7, 3
    s_mul_i32 s88, s88, 393216
    s_cmp_lt_u32 s18, 8
    s_cselect_b32 s89, 8, 4
    s_mul_i32 s89, s89, 393216
    s_cmp_lt_u32 s18, 8
    s_cselect_b32 s90, 9, 5
    s_mul_i32 s90, s90, 393216
    s_cmp_lt_u32 s18, 8
    s_cselect_b32 s91, 10, 6
    s_mul_i32 s91, s91, 393216
    s_cmp_lt_u32 s18, 8
    s_cselect_b32 s92, 11, 7
    s_mul_i32 s92, s92, 393216
    s_cmp_lt_u32 s18, 12
    s_cselect_b32 s93, 12, 8
    s_mul_i32 s93, s93, 393216
    s_cmp_lt_u32 s18, 12
    s_cselect_b32 s94, 13, 9
    s_mul_i32 s94, s94, 393216
    s_cmp_lt_u32 s18, 12
    s_cselect_b32 s95, 14, 10
    s_mul_i32 s95, s95, 393216
    s_cmp_lt_u32 s18, 12
    s_cselect_b32 s96, 15, 11
    s_mul_i32 s96, s96, 393216
    s_xor_b32 s97, s18, 1
    s_mul_i32 s97, s97, 393216
    s_xor_b32 s98, s18, 2
    s_mul_i32 s98, s98, 393216
    s_xor_b32 s99, s18, 3
    s_mul_i32 s99, s99, 393216
    v_lshrrev_b32 v24, 4, v1
    v_lshrrev_b32 v25, 3, v24
    v_mul_u32_u24 v16, 2048, v25
    v_and_b32 v26, 2, v25
    v_lshrrev_b32 v25, 2, v25
    v_or_b32 v26, v26, v25
    v_bfe_u32 v25, v24, 1, 2
    v_xor_b32 v26, v26, v25
    v_lshl_add_u32 v16, v26, 5, v16
    v_and_b32 v26, 1, v24
    v_lshl_add_u32 v16, v26, 4, v16
    s_lshl_b32 s3, s18, 7
    v_add_u32 v16, s3, v16
    v_add_u32 v17, 15360, v16
    v_add_u32 v18, 30720, v16
    v_add_u32 v19, 46080, v16
    s_and_b32 s3, s16, 3
    s_mul_i32 s3, s3, 49152
    v_add_u32 v11, s3, v12
    s_and_b32 s3, s16, 3
    s_lshl_b32 s3, s3, 10
    v_add_u32 v9, s3, v1
    v_add_u32 v10, 0x10000, v9
    s_waitcnt vmcnt(0)
    s_barrier
    s_add_u32 m0, s41, 32768
    s_add_u32 s44, s85, 0
    buffer_load_dwordx4 v14, s[8:11], s44 offen offset:0 lds
    buffer_load_dwordx4 v15, s[8:11], s44 offen offset:1024 lds
    s_add_u32 m0, s41, 36864
    s_add_u32 s44, s85, 198656
    buffer_load_dwordx4 v14, s[8:11], s44 offen offset:0 lds
    buffer_load_dwordx4 v15, s[8:11], s44 offen offset:1024 lds
    s_add_u32 m0, s41, 40960
    s_add_u32 s44, s85, 200704
    buffer_load_dwordx4 v14, s[8:11], s44 offen offset:0 lds
    buffer_load_dwordx4 v15, s[8:11], s44 offen offset:1024 lds
    s_add_u32 m0, s41, 45056
    s_add_u32 s44, s85, 196608
    buffer_load_dwordx4 v14, s[8:11], s44 offen offset:0 lds
    buffer_load_dwordx4 v15, s[8:11], s44 offen offset:1024 lds
    s_add_u32 m0, s41, 49152
    s_add_u32 s44, s86, 2048
    buffer_load_dwordx4 v14, s[8:11], s44 offen offset:0 lds
    buffer_load_dwordx4 v15, s[8:11], s44 offen offset:1024 lds
    s_add_u32 m0, s41, 53248
    s_add_u32 s44, s86, 4096
    buffer_load_dwordx4 v14, s[8:11], s44 offen offset:0 lds
    buffer_load_dwordx4 v15, s[8:11], s44 offen offset:1024 lds
    s_add_u32 m0, s41, 57344
    s_add_u32 s44, s86, 0
    buffer_load_dwordx4 v14, s[8:11], s44 offen offset:0 lds
    buffer_load_dwordx4 v15, s[8:11], s44 offen offset:1024 lds
    s_add_u32 m0, s41, 61440
    s_add_u32 s44, s86, 198656
    buffer_load_dwordx4 v14, s[8:11], s44 offen offset:0 lds
    buffer_load_dwordx4 v15, s[8:11], s44 offen offset:1024 lds
    s_waitcnt vmcnt(0)
    s_barrier
    s_add_u32 m0, s41, 65536
    s_add_u32 s44, s86, 200704
    buffer_load_dwordx4 v14, s[8:11], s44 offen offset:0 lds
    buffer_load_dwordx4 v15, s[8:11], s44 offen offset:1024 lds
    s_add_u32 m0, s41, 69632
    s_add_u32 s44, s86, 196608
    buffer_load_dwordx4 v14, s[8:11], s44 offen offset:0 lds
    buffer_load_dwordx4 v15, s[8:11], s44 offen offset:1024 lds
    s_add_u32 m0, s41, 73728
    s_add_u32 s44, s87, 2048
    buffer_load_dwordx4 v14, s[8:11], s44 offen offset:0 lds
    buffer_load_dwordx4 v15, s[8:11], s44 offen offset:1024 lds
    s_add_u32 m0, s41, 77824
    s_add_u32 s44, s87, 4096
    buffer_load_dwordx4 v14, s[8:11], s44 offen offset:0 lds
    buffer_load_dwordx4 v15, s[8:11], s44 offen offset:1024 lds
    s_add_u32 m0, s41, 81920
    s_add_u32 s44, s87, 0
    buffer_load_dwordx4 v14, s[8:11], s44 offen offset:0 lds
    buffer_load_dwordx4 v15, s[8:11], s44 offen offset:1024 lds
    s_add_u32 m0, s41, 86016
    s_add_u32 s44, s87, 198656
    buffer_load_dwordx4 v14, s[8:11], s44 offen offset:0 lds
    buffer_load_dwordx4 v15, s[8:11], s44 offen offset:1024 lds
    s_add_u32 m0, s41, 90112
    s_add_u32 s44, s87, 200704
    buffer_load_dwordx4 v14, s[8:11], s44 offen offset:0 lds
    buffer_load_dwordx4 v15, s[8:11], s44 offen offset:1024 lds
    s_add_u32 m0, s41, 94208
    s_add_u32 s44, s87, 196608
    buffer_load_dwordx4 v14, s[8:11], s44 offen offset:0 lds
    buffer_load_dwordx4 v15, s[8:11], s44 offen offset:1024 lds
    s_add_u32 m0, s41, 98304
    s_add_u32 s44, s88, 2048
    buffer_load_dwordx4 v14, s[8:11], s44 offen offset:0 lds
    buffer_load_dwordx4 v15, s[8:11], s44 offen offset:1024 lds
    s_add_u32 m0, s41, 102400
    s_add_u32 s44, s88, 4096
    buffer_load_dwordx4 v14, s[8:11], s44 offen offset:0 lds
    buffer_load_dwordx4 v15, s[8:11], s44 offen offset:1024 lds
    s_add_u32 m0, s41, 106496
    s_add_u32 s44, s88, 0
    buffer_load_dwordx4 v14, s[8:11], s44 offen offset:0 lds
    buffer_load_dwordx4 v15, s[8:11], s44 offen offset:1024 lds
    s_add_u32 m0, s41, 110592
    s_add_u32 s44, s88, 198656
    buffer_load_dwordx4 v14, s[8:11], s44 offen offset:0 lds
    buffer_load_dwordx4 v15, s[8:11], s44 offen offset:1024 lds
    s_add_u32 m0, s41, 114688
    s_add_u32 s44, s88, 200704
    buffer_load_dwordx4 v14, s[8:11], s44 offen offset:0 lds
    buffer_load_dwordx4 v15, s[8:11], s44 offen offset:1024 lds
    s_add_u32 m0, s41, 118784
    s_add_u32 s44, s88, 196608
    buffer_load_dwordx4 v14, s[8:11], s44 offen offset:0 lds
    buffer_load_dwordx4 v15, s[8:11], s44 offen offset:1024 lds
    s_add_u32 m0, s41, 122880
    s_add_u32 s44, s89, 2048
    buffer_load_dwordx4 v14, s[8:11], s44 offen offset:0 lds
    buffer_load_dwordx4 v15, s[8:11], s44 offen offset:1024 lds
    s_add_u32 m0, s41, 126976
    s_add_u32 s44, s89, 4096
    buffer_load_dwordx4 v14, s[8:11], s44 offen offset:0 lds
    buffer_load_dwordx4 v15, s[8:11], s44 offen offset:1024 lds
    s_add_u32 m0, s41, 0
    s_add_u32 s44, s89, 0
    buffer_load_dwordx4 v14, s[8:11], s44 offen offset:0 lds
    buffer_load_dwordx4 v15, s[8:11], s44 offen offset:1024 lds
    s_add_u32 m0, s41, 4096
    s_add_u32 s44, s89, 198656
    buffer_load_dwordx4 v14, s[8:11], s44 offen offset:0 lds
    buffer_load_dwordx4 v15, s[8:11], s44 offen offset:1024 lds
    s_add_u32 m0, s41, 8192
    s_add_u32 s44, s89, 200704
    buffer_load_dwordx4 v14, s[8:11], s44 offen offset:0 lds
    buffer_load_dwordx4 v15, s[8:11], s44 offen offset:1024 lds
    s_add_u32 m0, s41, 12288
    s_add_u32 s44, s89, 196608
    buffer_load_dwordx4 v14, s[8:11], s44 offen offset:0 lds
    buffer_load_dwordx4 v15, s[8:11], s44 offen offset:1024 lds
    s_waitcnt vmcnt(24)
    s_branch l_join
l_layer:
    s_waitcnt lgkmcnt(0)
    s_barrier
    s_add_u32 m0, s41, 0
    s_add_u32 s44, s89, 0
    buffer_load_dwordx4 v14, s[8:11], s44 offen offset:0 lds
    buffer_load_dwordx4 v15, s[8:11], s44 offen offset:1024 lds
    s_add_u32 m0, s41, 4096
    s_add_u32 s44, s89, 198656
    buffer_load_dwordx4 v14, s[8:11], s44 offen offset:0 lds
    buffer_load_dwordx4 v15, s[8:11], s44 offen offset:1024 lds
    s_add_u32 m0, s41, 8192
    s_add_u32 s44, s89, 200704
    buffer_load_dwordx4 v14, s[8:11], s44 offen offset:0 lds
    buffer_load_dwordx4 v15, s[8:11], s44 offen offset:1024 lds
    s_add_u32 m0, s41, 12288
    s_add_u32 s44, s89, 196608
    buffer_load_dwordx4 v14, s[8:11], s44 offen offset:0 lds
    buffer_load_dwordx4 v15, s[8:11], s44 offen offset:1024 lds
l_join:
    s_barrier
    s_add_u32 m0, s41, 16384
    s_add_u32 s44, s90, 2048
    buffer_load_dwordx4 v14, s[8:11], s44 offen offset:0 lds
    buffer_load_dwordx4 v15, s[8:11], s44 offen offset:1024 lds
    s_add_u32 m0, s41, 20480
    s_add_u32 s44, s90, 4096
    buffer_load_dwordx4 v14, s[8:11], s44 offen offset:0 lds
    buffer_load_dwordx4 v15, s[8:11], s44 offen offset:1024 lds
    s_add_u32 m0, s41, 24576
    s_add_u32 s44, s90, 0
    buffer_load_dwordx4 v14, s[8:11], s44 offen offset:0 lds
    buffer_load_dwordx4 v15, s[8:11], s44 offen offset:1024 lds
    s_add_u32 m0, s41, 28672
    s_add_u32 s44, s90, 198656
    buffer_load_dwordx4 v14, s[8:11], s44 offen offset:0 lds
    buffer_load_dwordx4 v15, s[8:11], s44 offen offset:1024 lds
    s_add_u32 m0, s41, 32768
    s_add_u32 s44, s90, 200704
    buffer_load_dwordx4 v14, s[8:11], s44 offen offset:0 lds
    buffer_load_dwordx4 v15, s[8:11], s44 offen offset:1024 lds
    s_add_u32 m0, s41, 36864
    s_add_u32 s44, s90, 196608
    buffer_load_dwordx4 v14, s[8:11], s44 offen offset:0 lds
    buffer_load_dwordx4 v15, s[8:11], s44 offen offset:1024 lds
    s_add_u32 m0, s41, 40960
    s_add_u32 s44, s91, 2048
    buffer_load_dwordx4 v14, s[8:11], s44 offen offset:0 lds
    buffer_load_dwordx4 v15, s[8:11], s44 offen offset:1024 lds
    s_add_u32 m0, s41, 45056
    s_add_u32 s44, s91, 4096
    buffer_load_dwordx4 v14, s[8:11], s44 offen offset:0 lds
    buffer_load_dwordx4 v15, s[8:11], s44 offen offset:1024 lds
    s_waitcnt vmcnt(24)
    s_barrier
    s_add_u32 m0, s41, 49152
    s_add_u32 s44, s91, 0
    buffer_load_dwordx4 v14, s[8:11], s44 offen offset:0 lds
    buffer_load_dwordx4 v15, s[8:11], s44 offen offset:1024 lds
    s_add_u32 m0, s41, 53248
    s_add_u32 s44, s91, 198656
    buffer_load_dwordx4 v14, s[8:11], s44 offen offset:0 lds
    buffer_load_dwordx4 v15, s[8:11], s44 offen offset:1024 lds
    s_add_u32 m0, s41, 57344
    s_add_u32 s44, s91, 200704
    buffer_load_dwordx4 v14, s[8:11], s44 offen offset:0 lds
    buffer_load_dwordx4 v15, s[8:11], s44 offen offset:1024 lds
    s_add_u32 m0, s41, 61440
    s_add_u32 s44, s91, 196608
    buffer_load_dwordx4 v14, s[8:11], s44 offen offset:0 lds
    buffer_load_dwordx4 v15, s[8:11], s44 offen offset:1024 lds
    s_waitcnt vmcnt(16)
    s_barrier
    s_add_u32 m0, s41, 65536
    s_add_u32 s44, s92, 2048
    buffer_load_dwordx4 v14, s[8:11], s44 offen offset:0 lds
    buffer_load_dwordx4 v15, s[8:11], s44 offen offset:1024 lds
    s_add_u32 m0, s41, 69632
    s_add_u32 s44, s92, 4096
    buffer_load_dwordx4 v14, s[8:11], s44 offen offset:0 lds
    buffer_load_dwordx4 v15, s[8:11], s44 offen offset:1024 lds
    s_add_u32 m0, s41, 73728
    s_add_u32 s44, s92, 0
    buffer_load_dwordx4 v14, s[8:11], s44 offen offset:0 lds
    buffer_load_dwordx4 v15, s[8:11], s44 offen offset:1024 lds
    s_add_u32 m0, s41, 77824
    s_add_u32 s44, s92, 198656
    buffer_load_dwordx4 v14, s[8:11], s44 offen offset:0 lds
    buffer_load_dwordx4 v15, s[8:11], s44 offen offset:1024 lds
    s_add_u32 m0, s41, 81920
    s_add_u32 s44, s92, 200704
    buffer_load_dwordx4 v14, s[8:11], s44 offen offset:0 lds
    buffer_load_dwordx4 v15, s[8:11], s44 offen offset:1024 lds
    s_add_u32 m0, s41, 86016
    s_add_u32 s44, s92, 196608
    buffer_load_dwordx4 v14, s[8:11], s44 offen offset:0 lds
    buffer_load_dwordx4 v15, s[8:11], s44 offen offset:1024 lds
    s_add_u32 m0, s41, 90112
    s_add_u32 s44, s93, 2048
    buffer_load_dwordx4 v14, s[8:11], s44 offen offset:0 lds
    buffer_load_dwordx4 v15, s[8:11], s44 offen offset:1024 lds
    s_add_u32 m0, s41, 94208
    s_add_u32 s44, s93, 4096
    buffer_load_dwordx4 v14, s[8:11], s44 offen offset:0 lds
    buffer_load_dwordx4 v15, s[8:11], s44 offen offset:1024 lds
    s_waitcnt vmcnt(16)
    s_barrier
    s_add_u32 m0, s41, 98304
    s_add_u32 s44, s93, 0
    buffer_load_dwordx4 v14, s[8:11], s44 offen offset:0 lds
    buffer_load_dwordx4 v15, s[8:11], s44 offen offset:1024 lds
    s_add_u32 m0, s41, 102400
    s_add_u32 s44, s93, 198656
    buffer_load_dwordx4 v14, s[8:11], s44 offen offset:0 lds
    buffer_load_dwordx4 v15, s[8:11], s44 offen offset:1024 lds
    s_add_u32 m0, s41, 106496
    s_add_u32 s44, s93, 200704
    buffer_load_dwordx4 v14, s[8:11], s44 offen offset:0 lds
    buffer_load_dwordx4 v15, s[8:11], s44 offen offset:1024 lds
    s_add_u32 m0, s41, 110592
    s_add_u32 s44, s93, 196608
    buffer_load_dwordx4 v14, s[8:11], s44 offen offset:0 lds
    buffer_load_dwordx4 v15, s[8:11], s44 offen offset:1024 lds
    s_add_u32 m0, s41, 114688
    s_add_u32 s44, s94, 2048
    buffer_load_dwordx4 v14, s[8:11], s44 offen offset:0 lds
    buffer_load_dwordx4 v15, s[8:11], s44 offen offset:1024 lds
    s_add_u32 m0, s41, 118784
    s_add_u32 s44, s94, 4096
    buffer_load_dwordx4 v14, s[8:11], s44 offen offset:0 lds
    buffer_load_dwordx4 v15, s[8:11], s44 offen offset:1024 lds
    s_add_u32 m0, s41, 122880
    s_add_u32 s44, s94, 198656
    buffer_load_dwordx4 v14, s[8:11], s44 offen offset:0 lds
    buffer_load_dwordx4 v15, s[8:11], s44 offen offset:1024 lds
    s_add_u32 m0, s41, 126976
    s_add_u32 s44, s94, 200704
    buffer_load_dwordx4 v14, s[8:11], s44 offen offset:0 lds
    buffer_load_dwordx4 v15, s[8:11], s44 offen offset:1024 lds
    s_waitcnt vmcnt(16)
    s_barrier
    s_add_u32 m0, s41, 0
    s_add_u32 s44, s95, 2048
    buffer_load_dwordx4 v14, s[8:11], s44 offen offset:0 lds
    buffer_load_dwordx4 v15, s[8:11], s44 offen offset:1024 lds
    s_add_u32 m0, s41, 4096
    s_add_u32 s44, s95, 4096
    buffer_load_dwordx4 v14, s[8:11], s44 offen offset:0 lds
    buffer_load_dwordx4 v15, s[8:11], s44 offen offset:1024 lds
    s_add_u32 m0, s41, 8192
    s_add_u32 s44, s95, 198656
    buffer_load_dwordx4 v14, s[8:11], s44 offen offset:0 lds
    buffer_load_dwordx4 v15, s[8:11], s44 offen offset:1024 lds
    s_add_u32 m0, s41, 12288
    s_add_u32 s44, s95, 200704
    buffer_load_dwordx4 v14, s[8:11], s44 offen offset:0 lds
    buffer_load_dwordx4 v15, s[8:11], s44 offen offset:1024 lds
    s_add_u32 m0, s41, 16384
    s_add_u32 s44, s96, 2048
    buffer_load_dwordx4 v14, s[8:11], s44 offen offset:0 lds
    buffer_load_dwordx4 v15, s[8:11], s44 offen offset:1024 lds
    s_add_u32 m0, s41, 20480
    s_add_u32 s44, s96, 198656
    buffer_load_dwordx4 v14, s[8:11], s44 offen offset:0 lds
    buffer_load_dwordx4 v15, s[8:11], s44 offen offset:1024 lds
    s_add_u32 m0, s41, 24576
    s_add_u32 s44, s97, 2048
    buffer_load_dwordx4 v14, s[8:11], s44 offen offset:0 lds
    buffer_load_dwordx4 v15, s[8:11], s44 offen offset:1024 lds
    s_add_u32 m0, s41, 28672
    s_add_u32 s44, s97, 198656
    buffer_load_dwordx4 v14, s[8:11], s44 offen offset:0 lds
    buffer_load_dwordx4 v15, s[8:11], s44 offen offset:1024 lds
    s_waitcnt vmcnt(16)
    s_barrier
    s_add_u32 m0, s41, 32768
    s_add_u32 s44, s98, 2048
    buffer_load_dwordx4 v14, s[8:11], s44 offen offset:0 lds
    buffer_load_dwordx4 v15, s[8:11], s44 offen offset:1024 lds
    s_add_u32 m0, s41, 36864
    s_add_u32 s44, s98, 198656
    buffer_load_dwordx4 v14, s[8:11], s44 offen offset:0 lds
    buffer_load_dwordx4 v15, s[8:11], s44 offen offset:1024 lds
    s_add_u32 m0, s41, 40960
    s_add_u32 s44, s99, 2048
    buffer_load_dwordx4 v14, s[8:11], s44 offen offset:0 lds
    buffer_load_dwordx4 v15, s[8:11], s44 offen offset:1024 lds
    s_add_u32 m0, s41, 45056
    s_add_u32 s44, s99, 198656
    buffer_load_dwordx4 v14, s[8:11], s44 offen offset:0 lds
    buffer_load_dwordx4 v15, s[8:11], s44 offen offset:1024 lds
    s_add_u32 m0, s41, 49152
    s_add_u32 s44, s96, 4096
    buffer_load_dwordx4 v14, s[8:11], s44 offen offset:0 lds
    buffer_load_dwordx4 v15, s[8:11], s44 offen offset:1024 lds
    s_add_u32 m0, s41, 53248
    s_add_u32 s44, s96, 200704
    buffer_load_dwordx4 v14, s[8:11], s44 offen offset:0 lds
    buffer_load_dwordx4 v15, s[8:11], s44 offen offset:1024 lds
    s_add_u32 m0, s41, 57344
    s_add_u32 s44, s97, 4096
    buffer_load_dwordx4 v14, s[8:11], s44 offen offset:0 lds
    buffer_load_dwordx4 v15, s[8:11], s44 offen offset:1024 lds
    s_add_u32 m0, s41, 61440
    s_add_u32 s44, s97, 200704
    buffer_load_dwordx4 v14, s[8:11], s44 offen offset:0 lds
    buffer_load_dwordx4 v15, s[8:11], s44 offen offset:1024 lds
    s_waitcnt vmcnt(16)
    s_barrier
    s_add_u32 m0, s41, 65536
    s_add_u32 s44, s98, 4096
    buffer_load_dwordx4 v14, s[8:11], s44 offen offset:0 lds
    buffer_load_dwordx4 v15, s[8:11], s44 offen offset:1024 lds
    s_add_u32 m0, s41, 69632
    s_add_u32 s44, s98, 200704
    buffer_load_dwordx4 v14, s[8:11], s44 offen offset:0 lds
    buffer_load_dwordx4 v15, s[8:11], s44 offen offset:1024 lds
    s_add_u32 m0, s41, 73728
    s_add_u32 s44, s99, 4096
    buffer_load_dwordx4 v14, s[8:11], s44 offen offset:0 lds
    buffer_load_dwordx4 v15, s[8:11], s44 offen offset:1024 lds
    s_add_u32 m0, s41, 77824
    s_add_u32 s44, s99, 200704
    buffer_load_dwordx4 v14, s[8:11], s44 offen offset:0 lds
    buffer_load_dwordx4 v15, s[8:11], s44 offen offset:1024 lds
    s_add_u32 m0, s41, 81920
    s_add_u32 s44, s94, 0
    buffer_load_dwordx4 v14, s[8:11], s44 offen offset:0 lds
    buffer_load_dwordx4 v15, s[8:11], s44 offen offset:1024 lds
    s_add_u32 m0, s41, 86016
    s_add_u32 s44, s94, 196608
    buffer_load_dwordx4 v14, s[8:11], s44 offen offset:0 lds
    buffer_load_dwordx4 v15, s[8:11], s44 offen offset:1024 lds
    s_add_u32 m0, s41, 90112
    s_add_u32 s44, s95, 0
    buffer_load_dwordx4 v14, s[8:11], s44 offen offset:0 lds
    buffer_load_dwordx4 v15, s[8:11], s44 offen offset:1024 lds
    s_add_u32 m0, s41, 94208
    s_add_u32 s44, s95, 196608
    buffer_load_dwordx4 v14, s[8:11], s44 offen offset:0 lds
    buffer_load_dwordx4 v15, s[8:11], s44 offen offset:1024 lds
    s_waitcnt vmcnt(16)
    s_barrier
    s_add_u32 m0, s41, 98304
    s_add_u32 s44, s96, 0
    buffer_load_dwordx4 v14, s[8:11], s44 offen offset:0 lds
    buffer_load_dwordx4 v15, s[8:11], s44 offen offset:1024 lds
    s_add_u32 m0, s41, 102400
    s_add_u32 s44, s96, 196608
    buffer_load_dwordx4 v14, s[8:11], s44 offen offset:0 lds
    buffer_load_dwordx4 v15, s[8:11], s44 offen offset:1024 lds
    s_add_u32 m0, s41, 106496
    s_add_u32 s44, s97, 0
    buffer_load_dwordx4 v14, s[8:11], s44 offen offset:0 lds
    buffer_load_dwordx4 v15, s[8:11], s44 offen offset:1024 lds
    s_add_u32 m0, s41, 110592
    s_add_u32 s44, s97, 196608
    buffer_load_dwordx4 v14, s[8:11], s44 offen offset:0 lds
    buffer_load_dwordx4 v15, s[8:11], s44 offen offset:1024 lds
    s_add_u32 m0, s41, 114688
    s_add_u32 s44, s98, 0
    buffer_load_dwordx4 v14, s[8:11], s44 offen offset:0 lds
    buffer_load_dwordx4 v15, s[8:11], s44 offen offset:1024 lds
    s_add_u32 m0, s41, 118784
    s_add_u32 s44, s98, 196608
    buffer_load_dwordx4 v14, s[8:11], s44 offen offset:0 lds
    buffer_load_dwordx4 v15, s[8:11], s44 offen offset:1024 lds
    s_add_u32 m0, s41, 122880
    s_add_u32 s44, s99, 0
    buffer_load_dwordx4 v14, s[8:11], s44 offen offset:0 lds
    buffer_load_dwordx4 v15, s[8:11], s44 offen offset:1024 lds
    s_add_u32 m0, s41, 126976
    s_add_u32 s44, s99, 196608
    buffer_load_dwordx4 v14, s[8:11], s44 offen offset:0 lds
    buffer_load_dwordx4 v15, s[8:11], s44 offen offset:1024 lds
    s_waitcnt vmcnt(16)
    s_barrier
    v_lshrrev_b32 v28, 4, v1
    v_and_b32 v29, 7, v28
    v_lshrrev_b32 v28, 3, v28
    v_mul_u32_u24 v28, 2048, v28
    v_lshl_add_u32 v28, v29, 4, v28
    s_and_b32 s3, s18, 12
    s_or_b32 s3, s3, 3
    s_lshl_b32 s3, s3, 7
    v_add_u32 v28, s3, v28
    s_lshr_b32 s3, s2, 3
    s_lshl_b32 s3, s3, 2
    s_and_b32 s60, s16, 3
    s_add_u32 s60, s60, s3
    s_lshl_b32 s61, s60, 14
    buffer_load_dwordx4 v[144:147], v28, s[12:15], s61 offen
    s_bitcmp0_b32 s21, 0
    s_cselect_b32 s56, s28, s24
    s_cselect_b32 s57, s29, s25
    s_mov_b32 s58, 6291456
    s_mov_b32 s59, 0x00020000
    v_lshrrev_b32 v28, 4, v1
    v_and_b32 v29, 7, v28
    v_lshrrev_b32 v28, 3, v28
    v_mul_u32_u24 v28, 6144, v28
    v_lshl_add_u32 v28, v29, 4, v28
    s_and_b32 s3, s18, 12
    s_or_b32 s3, s3, 3
    s_lshl_b32 s3, s3, 7
    v_add_u32 v28, s3, v28
    s_lshr_b32 s3, s2, 3
    s_lshl_b32 s3, s3, 2
    s_and_b32 s60, s16, 3
    s_add_u32 s60, s60, s3
    s_and_b32 s3, s60, 31
    s_mul_i32 s3, s3, 49152
    s_lshr_b32 s61, s60, 5
    s_min_u32 s61, s61, 2
    s_lshl_b32 s61, s61, 11
    s_add_u32 s61, s61, s3
    s_cmp_lt_u32 s18, 4
    s_cselect_b32 s3, 1572864, 0
    s_add_u32 s61, s61, s3
    buffer_load_dwordx4 v[148:151], v28, s[56:59], s61 offen
    s_waitcnt vmcnt(2)
    s_cmp_lg_u32 s21, 2
    s_cbranch_scc1 l_pe
    s_bitcmp0_b32 s21, 0
    s_cselect_b32 s56, s28, s24
    s_cselect_b32 s57, s29, s25
    s_mov_b32 s58, 6291456
    s_mov_b32 s59, 0x00020000
    s_add_u32 s61, s84, 2048
    buffer_load_dwordx4 v[160:163], v11, s[56:59], s61 offen
    s_add_u32 s61, s84, 4096
    buffer_load_dwordx4 v[164:167], v11, s[56:59], s61 offen
    s_add_u32 s61, s84, 0
    buffer_load_dwordx4 v[168:171], v11, s[56:59], s61 offen
    s_add_u32 s61, s84, 198656
    buffer_load_dwordx4 v[172:175], v11, s[56:59], s61 offen
    s_add_u32 s61, s84, 200704
    buffer_load_dwordx4 v[176:179], v11, s[56:59], s61 offen
    s_add_u32 s61, s84, 196608
    buffer_load_dwordx4 v[180:183], v11, s[56:59], s61 offen
    s_add_u32 s61, s85, 2048
    buffer_load_dwordx4 v[184:187], v11, s[56:59], s61 offen
    s_add_u32 s61, s85, 4096
    buffer_load_dwordx4 v[188:191], v11, s[56:59], s61 offen
    s_add_u32 s61, s85, 0
    buffer_load_dwordx4 v[192:195], v11, s[56:59], s61 offen
    s_add_u32 s61, s85, 198656
    buffer_load_dwordx4 v[196:199], v11, s[56:59], s61 offen
l_pe:
    s_barrier
    s_bitcmp1_b32 s21, 0
    s_cbranch_scc1 s_B
    s_add_u32 m0, s41, 0
    s_xor_b32 s44, s62, 0
    buffer_load_dwordx4 v16, s[12:15], s44 offen offset:0 lds
    buffer_load_dwordx4 v17, s[12:15], s44 offen offset:1024 lds
    s_add_u32 m0, s41, 4096
    s_xor_b32 s44, s62, 131072
    buffer_load_dwordx4 v16, s[12:15], s44 offen offset:0 lds
    buffer_load_dwordx4 v17, s[12:15], s44 offen offset:1024 lds
    s_add_u32 m0, s41, 8192
    s_xor_b32 s44, s62, 262144
    buffer_load_dwordx4 v16, s[12:15], s44 offen offset:0 lds
    buffer_load_dwordx4 v17, s[12:15], s44 offen offset:1024 lds
    s_add_u32 m0, s41, 12288
    s_xor_b32 s44, s62, 393216
    buffer_load_dwordx4 v16, s[12:15], s44 offen offset:0 lds
    buffer_load_dwordx4 v17, s[12:15], s44 offen offset:1024 lds
    s_add_u32 m0, s41, 16384
    s_xor_b32 s44, s62, 524288
    buffer_load_dwordx4 v16, s[12:15], s44 offen offset:0 lds
    buffer_load_dwordx4 v17, s[12:15], s44 offen offset:1024 lds
    s_add_u32 m0, s41, 20480
    s_xor_b32 s44, s62, 655360
    buffer_load_dwordx4 v16, s[12:15], s44 offen offset:0 lds
    buffer_load_dwordx4 v17, s[12:15], s44 offen offset:1024 lds
    s_add_u32 m0, s41, 24576
    s_xor_b32 s44, s62, 786432
    buffer_load_dwordx4 v16, s[12:15], s44 offen offset:0 lds
    buffer_load_dwordx4 v17, s[12:15], s44 offen offset:1024 lds
    s_add_u32 m0, s41, 28672
    s_xor_b32 s44, s62, 917504
    buffer_load_dwordx4 v16, s[12:15], s44 offen offset:0 lds
    buffer_load_dwordx4 v17, s[12:15], s44 offen offset:1024 lds
    s_add_u32 m0, s41, 32768
    s_xor_b32 s44, s62, 1048576
    buffer_load_dwordx4 v16, s[12:15], s44 offen offset:0 lds
    buffer_load_dwordx4 v17, s[12:15], s44 offen offset:1024 lds
    s_add_u32 m0, s41, 36864
    s_xor_b32 s44, s62, 1179648
    buffer_load_dwordx4 v16, s[12:15], s44 offen offset:0 lds
    buffer_load_dwordx4 v17, s[12:15], s44 offen offset:1024 lds
    s_add_u32 m0, s41, 40960
    s_xor_b32 s44, s62, 1310720
    buffer_load_dwordx4 v16, s[12:15], s44 offen offset:0 lds
    buffer_load_dwordx4 v17, s[12:15], s44 offen offset:1024 lds
    s_add_u32 m0, s41, 45056
    s_xor_b32 s44, s62, 1441792
    buffer_load_dwordx4 v16, s[12:15], s44 offen offset:0 lds
    buffer_load_dwordx4 v17, s[12:15], s44 offen offset:1024 lds
    s_add_u32 m0, s41, 49152
    s_xor_b32 s44, s62, 1572864
    buffer_load_dwordx4 v16, s[12:15], s44 offen offset:0 lds
    buffer_load_dwordx4 v17, s[12:15], s44 offen offset:1024 lds
    s_add_u32 m0, s41, 53248
    s_xor_b32 s44, s62, 1703936
    buffer_load_dwordx4 v16, s[12:15], s44 offen offset:0 lds
    buffer_load_dwordx4 v17, s[12:15], s44 offen offset:1024 lds
    s_add_u32 m0, s41, 57344
    s_xor_b32 s44, s62, 1835008
    buffer_load_dwordx4 v16, s[12:15], s44 offen offset:0 lds
    buffer_load_dwordx4 v17, s[12:15], s44 offen offset:1024 lds
    s_add_u32 m0, s41, 61440
    s_xor_b32 s44, s62, 1966080
    buffer_load_dwordx4 v16, s[12:15], s44 offen offset:0 lds
    buffer_load_dwordx4 v17, s[12:15], s44 offen offset:1024 lds
    s_branch s_tail
h_start:
    v_mov_b32 v20, 0
    v_mov_b32 v21, 0
    v_mov_b32 v22, 0
    v_mov_b32 v23, 0
    s_cmp_lt_u32 s2, 10
    s_cbranch_scc0 h_z0
    s_load_dword s101, s[34:35], 192
    s_lshl_b32 s44, s2, 11
    s_mov_b32 s45, 0
    s_mov_b32 s46, 0
    s_mov_b32 s47, 0
    s_mov_b32 s48, 0
    s_mov_b32 s49, 0
    s_mov_b32 s50, 0
    s_mov_b32 s51, 0
    s_mov_b32 s52, 0
    s_mov_b32 s53, 0
    s_mov_b32 s54, 0
    s_mov_b32 s55, 0
    s_mov_b32 s56, 0
    s_mov_b32 s57, 0
    s_mov_b32 s58, 0
    s_mov_b32 s59, 0
    s_mov_b32 s60, 0
    s_atomic_swap s45, s[22:23], s44 offset:0 glc
    s_atomic_swap s46, s[22:23], s44 offset:128 glc
    s_atomic_swap s47, s[22:23], s44 offset:256 glc
    s_atomic_swap s48, s[22:23], s44 offset:384 glc
    s_atomic_swap s49, s[22:23], s44 offset:512 glc
    s_atomic_swap s50, s[22:23], s44 offset:640 glc
    s_atomic_swap s51, s[22:23], s44 offset:768 glc
    s_atomic_swap s52, s[22:23], s44 offset:896 glc
    s_atomic_swap s53, s[22:23], s44 offset:1024 glc
    s_atomic_swap s54, s[22:23], s44 offset:1152 glc
    s_atomic_swap s55, s[22:23], s44 offset:1280 glc
    s_atomic_swap s56, s[22:23], s44 offset:1408 glc
    s_atomic_swap s57, s[22:23], s44 offset:1536 glc
    s_atomic_swap s58, s[22:23], s44 offset:1664 glc
    s_atomic_swap s59, s[22:23], s44 offset:1792 glc
    s_atomic_swap s60, s[22:23], s44 offset:1920 glc
    s_waitcnt lgkmcnt(0)
    s_atomic_add s40, s[34:35], 0
h_z0:
    v_lshrrev_b32 v24, 4, v1
    v_lshrrev_b32 v25, 3, v24
    v_mul_u32_u24 v12, 6144, v25
    v_and_b32 v26, 2, v25
    v_lshrrev_b32 v25, 2, v25
    v_or_b32 v26, v26, v25
    v_bfe_u32 v25, v24, 1, 2
    v_xor_b32 v26, v26, v25
    v_lshl_add_u32 v12, v26, 5, v12
    v_and_b32 v26, 1, v24
    v_lshl_add_u32 v12, v26, 4, v12
    s_lshl_b32 s3, s18, 7
    v_add_u32 v12, s3, v12
    v_add_u32 v13, 48128, v12
    s_mul_i32 s84, s18, 393216
    s_cmp_lt_u32 s18, 4
    s_cselect_b32 s85, 4, 0
    s_mul_i32 s85, s85, 393216
    s_cmp_lt_u32 s18, 4
    s_cselect_b32 s86, 5, 1
    s_mul_i32 s86, s86, 393216
    s_cmp_lt_u32 s18, 4
    s_cselect_b32 s87, 6, 2
    s_mul_i32 s87, s87, 393216
    s_cmp_lt_u32 s18, 4
    s_cselect_b32 s88, 7, 3
    s_mul_i32 s88, s88, 393216
    s_cmp_lt_u32 s18, 8
    s_cselect_b32 s89, 8, 4
    s_mul_i32 s89, s89, 393216
    s_cmp_lt_u32 s18, 8
    s_cselect_b32 s90, 9, 5
    s_mul_i32 s90, s90, 393216
    s_cmp_lt_u32 s18, 8
    s_cselect_b32 s91, 10, 6
    s_mul_i32 s91, s91, 393216
    s_cmp_lt_u32 s18, 8
    s_cselect_b32 s92, 11, 7
    s_mul_i32 s92, s92, 393216
    s_cmp_lt_u32 s18, 12
    s_cselect_b32 s93, 12, 8
    s_mul_i32 s93, s93, 393216
    s_cmp_lt_u32 s18, 12
    s_cselect_b32 s94, 13, 9
    s_mul_i32 s94, s94, 393216
    s_cmp_lt_u32 s18, 12
    s_cselect_b32 s95, 14, 10
    s_mul_i32 s95, s95, 393216
    s_cmp_lt_u32 s18, 12
    s_cselect_b32 s96, 15, 11
    s_mul_i32 s96, s96, 393216
    s_xor_b32 s97, s18, 1
    s_mul_i32 s97, s97, 393216
    s_xor_b32 s98, s18, 2
    s_mul_i32 s98, s98, 393216
    s_xor_b32 s99, s18, 3
    s_mul_i32 s99, s99, 393216
    v_lshrrev_b32 v24, 4, v1
    v_lshrrev_b32 v25, 3, v24
    v_mul_u32_u24 v16, 2048, v25
    v_and_b32 v26, 2, v25
    v_lshrrev_b32 v25, 2, v25
    v_or_b32 v26, v26, v25
    v_bfe_u32 v25, v24, 1, 2
    v_xor_b32 v26, v26, v25
    v_lshl_add_u32 v16, v26, 5, v16
    v_and_b32 v26, 1, v24
    v_lshl_add_u32 v16, v26, 4, v16
    s_lshl_b32 s3, s18, 7
    v_add_u32 v16, s3, v16
    v_add_u32 v17, 15360, v16
    v_add_u32 v18, 30720, v16
    v_add_u32 v19, 46080, v16
    s_and_b32 s3, s16, 3
    s_mul_i32 s3, s3, 49152
    v_add_u32 v11, s3, v12
    s_and_b32 s3, s16, 3
    s_lshl_b32 s3, s3, 10
    v_add_u32 v9, s3, v1
    v_add_u32 v10, 0x10000, v9
    v_lshrrev_b32 v24, 4, v1
    v_and_b32 v25, 15, v24
    v_lshrrev_b32 v24, 4, v24
    v_lshlrev_b32 v24, 2, v24
    v_sub_u32 v24, v25, v24
    v_mov_b32 v25, 0xf149f2ca
    v_add_u32 v26, 0x0, v24
    v_and_b32 v26, 0xfffffff1, v26
    v_cmp_eq_u32 vcc, 0, v26
    s_nop 1
    v_cndmask_b32 v32, v25, 0, vcc
    v_add_u32 v26, 0xffffffff, v24
    v_and_b32 v26, 0xfffffff1, v26
    v_cmp_eq_u32 vcc, 0, v26
    s_nop 1
    v_cndmask_b32 v33, v25, 0, vcc
    v_add_u32 v26, 0xfffffffe, v24
    v_and_b32 v26, 0xfffffff1, v26
    v_cmp_eq_u32 vcc, 0, v26
    s_nop 1
    v_cndmask_b32 v34, v25, 0, vcc
    v_add_u32 v26, 0xfffffffd, v24
    v_and_b32 v26, 0xfffffff1, v26
    v_cmp_eq_u32 vcc, 0, v26
    s_nop 1
    v_cndmask_b32 v35, v25, 0, vcc
    v_add_u32 v26, 0x10, v24
    v_and_b32 v26, 0xfffffff1, v26
    v_cmp_eq_u32 vcc, 0, v26
    s_nop 1
    v_cndmask_b32 v36, v25, 0, vcc
    v_add_u32 v26, 0xf, v24
    v_and_b32 v26, 0xfffffff1, v26
    v_cmp_eq_u32 vcc, 0, v26
    s_nop 1
    v_cndmask_b32 v37, v25, 0, vcc
    v_add_u32 v26, 0xe, v24
    v_and_b32 v26, 0xfffffff1, v26
    v_cmp_eq_u32 vcc, 0, v26
    s_nop 1
    v_cndmask_b32 v38, v25, 0, vcc
    v_add_u32 v26, 0xd, v24
    v_and_b32 v26, 0xfffffff1, v26
    v_cmp_eq_u32 vcc, 0, v26
    s_nop 1
    v_cndmask_b32 v39, v25, 0, vcc
    v_add_u32 v24, 153600, v1
    ds_write_b128 v24, v[32:35] offset:0
    ds_write_b128 v24, v[36:39] offset:1024
    s_waitcnt lgkmcnt(0)
    s_lshl_b32 s44, s21, 14
    s_lshl_b32 s67, s17, 9
    s_add_u32 s44, s44, s67
    s_add_u32 s44, s44, 4096
    s_barrier
    s_barrier
    s_mov_b32 s66, 0x10000
h_s0_poll:
    s_mov_b32 s68, 0
    s_mov_b32 s69, 0
    s_mov_b32 s70, 0
    s_mov_b32 s71, 0
    s_atomic_add s68, s[22:23], s44 offset:0 glc
    s_atomic_add s69, s[22:23], s44 offset:128 glc
    s_atomic_add s70, s[22:23], s44 offset:256 glc
    s_atomic_add s71, s[22:23], s44 offset:384 glc
    s_sub_u32 s66, s66, 1
    s_cselect_b32 s67, 67372036, 0
    s_waitcnt lgkmcnt(0)
    s_and_b32 s68, s68, s69
    s_and_b32 s68, s68, s70
    s_and_b32 s68, s68, s71
    s_max_u32 s68, s68, s67
    s_cmp_lt_u32 s68, 67372036
    s_cbranch_scc1 h_s0_poll
h_s0_ok:
    s_lshr_b32 s3, s2, 3
    s_cmp_eq_u32 s3, 2
    s_cbranch_scc0 h_g4
    s_barrier
    s_mul_i32 s44, s2, 24576
    s_add_u32 s44, s44, 58347520
    s_mov_b32 s45, 24
h_zloop:
    buffer_store_dwordx4 v[20:23], v1, s[4:7], s44 offen sc1
    s_add_u32 s44, s44, 1024
    s_sub_u32 s45, s45, 1
    s_cmp_lg_u32 s45, 0
    s_cbranch_scc1 h_zloop
    s_branch h_g4b
h_layer:
    s_waitcnt lgkmcnt(0)
    s_barrier
h_g4:
    s_barrier
h_g4b:
    s_lshl_b32 s44, s21, 14
    s_lshl_b32 s67, s17, 9
    s_add_u32 s44, s44, s67
    s_add_u32 s44, s44, 12288
    s_mov_b32 s66, 0x10000
h_s_poll:
    s_mov_b32 s68, 0
    s_mov_b32 s69, 0
    s_mov_b32 s70, 0
    s_mov_b32 s71, 0
    s_atomic_add s68, s[22:23], s44 offset:0 glc
    s_atomic_add s69, s[22:23], s44 offset:128 glc
    s_atomic_add s70, s[22:23], s44 offset:256 glc
    s_atomic_add s71, s[22:23], s44 offset:384 glc
    s_sub_u32 s66, s66, 1
    s_cselect_b32 s67, 16, 0
    s_waitcnt lgkmcnt(0)
    s_and_b32 s68, s68, s69
    s_and_b32 s68, s68, s70
    s_and_b32 s68, s68, s71
    s_max_u32 s68, s68, s67
    s_cmp_lt_u32 s68, 16
    s_cbranch_scc1 h_s_poll
h_s_ok:
    s_barrier
    s_lshl_b32 s44, s21, 18
    s_lshl_b32 s45, s17, 14
    s_add_u32 s44, s44, s45
    s_add_u32 s44, s44, 50331648
    buffer_load_dwordx4 v[32:35], v1, s[4:7], s44 offen offset:0 sc1
    buffer_load_dwordx4 v[36:39], v1, s[4:7], s44 offen offset:1024 sc1
    buffer_load_dwordx4 v[40:43], v1, s[4:7], s44 offen offset:2048 sc1
    buffer_load_dwordx4 v[44:47], v1, s[4:7], s44 offen offset:3072 sc1
    s_add_u32 s44, s44, 4096
    buffer_load_dwordx4 v[48:51], v1, s[4:7], s44 offen offset:0 sc1
    buffer_load_dwordx4 v[52:55], v1, s[4:7], s44 offen offset:1024 sc1
    buffer_load_dwordx4 v[56:59], v1, s[4:7], s44 offen offset:2048 sc1
    buffer_load_dwordx4 v[60:63], v1, s[4:7], s44 offen offset:3072 sc1
    s_add_u32 s44, s44, 4096
    buffer_load_dwordx4 v[64:67], v1, s[4:7], s44 offen offset:0 sc1
    buffer_load_dwordx4 v[68:71], v1, s[4:7], s44 offen offset:1024 sc1
    buffer_load_dwordx4 v[72:75], v1, s[4:7], s44 offen offset:2048 sc1
    buffer_load_dwordx4 v[76:79], v1, s[4:7], s44 offen offset:3072 sc1
    s_add_u32 s44, s44, 4096
    buffer_load_dwordx4 v[80:83], v1, s[4:7], s44 offen offset:0 sc1
    buffer_load_dwordx4 v[84:87], v1, s[4:7], s44 offen offset:1024 sc1
    buffer_load_dwordx4 v[88:91], v1, s[4:7], s44 offen offset:2048 sc1
    buffer_load_dwordx4 v[92:95], v1, s[4:7], s44 offen offset:3072 sc1
    s_barrier
    s_cmp_ge_u32 s21, 2
    s_cbranch_scc1 h_c_ok
    s_lshl_b32 s44, s21, 11
    s_lshl_b32 s67, s18, 7
    s_add_u32 s44, s44, s67
    s_add_u32 s44, s44, 0
    s_mov_b32 s66, 0x10000
h_c_poll:
    s_mov_b32 s68, 0
    s_atomic_add s68, s[22:23], s44 offset:0 glc
    s_sub_u32 s66, s66, 1
    s_cselect_b32 s67, 48, 0
    s_waitcnt lgkmcnt(0)
    s_max_u32 s68, s68, s67
    s_cmp_lt_u32 s68, 48
    s_cbranch_scc1 h_c_poll
h_c_ok:
    s_waitcnt vmcnt(0)
    s_lshl_b32 s3, s21, 8
    s_add_u32 s3, s3, s2
    s_lshr_b32 s3, s3, 3
    s_cmp_eq_u32 s3, 2
    s_cbranch_scc0 h_nf1
    s_atomic_add s40, s[34:35], 128
h_nf1:
    s_barrier
    s_cmp_ge_u32 s21, 2
    s_cbranch_scc1 h_cs1
    s_lshl_b32 s44, s21, 18
    s_lshl_b32 s45, s18, 14
    s_add_u32 s44, s44, s45
    s_add_u32 s44, s44, 52428800
    buffer_load_dwordx4 v[96:99], v1, s[4:7], s44 offen offset:0 sc1
    buffer_load_dwordx4 v[100:103], v1, s[4:7], s44 offen offset:1024 sc1
    buffer_load_dwordx4 v[104:107], v1, s[4:7], s44 offen offset:2048 sc1
    buffer_load_dwordx4 v[108:111], v1, s[4:7], s44 offen offset:3072 sc1
    s_add_u32 s44, s44, 4096
    buffer_load_dwordx4 v[112:115], v1, s[4:7], s44 offen offset:0 sc1
    buffer_load_dwordx4 v[116:119], v1, s[4:7], s44 offen offset:1024 sc1
    buffer_load_dwordx4 v[120:123], v1, s[4:7], s44 offen offset:2048 sc1
    buffer_load_dwordx4 v[124:127], v1, s[4:7], s44 offen offset:3072 sc1
    s_add_u32 s44, s44, 4096
    buffer_load_dwordx4 v[128:131], v1, s[4:7], s44 offen offset:0 sc1
    buffer_load_dwordx4 v[132:135], v1, s[4:7], s44 offen offset:1024 sc1
    buffer_load_dwordx4 v[136:139], v1, s[4:7], s44 offen offset:2048 sc1
    buffer_load_dwordx4 v[140:143], v1, s[4:7], s44 offen offset:3072 sc1
    s_add_u32 s44, s44, 4096
    buffer_load_dwordx4 v[144:147], v1, s[4:7], s44 offen offset:0 sc1
    buffer_load_dwordx4 v[148:151], v1, s[4:7], s44 offen offset:1024 sc1
    buffer_load_dwordx4 v[152:155], v1, s[4:7], s44 offen offset:2048 sc1
    buffer_load_dwordx4 v[156:159], v1, s[4:7], s44 offen offset:3072 sc1
h_cs1:
    v_add_f32 v32, v32, v36
    v_add_f32 v33, v33, v37
    v_add_f32 v34, v34, v38
    v_add_f32 v35, v35, v39
    v_add_f32 v48, v48, v52
    v_add_f32 v49, v49, v53
    v_add_f32 v50, v50, v54
    v_add_f32 v51, v51, v55
    v_add_f32 v64, v64, v68
    v_add_f32 v65, v65, v69
    v_add_f32 v66, v66, v70
    v_add_f32 v67, v67, v71
    v_add_f32 v80, v80, v84
    v_add_f32 v81, v81, v85
    v_add_f32 v82, v82, v86
    v_add_f32 v83, v83, v87
    v_add_f32 v32, v32, v40
    v_add_f32 v33, v33, v41
    v_add_f32 v34, v34, v42
    v_add_f32 v35, v35, v43
    v_add_f32 v48, v48, v56
    v_add_f32 v49, v49, v57
    v_add_f32 v50, v50, v58
    v_add_f32 v51, v51, v59
    v_add_f32 v64, v64, v72
    v_add_f32 v65, v65, v73
    v_add_f32 v66, v66, v74
    v_add_f32 v67, v67, v75
    v_add_f32 v80, v80, v88
    v_add_f32 v81, v81, v89
    v_add_f32 v82, v82, v90
    v_add_f32 v83, v83, v91
    s_barrier
    v_add_f32 v32, v32, v44
    v_add_f32 v33, v33, v45
    v_add_f32 v34, v34, v46
    v_add_f32 v35, v35, v47
    v_add_f32 v48, v48, v60
    v_add_f32 v49, v49, v61
    v_add_f32 v50, v50, v62
    v_add_f32 v51, v51, v63
    v_add_f32 v64, v64, v76
    v_add_f32 v65, v65, v77
    v_add_f32 v66, v66, v78
    v_add_f32 v67, v67, v79
    v_add_f32 v80, v80, v92
    v_add_f32 v81, v81, v93
    v_add_f32 v82, v82, v94
    v_add_f32 v83, v83, v95
    v_permlane32_swap_b32 v32, v64
    v_permlane32_swap_b32 v33, v65
    v_permlane32_swap_b32 v34, v66
    v_permlane32_swap_b32 v35, v67
    v_add_f32 v32, v32, v64
    v_add_f32 v33, v33, v65
    v_add_f32 v34, v34, v66
    v_add_f32 v35, v35, v67
    v_permlane32_swap_b32 v48, v80
    v_permlane32_swap_b32 v49, v81
    v_permlane32_swap_b32 v50, v82
    v_permlane32_swap_b32 v51, v83
    v_add_f32 v48, v48, v80
    v_add_f32 v49, v49, v81
    v_add_f32 v50, v50, v82
    v_add_f32 v51, v51, v83
    v_permlane16_swap_b32 v32, v48
    v_permlane16_swap_b32 v33, v49
    v_permlane16_swap_b32 v34, v50
    v_permlane16_swap_b32 v35, v51
    v_add_f32 v32, v32, v48
    v_add_f32 v33, v33, v49
    v_add_f32 v34, v34, v50
    v_add_f32 v35, v35, v51
    s_barrier
    v_mul_f32 v32, 0x3a800000, v32
    v_mul_f32 v33, 0x3a800000, v33
    v_mul_f32 v34, 0x3a800000, v34
    v_mul_f32 v35, 0x3a800000, v35
    v_fma_f32 v33, -v32, v32, v33
    v_fma_f32 v35, -v34, v34, v35
    v_max_f32 v33, 0, v33
    v_max_f32 v35, 0, v35
    v_add_f32 v33, 0x3727c5ac, v33
    v_add_f32 v35, 0x3727c5ac, v35
    v_rsq_f32 v33, v33
    v_rsq_f32 v35, v35
    v_lshrrev_b32 v26, 1, v1
    v_add_u32 v26, 155648, v26
    ds_write2_b32 v26, v32, v34 offset0:0 offset1:1
    ds_write2_b32 v26, v33, v35 offset0:128 offset1:129
    s_barrier
    s_cmp_ge_u32 s21, 2
    s_cbranch_scc1 h_cs_done
    s_waitcnt vmcnt(0)
    v_add_f32 v96, v96, v100
    v_add_f32 v97, v97, v101
    v_add_f32 v98, v98, v102
    v_add_f32 v99, v99, v103
    v_add_f32 v96, v96, v104
    v_add_f32 v97, v97, v105
    v_add_f32 v98, v98, v106
    v_add_f32 v99, v99, v107
    v_add_f32 v96, v96, v108
    v_add_f32 v97, v97, v109
    v_add_f32 v98, v98, v110
    v_add_f32 v99, v99, v111
    v_add_f32 v96, v96, v112
    v_add_f32 v97, v97, v113
    v_add_f32 v98, v98, v114
    v_add_f32 v99, v99, v115
    v_add_f32 v96, v96, v116
    v_add_f32 v97, v97, v117
    v_add_f32 v98, v98, v118
    v_add_f32 v99, v99, v119
    v_add_f32 v96, v96, v120
    v_add_f32 v97, v97, v121
    v_add_f32 v98, v98, v122
    v_add_f32 v99, v99, v123
    v_add_f32 v96, v96, v124
    v_add_f32 v97, v97, v125
    v_add_f32 v98, v98, v126
    v_add_f32 v99, v99, v127
    v_add_f32 v96, v96, v128
    v_add_f32 v97, v97, v129
    v_add_f32 v98, v98, v130
    v_add_f32 v99, v99, v131
    v_add_f32 v96, v96, v132
    v_add_f32 v97, v97, v133
    v_add_f32 v98, v98, v134
    v_add_f32 v99, v99, v135
    v_add_f32 v96, v96, v136
    v_add_f32 v97, v97, v137
    v_add_f32 v98, v98, v138
    v_add_f32 v99, v99, v139
    v_add_f32 v96, v96, v140
    v_add_f32 v97, v97, v141
    v_add_f32 v98, v98, v142
    v_add_f32 v99, v99, v143
    v_add_f32 v96, v96, v144
    v_add_f32 v97, v97, v145
    v_add_f32 v98, v98, v146
    v_add_f32 v99, v99, v147
    v_add_f32 v96, v96, v148
    v_add_f32 v97, v97, v149
    v_add_f32 v98, v98, v150
    v_add_f32 v99, v99, v151
    v_add_f32 v96, v96, v152
    v_add_f32 v97, v97, v153
    v_add_f32 v98, v98, v154
    v_add_f32 v99, v99, v155
    v_add_f32 v96, v96, v156
    v_add_f32 v97, v97, v157
    v_add_f32 v98, v98, v158
    v_add_f32 v99, v99, v159
    s_lshl_b32 s44, s21, 10
    s_add_u32 s44, s44, 151552
    v_add_u32 v24, s44, v1
    ds_write_b128 v24, v[96:99]
h_cs_done:
    s_waitcnt lgkmcnt(0)
    s_barrier
    s_cmp_lg_u32 s21, 0
    s_cbranch_scc1 h_f1_ok
    s_load_dword s68, s[34:35], 128
    s_mov_b32 s8, s34
    s_mov_b32 s9, s35
    s_mov_b32 s10, 256
    s_mov_b32 s11, 0x00020000
    s_mov_b32 s66, 0x10000
    v_mov_b32 v24, 0
    s_waitcnt lgkmcnt(0)
h_f1:
    s_cmp_eq_u32 s68, 8
    s_cbranch_scc1 h_f1_ok
    buffer_load_dword v25, v24, s[8:11], 0 offen offset:128 sc1
    s_waitcnt vmcnt(0)
    v_readfirstlane_b32 s68, v25
    s_sub_u32 s66, s66, 1
    s_cmp_lg_u32 s66, 0
    s_cbranch_scc1 h_f1
h_f1_ok:
    s_barrier
    s_bitcmp1_b32 s21, 0
    s_cselect_b32 s8, s28, s24
    s_cselect_b32 s9, s29, s25
    s_cselect_b32 s12, s30, s26
    s_cselect_b32 s13, s31, s27
    s_mov_b32 s10, 6291456
    s_mov_b32 s11, 0x00020000
    s_mov_b32 s14, 2097152
    s_mov_b32 s15, 0x00020000
    v_lshrrev_b32 v28, 4, v1
    v_and_b32 v29, 7, v28
    v_lshrrev_b32 v28, 3, v28
    v_mul_u32_u24 v28, 2048, v28
    v_lshl_add_u32 v28, v29, 4, v28
    s_and_b32 s3, s18, 12
    s_or_b32 s3, s3, 3
    s_lshl_b32 s3, s3, 7
    v_add_u32 v28, s3, v28
    s_lshr_b32 s3, s2, 3
    s_lshl_b32 s3, s3, 2
    s_and_b32 s60, s16, 3
    s_add_u32 s60, s60, s3
    s_lshl_b32 s61, s60, 14
    buffer_load_dwordx4 v[144:147], v28, s[12:15], s61 offen
    s_bitcmp0_b32 s21, 0
    s_cselect_b32 s56, s28, s24
    s_cselect_b32 s57, s29, s25
    s_mov_b32 s58, 6291456
    s_mov_b32 s59, 0x00020000
    v_lshrrev_b32 v28, 4, v1
    v_and_b32 v29, 7, v28
    v_lshrrev_b32 v28, 3, v28
    v_mul_u32_u24 v28, 6144, v28
    v_lshl_add_u32 v28, v29, 4, v28
    s_and_b32 s3, s18, 12
    s_or_b32 s3, s3, 3
    s_lshl_b32 s3, s3, 7
    v_add_u32 v28, s3, v28
    s_lshr_b32 s3, s2, 3
    s_lshl_b32 s3, s3, 2
    s_and_b32 s60, s16, 3
    s_add_u32 s60, s60, s3
    s_and_b32 s3, s60, 31
    s_mul_i32 s3, s3, 49152
    s_lshr_b32 s61, s60, 5
    s_min_u32 s61, s61, 2
    s_lshl_b32 s61, s61, 11
    s_add_u32 s61, s61, s3
    s_cmp_lt_u32 s18, 4
    s_cselect_b32 s3, 1572864, 0
    s_add_u32 s61, s61, s3
    buffer_load_dwordx4 v[148:151], v28, s[56:59], s61 offen
    s_cmp_lg_u32 s21, 2
    s_cbranch_scc1 h_pe
    s_bitcmp0_b32 s21, 0
    s_cselect_b32 s56, s28, s24
    s_cselect_b32 s57, s29, s25
    s_mov_b32 s58, 6291456
    s_mov_b32 s59, 0x00020000
    s_add_u32 s61, s84, 2048
    buffer_load_dwordx4 v[160:163], v11, s[56:59], s61 offen
    s_add_u32 s61, s84, 4096
    buffer_load_dwordx4 v[164:167], v11, s[56:59], s61 offen
    s_add_u32 s61, s84, 0
    buffer_load_dwordx4 v[168:171], v11, s[56:59], s61 offen
    s_add_u32 s61, s84, 198656
    buffer_load_dwordx4 v[172:175], v11, s[56:59], s61 offen
    s_add_u32 s61, s84, 200704
    buffer_load_dwordx4 v[176:179], v11, s[56:59], s61 offen
    s_add_u32 s61, s84, 196608
    buffer_load_dwordx4 v[180:183], v11, s[56:59], s61 offen
    s_add_u32 s61, s85, 2048
    buffer_load_dwordx4 v[184:187], v11, s[56:59], s61 offen
    s_add_u32 s61, s85, 4096
    buffer_load_dwordx4 v[188:191], v11, s[56:59], s61 offen
    s_add_u32 s61, s85, 0
    buffer_load_dwordx4 v[192:195], v11, s[56:59], s61 offen
    s_add_u32 s61, s85, 198656
    buffer_load_dwordx4 v[196:199], v11, s[56:59], s61 offen
h_pe:
    s_barrier
    s_branch s_tail
z_start:
    v_lshrrev_b32 v24, 4, v1
    v_lshrrev_b32 v25, 3, v24
    v_mul_u32_u24 v20, 6144, v25
    v_and_b32 v25, 7, v24
    v_lshl_add_u32 v20, v25, 4, v20
    s_add_u32 s3, s18, 2
    s_and_b32 s3, s3, 15
    s_lshl_b32 s3, s3, 7
    s_add_u32 s3, s3, 4096
    v_add_u32 v22, s3, v20
    s_add_u32 s3, s18, 1
    s_and_b32 s3, s3, 15
    s_lshl_b32 s3, s3, 7
    s_add_u32 s3, s3, 2048
    v_add_u32 v21, s3, v20
    s_add_u32 s3, s18, 0
    s_and_b32 s3, s3, 15
    s_lshl_b32 s3, s3, 7
    s_add_u32 s3, s3, 0
    v_add_u32 v20, s3, v20
    s_waitcnt lgkmcnt(0)
    s_mov_b32 s8, s24
    s_mov_b32 s9, s25
    s_mov_b32 s10, 6291456
    s_mov_b32 s11, 0x00020000
    s_mul_i32 s44, s17, 393216
    buffer_load_dwordx4 v[32:35], v20, s[8:11], s44 offen
    buffer_load_dwordx4 v[64:67], v21, s[8:11], s44 offen
    buffer_load_dwordx4 v[96:99], v22, s[8:11], s44 offen
    s_add_u32 s44, s44, 49152
    buffer_load_dwordx4 v[36:39], v20, s[8:11], s44 offen
    buffer_load_dwordx4 v[68:71], v21, s[8:11], s44 offen
    buffer_load_dwordx4 v[100:103], v22, s[8:11], s44 offen
    s_add_u32 s44, s44, 49152
    buffer_load_dwordx4 v[40:43], v20, s[8:11], s44 offen
    buffer_load_dwordx4 v[72:75], v21, s[8:11], s44 offen
    buffer_load_dwordx4 v[104:107], v22, s[8:11], s44 offen
    s_add_u32 s44, s44, 49152
    buffer_load_dwordx4 v[44:47], v20, s[8:11], s44 offen
    buffer_load_dwordx4 v[76:79], v21, s[8:11], s44 offen
    buffer_load_dwordx4 v[108:111], v22, s[8:11], s44 offen
    s_add_u32 s44, s44, 49152
    buffer_load_dwordx4 v[48:51], v20, s[8:11], s44 offen
    buffer_load_dwordx4 v[80:83], v21, s[8:11], s44 offen
    buffer_load_dwordx4 v[112:115], v22, s[8:11], s44 offen
    s_add_u32 s44, s44, 49152
    buffer_load_dwordx4 v[52:55], v20, s[8:11], s44 offen
    buffer_load_dwordx4 v[84:87], v21, s[8:11], s44 offen
    buffer_load_dwordx4 v[116:119], v22, s[8:11], s44 offen
    s_add_u32 s44, s44, 49152
    buffer_load_dwordx4 v[56:59], v20, s[8:11], s44 offen
    buffer_load_dwordx4 v[88:91], v21, s[8:11], s44 offen
    buffer_load_dwordx4 v[120:123], v22, s[8:11], s44 offen
    s_add_u32 s44, s44, 49152
    buffer_load_dwordx4 v[60:63], v20, s[8:11], s44 offen
    buffer_load_dwordx4 v[92:95], v21, s[8:11], s44 offen
    buffer_load_dwordx4 v[124:127], v22, s[8:11], s44 offen
    v_lshrrev_b32 v24, 4, v1
    v_lshrrev_b32 v25, 3, v24
    v_mul_u32_u24 v12, 6144, v25
    v_and_b32 v26, 2, v25
    v_lshrrev_b32 v25, 2, v25
    v_or_b32 v26, v26, v25
    v_bfe_u32 v25, v24, 1, 2
    v_xor_b32 v26, v26, v25
    v_lshl_add_u32 v12, v26, 5, v12
    v_and_b32 v26, 1, v24
    v_lshl_add_u32 v12, v26, 4, v12
    s_lshl_b32 s3, s18, 7
    v_add_u32 v12, s3, v12
    v_add_u32 v13, 48128, v12
    s_mul_i32 s84, s18, 393216
    s_cmp_lt_u32 s18, 4
    s_cselect_b32 s85, 4, 0
    s_mul_i32 s85, s85, 393216
    s_cmp_lt_u32 s18, 4
    s_cselect_b32 s86, 5, 1
    s_mul_i32 s86, s86, 393216
    s_cmp_lt_u32 s18, 4
    s_cselect_b32 s87, 6, 2
    s_mul_i32 s87, s87, 393216
    s_cmp_lt_u32 s18, 4
    s_cselect_b32 s88, 7, 3
    s_mul_i32 s88, s88, 393216
    s_cmp_lt_u32 s18, 8
    s_cselect_b32 s89, 8, 4
    s_mul_i32 s89, s89, 393216
    s_cmp_lt_u32 s18, 8
    s_cselect_b32 s90, 9, 5
    s_mul_i32 s90, s90, 393216
    s_cmp_lt_u32 s18, 8
    s_cselect_b32 s91, 10, 6
    s_mul_i32 s91, s91, 393216
    s_cmp_lt_u32 s18, 8
    s_cselect_b32 s92, 11, 7
    s_mul_i32 s92, s92, 393216
    s_cmp_lt_u32 s18, 12
    s_cselect_b32 s93, 12, 8
    s_mul_i32 s93, s93, 393216
    s_cmp_lt_u32 s18, 12
    s_cselect_b32 s94, 13, 9
    s_mul_i32 s94, s94, 393216
    s_cmp_lt_u32 s18, 12
    s_cselect_b32 s95, 14, 10
    s_mul_i32 s95, s95, 393216
    s_cmp_lt_u32 s18, 12
    s_cselect_b32 s96, 15, 11
    s_mul_i32 s96, s96, 393216
    s_xor_b32 s97, s18, 1
    s_mul_i32 s97, s97, 393216
    s_xor_b32 s98, s18, 2
    s_mul_i32 s98, s98, 393216
    s_xor_b32 s99, s18, 3
    s_mul_i32 s99, s99, 393216
    v_lshrrev_b32 v24, 4, v1
    v_lshrrev_b32 v25, 3, v24
    v_mul_u32_u24 v16, 2048, v25
    v_and_b32 v26, 2, v25
    v_lshrrev_b32 v25, 2, v25
    v_or_b32 v26, v26, v25
    v_bfe_u32 v25, v24, 1, 2
    v_xor_b32 v26, v26, v25
    v_lshl_add_u32 v16, v26, 5, v16
    v_and_b32 v26, 1, v24
    v_lshl_add_u32 v16, v26, 4, v16
    s_lshl_b32 s3, s18, 7
    v_add_u32 v16, s3, v16
    v_add_u32 v17, 15360, v16
    v_add_u32 v18, 30720, v16
    v_add_u32 v19, 46080, v16
    s_and_b32 s3, s16, 3
    s_mul_i32 s3, s3, 49152
    v_add_u32 v11, s3, v12
    s_and_b32 s3, s16, 3
    s_lshl_b32 s3, s3, 10
    v_add_u32 v9, s3, v1
    v_add_u32 v10, 0x10000, v9
    s_barrier
    v_lshrrev_b32 v24, 4, v1
    v_and_b32 v25, 1, v24
    v_lshlrev_b32 v25, 4, v25
    v_mov_b32 v26, 0x3f80
    v_lshlrev_b32 v25, v25, v26
    v_bfe_u32 v26, v24, 1, 2
    v_cmp_eq_u32 vcc, 0, v26
    s_nop 1
    v_cndmask_b32 v140, 0, v25, vcc
    v_cmp_eq_u32 vcc, 1, v26
    s_nop 1
    v_cndmask_b32 v141, 0, v25, vcc
    v_cmp_eq_u32 vcc, 2, v26
    s_nop 1
    v_cndmask_b32 v142, 0, v25, vcc
    v_cmp_eq_u32 vcc, 3, v26
    s_nop 1
    v_cndmask_b32 v143, 0, v25, vcc
    v_bfe_u32 v25, v24, 3, 1
    v_lshrrev_b32 v26, 5, v24
    v_lshl_add_u32 v26, v26, 1, v25
    v_lshlrev_b32 v25, 8, v26
    v_and_b32 v27, 7, v24
    v_lshl_add_u32 v25, v27, 5, v25
    v_bfe_u32 v27, v24, 4, 1
    v_lshl_add_u32 v25, v27, 4, v25
    v_add_u32 v27, s18, v26
    v_and_b32 v27, 15, v27
    v_lshl_add_u32 v25, v27, 14, v25
    s_lshl_b32 s44, s17, 10
    s_add_u32 s44, s44, 52428800
    s_waitcnt vmcnt(21)
    v_mfma_f32_16x16x32_bf16 v[128:131], v[140:143], v[32:35], 0
    v_mfma_f32_16x16x32_bf16 v[132:135], v[140:143], v[64:67], 0
    v_mfma_f32_16x16x32_bf16 v[136:139], v[140:143], v[96:99], 0
    s_waitcnt vmcnt(18)
    v_mfma_f32_16x16x32_bf16 v[128:131], v[140:143], v[36:39], v[128:131]
    v_mfma_f32_16x16x32_bf16 v[132:135], v[140:143], v[68:71], v[132:135]
    v_mfma_f32_16x16x32_bf16 v[136:139], v[140:143], v[100:103], v[136:139]
    s_waitcnt vmcnt(15)
    v_mfma_f32_16x16x32_bf16 v[128:131], v[140:143], v[40:43], v[128:131]
    v_mfma_f32_16x16x32_bf16 v[132:135], v[140:143], v[72:75], v[132:135]
    v_mfma_f32_16x16x32_bf16 v[136:139], v[140:143], v[104:107], v[136:139]
    s_waitcnt vmcnt(12)
    v_mfma_f32_16x16x32_bf16 v[128:131], v[140:143], v[44:47], v[128:131]
    v_mfma_f32_16x16x32_bf16 v[132:135], v[140:143], v[76:79], v[132:135]
    v_mfma_f32_16x16x32_bf16 v[136:139], v[140:143], v[108:111], v[136:139]
    s_waitcnt vmcnt(9)
    v_mfma_f32_16x16x32_bf16 v[128:131], v[140:143], v[48:51], v[128:131]
    v_mfma_f32_16x16x32_bf16 v[132:135], v[140:143], v[80:83], v[132:135]
    v_mfma_f32_16x16x32_bf16 v[136:139], v[140:143], v[112:115], v[136:139]
    s_waitcnt vmcnt(6)
    v_mfma_f32_16x16x32_bf16 v[128:131], v[140:143], v[52:55], v[128:131]
    v_mfma_f32_16x16x32_bf16 v[132:135], v[140:143], v[84:87], v[132:135]
    v_mfma_f32_16x16x32_bf16 v[136:139], v[140:143], v[116:119], v[136:139]
    s_waitcnt vmcnt(3)
    v_mfma_f32_16x16x32_bf16 v[128:131], v[140:143], v[56:59], v[128:131]
    v_mfma_f32_16x16x32_bf16 v[132:135], v[140:143], v[88:91], v[132:135]
    v_mfma_f32_16x16x32_bf16 v[136:139], v[140:143], v[120:123], v[136:139]
    s_waitcnt vmcnt(0)
    v_mfma_f32_16x16x32_bf16 v[128:131], v[140:143], v[60:63], v[128:131]
    v_mfma_f32_16x16x32_bf16 v[132:135], v[140:143], v[92:95], v[132:135]
    v_mfma_f32_16x16x32_bf16 v[136:139], v[140:143], v[124:127], v[136:139]
    s_barrier
    v_lshrrev_b32 v28, 4, v1
    v_and_b32 v29, 7, v28
    v_lshrrev_b32 v28, 3, v28
    v_mul_u32_u24 v28, 6144, v28
    v_lshl_add_u32 v28, v29, 4, v28
    s_and_b32 s3, s18, 12
    s_or_b32 s3, s3, 3
    s_lshl_b32 s3, s3, 7
    v_add_u32 v28, s3, v28
    s_lshr_b32 s3, s2, 3
    s_lshl_b32 s3, s3, 2
    s_and_b32 s60, s16, 3
    s_add_u32 s60, s60, s3
    s_lshr_b32 s60, s60, 2
    s_mul_i32 s60, s60, 49152
    s_cmp_lt_u32 s18, 4
    s_cselect_b32 s3, 0, 1
    s_mul_i32 s3, s3, 1572864
    s_add_u32 s3, s3, s60
    s_add_u32 s61, s3, 0
    buffer_load_dwordx4 v[160:163], v28, s[8:11], s61 offen
    s_add_u32 s61, s3, 2048
    buffer_load_dwordx4 v[164:167], v28, s[8:11], s61 offen
    s_add_u32 s61, s3, 4096
    buffer_load_dwordx4 v[168:171], v28, s[8:11], s61 offen
    s_add_u32 s3, s60, 3145728
    s_add_u32 s61, s3, 0
    buffer_load_dwordx4 v[172:175], v28, s[8:11], s61 offen
    s_add_u32 s61, s3, 2048
    buffer_load_dwordx4 v[176:179], v28, s[8:11], s61 offen
    s_add_u32 s61, s3, 4096
    buffer_load_dwordx4 v[180:183], v28, s[8:11], s61 offen
    s_add_u32 s3, s60, 4718592
    s_add_u32 s61, s3, 0
    buffer_load_dwordx4 v[184:187], v28, s[8:11], s61 offen
    s_add_u32 s61, s3, 2048
    buffer_load_dwordx4 v[188:191], v28, s[8:11], s61 offen
    s_add_u32 s61, s3, 4096
    buffer_load_dwordx4 v[192:195], v28, s[8:11], s61 offen
    v_add_f32_dpp v128, v128, v128 row_ror:8 row_mask:0xf bank_mask:0xf
    v_add_f32_dpp v129, v129, v129 row_ror:8 row_mask:0xf bank_mask:0xf
    v_add_f32_dpp v130, v130, v130 row_ror:8 row_mask:0xf bank_mask:0xf
    v_add_f32_dpp v131, v131, v131 row_ror:8 row_mask:0xf bank_mask:0xf
    v_add_f32_dpp v132, v132, v132 row_ror:8 row_mask:0xf bank_mask:0xf
    v_add_f32_dpp v133, v133, v133 row_ror:8 row_mask:0xf bank_mask:0xf
    v_add_f32_dpp v134, v134, v134 row_ror:8 row_mask:0xf bank_mask:0xf
    v_add_f32_dpp v135, v135, v135 row_ror:8 row_mask:0xf bank_mask:0xf
    v_add_f32_dpp v136, v136, v136 row_ror:8 row_mask:0xf bank_mask:0xf
    v_add_f32_dpp v137, v137, v137 row_ror:8 row_mask:0xf bank_mask:0xf
    v_add_f32_dpp v138, v138, v138 row_ror:8 row_mask:0xf bank_mask:0xf
    v_add_f32_dpp v139, v139, v139 row_ror:8 row_mask:0xf bank_mask:0xf
    v_cmp_le_u32 vcc, 1, v26
    s_nop 1
    v_cndmask_b32 v128, v128, v132, vcc
    v_cndmask_b32 v129, v129, v133, vcc
    v_cndmask_b32 v130, v130, v134, vcc
    v_cndmask_b32 v131, v131, v135, vcc
    v_cmp_le_u32 vcc, 2, v26
    s_nop 1
    v_cndmask_b32 v128, v128, v136, vcc
    v_cndmask_b32 v129, v129, v137, vcc
    v_cndmask_b32 v130, v130, v138, vcc
    v_cndmask_b32 v131, v131, v139, vcc
    buffer_store_dwordx4 v[128:131], v25, s[4:7], s44 offen sc1
    s_barrier
    s_barrier
    s_waitcnt vmcnt(0)
    s_add_u32 s44, s18, 0
    s_and_b32 s44, s44, 15
    s_lshl_b32 s44, s44, 7
    s_add_u32 s44, s44, 0
    s_atomic_add s40, s[22:23], s44
    s_add_u32 s45, s18, 1
    s_and_b32 s45, s45, 15
    s_lshl_b32 s45, s45, 7
    s_add_u32 s45, s45, 0
    s_atomic_add s40, s[22:23], s45
    s_add_u32 s46, s18, 2
    s_and_b32 s46, s46, 15
    s_lshl_b32 s46, s46, 7
    s_add_u32 s46, s46, 0
    s_atomic_add s40, s[22:23], s46
    s_barrier
    s_barrier
    s_barrier
    s_barrier
    s_barrier
    s_barrier
    s_mov_b32 s12, s26
    s_mov_b32 s13, s27
    s_mov_b32 s14, 2097152
    s_mov_b32 s15, 0x00020000
    s_lshl_b32 s44, s2, 13
    buffer_load_dwordx4 v[160:163], v1, s[12:15], s44 offen offset:0
    buffer_load_dwordx4 v[164:167], v1, s[12:15], s44 offen offset:1024
    buffer_load_dwordx4 v[168:171], v1, s[12:15], s44 offen offset:2048
    buffer_load_dwordx4 v[172:175], v1, s[12:15], s44 offen offset:3072
    s_add_u32 s44, s44, 4096
    buffer_load_dwordx4 v[176:179], v1, s[12:15], s44 offen offset:0
    buffer_load_dwordx4 v[180:183], v1, s[12:15], s44 offen offset:1024
    buffer_load_dwordx4 v[184:187], v1, s[12:15], s44 offen offset:2048
    buffer_load_dwordx4 v[188:191], v1, s[12:15], s44 offen offset:3072
    s_mov_b32 s8, s28
    s_mov_b32 s9, s29
    s_mov_b32 s10, 6291456
    s_mov_b32 s11, 0x00020000
    s_mul_i32 s44, s17, 393216
    buffer_load_dwordx4 v[32:35], v20, s[8:11], s44 offen
    buffer_load_dwordx4 v[64:67], v21, s[8:11], s44 offen
    buffer_load_dwordx4 v[96:99], v22, s[8:11], s44 offen
    s_add_u32 s44, s44, 49152
    buffer_load_dwordx4 v[36:39], v20, s[8:11], s44 offen
    buffer_load_dwordx4 v[68:71], v21, s[8:11], s44 offen
    buffer_load_dwordx4 v[100:103], v22, s[8:11], s44 offen
    s_add_u32 s44, s44, 49152
    buffer_load_dwordx4 v[40:43], v20, s[8:11], s44 offen
    buffer_load_dwordx4 v[72:75], v21, s[8:11], s44 offen
    buffer_load_dwordx4 v[104:107], v22, s[8:11], s44 offen
    s_add_u32 s44, s44, 49152
    s_barrier
    buffer_load_dwordx4 v[44:47], v20, s[8:11], s44 offen
    buffer_load_dwordx4 v[76:79], v21, s[8:11], s44 offen
    buffer_load_dwordx4 v[108:111], v22, s[8:11], s44 offen
    s_add_u32 s44, s44, 49152
    buffer_load_dwordx4 v[48:51], v20, s[8:11], s44 offen
    buffer_load_dwordx4 v[80:83], v21, s[8:11], s44 offen
    buffer_load_dwordx4 v[112:115], v22, s[8:11], s44 offen
    s_add_u32 s44, s44, 49152
    buffer_load_dwordx4 v[52:55], v20, s[8:11], s44 offen
    buffer_load_dwordx4 v[84:87], v21, s[8:11], s44 offen
    buffer_load_dwordx4 v[116:119], v22, s[8:11], s44 offen
    s_add_u32 s44, s44, 49152
    buffer_load_dwordx4 v[56:59], v20, s[8:11], s44 offen
    buffer_load_dwordx4 v[88:91], v21, s[8:11], s44 offen
    buffer_load_dwordx4 v[120:123], v22, s[8:11], s44 offen
    s_add_u32 s44, s44, 49152
    buffer_load_dwordx4 v[60:63], v20, s[8:11], s44 offen
    buffer_load_dwordx4 v[92:95], v21, s[8:11], s44 offen
    buffer_load_dwordx4 v[124:127], v22, s[8:11], s44 offen
    s_barrier
    s_bitcmp1_b32 s21, 0
    s_cselect_b32 s8, s28, s24
    s_cselect_b32 s9, s29, s25
    s_cselect_b32 s12, s30, s26
    s_cselect_b32 s13, s31, s27
    s_mov_b32 s10, 6291456
    s_mov_b32 s11, 0x00020000
    s_mov_b32 s14, 2097152
    s_mov_b32 s15, 0x00020000
    s_branch s_tail
z_layer:
    s_waitcnt lgkmcnt(0)
    v_lshrrev_b32 v28, 4, v1
    v_and_b32 v29, 7, v28
    v_lshrrev_b32 v28, 3, v28
    v_mul_u32_u24 v28, 6144, v28
    v_lshl_add_u32 v28, v29, 4, v28
    s_and_b32 s3, s18, 12
    s_or_b32 s3, s3, 3
    s_lshl_b32 s3, s3, 7
    v_add_u32 v28, s3, v28
    s_lshr_b32 s3, s2, 3
    s_lshl_b32 s3, s3, 2
    s_and_b32 s60, s16, 3
    s_add_u32 s60, s60, s3
    s_lshr_b32 s60, s60, 2
    s_mul_i32 s60, s60, 49152
    s_cmp_lt_u32 s18, 4
    s_cselect_b32 s3, 0, 1
    s_mul_i32 s3, s3, 1572864
    s_add_u32 s3, s3, s60
    s_add_u32 s61, s3, 0
    buffer_load_dwordx4 v[160:163], v28, s[8:11], s61 offen
    s_add_u32 s61, s3, 2048
    buffer_load_dwordx4 v[164:167], v28, s[8:11], s61 offen
    s_add_u32 s61, s3, 4096
    buffer_load_dwordx4 v[168:171], v28, s[8:11], s61 offen
    s_add_u32 s3, s60, 3145728
    s_add_u32 s61, s3, 0
    buffer_load_dwordx4 v[172:175], v28, s[8:11], s61 offen
    s_add_u32 s61, s3, 2048
    buffer_load_dwordx4 v[176:179], v28, s[8:11], s61 offen
    s_add_u32 s61, s3, 4096
    buffer_load_dwordx4 v[180:183], v28, s[8:11], s61 offen
    s_add_u32 s3, s60, 4718592
    s_add_u32 s61, s3, 0
    buffer_load_dwordx4 v[184:187], v28, s[8:11], s61 offen
    s_add_u32 s61, s3, 2048
    buffer_load_dwordx4 v[188:191], v28, s[8:11], s61 offen
    s_add_u32 s61, s3, 4096
    buffer_load_dwordx4 v[192:195], v28, s[8:11], s61 offen
    s_barrier
    s_barrier
    s_barrier
    s_barrier
    s_barrier
    s_barrier
    s_barrier
    s_barrier
    s_barrier
    s_barrier
    v_lshrrev_b32 v28, 4, v1
    v_and_b32 v29, 7, v28
    v_lshrrev_b32 v28, 3, v28
    v_mul_u32_u24 v28, 2048, v28
    v_lshl_add_u32 v28, v29, 4, v28
    s_and_b32 s3, s18, 12
    s_or_b32 s3, s3, 3
    s_lshl_b32 s3, s3, 7
    v_add_u32 v28, s3, v28
    s_lshr_b32 s3, s2, 3
    s_lshl_b32 s3, s3, 2
    s_and_b32 s60, s16, 3
    s_add_u32 s60, s60, s3
    s_lshl_b32 s61, s60, 14
    buffer_load_dwordx4 v[144:147], v28, s[12:15], s61 offen
    s_bitcmp0_b32 s21, 0
    s_cselect_b32 s56, s28, s24
    s_cselect_b32 s57, s29, s25
    s_mov_b32 s58, 6291456
    s_mov_b32 s59, 0x00020000
    v_lshrrev_b32 v28, 4, v1
    v_and_b32 v29, 7, v28
    v_lshrrev_b32 v28, 3, v28
    v_mul_u32_u24 v28, 6144, v28
    v_lshl_add_u32 v28, v29, 4, v28
    s_and_b32 s3, s18, 12
    s_or_b32 s3, s3, 3
    s_lshl_b32 s3, s3, 7
    v_add_u32 v28, s3, v28
    s_lshr_b32 s3, s2, 3
    s_lshl_b32 s3, s3, 2
    s_and_b32 s60, s16, 3
    s_add_u32 s60, s60, s3
    s_and_b32 s3, s60, 31
    s_mul_i32 s3, s3, 49152
    s_lshr_b32 s61, s60, 5
    s_min_u32 s61, s61, 2
    s_lshl_b32 s61, s61, 11
    s_add_u32 s61, s61, s3
    s_cmp_lt_u32 s18, 4
    s_cselect_b32 s3, 1572864, 0
    s_add_u32 s61, s61, s3
    buffer_load_dwordx4 v[148:151], v28, s[56:59], s61 offen
    s_cmp_lg_u32 s21, 2
    s_cbranch_scc1 z_pe
    s_bitcmp0_b32 s21, 0
    s_cselect_b32 s56, s28, s24
    s_cselect_b32 s57, s29, s25
    s_mov_b32 s58, 6291456
    s_mov_b32 s59, 0x00020000
    s_add_u32 s61, s84, 2048
    buffer_load_dwordx4 v[160:163], v11, s[56:59], s61 offen
    s_add_u32 s61, s84, 4096
    buffer_load_dwordx4 v[164:167], v11, s[56:59], s61 offen
    s_add_u32 s61, s84, 0
    buffer_load_dwordx4 v[168:171], v11, s[56:59], s61 offen
    s_add_u32 s61, s84, 198656
    buffer_load_dwordx4 v[172:175], v11, s[56:59], s61 offen
    s_add_u32 s61, s84, 200704
    buffer_load_dwordx4 v[176:179], v11, s[56:59], s61 offen
    s_add_u32 s61, s84, 196608
    buffer_load_dwordx4 v[180:183], v11, s[56:59], s61 offen
    s_add_u32 s61, s85, 2048
    buffer_load_dwordx4 v[184:187], v11, s[56:59], s61 offen
    s_add_u32 s61, s85, 4096
    buffer_load_dwordx4 v[188:191], v11, s[56:59], s61 offen
    s_add_u32 s61, s85, 0
    buffer_load_dwordx4 v[192:195], v11, s[56:59], s61 offen
    s_add_u32 s61, s85, 198656
    buffer_load_dwordx4 v[196:199], v11, s[56:59], s61 offen
z_pe:
    s_barrier
    s_branch s_tail
s_tail:
    s_bitcmp1_b32 s21, 0
    s_cbranch_scc1 s_B
    s_cmp_lg_u32 s16, 4
    s_cbranch_scc1 s_a1
    s_mov_b32 s45, 2146435072
    s_cmp_eq_u32 s17, 0
    s_cbranch_scc1 s_a0
    s_lshr_b32 s46, s21, 1
    s_lshl_b32 s44, s46, 15
    s_lshl_b32 s67, s17, 11
    s_add_u32 s44, s44, s67
    s_lshl_b32 s67, s18, 7
    s_add_u32 s44, s44, s67
    s_add_u32 s44, s44, 149504
    s_sub_u32 s45, s44, 151552
    s_lshl_b32 s45, s45, 5
    s_add_u32 s45, s45, 54525952
    s_mov_b32 s66, 0x10000
s_h_poll:
    s_mov_b32 s68, 0
    s_atomic_add s68, s[22:23], s44 offset:0 glc
    s_sub_u32 s66, s66, 1
    s_cselect_b32 s67, 1, 0
    s_waitcnt lgkmcnt(0)
    s_max_u32 s68, s68, s67
    s_cmp_lt_u32 s68, 1
    s_cbranch_scc1 s_h_poll
s_h_ok:
s_a0:
    s_mov_b32 m0, 131072
    s_nop 0
    buffer_load_dwordx4 v1, s[4:7], s45 offen offset:0 sc1 lds
    buffer_load_dwordx4 v1, s[4:7], s45 offen offset:1024 sc1 lds
    buffer_load_dwordx4 v1, s[4:7], s45 offen offset:2048 sc1 lds
    buffer_load_dwordx4 v1, s[4:7], s45 offen offset:3072 sc1 lds
    s_waitcnt vmcnt(0)
s_a1:
    s_barrier
    s_waitcnt vmcnt(0)
    s_barrier
    s_sub_u32 s3, s16, 5
    s_cmp_gt_u32 s3, 1
    s_cbranch_scc1 s_a2
    s_add_u32 m0, s41, 65536
    s_xor_b32 s44, s62, 65536
    buffer_load_dwordx4 v16, s[12:15], s44 offen offset:0 lds
    buffer_load_dwordx4 v17, s[12:15], s44 offen offset:1024 lds
    s_add_u32 m0, s41, 69632
    s_xor_b32 s44, s62, 196608
    buffer_load_dwordx4 v16, s[12:15], s44 offen offset:0 lds
    buffer_load_dwordx4 v17, s[12:15], s44 offen offset:1024 lds
    s_add_u32 m0, s41, 73728
    s_xor_b32 s44, s62, 327680
    buffer_load_dwordx4 v16, s[12:15], s44 offen offset:0 lds
    buffer_load_dwordx4 v17, s[12:15], s44 offen offset:1024 lds
    s_add_u32 m0, s41, 77824
    s_xor_b32 s44, s62, 458752
    buffer_load_dwordx4 v16, s[12:15], s44 offen offset:0 lds
    buffer_load_dwordx4 v17, s[12:15], s44 offen offset:1024 lds
    s_add_u32 m0, s41, 81920
    s_xor_b32 s44, s62, 589824
    buffer_load_dwordx4 v16, s[12:15], s44 offen offset:0 lds
    buffer_load_dwordx4 v17, s[12:15], s44 offen offset:1024 lds
    s_add_u32 m0, s41, 86016
    s_xor_b32 s44, s62, 720896
    buffer_load_dwordx4 v16, s[12:15], s44 offen offset:0 lds
    buffer_load_dwordx4 v17, s[12:15], s44 offen offset:1024 lds
    s_add_u32 m0, s41, 90112
    s_xor_b32 s44, s62, 851968
    buffer_load_dwordx4 v16, s[12:15], s44 offen offset:0 lds
    buffer_load_dwordx4 v17, s[12:15], s44 offen offset:1024 lds
    s_add_u32 m0, s41, 94208
    s_xor_b32 s44, s62, 983040
    buffer_load_dwordx4 v16, s[12:15], s44 offen offset:0 lds
    buffer_load_dwordx4 v17, s[12:15], s44 offen offset:1024 lds
    s_add_u32 m0, s41, 98304
    s_xor_b32 s44, s62, 1114112
    buffer_load_dwordx4 v16, s[12:15], s44 offen offset:0 lds
    buffer_load_dwordx4 v17, s[12:15], s44 offen offset:1024 lds
    s_add_u32 m0, s41, 102400
    s_xor_b32 s44, s62, 1245184
    buffer_load_dwordx4 v16, s[12:15], s44 offen offset:0 lds
    buffer_load_dwordx4 v17, s[12:15], s44 offen offset:1024 lds
    s_add_u32 m0, s41, 106496
    s_xor_b32 s44, s62, 1376256
    buffer_load_dwordx4 v16, s[12:15], s44 offen offset:0 lds
    buffer_load_dwordx4 v17, s[12:15], s44 offen offset:1024 lds
    s_add_u32 m0, s41, 110592
    s_xor_b32 s44, s62, 1507328
    buffer_load_dwordx4 v16, s[12:15], s44 offen offset:0 lds
    buffer_load_dwordx4 v17, s[12:15], s44 offen offset:1024 lds
    s_add_u32 m0, s41, 114688
    s_xor_b32 s44, s62, 1638400
    buffer_load_dwordx4 v16, s[12:15], s44 offen offset:0 lds
    buffer_load_dwordx4 v17, s[12:15], s44 offen offset:1024 lds
    s_add_u32 m0, s41, 118784
    s_xor_b32 s44, s62, 1769472
    buffer_load_dwordx4 v16, s[12:15], s44 offen offset:0 lds
    buffer_load_dwordx4 v17, s[12:15], s44 offen offset:1024 lds
    s_add_u32 m0, s41, 122880
    s_xor_b32 s44, s62, 1900544
    buffer_load_dwordx4 v16, s[12:15], s44 offen offset:0 lds
    buffer_load_dwordx4 v17, s[12:15], s44 offen offset:1024 lds
    s_add_u32 m0, s41, 126976
    s_xor_b32 s44, s62, 2031616
    buffer_load_dwordx4 v16, s[12:15], s44 offen offset:0 lds
    buffer_load_dwordx4 v17, s[12:15], s44 offen offset:1024 lds
s_a2:
    s_cmp_eq_u32 s21, 2
    s_cbranch_scc1 s_a3
    s_bitcmp0_b32 s21, 0
    s_cselect_b32 s56, s28, s24
    s_cselect_b32 s57, s29, s25
    s_mov_b32 s58, 6291456
    s_mov_b32 s59, 0x00020000
    s_add_u32 s61, s84, 2048
    buffer_load_dwordx4 v[160:163], v11, s[56:59], s61 offen
    s_add_u32 s61, s84, 4096
    buffer_load_dwordx4 v[164:167], v11, s[56:59], s61 offen
    s_add_u32 s61, s84, 0
    buffer_load_dwordx4 v[168:171], v11, s[56:59], s61 offen
    s_add_u32 s61, s84, 198656
    buffer_load_dwordx4 v[172:175], v11, s[56:59], s61 offen
    s_add_u32 s61, s84, 200704
    buffer_load_dwordx4 v[176:179], v11, s[56:59], s61 offen
    s_add_u32 s61, s84, 196608
    buffer_load_dwordx4 v[180:183], v11, s[56:59], s61 offen
    s_add_u32 s61, s85, 2048
    buffer_load_dwordx4 v[184:187], v11, s[56:59], s61 offen
    s_add_u32 s61, s85, 4096
    buffer_load_dwordx4 v[188:191], v11, s[56:59], s61 offen
    s_add_u32 s61, s85, 0
    buffer_load_dwordx4 v[192:195], v11, s[56:59], s61 offen
    s_add_u32 s61, s85, 198656
    buffer_load_dwordx4 v[196:199], v11, s[56:59], s61 offen
s_a3:
    s_bitcmp0_b32 s21, 0
    s_cselect_b32 s56, s28, s24
    s_cselect_b32 s57, s29, s25
    s_mov_b32 s58, 6291456
    s_mov_b32 s59, 0x00020000
    s_add_u32 s61, s85, 200704
    buffer_load_dwordx4 v[200:203], v11, s[56:59], s61 offen
    s_add_u32 s61, s85, 196608
    buffer_load_dwordx4 v[204:207], v11, s[56:59], s61 offen
    s_add_u32 s61, s86, 2048
    buffer_load_dwordx4 v[208:211], v11, s[56:59], s61 offen
    s_add_u32 s61, s86, 4096
    buffer_load_dwordx4 v[212:215], v11, s[56:59], s61 offen
    s_add_u32 s61, s86, 0
    buffer_load_dwordx4 v[216:219], v11, s[56:59], s61 offen
    s_add_u32 s61, s86, 198656
    buffer_load_dwordx4 v[220:223], v11, s[56:59], s61 offen
    s_add_u32 s61, s86, 200704
    buffer_load_dwordx4 v[224:227], v11, s[56:59], s61 offen
    s_add_u32 s61, s86, 196608
    buffer_load_dwordx4 v[228:231], v11, s[56:59], s61 offen
    s_add_u32 s61, s87, 2048
    buffer_load_dwordx4 v[232:235], v11, s[56:59], s61 offen
    s_add_u32 s61, s87, 4096
    buffer_load_dwordx4 v[236:239], v11, s[56:59], s61 offen
    s_add_u32 s61, s87, 0
    buffer_load_dwordx4 v[240:243], v11, s[56:59], s61 offen
    s_add_u32 s61, s87, 198656
    buffer_load_dwordx4 v[244:247], v11, s[56:59], s61 offen
    s_add_u32 s61, s87, 200704
    buffer_load_dwordx4 v[248:251], v11, s[56:59], s61 offen
    s_add_u32 s61, s87, 196608
    buffer_load_dwordx4 v[252:255], v11, s[56:59], s61 offen
    s_waitcnt vmcnt(0)
    s_lshl_b32 s3, s21, 3
    s_add_u32 s3, s3, s16
    s_cmp_lg_u32 s3, 7
    s_cbranch_scc1 s_g3
    v_lshrrev_b32 v24, 4, v1
    v_and_b32 v25, 1, v24
    v_lshlrev_b32 v25, 4, v25
    v_mov_b32 v26, 0x3f80
    v_lshlrev_b32 v25, v25, v26
    v_bfe_u32 v26, v24, 1, 2
    v_cmp_eq_u32 vcc, 0, v26
    s_nop 1
    v_cndmask_b32 v140, 0, v25, vcc
    v_cmp_eq_u32 vcc, 1, v26
    s_nop 1
    v_cndmask_b32 v141, 0, v25, vcc
    v_cmp_eq_u32 vcc, 2, v26
    s_nop 1
    v_cndmask_b32 v142, 0, v25, vcc
    v_cmp_eq_u32 vcc, 3, v26
    s_nop 1
    v_cndmask_b32 v143, 0, v25, vcc
    v_bfe_u32 v25, v24, 3, 1
    v_lshrrev_b32 v26, 5, v24
    v_lshl_add_u32 v26, v26, 1, v25
    v_lshlrev_b32 v25, 8, v26
    v_and_b32 v27, 7, v24
    v_lshl_add_u32 v25, v27, 5, v25
    v_bfe_u32 v27, v24, 4, 1
    v_lshl_add_u32 v25, v27, 4, v25
    v_add_u32 v27, s18, v26
    v_and_b32 v27, 15, v27
    v_lshl_add_u32 v25, v27, 14, v25
    s_lshl_b32 s44, s17, 10
    s_add_u32 s44, s44, 52690944
    v_mfma_f32_16x16x32_bf16 v[128:131], v[140:143], v[32:35], 0
    v_mfma_f32_16x16x32_bf16 v[132:135], v[140:143], v[64:67], 0
    v_mfma_f32_16x16x32_bf16 v[136:139], v[140:143], v[96:99], 0
    v_mfma_f32_16x16x32_bf16 v[128:131], v[140:143], v[36:39], v[128:131]
    v_mfma_f32_16x16x32_bf16 v[132:135], v[140:143], v[68:71], v[132:135]
    v_mfma_f32_16x16x32_bf16 v[136:139], v[140:143], v[100:103], v[136:139]
    v_mfma_f32_16x16x32_bf16 v[128:131], v[140:143], v[40:43], v[128:131]
    v_mfma_f32_16x16x32_bf16 v[132:135], v[140:143], v[72:75], v[132:135]
    v_mfma_f32_16x16x32_bf16 v[136:139], v[140:143], v[104:107], v[136:139]
    v_mfma_f32_16x16x32_bf16 v[128:131], v[140:143], v[44:47], v[128:131]
    v_mfma_f32_16x16x32_bf16 v[132:135], v[140:143], v[76:79], v[132:135]
    v_mfma_f32_16x16x32_bf16 v[136:139], v[140:143], v[108:111], v[136:139]
    v_mfma_f32_16x16x32_bf16 v[128:131], v[140:143], v[48:51], v[128:131]
    v_mfma_f32_16x16x32_bf16 v[132:135], v[140:143], v[80:83], v[132:135]
    v_mfma_f32_16x16x32_bf16 v[136:139], v[140:143], v[112:115], v[136:139]
    v_mfma_f32_16x16x32_bf16 v[128:131], v[140:143], v[52:55], v[128:131]
    v_mfma_f32_16x16x32_bf16 v[132:135], v[140:143], v[84:87], v[132:135]
    v_mfma_f32_16x16x32_bf16 v[136:139], v[140:143], v[116:119], v[136:139]
    v_mfma_f32_16x16x32_bf16 v[128:131], v[140:143], v[56:59], v[128:131]
    v_mfma_f32_16x16x32_bf16 v[132:135], v[140:143], v[88:91], v[132:135]
    v_mfma_f32_16x16x32_bf16 v[136:139], v[140:143], v[120:123], v[136:139]
    v_mfma_f32_16x16x32_bf16 v[128:131], v[140:143], v[60:63], v[128:131]
    v_mfma_f32_16x16x32_bf16 v[132:135], v[140:143], v[92:95], v[132:135]
    v_mfma_f32_16x16x32_bf16 v[136:139], v[140:143], v[124:127], v[136:139]
    s_nop 5
    v_add_f32_dpp v128, v128, v128 row_ror:8 row_mask:0xf bank_mask:0xf
    v_add_f32_dpp v129, v129, v129 row_ror:8 row_mask:0xf bank_mask:0xf
    v_add_f32_dpp v130, v130, v130 row_ror:8 row_mask:0xf bank_mask:0xf
    v_add_f32_dpp v131, v131, v131 row_ror:8 row_mask:0xf bank_mask:0xf
    v_add_f32_dpp v132, v132, v132 row_ror:8 row_mask:0xf bank_mask:0xf
    v_add_f32_dpp v133, v133, v133 row_ror:8 row_mask:0xf bank_mask:0xf
    v_add_f32_dpp v134, v134, v134 row_ror:8 row_mask:0xf bank_mask:0xf
    v_add_f32_dpp v135, v135, v135 row_ror:8 row_mask:0xf bank_mask:0xf
    v_add_f32_dpp v136, v136, v136 row_ror:8 row_mask:0xf bank_mask:0xf
    v_add_f32_dpp v137, v137, v137 row_ror:8 row_mask:0xf bank_mask:0xf
    v_add_f32_dpp v138, v138, v138 row_ror:8 row_mask:0xf bank_mask:0xf
    v_add_f32_dpp v139, v139, v139 row_ror:8 row_mask:0xf bank_mask:0xf
    v_cmp_le_u32 vcc, 1, v26
    s_nop 1
    v_cndmask_b32 v128, v128, v132, vcc
    v_cndmask_b32 v129, v129, v133, vcc
    v_cndmask_b32 v130, v130, v134, vcc
    v_cndmask_b32 v131, v131, v135, vcc
    v_cmp_le_u32 vcc, 2, v26
    s_nop 1
    v_cndmask_b32 v128, v128, v136, vcc
    v_cndmask_b32 v129, v129, v137, vcc
    v_cndmask_b32 v130, v130, v138, vcc
    v_cndmask_b32 v131, v131, v139, vcc
    buffer_store_dwordx4 v[128:131], v25, s[4:7], s44 offen sc1
    s_waitcnt vmcnt(0)
    s_add_u32 s44, s18, 0
    s_and_b32 s44, s44, 15
    s_lshl_b32 s44, s44, 7
    s_add_u32 s44, s44, 2048
    s_atomic_add s40, s[22:23], s44
    s_add_u32 s45, s18, 1
    s_and_b32 s45, s45, 15
    s_lshl_b32 s45, s45, 7
    s_add_u32 s45, s45, 2048
    s_atomic_add s40, s[22:23], s45
    s_add_u32 s46, s18, 2
    s_and_b32 s46, s46, 15
    s_lshl_b32 s46, s46, 7
    s_add_u32 s46, s46, 2048
    s_atomic_add s40, s[22:23], s46
    s_branch s_g3
s_B:
    s_barrier
    s_cmp_eq_u32 s21, 3
    s_cbranch_scc1 s_nopf
    s_bitcmp0_b32 s21, 0
    s_cselect_b32 s56, s28, s24
    s_cselect_b32 s57, s29, s25
    s_mov_b32 s58, 6291456
    s_mov_b32 s59, 0x00020000
    s_add_u32 s61, s84, 2048
    buffer_load_dwordx4 v[160:163], v11, s[56:59], s61 offen
    s_add_u32 s61, s84, 4096
    buffer_load_dwordx4 v[164:167], v11, s[56:59], s61 offen
    s_add_u32 s61, s84, 0
    buffer_load_dwordx4 v[168:171], v11, s[56:59], s61 offen
    s_add_u32 s61, s84, 198656
    buffer_load_dwordx4 v[172:175], v11, s[56:59], s61 offen
    s_waitcnt vmcnt(2)
    s_add_u32 s61, s84, 200704
    buffer_load_dwordx4 v[176:179], v11, s[56:59], s61 offen
    s_add_u32 s61, s84, 196608
    buffer_load_dwordx4 v[180:183], v11, s[56:59], s61 offen
    s_add_u32 s61, s85, 2048
    buffer_load_dwordx4 v[184:187], v11, s[56:59], s61 offen
    s_add_u32 s61, s85, 4096
    buffer_load_dwordx4 v[188:191], v11, s[56:59], s61 offen
    s_waitcnt vmcnt(2)
    s_add_u32 s61, s85, 0
    buffer_load_dwordx4 v[192:195], v11, s[56:59], s61 offen
    s_add_u32 s61, s85, 198656
    buffer_load_dwordx4 v[196:199], v11, s[56:59], s61 offen
    s_add_u32 s61, s85, 200704
    buffer_load_dwordx4 v[200:203], v11, s[56:59], s61 offen
    s_add_u32 s61, s85, 196608
    buffer_load_dwordx4 v[204:207], v11, s[56:59], s61 offen
    s_waitcnt vmcnt(2)
    s_add_u32 s61, s86, 2048
    buffer_load_dwordx4 v[208:211], v11, s[56:59], s61 offen
    s_add_u32 s61, s86, 4096
    buffer_load_dwordx4 v[212:215], v11, s[56:59], s61 offen
    s_add_u32 s61, s86, 0
    buffer_load_dwordx4 v[216:219], v11, s[56:59], s61 offen
    s_add_u32 s61, s86, 198656
    buffer_load_dwordx4 v[220:223], v11, s[56:59], s61 offen
    s_waitcnt vmcnt(2)
    s_add_u32 s61, s86, 200704
    buffer_load_dwordx4 v[224:227], v11, s[56:59], s61 offen
    s_add_u32 s61, s86, 196608
    buffer_load_dwordx4 v[228:231], v11, s[56:59], s61 offen
    s_add_u32 s61, s87, 2048
    buffer_load_dwordx4 v[232:235], v11, s[56:59], s61 offen
    s_add_u32 s61, s87, 4096
    buffer_load_dwordx4 v[236:239], v11, s[56:59], s61 offen
    s_waitcnt vmcnt(2)
    s_add_u32 s61, s87, 0
    buffer_load_dwordx4 v[240:243], v11, s[56:59], s61 offen
    s_add_u32 s61, s87, 198656
    buffer_load_dwordx4 v[244:247], v11, s[56:59], s61 offen
    s_add_u32 s61, s87, 200704
    buffer_load_dwordx4 v[248:251], v11, s[56:59], s61 offen
    s_add_u32 s61, s87, 196608
    buffer_load_dwordx4 v[252:255], v11, s[56:59], s61 offen
    s_waitcnt vmcnt(2)
    s_lshl_b32 s3, s2, 2
    s_and_b32 s60, s16, 3
    s_add_u32 s60, s60, s3
    s_lshl_b32 s60, s60, 11
    buffer_load_dwordx4 v[96:99], v1, s[12:15], s60 offen offset:0
    buffer_load_dwordx4 v[100:103], v1, s[12:15], s60 offen offset:1024
s_nopf:
    s_setprio 3
    s_mov_b32 s52, 0
    s_lshl_b32 s44, s16, 14
    v_add_u32 v24, s44, v1
    s_and_b32 s3, s16, 3
    s_lshl_b32 s44, s3, 10
    s_add_u32 s44, s44, 147456
    v_lshrrev_b32 v25, 2, v1
    v_add_u32 v25, s44, v25
    s_lshl_b32 s53, s21, 22
    s_lshl_b32 s44, s38, 16
    s_add_u32 s53, s53, s44
    s_lshl_b32 s44, s18, 12
    s_add_u32 s53, s53, s44
    s_add_u32 s53, s53, 16777216
    s_lshl_b32 s54, s21, 14
    s_lshl_b32 s67, s38, 8
    s_add_u32 s54, s54, s67
    s_add_u32 s54, s54, 86016
s_bhead:
    s_barrier
    s_waitcnt vmcnt(0) lgkmcnt(0)
    s_barrier
    ds_read_b32 v28, v25 offset:0
    ds_read_b32 v29, v25 offset:256
    ds_read_b32 v30, v25 offset:512
    ds_read_b32 v31, v25 offset:768
    ds_read_b128 v[32:35], v24 offset:0
    ds_read_b128 v[36:39], v24 offset:1024
    ds_read_b128 v[40:43], v24 offset:2048
    ds_read_b128 v[44:47], v24 offset:3072
    ds_read_b128 v[48:51], v24 offset:4096
    ds_read_b128 v[52:55], v24 offset:5120
    ds_read_b128 v[56:59], v24 offset:6144
    ds_read_b128 v[60:63], v24 offset:7168
    ds_read_b128 v[64:67], v24 offset:8192
    ds_read_b128 v[68:71], v24 offset:9216
    ds_read_b128 v[72:75], v24 offset:10240
    ds_read_b128 v[76:79], v24 offset:11264
    ds_read_b128 v[80:83], v24 offset:12288
    ds_read_b128 v[84:87], v24 offset:13312
    ds_read_b128 v[88:91], v24 offset:14336
    ds_read_b128 v[92:95], v24 offset:15360
    s_waitcnt lgkmcnt(14)
    v_add_f32 v28, v28, v29
    v_add_f32 v30, v30, v31
    v_add_f32 v28, v28, v30
    v_mov_b32 v29, 0x5d800000
    v_mov_b32 v30, 0x21800000
    v_cmp_nlt_f32 s[44:45], v28, v29
    v_cmp_ngt_f32 vcc, v28, v30
    v_rcp_f32 v28, v28
    s_or_b64 vcc, vcc, s[44:45]
    s_waitcnt lgkmcnt(8)
    v_pk_add_f32 v[32:33], v[32:33], v[48:49]
    v_pk_add_f32 v[34:35], v[34:35], v[50:51]
    v_pk_add_f32 v[36:37], v[36:37], v[52:53]
    v_pk_add_f32 v[38:39], v[38:39], v[54:55]
    v_pk_add_f32 v[40:41], v[40:41], v[56:57]
    v_pk_add_f32 v[42:43], v[42:43], v[58:59]
    v_pk_add_f32 v[44:45], v[44:45], v[60:61]
    v_pk_add_f32 v[46:47], v[46:47], v[62:63]
    s_waitcnt lgkmcnt(4)
    v_pk_add_f32 v[32:33], v[32:33], v[64:65]
    v_pk_add_f32 v[34:35], v[34:35], v[66:67]
    v_pk_add_f32 v[36:37], v[36:37], v[68:69]
    v_pk_add_f32 v[38:39], v[38:39], v[70:71]
    v_pk_add_f32 v[40:41], v[40:41], v[72:73]
    v_pk_add_f32 v[42:43], v[42:43], v[74:75]
    v_pk_add_f32 v[44:45], v[44:45], v[76:77]
    v_pk_add_f32 v[46:47], v[46:47], v[78:79]
    s_waitcnt lgkmcnt(0)
    v_pk_add_f32 v[32:33], v[32:33], v[80:81]
    v_pk_add_f32 v[34:35], v[34:35], v[82:83]
    v_pk_add_f32 v[36:37], v[36:37], v[84:85]
    v_pk_add_f32 v[38:39], v[38:39], v[86:87]
    v_pk_add_f32 v[40:41], v[40:41], v[88:89]
    v_pk_add_f32 v[42:43], v[42:43], v[90:91]
    v_pk_add_f32 v[44:45], v[44:45], v[92:93]
    v_pk_add_f32 v[46:47], v[46:47], v[94:95]
    s_cbranch_vccnz s_slow
s_fin:
    v_pk_mul_f32 v[32:33], v[28:29], v[32:33] op_sel_hi:[0,1]
    v_pk_mul_f32 v[34:35], v[28:29], v[34:35] op_sel_hi:[0,1]
    v_pk_mul_f32 v[36:37], v[28:29], v[36:37] op_sel_hi:[0,1]
    v_pk_mul_f32 v[38:39], v[28:29], v[38:39] op_sel_hi:[0,1]
    v_pk_mul_f32 v[40:41], v[28:29], v[40:41] op_sel_hi:[0,1]
    v_pk_mul_f32 v[42:43], v[28:29], v[42:43] op_sel_hi:[0,1]
    v_pk_mul_f32 v[44:45], v[28:29], v[44:45] op_sel_hi:[0,1]
    v_pk_mul_f32 v[46:47], v[28:29], v[46:47] op_sel_hi:[0,1]
    v_cvt_pk_bf16_f32 v32, v32, v33
    v_cvt_pk_bf16_f32 v33, v34, v35
    v_cvt_pk_bf16_f32 v34, v36, v37
    v_cvt_pk_bf16_f32 v35, v38, v39
    v_cvt_pk_bf16_f32 v36, v40, v41
    v_cvt_pk_bf16_f32 v37, v42, v43
    v_cvt_pk_bf16_f32 v38, v44, v45
    v_cvt_pk_bf16_f32 v39, v46, v47
    buffer_store_dwordx4 v[32:35], v1, s[4:7], s53 offen offset:0 sc1
    buffer_store_dwordx4 v[36:39], v1, s[4:7], s53 offen offset:1024 sc1
    s_cmp_lg_u32 s52, 0
    s_cbranch_scc1 s_b2
    s_waitcnt vmcnt(0)
    s_atomic_add s40, s[22:23], s54
    s_mov_b32 s52, 1
    s_add_u32 s53, s53, 2048
    s_waitcnt lgkmcnt(0)
    s_add_u32 s54, s54, 128
    s_setprio 0
    s_and_b32 s3, s16, 3
    s_lshl_b32 s46, s3, 19
    s_lshl_b32 s45, s3, 14
    s_and_b32 s3, s18, 0
    s_lshl_b32 s3, s3, 17
    s_xor_b32 s46, s46, s3
    s_add_u32 m0, s45, 0
    s_xor_b32 s44, s46, 0
    buffer_load_dwordx4 v16, s[12:15], s44 offen offset:0 lds
    buffer_load_dwordx4 v17, s[12:15], s44 offen offset:1024 lds
    buffer_load_dwordx4 v18, s[12:15], s44 offen offset:2048 lds
    buffer_load_dwordx4 v19, s[12:15], s44 offen offset:3072 lds
    s_add_u32 s44, s44, 65536
    s_waitcnt vmcnt(2)
    buffer_load_dwordx4 v[96:99], v16, s[12:15], s44 offen offset:0
    buffer_load_dwordx4 v[100:103], v17, s[12:15], s44 offen offset:1024
    buffer_load_dwordx4 v[104:107], v18, s[12:15], s44 offen offset:2048
    buffer_load_dwordx4 v[108:111], v19, s[12:15], s44 offen offset:3072
    s_waitcnt vmcnt(2)
    s_add_u32 m0, s45, 4096
    s_xor_b32 s44, s46, 131072
    buffer_load_dwordx4 v16, s[12:15], s44 offen offset:0 lds
    buffer_load_dwordx4 v17, s[12:15], s44 offen offset:1024 lds
    buffer_load_dwordx4 v18, s[12:15], s44 offen offset:2048 lds
    buffer_load_dwordx4 v19, s[12:15], s44 offen offset:3072 lds
    s_add_u32 s44, s44, 65536
    s_waitcnt vmcnt(2)
    buffer_load_dwordx4 v[112:115], v16, s[12:15], s44 offen offset:0
    buffer_load_dwordx4 v[116:119], v17, s[12:15], s44 offen offset:1024
    buffer_load_dwordx4 v[120:123], v18, s[12:15], s44 offen offset:2048
    buffer_load_dwordx4 v[124:127], v19, s[12:15], s44 offen offset:3072
    s_waitcnt vmcnt(2)
    s_add_u32 m0, s45, 8192
    s_xor_b32 s44, s46, 262144
    buffer_load_dwordx4 v16, s[12:15], s44 offen offset:0 lds
    buffer_load_dwordx4 v17, s[12:15], s44 offen offset:1024 lds
    buffer_load_dwordx4 v18, s[12:15], s44 offen offset:2048 lds
    buffer_load_dwordx4 v19, s[12:15], s44 offen offset:3072 lds
    s_add_u32 s44, s44, 65536
    s_waitcnt vmcnt(2)
    buffer_load_dwordx4 v[128:131], v16, s[12:15], s44 offen offset:0
    buffer_load_dwordx4 v[132:135], v17, s[12:15], s44 offen offset:1024
    buffer_load_dwordx4 v[136:139], v18, s[12:15], s44 offen offset:2048
    buffer_load_dwordx4 v[140:143], v19, s[12:15], s44 offen offset:3072
    s_waitcnt vmcnt(2)
    s_add_u32 m0, s45, 12288
    s_xor_b32 s44, s46, 393216
    buffer_load_dwordx4 v16, s[12:15], s44 offen offset:0 lds
    buffer_load_dwordx4 v17, s[12:15], s44 offen offset:1024 lds
    buffer_load_dwordx4 v18, s[12:15], s44 offen offset:2048 lds
    buffer_load_dwordx4 v19, s[12:15], s44 offen offset:3072 lds
    s_add_u32 s44, s44, 65536
    s_waitcnt vmcnt(2)
    buffer_load_dwordx4 v[144:147], v16, s[12:15], s44 offen offset:0
    buffer_load_dwordx4 v[148:151], v17, s[12:15], s44 offen offset:1024
    buffer_load_dwordx4 v[152:155], v18, s[12:15], s44 offen offset:2048
    buffer_load_dwordx4 v[156:159], v19, s[12:15], s44 offen offset:3072
    s_waitcnt vmcnt(2)
    s_setprio 3
    s_sub_u32 s44, s54, 128
    s_mov_b32 s66, 0x10000
s_o0_poll:
    s_mov_b32 s68, 0
    s_atomic_add s68, s[22:23], s44 offset:0 glc
    s_sub_u32 s66, s66, 1
    s_cselect_b32 s67, 16, 0
    s_waitcnt lgkmcnt(0)
    s_max_u32 s68, s68, s67
    s_cmp_lt_u32 s68, 16
    s_cbranch_scc1 s_o0_poll
s_o0_ok:
    s_branch s_bhead
s_b2:
    ds_write_b128 v24, v[96:99] offset:0
    ds_write_b128 v24, v[100:103] offset:1024
    ds_write_b128 v24, v[104:107] offset:2048
    ds_write_b128 v24, v[108:111] offset:3072
    ds_write_b128 v24, v[112:115] offset:4096
    ds_write_b128 v24, v[116:119] offset:5120
    ds_write_b128 v24, v[120:123] offset:6144
    ds_write_b128 v24, v[124:127] offset:7168
    ds_write_b128 v24, v[128:131] offset:8192
    ds_write_b128 v24, v[132:135] offset:9216
    ds_write_b128 v24, v[136:139] offset:10240
    ds_write_b128 v24, v[140:143] offset:11264
    ds_write_b128 v24, v[144:147] offset:12288
    ds_write_b128 v24, v[148:151] offset:13312
    ds_write_b128 v24, v[152:155] offset:14336
    ds_write_b128 v24, v[156:159] offset:15360
    s_mov_b32 s68, 1
    s_waitcnt vmcnt(0)
    s_atomic_add s68, s[22:23], s54 glc
    s_mov_b32 s66, 0x10000
    s_waitcnt lgkmcnt(0)
    s_cmp_eq_u32 s68, 15
    s_cbranch_scc1 s_o1_ok
s_o1_poll:
    s_mov_b32 s68, 0
    s_atomic_add s68, s[22:23], s54 offset:0 glc
    s_sub_u32 s66, s66, 1
    s_cselect_b32 s67, 16, 0
    s_waitcnt lgkmcnt(0)
    s_max_u32 s68, s68, s67
    s_cmp_lt_u32 s68, 16
    s_cbranch_scc1 s_o1_poll
s_o1_ok:
s_b3:
    s_setprio 0
    s_waitcnt lgkmcnt(0)
s_g3:
    s_barrier
    s_cmp_eq_u32 s21, 3
    s_cbranch_scc1 s_end
    s_barrier
    ds_write_b128 v9, v[160:163] offset:0
    ds_write_b128 v9, v[164:167] offset:4096
    ds_write_b128 v9, v[168:171] offset:8192
    ds_write_b128 v9, v[172:175] offset:12288
    ds_write_b128 v9, v[176:179] offset:16384
    ds_write_b128 v9, v[180:183] offset:20480
    ds_write_b128 v9, v[184:187] offset:24576
    ds_write_b128 v9, v[188:191] offset:28672
    s_add_u32 s21, s21, 1
    s_bitcmp1_b32 s21, 0
    s_cselect_b32 s8, s28, s24
    s_cselect_b32 s9, s29, s25
    s_cselect_b32 s12, s30, s26
    s_cselect_b32 s13, s31, s27
    s_mov_b32 s10, 6291456
    s_mov_b32 s11, 0x00020000
    s_mov_b32 s14, 2097152
    s_mov_b32 s15, 0x00020000
    s_sub_u32 s3, s16, 5
    s_cmp_gt_u32 s3, 1
    s_cbranch_scc1 s_n67
    s_add_u32 m0, s41, 98304
    s_add_u32 s44, s88, 2048
    buffer_load_dwordx4 v14, s[8:11], s44 offen offset:0 lds
    buffer_load_dwordx4 v15, s[8:11], s44 offen offset:1024 lds
    s_add_u32 m0, s41, 102400
    s_add_u32 s44, s88, 4096
    buffer_load_dwordx4 v14, s[8:11], s44 offen offset:0 lds
    buffer_load_dwordx4 v15, s[8:11], s44 offen offset:1024 lds
    s_add_u32 m0, s41, 106496
    s_add_u32 s44, s88, 0
    buffer_load_dwordx4 v14, s[8:11], s44 offen offset:0 lds
    buffer_load_dwordx4 v15, s[8:11], s44 offen offset:1024 lds
    s_add_u32 m0, s41, 110592
    s_add_u32 s44, s88, 198656
    buffer_load_dwordx4 v14, s[8:11], s44 offen offset:0 lds
    buffer_load_dwordx4 v15, s[8:11], s44 offen offset:1024 lds
    s_add_u32 m0, s41, 114688
    s_add_u32 s44, s88, 200704
    buffer_load_dwordx4 v14, s[8:11], s44 offen offset:0 lds
    buffer_load_dwordx4 v15, s[8:11], s44 offen offset:1024 lds
    s_add_u32 m0, s41, 118784
    s_add_u32 s44, s88, 196608
    buffer_load_dwordx4 v14, s[8:11], s44 offen offset:0 lds
    buffer_load_dwordx4 v15, s[8:11], s44 offen offset:1024 lds
    s_add_u32 m0, s41, 122880
    s_add_u32 s44, s89, 2048
    buffer_load_dwordx4 v14, s[8:11], s44 offen offset:0 lds
    buffer_load_dwordx4 v15, s[8:11], s44 offen offset:1024 lds
    s_add_u32 m0, s41, 126976
    s_add_u32 s44, s89, 4096
    buffer_load_dwordx4 v14, s[8:11], s44 offen offset:0 lds
    buffer_load_dwordx4 v15, s[8:11], s44 offen offset:1024 lds
s_n67:
    s_waitcnt lgkmcnt(0)
    s_barrier
    ds_write_b128 v9, v[192:195] offset:32768
    ds_write_b128 v9, v[196:199] offset:36864
    ds_write_b128 v9, v[200:203] offset:40960
    ds_write_b128 v9, v[204:207] offset:45056
    ds_write_b128 v9, v[208:211] offset:49152
    ds_write_b128 v9, v[212:215] offset:53248
    ds_write_b128 v9, v[216:219] offset:57344
    ds_write_b128 v9, v[220:223] offset:61440
    ds_write_b128 v10, v[224:227] offset:0
    ds_write_b128 v10, v[228:231] offset:4096
    ds_write_b128 v10, v[232:235] offset:8192
    ds_write_b128 v10, v[236:239] offset:12288
    ds_write_b128 v10, v[240:243] offset:16384
    ds_write_b128 v10, v[244:247] offset:20480
    ds_write_b128 v10, v[248:251] offset:24576
    ds_write_b128 v10, v[252:255] offset:28672
    s_cmp_eq_u32 s16, 4
    s_cbranch_scc1 h_layer
    s_cmp_eq_u32 s16, 7
    s_cbranch_scc1 z_layer
    s_branch l_layer
s_end:
    s_lshl_b32 s3, s2, 3
    s_add_u32 s3, s3, s16
    s_cmp_lg_u32 s3, 7
    s_cbranch_scc1 k_exit
    s_mov_b32 s8, s34
    s_mov_b32 s9, s35
    s_mov_b32 s10, 256
    s_mov_b32 s11, 0x00020000
    v_lshrrev_b32 v24, 2, v1
    v_mov_b32 v25, 0
    buffer_store_dword v25, v24, s[8:11], 0 offen sc1
    s_branch k_exit
s_slow:
    s_and_b32 s3, s16, 3
    s_lshl_b32 s44, s3, 11
    s_lshl_b32 s45, s52, 13
    s_add_u32 s44, s44, s45
    s_add_u32 s44, s44, 131072
    v_add_u32 v26, s44, v1
    ds_read_b128 v[48:51], v26 offset:0
    ds_read_b128 v[52:55], v26 offset:1024
    s_lshr_b32 s55, s21, 1
    s_lshl_b32 s55, s55, 23
    s_lshl_b32 s44, s18, 18
    s_add_u32 s55, s55, s44
    s_lshl_b32 s44, s52, 17
    s_add_u32 s55, s55, s44
    s_add_u32 s55, s55, 33554432
    s_waitcnt lgkmcnt(0)
    v_mov_b32 v26, 0xff800000
    s_mov_b32 s61, 0
s_slow1:
    s_add_u32 s44, s55, s61
    buffer_load_dwordx4 v[56:59], v1, s[4:7], s44 offen offset:0 sc1
    buffer_load_dwordx4 v[60:63], v1, s[4:7], s44 offen offset:1024 sc1
    s_waitcnt vmcnt(0)
    v_mfma_f32_32x32x16_bf16 v[72:87], v[56:59], v[48:51], 0
    v_mfma_f32_32x32x16_bf16 v[72:87], v[60:63], v[52:55], v[72:87]
    s_nop 11
    v_max3_f32 v26, v26, v72, v73
    v_max3_f32 v26, v26, v74, v75
    v_max3_f32 v26, v26, v76, v77
    v_max3_f32 v26, v26, v78, v79
    v_max3_f32 v26, v26, v80, v81
    v_max3_f32 v26, v26, v82, v83
    v_max3_f32 v26, v26, v84, v85
    v_max3_f32 v26, v26, v86, v87
    s_add_u32 s61, s61, 2048
    s_cmp_lt_u32 s61, 131072
    s_cbranch_scc1 s_slow1
    v_mov_b32 v27, v26
    s_nop 1
    v_permlane32_swap_b32 v26, v27
    v_max_f32 v26, v26, v27
    v_mov_b32 v32, 0
    v_mov_b32 v33, 0
    v_mov_b32 v34, 0
    v_mov_b32 v35, 0
    v_mov_b32 v36, 0
    v_mov_b32 v37, 0
    v_mov_b32 v38, 0
    v_mov_b32 v39, 0
    v_mov_b32 v40, 0
    v_mov_b32 v41, 0
    v_mov_b32 v42, 0
    v_mov_b32 v43, 0
    v_mov_b32 v44, 0
    v_mov_b32 v45, 0
    v_mov_b32 v46, 0
    v_mov_b32 v47, 0
    v_mov_b32 v28, 0
    v_mov_b32 v29, 0xdddddddd
    s_mov_b32 s3, 0xffff0000
    s_mov_b32 s61, 0
s_slow2:
    s_add_u32 s44, s55, s61
    buffer_load_dwordx4 v[56:59], v1, s[4:7], s44 offen offset:0 sc1
    buffer_load_dwordx4 v[60:63], v1, s[4:7], s44 offen offset:1024 sc1
    s_add_u32 s44, s44, 4194304
    buffer_load_dwordx4 v[64:67], v1, s[4:7], s44 offen offset:0 sc1
    buffer_load_dwordx4 v[68:71], v1, s[4:7], s44 offen offset:1024 sc1
    s_waitcnt vmcnt(0)
    v_mfma_f32_32x32x16_bf16 v[72:87], v[56:59], v[48:51], 0
    v_mfma_f32_32x32x16_bf16 v[72:87], v[60:63], v[52:55], v[72:87]
    s_nop 11
    v_sub_f32 v72, v72, v26
    v_sub_f32 v73, v73, v26
    v_sub_f32 v74, v74, v26
    v_sub_f32 v75, v75, v26
    v_sub_f32 v76, v76, v26
    v_sub_f32 v77, v77, v26
    v_sub_f32 v78, v78, v26
    v_sub_f32 v79, v79, v26
    v_sub_f32 v80, v80, v26
    v_sub_f32 v81, v81, v26
    v_sub_f32 v82, v82, v26
    v_sub_f32 v83, v83, v26
    v_sub_f32 v84, v84, v26
    v_sub_f32 v85, v85, v26
    v_sub_f32 v86, v86, v26
    v_sub_f32 v87, v87, v26
    v_exp_f32 v72, v72
    v_exp_f32 v73, v73
    v_exp_f32 v74, v74
    v_exp_f32 v75, v75
    v_exp_f32 v76, v76
    v_exp_f32 v77, v77
    v_exp_f32 v78, v78
    v_exp_f32 v79, v79
    v_exp_f32 v80, v80
    v_exp_f32 v81, v81
    v_exp_f32 v82, v82
    v_exp_f32 v83, v83
    v_exp_f32 v84, v84
    v_exp_f32 v85, v85
    v_exp_f32 v86, v86
    v_exp_f32 v87, v87
    v_and_b32 v72, s3, v72
    v_and_b32 v73, s3, v73
    v_and_b32 v74, s3, v74
    v_and_b32 v75, s3, v75
    v_and_b32 v76, s3, v76
    v_and_b32 v77, s3, v77
    v_and_b32 v78, s3, v78
    v_and_b32 v79, s3, v79
    v_and_b32 v80, s3, v80
    v_and_b32 v81, s3, v81
    v_and_b32 v82, s3, v82
    v_and_b32 v83, s3, v83
    v_and_b32 v84, s3, v84
    v_and_b32 v85, s3, v85
    v_and_b32 v86, s3, v86
    v_and_b32 v87, s3, v87
    v_add_f32 v28, v28, v72
    v_add_f32 v28, v28, v73
    v_add_f32 v28, v28, v74
    v_add_f32 v28, v28, v75
    v_add_f32 v28, v28, v76
    v_add_f32 v28, v28, v77
    v_add_f32 v28, v28, v78
    v_add_f32 v28, v28, v79
    v_add_f32 v28, v28, v80
    v_add_f32 v28, v28, v81
    v_add_f32 v28, v28, v82
    v_add_f32 v28, v28, v83
    v_add_f32 v28, v28, v84
    v_add_f32 v28, v28, v85
    v_add_f32 v28, v28, v86
    v_add_f32 v28, v28, v87
    v_smfmac_f32_32x32x32_bf16 v[32:47], v[64:67], v[72:79], v29
    v_smfmac_f32_32x32x32_bf16 v[32:47], v[68:71], v[80:87], v29
    s_add_u32 s61, s61, 2048
    s_cmp_lt_u32 s61, 131072
    s_cbranch_scc1 s_slow2
    v_mov_b32 v29, v28
    s_nop 1
    v_permlane32_swap_b32 v28, v29
    v_add_f32 v28, v28, v29
    v_rcp_f32 v28, v28
    s_nop 7
    s_branch s_fin
k_exit:
    s_endpgm
.if k_exit - interleave_layers__sliding_local_dilated__softmax_full_mha__prompt_kernel < 49152
.error "code prefetch reads past the end of the code"
.endif
.section .rodata,"a"
.p2align 6
.amdhsa_kernel interleave_layers__sliding_local_dilated__softmax_full_mha__prompt_kernel
  .amdhsa_next_free_vgpr 256
  .amdhsa_next_free_sgpr 102
  .amdhsa_accum_offset 256
  .amdhsa_group_segment_fixed_size 0
  .amdhsa_kernarg_size 72
  .amdhsa_user_sgpr_count 2
  .amdhsa_user_sgpr_kernarg_segment_ptr 1
  .amdhsa_system_sgpr_workgroup_id_x 1
.end_amdhsa_kernel
```

```asm
; @launch grid=(256,1,1) block=(512,1,1) lds=156736
.amdgcn_target "amdgcn-amd-amdhsa--gfx950"
.text
.globl interleave_layers__sliding_local_dilated__softmax_full_mha__prompt_kernel
.type interleave_layers__sliding_local_dilated__softmax_full_mha__prompt_kernel,@function
.p2align 8
interleave_layers__sliding_local_dilated__softmax_full_mha__prompt_kernel:
    s_cmp_ge_u32 s2, 256
    s_cbranch_scc1 k_exit
    s_load_dwordx2 s[36:37], s[0:1], 0
    s_load_dwordx4 s[24:27], s[0:1], 8
    s_load_dwordx8 s[28:35], s[0:1], 32
    s_load_dwordx2 s[44:45], s[0:1], 64
    v_lshrrev_b32 v2, 6, v0
    v_and_b32 v0, 63, v0
    v_readfirstlane_b32 s16, v2
    v_lshlrev_b32 v1, 4, v0
    s_mov_b32 s21, 0
    s_mov_b32 s40, 1
    s_and_b32 s3, s2, 1
    s_lshl_b32 s3, s3, 3
    s_bfe_u32 s17, s2, 0x30003
    s_add_u32 s17, s17, s3
    s_bfe_u32 s3, s2, 0x20001
    s_lshl_b32 s3, s3, 2
    s_lshr_b32 s18, s2, 6
    s_add_u32 s18, s18, s3
    s_and_b32 s3, s16, 3
    s_lshl_b32 s38, s17, 2
    s_add_u32 s38, s38, s3
    v_lshrrev_b32 v32, 3, v0
    v_and_b32 v33, 7, v0
    v_lshlrev_b32 v34, 11, v32
    v_lshl_add_u32 v34, v33, 4, v34
    s_lshl_b32 s46, s38, 16
    s_lshl_b32 s47, s18, 7
    s_add_u32 s46, s46, s47
    s_getpc_b64 s[76:77]
e_pc:
    s_sub_u32 s76, s76, e_pc - interleave_layers__sliding_local_dilated__softmax_full_mha__prompt_kernel
    s_subb_u32 s77, s77, 0
    s_and_b32 s3, s2, 0xf8
    s_add_u32 s3, s3, s16
    s_lshl_b32 s3, s3, 6
    s_add_u32 s78, s3, 49152
    s_min_u32 s78, s78, k_exit - interleave_layers__sliding_local_dilated__softmax_full_mha__prompt_kernel
    s_waitcnt lgkmcnt(0)
    s_mov_b32 s8, s36
    s_mov_b32 s9, s37
    s_mov_b32 s10, 4194304
    s_mov_b32 s11, 0x00020000
    s_cmp_gt_u32 s16, 3
    s_cbranch_scc1 e_side
    buffer_load_dwordx4 v[40:43], v34, s[8:11], s46 offen
    s_add_u32 s46, s46, 16384
    buffer_load_dwordx4 v[44:47], v34, s[8:11], s46 offen
    s_add_u32 s46, s46, 16384
    buffer_load_dwordx4 v[48:51], v34, s[8:11], s46 offen
    s_add_u32 s46, s46, 16384
    buffer_load_dwordx4 v[52:55], v34, s[8:11], s46 offen
e_side:
    s_load_dword s80, s[76:77], s3 offset:0
    s_load_dword s81, s[76:77], s3 offset:16384
    s_load_dword s82, s[76:77], s3 offset:32768
    s_load_dword s83, s[76:77], s78
    s_mov_b32 s4, s44
    s_mov_b32 s5, s45
    s_mov_b32 s6, 67108864
    s_mov_b32 s7, 0x00020000
    s_add_u32 s22, s44, 58720256
    s_addc_u32 s23, s45, 0
    s_load_dword s100, s[22:23], 217088
    s_cmp_gt_u32 s16, 3
    s_cbranch_scc1 s_start
    v_lshrrev_b32 v8, 4, v1
    s_lshl_b32 s44, s38, 16
    v_xor_b32 v88, v33, v32
    v_lshlrev_b32 v88, 4, v88
    v_lshl_add_u32 v88, v32, 11, v88
    v_xor_b32 v89, 16, v88
    v_add_u32 v89, 15360, v89
    v_add_u32 v90, 30720, v88
    v_add_u32 v91, 30720, v89
    s_mul_i32 s76, s16, 16384
    s_add_u32 s76, s76, 61440
    s_lshl_b32 s77, s38, 16
    s_mul_i32 s84, s18, 4096
    s_cmp_lt_u32 s18, 4
    s_cselect_b32 s85, 4, 0
    s_mul_i32 s85, s85, 4096
    s_cmp_lt_u32 s18, 4
    s_cselect_b32 s86, 5, 1
    s_mul_i32 s86, s86, 4096
    s_cmp_lt_u32 s18, 4
    s_cselect_b32 s87, 6, 2
    s_mul_i32 s87, s87, 4096
    s_cmp_lt_u32 s18, 4
    s_cselect_b32 s88, 7, 3
    s_mul_i32 s88, s88, 4096
    s_cmp_lt_u32 s18, 8
    s_cselect_b32 s89, 8, 4
    s_mul_i32 s89, s89, 4096
    s_cmp_lt_u32 s18, 8
    s_cselect_b32 s90, 9, 5
    s_mul_i32 s90, s90, 4096
    s_cmp_lt_u32 s18, 8
    s_cselect_b32 s91, 10, 6
    s_mul_i32 s91, s91, 4096
    s_cmp_lt_u32 s18, 8
    s_cselect_b32 s92, 11, 7
    s_mul_i32 s92, s92, 4096
    s_cmp_lt_u32 s18, 12
    s_cselect_b32 s93, 12, 8
    s_mul_i32 s93, s93, 4096
    s_cmp_lt_u32 s18, 12
    s_cselect_b32 s94, 13, 9
    s_mul_i32 s94, s94, 4096
    s_cmp_lt_u32 s18, 12
    s_cselect_b32 s95, 14, 10
    s_mul_i32 s95, s95, 4096
    s_cmp_lt_u32 s18, 12
    s_cselect_b32 s96, 15, 11
    s_mul_i32 s96, s96, 4096
    s_xor_b32 s97, s18, 1
    s_mul_i32 s97, s97, 4096
    s_xor_b32 s98, s18, 2
    s_mul_i32 s98, s98, 4096
    s_xor_b32 s99, s18, 3
    s_mul_i32 s99, s99, 4096
    s_lshr_b32 s3, s18, 2
    s_lshl_b32 s3, s3, 3
    s_lshl_b32 s63, 1, s3
    s_lshl_b32 s3, s63, 2
    s_andn2_b32 s19, 67372036, s3
    v_lshrrev_b32 v12, 4, v1
    v_and_b32 v13, 15, v12
    v_bfe_u32 v14, v12, 4, 1
    v_lshrrev_b32 v12, 5, v12
    v_lshl_add_u32 v2, v14, 5, v13
    v_lshlrev_b32 v2, 4, v2
    v_lshl_add_u32 v2, v12, 10, v2
    v_lshrrev_b32 v15, 2, v13
    v_lshl_add_u32 v15, v14, 2, v15
    v_lshlrev_b32 v3, 7, v15
    v_lshl_add_u32 v3, v12, 11, v3
    v_and_b32 v15, 3, v13
    v_lshl_add_u32 v3, v15, 3, v3
    v_lshrrev_b32 v15, 3, v13
    v_lshl_add_u32 v15, v15, 1, v14
    v_lshl_add_u32 v3, v15, 5, v3
    v_xor_b32 v4, 32, v3
    v_xor_b32 v5, 64, v3
    v_xor_b32 v6, 96, v3
    s_lshl_b32 s45, s16, 12
    s_add_u32 s45, s45, 131072
    v_lshrrev_b32 v35, 1, v33
    v_lshlrev_b32 v35, 10, v35
    v_lshl_add_u32 v35, v32, 4, v35
    v_and_b32 v36, 1, v33
    v_lshl_add_u32 v35, v36, 3, v35
    v_add_u32 v35, s45, v35
    v_add_u32 v36, s45, v1
    v_mov_b32 v37, 0x3f803f80
    v_and_b32 v38, 3, v8
    v_lshl_add_u32 v39, v38, 3, v32
    v_lshlrev_b32 v39, 3, v39
    v_mov_b32 v56, 0
    v_mov_b32 v57, 0
    v_mov_b32 v58, 0
    v_mov_b32 v59, 0
    v_mov_b32 v60, 0
    v_mov_b32 v61, 0
    v_mov_b32 v62, 0
    v_mov_b32 v63, 0
    s_waitcnt vmcnt(3)
    ds_write_b64 v35, v[40:41] offset:0
    ds_write_b64 v35, v[42:43] offset:512
    s_waitcnt vmcnt(2)
    ds_write_b64 v35, v[44:45] offset:128
    ds_write_b64 v35, v[46:47] offset:640
    s_waitcnt vmcnt(1)
    ds_write_b64 v35, v[48:49] offset:256
    ds_write_b64 v35, v[50:51] offset:768
    s_waitcnt vmcnt(0)
    ds_write_b64 v35, v[52:53] offset:384
    ds_write_b64 v35, v[54:55] offset:896
    ds_read_b128 v[64:67], v36 offset:0
    ds_read_b128 v[68:71], v36 offset:1024
    ds_read_b128 v[72:75], v36 offset:2048
    ds_read_b128 v[76:79], v36 offset:3072
    s_lshl_b32 s45, s18, 12
    s_add_u32 s46, s44, s45
    s_waitcnt lgkmcnt(3)
    buffer_store_dwordx4 v[64:67], v1, s[4:7], s46 offen offset:0 sc1
    s_waitcnt lgkmcnt(2)
    buffer_store_dwordx4 v[68:71], v1, s[4:7], s46 offen offset:1024 sc1
    s_waitcnt lgkmcnt(1)
    buffer_store_dwordx4 v[72:75], v1, s[4:7], s46 offen offset:2048 sc1
    s_waitcnt lgkmcnt(0)
    buffer_store_dwordx4 v[76:79], v1, s[4:7], s46 offen offset:3072 sc1
    s_add_u32 m0, s76, 4096
    s_lshr_b32 s78, s85, 5
    s_add_u32 s78, s78, s77
    buffer_load_dwordx4 v88, s[8:11], s78 offen offset:0 lds
    buffer_load_dwordx4 v89, s[8:11], s78 offen offset:1024 lds
    buffer_load_dwordx4 v90, s[8:11], s78 offen offset:2048 lds
    buffer_load_dwordx4 v91, s[8:11], s78 offen offset:3072 lds
    s_add_u32 m0, s76, 8192
    s_lshr_b32 s78, s86, 5
    s_add_u32 s78, s78, s77
    buffer_load_dwordx4 v88, s[8:11], s78 offen offset:0 lds
    buffer_load_dwordx4 v89, s[8:11], s78 offen offset:1024 lds
    buffer_load_dwordx4 v90, s[8:11], s78 offen offset:2048 lds
    buffer_load_dwordx4 v91, s[8:11], s78 offen offset:3072 lds
    s_add_u32 m0, s76, 12288
    s_lshr_b32 s78, s87, 5
    s_add_u32 s78, s78, s77
    buffer_load_dwordx4 v88, s[8:11], s78 offen offset:0 lds
    buffer_load_dwordx4 v89, s[8:11], s78 offen offset:1024 lds
    buffer_load_dwordx4 v90, s[8:11], s78 offen offset:2048 lds
    buffer_load_dwordx4 v91, s[8:11], s78 offen offset:3072 lds
    s_add_u32 m0, s76, 16384
    s_lshr_b32 s78, s88, 5
    s_add_u32 s78, s78, s77
    buffer_load_dwordx4 v88, s[8:11], s78 offen offset:0 lds
    buffer_load_dwordx4 v89, s[8:11], s78 offen offset:1024 lds
    buffer_load_dwordx4 v90, s[8:11], s78 offen offset:2048 lds
    buffer_load_dwordx4 v91, s[8:11], s78 offen offset:3072 lds
    v_dot2_f32_bf16 v56, v40, v37, v56
    v_dot2_f32_bf16 v57, v40, v40, v57
    v_dot2_f32_bf16 v58, v44, v37, v58
    v_dot2_f32_bf16 v59, v44, v44, v59
    v_dot2_f32_bf16 v60, v48, v37, v60
    v_dot2_f32_bf16 v61, v48, v48, v61
    v_dot2_f32_bf16 v62, v52, v37, v62
    v_dot2_f32_bf16 v63, v52, v52, v63
    v_dot2_f32_bf16 v56, v41, v37, v56
    v_dot2_f32_bf16 v57, v41, v41, v57
    v_dot2_f32_bf16 v58, v45, v37, v58
    v_dot2_f32_bf16 v59, v45, v45, v59
    v_dot2_f32_bf16 v60, v49, v37, v60
    v_dot2_f32_bf16 v61, v49, v49, v61
    v_dot2_f32_bf16 v62, v53, v37, v62
    v_dot2_f32_bf16 v63, v53, v53, v63
    v_dot2_f32_bf16 v56, v42, v37, v56
    v_dot2_f32_bf16 v57, v42, v42, v57
    v_dot2_f32_bf16 v58, v46, v37, v58
    v_dot2_f32_bf16 v59, v46, v46, v59
    v_dot2_f32_bf16 v60, v50, v37, v60
    v_dot2_f32_bf16 v61, v50, v50, v61
    v_dot2_f32_bf16 v62, v54, v37, v62
    v_dot2_f32_bf16 v63, v54, v54, v63
    v_dot2_f32_bf16 v56, v43, v37, v56
    v_dot2_f32_bf16 v57, v43, v43, v57
    v_dot2_f32_bf16 v58, v47, v37, v58
    v_dot2_f32_bf16 v59, v47, v47, v59
    v_dot2_f32_bf16 v60, v51, v37, v60
    v_dot2_f32_bf16 v61, v51, v51, v61
    v_dot2_f32_bf16 v62, v55, v37, v62
    v_dot2_f32_bf16 v63, v55, v55, v63
    s_nop 2
    v_add_f32_dpp v56, v56, v56 quad_perm:[1,0,3,2] row_mask:0xf bank_mask:0xf
    v_add_f32_dpp v57, v57, v57 quad_perm:[1,0,3,2] row_mask:0xf bank_mask:0xf
    v_add_f32_dpp v58, v58, v58 quad_perm:[1,0,3,2] row_mask:0xf bank_mask:0xf
    v_add_f32_dpp v59, v59, v59 quad_perm:[1,0,3,2] row_mask:0xf bank_mask:0xf
    v_add_f32_dpp v60, v60, v60 quad_perm:[1,0,3,2] row_mask:0xf bank_mask:0xf
    v_add_f32_dpp v61, v61, v61 quad_perm:[1,0,3,2] row_mask:0xf bank_mask:0xf
    v_add_f32_dpp v62, v62, v62 quad_perm:[1,0,3,2] row_mask:0xf bank_mask:0xf
    v_add_f32_dpp v63, v63, v63 quad_perm:[1,0,3,2] row_mask:0xf bank_mask:0xf
    v_add_f32_dpp v56, v56, v56 quad_perm:[2,3,0,1] row_mask:0xf bank_mask:0xf
    v_add_f32_dpp v57, v57, v57 quad_perm:[2,3,0,1] row_mask:0xf bank_mask:0xf
    v_add_f32_dpp v58, v58, v58 quad_perm:[2,3,0,1] row_mask:0xf bank_mask:0xf
    v_add_f32_dpp v59, v59, v59 quad_perm:[2,3,0,1] row_mask:0xf bank_mask:0xf
    v_add_f32_dpp v60, v60, v60 quad_perm:[2,3,0,1] row_mask:0xf bank_mask:0xf
    v_add_f32_dpp v61, v61, v61 quad_perm:[2,3,0,1] row_mask:0xf bank_mask:0xf
    v_add_f32_dpp v62, v62, v62 quad_perm:[2,3,0,1] row_mask:0xf bank_mask:0xf
    v_add_f32_dpp v63, v63, v63 quad_perm:[2,3,0,1] row_mask:0xf bank_mask:0xf
    v_add_f32_dpp v56, v56, v56 row_half_mirror row_mask:0xf bank_mask:0xf
    v_add_f32_dpp v57, v57, v57 row_half_mirror row_mask:0xf bank_mask:0xf
    v_add_f32_dpp v58, v58, v58 row_half_mirror row_mask:0xf bank_mask:0xf
    v_add_f32_dpp v59, v59, v59 row_half_mirror row_mask:0xf bank_mask:0xf
    v_add_f32_dpp v60, v60, v60 row_half_mirror row_mask:0xf bank_mask:0xf
    v_add_f32_dpp v61, v61, v61 row_half_mirror row_mask:0xf bank_mask:0xf
    v_add_f32_dpp v62, v62, v62 row_half_mirror row_mask:0xf bank_mask:0xf
    v_add_f32_dpp v63, v63, v63 row_half_mirror row_mask:0xf bank_mask:0xf
    v_cmp_eq_u32 vcc, 1, v38
    s_nop 1
    v_cndmask_b32 v56, v56, v58, vcc
    v_cndmask_b32 v57, v57, v59, vcc
    v_cmp_eq_u32 vcc, 2, v38
    s_nop 1
    v_cndmask_b32 v56, v56, v60, vcc
    v_cndmask_b32 v57, v57, v61, vcc
    v_cmp_eq_u32 vcc, 3, v38
    s_nop 1
    v_cndmask_b32 v56, v56, v62, vcc
    v_cndmask_b32 v57, v57, v63, vcc
    s_lshl_b32 s44, s21, 18
    s_lshl_b32 s45, s38, 12
    s_add_u32 s44, s44, s45
    s_lshl_b32 s45, s18, 8
    s_add_u32 s44, s44, s45
    s_add_u32 s44, s44, 50331648
    buffer_store_dwordx2 v[56:57], v39, s[4:7], s44 offen sc1
    s_lshl_b32 s46, s21, 14
    s_lshl_b32 s67, s38, 7
    s_add_u32 s46, s46, s67
    s_add_u32 s46, s46, 4096
    s_add_u32 s47, s46, 8192
    s_lshl_b32 s48, s21, 22
    s_lshl_b32 s49, s38, 16
    s_add_u32 s41, s48, s49
    v_lshrrev_b32 v16, 4, v1
    v_and_b32 v17, 15, v16
    v_lshrrev_b32 v16, 4, v16
    s_lshl_b32 s49, s16, 7
    s_add_u32 s50, s49, 151552
    s_and_b32 s49, s21, 1
    s_lshl_b32 s49, s49, 10
    s_add_u32 s49, s49, 151552
    v_lshlrev_b32 v11, 4, v16
    v_add_u32 v13, s50, v11
    v_add_u32 v11, s49, v11
    v_lshlrev_b32 v15, 2, v17
    v_add_u32 v9, s50, v15
    v_add_u32 v15, s49, v15
    s_lshr_b32 s49, s21, 1
    s_lshl_b32 s53, s49, 23
    s_lshl_b32 s50, s18, 18
    s_add_u32 s53, s53, s50
    s_add_u32 s53, s53, 33554432
    s_lshl_b32 s54, s38, 11
    s_add_u32 s52, s53, s54
    s_lshl_b32 s59, s49, 13
    s_lshl_b32 s67, s18, 9
    s_add_u32 s59, s59, s67
    s_lshl_b32 s67, s16, 7
    s_add_u32 s59, s59, s67
    s_add_u32 s59, s59, 69632
    s_lshl_b32 s61, s49, 15
    s_lshl_b32 s67, s17, 11
    s_add_u32 s61, s61, s67
    s_lshl_b32 s67, s18, 7
    s_add_u32 s61, s61, s67
    s_add_u32 s61, s61, 151552
    s_sub_u32 s60, s61, 151552
    s_lshl_b32 s60, s60, 5
    s_add_u32 s60, s60, 54525952
    s_lshl_b32 s62, s16, 12
    s_add_u32 s62, s62, 131072
    v_bfe_u32 v80, v8, 3, 1
    v_and_b32 v81, 7, v8
    v_lshrrev_b32 v82, 5, v8
    v_lshlrev_b32 v82, 1, v82
    v_xor_b32 v82, v82, v81
    v_xor_b32 v82, v82, v80
    v_lshlrev_b32 v82, 4, v82
    v_lshl_add_u32 v82, v81, 7, v82
    v_lshl_add_u32 v82, v80, 10, v82
    v_bfe_u32 v80, v8, 4, 1
    v_lshl_add_u32 v82, v80, 3, v82
    v_add_u32 v20, s76, v82
    v_xor_b32 v21, 16, v20
    v_xor_b32 v22, 64, v20
    v_xor_b32 v23, 80, v20
    v_add_u32 v80, s62, v2
    ds_read_b128 v[160:163], v80 offset:0
    ds_read_b128 v[164:167], v80 offset:256
    ds_read_b128 v[168:171], v80 offset:2048
    ds_read_b128 v[172:175], v80 offset:2304
    s_mov_b64 vcc, -1
    s_mov_b32 s48, 1
    s_or_b32 s20, s19, 0x80000000
    s_barrier
    ds_read_b64_tr_b16 v[32:33], v3 offset:0
    ds_read_b64_tr_b16 v[34:35], v3 offset:1024
    ds_read_b64_tr_b16 v[36:37], v4 offset:0
    ds_read_b64_tr_b16 v[38:39], v4 offset:1024
    ds_read_b64_tr_b16 v[40:41], v5 offset:0
    ds_read_b64_tr_b16 v[42:43], v5 offset:1024
    ds_read_b64_tr_b16 v[44:45], v6 offset:0
    ds_read_b64_tr_b16 v[46:47], v6 offset:1024
    ds_read_b64_tr_b16 v[48:49], v3 offset:4096
    ds_read_b64_tr_b16 v[50:51], v3 offset:5120
    ds_read_b64_tr_b16 v[52:53], v4 offset:4096
    ds_read_b64_tr_b16 v[54:55], v4 offset:5120
    ds_read_b64_tr_b16 v[56:57], v5 offset:4096
    ds_read_b64_tr_b16 v[58:59], v5 offset:5120
    s_branch c_g0
c_st1:
    s_waitcnt vmcnt(1)
    ds_read_b64 v[176:177], v20 offset:4096
    ds_read_b64 v[178:179], v21 offset:4096
    ds_read_b64 v[180:181], v20 offset:6144
    ds_read_b64 v[182:183], v21 offset:6144
    ds_read_b64 v[184:185], v22 offset:4096
    ds_read_b64 v[186:187], v23 offset:4096
    ds_read_b64 v[188:189], v22 offset:6144
    ds_read_b64 v[190:191], v23 offset:6144
    ds_read_b64 v[192:193], v20 offset:8192
    ds_read_b64 v[194:195], v21 offset:8192
    ds_read_b64 v[196:197], v20 offset:10240
    ds_read_b64 v[198:199], v21 offset:10240
    ds_read_b64 v[200:201], v22 offset:8192
    ds_read_b64 v[202:203], v23 offset:8192
    ds_read_b64 v[204:205], v22 offset:10240
    ds_read_b64 v[206:207], v23 offset:10240
    ds_read_b64 v[208:209], v20 offset:12288
    ds_read_b64 v[210:211], v21 offset:12288
    ds_read_b64 v[212:213], v20 offset:14336
    ds_read_b64 v[214:215], v21 offset:14336
    ds_read_b64 v[216:217], v22 offset:12288
    ds_read_b64 v[218:219], v23 offset:12288
    ds_read_b64 v[220:221], v22 offset:14336
    ds_read_b64 v[222:223], v23 offset:14336
    ds_read_b64 v[224:225], v20 offset:16384
    ds_read_b64 v[226:227], v21 offset:16384
    ds_read_b64 v[228:229], v20 offset:18432
    ds_read_b64 v[230:231], v21 offset:18432
    ds_read_b64 v[232:233], v22 offset:16384
    ds_read_b64 v[234:235], v23 offset:16384
    ds_read_b64 v[236:237], v22 offset:18432
    ds_read_b64 v[238:239], v23 offset:18432
    s_load_dword s68, s[34:35], 0
    s_mov_b32 s8, s34
    s_mov_b32 s9, s35
    s_mov_b32 s10, 256
    s_mov_b32 s11, 0x00020000
    s_mov_b32 s66, 0x10000
    v_mov_b32 v16, 0
    s_waitcnt lgkmcnt(0)
c_f0:
    s_cmp_eq_u32 s68, 10
    s_cbranch_scc1 c_f0_ok
    buffer_load_dword v17, v16, s[8:11], 0 offen offset:0 sc1
    s_waitcnt vmcnt(0)
    v_readfirstlane_b32 s68, v17
    s_sub_u32 s66, s66, 1
    s_cmp_lg_u32 s66, 0
    s_cbranch_scc1 c_f0
c_f0_ok:
    s_atomic_add s63, s[22:23], s46
    s_branch c_st2
c_cs1:
    s_waitcnt vmcnt(0)
    s_atomic_add s40, s[22:23], s47
    s_branch c_cs2
c_layer:
    s_mov_b64 vcc, 0
c_early2:
    s_barrier
    ds_read_b64_tr_b16 v[32:33], v3 offset:0
    ds_read_b64_tr_b16 v[34:35], v3 offset:1024
    ds_read_b64_tr_b16 v[36:37], v4 offset:0
    ds_read_b64_tr_b16 v[38:39], v4 offset:1024
    ds_read_b64_tr_b16 v[40:41], v5 offset:0
    ds_read_b64_tr_b16 v[42:43], v5 offset:1024
    ds_read_b64_tr_b16 v[44:45], v6 offset:0
    ds_read_b64_tr_b16 v[46:47], v6 offset:1024
    ds_read_b64_tr_b16 v[48:49], v3 offset:4096
    ds_read_b64_tr_b16 v[50:51], v3 offset:5120
    ds_read_b64_tr_b16 v[52:53], v4 offset:4096
    ds_read_b64_tr_b16 v[54:55], v4 offset:5120
    ds_read_b64_tr_b16 v[56:57], v5 offset:4096
    ds_read_b64_tr_b16 v[58:59], v5 offset:5120
c_g0:
    s_waitcnt lgkmcnt(10)
    v_mfma_f32_16x16x32_bf16 v[64:67], v[32:35], v[160:163], 0
    ds_read_b64_tr_b16 v[60:61], v6 offset:4096
    v_mfma_f32_16x16x32_bf16 v[68:71], v[32:35], v[164:167], 0
    ds_read_b64_tr_b16 v[62:63], v6 offset:5120
    v_mfma_f32_16x16x32_bf16 v[72:75], v[36:39], v[160:163], 0
    ds_read_b64_tr_b16 v[32:33], v3 offset:8192
    v_mfma_f32_16x16x32_bf16 v[76:79], v[36:39], v[164:167], 0
    ds_read_b64_tr_b16 v[34:35], v3 offset:9216
    s_waitcnt lgkmcnt(10)
    v_mfma_f32_16x16x32_bf16 v[80:83], v[40:43], v[160:163], 0
    ds_read_b64_tr_b16 v[36:37], v4 offset:8192
    v_mfma_f32_16x16x32_bf16 v[84:87], v[40:43], v[164:167], 0
    ds_read_b64_tr_b16 v[38:39], v4 offset:9216
    v_mfma_f32_16x16x32_bf16 v[88:91], v[44:47], v[160:163], 0
    ds_read_b64_tr_b16 v[40:41], v5 offset:8192
    v_mfma_f32_16x16x32_bf16 v[92:95], v[44:47], v[164:167], 0
    ds_read_b64_tr_b16 v[42:43], v5 offset:9216
    s_waitcnt lgkmcnt(10)
    v_mfma_f32_16x16x32_bf16 v[96:99], v[160:163], v[48:51], 0
    ds_read_b64_tr_b16 v[44:45], v6 offset:8192
    v_mfma_f32_16x16x32_bf16 v[100:103], v[164:167], v[48:51], 0
    ds_read_b64_tr_b16 v[46:47], v6 offset:9216
    v_mfma_f32_16x16x32_bf16 v[104:107], v[160:163], v[52:55], 0
    ds_read_b64_tr_b16 v[48:49], v3 offset:12288
    v_mfma_f32_16x16x32_bf16 v[108:111], v[164:167], v[52:55], 0
    ds_read_b64_tr_b16 v[50:51], v3 offset:13312
    s_waitcnt lgkmcnt(10)
    v_mfma_f32_16x16x32_bf16 v[112:115], v[160:163], v[56:59], 0
    ds_read_b64_tr_b16 v[52:53], v4 offset:12288
    v_mfma_f32_16x16x32_bf16 v[116:119], v[164:167], v[56:59], 0
    ds_read_b64_tr_b16 v[54:55], v4 offset:13312
    v_mfma_f32_16x16x32_bf16 v[120:123], v[160:163], v[60:63], 0
    ds_read_b64_tr_b16 v[56:57], v5 offset:12288
    v_mfma_f32_16x16x32_bf16 v[124:127], v[164:167], v[60:63], 0
    ds_read_b64_tr_b16 v[58:59], v5 offset:13312
    s_cmp_lg_u32 s48, 0
    s_cbranch_scc1 c_gate
    s_mov_b32 s66, 0x10000
    s_waitcnt lgkmcnt(0)
    s_and_b32 s68, s68, s19
    s_cmp_eq_u32 s68, s19
    s_cbranch_scc1 c_x_ok
c_x_poll:
    s_mov_b32 s68, 0
    s_atomic_add s68, s[22:23], s46 offset:0 glc
    s_sub_u32 s66, s66, 1
    s_cselect_b32 s67, s19, 0
    s_waitcnt lgkmcnt(0)
    s_and_b32 s68, s68, s19
    s_max_u32 s68, s68, s67
    s_cmp_lt_u32 s68, s19
    s_cbranch_scc1 c_x_poll
c_x_ok:
    s_add_u32 s42, s41, s85
    buffer_load_dwordx4 v[176:179], v2, s[4:7], s42 offen offset:0 sc1
    buffer_load_dwordx4 v[180:183], v2, s[4:7], s42 offen offset:256 sc1
    buffer_load_dwordx4 v[184:187], v2, s[4:7], s42 offen offset:2048 sc1
    buffer_load_dwordx4 v[188:191], v2, s[4:7], s42 offen offset:2304 sc1
    s_add_u32 s42, s41, s86
    buffer_load_dwordx4 v[192:195], v2, s[4:7], s42 offen offset:0 sc1
    buffer_load_dwordx4 v[196:199], v2, s[4:7], s42 offen offset:256 sc1
    buffer_load_dwordx4 v[200:203], v2, s[4:7], s42 offen offset:2048 sc1
    buffer_load_dwordx4 v[204:207], v2, s[4:7], s42 offen offset:2304 sc1
    s_add_u32 s42, s41, s87
    buffer_load_dwordx4 v[208:211], v2, s[4:7], s42 offen offset:0 sc1
    buffer_load_dwordx4 v[212:215], v2, s[4:7], s42 offen offset:256 sc1
    s_waitcnt vmcnt(10)
    s_atomic_add s40, s[22:23], s47
c_gate:
    s_waitcnt lgkmcnt(10)
    v_mfma_f32_16x16x32_bf16 v[128:131], v[32:35], v[160:163], 0
    ds_read_b64_tr_b16 v[60:61], v6 offset:12288
    v_mfma_f32_16x16x32_bf16 v[132:135], v[32:35], v[164:167], 0
    ds_read_b64_tr_b16 v[62:63], v6 offset:13312
    v_mfma_f32_16x16x32_bf16 v[136:139], v[36:39], v[160:163], 0
    ds_read_b64_tr_b16 v[32:33], v3 offset:16384
    v_mfma_f32_16x16x32_bf16 v[140:143], v[36:39], v[164:167], 0
    ds_read_b64_tr_b16 v[34:35], v3 offset:17408
    s_waitcnt lgkmcnt(10)
    v_mfma_f32_16x16x32_bf16 v[144:147], v[40:43], v[160:163], 0
    ds_read_b64_tr_b16 v[36:37], v4 offset:16384
    v_mfma_f32_16x16x32_bf16 v[148:151], v[40:43], v[164:167], 0
    ds_read_b64_tr_b16 v[38:39], v4 offset:17408
    v_mfma_f32_16x16x32_bf16 v[152:155], v[44:47], v[160:163], 0
    ds_read_b64_tr_b16 v[40:41], v5 offset:16384
    v_mfma_f32_16x16x32_bf16 v[156:159], v[44:47], v[164:167], 0
    ds_read_b64_tr_b16 v[42:43], v5 offset:17408
    s_waitcnt lgkmcnt(10)
    v_mfma_f32_16x16x32_bf16 v[64:67], v[48:51], v[168:171], v[64:67]
    ds_read_b64_tr_b16 v[44:45], v6 offset:16384
    v_mfma_f32_16x16x32_bf16 v[68:71], v[48:51], v[172:175], v[68:71]
    ds_read_b64_tr_b16 v[46:47], v6 offset:17408
    v_mfma_f32_16x16x32_bf16 v[72:75], v[52:55], v[168:171], v[72:75]
    ds_read_b64_tr_b16 v[48:49], v3 offset:20480
    v_mfma_f32_16x16x32_bf16 v[76:79], v[52:55], v[172:175], v[76:79]
    ds_read_b64_tr_b16 v[50:51], v3 offset:21504
    s_waitcnt lgkmcnt(10)
    v_mfma_f32_16x16x32_bf16 v[80:83], v[56:59], v[168:171], v[80:83]
    ds_read_b64_tr_b16 v[52:53], v4 offset:20480
    v_mfma_f32_16x16x32_bf16 v[84:87], v[56:59], v[172:175], v[84:87]
    ds_read_b64_tr_b16 v[54:55], v4 offset:21504
    v_mfma_f32_16x16x32_bf16 v[88:91], v[60:63], v[168:171], v[88:91]
    ds_read_b64_tr_b16 v[56:57], v5 offset:20480
    v_mfma_f32_16x16x32_bf16 v[92:95], v[60:63], v[172:175], v[92:95]
    ds_read_b64_tr_b16 v[58:59], v5 offset:21504
    s_waitcnt lgkmcnt(10)
    v_mfma_f32_16x16x32_bf16 v[96:99], v[168:171], v[32:35], v[96:99]
    ds_read_b64_tr_b16 v[60:61], v6 offset:20480
    v_mfma_f32_16x16x32_bf16 v[100:103], v[172:175], v[32:35], v[100:103]
    ds_read_b64_tr_b16 v[62:63], v6 offset:21504
    v_mfma_f32_16x16x32_bf16 v[104:107], v[168:171], v[36:39], v[104:107]
    ds_read_b64_tr_b16 v[32:33], v3 offset:24576
    v_mfma_f32_16x16x32_bf16 v[108:111], v[172:175], v[36:39], v[108:111]
    ds_read_b64_tr_b16 v[34:35], v3 offset:25600
    s_waitcnt lgkmcnt(10)
    v_mfma_f32_16x16x32_bf16 v[112:115], v[168:171], v[40:43], v[112:115]
    ds_read_b64_tr_b16 v[36:37], v4 offset:24576
    v_mfma_f32_16x16x32_bf16 v[116:119], v[172:175], v[40:43], v[116:119]
    ds_read_b64_tr_b16 v[38:39], v4 offset:25600
    v_mfma_f32_16x16x32_bf16 v[120:123], v[168:171], v[44:47], v[120:123]
    ds_read_b64_tr_b16 v[40:41], v5 offset:24576
    v_mfma_f32_16x16x32_bf16 v[124:127], v[172:175], v[44:47], v[124:127]
    ds_read_b64_tr_b16 v[42:43], v5 offset:25600
    s_waitcnt lgkmcnt(10)
    v_mfma_f32_16x16x32_bf16 v[128:131], v[48:51], v[168:171], v[128:131]
    ds_read_b64_tr_b16 v[44:45], v6 offset:24576
    v_mfma_f32_16x16x32_bf16 v[132:135], v[48:51], v[172:175], v[132:135]
    ds_read_b64_tr_b16 v[46:47], v6 offset:25600
    v_mfma_f32_16x16x32_bf16 v[136:139], v[52:55], v[168:171], v[136:139]
    ds_read_b64_tr_b16 v[48:49], v3 offset:28672
    v_mfma_f32_16x16x32_bf16 v[140:143], v[52:55], v[172:175], v[140:143]
    ds_read_b64_tr_b16 v[50:51], v3 offset:29696
    s_waitcnt lgkmcnt(10)
    v_mfma_f32_16x16x32_bf16 v[144:147], v[56:59], v[168:171], v[144:147]
    ds_read_b64_tr_b16 v[52:53], v4 offset:28672
    v_mfma_f32_16x16x32_bf16 v[148:151], v[56:59], v[172:175], v[148:151]
    ds_read_b64_tr_b16 v[54:55], v4 offset:29696
    v_mfma_f32_16x16x32_bf16 v[152:155], v[60:63], v[168:171], v[152:155]
    ds_read_b64_tr_b16 v[56:57], v5 offset:28672
    v_mfma_f32_16x16x32_bf16 v[156:159], v[60:63], v[172:175], v[156:159]
    ds_read_b64_tr_b16 v[58:59], v5 offset:29696
    s_cbranch_vccnz c_st1
c_st2:
    s_waitcnt vmcnt(8) lgkmcnt(10)
    v_mfma_f32_16x16x32_bf16 v[64:67], v[32:35], v[176:179], v[64:67]
    ds_read_b64_tr_b16 v[60:61], v6 offset:28672
    v_mfma_f32_16x16x32_bf16 v[68:71], v[32:35], v[180:183], v[68:71]
    ds_read_b64_tr_b16 v[62:63], v6 offset:29696
    s_barrier
    v_mfma_f32_16x16x32_bf16 v[72:75], v[36:39], v[176:179], v[72:75]
    ds_read_b64_tr_b16 v[32:33], v3 offset:32768
    v_mfma_f32_16x16x32_bf16 v[76:79], v[36:39], v[180:183], v[76:79]
    ds_read_b64_tr_b16 v[34:35], v3 offset:33792
    s_waitcnt lgkmcnt(10)
    v_mfma_f32_16x16x32_bf16 v[80:83], v[40:43], v[176:179], v[80:83]
    ds_read_b64_tr_b16 v[36:37], v4 offset:32768
    v_mfma_f32_16x16x32_bf16 v[84:87], v[40:43], v[180:183], v[84:87]
    ds_read_b64_tr_b16 v[38:39], v4 offset:33792
    v_mfma_f32_16x16x32_bf16 v[88:91], v[44:47], v[176:179], v[88:91]
    ds_read_b64_tr_b16 v[40:41], v5 offset:32768
    v_mfma_f32_16x16x32_bf16 v[92:95], v[44:47], v[180:183], v[92:95]
    ds_read_b64_tr_b16 v[42:43], v5 offset:33792
    s_waitcnt lgkmcnt(10)
    v_mfma_f32_16x16x32_bf16 v[96:99], v[176:179], v[48:51], v[96:99]
    ds_read_b64_tr_b16 v[44:45], v6 offset:32768
    v_mfma_f32_16x16x32_bf16 v[100:103], v[180:183], v[48:51], v[100:103]
    ds_read_b64_tr_b16 v[46:47], v6 offset:33792
    v_mfma_f32_16x16x32_bf16 v[104:107], v[176:179], v[52:55], v[104:107]
    ds_read_b64_tr_b16 v[48:49], v3 offset:36864
    v_mfma_f32_16x16x32_bf16 v[108:111], v[180:183], v[52:55], v[108:111]
    ds_read_b64_tr_b16 v[50:51], v3 offset:37888
    s_waitcnt lgkmcnt(10)
    v_mfma_f32_16x16x32_bf16 v[112:115], v[176:179], v[56:59], v[112:115]
    ds_read_b64_tr_b16 v[52:53], v4 offset:36864
    v_mfma_f32_16x16x32_bf16 v[116:119], v[180:183], v[56:59], v[116:119]
    ds_read_b64_tr_b16 v[54:55], v4 offset:37888
    v_mfma_f32_16x16x32_bf16 v[120:123], v[176:179], v[60:63], v[120:123]
    ds_read_b64_tr_b16 v[56:57], v5 offset:36864
    v_mfma_f32_16x16x32_bf16 v[124:127], v[180:183], v[60:63], v[124:127]
    ds_read_b64_tr_b16 v[58:59], v5 offset:37888
    s_waitcnt lgkmcnt(10)
    v_mfma_f32_16x16x32_bf16 v[128:131], v[32:35], v[176:179], v[128:131]
    ds_read_b64_tr_b16 v[60:61], v6 offset:36864
    v_mfma_f32_16x16x32_bf16 v[132:135], v[32:35], v[180:183], v[132:135]
    ds_read_b64_tr_b16 v[62:63], v6 offset:37888
    v_mfma_f32_16x16x32_bf16 v[136:139], v[36:39], v[176:179], v[136:139]
    ds_read_b64_tr_b16 v[32:33], v3 offset:40960
    v_mfma_f32_16x16x32_bf16 v[140:143], v[36:39], v[180:183], v[140:143]
    ds_read_b64_tr_b16 v[34:35], v3 offset:41984
    s_waitcnt lgkmcnt(10)
    v_mfma_f32_16x16x32_bf16 v[144:147], v[40:43], v[176:179], v[144:147]
    ds_read_b64_tr_b16 v[36:37], v4 offset:40960
    v_mfma_f32_16x16x32_bf16 v[148:151], v[40:43], v[180:183], v[148:151]
    ds_read_b64_tr_b16 v[38:39], v4 offset:41984
    v_mfma_f32_16x16x32_bf16 v[152:155], v[44:47], v[176:179], v[152:155]
    ds_read_b64_tr_b16 v[40:41], v5 offset:40960
    v_mfma_f32_16x16x32_bf16 v[156:159], v[44:47], v[180:183], v[156:159]
    ds_read_b64_tr_b16 v[42:43], v5 offset:41984
    s_waitcnt vmcnt(6) lgkmcnt(10)
    v_mfma_f32_16x16x32_bf16 v[64:67], v[48:51], v[184:187], v[64:67]
    s_add_u32 s42, s41, s87
    s_cbranch_vccnz xs1
    buffer_load_dwordx4 v[216:219], v2, s[4:7], s42 offen offset:2048 sc1
xs1:
    ds_read_b64_tr_b16 v[44:45], v6 offset:40960
    v_mfma_f32_16x16x32_bf16 v[68:71], v[48:51], v[188:191], v[68:71]
    ds_read_b64_tr_b16 v[46:47], v6 offset:41984
    v_mfma_f32_16x16x32_bf16 v[72:75], v[52:55], v[184:187], v[72:75]
    s_cbranch_vccnz xs2
    buffer_load_dwordx4 v[220:223], v2, s[4:7], s42 offen offset:2304 sc1
xs2:
    ds_read_b64_tr_b16 v[48:49], v3 offset:45056
    s_add_u32 s42, s41, s88
    v_mfma_f32_16x16x32_bf16 v[76:79], v[52:55], v[188:191], v[76:79]
    ds_read_b64_tr_b16 v[50:51], v3 offset:46080
    s_waitcnt lgkmcnt(10)
    v_mfma_f32_16x16x32_bf16 v[80:83], v[56:59], v[184:187], v[80:83]
    s_cbranch_vccnz xs3
    buffer_load_dwordx4 v[224:227], v2, s[4:7], s42 offen offset:0 sc1
xs3:
    ds_read_b64_tr_b16 v[52:53], v4 offset:45056
    v_mfma_f32_16x16x32_bf16 v[84:87], v[56:59], v[188:191], v[84:87]
    ds_read_b64_tr_b16 v[54:55], v4 offset:46080
    v_mfma_f32_16x16x32_bf16 v[88:91], v[60:63], v[184:187], v[88:91]
    s_cbranch_vccnz xs4
    buffer_load_dwordx4 v[228:231], v2, s[4:7], s42 offen offset:256 sc1
xs4:
    ds_read_b64_tr_b16 v[56:57], v5 offset:45056
    v_mfma_f32_16x16x32_bf16 v[92:95], v[60:63], v[188:191], v[92:95]
    ds_read_b64_tr_b16 v[58:59], v5 offset:46080
    s_waitcnt lgkmcnt(10)
    v_mfma_f32_16x16x32_bf16 v[96:99], v[184:187], v[32:35], v[96:99]
    ds_read_b64_tr_b16 v[60:61], v6 offset:45056
    s_cbranch_vccnz xs5
    buffer_load_dwordx4 v[232:235], v2, s[4:7], s42 offen offset:2048 sc1
xs5:
    s_cbranch_vccnz c_cs1
c_cs2:
    v_mfma_f32_16x16x32_bf16 v[100:103], v[188:191], v[32:35], v[100:103]
    ds_read_b64_tr_b16 v[62:63], v6 offset:46080
    v_mfma_f32_16x16x32_bf16 v[104:107], v[184:187], v[36:39], v[104:107]
    s_cbranch_vccnz xs6
    buffer_load_dwordx4 v[236:239], v2, s[4:7], s42 offen offset:2304 sc1
xs6:
    ds_read_b64_tr_b16 v[32:33], v3 offset:49152
    s_add_u32 s42, s41, s89
    v_mfma_f32_16x16x32_bf16 v[108:111], v[188:191], v[36:39], v[108:111]
    ds_read_b64_tr_b16 v[34:35], v3 offset:50176
    s_waitcnt lgkmcnt(10)
    v_mfma_f32_16x16x32_bf16 v[112:115], v[184:187], v[40:43], v[112:115]
    ds_read_b64_tr_b16 v[36:37], v4 offset:49152
    v_mfma_f32_16x16x32_bf16 v[116:119], v[188:191], v[40:43], v[116:119]
    ds_read_b64_tr_b16 v[38:39], v4 offset:50176
    v_mfma_f32_16x16x32_bf16 v[120:123], v[184:187], v[44:47], v[120:123]
    ds_read_b64_tr_b16 v[40:41], v5 offset:49152
    v_mfma_f32_16x16x32_bf16 v[124:127], v[188:191], v[44:47], v[124:127]
    ds_read_b64_tr_b16 v[42:43], v5 offset:50176
    s_waitcnt lgkmcnt(10)
    v_mfma_f32_16x16x32_bf16 v[128:131], v[48:51], v[184:187], v[128:131]
    ds_read_b64_tr_b16 v[44:45], v6 offset:49152
    v_mfma_f32_16x16x32_bf16 v[132:135], v[48:51], v[188:191], v[132:135]
    ds_read_b64_tr_b16 v[46:47], v6 offset:50176
    v_mfma_f32_16x16x32_bf16 v[136:139], v[52:55], v[184:187], v[136:139]
    ds_read_b64_tr_b16 v[48:49], v3 offset:53248
    v_mfma_f32_16x16x32_bf16 v[140:143], v[52:55], v[188:191], v[140:143]
    ds_read_b64_tr_b16 v[50:51], v3 offset:54272
    s_waitcnt lgkmcnt(10)
    v_mfma_f32_16x16x32_bf16 v[144:147], v[56:59], v[184:187], v[144:147]
    ds_read_b64_tr_b16 v[52:53], v4 offset:53248
    v_mfma_f32_16x16x32_bf16 v[148:151], v[56:59], v[188:191], v[148:151]
    ds_read_b64_tr_b16 v[54:55], v4 offset:54272
    v_mfma_f32_16x16x32_bf16 v[152:155], v[60:63], v[184:187], v[152:155]
    ds_read_b64_tr_b16 v[56:57], v5 offset:53248
    v_mfma_f32_16x16x32_bf16 v[156:159], v[60:63], v[188:191], v[156:159]
    ds_read_b64_tr_b16 v[58:59], v5 offset:54272
    s_waitcnt vmcnt(10) lgkmcnt(10)
    v_mfma_f32_16x16x32_bf16 v[64:67], v[32:35], v[192:195], v[64:67]
    ds_read_b64_tr_b16 v[60:61], v6 offset:53248
    v_mfma_f32_16x16x32_bf16 v[68:71], v[32:35], v[196:199], v[68:71]
    ds_read_b64_tr_b16 v[62:63], v6 offset:54272
    v_mfma_f32_16x16x32_bf16 v[72:75], v[36:39], v[192:195], v[72:75]
    ds_read_b64_tr_b16 v[32:33], v3 offset:57344
    v_mfma_f32_16x16x32_bf16 v[76:79], v[36:39], v[196:199], v[76:79]
    ds_read_b64_tr_b16 v[34:35], v3 offset:58368
    s_waitcnt lgkmcnt(10)
    v_mfma_f32_16x16x32_bf16 v[80:83], v[40:43], v[192:195], v[80:83]
    ds_read_b64_tr_b16 v[36:37], v4 offset:57344
    v_mfma_f32_16x16x32_bf16 v[84:87], v[40:43], v[196:199], v[84:87]
    ds_read_b64_tr_b16 v[38:39], v4 offset:58368
    v_mfma_f32_16x16x32_bf16 v[88:91], v[44:47], v[192:195], v[88:91]
    ds_read_b64_tr_b16 v[40:41], v5 offset:57344
    v_mfma_f32_16x16x32_bf16 v[92:95], v[44:47], v[196:199], v[92:95]
    ds_read_b64_tr_b16 v[42:43], v5 offset:58368
    s_waitcnt lgkmcnt(10)
    v_mfma_f32_16x16x32_bf16 v[96:99], v[192:195], v[48:51], v[96:99]
    ds_read_b64_tr_b16 v[44:45], v6 offset:57344
    v_mfma_f32_16x16x32_bf16 v[100:103], v[196:199], v[48:51], v[100:103]
    ds_read_b64_tr_b16 v[46:47], v6 offset:58368
    v_mfma_f32_16x16x32_bf16 v[104:107], v[192:195], v[52:55], v[104:107]
    ds_read_b64_tr_b16 v[48:49], v3 offset:61440
    v_mfma_f32_16x16x32_bf16 v[108:111], v[196:199], v[52:55], v[108:111]
    ds_read_b64_tr_b16 v[50:51], v3 offset:62464
    s_waitcnt lgkmcnt(10)
    v_mfma_f32_16x16x32_bf16 v[112:115], v[192:195], v[56:59], v[112:115]
    ds_read_b64_tr_b16 v[52:53], v4 offset:61440
    v_mfma_f32_16x16x32_bf16 v[116:119], v[196:199], v[56:59], v[116:119]
    ds_read_b64_tr_b16 v[54:55], v4 offset:62464
    v_mfma_f32_16x16x32_bf16 v[120:123], v[192:195], v[60:63], v[120:123]
    ds_read_b64_tr_b16 v[56:57], v5 offset:61440
    v_mfma_f32_16x16x32_bf16 v[124:127], v[196:199], v[60:63], v[124:127]
    ds_read_b64_tr_b16 v[58:59], v5 offset:62464
    s_waitcnt lgkmcnt(10)
    v_mfma_f32_16x16x32_bf16 v[128:131], v[32:35], v[192:195], v[128:131]
    ds_read_b64_tr_b16 v[60:61], v6 offset:61440
    v_mfma_f32_16x16x32_bf16 v[132:135], v[32:35], v[196:199], v[132:135]
    ds_read_b64_tr_b16 v[62:63], v6 offset:62464
    s_barrier
    v_xor_b32 v3, 0x10000, v3
    v_xor_b32 v4, 0x10000, v4
    v_xor_b32 v5, 0x10000, v5
    v_xor_b32 v6, 0x10000, v6
    v_mfma_f32_16x16x32_bf16 v[136:139], v[36:39], v[192:195], v[136:139]
    ds_read_b64_tr_b16 v[32:33], v3 offset:0
    v_mfma_f32_16x16x32_bf16 v[140:143], v[36:39], v[196:199], v[140:143]
    ds_read_b64_tr_b16 v[34:35], v3 offset:1024
    s_waitcnt lgkmcnt(10)
    v_mfma_f32_16x16x32_bf16 v[144:147], v[40:43], v[192:195], v[144:147]
    ds_read_b64_tr_b16 v[36:37], v4 offset:0
    v_mfma_f32_16x16x32_bf16 v[148:151], v[40:43], v[196:199], v[148:151]
    ds_read_b64_tr_b16 v[38:39], v4 offset:1024
    v_mfma_f32_16x16x32_bf16 v[152:155], v[44:47], v[192:195], v[152:155]
    ds_read_b64_tr_b16 v[40:41], v5 offset:0
    v_mfma_f32_16x16x32_bf16 v[156:159], v[44:47], v[196:199], v[156:159]
    ds_read_b64_tr_b16 v[42:43], v5 offset:1024
    s_waitcnt vmcnt(8) lgkmcnt(10)
    v_mfma_f32_16x16x32_bf16 v[64:67], v[48:51], v[200:203], v[64:67]
    ds_read_b64_tr_b16 v[44:45], v6 offset:0
    v_mfma_f32_16x16x32_bf16 v[68:71], v[48:51], v[204:207], v[68:71]
    ds_read_b64_tr_b16 v[46:47], v6 offset:1024
    v_mfma_f32_16x16x32_bf16 v[72:75], v[52:55], v[200:203], v[72:75]
    ds_read_b64_tr_b16 v[48:49], v3 offset:4096
    v_mfma_f32_16x16x32_bf16 v[76:79], v[52:55], v[204:207], v[76:79]
    ds_read_b64_tr_b16 v[50:51], v3 offset:5120
    s_waitcnt lgkmcnt(10)
    v_mfma_f32_16x16x32_bf16 v[80:83], v[56:59], v[200:203], v[80:83]
    ds_read_b64_tr_b16 v[52:53], v4 offset:4096
    v_mfma_f32_16x16x32_bf16 v[84:87], v[56:59], v[204:207], v[84:87]
    ds_read_b64_tr_b16 v[54:55], v4 offset:5120
    v_mfma_f32_16x16x32_bf16 v[88:91], v[60:63], v[200:203], v[88:91]
    ds_read_b64_tr_b16 v[56:57], v5 offset:4096
    v_mfma_f32_16x16x32_bf16 v[92:95], v[60:63], v[204:207], v[92:95]
    ds_read_b64_tr_b16 v[58:59], v5 offset:5120
    s_waitcnt lgkmcnt(10)
    v_mfma_f32_16x16x32_bf16 v[96:99], v[200:203], v[32:35], v[96:99]
    ds_read_b64_tr_b16 v[60:61], v6 offset:4096
    v_mfma_f32_16x16x32_bf16 v[100:103], v[204:207], v[32:35], v[100:103]
    ds_read_b64_tr_b16 v[62:63], v6 offset:5120
    v_mfma_f32_16x16x32_bf16 v[104:107], v[200:203], v[36:39], v[104:107]
    ds_read_b64_tr_b16 v[32:33], v3 offset:8192
    v_mfma_f32_16x16x32_bf16 v[108:111], v[204:207], v[36:39], v[108:111]
    ds_read_b64_tr_b16 v[34:35], v3 offset:9216
    s_waitcnt lgkmcnt(10)
    v_mfma_f32_16x16x32_bf16 v[112:115], v[200:203], v[40:43], v[112:115]
    ds_read_b64_tr_b16 v[36:37], v4 offset:8192
    v_mfma_f32_16x16x32_bf16 v[116:119], v[204:207], v[40:43], v[116:119]
    ds_read_b64_tr_b16 v[38:39], v4 offset:9216
    v_mfma_f32_16x16x32_bf16 v[120:123], v[200:203], v[44:47], v[120:123]
    ds_read_b64_tr_b16 v[40:41], v5 offset:8192
    v_mfma_f32_16x16x32_bf16 v[124:127], v[204:207], v[44:47], v[124:127]
    ds_read_b64_tr_b16 v[42:43], v5 offset:9216
    s_waitcnt lgkmcnt(10)
    v_mfma_f32_16x16x32_bf16 v[128:131], v[48:51], v[200:203], v[128:131]
    ds_read_b64_tr_b16 v[44:45], v6 offset:8192
    v_mfma_f32_16x16x32_bf16 v[132:135], v[48:51], v[204:207], v[132:135]
    ds_read_b64_tr_b16 v[46:47], v6 offset:9216
    v_mfma_f32_16x16x32_bf16 v[136:139], v[52:55], v[200:203], v[136:139]
    ds_read_b64_tr_b16 v[48:49], v3 offset:12288
    v_mfma_f32_16x16x32_bf16 v[140:143], v[52:55], v[204:207], v[140:143]
    ds_read_b64_tr_b16 v[50:51], v3 offset:13312
    s_waitcnt lgkmcnt(10)
    v_mfma_f32_16x16x32_bf16 v[144:147], v[56:59], v[200:203], v[144:147]
    ds_read_b64_tr_b16 v[52:53], v4 offset:12288
    v_mfma_f32_16x16x32_bf16 v[148:151], v[56:59], v[204:207], v[148:151]
    ds_read_b64_tr_b16 v[54:55], v4 offset:13312
    v_mfma_f32_16x16x32_bf16 v[152:155], v[60:63], v[200:203], v[152:155]
    ds_read_b64_tr_b16 v[56:57], v5 offset:12288
    v_mfma_f32_16x16x32_bf16 v[156:159], v[60:63], v[204:207], v[156:159]
    ds_read_b64_tr_b16 v[58:59], v5 offset:13312
    s_waitcnt vmcnt(6) lgkmcnt(10)
    v_mfma_f32_16x16x32_bf16 v[64:67], v[32:35], v[208:211], v[64:67]
    ds_read_b64_tr_b16 v[60:61], v6 offset:12288
    v_mfma_f32_16x16x32_bf16 v[68:71], v[32:35], v[212:215], v[68:71]
    ds_read_b64_tr_b16 v[62:63], v6 offset:13312
    v_mfma_f32_16x16x32_bf16 v[72:75], v[36:39], v[208:211], v[72:75]
    ds_read_b64_tr_b16 v[32:33], v3 offset:16384
    v_mfma_f32_16x16x32_bf16 v[76:79], v[36:39], v[212:215], v[76:79]
    ds_read_b64_tr_b16 v[34:35], v3 offset:17408
    s_waitcnt lgkmcnt(10)
    v_mfma_f32_16x16x32_bf16 v[80:83], v[40:43], v[208:211], v[80:83]
    ds_read_b64_tr_b16 v[36:37], v4 offset:16384
    v_mfma_f32_16x16x32_bf16 v[84:87], v[40:43], v[212:215], v[84:87]
    ds_read_b64_tr_b16 v[38:39], v4 offset:17408
    v_mfma_f32_16x16x32_bf16 v[88:91], v[44:47], v[208:211], v[88:91]
    ds_read_b64_tr_b16 v[40:41], v5 offset:16384
    v_mfma_f32_16x16x32_bf16 v[92:95], v[44:47], v[212:215], v[92:95]
    ds_read_b64_tr_b16 v[42:43], v5 offset:17408
    s_waitcnt lgkmcnt(10)
    v_mfma_f32_16x16x32_bf16 v[96:99], v[208:211], v[48:51], v[96:99]
    buffer_load_dwordx4 v[240:243], v2, s[4:7], s42 offen offset:0 sc1
    ds_read_b64_tr_b16 v[44:45], v6 offset:16384
    v_mfma_f32_16x16x32_bf16 v[100:103], v[212:215], v[48:51], v[100:103]
    ds_read_b64_tr_b16 v[46:47], v6 offset:17408
    v_mfma_f32_16x16x32_bf16 v[104:107], v[208:211], v[52:55], v[104:107]
    buffer_load_dwordx4 v[244:247], v2, s[4:7], s42 offen offset:256 sc1
    ds_read_b64_tr_b16 v[48:49], v3 offset:20480
    v_mfma_f32_16x16x32_bf16 v[108:111], v[212:215], v[52:55], v[108:111]
    ds_read_b64_tr_b16 v[50:51], v3 offset:21504
    s_waitcnt lgkmcnt(10)
    v_mfma_f32_16x16x32_bf16 v[112:115], v[208:211], v[56:59], v[112:115]
    buffer_load_dwordx4 v[248:251], v2, s[4:7], s42 offen offset:2048 sc1
    ds_read_b64_tr_b16 v[52:53], v4 offset:20480
    v_mfma_f32_16x16x32_bf16 v[116:119], v[212:215], v[56:59], v[116:119]
    ds_read_b64_tr_b16 v[54:55], v4 offset:21504
    v_mfma_f32_16x16x32_bf16 v[120:123], v[208:211], v[60:63], v[120:123]
    buffer_load_dwordx4 v[252:255], v2, s[4:7], s42 offen offset:2304 sc1
    ds_read_b64_tr_b16 v[56:57], v5 offset:20480
    s_add_u32 s42, s41, s90
    v_mfma_f32_16x16x32_bf16 v[124:127], v[212:215], v[60:63], v[124:127]
    ds_read_b64_tr_b16 v[58:59], v5 offset:21504
    s_waitcnt lgkmcnt(10)
    v_mfma_f32_16x16x32_bf16 v[128:131], v[32:35], v[208:211], v[128:131]
    ds_read_b64_tr_b16 v[60:61], v6 offset:20480
    buffer_load_dwordx4 v[160:163], v2, s[4:7], s42 offen offset:0 sc1
    v_mfma_f32_16x16x32_bf16 v[132:135], v[32:35], v[212:215], v[132:135]
    ds_read_b64_tr_b16 v[62:63], v6 offset:21504
    v_mfma_f32_16x16x32_bf16 v[136:139], v[36:39], v[208:211], v[136:139]
    buffer_load_dwordx4 v[164:167], v2, s[4:7], s42 offen offset:256 sc1
    ds_read_b64_tr_b16 v[32:33], v3 offset:24576
    v_mfma_f32_16x16x32_bf16 v[140:143], v[36:39], v[212:215], v[140:143]
    ds_read_b64_tr_b16 v[34:35], v3 offset:25600
    s_waitcnt lgkmcnt(10)
    v_mfma_f32_16x16x32_bf16 v[144:147], v[40:43], v[208:211], v[144:147]
    buffer_load_dwordx4 v[168:171], v2, s[4:7], s42 offen offset:2048 sc1
    ds_read_b64_tr_b16 v[36:37], v4 offset:24576
    v_mfma_f32_16x16x32_bf16 v[148:151], v[40:43], v[212:215], v[148:151]
    ds_read_b64_tr_b16 v[38:39], v4 offset:25600
    v_mfma_f32_16x16x32_bf16 v[152:155], v[44:47], v[208:211], v[152:155]
    buffer_load_dwordx4 v[172:175], v2, s[4:7], s42 offen offset:2304 sc1
    ds_read_b64_tr_b16 v[40:41], v5 offset:24576
    s_add_u32 s42, s41, s91
    v_mfma_f32_16x16x32_bf16 v[156:159], v[44:47], v[212:215], v[156:159]
    ds_read_b64_tr_b16 v[42:43], v5 offset:25600
    s_waitcnt vmcnt(12) lgkmcnt(10)
    v_mfma_f32_16x16x32_bf16 v[64:67], v[48:51], v[216:219], v[64:67]
    buffer_load_dwordx4 v[176:179], v2, s[4:7], s42 offen offset:0 sc1
    ds_read_b64_tr_b16 v[44:45], v6 offset:24576
    v_mfma_f32_16x16x32_bf16 v[68:71], v[48:51], v[220:223], v[68:71]
    ds_read_b64_tr_b16 v[46:47], v6 offset:25600
    v_mfma_f32_16x16x32_bf16 v[72:75], v[52:55], v[216:219], v[72:75]
    buffer_load_dwordx4 v[180:183], v2, s[4:7], s42 offen offset:256 sc1
    ds_read_b64_tr_b16 v[48:49], v3 offset:28672
    v_mfma_f32_16x16x32_bf16 v[76:79], v[52:55], v[220:223], v[76:79]
    ds_read_b64_tr_b16 v[50:51], v3 offset:29696
    s_waitcnt lgkmcnt(10)
    v_mfma_f32_16x16x32_bf16 v[80:83], v[56:59], v[216:219], v[80:83]
    buffer_load_dwordx4 v[184:187], v2, s[4:7], s42 offen offset:2048 sc1
    ds_read_b64_tr_b16 v[52:53], v4 offset:28672
    v_mfma_f32_16x16x32_bf16 v[84:87], v[56:59], v[220:223], v[84:87]
    ds_read_b64_tr_b16 v[54:55], v4 offset:29696
    v_mfma_f32_16x16x32_bf16 v[88:91], v[60:63], v[216:219], v[88:91]
    buffer_load_dwordx4 v[188:191], v2, s[4:7], s42 offen offset:2304 sc1
    ds_read_b64_tr_b16 v[56:57], v5 offset:28672
    s_add_u32 s42, s41, s92
    v_mfma_f32_16x16x32_bf16 v[92:95], v[60:63], v[220:223], v[92:95]
    ds_read_b64_tr_b16 v[58:59], v5 offset:29696
    s_waitcnt lgkmcnt(10)
    v_mfma_f32_16x16x32_bf16 v[96:99], v[216:219], v[32:35], v[96:99]
    ds_read_b64_tr_b16 v[60:61], v6 offset:28672
    v_mfma_f32_16x16x32_bf16 v[100:103], v[220:223], v[32:35], v[100:103]
    ds_read_b64_tr_b16 v[62:63], v6 offset:29696
    s_barrier
    v_mfma_f32_16x16x32_bf16 v[104:107], v[216:219], v[36:39], v[104:107]
    ds_read_b64_tr_b16 v[32:33], v3 offset:32768
    v_mfma_f32_16x16x32_bf16 v[108:111], v[220:223], v[36:39], v[108:111]
    ds_read_b64_tr_b16 v[34:35], v3 offset:33792
    s_waitcnt lgkmcnt(10)
    v_mfma_f32_16x16x32_bf16 v[112:115], v[216:219], v[40:43], v[112:115]
    ds_read_b64_tr_b16 v[36:37], v4 offset:32768
    v_mfma_f32_16x16x32_bf16 v[116:119], v[220:223], v[40:43], v[116:119]
    ds_read_b64_tr_b16 v[38:39], v4 offset:33792
    v_mfma_f32_16x16x32_bf16 v[120:123], v[216:219], v[44:47], v[120:123]
    ds_read_b64_tr_b16 v[40:41], v5 offset:32768
    v_mfma_f32_16x16x32_bf16 v[124:127], v[220:223], v[44:47], v[124:127]
    ds_read_b64_tr_b16 v[42:43], v5 offset:33792
    s_waitcnt lgkmcnt(10)
    v_mfma_f32_16x16x32_bf16 v[128:131], v[48:51], v[216:219], v[128:131]
    ds_read_b64_tr_b16 v[44:45], v6 offset:32768
    v_mfma_f32_16x16x32_bf16 v[132:135], v[48:51], v[220:223], v[132:135]
    ds_read_b64_tr_b16 v[46:47], v6 offset:33792
    v_mfma_f32_16x16x32_bf16 v[136:139], v[52:55], v[216:219], v[136:139]
    ds_read_b64_tr_b16 v[48:49], v3 offset:36864
    v_mfma_f32_16x16x32_bf16 v[140:143], v[52:55], v[220:223], v[140:143]
    ds_read_b64_tr_b16 v[50:51], v3 offset:37888
    s_waitcnt lgkmcnt(10)
    v_mfma_f32_16x16x32_bf16 v[144:147], v[56:59], v[216:219], v[144:147]
    ds_read_b64_tr_b16 v[52:53], v4 offset:36864
    v_mfma_f32_16x16x32_bf16 v[148:151], v[56:59], v[220:223], v[148:151]
    ds_read_b64_tr_b16 v[54:55], v4 offset:37888
    v_mfma_f32_16x16x32_bf16 v[152:155], v[60:63], v[216:219], v[152:155]
    ds_read_b64_tr_b16 v[56:57], v5 offset:36864
    v_mfma_f32_16x16x32_bf16 v[156:159], v[60:63], v[220:223], v[156:159]
    ds_read_b64_tr_b16 v[58:59], v5 offset:37888
    s_waitcnt vmcnt(14) lgkmcnt(10)
    v_mfma_f32_16x16x32_bf16 v[64:67], v[32:35], v[224:227], v[64:67]
    ds_read_b64_tr_b16 v[60:61], v6 offset:36864
    v_mfma_f32_16x16x32_bf16 v[68:71], v[32:35], v[228:231], v[68:71]
    ds_read_b64_tr_b16 v[62:63], v6 offset:37888
    v_mfma_f32_16x16x32_bf16 v[72:75], v[36:39], v[224:227], v[72:75]
    ds_read_b64_tr_b16 v[32:33], v3 offset:40960
    v_mfma_f32_16x16x32_bf16 v[76:79], v[36:39], v[228:231], v[76:79]
    ds_read_b64_tr_b16 v[34:35], v3 offset:41984
    s_waitcnt lgkmcnt(10)
    v_mfma_f32_16x16x32_bf16 v[80:83], v[40:43], v[224:227], v[80:83]
    ds_read_b64_tr_b16 v[36:37], v4 offset:40960
    v_mfma_f32_16x16x32_bf16 v[84:87], v[40:43], v[228:231], v[84:87]
    ds_read_b64_tr_b16 v[38:39], v4 offset:41984
    v_mfma_f32_16x16x32_bf16 v[88:91], v[44:47], v[224:227], v[88:91]
    ds_read_b64_tr_b16 v[40:41], v5 offset:40960
    v_mfma_f32_16x16x32_bf16 v[92:95], v[44:47], v[228:231], v[92:95]
    ds_read_b64_tr_b16 v[42:43], v5 offset:41984
    s_waitcnt lgkmcnt(10)
    v_mfma_f32_16x16x32_bf16 v[96:99], v[224:227], v[48:51], v[96:99]
    ds_read_b64_tr_b16 v[44:45], v6 offset:40960
    v_mfma_f32_16x16x32_bf16 v[100:103], v[228:231], v[48:51], v[100:103]
    ds_read_b64_tr_b16 v[46:47], v6 offset:41984
    v_mfma_f32_16x16x32_bf16 v[104:107], v[224:227], v[52:55], v[104:107]
    ds_read_b64_tr_b16 v[48:49], v3 offset:45056
    v_mfma_f32_16x16x32_bf16 v[108:111], v[228:231], v[52:55], v[108:111]
    ds_read_b64_tr_b16 v[50:51], v3 offset:46080
    s_waitcnt lgkmcnt(10)
    v_mfma_f32_16x16x32_bf16 v[112:115], v[224:227], v[56:59], v[112:115]
    ds_read_b64_tr_b16 v[52:53], v4 offset:45056
    v_mfma_f32_16x16x32_bf16 v[116:119], v[228:231], v[56:59], v[116:119]
    ds_read_b64_tr_b16 v[54:55], v4 offset:46080
    v_mfma_f32_16x16x32_bf16 v[120:123], v[224:227], v[60:63], v[120:123]
    ds_read_b64_tr_b16 v[56:57], v5 offset:45056
    v_mfma_f32_16x16x32_bf16 v[124:127], v[228:231], v[60:63], v[124:127]
    ds_read_b64_tr_b16 v[58:59], v5 offset:46080
    s_waitcnt lgkmcnt(10)
    v_mfma_f32_16x16x32_bf16 v[128:131], v[32:35], v[224:227], v[128:131]
    ds_read_b64_tr_b16 v[60:61], v6 offset:45056
    v_mfma_f32_16x16x32_bf16 v[132:135], v[32:35], v[228:231], v[132:135]
    ds_read_b64_tr_b16 v[62:63], v6 offset:46080
    v_mfma_f32_16x16x32_bf16 v[136:139], v[36:39], v[224:227], v[136:139]
    ds_read_b64_tr_b16 v[32:33], v3 offset:49152
    v_mfma_f32_16x16x32_bf16 v[140:143], v[36:39], v[228:231], v[140:143]
    ds_read_b64_tr_b16 v[34:35], v3 offset:50176
    s_waitcnt lgkmcnt(10)
    v_mfma_f32_16x16x32_bf16 v[144:147], v[40:43], v[224:227], v[144:147]
    ds_read_b64_tr_b16 v[36:37], v4 offset:49152
    v_mfma_f32_16x16x32_bf16 v[148:151], v[40:43], v[228:231], v[148:151]
    ds_read_b64_tr_b16 v[38:39], v4 offset:50176
    v_mfma_f32_16x16x32_bf16 v[152:155], v[44:47], v[224:227], v[152:155]
    ds_read_b64_tr_b16 v[40:41], v5 offset:49152
    v_mfma_f32_16x16x32_bf16 v[156:159], v[44:47], v[228:231], v[156:159]
    ds_read_b64_tr_b16 v[42:43], v5 offset:50176
    s_waitcnt vmcnt(12) lgkmcnt(10)
    v_mfma_f32_16x16x32_bf16 v[64:67], v[48:51], v[232:235], v[64:67]
    buffer_load_dwordx4 v[192:195], v2, s[4:7], s42 offen offset:0 sc1
    ds_read_b64_tr_b16 v[44:45], v6 offset:49152
    v_mfma_f32_16x16x32_bf16 v[68:71], v[48:51], v[236:239], v[68:71]
    ds_read_b64_tr_b16 v[46:47], v6 offset:50176
    v_mfma_f32_16x16x32_bf16 v[72:75], v[52:55], v[232:235], v[72:75]
    buffer_load_dwordx4 v[196:199], v2, s[4:7], s42 offen offset:256 sc1
    ds_read_b64_tr_b16 v[48:49], v3 offset:53248
    v_mfma_f32_16x16x32_bf16 v[76:79], v[52:55], v[236:239], v[76:79]
    ds_read_b64_tr_b16 v[50:51], v3 offset:54272
    s_waitcnt lgkmcnt(10)
    v_mfma_f32_16x16x32_bf16 v[80:83], v[56:59], v[232:235], v[80:83]
    buffer_load_dwordx4 v[200:203], v2, s[4:7], s42 offen offset:2048 sc1
    ds_read_b64_tr_b16 v[52:53], v4 offset:53248
    v_mfma_f32_16x16x32_bf16 v[84:87], v[56:59], v[236:239], v[84:87]
    ds_read_b64_tr_b16 v[54:55], v4 offset:54272
    v_mfma_f32_16x16x32_bf16 v[88:91], v[60:63], v[232:235], v[88:91]
    buffer_load_dwordx4 v[204:207], v2, s[4:7], s42 offen offset:2304 sc1
    ds_read_b64_tr_b16 v[56:57], v5 offset:53248
    s_add_u32 s42, s41, s93
    v_mfma_f32_16x16x32_bf16 v[92:95], v[60:63], v[236:239], v[92:95]
    ds_read_b64_tr_b16 v[58:59], v5 offset:54272
    s_waitcnt lgkmcnt(10)
    v_mfma_f32_16x16x32_bf16 v[96:99], v[232:235], v[32:35], v[96:99]
    ds_read_b64_tr_b16 v[60:61], v6 offset:53248
    buffer_load_dwordx4 v[208:211], v2, s[4:7], s42 offen offset:0 sc1
    v_mfma_f32_16x16x32_bf16 v[100:103], v[236:239], v[32:35], v[100:103]
    ds_read_b64_tr_b16 v[62:63], v6 offset:54272
    v_mfma_f32_16x16x32_bf16 v[104:107], v[232:235], v[36:39], v[104:107]
    ds_read_b64_tr_b16 v[32:33], v3 offset:57344
    v_mfma_f32_16x16x32_bf16 v[108:111], v[236:239], v[36:39], v[108:111]
    ds_read_b64_tr_b16 v[34:35], v3 offset:58368
    s_waitcnt lgkmcnt(10)
    v_mfma_f32_16x16x32_bf16 v[112:115], v[232:235], v[40:43], v[112:115]
    ds_read_b64_tr_b16 v[36:37], v4 offset:57344
    v_mfma_f32_16x16x32_bf16 v[116:119], v[236:239], v[40:43], v[116:119]
    ds_read_b64_tr_b16 v[38:39], v4 offset:58368
    v_mfma_f32_16x16x32_bf16 v[120:123], v[232:235], v[44:47], v[120:123]
    buffer_load_dwordx4 v[212:215], v2, s[4:7], s42 offen offset:256 sc1
    ds_read_b64_tr_b16 v[40:41], v5 offset:57344
    v_mfma_f32_16x16x32_bf16 v[124:127], v[236:239], v[44:47], v[124:127]
    ds_read_b64_tr_b16 v[42:43], v5 offset:58368
    s_waitcnt lgkmcnt(10)
    v_mfma_f32_16x16x32_bf16 v[128:131], v[48:51], v[232:235], v[128:131]
    ds_read_b64_tr_b16 v[44:45], v6 offset:57344
    v_mfma_f32_16x16x32_bf16 v[132:135], v[48:51], v[236:239], v[132:135]
    ds_read_b64_tr_b16 v[46:47], v6 offset:58368
    v_mfma_f32_16x16x32_bf16 v[136:139], v[52:55], v[232:235], v[136:139]
    ds_read_b64_tr_b16 v[48:49], v3 offset:61440
    v_mfma_f32_16x16x32_bf16 v[140:143], v[52:55], v[236:239], v[140:143]
    ds_read_b64_tr_b16 v[50:51], v3 offset:62464
    s_waitcnt lgkmcnt(10)
    v_mfma_f32_16x16x32_bf16 v[144:147], v[56:59], v[232:235], v[144:147]
    ds_read_b64_tr_b16 v[52:53], v4 offset:61440
    v_mfma_f32_16x16x32_bf16 v[148:151], v[56:59], v[236:239], v[148:151]
    ds_read_b64_tr_b16 v[54:55], v4 offset:62464
    v_mfma_f32_16x16x32_bf16 v[152:155], v[60:63], v[232:235], v[152:155]
    ds_read_b64_tr_b16 v[56:57], v5 offset:61440
    v_mfma_f32_16x16x32_bf16 v[156:159], v[60:63], v[236:239], v[156:159]
    ds_read_b64_tr_b16 v[58:59], v5 offset:62464
    s_waitcnt vmcnt(16) lgkmcnt(10)
    v_mfma_f32_16x16x32_bf16 v[64:67], v[32:35], v[240:243], v[64:67]
    ds_read_b64_tr_b16 v[60:61], v6 offset:61440
    v_mfma_f32_16x16x32_bf16 v[68:71], v[32:35], v[244:247], v[68:71]
    ds_read_b64_tr_b16 v[62:63], v6 offset:62464
    s_barrier
    v_xor_b32 v3, 0x10000, v3
    v_xor_b32 v4, 0x10000, v4
    v_xor_b32 v5, 0x10000, v5
    v_xor_b32 v6, 0x10000, v6
    v_mfma_f32_16x16x32_bf16 v[72:75], v[36:39], v[240:243], v[72:75]
    ds_read_b64_tr_b16 v[32:33], v3 offset:0
    v_mfma_f32_16x16x32_bf16 v[76:79], v[36:39], v[244:247], v[76:79]
    ds_read_b64_tr_b16 v[34:35], v3 offset:1024
    s_waitcnt lgkmcnt(10)
    v_mfma_f32_16x16x32_bf16 v[80:83], v[40:43], v[240:243], v[80:83]
    ds_read_b64_tr_b16 v[36:37], v4 offset:0
    v_mfma_f32_16x16x32_bf16 v[84:87], v[40:43], v[244:247], v[84:87]
    ds_read_b64_tr_b16 v[38:39], v4 offset:1024
    v_mfma_f32_16x16x32_bf16 v[88:91], v[44:47], v[240:243], v[88:91]
    ds_read_b64_tr_b16 v[40:41], v5 offset:0
    v_mfma_f32_16x16x32_bf16 v[92:95], v[44:47], v[244:247], v[92:95]
    ds_read_b64_tr_b16 v[42:43], v5 offset:1024
    s_waitcnt lgkmcnt(10)
    v_mfma_f32_16x16x32_bf16 v[96:99], v[240:243], v[48:51], v[96:99]
    ds_read_b64_tr_b16 v[44:45], v6 offset:0
    v_mfma_f32_16x16x32_bf16 v[100:103], v[244:247], v[48:51], v[100:103]
    ds_read_b64_tr_b16 v[46:47], v6 offset:1024
    v_mfma_f32_16x16x32_bf16 v[104:107], v[240:243], v[52:55], v[104:107]
    ds_read_b64_tr_b16 v[48:49], v3 offset:4096
    v_mfma_f32_16x16x32_bf16 v[108:111], v[244:247], v[52:55], v[108:111]
    ds_read_b64_tr_b16 v[50:51], v3 offset:5120
    s_waitcnt lgkmcnt(10)
    v_mfma_f32_16x16x32_bf16 v[112:115], v[240:243], v[56:59], v[112:115]
    ds_read_b64_tr_b16 v[52:53], v4 offset:4096
    v_mfma_f32_16x16x32_bf16 v[116:119], v[244:247], v[56:59], v[116:119]
    ds_read_b64_tr_b16 v[54:55], v4 offset:5120
    v_mfma_f32_16x16x32_bf16 v[120:123], v[240:243], v[60:63], v[120:123]
    ds_read_b64_tr_b16 v[56:57], v5 offset:4096
    v_mfma_f32_16x16x32_bf16 v[124:127], v[244:247], v[60:63], v[124:127]
    ds_read_b64_tr_b16 v[58:59], v5 offset:5120
    s_waitcnt lgkmcnt(10)
    v_mfma_f32_16x16x32_bf16 v[128:131], v[32:35], v[240:243], v[128:131]
    ds_read_b64_tr_b16 v[60:61], v6 offset:4096
    v_mfma_f32_16x16x32_bf16 v[132:135], v[32:35], v[244:247], v[132:135]
    ds_read_b64_tr_b16 v[62:63], v6 offset:5120
    v_mfma_f32_16x16x32_bf16 v[136:139], v[36:39], v[240:243], v[136:139]
    ds_read_b64_tr_b16 v[32:33], v3 offset:8192
    v_mfma_f32_16x16x32_bf16 v[140:143], v[36:39], v[244:247], v[140:143]
    ds_read_b64_tr_b16 v[34:35], v3 offset:9216
    s_waitcnt lgkmcnt(10)
    v_mfma_f32_16x16x32_bf16 v[144:147], v[40:43], v[240:243], v[144:147]
    ds_read_b64_tr_b16 v[36:37], v4 offset:8192
    v_mfma_f32_16x16x32_bf16 v[148:151], v[40:43], v[244:247], v[148:151]
    ds_read_b64_tr_b16 v[38:39], v4 offset:9216
    v_mfma_f32_16x16x32_bf16 v[152:155], v[44:47], v[240:243], v[152:155]
    ds_read_b64_tr_b16 v[40:41], v5 offset:8192
    v_mfma_f32_16x16x32_bf16 v[156:159], v[44:47], v[244:247], v[156:159]
    ds_read_b64_tr_b16 v[42:43], v5 offset:9216
    s_waitcnt vmcnt(14) lgkmcnt(10)
    v_mfma_f32_16x16x32_bf16 v[64:67], v[48:51], v[248:251], v[64:67]
    ds_read_b64_tr_b16 v[44:45], v6 offset:8192
    v_mfma_f32_16x16x32_bf16 v[68:71], v[48:51], v[252:255], v[68:71]
    ds_read_b64_tr_b16 v[46:47], v6 offset:9216
    v_mfma_f32_16x16x32_bf16 v[72:75], v[52:55], v[248:251], v[72:75]
    ds_read_b64_tr_b16 v[48:49], v3 offset:12288
    v_mfma_f32_16x16x32_bf16 v[76:79], v[52:55], v[252:255], v[76:79]
    ds_read_b64_tr_b16 v[50:51], v3 offset:13312
    s_waitcnt lgkmcnt(10)
    v_mfma_f32_16x16x32_bf16 v[80:83], v[56:59], v[248:251], v[80:83]
    ds_read_b64_tr_b16 v[52:53], v4 offset:12288
    v_mfma_f32_16x16x32_bf16 v[84:87], v[56:59], v[252:255], v[84:87]
    ds_read_b64_tr_b16 v[54:55], v4 offset:13312
    v_mfma_f32_16x16x32_bf16 v[88:91], v[60:63], v[248:251], v[88:91]
    ds_read_b64_tr_b16 v[56:57], v5 offset:12288
    v_mfma_f32_16x16x32_bf16 v[92:95], v[60:63], v[252:255], v[92:95]
    ds_read_b64_tr_b16 v[58:59], v5 offset:13312
    s_waitcnt lgkmcnt(10)
    v_mfma_f32_16x16x32_bf16 v[96:99], v[248:251], v[32:35], v[96:99]
    ds_read_b64_tr_b16 v[60:61], v6 offset:12288
    v_mfma_f32_16x16x32_bf16 v[100:103], v[252:255], v[32:35], v[100:103]
    ds_read_b64_tr_b16 v[62:63], v6 offset:13312
    v_mfma_f32_16x16x32_bf16 v[104:107], v[248:251], v[36:39], v[104:107]
    ds_read_b64_tr_b16 v[32:33], v3 offset:16384
    v_mfma_f32_16x16x32_bf16 v[108:111], v[252:255], v[36:39], v[108:111]
    ds_read_b64_tr_b16 v[34:35], v3 offset:17408
    s_waitcnt lgkmcnt(10)
    v_mfma_f32_16x16x32_bf16 v[112:115], v[248:251], v[40:43], v[112:115]
    ds_read_b64_tr_b16 v[36:37], v4 offset:16384
    v_mfma_f32_16x16x32_bf16 v[116:119], v[252:255], v[40:43], v[116:119]
    ds_read_b64_tr_b16 v[38:39], v4 offset:17408
    v_mfma_f32_16x16x32_bf16 v[120:123], v[248:251], v[44:47], v[120:123]
    ds_read_b64_tr_b16 v[40:41], v5 offset:16384
    v_mfma_f32_16x16x32_bf16 v[124:127], v[252:255], v[44:47], v[124:127]
    ds_read_b64_tr_b16 v[42:43], v5 offset:17408
    s_waitcnt lgkmcnt(10)
    v_mfma_f32_16x16x32_bf16 v[128:131], v[48:51], v[248:251], v[128:131]
    buffer_load_dwordx4 v[216:219], v2, s[4:7], s42 offen offset:2048 sc1
    ds_read_b64_tr_b16 v[44:45], v6 offset:16384
    v_mfma_f32_16x16x32_bf16 v[132:135], v[48:51], v[252:255], v[132:135]
    ds_read_b64_tr_b16 v[46:47], v6 offset:17408
    v_mfma_f32_16x16x32_bf16 v[136:139], v[52:55], v[248:251], v[136:139]
    buffer_load_dwordx4 v[220:223], v2, s[4:7], s42 offen offset:2304 sc1
    ds_read_b64_tr_b16 v[48:49], v3 offset:20480
    s_add_u32 s42, s41, s94
    v_mfma_f32_16x16x32_bf16 v[140:143], v[52:55], v[252:255], v[140:143]
    ds_read_b64_tr_b16 v[50:51], v3 offset:21504
    s_waitcnt lgkmcnt(10)
    v_mfma_f32_16x16x32_bf16 v[144:147], v[56:59], v[248:251], v[144:147]
    buffer_load_dwordx4 v[224:227], v2, s[4:7], s42 offen offset:0 sc1
    ds_read_b64_tr_b16 v[52:53], v4 offset:20480
    v_mfma_f32_16x16x32_bf16 v[148:151], v[56:59], v[252:255], v[148:151]
    ds_read_b64_tr_b16 v[54:55], v4 offset:21504
    v_mfma_f32_16x16x32_bf16 v[152:155], v[60:63], v[248:251], v[152:155]
    buffer_load_dwordx4 v[228:231], v2, s[4:7], s42 offen offset:256 sc1
    ds_read_b64_tr_b16 v[56:57], v5 offset:20480
    v_mfma_f32_16x16x32_bf16 v[156:159], v[60:63], v[252:255], v[156:159]
    ds_read_b64_tr_b16 v[58:59], v5 offset:21504
    s_waitcnt vmcnt(16) lgkmcnt(10)
    v_mfma_f32_16x16x32_bf16 v[64:67], v[32:35], v[160:163], v[64:67]
    ds_read_b64_tr_b16 v[60:61], v6 offset:20480
    buffer_load_dwordx4 v[232:235], v2, s[4:7], s42 offen offset:2048 sc1
    v_mfma_f32_16x16x32_bf16 v[68:71], v[32:35], v[164:167], v[68:71]
    ds_read_b64_tr_b16 v[62:63], v6 offset:21504
    v_mfma_f32_16x16x32_bf16 v[72:75], v[36:39], v[160:163], v[72:75]
    buffer_load_dwordx4 v[236:239], v2, s[4:7], s42 offen offset:2304 sc1
    ds_read_b64_tr_b16 v[32:33], v3 offset:24576
    s_add_u32 s42, s41, s95
    v_mfma_f32_16x16x32_bf16 v[76:79], v[36:39], v[164:167], v[76:79]
    ds_read_b64_tr_b16 v[34:35], v3 offset:25600
    s_waitcnt lgkmcnt(10)
    v_mfma_f32_16x16x32_bf16 v[80:83], v[40:43], v[160:163], v[80:83]
    ds_read_b64_tr_b16 v[36:37], v4 offset:24576
    v_mfma_f32_16x16x32_bf16 v[84:87], v[40:43], v[164:167], v[84:87]
    ds_read_b64_tr_b16 v[38:39], v4 offset:25600
    v_mfma_f32_16x16x32_bf16 v[88:91], v[44:47], v[160:163], v[88:91]
    ds_read_b64_tr_b16 v[40:41], v5 offset:24576
    v_mfma_f32_16x16x32_bf16 v[92:95], v[44:47], v[164:167], v[92:95]
    ds_read_b64_tr_b16 v[42:43], v5 offset:25600
    s_waitcnt lgkmcnt(10)
    v_mfma_f32_16x16x32_bf16 v[96:99], v[160:163], v[48:51], v[96:99]
    buffer_load_dwordx4 v[240:243], v2, s[4:7], s42 offen offset:0 sc1
    ds_read_b64_tr_b16 v[44:45], v6 offset:24576
    v_mfma_f32_16x16x32_bf16 v[100:103], v[164:167], v[48:51], v[100:103]
    ds_read_b64_tr_b16 v[46:47], v6 offset:25600
    v_mfma_f32_16x16x32_bf16 v[104:107], v[160:163], v[52:55], v[104:107]
    ds_read_b64_tr_b16 v[48:49], v3 offset:28672
    v_mfma_f32_16x16x32_bf16 v[108:111], v[164:167], v[52:55], v[108:111]
    ds_read_b64_tr_b16 v[50:51], v3 offset:29696
    s_waitcnt lgkmcnt(10)
    v_mfma_f32_16x16x32_bf16 v[112:115], v[160:163], v[56:59], v[112:115]
    ds_read_b64_tr_b16 v[52:53], v4 offset:28672
    v_mfma_f32_16x16x32_bf16 v[116:119], v[164:167], v[56:59], v[116:119]
    ds_read_b64_tr_b16 v[54:55], v4 offset:29696
    v_mfma_f32_16x16x32_bf16 v[120:123], v[160:163], v[60:63], v[120:123]
    ds_read_b64_tr_b16 v[56:57], v5 offset:28672
    v_mfma_f32_16x16x32_bf16 v[124:127], v[164:167], v[60:63], v[124:127]
    ds_read_b64_tr_b16 v[58:59], v5 offset:29696
    s_waitcnt lgkmcnt(10)
    v_mfma_f32_16x16x32_bf16 v[128:131], v[32:35], v[160:163], v[128:131]
    ds_read_b64_tr_b16 v[60:61], v6 offset:28672
    v_mfma_f32_16x16x32_bf16 v[132:135], v[32:35], v[164:167], v[132:135]
    ds_read_b64_tr_b16 v[62:63], v6 offset:29696
    s_barrier
    v_mfma_f32_16x16x32_bf16 v[136:139], v[36:39], v[160:163], v[136:139]
    ds_read_b64_tr_b16 v[32:33], v3 offset:32768
    v_mfma_f32_16x16x32_bf16 v[140:143], v[36:39], v[164:167], v[140:143]
    ds_read_b64_tr_b16 v[34:35], v3 offset:33792
    s_waitcnt lgkmcnt(10)
    v_mfma_f32_16x16x32_bf16 v[144:147], v[40:43], v[160:163], v[144:147]
    ds_read_b64_tr_b16 v[36:37], v4 offset:32768
    v_mfma_f32_16x16x32_bf16 v[148:151], v[40:43], v[164:167], v[148:151]
    ds_read_b64_tr_b16 v[38:39], v4 offset:33792
    v_mfma_f32_16x16x32_bf16 v[152:155], v[44:47], v[160:163], v[152:155]
    ds_read_b64_tr_b16 v[40:41], v5 offset:32768
    v_mfma_f32_16x16x32_bf16 v[156:159], v[44:47], v[164:167], v[156:159]
    ds_read_b64_tr_b16 v[42:43], v5 offset:33792
    s_waitcnt vmcnt(17) lgkmcnt(10)
    v_mfma_f32_16x16x32_bf16 v[64:67], v[48:51], v[168:171], v[64:67]
    ds_read_b64_tr_b16 v[44:45], v6 offset:32768
    v_mfma_f32_16x16x32_bf16 v[68:71], v[48:51], v[172:175], v[68:71]
    ds_read_b64_tr_b16 v[46:47], v6 offset:33792
    v_mfma_f32_16x16x32_bf16 v[72:75], v[52:55], v[168:171], v[72:75]
    ds_read_b64_tr_b16 v[48:49], v3 offset:36864
    v_mfma_f32_16x16x32_bf16 v[76:79], v[52:55], v[172:175], v[76:79]
    ds_read_b64_tr_b16 v[50:51], v3 offset:37888
    s_waitcnt lgkmcnt(10)
    v_mfma_f32_16x16x32_bf16 v[80:83], v[56:59], v[168:171], v[80:83]
    ds_read_b64_tr_b16 v[52:53], v4 offset:36864
    v_mfma_f32_16x16x32_bf16 v[84:87], v[56:59], v[172:175], v[84:87]
    ds_read_b64_tr_b16 v[54:55], v4 offset:37888
    v_mfma_f32_16x16x32_bf16 v[88:91], v[60:63], v[168:171], v[88:91]
    ds_read_b64_tr_b16 v[56:57], v5 offset:36864
    v_mfma_f32_16x16x32_bf16 v[92:95], v[60:63], v[172:175], v[92:95]
    ds_read_b64_tr_b16 v[58:59], v5 offset:37888
    s_waitcnt lgkmcnt(10)
    v_mfma_f32_16x16x32_bf16 v[96:99], v[168:171], v[32:35], v[96:99]
    ds_read_b64_tr_b16 v[60:61], v6 offset:36864
    v_mfma_f32_16x16x32_bf16 v[100:103], v[172:175], v[32:35], v[100:103]
    ds_read_b64_tr_b16 v[62:63], v6 offset:37888
    v_mfma_f32_16x16x32_bf16 v[104:107], v[168:171], v[36:39], v[104:107]
    ds_read_b64_tr_b16 v[32:33], v3 offset:40960
    v_mfma_f32_16x16x32_bf16 v[108:111], v[172:175], v[36:39], v[108:111]
    ds_read_b64_tr_b16 v[34:35], v3 offset:41984
    s_waitcnt lgkmcnt(10)
    v_mfma_f32_16x16x32_bf16 v[112:115], v[168:171], v[40:43], v[112:115]
    ds_read_b64_tr_b16 v[36:37], v4 offset:40960
    v_mfma_f32_16x16x32_bf16 v[116:119], v[172:175], v[40:43], v[116:119]
    ds_read_b64_tr_b16 v[38:39], v4 offset:41984
    v_mfma_f32_16x16x32_bf16 v[120:123], v[168:171], v[44:47], v[120:123]
    ds_read_b64_tr_b16 v[40:41], v5 offset:40960
    v_mfma_f32_16x16x32_bf16 v[124:127], v[172:175], v[44:47], v[124:127]
    ds_read_b64_tr_b16 v[42:43], v5 offset:41984
    s_waitcnt lgkmcnt(10)
    v_mfma_f32_16x16x32_bf16 v[128:131], v[48:51], v[168:171], v[128:131]
    ds_read_b64_tr_b16 v[44:45], v6 offset:40960
    v_mfma_f32_16x16x32_bf16 v[132:135], v[48:51], v[172:175], v[132:135]
    ds_read_b64_tr_b16 v[46:47], v6 offset:41984
    v_mfma_f32_16x16x32_bf16 v[136:139], v[52:55], v[168:171], v[136:139]
    ds_read_b64_tr_b16 v[48:49], v3 offset:45056
    v_mfma_f32_16x16x32_bf16 v[140:143], v[52:55], v[172:175], v[140:143]
    ds_read_b64_tr_b16 v[50:51], v3 offset:46080
    s_waitcnt lgkmcnt(10)
    v_mfma_f32_16x16x32_bf16 v[144:147], v[56:59], v[168:171], v[144:147]
    ds_read_b64_tr_b16 v[52:53], v4 offset:45056
    v_mfma_f32_16x16x32_bf16 v[148:151], v[56:59], v[172:175], v[148:151]
    ds_read_b64_tr_b16 v[54:55], v4 offset:46080
    v_mfma_f32_16x16x32_bf16 v[152:155], v[60:63], v[168:171], v[152:155]
    ds_read_b64_tr_b16 v[56:57], v5 offset:45056
    v_mfma_f32_16x16x32_bf16 v[156:159], v[60:63], v[172:175], v[156:159]
    ds_read_b64_tr_b16 v[58:59], v5 offset:46080
    s_waitcnt vmcnt(15) lgkmcnt(10)
    v_mfma_f32_16x16x32_bf16 v[64:67], v[32:35], v[176:179], v[64:67]
    ds_read_b64_tr_b16 v[60:61], v6 offset:45056
    v_mfma_f32_16x16x32_bf16 v[68:71], v[32:35], v[180:183], v[68:71]
    ds_read_b64_tr_b16 v[62:63], v6 offset:46080
    v_mfma_f32_16x16x32_bf16 v[72:75], v[36:39], v[176:179], v[72:75]
    ds_read_b64_tr_b16 v[32:33], v3 offset:49152
    v_mfma_f32_16x16x32_bf16 v[76:79], v[36:39], v[180:183], v[76:79]
    ds_read_b64_tr_b16 v[34:35], v3 offset:50176
    s_waitcnt lgkmcnt(10)
    v_mfma_f32_16x16x32_bf16 v[80:83], v[40:43], v[176:179], v[80:83]
    ds_read_b64_tr_b16 v[36:37], v4 offset:49152
    v_mfma_f32_16x16x32_bf16 v[84:87], v[40:43], v[180:183], v[84:87]
    ds_read_b64_tr_b16 v[38:39], v4 offset:50176
    v_mfma_f32_16x16x32_bf16 v[88:91], v[44:47], v[176:179], v[88:91]
    ds_read_b64_tr_b16 v[40:41], v5 offset:49152
    v_mfma_f32_16x16x32_bf16 v[92:95], v[44:47], v[180:183], v[92:95]
    ds_read_b64_tr_b16 v[42:43], v5 offset:50176
    s_waitcnt lgkmcnt(10)
    v_mfma_f32_16x16x32_bf16 v[96:99], v[176:179], v[48:51], v[96:99]
    buffer_load_dwordx4 v[244:247], v2, s[4:7], s42 offen offset:256 sc1
    ds_read_b64_tr_b16 v[44:45], v6 offset:49152
    v_mfma_f32_16x16x32_bf16 v[100:103], v[180:183], v[48:51], v[100:103]
    ds_read_b64_tr_b16 v[46:47], v6 offset:50176
    v_mfma_f32_16x16x32_bf16 v[104:107], v[176:179], v[52:55], v[104:107]
    buffer_load_dwordx4 v[248:251], v2, s[4:7], s42 offen offset:2048 sc1
    ds_read_b64_tr_b16 v[48:49], v3 offset:53248
    v_mfma_f32_16x16x32_bf16 v[108:111], v[180:183], v[52:55], v[108:111]
    ds_read_b64_tr_b16 v[50:51], v3 offset:54272
    s_waitcnt lgkmcnt(10)
    v_mfma_f32_16x16x32_bf16 v[112:115], v[176:179], v[56:59], v[112:115]
    buffer_load_dwordx4 v[252:255], v2, s[4:7], s42 offen offset:2304 sc1
    ds_read_b64_tr_b16 v[52:53], v4 offset:53248
    s_add_u32 s42, s41, s96
    v_mfma_f32_16x16x32_bf16 v[116:119], v[180:183], v[56:59], v[116:119]
    ds_read_b64_tr_b16 v[54:55], v4 offset:54272
    v_mfma_f32_16x16x32_bf16 v[120:123], v[176:179], v[60:63], v[120:123]
    buffer_load_dwordx4 v[160:163], v2, s[4:7], s42 offen offset:0 sc1
    ds_read_b64_tr_b16 v[56:57], v5 offset:53248
    v_mfma_f32_16x16x32_bf16 v[124:127], v[180:183], v[60:63], v[124:127]
    ds_read_b64_tr_b16 v[58:59], v5 offset:54272
    s_waitcnt lgkmcnt(10)
    v_mfma_f32_16x16x32_bf16 v[128:131], v[32:35], v[176:179], v[128:131]
    ds_read_b64_tr_b16 v[60:61], v6 offset:53248
    buffer_load_dwordx4 v[164:167], v2, s[4:7], s42 offen offset:256 sc1
    v_mfma_f32_16x16x32_bf16 v[132:135], v[32:35], v[180:183], v[132:135]
    ds_read_b64_tr_b16 v[62:63], v6 offset:54272
    v_mfma_f32_16x16x32_bf16 v[136:139], v[36:39], v[176:179], v[136:139]
    buffer_load_dwordx4 v[168:171], v2, s[4:7], s42 offen offset:2048 sc1
    ds_read_b64_tr_b16 v[32:33], v3 offset:57344
    v_mfma_f32_16x16x32_bf16 v[140:143], v[36:39], v[180:183], v[140:143]
    ds_read_b64_tr_b16 v[34:35], v3 offset:58368
    s_waitcnt lgkmcnt(10)
    v_mfma_f32_16x16x32_bf16 v[144:147], v[40:43], v[176:179], v[144:147]
    ds_read_b64_tr_b16 v[36:37], v4 offset:57344
    v_mfma_f32_16x16x32_bf16 v[148:151], v[40:43], v[180:183], v[148:151]
    ds_read_b64_tr_b16 v[38:39], v4 offset:58368
    v_mfma_f32_16x16x32_bf16 v[152:155], v[44:47], v[176:179], v[152:155]
    ds_read_b64_tr_b16 v[40:41], v5 offset:57344
    v_mfma_f32_16x16x32_bf16 v[156:159], v[44:47], v[180:183], v[156:159]
    ds_read_b64_tr_b16 v[42:43], v5 offset:58368
    s_waitcnt vmcnt(19) lgkmcnt(10)
    v_mfma_f32_16x16x32_bf16 v[64:67], v[48:51], v[184:187], v[64:67]
    ds_read_b64_tr_b16 v[44:45], v6 offset:57344
    v_mfma_f32_16x16x32_bf16 v[68:71], v[48:51], v[188:191], v[68:71]
    ds_read_b64_tr_b16 v[46:47], v6 offset:58368
    v_mfma_f32_16x16x32_bf16 v[72:75], v[52:55], v[184:187], v[72:75]
    ds_read_b64_tr_b16 v[48:49], v3 offset:61440
    v_mfma_f32_16x16x32_bf16 v[76:79], v[52:55], v[188:191], v[76:79]
    ds_read_b64_tr_b16 v[50:51], v3 offset:62464
    s_waitcnt lgkmcnt(10)
    v_mfma_f32_16x16x32_bf16 v[80:83], v[56:59], v[184:187], v[80:83]
    buffer_load_dwordx4 v[172:175], v2, s[4:7], s42 offen offset:2304 sc1
    ds_read_b64_tr_b16 v[52:53], v4 offset:61440
    s_add_u32 s42, s41, s97
    v_mfma_f32_16x16x32_bf16 v[84:87], v[56:59], v[188:191], v[84:87]
    ds_read_b64_tr_b16 v[54:55], v4 offset:62464
    v_mfma_f32_16x16x32_bf16 v[88:91], v[60:63], v[184:187], v[88:91]
    ds_read_b64_tr_b16 v[56:57], v5 offset:61440
    v_mfma_f32_16x16x32_bf16 v[92:95], v[60:63], v[188:191], v[92:95]
    ds_read_b64_tr_b16 v[58:59], v5 offset:62464
    s_waitcnt lgkmcnt(10)
    v_mfma_f32_16x16x32_bf16 v[96:99], v[184:187], v[32:35], v[96:99]
    ds_read_b64_tr_b16 v[60:61], v6 offset:61440
    v_mfma_f32_16x16x32_bf16 v[100:103], v[188:191], v[32:35], v[100:103]
    ds_read_b64_tr_b16 v[62:63], v6 offset:62464
    s_barrier
    v_xor_b32 v3, 0x10000, v3
    v_xor_b32 v4, 0x10000, v4
    v_xor_b32 v5, 0x10000, v5
    v_xor_b32 v6, 0x10000, v6
    v_mfma_f32_16x16x32_bf16 v[104:107], v[184:187], v[36:39], v[104:107]
    ds_read_b64_tr_b16 v[32:33], v3 offset:0
    v_mfma_f32_16x16x32_bf16 v[108:111], v[188:191], v[36:39], v[108:111]
    ds_read_b64_tr_b16 v[34:35], v3 offset:1024
    s_waitcnt lgkmcnt(10)
    v_mfma_f32_16x16x32_bf16 v[112:115], v[184:187], v[40:43], v[112:115]
    ds_read_b64_tr_b16 v[36:37], v4 offset:0
    v_mfma_f32_16x16x32_bf16 v[116:119], v[188:191], v[40:43], v[116:119]
    ds_read_b64_tr_b16 v[38:39], v4 offset:1024
    v_mfma_f32_16x16x32_bf16 v[120:123], v[184:187], v[44:47], v[120:123]
    ds_read_b64_tr_b16 v[40:41], v5 offset:0
    v_mfma_f32_16x16x32_bf16 v[124:127], v[188:191], v[44:47], v[124:127]
    ds_read_b64_tr_b16 v[42:43], v5 offset:1024
    s_waitcnt lgkmcnt(10)
    v_mfma_f32_16x16x32_bf16 v[128:131], v[48:51], v[184:187], v[128:131]
    ds_read_b64_tr_b16 v[44:45], v6 offset:0
    v_mfma_f32_16x16x32_bf16 v[132:135], v[48:51], v[188:191], v[132:135]
    ds_read_b64_tr_b16 v[46:47], v6 offset:1024
    v_mfma_f32_16x16x32_bf16 v[136:139], v[52:55], v[184:187], v[136:139]
    ds_read_b64_tr_b16 v[48:49], v3 offset:4096
    v_mfma_f32_16x16x32_bf16 v[140:143], v[52:55], v[188:191], v[140:143]
    ds_read_b64_tr_b16 v[50:51], v3 offset:5120
    s_waitcnt lgkmcnt(10)
    v_mfma_f32_16x16x32_bf16 v[144:147], v[56:59], v[184:187], v[144:147]
    ds_read_b64_tr_b16 v[52:53], v4 offset:4096
    v_mfma_f32_16x16x32_bf16 v[148:151], v[56:59], v[188:191], v[148:151]
    ds_read_b64_tr_b16 v[54:55], v4 offset:5120
    v_mfma_f32_16x16x32_bf16 v[152:155], v[60:63], v[184:187], v[152:155]
    ds_read_b64_tr_b16 v[56:57], v5 offset:4096
    v_mfma_f32_16x16x32_bf16 v[156:159], v[60:63], v[188:191], v[156:159]
    ds_read_b64_tr_b16 v[58:59], v5 offset:5120
    s_waitcnt vmcnt(18) lgkmcnt(10)
    v_mfma_f32_16x16x32_bf16 v[64:67], v[32:35], v[192:195], v[64:67]
    ds_read_b64_tr_b16 v[60:61], v6 offset:4096
    v_mfma_f32_16x16x32_bf16 v[68:71], v[32:35], v[196:199], v[68:71]
    ds_read_b64_tr_b16 v[62:63], v6 offset:5120
    v_mfma_f32_16x16x32_bf16 v[72:75], v[36:39], v[192:195], v[72:75]
    ds_read_b64_tr_b16 v[32:33], v3 offset:8192
    v_mfma_f32_16x16x32_bf16 v[76:79], v[36:39], v[196:199], v[76:79]
    ds_read_b64_tr_b16 v[34:35], v3 offset:9216
    s_waitcnt lgkmcnt(10)
    v_mfma_f32_16x16x32_bf16 v[80:83], v[40:43], v[192:195], v[80:83]
    ds_read_b64_tr_b16 v[36:37], v4 offset:8192
    v_mfma_f32_16x16x32_bf16 v[84:87], v[40:43], v[196:199], v[84:87]
    ds_read_b64_tr_b16 v[38:39], v4 offset:9216
    v_mfma_f32_16x16x32_bf16 v[88:91], v[44:47], v[192:195], v[88:91]
    ds_read_b64_tr_b16 v[40:41], v5 offset:8192
    v_mfma_f32_16x16x32_bf16 v[92:95], v[44:47], v[196:199], v[92:95]
    ds_read_b64_tr_b16 v[42:43], v5 offset:9216
    s_waitcnt lgkmcnt(10)
    v_mfma_f32_16x16x32_bf16 v[96:99], v[192:195], v[48:51], v[96:99]
    ds_read_b64_tr_b16 v[44:45], v6 offset:8192
    v_mfma_f32_16x16x32_bf16 v[100:103], v[196:199], v[48:51], v[100:103]
    ds_read_b64_tr_b16 v[46:47], v6 offset:9216
    v_mfma_f32_16x16x32_bf16 v[104:107], v[192:195], v[52:55], v[104:107]
    ds_read_b64_tr_b16 v[48:49], v3 offset:12288
    v_mfma_f32_16x16x32_bf16 v[108:111], v[196:199], v[52:55], v[108:111]
    ds_read_b64_tr_b16 v[50:51], v3 offset:13312
    s_waitcnt lgkmcnt(10)
    v_mfma_f32_16x16x32_bf16 v[112:115], v[192:195], v[56:59], v[112:115]
    ds_read_b64_tr_b16 v[52:53], v4 offset:12288
    v_mfma_f32_16x16x32_bf16 v[116:119], v[196:199], v[56:59], v[116:119]
    ds_read_b64_tr_b16 v[54:55], v4 offset:13312
    v_mfma_f32_16x16x32_bf16 v[120:123], v[192:195], v[60:63], v[120:123]
    ds_read_b64_tr_b16 v[56:57], v5 offset:12288
    v_mfma_f32_16x16x32_bf16 v[124:127], v[196:199], v[60:63], v[124:127]
    ds_read_b64_tr_b16 v[58:59], v5 offset:13312
    s_waitcnt lgkmcnt(10)
    v_mfma_f32_16x16x32_bf16 v[128:131], v[32:35], v[192:195], v[128:131]
    ds_read_b64_tr_b16 v[60:61], v6 offset:12288
    v_mfma_f32_16x16x32_bf16 v[132:135], v[32:35], v[196:199], v[132:135]
    ds_read_b64_tr_b16 v[62:63], v6 offset:13312
    v_mfma_f32_16x16x32_bf16 v[136:139], v[36:39], v[192:195], v[136:139]
    ds_read_b64_tr_b16 v[32:33], v3 offset:16384
    v_mfma_f32_16x16x32_bf16 v[140:143], v[36:39], v[196:199], v[140:143]
    ds_read_b64_tr_b16 v[34:35], v3 offset:17408
    s_waitcnt lgkmcnt(10)
    v_mfma_f32_16x16x32_bf16 v[144:147], v[40:43], v[192:195], v[144:147]
    ds_read_b64_tr_b16 v[36:37], v4 offset:16384
    v_mfma_f32_16x16x32_bf16 v[148:151], v[40:43], v[196:199], v[148:151]
    ds_read_b64_tr_b16 v[38:39], v4 offset:17408
    v_mfma_f32_16x16x32_bf16 v[152:155], v[44:47], v[192:195], v[152:155]
    ds_read_b64_tr_b16 v[40:41], v5 offset:16384
    v_mfma_f32_16x16x32_bf16 v[156:159], v[44:47], v[196:199], v[156:159]
    ds_read_b64_tr_b16 v[42:43], v5 offset:17408
    s_waitcnt vmcnt(16) lgkmcnt(10)
    v_mfma_f32_16x16x32_bf16 v[64:67], v[48:51], v[200:203], v[64:67]
    buffer_load_dwordx4 v[176:179], v2, s[4:7], s42 offen offset:0 sc1
    ds_read_b64_tr_b16 v[44:45], v6 offset:16384
    v_mfma_f32_16x16x32_bf16 v[68:71], v[48:51], v[204:207], v[68:71]
    ds_read_b64_tr_b16 v[46:47], v6 offset:17408
    v_mfma_f32_16x16x32_bf16 v[72:75], v[52:55], v[200:203], v[72:75]
    buffer_load_dwordx4 v[180:183], v2, s[4:7], s42 offen offset:256 sc1
    ds_read_b64_tr_b16 v[48:49], v3 offset:20480
    v_mfma_f32_16x16x32_bf16 v[76:79], v[52:55], v[204:207], v[76:79]
    ds_read_b64_tr_b16 v[50:51], v3 offset:21504
    s_waitcnt lgkmcnt(10)
    v_mfma_f32_16x16x32_bf16 v[80:83], v[56:59], v[200:203], v[80:83]
    buffer_load_dwordx4 v[184:187], v2, s[4:7], s42 offen offset:2048 sc1
    ds_read_b64_tr_b16 v[52:53], v4 offset:20480
    v_mfma_f32_16x16x32_bf16 v[84:87], v[56:59], v[204:207], v[84:87]
    ds_read_b64_tr_b16 v[54:55], v4 offset:21504
    v_mfma_f32_16x16x32_bf16 v[88:91], v[60:63], v[200:203], v[88:91]
    buffer_load_dwordx4 v[188:191], v2, s[4:7], s42 offen offset:2304 sc1
    ds_read_b64_tr_b16 v[56:57], v5 offset:20480
    s_add_u32 s42, s41, s98
    v_mfma_f32_16x16x32_bf16 v[92:95], v[60:63], v[204:207], v[92:95]
    ds_read_b64_tr_b16 v[58:59], v5 offset:21504
    s_waitcnt lgkmcnt(10)
    v_mfma_f32_16x16x32_bf16 v[96:99], v[200:203], v[32:35], v[96:99]
    ds_read_b64_tr_b16 v[60:61], v6 offset:20480
    buffer_load_dwordx4 v[192:195], v2, s[4:7], s42 offen offset:0 sc1
    v_mfma_f32_16x16x32_bf16 v[100:103], v[204:207], v[32:35], v[100:103]
    ds_read_b64_tr_b16 v[62:63], v6 offset:21504
    v_mfma_f32_16x16x32_bf16 v[104:107], v[200:203], v[36:39], v[104:107]
    ds_read_b64_tr_b16 v[32:33], v3 offset:24576
    v_mfma_f32_16x16x32_bf16 v[108:111], v[204:207], v[36:39], v[108:111]
    ds_read_b64_tr_b16 v[34:35], v3 offset:25600
    s_waitcnt lgkmcnt(10)
    v_mfma_f32_16x16x32_bf16 v[112:115], v[200:203], v[40:43], v[112:115]
    ds_read_b64_tr_b16 v[36:37], v4 offset:24576
    v_mfma_f32_16x16x32_bf16 v[116:119], v[204:207], v[40:43], v[116:119]
    ds_read_b64_tr_b16 v[38:39], v4 offset:25600
    v_mfma_f32_16x16x32_bf16 v[120:123], v[200:203], v[44:47], v[120:123]
    buffer_load_dwordx4 v[196:199], v2, s[4:7], s42 offen offset:256 sc1
    ds_read_b64_tr_b16 v[40:41], v5 offset:24576
    v_mfma_f32_16x16x32_bf16 v[124:127], v[204:207], v[44:47], v[124:127]
    ds_read_b64_tr_b16 v[42:43], v5 offset:25600
    s_waitcnt lgkmcnt(10)
    v_mfma_f32_16x16x32_bf16 v[128:131], v[48:51], v[200:203], v[128:131]
    ds_read_b64_tr_b16 v[44:45], v6 offset:24576
    v_mfma_f32_16x16x32_bf16 v[132:135], v[48:51], v[204:207], v[132:135]
    ds_read_b64_tr_b16 v[46:47], v6 offset:25600
    v_mfma_f32_16x16x32_bf16 v[136:139], v[52:55], v[200:203], v[136:139]
    ds_read_b64_tr_b16 v[48:49], v3 offset:28672
    v_mfma_f32_16x16x32_bf16 v[140:143], v[52:55], v[204:207], v[140:143]
    ds_read_b64_tr_b16 v[50:51], v3 offset:29696
    s_waitcnt lgkmcnt(10)
    v_mfma_f32_16x16x32_bf16 v[144:147], v[56:59], v[200:203], v[144:147]
    ds_read_b64_tr_b16 v[52:53], v4 offset:28672
    v_mfma_f32_16x16x32_bf16 v[148:151], v[56:59], v[204:207], v[148:151]
    ds_read_b64_tr_b16 v[54:55], v4 offset:29696
    v_mfma_f32_16x16x32_bf16 v[152:155], v[60:63], v[200:203], v[152:155]
    ds_read_b64_tr_b16 v[56:57], v5 offset:28672
    v_mfma_f32_16x16x32_bf16 v[156:159], v[60:63], v[204:207], v[156:159]
    ds_read_b64_tr_b16 v[58:59], v5 offset:29696
    s_waitcnt vmcnt(20) lgkmcnt(10)
    v_mfma_f32_16x16x32_bf16 v[64:67], v[32:35], v[208:211], v[64:67]
    ds_read_b64_tr_b16 v[60:61], v6 offset:28672
    v_mfma_f32_16x16x32_bf16 v[68:71], v[32:35], v[212:215], v[68:71]
    ds_read_b64_tr_b16 v[62:63], v6 offset:29696
    s_barrier
    v_mfma_f32_16x16x32_bf16 v[72:75], v[36:39], v[208:211], v[72:75]
    ds_read_b64_tr_b16 v[32:33], v3 offset:32768
    v_mfma_f32_16x16x32_bf16 v[76:79], v[36:39], v[212:215], v[76:79]
    ds_read_b64_tr_b16 v[34:35], v3 offset:33792
    s_waitcnt lgkmcnt(10)
    v_mfma_f32_16x16x32_bf16 v[80:83], v[40:43], v[208:211], v[80:83]
    ds_read_b64_tr_b16 v[36:37], v4 offset:32768
    v_mfma_f32_16x16x32_bf16 v[84:87], v[40:43], v[212:215], v[84:87]
    ds_read_b64_tr_b16 v[38:39], v4 offset:33792
    v_mfma_f32_16x16x32_bf16 v[88:91], v[44:47], v[208:211], v[88:91]
    ds_read_b64_tr_b16 v[40:41], v5 offset:32768
    v_mfma_f32_16x16x32_bf16 v[92:95], v[44:47], v[212:215], v[92:95]
    ds_read_b64_tr_b16 v[42:43], v5 offset:33792
    s_waitcnt lgkmcnt(10)
    v_mfma_f32_16x16x32_bf16 v[96:99], v[208:211], v[48:51], v[96:99]
    ds_read_b64_tr_b16 v[44:45], v6 offset:32768
    v_mfma_f32_16x16x32_bf16 v[100:103], v[212:215], v[48:51], v[100:103]
    ds_read_b64_tr_b16 v[46:47], v6 offset:33792
    v_mfma_f32_16x16x32_bf16 v[104:107], v[208:211], v[52:55], v[104:107]
    ds_read_b64_tr_b16 v[48:49], v3 offset:36864
    v_mfma_f32_16x16x32_bf16 v[108:111], v[212:215], v[52:55], v[108:111]
    ds_read_b64_tr_b16 v[50:51], v3 offset:37888
    s_waitcnt lgkmcnt(10)
    v_mfma_f32_16x16x32_bf16 v[112:115], v[208:211], v[56:59], v[112:115]
    ds_read_b64_tr_b16 v[52:53], v4 offset:36864
    v_mfma_f32_16x16x32_bf16 v[116:119], v[212:215], v[56:59], v[116:119]
    ds_read_b64_tr_b16 v[54:55], v4 offset:37888
    v_mfma_f32_16x16x32_bf16 v[120:123], v[208:211], v[60:63], v[120:123]
    ds_read_b64_tr_b16 v[56:57], v5 offset:36864
    v_mfma_f32_16x16x32_bf16 v[124:127], v[212:215], v[60:63], v[124:127]
    ds_read_b64_tr_b16 v[58:59], v5 offset:37888
    s_waitcnt lgkmcnt(10)
    v_mfma_f32_16x16x32_bf16 v[128:131], v[32:35], v[208:211], v[128:131]
    ds_read_b64_tr_b16 v[60:61], v6 offset:36864
    v_mfma_f32_16x16x32_bf16 v[132:135], v[32:35], v[212:215], v[132:135]
    ds_read_b64_tr_b16 v[62:63], v6 offset:37888
    v_mfma_f32_16x16x32_bf16 v[136:139], v[36:39], v[208:211], v[136:139]
    ds_read_b64_tr_b16 v[32:33], v3 offset:40960
    v_mfma_f32_16x16x32_bf16 v[140:143], v[36:39], v[212:215], v[140:143]
    ds_read_b64_tr_b16 v[34:35], v3 offset:41984
    s_waitcnt lgkmcnt(10)
    v_mfma_f32_16x16x32_bf16 v[144:147], v[40:43], v[208:211], v[144:147]
    ds_read_b64_tr_b16 v[36:37], v4 offset:40960
    v_mfma_f32_16x16x32_bf16 v[148:151], v[40:43], v[212:215], v[148:151]
    ds_read_b64_tr_b16 v[38:39], v4 offset:41984
    v_mfma_f32_16x16x32_bf16 v[152:155], v[44:47], v[208:211], v[152:155]
    ds_read_b64_tr_b16 v[40:41], v5 offset:40960
    v_mfma_f32_16x16x32_bf16 v[156:159], v[44:47], v[212:215], v[156:159]
    ds_read_b64_tr_b16 v[42:43], v5 offset:41984
    s_waitcnt vmcnt(18) lgkmcnt(10)
    v_mfma_f32_16x16x32_bf16 v[64:67], v[48:51], v[216:219], v[64:67]
    ds_read_b64_tr_b16 v[44:45], v6 offset:40960
    v_mfma_f32_16x16x32_bf16 v[68:71], v[48:51], v[220:223], v[68:71]
    ds_read_b64_tr_b16 v[46:47], v6 offset:41984
    v_mfma_f32_16x16x32_bf16 v[72:75], v[52:55], v[216:219], v[72:75]
    ds_read_b64_tr_b16 v[48:49], v3 offset:45056
    v_mfma_f32_16x16x32_bf16 v[76:79], v[52:55], v[220:223], v[76:79]
    ds_read_b64_tr_b16 v[50:51], v3 offset:46080
    s_waitcnt lgkmcnt(10)
    v_mfma_f32_16x16x32_bf16 v[80:83], v[56:59], v[216:219], v[80:83]
    ds_read_b64_tr_b16 v[52:53], v4 offset:45056
    v_mfma_f32_16x16x32_bf16 v[84:87], v[56:59], v[220:223], v[84:87]
    ds_read_b64_tr_b16 v[54:55], v4 offset:46080
    v_mfma_f32_16x16x32_bf16 v[88:91], v[60:63], v[216:219], v[88:91]
    ds_read_b64_tr_b16 v[56:57], v5 offset:45056
    v_mfma_f32_16x16x32_bf16 v[92:95], v[60:63], v[220:223], v[92:95]
    ds_read_b64_tr_b16 v[58:59], v5 offset:46080
    s_waitcnt lgkmcnt(10)
    v_mfma_f32_16x16x32_bf16 v[96:99], v[216:219], v[32:35], v[96:99]
    ds_read_b64_tr_b16 v[60:61], v6 offset:45056
    v_mfma_f32_16x16x32_bf16 v[100:103], v[220:223], v[32:35], v[100:103]
    ds_read_b64_tr_b16 v[62:63], v6 offset:46080
    v_mfma_f32_16x16x32_bf16 v[104:107], v[216:219], v[36:39], v[104:107]
    ds_read_b64_tr_b16 v[32:33], v3 offset:49152
    v_mfma_f32_16x16x32_bf16 v[108:111], v[220:223], v[36:39], v[108:111]
    ds_read_b64_tr_b16 v[34:35], v3 offset:50176
    s_waitcnt lgkmcnt(10)
    v_mfma_f32_16x16x32_bf16 v[112:115], v[216:219], v[40:43], v[112:115]
    ds_read_b64_tr_b16 v[36:37], v4 offset:49152
    v_mfma_f32_16x16x32_bf16 v[116:119], v[220:223], v[40:43], v[116:119]
    ds_read_b64_tr_b16 v[38:39], v4 offset:50176
    v_mfma_f32_16x16x32_bf16 v[120:123], v[216:219], v[44:47], v[120:123]
    ds_read_b64_tr_b16 v[40:41], v5 offset:49152
    v_mfma_f32_16x16x32_bf16 v[124:127], v[220:223], v[44:47], v[124:127]
    ds_read_b64_tr_b16 v[42:43], v5 offset:50176
    s_waitcnt lgkmcnt(10)
    v_mfma_f32_16x16x32_bf16 v[128:131], v[48:51], v[216:219], v[128:131]
    buffer_load_dwordx4 v[200:203], v2, s[4:7], s42 offen offset:2048 sc1
    ds_read_b64_tr_b16 v[44:45], v6 offset:49152
    v_mfma_f32_16x16x32_bf16 v[132:135], v[48:51], v[220:223], v[132:135]
    ds_read_b64_tr_b16 v[46:47], v6 offset:50176
    v_mfma_f32_16x16x32_bf16 v[136:139], v[52:55], v[216:219], v[136:139]
    buffer_load_dwordx4 v[204:207], v2, s[4:7], s42 offen offset:2304 sc1
    ds_read_b64_tr_b16 v[48:49], v3 offset:53248
    s_add_u32 s42, s41, s99
    v_mfma_f32_16x16x32_bf16 v[140:143], v[52:55], v[220:223], v[140:143]
    ds_read_b64_tr_b16 v[50:51], v3 offset:54272
    s_waitcnt lgkmcnt(10)
    v_mfma_f32_16x16x32_bf16 v[144:147], v[56:59], v[216:219], v[144:147]
    buffer_load_dwordx4 v[208:211], v2, s[4:7], s42 offen offset:0 sc1
    ds_read_b64_tr_b16 v[52:53], v4 offset:53248
    v_mfma_f32_16x16x32_bf16 v[148:151], v[56:59], v[220:223], v[148:151]
    ds_read_b64_tr_b16 v[54:55], v4 offset:54272
    v_mfma_f32_16x16x32_bf16 v[152:155], v[60:63], v[216:219], v[152:155]
    buffer_load_dwordx4 v[212:215], v2, s[4:7], s42 offen offset:256 sc1
    ds_read_b64_tr_b16 v[56:57], v5 offset:53248
    v_mfma_f32_16x16x32_bf16 v[156:159], v[60:63], v[220:223], v[156:159]
    ds_read_b64_tr_b16 v[58:59], v5 offset:54272
    s_waitcnt vmcnt(20) lgkmcnt(10)
    v_mfma_f32_16x16x32_bf16 v[64:67], v[32:35], v[224:227], v[64:67]
    ds_read_b64_tr_b16 v[60:61], v6 offset:53248
    buffer_load_dwordx4 v[216:219], v2, s[4:7], s42 offen offset:2048 sc1
    v_mfma_f32_16x16x32_bf16 v[68:71], v[32:35], v[228:231], v[68:71]
    ds_read_b64_tr_b16 v[62:63], v6 offset:54272
    v_mfma_f32_16x16x32_bf16 v[72:75], v[36:39], v[224:227], v[72:75]
    buffer_load_dwordx4 v[220:223], v2, s[4:7], s42 offen offset:2304 sc1
    ds_read_b64_tr_b16 v[32:33], v3 offset:57344
    v_mfma_f32_16x16x32_bf16 v[76:79], v[36:39], v[228:231], v[76:79]
    ds_read_b64_tr_b16 v[34:35], v3 offset:58368
    s_waitcnt lgkmcnt(10)
    v_mfma_f32_16x16x32_bf16 v[80:83], v[40:43], v[224:227], v[80:83]
    ds_read_b64_tr_b16 v[36:37], v4 offset:57344
    v_mfma_f32_16x16x32_bf16 v[84:87], v[40:43], v[228:231], v[84:87]
    ds_read_b64_tr_b16 v[38:39], v4 offset:58368
    v_mfma_f32_16x16x32_bf16 v[88:91], v[44:47], v[224:227], v[88:91]
    ds_read_b64_tr_b16 v[40:41], v5 offset:57344
    v_mfma_f32_16x16x32_bf16 v[92:95], v[44:47], v[228:231], v[92:95]
    ds_read_b64_tr_b16 v[42:43], v5 offset:58368
    s_waitcnt lgkmcnt(10)
    v_mfma_f32_16x16x32_bf16 v[96:99], v[224:227], v[48:51], v[96:99]
    ds_read_b64_tr_b16 v[44:45], v6 offset:57344
    v_mfma_f32_16x16x32_bf16 v[100:103], v[228:231], v[48:51], v[100:103]
    ds_read_b64_tr_b16 v[46:47], v6 offset:58368
    v_mfma_f32_16x16x32_bf16 v[104:107], v[224:227], v[52:55], v[104:107]
    ds_read_b64_tr_b16 v[48:49], v3 offset:61440
    v_mfma_f32_16x16x32_bf16 v[108:111], v[228:231], v[52:55], v[108:111]
    ds_read_b64_tr_b16 v[50:51], v3 offset:62464
    s_waitcnt lgkmcnt(10)
    v_mfma_f32_16x16x32_bf16 v[112:115], v[224:227], v[56:59], v[112:115]
    ds_read_b64_tr_b16 v[52:53], v4 offset:61440
    v_mfma_f32_16x16x32_bf16 v[116:119], v[228:231], v[56:59], v[116:119]
    ds_read_b64_tr_b16 v[54:55], v4 offset:62464
    v_mfma_f32_16x16x32_bf16 v[120:123], v[224:227], v[60:63], v[120:123]
    ds_read_b64_tr_b16 v[56:57], v5 offset:61440
    v_mfma_f32_16x16x32_bf16 v[124:127], v[228:231], v[60:63], v[124:127]
    ds_read_b64_tr_b16 v[58:59], v5 offset:62464
    s_waitcnt vmcnt(20) lgkmcnt(10)
    v_mfma_f32_16x16x32_bf16 v[64:67], v[32:35], v[232:235], v[64:67]
    ds_read_b64_tr_b16 v[60:61], v6 offset:61440
    v_mfma_f32_16x16x32_bf16 v[68:71], v[32:35], v[236:239], v[68:71]
    ds_read_b64_tr_b16 v[62:63], v6 offset:62464
    s_barrier
    v_xor_b32 v3, 0x10000, v3
    v_xor_b32 v4, 0x10000, v4
    v_xor_b32 v5, 0x10000, v5
    v_xor_b32 v6, 0x10000, v6
    v_mfma_f32_16x16x32_bf16 v[72:75], v[36:39], v[232:235], v[72:75]
    ds_read_b64_tr_b16 v[32:33], v3 offset:0
    v_mfma_f32_16x16x32_bf16 v[76:79], v[36:39], v[236:239], v[76:79]
    ds_read_b64_tr_b16 v[34:35], v3 offset:1024
    s_waitcnt lgkmcnt(10)
    v_mfma_f32_16x16x32_bf16 v[80:83], v[40:43], v[232:235], v[80:83]
    ds_read_b64_tr_b16 v[36:37], v4 offset:0
    v_mfma_f32_16x16x32_bf16 v[84:87], v[40:43], v[236:239], v[84:87]
    ds_read_b64_tr_b16 v[38:39], v4 offset:1024
    v_mfma_f32_16x16x32_bf16 v[88:91], v[44:47], v[232:235], v[88:91]
    ds_read_b64_tr_b16 v[40:41], v5 offset:0
    v_mfma_f32_16x16x32_bf16 v[92:95], v[44:47], v[236:239], v[92:95]
    ds_read_b64_tr_b16 v[42:43], v5 offset:1024
    s_waitcnt lgkmcnt(10)
    v_mfma_f32_16x16x32_bf16 v[96:99], v[232:235], v[48:51], v[96:99]
    ds_read_b64_tr_b16 v[44:45], v6 offset:0
    v_mfma_f32_16x16x32_bf16 v[100:103], v[236:239], v[48:51], v[100:103]
    ds_read_b64_tr_b16 v[46:47], v6 offset:1024
    v_mfma_f32_16x16x32_bf16 v[104:107], v[232:235], v[52:55], v[104:107]
    ds_read_b64_tr_b16 v[48:49], v3 offset:4096
    v_mfma_f32_16x16x32_bf16 v[108:111], v[236:239], v[52:55], v[108:111]
    ds_read_b64_tr_b16 v[50:51], v3 offset:5120
    s_waitcnt lgkmcnt(10)
    v_mfma_f32_16x16x32_bf16 v[112:115], v[232:235], v[56:59], v[112:115]
    ds_read_b64_tr_b16 v[52:53], v4 offset:4096
    v_mfma_f32_16x16x32_bf16 v[116:119], v[236:239], v[56:59], v[116:119]
    ds_read_b64_tr_b16 v[54:55], v4 offset:5120
    v_mfma_f32_16x16x32_bf16 v[120:123], v[232:235], v[60:63], v[120:123]
    ds_read_b64_tr_b16 v[56:57], v5 offset:4096
    v_mfma_f32_16x16x32_bf16 v[124:127], v[236:239], v[60:63], v[124:127]
    ds_read_b64_tr_b16 v[58:59], v5 offset:5120
    s_waitcnt vmcnt(18) lgkmcnt(10)
    v_mfma_f32_16x16x32_bf16 v[64:67], v[32:35], v[240:243], v[64:67]
    ds_read_b64_tr_b16 v[60:61], v6 offset:4096
    v_mfma_f32_16x16x32_bf16 v[68:71], v[32:35], v[244:247], v[68:71]
    ds_read_b64_tr_b16 v[62:63], v6 offset:5120
    v_mfma_f32_16x16x32_bf16 v[72:75], v[36:39], v[240:243], v[72:75]
    ds_read_b64_tr_b16 v[32:33], v3 offset:8192
    v_mfma_f32_16x16x32_bf16 v[76:79], v[36:39], v[244:247], v[76:79]
    ds_read_b64_tr_b16 v[34:35], v3 offset:9216
    s_waitcnt lgkmcnt(10)
    v_mfma_f32_16x16x32_bf16 v[80:83], v[40:43], v[240:243], v[80:83]
    ds_read_b64_tr_b16 v[36:37], v4 offset:8192
    v_mfma_f32_16x16x32_bf16 v[84:87], v[40:43], v[244:247], v[84:87]
    ds_read_b64_tr_b16 v[38:39], v4 offset:9216
    v_mfma_f32_16x16x32_bf16 v[88:91], v[44:47], v[240:243], v[88:91]
    ds_read_b64_tr_b16 v[40:41], v5 offset:8192
    v_mfma_f32_16x16x32_bf16 v[92:95], v[44:47], v[244:247], v[92:95]
    ds_read_b64_tr_b16 v[42:43], v5 offset:9216
    s_waitcnt lgkmcnt(10)
    v_mfma_f32_16x16x32_bf16 v[96:99], v[240:243], v[48:51], v[96:99]
    ds_read_b64_tr_b16 v[44:45], v6 offset:8192
    v_mfma_f32_16x16x32_bf16 v[100:103], v[244:247], v[48:51], v[100:103]
    ds_read_b64_tr_b16 v[46:47], v6 offset:9216
    v_mfma_f32_16x16x32_bf16 v[104:107], v[240:243], v[52:55], v[104:107]
    ds_read_b64_tr_b16 v[48:49], v3 offset:12288
    v_mfma_f32_16x16x32_bf16 v[108:111], v[244:247], v[52:55], v[108:111]
    ds_read_b64_tr_b16 v[50:51], v3 offset:13312
    s_waitcnt lgkmcnt(10)
    v_mfma_f32_16x16x32_bf16 v[112:115], v[240:243], v[56:59], v[112:115]
    ds_read_b64_tr_b16 v[52:53], v4 offset:12288
    v_mfma_f32_16x16x32_bf16 v[116:119], v[244:247], v[56:59], v[116:119]
    ds_read_b64_tr_b16 v[54:55], v4 offset:13312
    v_mfma_f32_16x16x32_bf16 v[120:123], v[240:243], v[60:63], v[120:123]
    ds_read_b64_tr_b16 v[56:57], v5 offset:12288
    v_mfma_f32_16x16x32_bf16 v[124:127], v[244:247], v[60:63], v[124:127]
    ds_read_b64_tr_b16 v[58:59], v5 offset:13312
    s_waitcnt vmcnt(16) lgkmcnt(10)
    v_mfma_f32_16x16x32_bf16 v[64:67], v[32:35], v[248:251], v[64:67]
    ds_read_b64_tr_b16 v[60:61], v6 offset:12288
    v_mfma_f32_16x16x32_bf16 v[68:71], v[32:35], v[252:255], v[68:71]
    ds_read_b64_tr_b16 v[62:63], v6 offset:13312
    v_mfma_f32_16x16x32_bf16 v[72:75], v[36:39], v[248:251], v[72:75]
    ds_read_b64_tr_b16 v[32:33], v3 offset:16384
    v_mfma_f32_16x16x32_bf16 v[76:79], v[36:39], v[252:255], v[76:79]
    ds_read_b64_tr_b16 v[34:35], v3 offset:17408
    s_waitcnt lgkmcnt(10)
    v_mfma_f32_16x16x32_bf16 v[80:83], v[40:43], v[248:251], v[80:83]
    ds_read_b64_tr_b16 v[36:37], v4 offset:16384
    v_mfma_f32_16x16x32_bf16 v[84:87], v[40:43], v[252:255], v[84:87]
    ds_read_b64_tr_b16 v[38:39], v4 offset:17408
    v_mfma_f32_16x16x32_bf16 v[88:91], v[44:47], v[248:251], v[88:91]
    ds_read_b64_tr_b16 v[40:41], v5 offset:16384
    v_mfma_f32_16x16x32_bf16 v[92:95], v[44:47], v[252:255], v[92:95]
    ds_read_b64_tr_b16 v[42:43], v5 offset:17408
    s_waitcnt lgkmcnt(10)
    v_mfma_f32_16x16x32_bf16 v[96:99], v[248:251], v[48:51], v[96:99]
    ds_read_b64_tr_b16 v[44:45], v6 offset:16384
    v_mfma_f32_16x16x32_bf16 v[100:103], v[252:255], v[48:51], v[100:103]
    ds_read_b64_tr_b16 v[46:47], v6 offset:17408
    v_mfma_f32_16x16x32_bf16 v[104:107], v[248:251], v[52:55], v[104:107]
    ds_read_b64_tr_b16 v[48:49], v3 offset:20480
    v_mfma_f32_16x16x32_bf16 v[108:111], v[252:255], v[52:55], v[108:111]
    ds_read_b64_tr_b16 v[50:51], v3 offset:21504
    s_waitcnt lgkmcnt(10)
    v_mfma_f32_16x16x32_bf16 v[112:115], v[248:251], v[56:59], v[112:115]
    ds_read_b64_tr_b16 v[52:53], v4 offset:20480
    v_mfma_f32_16x16x32_bf16 v[116:119], v[252:255], v[56:59], v[116:119]
    ds_read_b64_tr_b16 v[54:55], v4 offset:21504
    v_mfma_f32_16x16x32_bf16 v[120:123], v[248:251], v[60:63], v[120:123]
    ds_read_b64_tr_b16 v[56:57], v5 offset:20480
    v_mfma_f32_16x16x32_bf16 v[124:127], v[252:255], v[60:63], v[124:127]
    ds_read_b64_tr_b16 v[58:59], v5 offset:21504
    s_waitcnt vmcnt(14) lgkmcnt(10)
    v_mfma_f32_16x16x32_bf16 v[64:67], v[32:35], v[160:163], v[64:67]
    ds_read_b64_tr_b16 v[60:61], v6 offset:20480
    v_mfma_f32_16x16x32_bf16 v[68:71], v[32:35], v[164:167], v[68:71]
    ds_read_b64_tr_b16 v[62:63], v6 offset:21504
    v_mfma_f32_16x16x32_bf16 v[72:75], v[36:39], v[160:163], v[72:75]
    ds_read_b64_tr_b16 v[32:33], v3 offset:24576
    v_mfma_f32_16x16x32_bf16 v[76:79], v[36:39], v[164:167], v[76:79]
    ds_read_b64_tr_b16 v[34:35], v3 offset:25600
    s_waitcnt lgkmcnt(10)
    v_mfma_f32_16x16x32_bf16 v[80:83], v[40:43], v[160:163], v[80:83]
    ds_read_b64_tr_b16 v[36:37], v4 offset:24576
    v_mfma_f32_16x16x32_bf16 v[84:87], v[40:43], v[164:167], v[84:87]
    ds_read_b64_tr_b16 v[38:39], v4 offset:25600
    v_mfma_f32_16x16x32_bf16 v[88:91], v[44:47], v[160:163], v[88:91]
    ds_read_b64_tr_b16 v[40:41], v5 offset:24576
    v_mfma_f32_16x16x32_bf16 v[92:95], v[44:47], v[164:167], v[92:95]
    ds_read_b64_tr_b16 v[42:43], v5 offset:25600
    s_waitcnt vmcnt(12) lgkmcnt(10)
    v_mfma_f32_16x16x32_bf16 v[64:67], v[48:51], v[168:171], v[64:67]
    ds_read_b64_tr_b16 v[44:45], v6 offset:24576
    v_mfma_f32_16x16x32_bf16 v[68:71], v[48:51], v[172:175], v[68:71]
    ds_read_b64_tr_b16 v[46:47], v6 offset:25600
    v_mfma_f32_16x16x32_bf16 v[72:75], v[52:55], v[168:171], v[72:75]
    ds_read_b64_tr_b16 v[48:49], v3 offset:28672
    v_mfma_f32_16x16x32_bf16 v[76:79], v[52:55], v[172:175], v[76:79]
    ds_read_b64_tr_b16 v[50:51], v3 offset:29696
    s_waitcnt lgkmcnt(10)
    v_mfma_f32_16x16x32_bf16 v[80:83], v[56:59], v[168:171], v[80:83]
    ds_read_b64_tr_b16 v[52:53], v4 offset:28672
    v_mfma_f32_16x16x32_bf16 v[84:87], v[56:59], v[172:175], v[84:87]
    ds_read_b64_tr_b16 v[54:55], v4 offset:29696
    v_mfma_f32_16x16x32_bf16 v[88:91], v[60:63], v[168:171], v[88:91]
    ds_read_b64_tr_b16 v[56:57], v5 offset:28672
    v_mfma_f32_16x16x32_bf16 v[92:95], v[60:63], v[172:175], v[92:95]
    ds_read_b64_tr_b16 v[58:59], v5 offset:29696
    s_waitcnt vmcnt(10) lgkmcnt(10)
    v_mfma_f32_16x16x32_bf16 v[64:67], v[32:35], v[176:179], v[64:67]
    ds_read_b64_tr_b16 v[60:61], v6 offset:28672
    v_mfma_f32_16x16x32_bf16 v[68:71], v[32:35], v[180:183], v[68:71]
    ds_read_b64_tr_b16 v[62:63], v6 offset:29696
    s_barrier
    v_mfma_f32_16x16x32_bf16 v[72:75], v[36:39], v[176:179], v[72:75]
    ds_read_b64_tr_b16 v[32:33], v3 offset:32768
    v_mfma_f32_16x16x32_bf16 v[76:79], v[36:39], v[180:183], v[76:79]
    ds_read_b64_tr_b16 v[34:35], v3 offset:33792
    s_waitcnt lgkmcnt(10)
    v_mfma_f32_16x16x32_bf16 v[80:83], v[40:43], v[176:179], v[80:83]
    ds_read_b64_tr_b16 v[36:37], v4 offset:32768
    v_mfma_f32_16x16x32_bf16 v[84:87], v[40:43], v[180:183], v[84:87]
    ds_read_b64_tr_b16 v[38:39], v4 offset:33792
    v_mfma_f32_16x16x32_bf16 v[88:91], v[44:47], v[176:179], v[88:91]
    ds_read_b64_tr_b16 v[40:41], v5 offset:32768
    v_mfma_f32_16x16x32_bf16 v[92:95], v[44:47], v[180:183], v[92:95]
    ds_read_b64_tr_b16 v[42:43], v5 offset:33792
    s_waitcnt vmcnt(8) lgkmcnt(10)
    v_mfma_f32_16x16x32_bf16 v[64:67], v[48:51], v[184:187], v[64:67]
    ds_read_b64_tr_b16 v[44:45], v6 offset:32768
    v_mfma_f32_16x16x32_bf16 v[68:71], v[48:51], v[188:191], v[68:71]
    ds_read_b64_tr_b16 v[46:47], v6 offset:33792
    v_mfma_f32_16x16x32_bf16 v[72:75], v[52:55], v[184:187], v[72:75]
    ds_read_b64_tr_b16 v[48:49], v3 offset:36864
    v_mfma_f32_16x16x32_bf16 v[76:79], v[52:55], v[188:191], v[76:79]
    ds_read_b64_tr_b16 v[50:51], v3 offset:37888
    s_waitcnt lgkmcnt(10)
    v_mfma_f32_16x16x32_bf16 v[80:83], v[56:59], v[184:187], v[80:83]
    ds_read_b64_tr_b16 v[52:53], v4 offset:36864
    v_mfma_f32_16x16x32_bf16 v[84:87], v[56:59], v[188:191], v[84:87]
    ds_read_b64_tr_b16 v[54:55], v4 offset:37888
    v_mfma_f32_16x16x32_bf16 v[88:91], v[60:63], v[184:187], v[88:91]
    ds_read_b64_tr_b16 v[56:57], v5 offset:36864
    v_mfma_f32_16x16x32_bf16 v[92:95], v[60:63], v[188:191], v[92:95]
    ds_read_b64_tr_b16 v[58:59], v5 offset:37888
    s_waitcnt vmcnt(6) lgkmcnt(10)
    v_mfma_f32_16x16x32_bf16 v[64:67], v[32:35], v[192:195], v[64:67]
    ds_read_b64_tr_b16 v[60:61], v6 offset:36864
    v_mfma_f32_16x16x32_bf16 v[68:71], v[32:35], v[196:199], v[68:71]
    ds_read_b64_tr_b16 v[62:63], v6 offset:37888
    v_mfma_f32_16x16x32_bf16 v[72:75], v[36:39], v[192:195], v[72:75]
    ds_read_b64_tr_b16 v[32:33], v3 offset:40960
    v_mfma_f32_16x16x32_bf16 v[76:79], v[36:39], v[196:199], v[76:79]
    ds_read_b64_tr_b16 v[34:35], v3 offset:41984
    s_waitcnt lgkmcnt(10)
    v_mfma_f32_16x16x32_bf16 v[80:83], v[40:43], v[192:195], v[80:83]
    ds_read_b64_tr_b16 v[36:37], v4 offset:40960
    v_mfma_f32_16x16x32_bf16 v[84:87], v[40:43], v[196:199], v[84:87]
    ds_read_b64_tr_b16 v[38:39], v4 offset:41984
    v_mfma_f32_16x16x32_bf16 v[88:91], v[44:47], v[192:195], v[88:91]
    ds_read_b64_tr_b16 v[40:41], v5 offset:40960
    v_mfma_f32_16x16x32_bf16 v[92:95], v[44:47], v[196:199], v[92:95]
    ds_read_b64_tr_b16 v[42:43], v5 offset:41984
    s_waitcnt vmcnt(4) lgkmcnt(10)
    v_mfma_f32_16x16x32_bf16 v[64:67], v[48:51], v[200:203], v[64:67]
    ds_read_b64_tr_b16 v[44:45], v6 offset:40960
    v_mfma_f32_16x16x32_bf16 v[68:71], v[48:51], v[204:207], v[68:71]
    ds_read_b64_tr_b16 v[46:47], v6 offset:41984
    v_mfma_f32_16x16x32_bf16 v[72:75], v[52:55], v[200:203], v[72:75]
    ds_read_b64_tr_b16 v[48:49], v3 offset:45056
    v_mfma_f32_16x16x32_bf16 v[76:79], v[52:55], v[204:207], v[76:79]
    ds_read_b64_tr_b16 v[50:51], v3 offset:46080
    s_waitcnt lgkmcnt(10)
    v_mfma_f32_16x16x32_bf16 v[80:83], v[56:59], v[200:203], v[80:83]
    ds_read_b64_tr_b16 v[52:53], v4 offset:45056
    v_mfma_f32_16x16x32_bf16 v[84:87], v[56:59], v[204:207], v[84:87]
    ds_read_b64_tr_b16 v[54:55], v4 offset:46080
    v_mfma_f32_16x16x32_bf16 v[88:91], v[60:63], v[200:203], v[88:91]
    ds_read_b64_tr_b16 v[56:57], v5 offset:45056
    v_mfma_f32_16x16x32_bf16 v[92:95], v[60:63], v[204:207], v[92:95]
    ds_read_b64_tr_b16 v[58:59], v5 offset:46080
    s_waitcnt vmcnt(2) lgkmcnt(10)
    v_mfma_f32_16x16x32_bf16 v[64:67], v[32:35], v[208:211], v[64:67]
    ds_read_b64_tr_b16 v[60:61], v6 offset:45056
    v_mfma_f32_16x16x32_bf16 v[68:71], v[32:35], v[212:215], v[68:71]
    ds_read_b64_tr_b16 v[62:63], v6 offset:46080
    v_mfma_f32_16x16x32_bf16 v[72:75], v[36:39], v[208:211], v[72:75]
    ds_read_b64_tr_b16 v[32:33], v3 offset:49152
    ds_read_b32 v8, v9 offset:4096
    v_mfma_f32_16x16x32_bf16 v[76:79], v[36:39], v[212:215], v[76:79]
    ds_read_b64_tr_b16 v[34:35], v3 offset:50176
    ds_read_b32 v10, v9 offset:4608
    s_waitcnt lgkmcnt(12)
    v_mfma_f32_16x16x32_bf16 v[80:83], v[40:43], v[208:211], v[80:83]
    ds_read_b64_tr_b16 v[36:37], v4 offset:49152
    ds_read_b32 v12, v9 offset:4160
    v_mfma_f32_16x16x32_bf16 v[84:87], v[40:43], v[212:215], v[84:87]
    ds_read_b64_tr_b16 v[38:39], v4 offset:50176
    ds_read_b32 v14, v9 offset:4672
    v_mfma_f32_16x16x32_bf16 v[88:91], v[44:47], v[208:211], v[88:91]
    ds_read_b64_tr_b16 v[40:41], v5 offset:49152
    ds_read_b128 v[16:19], v11 offset:256
    v_mfma_f32_16x16x32_bf16 v[92:95], v[44:47], v[212:215], v[92:95]
    ds_read_b64_tr_b16 v[42:43], v5 offset:50176
    ds_read_b128 v[20:23], v11 offset:320
    s_waitcnt vmcnt(0) lgkmcnt(14)
    v_mfma_f32_16x16x32_bf16 v[64:67], v[48:51], v[216:219], v[64:67]
    ds_read_b64_tr_b16 v[44:45], v6 offset:49152
    ds_read_b128 v[24:27], v11 offset:384
    v_mfma_f32_16x16x32_bf16 v[68:71], v[48:51], v[220:223], v[68:71]
    ds_read_b64_tr_b16 v[46:47], v6 offset:50176
    ds_read_b128 v[28:31], v11 offset:448
    v_mfma_f32_16x16x32_bf16 v[72:75], v[52:55], v[216:219], v[72:75]
    ds_read_b64_tr_b16 v[48:49], v3 offset:53248
    v_mfma_f32_16x16x32_bf16 v[76:79], v[52:55], v[220:223], v[76:79]
    ds_read_b64_tr_b16 v[50:51], v3 offset:54272
    s_waitcnt lgkmcnt(14)
    v_mfma_f32_16x16x32_bf16 v[80:83], v[56:59], v[216:219], v[80:83]
    ds_read_b64_tr_b16 v[52:53], v4 offset:53248
    v_mfma_f32_16x16x32_bf16 v[84:87], v[56:59], v[220:223], v[84:87]
    ds_read_b64_tr_b16 v[54:55], v4 offset:54272
    v_mfma_f32_16x16x32_bf16 v[88:91], v[60:63], v[216:219], v[88:91]
    ds_read_b64_tr_b16 v[56:57], v5 offset:53248
    v_mfma_f32_16x16x32_bf16 v[92:95], v[60:63], v[220:223], v[92:95]
    ds_read_b64_tr_b16 v[58:59], v5 offset:54272
    s_bitcmp1_b32 s21, 0
    s_cbranch_scc1 c_B
    v_add_u32 v7, s62, v1
    s_waitcnt lgkmcnt(6)
    v_pk_fma_f32 v[68:69], v[12:13], v[16:17], v[68:69] op_sel_hi:[0,1,1] neg_lo:[1,0,0] neg_hi:[1,0,0]
    v_pk_fma_f32 v[70:71], v[12:13], v[18:19], v[70:71] op_sel_hi:[0,1,1] neg_lo:[1,0,0] neg_hi:[1,0,0]
    v_pk_fma_f32 v[76:77], v[12:13], v[20:21], v[76:77] op_sel_hi:[0,1,1] neg_lo:[1,0,0] neg_hi:[1,0,0]
    v_pk_fma_f32 v[78:79], v[12:13], v[22:23], v[78:79] op_sel_hi:[0,1,1] neg_lo:[1,0,0] neg_hi:[1,0,0]
    v_pk_mul_f32 v[68:69], v[14:15], v[68:69] op_sel_hi:[0,1]
    v_pk_mul_f32 v[70:71], v[14:15], v[70:71] op_sel_hi:[0,1]
    v_pk_mul_f32 v[76:77], v[14:15], v[76:77] op_sel_hi:[0,1]
    v_pk_mul_f32 v[78:79], v[14:15], v[78:79] op_sel_hi:[0,1]
    v_cvt_pk_bf16_f32 v68, v68, v69
    v_cvt_pk_bf16_f32 v69, v70, v71
    v_cvt_pk_bf16_f32 v70, v76, v77
    v_cvt_pk_bf16_f32 v71, v78, v79
    ds_write_b128 v7, v[68:71] offset:4096
    v_pk_fma_f32 v[64:65], v[8:9], v[16:17], v[64:65] op_sel_hi:[0,1,1] neg_lo:[1,0,0] neg_hi:[1,0,0]
    v_pk_fma_f32 v[66:67], v[8:9], v[18:19], v[66:67] op_sel_hi:[0,1,1] neg_lo:[1,0,0] neg_hi:[1,0,0]
    v_pk_fma_f32 v[72:73], v[8:9], v[20:21], v[72:73] op_sel_hi:[0,1,1] neg_lo:[1,0,0] neg_hi:[1,0,0]
    v_pk_fma_f32 v[74:75], v[8:9], v[22:23], v[74:75] op_sel_hi:[0,1,1] neg_lo:[1,0,0] neg_hi:[1,0,0]
    v_pk_mul_f32 v[64:65], v[10:11], v[64:65] op_sel_hi:[0,1]
    v_pk_mul_f32 v[66:67], v[10:11], v[66:67] op_sel_hi:[0,1]
    v_pk_mul_f32 v[72:73], v[10:11], v[72:73] op_sel_hi:[0,1]
    v_pk_mul_f32 v[74:75], v[10:11], v[74:75] op_sel_hi:[0,1]
    v_cvt_pk_bf16_f32 v64, v64, v65
    v_cvt_pk_bf16_f32 v65, v66, v67
    v_cvt_pk_bf16_f32 v66, v72, v73
    v_cvt_pk_bf16_f32 v67, v74, v75
    v_pk_fma_f32 v[84:85], v[12:13], v[24:25], v[84:85] op_sel_hi:[0,1,1] neg_lo:[1,0,0] neg_hi:[1,0,0]
    v_pk_fma_f32 v[86:87], v[12:13], v[26:27], v[86:87] op_sel_hi:[0,1,1] neg_lo:[1,0,0] neg_hi:[1,0,0]
    v_pk_fma_f32 v[92:93], v[12:13], v[28:29], v[92:93] op_sel_hi:[0,1,1] neg_lo:[1,0,0] neg_hi:[1,0,0]
    v_pk_fma_f32 v[94:95], v[12:13], v[30:31], v[94:95] op_sel_hi:[0,1,1] neg_lo:[1,0,0] neg_hi:[1,0,0]
    v_pk_mul_f32 v[84:85], v[14:15], v[84:85] op_sel_hi:[0,1]
    v_pk_mul_f32 v[86:87], v[14:15], v[86:87] op_sel_hi:[0,1]
    v_pk_mul_f32 v[92:93], v[14:15], v[92:93] op_sel_hi:[0,1]
    v_pk_mul_f32 v[94:95], v[14:15], v[94:95] op_sel_hi:[0,1]
    v_cvt_pk_bf16_f32 v84, v84, v85
    v_cvt_pk_bf16_f32 v85, v86, v87
    v_cvt_pk_bf16_f32 v86, v92, v93
    v_cvt_pk_bf16_f32 v87, v94, v95
    ds_write_b128 v7, v[84:87] offset:5120
    v_pk_fma_f32 v[80:81], v[8:9], v[24:25], v[80:81] op_sel_hi:[0,1,1] neg_lo:[1,0,0] neg_hi:[1,0,0]
    v_pk_fma_f32 v[82:83], v[8:9], v[26:27], v[82:83] op_sel_hi:[0,1,1] neg_lo:[1,0,0] neg_hi:[1,0,0]
    v_pk_fma_f32 v[88:89], v[8:9], v[28:29], v[88:89] op_sel_hi:[0,1,1] neg_lo:[1,0,0] neg_hi:[1,0,0]
    v_pk_fma_f32 v[90:91], v[8:9], v[30:31], v[90:91] op_sel_hi:[0,1,1] neg_lo:[1,0,0] neg_hi:[1,0,0]
    v_pk_mul_f32 v[80:81], v[10:11], v[80:81] op_sel_hi:[0,1]
    v_pk_mul_f32 v[82:83], v[10:11], v[82:83] op_sel_hi:[0,1]
    v_pk_mul_f32 v[88:89], v[10:11], v[88:89] op_sel_hi:[0,1]
    v_pk_mul_f32 v[90:91], v[10:11], v[90:91] op_sel_hi:[0,1]
    v_cvt_pk_bf16_f32 v80, v80, v81
    v_cvt_pk_bf16_f32 v81, v82, v83
    v_cvt_pk_bf16_f32 v82, v88, v89
    v_cvt_pk_bf16_f32 v83, v90, v91
    v_mfma_f32_16x16x32_bf16 v[96:99], v[160:163], v[32:35], v[96:99]
    ds_read_b64_tr_b16 v[60:61], v6 offset:53248
    v_mfma_f32_16x16x32_bf16 v[100:103], v[164:167], v[32:35], v[100:103]
    ds_read_b64_tr_b16 v[62:63], v6 offset:54272
    v_mfma_f32_16x16x32_bf16 v[104:107], v[160:163], v[36:39], v[104:107]
    ds_read_b64_tr_b16 v[32:33], v3 offset:57344
    v_mfma_f32_16x16x32_bf16 v[108:111], v[164:167], v[36:39], v[108:111]
    ds_read_b64_tr_b16 v[34:35], v3 offset:58368
    v_mfma_f32_16x16x32_bf16 v[112:115], v[160:163], v[40:43], v[112:115]
    ds_read_b64_tr_b16 v[36:37], v4 offset:57344
    v_mfma_f32_16x16x32_bf16 v[116:119], v[164:167], v[40:43], v[116:119]
    ds_read_b64_tr_b16 v[38:39], v4 offset:58368
    v_mfma_f32_16x16x32_bf16 v[120:123], v[160:163], v[44:47], v[120:123]
    ds_read_b64_tr_b16 v[40:41], v5 offset:57344
    v_mfma_f32_16x16x32_bf16 v[124:127], v[164:167], v[44:47], v[124:127]
    ds_read_b64_tr_b16 v[42:43], v5 offset:58368
    s_waitcnt lgkmcnt(12)
    v_mfma_f32_16x16x32_bf16 v[96:99], v[168:171], v[48:51], v[96:99]
    ds_read_b64_tr_b16 v[44:45], v6 offset:57344
    v_mfma_f32_16x16x32_bf16 v[100:103], v[172:175], v[48:51], v[100:103]
    ds_read_b64_tr_b16 v[46:47], v6 offset:58368
    v_mfma_f32_16x16x32_bf16 v[104:107], v[168:171], v[52:55], v[104:107]
    ds_read_b64_tr_b16 v[48:49], v3 offset:61440
    v_mfma_f32_16x16x32_bf16 v[108:111], v[172:175], v[52:55], v[108:111]
    ds_read_b64_tr_b16 v[50:51], v3 offset:62464
    s_waitcnt lgkmcnt(10)
    v_mfma_f32_16x16x32_bf16 v[112:115], v[168:171], v[56:59], v[112:115]
    ds_read_b64_tr_b16 v[52:53], v4 offset:61440
    v_mfma_f32_16x16x32_bf16 v[116:119], v[172:175], v[56:59], v[116:119]
    ds_read_b64_tr_b16 v[54:55], v4 offset:62464
    v_mfma_f32_16x16x32_bf16 v[120:123], v[168:171], v[60:63], v[120:123]
    ds_read_b64_tr_b16 v[56:57], v5 offset:61440
    v_mfma_f32_16x16x32_bf16 v[124:127], v[172:175], v[60:63], v[124:127]
    ds_read_b64_tr_b16 v[58:59], v5 offset:62464
    s_waitcnt lgkmcnt(10)
    v_mfma_f32_16x16x32_bf16 v[96:99], v[176:179], v[32:35], v[96:99]
    ds_read_b64_tr_b16 v[60:61], v6 offset:61440
    v_mfma_f32_16x16x32_bf16 v[100:103], v[180:183], v[32:35], v[100:103]
    ds_read_b64_tr_b16 v[62:63], v6 offset:62464
    s_barrier
    v_xor_b32 v3, 0x10000, v3
    v_xor_b32 v4, 0x10000, v4
    v_xor_b32 v5, 0x10000, v5
    v_xor_b32 v6, 0x10000, v6
    v_mfma_f32_16x16x32_bf16 v[104:107], v[176:179], v[36:39], v[104:107]
    ds_read_b64_tr_b16 v[32:33], v3 offset:0
    v_mfma_f32_16x16x32_bf16 v[108:111], v[180:183], v[36:39], v[108:111]
    ds_read_b64_tr_b16 v[34:35], v3 offset:1024
    s_waitcnt lgkmcnt(10)
    v_mfma_f32_16x16x32_bf16 v[112:115], v[176:179], v[40:43], v[112:115]
    ds_read_b64_tr_b16 v[36:37], v4 offset:0
    v_mfma_f32_16x16x32_bf16 v[116:119], v[180:183], v[40:43], v[116:119]
    ds_read_b64_tr_b16 v[38:39], v4 offset:1024
    v_mfma_f32_16x16x32_bf16 v[120:123], v[176:179], v[44:47], v[120:123]
    ds_read_b64_tr_b16 v[40:41], v5 offset:0
    v_mfma_f32_16x16x32_bf16 v[124:127], v[180:183], v[44:47], v[124:127]
    ds_read_b64_tr_b16 v[42:43], v5 offset:1024
    s_waitcnt lgkmcnt(10)
    v_mfma_f32_16x16x32_bf16 v[96:99], v[184:187], v[48:51], v[96:99]
    ds_read_b64_tr_b16 v[44:45], v6 offset:0
    v_mfma_f32_16x16x32_bf16 v[100:103], v[188:191], v[48:51], v[100:103]
    ds_read_b64_tr_b16 v[46:47], v6 offset:1024
    v_mfma_f32_16x16x32_bf16 v[104:107], v[184:187], v[52:55], v[104:107]
    ds_read_b64_tr_b16 v[48:49], v3 offset:4096
    v_mfma_f32_16x16x32_bf16 v[108:111], v[188:191], v[52:55], v[108:111]
    ds_read_b64_tr_b16 v[50:51], v3 offset:5120
    s_waitcnt lgkmcnt(10)
    v_mfma_f32_16x16x32_bf16 v[112:115], v[184:187], v[56:59], v[112:115]
    ds_read_b64_tr_b16 v[52:53], v4 offset:4096
    v_mfma_f32_16x16x32_bf16 v[116:119], v[188:191], v[56:59], v[116:119]
    ds_read_b64_tr_b16 v[54:55], v4 offset:5120
    v_mfma_f32_16x16x32_bf16 v[120:123], v[184:187], v[60:63], v[120:123]
    ds_read_b64_tr_b16 v[56:57], v5 offset:4096
    v_mfma_f32_16x16x32_bf16 v[124:127], v[188:191], v[60:63], v[124:127]
    ds_read_b64_tr_b16 v[58:59], v5 offset:5120
    s_waitcnt lgkmcnt(10)
    v_mfma_f32_16x16x32_bf16 v[96:99], v[192:195], v[32:35], v[96:99]
    ds_read_b64_tr_b16 v[60:61], v6 offset:4096
    v_mfma_f32_16x16x32_bf16 v[100:103], v[196:199], v[32:35], v[100:103]
    ds_read_b64_tr_b16 v[62:63], v6 offset:5120
    v_mfma_f32_16x16x32_bf16 v[104:107], v[192:195], v[36:39], v[104:107]
    ds_read_b64_tr_b16 v[32:33], v3 offset:8192
    v_mfma_f32_16x16x32_bf16 v[108:111], v[196:199], v[36:39], v[108:111]
    ds_read_b64_tr_b16 v[34:35], v3 offset:9216
    s_waitcnt lgkmcnt(10)
    v_mfma_f32_16x16x32_bf16 v[112:115], v[192:195], v[40:43], v[112:115]
    ds_read_b64_tr_b16 v[36:37], v4 offset:8192
    v_mfma_f32_16x16x32_bf16 v[116:119], v[196:199], v[40:43], v[116:119]
    ds_read_b64_tr_b16 v[38:39], v4 offset:9216
    v_mfma_f32_16x16x32_bf16 v[120:123], v[192:195], v[44:47], v[120:123]
    ds_read_b64_tr_b16 v[40:41], v5 offset:8192
    v_mfma_f32_16x16x32_bf16 v[124:127], v[196:199], v[44:47], v[124:127]
    ds_read_b64_tr_b16 v[42:43], v5 offset:9216
    s_waitcnt lgkmcnt(10)
    v_mfma_f32_16x16x32_bf16 v[96:99], v[200:203], v[48:51], v[96:99]
    ds_read_b64_tr_b16 v[44:45], v6 offset:8192
    v_mfma_f32_16x16x32_bf16 v[100:103], v[204:207], v[48:51], v[100:103]
    ds_read_b64_tr_b16 v[46:47], v6 offset:9216
    v_mfma_f32_16x16x32_bf16 v[104:107], v[200:203], v[52:55], v[104:107]
    ds_read_b64_tr_b16 v[48:49], v3 offset:12288
    v_mfma_f32_16x16x32_bf16 v[108:111], v[204:207], v[52:55], v[108:111]
    ds_read_b64_tr_b16 v[50:51], v3 offset:13312
    s_waitcnt lgkmcnt(10)
    v_mfma_f32_16x16x32_bf16 v[112:115], v[200:203], v[56:59], v[112:115]
    ds_read_b64_tr_b16 v[52:53], v4 offset:12288
    v_mfma_f32_16x16x32_bf16 v[116:119], v[204:207], v[56:59], v[116:119]
    ds_read_b64_tr_b16 v[54:55], v4 offset:13312
    v_mfma_f32_16x16x32_bf16 v[120:123], v[200:203], v[60:63], v[120:123]
    ds_read_b64_tr_b16 v[56:57], v5 offset:12288
    v_mfma_f32_16x16x32_bf16 v[124:127], v[204:207], v[60:63], v[124:127]
    ds_read_b64_tr_b16 v[58:59], v5 offset:13312
    s_waitcnt lgkmcnt(10)
    v_mfma_f32_16x16x32_bf16 v[96:99], v[208:211], v[32:35], v[96:99]
    ds_read_b64_tr_b16 v[60:61], v6 offset:12288
    v_mfma_f32_16x16x32_bf16 v[100:103], v[212:215], v[32:35], v[100:103]
    ds_read_b64_tr_b16 v[62:63], v6 offset:13312
    v_mfma_f32_16x16x32_bf16 v[104:107], v[208:211], v[36:39], v[104:107]
    ds_read_b64_tr_b16 v[32:33], v3 offset:16384
    ds_read_b128 v[16:19], v13 offset:4096
    v_mfma_f32_16x16x32_bf16 v[108:111], v[212:215], v[36:39], v[108:111]
    ds_read_b64_tr_b16 v[34:35], v3 offset:17408
    ds_read_b128 v[20:23], v13 offset:4608
    s_waitcnt lgkmcnt(12)
    v_mfma_f32_16x16x32_bf16 v[112:115], v[208:211], v[40:43], v[112:115]
    ds_read_b64_tr_b16 v[36:37], v4 offset:16384
    ds_read_b128 v[24:27], v13 offset:4160
    v_mfma_f32_16x16x32_bf16 v[116:119], v[212:215], v[40:43], v[116:119]
    ds_read_b64_tr_b16 v[38:39], v4 offset:17408
    ds_read_b128 v[28:31], v13 offset:4672
    v_mfma_f32_16x16x32_bf16 v[120:123], v[208:211], v[44:47], v[120:123]
    ds_read_b64_tr_b16 v[40:41], v5 offset:16384
    ds_read_b32 v8, v15 offset:512
    v_mfma_f32_16x16x32_bf16 v[124:127], v[212:215], v[44:47], v[124:127]
    ds_read_b64_tr_b16 v[42:43], v5 offset:17408
    ds_read_b32 v10, v15 offset:576
    s_waitcnt lgkmcnt(14)
    v_mfma_f32_16x16x32_bf16 v[96:99], v[216:219], v[48:51], v[96:99]
    ds_read_b64_tr_b16 v[44:45], v6 offset:16384
    ds_read_b32 v12, v15 offset:640
    v_mfma_f32_16x16x32_bf16 v[100:103], v[220:223], v[48:51], v[100:103]
    ds_read_b64_tr_b16 v[46:47], v6 offset:17408
    ds_read_b32 v14, v15 offset:704
    v_mfma_f32_16x16x32_bf16 v[104:107], v[216:219], v[52:55], v[104:107]
    ds_read_b64_tr_b16 v[48:49], v3 offset:20480
    v_mfma_f32_16x16x32_bf16 v[108:111], v[220:223], v[52:55], v[108:111]
    ds_read_b64_tr_b16 v[50:51], v3 offset:21504
    s_waitcnt lgkmcnt(14)
    v_mfma_f32_16x16x32_bf16 v[112:115], v[216:219], v[56:59], v[112:115]
    ds_read_b64_tr_b16 v[52:53], v4 offset:20480
    v_mfma_f32_16x16x32_bf16 v[116:119], v[220:223], v[56:59], v[116:119]
    ds_read_b64_tr_b16 v[54:55], v4 offset:21504
    v_mfma_f32_16x16x32_bf16 v[120:123], v[216:219], v[60:63], v[120:123]
    ds_read_b64_tr_b16 v[56:57], v5 offset:20480
    v_mfma_f32_16x16x32_bf16 v[124:127], v[220:223], v[60:63], v[124:127]
    ds_read_b64_tr_b16 v[58:59], v5 offset:21504
    s_waitcnt lgkmcnt(6)
    v_pk_fma_f32 v[100:101], v[8:9], v[24:25], v[100:101] op_sel_hi:[0,1,1] neg_lo:[1,0,0] neg_hi:[1,0,0]
    v_pk_fma_f32 v[102:103], v[8:9], v[26:27], v[102:103] op_sel_hi:[0,1,1] neg_lo:[1,0,0] neg_hi:[1,0,0]
    v_pk_fma_f32 v[108:109], v[10:11], v[24:25], v[108:109] op_sel_hi:[0,1,1] neg_lo:[1,0,0] neg_hi:[1,0,0]
    v_pk_fma_f32 v[110:111], v[10:11], v[26:27], v[110:111] op_sel_hi:[0,1,1] neg_lo:[1,0,0] neg_hi:[1,0,0]
    v_pk_mul_f32 v[100:101], v[28:29], v[100:101]
    v_pk_mul_f32 v[102:103], v[30:31], v[102:103]
    v_pk_mul_f32 v[108:109], v[28:29], v[108:109]
    v_pk_mul_f32 v[110:111], v[30:31], v[110:111]
    v_cvt_pk_bf16_f32 v74, v100, v101
    v_cvt_pk_bf16_f32 v75, v102, v103
    v_cvt_pk_bf16_f32 v78, v108, v109
    v_cvt_pk_bf16_f32 v79, v110, v111
    v_cvt_pk_bf16_f32 v100, v100, v101
    v_cvt_pk_bf16_f32 v101, v102, v103
    v_cvt_pk_bf16_f32 v102, v108, v109
    v_cvt_pk_bf16_f32 v103, v110, v111
    ds_write_b128 v7, v[100:103] offset:6144
    v_pk_fma_f32 v[116:117], v[12:13], v[24:25], v[116:117] op_sel_hi:[0,1,1] neg_lo:[1,0,0] neg_hi:[1,0,0]
    v_pk_fma_f32 v[118:119], v[12:13], v[26:27], v[118:119] op_sel_hi:[0,1,1] neg_lo:[1,0,0] neg_hi:[1,0,0]
    v_pk_fma_f32 v[124:125], v[14:15], v[24:25], v[124:125] op_sel_hi:[0,1,1] neg_lo:[1,0,0] neg_hi:[1,0,0]
    v_pk_fma_f32 v[126:127], v[14:15], v[26:27], v[126:127] op_sel_hi:[0,1,1] neg_lo:[1,0,0] neg_hi:[1,0,0]
    v_pk_mul_f32 v[116:117], v[28:29], v[116:117]
    v_pk_mul_f32 v[118:119], v[30:31], v[118:119]
    v_pk_mul_f32 v[124:125], v[28:29], v[124:125]
    v_pk_mul_f32 v[126:127], v[30:31], v[126:127]
    v_cvt_pk_bf16_f32 v90, v116, v117
    v_cvt_pk_bf16_f32 v91, v118, v119
    v_cvt_pk_bf16_f32 v94, v124, v125
    v_cvt_pk_bf16_f32 v95, v126, v127
    v_cvt_pk_bf16_f32 v116, v116, v117
    v_cvt_pk_bf16_f32 v117, v118, v119
    v_cvt_pk_bf16_f32 v118, v124, v125
    v_cvt_pk_bf16_f32 v119, v126, v127
    ds_write_b128 v7, v[116:119] offset:7168
    s_cmp_lg_u32 s16, 3
    s_cbranch_scc1 a_nh
    buffer_store_dwordx4 v[68:71], v1, s[4:7], s60 offen offset:0 sc1
    buffer_store_dwordx4 v[84:87], v1, s[4:7], s60 offen offset:1024 sc1
    buffer_store_dwordx4 v[100:103], v1, s[4:7], s60 offen offset:2048 sc1
    buffer_store_dwordx4 v[116:119], v1, s[4:7], s60 offen offset:3072 sc1
a_nh:
    v_pk_fma_f32 v[96:97], v[8:9], v[16:17], v[96:97] op_sel_hi:[0,1,1] neg_lo:[1,0,0] neg_hi:[1,0,0]
    v_pk_fma_f32 v[98:99], v[8:9], v[18:19], v[98:99] op_sel_hi:[0,1,1] neg_lo:[1,0,0] neg_hi:[1,0,0]
    v_pk_fma_f32 v[104:105], v[10:11], v[16:17], v[104:105] op_sel_hi:[0,1,1] neg_lo:[1,0,0] neg_hi:[1,0,0]
    v_pk_fma_f32 v[106:107], v[10:11], v[18:19], v[106:107] op_sel_hi:[0,1,1] neg_lo:[1,0,0] neg_hi:[1,0,0]
    v_pk_mul_f32 v[96:97], v[20:21], v[96:97]
    v_pk_mul_f32 v[98:99], v[22:23], v[98:99]
    v_pk_mul_f32 v[104:105], v[20:21], v[104:105]
    v_pk_mul_f32 v[106:107], v[22:23], v[106:107]
    v_cvt_pk_bf16_f32 v72, v96, v97
    v_cvt_pk_bf16_f32 v73, v98, v99
    v_cvt_pk_bf16_f32 v76, v104, v105
    v_cvt_pk_bf16_f32 v77, v106, v107
    v_pk_fma_f32 v[112:113], v[12:13], v[16:17], v[112:113] op_sel_hi:[0,1,1] neg_lo:[1,0,0] neg_hi:[1,0,0]
    v_pk_fma_f32 v[114:115], v[12:13], v[18:19], v[114:115] op_sel_hi:[0,1,1] neg_lo:[1,0,0] neg_hi:[1,0,0]
    v_pk_fma_f32 v[120:121], v[14:15], v[16:17], v[120:121] op_sel_hi:[0,1,1] neg_lo:[1,0,0] neg_hi:[1,0,0]
    v_pk_fma_f32 v[122:123], v[14:15], v[18:19], v[122:123] op_sel_hi:[0,1,1] neg_lo:[1,0,0] neg_hi:[1,0,0]
    v_pk_mul_f32 v[112:113], v[20:21], v[112:113]
    v_pk_mul_f32 v[114:115], v[22:23], v[114:115]
    v_pk_mul_f32 v[120:121], v[20:21], v[120:121]
    v_pk_mul_f32 v[122:123], v[22:23], v[122:123]
    v_cvt_pk_bf16_f32 v88, v112, v113
    v_cvt_pk_bf16_f32 v89, v114, v115
    v_cvt_pk_bf16_f32 v92, v120, v121
    v_cvt_pk_bf16_f32 v93, v122, v123
    v_mfma_f32_16x16x32_bf16 v[128:131], v[32:35], v[224:227], v[128:131]
    ds_read_b64_tr_b16 v[60:61], v6 offset:20480
    v_mfma_f32_16x16x32_bf16 v[132:135], v[32:35], v[228:231], v[132:135]
    ds_read_b64_tr_b16 v[62:63], v6 offset:21504
    v_mfma_f32_16x16x32_bf16 v[136:139], v[36:39], v[224:227], v[136:139]
    ds_read_b64_tr_b16 v[32:33], v3 offset:24576
    v_mfma_f32_16x16x32_bf16 v[140:143], v[36:39], v[228:231], v[140:143]
    ds_read_b64_tr_b16 v[34:35], v3 offset:25600
    v_mfma_f32_16x16x32_bf16 v[144:147], v[40:43], v[224:227], v[144:147]
    ds_read_b64_tr_b16 v[36:37], v4 offset:24576
    v_mfma_f32_16x16x32_bf16 v[148:151], v[40:43], v[228:231], v[148:151]
    ds_read_b64_tr_b16 v[38:39], v4 offset:25600
    v_mfma_f32_16x16x32_bf16 v[152:155], v[44:47], v[224:227], v[152:155]
    ds_read_b64_tr_b16 v[40:41], v5 offset:24576
    v_mfma_f32_16x16x32_bf16 v[156:159], v[44:47], v[228:231], v[156:159]
    ds_read_b64_tr_b16 v[42:43], v5 offset:25600
    s_waitcnt lgkmcnt(12)
    v_mfma_f32_16x16x32_bf16 v[128:131], v[48:51], v[232:235], v[128:131]
    ds_read_b64_tr_b16 v[44:45], v6 offset:24576
    v_mfma_f32_16x16x32_bf16 v[132:135], v[48:51], v[236:239], v[132:135]
    ds_read_b64_tr_b16 v[46:47], v6 offset:25600
    v_mfma_f32_16x16x32_bf16 v[136:139], v[52:55], v[232:235], v[136:139]
    ds_read_b64_tr_b16 v[48:49], v3 offset:28672
    v_mfma_f32_16x16x32_bf16 v[140:143], v[52:55], v[236:239], v[140:143]
    ds_read_b64_tr_b16 v[50:51], v3 offset:29696
    s_waitcnt lgkmcnt(10)
    v_mfma_f32_16x16x32_bf16 v[144:147], v[56:59], v[232:235], v[144:147]
    ds_read_b64_tr_b16 v[52:53], v4 offset:28672
    v_mfma_f32_16x16x32_bf16 v[148:151], v[56:59], v[236:239], v[148:151]
    ds_read_b64_tr_b16 v[54:55], v4 offset:29696
    v_mfma_f32_16x16x32_bf16 v[152:155], v[60:63], v[232:235], v[152:155]
    ds_read_b64_tr_b16 v[56:57], v5 offset:28672
    v_mfma_f32_16x16x32_bf16 v[156:159], v[60:63], v[236:239], v[156:159]
    ds_read_b64_tr_b16 v[58:59], v5 offset:29696
    s_waitcnt lgkmcnt(10)
    v_mfma_f32_16x16x32_bf16 v[128:131], v[32:35], v[240:243], v[128:131]
    ds_read_b64_tr_b16 v[60:61], v6 offset:28672
    v_mfma_f32_16x16x32_bf16 v[132:135], v[32:35], v[244:247], v[132:135]
    ds_read_b64_tr_b16 v[62:63], v6 offset:29696
    s_barrier
    v_mfma_f32_16x16x32_bf16 v[136:139], v[36:39], v[240:243], v[136:139]
    ds_read_b64_tr_b16 v[32:33], v3 offset:32768
    v_mfma_f32_16x16x32_bf16 v[140:143], v[36:39], v[244:247], v[140:143]
    ds_read_b64_tr_b16 v[34:35], v3 offset:33792
    s_waitcnt lgkmcnt(10)
    v_mfma_f32_16x16x32_bf16 v[144:147], v[40:43], v[240:243], v[144:147]
    ds_read_b64_tr_b16 v[36:37], v4 offset:32768
    v_mfma_f32_16x16x32_bf16 v[148:151], v[40:43], v[244:247], v[148:151]
    ds_read_b64_tr_b16 v[38:39], v4 offset:33792
    v_mfma_f32_16x16x32_bf16 v[152:155], v[44:47], v[240:243], v[152:155]
    ds_read_b64_tr_b16 v[40:41], v5 offset:32768
    v_mfma_f32_16x16x32_bf16 v[156:159], v[44:47], v[244:247], v[156:159]
    ds_read_b64_tr_b16 v[42:43], v5 offset:33792
    s_waitcnt lgkmcnt(10)
    v_mfma_f32_16x16x32_bf16 v[128:131], v[48:51], v[248:251], v[128:131]
    ds_read_b64_tr_b16 v[44:45], v6 offset:32768
    v_mfma_f32_16x16x32_bf16 v[132:135], v[48:51], v[252:255], v[132:135]
    ds_read_b64_tr_b16 v[46:47], v6 offset:33792
    v_mfma_f32_16x16x32_bf16 v[136:139], v[52:55], v[248:251], v[136:139]
    ds_read_b64_tr_b16 v[48:49], v3 offset:36864
    v_mfma_f32_16x16x32_bf16 v[140:143], v[52:55], v[252:255], v[140:143]
    ds_read_b64_tr_b16 v[50:51], v3 offset:37888
    s_waitcnt lgkmcnt(10)
    v_mfma_f32_16x16x32_bf16 v[144:147], v[56:59], v[248:251], v[144:147]
    ds_read_b64_tr_b16 v[52:53], v4 offset:36864
    v_mfma_f32_16x16x32_bf16 v[148:151], v[56:59], v[252:255], v[148:151]
    ds_read_b64_tr_b16 v[54:55], v4 offset:37888
    v_mfma_f32_16x16x32_bf16 v[152:155], v[60:63], v[248:251], v[152:155]
    ds_read_b64_tr_b16 v[56:57], v5 offset:36864
    v_mfma_f32_16x16x32_bf16 v[156:159], v[60:63], v[252:255], v[156:159]
    ds_read_b64_tr_b16 v[58:59], v5 offset:37888
    s_waitcnt lgkmcnt(10)
    v_mfma_f32_16x16x32_bf16 v[128:131], v[32:35], v[160:163], v[128:131]
    ds_read_b64_tr_b16 v[60:61], v6 offset:36864
    v_mfma_f32_16x16x32_bf16 v[132:135], v[32:35], v[164:167], v[132:135]
    ds_read_b64_tr_b16 v[62:63], v6 offset:37888
    v_mfma_f32_16x16x32_bf16 v[136:139], v[36:39], v[160:163], v[136:139]
    ds_read_b64_tr_b16 v[32:33], v3 offset:40960
    v_mfma_f32_16x16x32_bf16 v[140:143], v[36:39], v[164:167], v[140:143]
    ds_read_b64_tr_b16 v[34:35], v3 offset:41984
    s_waitcnt lgkmcnt(10)
    v_mfma_f32_16x16x32_bf16 v[144:147], v[40:43], v[160:163], v[144:147]
    ds_read_b64_tr_b16 v[36:37], v4 offset:40960
    v_mfma_f32_16x16x32_bf16 v[148:151], v[40:43], v[164:167], v[148:151]
    ds_read_b64_tr_b16 v[38:39], v4 offset:41984
    v_mfma_f32_16x16x32_bf16 v[152:155], v[44:47], v[160:163], v[152:155]
    ds_read_b64_tr_b16 v[40:41], v5 offset:40960
    v_mfma_f32_16x16x32_bf16 v[156:159], v[44:47], v[164:167], v[156:159]
    ds_read_b64_tr_b16 v[42:43], v5 offset:41984
    s_waitcnt lgkmcnt(10)
    v_mfma_f32_16x16x32_bf16 v[128:131], v[48:51], v[168:171], v[128:131]
    ds_read_b64_tr_b16 v[44:45], v6 offset:40960
    s_cmp_lg_u32 s16, 3
    s_cbranch_scc1 a_nopub
    s_waitcnt vmcnt(0)
    s_atomic_add s40, s[22:23], s61
a_nopub:
    v_mfma_f32_16x16x32_bf16 v[132:135], v[48:51], v[172:175], v[132:135]
    ds_read_b64_tr_b16 v[46:47], v6 offset:41984
    v_mfma_f32_16x16x32_bf16 v[136:139], v[52:55], v[168:171], v[136:139]
    ds_read_b64_tr_b16 v[48:49], v3 offset:45056
    v_mfma_f32_16x16x32_bf16 v[140:143], v[52:55], v[172:175], v[140:143]
    ds_read_b64_tr_b16 v[50:51], v3 offset:46080
    s_waitcnt lgkmcnt(10)
    v_mfma_f32_16x16x32_bf16 v[144:147], v[56:59], v[168:171], v[144:147]
    ds_read_b64_tr_b16 v[52:53], v4 offset:45056
    v_mfma_f32_16x16x32_bf16 v[148:151], v[56:59], v[172:175], v[148:151]
    ds_read_b64_tr_b16 v[54:55], v4 offset:46080
    v_mfma_f32_16x16x32_bf16 v[152:155], v[60:63], v[168:171], v[152:155]
    ds_read_b64_tr_b16 v[56:57], v5 offset:45056
    v_mfma_f32_16x16x32_bf16 v[156:159], v[60:63], v[172:175], v[156:159]
    ds_read_b64_tr_b16 v[58:59], v5 offset:46080
    s_waitcnt lgkmcnt(10)
    v_mfma_f32_16x16x32_bf16 v[128:131], v[32:35], v[176:179], v[128:131]
    ds_read_b64_tr_b16 v[60:61], v6 offset:45056
    v_mfma_f32_16x16x32_bf16 v[132:135], v[32:35], v[180:183], v[132:135]
    ds_read_b64_tr_b16 v[62:63], v6 offset:46080
    v_mfma_f32_16x16x32_bf16 v[136:139], v[36:39], v[176:179], v[136:139]
    ds_read_b64_tr_b16 v[32:33], v3 offset:49152
    v_mfma_f32_16x16x32_bf16 v[140:143], v[36:39], v[180:183], v[140:143]
    ds_read_b64_tr_b16 v[34:35], v3 offset:50176
    s_waitcnt lgkmcnt(10)
    v_mfma_f32_16x16x32_bf16 v[144:147], v[40:43], v[176:179], v[144:147]
    ds_read_b64_tr_b16 v[36:37], v4 offset:49152
    v_mfma_f32_16x16x32_bf16 v[148:151], v[40:43], v[180:183], v[148:151]
    ds_read_b64_tr_b16 v[38:39], v4 offset:50176
    v_mfma_f32_16x16x32_bf16 v[152:155], v[44:47], v[176:179], v[152:155]
    ds_read_b64_tr_b16 v[40:41], v5 offset:49152
    v_mfma_f32_16x16x32_bf16 v[156:159], v[44:47], v[180:183], v[156:159]
    ds_read_b64_tr_b16 v[42:43], v5 offset:50176
    s_waitcnt lgkmcnt(10)
    v_mfma_f32_16x16x32_bf16 v[128:131], v[48:51], v[184:187], v[128:131]
    ds_read_b64_tr_b16 v[44:45], v6 offset:49152
    ds_read_b32 v8, v9 offset:4096
    v_mfma_f32_16x16x32_bf16 v[132:135], v[48:51], v[188:191], v[132:135]
    ds_read_b64_tr_b16 v[46:47], v6 offset:50176
    ds_read_b32 v10, v9 offset:4608
    v_mfma_f32_16x16x32_bf16 v[136:139], v[52:55], v[184:187], v[136:139]
    ds_read_b64_tr_b16 v[48:49], v3 offset:53248
    ds_read_b32 v12, v9 offset:4160
    v_mfma_f32_16x16x32_bf16 v[140:143], v[52:55], v[188:191], v[140:143]
    ds_read_b64_tr_b16 v[50:51], v3 offset:54272
    ds_read_b32 v14, v9 offset:4672
    s_waitcnt lgkmcnt(14)
    v_mfma_f32_16x16x32_bf16 v[144:147], v[56:59], v[184:187], v[144:147]
    ds_read_b64_tr_b16 v[52:53], v4 offset:53248
    ds_read_b128 v[16:19], v11 offset:0
    v_mfma_f32_16x16x32_bf16 v[148:151], v[56:59], v[188:191], v[148:151]
    ds_read_b64_tr_b16 v[54:55], v4 offset:54272
    ds_read_b128 v[20:23], v11 offset:64
    v_mfma_f32_16x16x32_bf16 v[152:155], v[60:63], v[184:187], v[152:155]
    ds_read_b64_tr_b16 v[56:57], v5 offset:53248
    ds_read_b128 v[24:27], v11 offset:128
    v_mfma_f32_16x16x32_bf16 v[156:159], v[60:63], v[188:191], v[156:159]
    ds_read_b64_tr_b16 v[58:59], v5 offset:54272
    ds_read_b128 v[28:31], v11 offset:192
    s_waitcnt lgkmcnt(14)
    v_mfma_f32_16x16x32_bf16 v[128:131], v[32:35], v[192:195], v[128:131]
    ds_read_b64_tr_b16 v[60:61], v6 offset:53248
    v_add_u32 v13, 153600, v1
    v_mfma_f32_16x16x32_bf16 v[132:135], v[32:35], v[196:199], v[132:135]
    ds_read_b64_tr_b16 v[62:63], v6 offset:54272
    v_mfma_f32_16x16x32_bf16 v[136:139], v[36:39], v[192:195], v[136:139]
    ds_read_b64_tr_b16 v[32:33], v3 offset:57344
    v_mfma_f32_16x16x32_bf16 v[140:143], v[36:39], v[196:199], v[140:143]
    ds_read_b64_tr_b16 v[34:35], v3 offset:58368
    s_waitcnt lgkmcnt(14)
    v_mfma_f32_16x16x32_bf16 v[144:147], v[40:43], v[192:195], v[144:147]
    ds_read_b64_tr_b16 v[36:37], v4 offset:57344
    v_mfma_f32_16x16x32_bf16 v[148:151], v[40:43], v[196:199], v[148:151]
    ds_read_b64_tr_b16 v[38:39], v4 offset:58368
    v_mfma_f32_16x16x32_bf16 v[152:155], v[44:47], v[192:195], v[152:155]
    ds_read_b64_tr_b16 v[40:41], v5 offset:57344
    v_mfma_f32_16x16x32_bf16 v[156:159], v[44:47], v[196:199], v[156:159]
    ds_read_b64_tr_b16 v[42:43], v5 offset:58368
    s_waitcnt lgkmcnt(13)
    v_mfma_f32_16x16x32_bf16 v[128:131], v[48:51], v[200:203], v[128:131]
    ds_read_b64_tr_b16 v[44:45], v6 offset:57344
    s_waitcnt lgkmcnt(9)
    v_mfma_f32_16x16x32_bf16 v[132:135], v[48:51], v[204:207], v[132:135]
    ds_read_b64_tr_b16 v[46:47], v6 offset:58368
    v_mul_f32 v10, 0x3e8293ee, v10
    v_mfma_f32_16x16x32_bf16 v[136:139], v[52:55], v[200:203], v[136:139]
    ds_read_b64_tr_b16 v[48:49], v3 offset:61440
    v_mul_f32 v14, 0x3e8293ee, v14
    v_mfma_f32_16x16x32_bf16 v[140:143], v[52:55], v[204:207], v[140:143]
    ds_read_b64_tr_b16 v[50:51], v3 offset:62464
    ds_read_b128 v[120:123], v13 offset:0
    s_waitcnt lgkmcnt(11)
    v_mfma_f32_16x16x32_bf16 v[144:147], v[56:59], v[200:203], v[144:147]
    ds_read_b64_tr_b16 v[52:53], v4 offset:61440
    ds_read_b128 v[124:127], v13 offset:1024
    v_mfma_f32_16x16x32_bf16 v[148:151], v[56:59], v[204:207], v[148:151]
    ds_read_b64_tr_b16 v[54:55], v4 offset:62464
    v_mfma_f32_16x16x32_bf16 v[152:155], v[60:63], v[200:203], v[152:155]
    ds_read_b64_tr_b16 v[56:57], v5 offset:61440
    v_mfma_f32_16x16x32_bf16 v[156:159], v[60:63], v[204:207], v[156:159]
    ds_read_b64_tr_b16 v[58:59], v5 offset:62464
    s_waitcnt lgkmcnt(12)
    v_mfma_f32_16x16x32_bf16 v[128:131], v[32:35], v[208:211], v[128:131]
    ds_read_b64_tr_b16 v[60:61], v6 offset:61440
    v_mfma_f32_16x16x32_bf16 v[132:135], v[32:35], v[212:215], v[132:135]
    ds_read_b64_tr_b16 v[62:63], v6 offset:62464
    v_xor_b32 v3, 0x10000, v3
    v_xor_b32 v4, 0x10000, v4
    v_xor_b32 v5, 0x10000, v5
    v_xor_b32 v6, 0x10000, v6
    v_mfma_f32_16x16x32_bf16 v[136:139], v[36:39], v[208:211], v[136:139]
    v_mfma_f32_16x16x32_bf16 v[140:143], v[36:39], v[212:215], v[140:143]
    s_waitcnt lgkmcnt(10)
    v_mfma_f32_16x16x32_bf16 v[144:147], v[40:43], v[208:211], v[144:147]
    v_mfma_f32_16x16x32_bf16 v[148:151], v[40:43], v[212:215], v[148:151]
    v_mfma_f32_16x16x32_bf16 v[152:155], v[44:47], v[208:211], v[152:155]
    v_mfma_f32_16x16x32_bf16 v[156:159], v[44:47], v[212:215], v[156:159]
    s_waitcnt lgkmcnt(4)
    v_mfma_f32_16x16x32_bf16 v[128:131], v[48:51], v[216:219], v[128:131]
    v_mfma_f32_16x16x32_bf16 v[132:135], v[48:51], v[220:223], v[132:135]
    v_mfma_f32_16x16x32_bf16 v[136:139], v[52:55], v[216:219], v[136:139]
    v_mfma_f32_16x16x32_bf16 v[140:143], v[52:55], v[220:223], v[140:143]
    s_waitcnt lgkmcnt(0)
    v_mfma_f32_16x16x32_bf16 v[144:147], v[56:59], v[216:219], v[144:147]
    v_mfma_f32_16x16x32_bf16 v[148:151], v[56:59], v[220:223], v[148:151]
    v_mfma_f32_16x16x32_bf16 v[152:155], v[60:63], v[216:219], v[152:155]
    v_mfma_f32_16x16x32_bf16 v[156:159], v[60:63], v[220:223], v[156:159]
    s_lshl_b32 s44, s21, 22
    s_lshl_b32 s45, s38, 16
    s_add_u32 s44, s44, s45
    s_lshl_b32 s45, s18, 12
    s_add_u32 s44, s44, s45
    s_add_u32 s52, s44, 16777216
    v_pk_fma_f32 v[132:133], v[12:13], v[16:17], v[132:133] op_sel_hi:[0,1,1] neg_lo:[1,0,0] neg_hi:[1,0,0]
    v_pk_fma_f32 v[134:135], v[12:13], v[18:19], v[134:135] op_sel_hi:[0,1,1] neg_lo:[1,0,0] neg_hi:[1,0,0]
    v_pk_fma_f32 v[140:141], v[12:13], v[20:21], v[140:141] op_sel_hi:[0,1,1] neg_lo:[1,0,0] neg_hi:[1,0,0]
    v_pk_fma_f32 v[142:143], v[12:13], v[22:23], v[142:143] op_sel_hi:[0,1,1] neg_lo:[1,0,0] neg_hi:[1,0,0]
    v_pk_fma_f32 v[148:149], v[12:13], v[24:25], v[148:149] op_sel_hi:[0,1,1] neg_lo:[1,0,0] neg_hi:[1,0,0]
    v_pk_fma_f32 v[150:151], v[12:13], v[26:27], v[150:151] op_sel_hi:[0,1,1] neg_lo:[1,0,0] neg_hi:[1,0,0]
    v_pk_fma_f32 v[156:157], v[12:13], v[28:29], v[156:157] op_sel_hi:[0,1,1] neg_lo:[1,0,0] neg_hi:[1,0,0]
    v_pk_fma_f32 v[158:159], v[12:13], v[30:31], v[158:159] op_sel_hi:[0,1,1] neg_lo:[1,0,0] neg_hi:[1,0,0]
    v_pk_mul_f32 v[132:133], v[14:15], v[132:133] op_sel_hi:[0,1]
    v_pk_mul_f32 v[134:135], v[14:15], v[134:135] op_sel_hi:[0,1]
    v_pk_mul_f32 v[140:141], v[14:15], v[140:141] op_sel_hi:[0,1]
    v_pk_mul_f32 v[142:143], v[14:15], v[142:143] op_sel_hi:[0,1]
    v_pk_mul_f32 v[148:149], v[14:15], v[148:149] op_sel_hi:[0,1]
    v_pk_mul_f32 v[150:151], v[14:15], v[150:151] op_sel_hi:[0,1]
    v_pk_mul_f32 v[156:157], v[14:15], v[156:157] op_sel_hi:[0,1]
    v_pk_mul_f32 v[158:159], v[14:15], v[158:159] op_sel_hi:[0,1]
    v_cvt_pk_bf16_f32 v132, v132, v133
    v_cvt_pk_bf16_f32 v133, v134, v135
    v_cvt_pk_bf16_f32 v134, v140, v141
    v_cvt_pk_bf16_f32 v135, v142, v143
    v_cvt_pk_bf16_f32 v148, v148, v149
    v_cvt_pk_bf16_f32 v149, v150, v151
    v_cvt_pk_bf16_f32 v150, v156, v157
    v_cvt_pk_bf16_f32 v151, v158, v159
    v_mfma_f32_16x16x32_bf16 v[172:175], v[68:71], v[132:135], v[120:123]
    v_mfma_f32_16x16x32_bf16 v[168:171], v[64:67], v[132:135], v[124:127]
    v_mfma_f32_16x16x32_bf16 v[188:191], v[84:87], v[148:151], v[120:123]
    v_mfma_f32_16x16x32_bf16 v[184:187], v[80:83], v[148:151], v[124:127]
    v_pk_fma_f32 v[128:129], v[8:9], v[16:17], v[128:129] op_sel_hi:[0,1,1] neg_lo:[1,0,0] neg_hi:[1,0,0]
    v_pk_fma_f32 v[130:131], v[8:9], v[18:19], v[130:131] op_sel_hi:[0,1,1] neg_lo:[1,0,0] neg_hi:[1,0,0]
    v_pk_fma_f32 v[136:137], v[8:9], v[20:21], v[136:137] op_sel_hi:[0,1,1] neg_lo:[1,0,0] neg_hi:[1,0,0]
    v_pk_fma_f32 v[138:139], v[8:9], v[22:23], v[138:139] op_sel_hi:[0,1,1] neg_lo:[1,0,0] neg_hi:[1,0,0]
    v_pk_fma_f32 v[144:145], v[8:9], v[24:25], v[144:145] op_sel_hi:[0,1,1] neg_lo:[1,0,0] neg_hi:[1,0,0]
    v_pk_fma_f32 v[146:147], v[8:9], v[26:27], v[146:147] op_sel_hi:[0,1,1] neg_lo:[1,0,0] neg_hi:[1,0,0]
    v_pk_fma_f32 v[152:153], v[8:9], v[28:29], v[152:153] op_sel_hi:[0,1,1] neg_lo:[1,0,0] neg_hi:[1,0,0]
    v_pk_fma_f32 v[154:155], v[8:9], v[30:31], v[154:155] op_sel_hi:[0,1,1] neg_lo:[1,0,0] neg_hi:[1,0,0]
    v_pk_mul_f32 v[128:129], v[10:11], v[128:129] op_sel_hi:[0,1]
    v_pk_mul_f32 v[130:131], v[10:11], v[130:131] op_sel_hi:[0,1]
    v_pk_mul_f32 v[136:137], v[10:11], v[136:137] op_sel_hi:[0,1]
    v_pk_mul_f32 v[138:139], v[10:11], v[138:139] op_sel_hi:[0,1]
    v_pk_mul_f32 v[144:145], v[10:11], v[144:145] op_sel_hi:[0,1]
    v_pk_mul_f32 v[146:147], v[10:11], v[146:147] op_sel_hi:[0,1]
    v_pk_mul_f32 v[152:153], v[10:11], v[152:153] op_sel_hi:[0,1]
    v_pk_mul_f32 v[154:155], v[10:11], v[154:155] op_sel_hi:[0,1]
    v_cvt_pk_bf16_f32 v128, v128, v129
    v_cvt_pk_bf16_f32 v129, v130, v131
    v_cvt_pk_bf16_f32 v130, v136, v137
    v_cvt_pk_bf16_f32 v131, v138, v139
    v_cvt_pk_bf16_f32 v144, v144, v145
    v_cvt_pk_bf16_f32 v145, v146, v147
    v_cvt_pk_bf16_f32 v146, v152, v153
    v_cvt_pk_bf16_f32 v147, v154, v155
    v_mfma_f32_16x16x32_bf16 v[164:167], v[64:67], v[128:131], v[120:123]
    s_nop 0
    v_mfma_f32_16x16x32_bf16 v[180:183], v[80:83], v[144:147], v[120:123]
    v_mov_b32 v232, 0x3f803f80
    v_mov_b32 v233, 0x3f803f80
    v_mov_b32 v234, 0x3f803f80
    v_mov_b32 v235, 0x3f803f80
    v_exp_f32 v172, v172
    v_exp_f32 v173, v173
    v_exp_f32 v174, v174
    v_exp_f32 v175, v175
    v_exp_f32 v188, v188
    v_exp_f32 v189, v189
    v_exp_f32 v190, v190
    v_exp_f32 v191, v191
    s_mov_b32 s46, 1006632960
a_exp1:
    v_exp_f32 v168, v168
    v_exp_f32 v169, v169
    v_exp_f32 v170, v170
    v_exp_f32 v171, v171
    v_exp_f32 v184, v184
    v_exp_f32 v185, v185
    v_exp_f32 v186, v186
    v_exp_f32 v187, v187
    v_cvt_pk_bf16_f32 v200, v168, v169
    v_cvt_pk_bf16_f32 v201, v170, v171
    v_cvt_pk_bf16_f32 v202, v172, v173
    v_cvt_pk_bf16_f32 v203, v174, v175
    v_cvt_pk_bf16_f32 v204, v184, v185
    v_cvt_pk_bf16_f32 v205, v186, v187
    v_cvt_pk_bf16_f32 v206, v188, v189
    v_cvt_pk_bf16_f32 v207, v190, v191
    v_mfma_f32_16x16x32_bf16 v[16:19], v[232:235], v[200:203], 0
    s_nop 0
    v_mfma_f32_16x16x32_bf16 v[20:23], v[232:235], v[204:207], 0
    v_mfma_f32_16x16x32_bf16 v[40:43], v[72:75], v[200:203], 0
    v_mfma_f32_16x16x32_bf16 v[44:47], v[76:79], v[200:203], 0
    v_mfma_f32_16x16x32_bf16 v[56:59], v[88:91], v[204:207], 0
    v_mfma_f32_16x16x32_bf16 v[60:63], v[92:95], v[204:207], 0
    v_mov_b32 v218, v72
    v_mov_b32 v219, v73
    v_mov_b32 v222, v76
    v_mov_b32 v223, v77
    v_mov_b32 v226, v88
    v_mov_b32 v227, v89
    v_mov_b32 v230, v92
    v_mov_b32 v231, v93
    v_subrev_u32 v18, 0x21800000, v16
    v_subrev_u32 v22, 0x21800000, v20
    v_max_u32 v18, v18, v22
    v_cmp_le_u32 vcc, s46, v18
    v_rcp_f32 v16, v16
    v_rcp_f32 v20, v20
    s_cbranch_vccnz a_slow1
a_fin1:
    v_pk_mul_f32 v[40:41], v[16:17], v[40:41] op_sel_hi:[0,1]
    v_pk_mul_f32 v[42:43], v[16:17], v[42:43] op_sel_hi:[0,1]
    v_pk_mul_f32 v[44:45], v[16:17], v[44:45] op_sel_hi:[0,1]
    v_pk_mul_f32 v[46:47], v[16:17], v[46:47] op_sel_hi:[0,1]
    v_pk_mul_f32 v[56:57], v[20:21], v[56:57] op_sel_hi:[0,1]
    v_pk_mul_f32 v[58:59], v[20:21], v[58:59] op_sel_hi:[0,1]
    v_pk_mul_f32 v[60:61], v[20:21], v[60:61] op_sel_hi:[0,1]
    v_pk_mul_f32 v[62:63], v[20:21], v[62:63] op_sel_hi:[0,1]
    v_cvt_pk_bf16_f32 v40, v40, v41
    v_cvt_pk_bf16_f32 v41, v42, v43
    v_cvt_pk_bf16_f32 v42, v44, v45
    v_cvt_pk_bf16_f32 v43, v46, v47
    v_cvt_pk_bf16_f32 v56, v56, v57
    v_cvt_pk_bf16_f32 v57, v58, v59
    v_cvt_pk_bf16_f32 v58, v60, v61
    v_cvt_pk_bf16_f32 v59, v62, v63
    v_permlane32_swap_b32 v40, v42
    v_permlane32_swap_b32 v41, v43
    buffer_store_dwordx4 v[40:43], v2, s[4:7], s52 offen offset:256 sc1
    v_permlane32_swap_b32 v56, v58
    v_permlane32_swap_b32 v57, v59
    buffer_store_dwordx4 v[56:59], v2, s[4:7], s52 offen offset:2304 sc1
    s_cmp_lg_u32 s38, 0
    s_cbranch_scc1 a_hasprev
    v_mov_b32 v124, 0xf149f2ca
    v_mov_b32 v125, 0xf149f2ca
    v_mov_b32 v126, 0xf149f2ca
    v_mov_b32 v127, 0xf149f2ca
a_hasprev:
    s_waitcnt lgkmcnt(0)
    s_barrier
    ds_read_b128 v[192:195], v7 offset:0
    ds_read_b128 v[196:199], v7 offset:1024
    ds_read_b64 v[216:217], v7 offset:2048
    ds_read_b64 v[220:221], v7 offset:2056
    ds_read_b64 v[224:225], v7 offset:3072
    ds_read_b64 v[228:229], v7 offset:3080
    s_waitcnt lgkmcnt(4)
    v_mfma_f32_16x16x32_bf16 v[160:163], v[192:195], v[128:131], v[124:127]
    v_mfma_f32_16x16x32_bf16 v[176:179], v[196:199], v[144:147], v[124:127]
    v_exp_f32 v164, v164
    v_exp_f32 v165, v165
    v_exp_f32 v166, v166
    v_exp_f32 v167, v167
    v_exp_f32 v180, v180
    v_exp_f32 v181, v181
    v_exp_f32 v182, v182
    v_exp_f32 v183, v183
    s_waitcnt lgkmcnt(0)
    s_mov_b32 s46, 1006632960
a_exp0:
    v_exp_f32 v160, v160
    v_exp_f32 v161, v161
    v_exp_f32 v162, v162
    v_exp_f32 v163, v163
    v_exp_f32 v176, v176
    v_exp_f32 v177, v177
    v_exp_f32 v178, v178
    v_exp_f32 v179, v179
    v_cvt_pk_bf16_f32 v200, v160, v161
    v_cvt_pk_bf16_f32 v201, v162, v163
    v_cvt_pk_bf16_f32 v202, v164, v165
    v_cvt_pk_bf16_f32 v203, v166, v167
    v_cvt_pk_bf16_f32 v204, v176, v177
    v_cvt_pk_bf16_f32 v205, v178, v179
    v_cvt_pk_bf16_f32 v206, v180, v181
    v_cvt_pk_bf16_f32 v207, v182, v183
    v_mfma_f32_16x16x32_bf16 v[16:19], v[232:235], v[200:203], 0
    s_nop 0
    v_mfma_f32_16x16x32_bf16 v[20:23], v[232:235], v[204:207], 0
    v_mfma_f32_16x16x32_bf16 v[32:35], v[216:219], v[200:203], 0
    v_mfma_f32_16x16x32_bf16 v[36:39], v[220:223], v[200:203], 0
    v_mfma_f32_16x16x32_bf16 v[48:51], v[224:227], v[204:207], 0
    v_mfma_f32_16x16x32_bf16 v[52:55], v[228:231], v[204:207], 0
    s_nop 1
    v_subrev_u32 v18, 0x21800000, v16
    s_nop 0
    v_subrev_u32 v22, 0x21800000, v20
    v_max_u32 v18, v18, v22
    v_cmp_le_u32 vcc, s46, v18
    v_rcp_f32 v16, v16
    v_rcp_f32 v20, v20
    s_cbranch_vccnz a_slow0
a_fin0:
    v_pk_mul_f32 v[32:33], v[16:17], v[32:33] op_sel_hi:[0,1]
    v_pk_mul_f32 v[34:35], v[16:17], v[34:35] op_sel_hi:[0,1]
    v_pk_mul_f32 v[36:37], v[16:17], v[36:37] op_sel_hi:[0,1]
    v_pk_mul_f32 v[38:39], v[16:17], v[38:39] op_sel_hi:[0,1]
    v_pk_mul_f32 v[48:49], v[20:21], v[48:49] op_sel_hi:[0,1]
    v_pk_mul_f32 v[50:51], v[20:21], v[50:51] op_sel_hi:[0,1]
    v_pk_mul_f32 v[52:53], v[20:21], v[52:53] op_sel_hi:[0,1]
    v_pk_mul_f32 v[54:55], v[20:21], v[54:55] op_sel_hi:[0,1]
    v_cvt_pk_bf16_f32 v32, v32, v33
    v_cvt_pk_bf16_f32 v33, v34, v35
    v_cvt_pk_bf16_f32 v34, v36, v37
    v_cvt_pk_bf16_f32 v35, v38, v39
    v_cvt_pk_bf16_f32 v48, v48, v49
    v_cvt_pk_bf16_f32 v49, v50, v51
    v_cvt_pk_bf16_f32 v50, v52, v53
    v_cvt_pk_bf16_f32 v51, v54, v55
    v_permlane32_swap_b32 v32, v34
    v_permlane32_swap_b32 v33, v35
    buffer_store_dwordx4 v[32:35], v2, s[4:7], s52 offen offset:0 sc1
    v_permlane32_swap_b32 v48, v50
    v_permlane32_swap_b32 v49, v51
    buffer_store_dwordx4 v[48:51], v2, s[4:7], s52 offen offset:2048 sc1
    s_lshl_b32 s44, s21, 22
    s_lshl_b32 s45, s38, 16
    s_add_u32 s41, s44, s45
    s_lshl_b32 s45, s18, 12
    s_add_u32 s43, s41, s45
    s_and_b32 s45, s45, 0
    s_add_u32 s41, s41, s45
    s_add_u32 s41, s41, 16777216
    buffer_load_dwordx4 v[224:227], v2, s[4:7], s43 offen offset:0 sc1
    buffer_load_dwordx4 v[228:231], v2, s[4:7], s43 offen offset:256 sc1
    buffer_load_dwordx4 v[232:235], v2, s[4:7], s43 offen offset:2048 sc1
    buffer_load_dwordx4 v[236:239], v2, s[4:7], s43 offen offset:2304 sc1
    s_barrier
    s_lshl_b32 s47, s21, 14
    s_lshl_b32 s67, s38, 8
    s_add_u32 s47, s47, s67
    s_add_u32 s47, s47, 86144
    s_mov_b32 s68, 1
    s_waitcnt vmcnt(4)
    s_atomic_add s68, s[22:23], s47 glc
    s_mov_b32 s66, 0x10000
    s_waitcnt lgkmcnt(0)
    s_cmp_eq_u32 s68, 15
    s_cbranch_scc1 c_o_ok
c_o_poll:
    s_mov_b32 s68, 0
    s_atomic_add s68, s[22:23], s47 offset:0 glc
    s_sub_u32 s66, s66, 1
    s_cselect_b32 s67, 16, 0
    s_waitcnt lgkmcnt(0)
    s_max_u32 s68, s68, s67
    s_cmp_lt_u32 s68, 16
    s_cbranch_scc1 c_o_poll
c_o_ok:
    s_branch c_wo
a_slow1:
    s_cmp_eq_u32 s46, 0
    s_cbranch_scc1 a_fin1
    s_mov_b32 s46, 0
    v_mfma_f32_16x16x32_bf16 v[172:175], v[68:71], v[132:135], v[120:123]
    v_mfma_f32_16x16x32_bf16 v[168:171], v[64:67], v[132:135], v[124:127]
    v_mfma_f32_16x16x32_bf16 v[188:191], v[84:87], v[148:151], v[120:123]
    v_mfma_f32_16x16x32_bf16 v[184:187], v[80:83], v[148:151], v[124:127]
    s_nop 5
    v_max3_f32 v24, v168, v169, v170
    v_max3_f32 v24, v24, v171, v172
    v_max3_f32 v24, v24, v173, v174
    v_max_f32 v24, v24, v175
    v_max3_f32 v26, v184, v185, v186
    v_max3_f32 v26, v26, v187, v188
    v_max3_f32 v26, v26, v189, v190
    v_max_f32 v26, v26, v191
    v_mov_b32 v25, v24
    v_mov_b32 v27, v26
    s_nop 0
    v_permlane32_swap_b32 v24, v25
    v_permlane32_swap_b32 v26, v27
    v_max_f32 v24, v24, v25
    v_max_f32 v26, v26, v27
    v_mov_b32 v25, v24
    v_mov_b32 v27, v26
    s_nop 0
    v_permlane16_swap_b32 v24, v25
    v_permlane16_swap_b32 v26, v27
    v_max_f32 v24, v24, v25
    v_max_f32 v26, v26, v27
    v_sub_f32 v168, v168, v24
    v_sub_f32 v169, v169, v24
    v_sub_f32 v170, v170, v24
    v_sub_f32 v171, v171, v24
    v_sub_f32 v172, v172, v24
    v_sub_f32 v173, v173, v24
    v_sub_f32 v174, v174, v24
    v_sub_f32 v175, v175, v24
    v_sub_f32 v184, v184, v26
    v_sub_f32 v185, v185, v26
    v_sub_f32 v186, v186, v26
    v_sub_f32 v187, v187, v26
    v_sub_f32 v188, v188, v26
    v_sub_f32 v189, v189, v26
    v_sub_f32 v190, v190, v26
    v_sub_f32 v191, v191, v26
    v_exp_f32 v172, v172
    v_exp_f32 v173, v173
    v_exp_f32 v174, v174
    v_exp_f32 v175, v175
    v_exp_f32 v188, v188
    v_exp_f32 v189, v189
    v_exp_f32 v190, v190
    v_exp_f32 v191, v191
    s_branch a_exp1
a_slow0:
    s_cmp_eq_u32 s46, 0
    s_cbranch_scc1 a_fin0
    s_mov_b32 s46, 0
    v_mfma_f32_16x16x32_bf16 v[164:167], v[64:67], v[128:131], v[120:123]
    v_mfma_f32_16x16x32_bf16 v[160:163], v[192:195], v[128:131], v[124:127]
    v_mfma_f32_16x16x32_bf16 v[180:183], v[80:83], v[144:147], v[120:123]
    v_mfma_f32_16x16x32_bf16 v[176:179], v[196:199], v[144:147], v[124:127]
    s_nop 5
    v_max3_f32 v24, v160, v161, v162
    v_max3_f32 v24, v24, v163, v164
    v_max3_f32 v24, v24, v165, v166
    v_max_f32 v24, v24, v167
    v_max3_f32 v26, v176, v177, v178
    v_max3_f32 v26, v26, v179, v180
    v_max3_f32 v26, v26, v181, v182
    v_max_f32 v26, v26, v183
    v_mov_b32 v25, v24
    v_mov_b32 v27, v26
    s_nop 0
    v_permlane32_swap_b32 v24, v25
    v_permlane32_swap_b32 v26, v27
    v_max_f32 v24, v24, v25
    v_max_f32 v26, v26, v27
    v_mov_b32 v25, v24
    v_mov_b32 v27, v26
    s_nop 0
    v_permlane16_swap_b32 v24, v25
    v_permlane16_swap_b32 v26, v27
    v_max_f32 v24, v24, v25
    v_max_f32 v26, v26, v27
    v_sub_f32 v160, v160, v24
    v_sub_f32 v161, v161, v24
    v_sub_f32 v162, v162, v24
    v_sub_f32 v163, v163, v24
    v_sub_f32 v164, v164, v24
    v_sub_f32 v165, v165, v24
    v_sub_f32 v166, v166, v24
    v_sub_f32 v167, v167, v24
    v_sub_f32 v176, v176, v26
    v_sub_f32 v177, v177, v26
    v_sub_f32 v178, v178, v26
    v_sub_f32 v179, v179, v26
    v_sub_f32 v180, v180, v26
    v_sub_f32 v181, v181, v26
    v_sub_f32 v182, v182, v26
    v_sub_f32 v183, v183, v26
    v_exp_f32 v164, v164
    v_exp_f32 v165, v165
    v_exp_f32 v166, v166
    v_exp_f32 v167, v167
    v_exp_f32 v180, v180
    v_exp_f32 v181, v181
    v_exp_f32 v182, v182
    v_exp_f32 v183, v183
    s_branch a_exp0
c_B:
    s_waitcnt lgkmcnt(6)
    v_pk_fma_f32 v[64:65], v[8:9], v[16:17], v[64:65] op_sel_hi:[0,1,1] neg_lo:[1,0,0] neg_hi:[1,0,0]
    v_pk_fma_f32 v[66:67], v[8:9], v[18:19], v[66:67] op_sel_hi:[0,1,1] neg_lo:[1,0,0] neg_hi:[1,0,0]
    v_pk_fma_f32 v[72:73], v[8:9], v[20:21], v[72:73] op_sel_hi:[0,1,1] neg_lo:[1,0,0] neg_hi:[1,0,0]
    v_pk_fma_f32 v[74:75], v[8:9], v[22:23], v[74:75] op_sel_hi:[0,1,1] neg_lo:[1,0,0] neg_hi:[1,0,0]
    v_pk_mul_f32 v[64:65], v[10:11], v[64:65] op_sel_hi:[0,1]
    v_pk_mul_f32 v[66:67], v[10:11], v[66:67] op_sel_hi:[0,1]
    v_pk_mul_f32 v[72:73], v[10:11], v[72:73] op_sel_hi:[0,1]
    v_pk_mul_f32 v[74:75], v[10:11], v[74:75] op_sel_hi:[0,1]
    v_cvt_pk_bf16_f32 v64, v64, v65
    v_cvt_pk_bf16_f32 v65, v66, v67
    v_cvt_pk_bf16_f32 v66, v72, v73
    v_cvt_pk_bf16_f32 v67, v74, v75
    s_add_u32 s55, s52, 0
    buffer_store_dwordx4 v[64:67], v2, s[4:7], s55 offen offset:0 sc1
    v_pk_fma_f32 v[68:69], v[12:13], v[16:17], v[68:69] op_sel_hi:[0,1,1] neg_lo:[1,0,0] neg_hi:[1,0,0]
    v_pk_fma_f32 v[70:71], v[12:13], v[18:19], v[70:71] op_sel_hi:[0,1,1] neg_lo:[1,0,0] neg_hi:[1,0,0]
    v_pk_fma_f32 v[76:77], v[12:13], v[20:21], v[76:77] op_sel_hi:[0,1,1] neg_lo:[1,0,0] neg_hi:[1,0,0]
    v_pk_fma_f32 v[78:79], v[12:13], v[22:23], v[78:79] op_sel_hi:[0,1,1] neg_lo:[1,0,0] neg_hi:[1,0,0]
    v_pk_mul_f32 v[68:69], v[14:15], v[68:69] op_sel_hi:[0,1]
    v_pk_mul_f32 v[70:71], v[14:15], v[70:71] op_sel_hi:[0,1]
    v_pk_mul_f32 v[76:77], v[14:15], v[76:77] op_sel_hi:[0,1]
    v_pk_mul_f32 v[78:79], v[14:15], v[78:79] op_sel_hi:[0,1]
    v_cvt_pk_bf16_f32 v68, v68, v69
    v_cvt_pk_bf16_f32 v69, v70, v71
    v_cvt_pk_bf16_f32 v70, v76, v77
    v_cvt_pk_bf16_f32 v71, v78, v79
    buffer_store_dwordx4 v[68:71], v2, s[4:7], s55 offen offset:256 sc1
    v_pk_fma_f32 v[80:81], v[8:9], v[24:25], v[80:81] op_sel_hi:[0,1,1] neg_lo:[1,0,0] neg_hi:[1,0,0]
    v_pk_fma_f32 v[82:83], v[8:9], v[26:27], v[82:83] op_sel_hi:[0,1,1] neg_lo:[1,0,0] neg_hi:[1,0,0]
    v_pk_fma_f32 v[88:89], v[8:9], v[28:29], v[88:89] op_sel_hi:[0,1,1] neg_lo:[1,0,0] neg_hi:[1,0,0]
    v_pk_fma_f32 v[90:91], v[8:9], v[30:31], v[90:91] op_sel_hi:[0,1,1] neg_lo:[1,0,0] neg_hi:[1,0,0]
    v_pk_mul_f32 v[80:81], v[10:11], v[80:81] op_sel_hi:[0,1]
    v_pk_mul_f32 v[82:83], v[10:11], v[82:83] op_sel_hi:[0,1]
    v_pk_mul_f32 v[88:89], v[10:11], v[88:89] op_sel_hi:[0,1]
    v_pk_mul_f32 v[90:91], v[10:11], v[90:91] op_sel_hi:[0,1]
    v_cvt_pk_bf16_f32 v80, v80, v81
    v_cvt_pk_bf16_f32 v81, v82, v83
    v_cvt_pk_bf16_f32 v82, v88, v89
    v_cvt_pk_bf16_f32 v83, v90, v91
    s_add_u32 s55, s52, 131072
    buffer_store_dwordx4 v[80:83], v2, s[4:7], s55 offen offset:0 sc1
    v_pk_fma_f32 v[84:85], v[12:13], v[24:25], v[84:85] op_sel_hi:[0,1,1] neg_lo:[1,0,0] neg_hi:[1,0,0]
    v_pk_fma_f32 v[86:87], v[12:13], v[26:27], v[86:87] op_sel_hi:[0,1,1] neg_lo:[1,0,0] neg_hi:[1,0,0]
    v_pk_fma_f32 v[92:93], v[12:13], v[28:29], v[92:93] op_sel_hi:[0,1,1] neg_lo:[1,0,0] neg_hi:[1,0,0]
    v_pk_fma_f32 v[94:95], v[12:13], v[30:31], v[94:95] op_sel_hi:[0,1,1] neg_lo:[1,0,0] neg_hi:[1,0,0]
    v_pk_mul_f32 v[84:85], v[14:15], v[84:85] op_sel_hi:[0,1]
    v_pk_mul_f32 v[86:87], v[14:15], v[86:87] op_sel_hi:[0,1]
    v_pk_mul_f32 v[92:93], v[14:15], v[92:93] op_sel_hi:[0,1]
    v_pk_mul_f32 v[94:95], v[14:15], v[94:95] op_sel_hi:[0,1]
    v_cvt_pk_bf16_f32 v84, v84, v85
    v_cvt_pk_bf16_f32 v85, v86, v87
    v_cvt_pk_bf16_f32 v86, v92, v93
    v_cvt_pk_bf16_f32 v87, v94, v95
    buffer_store_dwordx4 v[84:87], v2, s[4:7], s55 offen offset:256 sc1
    v_mfma_f32_16x16x32_bf16 v[96:99], v[160:163], v[32:35], v[96:99]
    ds_read_b64_tr_b16 v[60:61], v6 offset:53248
    v_mfma_f32_16x16x32_bf16 v[100:103], v[164:167], v[32:35], v[100:103]
    ds_read_b64_tr_b16 v[62:63], v6 offset:54272
    v_mfma_f32_16x16x32_bf16 v[104:107], v[160:163], v[36:39], v[104:107]
    ds_read_b64_tr_b16 v[32:33], v3 offset:57344
    v_mfma_f32_16x16x32_bf16 v[108:111], v[164:167], v[36:39], v[108:111]
    ds_read_b64_tr_b16 v[34:35], v3 offset:58368
    v_mfma_f32_16x16x32_bf16 v[112:115], v[160:163], v[40:43], v[112:115]
    ds_read_b64_tr_b16 v[36:37], v4 offset:57344
    v_mfma_f32_16x16x32_bf16 v[116:119], v[164:167], v[40:43], v[116:119]
    ds_read_b64_tr_b16 v[38:39], v4 offset:58368
    v_mfma_f32_16x16x32_bf16 v[120:123], v[160:163], v[44:47], v[120:123]
    ds_read_b64_tr_b16 v[40:41], v5 offset:57344
    v_mfma_f32_16x16x32_bf16 v[124:127], v[164:167], v[44:47], v[124:127]
    ds_read_b64_tr_b16 v[42:43], v5 offset:58368
    s_waitcnt lgkmcnt(10)
    v_mfma_f32_16x16x32_bf16 v[96:99], v[168:171], v[48:51], v[96:99]
    ds_read_b64_tr_b16 v[44:45], v6 offset:57344
    v_mfma_f32_16x16x32_bf16 v[100:103], v[172:175], v[48:51], v[100:103]
    ds_read_b64_tr_b16 v[46:47], v6 offset:58368
    v_mfma_f32_16x16x32_bf16 v[104:107], v[168:171], v[52:55], v[104:107]
    ds_read_b64_tr_b16 v[48:49], v3 offset:61440
    v_mfma_f32_16x16x32_bf16 v[108:111], v[172:175], v[52:55], v[108:111]
    ds_read_b64_tr_b16 v[50:51], v3 offset:62464
    s_waitcnt lgkmcnt(10)
    v_mfma_f32_16x16x32_bf16 v[112:115], v[168:171], v[56:59], v[112:115]
    ds_read_b64_tr_b16 v[52:53], v4 offset:61440
    v_mfma_f32_16x16x32_bf16 v[116:119], v[172:175], v[56:59], v[116:119]
    ds_read_b64_tr_b16 v[54:55], v4 offset:62464
    v_mfma_f32_16x16x32_bf16 v[120:123], v[168:171], v[60:63], v[120:123]
    ds_read_b64_tr_b16 v[56:57], v5 offset:61440
    v_mfma_f32_16x16x32_bf16 v[124:127], v[172:175], v[60:63], v[124:127]
    ds_read_b64_tr_b16 v[58:59], v5 offset:62464
    s_waitcnt lgkmcnt(10)
    v_mfma_f32_16x16x32_bf16 v[96:99], v[176:179], v[32:35], v[96:99]
    ds_read_b64_tr_b16 v[60:61], v6 offset:61440
    v_mfma_f32_16x16x32_bf16 v[100:103], v[180:183], v[32:35], v[100:103]
    ds_read_b64_tr_b16 v[62:63], v6 offset:62464
    s_barrier
    v_xor_b32 v3, 0x10000, v3
    v_xor_b32 v4, 0x10000, v4
    v_xor_b32 v5, 0x10000, v5
    v_xor_b32 v6, 0x10000, v6
    v_mfma_f32_16x16x32_bf16 v[104:107], v[176:179], v[36:39], v[104:107]
    ds_read_b64_tr_b16 v[32:33], v3 offset:0
    v_mfma_f32_16x16x32_bf16 v[108:111], v[180:183], v[36:39], v[108:111]
    ds_read_b64_tr_b16 v[34:35], v3 offset:1024
    s_waitcnt lgkmcnt(10)
    v_mfma_f32_16x16x32_bf16 v[112:115], v[176:179], v[40:43], v[112:115]
    ds_read_b64_tr_b16 v[36:37], v4 offset:0
    v_mfma_f32_16x16x32_bf16 v[116:119], v[180:183], v[40:43], v[116:119]
    ds_read_b64_tr_b16 v[38:39], v4 offset:1024
    v_mfma_f32_16x16x32_bf16 v[120:123], v[176:179], v[44:47], v[120:123]
    ds_read_b64_tr_b16 v[40:41], v5 offset:0
    v_mfma_f32_16x16x32_bf16 v[124:127], v[180:183], v[44:47], v[124:127]
    ds_read_b64_tr_b16 v[42:43], v5 offset:1024
    s_waitcnt lgkmcnt(10)
    v_mfma_f32_16x16x32_bf16 v[96:99], v[184:187], v[48:51], v[96:99]
    ds_read_b64_tr_b16 v[44:45], v6 offset:0
    v_mfma_f32_16x16x32_bf16 v[100:103], v[188:191], v[48:51], v[100:103]
    ds_read_b64_tr_b16 v[46:47], v6 offset:1024
    v_mfma_f32_16x16x32_bf16 v[104:107], v[184:187], v[52:55], v[104:107]
    ds_read_b64_tr_b16 v[48:49], v3 offset:4096
    v_mfma_f32_16x16x32_bf16 v[108:111], v[188:191], v[52:55], v[108:111]
    ds_read_b64_tr_b16 v[50:51], v3 offset:5120
    s_waitcnt lgkmcnt(10)
    v_mfma_f32_16x16x32_bf16 v[112:115], v[184:187], v[56:59], v[112:115]
    ds_read_b64_tr_b16 v[52:53], v4 offset:4096
    v_mfma_f32_16x16x32_bf16 v[116:119], v[188:191], v[56:59], v[116:119]
    ds_read_b64_tr_b16 v[54:55], v4 offset:5120
    v_mfma_f32_16x16x32_bf16 v[120:123], v[184:187], v[60:63], v[120:123]
    ds_read_b64_tr_b16 v[56:57], v5 offset:4096
    v_mfma_f32_16x16x32_bf16 v[124:127], v[188:191], v[60:63], v[124:127]
    ds_read_b64_tr_b16 v[58:59], v5 offset:5120
    s_waitcnt lgkmcnt(10)
    v_mfma_f32_16x16x32_bf16 v[96:99], v[192:195], v[32:35], v[96:99]
    ds_read_b64_tr_b16 v[60:61], v6 offset:4096
    v_mfma_f32_16x16x32_bf16 v[100:103], v[196:199], v[32:35], v[100:103]
    ds_read_b64_tr_b16 v[62:63], v6 offset:5120
    v_mfma_f32_16x16x32_bf16 v[104:107], v[192:195], v[36:39], v[104:107]
    ds_read_b64_tr_b16 v[32:33], v3 offset:8192
    v_mfma_f32_16x16x32_bf16 v[108:111], v[196:199], v[36:39], v[108:111]
    ds_read_b64_tr_b16 v[34:35], v3 offset:9216
    s_waitcnt lgkmcnt(10)
    v_mfma_f32_16x16x32_bf16 v[112:115], v[192:195], v[40:43], v[112:115]
    ds_read_b64_tr_b16 v[36:37], v4 offset:8192
    v_mfma_f32_16x16x32_bf16 v[116:119], v[196:199], v[40:43], v[116:119]
    ds_read_b64_tr_b16 v[38:39], v4 offset:9216
    v_mfma_f32_16x16x32_bf16 v[120:123], v[192:195], v[44:47], v[120:123]
    ds_read_b64_tr_b16 v[40:41], v5 offset:8192
    v_mfma_f32_16x16x32_bf16 v[124:127], v[196:199], v[44:47], v[124:127]
    ds_read_b64_tr_b16 v[42:43], v5 offset:9216
    s_waitcnt lgkmcnt(10)
    v_mfma_f32_16x16x32_bf16 v[96:99], v[200:203], v[48:51], v[96:99]
    ds_read_b64_tr_b16 v[44:45], v6 offset:8192
    v_mfma_f32_16x16x32_bf16 v[100:103], v[204:207], v[48:51], v[100:103]
    ds_read_b64_tr_b16 v[46:47], v6 offset:9216
    v_mfma_f32_16x16x32_bf16 v[104:107], v[200:203], v[52:55], v[104:107]
    ds_read_b64_tr_b16 v[48:49], v3 offset:12288
    v_mfma_f32_16x16x32_bf16 v[108:111], v[204:207], v[52:55], v[108:111]
    ds_read_b64_tr_b16 v[50:51], v3 offset:13312
    s_waitcnt lgkmcnt(10)
    v_mfma_f32_16x16x32_bf16 v[112:115], v[200:203], v[56:59], v[112:115]
    ds_read_b64_tr_b16 v[52:53], v4 offset:12288
    v_mfma_f32_16x16x32_bf16 v[116:119], v[204:207], v[56:59], v[116:119]
    ds_read_b64_tr_b16 v[54:55], v4 offset:13312
    v_mfma_f32_16x16x32_bf16 v[120:123], v[200:203], v[60:63], v[120:123]
    ds_read_b64_tr_b16 v[56:57], v5 offset:12288
    v_mfma_f32_16x16x32_bf16 v[124:127], v[204:207], v[60:63], v[124:127]
    ds_read_b64_tr_b16 v[58:59], v5 offset:13312
    s_waitcnt lgkmcnt(10)
    v_mfma_f32_16x16x32_bf16 v[96:99], v[208:211], v[32:35], v[96:99]
    ds_read_b64_tr_b16 v[60:61], v6 offset:12288
    v_mfma_f32_16x16x32_bf16 v[100:103], v[212:215], v[32:35], v[100:103]
    ds_read_b64_tr_b16 v[62:63], v6 offset:13312
    v_mfma_f32_16x16x32_bf16 v[104:107], v[208:211], v[36:39], v[104:107]
    ds_read_b64_tr_b16 v[32:33], v3 offset:16384
    ds_read_b128 v[16:19], v13 offset:4096
    v_mfma_f32_16x16x32_bf16 v[108:111], v[212:215], v[36:39], v[108:111]
    ds_read_b64_tr_b16 v[34:35], v3 offset:17408
    ds_read_b128 v[20:23], v13 offset:4608
    s_waitcnt lgkmcnt(12)
    v_mfma_f32_16x16x32_bf16 v[112:115], v[208:211], v[40:43], v[112:115]
    ds_read_b64_tr_b16 v[36:37], v4 offset:16384
    ds_read_b128 v[24:27], v13 offset:4160
    v_mfma_f32_16x16x32_bf16 v[116:119], v[212:215], v[40:43], v[116:119]
    ds_read_b64_tr_b16 v[38:39], v4 offset:17408
    ds_read_b128 v[28:31], v13 offset:4672
    v_mfma_f32_16x16x32_bf16 v[120:123], v[208:211], v[44:47], v[120:123]
    ds_read_b64_tr_b16 v[40:41], v5 offset:16384
    ds_read_b32 v8, v15 offset:512
    v_mfma_f32_16x16x32_bf16 v[124:127], v[212:215], v[44:47], v[124:127]
    ds_read_b64_tr_b16 v[42:43], v5 offset:17408
    ds_read_b32 v10, v15 offset:576
    s_waitcnt lgkmcnt(14)
    v_mfma_f32_16x16x32_bf16 v[96:99], v[216:219], v[48:51], v[96:99]
    ds_read_b64_tr_b16 v[44:45], v6 offset:16384
    ds_read_b32 v12, v15 offset:640
    v_mfma_f32_16x16x32_bf16 v[100:103], v[220:223], v[48:51], v[100:103]
    ds_read_b64_tr_b16 v[46:47], v6 offset:17408
    ds_read_b32 v14, v15 offset:704
    v_mfma_f32_16x16x32_bf16 v[104:107], v[216:219], v[52:55], v[104:107]
    ds_read_b64_tr_b16 v[48:49], v3 offset:20480
    v_mfma_f32_16x16x32_bf16 v[108:111], v[220:223], v[52:55], v[108:111]
    ds_read_b64_tr_b16 v[50:51], v3 offset:21504
    s_waitcnt lgkmcnt(14)
    v_mfma_f32_16x16x32_bf16 v[112:115], v[216:219], v[56:59], v[112:115]
    ds_read_b64_tr_b16 v[52:53], v4 offset:20480
    v_mfma_f32_16x16x32_bf16 v[116:119], v[220:223], v[56:59], v[116:119]
    ds_read_b64_tr_b16 v[54:55], v4 offset:21504
    v_mfma_f32_16x16x32_bf16 v[120:123], v[216:219], v[60:63], v[120:123]
    ds_read_b64_tr_b16 v[56:57], v5 offset:20480
    v_mfma_f32_16x16x32_bf16 v[124:127], v[220:223], v[60:63], v[124:127]
    ds_read_b64_tr_b16 v[58:59], v5 offset:21504
    s_waitcnt lgkmcnt(6)
    v_pk_fma_f32 v[96:97], v[8:9], v[16:17], v[96:97] op_sel_hi:[0,1,1] neg_lo:[1,0,0] neg_hi:[1,0,0]
    v_pk_fma_f32 v[98:99], v[8:9], v[18:19], v[98:99] op_sel_hi:[0,1,1] neg_lo:[1,0,0] neg_hi:[1,0,0]
    v_pk_fma_f32 v[104:105], v[10:11], v[16:17], v[104:105] op_sel_hi:[0,1,1] neg_lo:[1,0,0] neg_hi:[1,0,0]
    v_pk_fma_f32 v[106:107], v[10:11], v[18:19], v[106:107] op_sel_hi:[0,1,1] neg_lo:[1,0,0] neg_hi:[1,0,0]
    v_pk_mul_f32 v[96:97], v[20:21], v[96:97]
    v_pk_mul_f32 v[98:99], v[22:23], v[98:99]
    v_pk_mul_f32 v[104:105], v[20:21], v[104:105]
    v_pk_mul_f32 v[106:107], v[22:23], v[106:107]
    v_cvt_pk_bf16_f32 v72, v96, v97
    v_cvt_pk_bf16_f32 v73, v98, v99
    v_cvt_pk_bf16_f32 v74, v104, v105
    v_cvt_pk_bf16_f32 v75, v106, v107
    s_add_u32 s56, s52, 4194304
    v_permlane16_swap_b32 v72, v74
    v_permlane16_swap_b32 v73, v75
    buffer_store_dwordx4 v[72:75], v1, s[4:7], s56 offen offset:0 sc1
    v_pk_fma_f32 v[112:113], v[12:13], v[16:17], v[112:113] op_sel_hi:[0,1,1] neg_lo:[1,0,0] neg_hi:[1,0,0]
    v_pk_fma_f32 v[114:115], v[12:13], v[18:19], v[114:115] op_sel_hi:[0,1,1] neg_lo:[1,0,0] neg_hi:[1,0,0]
    v_pk_fma_f32 v[120:121], v[14:15], v[16:17], v[120:121] op_sel_hi:[0,1,1] neg_lo:[1,0,0] neg_hi:[1,0,0]
    v_pk_fma_f32 v[122:123], v[14:15], v[18:19], v[122:123] op_sel_hi:[0,1,1] neg_lo:[1,0,0] neg_hi:[1,0,0]
    v_pk_mul_f32 v[112:113], v[20:21], v[112:113]
    v_pk_mul_f32 v[114:115], v[22:23], v[114:115]
    v_pk_mul_f32 v[120:121], v[20:21], v[120:121]
    v_pk_mul_f32 v[122:123], v[22:23], v[122:123]
    v_cvt_pk_bf16_f32 v88, v112, v113
    v_cvt_pk_bf16_f32 v89, v114, v115
    v_cvt_pk_bf16_f32 v90, v120, v121
    v_cvt_pk_bf16_f32 v91, v122, v123
    s_add_u32 s56, s52, 4325376
    v_permlane16_swap_b32 v88, v90
    v_permlane16_swap_b32 v89, v91
    buffer_store_dwordx4 v[88:91], v1, s[4:7], s56 offen offset:0 sc1
    v_pk_fma_f32 v[100:101], v[8:9], v[24:25], v[100:101] op_sel_hi:[0,1,1] neg_lo:[1,0,0] neg_hi:[1,0,0]
    v_pk_fma_f32 v[102:103], v[8:9], v[26:27], v[102:103] op_sel_hi:[0,1,1] neg_lo:[1,0,0] neg_hi:[1,0,0]
    v_pk_fma_f32 v[108:109], v[10:11], v[24:25], v[108:109] op_sel_hi:[0,1,1] neg_lo:[1,0,0] neg_hi:[1,0,0]
    v_pk_fma_f32 v[110:111], v[10:11], v[26:27], v[110:111] op_sel_hi:[0,1,1] neg_lo:[1,0,0] neg_hi:[1,0,0]
    v_pk_mul_f32 v[100:101], v[28:29], v[100:101]
    v_pk_mul_f32 v[102:103], v[30:31], v[102:103]
    v_pk_mul_f32 v[108:109], v[28:29], v[108:109]
    v_pk_mul_f32 v[110:111], v[30:31], v[110:111]
    v_cvt_pk_bf16_f32 v76, v100, v101
    v_cvt_pk_bf16_f32 v77, v102, v103
    v_cvt_pk_bf16_f32 v78, v108, v109
    v_cvt_pk_bf16_f32 v79, v110, v111
    s_add_u32 s56, s52, 4194304
    v_permlane16_swap_b32 v76, v78
    v_permlane16_swap_b32 v77, v79
    buffer_store_dwordx4 v[76:79], v1, s[4:7], s56 offen offset:1024 sc1
    v_pk_fma_f32 v[116:117], v[12:13], v[24:25], v[116:117] op_sel_hi:[0,1,1] neg_lo:[1,0,0] neg_hi:[1,0,0]
    v_pk_fma_f32 v[118:119], v[12:13], v[26:27], v[118:119] op_sel_hi:[0,1,1] neg_lo:[1,0,0] neg_hi:[1,0,0]
    v_pk_fma_f32 v[124:125], v[14:15], v[24:25], v[124:125] op_sel_hi:[0,1,1] neg_lo:[1,0,0] neg_hi:[1,0,0]
    v_pk_fma_f32 v[126:127], v[14:15], v[26:27], v[126:127] op_sel_hi:[0,1,1] neg_lo:[1,0,0] neg_hi:[1,0,0]
    v_pk_mul_f32 v[116:117], v[28:29], v[116:117]
    v_pk_mul_f32 v[118:119], v[30:31], v[118:119]
    v_pk_mul_f32 v[124:125], v[28:29], v[124:125]
    v_pk_mul_f32 v[126:127], v[30:31], v[126:127]
    v_cvt_pk_bf16_f32 v92, v116, v117
    v_cvt_pk_bf16_f32 v93, v118, v119
    v_cvt_pk_bf16_f32 v94, v124, v125
    v_cvt_pk_bf16_f32 v95, v126, v127
    s_add_u32 s56, s52, 4325376
    v_permlane16_swap_b32 v92, v94
    v_permlane16_swap_b32 v93, v95
    buffer_store_dwordx4 v[92:95], v1, s[4:7], s56 offen offset:1024 sc1
    v_mfma_f32_16x16x32_bf16 v[128:131], v[32:35], v[224:227], v[128:131]
    ds_read_b64_tr_b16 v[60:61], v6 offset:20480
    v_mfma_f32_16x16x32_bf16 v[132:135], v[32:35], v[228:231], v[132:135]
    ds_read_b64_tr_b16 v[62:63], v6 offset:21504
    v_mfma_f32_16x16x32_bf16 v[136:139], v[36:39], v[224:227], v[136:139]
    ds_read_b64_tr_b16 v[32:33], v3 offset:24576
    v_mfma_f32_16x16x32_bf16 v[140:143], v[36:39], v[228:231], v[140:143]
    ds_read_b64_tr_b16 v[34:35], v3 offset:25600
    v_mfma_f32_16x16x32_bf16 v[144:147], v[40:43], v[224:227], v[144:147]
    ds_read_b64_tr_b16 v[36:37], v4 offset:24576
    v_mfma_f32_16x16x32_bf16 v[148:151], v[40:43], v[228:231], v[148:151]
    ds_read_b64_tr_b16 v[38:39], v4 offset:25600
    v_mfma_f32_16x16x32_bf16 v[152:155], v[44:47], v[224:227], v[152:155]
    ds_read_b64_tr_b16 v[40:41], v5 offset:24576
    v_mfma_f32_16x16x32_bf16 v[156:159], v[44:47], v[228:231], v[156:159]
    ds_read_b64_tr_b16 v[42:43], v5 offset:25600
    s_waitcnt lgkmcnt(10)
    v_mfma_f32_16x16x32_bf16 v[128:131], v[48:51], v[232:235], v[128:131]
    ds_read_b64_tr_b16 v[44:45], v6 offset:24576
    v_mfma_f32_16x16x32_bf16 v[132:135], v[48:51], v[236:239], v[132:135]
    ds_read_b64_tr_b16 v[46:47], v6 offset:25600
    v_mfma_f32_16x16x32_bf16 v[136:139], v[52:55], v[232:235], v[136:139]
    ds_read_b64_tr_b16 v[48:49], v3 offset:28672
    v_mfma_f32_16x16x32_bf16 v[140:143], v[52:55], v[236:239], v[140:143]
    ds_read_b64_tr_b16 v[50:51], v3 offset:29696
    s_waitcnt lgkmcnt(10)
    v_mfma_f32_16x16x32_bf16 v[144:147], v[56:59], v[232:235], v[144:147]
    ds_read_b64_tr_b16 v[52:53], v4 offset:28672
    v_mfma_f32_16x16x32_bf16 v[148:151], v[56:59], v[236:239], v[148:151]
    ds_read_b64_tr_b16 v[54:55], v4 offset:29696
    v_mfma_f32_16x16x32_bf16 v[152:155], v[60:63], v[232:235], v[152:155]
    ds_read_b64_tr_b16 v[56:57], v5 offset:28672
    v_mfma_f32_16x16x32_bf16 v[156:159], v[60:63], v[236:239], v[156:159]
    ds_read_b64_tr_b16 v[58:59], v5 offset:29696
    s_waitcnt lgkmcnt(10)
    v_mfma_f32_16x16x32_bf16 v[128:131], v[32:35], v[240:243], v[128:131]
    ds_read_b64_tr_b16 v[60:61], v6 offset:28672
    v_mfma_f32_16x16x32_bf16 v[132:135], v[32:35], v[244:247], v[132:135]
    ds_read_b64_tr_b16 v[62:63], v6 offset:29696
    s_barrier
    v_mfma_f32_16x16x32_bf16 v[136:139], v[36:39], v[240:243], v[136:139]
    ds_read_b64_tr_b16 v[32:33], v3 offset:32768
    v_mfma_f32_16x16x32_bf16 v[140:143], v[36:39], v[244:247], v[140:143]
    ds_read_b64_tr_b16 v[34:35], v3 offset:33792
    s_waitcnt lgkmcnt(10)
    v_mfma_f32_16x16x32_bf16 v[144:147], v[40:43], v[240:243], v[144:147]
    ds_read_b64_tr_b16 v[36:37], v4 offset:32768
    v_mfma_f32_16x16x32_bf16 v[148:151], v[40:43], v[244:247], v[148:151]
    ds_read_b64_tr_b16 v[38:39], v4 offset:33792
    v_mfma_f32_16x16x32_bf16 v[152:155], v[44:47], v[240:243], v[152:155]
    ds_read_b64_tr_b16 v[40:41], v5 offset:32768
    v_mfma_f32_16x16x32_bf16 v[156:159], v[44:47], v[244:247], v[156:159]
    ds_read_b64_tr_b16 v[42:43], v5 offset:33792
    s_waitcnt lgkmcnt(10)
    v_mfma_f32_16x16x32_bf16 v[128:131], v[48:51], v[248:251], v[128:131]
    ds_read_b64_tr_b16 v[44:45], v6 offset:32768
    v_mfma_f32_16x16x32_bf16 v[132:135], v[48:51], v[252:255], v[132:135]
    ds_read_b64_tr_b16 v[46:47], v6 offset:33792
    v_mfma_f32_16x16x32_bf16 v[136:139], v[52:55], v[248:251], v[136:139]
    ds_read_b64_tr_b16 v[48:49], v3 offset:36864
    v_mfma_f32_16x16x32_bf16 v[140:143], v[52:55], v[252:255], v[140:143]
    ds_read_b64_tr_b16 v[50:51], v3 offset:37888
    s_waitcnt lgkmcnt(10)
    v_mfma_f32_16x16x32_bf16 v[144:147], v[56:59], v[248:251], v[144:147]
    ds_read_b64_tr_b16 v[52:53], v4 offset:36864
    v_mfma_f32_16x16x32_bf16 v[148:151], v[56:59], v[252:255], v[148:151]
    ds_read_b64_tr_b16 v[54:55], v4 offset:37888
    v_mfma_f32_16x16x32_bf16 v[152:155], v[60:63], v[248:251], v[152:155]
    ds_read_b64_tr_b16 v[56:57], v5 offset:36864
    v_mfma_f32_16x16x32_bf16 v[156:159], v[60:63], v[252:255], v[156:159]
    ds_read_b64_tr_b16 v[58:59], v5 offset:37888
    s_waitcnt lgkmcnt(10)
    v_mfma_f32_16x16x32_bf16 v[128:131], v[32:35], v[160:163], v[128:131]
    ds_read_b64_tr_b16 v[60:61], v6 offset:36864
    v_mfma_f32_16x16x32_bf16 v[132:135], v[32:35], v[164:167], v[132:135]
    ds_read_b64_tr_b16 v[62:63], v6 offset:37888
    v_mfma_f32_16x16x32_bf16 v[136:139], v[36:39], v[160:163], v[136:139]
    ds_read_b64_tr_b16 v[32:33], v3 offset:40960
    v_mfma_f32_16x16x32_bf16 v[140:143], v[36:39], v[164:167], v[140:143]
    ds_read_b64_tr_b16 v[34:35], v3 offset:41984
    s_waitcnt lgkmcnt(10)
    v_mfma_f32_16x16x32_bf16 v[144:147], v[40:43], v[160:163], v[144:147]
    ds_read_b64_tr_b16 v[36:37], v4 offset:40960
    v_mfma_f32_16x16x32_bf16 v[148:151], v[40:43], v[164:167], v[148:151]
    ds_read_b64_tr_b16 v[38:39], v4 offset:41984
    v_mfma_f32_16x16x32_bf16 v[152:155], v[44:47], v[160:163], v[152:155]
    ds_read_b64_tr_b16 v[40:41], v5 offset:40960
    v_mfma_f32_16x16x32_bf16 v[156:159], v[44:47], v[164:167], v[156:159]
    ds_read_b64_tr_b16 v[42:43], v5 offset:41984
    s_waitcnt lgkmcnt(10)
    v_mfma_f32_16x16x32_bf16 v[128:131], v[48:51], v[168:171], v[128:131]
    ds_read_b64_tr_b16 v[44:45], v6 offset:40960
    v_mfma_f32_16x16x32_bf16 v[132:135], v[48:51], v[172:175], v[132:135]
    ds_read_b64_tr_b16 v[46:47], v6 offset:41984
    v_mfma_f32_16x16x32_bf16 v[136:139], v[52:55], v[168:171], v[136:139]
    ds_read_b64_tr_b16 v[48:49], v3 offset:45056
    v_mfma_f32_16x16x32_bf16 v[140:143], v[52:55], v[172:175], v[140:143]
    ds_read_b64_tr_b16 v[50:51], v3 offset:46080
    s_waitcnt lgkmcnt(10)
    v_mfma_f32_16x16x32_bf16 v[144:147], v[56:59], v[168:171], v[144:147]
    ds_read_b64_tr_b16 v[52:53], v4 offset:45056
    v_mfma_f32_16x16x32_bf16 v[148:151], v[56:59], v[172:175], v[148:151]
    ds_read_b64_tr_b16 v[54:55], v4 offset:46080
    v_mfma_f32_16x16x32_bf16 v[152:155], v[60:63], v[168:171], v[152:155]
    ds_read_b64_tr_b16 v[56:57], v5 offset:45056
    v_mfma_f32_16x16x32_bf16 v[156:159], v[60:63], v[172:175], v[156:159]
    ds_read_b64_tr_b16 v[58:59], v5 offset:46080
    s_waitcnt lgkmcnt(10)
    v_mfma_f32_16x16x32_bf16 v[128:131], v[32:35], v[176:179], v[128:131]
    ds_read_b64_tr_b16 v[60:61], v6 offset:45056
    v_mfma_f32_16x16x32_bf16 v[132:135], v[32:35], v[180:183], v[132:135]
    ds_read_b64_tr_b16 v[62:63], v6 offset:46080
    v_mfma_f32_16x16x32_bf16 v[136:139], v[36:39], v[176:179], v[136:139]
    ds_read_b64_tr_b16 v[32:33], v3 offset:49152
    v_mfma_f32_16x16x32_bf16 v[140:143], v[36:39], v[180:183], v[140:143]
    ds_read_b64_tr_b16 v[34:35], v3 offset:50176
    s_waitcnt lgkmcnt(10)
    v_mfma_f32_16x16x32_bf16 v[144:147], v[40:43], v[176:179], v[144:147]
    ds_read_b64_tr_b16 v[36:37], v4 offset:49152
    v_mfma_f32_16x16x32_bf16 v[148:151], v[40:43], v[180:183], v[148:151]
    ds_read_b64_tr_b16 v[38:39], v4 offset:50176
    v_mfma_f32_16x16x32_bf16 v[152:155], v[44:47], v[176:179], v[152:155]
    ds_read_b64_tr_b16 v[40:41], v5 offset:49152
    v_mfma_f32_16x16x32_bf16 v[156:159], v[44:47], v[180:183], v[156:159]
    ds_read_b64_tr_b16 v[42:43], v5 offset:50176
    s_waitcnt lgkmcnt(10)
    v_mfma_f32_16x16x32_bf16 v[128:131], v[48:51], v[184:187], v[128:131]
    ds_read_b64_tr_b16 v[44:45], v6 offset:49152
    s_mov_b32 s68, 1
    s_waitcnt vmcnt(0)
    s_atomic_add s68, s[22:23], s59 glc
    s_mov_b32 s55, s52
    s_add_u32 s56, s52, 4194304
    ds_read_b32 v8, v9 offset:4096
    v_mfma_f32_16x16x32_bf16 v[132:135], v[48:51], v[188:191], v[132:135]
    ds_read_b64_tr_b16 v[46:47], v6 offset:50176
    buffer_load_dwordx4 v[64:67], v1, s[4:7], s55 offen offset:0 sc1
    ds_read_b32 v10, v9 offset:4608
    v_mfma_f32_16x16x32_bf16 v[136:139], v[52:55], v[184:187], v[136:139]
    ds_read_b64_tr_b16 v[48:49], v3 offset:53248
    buffer_load_dwordx4 v[68:71], v1, s[4:7], s55 offen offset:1024 sc1
    ds_read_b32 v12, v9 offset:4160
    v_mfma_f32_16x16x32_bf16 v[140:143], v[52:55], v[188:191], v[140:143]
    ds_read_b64_tr_b16 v[50:51], v3 offset:54272
    buffer_load_dwordx4 v[72:75], v1, s[4:7], s56 offen offset:0 sc1
    ds_read_b32 v14, v9 offset:4672
    s_waitcnt lgkmcnt(14)
    v_mfma_f32_16x16x32_bf16 v[144:147], v[56:59], v[184:187], v[144:147]
    ds_read_b64_tr_b16 v[52:53], v4 offset:53248
    buffer_load_dwordx4 v[76:79], v1, s[4:7], s56 offen offset:1024 sc1
    ds_read_b128 v[16:19], v11 offset:0
    v_mfma_f32_16x16x32_bf16 v[148:151], v[56:59], v[188:191], v[148:151]
    ds_read_b64_tr_b16 v[54:55], v4 offset:54272
    ds_read_b128 v[20:23], v11 offset:64
    v_mfma_f32_16x16x32_bf16 v[152:155], v[60:63], v[184:187], v[152:155]
    ds_read_b64_tr_b16 v[56:57], v5 offset:53248
    ds_read_b128 v[24:27], v11 offset:128
    v_mfma_f32_16x16x32_bf16 v[156:159], v[60:63], v[188:191], v[156:159]
    ds_read_b64_tr_b16 v[58:59], v5 offset:54272
    ds_read_b128 v[28:31], v11 offset:192
    s_waitcnt lgkmcnt(14)
    v_mfma_f32_16x16x32_bf16 v[128:131], v[32:35], v[192:195], v[128:131]
    ds_read_b64_tr_b16 v[60:61], v6 offset:53248
    v_mfma_f32_16x16x32_bf16 v[132:135], v[32:35], v[196:199], v[132:135]
    ds_read_b64_tr_b16 v[62:63], v6 offset:54272
    v_mfma_f32_16x16x32_bf16 v[136:139], v[36:39], v[192:195], v[136:139]
    ds_read_b64_tr_b16 v[32:33], v3 offset:57344
    v_mfma_f32_16x16x32_bf16 v[140:143], v[36:39], v[196:199], v[140:143]
    ds_read_b64_tr_b16 v[34:35], v3 offset:58368
    s_waitcnt lgkmcnt(14)
    v_mfma_f32_16x16x32_bf16 v[144:147], v[40:43], v[192:195], v[144:147]
    ds_read_b64_tr_b16 v[36:37], v4 offset:57344
    v_mfma_f32_16x16x32_bf16 v[148:151], v[40:43], v[196:199], v[148:151]
    ds_read_b64_tr_b16 v[38:39], v4 offset:58368
    v_mfma_f32_16x16x32_bf16 v[152:155], v[44:47], v[192:195], v[152:155]
    ds_read_b64_tr_b16 v[40:41], v5 offset:57344
    v_mfma_f32_16x16x32_bf16 v[156:159], v[44:47], v[196:199], v[156:159]
    ds_read_b64_tr_b16 v[42:43], v5 offset:58368
    s_waitcnt lgkmcnt(13)
    v_mfma_f32_16x16x32_bf16 v[128:131], v[48:51], v[200:203], v[128:131]
    ds_read_b64_tr_b16 v[44:45], v6 offset:57344
    s_waitcnt lgkmcnt(9)
    v_mfma_f32_16x16x32_bf16 v[132:135], v[48:51], v[204:207], v[132:135]
    ds_read_b64_tr_b16 v[46:47], v6 offset:58368
    v_mul_f32 v10, 0x3e8293ee, v10
    v_mfma_f32_16x16x32_bf16 v[136:139], v[52:55], v[200:203], v[136:139]
    ds_read_b64_tr_b16 v[48:49], v3 offset:61440
    v_mul_f32 v14, 0x3e8293ee, v14
    v_mfma_f32_16x16x32_bf16 v[140:143], v[52:55], v[204:207], v[140:143]
    ds_read_b64_tr_b16 v[50:51], v3 offset:62464
    s_lshl_b32 s44, s16, 11
    s_waitcnt lgkmcnt(10)
    v_mfma_f32_16x16x32_bf16 v[144:147], v[56:59], v[200:203], v[144:147]
    ds_read_b64_tr_b16 v[52:53], v4 offset:61440
    s_add_u32 s44, s44, 131072
    v_mfma_f32_16x16x32_bf16 v[148:151], v[56:59], v[204:207], v[148:151]
    ds_read_b64_tr_b16 v[54:55], v4 offset:62464
    v_add_u32 v13, s44, v2
    v_mfma_f32_16x16x32_bf16 v[152:155], v[60:63], v[200:203], v[152:155]
    ds_read_b64_tr_b16 v[56:57], v5 offset:61440
    v_mfma_f32_16x16x32_bf16 v[156:159], v[60:63], v[204:207], v[156:159]
    ds_read_b64_tr_b16 v[58:59], v5 offset:62464
    s_waitcnt lgkmcnt(10)
    v_mfma_f32_16x16x32_bf16 v[128:131], v[32:35], v[208:211], v[128:131]
    ds_read_b64_tr_b16 v[60:61], v6 offset:61440
    v_mfma_f32_16x16x32_bf16 v[132:135], v[32:35], v[212:215], v[132:135]
    ds_read_b64_tr_b16 v[62:63], v6 offset:62464
    v_xor_b32 v3, 0x10000, v3
    v_xor_b32 v4, 0x10000, v4
    v_xor_b32 v5, 0x10000, v5
    v_xor_b32 v6, 0x10000, v6
    v_mfma_f32_16x16x32_bf16 v[136:139], v[36:39], v[208:211], v[136:139]
    v_mfma_f32_16x16x32_bf16 v[140:143], v[36:39], v[212:215], v[140:143]
    s_waitcnt lgkmcnt(8)
    v_mfma_f32_16x16x32_bf16 v[144:147], v[40:43], v[208:211], v[144:147]
    v_mfma_f32_16x16x32_bf16 v[148:151], v[40:43], v[212:215], v[148:151]
    v_mfma_f32_16x16x32_bf16 v[152:155], v[44:47], v[208:211], v[152:155]
    v_mfma_f32_16x16x32_bf16 v[156:159], v[44:47], v[212:215], v[156:159]
    s_waitcnt lgkmcnt(4)
    v_mfma_f32_16x16x32_bf16 v[128:131], v[48:51], v[216:219], v[128:131]
    v_mfma_f32_16x16x32_bf16 v[132:135], v[48:51], v[220:223], v[132:135]
    v_mfma_f32_16x16x32_bf16 v[136:139], v[52:55], v[216:219], v[136:139]
    v_mfma_f32_16x16x32_bf16 v[140:143], v[52:55], v[220:223], v[140:143]
    s_waitcnt lgkmcnt(0)
    v_mfma_f32_16x16x32_bf16 v[144:147], v[56:59], v[216:219], v[144:147]
    v_mfma_f32_16x16x32_bf16 v[148:151], v[56:59], v[220:223], v[148:151]
    v_mfma_f32_16x16x32_bf16 v[152:155], v[60:63], v[216:219], v[152:155]
    v_mfma_f32_16x16x32_bf16 v[156:159], v[60:63], v[220:223], v[156:159]
    v_pk_fma_f32 v[128:129], v[8:9], v[16:17], v[128:129] op_sel_hi:[0,1,1] neg_lo:[1,0,0] neg_hi:[1,0,0]
    v_pk_fma_f32 v[130:131], v[8:9], v[18:19], v[130:131] op_sel_hi:[0,1,1] neg_lo:[1,0,0] neg_hi:[1,0,0]
    v_pk_fma_f32 v[136:137], v[8:9], v[20:21], v[136:137] op_sel_hi:[0,1,1] neg_lo:[1,0,0] neg_hi:[1,0,0]
    v_pk_fma_f32 v[138:139], v[8:9], v[22:23], v[138:139] op_sel_hi:[0,1,1] neg_lo:[1,0,0] neg_hi:[1,0,0]
    v_pk_mul_f32 v[128:129], v[10:11], v[128:129] op_sel_hi:[0,1]
    v_pk_mul_f32 v[130:131], v[10:11], v[130:131] op_sel_hi:[0,1]
    v_pk_mul_f32 v[136:137], v[10:11], v[136:137] op_sel_hi:[0,1]
    v_pk_mul_f32 v[138:139], v[10:11], v[138:139] op_sel_hi:[0,1]
    v_cvt_pk_bf16_f32 v128, v128, v129
    v_cvt_pk_bf16_f32 v129, v130, v131
    v_cvt_pk_bf16_f32 v130, v136, v137
    v_cvt_pk_bf16_f32 v131, v138, v139
    ds_write_b128 v13, v[128:131] offset:0
    v_pk_fma_f32 v[132:133], v[12:13], v[16:17], v[132:133] op_sel_hi:[0,1,1] neg_lo:[1,0,0] neg_hi:[1,0,0]
    v_pk_fma_f32 v[134:135], v[12:13], v[18:19], v[134:135] op_sel_hi:[0,1,1] neg_lo:[1,0,0] neg_hi:[1,0,0]
    v_pk_fma_f32 v[140:141], v[12:13], v[20:21], v[140:141] op_sel_hi:[0,1,1] neg_lo:[1,0,0] neg_hi:[1,0,0]
    v_pk_fma_f32 v[142:143], v[12:13], v[22:23], v[142:143] op_sel_hi:[0,1,1] neg_lo:[1,0,0] neg_hi:[1,0,0]
    v_pk_mul_f32 v[132:133], v[14:15], v[132:133] op_sel_hi:[0,1]
    v_pk_mul_f32 v[134:135], v[14:15], v[134:135] op_sel_hi:[0,1]
    v_pk_mul_f32 v[140:141], v[14:15], v[140:141] op_sel_hi:[0,1]
    v_pk_mul_f32 v[142:143], v[14:15], v[142:143] op_sel_hi:[0,1]
    v_cvt_pk_bf16_f32 v132, v132, v133
    v_cvt_pk_bf16_f32 v133, v134, v135
    v_cvt_pk_bf16_f32 v134, v140, v141
    v_cvt_pk_bf16_f32 v135, v142, v143
    ds_write_b128 v13, v[132:135] offset:256
    v_add_u32 v4, 131072, v1
    s_waitcnt lgkmcnt(0)
    s_cmp_eq_u32 s68, 15
    s_cselect_b32 s68, 16, 0
    s_cbranch_scc1 b_k2
    s_atomic_add s68, s[22:23], s59 glc
b_k2:
    s_barrier
    ds_read_b128 v[32:35], v4 offset:0
    ds_read_b128 v[36:39], v4 offset:1024
    ds_read_b128 v[40:43], v4 offset:2048
    ds_read_b128 v[44:47], v4 offset:3072
    ds_read_b128 v[48:51], v4 offset:4096
    ds_read_b128 v[52:55], v4 offset:5120
    ds_read_b128 v[56:59], v4 offset:6144
    ds_read_b128 v[60:63], v4 offset:7168
    v_pk_fma_f32 v[144:145], v[8:9], v[24:25], v[144:145] op_sel_hi:[0,1,1] neg_lo:[1,0,0] neg_hi:[1,0,0]
    v_pk_fma_f32 v[146:147], v[8:9], v[26:27], v[146:147] op_sel_hi:[0,1,1] neg_lo:[1,0,0] neg_hi:[1,0,0]
    v_pk_fma_f32 v[152:153], v[8:9], v[28:29], v[152:153] op_sel_hi:[0,1,1] neg_lo:[1,0,0] neg_hi:[1,0,0]
    v_pk_fma_f32 v[154:155], v[8:9], v[30:31], v[154:155] op_sel_hi:[0,1,1] neg_lo:[1,0,0] neg_hi:[1,0,0]
    v_pk_mul_f32 v[144:145], v[10:11], v[144:145] op_sel_hi:[0,1]
    v_pk_mul_f32 v[146:147], v[10:11], v[146:147] op_sel_hi:[0,1]
    v_pk_mul_f32 v[152:153], v[10:11], v[152:153] op_sel_hi:[0,1]
    v_pk_mul_f32 v[154:155], v[10:11], v[154:155] op_sel_hi:[0,1]
    v_cvt_pk_bf16_f32 v144, v144, v145
    v_cvt_pk_bf16_f32 v145, v146, v147
    v_cvt_pk_bf16_f32 v146, v152, v153
    v_cvt_pk_bf16_f32 v147, v154, v155
    ds_write_b128 v13, v[144:147] offset:8192
    s_waitcnt vmcnt(0) lgkmcnt(7)
    v_mfma_f32_32x32x16_bf16 v[192:207], v[64:67], v[32:35], 0
    v_mfma_f32_32x32x16_bf16 v[192:207], v[68:71], v[36:39], v[192:207]
    v_pk_fma_f32 v[148:149], v[12:13], v[24:25], v[148:149] op_sel_hi:[0,1,1] neg_lo:[1,0,0] neg_hi:[1,0,0]
    v_pk_fma_f32 v[150:151], v[12:13], v[26:27], v[150:151] op_sel_hi:[0,1,1] neg_lo:[1,0,0] neg_hi:[1,0,0]
    v_pk_fma_f32 v[156:157], v[12:13], v[28:29], v[156:157] op_sel_hi:[0,1,1] neg_lo:[1,0,0] neg_hi:[1,0,0]
    v_pk_fma_f32 v[158:159], v[12:13], v[30:31], v[158:159] op_sel_hi:[0,1,1] neg_lo:[1,0,0] neg_hi:[1,0,0]
    v_pk_mul_f32 v[148:149], v[14:15], v[148:149] op_sel_hi:[0,1]
    v_pk_mul_f32 v[150:151], v[14:15], v[150:151] op_sel_hi:[0,1]
    v_pk_mul_f32 v[156:157], v[14:15], v[156:157] op_sel_hi:[0,1]
    v_pk_mul_f32 v[158:159], v[14:15], v[158:159] op_sel_hi:[0,1]
    v_cvt_pk_bf16_f32 v148, v148, v149
    v_cvt_pk_bf16_f32 v149, v150, v151
    v_cvt_pk_bf16_f32 v150, v156, v157
    v_cvt_pk_bf16_f32 v151, v158, v159
    ds_write_b128 v13, v[148:151] offset:8448
    v_mov_b32 v9, 0xdddddddd
    v_bfe_u32 v10, v1, 4, 3
    v_mov_b32 v11, 0x3f803f80
    v_cmp_eq_u32 vcc, 0, v10
    v_cmp_eq_u32 s[44:45], 4, v10
    s_mov_b32 s57, 0
    v_cndmask_b32 v28, 0, v11, vcc
    v_cndmask_b32 v29, 0, v11, vcc
    v_cndmask_b32 v30, 0, v11, s[44:45]
    v_cndmask_b32 v31, 0, v11, s[44:45]
    v_mov_b32 v10, 0
    v_mov_b32 v11, 0
    s_mov_b32 s66, 0x10000
    s_waitcnt lgkmcnt(0)
    s_cmp_eq_u32 s68, 16
    s_cbranch_scc1 c_k_ok
c_k_poll:
    s_mov_b32 s68, 0
    s_atomic_add s68, s[22:23], s59 offset:0 glc
    s_sub_u32 s66, s66, 1
    s_cselect_b32 s67, 16, 0
    s_waitcnt lgkmcnt(0)
    s_max_u32 s68, s68, s67
    s_cmp_lt_u32 s68, 16
    s_cbranch_scc1 c_k_poll
c_k_ok:
    s_add_u32 s54, s54, 8192
    s_and_b32 s54, s54, 0x1ffff
    s_add_u32 s55, s53, s54
    s_add_u32 s56, s55, 4194304
    buffer_load_dwordx4 v[80:83], v1, s[4:7], s55 offen offset:0 sc1
    buffer_load_dwordx4 v[84:87], v1, s[4:7], s55 offen offset:1024 sc1
    buffer_load_dwordx4 v[88:91], v1, s[4:7], s56 offen offset:0 sc1
    buffer_load_dwordx4 v[92:95], v1, s[4:7], s56 offen offset:1024 sc1
    s_add_u32 s54, s54, 8192
    s_and_b32 s54, s54, 0x1ffff
    s_add_u32 s55, s53, s54
    s_add_u32 s56, s55, 4194304
    buffer_load_dwordx4 v[96:99], v1, s[4:7], s55 offen offset:0 sc1
    buffer_load_dwordx4 v[100:103], v1, s[4:7], s55 offen offset:1024 sc1
    buffer_load_dwordx4 v[104:107], v1, s[4:7], s56 offen offset:0 sc1
    buffer_load_dwordx4 v[108:111], v1, s[4:7], s56 offen offset:1024 sc1
    v_mfma_f32_32x32x16_bf16 v[208:223], v[64:67], v[40:43], 0
    s_add_u32 s54, s54, 8192
    s_and_b32 s54, s54, 0x1ffff
    s_add_u32 s55, s53, s54
    s_add_u32 s56, s55, 4194304
    v_exp_f32 v192, v192
    v_exp_f32 v193, v193
    v_exp_f32 v194, v194
    v_mfma_f32_32x32x8_bf16 v[128:143], v[10:11], v[10:11], 0
    v_mov_b32 v12, 0
    v_exp_f32 v195, v195
    v_exp_f32 v196, v196
    v_exp_f32 v197, v197
    v_mfma_f32_32x32x16_bf16 v[208:223], v[68:71], v[44:47], v[208:223]
    v_exp_f32 v198, v198
    v_exp_f32 v199, v199
    v_exp_f32 v200, v200
    v_mfma_f32_32x32x8_bf16 v[144:159], v[10:11], v[10:11], 0
    v_mov_b32 v16, 0
    buffer_load_dwordx4 v[112:115], v1, s[4:7], s55 offen offset:0 sc1
    v_exp_f32 v201, v201
    v_exp_f32 v202, v202
    v_mfma_f32_32x32x8_bf16 v[160:175], v[10:11], v[10:11], 0
    v_mov_b32 v20, 0
    s_lshl_b32 s44, s16, 12
    s_add_u32 s44, s44, 65536
    v_add_u32 v5, s44, v1
    s_lshl_b32 s44, s16, 8
    s_add_u32 s44, s44, 147456
    v_lshrrev_b32 v6, 2, v1
    v_add_u32 v6, s44, v6
    s_lshl_b32 s44, s21, 22
    s_lshl_b32 s45, s38, 16
    s_add_u32 s41, s44, s45
    s_lshl_b32 s45, s18, 12
    s_add_u32 s43, s41, s45
    s_and_b32 s45, s45, 0
    s_add_u32 s41, s41, s45
    s_add_u32 s41, s41, 16777216
    v_exp_f32 v203, v203
    v_exp_f32 v204, v204
    v_exp_f32 v205, v205
    v_mfma_f32_32x32x8_bf16 v[176:191], v[10:11], v[10:11], 0
    v_mov_b32 v24, 0
    v_exp_f32 v206, v206
    v_exp_f32 v207, v207
    v_mfma_f32_32x32x16_bf16 v[224:239], v[64:67], v[48:51], 0
    v_exp_f32 v208, v208
    v_exp_f32 v209, v209
    v_exp_f32 v210, v210
    v_smfmac_f32_32x32x32_bf16 v[128:143], v[72:75], v[192:199], v9
    v_exp_f32 v211, v211
    v_exp_f32 v212, v212
    v_exp_f32 v213, v213
    v_mfma_f32_32x32x16_bf16 v[224:239], v[68:71], v[52:55], v[224:239]
    v_exp_f32 v214, v214
    v_exp_f32 v215, v215
    v_exp_f32 v216, v216
    v_smfmac_f32_16x16x64_bf16 v[12:15], v[28:31], v[192:199], v9
    buffer_load_dwordx4 v[116:119], v1, s[4:7], s55 offen offset:1024 sc1
    v_exp_f32 v217, v217
    v_smfmac_f32_32x32x32_bf16 v[128:143], v[76:79], v[200:207], v9
    v_exp_f32 v218, v218
    v_exp_f32 v219, v219
    v_exp_f32 v220, v220
    v_smfmac_f32_16x16x64_bf16 v[12:15], v[28:31], v[200:207], v9
    v_exp_f32 v221, v221
    v_exp_f32 v222, v222
    v_exp_f32 v223, v223
b_head:
    s_mov_b32 s58, 3
b_loop:
    v_mfma_f32_32x32x16_bf16 v[240:255], v[64:67], v[56:59], 0
    v_exp_f32 v224, v224
    v_exp_f32 v225, v225
    v_exp_f32 v226, v226
    v_smfmac_f32_32x32x32_bf16 v[144:159], v[72:75], v[208:215], v9
    v_exp_f32 v227, v227
    v_exp_f32 v228, v228
    v_exp_f32 v229, v229
    v_mfma_f32_32x32x16_bf16 v[240:255], v[68:71], v[60:63], v[240:255]
    v_exp_f32 v230, v230
    v_exp_f32 v231, v231
    v_exp_f32 v232, v232
    v_smfmac_f32_16x16x64_bf16 v[16:19], v[28:31], v[208:215], v9
    buffer_load_dwordx4 v[120:123], v1, s[4:7], s56 offen offset:0 sc1
    v_exp_f32 v233, v233
    v_smfmac_f32_32x32x32_bf16 v[144:159], v[76:79], v[216:223], v9
    v_exp_f32 v234, v234
    v_exp_f32 v235, v235
    v_exp_f32 v236, v236
    v_smfmac_f32_16x16x64_bf16 v[16:19], v[28:31], v[216:223], v9
    v_exp_f32 v237, v237
    v_exp_f32 v238, v238
    v_exp_f32 v239, v239
    s_waitcnt vmcnt(7)
    v_mfma_f32_32x32x16_bf16 v[192:207], v[80:83], v[32:35], 0
    v_exp_f32 v240, v240
    v_exp_f32 v241, v241
    v_exp_f32 v242, v242
    v_smfmac_f32_32x32x32_bf16 v[160:175], v[72:75], v[224:231], v9
    v_exp_f32 v243, v243
    v_exp_f32 v244, v244
    v_exp_f32 v245, v245
    v_mfma_f32_32x32x16_bf16 v[192:207], v[84:87], v[36:39], v[192:207]
    v_exp_f32 v246, v246
    v_exp_f32 v247, v247
    v_exp_f32 v248, v248
    v_smfmac_f32_16x16x64_bf16 v[20:23], v[28:31], v[224:231], v9
    buffer_load_dwordx4 v[124:127], v1, s[4:7], s56 offen offset:1024 sc1
    v_exp_f32 v249, v249
    v_smfmac_f32_32x32x32_bf16 v[160:175], v[76:79], v[232:239], v9
    v_exp_f32 v250, v250
    v_exp_f32 v251, v251
    v_exp_f32 v252, v252
    v_smfmac_f32_16x16x64_bf16 v[20:23], v[28:31], v[232:239], v9
    v_exp_f32 v253, v253
    v_exp_f32 v254, v254
    v_exp_f32 v255, v255
    v_mfma_f32_32x32x16_bf16 v[208:223], v[80:83], v[40:43], 0
    s_add_u32 s54, s54, 8192
    s_and_b32 s54, s54, 0x1ffff
    s_add_u32 s55, s53, s54
    s_add_u32 s56, s55, 4194304
    v_exp_f32 v192, v192
    v_exp_f32 v193, v193
    v_exp_f32 v194, v194
    v_smfmac_f32_32x32x32_bf16 v[176:191], v[72:75], v[240:247], v9
    v_exp_f32 v195, v195
    v_exp_f32 v196, v196
    v_exp_f32 v197, v197
    v_mfma_f32_32x32x16_bf16 v[208:223], v[84:87], v[44:47], v[208:223]
    v_exp_f32 v198, v198
    v_exp_f32 v199, v199
    v_exp_f32 v200, v200
    v_smfmac_f32_16x16x64_bf16 v[24:27], v[28:31], v[240:247], v9
    buffer_load_dwordx4 v[64:67], v1, s[4:7], s55 offen offset:0 sc1
    v_exp_f32 v201, v201
    v_smfmac_f32_32x32x32_bf16 v[176:191], v[76:79], v[248:255], v9
    v_exp_f32 v202, v202
    v_exp_f32 v203, v203
    v_exp_f32 v204, v204
    v_smfmac_f32_16x16x64_bf16 v[24:27], v[28:31], v[248:255], v9
    v_exp_f32 v205, v205
    v_exp_f32 v206, v206
    v_exp_f32 v207, v207
    v_mfma_f32_32x32x16_bf16 v[224:239], v[80:83], v[48:51], 0
    v_exp_f32 v208, v208
    v_exp_f32 v209, v209
    v_exp_f32 v210, v210
    v_smfmac_f32_32x32x32_bf16 v[128:143], v[88:91], v[192:199], v9
    v_exp_f32 v211, v211
    v_exp_f32 v212, v212
    v_exp_f32 v213, v213
    v_mfma_f32_32x32x16_bf16 v[224:239], v[84:87], v[52:55], v[224:239]
    v_exp_f32 v214, v214
    v_exp_f32 v215, v215
    v_exp_f32 v216, v216
    v_smfmac_f32_16x16x64_bf16 v[12:15], v[28:31], v[192:199], v9
    buffer_load_dwordx4 v[68:71], v1, s[4:7], s55 offen offset:1024 sc1
    v_exp_f32 v217, v217
    v_smfmac_f32_32x32x32_bf16 v[128:143], v[92:95], v[200:207], v9
    v_exp_f32 v218, v218
    v_exp_f32 v219, v219
    v_exp_f32 v220, v220
    v_smfmac_f32_16x16x64_bf16 v[12:15], v[28:31], v[200:207], v9
    v_exp_f32 v221, v221
    v_exp_f32 v222, v222
    v_exp_f32 v223, v223
    v_mfma_f32_32x32x16_bf16 v[240:255], v[80:83], v[56:59], 0
    v_exp_f32 v224, v224
    v_exp_f32 v225, v225
    v_exp_f32 v226, v226
    v_smfmac_f32_32x32x32_bf16 v[144:159], v[88:91], v[208:215], v9
    v_exp_f32 v227, v227
    v_exp_f32 v228, v228
    v_exp_f32 v229, v229
    v_mfma_f32_32x32x16_bf16 v[240:255], v[84:87], v[60:63], v[240:255]
    v_exp_f32 v230, v230
    v_exp_f32 v231, v231
    v_exp_f32 v232, v232
    v_smfmac_f32_16x16x64_bf16 v[16:19], v[28:31], v[208:215], v9
    buffer_load_dwordx4 v[72:75], v1, s[4:7], s56 offen offset:0 sc1
    v_exp_f32 v233, v233
    v_smfmac_f32_32x32x32_bf16 v[144:159], v[92:95], v[216:223], v9
    v_exp_f32 v234, v234
    v_exp_f32 v235, v235
    v_exp_f32 v236, v236
    v_smfmac_f32_16x16x64_bf16 v[16:19], v[28:31], v[216:223], v9
    v_exp_f32 v237, v237
    v_exp_f32 v238, v238
    v_exp_f32 v239, v239
    s_waitcnt vmcnt(7)
    v_mfma_f32_32x32x16_bf16 v[192:207], v[96:99], v[32:35], 0
    v_exp_f32 v240, v240
    v_exp_f32 v241, v241
    v_exp_f32 v242, v242
    v_smfmac_f32_32x32x32_bf16 v[160:175], v[88:91], v[224:231], v9
    v_exp_f32 v243, v243
    v_exp_f32 v244, v244
    v_exp_f32 v245, v245
    v_mfma_f32_32x32x16_bf16 v[192:207], v[100:103], v[36:39], v[192:207]
    v_exp_f32 v246, v246
    v_exp_f32 v247, v247
    v_exp_f32 v248, v248
    v_smfmac_f32_16x16x64_bf16 v[20:23], v[28:31], v[224:231], v9
    buffer_load_dwordx4 v[76:79], v1, s[4:7], s56 offen offset:1024 sc1
    v_exp_f32 v249, v249
    v_smfmac_f32_32x32x32_bf16 v[160:175], v[92:95], v[232:239], v9
    v_exp_f32 v250, v250
    v_exp_f32 v251, v251
    v_exp_f32 v252, v252
    v_smfmac_f32_16x16x64_bf16 v[20:23], v[28:31], v[232:239], v9
    v_exp_f32 v253, v253
    v_exp_f32 v254, v254
    v_exp_f32 v255, v255
    v_mfma_f32_32x32x16_bf16 v[208:223], v[96:99], v[40:43], 0
    s_add_u32 s54, s54, 8192
    s_and_b32 s54, s54, 0x1ffff
    s_add_u32 s55, s53, s54
    s_add_u32 s56, s55, 4194304
    v_exp_f32 v192, v192
    v_exp_f32 v193, v193
    v_exp_f32 v194, v194
    v_smfmac_f32_32x32x32_bf16 v[176:191], v[88:91], v[240:247], v9
    v_exp_f32 v195, v195
    v_exp_f32 v196, v196
    v_exp_f32 v197, v197
    v_mfma_f32_32x32x16_bf16 v[208:223], v[100:103], v[44:47], v[208:223]
    v_exp_f32 v198, v198
    v_exp_f32 v199, v199
    v_exp_f32 v200, v200
    v_smfmac_f32_16x16x64_bf16 v[24:27], v[28:31], v[240:247], v9
    buffer_load_dwordx4 v[80:83], v1, s[4:7], s55 offen offset:0 sc1
    v_exp_f32 v201, v201
    v_smfmac_f32_32x32x32_bf16 v[176:191], v[92:95], v[248:255], v9
    v_exp_f32 v202, v202
    v_exp_f32 v203, v203
    v_exp_f32 v204, v204
    v_smfmac_f32_16x16x64_bf16 v[24:27], v[28:31], v[248:255], v9
    v_exp_f32 v205, v205
    v_exp_f32 v206, v206
    v_exp_f32 v207, v207
    v_mfma_f32_32x32x16_bf16 v[224:239], v[96:99], v[48:51], 0
    v_exp_f32 v208, v208
    v_exp_f32 v209, v209
    v_exp_f32 v210, v210
    v_smfmac_f32_32x32x32_bf16 v[128:143], v[104:107], v[192:199], v9
    v_exp_f32 v211, v211
    v_exp_f32 v212, v212
    v_exp_f32 v213, v213
    v_mfma_f32_32x32x16_bf16 v[224:239], v[100:103], v[52:55], v[224:239]
    v_exp_f32 v214, v214
    v_exp_f32 v215, v215
    v_exp_f32 v216, v216
    v_smfmac_f32_16x16x64_bf16 v[12:15], v[28:31], v[192:199], v9
    buffer_load_dwordx4 v[84:87], v1, s[4:7], s55 offen offset:1024 sc1
    v_exp_f32 v217, v217
    v_smfmac_f32_32x32x32_bf16 v[128:143], v[108:111], v[200:207], v9
    v_exp_f32 v218, v218
    v_exp_f32 v219, v219
    v_exp_f32 v220, v220
    v_smfmac_f32_16x16x64_bf16 v[12:15], v[28:31], v[200:207], v9
    v_exp_f32 v221, v221
    v_exp_f32 v222, v222
    v_exp_f32 v223, v223
    v_mfma_f32_32x32x16_bf16 v[240:255], v[96:99], v[56:59], 0
    v_exp_f32 v224, v224
    v_exp_f32 v225, v225
    v_exp_f32 v226, v226
    v_smfmac_f32_32x32x32_bf16 v[144:159], v[104:107], v[208:215], v9
    v_exp_f32 v227, v227
    v_exp_f32 v228, v228
    v_exp_f32 v229, v229
    v_mfma_f32_32x32x16_bf16 v[240:255], v[100:103], v[60:63], v[240:255]
    v_exp_f32 v230, v230
    v_exp_f32 v231, v231
    v_exp_f32 v232, v232
    v_smfmac_f32_16x16x64_bf16 v[16:19], v[28:31], v[208:215], v9
    buffer_load_dwordx4 v[88:91], v1, s[4:7], s56 offen offset:0 sc1
    v_exp_f32 v233, v233
    v_smfmac_f32_32x32x32_bf16 v[144:159], v[108:111], v[216:223], v9
    v_exp_f32 v234, v234
    v_exp_f32 v235, v235
    v_exp_f32 v236, v236
    v_smfmac_f32_16x16x64_bf16 v[16:19], v[28:31], v[216:223], v9
    v_exp_f32 v237, v237
    v_exp_f32 v238, v238
    v_exp_f32 v239, v239
    s_waitcnt vmcnt(7)
    v_mfma_f32_32x32x16_bf16 v[192:207], v[112:115], v[32:35], 0
    v_exp_f32 v240, v240
    v_exp_f32 v241, v241
    v_exp_f32 v242, v242
    v_smfmac_f32_32x32x32_bf16 v[160:175], v[104:107], v[224:231], v9
    v_exp_f32 v243, v243
    v_exp_f32 v244, v244
    v_exp_f32 v245, v245
    v_mfma_f32_32x32x16_bf16 v[192:207], v[116:119], v[36:39], v[192:207]
    v_exp_f32 v246, v246
    v_exp_f32 v247, v247
    v_exp_f32 v248, v248
    v_smfmac_f32_16x16x64_bf16 v[20:23], v[28:31], v[224:231], v9
    buffer_load_dwordx4 v[92:95], v1, s[4:7], s56 offen offset:1024 sc1
    v_exp_f32 v249, v249
    v_smfmac_f32_32x32x32_bf16 v[160:175], v[108:111], v[232:239], v9
    v_exp_f32 v250, v250
    v_exp_f32 v251, v251
    v_exp_f32 v252, v252
    v_smfmac_f32_16x16x64_bf16 v[20:23], v[28:31], v[232:239], v9
    v_exp_f32 v253, v253
    v_exp_f32 v254, v254
    v_exp_f32 v255, v255
    v_mfma_f32_32x32x16_bf16 v[208:223], v[112:115], v[40:43], 0
    s_add_u32 s54, s54, 8192
    s_and_b32 s54, s54, 0x1ffff
    s_add_u32 s55, s53, s54
    s_add_u32 s56, s55, 4194304
    v_exp_f32 v192, v192
    v_exp_f32 v193, v193
    v_exp_f32 v194, v194
    v_smfmac_f32_32x32x32_bf16 v[176:191], v[104:107], v[240:247], v9
    v_exp_f32 v195, v195
    v_exp_f32 v196, v196
    v_exp_f32 v197, v197
    v_mfma_f32_32x32x16_bf16 v[208:223], v[116:119], v[44:47], v[208:223]
    v_exp_f32 v198, v198
    v_exp_f32 v199, v199
    v_exp_f32 v200, v200
    v_smfmac_f32_16x16x64_bf16 v[24:27], v[28:31], v[240:247], v9
    buffer_load_dwordx4 v[96:99], v1, s[4:7], s55 offen offset:0 sc1
    v_exp_f32 v201, v201
    v_smfmac_f32_32x32x32_bf16 v[176:191], v[108:111], v[248:255], v9
    v_exp_f32 v202, v202
    v_exp_f32 v203, v203
    v_exp_f32 v204, v204
    v_smfmac_f32_16x16x64_bf16 v[24:27], v[28:31], v[248:255], v9
    v_exp_f32 v205, v205
    v_exp_f32 v206, v206
    v_exp_f32 v207, v207
    v_mfma_f32_32x32x16_bf16 v[224:239], v[112:115], v[48:51], 0
    v_exp_f32 v208, v208
    v_exp_f32 v209, v209
    v_exp_f32 v210, v210
    v_smfmac_f32_32x32x32_bf16 v[128:143], v[120:123], v[192:199], v9
    v_exp_f32 v211, v211
    v_exp_f32 v212, v212
    v_exp_f32 v213, v213
    v_mfma_f32_32x32x16_bf16 v[224:239], v[116:119], v[52:55], v[224:239]
    v_exp_f32 v214, v214
    v_exp_f32 v215, v215
    v_exp_f32 v216, v216
    v_smfmac_f32_16x16x64_bf16 v[12:15], v[28:31], v[192:199], v9
    buffer_load_dwordx4 v[100:103], v1, s[4:7], s55 offen offset:1024 sc1
    v_exp_f32 v217, v217
    v_smfmac_f32_32x32x32_bf16 v[128:143], v[124:127], v[200:207], v9
    v_exp_f32 v218, v218
    v_exp_f32 v219, v219
    v_exp_f32 v220, v220
    v_smfmac_f32_16x16x64_bf16 v[12:15], v[28:31], v[200:207], v9
    v_exp_f32 v221, v221
    v_exp_f32 v222, v222
    v_exp_f32 v223, v223
    v_mfma_f32_32x32x16_bf16 v[240:255], v[112:115], v[56:59], 0
    v_exp_f32 v224, v224
    v_exp_f32 v225, v225
    v_exp_f32 v226, v226
    v_smfmac_f32_32x32x32_bf16 v[144:159], v[120:123], v[208:215], v9
    v_exp_f32 v227, v227
    v_exp_f32 v228, v228
    v_exp_f32 v229, v229
    v_mfma_f32_32x32x16_bf16 v[240:255], v[116:119], v[60:63], v[240:255]
    v_exp_f32 v230, v230
    v_exp_f32 v231, v231
    v_exp_f32 v232, v232
    v_smfmac_f32_16x16x64_bf16 v[16:19], v[28:31], v[208:215], v9
    buffer_load_dwordx4 v[104:107], v1, s[4:7], s56 offen offset:0 sc1
    v_exp_f32 v233, v233
    v_smfmac_f32_32x32x32_bf16 v[144:159], v[124:127], v[216:223], v9
    v_exp_f32 v234, v234
    v_exp_f32 v235, v235
    v_exp_f32 v236, v236
    v_smfmac_f32_16x16x64_bf16 v[16:19], v[28:31], v[216:223], v9
    v_exp_f32 v237, v237
    v_exp_f32 v238, v238
    v_exp_f32 v239, v239
    s_waitcnt vmcnt(7)
    v_mfma_f32_32x32x16_bf16 v[192:207], v[64:67], v[32:35], 0
    v_exp_f32 v240, v240
    v_exp_f32 v241, v241
    v_exp_f32 v242, v242
    v_smfmac_f32_32x32x32_bf16 v[160:175], v[120:123], v[224:231], v9
    v_exp_f32 v243, v243
    v_exp_f32 v244, v244
    v_exp_f32 v245, v245
    v_mfma_f32_32x32x16_bf16 v[192:207], v[68:71], v[36:39], v[192:207]
    v_exp_f32 v246, v246
    v_exp_f32 v247, v247
    v_exp_f32 v248, v248
    v_smfmac_f32_16x16x64_bf16 v[20:23], v[28:31], v[224:231], v9
    buffer_load_dwordx4 v[108:111], v1, s[4:7], s56 offen offset:1024 sc1
    v_exp_f32 v249, v249
    v_smfmac_f32_32x32x32_bf16 v[160:175], v[124:127], v[232:239], v9
    v_exp_f32 v250, v250
    v_exp_f32 v251, v251
    v_exp_f32 v252, v252
    v_smfmac_f32_16x16x64_bf16 v[20:23], v[28:31], v[232:239], v9
    v_exp_f32 v253, v253
    v_exp_f32 v254, v254
    v_exp_f32 v255, v255
    v_mfma_f32_32x32x16_bf16 v[208:223], v[64:67], v[40:43], 0
    s_add_u32 s54, s54, 8192
    s_and_b32 s54, s54, 0x1ffff
    s_add_u32 s55, s53, s54
    s_add_u32 s56, s55, 4194304
    v_exp_f32 v192, v192
    v_exp_f32 v193, v193
    v_exp_f32 v194, v194
    v_smfmac_f32_32x32x32_bf16 v[176:191], v[120:123], v[240:247], v9
    v_exp_f32 v195, v195
    v_exp_f32 v196, v196
    v_exp_f32 v197, v197
    v_mfma_f32_32x32x16_bf16 v[208:223], v[68:71], v[44:47], v[208:223]
    v_exp_f32 v198, v198
    v_exp_f32 v199, v199
    v_exp_f32 v200, v200
    v_smfmac_f32_16x16x64_bf16 v[24:27], v[28:31], v[240:247], v9
    buffer_load_dwordx4 v[112:115], v1, s[4:7], s55 offen offset:0 sc1
    v_exp_f32 v201, v201
    v_smfmac_f32_32x32x32_bf16 v[176:191], v[124:127], v[248:255], v9
    v_exp_f32 v202, v202
    v_exp_f32 v203, v203
    v_exp_f32 v204, v204
    v_smfmac_f32_16x16x64_bf16 v[24:27], v[28:31], v[248:255], v9
    v_exp_f32 v205, v205
    v_exp_f32 v206, v206
    v_exp_f32 v207, v207
    v_mfma_f32_32x32x16_bf16 v[224:239], v[64:67], v[48:51], 0
    v_exp_f32 v208, v208
    v_exp_f32 v209, v209
    v_exp_f32 v210, v210
    v_smfmac_f32_32x32x32_bf16 v[128:143], v[72:75], v[192:199], v9
    v_exp_f32 v211, v211
    v_exp_f32 v212, v212
    v_exp_f32 v213, v213
    v_mfma_f32_32x32x16_bf16 v[224:239], v[68:71], v[52:55], v[224:239]
    v_exp_f32 v214, v214
    v_exp_f32 v215, v215
    v_exp_f32 v216, v216
    v_smfmac_f32_16x16x64_bf16 v[12:15], v[28:31], v[192:199], v9
    buffer_load_dwordx4 v[116:119], v1, s[4:7], s55 offen offset:1024 sc1
    v_exp_f32 v217, v217
    v_smfmac_f32_32x32x32_bf16 v[128:143], v[76:79], v[200:207], v9
    v_exp_f32 v218, v218
    v_exp_f32 v219, v219
    v_exp_f32 v220, v220
    v_smfmac_f32_16x16x64_bf16 v[12:15], v[28:31], v[200:207], v9
    v_exp_f32 v221, v221
    v_exp_f32 v222, v222
    v_exp_f32 v223, v223
    s_sub_u32 s58, s58, 1
    s_cmp_lg_u32 s58, 0
    s_cbranch_scc1 b_loop
    v_mfma_f32_32x32x16_bf16 v[240:255], v[64:67], v[56:59], 0
    v_exp_f32 v224, v224
    v_exp_f32 v225, v225
    v_exp_f32 v226, v226
    v_smfmac_f32_32x32x32_bf16 v[144:159], v[72:75], v[208:215], v9
    v_exp_f32 v227, v227
    v_exp_f32 v228, v228
    v_exp_f32 v229, v229
    v_mfma_f32_32x32x16_bf16 v[240:255], v[68:71], v[60:63], v[240:255]
    v_exp_f32 v230, v230
    v_exp_f32 v231, v231
    v_exp_f32 v232, v232
    v_smfmac_f32_16x16x64_bf16 v[16:19], v[28:31], v[208:215], v9
    buffer_load_dwordx4 v[120:123], v1, s[4:7], s56 offen offset:0 sc1
    v_exp_f32 v233, v233
    v_smfmac_f32_32x32x32_bf16 v[144:159], v[76:79], v[216:223], v9
    v_exp_f32 v234, v234
    v_exp_f32 v235, v235
    v_exp_f32 v236, v236
    v_smfmac_f32_16x16x64_bf16 v[16:19], v[28:31], v[216:223], v9
    v_exp_f32 v237, v237
    v_exp_f32 v238, v238
    v_exp_f32 v239, v239
    s_waitcnt vmcnt(7)
    v_mfma_f32_32x32x16_bf16 v[192:207], v[80:83], v[32:35], 0
    v_exp_f32 v240, v240
    v_exp_f32 v241, v241
    v_exp_f32 v242, v242
    v_smfmac_f32_32x32x32_bf16 v[160:175], v[72:75], v[224:231], v9
    v_exp_f32 v243, v243
    v_exp_f32 v244, v244
    v_exp_f32 v245, v245
    v_mfma_f32_32x32x16_bf16 v[192:207], v[84:87], v[36:39], v[192:207]
    v_exp_f32 v246, v246
    v_exp_f32 v247, v247
    v_exp_f32 v248, v248
    v_smfmac_f32_16x16x64_bf16 v[20:23], v[28:31], v[224:231], v9
    buffer_load_dwordx4 v[124:127], v1, s[4:7], s56 offen offset:1024 sc1
    v_exp_f32 v249, v249
    v_smfmac_f32_32x32x32_bf16 v[160:175], v[76:79], v[232:239], v9
    v_exp_f32 v250, v250
    v_exp_f32 v251, v251
    v_exp_f32 v252, v252
    v_smfmac_f32_16x16x64_bf16 v[20:23], v[28:31], v[232:239], v9
    v_exp_f32 v253, v253
    v_exp_f32 v254, v254
    v_exp_f32 v255, v255
    s_add_u32 s53, s53, 131072
    s_cmp_eq_u32 s57, 0
    s_cselect_b32 s53, s53, 2146435072
    v_mfma_f32_32x32x16_bf16 v[208:223], v[80:83], v[40:43], 0
    s_add_u32 s54, s54, 8192
    s_and_b32 s54, s54, 0x1ffff
    s_add_u32 s55, s53, s54
    s_add_u32 s56, s55, 4194304
    v_exp_f32 v192, v192
    v_exp_f32 v193, v193
    v_exp_f32 v194, v194
    v_smfmac_f32_32x32x32_bf16 v[176:191], v[72:75], v[240:247], v9
    v_exp_f32 v195, v195
    v_exp_f32 v196, v196
    v_exp_f32 v197, v197
    v_mfma_f32_32x32x16_bf16 v[208:223], v[84:87], v[44:47], v[208:223]
    v_exp_f32 v198, v198
    v_exp_f32 v199, v199
    v_exp_f32 v200, v200
    v_smfmac_f32_16x16x64_bf16 v[24:27], v[28:31], v[240:247], v9
    buffer_load_dwordx4 v[64:67], v1, s[4:7], s55 offen offset:0 sc1
    v_exp_f32 v201, v201
    v_smfmac_f32_32x32x32_bf16 v[176:191], v[76:79], v[248:255], v9
    v_exp_f32 v202, v202
    v_exp_f32 v203, v203
    v_exp_f32 v204, v204
    v_smfmac_f32_16x16x64_bf16 v[24:27], v[28:31], v[248:255], v9
    v_exp_f32 v205, v205
    v_exp_f32 v206, v206
    v_exp_f32 v207, v207
    v_mfma_f32_32x32x16_bf16 v[224:239], v[80:83], v[48:51], 0
    v_exp_f32 v208, v208
    v_exp_f32 v209, v209
    v_exp_f32 v210, v210
    v_smfmac_f32_32x32x32_bf16 v[128:143], v[88:91], v[192:199], v9
    v_exp_f32 v211, v211
    v_exp_f32 v212, v212
    v_exp_f32 v213, v213
    v_mfma_f32_32x32x16_bf16 v[224:239], v[84:87], v[52:55], v[224:239]
    v_exp_f32 v214, v214
    v_exp_f32 v215, v215
    v_exp_f32 v216, v216
    v_smfmac_f32_16x16x64_bf16 v[12:15], v[28:31], v[192:199], v9
    buffer_load_dwordx4 v[68:71], v1, s[4:7], s55 offen offset:1024 sc1
    v_exp_f32 v217, v217
    v_smfmac_f32_32x32x32_bf16 v[128:143], v[92:95], v[200:207], v9
    v_exp_f32 v218, v218
    v_exp_f32 v219, v219
    v_exp_f32 v220, v220
    v_smfmac_f32_16x16x64_bf16 v[12:15], v[28:31], v[200:207], v9
    v_exp_f32 v221, v221
    v_exp_f32 v222, v222
    v_exp_f32 v223, v223
    v_mfma_f32_32x32x16_bf16 v[240:255], v[80:83], v[56:59], 0
    v_exp_f32 v224, v224
    v_exp_f32 v225, v225
    v_exp_f32 v226, v226
    v_smfmac_f32_32x32x32_bf16 v[144:159], v[88:91], v[208:215], v9
    v_exp_f32 v227, v227
    v_exp_f32 v228, v228
    v_exp_f32 v229, v229
    v_mfma_f32_32x32x16_bf16 v[240:255], v[84:87], v[60:63], v[240:255]
    v_exp_f32 v230, v230
    v_exp_f32 v231, v231
    v_exp_f32 v232, v232
    v_smfmac_f32_16x16x64_bf16 v[16:19], v[28:31], v[208:215], v9
    buffer_load_dwordx4 v[72:75], v1, s[4:7], s56 offen offset:0 sc1
    v_exp_f32 v233, v233
    v_smfmac_f32_32x32x32_bf16 v[144:159], v[92:95], v[216:223], v9
    v_exp_f32 v234, v234
    v_exp_f32 v235, v235
    v_exp_f32 v236, v236
    v_smfmac_f32_16x16x64_bf16 v[16:19], v[28:31], v[216:223], v9
    v_exp_f32 v237, v237
    v_exp_f32 v238, v238
    v_exp_f32 v239, v239
    s_waitcnt vmcnt(7)
    v_mfma_f32_32x32x16_bf16 v[192:207], v[96:99], v[32:35], 0
    v_exp_f32 v240, v240
    v_exp_f32 v241, v241
    v_exp_f32 v242, v242
    v_smfmac_f32_32x32x32_bf16 v[160:175], v[88:91], v[224:231], v9
    v_exp_f32 v243, v243
    v_exp_f32 v244, v244
    v_exp_f32 v245, v245
    v_mfma_f32_32x32x16_bf16 v[192:207], v[100:103], v[36:39], v[192:207]
    v_exp_f32 v246, v246
    v_exp_f32 v247, v247
    v_exp_f32 v248, v248
    v_smfmac_f32_16x16x64_bf16 v[20:23], v[28:31], v[224:231], v9
    buffer_load_dwordx4 v[76:79], v1, s[4:7], s56 offen offset:1024 sc1
    v_exp_f32 v249, v249
    v_smfmac_f32_32x32x32_bf16 v[160:175], v[92:95], v[232:239], v9
    v_exp_f32 v250, v250
    v_exp_f32 v251, v251
    v_exp_f32 v252, v252
    v_smfmac_f32_16x16x64_bf16 v[20:23], v[28:31], v[232:239], v9
    v_exp_f32 v253, v253
    v_exp_f32 v254, v254
    v_exp_f32 v255, v255
    v_mfma_f32_32x32x16_bf16 v[208:223], v[96:99], v[40:43], 0
    s_add_u32 s54, s54, 8192
    s_and_b32 s54, s54, 0x1ffff
    s_add_u32 s55, s53, s54
    s_add_u32 s56, s55, 4194304
    v_exp_f32 v192, v192
    v_exp_f32 v193, v193
    v_exp_f32 v194, v194
    v_smfmac_f32_32x32x32_bf16 v[176:191], v[88:91], v[240:247], v9
    v_exp_f32 v195, v195
    v_exp_f32 v196, v196
    v_exp_f32 v197, v197
    v_mfma_f32_32x32x16_bf16 v[208:223], v[100:103], v[44:47], v[208:223]
    v_exp_f32 v198, v198
    v_exp_f32 v199, v199
    v_exp_f32 v200, v200
    v_smfmac_f32_16x16x64_bf16 v[24:27], v[28:31], v[240:247], v9
    buffer_load_dwordx4 v[80:83], v1, s[4:7], s55 offen offset:0 sc1
    v_exp_f32 v201, v201
    v_smfmac_f32_32x32x32_bf16 v[176:191], v[92:95], v[248:255], v9
    v_exp_f32 v202, v202
    v_exp_f32 v203, v203
    v_exp_f32 v204, v204
    v_smfmac_f32_16x16x64_bf16 v[24:27], v[28:31], v[248:255], v9
    v_exp_f32 v205, v205
    v_exp_f32 v206, v206
    v_exp_f32 v207, v207
    v_mfma_f32_32x32x16_bf16 v[224:239], v[96:99], v[48:51], 0
    v_exp_f32 v208, v208
    v_exp_f32 v209, v209
    v_exp_f32 v210, v210
    v_smfmac_f32_32x32x32_bf16 v[128:143], v[104:107], v[192:199], v9
    v_exp_f32 v211, v211
    v_exp_f32 v212, v212
    v_exp_f32 v213, v213
    v_mfma_f32_32x32x16_bf16 v[224:239], v[100:103], v[52:55], v[224:239]
    v_exp_f32 v214, v214
    v_exp_f32 v215, v215
    v_exp_f32 v216, v216
    v_smfmac_f32_16x16x64_bf16 v[12:15], v[28:31], v[192:199], v9
    buffer_load_dwordx4 v[84:87], v1, s[4:7], s55 offen offset:1024 sc1
    v_exp_f32 v217, v217
    v_smfmac_f32_32x32x32_bf16 v[128:143], v[108:111], v[200:207], v9
    v_exp_f32 v218, v218
    v_exp_f32 v219, v219
    v_exp_f32 v220, v220
    v_smfmac_f32_16x16x64_bf16 v[12:15], v[28:31], v[200:207], v9
    v_exp_f32 v221, v221
    v_exp_f32 v222, v222
    v_exp_f32 v223, v223
    v_mfma_f32_32x32x16_bf16 v[240:255], v[96:99], v[56:59], 0
    v_exp_f32 v224, v224
    v_exp_f32 v225, v225
    v_exp_f32 v226, v226
    v_smfmac_f32_32x32x32_bf16 v[144:159], v[104:107], v[208:215], v9
    v_exp_f32 v227, v227
    v_exp_f32 v228, v228
    v_exp_f32 v229, v229
    v_mfma_f32_32x32x16_bf16 v[240:255], v[100:103], v[60:63], v[240:255]
    v_exp_f32 v230, v230
    v_exp_f32 v231, v231
    v_exp_f32 v232, v232
    v_smfmac_f32_16x16x64_bf16 v[16:19], v[28:31], v[208:215], v9
    buffer_load_dwordx4 v[88:91], v1, s[4:7], s56 offen offset:0 sc1
    v_exp_f32 v233, v233
    v_smfmac_f32_32x32x32_bf16 v[144:159], v[108:111], v[216:223], v9
    v_exp_f32 v234, v234
    v_exp_f32 v235, v235
    v_exp_f32 v236, v236
    v_smfmac_f32_16x16x64_bf16 v[16:19], v[28:31], v[216:223], v9
    v_exp_f32 v237, v237
    v_exp_f32 v238, v238
    v_exp_f32 v239, v239
    s_waitcnt vmcnt(7)
    v_mfma_f32_32x32x16_bf16 v[192:207], v[112:115], v[32:35], 0
    v_exp_f32 v240, v240
    v_exp_f32 v241, v241
    v_exp_f32 v242, v242
    v_smfmac_f32_32x32x32_bf16 v[160:175], v[104:107], v[224:231], v9
    v_exp_f32 v243, v243
    v_exp_f32 v244, v244
    v_exp_f32 v245, v245
    v_mfma_f32_32x32x16_bf16 v[192:207], v[116:119], v[36:39], v[192:207]
    v_exp_f32 v246, v246
    v_exp_f32 v247, v247
    v_exp_f32 v248, v248
    v_smfmac_f32_16x16x64_bf16 v[20:23], v[28:31], v[224:231], v9
    buffer_load_dwordx4 v[92:95], v1, s[4:7], s56 offen offset:1024 sc1
    v_exp_f32 v249, v249
    v_smfmac_f32_32x32x32_bf16 v[160:175], v[108:111], v[232:239], v9
    v_exp_f32 v250, v250
    v_exp_f32 v251, v251
    v_exp_f32 v252, v252
    v_smfmac_f32_16x16x64_bf16 v[20:23], v[28:31], v[232:239], v9
    v_exp_f32 v253, v253
    v_exp_f32 v254, v254
    v_exp_f32 v255, v255
    s_barrier
    v_mfma_f32_32x32x16_bf16 v[208:223], v[112:115], v[40:43], 0
    s_add_u32 s54, s54, 8192
    s_and_b32 s54, s54, 0x1ffff
    s_add_u32 s55, s53, s54
    s_add_u32 s56, s55, 4194304
    ds_read_b128 v[32:35], v4 offset:8192
    ds_read_b128 v[36:39], v4 offset:9216
    v_exp_f32 v192, v192
    v_exp_f32 v193, v193
    v_exp_f32 v194, v194
    v_smfmac_f32_32x32x32_bf16 v[176:191], v[104:107], v[240:247], v9
    v_exp_f32 v195, v195
    v_exp_f32 v196, v196
    v_exp_f32 v197, v197
    v_mfma_f32_32x32x16_bf16 v[208:223], v[116:119], v[44:47], v[208:223]
    v_exp_f32 v198, v198
    v_exp_f32 v199, v199
    v_exp_f32 v200, v200
    v_smfmac_f32_16x16x64_bf16 v[24:27], v[28:31], v[240:247], v9
    buffer_load_dwordx4 v[96:99], v1, s[4:7], s55 offen offset:0 sc1
    v_exp_f32 v201, v201
    v_smfmac_f32_32x32x32_bf16 v[176:191], v[108:111], v[248:255], v9
    v_exp_f32 v202, v202
    v_exp_f32 v203, v203
    v_exp_f32 v204, v204
    v_smfmac_f32_16x16x64_bf16 v[24:27], v[28:31], v[248:255], v9
    v_exp_f32 v205, v205
    v_exp_f32 v206, v206
    v_exp_f32 v207, v207
    v_mfma_f32_32x32x16_bf16 v[224:239], v[112:115], v[48:51], 0
    ds_read_b128 v[40:43], v4 offset:10240
    ds_read_b128 v[44:47], v4 offset:11264
    v_exp_f32 v208, v208
    v_exp_f32 v209, v209
    v_exp_f32 v210, v210
    v_smfmac_f32_32x32x32_bf16 v[128:143], v[120:123], v[192:199], v9
    v_exp_f32 v211, v211
    v_exp_f32 v212, v212
    v_exp_f32 v213, v213
    v_mfma_f32_32x32x16_bf16 v[224:239], v[116:119], v[52:55], v[224:239]
    v_exp_f32 v214, v214
    v_exp_f32 v215, v215
    v_exp_f32 v216, v216
    v_smfmac_f32_16x16x64_bf16 v[12:15], v[28:31], v[192:199], v9
    buffer_load_dwordx4 v[100:103], v1, s[4:7], s55 offen offset:1024 sc1
    v_exp_f32 v217, v217
    v_smfmac_f32_32x32x32_bf16 v[128:143], v[124:127], v[200:207], v9
    v_exp_f32 v218, v218
    v_exp_f32 v219, v219
    v_exp_f32 v220, v220
    v_smfmac_f32_16x16x64_bf16 v[12:15], v[28:31], v[200:207], v9
    v_exp_f32 v221, v221
    v_exp_f32 v222, v222
    v_exp_f32 v223, v223
    v_mfma_f32_32x32x16_bf16 v[240:255], v[112:115], v[56:59], 0
    ds_read_b128 v[48:51], v4 offset:12288
    ds_read_b128 v[52:55], v4 offset:13312
    v_exp_f32 v224, v224
    v_exp_f32 v225, v225
    v_exp_f32 v226, v226
    v_smfmac_f32_32x32x32_bf16 v[144:159], v[120:123], v[208:215], v9
    ds_write_b128 v5, v[128:131] offset:0
    v_exp_f32 v227, v227
    v_exp_f32 v228, v228
    v_exp_f32 v229, v229
    v_mfma_f32_32x32x16_bf16 v[240:255], v[116:119], v[60:63], v[240:255]
    ds_write_b128 v5, v[132:135] offset:1024
    v_exp_f32 v230, v230
    v_exp_f32 v231, v231
    v_exp_f32 v232, v232
    v_smfmac_f32_16x16x64_bf16 v[16:19], v[28:31], v[208:215], v9
    buffer_load_dwordx4 v[104:107], v1, s[4:7], s56 offen offset:0 sc1
    ds_write_b32 v6, v12 offset:0
    v_exp_f32 v233, v233
    v_smfmac_f32_32x32x32_bf16 v[144:159], v[124:127], v[216:223], v9
    ds_write_b128 v5, v[136:139] offset:2048
    v_exp_f32 v234, v234
    v_exp_f32 v235, v235
    v_exp_f32 v236, v236
    v_smfmac_f32_16x16x64_bf16 v[16:19], v[28:31], v[216:223], v9
    ds_write_b128 v5, v[140:143] offset:3072
    v_exp_f32 v237, v237
    v_exp_f32 v238, v238
    v_exp_f32 v239, v239
    s_waitcnt vmcnt(7)
    s_waitcnt lgkmcnt(9)
    v_mfma_f32_32x32x16_bf16 v[192:207], v[64:67], v[32:35], 0
    ds_read_b128 v[56:59], v4 offset:14336
    ds_read_b128 v[60:63], v4 offset:15360
    v_exp_f32 v240, v240
    v_exp_f32 v241, v241
    v_exp_f32 v242, v242
    v_smfmac_f32_32x32x32_bf16 v[160:175], v[120:123], v[224:231], v9
    ds_write_b128 v5, v[144:147] offset:16384
    v_exp_f32 v243, v243
    v_exp_f32 v244, v244
    v_exp_f32 v245, v245
    v_mfma_f32_32x32x16_bf16 v[192:207], v[68:71], v[36:39], v[192:207]
    ds_write_b128 v5, v[148:151] offset:17408
    v_exp_f32 v246, v246
    v_exp_f32 v247, v247
    v_exp_f32 v248, v248
    v_smfmac_f32_16x16x64_bf16 v[20:23], v[28:31], v[224:231], v9
    buffer_load_dwordx4 v[108:111], v1, s[4:7], s56 offen offset:1024 sc1
    ds_write_b32 v6, v16 offset:1024
    v_exp_f32 v249, v249
    v_smfmac_f32_32x32x32_bf16 v[160:175], v[124:127], v[232:239], v9
    ds_write_b128 v5, v[152:155] offset:18432
    v_exp_f32 v250, v250
    v_exp_f32 v251, v251
    v_exp_f32 v252, v252
    v_smfmac_f32_16x16x64_bf16 v[20:23], v[28:31], v[232:239], v9
    ds_write_b128 v5, v[156:159] offset:19456
    v_exp_f32 v253, v253
    s_waitcnt lgkmcnt(7)
    v_mfma_f32_32x32x8_bf16 v[128:143], v[10:11], v[10:11], 0
    v_mov_b32 v12, 0
    v_exp_f32 v254, v254
    v_exp_f32 v255, v255
    s_cmp_lg_u32 s57, 0
    s_cbranch_scc1 b_tail
    v_mfma_f32_32x32x16_bf16 v[208:223], v[64:67], v[40:43], 0
    s_add_u32 s54, s54, 8192
    s_and_b32 s54, s54, 0x1ffff
    s_add_u32 s55, s53, s54
    s_add_u32 s56, s55, 4194304
    v_exp_f32 v192, v192
    v_exp_f32 v193, v193
    v_exp_f32 v194, v194
    v_smfmac_f32_32x32x32_bf16 v[176:191], v[120:123], v[240:247], v9
    ds_write_b128 v5, v[160:163] offset:32768
    v_exp_f32 v195, v195
    v_exp_f32 v196, v196
    v_exp_f32 v197, v197
    v_mfma_f32_32x32x16_bf16 v[208:223], v[68:71], v[44:47], v[208:223]
    ds_write_b128 v5, v[164:167] offset:33792
    v_exp_f32 v198, v198
    v_exp_f32 v199, v199
    v_exp_f32 v200, v200
    v_smfmac_f32_16x16x64_bf16 v[24:27], v[28:31], v[240:247], v9
    buffer_load_dwordx4 v[112:115], v1, s[4:7], s55 offen offset:0 sc1
    ds_write_b32 v6, v20 offset:2048
    v_exp_f32 v201, v201
    v_smfmac_f32_32x32x32_bf16 v[176:191], v[124:127], v[248:255], v9
    ds_write_b128 v5, v[168:171] offset:34816
    v_exp_f32 v202, v202
    v_exp_f32 v203, v203
    v_exp_f32 v204, v204
    v_smfmac_f32_16x16x64_bf16 v[24:27], v[28:31], v[248:255], v9
    ds_write_b128 v5, v[172:175] offset:35840
    v_exp_f32 v205, v205
    s_waitcnt lgkmcnt(5)
    v_mfma_f32_32x32x8_bf16 v[144:159], v[10:11], v[10:11], 0
    v_mov_b32 v16, 0
    v_exp_f32 v206, v206
    v_exp_f32 v207, v207
    v_mfma_f32_32x32x16_bf16 v[224:239], v[64:67], v[48:51], 0
    v_exp_f32 v208, v208
    v_exp_f32 v209, v209
    v_exp_f32 v210, v210
    v_smfmac_f32_32x32x32_bf16 v[128:143], v[72:75], v[192:199], v9
    ds_write_b128 v5, v[176:179] offset:49152
    v_exp_f32 v211, v211
    v_exp_f32 v212, v212
    v_exp_f32 v213, v213
    v_mfma_f32_32x32x16_bf16 v[224:239], v[68:71], v[52:55], v[224:239]
    ds_write_b128 v5, v[180:183] offset:50176
    v_exp_f32 v214, v214
    v_exp_f32 v215, v215
    v_exp_f32 v216, v216
    v_smfmac_f32_16x16x64_bf16 v[12:15], v[28:31], v[192:199], v9
    buffer_load_dwordx4 v[116:119], v1, s[4:7], s55 offen offset:1024 sc1
    ds_write_b32 v6, v24 offset:3072
    v_exp_f32 v217, v217
    v_smfmac_f32_32x32x32_bf16 v[128:143], v[76:79], v[200:207], v9
    ds_write_b128 v5, v[184:187] offset:51200
    v_exp_f32 v218, v218
    v_exp_f32 v219, v219
    v_exp_f32 v220, v220
    v_smfmac_f32_16x16x64_bf16 v[12:15], v[28:31], v[200:207], v9
    ds_write_b128 v5, v[188:191] offset:52224
    v_exp_f32 v221, v221
    s_waitcnt lgkmcnt(5)
    v_mfma_f32_32x32x8_bf16 v[160:175], v[10:11], v[10:11], 0
    v_mov_b32 v20, 0
    v_exp_f32 v222, v222
    v_exp_f32 v223, v223
    s_waitcnt lgkmcnt(0)
    v_mfma_f32_32x32x8_bf16 v[176:191], v[10:11], v[10:11], 0
    v_mov_b32 v24, 0
    s_barrier
    s_mov_b32 s57, 1
    s_branch b_head
b_tail:
    v_smfmac_f32_32x32x32_bf16 v[176:191], v[120:123], v[240:247], v9
    v_smfmac_f32_32x32x32_bf16 v[176:191], v[124:127], v[248:255], v9
    s_nop 0
    ds_write_b128 v5, v[160:163] offset:32768
    ds_write_b128 v5, v[164:167] offset:33792
    v_smfmac_f32_16x16x64_bf16 v[24:27], v[28:31], v[240:247], v9
    ds_write_b128 v5, v[168:171] offset:34816
    v_smfmac_f32_16x16x64_bf16 v[24:27], v[28:31], v[248:255], v9
    ds_write_b128 v5, v[172:175] offset:35840
    ds_write_b32 v6, v20 offset:2048
    s_nop 3
    ds_write_b128 v5, v[176:179] offset:49152
    ds_write_b128 v5, v[180:183] offset:50176
    ds_write_b128 v5, v[184:187] offset:51200
    ds_write_b128 v5, v[188:191] offset:52224
    s_nop 1
    ds_write_b32 v6, v24 offset:3072
    buffer_load_dwordx4 v[224:227], v2, s[4:7], s43 offen offset:0 sc1
    buffer_load_dwordx4 v[228:231], v2, s[4:7], s43 offen offset:256 sc1
    buffer_load_dwordx4 v[232:235], v2, s[4:7], s43 offen offset:2048 sc1
    buffer_load_dwordx4 v[236:239], v2, s[4:7], s43 offen offset:2304 sc1
    s_waitcnt lgkmcnt(0)
    s_barrier
    v_xor_b32 v4, 32, v3
    v_xor_b32 v5, 64, v3
    v_xor_b32 v6, 96, v3
c_wo:
    s_xor_b32 s42, s41, 0
    buffer_load_dwordx4 v[64:67], v2, s[4:7], s42 offen offset:0 sc1
    buffer_load_dwordx4 v[68:71], v2, s[4:7], s42 offen offset:256 sc1
    s_xor_b32 s42, s41, 4096
    buffer_load_dwordx4 v[72:75], v2, s[4:7], s42 offen offset:0 sc1
    buffer_load_dwordx4 v[76:79], v2, s[4:7], s42 offen offset:256 sc1
    s_xor_b32 s42, s41, 8192
    buffer_load_dwordx4 v[80:83], v2, s[4:7], s42 offen offset:0 sc1
    buffer_load_dwordx4 v[84:87], v2, s[4:7], s42 offen offset:256 sc1
    s_xor_b32 s42, s41, 12288
    buffer_load_dwordx4 v[88:91], v2, s[4:7], s42 offen offset:0 sc1
    buffer_load_dwordx4 v[92:95], v2, s[4:7], s42 offen offset:256 sc1
    s_xor_b32 s42, s41, 16384
    buffer_load_dwordx4 v[96:99], v2, s[4:7], s42 offen offset:0 sc1
    buffer_load_dwordx4 v[100:103], v2, s[4:7], s42 offen offset:256 sc1
    ds_read_b64_tr_b16 v[32:33], v3 offset:0
    ds_read_b64_tr_b16 v[34:35], v3 offset:1024
    ds_read_b64_tr_b16 v[36:37], v4 offset:0
    ds_read_b64_tr_b16 v[38:39], v4 offset:1024
    ds_read_b64_tr_b16 v[40:41], v5 offset:0
    ds_read_b64_tr_b16 v[42:43], v5 offset:1024
    ds_read_b64_tr_b16 v[44:45], v6 offset:0
    ds_read_b64_tr_b16 v[46:47], v6 offset:1024
    ds_read_b64_tr_b16 v[48:49], v3 offset:4096
    ds_read_b64_tr_b16 v[50:51], v3 offset:5120
    ds_read_b64_tr_b16 v[52:53], v4 offset:4096
    ds_read_b64_tr_b16 v[54:55], v4 offset:5120
    ds_read_b64_tr_b16 v[56:57], v5 offset:4096
    ds_read_b64_tr_b16 v[58:59], v5 offset:5120
    v_lshrrev_b32 v12, 4, v1
    v_and_b32 v13, 1, v12
    v_lshlrev_b32 v13, 4, v13
    v_mov_b32 v14, 0x3f80
    v_lshlrev_b32 v13, v13, v14
    v_lshrrev_b32 v14, 2, v12
    v_lshrrev_b32 v15, 4, v12
    v_xor_b32 v14, v14, v15
    v_and_b32 v14, 1, v14
    v_bfe_u32 v15, v12, 3, 1
    v_bfe_u32 v16, v12, 1, 1
    v_lshl_add_u32 v15, v15, 1, v16
    v_lshrrev_b32 v16, 5, v12
    v_lshl_add_u32 v15, v16, 2, v15
    v_lshl_add_u32 v15, v14, 3, v15
    v_cmp_eq_u32 vcc, 0, v15
    s_nop 1
    v_cndmask_b32 v240, 0, v13, vcc
    v_cmp_eq_u32 vcc, 1, v15
    s_nop 1
    v_cndmask_b32 v241, 0, v13, vcc
    v_cmp_eq_u32 vcc, 2, v15
    s_nop 1
    v_cndmask_b32 v242, 0, v13, vcc
    v_cmp_eq_u32 vcc, 3, v15
    s_nop 1
    v_cndmask_b32 v243, 0, v13, vcc
    v_cmp_eq_u32 vcc, 4, v15
    s_nop 1
    v_cndmask_b32 v244, 0, v13, vcc
    v_cmp_eq_u32 vcc, 5, v15
    s_nop 1
    v_cndmask_b32 v245, 0, v13, vcc
    v_cmp_eq_u32 vcc, 6, v15
    s_nop 1
    v_cndmask_b32 v246, 0, v13, vcc
    v_cmp_eq_u32 vcc, 7, v15
    s_nop 1
    v_cndmask_b32 v247, 0, v13, vcc
    s_mov_b32 s8, s32
    s_mov_b32 s9, s33
    s_mov_b32 s10, 4194304
    s_mov_b32 s11, 0x00020000
    s_mul_i32 s49, s16, 4608
    s_add_u32 s49, s49, 131072
    v_and_b32 v13, 15, v12
    v_mul_u32_u24 v13, 144, v13
    v_lshrrev_b32 v14, 4, v12
    v_lshl_add_u32 v13, v14, 3, v13
    v_add_u32 v17, s49, v13
    v_lshrrev_b32 v14, 3, v12
    v_and_b32 v15, 7, v12
    v_mul_u32_u24 v16, 144, v14
    v_lshl_add_u32 v16, v15, 4, v16
    v_add_u32 v18, s49, v16
    v_lshlrev_b32 v19, 11, v14
    v_lshl_add_u32 v19, v15, 4, v19
    s_lshl_b32 s50, s38, 16
    s_lshl_b32 s49, s18, 7
    s_add_u32 s50, s50, s49
    s_waitcnt vmcnt(10)
    v_mfma_f32_16x16x32_bf16 v[128:131], v[240:243], v[224:227], 0
    v_mfma_f32_16x16x32_bf16 v[132:135], v[240:243], v[228:231], 0
    v_mfma_f32_16x16x32_bf16 v[136:139], v[244:247], v[224:227], 0
    v_mfma_f32_16x16x32_bf16 v[140:143], v[244:247], v[228:231], 0
    v_mfma_f32_16x16x32_bf16 v[144:147], v[240:243], v[232:235], 0
    v_mfma_f32_16x16x32_bf16 v[148:151], v[240:243], v[236:239], 0
    v_mfma_f32_16x16x32_bf16 v[152:155], v[244:247], v[232:235], 0
    v_mfma_f32_16x16x32_bf16 v[156:159], v[244:247], v[236:239], 0
    s_waitcnt vmcnt(8) lgkmcnt(10)
    v_mfma_f32_16x16x32_bf16 v[128:131], v[32:35], v[64:67], v[128:131]
    ds_read_b64_tr_b16 v[60:61], v6 offset:4096
    s_xor_b32 s42, s41, 20480
    buffer_load_dwordx4 v[104:107], v2, s[4:7], s42 offen offset:0 sc1
    v_mfma_f32_16x16x32_bf16 v[132:135], v[32:35], v[68:71], v[132:135]
    ds_read_b64_tr_b16 v[62:63], v6 offset:5120
    v_mfma_f32_16x16x32_bf16 v[136:139], v[36:39], v[64:67], v[136:139]
    ds_read_b64_tr_b16 v[32:33], v3 offset:8192
    v_mfma_f32_16x16x32_bf16 v[140:143], v[36:39], v[68:71], v[140:143]
    ds_read_b64_tr_b16 v[34:35], v3 offset:9216
    s_waitcnt lgkmcnt(10)
    v_mfma_f32_16x16x32_bf16 v[144:147], v[40:43], v[64:67], v[144:147]
    buffer_load_dwordx4 v[108:111], v2, s[4:7], s42 offen offset:256 sc1
    ds_read_b64_tr_b16 v[36:37], v4 offset:8192
    s_xor_b32 s42, s41, 24576
    v_mfma_f32_16x16x32_bf16 v[148:151], v[40:43], v[68:71], v[148:151]
    ds_read_b64_tr_b16 v[38:39], v4 offset:9216
    v_mfma_f32_16x16x32_bf16 v[152:155], v[44:47], v[64:67], v[152:155]
    ds_read_b64_tr_b16 v[40:41], v5 offset:8192
    v_mfma_f32_16x16x32_bf16 v[156:159], v[44:47], v[68:71], v[156:159]
    ds_read_b64_tr_b16 v[42:43], v5 offset:9216
    s_waitcnt vmcnt(8) lgkmcnt(10)
    v_mfma_f32_16x16x32_bf16 v[128:131], v[48:51], v[72:75], v[128:131]
    buffer_load_dwordx4 v[112:115], v2, s[4:7], s42 offen offset:0 sc1
    ds_read_b64_tr_b16 v[44:45], v6 offset:8192
    v_mfma_f32_16x16x32_bf16 v[132:135], v[48:51], v[76:79], v[132:135]
    ds_read_b64_tr_b16 v[46:47], v6 offset:9216
    v_mfma_f32_16x16x32_bf16 v[136:139], v[52:55], v[72:75], v[136:139]
    ds_read_b64_tr_b16 v[48:49], v3 offset:12288
    v_mfma_f32_16x16x32_bf16 v[140:143], v[52:55], v[76:79], v[140:143]
    ds_read_b64_tr_b16 v[50:51], v3 offset:13312
    s_waitcnt lgkmcnt(10)
    v_mfma_f32_16x16x32_bf16 v[144:147], v[56:59], v[72:75], v[144:147]
    buffer_load_dwordx4 v[116:119], v2, s[4:7], s42 offen offset:256 sc1
    ds_read_b64_tr_b16 v[52:53], v4 offset:12288
    s_xor_b32 s42, s41, 28672
    v_mfma_f32_16x16x32_bf16 v[148:151], v[56:59], v[76:79], v[148:151]
    ds_read_b64_tr_b16 v[54:55], v4 offset:13312
    v_mfma_f32_16x16x32_bf16 v[152:155], v[60:63], v[72:75], v[152:155]
    ds_read_b64_tr_b16 v[56:57], v5 offset:12288
    v_mfma_f32_16x16x32_bf16 v[156:159], v[60:63], v[76:79], v[156:159]
    ds_read_b64_tr_b16 v[58:59], v5 offset:13312
    s_waitcnt vmcnt(8) lgkmcnt(10)
    v_mfma_f32_16x16x32_bf16 v[128:131], v[32:35], v[80:83], v[128:131]
    ds_read_b64_tr_b16 v[60:61], v6 offset:12288
    buffer_load_dwordx4 v[120:123], v2, s[4:7], s42 offen offset:0 sc1
    v_mfma_f32_16x16x32_bf16 v[132:135], v[32:35], v[84:87], v[132:135]
    ds_read_b64_tr_b16 v[62:63], v6 offset:13312
    v_mfma_f32_16x16x32_bf16 v[136:139], v[36:39], v[80:83], v[136:139]
    ds_read_b64_tr_b16 v[32:33], v3 offset:16384
    v_mfma_f32_16x16x32_bf16 v[140:143], v[36:39], v[84:87], v[140:143]
    ds_read_b64_tr_b16 v[34:35], v3 offset:17408
    s_waitcnt lgkmcnt(10)
    v_mfma_f32_16x16x32_bf16 v[144:147], v[40:43], v[80:83], v[144:147]
    buffer_load_dwordx4 v[124:127], v2, s[4:7], s42 offen offset:256 sc1
    ds_read_b64_tr_b16 v[36:37], v4 offset:16384
    s_xor_b32 s42, s41, 32768
    v_mfma_f32_16x16x32_bf16 v[148:151], v[40:43], v[84:87], v[148:151]
    ds_read_b64_tr_b16 v[38:39], v4 offset:17408
    v_mfma_f32_16x16x32_bf16 v[152:155], v[44:47], v[80:83], v[152:155]
    ds_read_b64_tr_b16 v[40:41], v5 offset:16384
    v_mfma_f32_16x16x32_bf16 v[156:159], v[44:47], v[84:87], v[156:159]
    ds_read_b64_tr_b16 v[42:43], v5 offset:17408
    s_waitcnt vmcnt(8) lgkmcnt(10)
    v_mfma_f32_16x16x32_bf16 v[128:131], v[48:51], v[88:91], v[128:131]
    buffer_load_dwordx4 v[160:163], v2, s[4:7], s42 offen offset:0 sc1
    ds_read_b64_tr_b16 v[44:45], v6 offset:16384
    v_mfma_f32_16x16x32_bf16 v[132:135], v[48:51], v[92:95], v[132:135]
    ds_read_b64_tr_b16 v[46:47], v6 offset:17408
    v_mfma_f32_16x16x32_bf16 v[136:139], v[52:55], v[88:91], v[136:139]
    ds_read_b64_tr_b16 v[48:49], v3 offset:20480
    v_mfma_f32_16x16x32_bf16 v[140:143], v[52:55], v[92:95], v[140:143]
    ds_read_b64_tr_b16 v[50:51], v3 offset:21504
    s_waitcnt lgkmcnt(10)
    v_mfma_f32_16x16x32_bf16 v[144:147], v[56:59], v[88:91], v[144:147]
    buffer_load_dwordx4 v[164:167], v2, s[4:7], s42 offen offset:256 sc1
    ds_read_b64_tr_b16 v[52:53], v4 offset:20480
    s_xor_b32 s42, s41, 36864
    v_mfma_f32_16x16x32_bf16 v[148:151], v[56:59], v[92:95], v[148:151]
    ds_read_b64_tr_b16 v[54:55], v4 offset:21504
    v_mfma_f32_16x16x32_bf16 v[152:155], v[60:63], v[88:91], v[152:155]
    ds_read_b64_tr_b16 v[56:57], v5 offset:20480
    v_mfma_f32_16x16x32_bf16 v[156:159], v[60:63], v[92:95], v[156:159]
    ds_read_b64_tr_b16 v[58:59], v5 offset:21504
    s_waitcnt vmcnt(8) lgkmcnt(10)
    v_mfma_f32_16x16x32_bf16 v[128:131], v[32:35], v[96:99], v[128:131]
    ds_read_b64_tr_b16 v[60:61], v6 offset:20480
    buffer_load_dwordx4 v[168:171], v2, s[4:7], s42 offen offset:0 sc1
    v_mfma_f32_16x16x32_bf16 v[132:135], v[32:35], v[100:103], v[132:135]
    ds_read_b64_tr_b16 v[62:63], v6 offset:21504
    v_mfma_f32_16x16x32_bf16 v[136:139], v[36:39], v[96:99], v[136:139]
    ds_read_b64_tr_b16 v[32:33], v3 offset:24576
    v_mfma_f32_16x16x32_bf16 v[140:143], v[36:39], v[100:103], v[140:143]
    ds_read_b64_tr_b16 v[34:35], v3 offset:25600
    s_waitcnt lgkmcnt(10)
    v_mfma_f32_16x16x32_bf16 v[144:147], v[40:43], v[96:99], v[144:147]
    buffer_load_dwordx4 v[172:175], v2, s[4:7], s42 offen offset:256 sc1
    ds_read_b64_tr_b16 v[36:37], v4 offset:24576
    s_xor_b32 s42, s41, 40960
    v_mfma_f32_16x16x32_bf16 v[148:151], v[40:43], v[100:103], v[148:151]
    ds_read_b64_tr_b16 v[38:39], v4 offset:25600
    v_mfma_f32_16x16x32_bf16 v[152:155], v[44:47], v[96:99], v[152:155]
    ds_read_b64_tr_b16 v[40:41], v5 offset:24576
    v_mfma_f32_16x16x32_bf16 v[156:159], v[44:47], v[100:103], v[156:159]
    ds_read_b64_tr_b16 v[42:43], v5 offset:25600
    s_waitcnt vmcnt(8) lgkmcnt(10)
    v_mfma_f32_16x16x32_bf16 v[128:131], v[48:51], v[104:107], v[128:131]
    buffer_load_dwordx4 v[176:179], v2, s[4:7], s42 offen offset:0 sc1
    ds_read_b64_tr_b16 v[44:45], v6 offset:24576
    v_mfma_f32_16x16x32_bf16 v[132:135], v[48:51], v[108:111], v[132:135]
    ds_read_b64_tr_b16 v[46:47], v6 offset:25600
    v_mfma_f32_16x16x32_bf16 v[136:139], v[52:55], v[104:107], v[136:139]
    ds_read_b64_tr_b16 v[48:49], v3 offset:28672
    v_mfma_f32_16x16x32_bf16 v[140:143], v[52:55], v[108:111], v[140:143]
    ds_read_b64_tr_b16 v[50:51], v3 offset:29696
    s_waitcnt lgkmcnt(10)
    v_mfma_f32_16x16x32_bf16 v[144:147], v[56:59], v[104:107], v[144:147]
    buffer_load_dwordx4 v[180:183], v2, s[4:7], s42 offen offset:256 sc1
    ds_read_b64_tr_b16 v[52:53], v4 offset:28672
    s_xor_b32 s42, s41, 45056
    v_mfma_f32_16x16x32_bf16 v[148:151], v[56:59], v[108:111], v[148:151]
    ds_read_b64_tr_b16 v[54:55], v4 offset:29696
    v_mfma_f32_16x16x32_bf16 v[152:155], v[60:63], v[104:107], v[152:155]
    ds_read_b64_tr_b16 v[56:57], v5 offset:28672
    v_mfma_f32_16x16x32_bf16 v[156:159], v[60:63], v[108:111], v[156:159]
    ds_read_b64_tr_b16 v[58:59], v5 offset:29696
    s_waitcnt vmcnt(8) lgkmcnt(10)
    v_mfma_f32_16x16x32_bf16 v[128:131], v[32:35], v[112:115], v[128:131]
    ds_read_b64_tr_b16 v[60:61], v6 offset:28672
    buffer_load_dwordx4 v[184:187], v2, s[4:7], s42 offen offset:0 sc1
    v_mfma_f32_16x16x32_bf16 v[132:135], v[32:35], v[116:119], v[132:135]
    ds_read_b64_tr_b16 v[62:63], v6 offset:29696
    v_mfma_f32_16x16x32_bf16 v[136:139], v[36:39], v[112:115], v[136:139]
    ds_read_b64_tr_b16 v[32:33], v3 offset:32768
    v_mfma_f32_16x16x32_bf16 v[140:143], v[36:39], v[116:119], v[140:143]
    ds_read_b64_tr_b16 v[34:35], v3 offset:33792
    s_waitcnt lgkmcnt(10)
    v_mfma_f32_16x16x32_bf16 v[144:147], v[40:43], v[112:115], v[144:147]
    buffer_load_dwordx4 v[188:191], v2, s[4:7], s42 offen offset:256 sc1
    ds_read_b64_tr_b16 v[36:37], v4 offset:32768
    s_xor_b32 s42, s41, 49152
    v_mfma_f32_16x16x32_bf16 v[148:151], v[40:43], v[116:119], v[148:151]
    ds_read_b64_tr_b16 v[38:39], v4 offset:33792
    v_mfma_f32_16x16x32_bf16 v[152:155], v[44:47], v[112:115], v[152:155]
    ds_read_b64_tr_b16 v[40:41], v5 offset:32768
    v_mfma_f32_16x16x32_bf16 v[156:159], v[44:47], v[116:119], v[156:159]
    ds_read_b64_tr_b16 v[42:43], v5 offset:33792
    s_waitcnt vmcnt(8) lgkmcnt(10)
    v_mfma_f32_16x16x32_bf16 v[128:131], v[48:51], v[120:123], v[128:131]
    buffer_load_dwordx4 v[64:67], v2, s[4:7], s42 offen offset:0 sc1
    ds_read_b64_tr_b16 v[44:45], v6 offset:32768
    v_mfma_f32_16x16x32_bf16 v[132:135], v[48:51], v[124:127], v[132:135]
    ds_read_b64_tr_b16 v[46:47], v6 offset:33792
    v_mfma_f32_16x16x32_bf16 v[136:139], v[52:55], v[120:123], v[136:139]
    ds_read_b64_tr_b16 v[48:49], v3 offset:36864
    v_mfma_f32_16x16x32_bf16 v[140:143], v[52:55], v[124:127], v[140:143]
    ds_read_b64_tr_b16 v[50:51], v3 offset:37888
    s_waitcnt lgkmcnt(10)
    v_mfma_f32_16x16x32_bf16 v[144:147], v[56:59], v[120:123], v[144:147]
    buffer_load_dwordx4 v[68:71], v2, s[4:7], s42 offen offset:256 sc1
    ds_read_b64_tr_b16 v[52:53], v4 offset:36864
    s_xor_b32 s42, s41, 53248
    v_mfma_f32_16x16x32_bf16 v[148:151], v[56:59], v[124:127], v[148:151]
    ds_read_b64_tr_b16 v[54:55], v4 offset:37888
    v_mfma_f32_16x16x32_bf16 v[152:155], v[60:63], v[120:123], v[152:155]
    ds_read_b64_tr_b16 v[56:57], v5 offset:36864
    v_mfma_f32_16x16x32_bf16 v[156:159], v[60:63], v[124:127], v[156:159]
    ds_read_b64_tr_b16 v[58:59], v5 offset:37888
    s_waitcnt vmcnt(8) lgkmcnt(10)
    v_mfma_f32_16x16x32_bf16 v[128:131], v[32:35], v[160:163], v[128:131]
    ds_read_b64_tr_b16 v[60:61], v6 offset:36864
    buffer_load_dwordx4 v[72:75], v2, s[4:7], s42 offen offset:0 sc1
    v_mfma_f32_16x16x32_bf16 v[132:135], v[32:35], v[164:167], v[132:135]
    ds_read_b64_tr_b16 v[62:63], v6 offset:37888
    v_mfma_f32_16x16x32_bf16 v[136:139], v[36:39], v[160:163], v[136:139]
    ds_read_b64_tr_b16 v[32:33], v3 offset:40960
    v_mfma_f32_16x16x32_bf16 v[140:143], v[36:39], v[164:167], v[140:143]
    ds_read_b64_tr_b16 v[34:35], v3 offset:41984
    s_waitcnt lgkmcnt(10)
    v_mfma_f32_16x16x32_bf16 v[144:147], v[40:43], v[160:163], v[144:147]
    buffer_load_dwordx4 v[76:79], v2, s[4:7], s42 offen offset:256 sc1
    ds_read_b64_tr_b16 v[36:37], v4 offset:40960
    s_xor_b32 s42, s41, 57344
    v_mfma_f32_16x16x32_bf16 v[148:151], v[40:43], v[164:167], v[148:151]
    ds_read_b64_tr_b16 v[38:39], v4 offset:41984
    v_mfma_f32_16x16x32_bf16 v[152:155], v[44:47], v[160:163], v[152:155]
    ds_read_b64_tr_b16 v[40:41], v5 offset:40960
    v_mfma_f32_16x16x32_bf16 v[156:159], v[44:47], v[164:167], v[156:159]
    ds_read_b64_tr_b16 v[42:43], v5 offset:41984
    s_waitcnt vmcnt(8) lgkmcnt(10)
    v_mfma_f32_16x16x32_bf16 v[128:131], v[48:51], v[168:171], v[128:131]
    buffer_load_dwordx4 v[80:83], v2, s[4:7], s42 offen offset:0 sc1
    ds_read_b64_tr_b16 v[44:45], v6 offset:40960
    v_mfma_f32_16x16x32_bf16 v[132:135], v[48:51], v[172:175], v[132:135]
    ds_read_b64_tr_b16 v[46:47], v6 offset:41984
    v_mfma_f32_16x16x32_bf16 v[136:139], v[52:55], v[168:171], v[136:139]
    ds_read_b64_tr_b16 v[48:49], v3 offset:45056
    v_mfma_f32_16x16x32_bf16 v[140:143], v[52:55], v[172:175], v[140:143]
    ds_read_b64_tr_b16 v[50:51], v3 offset:46080
    s_waitcnt lgkmcnt(10)
    v_mfma_f32_16x16x32_bf16 v[144:147], v[56:59], v[168:171], v[144:147]
    buffer_load_dwordx4 v[84:87], v2, s[4:7], s42 offen offset:256 sc1
    ds_read_b64_tr_b16 v[52:53], v4 offset:45056
    s_xor_b32 s42, s41, 61440
    v_mfma_f32_16x16x32_bf16 v[148:151], v[56:59], v[172:175], v[148:151]
    ds_read_b64_tr_b16 v[54:55], v4 offset:46080
    v_mfma_f32_16x16x32_bf16 v[152:155], v[60:63], v[168:171], v[152:155]
    ds_read_b64_tr_b16 v[56:57], v5 offset:45056
    v_mfma_f32_16x16x32_bf16 v[156:159], v[60:63], v[172:175], v[156:159]
    ds_read_b64_tr_b16 v[58:59], v5 offset:46080
    s_waitcnt vmcnt(8) lgkmcnt(10)
    v_mfma_f32_16x16x32_bf16 v[128:131], v[32:35], v[176:179], v[128:131]
    ds_read_b64_tr_b16 v[60:61], v6 offset:45056
    buffer_load_dwordx4 v[88:91], v2, s[4:7], s42 offen offset:0 sc1
    v_mfma_f32_16x16x32_bf16 v[132:135], v[32:35], v[180:183], v[132:135]
    ds_read_b64_tr_b16 v[62:63], v6 offset:46080
    s_barrier
    v_mfma_f32_16x16x32_bf16 v[136:139], v[36:39], v[176:179], v[136:139]
    ds_read_b64_tr_b16 v[32:33], v3 offset:49152
    v_mfma_f32_16x16x32_bf16 v[140:143], v[36:39], v[180:183], v[140:143]
    ds_read_b64_tr_b16 v[34:35], v3 offset:50176
    s_waitcnt lgkmcnt(10)
    v_mfma_f32_16x16x32_bf16 v[144:147], v[40:43], v[176:179], v[144:147]
    buffer_load_dwordx4 v[92:95], v2, s[4:7], s42 offen offset:256 sc1
    ds_read_b64_tr_b16 v[36:37], v4 offset:49152
    s_xor_b32 s42, s41, 0
    v_mfma_f32_16x16x32_bf16 v[148:151], v[40:43], v[180:183], v[148:151]
    ds_read_b64_tr_b16 v[38:39], v4 offset:50176
    v_mfma_f32_16x16x32_bf16 v[152:155], v[44:47], v[176:179], v[152:155]
    ds_read_b64_tr_b16 v[40:41], v5 offset:49152
    v_mfma_f32_16x16x32_bf16 v[156:159], v[44:47], v[180:183], v[156:159]
    ds_read_b64_tr_b16 v[42:43], v5 offset:50176
    s_waitcnt vmcnt(8) lgkmcnt(10)
    v_mfma_f32_16x16x32_bf16 v[128:131], v[48:51], v[184:187], v[128:131]
    buffer_load_dwordx4 v[96:99], v2, s[4:7], s42 offen offset:2048 sc1
    ds_read_b64_tr_b16 v[44:45], v6 offset:49152
    v_mfma_f32_16x16x32_bf16 v[132:135], v[48:51], v[188:191], v[132:135]
    ds_read_b64_tr_b16 v[46:47], v6 offset:50176
    v_mfma_f32_16x16x32_bf16 v[136:139], v[52:55], v[184:187], v[136:139]
    ds_read_b64_tr_b16 v[48:49], v3 offset:53248
    v_mfma_f32_16x16x32_bf16 v[140:143], v[52:55], v[188:191], v[140:143]
    ds_read_b64_tr_b16 v[50:51], v3 offset:54272
    s_waitcnt lgkmcnt(10)
    v_mfma_f32_16x16x32_bf16 v[144:147], v[56:59], v[184:187], v[144:147]
    buffer_load_dwordx4 v[100:103], v2, s[4:7], s42 offen offset:2304 sc1
    ds_read_b64_tr_b16 v[52:53], v4 offset:53248
    s_xor_b32 s42, s41, 4096
    v_mfma_f32_16x16x32_bf16 v[148:151], v[56:59], v[188:191], v[148:151]
    ds_read_b64_tr_b16 v[54:55], v4 offset:54272
    v_mfma_f32_16x16x32_bf16 v[152:155], v[60:63], v[184:187], v[152:155]
    ds_read_b64_tr_b16 v[56:57], v5 offset:53248
    v_mfma_f32_16x16x32_bf16 v[156:159], v[60:63], v[188:191], v[156:159]
    ds_read_b64_tr_b16 v[58:59], v5 offset:54272
    s_waitcnt vmcnt(8) lgkmcnt(10)
    v_mfma_f32_16x16x32_bf16 v[128:131], v[32:35], v[64:67], v[128:131]
    ds_read_b64_tr_b16 v[60:61], v6 offset:53248
    buffer_load_dwordx4 v[104:107], v2, s[4:7], s42 offen offset:2048 sc1
    v_mfma_f32_16x16x32_bf16 v[132:135], v[32:35], v[68:71], v[132:135]
    ds_read_b64_tr_b16 v[62:63], v6 offset:54272
    v_mfma_f32_16x16x32_bf16 v[136:139], v[36:39], v[64:67], v[136:139]
    ds_read_b64_tr_b16 v[32:33], v3 offset:57344
    v_mfma_f32_16x16x32_bf16 v[140:143], v[36:39], v[68:71], v[140:143]
    ds_read_b64_tr_b16 v[34:35], v3 offset:58368
    s_waitcnt lgkmcnt(10)
    v_mfma_f32_16x16x32_bf16 v[144:147], v[40:43], v[64:67], v[144:147]
    buffer_load_dwordx4 v[108:111], v2, s[4:7], s42 offen offset:2304 sc1
    ds_read_b64_tr_b16 v[36:37], v4 offset:57344
    s_xor_b32 s42, s41, 8192
    v_mfma_f32_16x16x32_bf16 v[148:151], v[40:43], v[68:71], v[148:151]
    ds_read_b64_tr_b16 v[38:39], v4 offset:58368
    v_mfma_f32_16x16x32_bf16 v[152:155], v[44:47], v[64:67], v[152:155]
    ds_read_b64_tr_b16 v[40:41], v5 offset:57344
    v_mfma_f32_16x16x32_bf16 v[156:159], v[44:47], v[68:71], v[156:159]
    ds_read_b64_tr_b16 v[42:43], v5 offset:58368
    s_waitcnt vmcnt(8) lgkmcnt(10)
    v_mfma_f32_16x16x32_bf16 v[128:131], v[48:51], v[72:75], v[128:131]
    buffer_load_dwordx4 v[112:115], v2, s[4:7], s42 offen offset:2048 sc1
    ds_read_b64_tr_b16 v[44:45], v6 offset:57344
    v_mfma_f32_16x16x32_bf16 v[132:135], v[48:51], v[76:79], v[132:135]
    ds_read_b64_tr_b16 v[46:47], v6 offset:58368
    v_mfma_f32_16x16x32_bf16 v[136:139], v[52:55], v[72:75], v[136:139]
    ds_read_b64_tr_b16 v[48:49], v3 offset:61440
    v_mfma_f32_16x16x32_bf16 v[140:143], v[52:55], v[76:79], v[140:143]
    ds_read_b64_tr_b16 v[50:51], v3 offset:62464
    s_waitcnt lgkmcnt(10)
    v_mfma_f32_16x16x32_bf16 v[144:147], v[56:59], v[72:75], v[144:147]
    buffer_load_dwordx4 v[116:119], v2, s[4:7], s42 offen offset:2304 sc1
    ds_read_b64_tr_b16 v[52:53], v4 offset:61440
    s_xor_b32 s42, s41, 12288
    v_mfma_f32_16x16x32_bf16 v[148:151], v[56:59], v[76:79], v[148:151]
    ds_read_b64_tr_b16 v[54:55], v4 offset:62464
    v_mfma_f32_16x16x32_bf16 v[152:155], v[60:63], v[72:75], v[152:155]
    ds_read_b64_tr_b16 v[56:57], v5 offset:61440
    v_mfma_f32_16x16x32_bf16 v[156:159], v[60:63], v[76:79], v[156:159]
    ds_read_b64_tr_b16 v[58:59], v5 offset:62464
    s_waitcnt vmcnt(8) lgkmcnt(10)
    v_mfma_f32_16x16x32_bf16 v[128:131], v[32:35], v[80:83], v[128:131]
    ds_read_b64_tr_b16 v[60:61], v6 offset:61440
    buffer_load_dwordx4 v[120:123], v2, s[4:7], s42 offen offset:2048 sc1
    v_mfma_f32_16x16x32_bf16 v[132:135], v[32:35], v[84:87], v[132:135]
    ds_read_b64_tr_b16 v[62:63], v6 offset:62464
    v_xor_b32 v3, 0x10000, v3
    v_xor_b32 v4, 0x10000, v4
    v_xor_b32 v5, 0x10000, v5
    v_xor_b32 v6, 0x10000, v6
    v_mfma_f32_16x16x32_bf16 v[136:139], v[36:39], v[80:83], v[136:139]
    ds_read_b64_tr_b16 v[32:33], v3 offset:0
    v_mfma_f32_16x16x32_bf16 v[140:143], v[36:39], v[84:87], v[140:143]
    ds_read_b64_tr_b16 v[34:35], v3 offset:1024
    s_waitcnt lgkmcnt(10)
    v_mfma_f32_16x16x32_bf16 v[144:147], v[40:43], v[80:83], v[144:147]
    buffer_load_dwordx4 v[124:127], v2, s[4:7], s42 offen offset:2304 sc1
    ds_read_b64_tr_b16 v[36:37], v4 offset:0
    s_xor_b32 s42, s41, 16384
    v_mfma_f32_16x16x32_bf16 v[148:151], v[40:43], v[84:87], v[148:151]
    ds_read_b64_tr_b16 v[38:39], v4 offset:1024
    v_mfma_f32_16x16x32_bf16 v[152:155], v[44:47], v[80:83], v[152:155]
    ds_read_b64_tr_b16 v[40:41], v5 offset:0
    v_mfma_f32_16x16x32_bf16 v[156:159], v[44:47], v[84:87], v[156:159]
    ds_read_b64_tr_b16 v[42:43], v5 offset:1024
    s_waitcnt vmcnt(8) lgkmcnt(10)
    v_mfma_f32_16x16x32_bf16 v[128:131], v[48:51], v[88:91], v[128:131]
    buffer_load_dwordx4 v[160:163], v2, s[4:7], s42 offen offset:2048 sc1
    ds_read_b64_tr_b16 v[44:45], v6 offset:0
    v_mfma_f32_16x16x32_bf16 v[132:135], v[48:51], v[92:95], v[132:135]
    ds_read_b64_tr_b16 v[46:47], v6 offset:1024
    v_mfma_f32_16x16x32_bf16 v[136:139], v[52:55], v[88:91], v[136:139]
    ds_read_b64_tr_b16 v[48:49], v3 offset:4096
    v_mfma_f32_16x16x32_bf16 v[140:143], v[52:55], v[92:95], v[140:143]
    ds_read_b64_tr_b16 v[50:51], v3 offset:5120
    s_waitcnt lgkmcnt(10)
    v_mfma_f32_16x16x32_bf16 v[144:147], v[56:59], v[88:91], v[144:147]
    buffer_load_dwordx4 v[164:167], v2, s[4:7], s42 offen offset:2304 sc1
    ds_read_b64_tr_b16 v[52:53], v4 offset:4096
    s_xor_b32 s42, s41, 20480
    v_mfma_f32_16x16x32_bf16 v[148:151], v[56:59], v[92:95], v[148:151]
    ds_read_b64_tr_b16 v[54:55], v4 offset:5120
    v_mfma_f32_16x16x32_bf16 v[152:155], v[60:63], v[88:91], v[152:155]
    ds_read_b64_tr_b16 v[56:57], v5 offset:4096
    v_mfma_f32_16x16x32_bf16 v[156:159], v[60:63], v[92:95], v[156:159]
    ds_read_b64_tr_b16 v[58:59], v5 offset:5120
    s_waitcnt vmcnt(8) lgkmcnt(10)
    v_mfma_f32_16x16x32_bf16 v[128:131], v[32:35], v[96:99], v[128:131]
    ds_read_b64_tr_b16 v[60:61], v6 offset:4096
    buffer_load_dwordx4 v[168:171], v2, s[4:7], s42 offen offset:2048 sc1
    v_mfma_f32_16x16x32_bf16 v[132:135], v[32:35], v[100:103], v[132:135]
    ds_read_b64_tr_b16 v[62:63], v6 offset:5120
    v_mfma_f32_16x16x32_bf16 v[136:139], v[36:39], v[96:99], v[136:139]
    ds_read_b64_tr_b16 v[32:33], v3 offset:8192
    v_mfma_f32_16x16x32_bf16 v[140:143], v[36:39], v[100:103], v[140:143]
    ds_read_b64_tr_b16 v[34:35], v3 offset:9216
    s_waitcnt lgkmcnt(10)
    v_mfma_f32_16x16x32_bf16 v[144:147], v[40:43], v[96:99], v[144:147]
    buffer_load_dwordx4 v[172:175], v2, s[4:7], s42 offen offset:2304 sc1
    ds_read_b64_tr_b16 v[36:37], v4 offset:8192
    s_xor_b32 s42, s41, 24576
    v_mfma_f32_16x16x32_bf16 v[148:151], v[40:43], v[100:103], v[148:151]
    ds_read_b64_tr_b16 v[38:39], v4 offset:9216
    v_mfma_f32_16x16x32_bf16 v[152:155], v[44:47], v[96:99], v[152:155]
    ds_read_b64_tr_b16 v[40:41], v5 offset:8192
    v_mfma_f32_16x16x32_bf16 v[156:159], v[44:47], v[100:103], v[156:159]
    ds_read_b64_tr_b16 v[42:43], v5 offset:9216
    s_waitcnt vmcnt(8) lgkmcnt(10)
    v_mfma_f32_16x16x32_bf16 v[128:131], v[48:51], v[104:107], v[128:131]
    buffer_load_dwordx4 v[176:179], v2, s[4:7], s42 offen offset:2048 sc1
    ds_read_b64_tr_b16 v[44:45], v6 offset:8192
    v_mfma_f32_16x16x32_bf16 v[132:135], v[48:51], v[108:111], v[132:135]
    ds_read_b64_tr_b16 v[46:47], v6 offset:9216
    v_mfma_f32_16x16x32_bf16 v[136:139], v[52:55], v[104:107], v[136:139]
    ds_read_b64_tr_b16 v[48:49], v3 offset:12288
    v_mfma_f32_16x16x32_bf16 v[140:143], v[52:55], v[108:111], v[140:143]
    ds_read_b64_tr_b16 v[50:51], v3 offset:13312
    s_waitcnt lgkmcnt(10)
    v_mfma_f32_16x16x32_bf16 v[144:147], v[56:59], v[104:107], v[144:147]
    buffer_load_dwordx4 v[180:183], v2, s[4:7], s42 offen offset:2304 sc1
    ds_read_b64_tr_b16 v[52:53], v4 offset:12288
    s_xor_b32 s42, s41, 28672
    v_mfma_f32_16x16x32_bf16 v[148:151], v[56:59], v[108:111], v[148:151]
    ds_read_b64_tr_b16 v[54:55], v4 offset:13312
    v_mfma_f32_16x16x32_bf16 v[152:155], v[60:63], v[104:107], v[152:155]
    ds_read_b64_tr_b16 v[56:57], v5 offset:12288
    v_mfma_f32_16x16x32_bf16 v[156:159], v[60:63], v[108:111], v[156:159]
    ds_read_b64_tr_b16 v[58:59], v5 offset:13312
    s_waitcnt vmcnt(8) lgkmcnt(10)
    v_mfma_f32_16x16x32_bf16 v[128:131], v[32:35], v[112:115], v[128:131]
    ds_read_b64_tr_b16 v[60:61], v6 offset:12288
    buffer_load_dwordx4 v[184:187], v2, s[4:7], s42 offen offset:2048 sc1
    v_mfma_f32_16x16x32_bf16 v[132:135], v[32:35], v[116:119], v[132:135]
    ds_read_b64_tr_b16 v[62:63], v6 offset:13312
    v_mfma_f32_16x16x32_bf16 v[136:139], v[36:39], v[112:115], v[136:139]
    ds_read_b64_tr_b16 v[32:33], v3 offset:16384
    v_mfma_f32_16x16x32_bf16 v[140:143], v[36:39], v[116:119], v[140:143]
    ds_read_b64_tr_b16 v[34:35], v3 offset:17408
    s_waitcnt lgkmcnt(10)
    v_mfma_f32_16x16x32_bf16 v[144:147], v[40:43], v[112:115], v[144:147]
    buffer_load_dwordx4 v[188:191], v2, s[4:7], s42 offen offset:2304 sc1
    ds_read_b64_tr_b16 v[36:37], v4 offset:16384
    s_xor_b32 s42, s41, 32768
    v_mfma_f32_16x16x32_bf16 v[148:151], v[40:43], v[116:119], v[148:151]
    ds_read_b64_tr_b16 v[38:39], v4 offset:17408
    v_mfma_f32_16x16x32_bf16 v[152:155], v[44:47], v[112:115], v[152:155]
    ds_read_b64_tr_b16 v[40:41], v5 offset:16384
    v_mfma_f32_16x16x32_bf16 v[156:159], v[44:47], v[116:119], v[156:159]
    ds_read_b64_tr_b16 v[42:43], v5 offset:17408
    s_waitcnt vmcnt(8) lgkmcnt(10)
    v_mfma_f32_16x16x32_bf16 v[128:131], v[48:51], v[120:123], v[128:131]
    buffer_load_dwordx4 v[64:67], v2, s[4:7], s42 offen offset:2048 sc1
    ds_read_b64_tr_b16 v[44:45], v6 offset:16384
    v_mfma_f32_16x16x32_bf16 v[132:135], v[48:51], v[124:127], v[132:135]
    ds_read_b64_tr_b16 v[46:47], v6 offset:17408
    v_mfma_f32_16x16x32_bf16 v[136:139], v[52:55], v[120:123], v[136:139]
    ds_read_b64_tr_b16 v[48:49], v3 offset:20480
    v_mfma_f32_16x16x32_bf16 v[140:143], v[52:55], v[124:127], v[140:143]
    ds_read_b64_tr_b16 v[50:51], v3 offset:21504
    s_waitcnt lgkmcnt(10)
    v_mfma_f32_16x16x32_bf16 v[144:147], v[56:59], v[120:123], v[144:147]
    buffer_load_dwordx4 v[68:71], v2, s[4:7], s42 offen offset:2304 sc1
    ds_read_b64_tr_b16 v[52:53], v4 offset:20480
    s_xor_b32 s42, s41, 36864
    v_mfma_f32_16x16x32_bf16 v[148:151], v[56:59], v[124:127], v[148:151]
    ds_read_b64_tr_b16 v[54:55], v4 offset:21504
    v_mfma_f32_16x16x32_bf16 v[152:155], v[60:63], v[120:123], v[152:155]
    ds_read_b64_tr_b16 v[56:57], v5 offset:20480
    v_mfma_f32_16x16x32_bf16 v[156:159], v[60:63], v[124:127], v[156:159]
    ds_read_b64_tr_b16 v[58:59], v5 offset:21504
    s_waitcnt vmcnt(8) lgkmcnt(10)
    v_mfma_f32_16x16x32_bf16 v[128:131], v[32:35], v[160:163], v[128:131]
    ds_read_b64_tr_b16 v[60:61], v6 offset:20480
    buffer_load_dwordx4 v[72:75], v2, s[4:7], s42 offen offset:2048 sc1
    v_mfma_f32_16x16x32_bf16 v[132:135], v[32:35], v[164:167], v[132:135]
    ds_read_b64_tr_b16 v[62:63], v6 offset:21504
    v_mfma_f32_16x16x32_bf16 v[136:139], v[36:39], v[160:163], v[136:139]
    ds_read_b64_tr_b16 v[32:33], v3 offset:24576
    v_mfma_f32_16x16x32_bf16 v[140:143], v[36:39], v[164:167], v[140:143]
    ds_read_b64_tr_b16 v[34:35], v3 offset:25600
    s_waitcnt lgkmcnt(10)
    v_mfma_f32_16x16x32_bf16 v[144:147], v[40:43], v[160:163], v[144:147]
    buffer_load_dwordx4 v[76:79], v2, s[4:7], s42 offen offset:2304 sc1
    ds_read_b64_tr_b16 v[36:37], v4 offset:24576
    s_xor_b32 s42, s41, 40960
    v_mfma_f32_16x16x32_bf16 v[148:151], v[40:43], v[164:167], v[148:151]
    ds_read_b64_tr_b16 v[38:39], v4 offset:25600
    v_mfma_f32_16x16x32_bf16 v[152:155], v[44:47], v[160:163], v[152:155]
    ds_read_b64_tr_b16 v[40:41], v5 offset:24576
    v_mfma_f32_16x16x32_bf16 v[156:159], v[44:47], v[164:167], v[156:159]
    ds_read_b64_tr_b16 v[42:43], v5 offset:25600
    s_waitcnt vmcnt(8) lgkmcnt(10)
    v_mfma_f32_16x16x32_bf16 v[128:131], v[48:51], v[168:171], v[128:131]
    buffer_load_dwordx4 v[80:83], v2, s[4:7], s42 offen offset:2048 sc1
    ds_read_b64_tr_b16 v[44:45], v6 offset:24576
    v_mfma_f32_16x16x32_bf16 v[132:135], v[48:51], v[172:175], v[132:135]
    ds_read_b64_tr_b16 v[46:47], v6 offset:25600
    v_mfma_f32_16x16x32_bf16 v[136:139], v[52:55], v[168:171], v[136:139]
    ds_read_b64_tr_b16 v[48:49], v3 offset:28672
    v_mfma_f32_16x16x32_bf16 v[140:143], v[52:55], v[172:175], v[140:143]
    ds_read_b64_tr_b16 v[50:51], v3 offset:29696
    s_waitcnt lgkmcnt(10)
    v_mfma_f32_16x16x32_bf16 v[144:147], v[56:59], v[168:171], v[144:147]
    buffer_load_dwordx4 v[84:87], v2, s[4:7], s42 offen offset:2304 sc1
    ds_read_b64_tr_b16 v[52:53], v4 offset:28672
    s_xor_b32 s42, s41, 45056
    v_mfma_f32_16x16x32_bf16 v[148:151], v[56:59], v[172:175], v[148:151]
    ds_read_b64_tr_b16 v[54:55], v4 offset:29696
    v_mfma_f32_16x16x32_bf16 v[152:155], v[60:63], v[168:171], v[152:155]
    ds_read_b64_tr_b16 v[56:57], v5 offset:28672
    v_mfma_f32_16x16x32_bf16 v[156:159], v[60:63], v[172:175], v[156:159]
    ds_read_b64_tr_b16 v[58:59], v5 offset:29696
    s_waitcnt vmcnt(8) lgkmcnt(10)
    v_mfma_f32_16x16x32_bf16 v[128:131], v[32:35], v[176:179], v[128:131]
    ds_read_b64_tr_b16 v[60:61], v6 offset:28672
    buffer_load_dwordx4 v[88:91], v2, s[4:7], s42 offen offset:2048 sc1
    v_mfma_f32_16x16x32_bf16 v[132:135], v[32:35], v[180:183], v[132:135]
    ds_read_b64_tr_b16 v[62:63], v6 offset:29696
    v_mfma_f32_16x16x32_bf16 v[136:139], v[36:39], v[176:179], v[136:139]
    ds_read_b64_tr_b16 v[32:33], v3 offset:32768
    v_mfma_f32_16x16x32_bf16 v[140:143], v[36:39], v[180:183], v[140:143]
    ds_read_b64_tr_b16 v[34:35], v3 offset:33792
    s_waitcnt lgkmcnt(10)
    v_mfma_f32_16x16x32_bf16 v[144:147], v[40:43], v[176:179], v[144:147]
    buffer_load_dwordx4 v[92:95], v2, s[4:7], s42 offen offset:2304 sc1
    ds_read_b64_tr_b16 v[36:37], v4 offset:32768
    s_xor_b32 s42, s41, 49152
    v_mfma_f32_16x16x32_bf16 v[148:151], v[40:43], v[180:183], v[148:151]
    ds_read_b64_tr_b16 v[38:39], v4 offset:33792
    v_mfma_f32_16x16x32_bf16 v[152:155], v[44:47], v[176:179], v[152:155]
    ds_read_b64_tr_b16 v[40:41], v5 offset:32768
    v_mfma_f32_16x16x32_bf16 v[156:159], v[44:47], v[180:183], v[156:159]
    ds_read_b64_tr_b16 v[42:43], v5 offset:33792
    s_waitcnt vmcnt(8) lgkmcnt(10)
    v_mfma_f32_16x16x32_bf16 v[128:131], v[48:51], v[184:187], v[128:131]
    buffer_load_dwordx4 v[96:99], v2, s[4:7], s42 offen offset:2048 sc1
    ds_read_b64_tr_b16 v[44:45], v6 offset:32768
    v_mfma_f32_16x16x32_bf16 v[132:135], v[48:51], v[188:191], v[132:135]
    ds_read_b64_tr_b16 v[46:47], v6 offset:33792
    v_mfma_f32_16x16x32_bf16 v[136:139], v[52:55], v[184:187], v[136:139]
    ds_read_b64_tr_b16 v[48:49], v3 offset:36864
    v_mfma_f32_16x16x32_bf16 v[140:143], v[52:55], v[188:191], v[140:143]
    ds_read_b64_tr_b16 v[50:51], v3 offset:37888
    s_waitcnt lgkmcnt(10)
    v_mfma_f32_16x16x32_bf16 v[144:147], v[56:59], v[184:187], v[144:147]
    buffer_load_dwordx4 v[100:103], v2, s[4:7], s42 offen offset:2304 sc1
    ds_read_b64_tr_b16 v[52:53], v4 offset:36864
    s_xor_b32 s42, s41, 53248
    v_mfma_f32_16x16x32_bf16 v[148:151], v[56:59], v[188:191], v[148:151]
    ds_read_b64_tr_b16 v[54:55], v4 offset:37888
    v_mfma_f32_16x16x32_bf16 v[152:155], v[60:63], v[184:187], v[152:155]
    ds_read_b64_tr_b16 v[56:57], v5 offset:36864
    v_mfma_f32_16x16x32_bf16 v[156:159], v[60:63], v[188:191], v[156:159]
    ds_read_b64_tr_b16 v[58:59], v5 offset:37888
    s_waitcnt vmcnt(8) lgkmcnt(10)
    v_mfma_f32_16x16x32_bf16 v[128:131], v[32:35], v[64:67], v[128:131]
    ds_read_b64_tr_b16 v[60:61], v6 offset:36864
    buffer_load_dwordx4 v[104:107], v2, s[4:7], s42 offen offset:2048 sc1
    v_mfma_f32_16x16x32_bf16 v[132:135], v[32:35], v[68:71], v[132:135]
    ds_read_b64_tr_b16 v[62:63], v6 offset:37888
    v_mfma_f32_16x16x32_bf16 v[136:139], v[36:39], v[64:67], v[136:139]
    ds_read_b64_tr_b16 v[32:33], v3 offset:40960
    v_mfma_f32_16x16x32_bf16 v[140:143], v[36:39], v[68:71], v[140:143]
    ds_read_b64_tr_b16 v[34:35], v3 offset:41984
    s_waitcnt lgkmcnt(10)
    v_mfma_f32_16x16x32_bf16 v[144:147], v[40:43], v[64:67], v[144:147]
    buffer_load_dwordx4 v[108:111], v2, s[4:7], s42 offen offset:2304 sc1
    ds_read_b64_tr_b16 v[36:37], v4 offset:40960
    s_xor_b32 s42, s41, 57344
    v_mfma_f32_16x16x32_bf16 v[148:151], v[40:43], v[68:71], v[148:151]
    ds_read_b64_tr_b16 v[38:39], v4 offset:41984
    v_mfma_f32_16x16x32_bf16 v[152:155], v[44:47], v[64:67], v[152:155]
    ds_read_b64_tr_b16 v[40:41], v5 offset:40960
    v_mfma_f32_16x16x32_bf16 v[156:159], v[44:47], v[68:71], v[156:159]
    ds_read_b64_tr_b16 v[42:43], v5 offset:41984
    s_waitcnt vmcnt(8) lgkmcnt(10)
    v_mfma_f32_16x16x32_bf16 v[128:131], v[48:51], v[72:75], v[128:131]
    buffer_load_dwordx4 v[112:115], v2, s[4:7], s42 offen offset:2048 sc1
    ds_read_b64_tr_b16 v[44:45], v6 offset:40960
    v_mfma_f32_16x16x32_bf16 v[132:135], v[48:51], v[76:79], v[132:135]
    ds_read_b64_tr_b16 v[46:47], v6 offset:41984
    v_mfma_f32_16x16x32_bf16 v[136:139], v[52:55], v[72:75], v[136:139]
    ds_read_b64_tr_b16 v[48:49], v3 offset:45056
    v_mfma_f32_16x16x32_bf16 v[140:143], v[52:55], v[76:79], v[140:143]
    ds_read_b64_tr_b16 v[50:51], v3 offset:46080
    s_waitcnt lgkmcnt(10)
    v_mfma_f32_16x16x32_bf16 v[144:147], v[56:59], v[72:75], v[144:147]
    buffer_load_dwordx4 v[116:119], v2, s[4:7], s42 offen offset:2304 sc1
    ds_read_b64_tr_b16 v[52:53], v4 offset:45056
    s_xor_b32 s42, s41, 61440
    v_mfma_f32_16x16x32_bf16 v[148:151], v[56:59], v[76:79], v[148:151]
    ds_read_b64_tr_b16 v[54:55], v4 offset:46080
    v_mfma_f32_16x16x32_bf16 v[152:155], v[60:63], v[72:75], v[152:155]
    ds_read_b64_tr_b16 v[56:57], v5 offset:45056
    v_mfma_f32_16x16x32_bf16 v[156:159], v[60:63], v[76:79], v[156:159]
    ds_read_b64_tr_b16 v[58:59], v5 offset:46080
    s_waitcnt vmcnt(8) lgkmcnt(10)
    v_mfma_f32_16x16x32_bf16 v[128:131], v[32:35], v[80:83], v[128:131]
    ds_read_b64_tr_b16 v[60:61], v6 offset:45056
    buffer_load_dwordx4 v[120:123], v2, s[4:7], s42 offen offset:2048 sc1
    v_mfma_f32_16x16x32_bf16 v[132:135], v[32:35], v[84:87], v[132:135]
    ds_read_b64_tr_b16 v[62:63], v6 offset:46080
    v_mfma_f32_16x16x32_bf16 v[136:139], v[36:39], v[80:83], v[136:139]
    ds_read_b64_tr_b16 v[32:33], v3 offset:49152
    v_mfma_f32_16x16x32_bf16 v[140:143], v[36:39], v[84:87], v[140:143]
    ds_read_b64_tr_b16 v[34:35], v3 offset:50176
    s_waitcnt lgkmcnt(10)
    v_mfma_f32_16x16x32_bf16 v[144:147], v[40:43], v[80:83], v[144:147]
    buffer_load_dwordx4 v[124:127], v2, s[4:7], s42 offen offset:2304 sc1
    ds_read_b64_tr_b16 v[36:37], v4 offset:49152
    v_mfma_f32_16x16x32_bf16 v[148:151], v[40:43], v[84:87], v[148:151]
    ds_read_b64_tr_b16 v[38:39], v4 offset:50176
    v_mfma_f32_16x16x32_bf16 v[152:155], v[44:47], v[80:83], v[152:155]
    ds_read_b64_tr_b16 v[40:41], v5 offset:49152
    v_mfma_f32_16x16x32_bf16 v[156:159], v[44:47], v[84:87], v[156:159]
    ds_read_b64_tr_b16 v[42:43], v5 offset:50176
    s_waitcnt vmcnt(8) lgkmcnt(10)
    v_mfma_f32_16x16x32_bf16 v[128:131], v[48:51], v[88:91], v[128:131]
    ds_read_b64_tr_b16 v[44:45], v6 offset:49152
    v_mfma_f32_16x16x32_bf16 v[132:135], v[48:51], v[92:95], v[132:135]
    ds_read_b64_tr_b16 v[46:47], v6 offset:50176
    v_mfma_f32_16x16x32_bf16 v[136:139], v[52:55], v[88:91], v[136:139]
    ds_read_b64_tr_b16 v[48:49], v3 offset:53248
    v_mfma_f32_16x16x32_bf16 v[140:143], v[52:55], v[92:95], v[140:143]
    ds_read_b64_tr_b16 v[50:51], v3 offset:54272
    s_waitcnt lgkmcnt(10)
    v_mfma_f32_16x16x32_bf16 v[144:147], v[56:59], v[88:91], v[144:147]
    ds_read_b64_tr_b16 v[52:53], v4 offset:53248
    v_mfma_f32_16x16x32_bf16 v[148:151], v[56:59], v[92:95], v[148:151]
    ds_read_b64_tr_b16 v[54:55], v4 offset:54272
    v_mfma_f32_16x16x32_bf16 v[152:155], v[60:63], v[88:91], v[152:155]
    ds_read_b64_tr_b16 v[56:57], v5 offset:53248
    v_mfma_f32_16x16x32_bf16 v[156:159], v[60:63], v[92:95], v[156:159]
    ds_read_b64_tr_b16 v[58:59], v5 offset:54272
    s_waitcnt vmcnt(6) lgkmcnt(10)
    v_mfma_f32_16x16x32_bf16 v[128:131], v[32:35], v[96:99], v[128:131]
    ds_read_b64_tr_b16 v[60:61], v6 offset:53248
    v_mfma_f32_16x16x32_bf16 v[132:135], v[32:35], v[100:103], v[132:135]
    ds_read_b64_tr_b16 v[62:63], v6 offset:54272
    v_mfma_f32_16x16x32_bf16 v[136:139], v[36:39], v[96:99], v[136:139]
    ds_read_b64_tr_b16 v[32:33], v3 offset:57344
    v_mfma_f32_16x16x32_bf16 v[140:143], v[36:39], v[100:103], v[140:143]
    ds_read_b64_tr_b16 v[34:35], v3 offset:58368
    s_waitcnt lgkmcnt(10)
    v_mfma_f32_16x16x32_bf16 v[144:147], v[40:43], v[96:99], v[144:147]
    ds_read_b64_tr_b16 v[36:37], v4 offset:57344
    v_mfma_f32_16x16x32_bf16 v[148:151], v[40:43], v[100:103], v[148:151]
    ds_read_b64_tr_b16 v[38:39], v4 offset:58368
    v_mfma_f32_16x16x32_bf16 v[152:155], v[44:47], v[96:99], v[152:155]
    ds_read_b64_tr_b16 v[40:41], v5 offset:57344
    v_mfma_f32_16x16x32_bf16 v[156:159], v[44:47], v[100:103], v[156:159]
    ds_read_b64_tr_b16 v[42:43], v5 offset:58368
    s_waitcnt vmcnt(4) lgkmcnt(10)
    v_mfma_f32_16x16x32_bf16 v[128:131], v[48:51], v[104:107], v[128:131]
    ds_read_b64_tr_b16 v[44:45], v6 offset:57344
    v_mfma_f32_16x16x32_bf16 v[132:135], v[48:51], v[108:111], v[132:135]
    ds_read_b64_tr_b16 v[46:47], v6 offset:58368
    v_mfma_f32_16x16x32_bf16 v[136:139], v[52:55], v[104:107], v[136:139]
    ds_read_b64_tr_b16 v[48:49], v3 offset:61440
    v_mfma_f32_16x16x32_bf16 v[140:143], v[52:55], v[108:111], v[140:143]
    ds_read_b64_tr_b16 v[50:51], v3 offset:62464
    s_waitcnt lgkmcnt(10)
    v_mfma_f32_16x16x32_bf16 v[144:147], v[56:59], v[104:107], v[144:147]
    ds_read_b64_tr_b16 v[52:53], v4 offset:61440
    v_mfma_f32_16x16x32_bf16 v[148:151], v[56:59], v[108:111], v[148:151]
    ds_read_b64_tr_b16 v[54:55], v4 offset:62464
    v_mfma_f32_16x16x32_bf16 v[152:155], v[60:63], v[104:107], v[152:155]
    ds_read_b64_tr_b16 v[56:57], v5 offset:61440
    v_mfma_f32_16x16x32_bf16 v[156:159], v[60:63], v[108:111], v[156:159]
    ds_read_b64_tr_b16 v[58:59], v5 offset:62464
    s_waitcnt vmcnt(2) lgkmcnt(10)
    v_mfma_f32_16x16x32_bf16 v[128:131], v[32:35], v[112:115], v[128:131]
    ds_read_b64_tr_b16 v[60:61], v6 offset:61440
    ds_read_b64_tr_b16 v[62:63], v6 offset:62464
    v_mfma_f32_16x16x32_bf16 v[136:139], v[36:39], v[112:115], v[136:139]
    v_xor_b32 v3, 0x10000, v3
    s_waitcnt lgkmcnt(8)
    v_mfma_f32_16x16x32_bf16 v[144:147], v[40:43], v[112:115], v[144:147]
    v_xor_b32 v4, 0x10000, v4
    v_mfma_f32_16x16x32_bf16 v[152:155], v[44:47], v[112:115], v[152:155]
    v_xor_b32 v5, 0x10000, v5
    s_waitcnt vmcnt(0) lgkmcnt(4)
    v_mfma_f32_16x16x32_bf16 v[128:131], v[48:51], v[120:123], v[128:131]
    v_xor_b32 v6, 0x10000, v6
    v_mfma_f32_16x16x32_bf16 v[136:139], v[52:55], v[120:123], v[136:139]
    s_waitcnt lgkmcnt(0)
    v_mfma_f32_16x16x32_bf16 v[144:147], v[56:59], v[120:123], v[144:147]
    v_mfma_f32_16x16x32_bf16 v[152:155], v[60:63], v[120:123], v[152:155]
    s_cmp_eq_u32 s21, 3
    s_cbranch_scc1 c_final
    s_barrier
    s_add_u32 s43, s43, 4194304
    v_mfma_f32_16x16x32_bf16 v[132:135], v[32:35], v[116:119], v[132:135]
    v_mfma_f32_16x16x32_bf16 v[140:143], v[36:39], v[116:119], v[140:143]
    v_mfma_f32_16x16x32_bf16 v[148:151], v[40:43], v[116:119], v[148:151]
    v_cvt_pk_bf16_f32 v160, v128, v129
    v_cvt_pk_bf16_f32 v161, v130, v131
    v_cvt_pk_bf16_f32 v162, v136, v137
    v_mfma_f32_16x16x32_bf16 v[156:159], v[44:47], v[116:119], v[156:159]
    v_cvt_pk_bf16_f32 v163, v138, v139
    v_cvt_pk_bf16_f32 v168, v144, v145
    v_cvt_pk_bf16_f32 v169, v146, v147
    v_mfma_f32_16x16x32_bf16 v[132:135], v[48:51], v[124:127], v[132:135]
    v_cvt_pk_bf16_f32 v170, v152, v153
    v_cvt_pk_bf16_f32 v171, v154, v155
    v_permlane32_swap_b32 v160, v162
    v_mfma_f32_16x16x32_bf16 v[140:143], v[52:55], v[124:127], v[140:143]
    v_permlane32_swap_b32 v161, v163
    buffer_store_dwordx4 v[160:163], v2, s[4:7], s43 offen offset:0 sc1
    v_permlane32_swap_b32 v168, v170
    v_mfma_f32_16x16x32_bf16 v[148:151], v[56:59], v[124:127], v[148:151]
    v_permlane32_swap_b32 v169, v171
    buffer_store_dwordx4 v[168:171], v2, s[4:7], s43 offen offset:2048 sc1
    v_mfma_f32_16x16x32_bf16 v[156:159], v[60:63], v[124:127], v[156:159]
    v_cvt_pk_bf16_f32 v164, v132, v133
    v_cvt_pk_bf16_f32 v165, v134, v135
    v_cvt_pk_bf16_f32 v166, v140, v141
    v_cvt_pk_bf16_f32 v167, v142, v143
    s_nop 0
    v_cvt_pk_bf16_f32 v172, v148, v149
    v_cvt_pk_bf16_f32 v173, v150, v151
    s_nop 0
    v_cvt_pk_bf16_f32 v174, v156, v157
    v_cvt_pk_bf16_f32 v175, v158, v159
    v_permlane32_swap_b32 v164, v166
    v_permlane32_swap_b32 v165, v167
    buffer_store_dwordx4 v[164:167], v2, s[4:7], s43 offen offset:256 sc1
    v_permlane32_swap_b32 v172, v174
    v_permlane32_swap_b32 v173, v175
    buffer_store_dwordx4 v[172:175], v2, s[4:7], s43 offen offset:2304 sc1
    s_add_u32 s21, s21, 1
    v_mov_b32 v22, 0x3f803f80
    v_dot2_f32_bf16 v24, v160, v22, 0
    v_dot2_f32_bf16 v25, v160, v160, 0
    v_dot2_f32_bf16 v26, v164, v22, 0
    v_dot2_f32_bf16 v27, v164, v164, 0
    v_dot2_f32_bf16 v24, v161, v22, v24
    v_dot2_f32_bf16 v25, v161, v161, v25
    v_dot2_f32_bf16 v26, v165, v22, v26
    v_dot2_f32_bf16 v27, v165, v165, v27
    v_dot2_f32_bf16 v24, v162, v22, v24
    v_dot2_f32_bf16 v25, v162, v162, v25
    v_dot2_f32_bf16 v26, v166, v22, v26
    v_dot2_f32_bf16 v27, v166, v166, v27
    v_dot2_f32_bf16 v24, v163, v22, v24
    v_dot2_f32_bf16 v25, v163, v163, v25
    v_dot2_f32_bf16 v26, v167, v22, v26
    v_dot2_f32_bf16 v27, v167, v167, v27
    v_dot2_f32_bf16 v24, v168, v22, v24
    v_dot2_f32_bf16 v25, v168, v168, v25
    v_dot2_f32_bf16 v26, v172, v22, v26
    v_dot2_f32_bf16 v27, v172, v172, v27
    v_dot2_f32_bf16 v24, v169, v22, v24
    v_dot2_f32_bf16 v25, v169, v169, v25
    v_dot2_f32_bf16 v26, v173, v22, v26
    v_dot2_f32_bf16 v27, v173, v173, v27
    v_dot2_f32_bf16 v24, v170, v22, v24
    v_dot2_f32_bf16 v25, v170, v170, v25
    v_dot2_f32_bf16 v26, v174, v22, v26
    v_dot2_f32_bf16 v27, v174, v174, v27
    v_dot2_f32_bf16 v24, v171, v22, v24
    v_dot2_f32_bf16 v25, v171, v171, v25
    v_dot2_f32_bf16 v26, v175, v22, v26
    v_dot2_f32_bf16 v27, v175, v175, v27
    v_lshrrev_b32 v23, 1, v1
    v_and_b32 v23, 0xf8, v23
    s_nop 0
    v_permlane16_swap_b32 v24, v26
    v_permlane16_swap_b32 v25, v27
    v_pk_add_f32 v[24:25], v[24:25], v[26:27]
    v_mov_b32 v26, v24
    v_mov_b32 v27, v25
    s_nop 0
    v_permlane32_swap_b32 v24, v26
    v_permlane32_swap_b32 v25, v27
    v_pk_add_f32 v[24:25], v[24:25], v[26:27]
    s_lshl_b32 s44, s21, 18
    s_lshl_b32 s45, s38, 12
    s_add_u32 s44, s44, s45
    s_lshl_b32 s45, s18, 8
    s_add_u32 s44, s44, s45
    s_add_u32 s44, s44, 50331648
    buffer_store_dwordx2 v[24:25], v23, s[4:7], s44 offen sc1
    s_lshl_b32 s46, s21, 14
    s_lshl_b32 s67, s38, 7
    s_add_u32 s46, s46, s67
    s_add_u32 s46, s46, 4096
    s_add_u32 s47, s46, 8192
    s_lshl_b32 s48, s21, 22
    s_lshl_b32 s49, s38, 16
    s_add_u32 s41, s48, s49
    v_lshrrev_b32 v16, 4, v1
    v_and_b32 v17, 15, v16
    v_lshrrev_b32 v16, 4, v16
    s_lshl_b32 s49, s16, 7
    s_add_u32 s50, s49, 151552
    s_and_b32 s49, s21, 1
    s_lshl_b32 s49, s49, 10
    s_add_u32 s49, s49, 151552
    v_lshlrev_b32 v11, 4, v16
    v_add_u32 v13, s50, v11
    v_add_u32 v11, s49, v11
    v_lshlrev_b32 v15, 2, v17
    v_add_u32 v9, s50, v15
    v_add_u32 v15, s49, v15
    s_lshr_b32 s49, s21, 1
    s_lshl_b32 s53, s49, 23
    s_lshl_b32 s50, s18, 18
    s_add_u32 s53, s53, s50
    s_add_u32 s53, s53, 33554432
    s_lshl_b32 s54, s38, 11
    s_add_u32 s52, s53, s54
    s_lshl_b32 s59, s49, 13
    s_lshl_b32 s67, s18, 9
    s_add_u32 s59, s59, s67
    s_lshl_b32 s67, s16, 7
    s_add_u32 s59, s59, s67
    s_add_u32 s59, s59, 69632
    s_lshl_b32 s61, s49, 15
    s_lshl_b32 s67, s17, 11
    s_add_u32 s61, s61, s67
    s_lshl_b32 s67, s18, 7
    s_add_u32 s61, s61, s67
    s_add_u32 s61, s61, 151552
    s_sub_u32 s60, s61, 151552
    s_lshl_b32 s60, s60, 5
    s_add_u32 s60, s60, 54525952
    s_lshl_b32 s62, s16, 12
    s_add_u32 s62, s62, 131072
    s_mov_b32 s68, s63
    s_waitcnt vmcnt(1)
    s_atomic_add s68, s[22:23], s46 glc
    s_mov_b32 s48, 0
    s_branch c_layer
c_final:
    v_mfma_f32_16x16x32_bf16 v[132:135], v[32:35], v[116:119], v[132:135]
    v_mfma_f32_16x16x32_bf16 v[140:143], v[36:39], v[116:119], v[140:143]
    v_mfma_f32_16x16x32_bf16 v[148:151], v[40:43], v[116:119], v[148:151]
    v_cvt_pk_bf16_f32 v128, v128, v129
    v_cvt_pk_bf16_f32 v129, v130, v131
    ds_write_b64 v17, v[128:129] offset:0
    v_mfma_f32_16x16x32_bf16 v[156:159], v[44:47], v[116:119], v[156:159]
    v_cvt_pk_bf16_f32 v136, v136, v137
    v_cvt_pk_bf16_f32 v137, v138, v139
    ds_write_b64 v17, v[136:137] offset:32
    v_mfma_f32_16x16x32_bf16 v[132:135], v[48:51], v[124:127], v[132:135]
    v_cvt_pk_bf16_f32 v144, v144, v145
    v_cvt_pk_bf16_f32 v145, v146, v147
    ds_write_b64 v17, v[144:145] offset:64
    v_mfma_f32_16x16x32_bf16 v[140:143], v[52:55], v[124:127], v[140:143]
    v_cvt_pk_bf16_f32 v152, v152, v153
    v_cvt_pk_bf16_f32 v153, v154, v155
    ds_write_b64 v17, v[152:153] offset:96
    v_mfma_f32_16x16x32_bf16 v[148:151], v[56:59], v[124:127], v[148:151]
    ds_read_b128 v[160:163], v18 offset:0
    ds_read_b128 v[164:167], v18 offset:1152
    v_mfma_f32_16x16x32_bf16 v[156:159], v[60:63], v[124:127], v[156:159]
    v_cvt_pk_bf16_f32 v132, v132, v133
    v_cvt_pk_bf16_f32 v133, v134, v135
    ds_write_b64 v17, v[132:133] offset:2304
    v_cvt_pk_bf16_f32 v140, v140, v141
    v_cvt_pk_bf16_f32 v141, v142, v143
    ds_write_b64 v17, v[140:141] offset:2336
    v_cvt_pk_bf16_f32 v148, v148, v149
    v_cvt_pk_bf16_f32 v149, v150, v151
    ds_write_b64 v17, v[148:149] offset:2368
    v_cvt_pk_bf16_f32 v156, v156, v157
    v_cvt_pk_bf16_f32 v157, v158, v159
    ds_write_b64 v17, v[156:157] offset:2400
    ds_read_b128 v[168:171], v18 offset:2304
    ds_read_b128 v[172:175], v18 offset:3456
    s_waitcnt lgkmcnt(7)
    buffer_store_dwordx4 v[160:163], v19, s[8:11], s50 offen sc1
    s_add_u32 s50, s50, 16384
    s_waitcnt lgkmcnt(6)
    buffer_store_dwordx4 v[164:167], v19, s[8:11], s50 offen sc1
    s_add_u32 s50, s50, 16384
    s_waitcnt lgkmcnt(1)
    buffer_store_dwordx4 v[168:171], v19, s[8:11], s50 offen sc1
    s_add_u32 s50, s50, 16384
    s_waitcnt lgkmcnt(0)
    buffer_store_dwordx4 v[172:175], v19, s[8:11], s50 offen sc1
    s_endpgm
s_start:
    v_mov_b32 v14, 0
    v_mov_b32 v15, 0
    v_mov_b32 v20, 0
    v_mov_b32 v21, 0
    v_mov_b32 v22, 0
    s_mov_b32 s41, 0
    s_mov_b32 s42, 0
    s_mov_b32 s43, 0
    s_mov_b32 s62, 0
    s_cmp_eq_u32 s16, 4
    s_cbranch_scc1 h_start
    s_cmp_eq_u32 s16, 7
    s_cbranch_scc1 z_start
l_start:
    v_lshrrev_b32 v24, 4, v1
    v_lshrrev_b32 v25, 3, v24
    v_mul_u32_u24 v12, 6144, v25
    v_and_b32 v26, 2, v25
    v_lshrrev_b32 v25, 2, v25
    v_or_b32 v26, v26, v25
    v_bfe_u32 v25, v24, 1, 2
    v_xor_b32 v26, v26, v25
    v_lshl_add_u32 v12, v26, 5, v12
    v_and_b32 v26, 1, v24
    v_lshl_add_u32 v12, v26, 4, v12
    s_lshl_b32 s3, s18, 7
    v_add_u32 v12, s3, v12
    v_add_u32 v13, 48128, v12
    s_mul_i32 s84, s18, 393216
    s_cmp_lt_u32 s18, 4
    s_cselect_b32 s85, 4, 0
    s_mul_i32 s85, s85, 393216
    s_sub_u32 s3, s16, 5
    s_lshl_b32 s41, s3, 11
    s_mul_i32 s42, s3, 98304
    s_lshl_b32 s62, s3, 15
    v_add_u32 v14, s42, v12
    v_add_u32 v15, s42, v13
    s_bitcmp1_b32 s21, 0
    s_cselect_b32 s8, s28, s24
    s_cselect_b32 s9, s29, s25
    s_cselect_b32 s12, s30, s26
    s_cselect_b32 s13, s31, s27
    s_mov_b32 s10, 6291456
    s_mov_b32 s11, 0x00020000
    s_mov_b32 s14, 2097152
    s_mov_b32 s15, 0x00020000
    s_add_u32 m0, s41, 0
    s_add_u32 s44, s84, 2048
    buffer_load_dwordx4 v14, s[8:11], s44 offen offset:0 lds
    buffer_load_dwordx4 v15, s[8:11], s44 offen offset:1024 lds
    s_add_u32 m0, s41, 4096
    s_add_u32 s44, s84, 4096
    buffer_load_dwordx4 v14, s[8:11], s44 offen offset:0 lds
    buffer_load_dwordx4 v15, s[8:11], s44 offen offset:1024 lds
    s_add_u32 m0, s41, 8192
    s_add_u32 s44, s84, 0
    buffer_load_dwordx4 v14, s[8:11], s44 offen offset:0 lds
    buffer_load_dwordx4 v15, s[8:11], s44 offen offset:1024 lds
    s_add_u32 m0, s41, 12288
    s_add_u32 s44, s84, 198656
    buffer_load_dwordx4 v14, s[8:11], s44 offen offset:0 lds
    buffer_load_dwordx4 v15, s[8:11], s44 offen offset:1024 lds
    s_add_u32 m0, s41, 16384
    s_add_u32 s44, s84, 200704
    buffer_load_dwordx4 v14, s[8:11], s44 offen offset:0 lds
    buffer_load_dwordx4 v15, s[8:11], s44 offen offset:1024 lds
    s_add_u32 m0, s41, 20480
    s_add_u32 s44, s84, 196608
    buffer_load_dwordx4 v14, s[8:11], s44 offen offset:0 lds
    buffer_load_dwordx4 v15, s[8:11], s44 offen offset:1024 lds
    s_add_u32 m0, s41, 24576
    s_add_u32 s44, s85, 2048
    buffer_load_dwordx4 v14, s[8:11], s44 offen offset:0 lds
    buffer_load_dwordx4 v15, s[8:11], s44 offen offset:1024 lds
    s_add_u32 m0, s41, 28672
    s_add_u32 s44, s85, 4096
    buffer_load_dwordx4 v14, s[8:11], s44 offen offset:0 lds
    buffer_load_dwordx4 v15, s[8:11], s44 offen offset:1024 lds
    s_cmp_lt_u32 s18, 4
    s_cselect_b32 s86, 5, 1
    s_mul_i32 s86, s86, 393216
    s_cmp_lt_u32 s18, 4
    s_cselect_b32 s87, 6, 2
    s_mul_i32 s87, s87, 393216
    s_cmp_lt_u32 s18, 4
    s_cselect_b32 s88, 7, 3
    s_mul_i32 s88, s88, 393216
    s_cmp_lt_u32 s18, 8
    s_cselect_b32 s89, 8, 4
    s_mul_i32 s89, s89, 393216
    s_cmp_lt_u32 s18, 8
    s_cselect_b32 s90, 9, 5
    s_mul_i32 s90, s90, 393216
    s_cmp_lt_u32 s18, 8
    s_cselect_b32 s91, 10, 6
    s_mul_i32 s91, s91, 393216
    s_cmp_lt_u32 s18, 8
    s_cselect_b32 s92, 11, 7
    s_mul_i32 s92, s92, 393216
    s_cmp_lt_u32 s18, 12
    s_cselect_b32 s93, 12, 8
    s_mul_i32 s93, s93, 393216
    s_cmp_lt_u32 s18, 12
    s_cselect_b32 s94, 13, 9
    s_mul_i32 s94, s94, 393216
    s_cmp_lt_u32 s18, 12
    s_cselect_b32 s95, 14, 10
    s_mul_i32 s95, s95, 393216
    s_cmp_lt_u32 s18, 12
    s_cselect_b32 s96, 15, 11
    s_mul_i32 s96, s96, 393216
    s_xor_b32 s97, s18, 1
    s_mul_i32 s97, s97, 393216
    s_xor_b32 s98, s18, 2
    s_mul_i32 s98, s98, 393216
    s_xor_b32 s99, s18, 3
    s_mul_i32 s99, s99, 393216
    v_lshrrev_b32 v24, 4, v1
    v_lshrrev_b32 v25, 3, v24
    v_mul_u32_u24 v16, 2048, v25
    v_and_b32 v26, 2, v25
    v_lshrrev_b32 v25, 2, v25
    v_or_b32 v26, v26, v25
    v_bfe_u32 v25, v24, 1, 2
    v_xor_b32 v26, v26, v25
    v_lshl_add_u32 v16, v26, 5, v16
    v_and_b32 v26, 1, v24
    v_lshl_add_u32 v16, v26, 4, v16
    s_lshl_b32 s3, s18, 7
    v_add_u32 v16, s3, v16
    v_add_u32 v17, 15360, v16
    v_add_u32 v18, 30720, v16
    v_add_u32 v19, 46080, v16
    s_and_b32 s3, s16, 3
    s_mul_i32 s3, s3, 49152
    v_add_u32 v11, s3, v12
    s_and_b32 s3, s16, 3
    s_lshl_b32 s3, s3, 10
    v_add_u32 v9, s3, v1
    v_add_u32 v10, 0x10000, v9
    s_waitcnt vmcnt(0)
    s_barrier
    s_add_u32 m0, s41, 32768
    s_add_u32 s44, s85, 0
    buffer_load_dwordx4 v14, s[8:11], s44 offen offset:0 lds
    buffer_load_dwordx4 v15, s[8:11], s44 offen offset:1024 lds
    s_add_u32 m0, s41, 36864
    s_add_u32 s44, s85, 198656
    buffer_load_dwordx4 v14, s[8:11], s44 offen offset:0 lds
    buffer_load_dwordx4 v15, s[8:11], s44 offen offset:1024 lds
    s_add_u32 m0, s41, 40960
    s_add_u32 s44, s85, 200704
    buffer_load_dwordx4 v14, s[8:11], s44 offen offset:0 lds
    buffer_load_dwordx4 v15, s[8:11], s44 offen offset:1024 lds
    s_add_u32 m0, s41, 45056
    s_add_u32 s44, s85, 196608
    buffer_load_dwordx4 v14, s[8:11], s44 offen offset:0 lds
    buffer_load_dwordx4 v15, s[8:11], s44 offen offset:1024 lds
    s_add_u32 m0, s41, 49152
    s_add_u32 s44, s86, 2048
    buffer_load_dwordx4 v14, s[8:11], s44 offen offset:0 lds
    buffer_load_dwordx4 v15, s[8:11], s44 offen offset:1024 lds
    s_add_u32 m0, s41, 53248
    s_add_u32 s44, s86, 4096
    buffer_load_dwordx4 v14, s[8:11], s44 offen offset:0 lds
    buffer_load_dwordx4 v15, s[8:11], s44 offen offset:1024 lds
    s_add_u32 m0, s41, 57344
    s_add_u32 s44, s86, 0
    buffer_load_dwordx4 v14, s[8:11], s44 offen offset:0 lds
    buffer_load_dwordx4 v15, s[8:11], s44 offen offset:1024 lds
    s_add_u32 m0, s41, 61440
    s_add_u32 s44, s86, 198656
    buffer_load_dwordx4 v14, s[8:11], s44 offen offset:0 lds
    buffer_load_dwordx4 v15, s[8:11], s44 offen offset:1024 lds
    s_waitcnt vmcnt(0)
    s_barrier
    s_add_u32 m0, s41, 65536
    s_add_u32 s44, s86, 200704
    buffer_load_dwordx4 v14, s[8:11], s44 offen offset:0 lds
    buffer_load_dwordx4 v15, s[8:11], s44 offen offset:1024 lds
    s_add_u32 m0, s41, 69632
    s_add_u32 s44, s86, 196608
    buffer_load_dwordx4 v14, s[8:11], s44 offen offset:0 lds
    buffer_load_dwordx4 v15, s[8:11], s44 offen offset:1024 lds
    s_add_u32 m0, s41, 73728
    s_add_u32 s44, s87, 2048
    buffer_load_dwordx4 v14, s[8:11], s44 offen offset:0 lds
    buffer_load_dwordx4 v15, s[8:11], s44 offen offset:1024 lds
    s_add_u32 m0, s41, 77824
    s_add_u32 s44, s87, 4096
    buffer_load_dwordx4 v14, s[8:11], s44 offen offset:0 lds
    buffer_load_dwordx4 v15, s[8:11], s44 offen offset:1024 lds
    s_add_u32 m0, s41, 81920
    s_add_u32 s44, s87, 0
    buffer_load_dwordx4 v14, s[8:11], s44 offen offset:0 lds
    buffer_load_dwordx4 v15, s[8:11], s44 offen offset:1024 lds
    s_add_u32 m0, s41, 86016
    s_add_u32 s44, s87, 198656
    buffer_load_dwordx4 v14, s[8:11], s44 offen offset:0 lds
    buffer_load_dwordx4 v15, s[8:11], s44 offen offset:1024 lds
    s_add_u32 m0, s41, 90112
    s_add_u32 s44, s87, 200704
    buffer_load_dwordx4 v14, s[8:11], s44 offen offset:0 lds
    buffer_load_dwordx4 v15, s[8:11], s44 offen offset:1024 lds
    s_add_u32 m0, s41, 94208
    s_add_u32 s44, s87, 196608
    buffer_load_dwordx4 v14, s[8:11], s44 offen offset:0 lds
    buffer_load_dwordx4 v15, s[8:11], s44 offen offset:1024 lds
    s_add_u32 m0, s41, 98304
    s_add_u32 s44, s88, 2048
    buffer_load_dwordx4 v14, s[8:11], s44 offen offset:0 lds
    buffer_load_dwordx4 v15, s[8:11], s44 offen offset:1024 lds
    s_add_u32 m0, s41, 102400
    s_add_u32 s44, s88, 4096
    buffer_load_dwordx4 v14, s[8:11], s44 offen offset:0 lds
    buffer_load_dwordx4 v15, s[8:11], s44 offen offset:1024 lds
    s_add_u32 m0, s41, 106496
    s_add_u32 s44, s88, 0
    buffer_load_dwordx4 v14, s[8:11], s44 offen offset:0 lds
    buffer_load_dwordx4 v15, s[8:11], s44 offen offset:1024 lds
    s_add_u32 m0, s41, 110592
    s_add_u32 s44, s88, 198656
    buffer_load_dwordx4 v14, s[8:11], s44 offen offset:0 lds
    buffer_load_dwordx4 v15, s[8:11], s44 offen offset:1024 lds
    s_add_u32 m0, s41, 114688
    s_add_u32 s44, s88, 200704
    buffer_load_dwordx4 v14, s[8:11], s44 offen offset:0 lds
    buffer_load_dwordx4 v15, s[8:11], s44 offen offset:1024 lds
    s_add_u32 m0, s41, 118784
    s_add_u32 s44, s88, 196608
    buffer_load_dwordx4 v14, s[8:11], s44 offen offset:0 lds
    buffer_load_dwordx4 v15, s[8:11], s44 offen offset:1024 lds
    s_add_u32 m0, s41, 122880
    s_add_u32 s44, s89, 2048
    buffer_load_dwordx4 v14, s[8:11], s44 offen offset:0 lds
    buffer_load_dwordx4 v15, s[8:11], s44 offen offset:1024 lds
    s_add_u32 m0, s41, 126976
    s_add_u32 s44, s89, 4096
    buffer_load_dwordx4 v14, s[8:11], s44 offen offset:0 lds
    buffer_load_dwordx4 v15, s[8:11], s44 offen offset:1024 lds
    s_add_u32 m0, s41, 0
    s_add_u32 s44, s89, 0
    buffer_load_dwordx4 v14, s[8:11], s44 offen offset:0 lds
    buffer_load_dwordx4 v15, s[8:11], s44 offen offset:1024 lds
    s_add_u32 m0, s41, 4096
    s_add_u32 s44, s89, 198656
    buffer_load_dwordx4 v14, s[8:11], s44 offen offset:0 lds
    buffer_load_dwordx4 v15, s[8:11], s44 offen offset:1024 lds
    s_add_u32 m0, s41, 8192
    s_add_u32 s44, s89, 200704
    buffer_load_dwordx4 v14, s[8:11], s44 offen offset:0 lds
    buffer_load_dwordx4 v15, s[8:11], s44 offen offset:1024 lds
    s_add_u32 m0, s41, 12288
    s_add_u32 s44, s89, 196608
    buffer_load_dwordx4 v14, s[8:11], s44 offen offset:0 lds
    buffer_load_dwordx4 v15, s[8:11], s44 offen offset:1024 lds
    s_waitcnt vmcnt(24)
    s_branch l_join
l_layer:
    s_waitcnt lgkmcnt(0)
    s_barrier
    s_add_u32 m0, s41, 0
    s_add_u32 s44, s89, 0
    buffer_load_dwordx4 v14, s[8:11], s44 offen offset:0 lds
    buffer_load_dwordx4 v15, s[8:11], s44 offen offset:1024 lds
    s_add_u32 m0, s41, 4096
    s_add_u32 s44, s89, 198656
    buffer_load_dwordx4 v14, s[8:11], s44 offen offset:0 lds
    buffer_load_dwordx4 v15, s[8:11], s44 offen offset:1024 lds
    s_add_u32 m0, s41, 8192
    s_add_u32 s44, s89, 200704
    buffer_load_dwordx4 v14, s[8:11], s44 offen offset:0 lds
    buffer_load_dwordx4 v15, s[8:11], s44 offen offset:1024 lds
    s_add_u32 m0, s41, 12288
    s_add_u32 s44, s89, 196608
    buffer_load_dwordx4 v14, s[8:11], s44 offen offset:0 lds
    buffer_load_dwordx4 v15, s[8:11], s44 offen offset:1024 lds
l_join:
    s_barrier
    s_add_u32 m0, s41, 16384
    s_add_u32 s44, s90, 2048
    buffer_load_dwordx4 v14, s[8:11], s44 offen offset:0 lds
    buffer_load_dwordx4 v15, s[8:11], s44 offen offset:1024 lds
    s_add_u32 m0, s41, 20480
    s_add_u32 s44, s90, 4096
    buffer_load_dwordx4 v14, s[8:11], s44 offen offset:0 lds
    buffer_load_dwordx4 v15, s[8:11], s44 offen offset:1024 lds
    s_add_u32 m0, s41, 24576
    s_add_u32 s44, s90, 0
    buffer_load_dwordx4 v14, s[8:11], s44 offen offset:0 lds
    buffer_load_dwordx4 v15, s[8:11], s44 offen offset:1024 lds
    s_add_u32 m0, s41, 28672
    s_add_u32 s44, s90, 198656
    buffer_load_dwordx4 v14, s[8:11], s44 offen offset:0 lds
    buffer_load_dwordx4 v15, s[8:11], s44 offen offset:1024 lds
    s_add_u32 m0, s41, 32768
    s_add_u32 s44, s90, 200704
    buffer_load_dwordx4 v14, s[8:11], s44 offen offset:0 lds
    buffer_load_dwordx4 v15, s[8:11], s44 offen offset:1024 lds
    s_add_u32 m0, s41, 36864
    s_add_u32 s44, s90, 196608
    buffer_load_dwordx4 v14, s[8:11], s44 offen offset:0 lds
    buffer_load_dwordx4 v15, s[8:11], s44 offen offset:1024 lds
    s_add_u32 m0, s41, 40960
    s_add_u32 s44, s91, 2048
    buffer_load_dwordx4 v14, s[8:11], s44 offen offset:0 lds
    buffer_load_dwordx4 v15, s[8:11], s44 offen offset:1024 lds
    s_add_u32 m0, s41, 45056
    s_add_u32 s44, s91, 4096
    buffer_load_dwordx4 v14, s[8:11], s44 offen offset:0 lds
    buffer_load_dwordx4 v15, s[8:11], s44 offen offset:1024 lds
    s_waitcnt vmcnt(24)
    s_barrier
    s_add_u32 m0, s41, 49152
    s_add_u32 s44, s91, 0
    buffer_load_dwordx4 v14, s[8:11], s44 offen offset:0 lds
    buffer_load_dwordx4 v15, s[8:11], s44 offen offset:1024 lds
    s_add_u32 m0, s41, 53248
    s_add_u32 s44, s91, 198656
    buffer_load_dwordx4 v14, s[8:11], s44 offen offset:0 lds
    buffer_load_dwordx4 v15, s[8:11], s44 offen offset:1024 lds
    s_add_u32 m0, s41, 57344
    s_add_u32 s44, s91, 200704
    buffer_load_dwordx4 v14, s[8:11], s44 offen offset:0 lds
    buffer_load_dwordx4 v15, s[8:11], s44 offen offset:1024 lds
    s_add_u32 m0, s41, 61440
    s_add_u32 s44, s91, 196608
    buffer_load_dwordx4 v14, s[8:11], s44 offen offset:0 lds
    buffer_load_dwordx4 v15, s[8:11], s44 offen offset:1024 lds
    s_waitcnt vmcnt(16)
    s_barrier
    s_add_u32 m0, s41, 65536
    s_add_u32 s44, s92, 2048
    buffer_load_dwordx4 v14, s[8:11], s44 offen offset:0 lds
    buffer_load_dwordx4 v15, s[8:11], s44 offen offset:1024 lds
    s_add_u32 m0, s41, 69632
    s_add_u32 s44, s92, 4096
    buffer_load_dwordx4 v14, s[8:11], s44 offen offset:0 lds
    buffer_load_dwordx4 v15, s[8:11], s44 offen offset:1024 lds
    s_add_u32 m0, s41, 73728
    s_add_u32 s44, s92, 0
    buffer_load_dwordx4 v14, s[8:11], s44 offen offset:0 lds
    buffer_load_dwordx4 v15, s[8:11], s44 offen offset:1024 lds
    s_add_u32 m0, s41, 77824
    s_add_u32 s44, s92, 198656
    buffer_load_dwordx4 v14, s[8:11], s44 offen offset:0 lds
    buffer_load_dwordx4 v15, s[8:11], s44 offen offset:1024 lds
    s_add_u32 m0, s41, 81920
    s_add_u32 s44, s92, 200704
    buffer_load_dwordx4 v14, s[8:11], s44 offen offset:0 lds
    buffer_load_dwordx4 v15, s[8:11], s44 offen offset:1024 lds
    s_add_u32 m0, s41, 86016
    s_add_u32 s44, s92, 196608
    buffer_load_dwordx4 v14, s[8:11], s44 offen offset:0 lds
    buffer_load_dwordx4 v15, s[8:11], s44 offen offset:1024 lds
    s_add_u32 m0, s41, 90112
    s_add_u32 s44, s93, 2048
    buffer_load_dwordx4 v14, s[8:11], s44 offen offset:0 lds
    buffer_load_dwordx4 v15, s[8:11], s44 offen offset:1024 lds
    s_add_u32 m0, s41, 94208
    s_add_u32 s44, s93, 4096
    buffer_load_dwordx4 v14, s[8:11], s44 offen offset:0 lds
    buffer_load_dwordx4 v15, s[8:11], s44 offen offset:1024 lds
    s_waitcnt vmcnt(16)
    s_barrier
    s_add_u32 m0, s41, 98304
    s_add_u32 s44, s93, 0
    buffer_load_dwordx4 v14, s[8:11], s44 offen offset:0 lds
    buffer_load_dwordx4 v15, s[8:11], s44 offen offset:1024 lds
    s_add_u32 m0, s41, 102400
    s_add_u32 s44, s93, 198656
    buffer_load_dwordx4 v14, s[8:11], s44 offen offset:0 lds
    buffer_load_dwordx4 v15, s[8:11], s44 offen offset:1024 lds
    s_add_u32 m0, s41, 106496
    s_add_u32 s44, s93, 200704
    buffer_load_dwordx4 v14, s[8:11], s44 offen offset:0 lds
    buffer_load_dwordx4 v15, s[8:11], s44 offen offset:1024 lds
    s_add_u32 m0, s41, 110592
    s_add_u32 s44, s93, 196608
    buffer_load_dwordx4 v14, s[8:11], s44 offen offset:0 lds
    buffer_load_dwordx4 v15, s[8:11], s44 offen offset:1024 lds
    s_add_u32 m0, s41, 114688
    s_add_u32 s44, s94, 2048
    buffer_load_dwordx4 v14, s[8:11], s44 offen offset:0 lds
    buffer_load_dwordx4 v15, s[8:11], s44 offen offset:1024 lds
    s_add_u32 m0, s41, 118784
    s_add_u32 s44, s94, 4096
    buffer_load_dwordx4 v14, s[8:11], s44 offen offset:0 lds
    buffer_load_dwordx4 v15, s[8:11], s44 offen offset:1024 lds
    s_add_u32 m0, s41, 122880
    s_add_u32 s44, s94, 198656
    buffer_load_dwordx4 v14, s[8:11], s44 offen offset:0 lds
    buffer_load_dwordx4 v15, s[8:11], s44 offen offset:1024 lds
    s_add_u32 m0, s41, 126976
    s_add_u32 s44, s94, 200704
    buffer_load_dwordx4 v14, s[8:11], s44 offen offset:0 lds
    buffer_load_dwordx4 v15, s[8:11], s44 offen offset:1024 lds
    s_waitcnt vmcnt(16)
    s_barrier
    s_add_u32 m0, s41, 0
    s_add_u32 s44, s95, 2048
    buffer_load_dwordx4 v14, s[8:11], s44 offen offset:0 lds
    buffer_load_dwordx4 v15, s[8:11], s44 offen offset:1024 lds
    s_add_u32 m0, s41, 4096
    s_add_u32 s44, s95, 4096
    buffer_load_dwordx4 v14, s[8:11], s44 offen offset:0 lds
    buffer_load_dwordx4 v15, s[8:11], s44 offen offset:1024 lds
    s_add_u32 m0, s41, 8192
    s_add_u32 s44, s95, 198656
    buffer_load_dwordx4 v14, s[8:11], s44 offen offset:0 lds
    buffer_load_dwordx4 v15, s[8:11], s44 offen offset:1024 lds
    s_add_u32 m0, s41, 12288
    s_add_u32 s44, s95, 200704
    buffer_load_dwordx4 v14, s[8:11], s44 offen offset:0 lds
    buffer_load_dwordx4 v15, s[8:11], s44 offen offset:1024 lds
    s_add_u32 m0, s41, 16384
    s_add_u32 s44, s96, 2048
    buffer_load_dwordx4 v14, s[8:11], s44 offen offset:0 lds
    buffer_load_dwordx4 v15, s[8:11], s44 offen offset:1024 lds
    s_add_u32 m0, s41, 20480
    s_add_u32 s44, s96, 198656
    buffer_load_dwordx4 v14, s[8:11], s44 offen offset:0 lds
    buffer_load_dwordx4 v15, s[8:11], s44 offen offset:1024 lds
    s_add_u32 m0, s41, 24576
    s_add_u32 s44, s97, 2048
    buffer_load_dwordx4 v14, s[8:11], s44 offen offset:0 lds
    buffer_load_dwordx4 v15, s[8:11], s44 offen offset:1024 lds
    s_add_u32 m0, s41, 28672
    s_add_u32 s44, s97, 198656
    buffer_load_dwordx4 v14, s[8:11], s44 offen offset:0 lds
    buffer_load_dwordx4 v15, s[8:11], s44 offen offset:1024 lds
    s_waitcnt vmcnt(16)
    s_barrier
    s_add_u32 m0, s41, 32768
    s_add_u32 s44, s98, 2048
    buffer_load_dwordx4 v14, s[8:11], s44 offen offset:0 lds
    buffer_load_dwordx4 v15, s[8:11], s44 offen offset:1024 lds
    s_add_u32 m0, s41, 36864
    s_add_u32 s44, s98, 198656
    buffer_load_dwordx4 v14, s[8:11], s44 offen offset:0 lds
    buffer_load_dwordx4 v15, s[8:11], s44 offen offset:1024 lds
    s_add_u32 m0, s41, 40960
    s_add_u32 s44, s99, 2048
    buffer_load_dwordx4 v14, s[8:11], s44 offen offset:0 lds
    buffer_load_dwordx4 v15, s[8:11], s44 offen offset:1024 lds
    s_add_u32 m0, s41, 45056
    s_add_u32 s44, s99, 198656
    buffer_load_dwordx4 v14, s[8:11], s44 offen offset:0 lds
    buffer_load_dwordx4 v15, s[8:11], s44 offen offset:1024 lds
    s_add_u32 m0, s41, 49152
    s_add_u32 s44, s96, 4096
    buffer_load_dwordx4 v14, s[8:11], s44 offen offset:0 lds
    buffer_load_dwordx4 v15, s[8:11], s44 offen offset:1024 lds
    s_add_u32 m0, s41, 53248
    s_add_u32 s44, s96, 200704
    buffer_load_dwordx4 v14, s[8:11], s44 offen offset:0 lds
    buffer_load_dwordx4 v15, s[8:11], s44 offen offset:1024 lds
    s_add_u32 m0, s41, 57344
    s_add_u32 s44, s97, 4096
    buffer_load_dwordx4 v14, s[8:11], s44 offen offset:0 lds
    buffer_load_dwordx4 v15, s[8:11], s44 offen offset:1024 lds
    s_add_u32 m0, s41, 61440
    s_add_u32 s44, s97, 200704
    buffer_load_dwordx4 v14, s[8:11], s44 offen offset:0 lds
    buffer_load_dwordx4 v15, s[8:11], s44 offen offset:1024 lds
    s_waitcnt vmcnt(16)
    s_barrier
    s_add_u32 m0, s41, 65536
    s_add_u32 s44, s98, 4096
    buffer_load_dwordx4 v14, s[8:11], s44 offen offset:0 lds
    buffer_load_dwordx4 v15, s[8:11], s44 offen offset:1024 lds
    s_add_u32 m0, s41, 69632
    s_add_u32 s44, s98, 200704
    buffer_load_dwordx4 v14, s[8:11], s44 offen offset:0 lds
    buffer_load_dwordx4 v15, s[8:11], s44 offen offset:1024 lds
    s_add_u32 m0, s41, 73728
    s_add_u32 s44, s99, 4096
    buffer_load_dwordx4 v14, s[8:11], s44 offen offset:0 lds
    buffer_load_dwordx4 v15, s[8:11], s44 offen offset:1024 lds
    s_add_u32 m0, s41, 77824
    s_add_u32 s44, s99, 200704
    buffer_load_dwordx4 v14, s[8:11], s44 offen offset:0 lds
    buffer_load_dwordx4 v15, s[8:11], s44 offen offset:1024 lds
    s_add_u32 m0, s41, 81920
    s_add_u32 s44, s94, 0
    buffer_load_dwordx4 v14, s[8:11], s44 offen offset:0 lds
    buffer_load_dwordx4 v15, s[8:11], s44 offen offset:1024 lds
    s_add_u32 m0, s41, 86016
    s_add_u32 s44, s94, 196608
    buffer_load_dwordx4 v14, s[8:11], s44 offen offset:0 lds
    buffer_load_dwordx4 v15, s[8:11], s44 offen offset:1024 lds
    s_add_u32 m0, s41, 90112
    s_add_u32 s44, s95, 0
    buffer_load_dwordx4 v14, s[8:11], s44 offen offset:0 lds
    buffer_load_dwordx4 v15, s[8:11], s44 offen offset:1024 lds
    s_add_u32 m0, s41, 94208
    s_add_u32 s44, s95, 196608
    buffer_load_dwordx4 v14, s[8:11], s44 offen offset:0 lds
    buffer_load_dwordx4 v15, s[8:11], s44 offen offset:1024 lds
    s_waitcnt vmcnt(16)
    s_barrier
    s_add_u32 m0, s41, 98304
    s_add_u32 s44, s96, 0
    buffer_load_dwordx4 v14, s[8:11], s44 offen offset:0 lds
    buffer_load_dwordx4 v15, s[8:11], s44 offen offset:1024 lds
    s_add_u32 m0, s41, 102400
    s_add_u32 s44, s96, 196608
    buffer_load_dwordx4 v14, s[8:11], s44 offen offset:0 lds
    buffer_load_dwordx4 v15, s[8:11], s44 offen offset:1024 lds
    s_add_u32 m0, s41, 106496
    s_add_u32 s44, s97, 0
    buffer_load_dwordx4 v14, s[8:11], s44 offen offset:0 lds
    buffer_load_dwordx4 v15, s[8:11], s44 offen offset:1024 lds
    s_add_u32 m0, s41, 110592
    s_add_u32 s44, s97, 196608
    buffer_load_dwordx4 v14, s[8:11], s44 offen offset:0 lds
    buffer_load_dwordx4 v15, s[8:11], s44 offen offset:1024 lds
    s_add_u32 m0, s41, 114688
    s_add_u32 s44, s98, 0
    buffer_load_dwordx4 v14, s[8:11], s44 offen offset:0 lds
    buffer_load_dwordx4 v15, s[8:11], s44 offen offset:1024 lds
    s_add_u32 m0, s41, 118784
    s_add_u32 s44, s98, 196608
    buffer_load_dwordx4 v14, s[8:11], s44 offen offset:0 lds
    buffer_load_dwordx4 v15, s[8:11], s44 offen offset:1024 lds
    s_add_u32 m0, s41, 122880
    s_add_u32 s44, s99, 0
    buffer_load_dwordx4 v14, s[8:11], s44 offen offset:0 lds
    buffer_load_dwordx4 v15, s[8:11], s44 offen offset:1024 lds
    s_add_u32 m0, s41, 126976
    s_add_u32 s44, s99, 196608
    buffer_load_dwordx4 v14, s[8:11], s44 offen offset:0 lds
    buffer_load_dwordx4 v15, s[8:11], s44 offen offset:1024 lds
    s_waitcnt vmcnt(16)
    s_barrier
    v_lshrrev_b32 v28, 4, v1
    v_and_b32 v29, 7, v28
    v_lshrrev_b32 v28, 3, v28
    v_mul_u32_u24 v28, 2048, v28
    v_lshl_add_u32 v28, v29, 4, v28
    s_and_b32 s3, s18, 12
    s_or_b32 s3, s3, 3
    s_lshl_b32 s3, s3, 7
    v_add_u32 v28, s3, v28
    s_lshr_b32 s3, s2, 3
    s_lshl_b32 s3, s3, 2
    s_and_b32 s60, s16, 3
    s_add_u32 s60, s60, s3
    s_lshl_b32 s61, s60, 14
    buffer_load_dwordx4 v[144:147], v28, s[12:15], s61 offen
    s_bitcmp0_b32 s21, 0
    s_cselect_b32 s56, s28, s24
    s_cselect_b32 s57, s29, s25
    s_mov_b32 s58, 6291456
    s_mov_b32 s59, 0x00020000
    v_lshrrev_b32 v28, 4, v1
    v_and_b32 v29, 7, v28
    v_lshrrev_b32 v28, 3, v28
    v_mul_u32_u24 v28, 6144, v28
    v_lshl_add_u32 v28, v29, 4, v28
    s_and_b32 s3, s18, 12
    s_or_b32 s3, s3, 3
    s_lshl_b32 s3, s3, 7
    v_add_u32 v28, s3, v28
    s_lshr_b32 s3, s2, 3
    s_lshl_b32 s3, s3, 2
    s_and_b32 s60, s16, 3
    s_add_u32 s60, s60, s3
    s_and_b32 s3, s60, 31
    s_mul_i32 s3, s3, 49152
    s_lshr_b32 s61, s60, 5
    s_min_u32 s61, s61, 2
    s_lshl_b32 s61, s61, 11
    s_add_u32 s61, s61, s3
    s_cmp_lt_u32 s18, 4
    s_cselect_b32 s3, 1572864, 0
    s_add_u32 s61, s61, s3
    buffer_load_dwordx4 v[148:151], v28, s[56:59], s61 offen
    s_waitcnt vmcnt(2)
    s_cmp_lg_u32 s21, 2
    s_cbranch_scc1 l_pe
    s_bitcmp0_b32 s21, 0
    s_cselect_b32 s56, s28, s24
    s_cselect_b32 s57, s29, s25
    s_mov_b32 s58, 6291456
    s_mov_b32 s59, 0x00020000
    s_add_u32 s61, s84, 2048
    buffer_load_dwordx4 v[160:163], v11, s[56:59], s61 offen
    s_add_u32 s61, s84, 4096
    buffer_load_dwordx4 v[164:167], v11, s[56:59], s61 offen
    s_add_u32 s61, s84, 0
    buffer_load_dwordx4 v[168:171], v11, s[56:59], s61 offen
    s_add_u32 s61, s84, 198656
    buffer_load_dwordx4 v[172:175], v11, s[56:59], s61 offen
    s_add_u32 s61, s84, 200704
    buffer_load_dwordx4 v[176:179], v11, s[56:59], s61 offen
    s_add_u32 s61, s84, 196608
    buffer_load_dwordx4 v[180:183], v11, s[56:59], s61 offen
    s_add_u32 s61, s85, 2048
    buffer_load_dwordx4 v[184:187], v11, s[56:59], s61 offen
    s_add_u32 s61, s85, 4096
    buffer_load_dwordx4 v[188:191], v11, s[56:59], s61 offen
    s_add_u32 s61, s85, 0
    buffer_load_dwordx4 v[192:195], v11, s[56:59], s61 offen
    s_add_u32 s61, s85, 198656
    buffer_load_dwordx4 v[196:199], v11, s[56:59], s61 offen
l_pe:
    s_barrier
    s_bitcmp1_b32 s21, 0
    s_cbranch_scc1 s_B
    s_add_u32 m0, s41, 0
    s_xor_b32 s44, s62, 0
    buffer_load_dwordx4 v16, s[12:15], s44 offen offset:0 lds
    buffer_load_dwordx4 v17, s[12:15], s44 offen offset:1024 lds
    s_add_u32 m0, s41, 4096
    s_xor_b32 s44, s62, 131072
    buffer_load_dwordx4 v16, s[12:15], s44 offen offset:0 lds
    buffer_load_dwordx4 v17, s[12:15], s44 offen offset:1024 lds
    s_add_u32 m0, s41, 8192
    s_xor_b32 s44, s62, 262144
    buffer_load_dwordx4 v16, s[12:15], s44 offen offset:0 lds
    buffer_load_dwordx4 v17, s[12:15], s44 offen offset:1024 lds
    s_add_u32 m0, s41, 12288
    s_xor_b32 s44, s62, 393216
    buffer_load_dwordx4 v16, s[12:15], s44 offen offset:0 lds
    buffer_load_dwordx4 v17, s[12:15], s44 offen offset:1024 lds
    s_add_u32 m0, s41, 16384
    s_xor_b32 s44, s62, 524288
    buffer_load_dwordx4 v16, s[12:15], s44 offen offset:0 lds
    buffer_load_dwordx4 v17, s[12:15], s44 offen offset:1024 lds
    s_add_u32 m0, s41, 20480
    s_xor_b32 s44, s62, 655360
    buffer_load_dwordx4 v16, s[12:15], s44 offen offset:0 lds
    buffer_load_dwordx4 v17, s[12:15], s44 offen offset:1024 lds
    s_add_u32 m0, s41, 24576
    s_xor_b32 s44, s62, 786432
    buffer_load_dwordx4 v16, s[12:15], s44 offen offset:0 lds
    buffer_load_dwordx4 v17, s[12:15], s44 offen offset:1024 lds
    s_add_u32 m0, s41, 28672
    s_xor_b32 s44, s62, 917504
    buffer_load_dwordx4 v16, s[12:15], s44 offen offset:0 lds
    buffer_load_dwordx4 v17, s[12:15], s44 offen offset:1024 lds
    s_add_u32 m0, s41, 32768
    s_xor_b32 s44, s62, 1048576
    buffer_load_dwordx4 v16, s[12:15], s44 offen offset:0 lds
    buffer_load_dwordx4 v17, s[12:15], s44 offen offset:1024 lds
    s_add_u32 m0, s41, 36864
    s_xor_b32 s44, s62, 1179648
    buffer_load_dwordx4 v16, s[12:15], s44 offen offset:0 lds
    buffer_load_dwordx4 v17, s[12:15], s44 offen offset:1024 lds
    s_add_u32 m0, s41, 40960
    s_xor_b32 s44, s62, 1310720
    buffer_load_dwordx4 v16, s[12:15], s44 offen offset:0 lds
    buffer_load_dwordx4 v17, s[12:15], s44 offen offset:1024 lds
    s_add_u32 m0, s41, 45056
    s_xor_b32 s44, s62, 1441792
    buffer_load_dwordx4 v16, s[12:15], s44 offen offset:0 lds
    buffer_load_dwordx4 v17, s[12:15], s44 offen offset:1024 lds
    s_add_u32 m0, s41, 49152
    s_xor_b32 s44, s62, 1572864
    buffer_load_dwordx4 v16, s[12:15], s44 offen offset:0 lds
    buffer_load_dwordx4 v17, s[12:15], s44 offen offset:1024 lds
    s_add_u32 m0, s41, 53248
    s_xor_b32 s44, s62, 1703936
    buffer_load_dwordx4 v16, s[12:15], s44 offen offset:0 lds
    buffer_load_dwordx4 v17, s[12:15], s44 offen offset:1024 lds
    s_add_u32 m0, s41, 57344
    s_xor_b32 s44, s62, 1835008
    buffer_load_dwordx4 v16, s[12:15], s44 offen offset:0 lds
    buffer_load_dwordx4 v17, s[12:15], s44 offen offset:1024 lds
    s_add_u32 m0, s41, 61440
    s_xor_b32 s44, s62, 1966080
    buffer_load_dwordx4 v16, s[12:15], s44 offen offset:0 lds
    buffer_load_dwordx4 v17, s[12:15], s44 offen offset:1024 lds
    s_branch s_tail
h_start:
    v_mov_b32 v20, 0
    v_mov_b32 v21, 0
    v_mov_b32 v22, 0
    v_mov_b32 v23, 0
    s_cmp_lt_u32 s2, 10
    s_cbranch_scc0 h_z0
    s_load_dword s101, s[34:35], 192
    s_lshl_b32 s44, s2, 11
    s_mov_b32 s45, 0
    s_mov_b32 s46, 0
    s_mov_b32 s47, 0
    s_mov_b32 s48, 0
    s_mov_b32 s49, 0
    s_mov_b32 s50, 0
    s_mov_b32 s51, 0
    s_mov_b32 s52, 0
    s_mov_b32 s53, 0
    s_mov_b32 s54, 0
    s_mov_b32 s55, 0
    s_mov_b32 s56, 0
    s_mov_b32 s57, 0
    s_mov_b32 s58, 0
    s_mov_b32 s59, 0
    s_mov_b32 s60, 0
    s_atomic_swap s45, s[22:23], s44 offset:0 glc
    s_atomic_swap s46, s[22:23], s44 offset:128 glc
    s_atomic_swap s47, s[22:23], s44 offset:256 glc
    s_atomic_swap s48, s[22:23], s44 offset:384 glc
    s_atomic_swap s49, s[22:23], s44 offset:512 glc
    s_atomic_swap s50, s[22:23], s44 offset:640 glc
    s_atomic_swap s51, s[22:23], s44 offset:768 glc
    s_atomic_swap s52, s[22:23], s44 offset:896 glc
    s_atomic_swap s53, s[22:23], s44 offset:1024 glc
    s_atomic_swap s54, s[22:23], s44 offset:1152 glc
    s_atomic_swap s55, s[22:23], s44 offset:1280 glc
    s_atomic_swap s56, s[22:23], s44 offset:1408 glc
    s_atomic_swap s57, s[22:23], s44 offset:1536 glc
    s_atomic_swap s58, s[22:23], s44 offset:1664 glc
    s_atomic_swap s59, s[22:23], s44 offset:1792 glc
    s_atomic_swap s60, s[22:23], s44 offset:1920 glc
    s_waitcnt lgkmcnt(0)
    s_atomic_add s40, s[34:35], 0
h_z0:
    v_lshrrev_b32 v24, 4, v1
    v_lshrrev_b32 v25, 3, v24
    v_mul_u32_u24 v12, 6144, v25
    v_and_b32 v26, 2, v25
    v_lshrrev_b32 v25, 2, v25
    v_or_b32 v26, v26, v25
    v_bfe_u32 v25, v24, 1, 2
    v_xor_b32 v26, v26, v25
    v_lshl_add_u32 v12, v26, 5, v12
    v_and_b32 v26, 1, v24
    v_lshl_add_u32 v12, v26, 4, v12
    s_lshl_b32 s3, s18, 7
    v_add_u32 v12, s3, v12
    v_add_u32 v13, 48128, v12
    s_mul_i32 s84, s18, 393216
    s_cmp_lt_u32 s18, 4
    s_cselect_b32 s85, 4, 0
    s_mul_i32 s85, s85, 393216
    s_cmp_lt_u32 s18, 4
    s_cselect_b32 s86, 5, 1
    s_mul_i32 s86, s86, 393216
    s_cmp_lt_u32 s18, 4
    s_cselect_b32 s87, 6, 2
    s_mul_i32 s87, s87, 393216
    s_cmp_lt_u32 s18, 4
    s_cselect_b32 s88, 7, 3
    s_mul_i32 s88, s88, 393216
    s_cmp_lt_u32 s18, 8
    s_cselect_b32 s89, 8, 4
    s_mul_i32 s89, s89, 393216
    s_cmp_lt_u32 s18, 8
    s_cselect_b32 s90, 9, 5
    s_mul_i32 s90, s90, 393216
    s_cmp_lt_u32 s18, 8
    s_cselect_b32 s91, 10, 6
    s_mul_i32 s91, s91, 393216
    s_cmp_lt_u32 s18, 8
    s_cselect_b32 s92, 11, 7
    s_mul_i32 s92, s92, 393216
    s_cmp_lt_u32 s18, 12
    s_cselect_b32 s93, 12, 8
    s_mul_i32 s93, s93, 393216
    s_cmp_lt_u32 s18, 12
    s_cselect_b32 s94, 13, 9
    s_mul_i32 s94, s94, 393216
    s_cmp_lt_u32 s18, 12
    s_cselect_b32 s95, 14, 10
    s_mul_i32 s95, s95, 393216
    s_cmp_lt_u32 s18, 12
    s_cselect_b32 s96, 15, 11
    s_mul_i32 s96, s96, 393216
    s_xor_b32 s97, s18, 1
    s_mul_i32 s97, s97, 393216
    s_xor_b32 s98, s18, 2
    s_mul_i32 s98, s98, 393216
    s_xor_b32 s99, s18, 3
    s_mul_i32 s99, s99, 393216
    v_lshrrev_b32 v24, 4, v1
    v_lshrrev_b32 v25, 3, v24
    v_mul_u32_u24 v16, 2048, v25
    v_and_b32 v26, 2, v25
    v_lshrrev_b32 v25, 2, v25
    v_or_b32 v26, v26, v25
    v_bfe_u32 v25, v24, 1, 2
    v_xor_b32 v26, v26, v25
    v_lshl_add_u32 v16, v26, 5, v16
    v_and_b32 v26, 1, v24
    v_lshl_add_u32 v16, v26, 4, v16
    s_lshl_b32 s3, s18, 7
    v_add_u32 v16, s3, v16
    v_add_u32 v17, 15360, v16
    v_add_u32 v18, 30720, v16
    v_add_u32 v19, 46080, v16
    s_and_b32 s3, s16, 3
    s_mul_i32 s3, s3, 49152
    v_add_u32 v11, s3, v12
    s_and_b32 s3, s16, 3
    s_lshl_b32 s3, s3, 10
    v_add_u32 v9, s3, v1
    v_add_u32 v10, 0x10000, v9
    v_lshrrev_b32 v24, 4, v1
    v_and_b32 v25, 15, v24
    v_lshrrev_b32 v24, 4, v24
    v_lshlrev_b32 v24, 2, v24
    v_sub_u32 v24, v25, v24
    v_mov_b32 v25, 0xf149f2ca
    v_add_u32 v26, 0x0, v24
    v_and_b32 v26, 0xfffffff1, v26
    v_cmp_eq_u32 vcc, 0, v26
    s_nop 1
    v_cndmask_b32 v32, v25, 0, vcc
    v_add_u32 v26, 0xffffffff, v24
    v_and_b32 v26, 0xfffffff1, v26
    v_cmp_eq_u32 vcc, 0, v26
    s_nop 1
    v_cndmask_b32 v33, v25, 0, vcc
    v_add_u32 v26, 0xfffffffe, v24
    v_and_b32 v26, 0xfffffff1, v26
    v_cmp_eq_u32 vcc, 0, v26
    s_nop 1
    v_cndmask_b32 v34, v25, 0, vcc
    v_add_u32 v26, 0xfffffffd, v24
    v_and_b32 v26, 0xfffffff1, v26
    v_cmp_eq_u32 vcc, 0, v26
    s_nop 1
    v_cndmask_b32 v35, v25, 0, vcc
    v_add_u32 v26, 0x10, v24
    v_and_b32 v26, 0xfffffff1, v26
    v_cmp_eq_u32 vcc, 0, v26
    s_nop 1
    v_cndmask_b32 v36, v25, 0, vcc
    v_add_u32 v26, 0xf, v24
    v_and_b32 v26, 0xfffffff1, v26
    v_cmp_eq_u32 vcc, 0, v26
    s_nop 1
    v_cndmask_b32 v37, v25, 0, vcc
    v_add_u32 v26, 0xe, v24
    v_and_b32 v26, 0xfffffff1, v26
    v_cmp_eq_u32 vcc, 0, v26
    s_nop 1
    v_cndmask_b32 v38, v25, 0, vcc
    v_add_u32 v26, 0xd, v24
    v_and_b32 v26, 0xfffffff1, v26
    v_cmp_eq_u32 vcc, 0, v26
    s_nop 1
    v_cndmask_b32 v39, v25, 0, vcc
    v_add_u32 v24, 153600, v1
    ds_write_b128 v24, v[32:35] offset:0
    ds_write_b128 v24, v[36:39] offset:1024
    s_waitcnt lgkmcnt(0)
    s_lshl_b32 s44, s21, 14
    s_lshl_b32 s67, s17, 9
    s_add_u32 s44, s44, s67
    s_add_u32 s44, s44, 4096
    s_barrier
    s_barrier
    s_mov_b32 s66, 0x10000
h_s0_poll:
    s_mov_b32 s68, 0
    s_mov_b32 s69, 0
    s_mov_b32 s70, 0
    s_mov_b32 s71, 0
    s_atomic_add s68, s[22:23], s44 offset:0 glc
    s_atomic_add s69, s[22:23], s44 offset:128 glc
    s_atomic_add s70, s[22:23], s44 offset:256 glc
    s_atomic_add s71, s[22:23], s44 offset:384 glc
    s_sub_u32 s66, s66, 1
    s_cselect_b32 s67, 67372036, 0
    s_waitcnt lgkmcnt(0)
    s_and_b32 s68, s68, s69
    s_and_b32 s68, s68, s70
    s_and_b32 s68, s68, s71
    s_max_u32 s68, s68, s67
    s_cmp_lt_u32 s68, 67372036
    s_cbranch_scc1 h_s0_poll
h_s0_ok:
    s_lshr_b32 s3, s2, 3
    s_cmp_eq_u32 s3, 2
    s_cbranch_scc0 h_g4
    s_barrier
    s_mul_i32 s44, s2, 24576
    s_add_u32 s44, s44, 58347520
    s_mov_b32 s45, 24
h_zloop:
    buffer_store_dwordx4 v[20:23], v1, s[4:7], s44 offen sc1
    s_add_u32 s44, s44, 1024
    s_sub_u32 s45, s45, 1
    s_cmp_lg_u32 s45, 0
    s_cbranch_scc1 h_zloop
    s_branch h_g4b
h_layer:
    s_waitcnt lgkmcnt(0)
    s_barrier
h_g4:
    s_barrier
h_g4b:
    s_lshl_b32 s44, s21, 14
    s_lshl_b32 s67, s17, 9
    s_add_u32 s44, s44, s67
    s_add_u32 s44, s44, 12288
    s_mov_b32 s66, 0x10000
h_s_poll:
    s_mov_b32 s68, 0
    s_mov_b32 s69, 0
    s_mov_b32 s70, 0
    s_mov_b32 s71, 0
    s_atomic_add s68, s[22:23], s44 offset:0 glc
    s_atomic_add s69, s[22:23], s44 offset:128 glc
    s_atomic_add s70, s[22:23], s44 offset:256 glc
    s_atomic_add s71, s[22:23], s44 offset:384 glc
    s_sub_u32 s66, s66, 1
    s_cselect_b32 s67, 16, 0
    s_waitcnt lgkmcnt(0)
    s_and_b32 s68, s68, s69
    s_and_b32 s68, s68, s70
    s_and_b32 s68, s68, s71
    s_max_u32 s68, s68, s67
    s_cmp_lt_u32 s68, 16
    s_cbranch_scc1 h_s_poll
h_s_ok:
    s_barrier
    s_lshl_b32 s44, s21, 18
    s_lshl_b32 s45, s17, 14
    s_add_u32 s44, s44, s45
    s_add_u32 s44, s44, 50331648
    buffer_load_dwordx4 v[32:35], v1, s[4:7], s44 offen offset:0 sc1
    buffer_load_dwordx4 v[36:39], v1, s[4:7], s44 offen offset:1024 sc1
    buffer_load_dwordx4 v[40:43], v1, s[4:7], s44 offen offset:2048 sc1
    buffer_load_dwordx4 v[44:47], v1, s[4:7], s44 offen offset:3072 sc1
    s_add_u32 s44, s44, 4096
    buffer_load_dwordx4 v[48:51], v1, s[4:7], s44 offen offset:0 sc1
    buffer_load_dwordx4 v[52:55], v1, s[4:7], s44 offen offset:1024 sc1
    buffer_load_dwordx4 v[56:59], v1, s[4:7], s44 offen offset:2048 sc1
    buffer_load_dwordx4 v[60:63], v1, s[4:7], s44 offen offset:3072 sc1
    s_add_u32 s44, s44, 4096
    buffer_load_dwordx4 v[64:67], v1, s[4:7], s44 offen offset:0 sc1
    buffer_load_dwordx4 v[68:71], v1, s[4:7], s44 offen offset:1024 sc1
    buffer_load_dwordx4 v[72:75], v1, s[4:7], s44 offen offset:2048 sc1
    buffer_load_dwordx4 v[76:79], v1, s[4:7], s44 offen offset:3072 sc1
    s_add_u32 s44, s44, 4096
    buffer_load_dwordx4 v[80:83], v1, s[4:7], s44 offen offset:0 sc1
    buffer_load_dwordx4 v[84:87], v1, s[4:7], s44 offen offset:1024 sc1
    buffer_load_dwordx4 v[88:91], v1, s[4:7], s44 offen offset:2048 sc1
    buffer_load_dwordx4 v[92:95], v1, s[4:7], s44 offen offset:3072 sc1
    s_barrier
    s_cmp_ge_u32 s21, 2
    s_cbranch_scc1 h_c_ok
    s_lshl_b32 s44, s21, 11
    s_lshl_b32 s67, s18, 7
    s_add_u32 s44, s44, s67
    s_add_u32 s44, s44, 0
    s_mov_b32 s66, 0x10000
h_c_poll:
    s_mov_b32 s68, 0
    s_atomic_add s68, s[22:23], s44 offset:0 glc
    s_sub_u32 s66, s66, 1
    s_cselect_b32 s67, 48, 0
    s_waitcnt lgkmcnt(0)
    s_max_u32 s68, s68, s67
    s_cmp_lt_u32 s68, 48
    s_cbranch_scc1 h_c_poll
h_c_ok:
    s_waitcnt vmcnt(0)
    s_lshl_b32 s3, s21, 8
    s_add_u32 s3, s3, s2
    s_lshr_b32 s3, s3, 3
    s_cmp_eq_u32 s3, 2
    s_cbranch_scc0 h_nf1
    s_atomic_add s40, s[34:35], 128
h_nf1:
    s_barrier
    s_cmp_ge_u32 s21, 2
    s_cbranch_scc1 h_cs1
    s_lshl_b32 s44, s21, 18
    s_lshl_b32 s45, s18, 14
    s_add_u32 s44, s44, s45
    s_add_u32 s44, s44, 52428800
    buffer_load_dwordx4 v[96:99], v1, s[4:7], s44 offen offset:0 sc1
    buffer_load_dwordx4 v[100:103], v1, s[4:7], s44 offen offset:1024 sc1
    buffer_load_dwordx4 v[104:107], v1, s[4:7], s44 offen offset:2048 sc1
    buffer_load_dwordx4 v[108:111], v1, s[4:7], s44 offen offset:3072 sc1
    s_add_u32 s44, s44, 4096
    buffer_load_dwordx4 v[112:115], v1, s[4:7], s44 offen offset:0 sc1
    buffer_load_dwordx4 v[116:119], v1, s[4:7], s44 offen offset:1024 sc1
    buffer_load_dwordx4 v[120:123], v1, s[4:7], s44 offen offset:2048 sc1
    buffer_load_dwordx4 v[124:127], v1, s[4:7], s44 offen offset:3072 sc1
    s_add_u32 s44, s44, 4096
    buffer_load_dwordx4 v[128:131], v1, s[4:7], s44 offen offset:0 sc1
    buffer_load_dwordx4 v[132:135], v1, s[4:7], s44 offen offset:1024 sc1
    buffer_load_dwordx4 v[136:139], v1, s[4:7], s44 offen offset:2048 sc1
    buffer_load_dwordx4 v[140:143], v1, s[4:7], s44 offen offset:3072 sc1
    s_add_u32 s44, s44, 4096
    buffer_load_dwordx4 v[144:147], v1, s[4:7], s44 offen offset:0 sc1
    buffer_load_dwordx4 v[148:151], v1, s[4:7], s44 offen offset:1024 sc1
    buffer_load_dwordx4 v[152:155], v1, s[4:7], s44 offen offset:2048 sc1
    buffer_load_dwordx4 v[156:159], v1, s[4:7], s44 offen offset:3072 sc1
h_cs1:
    v_add_f32 v32, v32, v36
    v_add_f32 v33, v33, v37
    v_add_f32 v34, v34, v38
    v_add_f32 v35, v35, v39
    v_add_f32 v48, v48, v52
    v_add_f32 v49, v49, v53
    v_add_f32 v50, v50, v54
    v_add_f32 v51, v51, v55
    v_add_f32 v64, v64, v68
    v_add_f32 v65, v65, v69
    v_add_f32 v66, v66, v70
    v_add_f32 v67, v67, v71
    v_add_f32 v80, v80, v84
    v_add_f32 v81, v81, v85
    v_add_f32 v82, v82, v86
    v_add_f32 v83, v83, v87
    v_add_f32 v32, v32, v40
    v_add_f32 v33, v33, v41
    v_add_f32 v34, v34, v42
    v_add_f32 v35, v35, v43
    v_add_f32 v48, v48, v56
    v_add_f32 v49, v49, v57
    v_add_f32 v50, v50, v58
    v_add_f32 v51, v51, v59
    v_add_f32 v64, v64, v72
    v_add_f32 v65, v65, v73
    v_add_f32 v66, v66, v74
    v_add_f32 v67, v67, v75
    v_add_f32 v80, v80, v88
    v_add_f32 v81, v81, v89
    v_add_f32 v82, v82, v90
    v_add_f32 v83, v83, v91
    s_barrier
    v_add_f32 v32, v32, v44
    v_add_f32 v33, v33, v45
    v_add_f32 v34, v34, v46
    v_add_f32 v35, v35, v47
    v_add_f32 v48, v48, v60
    v_add_f32 v49, v49, v61
    v_add_f32 v50, v50, v62
    v_add_f32 v51, v51, v63
    v_add_f32 v64, v64, v76
    v_add_f32 v65, v65, v77
    v_add_f32 v66, v66, v78
    v_add_f32 v67, v67, v79
    v_add_f32 v80, v80, v92
    v_add_f32 v81, v81, v93
    v_add_f32 v82, v82, v94
    v_add_f32 v83, v83, v95
    v_permlane32_swap_b32 v32, v64
    v_permlane32_swap_b32 v33, v65
    v_permlane32_swap_b32 v34, v66
    v_permlane32_swap_b32 v35, v67
    v_add_f32 v32, v32, v64
    v_add_f32 v33, v33, v65
    v_add_f32 v34, v34, v66
    v_add_f32 v35, v35, v67
    v_permlane32_swap_b32 v48, v80
    v_permlane32_swap_b32 v49, v81
    v_permlane32_swap_b32 v50, v82
    v_permlane32_swap_b32 v51, v83
    v_add_f32 v48, v48, v80
    v_add_f32 v49, v49, v81
    v_add_f32 v50, v50, v82
    v_add_f32 v51, v51, v83
    v_permlane16_swap_b32 v32, v48
    v_permlane16_swap_b32 v33, v49
    v_permlane16_swap_b32 v34, v50
    v_permlane16_swap_b32 v35, v51
    v_add_f32 v32, v32, v48
    v_add_f32 v33, v33, v49
    v_add_f32 v34, v34, v50
    v_add_f32 v35, v35, v51
    s_barrier
    v_mul_f32 v32, 0x3a800000, v32
    v_mul_f32 v33, 0x3a800000, v33
    v_mul_f32 v34, 0x3a800000, v34
    v_mul_f32 v35, 0x3a800000, v35
    v_fma_f32 v33, -v32, v32, v33
    v_fma_f32 v35, -v34, v34, v35
    v_max_f32 v33, 0, v33
    v_max_f32 v35, 0, v35
    v_add_f32 v33, 0x3727c5ac, v33
    v_add_f32 v35, 0x3727c5ac, v35
    v_rsq_f32 v33, v33
    v_rsq_f32 v35, v35
    v_lshrrev_b32 v26, 1, v1
    v_add_u32 v26, 155648, v26
    ds_write2_b32 v26, v32, v34 offset0:0 offset1:1
    ds_write2_b32 v26, v33, v35 offset0:128 offset1:129
    s_barrier
    s_cmp_ge_u32 s21, 2
    s_cbranch_scc1 h_cs_done
    s_waitcnt vmcnt(0)
    v_add_f32 v96, v96, v100
    v_add_f32 v97, v97, v101
    v_add_f32 v98, v98, v102
    v_add_f32 v99, v99, v103
    v_add_f32 v96, v96, v104
    v_add_f32 v97, v97, v105
    v_add_f32 v98, v98, v106
    v_add_f32 v99, v99, v107
    v_add_f32 v96, v96, v108
    v_add_f32 v97, v97, v109
    v_add_f32 v98, v98, v110
    v_add_f32 v99, v99, v111
    v_add_f32 v96, v96, v112
    v_add_f32 v97, v97, v113
    v_add_f32 v98, v98, v114
    v_add_f32 v99, v99, v115
    v_add_f32 v96, v96, v116
    v_add_f32 v97, v97, v117
    v_add_f32 v98, v98, v118
    v_add_f32 v99, v99, v119
    v_add_f32 v96, v96, v120
    v_add_f32 v97, v97, v121
    v_add_f32 v98, v98, v122
    v_add_f32 v99, v99, v123
    v_add_f32 v96, v96, v124
    v_add_f32 v97, v97, v125
    v_add_f32 v98, v98, v126
    v_add_f32 v99, v99, v127
    v_add_f32 v96, v96, v128
    v_add_f32 v97, v97, v129
    v_add_f32 v98, v98, v130
    v_add_f32 v99, v99, v131
    v_add_f32 v96, v96, v132
    v_add_f32 v97, v97, v133
    v_add_f32 v98, v98, v134
    v_add_f32 v99, v99, v135
    v_add_f32 v96, v96, v136
    v_add_f32 v97, v97, v137
    v_add_f32 v98, v98, v138
    v_add_f32 v99, v99, v139
    v_add_f32 v96, v96, v140
    v_add_f32 v97, v97, v141
    v_add_f32 v98, v98, v142
    v_add_f32 v99, v99, v143
    v_add_f32 v96, v96, v144
    v_add_f32 v97, v97, v145
    v_add_f32 v98, v98, v146
    v_add_f32 v99, v99, v147
    v_add_f32 v96, v96, v148
    v_add_f32 v97, v97, v149
    v_add_f32 v98, v98, v150
    v_add_f32 v99, v99, v151
    v_add_f32 v96, v96, v152
    v_add_f32 v97, v97, v153
    v_add_f32 v98, v98, v154
    v_add_f32 v99, v99, v155
    v_add_f32 v96, v96, v156
    v_add_f32 v97, v97, v157
    v_add_f32 v98, v98, v158
    v_add_f32 v99, v99, v159
    s_lshl_b32 s44, s21, 10
    s_add_u32 s44, s44, 151552
    v_add_u32 v24, s44, v1
    ds_write_b128 v24, v[96:99]
h_cs_done:
    s_waitcnt lgkmcnt(0)
    s_barrier
    s_cmp_lg_u32 s21, 0
    s_cbranch_scc1 h_f1_ok
    s_load_dword s68, s[34:35], 128
    s_mov_b32 s8, s34
    s_mov_b32 s9, s35
    s_mov_b32 s10, 256
    s_mov_b32 s11, 0x00020000
    s_mov_b32 s66, 0x10000
    v_mov_b32 v24, 0
    s_waitcnt lgkmcnt(0)
h_f1:
    s_cmp_eq_u32 s68, 8
    s_cbranch_scc1 h_f1_ok
    buffer_load_dword v25, v24, s[8:11], 0 offen offset:128 sc1
    s_waitcnt vmcnt(0)
    v_readfirstlane_b32 s68, v25
    s_sub_u32 s66, s66, 1
    s_cmp_lg_u32 s66, 0
    s_cbranch_scc1 h_f1
h_f1_ok:
    s_barrier
    s_bitcmp1_b32 s21, 0
    s_cselect_b32 s8, s28, s24
    s_cselect_b32 s9, s29, s25
    s_cselect_b32 s12, s30, s26
    s_cselect_b32 s13, s31, s27
    s_mov_b32 s10, 6291456
    s_mov_b32 s11, 0x00020000
    s_mov_b32 s14, 2097152
    s_mov_b32 s15, 0x00020000
    v_lshrrev_b32 v28, 4, v1
    v_and_b32 v29, 7, v28
    v_lshrrev_b32 v28, 3, v28
    v_mul_u32_u24 v28, 2048, v28
    v_lshl_add_u32 v28, v29, 4, v28
    s_and_b32 s3, s18, 12
    s_or_b32 s3, s3, 3
    s_lshl_b32 s3, s3, 7
    v_add_u32 v28, s3, v28
    s_lshr_b32 s3, s2, 3
    s_lshl_b32 s3, s3, 2
    s_and_b32 s60, s16, 3
    s_add_u32 s60, s60, s3
    s_lshl_b32 s61, s60, 14
    buffer_load_dwordx4 v[144:147], v28, s[12:15], s61 offen
    s_bitcmp0_b32 s21, 0
    s_cselect_b32 s56, s28, s24
    s_cselect_b32 s57, s29, s25
    s_mov_b32 s58, 6291456
    s_mov_b32 s59, 0x00020000
    v_lshrrev_b32 v28, 4, v1
    v_and_b32 v29, 7, v28
    v_lshrrev_b32 v28, 3, v28
    v_mul_u32_u24 v28, 6144, v28
    v_lshl_add_u32 v28, v29, 4, v28
    s_and_b32 s3, s18, 12
    s_or_b32 s3, s3, 3
    s_lshl_b32 s3, s3, 7
    v_add_u32 v28, s3, v28
    s_lshr_b32 s3, s2, 3
    s_lshl_b32 s3, s3, 2
    s_and_b32 s60, s16, 3
    s_add_u32 s60, s60, s3
    s_and_b32 s3, s60, 31
    s_mul_i32 s3, s3, 49152
    s_lshr_b32 s61, s60, 5
    s_min_u32 s61, s61, 2
    s_lshl_b32 s61, s61, 11
    s_add_u32 s61, s61, s3
    s_cmp_lt_u32 s18, 4
    s_cselect_b32 s3, 1572864, 0
    s_add_u32 s61, s61, s3
    buffer_load_dwordx4 v[148:151], v28, s[56:59], s61 offen
    s_cmp_lg_u32 s21, 2
    s_cbranch_scc1 h_pe
    s_bitcmp0_b32 s21, 0
    s_cselect_b32 s56, s28, s24
    s_cselect_b32 s57, s29, s25
    s_mov_b32 s58, 6291456
    s_mov_b32 s59, 0x00020000
    s_add_u32 s61, s84, 2048
    buffer_load_dwordx4 v[160:163], v11, s[56:59], s61 offen
    s_add_u32 s61, s84, 4096
    buffer_load_dwordx4 v[164:167], v11, s[56:59], s61 offen
    s_add_u32 s61, s84, 0
    buffer_load_dwordx4 v[168:171], v11, s[56:59], s61 offen
    s_add_u32 s61, s84, 198656
    buffer_load_dwordx4 v[172:175], v11, s[56:59], s61 offen
    s_add_u32 s61, s84, 200704
    buffer_load_dwordx4 v[176:179], v11, s[56:59], s61 offen
    s_add_u32 s61, s84, 196608
    buffer_load_dwordx4 v[180:183], v11, s[56:59], s61 offen
    s_add_u32 s61, s85, 2048
    buffer_load_dwordx4 v[184:187], v11, s[56:59], s61 offen
    s_add_u32 s61, s85, 4096
    buffer_load_dwordx4 v[188:191], v11, s[56:59], s61 offen
    s_add_u32 s61, s85, 0
    buffer_load_dwordx4 v[192:195], v11, s[56:59], s61 offen
    s_add_u32 s61, s85, 198656
    buffer_load_dwordx4 v[196:199], v11, s[56:59], s61 offen
h_pe:
    s_barrier
    s_branch s_tail
z_start:
    v_lshrrev_b32 v24, 4, v1
    v_lshrrev_b32 v25, 3, v24
    v_mul_u32_u24 v20, 6144, v25
    v_and_b32 v25, 7, v24
    v_lshl_add_u32 v20, v25, 4, v20
    s_add_u32 s3, s18, 2
    s_and_b32 s3, s3, 15
    s_lshl_b32 s3, s3, 7
    s_add_u32 s3, s3, 4096
    v_add_u32 v22, s3, v20
    s_add_u32 s3, s18, 1
    s_and_b32 s3, s3, 15
    s_lshl_b32 s3, s3, 7
    s_add_u32 s3, s3, 2048
    v_add_u32 v21, s3, v20
    s_add_u32 s3, s18, 0
    s_and_b32 s3, s3, 15
    s_lshl_b32 s3, s3, 7
    s_add_u32 s3, s3, 0
    v_add_u32 v20, s3, v20
    s_waitcnt lgkmcnt(0)
    s_mov_b32 s8, s24
    s_mov_b32 s9, s25
    s_mov_b32 s10, 6291456
    s_mov_b32 s11, 0x00020000
    s_mul_i32 s44, s17, 393216
    buffer_load_dwordx4 v[32:35], v20, s[8:11], s44 offen
    buffer_load_dwordx4 v[64:67], v21, s[8:11], s44 offen
    buffer_load_dwordx4 v[96:99], v22, s[8:11], s44 offen
    s_add_u32 s44, s44, 49152
    buffer_load_dwordx4 v[36:39], v20, s[8:11], s44 offen
    buffer_load_dwordx4 v[68:71], v21, s[8:11], s44 offen
    buffer_load_dwordx4 v[100:103], v22, s[8:11], s44 offen
    s_add_u32 s44, s44, 49152
    buffer_load_dwordx4 v[40:43], v20, s[8:11], s44 offen
    buffer_load_dwordx4 v[72:75], v21, s[8:11], s44 offen
    buffer_load_dwordx4 v[104:107], v22, s[8:11], s44 offen
    s_add_u32 s44, s44, 49152
    buffer_load_dwordx4 v[44:47], v20, s[8:11], s44 offen
    buffer_load_dwordx4 v[76:79], v21, s[8:11], s44 offen
    buffer_load_dwordx4 v[108:111], v22, s[8:11], s44 offen
    s_add_u32 s44, s44, 49152
    buffer_load_dwordx4 v[48:51], v20, s[8:11], s44 offen
    buffer_load_dwordx4 v[80:83], v21, s[8:11], s44 offen
    buffer_load_dwordx4 v[112:115], v22, s[8:11], s44 offen
    s_add_u32 s44, s44, 49152
    buffer_load_dwordx4 v[52:55], v20, s[8:11], s44 offen
    buffer_load_dwordx4 v[84:87], v21, s[8:11], s44 offen
    buffer_load_dwordx4 v[116:119], v22, s[8:11], s44 offen
    s_add_u32 s44, s44, 49152
    buffer_load_dwordx4 v[56:59], v20, s[8:11], s44 offen
    buffer_load_dwordx4 v[88:91], v21, s[8:11], s44 offen
    buffer_load_dwordx4 v[120:123], v22, s[8:11], s44 offen
    s_add_u32 s44, s44, 49152
    buffer_load_dwordx4 v[60:63], v20, s[8:11], s44 offen
    buffer_load_dwordx4 v[92:95], v21, s[8:11], s44 offen
    buffer_load_dwordx4 v[124:127], v22, s[8:11], s44 offen
    v_lshrrev_b32 v24, 4, v1
    v_lshrrev_b32 v25, 3, v24
    v_mul_u32_u24 v12, 6144, v25
    v_and_b32 v26, 2, v25
    v_lshrrev_b32 v25, 2, v25
    v_or_b32 v26, v26, v25
    v_bfe_u32 v25, v24, 1, 2
    v_xor_b32 v26, v26, v25
    v_lshl_add_u32 v12, v26, 5, v12
    v_and_b32 v26, 1, v24
    v_lshl_add_u32 v12, v26, 4, v12
    s_lshl_b32 s3, s18, 7
    v_add_u32 v12, s3, v12
    v_add_u32 v13, 48128, v12
    s_mul_i32 s84, s18, 393216
    s_cmp_lt_u32 s18, 4
    s_cselect_b32 s85, 4, 0
    s_mul_i32 s85, s85, 393216
    s_cmp_lt_u32 s18, 4
    s_cselect_b32 s86, 5, 1
    s_mul_i32 s86, s86, 393216
    s_cmp_lt_u32 s18, 4
    s_cselect_b32 s87, 6, 2
    s_mul_i32 s87, s87, 393216
    s_cmp_lt_u32 s18, 4
    s_cselect_b32 s88, 7, 3
    s_mul_i32 s88, s88, 393216
    s_cmp_lt_u32 s18, 8
    s_cselect_b32 s89, 8, 4
    s_mul_i32 s89, s89, 393216
    s_cmp_lt_u32 s18, 8
    s_cselect_b32 s90, 9, 5
    s_mul_i32 s90, s90, 393216
    s_cmp_lt_u32 s18, 8
    s_cselect_b32 s91, 10, 6
    s_mul_i32 s91, s91, 393216
    s_cmp_lt_u32 s18, 8
    s_cselect_b32 s92, 11, 7
    s_mul_i32 s92, s92, 393216
    s_cmp_lt_u32 s18, 12
    s_cselect_b32 s93, 12, 8
    s_mul_i32 s93, s93, 393216
    s_cmp_lt_u32 s18, 12
    s_cselect_b32 s94, 13, 9
    s_mul_i32 s94, s94, 393216
    s_cmp_lt_u32 s18, 12
    s_cselect_b32 s95, 14, 10
    s_mul_i32 s95, s95, 393216
    s_cmp_lt_u32 s18, 12
    s_cselect_b32 s96, 15, 11
    s_mul_i32 s96, s96, 393216
    s_xor_b32 s97, s18, 1
    s_mul_i32 s97, s97, 393216
    s_xor_b32 s98, s18, 2
    s_mul_i32 s98, s98, 393216
    s_xor_b32 s99, s18, 3
    s_mul_i32 s99, s99, 393216
    v_lshrrev_b32 v24, 4, v1
    v_lshrrev_b32 v25, 3, v24
    v_mul_u32_u24 v16, 2048, v25
    v_and_b32 v26, 2, v25
    v_lshrrev_b32 v25, 2, v25
    v_or_b32 v26, v26, v25
    v_bfe_u32 v25, v24, 1, 2
    v_xor_b32 v26, v26, v25
    v_lshl_add_u32 v16, v26, 5, v16
    v_and_b32 v26, 1, v24
    v_lshl_add_u32 v16, v26, 4, v16
    s_lshl_b32 s3, s18, 7
    v_add_u32 v16, s3, v16
    v_add_u32 v17, 15360, v16
    v_add_u32 v18, 30720, v16
    v_add_u32 v19, 46080, v16
    s_and_b32 s3, s16, 3
    s_mul_i32 s3, s3, 49152
    v_add_u32 v11, s3, v12
    s_and_b32 s3, s16, 3
    s_lshl_b32 s3, s3, 10
    v_add_u32 v9, s3, v1
    v_add_u32 v10, 0x10000, v9
    s_barrier
    v_lshrrev_b32 v24, 4, v1
    v_and_b32 v25, 1, v24
    v_lshlrev_b32 v25, 4, v25
    v_mov_b32 v26, 0x3f80
    v_lshlrev_b32 v25, v25, v26
    v_bfe_u32 v26, v24, 1, 2
    v_cmp_eq_u32 vcc, 0, v26
    s_nop 1
    v_cndmask_b32 v140, 0, v25, vcc
    v_cmp_eq_u32 vcc, 1, v26
    s_nop 1
    v_cndmask_b32 v141, 0, v25, vcc
    v_cmp_eq_u32 vcc, 2, v26
    s_nop 1
    v_cndmask_b32 v142, 0, v25, vcc
    v_cmp_eq_u32 vcc, 3, v26
    s_nop 1
    v_cndmask_b32 v143, 0, v25, vcc
    v_bfe_u32 v25, v24, 3, 1
    v_lshrrev_b32 v26, 5, v24
    v_lshl_add_u32 v26, v26, 1, v25
    v_lshlrev_b32 v25, 8, v26
    v_and_b32 v27, 7, v24
    v_lshl_add_u32 v25, v27, 5, v25
    v_bfe_u32 v27, v24, 4, 1
    v_lshl_add_u32 v25, v27, 4, v25
    v_add_u32 v27, s18, v26
    v_and_b32 v27, 15, v27
    v_lshl_add_u32 v25, v27, 14, v25
    s_lshl_b32 s44, s17, 10
    s_add_u32 s44, s44, 52428800
    s_waitcnt vmcnt(21)
    v_mfma_f32_16x16x32_bf16 v[128:131], v[140:143], v[32:35], 0
    v_mfma_f32_16x16x32_bf16 v[132:135], v[140:143], v[64:67], 0
    v_mfma_f32_16x16x32_bf16 v[136:139], v[140:143], v[96:99], 0
    s_waitcnt vmcnt(18)
    v_mfma_f32_16x16x32_bf16 v[128:131], v[140:143], v[36:39], v[128:131]
    v_mfma_f32_16x16x32_bf16 v[132:135], v[140:143], v[68:71], v[132:135]
    v_mfma_f32_16x16x32_bf16 v[136:139], v[140:143], v[100:103], v[136:139]
    s_waitcnt vmcnt(15)
    v_mfma_f32_16x16x32_bf16 v[128:131], v[140:143], v[40:43], v[128:131]
    v_mfma_f32_16x16x32_bf16 v[132:135], v[140:143], v[72:75], v[132:135]
    v_mfma_f32_16x16x32_bf16 v[136:139], v[140:143], v[104:107], v[136:139]
    s_waitcnt vmcnt(12)
    v_mfma_f32_16x16x32_bf16 v[128:131], v[140:143], v[44:47], v[128:131]
    v_mfma_f32_16x16x32_bf16 v[132:135], v[140:143], v[76:79], v[132:135]
    v_mfma_f32_16x16x32_bf16 v[136:139], v[140:143], v[108:111], v[136:139]
    s_waitcnt vmcnt(9)
    v_mfma_f32_16x16x32_bf16 v[128:131], v[140:143], v[48:51], v[128:131]
    v_mfma_f32_16x16x32_bf16 v[132:135], v[140:143], v[80:83], v[132:135]
    v_mfma_f32_16x16x32_bf16 v[136:139], v[140:143], v[112:115], v[136:139]
    s_waitcnt vmcnt(6)
    v_mfma_f32_16x16x32_bf16 v[128:131], v[140:143], v[52:55], v[128:131]
    v_mfma_f32_16x16x32_bf16 v[132:135], v[140:143], v[84:87], v[132:135]
    v_mfma_f32_16x16x32_bf16 v[136:139], v[140:143], v[116:119], v[136:139]
    s_waitcnt vmcnt(3)
    v_mfma_f32_16x16x32_bf16 v[128:131], v[140:143], v[56:59], v[128:131]
    v_mfma_f32_16x16x32_bf16 v[132:135], v[140:143], v[88:91], v[132:135]
    v_mfma_f32_16x16x32_bf16 v[136:139], v[140:143], v[120:123], v[136:139]
    s_waitcnt vmcnt(0)
    v_mfma_f32_16x16x32_bf16 v[128:131], v[140:143], v[60:63], v[128:131]
    v_mfma_f32_16x16x32_bf16 v[132:135], v[140:143], v[92:95], v[132:135]
    v_mfma_f32_16x16x32_bf16 v[136:139], v[140:143], v[124:127], v[136:139]
    s_barrier
    v_lshrrev_b32 v28, 4, v1
    v_and_b32 v29, 7, v28
    v_lshrrev_b32 v28, 3, v28
    v_mul_u32_u24 v28, 6144, v28
    v_lshl_add_u32 v28, v29, 4, v28
    s_and_b32 s3, s18, 12
    s_or_b32 s3, s3, 3
    s_lshl_b32 s3, s3, 7
    v_add_u32 v28, s3, v28
    s_lshr_b32 s3, s2, 3
    s_lshl_b32 s3, s3, 2
    s_and_b32 s60, s16, 3
    s_add_u32 s60, s60, s3
    s_lshr_b32 s60, s60, 2
    s_mul_i32 s60, s60, 49152
    s_cmp_lt_u32 s18, 4
    s_cselect_b32 s3, 0, 1
    s_mul_i32 s3, s3, 1572864
    s_add_u32 s3, s3, s60
    s_add_u32 s61, s3, 0
    buffer_load_dwordx4 v[160:163], v28, s[8:11], s61 offen
    s_add_u32 s61, s3, 2048
    buffer_load_dwordx4 v[164:167], v28, s[8:11], s61 offen
    s_add_u32 s61, s3, 4096
    buffer_load_dwordx4 v[168:171], v28, s[8:11], s61 offen
    s_add_u32 s3, s60, 3145728
    s_add_u32 s61, s3, 0
    buffer_load_dwordx4 v[172:175], v28, s[8:11], s61 offen
    s_add_u32 s61, s3, 2048
    buffer_load_dwordx4 v[176:179], v28, s[8:11], s61 offen
    s_add_u32 s61, s3, 4096
    buffer_load_dwordx4 v[180:183], v28, s[8:11], s61 offen
    s_add_u32 s3, s60, 4718592
    s_add_u32 s61, s3, 0
    buffer_load_dwordx4 v[184:187], v28, s[8:11], s61 offen
    s_add_u32 s61, s3, 2048
    buffer_load_dwordx4 v[188:191], v28, s[8:11], s61 offen
    s_add_u32 s61, s3, 4096
    buffer_load_dwordx4 v[192:195], v28, s[8:11], s61 offen
    v_add_f32_dpp v128, v128, v128 row_ror:8 row_mask:0xf bank_mask:0xf
    v_add_f32_dpp v129, v129, v129 row_ror:8 row_mask:0xf bank_mask:0xf
    v_add_f32_dpp v130, v130, v130 row_ror:8 row_mask:0xf bank_mask:0xf
    v_add_f32_dpp v131, v131, v131 row_ror:8 row_mask:0xf bank_mask:0xf
    v_add_f32_dpp v132, v132, v132 row_ror:8 row_mask:0xf bank_mask:0xf
    v_add_f32_dpp v133, v133, v133 row_ror:8 row_mask:0xf bank_mask:0xf
    v_add_f32_dpp v134, v134, v134 row_ror:8 row_mask:0xf bank_mask:0xf
    v_add_f32_dpp v135, v135, v135 row_ror:8 row_mask:0xf bank_mask:0xf
    v_add_f32_dpp v136, v136, v136 row_ror:8 row_mask:0xf bank_mask:0xf
    v_add_f32_dpp v137, v137, v137 row_ror:8 row_mask:0xf bank_mask:0xf
    v_add_f32_dpp v138, v138, v138 row_ror:8 row_mask:0xf bank_mask:0xf
    v_add_f32_dpp v139, v139, v139 row_ror:8 row_mask:0xf bank_mask:0xf
    v_cmp_le_u32 vcc, 1, v26
    s_nop 1
    v_cndmask_b32 v128, v128, v132, vcc
    v_cndmask_b32 v129, v129, v133, vcc
    v_cndmask_b32 v130, v130, v134, vcc
    v_cndmask_b32 v131, v131, v135, vcc
    v_cmp_le_u32 vcc, 2, v26
    s_nop 1
    v_cndmask_b32 v128, v128, v136, vcc
    v_cndmask_b32 v129, v129, v137, vcc
    v_cndmask_b32 v130, v130, v138, vcc
    v_cndmask_b32 v131, v131, v139, vcc
    buffer_store_dwordx4 v[128:131], v25, s[4:7], s44 offen sc1
    s_barrier
    s_barrier
    s_waitcnt vmcnt(0)
    s_add_u32 s44, s18, 0
    s_and_b32 s44, s44, 15
    s_lshl_b32 s44, s44, 7
    s_add_u32 s44, s44, 0
    s_atomic_add s40, s[22:23], s44
    s_add_u32 s45, s18, 1
    s_and_b32 s45, s45, 15
    s_lshl_b32 s45, s45, 7
    s_add_u32 s45, s45, 0
    s_atomic_add s40, s[22:23], s45
    s_add_u32 s46, s18, 2
    s_and_b32 s46, s46, 15
    s_lshl_b32 s46, s46, 7
    s_add_u32 s46, s46, 0
    s_atomic_add s40, s[22:23], s46
    s_barrier
    s_barrier
    s_barrier
    s_barrier
    s_barrier
    s_barrier
    s_mov_b32 s12, s26
    s_mov_b32 s13, s27
    s_mov_b32 s14, 2097152
    s_mov_b32 s15, 0x00020000
    s_lshl_b32 s44, s2, 13
    buffer_load_dwordx4 v[160:163], v1, s[12:15], s44 offen offset:0
    buffer_load_dwordx4 v[164:167], v1, s[12:15], s44 offen offset:1024
    buffer_load_dwordx4 v[168:171], v1, s[12:15], s44 offen offset:2048
    buffer_load_dwordx4 v[172:175], v1, s[12:15], s44 offen offset:3072
    s_add_u32 s44, s44, 4096
    buffer_load_dwordx4 v[176:179], v1, s[12:15], s44 offen offset:0
    buffer_load_dwordx4 v[180:183], v1, s[12:15], s44 offen offset:1024
    buffer_load_dwordx4 v[184:187], v1, s[12:15], s44 offen offset:2048
    buffer_load_dwordx4 v[188:191], v1, s[12:15], s44 offen offset:3072
    s_mov_b32 s8, s28
    s_mov_b32 s9, s29
    s_mov_b32 s10, 6291456
    s_mov_b32 s11, 0x00020000
    s_mul_i32 s44, s17, 393216
    buffer_load_dwordx4 v[32:35], v20, s[8:11], s44 offen
    buffer_load_dwordx4 v[64:67], v21, s[8:11], s44 offen
    buffer_load_dwordx4 v[96:99], v22, s[8:11], s44 offen
    s_add_u32 s44, s44, 49152
    buffer_load_dwordx4 v[36:39], v20, s[8:11], s44 offen
    buffer_load_dwordx4 v[68:71], v21, s[8:11], s44 offen
    buffer_load_dwordx4 v[100:103], v22, s[8:11], s44 offen
    s_add_u32 s44, s44, 49152
    buffer_load_dwordx4 v[40:43], v20, s[8:11], s44 offen
    buffer_load_dwordx4 v[72:75], v21, s[8:11], s44 offen
    buffer_load_dwordx4 v[104:107], v22, s[8:11], s44 offen
    s_add_u32 s44, s44, 49152
    s_barrier
    buffer_load_dwordx4 v[44:47], v20, s[8:11], s44 offen
    buffer_load_dwordx4 v[76:79], v21, s[8:11], s44 offen
    buffer_load_dwordx4 v[108:111], v22, s[8:11], s44 offen
    s_add_u32 s44, s44, 49152
    buffer_load_dwordx4 v[48:51], v20, s[8:11], s44 offen
    buffer_load_dwordx4 v[80:83], v21, s[8:11], s44 offen
    buffer_load_dwordx4 v[112:115], v22, s[8:11], s44 offen
    s_add_u32 s44, s44, 49152
    buffer_load_dwordx4 v[52:55], v20, s[8:11], s44 offen
    buffer_load_dwordx4 v[84:87], v21, s[8:11], s44 offen
    buffer_load_dwordx4 v[116:119], v22, s[8:11], s44 offen
    s_add_u32 s44, s44, 49152
    buffer_load_dwordx4 v[56:59], v20, s[8:11], s44 offen
    buffer_load_dwordx4 v[88:91], v21, s[8:11], s44 offen
    buffer_load_dwordx4 v[120:123], v22, s[8:11], s44 offen
    s_add_u32 s44, s44, 49152
    buffer_load_dwordx4 v[60:63], v20, s[8:11], s44 offen
    buffer_load_dwordx4 v[92:95], v21, s[8:11], s44 offen
    buffer_load_dwordx4 v[124:127], v22, s[8:11], s44 offen
    s_barrier
    s_bitcmp1_b32 s21, 0
    s_cselect_b32 s8, s28, s24
    s_cselect_b32 s9, s29, s25
    s_cselect_b32 s12, s30, s26
    s_cselect_b32 s13, s31, s27
    s_mov_b32 s10, 6291456
    s_mov_b32 s11, 0x00020000
    s_mov_b32 s14, 2097152
    s_mov_b32 s15, 0x00020000
    s_branch s_tail
z_layer:
    s_waitcnt lgkmcnt(0)
    v_lshrrev_b32 v28, 4, v1
    v_and_b32 v29, 7, v28
    v_lshrrev_b32 v28, 3, v28
    v_mul_u32_u24 v28, 6144, v28
    v_lshl_add_u32 v28, v29, 4, v28
    s_and_b32 s3, s18, 12
    s_or_b32 s3, s3, 3
    s_lshl_b32 s3, s3, 7
    v_add_u32 v28, s3, v28
    s_lshr_b32 s3, s2, 3
    s_lshl_b32 s3, s3, 2
    s_and_b32 s60, s16, 3
    s_add_u32 s60, s60, s3
    s_lshr_b32 s60, s60, 2
    s_mul_i32 s60, s60, 49152
    s_cmp_lt_u32 s18, 4
    s_cselect_b32 s3, 0, 1
    s_mul_i32 s3, s3, 1572864
    s_add_u32 s3, s3, s60
    s_add_u32 s61, s3, 0
    buffer_load_dwordx4 v[160:163], v28, s[8:11], s61 offen
    s_add_u32 s61, s3, 2048
    buffer_load_dwordx4 v[164:167], v28, s[8:11], s61 offen
    s_add_u32 s61, s3, 4096
    buffer_load_dwordx4 v[168:171], v28, s[8:11], s61 offen
    s_add_u32 s3, s60, 3145728
    s_add_u32 s61, s3, 0
    buffer_load_dwordx4 v[172:175], v28, s[8:11], s61 offen
    s_add_u32 s61, s3, 2048
    buffer_load_dwordx4 v[176:179], v28, s[8:11], s61 offen
    s_add_u32 s61, s3, 4096
    buffer_load_dwordx4 v[180:183], v28, s[8:11], s61 offen
    s_add_u32 s3, s60, 4718592
    s_add_u32 s61, s3, 0
    buffer_load_dwordx4 v[184:187], v28, s[8:11], s61 offen
    s_add_u32 s61, s3, 2048
    buffer_load_dwordx4 v[188:191], v28, s[8:11], s61 offen
    s_add_u32 s61, s3, 4096
    buffer_load_dwordx4 v[192:195], v28, s[8:11], s61 offen
    s_barrier
    s_barrier
    s_barrier
    s_barrier
    s_barrier
    s_barrier
    s_barrier
    s_barrier
    s_barrier
    s_barrier
    v_lshrrev_b32 v28, 4, v1
    v_and_b32 v29, 7, v28
    v_lshrrev_b32 v28, 3, v28
    v_mul_u32_u24 v28, 2048, v28
    v_lshl_add_u32 v28, v29, 4, v28
    s_and_b32 s3, s18, 12
    s_or_b32 s3, s3, 3
    s_lshl_b32 s3, s3, 7
    v_add_u32 v28, s3, v28
    s_lshr_b32 s3, s2, 3
    s_lshl_b32 s3, s3, 2
    s_and_b32 s60, s16, 3
    s_add_u32 s60, s60, s3
    s_lshl_b32 s61, s60, 14
    buffer_load_dwordx4 v[144:147], v28, s[12:15], s61 offen
    s_bitcmp0_b32 s21, 0
    s_cselect_b32 s56, s28, s24
    s_cselect_b32 s57, s29, s25
    s_mov_b32 s58, 6291456
    s_mov_b32 s59, 0x00020000
    v_lshrrev_b32 v28, 4, v1
    v_and_b32 v29, 7, v28
    v_lshrrev_b32 v28, 3, v28
    v_mul_u32_u24 v28, 6144, v28
    v_lshl_add_u32 v28, v29, 4, v28
    s_and_b32 s3, s18, 12
    s_or_b32 s3, s3, 3
    s_lshl_b32 s3, s3, 7
    v_add_u32 v28, s3, v28
    s_lshr_b32 s3, s2, 3
    s_lshl_b32 s3, s3, 2
    s_and_b32 s60, s16, 3
    s_add_u32 s60, s60, s3
    s_and_b32 s3, s60, 31
    s_mul_i32 s3, s3, 49152
    s_lshr_b32 s61, s60, 5
    s_min_u32 s61, s61, 2
    s_lshl_b32 s61, s61, 11
    s_add_u32 s61, s61, s3
    s_cmp_lt_u32 s18, 4
    s_cselect_b32 s3, 1572864, 0
    s_add_u32 s61, s61, s3
    buffer_load_dwordx4 v[148:151], v28, s[56:59], s61 offen
    s_cmp_lg_u32 s21, 2
    s_cbranch_scc1 z_pe
    s_bitcmp0_b32 s21, 0
    s_cselect_b32 s56, s28, s24
    s_cselect_b32 s57, s29, s25
    s_mov_b32 s58, 6291456
    s_mov_b32 s59, 0x00020000
    s_add_u32 s61, s84, 2048
    buffer_load_dwordx4 v[160:163], v11, s[56:59], s61 offen
    s_add_u32 s61, s84, 4096
    buffer_load_dwordx4 v[164:167], v11, s[56:59], s61 offen
    s_add_u32 s61, s84, 0
    buffer_load_dwordx4 v[168:171], v11, s[56:59], s61 offen
    s_add_u32 s61, s84, 198656
    buffer_load_dwordx4 v[172:175], v11, s[56:59], s61 offen
    s_add_u32 s61, s84, 200704
    buffer_load_dwordx4 v[176:179], v11, s[56:59], s61 offen
    s_add_u32 s61, s84, 196608
    buffer_load_dwordx4 v[180:183], v11, s[56:59], s61 offen
    s_add_u32 s61, s85, 2048
    buffer_load_dwordx4 v[184:187], v11, s[56:59], s61 offen
    s_add_u32 s61, s85, 4096
    buffer_load_dwordx4 v[188:191], v11, s[56:59], s61 offen
    s_add_u32 s61, s85, 0
    buffer_load_dwordx4 v[192:195], v11, s[56:59], s61 offen
    s_add_u32 s61, s85, 198656
    buffer_load_dwordx4 v[196:199], v11, s[56:59], s61 offen
z_pe:
    s_barrier
    s_branch s_tail
s_tail:
    s_bitcmp1_b32 s21, 0
    s_cbranch_scc1 s_B
    s_cmp_lg_u32 s16, 4
    s_cbranch_scc1 s_a1
    s_mov_b32 s45, 2146435072
    s_cmp_eq_u32 s17, 0
    s_cbranch_scc1 s_a0
    s_lshr_b32 s46, s21, 1
    s_lshl_b32 s44, s46, 15
    s_lshl_b32 s67, s17, 11
    s_add_u32 s44, s44, s67
    s_lshl_b32 s67, s18, 7
    s_add_u32 s44, s44, s67
    s_add_u32 s44, s44, 149504
    s_sub_u32 s45, s44, 151552
    s_lshl_b32 s45, s45, 5
    s_add_u32 s45, s45, 54525952
    s_mov_b32 s66, 0x10000
s_h_poll:
    s_mov_b32 s68, 0
    s_atomic_add s68, s[22:23], s44 offset:0 glc
    s_sub_u32 s66, s66, 1
    s_cselect_b32 s67, 1, 0
    s_waitcnt lgkmcnt(0)
    s_max_u32 s68, s68, s67
    s_cmp_lt_u32 s68, 1
    s_cbranch_scc1 s_h_poll
s_h_ok:
s_a0:
    s_mov_b32 m0, 131072
    s_nop 0
    buffer_load_dwordx4 v1, s[4:7], s45 offen offset:0 sc1 lds
    buffer_load_dwordx4 v1, s[4:7], s45 offen offset:1024 sc1 lds
    buffer_load_dwordx4 v1, s[4:7], s45 offen offset:2048 sc1 lds
    buffer_load_dwordx4 v1, s[4:7], s45 offen offset:3072 sc1 lds
    s_waitcnt vmcnt(0)
s_a1:
    s_barrier
    s_waitcnt vmcnt(0)
    s_barrier
    s_sub_u32 s3, s16, 5
    s_cmp_gt_u32 s3, 1
    s_cbranch_scc1 s_a2
    s_add_u32 m0, s41, 65536
    s_xor_b32 s44, s62, 65536
    buffer_load_dwordx4 v16, s[12:15], s44 offen offset:0 lds
    buffer_load_dwordx4 v17, s[12:15], s44 offen offset:1024 lds
    s_add_u32 m0, s41, 69632
    s_xor_b32 s44, s62, 196608
    buffer_load_dwordx4 v16, s[12:15], s44 offen offset:0 lds
    buffer_load_dwordx4 v17, s[12:15], s44 offen offset:1024 lds
    s_add_u32 m0, s41, 73728
    s_xor_b32 s44, s62, 327680
    buffer_load_dwordx4 v16, s[12:15], s44 offen offset:0 lds
    buffer_load_dwordx4 v17, s[12:15], s44 offen offset:1024 lds
    s_add_u32 m0, s41, 77824
    s_xor_b32 s44, s62, 458752
    buffer_load_dwordx4 v16, s[12:15], s44 offen offset:0 lds
    buffer_load_dwordx4 v17, s[12:15], s44 offen offset:1024 lds
    s_add_u32 m0, s41, 81920
    s_xor_b32 s44, s62, 589824
    buffer_load_dwordx4 v16, s[12:15], s44 offen offset:0 lds
    buffer_load_dwordx4 v17, s[12:15], s44 offen offset:1024 lds
    s_add_u32 m0, s41, 86016
    s_xor_b32 s44, s62, 720896
    buffer_load_dwordx4 v16, s[12:15], s44 offen offset:0 lds
    buffer_load_dwordx4 v17, s[12:15], s44 offen offset:1024 lds
    s_add_u32 m0, s41, 90112
    s_xor_b32 s44, s62, 851968
    buffer_load_dwordx4 v16, s[12:15], s44 offen offset:0 lds
    buffer_load_dwordx4 v17, s[12:15], s44 offen offset:1024 lds
    s_add_u32 m0, s41, 94208
    s_xor_b32 s44, s62, 983040
    buffer_load_dwordx4 v16, s[12:15], s44 offen offset:0 lds
    buffer_load_dwordx4 v17, s[12:15], s44 offen offset:1024 lds
    s_add_u32 m0, s41, 98304
    s_xor_b32 s44, s62, 1114112
    buffer_load_dwordx4 v16, s[12:15], s44 offen offset:0 lds
    buffer_load_dwordx4 v17, s[12:15], s44 offen offset:1024 lds
    s_add_u32 m0, s41, 102400
    s_xor_b32 s44, s62, 1245184
    buffer_load_dwordx4 v16, s[12:15], s44 offen offset:0 lds
    buffer_load_dwordx4 v17, s[12:15], s44 offen offset:1024 lds
    s_add_u32 m0, s41, 106496
    s_xor_b32 s44, s62, 1376256
    buffer_load_dwordx4 v16, s[12:15], s44 offen offset:0 lds
    buffer_load_dwordx4 v17, s[12:15], s44 offen offset:1024 lds
    s_add_u32 m0, s41, 110592
    s_xor_b32 s44, s62, 1507328
    buffer_load_dwordx4 v16, s[12:15], s44 offen offset:0 lds
    buffer_load_dwordx4 v17, s[12:15], s44 offen offset:1024 lds
    s_add_u32 m0, s41, 114688
    s_xor_b32 s44, s62, 1638400
    buffer_load_dwordx4 v16, s[12:15], s44 offen offset:0 lds
    buffer_load_dwordx4 v17, s[12:15], s44 offen offset:1024 lds
    s_add_u32 m0, s41, 118784
    s_xor_b32 s44, s62, 1769472
    buffer_load_dwordx4 v16, s[12:15], s44 offen offset:0 lds
    buffer_load_dwordx4 v17, s[12:15], s44 offen offset:1024 lds
    s_add_u32 m0, s41, 122880
    s_xor_b32 s44, s62, 1900544
    buffer_load_dwordx4 v16, s[12:15], s44 offen offset:0 lds
    buffer_load_dwordx4 v17, s[12:15], s44 offen offset:1024 lds
    s_add_u32 m0, s41, 126976
    s_xor_b32 s44, s62, 2031616
    buffer_load_dwordx4 v16, s[12:15], s44 offen offset:0 lds
    buffer_load_dwordx4 v17, s[12:15], s44 offen offset:1024 lds
s_a2:
    s_cmp_eq_u32 s21, 2
    s_cbranch_scc1 s_a3
    s_bitcmp0_b32 s21, 0
    s_cselect_b32 s56, s28, s24
    s_cselect_b32 s57, s29, s25
    s_mov_b32 s58, 6291456
    s_mov_b32 s59, 0x00020000
    s_add_u32 s61, s84, 2048
    buffer_load_dwordx4 v[160:163], v11, s[56:59], s61 offen
    s_add_u32 s61, s84, 4096
    buffer_load_dwordx4 v[164:167], v11, s[56:59], s61 offen
    s_add_u32 s61, s84, 0
    buffer_load_dwordx4 v[168:171], v11, s[56:59], s61 offen
    s_add_u32 s61, s84, 198656
    buffer_load_dwordx4 v[172:175], v11, s[56:59], s61 offen
    s_add_u32 s61, s84, 200704
    buffer_load_dwordx4 v[176:179], v11, s[56:59], s61 offen
    s_add_u32 s61, s84, 196608
    buffer_load_dwordx4 v[180:183], v11, s[56:59], s61 offen
    s_add_u32 s61, s85, 2048
    buffer_load_dwordx4 v[184:187], v11, s[56:59], s61 offen
    s_add_u32 s61, s85, 4096
    buffer_load_dwordx4 v[188:191], v11, s[56:59], s61 offen
    s_add_u32 s61, s85, 0
    buffer_load_dwordx4 v[192:195], v11, s[56:59], s61 offen
    s_add_u32 s61, s85, 198656
    buffer_load_dwordx4 v[196:199], v11, s[56:59], s61 offen
s_a3:
    s_bitcmp0_b32 s21, 0
    s_cselect_b32 s56, s28, s24
    s_cselect_b32 s57, s29, s25
    s_mov_b32 s58, 6291456
    s_mov_b32 s59, 0x00020000
    s_add_u32 s61, s85, 200704
    buffer_load_dwordx4 v[200:203], v11, s[56:59], s61 offen
    s_add_u32 s61, s85, 196608
    buffer_load_dwordx4 v[204:207], v11, s[56:59], s61 offen
    s_add_u32 s61, s86, 2048
    buffer_load_dwordx4 v[208:211], v11, s[56:59], s61 offen
    s_add_u32 s61, s86, 4096
    buffer_load_dwordx4 v[212:215], v11, s[56:59], s61 offen
    s_add_u32 s61, s86, 0
    buffer_load_dwordx4 v[216:219], v11, s[56:59], s61 offen
    s_add_u32 s61, s86, 198656
    buffer_load_dwordx4 v[220:223], v11, s[56:59], s61 offen
    s_add_u32 s61, s86, 200704
    buffer_load_dwordx4 v[224:227], v11, s[56:59], s61 offen
    s_add_u32 s61, s86, 196608
    buffer_load_dwordx4 v[228:231], v11, s[56:59], s61 offen
    s_add_u32 s61, s87, 2048
    buffer_load_dwordx4 v[232:235], v11, s[56:59], s61 offen
    s_add_u32 s61, s87, 4096
    buffer_load_dwordx4 v[236:239], v11, s[56:59], s61 offen
    s_add_u32 s61, s87, 0
    buffer_load_dwordx4 v[240:243], v11, s[56:59], s61 offen
    s_add_u32 s61, s87, 198656
    buffer_load_dwordx4 v[244:247], v11, s[56:59], s61 offen
    s_add_u32 s61, s87, 200704
    buffer_load_dwordx4 v[248:251], v11, s[56:59], s61 offen
    s_add_u32 s61, s87, 196608
    buffer_load_dwordx4 v[252:255], v11, s[56:59], s61 offen
    s_waitcnt vmcnt(0)
    s_lshl_b32 s3, s21, 3
    s_add_u32 s3, s3, s16
    s_cmp_lg_u32 s3, 7
    s_cbranch_scc1 s_g3
    v_lshrrev_b32 v24, 4, v1
    v_and_b32 v25, 1, v24
    v_lshlrev_b32 v25, 4, v25
    v_mov_b32 v26, 0x3f80
    v_lshlrev_b32 v25, v25, v26
    v_bfe_u32 v26, v24, 1, 2
    v_cmp_eq_u32 vcc, 0, v26
    s_nop 1
    v_cndmask_b32 v140, 0, v25, vcc
    v_cmp_eq_u32 vcc, 1, v26
    s_nop 1
    v_cndmask_b32 v141, 0, v25, vcc
    v_cmp_eq_u32 vcc, 2, v26
    s_nop 1
    v_cndmask_b32 v142, 0, v25, vcc
    v_cmp_eq_u32 vcc, 3, v26
    s_nop 1
    v_cndmask_b32 v143, 0, v25, vcc
    v_bfe_u32 v25, v24, 3, 1
    v_lshrrev_b32 v26, 5, v24
    v_lshl_add_u32 v26, v26, 1, v25
    v_lshlrev_b32 v25, 8, v26
    v_and_b32 v27, 7, v24
    v_lshl_add_u32 v25, v27, 5, v25
    v_bfe_u32 v27, v24, 4, 1
    v_lshl_add_u32 v25, v27, 4, v25
    v_add_u32 v27, s18, v26
    v_and_b32 v27, 15, v27
    v_lshl_add_u32 v25, v27, 14, v25
    s_lshl_b32 s44, s17, 10
    s_add_u32 s44, s44, 52690944
    v_mfma_f32_16x16x32_bf16 v[128:131], v[140:143], v[32:35], 0
    v_mfma_f32_16x16x32_bf16 v[132:135], v[140:143], v[64:67], 0
    v_mfma_f32_16x16x32_bf16 v[136:139], v[140:143], v[96:99], 0
    v_mfma_f32_16x16x32_bf16 v[128:131], v[140:143], v[36:39], v[128:131]
    v_mfma_f32_16x16x32_bf16 v[132:135], v[140:143], v[68:71], v[132:135]
    v_mfma_f32_16x16x32_bf16 v[136:139], v[140:143], v[100:103], v[136:139]
    v_mfma_f32_16x16x32_bf16 v[128:131], v[140:143], v[40:43], v[128:131]
    v_mfma_f32_16x16x32_bf16 v[132:135], v[140:143], v[72:75], v[132:135]
    v_mfma_f32_16x16x32_bf16 v[136:139], v[140:143], v[104:107], v[136:139]
    v_mfma_f32_16x16x32_bf16 v[128:131], v[140:143], v[44:47], v[128:131]
    v_mfma_f32_16x16x32_bf16 v[132:135], v[140:143], v[76:79], v[132:135]
    v_mfma_f32_16x16x32_bf16 v[136:139], v[140:143], v[108:111], v[136:139]
    v_mfma_f32_16x16x32_bf16 v[128:131], v[140:143], v[48:51], v[128:131]
    v_mfma_f32_16x16x32_bf16 v[132:135], v[140:143], v[80:83], v[132:135]
    v_mfma_f32_16x16x32_bf16 v[136:139], v[140:143], v[112:115], v[136:139]
    v_mfma_f32_16x16x32_bf16 v[128:131], v[140:143], v[52:55], v[128:131]
    v_mfma_f32_16x16x32_bf16 v[132:135], v[140:143], v[84:87], v[132:135]
    v_mfma_f32_16x16x32_bf16 v[136:139], v[140:143], v[116:119], v[136:139]
    v_mfma_f32_16x16x32_bf16 v[128:131], v[140:143], v[56:59], v[128:131]
    v_mfma_f32_16x16x32_bf16 v[132:135], v[140:143], v[88:91], v[132:135]
    v_mfma_f32_16x16x32_bf16 v[136:139], v[140:143], v[120:123], v[136:139]
    v_mfma_f32_16x16x32_bf16 v[128:131], v[140:143], v[60:63], v[128:131]
    v_mfma_f32_16x16x32_bf16 v[132:135], v[140:143], v[92:95], v[132:135]
    v_mfma_f32_16x16x32_bf16 v[136:139], v[140:143], v[124:127], v[136:139]
    s_nop 5
    v_add_f32_dpp v128, v128, v128 row_ror:8 row_mask:0xf bank_mask:0xf
    v_add_f32_dpp v129, v129, v129 row_ror:8 row_mask:0xf bank_mask:0xf
    v_add_f32_dpp v130, v130, v130 row_ror:8 row_mask:0xf bank_mask:0xf
    v_add_f32_dpp v131, v131, v131 row_ror:8 row_mask:0xf bank_mask:0xf
    v_add_f32_dpp v132, v132, v132 row_ror:8 row_mask:0xf bank_mask:0xf
    v_add_f32_dpp v133, v133, v133 row_ror:8 row_mask:0xf bank_mask:0xf
    v_add_f32_dpp v134, v134, v134 row_ror:8 row_mask:0xf bank_mask:0xf
    v_add_f32_dpp v135, v135, v135 row_ror:8 row_mask:0xf bank_mask:0xf
    v_add_f32_dpp v136, v136, v136 row_ror:8 row_mask:0xf bank_mask:0xf
    v_add_f32_dpp v137, v137, v137 row_ror:8 row_mask:0xf bank_mask:0xf
    v_add_f32_dpp v138, v138, v138 row_ror:8 row_mask:0xf bank_mask:0xf
    v_add_f32_dpp v139, v139, v139 row_ror:8 row_mask:0xf bank_mask:0xf
    v_cmp_le_u32 vcc, 1, v26
    s_nop 1
    v_cndmask_b32 v128, v128, v132, vcc
    v_cndmask_b32 v129, v129, v133, vcc
    v_cndmask_b32 v130, v130, v134, vcc
    v_cndmask_b32 v131, v131, v135, vcc
    v_cmp_le_u32 vcc, 2, v26
    s_nop 1
    v_cndmask_b32 v128, v128, v136, vcc
    v_cndmask_b32 v129, v129, v137, vcc
    v_cndmask_b32 v130, v130, v138, vcc
    v_cndmask_b32 v131, v131, v139, vcc
    buffer_store_dwordx4 v[128:131], v25, s[4:7], s44 offen sc1
    s_waitcnt vmcnt(0)
    s_add_u32 s44, s18, 0
    s_and_b32 s44, s44, 15
    s_lshl_b32 s44, s44, 7
    s_add_u32 s44, s44, 2048
    s_atomic_add s40, s[22:23], s44
    s_add_u32 s45, s18, 1
    s_and_b32 s45, s45, 15
    s_lshl_b32 s45, s45, 7
    s_add_u32 s45, s45, 2048
    s_atomic_add s40, s[22:23], s45
    s_add_u32 s46, s18, 2
    s_and_b32 s46, s46, 15
    s_lshl_b32 s46, s46, 7
    s_add_u32 s46, s46, 2048
    s_atomic_add s40, s[22:23], s46
    s_branch s_g3
s_B:
    s_barrier
    s_cmp_eq_u32 s21, 3
    s_cbranch_scc1 s_nopf
    s_bitcmp0_b32 s21, 0
    s_cselect_b32 s56, s28, s24
    s_cselect_b32 s57, s29, s25
    s_mov_b32 s58, 6291456
    s_mov_b32 s59, 0x00020000
    s_add_u32 s61, s84, 2048
    buffer_load_dwordx4 v[160:163], v11, s[56:59], s61 offen
    s_add_u32 s61, s84, 4096
    buffer_load_dwordx4 v[164:167], v11, s[56:59], s61 offen
    s_add_u32 s61, s84, 0
    buffer_load_dwordx4 v[168:171], v11, s[56:59], s61 offen
    s_add_u32 s61, s84, 198656
    buffer_load_dwordx4 v[172:175], v11, s[56:59], s61 offen
    s_waitcnt vmcnt(2)
    s_add_u32 s61, s84, 200704
    buffer_load_dwordx4 v[176:179], v11, s[56:59], s61 offen
    s_add_u32 s61, s84, 196608
    buffer_load_dwordx4 v[180:183], v11, s[56:59], s61 offen
    s_add_u32 s61, s85, 2048
    buffer_load_dwordx4 v[184:187], v11, s[56:59], s61 offen
    s_add_u32 s61, s85, 4096
    buffer_load_dwordx4 v[188:191], v11, s[56:59], s61 offen
    s_waitcnt vmcnt(2)
    s_add_u32 s61, s85, 0
    buffer_load_dwordx4 v[192:195], v11, s[56:59], s61 offen
    s_add_u32 s61, s85, 198656
    buffer_load_dwordx4 v[196:199], v11, s[56:59], s61 offen
    s_add_u32 s61, s85, 200704
    buffer_load_dwordx4 v[200:203], v11, s[56:59], s61 offen
    s_add_u32 s61, s85, 196608
    buffer_load_dwordx4 v[204:207], v11, s[56:59], s61 offen
    s_waitcnt vmcnt(2)
    s_add_u32 s61, s86, 2048
    buffer_load_dwordx4 v[208:211], v11, s[56:59], s61 offen
    s_add_u32 s61, s86, 4096
    buffer_load_dwordx4 v[212:215], v11, s[56:59], s61 offen
    s_add_u32 s61, s86, 0
    buffer_load_dwordx4 v[216:219], v11, s[56:59], s61 offen
    s_add_u32 s61, s86, 198656
    buffer_load_dwordx4 v[220:223], v11, s[56:59], s61 offen
    s_waitcnt vmcnt(2)
    s_add_u32 s61, s86, 200704
    buffer_load_dwordx4 v[224:227], v11, s[56:59], s61 offen
    s_add_u32 s61, s86, 196608
    buffer_load_dwordx4 v[228:231], v11, s[56:59], s61 offen
    s_add_u32 s61, s87, 2048
    buffer_load_dwordx4 v[232:235], v11, s[56:59], s61 offen
    s_add_u32 s61, s87, 4096
    buffer_load_dwordx4 v[236:239], v11, s[56:59], s61 offen
    s_waitcnt vmcnt(2)
    s_add_u32 s61, s87, 0
    buffer_load_dwordx4 v[240:243], v11, s[56:59], s61 offen
    s_add_u32 s61, s87, 198656
    buffer_load_dwordx4 v[244:247], v11, s[56:59], s61 offen
    s_add_u32 s61, s87, 200704
    buffer_load_dwordx4 v[248:251], v11, s[56:59], s61 offen
    s_add_u32 s61, s87, 196608
    buffer_load_dwordx4 v[252:255], v11, s[56:59], s61 offen
    s_waitcnt vmcnt(2)
    s_lshl_b32 s3, s2, 2
    s_and_b32 s60, s16, 3
    s_add_u32 s60, s60, s3
    s_lshl_b32 s60, s60, 11
    buffer_load_dwordx4 v[96:99], v1, s[12:15], s60 offen offset:0
    buffer_load_dwordx4 v[100:103], v1, s[12:15], s60 offen offset:1024
s_nopf:
    s_setprio 3
    s_mov_b32 s52, 0
    s_lshl_b32 s44, s16, 14
    v_add_u32 v24, s44, v1
    s_and_b32 s3, s16, 3
    s_lshl_b32 s44, s3, 10
    s_add_u32 s44, s44, 147456
    v_lshrrev_b32 v25, 2, v1
    v_add_u32 v25, s44, v25
    s_lshl_b32 s53, s21, 22
    s_lshl_b32 s44, s38, 16
    s_add_u32 s53, s53, s44
    s_lshl_b32 s44, s18, 12
    s_add_u32 s53, s53, s44
    s_add_u32 s53, s53, 16777216
    s_lshl_b32 s54, s21, 14
    s_lshl_b32 s67, s38, 8
    s_add_u32 s54, s54, s67
    s_add_u32 s54, s54, 86016
s_bhead:
    s_barrier
    s_waitcnt vmcnt(0) lgkmcnt(0)
    s_barrier
    ds_read_b32 v28, v25 offset:0
    ds_read_b32 v29, v25 offset:256
    ds_read_b32 v30, v25 offset:512
    ds_read_b32 v31, v25 offset:768
    ds_read_b128 v[32:35], v24 offset:0
    ds_read_b128 v[36:39], v24 offset:1024
    ds_read_b128 v[40:43], v24 offset:2048
    ds_read_b128 v[44:47], v24 offset:3072
    ds_read_b128 v[48:51], v24 offset:4096
    ds_read_b128 v[52:55], v24 offset:5120
    ds_read_b128 v[56:59], v24 offset:6144
    ds_read_b128 v[60:63], v24 offset:7168
    ds_read_b128 v[64:67], v24 offset:8192
    ds_read_b128 v[68:71], v24 offset:9216
    ds_read_b128 v[72:75], v24 offset:10240
    ds_read_b128 v[76:79], v24 offset:11264
    ds_read_b128 v[80:83], v24 offset:12288
    ds_read_b128 v[84:87], v24 offset:13312
    ds_read_b128 v[88:91], v24 offset:14336
    ds_read_b128 v[92:95], v24 offset:15360
    s_waitcnt lgkmcnt(14)
    v_add_f32 v28, v28, v29
    v_add_f32 v30, v30, v31
    v_add_f32 v28, v28, v30
    v_mov_b32 v29, 0x5d800000
    v_mov_b32 v30, 0x21800000
    v_cmp_nlt_f32 s[44:45], v28, v29
    v_cmp_ngt_f32 vcc, v28, v30
    v_rcp_f32 v28, v28
    s_or_b64 vcc, vcc, s[44:45]
    s_waitcnt lgkmcnt(8)
    v_pk_add_f32 v[32:33], v[32:33], v[48:49]
    v_pk_add_f32 v[34:35], v[34:35], v[50:51]
    v_pk_add_f32 v[36:37], v[36:37], v[52:53]
    v_pk_add_f32 v[38:39], v[38:39], v[54:55]
    v_pk_add_f32 v[40:41], v[40:41], v[56:57]
    v_pk_add_f32 v[42:43], v[42:43], v[58:59]
    v_pk_add_f32 v[44:45], v[44:45], v[60:61]
    v_pk_add_f32 v[46:47], v[46:47], v[62:63]
    s_waitcnt lgkmcnt(4)
    v_pk_add_f32 v[32:33], v[32:33], v[64:65]
    v_pk_add_f32 v[34:35], v[34:35], v[66:67]
    v_pk_add_f32 v[36:37], v[36:37], v[68:69]
    v_pk_add_f32 v[38:39], v[38:39], v[70:71]
    v_pk_add_f32 v[40:41], v[40:41], v[72:73]
    v_pk_add_f32 v[42:43], v[42:43], v[74:75]
    v_pk_add_f32 v[44:45], v[44:45], v[76:77]
    v_pk_add_f32 v[46:47], v[46:47], v[78:79]
    s_waitcnt lgkmcnt(0)
    v_pk_add_f32 v[32:33], v[32:33], v[80:81]
    v_pk_add_f32 v[34:35], v[34:35], v[82:83]
    v_pk_add_f32 v[36:37], v[36:37], v[84:85]
    v_pk_add_f32 v[38:39], v[38:39], v[86:87]
    v_pk_add_f32 v[40:41], v[40:41], v[88:89]
    v_pk_add_f32 v[42:43], v[42:43], v[90:91]
    v_pk_add_f32 v[44:45], v[44:45], v[92:93]
    v_pk_add_f32 v[46:47], v[46:47], v[94:95]
    s_cbranch_vccnz s_slow
s_fin:
    v_pk_mul_f32 v[32:33], v[28:29], v[32:33] op_sel_hi:[0,1]
    v_pk_mul_f32 v[34:35], v[28:29], v[34:35] op_sel_hi:[0,1]
    v_pk_mul_f32 v[36:37], v[28:29], v[36:37] op_sel_hi:[0,1]
    v_pk_mul_f32 v[38:39], v[28:29], v[38:39] op_sel_hi:[0,1]
    v_pk_mul_f32 v[40:41], v[28:29], v[40:41] op_sel_hi:[0,1]
    v_pk_mul_f32 v[42:43], v[28:29], v[42:43] op_sel_hi:[0,1]
    v_pk_mul_f32 v[44:45], v[28:29], v[44:45] op_sel_hi:[0,1]
    v_pk_mul_f32 v[46:47], v[28:29], v[46:47] op_sel_hi:[0,1]
    v_cvt_pk_bf16_f32 v32, v32, v33
    v_cvt_pk_bf16_f32 v33, v34, v35
    v_cvt_pk_bf16_f32 v34, v36, v37
    v_cvt_pk_bf16_f32 v35, v38, v39
    v_cvt_pk_bf16_f32 v36, v40, v41
    v_cvt_pk_bf16_f32 v37, v42, v43
    v_cvt_pk_bf16_f32 v38, v44, v45
    v_cvt_pk_bf16_f32 v39, v46, v47
    buffer_store_dwordx4 v[32:35], v1, s[4:7], s53 offen offset:0 sc1
    buffer_store_dwordx4 v[36:39], v1, s[4:7], s53 offen offset:1024 sc1
    s_cmp_lg_u32 s52, 0
    s_cbranch_scc1 s_b2
    s_waitcnt vmcnt(0)
    s_atomic_add s40, s[22:23], s54
    s_mov_b32 s52, 1
    s_add_u32 s53, s53, 2048
    s_waitcnt lgkmcnt(0)
    s_add_u32 s54, s54, 128
    s_setprio 0
    s_and_b32 s3, s16, 3
    s_lshl_b32 s46, s3, 19
    s_lshl_b32 s45, s3, 14
    s_and_b32 s3, s18, 0
    s_lshl_b32 s3, s3, 17
    s_xor_b32 s46, s46, s3
    s_add_u32 m0, s45, 0
    s_xor_b32 s44, s46, 0
    buffer_load_dwordx4 v16, s[12:15], s44 offen offset:0 lds
    buffer_load_dwordx4 v17, s[12:15], s44 offen offset:1024 lds
    buffer_load_dwordx4 v18, s[12:15], s44 offen offset:2048 lds
    buffer_load_dwordx4 v19, s[12:15], s44 offen offset:3072 lds
    s_add_u32 s44, s44, 65536
    s_waitcnt vmcnt(2)
    buffer_load_dwordx4 v[96:99], v16, s[12:15], s44 offen offset:0
    buffer_load_dwordx4 v[100:103], v17, s[12:15], s44 offen offset:1024
    buffer_load_dwordx4 v[104:107], v18, s[12:15], s44 offen offset:2048
    buffer_load_dwordx4 v[108:111], v19, s[12:15], s44 offen offset:3072
    s_waitcnt vmcnt(2)
    s_add_u32 m0, s45, 4096
    s_xor_b32 s44, s46, 131072
    buffer_load_dwordx4 v16, s[12:15], s44 offen offset:0 lds
    buffer_load_dwordx4 v17, s[12:15], s44 offen offset:1024 lds
    buffer_load_dwordx4 v18, s[12:15], s44 offen offset:2048 lds
    buffer_load_dwordx4 v19, s[12:15], s44 offen offset:3072 lds
    s_add_u32 s44, s44, 65536
    s_waitcnt vmcnt(2)
    buffer_load_dwordx4 v[112:115], v16, s[12:15], s44 offen offset:0
    buffer_load_dwordx4 v[116:119], v17, s[12:15], s44 offen offset:1024
    buffer_load_dwordx4 v[120:123], v18, s[12:15], s44 offen offset:2048
    buffer_load_dwordx4 v[124:127], v19, s[12:15], s44 offen offset:3072
    s_waitcnt vmcnt(2)
    s_add_u32 m0, s45, 8192
    s_xor_b32 s44, s46, 262144
    buffer_load_dwordx4 v16, s[12:15], s44 offen offset:0 lds
    buffer_load_dwordx4 v17, s[12:15], s44 offen offset:1024 lds
    buffer_load_dwordx4 v18, s[12:15], s44 offen offset:2048 lds
    buffer_load_dwordx4 v19, s[12:15], s44 offen offset:3072 lds
    s_add_u32 s44, s44, 65536
    s_waitcnt vmcnt(2)
    buffer_load_dwordx4 v[128:131], v16, s[12:15], s44 offen offset:0
    buffer_load_dwordx4 v[132:135], v17, s[12:15], s44 offen offset:1024
    buffer_load_dwordx4 v[136:139], v18, s[12:15], s44 offen offset:2048
    buffer_load_dwordx4 v[140:143], v19, s[12:15], s44 offen offset:3072
    s_waitcnt vmcnt(2)
    s_add_u32 m0, s45, 12288
    s_xor_b32 s44, s46, 393216
    buffer_load_dwordx4 v16, s[12:15], s44 offen offset:0 lds
    buffer_load_dwordx4 v17, s[12:15], s44 offen offset:1024 lds
    buffer_load_dwordx4 v18, s[12:15], s44 offen offset:2048 lds
    buffer_load_dwordx4 v19, s[12:15], s44 offen offset:3072 lds
    s_add_u32 s44, s44, 65536
    s_waitcnt vmcnt(2)
    buffer_load_dwordx4 v[144:147], v16, s[12:15], s44 offen offset:0
    buffer_load_dwordx4 v[148:151], v17, s[12:15], s44 offen offset:1024
    buffer_load_dwordx4 v[152:155], v18, s[12:15], s44 offen offset:2048
    buffer_load_dwordx4 v[156:159], v19, s[12:15], s44 offen offset:3072
    s_waitcnt vmcnt(2)
    s_setprio 3
    s_sub_u32 s44, s54, 128
    s_mov_b32 s66, 0x10000
s_o0_poll:
    s_mov_b32 s68, 0
    s_atomic_add s68, s[22:23], s44 offset:0 glc
    s_sub_u32 s66, s66, 1
    s_cselect_b32 s67, 16, 0
    s_waitcnt lgkmcnt(0)
    s_max_u32 s68, s68, s67
    s_cmp_lt_u32 s68, 16
    s_cbranch_scc1 s_o0_poll
s_o0_ok:
    s_branch s_bhead
s_b2:
    ds_write_b128 v24, v[96:99] offset:0
    ds_write_b128 v24, v[100:103] offset:1024
    ds_write_b128 v24, v[104:107] offset:2048
    ds_write_b128 v24, v[108:111] offset:3072
    ds_write_b128 v24, v[112:115] offset:4096
    ds_write_b128 v24, v[116:119] offset:5120
    ds_write_b128 v24, v[120:123] offset:6144
    ds_write_b128 v24, v[124:127] offset:7168
    ds_write_b128 v24, v[128:131] offset:8192
    ds_write_b128 v24, v[132:135] offset:9216
    ds_write_b128 v24, v[136:139] offset:10240
    ds_write_b128 v24, v[140:143] offset:11264
    ds_write_b128 v24, v[144:147] offset:12288
    ds_write_b128 v24, v[148:151] offset:13312
    ds_write_b128 v24, v[152:155] offset:14336
    ds_write_b128 v24, v[156:159] offset:15360
    s_mov_b32 s68, 1
    s_waitcnt vmcnt(0)
    s_atomic_add s68, s[22:23], s54 glc
    s_mov_b32 s66, 0x10000
    s_waitcnt lgkmcnt(0)
    s_cmp_eq_u32 s68, 15
    s_cbranch_scc1 s_o1_ok
s_o1_poll:
    s_mov_b32 s68, 0
    s_atomic_add s68, s[22:23], s54 offset:0 glc
    s_sub_u32 s66, s66, 1
    s_cselect_b32 s67, 16, 0
    s_waitcnt lgkmcnt(0)
    s_max_u32 s68, s68, s67
    s_cmp_lt_u32 s68, 16
    s_cbranch_scc1 s_o1_poll
s_o1_ok:
s_b3:
    s_setprio 0
    s_waitcnt lgkmcnt(0)
s_g3:
    s_barrier
    s_cmp_eq_u32 s21, 3
    s_cbranch_scc1 s_end
    s_barrier
    ds_write_b128 v9, v[160:163] offset:0
    ds_write_b128 v9, v[164:167] offset:4096
    ds_write_b128 v9, v[168:171] offset:8192
    ds_write_b128 v9, v[172:175] offset:12288
    ds_write_b128 v9, v[176:179] offset:16384
    ds_write_b128 v9, v[180:183] offset:20480
    ds_write_b128 v9, v[184:187] offset:24576
    ds_write_b128 v9, v[188:191] offset:28672
    s_add_u32 s21, s21, 1
    s_bitcmp1_b32 s21, 0
    s_cselect_b32 s8, s28, s24
    s_cselect_b32 s9, s29, s25
    s_cselect_b32 s12, s30, s26
    s_cselect_b32 s13, s31, s27
    s_mov_b32 s10, 6291456
    s_mov_b32 s11, 0x00020000
    s_mov_b32 s14, 2097152
    s_mov_b32 s15, 0x00020000
    s_sub_u32 s3, s16, 5
    s_cmp_gt_u32 s3, 1
    s_cbranch_scc1 s_n67
    s_add_u32 m0, s41, 98304
    s_add_u32 s44, s88, 2048
    buffer_load_dwordx4 v14, s[8:11], s44 offen offset:0 lds
    buffer_load_dwordx4 v15, s[8:11], s44 offen offset:1024 lds
    s_add_u32 m0, s41, 102400
    s_add_u32 s44, s88, 4096
    buffer_load_dwordx4 v14, s[8:11], s44 offen offset:0 lds
    buffer_load_dwordx4 v15, s[8:11], s44 offen offset:1024 lds
    s_add_u32 m0, s41, 106496
    s_add_u32 s44, s88, 0
    buffer_load_dwordx4 v14, s[8:11], s44 offen offset:0 lds
    buffer_load_dwordx4 v15, s[8:11], s44 offen offset:1024 lds
    s_add_u32 m0, s41, 110592
    s_add_u32 s44, s88, 198656
    buffer_load_dwordx4 v14, s[8:11], s44 offen offset:0 lds
    buffer_load_dwordx4 v15, s[8:11], s44 offen offset:1024 lds
    s_add_u32 m0, s41, 114688
    s_add_u32 s44, s88, 200704
    buffer_load_dwordx4 v14, s[8:11], s44 offen offset:0 lds
    buffer_load_dwordx4 v15, s[8:11], s44 offen offset:1024 lds
    s_add_u32 m0, s41, 118784
    s_add_u32 s44, s88, 196608
    buffer_load_dwordx4 v14, s[8:11], s44 offen offset:0 lds
    buffer_load_dwordx4 v15, s[8:11], s44 offen offset:1024 lds
    s_add_u32 m0, s41, 122880
    s_add_u32 s44, s89, 2048
    buffer_load_dwordx4 v14, s[8:11], s44 offen offset:0 lds
    buffer_load_dwordx4 v15, s[8:11], s44 offen offset:1024 lds
    s_add_u32 m0, s41, 126976
    s_add_u32 s44, s89, 4096
    buffer_load_dwordx4 v14, s[8:11], s44 offen offset:0 lds
    buffer_load_dwordx4 v15, s[8:11], s44 offen offset:1024 lds
s_n67:
    s_waitcnt lgkmcnt(0)
    s_barrier
    ds_write_b128 v9, v[192:195] offset:32768
    ds_write_b128 v9, v[196:199] offset:36864
    ds_write_b128 v9, v[200:203] offset:40960
    ds_write_b128 v9, v[204:207] offset:45056
    ds_write_b128 v9, v[208:211] offset:49152
    ds_write_b128 v9, v[212:215] offset:53248
    ds_write_b128 v9, v[216:219] offset:57344
    ds_write_b128 v9, v[220:223] offset:61440
    ds_write_b128 v10, v[224:227] offset:0
    ds_write_b128 v10, v[228:231] offset:4096
    ds_write_b128 v10, v[232:235] offset:8192
    ds_write_b128 v10, v[236:239] offset:12288
    ds_write_b128 v10, v[240:243] offset:16384
    ds_write_b128 v10, v[244:247] offset:20480
    ds_write_b128 v10, v[248:251] offset:24576
    ds_write_b128 v10, v[252:255] offset:28672
    s_cmp_eq_u32 s16, 4
    s_cbranch_scc1 h_layer
    s_cmp_eq_u32 s16, 7
    s_cbranch_scc1 z_layer
    s_branch l_layer
s_end:
    s_lshl_b32 s3, s2, 3
    s_add_u32 s3, s3, s16
    s_cmp_lg_u32 s3, 7
    s_cbranch_scc1 k_exit
    s_mov_b32 s8, s34
    s_mov_b32 s9, s35
    s_mov_b32 s10, 256
    s_mov_b32 s11, 0x00020000
    v_lshrrev_b32 v24, 2, v1
    v_mov_b32 v25, 0
    buffer_store_dword v25, v24, s[8:11], 0 offen sc1
    s_branch k_exit
s_slow:
    s_and_b32 s3, s16, 3
    s_lshl_b32 s44, s3, 11
    s_lshl_b32 s45, s52, 13
    s_add_u32 s44, s44, s45
    s_add_u32 s44, s44, 131072
    v_add_u32 v26, s44, v1
    ds_read_b128 v[48:51], v26 offset:0
    ds_read_b128 v[52:55], v26 offset:1024
    s_lshr_b32 s55, s21, 1
    s_lshl_b32 s55, s55, 23
    s_lshl_b32 s44, s18, 18
    s_add_u32 s55, s55, s44
    s_lshl_b32 s44, s52, 17
    s_add_u32 s55, s55, s44
    s_add_u32 s55, s55, 33554432
    s_waitcnt lgkmcnt(0)
    v_mov_b32 v26, 0xff800000
    s_mov_b32 s61, 0
s_slow1:
    s_add_u32 s44, s55, s61
    buffer_load_dwordx4 v[56:59], v1, s[4:7], s44 offen offset:0 sc1
    buffer_load_dwordx4 v[60:63], v1, s[4:7], s44 offen offset:1024 sc1
    s_waitcnt vmcnt(0)
    v_mfma_f32_32x32x16_bf16 v[72:87], v[56:59], v[48:51], 0
    v_mfma_f32_32x32x16_bf16 v[72:87], v[60:63], v[52:55], v[72:87]
    s_nop 11
    v_max3_f32 v26, v26, v72, v73
    v_max3_f32 v26, v26, v74, v75
    v_max3_f32 v26, v26, v76, v77
    v_max3_f32 v26, v26, v78, v79
    v_max3_f32 v26, v26, v80, v81
    v_max3_f32 v26, v26, v82, v83
    v_max3_f32 v26, v26, v84, v85
    v_max3_f32 v26, v26, v86, v87
    s_add_u32 s61, s61, 2048
    s_cmp_lt_u32 s61, 131072
    s_cbranch_scc1 s_slow1
    v_mov_b32 v27, v26
    s_nop 1
    v_permlane32_swap_b32 v26, v27
    v_max_f32 v26, v26, v27
    v_mov_b32 v32, 0
    v_mov_b32 v33, 0
    v_mov_b32 v34, 0
    v_mov_b32 v35, 0
    v_mov_b32 v36, 0
    v_mov_b32 v37, 0
    v_mov_b32 v38, 0
    v_mov_b32 v39, 0
    v_mov_b32 v40, 0
    v_mov_b32 v41, 0
    v_mov_b32 v42, 0
    v_mov_b32 v43, 0
    v_mov_b32 v44, 0
    v_mov_b32 v45, 0
    v_mov_b32 v46, 0
    v_mov_b32 v47, 0
    v_mov_b32 v28, 0
    v_mov_b32 v29, 0xdddddddd
    s_mov_b32 s3, 0xffff0000
    s_mov_b32 s61, 0
s_slow2:
    s_add_u32 s44, s55, s61
    buffer_load_dwordx4 v[56:59], v1, s[4:7], s44 offen offset:0 sc1
    buffer_load_dwordx4 v[60:63], v1, s[4:7], s44 offen offset:1024 sc1
    s_add_u32 s44, s44, 4194304
    buffer_load_dwordx4 v[64:67], v1, s[4:7], s44 offen offset:0 sc1
    buffer_load_dwordx4 v[68:71], v1, s[4:7], s44 offen offset:1024 sc1
    s_waitcnt vmcnt(0)
    v_mfma_f32_32x32x16_bf16 v[72:87], v[56:59], v[48:51], 0
    v_mfma_f32_32x32x16_bf16 v[72:87], v[60:63], v[52:55], v[72:87]
    s_nop 11
    v_sub_f32 v72, v72, v26
    v_sub_f32 v73, v73, v26
    v_sub_f32 v74, v74, v26
    v_sub_f32 v75, v75, v26
    v_sub_f32 v76, v76, v26
    v_sub_f32 v77, v77, v26
    v_sub_f32 v78, v78, v26
    v_sub_f32 v79, v79, v26
    v_sub_f32 v80, v80, v26
    v_sub_f32 v81, v81, v26
    v_sub_f32 v82, v82, v26
    v_sub_f32 v83, v83, v26
    v_sub_f32 v84, v84, v26
    v_sub_f32 v85, v85, v26
    v_sub_f32 v86, v86, v26
    v_sub_f32 v87, v87, v26
    v_exp_f32 v72, v72
    v_exp_f32 v73, v73
    v_exp_f32 v74, v74
    v_exp_f32 v75, v75
    v_exp_f32 v76, v76
    v_exp_f32 v77, v77
    v_exp_f32 v78, v78
    v_exp_f32 v79, v79
    v_exp_f32 v80, v80
    v_exp_f32 v81, v81
    v_exp_f32 v82, v82
    v_exp_f32 v83, v83
    v_exp_f32 v84, v84
    v_exp_f32 v85, v85
    v_exp_f32 v86, v86
    v_exp_f32 v87, v87
    v_and_b32 v72, s3, v72
    v_and_b32 v73, s3, v73
    v_and_b32 v74, s3, v74
    v_and_b32 v75, s3, v75
    v_and_b32 v76, s3, v76
    v_and_b32 v77, s3, v77
    v_and_b32 v78, s3, v78
    v_and_b32 v79, s3, v79
    v_and_b32 v80, s3, v80
    v_and_b32 v81, s3, v81
    v_and_b32 v82, s3, v82
    v_and_b32 v83, s3, v83
    v_and_b32 v84, s3, v84
    v_and_b32 v85, s3, v85
    v_and_b32 v86, s3, v86
    v_and_b32 v87, s3, v87
    v_add_f32 v28, v28, v72
    v_add_f32 v28, v28, v73
    v_add_f32 v28, v28, v74
    v_add_f32 v28, v28, v75
    v_add_f32 v28, v28, v76
    v_add_f32 v28, v28, v77
    v_add_f32 v28, v28, v78
    v_add_f32 v28, v28, v79
    v_add_f32 v28, v28, v80
    v_add_f32 v28, v28, v81
    v_add_f32 v28, v28, v82
    v_add_f32 v28, v28, v83
    v_add_f32 v28, v28, v84
    v_add_f32 v28, v28, v85
    v_add_f32 v28, v28, v86
    v_add_f32 v28, v28, v87
    v_smfmac_f32_32x32x32_bf16 v[32:47], v[64:67], v[72:79], v29
    v_smfmac_f32_32x32x32_bf16 v[32:47], v[68:71], v[80:87], v29
    s_add_u32 s61, s61, 2048
    s_cmp_lt_u32 s61, 131072
    s_cbranch_scc1 s_slow2
    v_mov_b32 v29, v28
    s_nop 1
    v_permlane32_swap_b32 v28, v29
    v_add_f32 v28, v28, v29
    v_rcp_f32 v28, v28
    s_nop 7
    s_branch s_fin
k_exit:
    s_endpgm
.if k_exit - interleave_layers__sliding_local_dilated__softmax_full_mha__prompt_kernel < 49152
.error "code prefetch reads past the end of the code"
.endif
.section .rodata,"a"
.p2align 6
.amdhsa_kernel interleave_layers__sliding_local_dilated__softmax_full_mha__prompt_kernel
  .amdhsa_next_free_vgpr 256
  .amdhsa_next_free_sgpr 102
  .amdhsa_accum_offset 256
  .amdhsa_group_segment_fixed_size 0
  .amdhsa_kernarg_size 72
  .amdhsa_user_sgpr_count 2
  .amdhsa_user_sgpr_kernarg_segment_ptr 1
  .amdhsa_system_sgpr_workgroup_id_x 1
.end_amdhsa_kernel
```

```asm
; @launch grid=(256,1,1) block=(512,1,1) lds=156736
.amdgcn_target "amdgcn-amd-amdhsa--gfx950"
.text
.globl interleave_layers__sliding_local_dilated__softmax_full_mha__prompt_kernel
.type interleave_layers__sliding_local_dilated__softmax_full_mha__prompt_kernel,@function
.p2align 8
interleave_layers__sliding_local_dilated__softmax_full_mha__prompt_kernel:
    s_cmp_ge_u32 s2, 256
    s_cbranch_scc1 k_exit
    s_load_dwordx2 s[36:37], s[0:1], 0
    s_load_dwordx4 s[24:27], s[0:1], 8
    s_load_dwordx8 s[28:35], s[0:1], 32
    s_load_dwordx2 s[44:45], s[0:1], 64
    v_lshrrev_b32 v2, 6, v0
    v_and_b32 v0, 63, v0
    v_readfirstlane_b32 s16, v2
    v_lshlrev_b32 v1, 4, v0
    s_mov_b32 s21, 0
    s_mov_b32 s40, 1
    s_and_b32 s3, s2, 1
    s_lshl_b32 s3, s3, 3
    s_bfe_u32 s17, s2, 0x30003
    s_add_u32 s17, s17, s3
    s_bfe_u32 s3, s2, 0x20001
    s_lshl_b32 s3, s3, 2
    s_lshr_b32 s18, s2, 6
    s_add_u32 s18, s18, s3
    s_and_b32 s3, s16, 3
    s_lshl_b32 s38, s17, 2
    s_add_u32 s38, s38, s3
    v_lshrrev_b32 v32, 3, v0
    v_and_b32 v33, 7, v0
    v_lshlrev_b32 v34, 11, v32
    v_lshl_add_u32 v34, v33, 4, v34
    s_lshl_b32 s46, s38, 16
    s_lshl_b32 s47, s18, 7
    s_add_u32 s46, s46, s47
    s_getpc_b64 s[76:77]
e_pc:
    s_sub_u32 s76, s76, e_pc - interleave_layers__sliding_local_dilated__softmax_full_mha__prompt_kernel
    s_subb_u32 s77, s77, 0
    s_and_b32 s3, s2, 0xf8
    s_add_u32 s3, s3, s16
    s_lshl_b32 s3, s3, 6
    s_add_u32 s78, s3, 49152
    s_min_u32 s78, s78, k_exit - interleave_layers__sliding_local_dilated__softmax_full_mha__prompt_kernel
    s_waitcnt lgkmcnt(0)
    s_mov_b32 s8, s36
    s_mov_b32 s9, s37
    s_mov_b32 s10, 4194304
    s_mov_b32 s11, 0x00020000
    s_cmp_gt_u32 s16, 3
    s_cbranch_scc1 e_side
    buffer_load_dwordx4 v[40:43], v34, s[8:11], s46 offen
    s_add_u32 s46, s46, 16384
    buffer_load_dwordx4 v[44:47], v34, s[8:11], s46 offen
    s_add_u32 s46, s46, 16384
    buffer_load_dwordx4 v[48:51], v34, s[8:11], s46 offen
    s_add_u32 s46, s46, 16384
    buffer_load_dwordx4 v[52:55], v34, s[8:11], s46 offen
e_side:
    s_load_dword s80, s[76:77], s3 offset:0
    s_load_dword s81, s[76:77], s3 offset:16384
    s_load_dword s82, s[76:77], s3 offset:32768
    s_load_dword s83, s[76:77], s78
    s_mov_b32 s4, s44
    s_mov_b32 s5, s45
    s_mov_b32 s6, 67108864
    s_mov_b32 s7, 0x00020000
    s_add_u32 s22, s44, 58720256
    s_addc_u32 s23, s45, 0
    s_load_dword s100, s[22:23], 217088
    s_cmp_gt_u32 s16, 3
    s_cbranch_scc1 s_start
    v_lshrrev_b32 v8, 4, v1
    s_lshl_b32 s44, s38, 16
    v_xor_b32 v88, v33, v32
    v_lshlrev_b32 v88, 4, v88
    v_lshl_add_u32 v88, v32, 11, v88
    v_xor_b32 v89, 16, v88
    v_add_u32 v89, 15360, v89
    v_add_u32 v90, 30720, v88
    v_add_u32 v91, 30720, v89
    s_mul_i32 s76, s16, 16384
    s_add_u32 s76, s76, 61440
    s_lshl_b32 s77, s38, 16
    s_mul_i32 s84, s18, 4096
    s_cmp_lt_u32 s18, 4
    s_cselect_b32 s85, 4, 0
    s_mul_i32 s85, s85, 4096
    s_cmp_lt_u32 s18, 4
    s_cselect_b32 s86, 5, 1
    s_mul_i32 s86, s86, 4096
    s_cmp_lt_u32 s18, 4
    s_cselect_b32 s87, 6, 2
    s_mul_i32 s87, s87, 4096
    s_cmp_lt_u32 s18, 4
    s_cselect_b32 s88, 7, 3
    s_mul_i32 s88, s88, 4096
    s_cmp_lt_u32 s18, 8
    s_cselect_b32 s89, 8, 4
    s_mul_i32 s89, s89, 4096
    s_cmp_lt_u32 s18, 8
    s_cselect_b32 s90, 9, 5
    s_mul_i32 s90, s90, 4096
    s_cmp_lt_u32 s18, 8
    s_cselect_b32 s91, 10, 6
    s_mul_i32 s91, s91, 4096
    s_cmp_lt_u32 s18, 8
    s_cselect_b32 s92, 11, 7
    s_mul_i32 s92, s92, 4096
    s_cmp_lt_u32 s18, 12
    s_cselect_b32 s93, 12, 8
    s_mul_i32 s93, s93, 4096
    s_cmp_lt_u32 s18, 12
    s_cselect_b32 s94, 13, 9
    s_mul_i32 s94, s94, 4096
    s_cmp_lt_u32 s18, 12
    s_cselect_b32 s95, 14, 10
    s_mul_i32 s95, s95, 4096
    s_cmp_lt_u32 s18, 12
    s_cselect_b32 s96, 15, 11
    s_mul_i32 s96, s96, 4096
    s_xor_b32 s97, s18, 1
    s_mul_i32 s97, s97, 4096
    s_xor_b32 s98, s18, 2
    s_mul_i32 s98, s98, 4096
    s_xor_b32 s99, s18, 3
    s_mul_i32 s99, s99, 4096
    s_lshr_b32 s3, s18, 2
    s_lshl_b32 s3, s3, 3
    s_lshl_b32 s63, 1, s3
    s_lshl_b32 s3, s63, 2
    s_andn2_b32 s19, 67372036, s3
    v_lshrrev_b32 v12, 4, v1
    v_and_b32 v13, 15, v12
    v_bfe_u32 v14, v12, 4, 1
    v_lshrrev_b32 v12, 5, v12
    v_lshl_add_u32 v2, v14, 5, v13
    v_lshlrev_b32 v2, 4, v2
    v_lshl_add_u32 v2, v12, 10, v2
    v_lshrrev_b32 v15, 2, v13
    v_lshl_add_u32 v15, v14, 2, v15
    v_lshlrev_b32 v3, 7, v15
    v_lshl_add_u32 v3, v12, 11, v3
    v_and_b32 v15, 3, v13
    v_lshl_add_u32 v3, v15, 3, v3
    v_lshrrev_b32 v15, 3, v13
    v_lshl_add_u32 v15, v15, 1, v14
    v_lshl_add_u32 v3, v15, 5, v3
    v_xor_b32 v4, 32, v3
    v_xor_b32 v5, 64, v3
    v_xor_b32 v6, 96, v3
    s_lshl_b32 s45, s16, 12
    s_add_u32 s45, s45, 131072
    v_lshrrev_b32 v35, 1, v33
    v_lshlrev_b32 v35, 10, v35
    v_lshl_add_u32 v35, v32, 4, v35
    v_and_b32 v36, 1, v33
    v_lshl_add_u32 v35, v36, 3, v35
    v_add_u32 v35, s45, v35
    v_add_u32 v36, s45, v1
    v_mov_b32 v37, 0x3f803f80
    v_and_b32 v38, 3, v8
    v_lshl_add_u32 v39, v38, 3, v32
    v_lshlrev_b32 v39, 3, v39
    v_mov_b32 v56, 0
    v_mov_b32 v57, 0
    v_mov_b32 v58, 0
    v_mov_b32 v59, 0
    v_mov_b32 v60, 0
    v_mov_b32 v61, 0
    v_mov_b32 v62, 0
    v_mov_b32 v63, 0
    s_waitcnt vmcnt(3)
    ds_write_b64 v35, v[40:41] offset:0
    ds_write_b64 v35, v[42:43] offset:512
    s_waitcnt vmcnt(2)
    ds_write_b64 v35, v[44:45] offset:128
    ds_write_b64 v35, v[46:47] offset:640
    s_waitcnt vmcnt(1)
    ds_write_b64 v35, v[48:49] offset:256
    ds_write_b64 v35, v[50:51] offset:768
    s_waitcnt vmcnt(0)
    ds_write_b64 v35, v[52:53] offset:384
    ds_write_b64 v35, v[54:55] offset:896
    ds_read_b128 v[64:67], v36 offset:0
    ds_read_b128 v[68:71], v36 offset:1024
    ds_read_b128 v[72:75], v36 offset:2048
    ds_read_b128 v[76:79], v36 offset:3072
    s_lshl_b32 s45, s18, 12
    s_add_u32 s46, s44, s45
    s_waitcnt lgkmcnt(3)
    buffer_store_dwordx4 v[64:67], v1, s[4:7], s46 offen offset:0 sc1
    s_waitcnt lgkmcnt(2)
    buffer_store_dwordx4 v[68:71], v1, s[4:7], s46 offen offset:1024 sc1
    s_waitcnt lgkmcnt(1)
    buffer_store_dwordx4 v[72:75], v1, s[4:7], s46 offen offset:2048 sc1
    s_waitcnt lgkmcnt(0)
    buffer_store_dwordx4 v[76:79], v1, s[4:7], s46 offen offset:3072 sc1
    s_add_u32 m0, s76, 4096
    s_lshr_b32 s78, s85, 5
    s_add_u32 s78, s78, s77
    buffer_load_dwordx4 v88, s[8:11], s78 offen offset:0 lds
    buffer_load_dwordx4 v89, s[8:11], s78 offen offset:1024 lds
    buffer_load_dwordx4 v90, s[8:11], s78 offen offset:2048 lds
    buffer_load_dwordx4 v91, s[8:11], s78 offen offset:3072 lds
    s_add_u32 m0, s76, 8192
    s_lshr_b32 s78, s86, 5
    s_add_u32 s78, s78, s77
    buffer_load_dwordx4 v88, s[8:11], s78 offen offset:0 lds
    buffer_load_dwordx4 v89, s[8:11], s78 offen offset:1024 lds
    buffer_load_dwordx4 v90, s[8:11], s78 offen offset:2048 lds
    buffer_load_dwordx4 v91, s[8:11], s78 offen offset:3072 lds
    s_add_u32 m0, s76, 12288
    s_lshr_b32 s78, s87, 5
    s_add_u32 s78, s78, s77
    buffer_load_dwordx4 v88, s[8:11], s78 offen offset:0 lds
    buffer_load_dwordx4 v89, s[8:11], s78 offen offset:1024 lds
    buffer_load_dwordx4 v90, s[8:11], s78 offen offset:2048 lds
    buffer_load_dwordx4 v91, s[8:11], s78 offen offset:3072 lds
    s_add_u32 m0, s76, 16384
    s_lshr_b32 s78, s88, 5
    s_add_u32 s78, s78, s77
    buffer_load_dwordx4 v88, s[8:11], s78 offen offset:0 lds
    buffer_load_dwordx4 v89, s[8:11], s78 offen offset:1024 lds
    buffer_load_dwordx4 v90, s[8:11], s78 offen offset:2048 lds
    buffer_load_dwordx4 v91, s[8:11], s78 offen offset:3072 lds
    v_dot2_f32_bf16 v56, v40, v37, v56
    v_dot2_f32_bf16 v57, v40, v40, v57
    v_dot2_f32_bf16 v58, v44, v37, v58
    v_dot2_f32_bf16 v59, v44, v44, v59
    v_dot2_f32_bf16 v60, v48, v37, v60
    v_dot2_f32_bf16 v61, v48, v48, v61
    v_dot2_f32_bf16 v62, v52, v37, v62
    v_dot2_f32_bf16 v63, v52, v52, v63
    v_dot2_f32_bf16 v56, v41, v37, v56
    v_dot2_f32_bf16 v57, v41, v41, v57
    v_dot2_f32_bf16 v58, v45, v37, v58
    v_dot2_f32_bf16 v59, v45, v45, v59
    v_dot2_f32_bf16 v60, v49, v37, v60
    v_dot2_f32_bf16 v61, v49, v49, v61
    v_dot2_f32_bf16 v62, v53, v37, v62
    v_dot2_f32_bf16 v63, v53, v53, v63
    v_dot2_f32_bf16 v56, v42, v37, v56
    v_dot2_f32_bf16 v57, v42, v42, v57
    v_dot2_f32_bf16 v58, v46, v37, v58
    v_dot2_f32_bf16 v59, v46, v46, v59
    v_dot2_f32_bf16 v60, v50, v37, v60
    v_dot2_f32_bf16 v61, v50, v50, v61
    v_dot2_f32_bf16 v62, v54, v37, v62
    v_dot2_f32_bf16 v63, v54, v54, v63
    v_dot2_f32_bf16 v56, v43, v37, v56
    v_dot2_f32_bf16 v57, v43, v43, v57
    v_dot2_f32_bf16 v58, v47, v37, v58
    v_dot2_f32_bf16 v59, v47, v47, v59
    v_dot2_f32_bf16 v60, v51, v37, v60
    v_dot2_f32_bf16 v61, v51, v51, v61
    v_dot2_f32_bf16 v62, v55, v37, v62
    v_dot2_f32_bf16 v63, v55, v55, v63
    s_nop 2
    v_add_f32_dpp v56, v56, v56 quad_perm:[1,0,3,2] row_mask:0xf bank_mask:0xf
    v_add_f32_dpp v57, v57, v57 quad_perm:[1,0,3,2] row_mask:0xf bank_mask:0xf
    v_add_f32_dpp v58, v58, v58 quad_perm:[1,0,3,2] row_mask:0xf bank_mask:0xf
    v_add_f32_dpp v59, v59, v59 quad_perm:[1,0,3,2] row_mask:0xf bank_mask:0xf
    v_add_f32_dpp v60, v60, v60 quad_perm:[1,0,3,2] row_mask:0xf bank_mask:0xf
    v_add_f32_dpp v61, v61, v61 quad_perm:[1,0,3,2] row_mask:0xf bank_mask:0xf
    v_add_f32_dpp v62, v62, v62 quad_perm:[1,0,3,2] row_mask:0xf bank_mask:0xf
    v_add_f32_dpp v63, v63, v63 quad_perm:[1,0,3,2] row_mask:0xf bank_mask:0xf
    v_add_f32_dpp v56, v56, v56 quad_perm:[2,3,0,1] row_mask:0xf bank_mask:0xf
    v_add_f32_dpp v57, v57, v57 quad_perm:[2,3,0,1] row_mask:0xf bank_mask:0xf
    v_add_f32_dpp v58, v58, v58 quad_perm:[2,3,0,1] row_mask:0xf bank_mask:0xf
    v_add_f32_dpp v59, v59, v59 quad_perm:[2,3,0,1] row_mask:0xf bank_mask:0xf
    v_add_f32_dpp v60, v60, v60 quad_perm:[2,3,0,1] row_mask:0xf bank_mask:0xf
    v_add_f32_dpp v61, v61, v61 quad_perm:[2,3,0,1] row_mask:0xf bank_mask:0xf
    v_add_f32_dpp v62, v62, v62 quad_perm:[2,3,0,1] row_mask:0xf bank_mask:0xf
    v_add_f32_dpp v63, v63, v63 quad_perm:[2,3,0,1] row_mask:0xf bank_mask:0xf
    v_add_f32_dpp v56, v56, v56 row_half_mirror row_mask:0xf bank_mask:0xf
    v_add_f32_dpp v57, v57, v57 row_half_mirror row_mask:0xf bank_mask:0xf
    v_add_f32_dpp v58, v58, v58 row_half_mirror row_mask:0xf bank_mask:0xf
    v_add_f32_dpp v59, v59, v59 row_half_mirror row_mask:0xf bank_mask:0xf
    v_add_f32_dpp v60, v60, v60 row_half_mirror row_mask:0xf bank_mask:0xf
    v_add_f32_dpp v61, v61, v61 row_half_mirror row_mask:0xf bank_mask:0xf
    v_add_f32_dpp v62, v62, v62 row_half_mirror row_mask:0xf bank_mask:0xf
    v_add_f32_dpp v63, v63, v63 row_half_mirror row_mask:0xf bank_mask:0xf
    v_cmp_eq_u32 vcc, 1, v38
    s_nop 1
    v_cndmask_b32 v56, v56, v58, vcc
    v_cndmask_b32 v57, v57, v59, vcc
    v_cmp_eq_u32 vcc, 2, v38
    s_nop 1
    v_cndmask_b32 v56, v56, v60, vcc
    v_cndmask_b32 v57, v57, v61, vcc
    v_cmp_eq_u32 vcc, 3, v38
    s_nop 1
    v_cndmask_b32 v56, v56, v62, vcc
    v_cndmask_b32 v57, v57, v63, vcc
    s_lshl_b32 s44, s21, 18
    s_lshl_b32 s45, s38, 12
    s_add_u32 s44, s44, s45
    s_lshl_b32 s45, s18, 8
    s_add_u32 s44, s44, s45
    s_add_u32 s44, s44, 50331648
    buffer_store_dwordx2 v[56:57], v39, s[4:7], s44 offen sc1
    s_lshl_b32 s46, s21, 14
    s_lshl_b32 s67, s38, 7
    s_add_u32 s46, s46, s67
    s_add_u32 s46, s46, 4096
    s_add_u32 s47, s46, 8192
    s_lshl_b32 s48, s21, 22
    s_lshl_b32 s49, s38, 16
    s_add_u32 s41, s48, s49
    v_lshrrev_b32 v16, 4, v1
    v_and_b32 v17, 15, v16
    v_lshrrev_b32 v16, 4, v16
    s_lshl_b32 s49, s16, 7
    s_add_u32 s50, s49, 151552
    s_and_b32 s49, s21, 1
    s_lshl_b32 s49, s49, 10
    s_add_u32 s49, s49, 151552
    v_lshlrev_b32 v11, 4, v16
    v_add_u32 v13, s50, v11
    v_add_u32 v11, s49, v11
    v_lshlrev_b32 v15, 2, v17
    v_add_u32 v9, s50, v15
    v_add_u32 v15, s49, v15
    s_lshr_b32 s49, s21, 1
    s_lshl_b32 s53, s49, 23
    s_lshl_b32 s50, s18, 18
    s_add_u32 s53, s53, s50
    s_add_u32 s53, s53, 33554432
    s_lshl_b32 s54, s38, 11
    s_add_u32 s52, s53, s54
    s_lshl_b32 s59, s49, 13
    s_lshl_b32 s67, s18, 9
    s_add_u32 s59, s59, s67
    s_lshl_b32 s67, s16, 7
    s_add_u32 s59, s59, s67
    s_add_u32 s59, s59, 69632
    s_lshl_b32 s61, s49, 15
    s_lshl_b32 s67, s17, 11
    s_add_u32 s61, s61, s67
    s_lshl_b32 s67, s18, 7
    s_add_u32 s61, s61, s67
    s_add_u32 s61, s61, 151552
    s_sub_u32 s60, s61, 151552
    s_lshl_b32 s60, s60, 5
    s_add_u32 s60, s60, 54525952
    s_lshl_b32 s62, s16, 12
    s_add_u32 s62, s62, 131072
    v_bfe_u32 v80, v8, 3, 1
    v_and_b32 v81, 7, v8
    v_lshrrev_b32 v82, 5, v8
    v_lshlrev_b32 v82, 1, v82
    v_xor_b32 v82, v82, v81
    v_xor_b32 v82, v82, v80
    v_lshlrev_b32 v82, 4, v82
    v_lshl_add_u32 v82, v81, 7, v82
    v_lshl_add_u32 v82, v80, 10, v82
    v_bfe_u32 v80, v8, 4, 1
    v_lshl_add_u32 v82, v80, 3, v82
    v_add_u32 v20, s76, v82
    v_xor_b32 v21, 16, v20
    v_xor_b32 v22, 64, v20
    v_xor_b32 v23, 80, v20
    v_add_u32 v80, s62, v2
    ds_read_b128 v[160:163], v80 offset:0
    ds_read_b128 v[164:167], v80 offset:256
    ds_read_b128 v[168:171], v80 offset:2048
    ds_read_b128 v[172:175], v80 offset:2304
    s_mov_b64 vcc, -1
    s_mov_b32 s48, 1
    s_or_b32 s20, s19, 0x80000000
    s_barrier
    ds_read_b64_tr_b16 v[32:33], v3 offset:0
    ds_read_b64_tr_b16 v[34:35], v3 offset:1024
    ds_read_b64_tr_b16 v[36:37], v4 offset:0
    ds_read_b64_tr_b16 v[38:39], v4 offset:1024
    ds_read_b64_tr_b16 v[40:41], v5 offset:0
    ds_read_b64_tr_b16 v[42:43], v5 offset:1024
    ds_read_b64_tr_b16 v[44:45], v6 offset:0
    ds_read_b64_tr_b16 v[46:47], v6 offset:1024
    ds_read_b64_tr_b16 v[48:49], v3 offset:4096
    ds_read_b64_tr_b16 v[50:51], v3 offset:5120
    ds_read_b64_tr_b16 v[52:53], v4 offset:4096
    ds_read_b64_tr_b16 v[54:55], v4 offset:5120
    ds_read_b64_tr_b16 v[56:57], v5 offset:4096
    ds_read_b64_tr_b16 v[58:59], v5 offset:5120
    s_branch c_g0
c_st1:
    s_waitcnt vmcnt(1)
    ds_read_b64 v[176:177], v20 offset:4096
    ds_read_b64 v[178:179], v21 offset:4096
    ds_read_b64 v[180:181], v20 offset:6144
    ds_read_b64 v[182:183], v21 offset:6144
    ds_read_b64 v[184:185], v22 offset:4096
    ds_read_b64 v[186:187], v23 offset:4096
    ds_read_b64 v[188:189], v22 offset:6144
    ds_read_b64 v[190:191], v23 offset:6144
    ds_read_b64 v[192:193], v20 offset:8192
    ds_read_b64 v[194:195], v21 offset:8192
    ds_read_b64 v[196:197], v20 offset:10240
    ds_read_b64 v[198:199], v21 offset:10240
    ds_read_b64 v[200:201], v22 offset:8192
    ds_read_b64 v[202:203], v23 offset:8192
    ds_read_b64 v[204:205], v22 offset:10240
    ds_read_b64 v[206:207], v23 offset:10240
    ds_read_b64 v[208:209], v20 offset:12288
    ds_read_b64 v[210:211], v21 offset:12288
    ds_read_b64 v[212:213], v20 offset:14336
    ds_read_b64 v[214:215], v21 offset:14336
    ds_read_b64 v[216:217], v22 offset:12288
    ds_read_b64 v[218:219], v23 offset:12288
    ds_read_b64 v[220:221], v22 offset:14336
    ds_read_b64 v[222:223], v23 offset:14336
    ds_read_b64 v[224:225], v20 offset:16384
    ds_read_b64 v[226:227], v21 offset:16384
    ds_read_b64 v[228:229], v20 offset:18432
    ds_read_b64 v[230:231], v21 offset:18432
    ds_read_b64 v[232:233], v22 offset:16384
    ds_read_b64 v[234:235], v23 offset:16384
    ds_read_b64 v[236:237], v22 offset:18432
    ds_read_b64 v[238:239], v23 offset:18432
    s_load_dword s68, s[34:35], 0
    s_mov_b32 s8, s34
    s_mov_b32 s9, s35
    s_mov_b32 s10, 256
    s_mov_b32 s11, 0x00020000
    s_mov_b32 s66, 0x10000
    v_mov_b32 v16, 0
    s_waitcnt lgkmcnt(0)
c_f0:
    s_cmp_eq_u32 s68, 10
    s_cbranch_scc1 c_f0_ok
    buffer_load_dword v17, v16, s[8:11], 0 offen offset:0 sc1
    s_waitcnt vmcnt(0)
    v_readfirstlane_b32 s68, v17
    s_sub_u32 s66, s66, 1
    s_cmp_lg_u32 s66, 0
    s_cbranch_scc1 c_f0
c_f0_ok:
    s_atomic_add s63, s[22:23], s46
    s_branch c_st2
c_cs1:
    s_waitcnt vmcnt(0)
    s_atomic_add s40, s[22:23], s47
    s_branch c_cs2
c_layer:
    s_mov_b64 vcc, 0
c_early2:
    s_barrier
    ds_read_b64_tr_b16 v[32:33], v3 offset:0
    ds_read_b64_tr_b16 v[34:35], v3 offset:1024
    ds_read_b64_tr_b16 v[36:37], v4 offset:0
    ds_read_b64_tr_b16 v[38:39], v4 offset:1024
    ds_read_b64_tr_b16 v[40:41], v5 offset:0
    ds_read_b64_tr_b16 v[42:43], v5 offset:1024
    ds_read_b64_tr_b16 v[44:45], v6 offset:0
    ds_read_b64_tr_b16 v[46:47], v6 offset:1024
    ds_read_b64_tr_b16 v[48:49], v3 offset:4096
    ds_read_b64_tr_b16 v[50:51], v3 offset:5120
    ds_read_b64_tr_b16 v[52:53], v4 offset:4096
    ds_read_b64_tr_b16 v[54:55], v4 offset:5120
    ds_read_b64_tr_b16 v[56:57], v5 offset:4096
    ds_read_b64_tr_b16 v[58:59], v5 offset:5120
c_g0:
    s_waitcnt lgkmcnt(10)
    v_mfma_f32_16x16x32_bf16 v[64:67], v[32:35], v[160:163], 0
    ds_read_b64_tr_b16 v[60:61], v6 offset:4096
    v_mfma_f32_16x16x32_bf16 v[68:71], v[32:35], v[164:167], 0
    ds_read_b64_tr_b16 v[62:63], v6 offset:5120
    v_mfma_f32_16x16x32_bf16 v[72:75], v[36:39], v[160:163], 0
    ds_read_b64_tr_b16 v[32:33], v3 offset:8192
    v_mfma_f32_16x16x32_bf16 v[76:79], v[36:39], v[164:167], 0
    ds_read_b64_tr_b16 v[34:35], v3 offset:9216
    s_waitcnt lgkmcnt(10)
    v_mfma_f32_16x16x32_bf16 v[80:83], v[40:43], v[160:163], 0
    ds_read_b64_tr_b16 v[36:37], v4 offset:8192
    v_mfma_f32_16x16x32_bf16 v[84:87], v[40:43], v[164:167], 0
    ds_read_b64_tr_b16 v[38:39], v4 offset:9216
    v_mfma_f32_16x16x32_bf16 v[88:91], v[44:47], v[160:163], 0
    ds_read_b64_tr_b16 v[40:41], v5 offset:8192
    v_mfma_f32_16x16x32_bf16 v[92:95], v[44:47], v[164:167], 0
    ds_read_b64_tr_b16 v[42:43], v5 offset:9216
    s_waitcnt lgkmcnt(10)
    v_mfma_f32_16x16x32_bf16 v[96:99], v[160:163], v[48:51], 0
    ds_read_b64_tr_b16 v[44:45], v6 offset:8192
    v_mfma_f32_16x16x32_bf16 v[100:103], v[164:167], v[48:51], 0
    ds_read_b64_tr_b16 v[46:47], v6 offset:9216
    v_mfma_f32_16x16x32_bf16 v[104:107], v[160:163], v[52:55], 0
    ds_read_b64_tr_b16 v[48:49], v3 offset:12288
    v_mfma_f32_16x16x32_bf16 v[108:111], v[164:167], v[52:55], 0
    ds_read_b64_tr_b16 v[50:51], v3 offset:13312
    s_waitcnt lgkmcnt(10)
    v_mfma_f32_16x16x32_bf16 v[112:115], v[160:163], v[56:59], 0
    ds_read_b64_tr_b16 v[52:53], v4 offset:12288
    v_mfma_f32_16x16x32_bf16 v[116:119], v[164:167], v[56:59], 0
    ds_read_b64_tr_b16 v[54:55], v4 offset:13312
    v_mfma_f32_16x16x32_bf16 v[120:123], v[160:163], v[60:63], 0
    ds_read_b64_tr_b16 v[56:57], v5 offset:12288
    v_mfma_f32_16x16x32_bf16 v[124:127], v[164:167], v[60:63], 0
    ds_read_b64_tr_b16 v[58:59], v5 offset:13312
    s_cmp_lg_u32 s48, 0
    s_cbranch_scc1 c_gate
    s_mov_b32 s66, 0x10000
    s_waitcnt lgkmcnt(0)
    s_and_b32 s68, s68, s19
    s_cmp_eq_u32 s68, s19
    s_cbranch_scc1 c_x_ok
c_x_poll:
    s_mov_b32 s68, 0
    s_atomic_add s68, s[22:23], s46 offset:0 glc
    s_sub_u32 s66, s66, 1
    s_cselect_b32 s67, s19, 0
    s_waitcnt lgkmcnt(0)
    s_and_b32 s68, s68, s19
    s_max_u32 s68, s68, s67
    s_cmp_lt_u32 s68, s19
    s_cbranch_scc1 c_x_poll
c_x_ok:
    s_add_u32 s42, s41, s85
    buffer_load_dwordx4 v[176:179], v2, s[4:7], s42 offen offset:0 sc1
    buffer_load_dwordx4 v[180:183], v2, s[4:7], s42 offen offset:256 sc1
    buffer_load_dwordx4 v[184:187], v2, s[4:7], s42 offen offset:2048 sc1
    buffer_load_dwordx4 v[188:191], v2, s[4:7], s42 offen offset:2304 sc1
    s_add_u32 s42, s41, s86
    buffer_load_dwordx4 v[192:195], v2, s[4:7], s42 offen offset:0 sc1
    buffer_load_dwordx4 v[196:199], v2, s[4:7], s42 offen offset:256 sc1
    buffer_load_dwordx4 v[200:203], v2, s[4:7], s42 offen offset:2048 sc1
    buffer_load_dwordx4 v[204:207], v2, s[4:7], s42 offen offset:2304 sc1
    s_add_u32 s42, s41, s87
    buffer_load_dwordx4 v[208:211], v2, s[4:7], s42 offen offset:0 sc1
    buffer_load_dwordx4 v[212:215], v2, s[4:7], s42 offen offset:256 sc1
    s_waitcnt vmcnt(10)
    s_atomic_add s40, s[22:23], s47
c_gate:
    s_waitcnt lgkmcnt(10)
    v_mfma_f32_16x16x32_bf16 v[128:131], v[32:35], v[160:163], 0
    ds_read_b64_tr_b16 v[60:61], v6 offset:12288
    v_mfma_f32_16x16x32_bf16 v[132:135], v[32:35], v[164:167], 0
    ds_read_b64_tr_b16 v[62:63], v6 offset:13312
    v_mfma_f32_16x16x32_bf16 v[136:139], v[36:39], v[160:163], 0
    ds_read_b64_tr_b16 v[32:33], v3 offset:16384
    v_mfma_f32_16x16x32_bf16 v[140:143], v[36:39], v[164:167], 0
    ds_read_b64_tr_b16 v[34:35], v3 offset:17408
    s_waitcnt lgkmcnt(10)
    v_mfma_f32_16x16x32_bf16 v[144:147], v[40:43], v[160:163], 0
    ds_read_b64_tr_b16 v[36:37], v4 offset:16384
    v_mfma_f32_16x16x32_bf16 v[148:151], v[40:43], v[164:167], 0
    ds_read_b64_tr_b16 v[38:39], v4 offset:17408
    v_mfma_f32_16x16x32_bf16 v[152:155], v[44:47], v[160:163], 0
    ds_read_b64_tr_b16 v[40:41], v5 offset:16384
    v_mfma_f32_16x16x32_bf16 v[156:159], v[44:47], v[164:167], 0
    ds_read_b64_tr_b16 v[42:43], v5 offset:17408
    s_waitcnt lgkmcnt(10)
    v_mfma_f32_16x16x32_bf16 v[64:67], v[48:51], v[168:171], v[64:67]
    ds_read_b64_tr_b16 v[44:45], v6 offset:16384
    v_mfma_f32_16x16x32_bf16 v[68:71], v[48:51], v[172:175], v[68:71]
    ds_read_b64_tr_b16 v[46:47], v6 offset:17408
    v_mfma_f32_16x16x32_bf16 v[72:75], v[52:55], v[168:171], v[72:75]
    ds_read_b64_tr_b16 v[48:49], v3 offset:20480
    v_mfma_f32_16x16x32_bf16 v[76:79], v[52:55], v[172:175], v[76:79]
    ds_read_b64_tr_b16 v[50:51], v3 offset:21504
    s_waitcnt lgkmcnt(10)
    v_mfma_f32_16x16x32_bf16 v[80:83], v[56:59], v[168:171], v[80:83]
    ds_read_b64_tr_b16 v[52:53], v4 offset:20480
    v_mfma_f32_16x16x32_bf16 v[84:87], v[56:59], v[172:175], v[84:87]
    ds_read_b64_tr_b16 v[54:55], v4 offset:21504
    v_mfma_f32_16x16x32_bf16 v[88:91], v[60:63], v[168:171], v[88:91]
    ds_read_b64_tr_b16 v[56:57], v5 offset:20480
    v_mfma_f32_16x16x32_bf16 v[92:95], v[60:63], v[172:175], v[92:95]
    ds_read_b64_tr_b16 v[58:59], v5 offset:21504
    s_waitcnt lgkmcnt(10)
    v_mfma_f32_16x16x32_bf16 v[96:99], v[168:171], v[32:35], v[96:99]
    ds_read_b64_tr_b16 v[60:61], v6 offset:20480
    v_mfma_f32_16x16x32_bf16 v[100:103], v[172:175], v[32:35], v[100:103]
    ds_read_b64_tr_b16 v[62:63], v6 offset:21504
    v_mfma_f32_16x16x32_bf16 v[104:107], v[168:171], v[36:39], v[104:107]
    ds_read_b64_tr_b16 v[32:33], v3 offset:24576
    v_mfma_f32_16x16x32_bf16 v[108:111], v[172:175], v[36:39], v[108:111]
    ds_read_b64_tr_b16 v[34:35], v3 offset:25600
    s_waitcnt lgkmcnt(10)
    v_mfma_f32_16x16x32_bf16 v[112:115], v[168:171], v[40:43], v[112:115]
    ds_read_b64_tr_b16 v[36:37], v4 offset:24576
    v_mfma_f32_16x16x32_bf16 v[116:119], v[172:175], v[40:43], v[116:119]
    ds_read_b64_tr_b16 v[38:39], v4 offset:25600
    v_mfma_f32_16x16x32_bf16 v[120:123], v[168:171], v[44:47], v[120:123]
    ds_read_b64_tr_b16 v[40:41], v5 offset:24576
    v_mfma_f32_16x16x32_bf16 v[124:127], v[172:175], v[44:47], v[124:127]
    ds_read_b64_tr_b16 v[42:43], v5 offset:25600
    s_waitcnt lgkmcnt(10)
    v_mfma_f32_16x16x32_bf16 v[128:131], v[48:51], v[168:171], v[128:131]
    ds_read_b64_tr_b16 v[44:45], v6 offset:24576
    v_mfma_f32_16x16x32_bf16 v[132:135], v[48:51], v[172:175], v[132:135]
    ds_read_b64_tr_b16 v[46:47], v6 offset:25600
    v_mfma_f32_16x16x32_bf16 v[136:139], v[52:55], v[168:171], v[136:139]
    ds_read_b64_tr_b16 v[48:49], v3 offset:28672
    v_mfma_f32_16x16x32_bf16 v[140:143], v[52:55], v[172:175], v[140:143]
    ds_read_b64_tr_b16 v[50:51], v3 offset:29696
    s_waitcnt lgkmcnt(10)
    v_mfma_f32_16x16x32_bf16 v[144:147], v[56:59], v[168:171], v[144:147]
    ds_read_b64_tr_b16 v[52:53], v4 offset:28672
    v_mfma_f32_16x16x32_bf16 v[148:151], v[56:59], v[172:175], v[148:151]
    ds_read_b64_tr_b16 v[54:55], v4 offset:29696
    v_mfma_f32_16x16x32_bf16 v[152:155], v[60:63], v[168:171], v[152:155]
    ds_read_b64_tr_b16 v[56:57], v5 offset:28672
    v_mfma_f32_16x16x32_bf16 v[156:159], v[60:63], v[172:175], v[156:159]
    ds_read_b64_tr_b16 v[58:59], v5 offset:29696
    s_cbranch_vccnz c_st1
c_st2:
    s_waitcnt vmcnt(8) lgkmcnt(10)
    v_mfma_f32_16x16x32_bf16 v[64:67], v[32:35], v[176:179], v[64:67]
    ds_read_b64_tr_b16 v[60:61], v6 offset:28672
    v_mfma_f32_16x16x32_bf16 v[68:71], v[32:35], v[180:183], v[68:71]
    ds_read_b64_tr_b16 v[62:63], v6 offset:29696
    s_barrier
    v_mfma_f32_16x16x32_bf16 v[72:75], v[36:39], v[176:179], v[72:75]
    ds_read_b64_tr_b16 v[32:33], v3 offset:32768
    v_mfma_f32_16x16x32_bf16 v[76:79], v[36:39], v[180:183], v[76:79]
    ds_read_b64_tr_b16 v[34:35], v3 offset:33792
    s_waitcnt lgkmcnt(10)
    v_mfma_f32_16x16x32_bf16 v[80:83], v[40:43], v[176:179], v[80:83]
    ds_read_b64_tr_b16 v[36:37], v4 offset:32768
    v_mfma_f32_16x16x32_bf16 v[84:87], v[40:43], v[180:183], v[84:87]
    ds_read_b64_tr_b16 v[38:39], v4 offset:33792
    v_mfma_f32_16x16x32_bf16 v[88:91], v[44:47], v[176:179], v[88:91]
    ds_read_b64_tr_b16 v[40:41], v5 offset:32768
    v_mfma_f32_16x16x32_bf16 v[92:95], v[44:47], v[180:183], v[92:95]
    ds_read_b64_tr_b16 v[42:43], v5 offset:33792
    s_waitcnt lgkmcnt(10)
    v_mfma_f32_16x16x32_bf16 v[96:99], v[176:179], v[48:51], v[96:99]
    ds_read_b64_tr_b16 v[44:45], v6 offset:32768
    v_mfma_f32_16x16x32_bf16 v[100:103], v[180:183], v[48:51], v[100:103]
    ds_read_b64_tr_b16 v[46:47], v6 offset:33792
    v_mfma_f32_16x16x32_bf16 v[104:107], v[176:179], v[52:55], v[104:107]
    ds_read_b64_tr_b16 v[48:49], v3 offset:36864
    v_mfma_f32_16x16x32_bf16 v[108:111], v[180:183], v[52:55], v[108:111]
    ds_read_b64_tr_b16 v[50:51], v3 offset:37888
    s_waitcnt lgkmcnt(10)
    v_mfma_f32_16x16x32_bf16 v[112:115], v[176:179], v[56:59], v[112:115]
    ds_read_b64_tr_b16 v[52:53], v4 offset:36864
    v_mfma_f32_16x16x32_bf16 v[116:119], v[180:183], v[56:59], v[116:119]
    ds_read_b64_tr_b16 v[54:55], v4 offset:37888
    v_mfma_f32_16x16x32_bf16 v[120:123], v[176:179], v[60:63], v[120:123]
    ds_read_b64_tr_b16 v[56:57], v5 offset:36864
    v_mfma_f32_16x16x32_bf16 v[124:127], v[180:183], v[60:63], v[124:127]
    ds_read_b64_tr_b16 v[58:59], v5 offset:37888
    s_waitcnt lgkmcnt(10)
    v_mfma_f32_16x16x32_bf16 v[128:131], v[32:35], v[176:179], v[128:131]
    ds_read_b64_tr_b16 v[60:61], v6 offset:36864
    v_mfma_f32_16x16x32_bf16 v[132:135], v[32:35], v[180:183], v[132:135]
    ds_read_b64_tr_b16 v[62:63], v6 offset:37888
    v_mfma_f32_16x16x32_bf16 v[136:139], v[36:39], v[176:179], v[136:139]
    ds_read_b64_tr_b16 v[32:33], v3 offset:40960
    v_mfma_f32_16x16x32_bf16 v[140:143], v[36:39], v[180:183], v[140:143]
    ds_read_b64_tr_b16 v[34:35], v3 offset:41984
    s_waitcnt lgkmcnt(10)
    v_mfma_f32_16x16x32_bf16 v[144:147], v[40:43], v[176:179], v[144:147]
    ds_read_b64_tr_b16 v[36:37], v4 offset:40960
    v_mfma_f32_16x16x32_bf16 v[148:151], v[40:43], v[180:183], v[148:151]
    ds_read_b64_tr_b16 v[38:39], v4 offset:41984
    v_mfma_f32_16x16x32_bf16 v[152:155], v[44:47], v[176:179], v[152:155]
    ds_read_b64_tr_b16 v[40:41], v5 offset:40960
    v_mfma_f32_16x16x32_bf16 v[156:159], v[44:47], v[180:183], v[156:159]
    ds_read_b64_tr_b16 v[42:43], v5 offset:41984
    s_waitcnt vmcnt(6) lgkmcnt(10)
    v_mfma_f32_16x16x32_bf16 v[64:67], v[48:51], v[184:187], v[64:67]
    s_add_u32 s42, s41, s87
    s_cbranch_vccnz xs1
    buffer_load_dwordx4 v[216:219], v2, s[4:7], s42 offen offset:2048 sc1
xs1:
    ds_read_b64_tr_b16 v[44:45], v6 offset:40960
    v_mfma_f32_16x16x32_bf16 v[68:71], v[48:51], v[188:191], v[68:71]
    ds_read_b64_tr_b16 v[46:47], v6 offset:41984
    v_mfma_f32_16x16x32_bf16 v[72:75], v[52:55], v[184:187], v[72:75]
    s_cbranch_vccnz xs2
    buffer_load_dwordx4 v[220:223], v2, s[4:7], s42 offen offset:2304 sc1
xs2:
    ds_read_b64_tr_b16 v[48:49], v3 offset:45056
    s_add_u32 s42, s41, s88
    v_mfma_f32_16x16x32_bf16 v[76:79], v[52:55], v[188:191], v[76:79]
    ds_read_b64_tr_b16 v[50:51], v3 offset:46080
    s_waitcnt lgkmcnt(10)
    v_mfma_f32_16x16x32_bf16 v[80:83], v[56:59], v[184:187], v[80:83]
    s_cbranch_vccnz xs3
    buffer_load_dwordx4 v[224:227], v2, s[4:7], s42 offen offset:0 sc1
xs3:
    ds_read_b64_tr_b16 v[52:53], v4 offset:45056
    v_mfma_f32_16x16x32_bf16 v[84:87], v[56:59], v[188:191], v[84:87]
    ds_read_b64_tr_b16 v[54:55], v4 offset:46080
    v_mfma_f32_16x16x32_bf16 v[88:91], v[60:63], v[184:187], v[88:91]
    s_cbranch_vccnz xs4
    buffer_load_dwordx4 v[228:231], v2, s[4:7], s42 offen offset:256 sc1
xs4:
    ds_read_b64_tr_b16 v[56:57], v5 offset:45056
    v_mfma_f32_16x16x32_bf16 v[92:95], v[60:63], v[188:191], v[92:95]
    ds_read_b64_tr_b16 v[58:59], v5 offset:46080
    s_waitcnt lgkmcnt(10)
    v_mfma_f32_16x16x32_bf16 v[96:99], v[184:187], v[32:35], v[96:99]
    ds_read_b64_tr_b16 v[60:61], v6 offset:45056
    s_cbranch_vccnz xs5
    buffer_load_dwordx4 v[232:235], v2, s[4:7], s42 offen offset:2048 sc1
xs5:
    s_cbranch_vccnz c_cs1
c_cs2:
    v_mfma_f32_16x16x32_bf16 v[100:103], v[188:191], v[32:35], v[100:103]
    ds_read_b64_tr_b16 v[62:63], v6 offset:46080
    v_mfma_f32_16x16x32_bf16 v[104:107], v[184:187], v[36:39], v[104:107]
    s_cbranch_vccnz xs6
    buffer_load_dwordx4 v[236:239], v2, s[4:7], s42 offen offset:2304 sc1
xs6:
    ds_read_b64_tr_b16 v[32:33], v3 offset:49152
    s_add_u32 s42, s41, s89
    v_mfma_f32_16x16x32_bf16 v[108:111], v[188:191], v[36:39], v[108:111]
    ds_read_b64_tr_b16 v[34:35], v3 offset:50176
    s_waitcnt lgkmcnt(10)
    v_mfma_f32_16x16x32_bf16 v[112:115], v[184:187], v[40:43], v[112:115]
    ds_read_b64_tr_b16 v[36:37], v4 offset:49152
    v_mfma_f32_16x16x32_bf16 v[116:119], v[188:191], v[40:43], v[116:119]
    ds_read_b64_tr_b16 v[38:39], v4 offset:50176
    v_mfma_f32_16x16x32_bf16 v[120:123], v[184:187], v[44:47], v[120:123]
    ds_read_b64_tr_b16 v[40:41], v5 offset:49152
    v_mfma_f32_16x16x32_bf16 v[124:127], v[188:191], v[44:47], v[124:127]
    ds_read_b64_tr_b16 v[42:43], v5 offset:50176
    s_waitcnt lgkmcnt(10)
    v_mfma_f32_16x16x32_bf16 v[128:131], v[48:51], v[184:187], v[128:131]
    ds_read_b64_tr_b16 v[44:45], v6 offset:49152
    v_mfma_f32_16x16x32_bf16 v[132:135], v[48:51], v[188:191], v[132:135]
    ds_read_b64_tr_b16 v[46:47], v6 offset:50176
    v_mfma_f32_16x16x32_bf16 v[136:139], v[52:55], v[184:187], v[136:139]
    ds_read_b64_tr_b16 v[48:49], v3 offset:53248
    v_mfma_f32_16x16x32_bf16 v[140:143], v[52:55], v[188:191], v[140:143]
    ds_read_b64_tr_b16 v[50:51], v3 offset:54272
    s_waitcnt lgkmcnt(10)
    v_mfma_f32_16x16x32_bf16 v[144:147], v[56:59], v[184:187], v[144:147]
    ds_read_b64_tr_b16 v[52:53], v4 offset:53248
    v_mfma_f32_16x16x32_bf16 v[148:151], v[56:59], v[188:191], v[148:151]
    ds_read_b64_tr_b16 v[54:55], v4 offset:54272
    v_mfma_f32_16x16x32_bf16 v[152:155], v[60:63], v[184:187], v[152:155]
    ds_read_b64_tr_b16 v[56:57], v5 offset:53248
    v_mfma_f32_16x16x32_bf16 v[156:159], v[60:63], v[188:191], v[156:159]
    ds_read_b64_tr_b16 v[58:59], v5 offset:54272
    s_waitcnt vmcnt(10) lgkmcnt(10)
    v_mfma_f32_16x16x32_bf16 v[64:67], v[32:35], v[192:195], v[64:67]
    ds_read_b64_tr_b16 v[60:61], v6 offset:53248
    v_mfma_f32_16x16x32_bf16 v[68:71], v[32:35], v[196:199], v[68:71]
    ds_read_b64_tr_b16 v[62:63], v6 offset:54272
    v_mfma_f32_16x16x32_bf16 v[72:75], v[36:39], v[192:195], v[72:75]
    ds_read_b64_tr_b16 v[32:33], v3 offset:57344
    v_mfma_f32_16x16x32_bf16 v[76:79], v[36:39], v[196:199], v[76:79]
    ds_read_b64_tr_b16 v[34:35], v3 offset:58368
    s_waitcnt lgkmcnt(10)
    v_mfma_f32_16x16x32_bf16 v[80:83], v[40:43], v[192:195], v[80:83]
    ds_read_b64_tr_b16 v[36:37], v4 offset:57344
    v_mfma_f32_16x16x32_bf16 v[84:87], v[40:43], v[196:199], v[84:87]
    ds_read_b64_tr_b16 v[38:39], v4 offset:58368
    v_mfma_f32_16x16x32_bf16 v[88:91], v[44:47], v[192:195], v[88:91]
    ds_read_b64_tr_b16 v[40:41], v5 offset:57344
    v_mfma_f32_16x16x32_bf16 v[92:95], v[44:47], v[196:199], v[92:95]
    ds_read_b64_tr_b16 v[42:43], v5 offset:58368
    s_waitcnt lgkmcnt(10)
    v_mfma_f32_16x16x32_bf16 v[96:99], v[192:195], v[48:51], v[96:99]
    ds_read_b64_tr_b16 v[44:45], v6 offset:57344
    v_mfma_f32_16x16x32_bf16 v[100:103], v[196:199], v[48:51], v[100:103]
    ds_read_b64_tr_b16 v[46:47], v6 offset:58368
    v_mfma_f32_16x16x32_bf16 v[104:107], v[192:195], v[52:55], v[104:107]
    ds_read_b64_tr_b16 v[48:49], v3 offset:61440
    v_mfma_f32_16x16x32_bf16 v[108:111], v[196:199], v[52:55], v[108:111]
    ds_read_b64_tr_b16 v[50:51], v3 offset:62464
    s_waitcnt lgkmcnt(10)
    v_mfma_f32_16x16x32_bf16 v[112:115], v[192:195], v[56:59], v[112:115]
    ds_read_b64_tr_b16 v[52:53], v4 offset:61440
    v_mfma_f32_16x16x32_bf16 v[116:119], v[196:199], v[56:59], v[116:119]
    ds_read_b64_tr_b16 v[54:55], v4 offset:62464
    v_mfma_f32_16x16x32_bf16 v[120:123], v[192:195], v[60:63], v[120:123]
    ds_read_b64_tr_b16 v[56:57], v5 offset:61440
    v_mfma_f32_16x16x32_bf16 v[124:127], v[196:199], v[60:63], v[124:127]
    ds_read_b64_tr_b16 v[58:59], v5 offset:62464
    s_waitcnt lgkmcnt(10)
    v_mfma_f32_16x16x32_bf16 v[128:131], v[32:35], v[192:195], v[128:131]
    ds_read_b64_tr_b16 v[60:61], v6 offset:61440
    v_mfma_f32_16x16x32_bf16 v[132:135], v[32:35], v[196:199], v[132:135]
    ds_read_b64_tr_b16 v[62:63], v6 offset:62464
    s_barrier
    v_xor_b32 v3, 0x10000, v3
    v_xor_b32 v4, 0x10000, v4
    v_xor_b32 v5, 0x10000, v5
    v_xor_b32 v6, 0x10000, v6
    v_mfma_f32_16x16x32_bf16 v[136:139], v[36:39], v[192:195], v[136:139]
    ds_read_b64_tr_b16 v[32:33], v3 offset:0
    v_mfma_f32_16x16x32_bf16 v[140:143], v[36:39], v[196:199], v[140:143]
    ds_read_b64_tr_b16 v[34:35], v3 offset:1024
    s_waitcnt lgkmcnt(10)
    v_mfma_f32_16x16x32_bf16 v[144:147], v[40:43], v[192:195], v[144:147]
    ds_read_b64_tr_b16 v[36:37], v4 offset:0
    v_mfma_f32_16x16x32_bf16 v[148:151], v[40:43], v[196:199], v[148:151]
    ds_read_b64_tr_b16 v[38:39], v4 offset:1024
    v_mfma_f32_16x16x32_bf16 v[152:155], v[44:47], v[192:195], v[152:155]
    ds_read_b64_tr_b16 v[40:41], v5 offset:0
    v_mfma_f32_16x16x32_bf16 v[156:159], v[44:47], v[196:199], v[156:159]
    ds_read_b64_tr_b16 v[42:43], v5 offset:1024
    s_waitcnt vmcnt(8) lgkmcnt(10)
    v_mfma_f32_16x16x32_bf16 v[64:67], v[48:51], v[200:203], v[64:67]
    ds_read_b64_tr_b16 v[44:45], v6 offset:0
    v_mfma_f32_16x16x32_bf16 v[68:71], v[48:51], v[204:207], v[68:71]
    ds_read_b64_tr_b16 v[46:47], v6 offset:1024
    v_mfma_f32_16x16x32_bf16 v[72:75], v[52:55], v[200:203], v[72:75]
    ds_read_b64_tr_b16 v[48:49], v3 offset:4096
    v_mfma_f32_16x16x32_bf16 v[76:79], v[52:55], v[204:207], v[76:79]
    ds_read_b64_tr_b16 v[50:51], v3 offset:5120
    s_waitcnt lgkmcnt(10)
    v_mfma_f32_16x16x32_bf16 v[80:83], v[56:59], v[200:203], v[80:83]
    ds_read_b64_tr_b16 v[52:53], v4 offset:4096
    v_mfma_f32_16x16x32_bf16 v[84:87], v[56:59], v[204:207], v[84:87]
    ds_read_b64_tr_b16 v[54:55], v4 offset:5120
    v_mfma_f32_16x16x32_bf16 v[88:91], v[60:63], v[200:203], v[88:91]
    ds_read_b64_tr_b16 v[56:57], v5 offset:4096
    v_mfma_f32_16x16x32_bf16 v[92:95], v[60:63], v[204:207], v[92:95]
    ds_read_b64_tr_b16 v[58:59], v5 offset:5120
    s_waitcnt lgkmcnt(10)
    v_mfma_f32_16x16x32_bf16 v[96:99], v[200:203], v[32:35], v[96:99]
    ds_read_b64_tr_b16 v[60:61], v6 offset:4096
    v_mfma_f32_16x16x32_bf16 v[100:103], v[204:207], v[32:35], v[100:103]
    ds_read_b64_tr_b16 v[62:63], v6 offset:5120
    v_mfma_f32_16x16x32_bf16 v[104:107], v[200:203], v[36:39], v[104:107]
    ds_read_b64_tr_b16 v[32:33], v3 offset:8192
    v_mfma_f32_16x16x32_bf16 v[108:111], v[204:207], v[36:39], v[108:111]
    ds_read_b64_tr_b16 v[34:35], v3 offset:9216
    s_waitcnt lgkmcnt(10)
    v_mfma_f32_16x16x32_bf16 v[112:115], v[200:203], v[40:43], v[112:115]
    ds_read_b64_tr_b16 v[36:37], v4 offset:8192
    v_mfma_f32_16x16x32_bf16 v[116:119], v[204:207], v[40:43], v[116:119]
    ds_read_b64_tr_b16 v[38:39], v4 offset:9216
    v_mfma_f32_16x16x32_bf16 v[120:123], v[200:203], v[44:47], v[120:123]
    ds_read_b64_tr_b16 v[40:41], v5 offset:8192
    v_mfma_f32_16x16x32_bf16 v[124:127], v[204:207], v[44:47], v[124:127]
    ds_read_b64_tr_b16 v[42:43], v5 offset:9216
    s_waitcnt lgkmcnt(10)
    v_mfma_f32_16x16x32_bf16 v[128:131], v[48:51], v[200:203], v[128:131]
    ds_read_b64_tr_b16 v[44:45], v6 offset:8192
    v_mfma_f32_16x16x32_bf16 v[132:135], v[48:51], v[204:207], v[132:135]
    ds_read_b64_tr_b16 v[46:47], v6 offset:9216
    v_mfma_f32_16x16x32_bf16 v[136:139], v[52:55], v[200:203], v[136:139]
    ds_read_b64_tr_b16 v[48:49], v3 offset:12288
    v_mfma_f32_16x16x32_bf16 v[140:143], v[52:55], v[204:207], v[140:143]
    ds_read_b64_tr_b16 v[50:51], v3 offset:13312
    s_waitcnt lgkmcnt(10)
    v_mfma_f32_16x16x32_bf16 v[144:147], v[56:59], v[200:203], v[144:147]
    ds_read_b64_tr_b16 v[52:53], v4 offset:12288
    v_mfma_f32_16x16x32_bf16 v[148:151], v[56:59], v[204:207], v[148:151]
    ds_read_b64_tr_b16 v[54:55], v4 offset:13312
    v_mfma_f32_16x16x32_bf16 v[152:155], v[60:63], v[200:203], v[152:155]
    ds_read_b64_tr_b16 v[56:57], v5 offset:12288
    v_mfma_f32_16x16x32_bf16 v[156:159], v[60:63], v[204:207], v[156:159]
    ds_read_b64_tr_b16 v[58:59], v5 offset:13312
    s_waitcnt vmcnt(6) lgkmcnt(10)
    v_mfma_f32_16x16x32_bf16 v[64:67], v[32:35], v[208:211], v[64:67]
    ds_read_b64_tr_b16 v[60:61], v6 offset:12288
    v_mfma_f32_16x16x32_bf16 v[68:71], v[32:35], v[212:215], v[68:71]
    ds_read_b64_tr_b16 v[62:63], v6 offset:13312
    v_mfma_f32_16x16x32_bf16 v[72:75], v[36:39], v[208:211], v[72:75]
    ds_read_b64_tr_b16 v[32:33], v3 offset:16384
    v_mfma_f32_16x16x32_bf16 v[76:79], v[36:39], v[212:215], v[76:79]
    ds_read_b64_tr_b16 v[34:35], v3 offset:17408
    s_waitcnt lgkmcnt(10)
    v_mfma_f32_16x16x32_bf16 v[80:83], v[40:43], v[208:211], v[80:83]
    ds_read_b64_tr_b16 v[36:37], v4 offset:16384
    v_mfma_f32_16x16x32_bf16 v[84:87], v[40:43], v[212:215], v[84:87]
    ds_read_b64_tr_b16 v[38:39], v4 offset:17408
    v_mfma_f32_16x16x32_bf16 v[88:91], v[44:47], v[208:211], v[88:91]
    ds_read_b64_tr_b16 v[40:41], v5 offset:16384
    v_mfma_f32_16x16x32_bf16 v[92:95], v[44:47], v[212:215], v[92:95]
    ds_read_b64_tr_b16 v[42:43], v5 offset:17408
    s_waitcnt lgkmcnt(10)
    v_mfma_f32_16x16x32_bf16 v[96:99], v[208:211], v[48:51], v[96:99]
    buffer_load_dwordx4 v[240:243], v2, s[4:7], s42 offen offset:0 sc1
    ds_read_b64_tr_b16 v[44:45], v6 offset:16384
    v_mfma_f32_16x16x32_bf16 v[100:103], v[212:215], v[48:51], v[100:103]
    ds_read_b64_tr_b16 v[46:47], v6 offset:17408
    v_mfma_f32_16x16x32_bf16 v[104:107], v[208:211], v[52:55], v[104:107]
    buffer_load_dwordx4 v[244:247], v2, s[4:7], s42 offen offset:256 sc1
    ds_read_b64_tr_b16 v[48:49], v3 offset:20480
    v_mfma_f32_16x16x32_bf16 v[108:111], v[212:215], v[52:55], v[108:111]
    ds_read_b64_tr_b16 v[50:51], v3 offset:21504
    s_waitcnt lgkmcnt(10)
    v_mfma_f32_16x16x32_bf16 v[112:115], v[208:211], v[56:59], v[112:115]
    buffer_load_dwordx4 v[248:251], v2, s[4:7], s42 offen offset:2048 sc1
    ds_read_b64_tr_b16 v[52:53], v4 offset:20480
    v_mfma_f32_16x16x32_bf16 v[116:119], v[212:215], v[56:59], v[116:119]
    ds_read_b64_tr_b16 v[54:55], v4 offset:21504
    v_mfma_f32_16x16x32_bf16 v[120:123], v[208:211], v[60:63], v[120:123]
    buffer_load_dwordx4 v[252:255], v2, s[4:7], s42 offen offset:2304 sc1
    ds_read_b64_tr_b16 v[56:57], v5 offset:20480
    s_add_u32 s42, s41, s90
    v_mfma_f32_16x16x32_bf16 v[124:127], v[212:215], v[60:63], v[124:127]
    ds_read_b64_tr_b16 v[58:59], v5 offset:21504
    s_waitcnt lgkmcnt(10)
    v_mfma_f32_16x16x32_bf16 v[128:131], v[32:35], v[208:211], v[128:131]
    ds_read_b64_tr_b16 v[60:61], v6 offset:20480
    buffer_load_dwordx4 v[160:163], v2, s[4:7], s42 offen offset:0 sc1
    v_mfma_f32_16x16x32_bf16 v[132:135], v[32:35], v[212:215], v[132:135]
    ds_read_b64_tr_b16 v[62:63], v6 offset:21504
    v_mfma_f32_16x16x32_bf16 v[136:139], v[36:39], v[208:211], v[136:139]
    buffer_load_dwordx4 v[164:167], v2, s[4:7], s42 offen offset:256 sc1
    ds_read_b64_tr_b16 v[32:33], v3 offset:24576
    v_mfma_f32_16x16x32_bf16 v[140:143], v[36:39], v[212:215], v[140:143]
    ds_read_b64_tr_b16 v[34:35], v3 offset:25600
    s_waitcnt lgkmcnt(10)
    v_mfma_f32_16x16x32_bf16 v[144:147], v[40:43], v[208:211], v[144:147]
    buffer_load_dwordx4 v[168:171], v2, s[4:7], s42 offen offset:2048 sc1
    ds_read_b64_tr_b16 v[36:37], v4 offset:24576
    v_mfma_f32_16x16x32_bf16 v[148:151], v[40:43], v[212:215], v[148:151]
    ds_read_b64_tr_b16 v[38:39], v4 offset:25600
    v_mfma_f32_16x16x32_bf16 v[152:155], v[44:47], v[208:211], v[152:155]
    buffer_load_dwordx4 v[172:175], v2, s[4:7], s42 offen offset:2304 sc1
    ds_read_b64_tr_b16 v[40:41], v5 offset:24576
    s_add_u32 s42, s41, s91
    v_mfma_f32_16x16x32_bf16 v[156:159], v[44:47], v[212:215], v[156:159]
    ds_read_b64_tr_b16 v[42:43], v5 offset:25600
    s_waitcnt vmcnt(12) lgkmcnt(10)
    v_mfma_f32_16x16x32_bf16 v[64:67], v[48:51], v[216:219], v[64:67]
    buffer_load_dwordx4 v[176:179], v2, s[4:7], s42 offen offset:0 sc1
    ds_read_b64_tr_b16 v[44:45], v6 offset:24576
    v_mfma_f32_16x16x32_bf16 v[68:71], v[48:51], v[220:223], v[68:71]
    ds_read_b64_tr_b16 v[46:47], v6 offset:25600
    v_mfma_f32_16x16x32_bf16 v[72:75], v[52:55], v[216:219], v[72:75]
    buffer_load_dwordx4 v[180:183], v2, s[4:7], s42 offen offset:256 sc1
    ds_read_b64_tr_b16 v[48:49], v3 offset:28672
    v_mfma_f32_16x16x32_bf16 v[76:79], v[52:55], v[220:223], v[76:79]
    ds_read_b64_tr_b16 v[50:51], v3 offset:29696
    s_waitcnt lgkmcnt(10)
    v_mfma_f32_16x16x32_bf16 v[80:83], v[56:59], v[216:219], v[80:83]
    buffer_load_dwordx4 v[184:187], v2, s[4:7], s42 offen offset:2048 sc1
    ds_read_b64_tr_b16 v[52:53], v4 offset:28672
    v_mfma_f32_16x16x32_bf16 v[84:87], v[56:59], v[220:223], v[84:87]
    ds_read_b64_tr_b16 v[54:55], v4 offset:29696
    v_mfma_f32_16x16x32_bf16 v[88:91], v[60:63], v[216:219], v[88:91]
    buffer_load_dwordx4 v[188:191], v2, s[4:7], s42 offen offset:2304 sc1
    ds_read_b64_tr_b16 v[56:57], v5 offset:28672
    s_add_u32 s42, s41, s92
    v_mfma_f32_16x16x32_bf16 v[92:95], v[60:63], v[220:223], v[92:95]
    ds_read_b64_tr_b16 v[58:59], v5 offset:29696
    s_waitcnt lgkmcnt(10)
    v_mfma_f32_16x16x32_bf16 v[96:99], v[216:219], v[32:35], v[96:99]
    ds_read_b64_tr_b16 v[60:61], v6 offset:28672
    v_mfma_f32_16x16x32_bf16 v[100:103], v[220:223], v[32:35], v[100:103]
    ds_read_b64_tr_b16 v[62:63], v6 offset:29696
    s_barrier
    v_mfma_f32_16x16x32_bf16 v[104:107], v[216:219], v[36:39], v[104:107]
    ds_read_b64_tr_b16 v[32:33], v3 offset:32768
    v_mfma_f32_16x16x32_bf16 v[108:111], v[220:223], v[36:39], v[108:111]
    ds_read_b64_tr_b16 v[34:35], v3 offset:33792
    s_waitcnt lgkmcnt(10)
    v_mfma_f32_16x16x32_bf16 v[112:115], v[216:219], v[40:43], v[112:115]
    ds_read_b64_tr_b16 v[36:37], v4 offset:32768
    v_mfma_f32_16x16x32_bf16 v[116:119], v[220:223], v[40:43], v[116:119]
    ds_read_b64_tr_b16 v[38:39], v4 offset:33792
    v_mfma_f32_16x16x32_bf16 v[120:123], v[216:219], v[44:47], v[120:123]
    ds_read_b64_tr_b16 v[40:41], v5 offset:32768
    v_mfma_f32_16x16x32_bf16 v[124:127], v[220:223], v[44:47], v[124:127]
    ds_read_b64_tr_b16 v[42:43], v5 offset:33792
    s_waitcnt lgkmcnt(10)
    v_mfma_f32_16x16x32_bf16 v[128:131], v[48:51], v[216:219], v[128:131]
    ds_read_b64_tr_b16 v[44:45], v6 offset:32768
    v_mfma_f32_16x16x32_bf16 v[132:135], v[48:51], v[220:223], v[132:135]
    ds_read_b64_tr_b16 v[46:47], v6 offset:33792
    v_mfma_f32_16x16x32_bf16 v[136:139], v[52:55], v[216:219], v[136:139]
    ds_read_b64_tr_b16 v[48:49], v3 offset:36864
    v_mfma_f32_16x16x32_bf16 v[140:143], v[52:55], v[220:223], v[140:143]
    ds_read_b64_tr_b16 v[50:51], v3 offset:37888
    s_waitcnt lgkmcnt(10)
    v_mfma_f32_16x16x32_bf16 v[144:147], v[56:59], v[216:219], v[144:147]
    ds_read_b64_tr_b16 v[52:53], v4 offset:36864
    v_mfma_f32_16x16x32_bf16 v[148:151], v[56:59], v[220:223], v[148:151]
    ds_read_b64_tr_b16 v[54:55], v4 offset:37888
    v_mfma_f32_16x16x32_bf16 v[152:155], v[60:63], v[216:219], v[152:155]
    ds_read_b64_tr_b16 v[56:57], v5 offset:36864
    v_mfma_f32_16x16x32_bf16 v[156:159], v[60:63], v[220:223], v[156:159]
    ds_read_b64_tr_b16 v[58:59], v5 offset:37888
    s_waitcnt vmcnt(14) lgkmcnt(10)
    v_mfma_f32_16x16x32_bf16 v[64:67], v[32:35], v[224:227], v[64:67]
    ds_read_b64_tr_b16 v[60:61], v6 offset:36864
    v_mfma_f32_16x16x32_bf16 v[68:71], v[32:35], v[228:231], v[68:71]
    ds_read_b64_tr_b16 v[62:63], v6 offset:37888
    v_mfma_f32_16x16x32_bf16 v[72:75], v[36:39], v[224:227], v[72:75]
    ds_read_b64_tr_b16 v[32:33], v3 offset:40960
    v_mfma_f32_16x16x32_bf16 v[76:79], v[36:39], v[228:231], v[76:79]
    ds_read_b64_tr_b16 v[34:35], v3 offset:41984
    s_waitcnt lgkmcnt(10)
    v_mfma_f32_16x16x32_bf16 v[80:83], v[40:43], v[224:227], v[80:83]
    ds_read_b64_tr_b16 v[36:37], v4 offset:40960
    v_mfma_f32_16x16x32_bf16 v[84:87], v[40:43], v[228:231], v[84:87]
    ds_read_b64_tr_b16 v[38:39], v4 offset:41984
    v_mfma_f32_16x16x32_bf16 v[88:91], v[44:47], v[224:227], v[88:91]
    ds_read_b64_tr_b16 v[40:41], v5 offset:40960
    v_mfma_f32_16x16x32_bf16 v[92:95], v[44:47], v[228:231], v[92:95]
    ds_read_b64_tr_b16 v[42:43], v5 offset:41984
    s_waitcnt lgkmcnt(10)
    v_mfma_f32_16x16x32_bf16 v[96:99], v[224:227], v[48:51], v[96:99]
    ds_read_b64_tr_b16 v[44:45], v6 offset:40960
    v_mfma_f32_16x16x32_bf16 v[100:103], v[228:231], v[48:51], v[100:103]
    ds_read_b64_tr_b16 v[46:47], v6 offset:41984
    v_mfma_f32_16x16x32_bf16 v[104:107], v[224:227], v[52:55], v[104:107]
    ds_read_b64_tr_b16 v[48:49], v3 offset:45056
    v_mfma_f32_16x16x32_bf16 v[108:111], v[228:231], v[52:55], v[108:111]
    ds_read_b64_tr_b16 v[50:51], v3 offset:46080
    s_waitcnt lgkmcnt(10)
    v_mfma_f32_16x16x32_bf16 v[112:115], v[224:227], v[56:59], v[112:115]
    ds_read_b64_tr_b16 v[52:53], v4 offset:45056
    v_mfma_f32_16x16x32_bf16 v[116:119], v[228:231], v[56:59], v[116:119]
    ds_read_b64_tr_b16 v[54:55], v4 offset:46080
    v_mfma_f32_16x16x32_bf16 v[120:123], v[224:227], v[60:63], v[120:123]
    ds_read_b64_tr_b16 v[56:57], v5 offset:45056
    v_mfma_f32_16x16x32_bf16 v[124:127], v[228:231], v[60:63], v[124:127]
    ds_read_b64_tr_b16 v[58:59], v5 offset:46080
    s_waitcnt lgkmcnt(10)
    v_mfma_f32_16x16x32_bf16 v[128:131], v[32:35], v[224:227], v[128:131]
    ds_read_b64_tr_b16 v[60:61], v6 offset:45056
    v_mfma_f32_16x16x32_bf16 v[132:135], v[32:35], v[228:231], v[132:135]
    ds_read_b64_tr_b16 v[62:63], v6 offset:46080
    v_mfma_f32_16x16x32_bf16 v[136:139], v[36:39], v[224:227], v[136:139]
    ds_read_b64_tr_b16 v[32:33], v3 offset:49152
    v_mfma_f32_16x16x32_bf16 v[140:143], v[36:39], v[228:231], v[140:143]
    ds_read_b64_tr_b16 v[34:35], v3 offset:50176
    s_waitcnt lgkmcnt(10)
    v_mfma_f32_16x16x32_bf16 v[144:147], v[40:43], v[224:227], v[144:147]
    ds_read_b64_tr_b16 v[36:37], v4 offset:49152
    v_mfma_f32_16x16x32_bf16 v[148:151], v[40:43], v[228:231], v[148:151]
    ds_read_b64_tr_b16 v[38:39], v4 offset:50176
    v_mfma_f32_16x16x32_bf16 v[152:155], v[44:47], v[224:227], v[152:155]
    ds_read_b64_tr_b16 v[40:41], v5 offset:49152
    v_mfma_f32_16x16x32_bf16 v[156:159], v[44:47], v[228:231], v[156:159]
    ds_read_b64_tr_b16 v[42:43], v5 offset:50176
    s_waitcnt vmcnt(12) lgkmcnt(10)
    v_mfma_f32_16x16x32_bf16 v[64:67], v[48:51], v[232:235], v[64:67]
    buffer_load_dwordx4 v[192:195], v2, s[4:7], s42 offen offset:0 sc1
    ds_read_b64_tr_b16 v[44:45], v6 offset:49152
    v_mfma_f32_16x16x32_bf16 v[68:71], v[48:51], v[236:239], v[68:71]
    ds_read_b64_tr_b16 v[46:47], v6 offset:50176
    v_mfma_f32_16x16x32_bf16 v[72:75], v[52:55], v[232:235], v[72:75]
    buffer_load_dwordx4 v[196:199], v2, s[4:7], s42 offen offset:256 sc1
    ds_read_b64_tr_b16 v[48:49], v3 offset:53248
    v_mfma_f32_16x16x32_bf16 v[76:79], v[52:55], v[236:239], v[76:79]
    ds_read_b64_tr_b16 v[50:51], v3 offset:54272
    s_waitcnt lgkmcnt(10)
    v_mfma_f32_16x16x32_bf16 v[80:83], v[56:59], v[232:235], v[80:83]
    buffer_load_dwordx4 v[200:203], v2, s[4:7], s42 offen offset:2048 sc1
    ds_read_b64_tr_b16 v[52:53], v4 offset:53248
    v_mfma_f32_16x16x32_bf16 v[84:87], v[56:59], v[236:239], v[84:87]
    ds_read_b64_tr_b16 v[54:55], v4 offset:54272
    v_mfma_f32_16x16x32_bf16 v[88:91], v[60:63], v[232:235], v[88:91]
    buffer_load_dwordx4 v[204:207], v2, s[4:7], s42 offen offset:2304 sc1
    ds_read_b64_tr_b16 v[56:57], v5 offset:53248
    s_add_u32 s42, s41, s93
    v_mfma_f32_16x16x32_bf16 v[92:95], v[60:63], v[236:239], v[92:95]
    ds_read_b64_tr_b16 v[58:59], v5 offset:54272
    s_waitcnt lgkmcnt(10)
    v_mfma_f32_16x16x32_bf16 v[96:99], v[232:235], v[32:35], v[96:99]
    ds_read_b64_tr_b16 v[60:61], v6 offset:53248
    buffer_load_dwordx4 v[208:211], v2, s[4:7], s42 offen offset:0 sc1
    v_mfma_f32_16x16x32_bf16 v[100:103], v[236:239], v[32:35], v[100:103]
    ds_read_b64_tr_b16 v[62:63], v6 offset:54272
    v_mfma_f32_16x16x32_bf16 v[104:107], v[232:235], v[36:39], v[104:107]
    ds_read_b64_tr_b16 v[32:33], v3 offset:57344
    v_mfma_f32_16x16x32_bf16 v[108:111], v[236:239], v[36:39], v[108:111]
    ds_read_b64_tr_b16 v[34:35], v3 offset:58368
    s_waitcnt lgkmcnt(10)
    v_mfma_f32_16x16x32_bf16 v[112:115], v[232:235], v[40:43], v[112:115]
    ds_read_b64_tr_b16 v[36:37], v4 offset:57344
    v_mfma_f32_16x16x32_bf16 v[116:119], v[236:239], v[40:43], v[116:119]
    ds_read_b64_tr_b16 v[38:39], v4 offset:58368
    v_mfma_f32_16x16x32_bf16 v[120:123], v[232:235], v[44:47], v[120:123]
    buffer_load_dwordx4 v[212:215], v2, s[4:7], s42 offen offset:256 sc1
    ds_read_b64_tr_b16 v[40:41], v5 offset:57344
    v_mfma_f32_16x16x32_bf16 v[124:127], v[236:239], v[44:47], v[124:127]
    ds_read_b64_tr_b16 v[42:43], v5 offset:58368
    s_waitcnt lgkmcnt(10)
    v_mfma_f32_16x16x32_bf16 v[128:131], v[48:51], v[232:235], v[128:131]
    ds_read_b64_tr_b16 v[44:45], v6 offset:57344
    v_mfma_f32_16x16x32_bf16 v[132:135], v[48:51], v[236:239], v[132:135]
    ds_read_b64_tr_b16 v[46:47], v6 offset:58368
    v_mfma_f32_16x16x32_bf16 v[136:139], v[52:55], v[232:235], v[136:139]
    ds_read_b64_tr_b16 v[48:49], v3 offset:61440
    v_mfma_f32_16x16x32_bf16 v[140:143], v[52:55], v[236:239], v[140:143]
    ds_read_b64_tr_b16 v[50:51], v3 offset:62464
    s_waitcnt lgkmcnt(10)
    v_mfma_f32_16x16x32_bf16 v[144:147], v[56:59], v[232:235], v[144:147]
    ds_read_b64_tr_b16 v[52:53], v4 offset:61440
    v_mfma_f32_16x16x32_bf16 v[148:151], v[56:59], v[236:239], v[148:151]
    ds_read_b64_tr_b16 v[54:55], v4 offset:62464
    v_mfma_f32_16x16x32_bf16 v[152:155], v[60:63], v[232:235], v[152:155]
    ds_read_b64_tr_b16 v[56:57], v5 offset:61440
    v_mfma_f32_16x16x32_bf16 v[156:159], v[60:63], v[236:239], v[156:159]
    ds_read_b64_tr_b16 v[58:59], v5 offset:62464
    s_waitcnt vmcnt(16) lgkmcnt(10)
    v_mfma_f32_16x16x32_bf16 v[64:67], v[32:35], v[240:243], v[64:67]
    ds_read_b64_tr_b16 v[60:61], v6 offset:61440
    v_mfma_f32_16x16x32_bf16 v[68:71], v[32:35], v[244:247], v[68:71]
    ds_read_b64_tr_b16 v[62:63], v6 offset:62464
    s_barrier
    v_xor_b32 v3, 0x10000, v3
    v_xor_b32 v4, 0x10000, v4
    v_xor_b32 v5, 0x10000, v5
    v_xor_b32 v6, 0x10000, v6
    v_mfma_f32_16x16x32_bf16 v[72:75], v[36:39], v[240:243], v[72:75]
    ds_read_b64_tr_b16 v[32:33], v3 offset:0
    v_mfma_f32_16x16x32_bf16 v[76:79], v[36:39], v[244:247], v[76:79]
    ds_read_b64_tr_b16 v[34:35], v3 offset:1024
    s_waitcnt lgkmcnt(10)
    v_mfma_f32_16x16x32_bf16 v[80:83], v[40:43], v[240:243], v[80:83]
    ds_read_b64_tr_b16 v[36:37], v4 offset:0
    v_mfma_f32_16x16x32_bf16 v[84:87], v[40:43], v[244:247], v[84:87]
    ds_read_b64_tr_b16 v[38:39], v4 offset:1024
    v_mfma_f32_16x16x32_bf16 v[88:91], v[44:47], v[240:243], v[88:91]
    ds_read_b64_tr_b16 v[40:41], v5 offset:0
    v_mfma_f32_16x16x32_bf16 v[92:95], v[44:47], v[244:247], v[92:95]
    ds_read_b64_tr_b16 v[42:43], v5 offset:1024
    s_waitcnt lgkmcnt(10)
    v_mfma_f32_16x16x32_bf16 v[96:99], v[240:243], v[48:51], v[96:99]
    ds_read_b64_tr_b16 v[44:45], v6 offset:0
    v_mfma_f32_16x16x32_bf16 v[100:103], v[244:247], v[48:51], v[100:103]
    ds_read_b64_tr_b16 v[46:47], v6 offset:1024
    v_mfma_f32_16x16x32_bf16 v[104:107], v[240:243], v[52:55], v[104:107]
    ds_read_b64_tr_b16 v[48:49], v3 offset:4096
    v_mfma_f32_16x16x32_bf16 v[108:111], v[244:247], v[52:55], v[108:111]
    ds_read_b64_tr_b16 v[50:51], v3 offset:5120
    s_waitcnt lgkmcnt(10)
    v_mfma_f32_16x16x32_bf16 v[112:115], v[240:243], v[56:59], v[112:115]
    ds_read_b64_tr_b16 v[52:53], v4 offset:4096
    v_mfma_f32_16x16x32_bf16 v[116:119], v[244:247], v[56:59], v[116:119]
    ds_read_b64_tr_b16 v[54:55], v4 offset:5120
    v_mfma_f32_16x16x32_bf16 v[120:123], v[240:243], v[60:63], v[120:123]
    ds_read_b64_tr_b16 v[56:57], v5 offset:4096
    v_mfma_f32_16x16x32_bf16 v[124:127], v[244:247], v[60:63], v[124:127]
    ds_read_b64_tr_b16 v[58:59], v5 offset:5120
    s_waitcnt lgkmcnt(10)
    v_mfma_f32_16x16x32_bf16 v[128:131], v[32:35], v[240:243], v[128:131]
    ds_read_b64_tr_b16 v[60:61], v6 offset:4096
    v_mfma_f32_16x16x32_bf16 v[132:135], v[32:35], v[244:247], v[132:135]
    ds_read_b64_tr_b16 v[62:63], v6 offset:5120
    v_mfma_f32_16x16x32_bf16 v[136:139], v[36:39], v[240:243], v[136:139]
    ds_read_b64_tr_b16 v[32:33], v3 offset:8192
    v_mfma_f32_16x16x32_bf16 v[140:143], v[36:39], v[244:247], v[140:143]
    ds_read_b64_tr_b16 v[34:35], v3 offset:9216
    s_waitcnt lgkmcnt(10)
    v_mfma_f32_16x16x32_bf16 v[144:147], v[40:43], v[240:243], v[144:147]
    ds_read_b64_tr_b16 v[36:37], v4 offset:8192
    v_mfma_f32_16x16x32_bf16 v[148:151], v[40:43], v[244:247], v[148:151]
    ds_read_b64_tr_b16 v[38:39], v4 offset:9216
    v_mfma_f32_16x16x32_bf16 v[152:155], v[44:47], v[240:243], v[152:155]
    ds_read_b64_tr_b16 v[40:41], v5 offset:8192
    v_mfma_f32_16x16x32_bf16 v[156:159], v[44:47], v[244:247], v[156:159]
    ds_read_b64_tr_b16 v[42:43], v5 offset:9216
    s_waitcnt vmcnt(14) lgkmcnt(10)
    v_mfma_f32_16x16x32_bf16 v[64:67], v[48:51], v[248:251], v[64:67]
    ds_read_b64_tr_b16 v[44:45], v6 offset:8192
    v_mfma_f32_16x16x32_bf16 v[68:71], v[48:51], v[252:255], v[68:71]
    ds_read_b64_tr_b16 v[46:47], v6 offset:9216
    v_mfma_f32_16x16x32_bf16 v[72:75], v[52:55], v[248:251], v[72:75]
    ds_read_b64_tr_b16 v[48:49], v3 offset:12288
    v_mfma_f32_16x16x32_bf16 v[76:79], v[52:55], v[252:255], v[76:79]
    ds_read_b64_tr_b16 v[50:51], v3 offset:13312
    s_waitcnt lgkmcnt(10)
    v_mfma_f32_16x16x32_bf16 v[80:83], v[56:59], v[248:251], v[80:83]
    ds_read_b64_tr_b16 v[52:53], v4 offset:12288
    v_mfma_f32_16x16x32_bf16 v[84:87], v[56:59], v[252:255], v[84:87]
    ds_read_b64_tr_b16 v[54:55], v4 offset:13312
    v_mfma_f32_16x16x32_bf16 v[88:91], v[60:63], v[248:251], v[88:91]
    ds_read_b64_tr_b16 v[56:57], v5 offset:12288
    v_mfma_f32_16x16x32_bf16 v[92:95], v[60:63], v[252:255], v[92:95]
    ds_read_b64_tr_b16 v[58:59], v5 offset:13312
    s_waitcnt lgkmcnt(10)
    v_mfma_f32_16x16x32_bf16 v[96:99], v[248:251], v[32:35], v[96:99]
    ds_read_b64_tr_b16 v[60:61], v6 offset:12288
    v_mfma_f32_16x16x32_bf16 v[100:103], v[252:255], v[32:35], v[100:103]
    ds_read_b64_tr_b16 v[62:63], v6 offset:13312
    v_mfma_f32_16x16x32_bf16 v[104:107], v[248:251], v[36:39], v[104:107]
    ds_read_b64_tr_b16 v[32:33], v3 offset:16384
    v_mfma_f32_16x16x32_bf16 v[108:111], v[252:255], v[36:39], v[108:111]
    ds_read_b64_tr_b16 v[34:35], v3 offset:17408
    s_waitcnt lgkmcnt(10)
    v_mfma_f32_16x16x32_bf16 v[112:115], v[248:251], v[40:43], v[112:115]
    ds_read_b64_tr_b16 v[36:37], v4 offset:16384
    v_mfma_f32_16x16x32_bf16 v[116:119], v[252:255], v[40:43], v[116:119]
    ds_read_b64_tr_b16 v[38:39], v4 offset:17408
    v_mfma_f32_16x16x32_bf16 v[120:123], v[248:251], v[44:47], v[120:123]
    ds_read_b64_tr_b16 v[40:41], v5 offset:16384
    v_mfma_f32_16x16x32_bf16 v[124:127], v[252:255], v[44:47], v[124:127]
    ds_read_b64_tr_b16 v[42:43], v5 offset:17408
    s_waitcnt lgkmcnt(10)
    v_mfma_f32_16x16x32_bf16 v[128:131], v[48:51], v[248:251], v[128:131]
    buffer_load_dwordx4 v[216:219], v2, s[4:7], s42 offen offset:2048 sc1
    ds_read_b64_tr_b16 v[44:45], v6 offset:16384
    v_mfma_f32_16x16x32_bf16 v[132:135], v[48:51], v[252:255], v[132:135]
    ds_read_b64_tr_b16 v[46:47], v6 offset:17408
    v_mfma_f32_16x16x32_bf16 v[136:139], v[52:55], v[248:251], v[136:139]
    buffer_load_dwordx4 v[220:223], v2, s[4:7], s42 offen offset:2304 sc1
    ds_read_b64_tr_b16 v[48:49], v3 offset:20480
    s_add_u32 s42, s41, s94
    v_mfma_f32_16x16x32_bf16 v[140:143], v[52:55], v[252:255], v[140:143]
    ds_read_b64_tr_b16 v[50:51], v3 offset:21504
    s_waitcnt lgkmcnt(10)
    v_mfma_f32_16x16x32_bf16 v[144:147], v[56:59], v[248:251], v[144:147]
    buffer_load_dwordx4 v[224:227], v2, s[4:7], s42 offen offset:0 sc1
    ds_read_b64_tr_b16 v[52:53], v4 offset:20480
    v_mfma_f32_16x16x32_bf16 v[148:151], v[56:59], v[252:255], v[148:151]
    ds_read_b64_tr_b16 v[54:55], v4 offset:21504
    v_mfma_f32_16x16x32_bf16 v[152:155], v[60:63], v[248:251], v[152:155]
    buffer_load_dwordx4 v[228:231], v2, s[4:7], s42 offen offset:256 sc1
    ds_read_b64_tr_b16 v[56:57], v5 offset:20480
    v_mfma_f32_16x16x32_bf16 v[156:159], v[60:63], v[252:255], v[156:159]
    ds_read_b64_tr_b16 v[58:59], v5 offset:21504
    s_waitcnt vmcnt(16) lgkmcnt(10)
    v_mfma_f32_16x16x32_bf16 v[64:67], v[32:35], v[160:163], v[64:67]
    ds_read_b64_tr_b16 v[60:61], v6 offset:20480
    buffer_load_dwordx4 v[232:235], v2, s[4:7], s42 offen offset:2048 sc1
    v_mfma_f32_16x16x32_bf16 v[68:71], v[32:35], v[164:167], v[68:71]
    ds_read_b64_tr_b16 v[62:63], v6 offset:21504
    v_mfma_f32_16x16x32_bf16 v[72:75], v[36:39], v[160:163], v[72:75]
    buffer_load_dwordx4 v[236:239], v2, s[4:7], s42 offen offset:2304 sc1
    ds_read_b64_tr_b16 v[32:33], v3 offset:24576
    s_add_u32 s42, s41, s95
    v_mfma_f32_16x16x32_bf16 v[76:79], v[36:39], v[164:167], v[76:79]
    ds_read_b64_tr_b16 v[34:35], v3 offset:25600
    s_waitcnt lgkmcnt(10)
    v_mfma_f32_16x16x32_bf16 v[80:83], v[40:43], v[160:163], v[80:83]
    ds_read_b64_tr_b16 v[36:37], v4 offset:24576
    v_mfma_f32_16x16x32_bf16 v[84:87], v[40:43], v[164:167], v[84:87]
    ds_read_b64_tr_b16 v[38:39], v4 offset:25600
    v_mfma_f32_16x16x32_bf16 v[88:91], v[44:47], v[160:163], v[88:91]
    ds_read_b64_tr_b16 v[40:41], v5 offset:24576
    v_mfma_f32_16x16x32_bf16 v[92:95], v[44:47], v[164:167], v[92:95]
    ds_read_b64_tr_b16 v[42:43], v5 offset:25600
    s_waitcnt lgkmcnt(10)
    v_mfma_f32_16x16x32_bf16 v[96:99], v[160:163], v[48:51], v[96:99]
    buffer_load_dwordx4 v[240:243], v2, s[4:7], s42 offen offset:0 sc1
    ds_read_b64_tr_b16 v[44:45], v6 offset:24576
    v_mfma_f32_16x16x32_bf16 v[100:103], v[164:167], v[48:51], v[100:103]
    ds_read_b64_tr_b16 v[46:47], v6 offset:25600
    v_mfma_f32_16x16x32_bf16 v[104:107], v[160:163], v[52:55], v[104:107]
    ds_read_b64_tr_b16 v[48:49], v3 offset:28672
    v_mfma_f32_16x16x32_bf16 v[108:111], v[164:167], v[52:55], v[108:111]
    ds_read_b64_tr_b16 v[50:51], v3 offset:29696
    s_waitcnt lgkmcnt(10)
    v_mfma_f32_16x16x32_bf16 v[112:115], v[160:163], v[56:59], v[112:115]
    ds_read_b64_tr_b16 v[52:53], v4 offset:28672
    v_mfma_f32_16x16x32_bf16 v[116:119], v[164:167], v[56:59], v[116:119]
    ds_read_b64_tr_b16 v[54:55], v4 offset:29696
    v_mfma_f32_16x16x32_bf16 v[120:123], v[160:163], v[60:63], v[120:123]
    ds_read_b64_tr_b16 v[56:57], v5 offset:28672
    v_mfma_f32_16x16x32_bf16 v[124:127], v[164:167], v[60:63], v[124:127]
    ds_read_b64_tr_b16 v[58:59], v5 offset:29696
    s_waitcnt lgkmcnt(10)
    v_mfma_f32_16x16x32_bf16 v[128:131], v[32:35], v[160:163], v[128:131]
    ds_read_b64_tr_b16 v[60:61], v6 offset:28672
    v_mfma_f32_16x16x32_bf16 v[132:135], v[32:35], v[164:167], v[132:135]
    ds_read_b64_tr_b16 v[62:63], v6 offset:29696
    s_barrier
    v_mfma_f32_16x16x32_bf16 v[136:139], v[36:39], v[160:163], v[136:139]
    ds_read_b64_tr_b16 v[32:33], v3 offset:32768
    v_mfma_f32_16x16x32_bf16 v[140:143], v[36:39], v[164:167], v[140:143]
    ds_read_b64_tr_b16 v[34:35], v3 offset:33792
    s_waitcnt lgkmcnt(10)
    v_mfma_f32_16x16x32_bf16 v[144:147], v[40:43], v[160:163], v[144:147]
    ds_read_b64_tr_b16 v[36:37], v4 offset:32768
    v_mfma_f32_16x16x32_bf16 v[148:151], v[40:43], v[164:167], v[148:151]
    ds_read_b64_tr_b16 v[38:39], v4 offset:33792
    v_mfma_f32_16x16x32_bf16 v[152:155], v[44:47], v[160:163], v[152:155]
    ds_read_b64_tr_b16 v[40:41], v5 offset:32768
    v_mfma_f32_16x16x32_bf16 v[156:159], v[44:47], v[164:167], v[156:159]
    ds_read_b64_tr_b16 v[42:43], v5 offset:33792
    s_waitcnt vmcnt(17) lgkmcnt(10)
    v_mfma_f32_16x16x32_bf16 v[64:67], v[48:51], v[168:171], v[64:67]
    ds_read_b64_tr_b16 v[44:45], v6 offset:32768
    v_mfma_f32_16x16x32_bf16 v[68:71], v[48:51], v[172:175], v[68:71]
    ds_read_b64_tr_b16 v[46:47], v6 offset:33792
    v_mfma_f32_16x16x32_bf16 v[72:75], v[52:55], v[168:171], v[72:75]
    ds_read_b64_tr_b16 v[48:49], v3 offset:36864
    v_mfma_f32_16x16x32_bf16 v[76:79], v[52:55], v[172:175], v[76:79]
    ds_read_b64_tr_b16 v[50:51], v3 offset:37888
    s_waitcnt lgkmcnt(10)
    v_mfma_f32_16x16x32_bf16 v[80:83], v[56:59], v[168:171], v[80:83]
    ds_read_b64_tr_b16 v[52:53], v4 offset:36864
    v_mfma_f32_16x16x32_bf16 v[84:87], v[56:59], v[172:175], v[84:87]
    ds_read_b64_tr_b16 v[54:55], v4 offset:37888
    v_mfma_f32_16x16x32_bf16 v[88:91], v[60:63], v[168:171], v[88:91]
    ds_read_b64_tr_b16 v[56:57], v5 offset:36864
    v_mfma_f32_16x16x32_bf16 v[92:95], v[60:63], v[172:175], v[92:95]
    ds_read_b64_tr_b16 v[58:59], v5 offset:37888
    s_waitcnt lgkmcnt(10)
    v_mfma_f32_16x16x32_bf16 v[96:99], v[168:171], v[32:35], v[96:99]
    ds_read_b64_tr_b16 v[60:61], v6 offset:36864
    v_mfma_f32_16x16x32_bf16 v[100:103], v[172:175], v[32:35], v[100:103]
    ds_read_b64_tr_b16 v[62:63], v6 offset:37888
    v_mfma_f32_16x16x32_bf16 v[104:107], v[168:171], v[36:39], v[104:107]
    ds_read_b64_tr_b16 v[32:33], v3 offset:40960
    v_mfma_f32_16x16x32_bf16 v[108:111], v[172:175], v[36:39], v[108:111]
    ds_read_b64_tr_b16 v[34:35], v3 offset:41984
    s_waitcnt lgkmcnt(10)
    v_mfma_f32_16x16x32_bf16 v[112:115], v[168:171], v[40:43], v[112:115]
    ds_read_b64_tr_b16 v[36:37], v4 offset:40960
    v_mfma_f32_16x16x32_bf16 v[116:119], v[172:175], v[40:43], v[116:119]
    ds_read_b64_tr_b16 v[38:39], v4 offset:41984
    v_mfma_f32_16x16x32_bf16 v[120:123], v[168:171], v[44:47], v[120:123]
    ds_read_b64_tr_b16 v[40:41], v5 offset:40960
    v_mfma_f32_16x16x32_bf16 v[124:127], v[172:175], v[44:47], v[124:127]
    ds_read_b64_tr_b16 v[42:43], v5 offset:41984
    s_waitcnt lgkmcnt(10)
    v_mfma_f32_16x16x32_bf16 v[128:131], v[48:51], v[168:171], v[128:131]
    ds_read_b64_tr_b16 v[44:45], v6 offset:40960
    v_mfma_f32_16x16x32_bf16 v[132:135], v[48:51], v[172:175], v[132:135]
    ds_read_b64_tr_b16 v[46:47], v6 offset:41984
    v_mfma_f32_16x16x32_bf16 v[136:139], v[52:55], v[168:171], v[136:139]
    ds_read_b64_tr_b16 v[48:49], v3 offset:45056
    v_mfma_f32_16x16x32_bf16 v[140:143], v[52:55], v[172:175], v[140:143]
    ds_read_b64_tr_b16 v[50:51], v3 offset:46080
    s_waitcnt lgkmcnt(10)
    v_mfma_f32_16x16x32_bf16 v[144:147], v[56:59], v[168:171], v[144:147]
    ds_read_b64_tr_b16 v[52:53], v4 offset:45056
    v_mfma_f32_16x16x32_bf16 v[148:151], v[56:59], v[172:175], v[148:151]
    ds_read_b64_tr_b16 v[54:55], v4 offset:46080
    v_mfma_f32_16x16x32_bf16 v[152:155], v[60:63], v[168:171], v[152:155]
    ds_read_b64_tr_b16 v[56:57], v5 offset:45056
    v_mfma_f32_16x16x32_bf16 v[156:159], v[60:63], v[172:175], v[156:159]
    ds_read_b64_tr_b16 v[58:59], v5 offset:46080
    s_waitcnt vmcnt(15) lgkmcnt(10)
    v_mfma_f32_16x16x32_bf16 v[64:67], v[32:35], v[176:179], v[64:67]
    ds_read_b64_tr_b16 v[60:61], v6 offset:45056
    v_mfma_f32_16x16x32_bf16 v[68:71], v[32:35], v[180:183], v[68:71]
    ds_read_b64_tr_b16 v[62:63], v6 offset:46080
    v_mfma_f32_16x16x32_bf16 v[72:75], v[36:39], v[176:179], v[72:75]
    ds_read_b64_tr_b16 v[32:33], v3 offset:49152
    v_mfma_f32_16x16x32_bf16 v[76:79], v[36:39], v[180:183], v[76:79]
    ds_read_b64_tr_b16 v[34:35], v3 offset:50176
    s_waitcnt lgkmcnt(10)
    v_mfma_f32_16x16x32_bf16 v[80:83], v[40:43], v[176:179], v[80:83]
    ds_read_b64_tr_b16 v[36:37], v4 offset:49152
    v_mfma_f32_16x16x32_bf16 v[84:87], v[40:43], v[180:183], v[84:87]
    ds_read_b64_tr_b16 v[38:39], v4 offset:50176
    v_mfma_f32_16x16x32_bf16 v[88:91], v[44:47], v[176:179], v[88:91]
    ds_read_b64_tr_b16 v[40:41], v5 offset:49152
    v_mfma_f32_16x16x32_bf16 v[92:95], v[44:47], v[180:183], v[92:95]
    ds_read_b64_tr_b16 v[42:43], v5 offset:50176
    s_waitcnt lgkmcnt(10)
    v_mfma_f32_16x16x32_bf16 v[96:99], v[176:179], v[48:51], v[96:99]
    buffer_load_dwordx4 v[244:247], v2, s[4:7], s42 offen offset:256 sc1
    ds_read_b64_tr_b16 v[44:45], v6 offset:49152
    v_mfma_f32_16x16x32_bf16 v[100:103], v[180:183], v[48:51], v[100:103]
    ds_read_b64_tr_b16 v[46:47], v6 offset:50176
    v_mfma_f32_16x16x32_bf16 v[104:107], v[176:179], v[52:55], v[104:107]
    buffer_load_dwordx4 v[248:251], v2, s[4:7], s42 offen offset:2048 sc1
    ds_read_b64_tr_b16 v[48:49], v3 offset:53248
    v_mfma_f32_16x16x32_bf16 v[108:111], v[180:183], v[52:55], v[108:111]
    ds_read_b64_tr_b16 v[50:51], v3 offset:54272
    s_waitcnt lgkmcnt(10)
    v_mfma_f32_16x16x32_bf16 v[112:115], v[176:179], v[56:59], v[112:115]
    buffer_load_dwordx4 v[252:255], v2, s[4:7], s42 offen offset:2304 sc1
    ds_read_b64_tr_b16 v[52:53], v4 offset:53248
    s_add_u32 s42, s41, s96
    v_mfma_f32_16x16x32_bf16 v[116:119], v[180:183], v[56:59], v[116:119]
    ds_read_b64_tr_b16 v[54:55], v4 offset:54272
    v_mfma_f32_16x16x32_bf16 v[120:123], v[176:179], v[60:63], v[120:123]
    buffer_load_dwordx4 v[160:163], v2, s[4:7], s42 offen offset:0 sc1
    ds_read_b64_tr_b16 v[56:57], v5 offset:53248
    v_mfma_f32_16x16x32_bf16 v[124:127], v[180:183], v[60:63], v[124:127]
    ds_read_b64_tr_b16 v[58:59], v5 offset:54272
    s_waitcnt lgkmcnt(10)
    v_mfma_f32_16x16x32_bf16 v[128:131], v[32:35], v[176:179], v[128:131]
    ds_read_b64_tr_b16 v[60:61], v6 offset:53248
    buffer_load_dwordx4 v[164:167], v2, s[4:7], s42 offen offset:256 sc1
    v_mfma_f32_16x16x32_bf16 v[132:135], v[32:35], v[180:183], v[132:135]
    ds_read_b64_tr_b16 v[62:63], v6 offset:54272
    v_mfma_f32_16x16x32_bf16 v[136:139], v[36:39], v[176:179], v[136:139]
    buffer_load_dwordx4 v[168:171], v2, s[4:7], s42 offen offset:2048 sc1
    ds_read_b64_tr_b16 v[32:33], v3 offset:57344
    v_mfma_f32_16x16x32_bf16 v[140:143], v[36:39], v[180:183], v[140:143]
    ds_read_b64_tr_b16 v[34:35], v3 offset:58368
    s_waitcnt lgkmcnt(10)
    v_mfma_f32_16x16x32_bf16 v[144:147], v[40:43], v[176:179], v[144:147]
    ds_read_b64_tr_b16 v[36:37], v4 offset:57344
    v_mfma_f32_16x16x32_bf16 v[148:151], v[40:43], v[180:183], v[148:151]
    ds_read_b64_tr_b16 v[38:39], v4 offset:58368
    v_mfma_f32_16x16x32_bf16 v[152:155], v[44:47], v[176:179], v[152:155]
    ds_read_b64_tr_b16 v[40:41], v5 offset:57344
    v_mfma_f32_16x16x32_bf16 v[156:159], v[44:47], v[180:183], v[156:159]
    ds_read_b64_tr_b16 v[42:43], v5 offset:58368
    s_waitcnt vmcnt(19) lgkmcnt(10)
    v_mfma_f32_16x16x32_bf16 v[64:67], v[48:51], v[184:187], v[64:67]
    ds_read_b64_tr_b16 v[44:45], v6 offset:57344
    v_mfma_f32_16x16x32_bf16 v[68:71], v[48:51], v[188:191], v[68:71]
    ds_read_b64_tr_b16 v[46:47], v6 offset:58368
    v_mfma_f32_16x16x32_bf16 v[72:75], v[52:55], v[184:187], v[72:75]
    ds_read_b64_tr_b16 v[48:49], v3 offset:61440
    v_mfma_f32_16x16x32_bf16 v[76:79], v[52:55], v[188:191], v[76:79]
    ds_read_b64_tr_b16 v[50:51], v3 offset:62464
    s_waitcnt lgkmcnt(10)
    v_mfma_f32_16x16x32_bf16 v[80:83], v[56:59], v[184:187], v[80:83]
    buffer_load_dwordx4 v[172:175], v2, s[4:7], s42 offen offset:2304 sc1
    ds_read_b64_tr_b16 v[52:53], v4 offset:61440
    s_add_u32 s42, s41, s97
    v_mfma_f32_16x16x32_bf16 v[84:87], v[56:59], v[188:191], v[84:87]
    ds_read_b64_tr_b16 v[54:55], v4 offset:62464
    v_mfma_f32_16x16x32_bf16 v[88:91], v[60:63], v[184:187], v[88:91]
    ds_read_b64_tr_b16 v[56:57], v5 offset:61440
    v_mfma_f32_16x16x32_bf16 v[92:95], v[60:63], v[188:191], v[92:95]
    ds_read_b64_tr_b16 v[58:59], v5 offset:62464
    s_waitcnt lgkmcnt(10)
    v_mfma_f32_16x16x32_bf16 v[96:99], v[184:187], v[32:35], v[96:99]
    ds_read_b64_tr_b16 v[60:61], v6 offset:61440
    v_mfma_f32_16x16x32_bf16 v[100:103], v[188:191], v[32:35], v[100:103]
    ds_read_b64_tr_b16 v[62:63], v6 offset:62464
    s_barrier
    v_xor_b32 v3, 0x10000, v3
    v_xor_b32 v4, 0x10000, v4
    v_xor_b32 v5, 0x10000, v5
    v_xor_b32 v6, 0x10000, v6
    v_mfma_f32_16x16x32_bf16 v[104:107], v[184:187], v[36:39], v[104:107]
    ds_read_b64_tr_b16 v[32:33], v3 offset:0
    v_mfma_f32_16x16x32_bf16 v[108:111], v[188:191], v[36:39], v[108:111]
    ds_read_b64_tr_b16 v[34:35], v3 offset:1024
    s_waitcnt lgkmcnt(10)
    v_mfma_f32_16x16x32_bf16 v[112:115], v[184:187], v[40:43], v[112:115]
    ds_read_b64_tr_b16 v[36:37], v4 offset:0
    v_mfma_f32_16x16x32_bf16 v[116:119], v[188:191], v[40:43], v[116:119]
    ds_read_b64_tr_b16 v[38:39], v4 offset:1024
    v_mfma_f32_16x16x32_bf16 v[120:123], v[184:187], v[44:47], v[120:123]
    ds_read_b64_tr_b16 v[40:41], v5 offset:0
    v_mfma_f32_16x16x32_bf16 v[124:127], v[188:191], v[44:47], v[124:127]
    ds_read_b64_tr_b16 v[42:43], v5 offset:1024
    s_waitcnt lgkmcnt(10)
    v_mfma_f32_16x16x32_bf16 v[128:131], v[48:51], v[184:187], v[128:131]
    ds_read_b64_tr_b16 v[44:45], v6 offset:0
    v_mfma_f32_16x16x32_bf16 v[132:135], v[48:51], v[188:191], v[132:135]
    ds_read_b64_tr_b16 v[46:47], v6 offset:1024
    v_mfma_f32_16x16x32_bf16 v[136:139], v[52:55], v[184:187], v[136:139]
    ds_read_b64_tr_b16 v[48:49], v3 offset:4096
    v_mfma_f32_16x16x32_bf16 v[140:143], v[52:55], v[188:191], v[140:143]
    ds_read_b64_tr_b16 v[50:51], v3 offset:5120
    s_waitcnt lgkmcnt(10)
    v_mfma_f32_16x16x32_bf16 v[144:147], v[56:59], v[184:187], v[144:147]
    ds_read_b64_tr_b16 v[52:53], v4 offset:4096
    v_mfma_f32_16x16x32_bf16 v[148:151], v[56:59], v[188:191], v[148:151]
    ds_read_b64_tr_b16 v[54:55], v4 offset:5120
    v_mfma_f32_16x16x32_bf16 v[152:155], v[60:63], v[184:187], v[152:155]
    ds_read_b64_tr_b16 v[56:57], v5 offset:4096
    v_mfma_f32_16x16x32_bf16 v[156:159], v[60:63], v[188:191], v[156:159]
    ds_read_b64_tr_b16 v[58:59], v5 offset:5120
    s_waitcnt vmcnt(18) lgkmcnt(10)
    v_mfma_f32_16x16x32_bf16 v[64:67], v[32:35], v[192:195], v[64:67]
    ds_read_b64_tr_b16 v[60:61], v6 offset:4096
    v_mfma_f32_16x16x32_bf16 v[68:71], v[32:35], v[196:199], v[68:71]
    ds_read_b64_tr_b16 v[62:63], v6 offset:5120
    v_mfma_f32_16x16x32_bf16 v[72:75], v[36:39], v[192:195], v[72:75]
    ds_read_b64_tr_b16 v[32:33], v3 offset:8192
    v_mfma_f32_16x16x32_bf16 v[76:79], v[36:39], v[196:199], v[76:79]
    ds_read_b64_tr_b16 v[34:35], v3 offset:9216
    s_waitcnt lgkmcnt(10)
    v_mfma_f32_16x16x32_bf16 v[80:83], v[40:43], v[192:195], v[80:83]
    ds_read_b64_tr_b16 v[36:37], v4 offset:8192
    v_mfma_f32_16x16x32_bf16 v[84:87], v[40:43], v[196:199], v[84:87]
    ds_read_b64_tr_b16 v[38:39], v4 offset:9216
    v_mfma_f32_16x16x32_bf16 v[88:91], v[44:47], v[192:195], v[88:91]
    ds_read_b64_tr_b16 v[40:41], v5 offset:8192
    v_mfma_f32_16x16x32_bf16 v[92:95], v[44:47], v[196:199], v[92:95]
    ds_read_b64_tr_b16 v[42:43], v5 offset:9216
    s_waitcnt lgkmcnt(10)
    v_mfma_f32_16x16x32_bf16 v[96:99], v[192:195], v[48:51], v[96:99]
    ds_read_b64_tr_b16 v[44:45], v6 offset:8192
    v_mfma_f32_16x16x32_bf16 v[100:103], v[196:199], v[48:51], v[100:103]
    ds_read_b64_tr_b16 v[46:47], v6 offset:9216
    v_mfma_f32_16x16x32_bf16 v[104:107], v[192:195], v[52:55], v[104:107]
    ds_read_b64_tr_b16 v[48:49], v3 offset:12288
    v_mfma_f32_16x16x32_bf16 v[108:111], v[196:199], v[52:55], v[108:111]
    ds_read_b64_tr_b16 v[50:51], v3 offset:13312
    s_waitcnt lgkmcnt(10)
    v_mfma_f32_16x16x32_bf16 v[112:115], v[192:195], v[56:59], v[112:115]
    ds_read_b64_tr_b16 v[52:53], v4 offset:12288
    v_mfma_f32_16x16x32_bf16 v[116:119], v[196:199], v[56:59], v[116:119]
    ds_read_b64_tr_b16 v[54:55], v4 offset:13312
    v_mfma_f32_16x16x32_bf16 v[120:123], v[192:195], v[60:63], v[120:123]
    ds_read_b64_tr_b16 v[56:57], v5 offset:12288
    v_mfma_f32_16x16x32_bf16 v[124:127], v[196:199], v[60:63], v[124:127]
    ds_read_b64_tr_b16 v[58:59], v5 offset:13312
    s_waitcnt lgkmcnt(10)
    v_mfma_f32_16x16x32_bf16 v[128:131], v[32:35], v[192:195], v[128:131]
    ds_read_b64_tr_b16 v[60:61], v6 offset:12288
    v_mfma_f32_16x16x32_bf16 v[132:135], v[32:35], v[196:199], v[132:135]
    ds_read_b64_tr_b16 v[62:63], v6 offset:13312
    v_mfma_f32_16x16x32_bf16 v[136:139], v[36:39], v[192:195], v[136:139]
    ds_read_b64_tr_b16 v[32:33], v3 offset:16384
    v_mfma_f32_16x16x32_bf16 v[140:143], v[36:39], v[196:199], v[140:143]
    ds_read_b64_tr_b16 v[34:35], v3 offset:17408
    s_waitcnt lgkmcnt(10)
    v_mfma_f32_16x16x32_bf16 v[144:147], v[40:43], v[192:195], v[144:147]
    ds_read_b64_tr_b16 v[36:37], v4 offset:16384
    v_mfma_f32_16x16x32_bf16 v[148:151], v[40:43], v[196:199], v[148:151]
    ds_read_b64_tr_b16 v[38:39], v4 offset:17408
    v_mfma_f32_16x16x32_bf16 v[152:155], v[44:47], v[192:195], v[152:155]
    ds_read_b64_tr_b16 v[40:41], v5 offset:16384
    v_mfma_f32_16x16x32_bf16 v[156:159], v[44:47], v[196:199], v[156:159]
    ds_read_b64_tr_b16 v[42:43], v5 offset:17408
    s_waitcnt vmcnt(16) lgkmcnt(10)
    v_mfma_f32_16x16x32_bf16 v[64:67], v[48:51], v[200:203], v[64:67]
    buffer_load_dwordx4 v[176:179], v2, s[4:7], s42 offen offset:0 sc1
    ds_read_b64_tr_b16 v[44:45], v6 offset:16384
    v_mfma_f32_16x16x32_bf16 v[68:71], v[48:51], v[204:207], v[68:71]
    ds_read_b64_tr_b16 v[46:47], v6 offset:17408
    v_mfma_f32_16x16x32_bf16 v[72:75], v[52:55], v[200:203], v[72:75]
    buffer_load_dwordx4 v[180:183], v2, s[4:7], s42 offen offset:256 sc1
    ds_read_b64_tr_b16 v[48:49], v3 offset:20480
    v_mfma_f32_16x16x32_bf16 v[76:79], v[52:55], v[204:207], v[76:79]
    ds_read_b64_tr_b16 v[50:51], v3 offset:21504
    s_waitcnt lgkmcnt(10)
    v_mfma_f32_16x16x32_bf16 v[80:83], v[56:59], v[200:203], v[80:83]
    buffer_load_dwordx4 v[184:187], v2, s[4:7], s42 offen offset:2048 sc1
    ds_read_b64_tr_b16 v[52:53], v4 offset:20480
    v_mfma_f32_16x16x32_bf16 v[84:87], v[56:59], v[204:207], v[84:87]
    ds_read_b64_tr_b16 v[54:55], v4 offset:21504
    v_mfma_f32_16x16x32_bf16 v[88:91], v[60:63], v[200:203], v[88:91]
    buffer_load_dwordx4 v[188:191], v2, s[4:7], s42 offen offset:2304 sc1
    ds_read_b64_tr_b16 v[56:57], v5 offset:20480
    s_add_u32 s42, s41, s98
    v_mfma_f32_16x16x32_bf16 v[92:95], v[60:63], v[204:207], v[92:95]
    ds_read_b64_tr_b16 v[58:59], v5 offset:21504
    s_waitcnt lgkmcnt(10)
    v_mfma_f32_16x16x32_bf16 v[96:99], v[200:203], v[32:35], v[96:99]
    ds_read_b64_tr_b16 v[60:61], v6 offset:20480
    buffer_load_dwordx4 v[192:195], v2, s[4:7], s42 offen offset:0 sc1
    v_mfma_f32_16x16x32_bf16 v[100:103], v[204:207], v[32:35], v[100:103]
    ds_read_b64_tr_b16 v[62:63], v6 offset:21504
    v_mfma_f32_16x16x32_bf16 v[104:107], v[200:203], v[36:39], v[104:107]
    ds_read_b64_tr_b16 v[32:33], v3 offset:24576
    v_mfma_f32_16x16x32_bf16 v[108:111], v[204:207], v[36:39], v[108:111]
    ds_read_b64_tr_b16 v[34:35], v3 offset:25600
    s_waitcnt lgkmcnt(10)
    v_mfma_f32_16x16x32_bf16 v[112:115], v[200:203], v[40:43], v[112:115]
    ds_read_b64_tr_b16 v[36:37], v4 offset:24576
    v_mfma_f32_16x16x32_bf16 v[116:119], v[204:207], v[40:43], v[116:119]
    ds_read_b64_tr_b16 v[38:39], v4 offset:25600
    v_mfma_f32_16x16x32_bf16 v[120:123], v[200:203], v[44:47], v[120:123]
    buffer_load_dwordx4 v[196:199], v2, s[4:7], s42 offen offset:256 sc1
    ds_read_b64_tr_b16 v[40:41], v5 offset:24576
    v_mfma_f32_16x16x32_bf16 v[124:127], v[204:207], v[44:47], v[124:127]
    ds_read_b64_tr_b16 v[42:43], v5 offset:25600
    s_waitcnt lgkmcnt(10)
    v_mfma_f32_16x16x32_bf16 v[128:131], v[48:51], v[200:203], v[128:131]
    ds_read_b64_tr_b16 v[44:45], v6 offset:24576
    v_mfma_f32_16x16x32_bf16 v[132:135], v[48:51], v[204:207], v[132:135]
    ds_read_b64_tr_b16 v[46:47], v6 offset:25600
    v_mfma_f32_16x16x32_bf16 v[136:139], v[52:55], v[200:203], v[136:139]
    ds_read_b64_tr_b16 v[48:49], v3 offset:28672
    v_mfma_f32_16x16x32_bf16 v[140:143], v[52:55], v[204:207], v[140:143]
    ds_read_b64_tr_b16 v[50:51], v3 offset:29696
    s_waitcnt lgkmcnt(10)
    v_mfma_f32_16x16x32_bf16 v[144:147], v[56:59], v[200:203], v[144:147]
    ds_read_b64_tr_b16 v[52:53], v4 offset:28672
    v_mfma_f32_16x16x32_bf16 v[148:151], v[56:59], v[204:207], v[148:151]
    ds_read_b64_tr_b16 v[54:55], v4 offset:29696
    v_mfma_f32_16x16x32_bf16 v[152:155], v[60:63], v[200:203], v[152:155]
    ds_read_b64_tr_b16 v[56:57], v5 offset:28672
    v_mfma_f32_16x16x32_bf16 v[156:159], v[60:63], v[204:207], v[156:159]
    ds_read_b64_tr_b16 v[58:59], v5 offset:29696
    s_waitcnt vmcnt(20) lgkmcnt(10)
    v_mfma_f32_16x16x32_bf16 v[64:67], v[32:35], v[208:211], v[64:67]
    ds_read_b64_tr_b16 v[60:61], v6 offset:28672
    v_mfma_f32_16x16x32_bf16 v[68:71], v[32:35], v[212:215], v[68:71]
    ds_read_b64_tr_b16 v[62:63], v6 offset:29696
    s_barrier
    v_mfma_f32_16x16x32_bf16 v[72:75], v[36:39], v[208:211], v[72:75]
    ds_read_b64_tr_b16 v[32:33], v3 offset:32768
    v_mfma_f32_16x16x32_bf16 v[76:79], v[36:39], v[212:215], v[76:79]
    ds_read_b64_tr_b16 v[34:35], v3 offset:33792
    s_waitcnt lgkmcnt(10)
    v_mfma_f32_16x16x32_bf16 v[80:83], v[40:43], v[208:211], v[80:83]
    ds_read_b64_tr_b16 v[36:37], v4 offset:32768
    v_mfma_f32_16x16x32_bf16 v[84:87], v[40:43], v[212:215], v[84:87]
    ds_read_b64_tr_b16 v[38:39], v4 offset:33792
    v_mfma_f32_16x16x32_bf16 v[88:91], v[44:47], v[208:211], v[88:91]
    ds_read_b64_tr_b16 v[40:41], v5 offset:32768
    v_mfma_f32_16x16x32_bf16 v[92:95], v[44:47], v[212:215], v[92:95]
    ds_read_b64_tr_b16 v[42:43], v5 offset:33792
    s_waitcnt lgkmcnt(10)
    v_mfma_f32_16x16x32_bf16 v[96:99], v[208:211], v[48:51], v[96:99]
    ds_read_b64_tr_b16 v[44:45], v6 offset:32768
    v_mfma_f32_16x16x32_bf16 v[100:103], v[212:215], v[48:51], v[100:103]
    ds_read_b64_tr_b16 v[46:47], v6 offset:33792
    v_mfma_f32_16x16x32_bf16 v[104:107], v[208:211], v[52:55], v[104:107]
    ds_read_b64_tr_b16 v[48:49], v3 offset:36864
    v_mfma_f32_16x16x32_bf16 v[108:111], v[212:215], v[52:55], v[108:111]
    ds_read_b64_tr_b16 v[50:51], v3 offset:37888
    s_waitcnt lgkmcnt(10)
    v_mfma_f32_16x16x32_bf16 v[112:115], v[208:211], v[56:59], v[112:115]
    ds_read_b64_tr_b16 v[52:53], v4 offset:36864
    v_mfma_f32_16x16x32_bf16 v[116:119], v[212:215], v[56:59], v[116:119]
    ds_read_b64_tr_b16 v[54:55], v4 offset:37888
    v_mfma_f32_16x16x32_bf16 v[120:123], v[208:211], v[60:63], v[120:123]
    ds_read_b64_tr_b16 v[56:57], v5 offset:36864
    v_mfma_f32_16x16x32_bf16 v[124:127], v[212:215], v[60:63], v[124:127]
    ds_read_b64_tr_b16 v[58:59], v5 offset:37888
    s_waitcnt lgkmcnt(10)
    v_mfma_f32_16x16x32_bf16 v[128:131], v[32:35], v[208:211], v[128:131]
    ds_read_b64_tr_b16 v[60:61], v6 offset:36864
    v_mfma_f32_16x16x32_bf16 v[132:135], v[32:35], v[212:215], v[132:135]
    ds_read_b64_tr_b16 v[62:63], v6 offset:37888
    v_mfma_f32_16x16x32_bf16 v[136:139], v[36:39], v[208:211], v[136:139]
    ds_read_b64_tr_b16 v[32:33], v3 offset:40960
    v_mfma_f32_16x16x32_bf16 v[140:143], v[36:39], v[212:215], v[140:143]
    ds_read_b64_tr_b16 v[34:35], v3 offset:41984
    s_waitcnt lgkmcnt(10)
    v_mfma_f32_16x16x32_bf16 v[144:147], v[40:43], v[208:211], v[144:147]
    ds_read_b64_tr_b16 v[36:37], v4 offset:40960
    v_mfma_f32_16x16x32_bf16 v[148:151], v[40:43], v[212:215], v[148:151]
    ds_read_b64_tr_b16 v[38:39], v4 offset:41984
    v_mfma_f32_16x16x32_bf16 v[152:155], v[44:47], v[208:211], v[152:155]
    ds_read_b64_tr_b16 v[40:41], v5 offset:40960
    v_mfma_f32_16x16x32_bf16 v[156:159], v[44:47], v[212:215], v[156:159]
    ds_read_b64_tr_b16 v[42:43], v5 offset:41984
    s_waitcnt vmcnt(18) lgkmcnt(10)
    v_mfma_f32_16x16x32_bf16 v[64:67], v[48:51], v[216:219], v[64:67]
    ds_read_b64_tr_b16 v[44:45], v6 offset:40960
    v_mfma_f32_16x16x32_bf16 v[68:71], v[48:51], v[220:223], v[68:71]
    ds_read_b64_tr_b16 v[46:47], v6 offset:41984
    v_mfma_f32_16x16x32_bf16 v[72:75], v[52:55], v[216:219], v[72:75]
    ds_read_b64_tr_b16 v[48:49], v3 offset:45056
    v_mfma_f32_16x16x32_bf16 v[76:79], v[52:55], v[220:223], v[76:79]
    ds_read_b64_tr_b16 v[50:51], v3 offset:46080
    s_waitcnt lgkmcnt(10)
    v_mfma_f32_16x16x32_bf16 v[80:83], v[56:59], v[216:219], v[80:83]
    ds_read_b64_tr_b16 v[52:53], v4 offset:45056
    v_mfma_f32_16x16x32_bf16 v[84:87], v[56:59], v[220:223], v[84:87]
    ds_read_b64_tr_b16 v[54:55], v4 offset:46080
    v_mfma_f32_16x16x32_bf16 v[88:91], v[60:63], v[216:219], v[88:91]
    ds_read_b64_tr_b16 v[56:57], v5 offset:45056
    v_mfma_f32_16x16x32_bf16 v[92:95], v[60:63], v[220:223], v[92:95]
    ds_read_b64_tr_b16 v[58:59], v5 offset:46080
    s_waitcnt lgkmcnt(10)
    v_mfma_f32_16x16x32_bf16 v[96:99], v[216:219], v[32:35], v[96:99]
    ds_read_b64_tr_b16 v[60:61], v6 offset:45056
    v_mfma_f32_16x16x32_bf16 v[100:103], v[220:223], v[32:35], v[100:103]
    ds_read_b64_tr_b16 v[62:63], v6 offset:46080
    v_mfma_f32_16x16x32_bf16 v[104:107], v[216:219], v[36:39], v[104:107]
    ds_read_b64_tr_b16 v[32:33], v3 offset:49152
    v_mfma_f32_16x16x32_bf16 v[108:111], v[220:223], v[36:39], v[108:111]
    ds_read_b64_tr_b16 v[34:35], v3 offset:50176
    s_waitcnt lgkmcnt(10)
    v_mfma_f32_16x16x32_bf16 v[112:115], v[216:219], v[40:43], v[112:115]
    ds_read_b64_tr_b16 v[36:37], v4 offset:49152
    v_mfma_f32_16x16x32_bf16 v[116:119], v[220:223], v[40:43], v[116:119]
    ds_read_b64_tr_b16 v[38:39], v4 offset:50176
    v_mfma_f32_16x16x32_bf16 v[120:123], v[216:219], v[44:47], v[120:123]
    ds_read_b64_tr_b16 v[40:41], v5 offset:49152
    v_mfma_f32_16x16x32_bf16 v[124:127], v[220:223], v[44:47], v[124:127]
    ds_read_b64_tr_b16 v[42:43], v5 offset:50176
    s_waitcnt lgkmcnt(10)
    v_mfma_f32_16x16x32_bf16 v[128:131], v[48:51], v[216:219], v[128:131]
    buffer_load_dwordx4 v[200:203], v2, s[4:7], s42 offen offset:2048 sc1
    ds_read_b64_tr_b16 v[44:45], v6 offset:49152
    v_mfma_f32_16x16x32_bf16 v[132:135], v[48:51], v[220:223], v[132:135]
    ds_read_b64_tr_b16 v[46:47], v6 offset:50176
    v_mfma_f32_16x16x32_bf16 v[136:139], v[52:55], v[216:219], v[136:139]
    buffer_load_dwordx4 v[204:207], v2, s[4:7], s42 offen offset:2304 sc1
    ds_read_b64_tr_b16 v[48:49], v3 offset:53248
    s_add_u32 s42, s41, s99
    v_mfma_f32_16x16x32_bf16 v[140:143], v[52:55], v[220:223], v[140:143]
    ds_read_b64_tr_b16 v[50:51], v3 offset:54272
    s_waitcnt lgkmcnt(10)
    v_mfma_f32_16x16x32_bf16 v[144:147], v[56:59], v[216:219], v[144:147]
    buffer_load_dwordx4 v[208:211], v2, s[4:7], s42 offen offset:0 sc1
    ds_read_b64_tr_b16 v[52:53], v4 offset:53248
    v_mfma_f32_16x16x32_bf16 v[148:151], v[56:59], v[220:223], v[148:151]
    ds_read_b64_tr_b16 v[54:55], v4 offset:54272
    v_mfma_f32_16x16x32_bf16 v[152:155], v[60:63], v[216:219], v[152:155]
    buffer_load_dwordx4 v[212:215], v2, s[4:7], s42 offen offset:256 sc1
    ds_read_b64_tr_b16 v[56:57], v5 offset:53248
    v_mfma_f32_16x16x32_bf16 v[156:159], v[60:63], v[220:223], v[156:159]
    ds_read_b64_tr_b16 v[58:59], v5 offset:54272
    s_waitcnt vmcnt(20) lgkmcnt(10)
    v_mfma_f32_16x16x32_bf16 v[64:67], v[32:35], v[224:227], v[64:67]
    ds_read_b64_tr_b16 v[60:61], v6 offset:53248
    buffer_load_dwordx4 v[216:219], v2, s[4:7], s42 offen offset:2048 sc1
    v_mfma_f32_16x16x32_bf16 v[68:71], v[32:35], v[228:231], v[68:71]
    ds_read_b64_tr_b16 v[62:63], v6 offset:54272
    v_mfma_f32_16x16x32_bf16 v[72:75], v[36:39], v[224:227], v[72:75]
    buffer_load_dwordx4 v[220:223], v2, s[4:7], s42 offen offset:2304 sc1
    ds_read_b64_tr_b16 v[32:33], v3 offset:57344
    v_mfma_f32_16x16x32_bf16 v[76:79], v[36:39], v[228:231], v[76:79]
    ds_read_b64_tr_b16 v[34:35], v3 offset:58368
    s_waitcnt lgkmcnt(10)
    v_mfma_f32_16x16x32_bf16 v[80:83], v[40:43], v[224:227], v[80:83]
    ds_read_b64_tr_b16 v[36:37], v4 offset:57344
    v_mfma_f32_16x16x32_bf16 v[84:87], v[40:43], v[228:231], v[84:87]
    ds_read_b64_tr_b16 v[38:39], v4 offset:58368
    v_mfma_f32_16x16x32_bf16 v[88:91], v[44:47], v[224:227], v[88:91]
    ds_read_b64_tr_b16 v[40:41], v5 offset:57344
    v_mfma_f32_16x16x32_bf16 v[92:95], v[44:47], v[228:231], v[92:95]
    ds_read_b64_tr_b16 v[42:43], v5 offset:58368
    s_waitcnt lgkmcnt(10)
    v_mfma_f32_16x16x32_bf16 v[96:99], v[224:227], v[48:51], v[96:99]
    ds_read_b64_tr_b16 v[44:45], v6 offset:57344
    v_mfma_f32_16x16x32_bf16 v[100:103], v[228:231], v[48:51], v[100:103]
    ds_read_b64_tr_b16 v[46:47], v6 offset:58368
    v_mfma_f32_16x16x32_bf16 v[104:107], v[224:227], v[52:55], v[104:107]
    ds_read_b64_tr_b16 v[48:49], v3 offset:61440
    v_mfma_f32_16x16x32_bf16 v[108:111], v[228:231], v[52:55], v[108:111]
    ds_read_b64_tr_b16 v[50:51], v3 offset:62464
    s_waitcnt lgkmcnt(10)
    v_mfma_f32_16x16x32_bf16 v[112:115], v[224:227], v[56:59], v[112:115]
    ds_read_b64_tr_b16 v[52:53], v4 offset:61440
    v_mfma_f32_16x16x32_bf16 v[116:119], v[228:231], v[56:59], v[116:119]
    ds_read_b64_tr_b16 v[54:55], v4 offset:62464
    v_mfma_f32_16x16x32_bf16 v[120:123], v[224:227], v[60:63], v[120:123]
    ds_read_b64_tr_b16 v[56:57], v5 offset:61440
    v_mfma_f32_16x16x32_bf16 v[124:127], v[228:231], v[60:63], v[124:127]
    ds_read_b64_tr_b16 v[58:59], v5 offset:62464
    s_waitcnt vmcnt(20) lgkmcnt(10)
    v_mfma_f32_16x16x32_bf16 v[64:67], v[32:35], v[232:235], v[64:67]
    ds_read_b64_tr_b16 v[60:61], v6 offset:61440
    v_mfma_f32_16x16x32_bf16 v[68:71], v[32:35], v[236:239], v[68:71]
    ds_read_b64_tr_b16 v[62:63], v6 offset:62464
    s_barrier
    v_xor_b32 v3, 0x10000, v3
    v_xor_b32 v4, 0x10000, v4
    v_xor_b32 v5, 0x10000, v5
    v_xor_b32 v6, 0x10000, v6
    v_mfma_f32_16x16x32_bf16 v[72:75], v[36:39], v[232:235], v[72:75]
    ds_read_b64_tr_b16 v[32:33], v3 offset:0
    v_mfma_f32_16x16x32_bf16 v[76:79], v[36:39], v[236:239], v[76:79]
    ds_read_b64_tr_b16 v[34:35], v3 offset:1024
    s_waitcnt lgkmcnt(10)
    v_mfma_f32_16x16x32_bf16 v[80:83], v[40:43], v[232:235], v[80:83]
    ds_read_b64_tr_b16 v[36:37], v4 offset:0
    v_mfma_f32_16x16x32_bf16 v[84:87], v[40:43], v[236:239], v[84:87]
    ds_read_b64_tr_b16 v[38:39], v4 offset:1024
    v_mfma_f32_16x16x32_bf16 v[88:91], v[44:47], v[232:235], v[88:91]
    ds_read_b64_tr_b16 v[40:41], v5 offset:0
    v_mfma_f32_16x16x32_bf16 v[92:95], v[44:47], v[236:239], v[92:95]
    ds_read_b64_tr_b16 v[42:43], v5 offset:1024
    s_waitcnt lgkmcnt(10)
    v_mfma_f32_16x16x32_bf16 v[96:99], v[232:235], v[48:51], v[96:99]
    ds_read_b64_tr_b16 v[44:45], v6 offset:0
    v_mfma_f32_16x16x32_bf16 v[100:103], v[236:239], v[48:51], v[100:103]
    ds_read_b64_tr_b16 v[46:47], v6 offset:1024
    v_mfma_f32_16x16x32_bf16 v[104:107], v[232:235], v[52:55], v[104:107]
    ds_read_b64_tr_b16 v[48:49], v3 offset:4096
    v_mfma_f32_16x16x32_bf16 v[108:111], v[236:239], v[52:55], v[108:111]
    ds_read_b64_tr_b16 v[50:51], v3 offset:5120
    s_waitcnt lgkmcnt(10)
    v_mfma_f32_16x16x32_bf16 v[112:115], v[232:235], v[56:59], v[112:115]
    ds_read_b64_tr_b16 v[52:53], v4 offset:4096
    v_mfma_f32_16x16x32_bf16 v[116:119], v[236:239], v[56:59], v[116:119]
    ds_read_b64_tr_b16 v[54:55], v4 offset:5120
    v_mfma_f32_16x16x32_bf16 v[120:123], v[232:235], v[60:63], v[120:123]
    ds_read_b64_tr_b16 v[56:57], v5 offset:4096
    v_mfma_f32_16x16x32_bf16 v[124:127], v[236:239], v[60:63], v[124:127]
    ds_read_b64_tr_b16 v[58:59], v5 offset:5120
    s_waitcnt vmcnt(18) lgkmcnt(10)
    v_mfma_f32_16x16x32_bf16 v[64:67], v[32:35], v[240:243], v[64:67]
    ds_read_b64_tr_b16 v[60:61], v6 offset:4096
    v_mfma_f32_16x16x32_bf16 v[68:71], v[32:35], v[244:247], v[68:71]
    ds_read_b64_tr_b16 v[62:63], v6 offset:5120
    v_mfma_f32_16x16x32_bf16 v[72:75], v[36:39], v[240:243], v[72:75]
    ds_read_b64_tr_b16 v[32:33], v3 offset:8192
    v_mfma_f32_16x16x32_bf16 v[76:79], v[36:39], v[244:247], v[76:79]
    ds_read_b64_tr_b16 v[34:35], v3 offset:9216
    s_waitcnt lgkmcnt(10)
    v_mfma_f32_16x16x32_bf16 v[80:83], v[40:43], v[240:243], v[80:83]
    ds_read_b64_tr_b16 v[36:37], v4 offset:8192
    v_mfma_f32_16x16x32_bf16 v[84:87], v[40:43], v[244:247], v[84:87]
    ds_read_b64_tr_b16 v[38:39], v4 offset:9216
    v_mfma_f32_16x16x32_bf16 v[88:91], v[44:47], v[240:243], v[88:91]
    ds_read_b64_tr_b16 v[40:41], v5 offset:8192
    v_mfma_f32_16x16x32_bf16 v[92:95], v[44:47], v[244:247], v[92:95]
    ds_read_b64_tr_b16 v[42:43], v5 offset:9216
    s_waitcnt lgkmcnt(10)
    v_mfma_f32_16x16x32_bf16 v[96:99], v[240:243], v[48:51], v[96:99]
    ds_read_b64_tr_b16 v[44:45], v6 offset:8192
    v_mfma_f32_16x16x32_bf16 v[100:103], v[244:247], v[48:51], v[100:103]
    ds_read_b64_tr_b16 v[46:47], v6 offset:9216
    v_mfma_f32_16x16x32_bf16 v[104:107], v[240:243], v[52:55], v[104:107]
    ds_read_b64_tr_b16 v[48:49], v3 offset:12288
    v_mfma_f32_16x16x32_bf16 v[108:111], v[244:247], v[52:55], v[108:111]
    ds_read_b64_tr_b16 v[50:51], v3 offset:13312
    s_waitcnt lgkmcnt(10)
    v_mfma_f32_16x16x32_bf16 v[112:115], v[240:243], v[56:59], v[112:115]
    ds_read_b64_tr_b16 v[52:53], v4 offset:12288
    v_mfma_f32_16x16x32_bf16 v[116:119], v[244:247], v[56:59], v[116:119]
    ds_read_b64_tr_b16 v[54:55], v4 offset:13312
    v_mfma_f32_16x16x32_bf16 v[120:123], v[240:243], v[60:63], v[120:123]
    ds_read_b64_tr_b16 v[56:57], v5 offset:12288
    v_mfma_f32_16x16x32_bf16 v[124:127], v[244:247], v[60:63], v[124:127]
    ds_read_b64_tr_b16 v[58:59], v5 offset:13312
    s_waitcnt vmcnt(16) lgkmcnt(10)
    v_mfma_f32_16x16x32_bf16 v[64:67], v[32:35], v[248:251], v[64:67]
    ds_read_b64_tr_b16 v[60:61], v6 offset:12288
    v_mfma_f32_16x16x32_bf16 v[68:71], v[32:35], v[252:255], v[68:71]
    ds_read_b64_tr_b16 v[62:63], v6 offset:13312
    v_mfma_f32_16x16x32_bf16 v[72:75], v[36:39], v[248:251], v[72:75]
    ds_read_b64_tr_b16 v[32:33], v3 offset:16384
    v_mfma_f32_16x16x32_bf16 v[76:79], v[36:39], v[252:255], v[76:79]
    ds_read_b64_tr_b16 v[34:35], v3 offset:17408
    s_waitcnt lgkmcnt(10)
    v_mfma_f32_16x16x32_bf16 v[80:83], v[40:43], v[248:251], v[80:83]
    ds_read_b64_tr_b16 v[36:37], v4 offset:16384
    v_mfma_f32_16x16x32_bf16 v[84:87], v[40:43], v[252:255], v[84:87]
    ds_read_b64_tr_b16 v[38:39], v4 offset:17408
    v_mfma_f32_16x16x32_bf16 v[88:91], v[44:47], v[248:251], v[88:91]
    ds_read_b64_tr_b16 v[40:41], v5 offset:16384
    v_mfma_f32_16x16x32_bf16 v[92:95], v[44:47], v[252:255], v[92:95]
    ds_read_b64_tr_b16 v[42:43], v5 offset:17408
    s_waitcnt lgkmcnt(10)
    v_mfma_f32_16x16x32_bf16 v[96:99], v[248:251], v[48:51], v[96:99]
    ds_read_b64_tr_b16 v[44:45], v6 offset:16384
    v_mfma_f32_16x16x32_bf16 v[100:103], v[252:255], v[48:51], v[100:103]
    ds_read_b64_tr_b16 v[46:47], v6 offset:17408
    v_mfma_f32_16x16x32_bf16 v[104:107], v[248:251], v[52:55], v[104:107]
    ds_read_b64_tr_b16 v[48:49], v3 offset:20480
    v_mfma_f32_16x16x32_bf16 v[108:111], v[252:255], v[52:55], v[108:111]
    ds_read_b64_tr_b16 v[50:51], v3 offset:21504
    s_waitcnt lgkmcnt(10)
    v_mfma_f32_16x16x32_bf16 v[112:115], v[248:251], v[56:59], v[112:115]
    ds_read_b64_tr_b16 v[52:53], v4 offset:20480
    v_mfma_f32_16x16x32_bf16 v[116:119], v[252:255], v[56:59], v[116:119]
    ds_read_b64_tr_b16 v[54:55], v4 offset:21504
    v_mfma_f32_16x16x32_bf16 v[120:123], v[248:251], v[60:63], v[120:123]
    ds_read_b64_tr_b16 v[56:57], v5 offset:20480
    v_mfma_f32_16x16x32_bf16 v[124:127], v[252:255], v[60:63], v[124:127]
    ds_read_b64_tr_b16 v[58:59], v5 offset:21504
    s_waitcnt vmcnt(14) lgkmcnt(10)
    v_mfma_f32_16x16x32_bf16 v[64:67], v[32:35], v[160:163], v[64:67]
    ds_read_b64_tr_b16 v[60:61], v6 offset:20480
    v_mfma_f32_16x16x32_bf16 v[68:71], v[32:35], v[164:167], v[68:71]
    ds_read_b64_tr_b16 v[62:63], v6 offset:21504
    v_mfma_f32_16x16x32_bf16 v[72:75], v[36:39], v[160:163], v[72:75]
    ds_read_b64_tr_b16 v[32:33], v3 offset:24576
    v_mfma_f32_16x16x32_bf16 v[76:79], v[36:39], v[164:167], v[76:79]
    ds_read_b64_tr_b16 v[34:35], v3 offset:25600
    s_waitcnt lgkmcnt(10)
    v_mfma_f32_16x16x32_bf16 v[80:83], v[40:43], v[160:163], v[80:83]
    ds_read_b64_tr_b16 v[36:37], v4 offset:24576
    v_mfma_f32_16x16x32_bf16 v[84:87], v[40:43], v[164:167], v[84:87]
    ds_read_b64_tr_b16 v[38:39], v4 offset:25600
    v_mfma_f32_16x16x32_bf16 v[88:91], v[44:47], v[160:163], v[88:91]
    ds_read_b64_tr_b16 v[40:41], v5 offset:24576
    v_mfma_f32_16x16x32_bf16 v[92:95], v[44:47], v[164:167], v[92:95]
    ds_read_b64_tr_b16 v[42:43], v5 offset:25600
    s_waitcnt vmcnt(12) lgkmcnt(10)
    v_mfma_f32_16x16x32_bf16 v[64:67], v[48:51], v[168:171], v[64:67]
    ds_read_b64_tr_b16 v[44:45], v6 offset:24576
    v_mfma_f32_16x16x32_bf16 v[68:71], v[48:51], v[172:175], v[68:71]
    ds_read_b64_tr_b16 v[46:47], v6 offset:25600
    v_mfma_f32_16x16x32_bf16 v[72:75], v[52:55], v[168:171], v[72:75]
    ds_read_b64_tr_b16 v[48:49], v3 offset:28672
    v_mfma_f32_16x16x32_bf16 v[76:79], v[52:55], v[172:175], v[76:79]
    ds_read_b64_tr_b16 v[50:51], v3 offset:29696
    s_waitcnt lgkmcnt(10)
    v_mfma_f32_16x16x32_bf16 v[80:83], v[56:59], v[168:171], v[80:83]
    ds_read_b64_tr_b16 v[52:53], v4 offset:28672
    v_mfma_f32_16x16x32_bf16 v[84:87], v[56:59], v[172:175], v[84:87]
    ds_read_b64_tr_b16 v[54:55], v4 offset:29696
    v_mfma_f32_16x16x32_bf16 v[88:91], v[60:63], v[168:171], v[88:91]
    ds_read_b64_tr_b16 v[56:57], v5 offset:28672
    v_mfma_f32_16x16x32_bf16 v[92:95], v[60:63], v[172:175], v[92:95]
    ds_read_b64_tr_b16 v[58:59], v5 offset:29696
    s_waitcnt vmcnt(10) lgkmcnt(10)
    v_mfma_f32_16x16x32_bf16 v[64:67], v[32:35], v[176:179], v[64:67]
    ds_read_b64_tr_b16 v[60:61], v6 offset:28672
    v_mfma_f32_16x16x32_bf16 v[68:71], v[32:35], v[180:183], v[68:71]
    ds_read_b64_tr_b16 v[62:63], v6 offset:29696
    s_barrier
    v_mfma_f32_16x16x32_bf16 v[72:75], v[36:39], v[176:179], v[72:75]
    ds_read_b64_tr_b16 v[32:33], v3 offset:32768
    v_mfma_f32_16x16x32_bf16 v[76:79], v[36:39], v[180:183], v[76:79]
    ds_read_b64_tr_b16 v[34:35], v3 offset:33792
    s_waitcnt lgkmcnt(10)
    v_mfma_f32_16x16x32_bf16 v[80:83], v[40:43], v[176:179], v[80:83]
    ds_read_b64_tr_b16 v[36:37], v4 offset:32768
    v_mfma_f32_16x16x32_bf16 v[84:87], v[40:43], v[180:183], v[84:87]
    ds_read_b64_tr_b16 v[38:39], v4 offset:33792
    v_mfma_f32_16x16x32_bf16 v[88:91], v[44:47], v[176:179], v[88:91]
    ds_read_b64_tr_b16 v[40:41], v5 offset:32768
    v_mfma_f32_16x16x32_bf16 v[92:95], v[44:47], v[180:183], v[92:95]
    ds_read_b64_tr_b16 v[42:43], v5 offset:33792
    s_waitcnt vmcnt(8) lgkmcnt(10)
    v_mfma_f32_16x16x32_bf16 v[64:67], v[48:51], v[184:187], v[64:67]
    ds_read_b64_tr_b16 v[44:45], v6 offset:32768
    v_mfma_f32_16x16x32_bf16 v[68:71], v[48:51], v[188:191], v[68:71]
    ds_read_b64_tr_b16 v[46:47], v6 offset:33792
    v_mfma_f32_16x16x32_bf16 v[72:75], v[52:55], v[184:187], v[72:75]
    ds_read_b64_tr_b16 v[48:49], v3 offset:36864
    v_mfma_f32_16x16x32_bf16 v[76:79], v[52:55], v[188:191], v[76:79]
    ds_read_b64_tr_b16 v[50:51], v3 offset:37888
    s_waitcnt lgkmcnt(10)
    v_mfma_f32_16x16x32_bf16 v[80:83], v[56:59], v[184:187], v[80:83]
    ds_read_b64_tr_b16 v[52:53], v4 offset:36864
    v_mfma_f32_16x16x32_bf16 v[84:87], v[56:59], v[188:191], v[84:87]
    ds_read_b64_tr_b16 v[54:55], v4 offset:37888
    v_mfma_f32_16x16x32_bf16 v[88:91], v[60:63], v[184:187], v[88:91]
    ds_read_b64_tr_b16 v[56:57], v5 offset:36864
    v_mfma_f32_16x16x32_bf16 v[92:95], v[60:63], v[188:191], v[92:95]
    ds_read_b64_tr_b16 v[58:59], v5 offset:37888
    s_waitcnt vmcnt(6) lgkmcnt(10)
    v_mfma_f32_16x16x32_bf16 v[64:67], v[32:35], v[192:195], v[64:67]
    ds_read_b64_tr_b16 v[60:61], v6 offset:36864
    v_mfma_f32_16x16x32_bf16 v[68:71], v[32:35], v[196:199], v[68:71]
    ds_read_b64_tr_b16 v[62:63], v6 offset:37888
    v_mfma_f32_16x16x32_bf16 v[72:75], v[36:39], v[192:195], v[72:75]
    ds_read_b64_tr_b16 v[32:33], v3 offset:40960
    v_mfma_f32_16x16x32_bf16 v[76:79], v[36:39], v[196:199], v[76:79]
    ds_read_b64_tr_b16 v[34:35], v3 offset:41984
    s_waitcnt lgkmcnt(10)
    v_mfma_f32_16x16x32_bf16 v[80:83], v[40:43], v[192:195], v[80:83]
    ds_read_b64_tr_b16 v[36:37], v4 offset:40960
    v_mfma_f32_16x16x32_bf16 v[84:87], v[40:43], v[196:199], v[84:87]
    ds_read_b64_tr_b16 v[38:39], v4 offset:41984
    v_mfma_f32_16x16x32_bf16 v[88:91], v[44:47], v[192:195], v[88:91]
    ds_read_b64_tr_b16 v[40:41], v5 offset:40960
    v_mfma_f32_16x16x32_bf16 v[92:95], v[44:47], v[196:199], v[92:95]
    ds_read_b64_tr_b16 v[42:43], v5 offset:41984
    s_waitcnt vmcnt(4) lgkmcnt(10)
    v_mfma_f32_16x16x32_bf16 v[64:67], v[48:51], v[200:203], v[64:67]
    ds_read_b64_tr_b16 v[44:45], v6 offset:40960
    v_mfma_f32_16x16x32_bf16 v[68:71], v[48:51], v[204:207], v[68:71]
    ds_read_b64_tr_b16 v[46:47], v6 offset:41984
    v_mfma_f32_16x16x32_bf16 v[72:75], v[52:55], v[200:203], v[72:75]
    ds_read_b64_tr_b16 v[48:49], v3 offset:45056
    v_mfma_f32_16x16x32_bf16 v[76:79], v[52:55], v[204:207], v[76:79]
    ds_read_b64_tr_b16 v[50:51], v3 offset:46080
    s_waitcnt lgkmcnt(10)
    v_mfma_f32_16x16x32_bf16 v[80:83], v[56:59], v[200:203], v[80:83]
    ds_read_b64_tr_b16 v[52:53], v4 offset:45056
    v_mfma_f32_16x16x32_bf16 v[84:87], v[56:59], v[204:207], v[84:87]
    ds_read_b64_tr_b16 v[54:55], v4 offset:46080
    v_mfma_f32_16x16x32_bf16 v[88:91], v[60:63], v[200:203], v[88:91]
    ds_read_b64_tr_b16 v[56:57], v5 offset:45056
    v_mfma_f32_16x16x32_bf16 v[92:95], v[60:63], v[204:207], v[92:95]
    ds_read_b64_tr_b16 v[58:59], v5 offset:46080
    s_waitcnt vmcnt(2) lgkmcnt(10)
    v_mfma_f32_16x16x32_bf16 v[64:67], v[32:35], v[208:211], v[64:67]
    ds_read_b64_tr_b16 v[60:61], v6 offset:45056
    v_mfma_f32_16x16x32_bf16 v[68:71], v[32:35], v[212:215], v[68:71]
    ds_read_b64_tr_b16 v[62:63], v6 offset:46080
    v_mfma_f32_16x16x32_bf16 v[72:75], v[36:39], v[208:211], v[72:75]
    ds_read_b64_tr_b16 v[32:33], v3 offset:49152
    ds_read_b32 v8, v9 offset:4096
    v_mfma_f32_16x16x32_bf16 v[76:79], v[36:39], v[212:215], v[76:79]
    ds_read_b64_tr_b16 v[34:35], v3 offset:50176
    ds_read_b32 v10, v9 offset:4608
    s_waitcnt lgkmcnt(12)
    v_mfma_f32_16x16x32_bf16 v[80:83], v[40:43], v[208:211], v[80:83]
    ds_read_b64_tr_b16 v[36:37], v4 offset:49152
    ds_read_b32 v12, v9 offset:4160
    v_mfma_f32_16x16x32_bf16 v[84:87], v[40:43], v[212:215], v[84:87]
    ds_read_b64_tr_b16 v[38:39], v4 offset:50176
    ds_read_b32 v14, v9 offset:4672
    v_mfma_f32_16x16x32_bf16 v[88:91], v[44:47], v[208:211], v[88:91]
    ds_read_b64_tr_b16 v[40:41], v5 offset:49152
    ds_read_b128 v[16:19], v11 offset:256
    v_mfma_f32_16x16x32_bf16 v[92:95], v[44:47], v[212:215], v[92:95]
    ds_read_b64_tr_b16 v[42:43], v5 offset:50176
    ds_read_b128 v[20:23], v11 offset:320
    s_waitcnt vmcnt(0) lgkmcnt(14)
    v_mfma_f32_16x16x32_bf16 v[64:67], v[48:51], v[216:219], v[64:67]
    ds_read_b64_tr_b16 v[44:45], v6 offset:49152
    ds_read_b128 v[24:27], v11 offset:384
    v_mfma_f32_16x16x32_bf16 v[68:71], v[48:51], v[220:223], v[68:71]
    ds_read_b64_tr_b16 v[46:47], v6 offset:50176
    ds_read_b128 v[28:31], v11 offset:448
    v_mfma_f32_16x16x32_bf16 v[72:75], v[52:55], v[216:219], v[72:75]
    ds_read_b64_tr_b16 v[48:49], v3 offset:53248
    v_mfma_f32_16x16x32_bf16 v[76:79], v[52:55], v[220:223], v[76:79]
    ds_read_b64_tr_b16 v[50:51], v3 offset:54272
    s_waitcnt lgkmcnt(14)
    v_mfma_f32_16x16x32_bf16 v[80:83], v[56:59], v[216:219], v[80:83]
    ds_read_b64_tr_b16 v[52:53], v4 offset:53248
    v_mfma_f32_16x16x32_bf16 v[84:87], v[56:59], v[220:223], v[84:87]
    ds_read_b64_tr_b16 v[54:55], v4 offset:54272
    v_mfma_f32_16x16x32_bf16 v[88:91], v[60:63], v[216:219], v[88:91]
    ds_read_b64_tr_b16 v[56:57], v5 offset:53248
    v_mfma_f32_16x16x32_bf16 v[92:95], v[60:63], v[220:223], v[92:95]
    ds_read_b64_tr_b16 v[58:59], v5 offset:54272
    s_bitcmp1_b32 s21, 0
    s_cbranch_scc1 c_B
    v_add_u32 v7, s62, v1
    s_waitcnt lgkmcnt(6)
    v_pk_fma_f32 v[68:69], v[12:13], v[16:17], v[68:69] op_sel_hi:[0,1,1] neg_lo:[1,0,0] neg_hi:[1,0,0]
    v_pk_fma_f32 v[70:71], v[12:13], v[18:19], v[70:71] op_sel_hi:[0,1,1] neg_lo:[1,0,0] neg_hi:[1,0,0]
    v_pk_fma_f32 v[76:77], v[12:13], v[20:21], v[76:77] op_sel_hi:[0,1,1] neg_lo:[1,0,0] neg_hi:[1,0,0]
    v_pk_fma_f32 v[78:79], v[12:13], v[22:23], v[78:79] op_sel_hi:[0,1,1] neg_lo:[1,0,0] neg_hi:[1,0,0]
    v_pk_mul_f32 v[68:69], v[14:15], v[68:69] op_sel_hi:[0,1]
    v_pk_mul_f32 v[70:71], v[14:15], v[70:71] op_sel_hi:[0,1]
    v_pk_mul_f32 v[76:77], v[14:15], v[76:77] op_sel_hi:[0,1]
    v_pk_mul_f32 v[78:79], v[14:15], v[78:79] op_sel_hi:[0,1]
    v_cvt_pk_bf16_f32 v68, v68, v69
    v_cvt_pk_bf16_f32 v69, v70, v71
    v_cvt_pk_bf16_f32 v70, v76, v77
    v_cvt_pk_bf16_f32 v71, v78, v79
    ds_write_b128 v7, v[68:71] offset:4096
    v_pk_fma_f32 v[64:65], v[8:9], v[16:17], v[64:65] op_sel_hi:[0,1,1] neg_lo:[1,0,0] neg_hi:[1,0,0]
    v_pk_fma_f32 v[66:67], v[8:9], v[18:19], v[66:67] op_sel_hi:[0,1,1] neg_lo:[1,0,0] neg_hi:[1,0,0]
    v_pk_fma_f32 v[72:73], v[8:9], v[20:21], v[72:73] op_sel_hi:[0,1,1] neg_lo:[1,0,0] neg_hi:[1,0,0]
    v_pk_fma_f32 v[74:75], v[8:9], v[22:23], v[74:75] op_sel_hi:[0,1,1] neg_lo:[1,0,0] neg_hi:[1,0,0]
    v_pk_mul_f32 v[64:65], v[10:11], v[64:65] op_sel_hi:[0,1]
    v_pk_mul_f32 v[66:67], v[10:11], v[66:67] op_sel_hi:[0,1]
    v_pk_mul_f32 v[72:73], v[10:11], v[72:73] op_sel_hi:[0,1]
    v_pk_mul_f32 v[74:75], v[10:11], v[74:75] op_sel_hi:[0,1]
    v_cvt_pk_bf16_f32 v64, v64, v65
    v_cvt_pk_bf16_f32 v65, v66, v67
    v_cvt_pk_bf16_f32 v66, v72, v73
    v_cvt_pk_bf16_f32 v67, v74, v75
    v_pk_fma_f32 v[84:85], v[12:13], v[24:25], v[84:85] op_sel_hi:[0,1,1] neg_lo:[1,0,0] neg_hi:[1,0,0]
    v_pk_fma_f32 v[86:87], v[12:13], v[26:27], v[86:87] op_sel_hi:[0,1,1] neg_lo:[1,0,0] neg_hi:[1,0,0]
    v_pk_fma_f32 v[92:93], v[12:13], v[28:29], v[92:93] op_sel_hi:[0,1,1] neg_lo:[1,0,0] neg_hi:[1,0,0]
    v_pk_fma_f32 v[94:95], v[12:13], v[30:31], v[94:95] op_sel_hi:[0,1,1] neg_lo:[1,0,0] neg_hi:[1,0,0]
    v_pk_mul_f32 v[84:85], v[14:15], v[84:85] op_sel_hi:[0,1]
    v_pk_mul_f32 v[86:87], v[14:15], v[86:87] op_sel_hi:[0,1]
    v_pk_mul_f32 v[92:93], v[14:15], v[92:93] op_sel_hi:[0,1]
    v_pk_mul_f32 v[94:95], v[14:15], v[94:95] op_sel_hi:[0,1]
    v_cvt_pk_bf16_f32 v84, v84, v85
    v_cvt_pk_bf16_f32 v85, v86, v87
    v_cvt_pk_bf16_f32 v86, v92, v93
    v_cvt_pk_bf16_f32 v87, v94, v95
    ds_write_b128 v7, v[84:87] offset:5120
    v_pk_fma_f32 v[80:81], v[8:9], v[24:25], v[80:81] op_sel_hi:[0,1,1] neg_lo:[1,0,0] neg_hi:[1,0,0]
    v_pk_fma_f32 v[82:83], v[8:9], v[26:27], v[82:83] op_sel_hi:[0,1,1] neg_lo:[1,0,0] neg_hi:[1,0,0]
    v_pk_fma_f32 v[88:89], v[8:9], v[28:29], v[88:89] op_sel_hi:[0,1,1] neg_lo:[1,0,0] neg_hi:[1,0,0]
    v_pk_fma_f32 v[90:91], v[8:9], v[30:31], v[90:91] op_sel_hi:[0,1,1] neg_lo:[1,0,0] neg_hi:[1,0,0]
    v_pk_mul_f32 v[80:81], v[10:11], v[80:81] op_sel_hi:[0,1]
    v_pk_mul_f32 v[82:83], v[10:11], v[82:83] op_sel_hi:[0,1]
    v_pk_mul_f32 v[88:89], v[10:11], v[88:89] op_sel_hi:[0,1]
    v_pk_mul_f32 v[90:91], v[10:11], v[90:91] op_sel_hi:[0,1]
    v_cvt_pk_bf16_f32 v80, v80, v81
    v_cvt_pk_bf16_f32 v81, v82, v83
    v_cvt_pk_bf16_f32 v82, v88, v89
    v_cvt_pk_bf16_f32 v83, v90, v91
    v_mfma_f32_16x16x32_bf16 v[96:99], v[160:163], v[32:35], v[96:99]
    ds_read_b64_tr_b16 v[60:61], v6 offset:53248
    v_mfma_f32_16x16x32_bf16 v[100:103], v[164:167], v[32:35], v[100:103]
    ds_read_b64_tr_b16 v[62:63], v6 offset:54272
    v_mfma_f32_16x16x32_bf16 v[104:107], v[160:163], v[36:39], v[104:107]
    ds_read_b64_tr_b16 v[32:33], v3 offset:57344
    v_mfma_f32_16x16x32_bf16 v[108:111], v[164:167], v[36:39], v[108:111]
    ds_read_b64_tr_b16 v[34:35], v3 offset:58368
    v_mfma_f32_16x16x32_bf16 v[112:115], v[160:163], v[40:43], v[112:115]
    ds_read_b64_tr_b16 v[36:37], v4 offset:57344
    v_mfma_f32_16x16x32_bf16 v[116:119], v[164:167], v[40:43], v[116:119]
    ds_read_b64_tr_b16 v[38:39], v4 offset:58368
    v_mfma_f32_16x16x32_bf16 v[120:123], v[160:163], v[44:47], v[120:123]
    ds_read_b64_tr_b16 v[40:41], v5 offset:57344
    v_mfma_f32_16x16x32_bf16 v[124:127], v[164:167], v[44:47], v[124:127]
    ds_read_b64_tr_b16 v[42:43], v5 offset:58368
    s_waitcnt lgkmcnt(12)
    v_mfma_f32_16x16x32_bf16 v[96:99], v[168:171], v[48:51], v[96:99]
    ds_read_b64_tr_b16 v[44:45], v6 offset:57344
    v_mfma_f32_16x16x32_bf16 v[100:103], v[172:175], v[48:51], v[100:103]
    ds_read_b64_tr_b16 v[46:47], v6 offset:58368
    v_mfma_f32_16x16x32_bf16 v[104:107], v[168:171], v[52:55], v[104:107]
    ds_read_b64_tr_b16 v[48:49], v3 offset:61440
    v_mfma_f32_16x16x32_bf16 v[108:111], v[172:175], v[52:55], v[108:111]
    ds_read_b64_tr_b16 v[50:51], v3 offset:62464
    s_waitcnt lgkmcnt(10)
    v_mfma_f32_16x16x32_bf16 v[112:115], v[168:171], v[56:59], v[112:115]
    ds_read_b64_tr_b16 v[52:53], v4 offset:61440
    v_mfma_f32_16x16x32_bf16 v[116:119], v[172:175], v[56:59], v[116:119]
    ds_read_b64_tr_b16 v[54:55], v4 offset:62464
    v_mfma_f32_16x16x32_bf16 v[120:123], v[168:171], v[60:63], v[120:123]
    ds_read_b64_tr_b16 v[56:57], v5 offset:61440
    v_mfma_f32_16x16x32_bf16 v[124:127], v[172:175], v[60:63], v[124:127]
    ds_read_b64_tr_b16 v[58:59], v5 offset:62464
    s_waitcnt lgkmcnt(10)
    v_mfma_f32_16x16x32_bf16 v[96:99], v[176:179], v[32:35], v[96:99]
    ds_read_b64_tr_b16 v[60:61], v6 offset:61440
    v_mfma_f32_16x16x32_bf16 v[100:103], v[180:183], v[32:35], v[100:103]
    ds_read_b64_tr_b16 v[62:63], v6 offset:62464
    s_barrier
    v_xor_b32 v3, 0x10000, v3
    v_xor_b32 v4, 0x10000, v4
    v_xor_b32 v5, 0x10000, v5
    v_xor_b32 v6, 0x10000, v6
    v_mfma_f32_16x16x32_bf16 v[104:107], v[176:179], v[36:39], v[104:107]
    ds_read_b64_tr_b16 v[32:33], v3 offset:0
    v_mfma_f32_16x16x32_bf16 v[108:111], v[180:183], v[36:39], v[108:111]
    ds_read_b64_tr_b16 v[34:35], v3 offset:1024
    s_waitcnt lgkmcnt(10)
    v_mfma_f32_16x16x32_bf16 v[112:115], v[176:179], v[40:43], v[112:115]
    ds_read_b64_tr_b16 v[36:37], v4 offset:0
    v_mfma_f32_16x16x32_bf16 v[116:119], v[180:183], v[40:43], v[116:119]
    ds_read_b64_tr_b16 v[38:39], v4 offset:1024
    v_mfma_f32_16x16x32_bf16 v[120:123], v[176:179], v[44:47], v[120:123]
    ds_read_b64_tr_b16 v[40:41], v5 offset:0
    v_mfma_f32_16x16x32_bf16 v[124:127], v[180:183], v[44:47], v[124:127]
    ds_read_b64_tr_b16 v[42:43], v5 offset:1024
    s_waitcnt lgkmcnt(10)
    v_mfma_f32_16x16x32_bf16 v[96:99], v[184:187], v[48:51], v[96:99]
    ds_read_b64_tr_b16 v[44:45], v6 offset:0
    v_mfma_f32_16x16x32_bf16 v[100:103], v[188:191], v[48:51], v[100:103]
    ds_read_b64_tr_b16 v[46:47], v6 offset:1024
    v_mfma_f32_16x16x32_bf16 v[104:107], v[184:187], v[52:55], v[104:107]
    ds_read_b64_tr_b16 v[48:49], v3 offset:4096
    v_mfma_f32_16x16x32_bf16 v[108:111], v[188:191], v[52:55], v[108:111]
    ds_read_b64_tr_b16 v[50:51], v3 offset:5120
    s_waitcnt lgkmcnt(10)
    v_mfma_f32_16x16x32_bf16 v[112:115], v[184:187], v[56:59], v[112:115]
    ds_read_b64_tr_b16 v[52:53], v4 offset:4096
    v_mfma_f32_16x16x32_bf16 v[116:119], v[188:191], v[56:59], v[116:119]
    ds_read_b64_tr_b16 v[54:55], v4 offset:5120
    v_mfma_f32_16x16x32_bf16 v[120:123], v[184:187], v[60:63], v[120:123]
    ds_read_b64_tr_b16 v[56:57], v5 offset:4096
    v_mfma_f32_16x16x32_bf16 v[124:127], v[188:191], v[60:63], v[124:127]
    ds_read_b64_tr_b16 v[58:59], v5 offset:5120
    s_waitcnt lgkmcnt(10)
    v_mfma_f32_16x16x32_bf16 v[96:99], v[192:195], v[32:35], v[96:99]
    ds_read_b64_tr_b16 v[60:61], v6 offset:4096
    v_mfma_f32_16x16x32_bf16 v[100:103], v[196:199], v[32:35], v[100:103]
    ds_read_b64_tr_b16 v[62:63], v6 offset:5120
    v_mfma_f32_16x16x32_bf16 v[104:107], v[192:195], v[36:39], v[104:107]
    ds_read_b64_tr_b16 v[32:33], v3 offset:8192
    v_mfma_f32_16x16x32_bf16 v[108:111], v[196:199], v[36:39], v[108:111]
    ds_read_b64_tr_b16 v[34:35], v3 offset:9216
    s_waitcnt lgkmcnt(10)
    v_mfma_f32_16x16x32_bf16 v[112:115], v[192:195], v[40:43], v[112:115]
    ds_read_b64_tr_b16 v[36:37], v4 offset:8192
    v_mfma_f32_16x16x32_bf16 v[116:119], v[196:199], v[40:43], v[116:119]
    ds_read_b64_tr_b16 v[38:39], v4 offset:9216
    v_mfma_f32_16x16x32_bf16 v[120:123], v[192:195], v[44:47], v[120:123]
    ds_read_b64_tr_b16 v[40:41], v5 offset:8192
    v_mfma_f32_16x16x32_bf16 v[124:127], v[196:199], v[44:47], v[124:127]
    ds_read_b64_tr_b16 v[42:43], v5 offset:9216
    s_waitcnt lgkmcnt(10)
    v_mfma_f32_16x16x32_bf16 v[96:99], v[200:203], v[48:51], v[96:99]
    ds_read_b64_tr_b16 v[44:45], v6 offset:8192
    v_mfma_f32_16x16x32_bf16 v[100:103], v[204:207], v[48:51], v[100:103]
    ds_read_b64_tr_b16 v[46:47], v6 offset:9216
    v_mfma_f32_16x16x32_bf16 v[104:107], v[200:203], v[52:55], v[104:107]
    ds_read_b64_tr_b16 v[48:49], v3 offset:12288
    v_mfma_f32_16x16x32_bf16 v[108:111], v[204:207], v[52:55], v[108:111]
    ds_read_b64_tr_b16 v[50:51], v3 offset:13312
    s_waitcnt lgkmcnt(10)
    v_mfma_f32_16x16x32_bf16 v[112:115], v[200:203], v[56:59], v[112:115]
    ds_read_b64_tr_b16 v[52:53], v4 offset:12288
    v_mfma_f32_16x16x32_bf16 v[116:119], v[204:207], v[56:59], v[116:119]
    ds_read_b64_tr_b16 v[54:55], v4 offset:13312
    v_mfma_f32_16x16x32_bf16 v[120:123], v[200:203], v[60:63], v[120:123]
    ds_read_b64_tr_b16 v[56:57], v5 offset:12288
    v_mfma_f32_16x16x32_bf16 v[124:127], v[204:207], v[60:63], v[124:127]
    ds_read_b64_tr_b16 v[58:59], v5 offset:13312
    s_waitcnt lgkmcnt(10)
    v_mfma_f32_16x16x32_bf16 v[96:99], v[208:211], v[32:35], v[96:99]
    ds_read_b64_tr_b16 v[60:61], v6 offset:12288
    v_mfma_f32_16x16x32_bf16 v[100:103], v[212:215], v[32:35], v[100:103]
    ds_read_b64_tr_b16 v[62:63], v6 offset:13312
    v_mfma_f32_16x16x32_bf16 v[104:107], v[208:211], v[36:39], v[104:107]
    ds_read_b64_tr_b16 v[32:33], v3 offset:16384
    ds_read_b128 v[16:19], v13 offset:4096
    v_mfma_f32_16x16x32_bf16 v[108:111], v[212:215], v[36:39], v[108:111]
    ds_read_b64_tr_b16 v[34:35], v3 offset:17408
    ds_read_b128 v[20:23], v13 offset:4608
    s_waitcnt lgkmcnt(12)
    v_mfma_f32_16x16x32_bf16 v[112:115], v[208:211], v[40:43], v[112:115]
    ds_read_b64_tr_b16 v[36:37], v4 offset:16384
    ds_read_b128 v[24:27], v13 offset:4160
    v_mfma_f32_16x16x32_bf16 v[116:119], v[212:215], v[40:43], v[116:119]
    ds_read_b64_tr_b16 v[38:39], v4 offset:17408
    ds_read_b128 v[28:31], v13 offset:4672
    v_mfma_f32_16x16x32_bf16 v[120:123], v[208:211], v[44:47], v[120:123]
    ds_read_b64_tr_b16 v[40:41], v5 offset:16384
    ds_read_b32 v8, v15 offset:512
    v_mfma_f32_16x16x32_bf16 v[124:127], v[212:215], v[44:47], v[124:127]
    ds_read_b64_tr_b16 v[42:43], v5 offset:17408
    ds_read_b32 v10, v15 offset:576
    s_waitcnt lgkmcnt(14)
    v_mfma_f32_16x16x32_bf16 v[96:99], v[216:219], v[48:51], v[96:99]
    ds_read_b64_tr_b16 v[44:45], v6 offset:16384
    ds_read_b32 v12, v15 offset:640
    v_mfma_f32_16x16x32_bf16 v[100:103], v[220:223], v[48:51], v[100:103]
    ds_read_b64_tr_b16 v[46:47], v6 offset:17408
    ds_read_b32 v14, v15 offset:704
    v_mfma_f32_16x16x32_bf16 v[104:107], v[216:219], v[52:55], v[104:107]
    ds_read_b64_tr_b16 v[48:49], v3 offset:20480
    v_mfma_f32_16x16x32_bf16 v[108:111], v[220:223], v[52:55], v[108:111]
    ds_read_b64_tr_b16 v[50:51], v3 offset:21504
    s_waitcnt lgkmcnt(14)
    v_mfma_f32_16x16x32_bf16 v[112:115], v[216:219], v[56:59], v[112:115]
    ds_read_b64_tr_b16 v[52:53], v4 offset:20480
    v_mfma_f32_16x16x32_bf16 v[116:119], v[220:223], v[56:59], v[116:119]
    ds_read_b64_tr_b16 v[54:55], v4 offset:21504
    v_mfma_f32_16x16x32_bf16 v[120:123], v[216:219], v[60:63], v[120:123]
    ds_read_b64_tr_b16 v[56:57], v5 offset:20480
    v_mfma_f32_16x16x32_bf16 v[124:127], v[220:223], v[60:63], v[124:127]
    ds_read_b64_tr_b16 v[58:59], v5 offset:21504
    s_waitcnt lgkmcnt(6)
    v_pk_fma_f32 v[100:101], v[8:9], v[24:25], v[100:101] op_sel_hi:[0,1,1] neg_lo:[1,0,0] neg_hi:[1,0,0]
    v_pk_fma_f32 v[102:103], v[8:9], v[26:27], v[102:103] op_sel_hi:[0,1,1] neg_lo:[1,0,0] neg_hi:[1,0,0]
    v_pk_fma_f32 v[108:109], v[10:11], v[24:25], v[108:109] op_sel_hi:[0,1,1] neg_lo:[1,0,0] neg_hi:[1,0,0]
    v_pk_fma_f32 v[110:111], v[10:11], v[26:27], v[110:111] op_sel_hi:[0,1,1] neg_lo:[1,0,0] neg_hi:[1,0,0]
    v_pk_mul_f32 v[100:101], v[28:29], v[100:101]
    v_pk_mul_f32 v[102:103], v[30:31], v[102:103]
    v_pk_mul_f32 v[108:109], v[28:29], v[108:109]
    v_pk_mul_f32 v[110:111], v[30:31], v[110:111]
    v_cvt_pk_bf16_f32 v74, v100, v101
    v_cvt_pk_bf16_f32 v75, v102, v103
    v_cvt_pk_bf16_f32 v78, v108, v109
    v_cvt_pk_bf16_f32 v79, v110, v111
    v_cvt_pk_bf16_f32 v100, v100, v101
    v_cvt_pk_bf16_f32 v101, v102, v103
    v_cvt_pk_bf16_f32 v102, v108, v109
    v_cvt_pk_bf16_f32 v103, v110, v111
    ds_write_b128 v7, v[100:103] offset:6144
    v_pk_fma_f32 v[116:117], v[12:13], v[24:25], v[116:117] op_sel_hi:[0,1,1] neg_lo:[1,0,0] neg_hi:[1,0,0]
    v_pk_fma_f32 v[118:119], v[12:13], v[26:27], v[118:119] op_sel_hi:[0,1,1] neg_lo:[1,0,0] neg_hi:[1,0,0]
    v_pk_fma_f32 v[124:125], v[14:15], v[24:25], v[124:125] op_sel_hi:[0,1,1] neg_lo:[1,0,0] neg_hi:[1,0,0]
    v_pk_fma_f32 v[126:127], v[14:15], v[26:27], v[126:127] op_sel_hi:[0,1,1] neg_lo:[1,0,0] neg_hi:[1,0,0]
    v_pk_mul_f32 v[116:117], v[28:29], v[116:117]
    v_pk_mul_f32 v[118:119], v[30:31], v[118:119]
    v_pk_mul_f32 v[124:125], v[28:29], v[124:125]
    v_pk_mul_f32 v[126:127], v[30:31], v[126:127]
    v_cvt_pk_bf16_f32 v90, v116, v117
    v_cvt_pk_bf16_f32 v91, v118, v119
    v_cvt_pk_bf16_f32 v94, v124, v125
    v_cvt_pk_bf16_f32 v95, v126, v127
    v_cvt_pk_bf16_f32 v116, v116, v117
    v_cvt_pk_bf16_f32 v117, v118, v119
    v_cvt_pk_bf16_f32 v118, v124, v125
    v_cvt_pk_bf16_f32 v119, v126, v127
    ds_write_b128 v7, v[116:119] offset:7168
    s_cmp_lg_u32 s16, 3
    s_cbranch_scc1 a_nh
    buffer_store_dwordx4 v[68:71], v1, s[4:7], s60 offen offset:0 sc1
    buffer_store_dwordx4 v[84:87], v1, s[4:7], s60 offen offset:1024 sc1
    buffer_store_dwordx4 v[100:103], v1, s[4:7], s60 offen offset:2048 sc1
    buffer_store_dwordx4 v[116:119], v1, s[4:7], s60 offen offset:3072 sc1
a_nh:
    v_pk_fma_f32 v[96:97], v[8:9], v[16:17], v[96:97] op_sel_hi:[0,1,1] neg_lo:[1,0,0] neg_hi:[1,0,0]
    v_pk_fma_f32 v[98:99], v[8:9], v[18:19], v[98:99] op_sel_hi:[0,1,1] neg_lo:[1,0,0] neg_hi:[1,0,0]
    v_pk_fma_f32 v[104:105], v[10:11], v[16:17], v[104:105] op_sel_hi:[0,1,1] neg_lo:[1,0,0] neg_hi:[1,0,0]
    v_pk_fma_f32 v[106:107], v[10:11], v[18:19], v[106:107] op_sel_hi:[0,1,1] neg_lo:[1,0,0] neg_hi:[1,0,0]
    v_pk_mul_f32 v[96:97], v[20:21], v[96:97]
    v_pk_mul_f32 v[98:99], v[22:23], v[98:99]
    v_pk_mul_f32 v[104:105], v[20:21], v[104:105]
    v_pk_mul_f32 v[106:107], v[22:23], v[106:107]
    v_cvt_pk_bf16_f32 v72, v96, v97
    v_cvt_pk_bf16_f32 v73, v98, v99
    v_cvt_pk_bf16_f32 v76, v104, v105
    v_cvt_pk_bf16_f32 v77, v106, v107
    v_pk_fma_f32 v[112:113], v[12:13], v[16:17], v[112:113] op_sel_hi:[0,1,1] neg_lo:[1,0,0] neg_hi:[1,0,0]
    v_pk_fma_f32 v[114:115], v[12:13], v[18:19], v[114:115] op_sel_hi:[0,1,1] neg_lo:[1,0,0] neg_hi:[1,0,0]
    v_pk_fma_f32 v[120:121], v[14:15], v[16:17], v[120:121] op_sel_hi:[0,1,1] neg_lo:[1,0,0] neg_hi:[1,0,0]
    v_pk_fma_f32 v[122:123], v[14:15], v[18:19], v[122:123] op_sel_hi:[0,1,1] neg_lo:[1,0,0] neg_hi:[1,0,0]
    v_pk_mul_f32 v[112:113], v[20:21], v[112:113]
    v_pk_mul_f32 v[114:115], v[22:23], v[114:115]
    v_pk_mul_f32 v[120:121], v[20:21], v[120:121]
    v_pk_mul_f32 v[122:123], v[22:23], v[122:123]
    v_cvt_pk_bf16_f32 v88, v112, v113
    v_cvt_pk_bf16_f32 v89, v114, v115
    v_cvt_pk_bf16_f32 v92, v120, v121
    v_cvt_pk_bf16_f32 v93, v122, v123
    v_mfma_f32_16x16x32_bf16 v[128:131], v[32:35], v[224:227], v[128:131]
    ds_read_b64_tr_b16 v[60:61], v6 offset:20480
    v_mfma_f32_16x16x32_bf16 v[132:135], v[32:35], v[228:231], v[132:135]
    ds_read_b64_tr_b16 v[62:63], v6 offset:21504
    v_mfma_f32_16x16x32_bf16 v[136:139], v[36:39], v[224:227], v[136:139]
    ds_read_b64_tr_b16 v[32:33], v3 offset:24576
    v_mfma_f32_16x16x32_bf16 v[140:143], v[36:39], v[228:231], v[140:143]
    ds_read_b64_tr_b16 v[34:35], v3 offset:25600
    v_mfma_f32_16x16x32_bf16 v[144:147], v[40:43], v[224:227], v[144:147]
    ds_read_b64_tr_b16 v[36:37], v4 offset:24576
    v_mfma_f32_16x16x32_bf16 v[148:151], v[40:43], v[228:231], v[148:151]
    ds_read_b64_tr_b16 v[38:39], v4 offset:25600
    v_mfma_f32_16x16x32_bf16 v[152:155], v[44:47], v[224:227], v[152:155]
    ds_read_b64_tr_b16 v[40:41], v5 offset:24576
    v_mfma_f32_16x16x32_bf16 v[156:159], v[44:47], v[228:231], v[156:159]
    ds_read_b64_tr_b16 v[42:43], v5 offset:25600
    s_waitcnt lgkmcnt(12)
    v_mfma_f32_16x16x32_bf16 v[128:131], v[48:51], v[232:235], v[128:131]
    ds_read_b64_tr_b16 v[44:45], v6 offset:24576
    v_mfma_f32_16x16x32_bf16 v[132:135], v[48:51], v[236:239], v[132:135]
    ds_read_b64_tr_b16 v[46:47], v6 offset:25600
    v_mfma_f32_16x16x32_bf16 v[136:139], v[52:55], v[232:235], v[136:139]
    ds_read_b64_tr_b16 v[48:49], v3 offset:28672
    v_mfma_f32_16x16x32_bf16 v[140:143], v[52:55], v[236:239], v[140:143]
    ds_read_b64_tr_b16 v[50:51], v3 offset:29696
    s_waitcnt lgkmcnt(10)
    v_mfma_f32_16x16x32_bf16 v[144:147], v[56:59], v[232:235], v[144:147]
    ds_read_b64_tr_b16 v[52:53], v4 offset:28672
    v_mfma_f32_16x16x32_bf16 v[148:151], v[56:59], v[236:239], v[148:151]
    ds_read_b64_tr_b16 v[54:55], v4 offset:29696
    v_mfma_f32_16x16x32_bf16 v[152:155], v[60:63], v[232:235], v[152:155]
    ds_read_b64_tr_b16 v[56:57], v5 offset:28672
    v_mfma_f32_16x16x32_bf16 v[156:159], v[60:63], v[236:239], v[156:159]
    ds_read_b64_tr_b16 v[58:59], v5 offset:29696
    s_waitcnt lgkmcnt(10)
    v_mfma_f32_16x16x32_bf16 v[128:131], v[32:35], v[240:243], v[128:131]
    ds_read_b64_tr_b16 v[60:61], v6 offset:28672
    v_mfma_f32_16x16x32_bf16 v[132:135], v[32:35], v[244:247], v[132:135]
    ds_read_b64_tr_b16 v[62:63], v6 offset:29696
    s_barrier
    v_mfma_f32_16x16x32_bf16 v[136:139], v[36:39], v[240:243], v[136:139]
    ds_read_b64_tr_b16 v[32:33], v3 offset:32768
    v_mfma_f32_16x16x32_bf16 v[140:143], v[36:39], v[244:247], v[140:143]
    ds_read_b64_tr_b16 v[34:35], v3 offset:33792
    s_waitcnt lgkmcnt(10)
    v_mfma_f32_16x16x32_bf16 v[144:147], v[40:43], v[240:243], v[144:147]
    ds_read_b64_tr_b16 v[36:37], v4 offset:32768
    v_mfma_f32_16x16x32_bf16 v[148:151], v[40:43], v[244:247], v[148:151]
    ds_read_b64_tr_b16 v[38:39], v4 offset:33792
    v_mfma_f32_16x16x32_bf16 v[152:155], v[44:47], v[240:243], v[152:155]
    ds_read_b64_tr_b16 v[40:41], v5 offset:32768
    v_mfma_f32_16x16x32_bf16 v[156:159], v[44:47], v[244:247], v[156:159]
    ds_read_b64_tr_b16 v[42:43], v5 offset:33792
    s_waitcnt lgkmcnt(10)
    v_mfma_f32_16x16x32_bf16 v[128:131], v[48:51], v[248:251], v[128:131]
    ds_read_b64_tr_b16 v[44:45], v6 offset:32768
    v_mfma_f32_16x16x32_bf16 v[132:135], v[48:51], v[252:255], v[132:135]
    ds_read_b64_tr_b16 v[46:47], v6 offset:33792
    v_mfma_f32_16x16x32_bf16 v[136:139], v[52:55], v[248:251], v[136:139]
    ds_read_b64_tr_b16 v[48:49], v3 offset:36864
    v_mfma_f32_16x16x32_bf16 v[140:143], v[52:55], v[252:255], v[140:143]
    ds_read_b64_tr_b16 v[50:51], v3 offset:37888
    s_waitcnt lgkmcnt(10)
    v_mfma_f32_16x16x32_bf16 v[144:147], v[56:59], v[248:251], v[144:147]
    ds_read_b64_tr_b16 v[52:53], v4 offset:36864
    v_mfma_f32_16x16x32_bf16 v[148:151], v[56:59], v[252:255], v[148:151]
    ds_read_b64_tr_b16 v[54:55], v4 offset:37888
    v_mfma_f32_16x16x32_bf16 v[152:155], v[60:63], v[248:251], v[152:155]
    ds_read_b64_tr_b16 v[56:57], v5 offset:36864
    v_mfma_f32_16x16x32_bf16 v[156:159], v[60:63], v[252:255], v[156:159]
    ds_read_b64_tr_b16 v[58:59], v5 offset:37888
    s_waitcnt lgkmcnt(10)
    v_mfma_f32_16x16x32_bf16 v[128:131], v[32:35], v[160:163], v[128:131]
    ds_read_b64_tr_b16 v[60:61], v6 offset:36864
    v_mfma_f32_16x16x32_bf16 v[132:135], v[32:35], v[164:167], v[132:135]
    ds_read_b64_tr_b16 v[62:63], v6 offset:37888
    v_mfma_f32_16x16x32_bf16 v[136:139], v[36:39], v[160:163], v[136:139]
    ds_read_b64_tr_b16 v[32:33], v3 offset:40960
    v_mfma_f32_16x16x32_bf16 v[140:143], v[36:39], v[164:167], v[140:143]
    ds_read_b64_tr_b16 v[34:35], v3 offset:41984
    s_waitcnt lgkmcnt(10)
    v_mfma_f32_16x16x32_bf16 v[144:147], v[40:43], v[160:163], v[144:147]
    ds_read_b64_tr_b16 v[36:37], v4 offset:40960
    v_mfma_f32_16x16x32_bf16 v[148:151], v[40:43], v[164:167], v[148:151]
    ds_read_b64_tr_b16 v[38:39], v4 offset:41984
    v_mfma_f32_16x16x32_bf16 v[152:155], v[44:47], v[160:163], v[152:155]
    ds_read_b64_tr_b16 v[40:41], v5 offset:40960
    v_mfma_f32_16x16x32_bf16 v[156:159], v[44:47], v[164:167], v[156:159]
    ds_read_b64_tr_b16 v[42:43], v5 offset:41984
    s_waitcnt lgkmcnt(10)
    v_mfma_f32_16x16x32_bf16 v[128:131], v[48:51], v[168:171], v[128:131]
    ds_read_b64_tr_b16 v[44:45], v6 offset:40960
    s_cmp_lg_u32 s16, 3
    s_cbranch_scc1 a_nopub
    s_waitcnt vmcnt(0)
    s_atomic_add s40, s[22:23], s61
a_nopub:
    v_mfma_f32_16x16x32_bf16 v[132:135], v[48:51], v[172:175], v[132:135]
    ds_read_b64_tr_b16 v[46:47], v6 offset:41984
    v_mfma_f32_16x16x32_bf16 v[136:139], v[52:55], v[168:171], v[136:139]
    ds_read_b64_tr_b16 v[48:49], v3 offset:45056
    v_mfma_f32_16x16x32_bf16 v[140:143], v[52:55], v[172:175], v[140:143]
    ds_read_b64_tr_b16 v[50:51], v3 offset:46080
    s_waitcnt lgkmcnt(10)
    v_mfma_f32_16x16x32_bf16 v[144:147], v[56:59], v[168:171], v[144:147]
    ds_read_b64_tr_b16 v[52:53], v4 offset:45056
    v_mfma_f32_16x16x32_bf16 v[148:151], v[56:59], v[172:175], v[148:151]
    ds_read_b64_tr_b16 v[54:55], v4 offset:46080
    v_mfma_f32_16x16x32_bf16 v[152:155], v[60:63], v[168:171], v[152:155]
    ds_read_b64_tr_b16 v[56:57], v5 offset:45056
    v_mfma_f32_16x16x32_bf16 v[156:159], v[60:63], v[172:175], v[156:159]
    ds_read_b64_tr_b16 v[58:59], v5 offset:46080
    s_waitcnt lgkmcnt(10)
    v_mfma_f32_16x16x32_bf16 v[128:131], v[32:35], v[176:179], v[128:131]
    ds_read_b64_tr_b16 v[60:61], v6 offset:45056
    v_mfma_f32_16x16x32_bf16 v[132:135], v[32:35], v[180:183], v[132:135]
    ds_read_b64_tr_b16 v[62:63], v6 offset:46080
    v_mfma_f32_16x16x32_bf16 v[136:139], v[36:39], v[176:179], v[136:139]
    ds_read_b64_tr_b16 v[32:33], v3 offset:49152
    v_mfma_f32_16x16x32_bf16 v[140:143], v[36:39], v[180:183], v[140:143]
    ds_read_b64_tr_b16 v[34:35], v3 offset:50176
    s_waitcnt lgkmcnt(10)
    v_mfma_f32_16x16x32_bf16 v[144:147], v[40:43], v[176:179], v[144:147]
    ds_read_b64_tr_b16 v[36:37], v4 offset:49152
    v_mfma_f32_16x16x32_bf16 v[148:151], v[40:43], v[180:183], v[148:151]
    ds_read_b64_tr_b16 v[38:39], v4 offset:50176
    v_mfma_f32_16x16x32_bf16 v[152:155], v[44:47], v[176:179], v[152:155]
    ds_read_b64_tr_b16 v[40:41], v5 offset:49152
    v_mfma_f32_16x16x32_bf16 v[156:159], v[44:47], v[180:183], v[156:159]
    ds_read_b64_tr_b16 v[42:43], v5 offset:50176
    s_waitcnt lgkmcnt(10)
    v_mfma_f32_16x16x32_bf16 v[128:131], v[48:51], v[184:187], v[128:131]
    ds_read_b64_tr_b16 v[44:45], v6 offset:49152
    ds_read_b32 v8, v9 offset:4096
    v_mfma_f32_16x16x32_bf16 v[132:135], v[48:51], v[188:191], v[132:135]
    ds_read_b64_tr_b16 v[46:47], v6 offset:50176
    ds_read_b32 v10, v9 offset:4608
    v_mfma_f32_16x16x32_bf16 v[136:139], v[52:55], v[184:187], v[136:139]
    ds_read_b64_tr_b16 v[48:49], v3 offset:53248
    ds_read_b32 v12, v9 offset:4160
    v_mfma_f32_16x16x32_bf16 v[140:143], v[52:55], v[188:191], v[140:143]
    ds_read_b64_tr_b16 v[50:51], v3 offset:54272
    ds_read_b32 v14, v9 offset:4672
    s_waitcnt lgkmcnt(14)
    v_mfma_f32_16x16x32_bf16 v[144:147], v[56:59], v[184:187], v[144:147]
    ds_read_b64_tr_b16 v[52:53], v4 offset:53248
    ds_read_b128 v[16:19], v11 offset:0
    v_mfma_f32_16x16x32_bf16 v[148:151], v[56:59], v[188:191], v[148:151]
    ds_read_b64_tr_b16 v[54:55], v4 offset:54272
    ds_read_b128 v[20:23], v11 offset:64
    v_mfma_f32_16x16x32_bf16 v[152:155], v[60:63], v[184:187], v[152:155]
    ds_read_b64_tr_b16 v[56:57], v5 offset:53248
    ds_read_b128 v[24:27], v11 offset:128
    v_mfma_f32_16x16x32_bf16 v[156:159], v[60:63], v[188:191], v[156:159]
    ds_read_b64_tr_b16 v[58:59], v5 offset:54272
    ds_read_b128 v[28:31], v11 offset:192
    s_waitcnt lgkmcnt(14)
    v_mfma_f32_16x16x32_bf16 v[128:131], v[32:35], v[192:195], v[128:131]
    ds_read_b64_tr_b16 v[60:61], v6 offset:53248
    v_add_u32 v13, 153600, v1
    v_mfma_f32_16x16x32_bf16 v[132:135], v[32:35], v[196:199], v[132:135]
    ds_read_b64_tr_b16 v[62:63], v6 offset:54272
    v_mfma_f32_16x16x32_bf16 v[136:139], v[36:39], v[192:195], v[136:139]
    ds_read_b64_tr_b16 v[32:33], v3 offset:57344
    v_mfma_f32_16x16x32_bf16 v[140:143], v[36:39], v[196:199], v[140:143]
    ds_read_b64_tr_b16 v[34:35], v3 offset:58368
    s_waitcnt lgkmcnt(14)
    v_mfma_f32_16x16x32_bf16 v[144:147], v[40:43], v[192:195], v[144:147]
    ds_read_b64_tr_b16 v[36:37], v4 offset:57344
    v_mfma_f32_16x16x32_bf16 v[148:151], v[40:43], v[196:199], v[148:151]
    ds_read_b64_tr_b16 v[38:39], v4 offset:58368
    v_mfma_f32_16x16x32_bf16 v[152:155], v[44:47], v[192:195], v[152:155]
    ds_read_b64_tr_b16 v[40:41], v5 offset:57344
    v_mfma_f32_16x16x32_bf16 v[156:159], v[44:47], v[196:199], v[156:159]
    ds_read_b64_tr_b16 v[42:43], v5 offset:58368
    s_waitcnt lgkmcnt(13)
    v_mfma_f32_16x16x32_bf16 v[128:131], v[48:51], v[200:203], v[128:131]
    ds_read_b64_tr_b16 v[44:45], v6 offset:57344
    s_waitcnt lgkmcnt(9)
    v_mfma_f32_16x16x32_bf16 v[132:135], v[48:51], v[204:207], v[132:135]
    ds_read_b64_tr_b16 v[46:47], v6 offset:58368
    v_mul_f32 v10, 0x3e8293ee, v10
    v_mfma_f32_16x16x32_bf16 v[136:139], v[52:55], v[200:203], v[136:139]
    ds_read_b64_tr_b16 v[48:49], v3 offset:61440
    v_mul_f32 v14, 0x3e8293ee, v14
    v_mfma_f32_16x16x32_bf16 v[140:143], v[52:55], v[204:207], v[140:143]
    ds_read_b64_tr_b16 v[50:51], v3 offset:62464
    ds_read_b128 v[120:123], v13 offset:0
    s_waitcnt lgkmcnt(11)
    v_mfma_f32_16x16x32_bf16 v[144:147], v[56:59], v[200:203], v[144:147]
    ds_read_b64_tr_b16 v[52:53], v4 offset:61440
    ds_read_b128 v[124:127], v13 offset:1024
    v_mfma_f32_16x16x32_bf16 v[148:151], v[56:59], v[204:207], v[148:151]
    ds_read_b64_tr_b16 v[54:55], v4 offset:62464
    v_mfma_f32_16x16x32_bf16 v[152:155], v[60:63], v[200:203], v[152:155]
    ds_read_b64_tr_b16 v[56:57], v5 offset:61440
    v_mfma_f32_16x16x32_bf16 v[156:159], v[60:63], v[204:207], v[156:159]
    ds_read_b64_tr_b16 v[58:59], v5 offset:62464
    s_waitcnt lgkmcnt(12)
    v_mfma_f32_16x16x32_bf16 v[128:131], v[32:35], v[208:211], v[128:131]
    ds_read_b64_tr_b16 v[60:61], v6 offset:61440
    v_mfma_f32_16x16x32_bf16 v[132:135], v[32:35], v[212:215], v[132:135]
    ds_read_b64_tr_b16 v[62:63], v6 offset:62464
    v_xor_b32 v3, 0x10000, v3
    v_xor_b32 v4, 0x10000, v4
    v_xor_b32 v5, 0x10000, v5
    v_xor_b32 v6, 0x10000, v6
    v_mfma_f32_16x16x32_bf16 v[136:139], v[36:39], v[208:211], v[136:139]
    v_mfma_f32_16x16x32_bf16 v[140:143], v[36:39], v[212:215], v[140:143]
    s_waitcnt lgkmcnt(10)
    v_mfma_f32_16x16x32_bf16 v[144:147], v[40:43], v[208:211], v[144:147]
    v_mfma_f32_16x16x32_bf16 v[148:151], v[40:43], v[212:215], v[148:151]
    v_mfma_f32_16x16x32_bf16 v[152:155], v[44:47], v[208:211], v[152:155]
    v_mfma_f32_16x16x32_bf16 v[156:159], v[44:47], v[212:215], v[156:159]
    s_waitcnt lgkmcnt(4)
    v_mfma_f32_16x16x32_bf16 v[128:131], v[48:51], v[216:219], v[128:131]
    v_mfma_f32_16x16x32_bf16 v[132:135], v[48:51], v[220:223], v[132:135]
    v_mfma_f32_16x16x32_bf16 v[136:139], v[52:55], v[216:219], v[136:139]
    v_mfma_f32_16x16x32_bf16 v[140:143], v[52:55], v[220:223], v[140:143]
    s_waitcnt lgkmcnt(0)
    v_mfma_f32_16x16x32_bf16 v[144:147], v[56:59], v[216:219], v[144:147]
    v_mfma_f32_16x16x32_bf16 v[148:151], v[56:59], v[220:223], v[148:151]
    v_mfma_f32_16x16x32_bf16 v[152:155], v[60:63], v[216:219], v[152:155]
    v_mfma_f32_16x16x32_bf16 v[156:159], v[60:63], v[220:223], v[156:159]
    s_lshl_b32 s44, s21, 22
    s_lshl_b32 s45, s38, 16
    s_add_u32 s44, s44, s45
    s_lshl_b32 s45, s18, 12
    s_add_u32 s44, s44, s45
    s_add_u32 s52, s44, 16777216
    v_pk_fma_f32 v[132:133], v[12:13], v[16:17], v[132:133] op_sel_hi:[0,1,1] neg_lo:[1,0,0] neg_hi:[1,0,0]
    v_pk_fma_f32 v[134:135], v[12:13], v[18:19], v[134:135] op_sel_hi:[0,1,1] neg_lo:[1,0,0] neg_hi:[1,0,0]
    v_pk_fma_f32 v[140:141], v[12:13], v[20:21], v[140:141] op_sel_hi:[0,1,1] neg_lo:[1,0,0] neg_hi:[1,0,0]
    v_pk_fma_f32 v[142:143], v[12:13], v[22:23], v[142:143] op_sel_hi:[0,1,1] neg_lo:[1,0,0] neg_hi:[1,0,0]
    v_pk_fma_f32 v[148:149], v[12:13], v[24:25], v[148:149] op_sel_hi:[0,1,1] neg_lo:[1,0,0] neg_hi:[1,0,0]
    v_pk_fma_f32 v[150:151], v[12:13], v[26:27], v[150:151] op_sel_hi:[0,1,1] neg_lo:[1,0,0] neg_hi:[1,0,0]
    v_pk_fma_f32 v[156:157], v[12:13], v[28:29], v[156:157] op_sel_hi:[0,1,1] neg_lo:[1,0,0] neg_hi:[1,0,0]
    v_pk_fma_f32 v[158:159], v[12:13], v[30:31], v[158:159] op_sel_hi:[0,1,1] neg_lo:[1,0,0] neg_hi:[1,0,0]
    v_pk_mul_f32 v[132:133], v[14:15], v[132:133] op_sel_hi:[0,1]
    v_pk_mul_f32 v[134:135], v[14:15], v[134:135] op_sel_hi:[0,1]
    v_pk_mul_f32 v[140:141], v[14:15], v[140:141] op_sel_hi:[0,1]
    v_pk_mul_f32 v[142:143], v[14:15], v[142:143] op_sel_hi:[0,1]
    v_pk_mul_f32 v[148:149], v[14:15], v[148:149] op_sel_hi:[0,1]
    v_pk_mul_f32 v[150:151], v[14:15], v[150:151] op_sel_hi:[0,1]
    v_pk_mul_f32 v[156:157], v[14:15], v[156:157] op_sel_hi:[0,1]
    v_pk_mul_f32 v[158:159], v[14:15], v[158:159] op_sel_hi:[0,1]
    v_cvt_pk_bf16_f32 v132, v132, v133
    v_cvt_pk_bf16_f32 v133, v134, v135
    v_cvt_pk_bf16_f32 v134, v140, v141
    v_cvt_pk_bf16_f32 v135, v142, v143
    v_cvt_pk_bf16_f32 v148, v148, v149
    v_cvt_pk_bf16_f32 v149, v150, v151
    v_cvt_pk_bf16_f32 v150, v156, v157
    v_cvt_pk_bf16_f32 v151, v158, v159
    v_mfma_f32_16x16x32_bf16 v[172:175], v[68:71], v[132:135], v[120:123]
    v_mfma_f32_16x16x32_bf16 v[168:171], v[64:67], v[132:135], v[124:127]
    v_mfma_f32_16x16x32_bf16 v[188:191], v[84:87], v[148:151], v[120:123]
    v_mfma_f32_16x16x32_bf16 v[184:187], v[80:83], v[148:151], v[124:127]
    v_pk_fma_f32 v[128:129], v[8:9], v[16:17], v[128:129] op_sel_hi:[0,1,1] neg_lo:[1,0,0] neg_hi:[1,0,0]
    v_pk_fma_f32 v[130:131], v[8:9], v[18:19], v[130:131] op_sel_hi:[0,1,1] neg_lo:[1,0,0] neg_hi:[1,0,0]
    v_pk_fma_f32 v[136:137], v[8:9], v[20:21], v[136:137] op_sel_hi:[0,1,1] neg_lo:[1,0,0] neg_hi:[1,0,0]
    v_pk_fma_f32 v[138:139], v[8:9], v[22:23], v[138:139] op_sel_hi:[0,1,1] neg_lo:[1,0,0] neg_hi:[1,0,0]
    v_pk_fma_f32 v[144:145], v[8:9], v[24:25], v[144:145] op_sel_hi:[0,1,1] neg_lo:[1,0,0] neg_hi:[1,0,0]
    v_pk_fma_f32 v[146:147], v[8:9], v[26:27], v[146:147] op_sel_hi:[0,1,1] neg_lo:[1,0,0] neg_hi:[1,0,0]
    v_pk_fma_f32 v[152:153], v[8:9], v[28:29], v[152:153] op_sel_hi:[0,1,1] neg_lo:[1,0,0] neg_hi:[1,0,0]
    v_pk_fma_f32 v[154:155], v[8:9], v[30:31], v[154:155] op_sel_hi:[0,1,1] neg_lo:[1,0,0] neg_hi:[1,0,0]
    v_pk_mul_f32 v[128:129], v[10:11], v[128:129] op_sel_hi:[0,1]
    v_pk_mul_f32 v[130:131], v[10:11], v[130:131] op_sel_hi:[0,1]
    v_pk_mul_f32 v[136:137], v[10:11], v[136:137] op_sel_hi:[0,1]
    v_pk_mul_f32 v[138:139], v[10:11], v[138:139] op_sel_hi:[0,1]
    v_pk_mul_f32 v[144:145], v[10:11], v[144:145] op_sel_hi:[0,1]
    v_pk_mul_f32 v[146:147], v[10:11], v[146:147] op_sel_hi:[0,1]
    v_pk_mul_f32 v[152:153], v[10:11], v[152:153] op_sel_hi:[0,1]
    v_pk_mul_f32 v[154:155], v[10:11], v[154:155] op_sel_hi:[0,1]
    v_cvt_pk_bf16_f32 v128, v128, v129
    v_cvt_pk_bf16_f32 v129, v130, v131
    v_cvt_pk_bf16_f32 v130, v136, v137
    v_cvt_pk_bf16_f32 v131, v138, v139
    v_cvt_pk_bf16_f32 v144, v144, v145
    v_cvt_pk_bf16_f32 v145, v146, v147
    v_cvt_pk_bf16_f32 v146, v152, v153
    v_cvt_pk_bf16_f32 v147, v154, v155
    v_mfma_f32_16x16x32_bf16 v[164:167], v[64:67], v[128:131], v[120:123]
    s_nop 0
    v_mfma_f32_16x16x32_bf16 v[180:183], v[80:83], v[144:147], v[120:123]
    v_mov_b32 v232, 0x3f803f80
    v_mov_b32 v233, 0x3f803f80
    v_mov_b32 v234, 0x3f803f80
    v_mov_b32 v235, 0x3f803f80
    v_exp_f32 v172, v172
    v_exp_f32 v173, v173
    v_exp_f32 v174, v174
    v_exp_f32 v175, v175
    v_exp_f32 v188, v188
    v_exp_f32 v189, v189
    v_exp_f32 v190, v190
    v_exp_f32 v191, v191
    s_mov_b32 s46, 1006632960
a_exp1:
    v_exp_f32 v168, v168
    v_exp_f32 v169, v169
    v_exp_f32 v170, v170
    v_exp_f32 v171, v171
    v_exp_f32 v184, v184
    v_exp_f32 v185, v185
    v_exp_f32 v186, v186
    v_exp_f32 v187, v187
    v_cvt_pk_bf16_f32 v200, v168, v169
    v_cvt_pk_bf16_f32 v201, v170, v171
    v_cvt_pk_bf16_f32 v202, v172, v173
    v_cvt_pk_bf16_f32 v203, v174, v175
    v_cvt_pk_bf16_f32 v204, v184, v185
    v_cvt_pk_bf16_f32 v205, v186, v187
    v_cvt_pk_bf16_f32 v206, v188, v189
    v_cvt_pk_bf16_f32 v207, v190, v191
    v_mfma_f32_16x16x32_bf16 v[16:19], v[232:235], v[200:203], 0
    s_nop 0
    v_mfma_f32_16x16x32_bf16 v[20:23], v[232:235], v[204:207], 0
    v_mfma_f32_16x16x32_bf16 v[40:43], v[72:75], v[200:203], 0
    v_mfma_f32_16x16x32_bf16 v[44:47], v[76:79], v[200:203], 0
    v_mfma_f32_16x16x32_bf16 v[56:59], v[88:91], v[204:207], 0
    v_mfma_f32_16x16x32_bf16 v[60:63], v[92:95], v[204:207], 0
    v_mov_b32 v218, v72
    v_mov_b32 v219, v73
    v_mov_b32 v222, v76
    v_mov_b32 v223, v77
    v_mov_b32 v226, v88
    v_mov_b32 v227, v89
    v_mov_b32 v230, v92
    v_mov_b32 v231, v93
    v_subrev_u32 v18, 0x21800000, v16
    v_subrev_u32 v22, 0x21800000, v20
    v_max_u32 v18, v18, v22
    v_cmp_le_u32 vcc, s46, v18
    v_rcp_f32 v16, v16
    v_rcp_f32 v20, v20
    s_cbranch_vccnz a_slow1
a_fin1:
    v_pk_mul_f32 v[40:41], v[16:17], v[40:41] op_sel_hi:[0,1]
    v_pk_mul_f32 v[42:43], v[16:17], v[42:43] op_sel_hi:[0,1]
    v_pk_mul_f32 v[44:45], v[16:17], v[44:45] op_sel_hi:[0,1]
    v_pk_mul_f32 v[46:47], v[16:17], v[46:47] op_sel_hi:[0,1]
    v_pk_mul_f32 v[56:57], v[20:21], v[56:57] op_sel_hi:[0,1]
    v_pk_mul_f32 v[58:59], v[20:21], v[58:59] op_sel_hi:[0,1]
    v_pk_mul_f32 v[60:61], v[20:21], v[60:61] op_sel_hi:[0,1]
    v_pk_mul_f32 v[62:63], v[20:21], v[62:63] op_sel_hi:[0,1]
    v_cvt_pk_bf16_f32 v40, v40, v41
    v_cvt_pk_bf16_f32 v41, v42, v43
    v_cvt_pk_bf16_f32 v42, v44, v45
    v_cvt_pk_bf16_f32 v43, v46, v47
    v_cvt_pk_bf16_f32 v56, v56, v57
    v_cvt_pk_bf16_f32 v57, v58, v59
    v_cvt_pk_bf16_f32 v58, v60, v61
    v_cvt_pk_bf16_f32 v59, v62, v63
    v_permlane32_swap_b32 v40, v42
    v_permlane32_swap_b32 v41, v43
    buffer_store_dwordx4 v[40:43], v2, s[4:7], s52 offen offset:256 sc1
    v_permlane32_swap_b32 v56, v58
    v_permlane32_swap_b32 v57, v59
    buffer_store_dwordx4 v[56:59], v2, s[4:7], s52 offen offset:2304 sc1
    s_cmp_lg_u32 s38, 0
    s_cbranch_scc1 a_hasprev
    v_mov_b32 v124, 0xf149f2ca
    v_mov_b32 v125, 0xf149f2ca
    v_mov_b32 v126, 0xf149f2ca
    v_mov_b32 v127, 0xf149f2ca
a_hasprev:
    s_waitcnt lgkmcnt(0)
    s_barrier
    ds_read_b128 v[192:195], v7 offset:0
    ds_read_b128 v[196:199], v7 offset:1024
    ds_read_b64 v[216:217], v7 offset:2048
    ds_read_b64 v[220:221], v7 offset:2056
    ds_read_b64 v[224:225], v7 offset:3072
    ds_read_b64 v[228:229], v7 offset:3080
    s_waitcnt lgkmcnt(4)
    v_mfma_f32_16x16x32_bf16 v[160:163], v[192:195], v[128:131], v[124:127]
    v_mfma_f32_16x16x32_bf16 v[176:179], v[196:199], v[144:147], v[124:127]
    v_exp_f32 v164, v164
    v_exp_f32 v165, v165
    v_exp_f32 v166, v166
    v_exp_f32 v167, v167
    v_exp_f32 v180, v180
    v_exp_f32 v181, v181
    v_exp_f32 v182, v182
    v_exp_f32 v183, v183
    s_waitcnt lgkmcnt(0)
    s_mov_b32 s46, 1006632960
a_exp0:
    v_exp_f32 v160, v160
    v_exp_f32 v161, v161
    v_exp_f32 v162, v162
    v_exp_f32 v163, v163
    v_exp_f32 v176, v176
    v_exp_f32 v177, v177
    v_exp_f32 v178, v178
    v_exp_f32 v179, v179
    v_cvt_pk_bf16_f32 v200, v160, v161
    v_cvt_pk_bf16_f32 v201, v162, v163
    v_cvt_pk_bf16_f32 v202, v164, v165
    v_cvt_pk_bf16_f32 v203, v166, v167
    v_cvt_pk_bf16_f32 v204, v176, v177
    v_cvt_pk_bf16_f32 v205, v178, v179
    v_cvt_pk_bf16_f32 v206, v180, v181
    v_cvt_pk_bf16_f32 v207, v182, v183
    v_mfma_f32_16x16x32_bf16 v[16:19], v[232:235], v[200:203], 0
    s_nop 0
    v_mfma_f32_16x16x32_bf16 v[20:23], v[232:235], v[204:207], 0
    v_mfma_f32_16x16x32_bf16 v[32:35], v[216:219], v[200:203], 0
    v_mfma_f32_16x16x32_bf16 v[36:39], v[220:223], v[200:203], 0
    v_mfma_f32_16x16x32_bf16 v[48:51], v[224:227], v[204:207], 0
    v_mfma_f32_16x16x32_bf16 v[52:55], v[228:231], v[204:207], 0
    s_nop 1
    v_subrev_u32 v18, 0x21800000, v16
    s_nop 0
    v_subrev_u32 v22, 0x21800000, v20
    v_max_u32 v18, v18, v22
    v_cmp_le_u32 vcc, s46, v18
    v_rcp_f32 v16, v16
    v_rcp_f32 v20, v20
    s_cbranch_vccnz a_slow0
a_fin0:
    v_pk_mul_f32 v[32:33], v[16:17], v[32:33] op_sel_hi:[0,1]
    v_pk_mul_f32 v[34:35], v[16:17], v[34:35] op_sel_hi:[0,1]
    v_pk_mul_f32 v[36:37], v[16:17], v[36:37] op_sel_hi:[0,1]
    v_pk_mul_f32 v[38:39], v[16:17], v[38:39] op_sel_hi:[0,1]
    v_pk_mul_f32 v[48:49], v[20:21], v[48:49] op_sel_hi:[0,1]
    v_pk_mul_f32 v[50:51], v[20:21], v[50:51] op_sel_hi:[0,1]
    v_pk_mul_f32 v[52:53], v[20:21], v[52:53] op_sel_hi:[0,1]
    v_pk_mul_f32 v[54:55], v[20:21], v[54:55] op_sel_hi:[0,1]
    v_cvt_pk_bf16_f32 v32, v32, v33
    v_cvt_pk_bf16_f32 v33, v34, v35
    v_cvt_pk_bf16_f32 v34, v36, v37
    v_cvt_pk_bf16_f32 v35, v38, v39
    v_cvt_pk_bf16_f32 v48, v48, v49
    v_cvt_pk_bf16_f32 v49, v50, v51
    v_cvt_pk_bf16_f32 v50, v52, v53
    v_cvt_pk_bf16_f32 v51, v54, v55
    v_permlane32_swap_b32 v32, v34
    v_permlane32_swap_b32 v33, v35
    buffer_store_dwordx4 v[32:35], v2, s[4:7], s52 offen offset:0 sc1
    v_permlane32_swap_b32 v48, v50
    v_permlane32_swap_b32 v49, v51
    buffer_store_dwordx4 v[48:51], v2, s[4:7], s52 offen offset:2048 sc1
    s_lshl_b32 s44, s21, 22
    s_lshl_b32 s45, s38, 16
    s_add_u32 s41, s44, s45
    s_lshl_b32 s45, s18, 12
    s_add_u32 s43, s41, s45
    s_and_b32 s45, s45, 0
    s_add_u32 s41, s41, s45
    s_add_u32 s41, s41, 16777216
    buffer_load_dwordx4 v[224:227], v2, s[4:7], s43 offen offset:0 sc1
    buffer_load_dwordx4 v[228:231], v2, s[4:7], s43 offen offset:256 sc1
    buffer_load_dwordx4 v[232:235], v2, s[4:7], s43 offen offset:2048 sc1
    buffer_load_dwordx4 v[236:239], v2, s[4:7], s43 offen offset:2304 sc1
    s_barrier
    s_lshl_b32 s47, s21, 14
    s_lshl_b32 s67, s38, 8
    s_add_u32 s47, s47, s67
    s_add_u32 s47, s47, 86144
    s_mov_b32 s68, 1
    s_waitcnt vmcnt(4)
    s_atomic_add s68, s[22:23], s47 glc
    s_mov_b32 s66, 0x10000
    s_waitcnt lgkmcnt(0)
    s_cmp_eq_u32 s68, 15
    s_cbranch_scc1 c_o_ok
c_o_poll:
    s_mov_b32 s68, 0
    s_atomic_add s68, s[22:23], s47 offset:0 glc
    s_sub_u32 s66, s66, 1
    s_cselect_b32 s67, 16, 0
    s_waitcnt lgkmcnt(0)
    s_max_u32 s68, s68, s67
    s_cmp_lt_u32 s68, 16
    s_cbranch_scc1 c_o_poll
c_o_ok:
    s_branch c_wo
a_slow1:
    s_cmp_eq_u32 s46, 0
    s_cbranch_scc1 a_fin1
    s_mov_b32 s46, 0
    v_mfma_f32_16x16x32_bf16 v[172:175], v[68:71], v[132:135], v[120:123]
    v_mfma_f32_16x16x32_bf16 v[168:171], v[64:67], v[132:135], v[124:127]
    v_mfma_f32_16x16x32_bf16 v[188:191], v[84:87], v[148:151], v[120:123]
    v_mfma_f32_16x16x32_bf16 v[184:187], v[80:83], v[148:151], v[124:127]
    s_nop 5
    v_max3_f32 v24, v168, v169, v170
    v_max3_f32 v24, v24, v171, v172
    v_max3_f32 v24, v24, v173, v174
    v_max_f32 v24, v24, v175
    v_max3_f32 v26, v184, v185, v186
    v_max3_f32 v26, v26, v187, v188
    v_max3_f32 v26, v26, v189, v190
    v_max_f32 v26, v26, v191
    v_mov_b32 v25, v24
    v_mov_b32 v27, v26
    s_nop 0
    v_permlane32_swap_b32 v24, v25
    v_permlane32_swap_b32 v26, v27
    v_max_f32 v24, v24, v25
    v_max_f32 v26, v26, v27
    v_mov_b32 v25, v24
    v_mov_b32 v27, v26
    s_nop 0
    v_permlane16_swap_b32 v24, v25
    v_permlane16_swap_b32 v26, v27
    v_max_f32 v24, v24, v25
    v_max_f32 v26, v26, v27
    v_sub_f32 v168, v168, v24
    v_sub_f32 v169, v169, v24
    v_sub_f32 v170, v170, v24
    v_sub_f32 v171, v171, v24
    v_sub_f32 v172, v172, v24
    v_sub_f32 v173, v173, v24
    v_sub_f32 v174, v174, v24
    v_sub_f32 v175, v175, v24
    v_sub_f32 v184, v184, v26
    v_sub_f32 v185, v185, v26
    v_sub_f32 v186, v186, v26
    v_sub_f32 v187, v187, v26
    v_sub_f32 v188, v188, v26
    v_sub_f32 v189, v189, v26
    v_sub_f32 v190, v190, v26
    v_sub_f32 v191, v191, v26
    v_exp_f32 v172, v172
    v_exp_f32 v173, v173
    v_exp_f32 v174, v174
    v_exp_f32 v175, v175
    v_exp_f32 v188, v188
    v_exp_f32 v189, v189
    v_exp_f32 v190, v190
    v_exp_f32 v191, v191
    s_branch a_exp1
a_slow0:
    s_cmp_eq_u32 s46, 0
    s_cbranch_scc1 a_fin0
    s_mov_b32 s46, 0
    v_mfma_f32_16x16x32_bf16 v[164:167], v[64:67], v[128:131], v[120:123]
    v_mfma_f32_16x16x32_bf16 v[160:163], v[192:195], v[128:131], v[124:127]
    v_mfma_f32_16x16x32_bf16 v[180:183], v[80:83], v[144:147], v[120:123]
    v_mfma_f32_16x16x32_bf16 v[176:179], v[196:199], v[144:147], v[124:127]
    s_nop 5
    v_max3_f32 v24, v160, v161, v162
    v_max3_f32 v24, v24, v163, v164
    v_max3_f32 v24, v24, v165, v166
    v_max_f32 v24, v24, v167
    v_max3_f32 v26, v176, v177, v178
    v_max3_f32 v26, v26, v179, v180
    v_max3_f32 v26, v26, v181, v182
    v_max_f32 v26, v26, v183
    v_mov_b32 v25, v24
    v_mov_b32 v27, v26
    s_nop 0
    v_permlane32_swap_b32 v24, v25
    v_permlane32_swap_b32 v26, v27
    v_max_f32 v24, v24, v25
    v_max_f32 v26, v26, v27
    v_mov_b32 v25, v24
    v_mov_b32 v27, v26
    s_nop 0
    v_permlane16_swap_b32 v24, v25
    v_permlane16_swap_b32 v26, v27
    v_max_f32 v24, v24, v25
    v_max_f32 v26, v26, v27
    v_sub_f32 v160, v160, v24
    v_sub_f32 v161, v161, v24
    v_sub_f32 v162, v162, v24
    v_sub_f32 v163, v163, v24
    v_sub_f32 v164, v164, v24
    v_sub_f32 v165, v165, v24
    v_sub_f32 v166, v166, v24
    v_sub_f32 v167, v167, v24
    v_sub_f32 v176, v176, v26
    v_sub_f32 v177, v177, v26
    v_sub_f32 v178, v178, v26
    v_sub_f32 v179, v179, v26
    v_sub_f32 v180, v180, v26
    v_sub_f32 v181, v181, v26
    v_sub_f32 v182, v182, v26
    v_sub_f32 v183, v183, v26
    v_exp_f32 v164, v164
    v_exp_f32 v165, v165
    v_exp_f32 v166, v166
    v_exp_f32 v167, v167
    v_exp_f32 v180, v180
    v_exp_f32 v181, v181
    v_exp_f32 v182, v182
    v_exp_f32 v183, v183
    s_branch a_exp0
c_B:
    s_waitcnt lgkmcnt(6)
    v_pk_fma_f32 v[64:65], v[8:9], v[16:17], v[64:65] op_sel_hi:[0,1,1] neg_lo:[1,0,0] neg_hi:[1,0,0]
    v_pk_fma_f32 v[66:67], v[8:9], v[18:19], v[66:67] op_sel_hi:[0,1,1] neg_lo:[1,0,0] neg_hi:[1,0,0]
    v_pk_fma_f32 v[72:73], v[8:9], v[20:21], v[72:73] op_sel_hi:[0,1,1] neg_lo:[1,0,0] neg_hi:[1,0,0]
    v_pk_fma_f32 v[74:75], v[8:9], v[22:23], v[74:75] op_sel_hi:[0,1,1] neg_lo:[1,0,0] neg_hi:[1,0,0]
    v_pk_mul_f32 v[64:65], v[10:11], v[64:65] op_sel_hi:[0,1]
    v_pk_mul_f32 v[66:67], v[10:11], v[66:67] op_sel_hi:[0,1]
    v_pk_mul_f32 v[72:73], v[10:11], v[72:73] op_sel_hi:[0,1]
    v_pk_mul_f32 v[74:75], v[10:11], v[74:75] op_sel_hi:[0,1]
    v_cvt_pk_bf16_f32 v64, v64, v65
    v_cvt_pk_bf16_f32 v65, v66, v67
    v_cvt_pk_bf16_f32 v66, v72, v73
    v_cvt_pk_bf16_f32 v67, v74, v75
    s_add_u32 s55, s52, 0
    buffer_store_dwordx4 v[64:67], v2, s[4:7], s55 offen offset:0 sc1
    v_pk_fma_f32 v[68:69], v[12:13], v[16:17], v[68:69] op_sel_hi:[0,1,1] neg_lo:[1,0,0] neg_hi:[1,0,0]
    v_pk_fma_f32 v[70:71], v[12:13], v[18:19], v[70:71] op_sel_hi:[0,1,1] neg_lo:[1,0,0] neg_hi:[1,0,0]
    v_pk_fma_f32 v[76:77], v[12:13], v[20:21], v[76:77] op_sel_hi:[0,1,1] neg_lo:[1,0,0] neg_hi:[1,0,0]
    v_pk_fma_f32 v[78:79], v[12:13], v[22:23], v[78:79] op_sel_hi:[0,1,1] neg_lo:[1,0,0] neg_hi:[1,0,0]
    v_pk_mul_f32 v[68:69], v[14:15], v[68:69] op_sel_hi:[0,1]
    v_pk_mul_f32 v[70:71], v[14:15], v[70:71] op_sel_hi:[0,1]
    v_pk_mul_f32 v[76:77], v[14:15], v[76:77] op_sel_hi:[0,1]
    v_pk_mul_f32 v[78:79], v[14:15], v[78:79] op_sel_hi:[0,1]
    v_cvt_pk_bf16_f32 v68, v68, v69
    v_cvt_pk_bf16_f32 v69, v70, v71
    v_cvt_pk_bf16_f32 v70, v76, v77
    v_cvt_pk_bf16_f32 v71, v78, v79
    buffer_store_dwordx4 v[68:71], v2, s[4:7], s55 offen offset:256 sc1
    v_pk_fma_f32 v[80:81], v[8:9], v[24:25], v[80:81] op_sel_hi:[0,1,1] neg_lo:[1,0,0] neg_hi:[1,0,0]
    v_pk_fma_f32 v[82:83], v[8:9], v[26:27], v[82:83] op_sel_hi:[0,1,1] neg_lo:[1,0,0] neg_hi:[1,0,0]
    v_pk_fma_f32 v[88:89], v[8:9], v[28:29], v[88:89] op_sel_hi:[0,1,1] neg_lo:[1,0,0] neg_hi:[1,0,0]
    v_pk_fma_f32 v[90:91], v[8:9], v[30:31], v[90:91] op_sel_hi:[0,1,1] neg_lo:[1,0,0] neg_hi:[1,0,0]
    v_pk_mul_f32 v[80:81], v[10:11], v[80:81] op_sel_hi:[0,1]
    v_pk_mul_f32 v[82:83], v[10:11], v[82:83] op_sel_hi:[0,1]
    v_pk_mul_f32 v[88:89], v[10:11], v[88:89] op_sel_hi:[0,1]
    v_pk_mul_f32 v[90:91], v[10:11], v[90:91] op_sel_hi:[0,1]
    v_cvt_pk_bf16_f32 v80, v80, v81
    v_cvt_pk_bf16_f32 v81, v82, v83
    v_cvt_pk_bf16_f32 v82, v88, v89
    v_cvt_pk_bf16_f32 v83, v90, v91
    s_add_u32 s55, s52, 131072
    buffer_store_dwordx4 v[80:83], v2, s[4:7], s55 offen offset:0 sc1
    v_pk_fma_f32 v[84:85], v[12:13], v[24:25], v[84:85] op_sel_hi:[0,1,1] neg_lo:[1,0,0] neg_hi:[1,0,0]
    v_pk_fma_f32 v[86:87], v[12:13], v[26:27], v[86:87] op_sel_hi:[0,1,1] neg_lo:[1,0,0] neg_hi:[1,0,0]
    v_pk_fma_f32 v[92:93], v[12:13], v[28:29], v[92:93] op_sel_hi:[0,1,1] neg_lo:[1,0,0] neg_hi:[1,0,0]
    v_pk_fma_f32 v[94:95], v[12:13], v[30:31], v[94:95] op_sel_hi:[0,1,1] neg_lo:[1,0,0] neg_hi:[1,0,0]
    v_pk_mul_f32 v[84:85], v[14:15], v[84:85] op_sel_hi:[0,1]
    v_pk_mul_f32 v[86:87], v[14:15], v[86:87] op_sel_hi:[0,1]
    v_pk_mul_f32 v[92:93], v[14:15], v[92:93] op_sel_hi:[0,1]
    v_pk_mul_f32 v[94:95], v[14:15], v[94:95] op_sel_hi:[0,1]
    v_cvt_pk_bf16_f32 v84, v84, v85
    v_cvt_pk_bf16_f32 v85, v86, v87
    v_cvt_pk_bf16_f32 v86, v92, v93
    v_cvt_pk_bf16_f32 v87, v94, v95
    buffer_store_dwordx4 v[84:87], v2, s[4:7], s55 offen offset:256 sc1
    v_mfma_f32_16x16x32_bf16 v[96:99], v[160:163], v[32:35], v[96:99]
    ds_read_b64_tr_b16 v[60:61], v6 offset:53248
    v_mfma_f32_16x16x32_bf16 v[100:103], v[164:167], v[32:35], v[100:103]
    ds_read_b64_tr_b16 v[62:63], v6 offset:54272
    v_mfma_f32_16x16x32_bf16 v[104:107], v[160:163], v[36:39], v[104:107]
    ds_read_b64_tr_b16 v[32:33], v3 offset:57344
    v_mfma_f32_16x16x32_bf16 v[108:111], v[164:167], v[36:39], v[108:111]
    ds_read_b64_tr_b16 v[34:35], v3 offset:58368
    v_mfma_f32_16x16x32_bf16 v[112:115], v[160:163], v[40:43], v[112:115]
    ds_read_b64_tr_b16 v[36:37], v4 offset:57344
    v_mfma_f32_16x16x32_bf16 v[116:119], v[164:167], v[40:43], v[116:119]
    ds_read_b64_tr_b16 v[38:39], v4 offset:58368
    v_mfma_f32_16x16x32_bf16 v[120:123], v[160:163], v[44:47], v[120:123]
    ds_read_b64_tr_b16 v[40:41], v5 offset:57344
    v_mfma_f32_16x16x32_bf16 v[124:127], v[164:167], v[44:47], v[124:127]
    ds_read_b64_tr_b16 v[42:43], v5 offset:58368
    s_waitcnt lgkmcnt(10)
    v_mfma_f32_16x16x32_bf16 v[96:99], v[168:171], v[48:51], v[96:99]
    ds_read_b64_tr_b16 v[44:45], v6 offset:57344
    v_mfma_f32_16x16x32_bf16 v[100:103], v[172:175], v[48:51], v[100:103]
    ds_read_b64_tr_b16 v[46:47], v6 offset:58368
    v_mfma_f32_16x16x32_bf16 v[104:107], v[168:171], v[52:55], v[104:107]
    ds_read_b64_tr_b16 v[48:49], v3 offset:61440
    v_mfma_f32_16x16x32_bf16 v[108:111], v[172:175], v[52:55], v[108:111]
    ds_read_b64_tr_b16 v[50:51], v3 offset:62464
    s_waitcnt lgkmcnt(10)
    v_mfma_f32_16x16x32_bf16 v[112:115], v[168:171], v[56:59], v[112:115]
    ds_read_b64_tr_b16 v[52:53], v4 offset:61440
    v_mfma_f32_16x16x32_bf16 v[116:119], v[172:175], v[56:59], v[116:119]
    ds_read_b64_tr_b16 v[54:55], v4 offset:62464
    v_mfma_f32_16x16x32_bf16 v[120:123], v[168:171], v[60:63], v[120:123]
    ds_read_b64_tr_b16 v[56:57], v5 offset:61440
    v_mfma_f32_16x16x32_bf16 v[124:127], v[172:175], v[60:63], v[124:127]
    ds_read_b64_tr_b16 v[58:59], v5 offset:62464
    s_waitcnt lgkmcnt(10)
    v_mfma_f32_16x16x32_bf16 v[96:99], v[176:179], v[32:35], v[96:99]
    ds_read_b64_tr_b16 v[60:61], v6 offset:61440
    v_mfma_f32_16x16x32_bf16 v[100:103], v[180:183], v[32:35], v[100:103]
    ds_read_b64_tr_b16 v[62:63], v6 offset:62464
    s_barrier
    v_xor_b32 v3, 0x10000, v3
    v_xor_b32 v4, 0x10000, v4
    v_xor_b32 v5, 0x10000, v5
    v_xor_b32 v6, 0x10000, v6
    v_mfma_f32_16x16x32_bf16 v[104:107], v[176:179], v[36:39], v[104:107]
    ds_read_b64_tr_b16 v[32:33], v3 offset:0
    v_mfma_f32_16x16x32_bf16 v[108:111], v[180:183], v[36:39], v[108:111]
    ds_read_b64_tr_b16 v[34:35], v3 offset:1024
    s_waitcnt lgkmcnt(10)
    v_mfma_f32_16x16x32_bf16 v[112:115], v[176:179], v[40:43], v[112:115]
    ds_read_b64_tr_b16 v[36:37], v4 offset:0
    v_mfma_f32_16x16x32_bf16 v[116:119], v[180:183], v[40:43], v[116:119]
    ds_read_b64_tr_b16 v[38:39], v4 offset:1024
    v_mfma_f32_16x16x32_bf16 v[120:123], v[176:179], v[44:47], v[120:123]
    ds_read_b64_tr_b16 v[40:41], v5 offset:0
    v_mfma_f32_16x16x32_bf16 v[124:127], v[180:183], v[44:47], v[124:127]
    ds_read_b64_tr_b16 v[42:43], v5 offset:1024
    s_waitcnt lgkmcnt(10)
    v_mfma_f32_16x16x32_bf16 v[96:99], v[184:187], v[48:51], v[96:99]
    ds_read_b64_tr_b16 v[44:45], v6 offset:0
    v_mfma_f32_16x16x32_bf16 v[100:103], v[188:191], v[48:51], v[100:103]
    ds_read_b64_tr_b16 v[46:47], v6 offset:1024
    v_mfma_f32_16x16x32_bf16 v[104:107], v[184:187], v[52:55], v[104:107]
    ds_read_b64_tr_b16 v[48:49], v3 offset:4096
    v_mfma_f32_16x16x32_bf16 v[108:111], v[188:191], v[52:55], v[108:111]
    ds_read_b64_tr_b16 v[50:51], v3 offset:5120
    s_waitcnt lgkmcnt(10)
    v_mfma_f32_16x16x32_bf16 v[112:115], v[184:187], v[56:59], v[112:115]
    ds_read_b64_tr_b16 v[52:53], v4 offset:4096
    v_mfma_f32_16x16x32_bf16 v[116:119], v[188:191], v[56:59], v[116:119]
    ds_read_b64_tr_b16 v[54:55], v4 offset:5120
    v_mfma_f32_16x16x32_bf16 v[120:123], v[184:187], v[60:63], v[120:123]
    ds_read_b64_tr_b16 v[56:57], v5 offset:4096
    v_mfma_f32_16x16x32_bf16 v[124:127], v[188:191], v[60:63], v[124:127]
    ds_read_b64_tr_b16 v[58:59], v5 offset:5120
    s_waitcnt lgkmcnt(10)
    v_mfma_f32_16x16x32_bf16 v[96:99], v[192:195], v[32:35], v[96:99]
    ds_read_b64_tr_b16 v[60:61], v6 offset:4096
    v_mfma_f32_16x16x32_bf16 v[100:103], v[196:199], v[32:35], v[100:103]
    ds_read_b64_tr_b16 v[62:63], v6 offset:5120
    v_mfma_f32_16x16x32_bf16 v[104:107], v[192:195], v[36:39], v[104:107]
    ds_read_b64_tr_b16 v[32:33], v3 offset:8192
    v_mfma_f32_16x16x32_bf16 v[108:111], v[196:199], v[36:39], v[108:111]
    ds_read_b64_tr_b16 v[34:35], v3 offset:9216
    s_waitcnt lgkmcnt(10)
    v_mfma_f32_16x16x32_bf16 v[112:115], v[192:195], v[40:43], v[112:115]
    ds_read_b64_tr_b16 v[36:37], v4 offset:8192
    v_mfma_f32_16x16x32_bf16 v[116:119], v[196:199], v[40:43], v[116:119]
    ds_read_b64_tr_b16 v[38:39], v4 offset:9216
    v_mfma_f32_16x16x32_bf16 v[120:123], v[192:195], v[44:47], v[120:123]
    ds_read_b64_tr_b16 v[40:41], v5 offset:8192
    v_mfma_f32_16x16x32_bf16 v[124:127], v[196:199], v[44:47], v[124:127]
    ds_read_b64_tr_b16 v[42:43], v5 offset:9216
    s_waitcnt lgkmcnt(10)
    v_mfma_f32_16x16x32_bf16 v[96:99], v[200:203], v[48:51], v[96:99]
    ds_read_b64_tr_b16 v[44:45], v6 offset:8192
    v_mfma_f32_16x16x32_bf16 v[100:103], v[204:207], v[48:51], v[100:103]
    ds_read_b64_tr_b16 v[46:47], v6 offset:9216
    v_mfma_f32_16x16x32_bf16 v[104:107], v[200:203], v[52:55], v[104:107]
    ds_read_b64_tr_b16 v[48:49], v3 offset:12288
    v_mfma_f32_16x16x32_bf16 v[108:111], v[204:207], v[52:55], v[108:111]
    ds_read_b64_tr_b16 v[50:51], v3 offset:13312
    s_waitcnt lgkmcnt(10)
    v_mfma_f32_16x16x32_bf16 v[112:115], v[200:203], v[56:59], v[112:115]
    ds_read_b64_tr_b16 v[52:53], v4 offset:12288
    v_mfma_f32_16x16x32_bf16 v[116:119], v[204:207], v[56:59], v[116:119]
    ds_read_b64_tr_b16 v[54:55], v4 offset:13312
    v_mfma_f32_16x16x32_bf16 v[120:123], v[200:203], v[60:63], v[120:123]
    ds_read_b64_tr_b16 v[56:57], v5 offset:12288
    v_mfma_f32_16x16x32_bf16 v[124:127], v[204:207], v[60:63], v[124:127]
    ds_read_b64_tr_b16 v[58:59], v5 offset:13312
    s_waitcnt lgkmcnt(10)
    v_mfma_f32_16x16x32_bf16 v[96:99], v[208:211], v[32:35], v[96:99]
    ds_read_b64_tr_b16 v[60:61], v6 offset:12288
    v_mfma_f32_16x16x32_bf16 v[100:103], v[212:215], v[32:35], v[100:103]
    ds_read_b64_tr_b16 v[62:63], v6 offset:13312
    v_mfma_f32_16x16x32_bf16 v[104:107], v[208:211], v[36:39], v[104:107]
    ds_read_b64_tr_b16 v[32:33], v3 offset:16384
    ds_read_b128 v[16:19], v13 offset:4096
    v_mfma_f32_16x16x32_bf16 v[108:111], v[212:215], v[36:39], v[108:111]
    ds_read_b64_tr_b16 v[34:35], v3 offset:17408
    ds_read_b128 v[20:23], v13 offset:4608
    s_waitcnt lgkmcnt(12)
    v_mfma_f32_16x16x32_bf16 v[112:115], v[208:211], v[40:43], v[112:115]
    ds_read_b64_tr_b16 v[36:37], v4 offset:16384
    ds_read_b128 v[24:27], v13 offset:4160
    v_mfma_f32_16x16x32_bf16 v[116:119], v[212:215], v[40:43], v[116:119]
    ds_read_b64_tr_b16 v[38:39], v4 offset:17408
    ds_read_b128 v[28:31], v13 offset:4672
    v_mfma_f32_16x16x32_bf16 v[120:123], v[208:211], v[44:47], v[120:123]
    ds_read_b64_tr_b16 v[40:41], v5 offset:16384
    ds_read_b32 v8, v15 offset:512
    v_mfma_f32_16x16x32_bf16 v[124:127], v[212:215], v[44:47], v[124:127]
    ds_read_b64_tr_b16 v[42:43], v5 offset:17408
    ds_read_b32 v10, v15 offset:576
    s_waitcnt lgkmcnt(14)
    v_mfma_f32_16x16x32_bf16 v[96:99], v[216:219], v[48:51], v[96:99]
    ds_read_b64_tr_b16 v[44:45], v6 offset:16384
    ds_read_b32 v12, v15 offset:640
    v_mfma_f32_16x16x32_bf16 v[100:103], v[220:223], v[48:51], v[100:103]
    ds_read_b64_tr_b16 v[46:47], v6 offset:17408
    ds_read_b32 v14, v15 offset:704
    v_mfma_f32_16x16x32_bf16 v[104:107], v[216:219], v[52:55], v[104:107]
    ds_read_b64_tr_b16 v[48:49], v3 offset:20480
    v_mfma_f32_16x16x32_bf16 v[108:111], v[220:223], v[52:55], v[108:111]
    ds_read_b64_tr_b16 v[50:51], v3 offset:21504
    s_waitcnt lgkmcnt(14)
    v_mfma_f32_16x16x32_bf16 v[112:115], v[216:219], v[56:59], v[112:115]
    ds_read_b64_tr_b16 v[52:53], v4 offset:20480
    v_mfma_f32_16x16x32_bf16 v[116:119], v[220:223], v[56:59], v[116:119]
    ds_read_b64_tr_b16 v[54:55], v4 offset:21504
    v_mfma_f32_16x16x32_bf16 v[120:123], v[216:219], v[60:63], v[120:123]
    ds_read_b64_tr_b16 v[56:57], v5 offset:20480
    v_mfma_f32_16x16x32_bf16 v[124:127], v[220:223], v[60:63], v[124:127]
    ds_read_b64_tr_b16 v[58:59], v5 offset:21504
    s_waitcnt lgkmcnt(6)
    v_pk_fma_f32 v[96:97], v[8:9], v[16:17], v[96:97] op_sel_hi:[0,1,1] neg_lo:[1,0,0] neg_hi:[1,0,0]
    v_pk_fma_f32 v[98:99], v[8:9], v[18:19], v[98:99] op_sel_hi:[0,1,1] neg_lo:[1,0,0] neg_hi:[1,0,0]
    v_pk_fma_f32 v[104:105], v[10:11], v[16:17], v[104:105] op_sel_hi:[0,1,1] neg_lo:[1,0,0] neg_hi:[1,0,0]
    v_pk_fma_f32 v[106:107], v[10:11], v[18:19], v[106:107] op_sel_hi:[0,1,1] neg_lo:[1,0,0] neg_hi:[1,0,0]
    v_pk_mul_f32 v[96:97], v[20:21], v[96:97]
    v_pk_mul_f32 v[98:99], v[22:23], v[98:99]
    v_pk_mul_f32 v[104:105], v[20:21], v[104:105]
    v_pk_mul_f32 v[106:107], v[22:23], v[106:107]
    v_cvt_pk_bf16_f32 v72, v96, v97
    v_cvt_pk_bf16_f32 v73, v98, v99
    v_cvt_pk_bf16_f32 v74, v104, v105
    v_cvt_pk_bf16_f32 v75, v106, v107
    s_add_u32 s56, s52, 4194304
    v_permlane16_swap_b32 v72, v74
    v_permlane16_swap_b32 v73, v75
    buffer_store_dwordx4 v[72:75], v1, s[4:7], s56 offen offset:0 sc1
    v_pk_fma_f32 v[112:113], v[12:13], v[16:17], v[112:113] op_sel_hi:[0,1,1] neg_lo:[1,0,0] neg_hi:[1,0,0]
    v_pk_fma_f32 v[114:115], v[12:13], v[18:19], v[114:115] op_sel_hi:[0,1,1] neg_lo:[1,0,0] neg_hi:[1,0,0]
    v_pk_fma_f32 v[120:121], v[14:15], v[16:17], v[120:121] op_sel_hi:[0,1,1] neg_lo:[1,0,0] neg_hi:[1,0,0]
    v_pk_fma_f32 v[122:123], v[14:15], v[18:19], v[122:123] op_sel_hi:[0,1,1] neg_lo:[1,0,0] neg_hi:[1,0,0]
    v_pk_mul_f32 v[112:113], v[20:21], v[112:113]
    v_pk_mul_f32 v[114:115], v[22:23], v[114:115]
    v_pk_mul_f32 v[120:121], v[20:21], v[120:121]
    v_pk_mul_f32 v[122:123], v[22:23], v[122:123]
    v_cvt_pk_bf16_f32 v88, v112, v113
    v_cvt_pk_bf16_f32 v89, v114, v115
    v_cvt_pk_bf16_f32 v90, v120, v121
    v_cvt_pk_bf16_f32 v91, v122, v123
    s_add_u32 s56, s52, 4325376
    v_permlane16_swap_b32 v88, v90
    v_permlane16_swap_b32 v89, v91
    buffer_store_dwordx4 v[88:91], v1, s[4:7], s56 offen offset:0 sc1
    v_pk_fma_f32 v[100:101], v[8:9], v[24:25], v[100:101] op_sel_hi:[0,1,1] neg_lo:[1,0,0] neg_hi:[1,0,0]
    v_pk_fma_f32 v[102:103], v[8:9], v[26:27], v[102:103] op_sel_hi:[0,1,1] neg_lo:[1,0,0] neg_hi:[1,0,0]
    v_pk_fma_f32 v[108:109], v[10:11], v[24:25], v[108:109] op_sel_hi:[0,1,1] neg_lo:[1,0,0] neg_hi:[1,0,0]
    v_pk_fma_f32 v[110:111], v[10:11], v[26:27], v[110:111] op_sel_hi:[0,1,1] neg_lo:[1,0,0] neg_hi:[1,0,0]
    v_pk_mul_f32 v[100:101], v[28:29], v[100:101]
    v_pk_mul_f32 v[102:103], v[30:31], v[102:103]
    v_pk_mul_f32 v[108:109], v[28:29], v[108:109]
    v_pk_mul_f32 v[110:111], v[30:31], v[110:111]
    v_cvt_pk_bf16_f32 v76, v100, v101
    v_cvt_pk_bf16_f32 v77, v102, v103
    v_cvt_pk_bf16_f32 v78, v108, v109
    v_cvt_pk_bf16_f32 v79, v110, v111
    s_add_u32 s56, s52, 4194304
    v_permlane16_swap_b32 v76, v78
    v_permlane16_swap_b32 v77, v79
    buffer_store_dwordx4 v[76:79], v1, s[4:7], s56 offen offset:1024 sc1
    v_pk_fma_f32 v[116:117], v[12:13], v[24:25], v[116:117] op_sel_hi:[0,1,1] neg_lo:[1,0,0] neg_hi:[1,0,0]
    v_pk_fma_f32 v[118:119], v[12:13], v[26:27], v[118:119] op_sel_hi:[0,1,1] neg_lo:[1,0,0] neg_hi:[1,0,0]
    v_pk_fma_f32 v[124:125], v[14:15], v[24:25], v[124:125] op_sel_hi:[0,1,1] neg_lo:[1,0,0] neg_hi:[1,0,0]
    v_pk_fma_f32 v[126:127], v[14:15], v[26:27], v[126:127] op_sel_hi:[0,1,1] neg_lo:[1,0,0] neg_hi:[1,0,0]
    v_pk_mul_f32 v[116:117], v[28:29], v[116:117]
    v_pk_mul_f32 v[118:119], v[30:31], v[118:119]
    v_pk_mul_f32 v[124:125], v[28:29], v[124:125]
    v_pk_mul_f32 v[126:127], v[30:31], v[126:127]
    v_cvt_pk_bf16_f32 v92, v116, v117
    v_cvt_pk_bf16_f32 v93, v118, v119
    v_cvt_pk_bf16_f32 v94, v124, v125
    v_cvt_pk_bf16_f32 v95, v126, v127
    s_add_u32 s56, s52, 4325376
    v_permlane16_swap_b32 v92, v94
    v_permlane16_swap_b32 v93, v95
    buffer_store_dwordx4 v[92:95], v1, s[4:7], s56 offen offset:1024 sc1
    v_mfma_f32_16x16x32_bf16 v[128:131], v[32:35], v[224:227], v[128:131]
    ds_read_b64_tr_b16 v[60:61], v6 offset:20480
    v_mfma_f32_16x16x32_bf16 v[132:135], v[32:35], v[228:231], v[132:135]
    ds_read_b64_tr_b16 v[62:63], v6 offset:21504
    v_mfma_f32_16x16x32_bf16 v[136:139], v[36:39], v[224:227], v[136:139]
    ds_read_b64_tr_b16 v[32:33], v3 offset:24576
    v_mfma_f32_16x16x32_bf16 v[140:143], v[36:39], v[228:231], v[140:143]
    ds_read_b64_tr_b16 v[34:35], v3 offset:25600
    v_mfma_f32_16x16x32_bf16 v[144:147], v[40:43], v[224:227], v[144:147]
    ds_read_b64_tr_b16 v[36:37], v4 offset:24576
    v_mfma_f32_16x16x32_bf16 v[148:151], v[40:43], v[228:231], v[148:151]
    ds_read_b64_tr_b16 v[38:39], v4 offset:25600
    v_mfma_f32_16x16x32_bf16 v[152:155], v[44:47], v[224:227], v[152:155]
    ds_read_b64_tr_b16 v[40:41], v5 offset:24576
    v_mfma_f32_16x16x32_bf16 v[156:159], v[44:47], v[228:231], v[156:159]
    ds_read_b64_tr_b16 v[42:43], v5 offset:25600
    s_waitcnt lgkmcnt(10)
    v_mfma_f32_16x16x32_bf16 v[128:131], v[48:51], v[232:235], v[128:131]
    ds_read_b64_tr_b16 v[44:45], v6 offset:24576
    v_mfma_f32_16x16x32_bf16 v[132:135], v[48:51], v[236:239], v[132:135]
    ds_read_b64_tr_b16 v[46:47], v6 offset:25600
    v_mfma_f32_16x16x32_bf16 v[136:139], v[52:55], v[232:235], v[136:139]
    ds_read_b64_tr_b16 v[48:49], v3 offset:28672
    v_mfma_f32_16x16x32_bf16 v[140:143], v[52:55], v[236:239], v[140:143]
    ds_read_b64_tr_b16 v[50:51], v3 offset:29696
    s_waitcnt lgkmcnt(10)
    v_mfma_f32_16x16x32_bf16 v[144:147], v[56:59], v[232:235], v[144:147]
    ds_read_b64_tr_b16 v[52:53], v4 offset:28672
    v_mfma_f32_16x16x32_bf16 v[148:151], v[56:59], v[236:239], v[148:151]
    ds_read_b64_tr_b16 v[54:55], v4 offset:29696
    v_mfma_f32_16x16x32_bf16 v[152:155], v[60:63], v[232:235], v[152:155]
    ds_read_b64_tr_b16 v[56:57], v5 offset:28672
    v_mfma_f32_16x16x32_bf16 v[156:159], v[60:63], v[236:239], v[156:159]
    ds_read_b64_tr_b16 v[58:59], v5 offset:29696
    s_waitcnt lgkmcnt(10)
    v_mfma_f32_16x16x32_bf16 v[128:131], v[32:35], v[240:243], v[128:131]
    ds_read_b64_tr_b16 v[60:61], v6 offset:28672
    v_mfma_f32_16x16x32_bf16 v[132:135], v[32:35], v[244:247], v[132:135]
    ds_read_b64_tr_b16 v[62:63], v6 offset:29696
    s_barrier
    v_mfma_f32_16x16x32_bf16 v[136:139], v[36:39], v[240:243], v[136:139]
    ds_read_b64_tr_b16 v[32:33], v3 offset:32768
    v_mfma_f32_16x16x32_bf16 v[140:143], v[36:39], v[244:247], v[140:143]
    ds_read_b64_tr_b16 v[34:35], v3 offset:33792
    s_waitcnt lgkmcnt(10)
    v_mfma_f32_16x16x32_bf16 v[144:147], v[40:43], v[240:243], v[144:147]
    ds_read_b64_tr_b16 v[36:37], v4 offset:32768
    v_mfma_f32_16x16x32_bf16 v[148:151], v[40:43], v[244:247], v[148:151]
    ds_read_b64_tr_b16 v[38:39], v4 offset:33792
    v_mfma_f32_16x16x32_bf16 v[152:155], v[44:47], v[240:243], v[152:155]
    ds_read_b64_tr_b16 v[40:41], v5 offset:32768
    v_mfma_f32_16x16x32_bf16 v[156:159], v[44:47], v[244:247], v[156:159]
    ds_read_b64_tr_b16 v[42:43], v5 offset:33792
    s_waitcnt lgkmcnt(10)
    v_mfma_f32_16x16x32_bf16 v[128:131], v[48:51], v[248:251], v[128:131]
    ds_read_b64_tr_b16 v[44:45], v6 offset:32768
    v_mfma_f32_16x16x32_bf16 v[132:135], v[48:51], v[252:255], v[132:135]
    ds_read_b64_tr_b16 v[46:47], v6 offset:33792
    v_mfma_f32_16x16x32_bf16 v[136:139], v[52:55], v[248:251], v[136:139]
    ds_read_b64_tr_b16 v[48:49], v3 offset:36864
    v_mfma_f32_16x16x32_bf16 v[140:143], v[52:55], v[252:255], v[140:143]
    ds_read_b64_tr_b16 v[50:51], v3 offset:37888
    s_waitcnt lgkmcnt(10)
    v_mfma_f32_16x16x32_bf16 v[144:147], v[56:59], v[248:251], v[144:147]
    ds_read_b64_tr_b16 v[52:53], v4 offset:36864
    v_mfma_f32_16x16x32_bf16 v[148:151], v[56:59], v[252:255], v[148:151]
    ds_read_b64_tr_b16 v[54:55], v4 offset:37888
    v_mfma_f32_16x16x32_bf16 v[152:155], v[60:63], v[248:251], v[152:155]
    ds_read_b64_tr_b16 v[56:57], v5 offset:36864
    v_mfma_f32_16x16x32_bf16 v[156:159], v[60:63], v[252:255], v[156:159]
    ds_read_b64_tr_b16 v[58:59], v5 offset:37888
    s_waitcnt lgkmcnt(10)
    v_mfma_f32_16x16x32_bf16 v[128:131], v[32:35], v[160:163], v[128:131]
    ds_read_b64_tr_b16 v[60:61], v6 offset:36864
    v_mfma_f32_16x16x32_bf16 v[132:135], v[32:35], v[164:167], v[132:135]
    ds_read_b64_tr_b16 v[62:63], v6 offset:37888
    v_mfma_f32_16x16x32_bf16 v[136:139], v[36:39], v[160:163], v[136:139]
    ds_read_b64_tr_b16 v[32:33], v3 offset:40960
    v_mfma_f32_16x16x32_bf16 v[140:143], v[36:39], v[164:167], v[140:143]
    ds_read_b64_tr_b16 v[34:35], v3 offset:41984
    s_waitcnt lgkmcnt(10)
    v_mfma_f32_16x16x32_bf16 v[144:147], v[40:43], v[160:163], v[144:147]
    ds_read_b64_tr_b16 v[36:37], v4 offset:40960
    v_mfma_f32_16x16x32_bf16 v[148:151], v[40:43], v[164:167], v[148:151]
    ds_read_b64_tr_b16 v[38:39], v4 offset:41984
    v_mfma_f32_16x16x32_bf16 v[152:155], v[44:47], v[160:163], v[152:155]
    ds_read_b64_tr_b16 v[40:41], v5 offset:40960
    v_mfma_f32_16x16x32_bf16 v[156:159], v[44:47], v[164:167], v[156:159]
    ds_read_b64_tr_b16 v[42:43], v5 offset:41984
    s_waitcnt lgkmcnt(10)
    v_mfma_f32_16x16x32_bf16 v[128:131], v[48:51], v[168:171], v[128:131]
    ds_read_b64_tr_b16 v[44:45], v6 offset:40960
    v_mfma_f32_16x16x32_bf16 v[132:135], v[48:51], v[172:175], v[132:135]
    ds_read_b64_tr_b16 v[46:47], v6 offset:41984
    v_mfma_f32_16x16x32_bf16 v[136:139], v[52:55], v[168:171], v[136:139]
    ds_read_b64_tr_b16 v[48:49], v3 offset:45056
    v_mfma_f32_16x16x32_bf16 v[140:143], v[52:55], v[172:175], v[140:143]
    ds_read_b64_tr_b16 v[50:51], v3 offset:46080
    s_waitcnt lgkmcnt(10)
    v_mfma_f32_16x16x32_bf16 v[144:147], v[56:59], v[168:171], v[144:147]
    ds_read_b64_tr_b16 v[52:53], v4 offset:45056
    v_mfma_f32_16x16x32_bf16 v[148:151], v[56:59], v[172:175], v[148:151]
    ds_read_b64_tr_b16 v[54:55], v4 offset:46080
    v_mfma_f32_16x16x32_bf16 v[152:155], v[60:63], v[168:171], v[152:155]
    ds_read_b64_tr_b16 v[56:57], v5 offset:45056
    v_mfma_f32_16x16x32_bf16 v[156:159], v[60:63], v[172:175], v[156:159]
    ds_read_b64_tr_b16 v[58:59], v5 offset:46080
    s_waitcnt lgkmcnt(10)
    v_mfma_f32_16x16x32_bf16 v[128:131], v[32:35], v[176:179], v[128:131]
    ds_read_b64_tr_b16 v[60:61], v6 offset:45056
    v_mfma_f32_16x16x32_bf16 v[132:135], v[32:35], v[180:183], v[132:135]
    ds_read_b64_tr_b16 v[62:63], v6 offset:46080
    v_mfma_f32_16x16x32_bf16 v[136:139], v[36:39], v[176:179], v[136:139]
    ds_read_b64_tr_b16 v[32:33], v3 offset:49152
    v_mfma_f32_16x16x32_bf16 v[140:143], v[36:39], v[180:183], v[140:143]
    ds_read_b64_tr_b16 v[34:35], v3 offset:50176
    s_waitcnt lgkmcnt(10)
    v_mfma_f32_16x16x32_bf16 v[144:147], v[40:43], v[176:179], v[144:147]
    ds_read_b64_tr_b16 v[36:37], v4 offset:49152
    v_mfma_f32_16x16x32_bf16 v[148:151], v[40:43], v[180:183], v[148:151]
    ds_read_b64_tr_b16 v[38:39], v4 offset:50176
    v_mfma_f32_16x16x32_bf16 v[152:155], v[44:47], v[176:179], v[152:155]
    ds_read_b64_tr_b16 v[40:41], v5 offset:49152
    v_mfma_f32_16x16x32_bf16 v[156:159], v[44:47], v[180:183], v[156:159]
    ds_read_b64_tr_b16 v[42:43], v5 offset:50176
    s_waitcnt lgkmcnt(10)
    v_mfma_f32_16x16x32_bf16 v[128:131], v[48:51], v[184:187], v[128:131]
    ds_read_b64_tr_b16 v[44:45], v6 offset:49152
    s_mov_b32 s68, 1
    s_waitcnt vmcnt(0)
    s_atomic_add s68, s[22:23], s59 glc
    s_add_u32 s55, s52, 131072
    s_add_u32 s56, s52, 4325376
    s_add_u32 s53, s53, 131072
    ds_read_b32 v8, v9 offset:4096
    v_mfma_f32_16x16x32_bf16 v[132:135], v[48:51], v[188:191], v[132:135]
    ds_read_b64_tr_b16 v[46:47], v6 offset:50176
    buffer_load_dwordx4 v[64:67], v1, s[4:7], s55 offen offset:0 sc1
    ds_read_b32 v10, v9 offset:4608
    v_mfma_f32_16x16x32_bf16 v[136:139], v[52:55], v[184:187], v[136:139]
    ds_read_b64_tr_b16 v[48:49], v3 offset:53248
    buffer_load_dwordx4 v[68:71], v1, s[4:7], s55 offen offset:1024 sc1
    ds_read_b32 v12, v9 offset:4160
    v_mfma_f32_16x16x32_bf16 v[140:143], v[52:55], v[188:191], v[140:143]
    ds_read_b64_tr_b16 v[50:51], v3 offset:54272
    buffer_load_dwordx4 v[72:75], v1, s[4:7], s56 offen offset:0 sc1
    ds_read_b32 v14, v9 offset:4672
    s_waitcnt lgkmcnt(14)
    v_mfma_f32_16x16x32_bf16 v[144:147], v[56:59], v[184:187], v[144:147]
    ds_read_b64_tr_b16 v[52:53], v4 offset:53248
    buffer_load_dwordx4 v[76:79], v1, s[4:7], s56 offen offset:1024 sc1
    ds_read_b128 v[16:19], v11 offset:0
    v_mfma_f32_16x16x32_bf16 v[148:151], v[56:59], v[188:191], v[148:151]
    ds_read_b64_tr_b16 v[54:55], v4 offset:54272
    ds_read_b128 v[20:23], v11 offset:64
    v_mfma_f32_16x16x32_bf16 v[152:155], v[60:63], v[184:187], v[152:155]
    ds_read_b64_tr_b16 v[56:57], v5 offset:53248
    ds_read_b128 v[24:27], v11 offset:128
    v_mfma_f32_16x16x32_bf16 v[156:159], v[60:63], v[188:191], v[156:159]
    ds_read_b64_tr_b16 v[58:59], v5 offset:54272
    ds_read_b128 v[28:31], v11 offset:192
    s_waitcnt lgkmcnt(14)
    v_mfma_f32_16x16x32_bf16 v[128:131], v[32:35], v[192:195], v[128:131]
    ds_read_b64_tr_b16 v[60:61], v6 offset:53248
    v_mfma_f32_16x16x32_bf16 v[132:135], v[32:35], v[196:199], v[132:135]
    ds_read_b64_tr_b16 v[62:63], v6 offset:54272
    v_mfma_f32_16x16x32_bf16 v[136:139], v[36:39], v[192:195], v[136:139]
    ds_read_b64_tr_b16 v[32:33], v3 offset:57344
    v_mfma_f32_16x16x32_bf16 v[140:143], v[36:39], v[196:199], v[140:143]
    ds_read_b64_tr_b16 v[34:35], v3 offset:58368
    s_waitcnt lgkmcnt(14)
    v_mfma_f32_16x16x32_bf16 v[144:147], v[40:43], v[192:195], v[144:147]
    ds_read_b64_tr_b16 v[36:37], v4 offset:57344
    v_mfma_f32_16x16x32_bf16 v[148:151], v[40:43], v[196:199], v[148:151]
    ds_read_b64_tr_b16 v[38:39], v4 offset:58368
    v_mfma_f32_16x16x32_bf16 v[152:155], v[44:47], v[192:195], v[152:155]
    ds_read_b64_tr_b16 v[40:41], v5 offset:57344
    v_mfma_f32_16x16x32_bf16 v[156:159], v[44:47], v[196:199], v[156:159]
    ds_read_b64_tr_b16 v[42:43], v5 offset:58368
    s_waitcnt lgkmcnt(13)
    v_mfma_f32_16x16x32_bf16 v[128:131], v[48:51], v[200:203], v[128:131]
    ds_read_b64_tr_b16 v[44:45], v6 offset:57344
    s_waitcnt lgkmcnt(9)
    v_mfma_f32_16x16x32_bf16 v[132:135], v[48:51], v[204:207], v[132:135]
    ds_read_b64_tr_b16 v[46:47], v6 offset:58368
    v_mul_f32 v10, 0x3e8293ee, v10
    v_mfma_f32_16x16x32_bf16 v[136:139], v[52:55], v[200:203], v[136:139]
    ds_read_b64_tr_b16 v[48:49], v3 offset:61440
    v_mul_f32 v14, 0x3e8293ee, v14
    v_mfma_f32_16x16x32_bf16 v[140:143], v[52:55], v[204:207], v[140:143]
    ds_read_b64_tr_b16 v[50:51], v3 offset:62464
    s_lshl_b32 s44, s16, 11
    s_waitcnt lgkmcnt(10)
    v_mfma_f32_16x16x32_bf16 v[144:147], v[56:59], v[200:203], v[144:147]
    ds_read_b64_tr_b16 v[52:53], v4 offset:61440
    s_add_u32 s44, s44, 131072
    v_mfma_f32_16x16x32_bf16 v[148:151], v[56:59], v[204:207], v[148:151]
    ds_read_b64_tr_b16 v[54:55], v4 offset:62464
    v_add_u32 v13, s44, v2
    v_mfma_f32_16x16x32_bf16 v[152:155], v[60:63], v[200:203], v[152:155]
    ds_read_b64_tr_b16 v[56:57], v5 offset:61440
    v_mfma_f32_16x16x32_bf16 v[156:159], v[60:63], v[204:207], v[156:159]
    ds_read_b64_tr_b16 v[58:59], v5 offset:62464
    s_waitcnt lgkmcnt(10)
    v_mfma_f32_16x16x32_bf16 v[128:131], v[32:35], v[208:211], v[128:131]
    ds_read_b64_tr_b16 v[60:61], v6 offset:61440
    v_mfma_f32_16x16x32_bf16 v[132:135], v[32:35], v[212:215], v[132:135]
    ds_read_b64_tr_b16 v[62:63], v6 offset:62464
    v_xor_b32 v3, 0x10000, v3
    v_xor_b32 v4, 0x10000, v4
    v_xor_b32 v5, 0x10000, v5
    v_xor_b32 v6, 0x10000, v6
    v_mfma_f32_16x16x32_bf16 v[136:139], v[36:39], v[208:211], v[136:139]
    v_mfma_f32_16x16x32_bf16 v[140:143], v[36:39], v[212:215], v[140:143]
    s_waitcnt lgkmcnt(8)
    v_mfma_f32_16x16x32_bf16 v[144:147], v[40:43], v[208:211], v[144:147]
    v_mfma_f32_16x16x32_bf16 v[148:151], v[40:43], v[212:215], v[148:151]
    v_mfma_f32_16x16x32_bf16 v[152:155], v[44:47], v[208:211], v[152:155]
    v_mfma_f32_16x16x32_bf16 v[156:159], v[44:47], v[212:215], v[156:159]
    s_waitcnt lgkmcnt(4)
    v_mfma_f32_16x16x32_bf16 v[128:131], v[48:51], v[216:219], v[128:131]
    v_mfma_f32_16x16x32_bf16 v[132:135], v[48:51], v[220:223], v[132:135]
    v_mfma_f32_16x16x32_bf16 v[136:139], v[52:55], v[216:219], v[136:139]
    v_mfma_f32_16x16x32_bf16 v[140:143], v[52:55], v[220:223], v[140:143]
    s_waitcnt lgkmcnt(0)
    v_mfma_f32_16x16x32_bf16 v[144:147], v[56:59], v[216:219], v[144:147]
    v_mfma_f32_16x16x32_bf16 v[148:151], v[56:59], v[220:223], v[148:151]
    v_mfma_f32_16x16x32_bf16 v[152:155], v[60:63], v[216:219], v[152:155]
    v_mfma_f32_16x16x32_bf16 v[156:159], v[60:63], v[220:223], v[156:159]
    v_pk_fma_f32 v[128:129], v[8:9], v[16:17], v[128:129] op_sel_hi:[0,1,1] neg_lo:[1,0,0] neg_hi:[1,0,0]
    v_pk_fma_f32 v[130:131], v[8:9], v[18:19], v[130:131] op_sel_hi:[0,1,1] neg_lo:[1,0,0] neg_hi:[1,0,0]
    v_pk_fma_f32 v[136:137], v[8:9], v[20:21], v[136:137] op_sel_hi:[0,1,1] neg_lo:[1,0,0] neg_hi:[1,0,0]
    v_pk_fma_f32 v[138:139], v[8:9], v[22:23], v[138:139] op_sel_hi:[0,1,1] neg_lo:[1,0,0] neg_hi:[1,0,0]
    v_pk_mul_f32 v[128:129], v[10:11], v[128:129] op_sel_hi:[0,1]
    v_pk_mul_f32 v[130:131], v[10:11], v[130:131] op_sel_hi:[0,1]
    v_pk_mul_f32 v[136:137], v[10:11], v[136:137] op_sel_hi:[0,1]
    v_pk_mul_f32 v[138:139], v[10:11], v[138:139] op_sel_hi:[0,1]
    v_cvt_pk_bf16_f32 v128, v128, v129
    v_cvt_pk_bf16_f32 v129, v130, v131
    v_cvt_pk_bf16_f32 v130, v136, v137
    v_cvt_pk_bf16_f32 v131, v138, v139
    ds_write_b128 v13, v[128:131] offset:0
    v_pk_fma_f32 v[132:133], v[12:13], v[16:17], v[132:133] op_sel_hi:[0,1,1] neg_lo:[1,0,0] neg_hi:[1,0,0]
    v_pk_fma_f32 v[134:135], v[12:13], v[18:19], v[134:135] op_sel_hi:[0,1,1] neg_lo:[1,0,0] neg_hi:[1,0,0]
    v_pk_fma_f32 v[140:141], v[12:13], v[20:21], v[140:141] op_sel_hi:[0,1,1] neg_lo:[1,0,0] neg_hi:[1,0,0]
    v_pk_fma_f32 v[142:143], v[12:13], v[22:23], v[142:143] op_sel_hi:[0,1,1] neg_lo:[1,0,0] neg_hi:[1,0,0]
    v_pk_mul_f32 v[132:133], v[14:15], v[132:133] op_sel_hi:[0,1]
    v_pk_mul_f32 v[134:135], v[14:15], v[134:135] op_sel_hi:[0,1]
    v_pk_mul_f32 v[140:141], v[14:15], v[140:141] op_sel_hi:[0,1]
    v_pk_mul_f32 v[142:143], v[14:15], v[142:143] op_sel_hi:[0,1]
    v_cvt_pk_bf16_f32 v132, v132, v133
    v_cvt_pk_bf16_f32 v133, v134, v135
    v_cvt_pk_bf16_f32 v134, v140, v141
    v_cvt_pk_bf16_f32 v135, v142, v143
    ds_write_b128 v13, v[132:135] offset:256
    v_pk_fma_f32 v[144:145], v[8:9], v[24:25], v[144:145] op_sel_hi:[0,1,1] neg_lo:[1,0,0] neg_hi:[1,0,0]
    v_pk_fma_f32 v[146:147], v[8:9], v[26:27], v[146:147] op_sel_hi:[0,1,1] neg_lo:[1,0,0] neg_hi:[1,0,0]
    v_pk_fma_f32 v[152:153], v[8:9], v[28:29], v[152:153] op_sel_hi:[0,1,1] neg_lo:[1,0,0] neg_hi:[1,0,0]
    v_pk_fma_f32 v[154:155], v[8:9], v[30:31], v[154:155] op_sel_hi:[0,1,1] neg_lo:[1,0,0] neg_hi:[1,0,0]
    v_pk_mul_f32 v[144:145], v[10:11], v[144:145] op_sel_hi:[0,1]
    v_pk_mul_f32 v[146:147], v[10:11], v[146:147] op_sel_hi:[0,1]
    v_pk_mul_f32 v[152:153], v[10:11], v[152:153] op_sel_hi:[0,1]
    v_pk_mul_f32 v[154:155], v[10:11], v[154:155] op_sel_hi:[0,1]
    v_cvt_pk_bf16_f32 v144, v144, v145
    v_cvt_pk_bf16_f32 v145, v146, v147
    v_cvt_pk_bf16_f32 v146, v152, v153
    v_cvt_pk_bf16_f32 v147, v154, v155
    ds_write_b128 v13, v[144:147] offset:8192
    v_pk_fma_f32 v[148:149], v[12:13], v[24:25], v[148:149] op_sel_hi:[0,1,1] neg_lo:[1,0,0] neg_hi:[1,0,0]
    v_pk_fma_f32 v[150:151], v[12:13], v[26:27], v[150:151] op_sel_hi:[0,1,1] neg_lo:[1,0,0] neg_hi:[1,0,0]
    v_pk_fma_f32 v[156:157], v[12:13], v[28:29], v[156:157] op_sel_hi:[0,1,1] neg_lo:[1,0,0] neg_hi:[1,0,0]
    v_pk_fma_f32 v[158:159], v[12:13], v[30:31], v[158:159] op_sel_hi:[0,1,1] neg_lo:[1,0,0] neg_hi:[1,0,0]
    v_pk_mul_f32 v[148:149], v[14:15], v[148:149] op_sel_hi:[0,1]
    v_pk_mul_f32 v[150:151], v[14:15], v[150:151] op_sel_hi:[0,1]
    v_pk_mul_f32 v[156:157], v[14:15], v[156:157] op_sel_hi:[0,1]
    v_pk_mul_f32 v[158:159], v[14:15], v[158:159] op_sel_hi:[0,1]
    v_cvt_pk_bf16_f32 v148, v148, v149
    v_cvt_pk_bf16_f32 v149, v150, v151
    v_cvt_pk_bf16_f32 v150, v156, v157
    v_cvt_pk_bf16_f32 v151, v158, v159
    ds_write_b128 v13, v[148:151] offset:8448
    v_add_u32 v4, 139264, v1
    s_lshl_b32 s44, s21, 22
    s_lshl_b32 s45, s38, 16
    s_add_u32 s41, s44, s45
    s_lshl_b32 s45, s18, 12
    s_add_u32 s43, s41, s45
    s_and_b32 s45, s45, 0
    s_add_u32 s41, s41, s45
    s_add_u32 s41, s41, 16777216
    s_mov_b32 s39, 1
    s_waitcnt lgkmcnt(0)
    s_cmp_eq_u32 s68, 15
    s_cselect_b32 s68, 16, 0
    s_cbranch_scc1 b_k2
    s_atomic_add s68, s[22:23], s59 glc
b_k2:
    s_barrier
b_att:
    ds_read_b128 v[32:35], v4 offset:0
    ds_read_b128 v[36:39], v4 offset:1024
    ds_read_b128 v[40:43], v4 offset:2048
    ds_read_b128 v[44:47], v4 offset:3072
    ds_read_b128 v[48:51], v4 offset:4096
    ds_read_b128 v[52:55], v4 offset:5120
    ds_read_b128 v[56:59], v4 offset:6144
    ds_read_b128 v[60:63], v4 offset:7168
    v_mov_b32 v9, 0xdddddddd
    v_bfe_u32 v10, v1, 4, 3
    v_mov_b32 v11, 0x3f803f80
    v_cmp_eq_u32 vcc, 0, v10
    v_cmp_eq_u32 s[44:45], 4, v10
    s_mov_b32 s58, 3
    v_cndmask_b32 v28, 0, v11, vcc
    v_cndmask_b32 v29, 0, v11, vcc
    v_cndmask_b32 v30, 0, v11, s[44:45]
    v_cndmask_b32 v31, 0, v11, s[44:45]
    v_mov_b32 v10, 0
    v_mov_b32 v11, 0
    s_waitcnt vmcnt(0) lgkmcnt(6)
    v_mfma_f32_32x32x16_bf16 v[192:207], v[64:67], v[32:35], 0
    v_mfma_f32_32x32x16_bf16 v[192:207], v[68:71], v[36:39], v[192:207]
    s_and_b32 s3, s16, 3
    s_lshl_b32 s44, s3, 12
    s_add_u32 s44, s44, 65536
    v_add_u32 v5, s44, v1
    s_lshl_b32 s44, s3, 8
    s_add_u32 s44, s44, 147456
    v_lshrrev_b32 v6, 2, v1
    v_add_u32 v6, s44, v6
    s_waitcnt lgkmcnt(4)
    v_mfma_f32_32x32x16_bf16 v[208:223], v[64:67], v[40:43], 0
    s_nop 1
    v_exp_f32 v192, v192
    v_exp_f32 v193, v193
    v_exp_f32 v194, v194
    v_mfma_f32_32x32x8_bf16 v[128:143], v[10:11], v[10:11], 0
    v_mov_b32 v12, 0
    v_exp_f32 v195, v195
    v_exp_f32 v196, v196
    v_exp_f32 v197, v197
    v_mfma_f32_32x32x16_bf16 v[208:223], v[68:71], v[44:47], v[208:223]
    v_exp_f32 v198, v198
    v_exp_f32 v199, v199
    v_exp_f32 v200, v200
    v_mfma_f32_32x32x8_bf16 v[144:159], v[10:11], v[10:11], 0
    v_mov_b32 v16, 0
    v_exp_f32 v201, v201
    v_exp_f32 v202, v202
    v_mfma_f32_32x32x8_bf16 v[160:175], v[10:11], v[10:11], 0
    v_mov_b32 v20, 0
    v_exp_f32 v203, v203
    v_exp_f32 v204, v204
    v_exp_f32 v205, v205
    v_mfma_f32_32x32x8_bf16 v[176:191], v[10:11], v[10:11], 0
    v_mov_b32 v24, 0
    v_exp_f32 v206, v206
    v_exp_f32 v207, v207
    s_waitcnt lgkmcnt(2)
    v_mfma_f32_32x32x16_bf16 v[224:239], v[64:67], v[48:51], 0
    v_exp_f32 v208, v208
    v_exp_f32 v209, v209
    v_exp_f32 v210, v210
    v_smfmac_f32_32x32x32_bf16 v[128:143], v[72:75], v[192:199], v9
    v_exp_f32 v211, v211
    v_exp_f32 v212, v212
    v_exp_f32 v213, v213
    v_mfma_f32_32x32x16_bf16 v[224:239], v[68:71], v[52:55], v[224:239]
    v_exp_f32 v214, v214
    v_exp_f32 v215, v215
    v_exp_f32 v216, v216
    v_smfmac_f32_16x16x64_bf16 v[12:15], v[28:31], v[192:199], v9
    v_exp_f32 v217, v217
    v_smfmac_f32_32x32x32_bf16 v[128:143], v[76:79], v[200:207], v9
    v_exp_f32 v218, v218
    v_exp_f32 v219, v219
    v_exp_f32 v220, v220
    v_smfmac_f32_16x16x64_bf16 v[12:15], v[28:31], v[200:207], v9
    v_exp_f32 v221, v221
    v_exp_f32 v222, v222
    v_exp_f32 v223, v223
    s_mov_b32 s66, 0x10000
    s_waitcnt lgkmcnt(0)
    s_cmp_eq_u32 s68, 16
    s_cbranch_scc1 c_k_ok
c_k_poll:
    s_mov_b32 s68, 0
    s_atomic_add s68, s[22:23], s59 offset:0 glc
    s_sub_u32 s66, s66, 1
    s_cselect_b32 s67, 16, 0
    s_waitcnt lgkmcnt(0)
    s_max_u32 s68, s68, s67
    s_cmp_lt_u32 s68, 16
    s_cbranch_scc1 c_k_poll
c_k_ok:
    s_add_u32 s54, s54, 8192
    s_and_b32 s54, s54, 0x1ffff
    s_add_u32 s55, s53, s54
    s_add_u32 s56, s55, 4194304
    buffer_load_dwordx4 v[80:83], v1, s[4:7], s55 offen offset:0 sc1
    buffer_load_dwordx4 v[84:87], v1, s[4:7], s55 offen offset:1024 sc1
    buffer_load_dwordx4 v[88:91], v1, s[4:7], s56 offen offset:0 sc1
    buffer_load_dwordx4 v[92:95], v1, s[4:7], s56 offen offset:1024 sc1
    s_add_u32 s54, s54, 8192
    s_and_b32 s54, s54, 0x1ffff
    s_add_u32 s55, s53, s54
    s_add_u32 s56, s55, 4194304
    buffer_load_dwordx4 v[96:99], v1, s[4:7], s55 offen offset:0 sc1
    buffer_load_dwordx4 v[100:103], v1, s[4:7], s55 offen offset:1024 sc1
    buffer_load_dwordx4 v[104:107], v1, s[4:7], s56 offen offset:0 sc1
    buffer_load_dwordx4 v[108:111], v1, s[4:7], s56 offen offset:1024 sc1
    s_add_u32 s54, s54, 8192
    s_and_b32 s54, s54, 0x1ffff
    s_add_u32 s55, s53, s54
    s_add_u32 s56, s55, 4194304
    buffer_load_dwordx4 v[112:115], v1, s[4:7], s55 offen offset:0 sc1
    buffer_load_dwordx4 v[116:119], v1, s[4:7], s55 offen offset:1024 sc1
    buffer_load_dwordx4 v[120:123], v1, s[4:7], s56 offen offset:0 sc1
    v_mfma_f32_32x32x16_bf16 v[240:255], v[64:67], v[56:59], 0
    v_exp_f32 v224, v224
    v_exp_f32 v225, v225
    v_exp_f32 v226, v226
    v_smfmac_f32_32x32x32_bf16 v[144:159], v[72:75], v[208:215], v9
    v_exp_f32 v227, v227
    v_exp_f32 v228, v228
    v_exp_f32 v229, v229
    v_mfma_f32_32x32x16_bf16 v[240:255], v[68:71], v[60:63], v[240:255]
    v_exp_f32 v230, v230
    v_exp_f32 v231, v231
    v_exp_f32 v232, v232
    v_smfmac_f32_16x16x64_bf16 v[16:19], v[28:31], v[208:215], v9
    v_exp_f32 v233, v233
    v_smfmac_f32_32x32x32_bf16 v[144:159], v[76:79], v[216:223], v9
    v_exp_f32 v234, v234
    v_exp_f32 v235, v235
    v_exp_f32 v236, v236
    v_smfmac_f32_16x16x64_bf16 v[16:19], v[28:31], v[216:223], v9
    v_exp_f32 v237, v237
    v_exp_f32 v238, v238
    v_exp_f32 v239, v239
b_loop:
    s_waitcnt vmcnt(7)
    v_mfma_f32_32x32x16_bf16 v[192:207], v[80:83], v[32:35], 0
    v_exp_f32 v240, v240
    v_exp_f32 v241, v241
    v_exp_f32 v242, v242
    v_smfmac_f32_32x32x32_bf16 v[160:175], v[72:75], v[224:231], v9
    v_exp_f32 v243, v243
    v_exp_f32 v244, v244
    v_exp_f32 v245, v245
    v_mfma_f32_32x32x16_bf16 v[192:207], v[84:87], v[36:39], v[192:207]
    v_exp_f32 v246, v246
    v_exp_f32 v247, v247
    v_exp_f32 v248, v248
    v_smfmac_f32_16x16x64_bf16 v[20:23], v[28:31], v[224:231], v9
    buffer_load_dwordx4 v[124:127], v1, s[4:7], s56 offen offset:1024 sc1
    v_exp_f32 v249, v249
    v_smfmac_f32_32x32x32_bf16 v[160:175], v[76:79], v[232:239], v9
    v_exp_f32 v250, v250
    v_exp_f32 v251, v251
    v_exp_f32 v252, v252
    v_smfmac_f32_16x16x64_bf16 v[20:23], v[28:31], v[232:239], v9
    v_exp_f32 v253, v253
    v_exp_f32 v254, v254
    v_exp_f32 v255, v255
    v_mfma_f32_32x32x16_bf16 v[208:223], v[80:83], v[40:43], 0
    s_add_u32 s54, s54, 8192
    s_and_b32 s54, s54, 0x1ffff
    s_add_u32 s55, s53, s54
    s_add_u32 s56, s55, 4194304
    v_exp_f32 v192, v192
    v_exp_f32 v193, v193
    v_exp_f32 v194, v194
    v_smfmac_f32_32x32x32_bf16 v[176:191], v[72:75], v[240:247], v9
    v_exp_f32 v195, v195
    v_exp_f32 v196, v196
    v_exp_f32 v197, v197
    v_mfma_f32_32x32x16_bf16 v[208:223], v[84:87], v[44:47], v[208:223]
    v_exp_f32 v198, v198
    v_exp_f32 v199, v199
    v_exp_f32 v200, v200
    v_smfmac_f32_16x16x64_bf16 v[24:27], v[28:31], v[240:247], v9
    buffer_load_dwordx4 v[64:67], v1, s[4:7], s55 offen offset:0 sc1
    v_exp_f32 v201, v201
    v_smfmac_f32_32x32x32_bf16 v[176:191], v[76:79], v[248:255], v9
    v_exp_f32 v202, v202
    v_exp_f32 v203, v203
    v_exp_f32 v204, v204
    v_smfmac_f32_16x16x64_bf16 v[24:27], v[28:31], v[248:255], v9
    v_exp_f32 v205, v205
    v_exp_f32 v206, v206
    v_exp_f32 v207, v207
    v_mfma_f32_32x32x16_bf16 v[224:239], v[80:83], v[48:51], 0
    v_exp_f32 v208, v208
    v_exp_f32 v209, v209
    v_exp_f32 v210, v210
    v_smfmac_f32_32x32x32_bf16 v[128:143], v[88:91], v[192:199], v9
    v_exp_f32 v211, v211
    v_exp_f32 v212, v212
    v_exp_f32 v213, v213
    v_mfma_f32_32x32x16_bf16 v[224:239], v[84:87], v[52:55], v[224:239]
    v_exp_f32 v214, v214
    v_exp_f32 v215, v215
    v_exp_f32 v216, v216
    v_smfmac_f32_16x16x64_bf16 v[12:15], v[28:31], v[192:199], v9
    buffer_load_dwordx4 v[68:71], v1, s[4:7], s55 offen offset:1024 sc1
    v_exp_f32 v217, v217
    v_smfmac_f32_32x32x32_bf16 v[128:143], v[92:95], v[200:207], v9
    v_exp_f32 v218, v218
    v_exp_f32 v219, v219
    v_exp_f32 v220, v220
    v_smfmac_f32_16x16x64_bf16 v[12:15], v[28:31], v[200:207], v9
    v_exp_f32 v221, v221
    v_exp_f32 v222, v222
    v_exp_f32 v223, v223
    v_mfma_f32_32x32x16_bf16 v[240:255], v[80:83], v[56:59], 0
    v_exp_f32 v224, v224
    v_exp_f32 v225, v225
    v_exp_f32 v226, v226
    v_smfmac_f32_32x32x32_bf16 v[144:159], v[88:91], v[208:215], v9
    v_exp_f32 v227, v227
    v_exp_f32 v228, v228
    v_exp_f32 v229, v229
    v_mfma_f32_32x32x16_bf16 v[240:255], v[84:87], v[60:63], v[240:255]
    v_exp_f32 v230, v230
    v_exp_f32 v231, v231
    v_exp_f32 v232, v232
    v_smfmac_f32_16x16x64_bf16 v[16:19], v[28:31], v[208:215], v9
    buffer_load_dwordx4 v[72:75], v1, s[4:7], s56 offen offset:0 sc1
    v_exp_f32 v233, v233
    v_smfmac_f32_32x32x32_bf16 v[144:159], v[92:95], v[216:223], v9
    v_exp_f32 v234, v234
    v_exp_f32 v235, v235
    v_exp_f32 v236, v236
    v_smfmac_f32_16x16x64_bf16 v[16:19], v[28:31], v[216:223], v9
    v_exp_f32 v237, v237
    v_exp_f32 v238, v238
    v_exp_f32 v239, v239
    s_waitcnt vmcnt(7)
    v_mfma_f32_32x32x16_bf16 v[192:207], v[96:99], v[32:35], 0
    v_exp_f32 v240, v240
    v_exp_f32 v241, v241
    v_exp_f32 v242, v242
    v_smfmac_f32_32x32x32_bf16 v[160:175], v[88:91], v[224:231], v9
    v_exp_f32 v243, v243
    v_exp_f32 v244, v244
    v_exp_f32 v245, v245
    v_mfma_f32_32x32x16_bf16 v[192:207], v[100:103], v[36:39], v[192:207]
    v_exp_f32 v246, v246
    v_exp_f32 v247, v247
    v_exp_f32 v248, v248
    v_smfmac_f32_16x16x64_bf16 v[20:23], v[28:31], v[224:231], v9
    buffer_load_dwordx4 v[76:79], v1, s[4:7], s56 offen offset:1024 sc1
    v_exp_f32 v249, v249
    v_smfmac_f32_32x32x32_bf16 v[160:175], v[92:95], v[232:239], v9
    v_exp_f32 v250, v250
    v_exp_f32 v251, v251
    v_exp_f32 v252, v252
    v_smfmac_f32_16x16x64_bf16 v[20:23], v[28:31], v[232:239], v9
    v_exp_f32 v253, v253
    v_exp_f32 v254, v254
    v_exp_f32 v255, v255
    v_mfma_f32_32x32x16_bf16 v[208:223], v[96:99], v[40:43], 0
    s_add_u32 s54, s54, 8192
    s_and_b32 s54, s54, 0x1ffff
    s_add_u32 s55, s53, s54
    s_add_u32 s56, s55, 4194304
    v_exp_f32 v192, v192
    v_exp_f32 v193, v193
    v_exp_f32 v194, v194
    v_smfmac_f32_32x32x32_bf16 v[176:191], v[88:91], v[240:247], v9
    v_exp_f32 v195, v195
    v_exp_f32 v196, v196
    v_exp_f32 v197, v197
    v_mfma_f32_32x32x16_bf16 v[208:223], v[100:103], v[44:47], v[208:223]
    v_exp_f32 v198, v198
    v_exp_f32 v199, v199
    v_exp_f32 v200, v200
    v_smfmac_f32_16x16x64_bf16 v[24:27], v[28:31], v[240:247], v9
    buffer_load_dwordx4 v[80:83], v1, s[4:7], s55 offen offset:0 sc1
    v_exp_f32 v201, v201
    v_smfmac_f32_32x32x32_bf16 v[176:191], v[92:95], v[248:255], v9
    v_exp_f32 v202, v202
    v_exp_f32 v203, v203
    v_exp_f32 v204, v204
    v_smfmac_f32_16x16x64_bf16 v[24:27], v[28:31], v[248:255], v9
    v_exp_f32 v205, v205
    v_exp_f32 v206, v206
    v_exp_f32 v207, v207
    v_mfma_f32_32x32x16_bf16 v[224:239], v[96:99], v[48:51], 0
    v_exp_f32 v208, v208
    v_exp_f32 v209, v209
    v_exp_f32 v210, v210
    v_smfmac_f32_32x32x32_bf16 v[128:143], v[104:107], v[192:199], v9
    v_exp_f32 v211, v211
    v_exp_f32 v212, v212
    v_exp_f32 v213, v213
    v_mfma_f32_32x32x16_bf16 v[224:239], v[100:103], v[52:55], v[224:239]
    v_exp_f32 v214, v214
    v_exp_f32 v215, v215
    v_exp_f32 v216, v216
    v_smfmac_f32_16x16x64_bf16 v[12:15], v[28:31], v[192:199], v9
    buffer_load_dwordx4 v[84:87], v1, s[4:7], s55 offen offset:1024 sc1
    v_exp_f32 v217, v217
    v_smfmac_f32_32x32x32_bf16 v[128:143], v[108:111], v[200:207], v9
    v_exp_f32 v218, v218
    v_exp_f32 v219, v219
    v_exp_f32 v220, v220
    v_smfmac_f32_16x16x64_bf16 v[12:15], v[28:31], v[200:207], v9
    v_exp_f32 v221, v221
    v_exp_f32 v222, v222
    v_exp_f32 v223, v223
    v_mfma_f32_32x32x16_bf16 v[240:255], v[96:99], v[56:59], 0
    v_exp_f32 v224, v224
    v_exp_f32 v225, v225
    v_exp_f32 v226, v226
    v_smfmac_f32_32x32x32_bf16 v[144:159], v[104:107], v[208:215], v9
    v_exp_f32 v227, v227
    v_exp_f32 v228, v228
    v_exp_f32 v229, v229
    v_mfma_f32_32x32x16_bf16 v[240:255], v[100:103], v[60:63], v[240:255]
    v_exp_f32 v230, v230
    v_exp_f32 v231, v231
    v_exp_f32 v232, v232
    v_smfmac_f32_16x16x64_bf16 v[16:19], v[28:31], v[208:215], v9
    buffer_load_dwordx4 v[88:91], v1, s[4:7], s56 offen offset:0 sc1
    v_exp_f32 v233, v233
    v_smfmac_f32_32x32x32_bf16 v[144:159], v[108:111], v[216:223], v9
    v_exp_f32 v234, v234
    v_exp_f32 v235, v235
    v_exp_f32 v236, v236
    v_smfmac_f32_16x16x64_bf16 v[16:19], v[28:31], v[216:223], v9
    v_exp_f32 v237, v237
    v_exp_f32 v238, v238
    v_exp_f32 v239, v239
    s_waitcnt vmcnt(7)
    v_mfma_f32_32x32x16_bf16 v[192:207], v[112:115], v[32:35], 0
    v_exp_f32 v240, v240
    v_exp_f32 v241, v241
    v_exp_f32 v242, v242
    v_smfmac_f32_32x32x32_bf16 v[160:175], v[104:107], v[224:231], v9
    v_exp_f32 v243, v243
    v_exp_f32 v244, v244
    v_exp_f32 v245, v245
    v_mfma_f32_32x32x16_bf16 v[192:207], v[116:119], v[36:39], v[192:207]
    v_exp_f32 v246, v246
    v_exp_f32 v247, v247
    v_exp_f32 v248, v248
    v_smfmac_f32_16x16x64_bf16 v[20:23], v[28:31], v[224:231], v9
    buffer_load_dwordx4 v[92:95], v1, s[4:7], s56 offen offset:1024 sc1
    v_exp_f32 v249, v249
    v_smfmac_f32_32x32x32_bf16 v[160:175], v[108:111], v[232:239], v9
    v_exp_f32 v250, v250
    v_exp_f32 v251, v251
    v_exp_f32 v252, v252
    v_smfmac_f32_16x16x64_bf16 v[20:23], v[28:31], v[232:239], v9
    v_exp_f32 v253, v253
    v_exp_f32 v254, v254
    v_exp_f32 v255, v255
    v_mfma_f32_32x32x16_bf16 v[208:223], v[112:115], v[40:43], 0
    s_add_u32 s54, s54, 8192
    s_and_b32 s54, s54, 0x1ffff
    s_add_u32 s55, s53, s54
    s_add_u32 s56, s55, 4194304
    v_exp_f32 v192, v192
    v_exp_f32 v193, v193
    v_exp_f32 v194, v194
    v_smfmac_f32_32x32x32_bf16 v[176:191], v[104:107], v[240:247], v9
    v_exp_f32 v195, v195
    v_exp_f32 v196, v196
    v_exp_f32 v197, v197
    v_mfma_f32_32x32x16_bf16 v[208:223], v[116:119], v[44:47], v[208:223]
    v_exp_f32 v198, v198
    v_exp_f32 v199, v199
    v_exp_f32 v200, v200
    v_smfmac_f32_16x16x64_bf16 v[24:27], v[28:31], v[240:247], v9
    buffer_load_dwordx4 v[96:99], v1, s[4:7], s55 offen offset:0 sc1
    v_exp_f32 v201, v201
    v_smfmac_f32_32x32x32_bf16 v[176:191], v[108:111], v[248:255], v9
    v_exp_f32 v202, v202
    v_exp_f32 v203, v203
    v_exp_f32 v204, v204
    v_smfmac_f32_16x16x64_bf16 v[24:27], v[28:31], v[248:255], v9
    v_exp_f32 v205, v205
    v_exp_f32 v206, v206
    v_exp_f32 v207, v207
    v_mfma_f32_32x32x16_bf16 v[224:239], v[112:115], v[48:51], 0
    v_exp_f32 v208, v208
    v_exp_f32 v209, v209
    v_exp_f32 v210, v210
    v_smfmac_f32_32x32x32_bf16 v[128:143], v[120:123], v[192:199], v9
    v_exp_f32 v211, v211
    v_exp_f32 v212, v212
    v_exp_f32 v213, v213
    v_mfma_f32_32x32x16_bf16 v[224:239], v[116:119], v[52:55], v[224:239]
    v_exp_f32 v214, v214
    v_exp_f32 v215, v215
    v_exp_f32 v216, v216
    v_smfmac_f32_16x16x64_bf16 v[12:15], v[28:31], v[192:199], v9
    buffer_load_dwordx4 v[100:103], v1, s[4:7], s55 offen offset:1024 sc1
    v_exp_f32 v217, v217
    v_smfmac_f32_32x32x32_bf16 v[128:143], v[124:127], v[200:207], v9
    v_exp_f32 v218, v218
    v_exp_f32 v219, v219
    v_exp_f32 v220, v220
    v_smfmac_f32_16x16x64_bf16 v[12:15], v[28:31], v[200:207], v9
    v_exp_f32 v221, v221
    v_exp_f32 v222, v222
    v_exp_f32 v223, v223
    v_mfma_f32_32x32x16_bf16 v[240:255], v[112:115], v[56:59], 0
    v_exp_f32 v224, v224
    v_exp_f32 v225, v225
    v_exp_f32 v226, v226
    v_smfmac_f32_32x32x32_bf16 v[144:159], v[120:123], v[208:215], v9
    v_exp_f32 v227, v227
    v_exp_f32 v228, v228
    v_exp_f32 v229, v229
    v_mfma_f32_32x32x16_bf16 v[240:255], v[116:119], v[60:63], v[240:255]
    v_exp_f32 v230, v230
    v_exp_f32 v231, v231
    v_exp_f32 v232, v232
    v_smfmac_f32_16x16x64_bf16 v[16:19], v[28:31], v[208:215], v9
    buffer_load_dwordx4 v[104:107], v1, s[4:7], s56 offen offset:0 sc1
    v_exp_f32 v233, v233
    v_smfmac_f32_32x32x32_bf16 v[144:159], v[124:127], v[216:223], v9
    v_exp_f32 v234, v234
    v_exp_f32 v235, v235
    v_exp_f32 v236, v236
    v_smfmac_f32_16x16x64_bf16 v[16:19], v[28:31], v[216:223], v9
    v_exp_f32 v237, v237
    v_exp_f32 v238, v238
    v_exp_f32 v239, v239
    s_waitcnt vmcnt(7)
    v_mfma_f32_32x32x16_bf16 v[192:207], v[64:67], v[32:35], 0
    v_exp_f32 v240, v240
    v_exp_f32 v241, v241
    v_exp_f32 v242, v242
    v_smfmac_f32_32x32x32_bf16 v[160:175], v[120:123], v[224:231], v9
    v_exp_f32 v243, v243
    v_exp_f32 v244, v244
    v_exp_f32 v245, v245
    v_mfma_f32_32x32x16_bf16 v[192:207], v[68:71], v[36:39], v[192:207]
    v_exp_f32 v246, v246
    v_exp_f32 v247, v247
    v_exp_f32 v248, v248
    v_smfmac_f32_16x16x64_bf16 v[20:23], v[28:31], v[224:231], v9
    buffer_load_dwordx4 v[108:111], v1, s[4:7], s56 offen offset:1024 sc1
    v_exp_f32 v249, v249
    v_smfmac_f32_32x32x32_bf16 v[160:175], v[124:127], v[232:239], v9
    v_exp_f32 v250, v250
    v_exp_f32 v251, v251
    v_exp_f32 v252, v252
    v_smfmac_f32_16x16x64_bf16 v[20:23], v[28:31], v[232:239], v9
    v_exp_f32 v253, v253
    v_exp_f32 v254, v254
    v_exp_f32 v255, v255
    v_mfma_f32_32x32x16_bf16 v[208:223], v[64:67], v[40:43], 0
    s_add_u32 s54, s54, 8192
    s_and_b32 s54, s54, 0x1ffff
    s_add_u32 s55, s53, s54
    s_add_u32 s56, s55, 4194304
    v_exp_f32 v192, v192
    v_exp_f32 v193, v193
    v_exp_f32 v194, v194
    v_smfmac_f32_32x32x32_bf16 v[176:191], v[120:123], v[240:247], v9
    v_exp_f32 v195, v195
    v_exp_f32 v196, v196
    v_exp_f32 v197, v197
    v_mfma_f32_32x32x16_bf16 v[208:223], v[68:71], v[44:47], v[208:223]
    v_exp_f32 v198, v198
    v_exp_f32 v199, v199
    v_exp_f32 v200, v200
    v_smfmac_f32_16x16x64_bf16 v[24:27], v[28:31], v[240:247], v9
    buffer_load_dwordx4 v[112:115], v1, s[4:7], s55 offen offset:0 sc1
    v_exp_f32 v201, v201
    v_smfmac_f32_32x32x32_bf16 v[176:191], v[124:127], v[248:255], v9
    v_exp_f32 v202, v202
    v_exp_f32 v203, v203
    v_exp_f32 v204, v204
    v_smfmac_f32_16x16x64_bf16 v[24:27], v[28:31], v[248:255], v9
    v_exp_f32 v205, v205
    v_exp_f32 v206, v206
    v_exp_f32 v207, v207
    v_mfma_f32_32x32x16_bf16 v[224:239], v[64:67], v[48:51], 0
    v_exp_f32 v208, v208
    v_exp_f32 v209, v209
    v_exp_f32 v210, v210
    v_smfmac_f32_32x32x32_bf16 v[128:143], v[72:75], v[192:199], v9
    v_exp_f32 v211, v211
    v_exp_f32 v212, v212
    v_exp_f32 v213, v213
    v_mfma_f32_32x32x16_bf16 v[224:239], v[68:71], v[52:55], v[224:239]
    v_exp_f32 v214, v214
    v_exp_f32 v215, v215
    v_exp_f32 v216, v216
    v_smfmac_f32_16x16x64_bf16 v[12:15], v[28:31], v[192:199], v9
    buffer_load_dwordx4 v[116:119], v1, s[4:7], s55 offen offset:1024 sc1
    v_exp_f32 v217, v217
    v_smfmac_f32_32x32x32_bf16 v[128:143], v[76:79], v[200:207], v9
    v_exp_f32 v218, v218
    v_exp_f32 v219, v219
    v_exp_f32 v220, v220
    v_smfmac_f32_16x16x64_bf16 v[12:15], v[28:31], v[200:207], v9
    v_exp_f32 v221, v221
    v_exp_f32 v222, v222
    v_exp_f32 v223, v223
    v_mfma_f32_32x32x16_bf16 v[240:255], v[64:67], v[56:59], 0
    v_exp_f32 v224, v224
    v_exp_f32 v225, v225
    v_exp_f32 v226, v226
    v_smfmac_f32_32x32x32_bf16 v[144:159], v[72:75], v[208:215], v9
    v_exp_f32 v227, v227
    v_exp_f32 v228, v228
    v_exp_f32 v229, v229
    v_mfma_f32_32x32x16_bf16 v[240:255], v[68:71], v[60:63], v[240:255]
    v_exp_f32 v230, v230
    v_exp_f32 v231, v231
    v_exp_f32 v232, v232
    v_smfmac_f32_16x16x64_bf16 v[16:19], v[28:31], v[208:215], v9
    buffer_load_dwordx4 v[120:123], v1, s[4:7], s56 offen offset:0 sc1
    v_exp_f32 v233, v233
    v_smfmac_f32_32x32x32_bf16 v[144:159], v[76:79], v[216:223], v9
    v_exp_f32 v234, v234
    v_exp_f32 v235, v235
    v_exp_f32 v236, v236
    v_smfmac_f32_16x16x64_bf16 v[16:19], v[28:31], v[216:223], v9
    v_exp_f32 v237, v237
    v_exp_f32 v238, v238
    v_exp_f32 v239, v239
    s_sub_u32 s58, s58, 1
    s_cmp_eq_u32 s58, 0
    s_cbranch_scc1 b_last
    s_cmp_eq_u32 s39, 0
    s_cbranch_scc1 b_loop
    s_barrier
    s_branch b_loop
b_last:
    s_waitcnt vmcnt(7)
    v_mfma_f32_32x32x16_bf16 v[192:207], v[80:83], v[32:35], 0
    v_exp_f32 v240, v240
    v_exp_f32 v241, v241
    v_exp_f32 v242, v242
    v_smfmac_f32_32x32x32_bf16 v[160:175], v[72:75], v[224:231], v9
    v_exp_f32 v243, v243
    v_exp_f32 v244, v244
    v_exp_f32 v245, v245
    v_mfma_f32_32x32x16_bf16 v[192:207], v[84:87], v[36:39], v[192:207]
    v_exp_f32 v246, v246
    v_exp_f32 v247, v247
    v_exp_f32 v248, v248
    v_smfmac_f32_16x16x64_bf16 v[20:23], v[28:31], v[224:231], v9
    buffer_load_dwordx4 v[124:127], v1, s[4:7], s56 offen offset:1024 sc1
    v_exp_f32 v249, v249
    v_smfmac_f32_32x32x32_bf16 v[160:175], v[76:79], v[232:239], v9
    v_exp_f32 v250, v250
    v_exp_f32 v251, v251
    v_exp_f32 v252, v252
    v_smfmac_f32_16x16x64_bf16 v[20:23], v[28:31], v[232:239], v9
    v_exp_f32 v253, v253
    v_exp_f32 v254, v254
    v_exp_f32 v255, v255
    v_mfma_f32_32x32x16_bf16 v[208:223], v[80:83], v[40:43], 0
    v_exp_f32 v192, v192
    v_exp_f32 v193, v193
    v_exp_f32 v194, v194
    v_smfmac_f32_32x32x32_bf16 v[176:191], v[72:75], v[240:247], v9
    v_exp_f32 v195, v195
    v_exp_f32 v196, v196
    v_exp_f32 v197, v197
    v_mfma_f32_32x32x16_bf16 v[208:223], v[84:87], v[44:47], v[208:223]
    v_exp_f32 v198, v198
    v_exp_f32 v199, v199
    v_exp_f32 v200, v200
    v_smfmac_f32_16x16x64_bf16 v[24:27], v[28:31], v[240:247], v9
    v_exp_f32 v201, v201
    v_smfmac_f32_32x32x32_bf16 v[176:191], v[76:79], v[248:255], v9
    v_exp_f32 v202, v202
    v_exp_f32 v203, v203
    v_exp_f32 v204, v204
    v_smfmac_f32_16x16x64_bf16 v[24:27], v[28:31], v[248:255], v9
    v_exp_f32 v205, v205
    v_exp_f32 v206, v206
    v_exp_f32 v207, v207
    v_mfma_f32_32x32x16_bf16 v[224:239], v[80:83], v[48:51], 0
    v_exp_f32 v208, v208
    v_exp_f32 v209, v209
    v_exp_f32 v210, v210
    v_smfmac_f32_32x32x32_bf16 v[128:143], v[88:91], v[192:199], v9
    v_exp_f32 v211, v211
    v_exp_f32 v212, v212
    v_exp_f32 v213, v213
    v_mfma_f32_32x32x16_bf16 v[224:239], v[84:87], v[52:55], v[224:239]
    v_exp_f32 v214, v214
    v_exp_f32 v215, v215
    v_exp_f32 v216, v216
    v_smfmac_f32_16x16x64_bf16 v[12:15], v[28:31], v[192:199], v9
    v_exp_f32 v217, v217
    v_smfmac_f32_32x32x32_bf16 v[128:143], v[92:95], v[200:207], v9
    v_exp_f32 v218, v218
    v_exp_f32 v219, v219
    v_exp_f32 v220, v220
    v_smfmac_f32_16x16x64_bf16 v[12:15], v[28:31], v[200:207], v9
    v_exp_f32 v221, v221
    v_exp_f32 v222, v222
    v_exp_f32 v223, v223
    v_mfma_f32_32x32x16_bf16 v[240:255], v[80:83], v[56:59], 0
    v_exp_f32 v224, v224
    v_exp_f32 v225, v225
    v_exp_f32 v226, v226
    v_smfmac_f32_32x32x32_bf16 v[144:159], v[88:91], v[208:215], v9
    v_exp_f32 v227, v227
    v_exp_f32 v228, v228
    v_exp_f32 v229, v229
    v_mfma_f32_32x32x16_bf16 v[240:255], v[84:87], v[60:63], v[240:255]
    v_exp_f32 v230, v230
    v_exp_f32 v231, v231
    v_exp_f32 v232, v232
    v_smfmac_f32_16x16x64_bf16 v[16:19], v[28:31], v[208:215], v9
    v_exp_f32 v233, v233
    v_smfmac_f32_32x32x32_bf16 v[144:159], v[92:95], v[216:223], v9
    v_exp_f32 v234, v234
    v_exp_f32 v235, v235
    v_exp_f32 v236, v236
    v_smfmac_f32_16x16x64_bf16 v[16:19], v[28:31], v[216:223], v9
    v_exp_f32 v237, v237
    v_exp_f32 v238, v238
    v_exp_f32 v239, v239
    s_waitcnt vmcnt(4)
    v_mfma_f32_32x32x16_bf16 v[192:207], v[96:99], v[32:35], 0
    v_exp_f32 v240, v240
    v_exp_f32 v241, v241
    v_exp_f32 v242, v242
    v_smfmac_f32_32x32x32_bf16 v[160:175], v[88:91], v[224:231], v9
    v_exp_f32 v243, v243
    v_exp_f32 v244, v244
    v_exp_f32 v245, v245
    v_mfma_f32_32x32x16_bf16 v[192:207], v[100:103], v[36:39], v[192:207]
    v_exp_f32 v246, v246
    v_exp_f32 v247, v247
    v_exp_f32 v248, v248
    v_smfmac_f32_16x16x64_bf16 v[20:23], v[28:31], v[224:231], v9
    v_exp_f32 v249, v249
    v_smfmac_f32_32x32x32_bf16 v[160:175], v[92:95], v[232:239], v9
    v_exp_f32 v250, v250
    v_exp_f32 v251, v251
    v_exp_f32 v252, v252
    v_smfmac_f32_16x16x64_bf16 v[20:23], v[28:31], v[232:239], v9
    v_exp_f32 v253, v253
    v_exp_f32 v254, v254
    v_exp_f32 v255, v255
    v_mfma_f32_32x32x16_bf16 v[208:223], v[96:99], v[40:43], 0
    v_exp_f32 v192, v192
    v_exp_f32 v193, v193
    v_exp_f32 v194, v194
    v_smfmac_f32_32x32x32_bf16 v[176:191], v[88:91], v[240:247], v9
    v_exp_f32 v195, v195
    v_exp_f32 v196, v196
    v_exp_f32 v197, v197
    v_mfma_f32_32x32x16_bf16 v[208:223], v[100:103], v[44:47], v[208:223]
    v_exp_f32 v198, v198
    v_exp_f32 v199, v199
    v_exp_f32 v200, v200
    v_smfmac_f32_16x16x64_bf16 v[24:27], v[28:31], v[240:247], v9
    v_exp_f32 v201, v201
    v_smfmac_f32_32x32x32_bf16 v[176:191], v[92:95], v[248:255], v9
    v_exp_f32 v202, v202
    v_exp_f32 v203, v203
    v_exp_f32 v204, v204
    v_smfmac_f32_16x16x64_bf16 v[24:27], v[28:31], v[248:255], v9
    v_exp_f32 v205, v205
    v_exp_f32 v206, v206
    v_exp_f32 v207, v207
    v_mfma_f32_32x32x16_bf16 v[224:239], v[96:99], v[48:51], 0
    v_exp_f32 v208, v208
    v_exp_f32 v209, v209
    v_exp_f32 v210, v210
    v_smfmac_f32_32x32x32_bf16 v[128:143], v[104:107], v[192:199], v9
    v_exp_f32 v211, v211
    v_exp_f32 v212, v212
    v_exp_f32 v213, v213
    v_mfma_f32_32x32x16_bf16 v[224:239], v[100:103], v[52:55], v[224:239]
    v_exp_f32 v214, v214
    v_exp_f32 v215, v215
    v_exp_f32 v216, v216
    v_smfmac_f32_16x16x64_bf16 v[12:15], v[28:31], v[192:199], v9
    v_exp_f32 v217, v217
    v_smfmac_f32_32x32x32_bf16 v[128:143], v[108:111], v[200:207], v9
    v_exp_f32 v218, v218
    v_exp_f32 v219, v219
    v_exp_f32 v220, v220
    v_smfmac_f32_16x16x64_bf16 v[12:15], v[28:31], v[200:207], v9
    v_exp_f32 v221, v221
    v_exp_f32 v222, v222
    v_exp_f32 v223, v223
    v_mfma_f32_32x32x16_bf16 v[240:255], v[96:99], v[56:59], 0
    v_exp_f32 v224, v224
    v_exp_f32 v225, v225
    v_exp_f32 v226, v226
    v_smfmac_f32_32x32x32_bf16 v[144:159], v[104:107], v[208:215], v9
    v_exp_f32 v227, v227
    v_exp_f32 v228, v228
    v_exp_f32 v229, v229
    v_mfma_f32_32x32x16_bf16 v[240:255], v[100:103], v[60:63], v[240:255]
    v_exp_f32 v230, v230
    v_exp_f32 v231, v231
    v_exp_f32 v232, v232
    v_smfmac_f32_16x16x64_bf16 v[16:19], v[28:31], v[208:215], v9
    v_exp_f32 v233, v233
    v_smfmac_f32_32x32x32_bf16 v[144:159], v[108:111], v[216:223], v9
    v_exp_f32 v234, v234
    v_exp_f32 v235, v235
    v_exp_f32 v236, v236
    v_smfmac_f32_16x16x64_bf16 v[16:19], v[28:31], v[216:223], v9
    v_exp_f32 v237, v237
    v_exp_f32 v238, v238
    v_exp_f32 v239, v239
    s_waitcnt vmcnt(0)
    v_mfma_f32_32x32x16_bf16 v[192:207], v[112:115], v[32:35], 0
    v_exp_f32 v240, v240
    v_exp_f32 v241, v241
    v_exp_f32 v242, v242
    v_smfmac_f32_32x32x32_bf16 v[160:175], v[104:107], v[224:231], v9
    v_exp_f32 v243, v243
    v_exp_f32 v244, v244
    v_exp_f32 v245, v245
    v_mfma_f32_32x32x16_bf16 v[192:207], v[116:119], v[36:39], v[192:207]
    v_exp_f32 v246, v246
    v_exp_f32 v247, v247
    v_exp_f32 v248, v248
    v_smfmac_f32_16x16x64_bf16 v[20:23], v[28:31], v[224:231], v9
    v_exp_f32 v249, v249
    v_smfmac_f32_32x32x32_bf16 v[160:175], v[108:111], v[232:239], v9
    v_exp_f32 v250, v250
    v_exp_f32 v251, v251
    v_exp_f32 v252, v252
    v_smfmac_f32_16x16x64_bf16 v[20:23], v[28:31], v[232:239], v9
    v_exp_f32 v253, v253
    v_exp_f32 v254, v254
    v_exp_f32 v255, v255
    v_mfma_f32_32x32x16_bf16 v[208:223], v[112:115], v[40:43], 0
    v_exp_f32 v192, v192
    v_exp_f32 v193, v193
    v_exp_f32 v194, v194
    v_smfmac_f32_32x32x32_bf16 v[176:191], v[104:107], v[240:247], v9
    v_exp_f32 v195, v195
    v_exp_f32 v196, v196
    v_exp_f32 v197, v197
    v_mfma_f32_32x32x16_bf16 v[208:223], v[116:119], v[44:47], v[208:223]
    v_exp_f32 v198, v198
    v_exp_f32 v199, v199
    v_exp_f32 v200, v200
    v_smfmac_f32_16x16x64_bf16 v[24:27], v[28:31], v[240:247], v9
    v_exp_f32 v201, v201
    v_smfmac_f32_32x32x32_bf16 v[176:191], v[108:111], v[248:255], v9
    v_exp_f32 v202, v202
    v_exp_f32 v203, v203
    v_exp_f32 v204, v204
    v_smfmac_f32_16x16x64_bf16 v[24:27], v[28:31], v[248:255], v9
    v_exp_f32 v205, v205
    v_exp_f32 v206, v206
    v_exp_f32 v207, v207
    v_mfma_f32_32x32x16_bf16 v[224:239], v[112:115], v[48:51], 0
    v_exp_f32 v208, v208
    v_exp_f32 v209, v209
    v_exp_f32 v210, v210
    v_smfmac_f32_32x32x32_bf16 v[128:143], v[120:123], v[192:199], v9
    v_exp_f32 v211, v211
    v_exp_f32 v212, v212
    v_exp_f32 v213, v213
    v_mfma_f32_32x32x16_bf16 v[224:239], v[116:119], v[52:55], v[224:239]
    v_exp_f32 v214, v214
    v_exp_f32 v215, v215
    v_exp_f32 v216, v216
    v_smfmac_f32_16x16x64_bf16 v[12:15], v[28:31], v[192:199], v9
    v_exp_f32 v217, v217
    v_smfmac_f32_32x32x32_bf16 v[128:143], v[124:127], v[200:207], v9
    v_exp_f32 v218, v218
    v_exp_f32 v219, v219
    v_exp_f32 v220, v220
    v_smfmac_f32_16x16x64_bf16 v[12:15], v[28:31], v[200:207], v9
    v_exp_f32 v221, v221
    v_exp_f32 v222, v222
    v_exp_f32 v223, v223
    v_mfma_f32_32x32x16_bf16 v[240:255], v[112:115], v[56:59], 0
    v_exp_f32 v224, v224
    v_exp_f32 v225, v225
    v_exp_f32 v226, v226
    v_smfmac_f32_32x32x32_bf16 v[144:159], v[120:123], v[208:215], v9
    ds_write_b128 v5, v[128:131] offset:0
    v_exp_f32 v227, v227
    v_exp_f32 v228, v228
    v_exp_f32 v229, v229
    v_mfma_f32_32x32x16_bf16 v[240:255], v[116:119], v[60:63], v[240:255]
    ds_write_b128 v5, v[132:135] offset:1024
    v_exp_f32 v230, v230
    v_exp_f32 v231, v231
    v_exp_f32 v232, v232
    v_smfmac_f32_16x16x64_bf16 v[16:19], v[28:31], v[208:215], v9
    ds_write_b32 v6, v12 offset:0
    v_exp_f32 v233, v233
    v_smfmac_f32_32x32x32_bf16 v[144:159], v[124:127], v[216:223], v9
    ds_write_b128 v5, v[136:139] offset:2048
    v_exp_f32 v234, v234
    v_exp_f32 v235, v235
    v_exp_f32 v236, v236
    v_smfmac_f32_16x16x64_bf16 v[16:19], v[28:31], v[216:223], v9
    ds_write_b128 v5, v[140:143] offset:3072
    v_exp_f32 v237, v237
    v_exp_f32 v238, v238
    v_exp_f32 v239, v239
    v_exp_f32 v240, v240
    v_exp_f32 v241, v241
    v_exp_f32 v242, v242
    v_smfmac_f32_32x32x32_bf16 v[160:175], v[120:123], v[224:231], v9
    ds_write_b128 v5, v[144:147] offset:16384
    v_exp_f32 v243, v243
    v_exp_f32 v244, v244
    v_exp_f32 v245, v245
    ds_write_b128 v5, v[148:151] offset:17408
    v_exp_f32 v246, v246
    v_exp_f32 v247, v247
    v_exp_f32 v248, v248
    v_smfmac_f32_16x16x64_bf16 v[20:23], v[28:31], v[224:231], v9
    ds_write_b32 v6, v16 offset:1024
    v_exp_f32 v249, v249
    v_smfmac_f32_32x32x32_bf16 v[160:175], v[124:127], v[232:239], v9
    ds_write_b128 v5, v[152:155] offset:18432
    v_exp_f32 v250, v250
    v_exp_f32 v251, v251
    v_exp_f32 v252, v252
    v_smfmac_f32_16x16x64_bf16 v[20:23], v[28:31], v[232:239], v9
    ds_write_b128 v5, v[156:159] offset:19456
    v_exp_f32 v253, v253
    v_exp_f32 v254, v254
    v_exp_f32 v255, v255
    v_smfmac_f32_32x32x32_bf16 v[176:191], v[120:123], v[240:247], v9
    s_nop 0
    v_smfmac_f32_32x32x32_bf16 v[176:191], v[124:127], v[248:255], v9
    ds_write_b128 v5, v[160:163] offset:32768
    ds_write_b128 v5, v[164:167] offset:33792
    v_smfmac_f32_16x16x64_bf16 v[24:27], v[28:31], v[240:247], v9
    ds_write_b128 v5, v[168:171] offset:34816
    v_smfmac_f32_16x16x64_bf16 v[24:27], v[28:31], v[248:255], v9
    ds_write_b128 v5, v[172:175] offset:35840
    ds_write_b32 v6, v20 offset:2048
    s_nop 4
    ds_write_b128 v5, v[176:179] offset:49152
    ds_write_b128 v5, v[180:183] offset:50176
    ds_write_b128 v5, v[184:187] offset:51200
    ds_write_b128 v5, v[188:191] offset:52224
    s_nop 0
    ds_write_b32 v6, v24 offset:3072
    s_cmp_eq_u32 s39, 0
    s_cbranch_scc1 s_att_done
    buffer_load_dwordx4 v[224:227], v2, s[4:7], s43 offen offset:0 sc1
    buffer_load_dwordx4 v[228:231], v2, s[4:7], s43 offen offset:256 sc1
    buffer_load_dwordx4 v[232:235], v2, s[4:7], s43 offen offset:2048 sc1
    buffer_load_dwordx4 v[236:239], v2, s[4:7], s43 offen offset:2304 sc1
    s_waitcnt lgkmcnt(0)
    s_barrier
    v_xor_b32 v4, 32, v3
    v_xor_b32 v5, 64, v3
    v_xor_b32 v6, 96, v3
c_wo:
    s_xor_b32 s42, s41, 0
    buffer_load_dwordx4 v[64:67], v2, s[4:7], s42 offen offset:0 sc1
    buffer_load_dwordx4 v[68:71], v2, s[4:7], s42 offen offset:256 sc1
    s_xor_b32 s42, s41, 4096
    buffer_load_dwordx4 v[72:75], v2, s[4:7], s42 offen offset:0 sc1
    buffer_load_dwordx4 v[76:79], v2, s[4:7], s42 offen offset:256 sc1
    s_xor_b32 s42, s41, 8192
    buffer_load_dwordx4 v[80:83], v2, s[4:7], s42 offen offset:0 sc1
    buffer_load_dwordx4 v[84:87], v2, s[4:7], s42 offen offset:256 sc1
    s_xor_b32 s42, s41, 12288
    buffer_load_dwordx4 v[88:91], v2, s[4:7], s42 offen offset:0 sc1
    buffer_load_dwordx4 v[92:95], v2, s[4:7], s42 offen offset:256 sc1
    s_xor_b32 s42, s41, 16384
    buffer_load_dwordx4 v[96:99], v2, s[4:7], s42 offen offset:0 sc1
    buffer_load_dwordx4 v[100:103], v2, s[4:7], s42 offen offset:256 sc1
    ds_read_b64_tr_b16 v[32:33], v3 offset:0
    ds_read_b64_tr_b16 v[34:35], v3 offset:1024
    ds_read_b64_tr_b16 v[36:37], v4 offset:0
    ds_read_b64_tr_b16 v[38:39], v4 offset:1024
    ds_read_b64_tr_b16 v[40:41], v5 offset:0
    ds_read_b64_tr_b16 v[42:43], v5 offset:1024
    ds_read_b64_tr_b16 v[44:45], v6 offset:0
    ds_read_b64_tr_b16 v[46:47], v6 offset:1024
    ds_read_b64_tr_b16 v[48:49], v3 offset:4096
    ds_read_b64_tr_b16 v[50:51], v3 offset:5120
    ds_read_b64_tr_b16 v[52:53], v4 offset:4096
    ds_read_b64_tr_b16 v[54:55], v4 offset:5120
    ds_read_b64_tr_b16 v[56:57], v5 offset:4096
    ds_read_b64_tr_b16 v[58:59], v5 offset:5120
    v_lshrrev_b32 v12, 4, v1
    v_and_b32 v13, 1, v12
    v_lshlrev_b32 v13, 4, v13
    v_mov_b32 v14, 0x3f80
    v_lshlrev_b32 v13, v13, v14
    v_lshrrev_b32 v14, 2, v12
    v_lshrrev_b32 v15, 4, v12
    v_xor_b32 v14, v14, v15
    v_and_b32 v14, 1, v14
    v_bfe_u32 v15, v12, 3, 1
    v_bfe_u32 v16, v12, 1, 1
    v_lshl_add_u32 v15, v15, 1, v16
    v_lshrrev_b32 v16, 5, v12
    v_lshl_add_u32 v15, v16, 2, v15
    v_lshl_add_u32 v15, v14, 3, v15
    v_cmp_eq_u32 vcc, 0, v15
    s_nop 1
    v_cndmask_b32 v240, 0, v13, vcc
    v_cmp_eq_u32 vcc, 1, v15
    s_nop 1
    v_cndmask_b32 v241, 0, v13, vcc
    v_cmp_eq_u32 vcc, 2, v15
    s_nop 1
    v_cndmask_b32 v242, 0, v13, vcc
    v_cmp_eq_u32 vcc, 3, v15
    s_nop 1
    v_cndmask_b32 v243, 0, v13, vcc
    v_cmp_eq_u32 vcc, 4, v15
    s_nop 1
    v_cndmask_b32 v244, 0, v13, vcc
    v_cmp_eq_u32 vcc, 5, v15
    s_nop 1
    v_cndmask_b32 v245, 0, v13, vcc
    v_cmp_eq_u32 vcc, 6, v15
    s_nop 1
    v_cndmask_b32 v246, 0, v13, vcc
    v_cmp_eq_u32 vcc, 7, v15
    s_nop 1
    v_cndmask_b32 v247, 0, v13, vcc
    s_mov_b32 s8, s32
    s_mov_b32 s9, s33
    s_mov_b32 s10, 4194304
    s_mov_b32 s11, 0x00020000
    s_mul_i32 s49, s16, 4608
    s_add_u32 s49, s49, 131072
    v_and_b32 v13, 15, v12
    v_mul_u32_u24 v13, 144, v13
    v_lshrrev_b32 v14, 4, v12
    v_lshl_add_u32 v13, v14, 3, v13
    v_add_u32 v17, s49, v13
    v_lshrrev_b32 v14, 3, v12
    v_and_b32 v15, 7, v12
    v_mul_u32_u24 v16, 144, v14
    v_lshl_add_u32 v16, v15, 4, v16
    v_add_u32 v18, s49, v16
    v_lshlrev_b32 v19, 11, v14
    v_lshl_add_u32 v19, v15, 4, v19
    s_lshl_b32 s50, s38, 16
    s_lshl_b32 s49, s18, 7
    s_add_u32 s50, s50, s49
    s_waitcnt vmcnt(10)
    v_mfma_f32_16x16x32_bf16 v[128:131], v[240:243], v[224:227], 0
    v_mfma_f32_16x16x32_bf16 v[132:135], v[240:243], v[228:231], 0
    v_mfma_f32_16x16x32_bf16 v[136:139], v[244:247], v[224:227], 0
    v_mfma_f32_16x16x32_bf16 v[140:143], v[244:247], v[228:231], 0
    v_mfma_f32_16x16x32_bf16 v[144:147], v[240:243], v[232:235], 0
    v_mfma_f32_16x16x32_bf16 v[148:151], v[240:243], v[236:239], 0
    v_mfma_f32_16x16x32_bf16 v[152:155], v[244:247], v[232:235], 0
    v_mfma_f32_16x16x32_bf16 v[156:159], v[244:247], v[236:239], 0
    s_waitcnt vmcnt(8) lgkmcnt(10)
    v_mfma_f32_16x16x32_bf16 v[128:131], v[32:35], v[64:67], v[128:131]
    ds_read_b64_tr_b16 v[60:61], v6 offset:4096
    s_xor_b32 s42, s41, 20480
    buffer_load_dwordx4 v[104:107], v2, s[4:7], s42 offen offset:0 sc1
    v_mfma_f32_16x16x32_bf16 v[132:135], v[32:35], v[68:71], v[132:135]
    ds_read_b64_tr_b16 v[62:63], v6 offset:5120
    v_mfma_f32_16x16x32_bf16 v[136:139], v[36:39], v[64:67], v[136:139]
    ds_read_b64_tr_b16 v[32:33], v3 offset:8192
    v_mfma_f32_16x16x32_bf16 v[140:143], v[36:39], v[68:71], v[140:143]
    ds_read_b64_tr_b16 v[34:35], v3 offset:9216
    s_waitcnt lgkmcnt(10)
    v_mfma_f32_16x16x32_bf16 v[144:147], v[40:43], v[64:67], v[144:147]
    buffer_load_dwordx4 v[108:111], v2, s[4:7], s42 offen offset:256 sc1
    ds_read_b64_tr_b16 v[36:37], v4 offset:8192
    s_xor_b32 s42, s41, 24576
    v_mfma_f32_16x16x32_bf16 v[148:151], v[40:43], v[68:71], v[148:151]
    ds_read_b64_tr_b16 v[38:39], v4 offset:9216
    v_mfma_f32_16x16x32_bf16 v[152:155], v[44:47], v[64:67], v[152:155]
    ds_read_b64_tr_b16 v[40:41], v5 offset:8192
    v_mfma_f32_16x16x32_bf16 v[156:159], v[44:47], v[68:71], v[156:159]
    ds_read_b64_tr_b16 v[42:43], v5 offset:9216
    s_waitcnt vmcnt(8) lgkmcnt(10)
    v_mfma_f32_16x16x32_bf16 v[128:131], v[48:51], v[72:75], v[128:131]
    buffer_load_dwordx4 v[112:115], v2, s[4:7], s42 offen offset:0 sc1
    ds_read_b64_tr_b16 v[44:45], v6 offset:8192
    v_mfma_f32_16x16x32_bf16 v[132:135], v[48:51], v[76:79], v[132:135]
    ds_read_b64_tr_b16 v[46:47], v6 offset:9216
    v_mfma_f32_16x16x32_bf16 v[136:139], v[52:55], v[72:75], v[136:139]
    ds_read_b64_tr_b16 v[48:49], v3 offset:12288
    v_mfma_f32_16x16x32_bf16 v[140:143], v[52:55], v[76:79], v[140:143]
    ds_read_b64_tr_b16 v[50:51], v3 offset:13312
    s_waitcnt lgkmcnt(10)
    v_mfma_f32_16x16x32_bf16 v[144:147], v[56:59], v[72:75], v[144:147]
    buffer_load_dwordx4 v[116:119], v2, s[4:7], s42 offen offset:256 sc1
    ds_read_b64_tr_b16 v[52:53], v4 offset:12288
    s_xor_b32 s42, s41, 28672
    v_mfma_f32_16x16x32_bf16 v[148:151], v[56:59], v[76:79], v[148:151]
    ds_read_b64_tr_b16 v[54:55], v4 offset:13312
    v_mfma_f32_16x16x32_bf16 v[152:155], v[60:63], v[72:75], v[152:155]
    ds_read_b64_tr_b16 v[56:57], v5 offset:12288
    v_mfma_f32_16x16x32_bf16 v[156:159], v[60:63], v[76:79], v[156:159]
    ds_read_b64_tr_b16 v[58:59], v5 offset:13312
    s_waitcnt vmcnt(8) lgkmcnt(10)
    v_mfma_f32_16x16x32_bf16 v[128:131], v[32:35], v[80:83], v[128:131]
    ds_read_b64_tr_b16 v[60:61], v6 offset:12288
    buffer_load_dwordx4 v[120:123], v2, s[4:7], s42 offen offset:0 sc1
    v_mfma_f32_16x16x32_bf16 v[132:135], v[32:35], v[84:87], v[132:135]
    ds_read_b64_tr_b16 v[62:63], v6 offset:13312
    v_mfma_f32_16x16x32_bf16 v[136:139], v[36:39], v[80:83], v[136:139]
    ds_read_b64_tr_b16 v[32:33], v3 offset:16384
    v_mfma_f32_16x16x32_bf16 v[140:143], v[36:39], v[84:87], v[140:143]
    ds_read_b64_tr_b16 v[34:35], v3 offset:17408
    s_waitcnt lgkmcnt(10)
    v_mfma_f32_16x16x32_bf16 v[144:147], v[40:43], v[80:83], v[144:147]
    buffer_load_dwordx4 v[124:127], v2, s[4:7], s42 offen offset:256 sc1
    ds_read_b64_tr_b16 v[36:37], v4 offset:16384
    s_xor_b32 s42, s41, 32768
    v_mfma_f32_16x16x32_bf16 v[148:151], v[40:43], v[84:87], v[148:151]
    ds_read_b64_tr_b16 v[38:39], v4 offset:17408
    v_mfma_f32_16x16x32_bf16 v[152:155], v[44:47], v[80:83], v[152:155]
    ds_read_b64_tr_b16 v[40:41], v5 offset:16384
    v_mfma_f32_16x16x32_bf16 v[156:159], v[44:47], v[84:87], v[156:159]
    ds_read_b64_tr_b16 v[42:43], v5 offset:17408
    s_waitcnt vmcnt(8) lgkmcnt(10)
    v_mfma_f32_16x16x32_bf16 v[128:131], v[48:51], v[88:91], v[128:131]
    buffer_load_dwordx4 v[160:163], v2, s[4:7], s42 offen offset:0 sc1
    ds_read_b64_tr_b16 v[44:45], v6 offset:16384
    v_mfma_f32_16x16x32_bf16 v[132:135], v[48:51], v[92:95], v[132:135]
    ds_read_b64_tr_b16 v[46:47], v6 offset:17408
    v_mfma_f32_16x16x32_bf16 v[136:139], v[52:55], v[88:91], v[136:139]
    ds_read_b64_tr_b16 v[48:49], v3 offset:20480
    v_mfma_f32_16x16x32_bf16 v[140:143], v[52:55], v[92:95], v[140:143]
    ds_read_b64_tr_b16 v[50:51], v3 offset:21504
    s_waitcnt lgkmcnt(10)
    v_mfma_f32_16x16x32_bf16 v[144:147], v[56:59], v[88:91], v[144:147]
    buffer_load_dwordx4 v[164:167], v2, s[4:7], s42 offen offset:256 sc1
    ds_read_b64_tr_b16 v[52:53], v4 offset:20480
    s_xor_b32 s42, s41, 36864
    v_mfma_f32_16x16x32_bf16 v[148:151], v[56:59], v[92:95], v[148:151]
    ds_read_b64_tr_b16 v[54:55], v4 offset:21504
    v_mfma_f32_16x16x32_bf16 v[152:155], v[60:63], v[88:91], v[152:155]
    ds_read_b64_tr_b16 v[56:57], v5 offset:20480
    v_mfma_f32_16x16x32_bf16 v[156:159], v[60:63], v[92:95], v[156:159]
    ds_read_b64_tr_b16 v[58:59], v5 offset:21504
    s_waitcnt vmcnt(8) lgkmcnt(10)
    v_mfma_f32_16x16x32_bf16 v[128:131], v[32:35], v[96:99], v[128:131]
    ds_read_b64_tr_b16 v[60:61], v6 offset:20480
    buffer_load_dwordx4 v[168:171], v2, s[4:7], s42 offen offset:0 sc1
    v_mfma_f32_16x16x32_bf16 v[132:135], v[32:35], v[100:103], v[132:135]
    ds_read_b64_tr_b16 v[62:63], v6 offset:21504
    v_mfma_f32_16x16x32_bf16 v[136:139], v[36:39], v[96:99], v[136:139]
    ds_read_b64_tr_b16 v[32:33], v3 offset:24576
    v_mfma_f32_16x16x32_bf16 v[140:143], v[36:39], v[100:103], v[140:143]
    ds_read_b64_tr_b16 v[34:35], v3 offset:25600
    s_waitcnt lgkmcnt(10)
    v_mfma_f32_16x16x32_bf16 v[144:147], v[40:43], v[96:99], v[144:147]
    buffer_load_dwordx4 v[172:175], v2, s[4:7], s42 offen offset:256 sc1
    ds_read_b64_tr_b16 v[36:37], v4 offset:24576
    s_xor_b32 s42, s41, 40960
    v_mfma_f32_16x16x32_bf16 v[148:151], v[40:43], v[100:103], v[148:151]
    ds_read_b64_tr_b16 v[38:39], v4 offset:25600
    v_mfma_f32_16x16x32_bf16 v[152:155], v[44:47], v[96:99], v[152:155]
    ds_read_b64_tr_b16 v[40:41], v5 offset:24576
    v_mfma_f32_16x16x32_bf16 v[156:159], v[44:47], v[100:103], v[156:159]
    ds_read_b64_tr_b16 v[42:43], v5 offset:25600
    s_waitcnt vmcnt(8) lgkmcnt(10)
    v_mfma_f32_16x16x32_bf16 v[128:131], v[48:51], v[104:107], v[128:131]
    buffer_load_dwordx4 v[176:179], v2, s[4:7], s42 offen offset:0 sc1
    ds_read_b64_tr_b16 v[44:45], v6 offset:24576
    v_mfma_f32_16x16x32_bf16 v[132:135], v[48:51], v[108:111], v[132:135]
    ds_read_b64_tr_b16 v[46:47], v6 offset:25600
    v_mfma_f32_16x16x32_bf16 v[136:139], v[52:55], v[104:107], v[136:139]
    ds_read_b64_tr_b16 v[48:49], v3 offset:28672
    v_mfma_f32_16x16x32_bf16 v[140:143], v[52:55], v[108:111], v[140:143]
    ds_read_b64_tr_b16 v[50:51], v3 offset:29696
    s_waitcnt lgkmcnt(10)
    v_mfma_f32_16x16x32_bf16 v[144:147], v[56:59], v[104:107], v[144:147]
    buffer_load_dwordx4 v[180:183], v2, s[4:7], s42 offen offset:256 sc1
    ds_read_b64_tr_b16 v[52:53], v4 offset:28672
    s_xor_b32 s42, s41, 45056
    v_mfma_f32_16x16x32_bf16 v[148:151], v[56:59], v[108:111], v[148:151]
    ds_read_b64_tr_b16 v[54:55], v4 offset:29696
    v_mfma_f32_16x16x32_bf16 v[152:155], v[60:63], v[104:107], v[152:155]
    ds_read_b64_tr_b16 v[56:57], v5 offset:28672
    v_mfma_f32_16x16x32_bf16 v[156:159], v[60:63], v[108:111], v[156:159]
    ds_read_b64_tr_b16 v[58:59], v5 offset:29696
    s_waitcnt vmcnt(8) lgkmcnt(10)
    v_mfma_f32_16x16x32_bf16 v[128:131], v[32:35], v[112:115], v[128:131]
    ds_read_b64_tr_b16 v[60:61], v6 offset:28672
    buffer_load_dwordx4 v[184:187], v2, s[4:7], s42 offen offset:0 sc1
    v_mfma_f32_16x16x32_bf16 v[132:135], v[32:35], v[116:119], v[132:135]
    ds_read_b64_tr_b16 v[62:63], v6 offset:29696
    v_mfma_f32_16x16x32_bf16 v[136:139], v[36:39], v[112:115], v[136:139]
    ds_read_b64_tr_b16 v[32:33], v3 offset:32768
    v_mfma_f32_16x16x32_bf16 v[140:143], v[36:39], v[116:119], v[140:143]
    ds_read_b64_tr_b16 v[34:35], v3 offset:33792
    s_waitcnt lgkmcnt(10)
    v_mfma_f32_16x16x32_bf16 v[144:147], v[40:43], v[112:115], v[144:147]
    buffer_load_dwordx4 v[188:191], v2, s[4:7], s42 offen offset:256 sc1
    ds_read_b64_tr_b16 v[36:37], v4 offset:32768
    s_xor_b32 s42, s41, 49152
    v_mfma_f32_16x16x32_bf16 v[148:151], v[40:43], v[116:119], v[148:151]
    ds_read_b64_tr_b16 v[38:39], v4 offset:33792
    v_mfma_f32_16x16x32_bf16 v[152:155], v[44:47], v[112:115], v[152:155]
    ds_read_b64_tr_b16 v[40:41], v5 offset:32768
    v_mfma_f32_16x16x32_bf16 v[156:159], v[44:47], v[116:119], v[156:159]
    ds_read_b64_tr_b16 v[42:43], v5 offset:33792
    s_waitcnt vmcnt(8) lgkmcnt(10)
    v_mfma_f32_16x16x32_bf16 v[128:131], v[48:51], v[120:123], v[128:131]
    buffer_load_dwordx4 v[64:67], v2, s[4:7], s42 offen offset:0 sc1
    ds_read_b64_tr_b16 v[44:45], v6 offset:32768
    v_mfma_f32_16x16x32_bf16 v[132:135], v[48:51], v[124:127], v[132:135]
    ds_read_b64_tr_b16 v[46:47], v6 offset:33792
    v_mfma_f32_16x16x32_bf16 v[136:139], v[52:55], v[120:123], v[136:139]
    ds_read_b64_tr_b16 v[48:49], v3 offset:36864
    v_mfma_f32_16x16x32_bf16 v[140:143], v[52:55], v[124:127], v[140:143]
    ds_read_b64_tr_b16 v[50:51], v3 offset:37888
    s_waitcnt lgkmcnt(10)
    v_mfma_f32_16x16x32_bf16 v[144:147], v[56:59], v[120:123], v[144:147]
    buffer_load_dwordx4 v[68:71], v2, s[4:7], s42 offen offset:256 sc1
    ds_read_b64_tr_b16 v[52:53], v4 offset:36864
    s_xor_b32 s42, s41, 53248
    v_mfma_f32_16x16x32_bf16 v[148:151], v[56:59], v[124:127], v[148:151]
    ds_read_b64_tr_b16 v[54:55], v4 offset:37888
    v_mfma_f32_16x16x32_bf16 v[152:155], v[60:63], v[120:123], v[152:155]
    ds_read_b64_tr_b16 v[56:57], v5 offset:36864
    v_mfma_f32_16x16x32_bf16 v[156:159], v[60:63], v[124:127], v[156:159]
    ds_read_b64_tr_b16 v[58:59], v5 offset:37888
    s_waitcnt vmcnt(8) lgkmcnt(10)
    v_mfma_f32_16x16x32_bf16 v[128:131], v[32:35], v[160:163], v[128:131]
    ds_read_b64_tr_b16 v[60:61], v6 offset:36864
    buffer_load_dwordx4 v[72:75], v2, s[4:7], s42 offen offset:0 sc1
    v_mfma_f32_16x16x32_bf16 v[132:135], v[32:35], v[164:167], v[132:135]
    ds_read_b64_tr_b16 v[62:63], v6 offset:37888
    v_mfma_f32_16x16x32_bf16 v[136:139], v[36:39], v[160:163], v[136:139]
    ds_read_b64_tr_b16 v[32:33], v3 offset:40960
    v_mfma_f32_16x16x32_bf16 v[140:143], v[36:39], v[164:167], v[140:143]
    ds_read_b64_tr_b16 v[34:35], v3 offset:41984
    s_waitcnt lgkmcnt(10)
    v_mfma_f32_16x16x32_bf16 v[144:147], v[40:43], v[160:163], v[144:147]
    buffer_load_dwordx4 v[76:79], v2, s[4:7], s42 offen offset:256 sc1
    ds_read_b64_tr_b16 v[36:37], v4 offset:40960
    s_xor_b32 s42, s41, 57344
    v_mfma_f32_16x16x32_bf16 v[148:151], v[40:43], v[164:167], v[148:151]
    ds_read_b64_tr_b16 v[38:39], v4 offset:41984
    v_mfma_f32_16x16x32_bf16 v[152:155], v[44:47], v[160:163], v[152:155]
    ds_read_b64_tr_b16 v[40:41], v5 offset:40960
    v_mfma_f32_16x16x32_bf16 v[156:159], v[44:47], v[164:167], v[156:159]
    ds_read_b64_tr_b16 v[42:43], v5 offset:41984
    s_waitcnt vmcnt(8) lgkmcnt(10)
    v_mfma_f32_16x16x32_bf16 v[128:131], v[48:51], v[168:171], v[128:131]
    buffer_load_dwordx4 v[80:83], v2, s[4:7], s42 offen offset:0 sc1
    ds_read_b64_tr_b16 v[44:45], v6 offset:40960
    v_mfma_f32_16x16x32_bf16 v[132:135], v[48:51], v[172:175], v[132:135]
    ds_read_b64_tr_b16 v[46:47], v6 offset:41984
    v_mfma_f32_16x16x32_bf16 v[136:139], v[52:55], v[168:171], v[136:139]
    ds_read_b64_tr_b16 v[48:49], v3 offset:45056
    v_mfma_f32_16x16x32_bf16 v[140:143], v[52:55], v[172:175], v[140:143]
    ds_read_b64_tr_b16 v[50:51], v3 offset:46080
    s_waitcnt lgkmcnt(10)
    v_mfma_f32_16x16x32_bf16 v[144:147], v[56:59], v[168:171], v[144:147]
    buffer_load_dwordx4 v[84:87], v2, s[4:7], s42 offen offset:256 sc1
    ds_read_b64_tr_b16 v[52:53], v4 offset:45056
    s_xor_b32 s42, s41, 61440
    v_mfma_f32_16x16x32_bf16 v[148:151], v[56:59], v[172:175], v[148:151]
    ds_read_b64_tr_b16 v[54:55], v4 offset:46080
    v_mfma_f32_16x16x32_bf16 v[152:155], v[60:63], v[168:171], v[152:155]
    ds_read_b64_tr_b16 v[56:57], v5 offset:45056
    v_mfma_f32_16x16x32_bf16 v[156:159], v[60:63], v[172:175], v[156:159]
    ds_read_b64_tr_b16 v[58:59], v5 offset:46080
    s_waitcnt vmcnt(8) lgkmcnt(10)
    v_mfma_f32_16x16x32_bf16 v[128:131], v[32:35], v[176:179], v[128:131]
    ds_read_b64_tr_b16 v[60:61], v6 offset:45056
    buffer_load_dwordx4 v[88:91], v2, s[4:7], s42 offen offset:0 sc1
    v_mfma_f32_16x16x32_bf16 v[132:135], v[32:35], v[180:183], v[132:135]
    ds_read_b64_tr_b16 v[62:63], v6 offset:46080
    s_barrier
    v_mfma_f32_16x16x32_bf16 v[136:139], v[36:39], v[176:179], v[136:139]
    ds_read_b64_tr_b16 v[32:33], v3 offset:49152
    v_mfma_f32_16x16x32_bf16 v[140:143], v[36:39], v[180:183], v[140:143]
    ds_read_b64_tr_b16 v[34:35], v3 offset:50176
    s_waitcnt lgkmcnt(10)
    v_mfma_f32_16x16x32_bf16 v[144:147], v[40:43], v[176:179], v[144:147]
    buffer_load_dwordx4 v[92:95], v2, s[4:7], s42 offen offset:256 sc1
    ds_read_b64_tr_b16 v[36:37], v4 offset:49152
    s_xor_b32 s42, s41, 0
    v_mfma_f32_16x16x32_bf16 v[148:151], v[40:43], v[180:183], v[148:151]
    ds_read_b64_tr_b16 v[38:39], v4 offset:50176
    v_mfma_f32_16x16x32_bf16 v[152:155], v[44:47], v[176:179], v[152:155]
    ds_read_b64_tr_b16 v[40:41], v5 offset:49152
    v_mfma_f32_16x16x32_bf16 v[156:159], v[44:47], v[180:183], v[156:159]
    ds_read_b64_tr_b16 v[42:43], v5 offset:50176
    s_waitcnt vmcnt(8) lgkmcnt(10)
    v_mfma_f32_16x16x32_bf16 v[128:131], v[48:51], v[184:187], v[128:131]
    buffer_load_dwordx4 v[96:99], v2, s[4:7], s42 offen offset:2048 sc1
    ds_read_b64_tr_b16 v[44:45], v6 offset:49152
    v_mfma_f32_16x16x32_bf16 v[132:135], v[48:51], v[188:191], v[132:135]
    ds_read_b64_tr_b16 v[46:47], v6 offset:50176
    v_mfma_f32_16x16x32_bf16 v[136:139], v[52:55], v[184:187], v[136:139]
    ds_read_b64_tr_b16 v[48:49], v3 offset:53248
    v_mfma_f32_16x16x32_bf16 v[140:143], v[52:55], v[188:191], v[140:143]
    ds_read_b64_tr_b16 v[50:51], v3 offset:54272
    s_waitcnt lgkmcnt(10)
    v_mfma_f32_16x16x32_bf16 v[144:147], v[56:59], v[184:187], v[144:147]
    buffer_load_dwordx4 v[100:103], v2, s[4:7], s42 offen offset:2304 sc1
    ds_read_b64_tr_b16 v[52:53], v4 offset:53248
    s_xor_b32 s42, s41, 4096
    v_mfma_f32_16x16x32_bf16 v[148:151], v[56:59], v[188:191], v[148:151]
    ds_read_b64_tr_b16 v[54:55], v4 offset:54272
    v_mfma_f32_16x16x32_bf16 v[152:155], v[60:63], v[184:187], v[152:155]
    ds_read_b64_tr_b16 v[56:57], v5 offset:53248
    v_mfma_f32_16x16x32_bf16 v[156:159], v[60:63], v[188:191], v[156:159]
    ds_read_b64_tr_b16 v[58:59], v5 offset:54272
    s_waitcnt vmcnt(8) lgkmcnt(10)
    v_mfma_f32_16x16x32_bf16 v[128:131], v[32:35], v[64:67], v[128:131]
    ds_read_b64_tr_b16 v[60:61], v6 offset:53248
    buffer_load_dwordx4 v[104:107], v2, s[4:7], s42 offen offset:2048 sc1
    v_mfma_f32_16x16x32_bf16 v[132:135], v[32:35], v[68:71], v[132:135]
    ds_read_b64_tr_b16 v[62:63], v6 offset:54272
    v_mfma_f32_16x16x32_bf16 v[136:139], v[36:39], v[64:67], v[136:139]
    ds_read_b64_tr_b16 v[32:33], v3 offset:57344
    v_mfma_f32_16x16x32_bf16 v[140:143], v[36:39], v[68:71], v[140:143]
    ds_read_b64_tr_b16 v[34:35], v3 offset:58368
    s_waitcnt lgkmcnt(10)
    v_mfma_f32_16x16x32_bf16 v[144:147], v[40:43], v[64:67], v[144:147]
    buffer_load_dwordx4 v[108:111], v2, s[4:7], s42 offen offset:2304 sc1
    ds_read_b64_tr_b16 v[36:37], v4 offset:57344
    s_xor_b32 s42, s41, 8192
    v_mfma_f32_16x16x32_bf16 v[148:151], v[40:43], v[68:71], v[148:151]
    ds_read_b64_tr_b16 v[38:39], v4 offset:58368
    v_mfma_f32_16x16x32_bf16 v[152:155], v[44:47], v[64:67], v[152:155]
    ds_read_b64_tr_b16 v[40:41], v5 offset:57344
    v_mfma_f32_16x16x32_bf16 v[156:159], v[44:47], v[68:71], v[156:159]
    ds_read_b64_tr_b16 v[42:43], v5 offset:58368
    s_waitcnt vmcnt(8) lgkmcnt(10)
    v_mfma_f32_16x16x32_bf16 v[128:131], v[48:51], v[72:75], v[128:131]
    buffer_load_dwordx4 v[112:115], v2, s[4:7], s42 offen offset:2048 sc1
    ds_read_b64_tr_b16 v[44:45], v6 offset:57344
    v_mfma_f32_16x16x32_bf16 v[132:135], v[48:51], v[76:79], v[132:135]
    ds_read_b64_tr_b16 v[46:47], v6 offset:58368
    v_mfma_f32_16x16x32_bf16 v[136:139], v[52:55], v[72:75], v[136:139]
    ds_read_b64_tr_b16 v[48:49], v3 offset:61440
    v_mfma_f32_16x16x32_bf16 v[140:143], v[52:55], v[76:79], v[140:143]
    ds_read_b64_tr_b16 v[50:51], v3 offset:62464
    s_waitcnt lgkmcnt(10)
    v_mfma_f32_16x16x32_bf16 v[144:147], v[56:59], v[72:75], v[144:147]
    buffer_load_dwordx4 v[116:119], v2, s[4:7], s42 offen offset:2304 sc1
    ds_read_b64_tr_b16 v[52:53], v4 offset:61440
    s_xor_b32 s42, s41, 12288
    v_mfma_f32_16x16x32_bf16 v[148:151], v[56:59], v[76:79], v[148:151]
    ds_read_b64_tr_b16 v[54:55], v4 offset:62464
    v_mfma_f32_16x16x32_bf16 v[152:155], v[60:63], v[72:75], v[152:155]
    ds_read_b64_tr_b16 v[56:57], v5 offset:61440
    v_mfma_f32_16x16x32_bf16 v[156:159], v[60:63], v[76:79], v[156:159]
    ds_read_b64_tr_b16 v[58:59], v5 offset:62464
    s_waitcnt vmcnt(8) lgkmcnt(10)
    v_mfma_f32_16x16x32_bf16 v[128:131], v[32:35], v[80:83], v[128:131]
    ds_read_b64_tr_b16 v[60:61], v6 offset:61440
    buffer_load_dwordx4 v[120:123], v2, s[4:7], s42 offen offset:2048 sc1
    v_mfma_f32_16x16x32_bf16 v[132:135], v[32:35], v[84:87], v[132:135]
    ds_read_b64_tr_b16 v[62:63], v6 offset:62464
    v_xor_b32 v3, 0x10000, v3
    v_xor_b32 v4, 0x10000, v4
    v_xor_b32 v5, 0x10000, v5
    v_xor_b32 v6, 0x10000, v6
    v_mfma_f32_16x16x32_bf16 v[136:139], v[36:39], v[80:83], v[136:139]
    ds_read_b64_tr_b16 v[32:33], v3 offset:0
    v_mfma_f32_16x16x32_bf16 v[140:143], v[36:39], v[84:87], v[140:143]
    ds_read_b64_tr_b16 v[34:35], v3 offset:1024
    s_waitcnt lgkmcnt(10)
    v_mfma_f32_16x16x32_bf16 v[144:147], v[40:43], v[80:83], v[144:147]
    buffer_load_dwordx4 v[124:127], v2, s[4:7], s42 offen offset:2304 sc1
    ds_read_b64_tr_b16 v[36:37], v4 offset:0
    s_xor_b32 s42, s41, 16384
    v_mfma_f32_16x16x32_bf16 v[148:151], v[40:43], v[84:87], v[148:151]
    ds_read_b64_tr_b16 v[38:39], v4 offset:1024
    v_mfma_f32_16x16x32_bf16 v[152:155], v[44:47], v[80:83], v[152:155]
    ds_read_b64_tr_b16 v[40:41], v5 offset:0
    v_mfma_f32_16x16x32_bf16 v[156:159], v[44:47], v[84:87], v[156:159]
    ds_read_b64_tr_b16 v[42:43], v5 offset:1024
    s_waitcnt vmcnt(8) lgkmcnt(10)
    v_mfma_f32_16x16x32_bf16 v[128:131], v[48:51], v[88:91], v[128:131]
    buffer_load_dwordx4 v[160:163], v2, s[4:7], s42 offen offset:2048 sc1
    ds_read_b64_tr_b16 v[44:45], v6 offset:0
    v_mfma_f32_16x16x32_bf16 v[132:135], v[48:51], v[92:95], v[132:135]
    ds_read_b64_tr_b16 v[46:47], v6 offset:1024
    v_mfma_f32_16x16x32_bf16 v[136:139], v[52:55], v[88:91], v[136:139]
    ds_read_b64_tr_b16 v[48:49], v3 offset:4096
    v_mfma_f32_16x16x32_bf16 v[140:143], v[52:55], v[92:95], v[140:143]
    ds_read_b64_tr_b16 v[50:51], v3 offset:5120
    s_waitcnt lgkmcnt(10)
    v_mfma_f32_16x16x32_bf16 v[144:147], v[56:59], v[88:91], v[144:147]
    buffer_load_dwordx4 v[164:167], v2, s[4:7], s42 offen offset:2304 sc1
    ds_read_b64_tr_b16 v[52:53], v4 offset:4096
    s_xor_b32 s42, s41, 20480
    v_mfma_f32_16x16x32_bf16 v[148:151], v[56:59], v[92:95], v[148:151]
    ds_read_b64_tr_b16 v[54:55], v4 offset:5120
    v_mfma_f32_16x16x32_bf16 v[152:155], v[60:63], v[88:91], v[152:155]
    ds_read_b64_tr_b16 v[56:57], v5 offset:4096
    v_mfma_f32_16x16x32_bf16 v[156:159], v[60:63], v[92:95], v[156:159]
    ds_read_b64_tr_b16 v[58:59], v5 offset:5120
    s_waitcnt vmcnt(8) lgkmcnt(10)
    v_mfma_f32_16x16x32_bf16 v[128:131], v[32:35], v[96:99], v[128:131]
    ds_read_b64_tr_b16 v[60:61], v6 offset:4096
    buffer_load_dwordx4 v[168:171], v2, s[4:7], s42 offen offset:2048 sc1
    v_mfma_f32_16x16x32_bf16 v[132:135], v[32:35], v[100:103], v[132:135]
    ds_read_b64_tr_b16 v[62:63], v6 offset:5120
    v_mfma_f32_16x16x32_bf16 v[136:139], v[36:39], v[96:99], v[136:139]
    ds_read_b64_tr_b16 v[32:33], v3 offset:8192
    v_mfma_f32_16x16x32_bf16 v[140:143], v[36:39], v[100:103], v[140:143]
    ds_read_b64_tr_b16 v[34:35], v3 offset:9216
    s_waitcnt lgkmcnt(10)
    v_mfma_f32_16x16x32_bf16 v[144:147], v[40:43], v[96:99], v[144:147]
    buffer_load_dwordx4 v[172:175], v2, s[4:7], s42 offen offset:2304 sc1
    ds_read_b64_tr_b16 v[36:37], v4 offset:8192
    s_xor_b32 s42, s41, 24576
    v_mfma_f32_16x16x32_bf16 v[148:151], v[40:43], v[100:103], v[148:151]
    ds_read_b64_tr_b16 v[38:39], v4 offset:9216
    v_mfma_f32_16x16x32_bf16 v[152:155], v[44:47], v[96:99], v[152:155]
    ds_read_b64_tr_b16 v[40:41], v5 offset:8192
    v_mfma_f32_16x16x32_bf16 v[156:159], v[44:47], v[100:103], v[156:159]
    ds_read_b64_tr_b16 v[42:43], v5 offset:9216
    s_waitcnt vmcnt(8) lgkmcnt(10)
    v_mfma_f32_16x16x32_bf16 v[128:131], v[48:51], v[104:107], v[128:131]
    buffer_load_dwordx4 v[176:179], v2, s[4:7], s42 offen offset:2048 sc1
    ds_read_b64_tr_b16 v[44:45], v6 offset:8192
    v_mfma_f32_16x16x32_bf16 v[132:135], v[48:51], v[108:111], v[132:135]
    ds_read_b64_tr_b16 v[46:47], v6 offset:9216
    v_mfma_f32_16x16x32_bf16 v[136:139], v[52:55], v[104:107], v[136:139]
    ds_read_b64_tr_b16 v[48:49], v3 offset:12288
    v_mfma_f32_16x16x32_bf16 v[140:143], v[52:55], v[108:111], v[140:143]
    ds_read_b64_tr_b16 v[50:51], v3 offset:13312
    s_waitcnt lgkmcnt(10)
    v_mfma_f32_16x16x32_bf16 v[144:147], v[56:59], v[104:107], v[144:147]
    buffer_load_dwordx4 v[180:183], v2, s[4:7], s42 offen offset:2304 sc1
    ds_read_b64_tr_b16 v[52:53], v4 offset:12288
    s_xor_b32 s42, s41, 28672
    v_mfma_f32_16x16x32_bf16 v[148:151], v[56:59], v[108:111], v[148:151]
    ds_read_b64_tr_b16 v[54:55], v4 offset:13312
    v_mfma_f32_16x16x32_bf16 v[152:155], v[60:63], v[104:107], v[152:155]
    ds_read_b64_tr_b16 v[56:57], v5 offset:12288
    v_mfma_f32_16x16x32_bf16 v[156:159], v[60:63], v[108:111], v[156:159]
    ds_read_b64_tr_b16 v[58:59], v5 offset:13312
    s_waitcnt vmcnt(8) lgkmcnt(10)
    v_mfma_f32_16x16x32_bf16 v[128:131], v[32:35], v[112:115], v[128:131]
    ds_read_b64_tr_b16 v[60:61], v6 offset:12288
    buffer_load_dwordx4 v[184:187], v2, s[4:7], s42 offen offset:2048 sc1
    v_mfma_f32_16x16x32_bf16 v[132:135], v[32:35], v[116:119], v[132:135]
    ds_read_b64_tr_b16 v[62:63], v6 offset:13312
    v_mfma_f32_16x16x32_bf16 v[136:139], v[36:39], v[112:115], v[136:139]
    ds_read_b64_tr_b16 v[32:33], v3 offset:16384
    v_mfma_f32_16x16x32_bf16 v[140:143], v[36:39], v[116:119], v[140:143]
    ds_read_b64_tr_b16 v[34:35], v3 offset:17408
    s_waitcnt lgkmcnt(10)
    v_mfma_f32_16x16x32_bf16 v[144:147], v[40:43], v[112:115], v[144:147]
    buffer_load_dwordx4 v[188:191], v2, s[4:7], s42 offen offset:2304 sc1
    ds_read_b64_tr_b16 v[36:37], v4 offset:16384
    s_xor_b32 s42, s41, 32768
    v_mfma_f32_16x16x32_bf16 v[148:151], v[40:43], v[116:119], v[148:151]
    ds_read_b64_tr_b16 v[38:39], v4 offset:17408
    v_mfma_f32_16x16x32_bf16 v[152:155], v[44:47], v[112:115], v[152:155]
    ds_read_b64_tr_b16 v[40:41], v5 offset:16384
    v_mfma_f32_16x16x32_bf16 v[156:159], v[44:47], v[116:119], v[156:159]
    ds_read_b64_tr_b16 v[42:43], v5 offset:17408
    s_waitcnt vmcnt(8) lgkmcnt(10)
    v_mfma_f32_16x16x32_bf16 v[128:131], v[48:51], v[120:123], v[128:131]
    buffer_load_dwordx4 v[64:67], v2, s[4:7], s42 offen offset:2048 sc1
    ds_read_b64_tr_b16 v[44:45], v6 offset:16384
    v_mfma_f32_16x16x32_bf16 v[132:135], v[48:51], v[124:127], v[132:135]
    ds_read_b64_tr_b16 v[46:47], v6 offset:17408
    v_mfma_f32_16x16x32_bf16 v[136:139], v[52:55], v[120:123], v[136:139]
    ds_read_b64_tr_b16 v[48:49], v3 offset:20480
    v_mfma_f32_16x16x32_bf16 v[140:143], v[52:55], v[124:127], v[140:143]
    ds_read_b64_tr_b16 v[50:51], v3 offset:21504
    s_waitcnt lgkmcnt(10)
    v_mfma_f32_16x16x32_bf16 v[144:147], v[56:59], v[120:123], v[144:147]
    buffer_load_dwordx4 v[68:71], v2, s[4:7], s42 offen offset:2304 sc1
    ds_read_b64_tr_b16 v[52:53], v4 offset:20480
    s_xor_b32 s42, s41, 36864
    v_mfma_f32_16x16x32_bf16 v[148:151], v[56:59], v[124:127], v[148:151]
    ds_read_b64_tr_b16 v[54:55], v4 offset:21504
    v_mfma_f32_16x16x32_bf16 v[152:155], v[60:63], v[120:123], v[152:155]
    ds_read_b64_tr_b16 v[56:57], v5 offset:20480
    v_mfma_f32_16x16x32_bf16 v[156:159], v[60:63], v[124:127], v[156:159]
    ds_read_b64_tr_b16 v[58:59], v5 offset:21504
    s_waitcnt vmcnt(8) lgkmcnt(10)
    v_mfma_f32_16x16x32_bf16 v[128:131], v[32:35], v[160:163], v[128:131]
    ds_read_b64_tr_b16 v[60:61], v6 offset:20480
    buffer_load_dwordx4 v[72:75], v2, s[4:7], s42 offen offset:2048 sc1
    v_mfma_f32_16x16x32_bf16 v[132:135], v[32:35], v[164:167], v[132:135]
    ds_read_b64_tr_b16 v[62:63], v6 offset:21504
    v_mfma_f32_16x16x32_bf16 v[136:139], v[36:39], v[160:163], v[136:139]
    ds_read_b64_tr_b16 v[32:33], v3 offset:24576
    v_mfma_f32_16x16x32_bf16 v[140:143], v[36:39], v[164:167], v[140:143]
    ds_read_b64_tr_b16 v[34:35], v3 offset:25600
    s_waitcnt lgkmcnt(10)
    v_mfma_f32_16x16x32_bf16 v[144:147], v[40:43], v[160:163], v[144:147]
    buffer_load_dwordx4 v[76:79], v2, s[4:7], s42 offen offset:2304 sc1
    ds_read_b64_tr_b16 v[36:37], v4 offset:24576
    s_xor_b32 s42, s41, 40960
    v_mfma_f32_16x16x32_bf16 v[148:151], v[40:43], v[164:167], v[148:151]
    ds_read_b64_tr_b16 v[38:39], v4 offset:25600
    v_mfma_f32_16x16x32_bf16 v[152:155], v[44:47], v[160:163], v[152:155]
    ds_read_b64_tr_b16 v[40:41], v5 offset:24576
    v_mfma_f32_16x16x32_bf16 v[156:159], v[44:47], v[164:167], v[156:159]
    ds_read_b64_tr_b16 v[42:43], v5 offset:25600
    s_waitcnt vmcnt(8) lgkmcnt(10)
    v_mfma_f32_16x16x32_bf16 v[128:131], v[48:51], v[168:171], v[128:131]
    buffer_load_dwordx4 v[80:83], v2, s[4:7], s42 offen offset:2048 sc1
    ds_read_b64_tr_b16 v[44:45], v6 offset:24576
    v_mfma_f32_16x16x32_bf16 v[132:135], v[48:51], v[172:175], v[132:135]
    ds_read_b64_tr_b16 v[46:47], v6 offset:25600
    v_mfma_f32_16x16x32_bf16 v[136:139], v[52:55], v[168:171], v[136:139]
    ds_read_b64_tr_b16 v[48:49], v3 offset:28672
    v_mfma_f32_16x16x32_bf16 v[140:143], v[52:55], v[172:175], v[140:143]
    ds_read_b64_tr_b16 v[50:51], v3 offset:29696
    s_waitcnt lgkmcnt(10)
    v_mfma_f32_16x16x32_bf16 v[144:147], v[56:59], v[168:171], v[144:147]
    buffer_load_dwordx4 v[84:87], v2, s[4:7], s42 offen offset:2304 sc1
    ds_read_b64_tr_b16 v[52:53], v4 offset:28672
    s_xor_b32 s42, s41, 45056
    v_mfma_f32_16x16x32_bf16 v[148:151], v[56:59], v[172:175], v[148:151]
    ds_read_b64_tr_b16 v[54:55], v4 offset:29696
    v_mfma_f32_16x16x32_bf16 v[152:155], v[60:63], v[168:171], v[152:155]
    ds_read_b64_tr_b16 v[56:57], v5 offset:28672
    v_mfma_f32_16x16x32_bf16 v[156:159], v[60:63], v[172:175], v[156:159]
    ds_read_b64_tr_b16 v[58:59], v5 offset:29696
    s_waitcnt vmcnt(8) lgkmcnt(10)
    v_mfma_f32_16x16x32_bf16 v[128:131], v[32:35], v[176:179], v[128:131]
    ds_read_b64_tr_b16 v[60:61], v6 offset:28672
    buffer_load_dwordx4 v[88:91], v2, s[4:7], s42 offen offset:2048 sc1
    v_mfma_f32_16x16x32_bf16 v[132:135], v[32:35], v[180:183], v[132:135]
    ds_read_b64_tr_b16 v[62:63], v6 offset:29696
    v_mfma_f32_16x16x32_bf16 v[136:139], v[36:39], v[176:179], v[136:139]
    ds_read_b64_tr_b16 v[32:33], v3 offset:32768
    v_mfma_f32_16x16x32_bf16 v[140:143], v[36:39], v[180:183], v[140:143]
    ds_read_b64_tr_b16 v[34:35], v3 offset:33792
    s_waitcnt lgkmcnt(10)
    v_mfma_f32_16x16x32_bf16 v[144:147], v[40:43], v[176:179], v[144:147]
    buffer_load_dwordx4 v[92:95], v2, s[4:7], s42 offen offset:2304 sc1
    ds_read_b64_tr_b16 v[36:37], v4 offset:32768
    s_xor_b32 s42, s41, 49152
    v_mfma_f32_16x16x32_bf16 v[148:151], v[40:43], v[180:183], v[148:151]
    ds_read_b64_tr_b16 v[38:39], v4 offset:33792
    v_mfma_f32_16x16x32_bf16 v[152:155], v[44:47], v[176:179], v[152:155]
    ds_read_b64_tr_b16 v[40:41], v5 offset:32768
    v_mfma_f32_16x16x32_bf16 v[156:159], v[44:47], v[180:183], v[156:159]
    ds_read_b64_tr_b16 v[42:43], v5 offset:33792
    s_waitcnt vmcnt(8) lgkmcnt(10)
    v_mfma_f32_16x16x32_bf16 v[128:131], v[48:51], v[184:187], v[128:131]
    buffer_load_dwordx4 v[96:99], v2, s[4:7], s42 offen offset:2048 sc1
    ds_read_b64_tr_b16 v[44:45], v6 offset:32768
    v_mfma_f32_16x16x32_bf16 v[132:135], v[48:51], v[188:191], v[132:135]
    ds_read_b64_tr_b16 v[46:47], v6 offset:33792
    v_mfma_f32_16x16x32_bf16 v[136:139], v[52:55], v[184:187], v[136:139]
    ds_read_b64_tr_b16 v[48:49], v3 offset:36864
    v_mfma_f32_16x16x32_bf16 v[140:143], v[52:55], v[188:191], v[140:143]
    ds_read_b64_tr_b16 v[50:51], v3 offset:37888
    s_waitcnt lgkmcnt(10)
    v_mfma_f32_16x16x32_bf16 v[144:147], v[56:59], v[184:187], v[144:147]
    buffer_load_dwordx4 v[100:103], v2, s[4:7], s42 offen offset:2304 sc1
    ds_read_b64_tr_b16 v[52:53], v4 offset:36864
    s_xor_b32 s42, s41, 53248
    v_mfma_f32_16x16x32_bf16 v[148:151], v[56:59], v[188:191], v[148:151]
    ds_read_b64_tr_b16 v[54:55], v4 offset:37888
    v_mfma_f32_16x16x32_bf16 v[152:155], v[60:63], v[184:187], v[152:155]
    ds_read_b64_tr_b16 v[56:57], v5 offset:36864
    v_mfma_f32_16x16x32_bf16 v[156:159], v[60:63], v[188:191], v[156:159]
    ds_read_b64_tr_b16 v[58:59], v5 offset:37888
    s_waitcnt vmcnt(8) lgkmcnt(10)
    v_mfma_f32_16x16x32_bf16 v[128:131], v[32:35], v[64:67], v[128:131]
    ds_read_b64_tr_b16 v[60:61], v6 offset:36864
    buffer_load_dwordx4 v[104:107], v2, s[4:7], s42 offen offset:2048 sc1
    v_mfma_f32_16x16x32_bf16 v[132:135], v[32:35], v[68:71], v[132:135]
    ds_read_b64_tr_b16 v[62:63], v6 offset:37888
    v_mfma_f32_16x16x32_bf16 v[136:139], v[36:39], v[64:67], v[136:139]
    ds_read_b64_tr_b16 v[32:33], v3 offset:40960
    v_mfma_f32_16x16x32_bf16 v[140:143], v[36:39], v[68:71], v[140:143]
    ds_read_b64_tr_b16 v[34:35], v3 offset:41984
    s_waitcnt lgkmcnt(10)
    v_mfma_f32_16x16x32_bf16 v[144:147], v[40:43], v[64:67], v[144:147]
    buffer_load_dwordx4 v[108:111], v2, s[4:7], s42 offen offset:2304 sc1
    ds_read_b64_tr_b16 v[36:37], v4 offset:40960
    s_xor_b32 s42, s41, 57344
    v_mfma_f32_16x16x32_bf16 v[148:151], v[40:43], v[68:71], v[148:151]
    ds_read_b64_tr_b16 v[38:39], v4 offset:41984
    v_mfma_f32_16x16x32_bf16 v[152:155], v[44:47], v[64:67], v[152:155]
    ds_read_b64_tr_b16 v[40:41], v5 offset:40960
    v_mfma_f32_16x16x32_bf16 v[156:159], v[44:47], v[68:71], v[156:159]
    ds_read_b64_tr_b16 v[42:43], v5 offset:41984
    s_waitcnt vmcnt(8) lgkmcnt(10)
    v_mfma_f32_16x16x32_bf16 v[128:131], v[48:51], v[72:75], v[128:131]
    buffer_load_dwordx4 v[112:115], v2, s[4:7], s42 offen offset:2048 sc1
    ds_read_b64_tr_b16 v[44:45], v6 offset:40960
    v_mfma_f32_16x16x32_bf16 v[132:135], v[48:51], v[76:79], v[132:135]
    ds_read_b64_tr_b16 v[46:47], v6 offset:41984
    v_mfma_f32_16x16x32_bf16 v[136:139], v[52:55], v[72:75], v[136:139]
    ds_read_b64_tr_b16 v[48:49], v3 offset:45056
    v_mfma_f32_16x16x32_bf16 v[140:143], v[52:55], v[76:79], v[140:143]
    ds_read_b64_tr_b16 v[50:51], v3 offset:46080
    s_waitcnt lgkmcnt(10)
    v_mfma_f32_16x16x32_bf16 v[144:147], v[56:59], v[72:75], v[144:147]
    buffer_load_dwordx4 v[116:119], v2, s[4:7], s42 offen offset:2304 sc1
    ds_read_b64_tr_b16 v[52:53], v4 offset:45056
    s_xor_b32 s42, s41, 61440
    v_mfma_f32_16x16x32_bf16 v[148:151], v[56:59], v[76:79], v[148:151]
    ds_read_b64_tr_b16 v[54:55], v4 offset:46080
    v_mfma_f32_16x16x32_bf16 v[152:155], v[60:63], v[72:75], v[152:155]
    ds_read_b64_tr_b16 v[56:57], v5 offset:45056
    v_mfma_f32_16x16x32_bf16 v[156:159], v[60:63], v[76:79], v[156:159]
    ds_read_b64_tr_b16 v[58:59], v5 offset:46080
    s_waitcnt vmcnt(8) lgkmcnt(10)
    v_mfma_f32_16x16x32_bf16 v[128:131], v[32:35], v[80:83], v[128:131]
    ds_read_b64_tr_b16 v[60:61], v6 offset:45056
    buffer_load_dwordx4 v[120:123], v2, s[4:7], s42 offen offset:2048 sc1
    v_mfma_f32_16x16x32_bf16 v[132:135], v[32:35], v[84:87], v[132:135]
    ds_read_b64_tr_b16 v[62:63], v6 offset:46080
    v_mfma_f32_16x16x32_bf16 v[136:139], v[36:39], v[80:83], v[136:139]
    ds_read_b64_tr_b16 v[32:33], v3 offset:49152
    v_mfma_f32_16x16x32_bf16 v[140:143], v[36:39], v[84:87], v[140:143]
    ds_read_b64_tr_b16 v[34:35], v3 offset:50176
    s_waitcnt lgkmcnt(10)
    v_mfma_f32_16x16x32_bf16 v[144:147], v[40:43], v[80:83], v[144:147]
    buffer_load_dwordx4 v[124:127], v2, s[4:7], s42 offen offset:2304 sc1
    ds_read_b64_tr_b16 v[36:37], v4 offset:49152
    v_mfma_f32_16x16x32_bf16 v[148:151], v[40:43], v[84:87], v[148:151]
    ds_read_b64_tr_b16 v[38:39], v4 offset:50176
    v_mfma_f32_16x16x32_bf16 v[152:155], v[44:47], v[80:83], v[152:155]
    ds_read_b64_tr_b16 v[40:41], v5 offset:49152
    v_mfma_f32_16x16x32_bf16 v[156:159], v[44:47], v[84:87], v[156:159]
    ds_read_b64_tr_b16 v[42:43], v5 offset:50176
    s_waitcnt vmcnt(8) lgkmcnt(10)
    v_mfma_f32_16x16x32_bf16 v[128:131], v[48:51], v[88:91], v[128:131]
    ds_read_b64_tr_b16 v[44:45], v6 offset:49152
    v_mfma_f32_16x16x32_bf16 v[132:135], v[48:51], v[92:95], v[132:135]
    ds_read_b64_tr_b16 v[46:47], v6 offset:50176
    v_mfma_f32_16x16x32_bf16 v[136:139], v[52:55], v[88:91], v[136:139]
    ds_read_b64_tr_b16 v[48:49], v3 offset:53248
    v_mfma_f32_16x16x32_bf16 v[140:143], v[52:55], v[92:95], v[140:143]
    ds_read_b64_tr_b16 v[50:51], v3 offset:54272
    s_waitcnt lgkmcnt(10)
    v_mfma_f32_16x16x32_bf16 v[144:147], v[56:59], v[88:91], v[144:147]
    ds_read_b64_tr_b16 v[52:53], v4 offset:53248
    v_mfma_f32_16x16x32_bf16 v[148:151], v[56:59], v[92:95], v[148:151]
    ds_read_b64_tr_b16 v[54:55], v4 offset:54272
    v_mfma_f32_16x16x32_bf16 v[152:155], v[60:63], v[88:91], v[152:155]
    ds_read_b64_tr_b16 v[56:57], v5 offset:53248
    v_mfma_f32_16x16x32_bf16 v[156:159], v[60:63], v[92:95], v[156:159]
    ds_read_b64_tr_b16 v[58:59], v5 offset:54272
    s_waitcnt vmcnt(6) lgkmcnt(10)
    v_mfma_f32_16x16x32_bf16 v[128:131], v[32:35], v[96:99], v[128:131]
    ds_read_b64_tr_b16 v[60:61], v6 offset:53248
    v_mfma_f32_16x16x32_bf16 v[132:135], v[32:35], v[100:103], v[132:135]
    ds_read_b64_tr_b16 v[62:63], v6 offset:54272
    v_mfma_f32_16x16x32_bf16 v[136:139], v[36:39], v[96:99], v[136:139]
    ds_read_b64_tr_b16 v[32:33], v3 offset:57344
    v_mfma_f32_16x16x32_bf16 v[140:143], v[36:39], v[100:103], v[140:143]
    ds_read_b64_tr_b16 v[34:35], v3 offset:58368
    s_waitcnt lgkmcnt(10)
    v_mfma_f32_16x16x32_bf16 v[144:147], v[40:43], v[96:99], v[144:147]
    ds_read_b64_tr_b16 v[36:37], v4 offset:57344
    v_mfma_f32_16x16x32_bf16 v[148:151], v[40:43], v[100:103], v[148:151]
    ds_read_b64_tr_b16 v[38:39], v4 offset:58368
    v_mfma_f32_16x16x32_bf16 v[152:155], v[44:47], v[96:99], v[152:155]
    ds_read_b64_tr_b16 v[40:41], v5 offset:57344
    v_mfma_f32_16x16x32_bf16 v[156:159], v[44:47], v[100:103], v[156:159]
    ds_read_b64_tr_b16 v[42:43], v5 offset:58368
    s_waitcnt vmcnt(4) lgkmcnt(10)
    v_mfma_f32_16x16x32_bf16 v[128:131], v[48:51], v[104:107], v[128:131]
    ds_read_b64_tr_b16 v[44:45], v6 offset:57344
    v_mfma_f32_16x16x32_bf16 v[132:135], v[48:51], v[108:111], v[132:135]
    ds_read_b64_tr_b16 v[46:47], v6 offset:58368
    v_mfma_f32_16x16x32_bf16 v[136:139], v[52:55], v[104:107], v[136:139]
    ds_read_b64_tr_b16 v[48:49], v3 offset:61440
    v_mfma_f32_16x16x32_bf16 v[140:143], v[52:55], v[108:111], v[140:143]
    ds_read_b64_tr_b16 v[50:51], v3 offset:62464
    s_waitcnt lgkmcnt(10)
    v_mfma_f32_16x16x32_bf16 v[144:147], v[56:59], v[104:107], v[144:147]
    ds_read_b64_tr_b16 v[52:53], v4 offset:61440
    v_mfma_f32_16x16x32_bf16 v[148:151], v[56:59], v[108:111], v[148:151]
    ds_read_b64_tr_b16 v[54:55], v4 offset:62464
    v_mfma_f32_16x16x32_bf16 v[152:155], v[60:63], v[104:107], v[152:155]
    ds_read_b64_tr_b16 v[56:57], v5 offset:61440
    v_mfma_f32_16x16x32_bf16 v[156:159], v[60:63], v[108:111], v[156:159]
    ds_read_b64_tr_b16 v[58:59], v5 offset:62464
    s_waitcnt vmcnt(2) lgkmcnt(10)
    v_mfma_f32_16x16x32_bf16 v[128:131], v[32:35], v[112:115], v[128:131]
    ds_read_b64_tr_b16 v[60:61], v6 offset:61440
    ds_read_b64_tr_b16 v[62:63], v6 offset:62464
    v_mfma_f32_16x16x32_bf16 v[136:139], v[36:39], v[112:115], v[136:139]
    v_xor_b32 v3, 0x10000, v3
    s_waitcnt lgkmcnt(8)
    v_mfma_f32_16x16x32_bf16 v[144:147], v[40:43], v[112:115], v[144:147]
    v_xor_b32 v4, 0x10000, v4
    v_mfma_f32_16x16x32_bf16 v[152:155], v[44:47], v[112:115], v[152:155]
    v_xor_b32 v5, 0x10000, v5
    s_waitcnt vmcnt(0) lgkmcnt(4)
    v_mfma_f32_16x16x32_bf16 v[128:131], v[48:51], v[120:123], v[128:131]
    v_xor_b32 v6, 0x10000, v6
    v_mfma_f32_16x16x32_bf16 v[136:139], v[52:55], v[120:123], v[136:139]
    s_waitcnt lgkmcnt(0)
    v_mfma_f32_16x16x32_bf16 v[144:147], v[56:59], v[120:123], v[144:147]
    v_mfma_f32_16x16x32_bf16 v[152:155], v[60:63], v[120:123], v[152:155]
    s_cmp_eq_u32 s21, 3
    s_cbranch_scc1 c_final
    s_barrier
    s_add_u32 s43, s43, 4194304
    v_mfma_f32_16x16x32_bf16 v[132:135], v[32:35], v[116:119], v[132:135]
    v_mfma_f32_16x16x32_bf16 v[140:143], v[36:39], v[116:119], v[140:143]
    v_mfma_f32_16x16x32_bf16 v[148:151], v[40:43], v[116:119], v[148:151]
    v_cvt_pk_bf16_f32 v160, v128, v129
    v_cvt_pk_bf16_f32 v161, v130, v131
    v_cvt_pk_bf16_f32 v162, v136, v137
    v_mfma_f32_16x16x32_bf16 v[156:159], v[44:47], v[116:119], v[156:159]
    v_cvt_pk_bf16_f32 v163, v138, v139
    v_cvt_pk_bf16_f32 v168, v144, v145
    v_cvt_pk_bf16_f32 v169, v146, v147
    v_mfma_f32_16x16x32_bf16 v[132:135], v[48:51], v[124:127], v[132:135]
    v_cvt_pk_bf16_f32 v170, v152, v153
    v_cvt_pk_bf16_f32 v171, v154, v155
    v_permlane32_swap_b32 v160, v162
    v_mfma_f32_16x16x32_bf16 v[140:143], v[52:55], v[124:127], v[140:143]
    v_permlane32_swap_b32 v161, v163
    buffer_store_dwordx4 v[160:163], v2, s[4:7], s43 offen offset:0 sc1
    v_permlane32_swap_b32 v168, v170
    v_mfma_f32_16x16x32_bf16 v[148:151], v[56:59], v[124:127], v[148:151]
    v_permlane32_swap_b32 v169, v171
    buffer_store_dwordx4 v[168:171], v2, s[4:7], s43 offen offset:2048 sc1
    v_mfma_f32_16x16x32_bf16 v[156:159], v[60:63], v[124:127], v[156:159]
    v_cvt_pk_bf16_f32 v164, v132, v133
    v_cvt_pk_bf16_f32 v165, v134, v135
    v_cvt_pk_bf16_f32 v166, v140, v141
    v_cvt_pk_bf16_f32 v167, v142, v143
    s_nop 0
    v_cvt_pk_bf16_f32 v172, v148, v149
    v_cvt_pk_bf16_f32 v173, v150, v151
    s_nop 0
    v_cvt_pk_bf16_f32 v174, v156, v157
    v_cvt_pk_bf16_f32 v175, v158, v159
    v_permlane32_swap_b32 v164, v166
    v_permlane32_swap_b32 v165, v167
    buffer_store_dwordx4 v[164:167], v2, s[4:7], s43 offen offset:256 sc1
    v_permlane32_swap_b32 v172, v174
    v_permlane32_swap_b32 v173, v175
    buffer_store_dwordx4 v[172:175], v2, s[4:7], s43 offen offset:2304 sc1
    s_add_u32 s21, s21, 1
    v_mov_b32 v22, 0x3f803f80
    v_dot2_f32_bf16 v24, v160, v22, 0
    v_dot2_f32_bf16 v25, v160, v160, 0
    v_dot2_f32_bf16 v26, v164, v22, 0
    v_dot2_f32_bf16 v27, v164, v164, 0
    v_dot2_f32_bf16 v24, v161, v22, v24
    v_dot2_f32_bf16 v25, v161, v161, v25
    v_dot2_f32_bf16 v26, v165, v22, v26
    v_dot2_f32_bf16 v27, v165, v165, v27
    v_dot2_f32_bf16 v24, v162, v22, v24
    v_dot2_f32_bf16 v25, v162, v162, v25
    v_dot2_f32_bf16 v26, v166, v22, v26
    v_dot2_f32_bf16 v27, v166, v166, v27
    v_dot2_f32_bf16 v24, v163, v22, v24
    v_dot2_f32_bf16 v25, v163, v163, v25
    v_dot2_f32_bf16 v26, v167, v22, v26
    v_dot2_f32_bf16 v27, v167, v167, v27
    v_dot2_f32_bf16 v24, v168, v22, v24
    v_dot2_f32_bf16 v25, v168, v168, v25
    v_dot2_f32_bf16 v26, v172, v22, v26
    v_dot2_f32_bf16 v27, v172, v172, v27
    v_dot2_f32_bf16 v24, v169, v22, v24
    v_dot2_f32_bf16 v25, v169, v169, v25
    v_dot2_f32_bf16 v26, v173, v22, v26
    v_dot2_f32_bf16 v27, v173, v173, v27
    v_dot2_f32_bf16 v24, v170, v22, v24
    v_dot2_f32_bf16 v25, v170, v170, v25
    v_dot2_f32_bf16 v26, v174, v22, v26
    v_dot2_f32_bf16 v27, v174, v174, v27
    v_dot2_f32_bf16 v24, v171, v22, v24
    v_dot2_f32_bf16 v25, v171, v171, v25
    v_dot2_f32_bf16 v26, v175, v22, v26
    v_dot2_f32_bf16 v27, v175, v175, v27
    v_lshrrev_b32 v23, 1, v1
    v_and_b32 v23, 0xf8, v23
    s_nop 0
    v_permlane16_swap_b32 v24, v26
    v_permlane16_swap_b32 v25, v27
    v_pk_add_f32 v[24:25], v[24:25], v[26:27]
    v_mov_b32 v26, v24
    v_mov_b32 v27, v25
    s_nop 0
    v_permlane32_swap_b32 v24, v26
    v_permlane32_swap_b32 v25, v27
    v_pk_add_f32 v[24:25], v[24:25], v[26:27]
    s_lshl_b32 s44, s21, 18
    s_lshl_b32 s45, s38, 12
    s_add_u32 s44, s44, s45
    s_lshl_b32 s45, s18, 8
    s_add_u32 s44, s44, s45
    s_add_u32 s44, s44, 50331648
    buffer_store_dwordx2 v[24:25], v23, s[4:7], s44 offen sc1
    s_lshl_b32 s46, s21, 14
    s_lshl_b32 s67, s38, 7
    s_add_u32 s46, s46, s67
    s_add_u32 s46, s46, 4096
    s_add_u32 s47, s46, 8192
    s_lshl_b32 s48, s21, 22
    s_lshl_b32 s49, s38, 16
    s_add_u32 s41, s48, s49
    v_lshrrev_b32 v16, 4, v1
    v_and_b32 v17, 15, v16
    v_lshrrev_b32 v16, 4, v16
    s_lshl_b32 s49, s16, 7
    s_add_u32 s50, s49, 151552
    s_and_b32 s49, s21, 1
    s_lshl_b32 s49, s49, 10
    s_add_u32 s49, s49, 151552
    v_lshlrev_b32 v11, 4, v16
    v_add_u32 v13, s50, v11
    v_add_u32 v11, s49, v11
    v_lshlrev_b32 v15, 2, v17
    v_add_u32 v9, s50, v15
    v_add_u32 v15, s49, v15
    s_lshr_b32 s49, s21, 1
    s_lshl_b32 s53, s49, 23
    s_lshl_b32 s50, s18, 18
    s_add_u32 s53, s53, s50
    s_add_u32 s53, s53, 33554432
    s_lshl_b32 s54, s38, 11
    s_add_u32 s52, s53, s54
    s_lshl_b32 s59, s49, 13
    s_lshl_b32 s67, s18, 9
    s_add_u32 s59, s59, s67
    s_lshl_b32 s67, s16, 7
    s_add_u32 s59, s59, s67
    s_add_u32 s59, s59, 69632
    s_lshl_b32 s61, s49, 15
    s_lshl_b32 s67, s17, 11
    s_add_u32 s61, s61, s67
    s_lshl_b32 s67, s18, 7
    s_add_u32 s61, s61, s67
    s_add_u32 s61, s61, 151552
    s_sub_u32 s60, s61, 151552
    s_lshl_b32 s60, s60, 5
    s_add_u32 s60, s60, 54525952
    s_lshl_b32 s62, s16, 12
    s_add_u32 s62, s62, 131072
    s_mov_b32 s68, s63
    s_waitcnt vmcnt(1)
    s_atomic_add s68, s[22:23], s46 glc
    s_mov_b32 s48, 0
    s_branch c_layer
c_final:
    v_mfma_f32_16x16x32_bf16 v[132:135], v[32:35], v[116:119], v[132:135]
    v_mfma_f32_16x16x32_bf16 v[140:143], v[36:39], v[116:119], v[140:143]
    v_mfma_f32_16x16x32_bf16 v[148:151], v[40:43], v[116:119], v[148:151]
    v_cvt_pk_bf16_f32 v128, v128, v129
    v_cvt_pk_bf16_f32 v129, v130, v131
    ds_write_b64 v17, v[128:129] offset:0
    v_mfma_f32_16x16x32_bf16 v[156:159], v[44:47], v[116:119], v[156:159]
    v_cvt_pk_bf16_f32 v136, v136, v137
    v_cvt_pk_bf16_f32 v137, v138, v139
    ds_write_b64 v17, v[136:137] offset:32
    v_mfma_f32_16x16x32_bf16 v[132:135], v[48:51], v[124:127], v[132:135]
    v_cvt_pk_bf16_f32 v144, v144, v145
    v_cvt_pk_bf16_f32 v145, v146, v147
    ds_write_b64 v17, v[144:145] offset:64
    v_mfma_f32_16x16x32_bf16 v[140:143], v[52:55], v[124:127], v[140:143]
    v_cvt_pk_bf16_f32 v152, v152, v153
    v_cvt_pk_bf16_f32 v153, v154, v155
    ds_write_b64 v17, v[152:153] offset:96
    v_mfma_f32_16x16x32_bf16 v[148:151], v[56:59], v[124:127], v[148:151]
    ds_read_b128 v[160:163], v18 offset:0
    ds_read_b128 v[164:167], v18 offset:1152
    v_mfma_f32_16x16x32_bf16 v[156:159], v[60:63], v[124:127], v[156:159]
    v_cvt_pk_bf16_f32 v132, v132, v133
    v_cvt_pk_bf16_f32 v133, v134, v135
    ds_write_b64 v17, v[132:133] offset:2304
    v_cvt_pk_bf16_f32 v140, v140, v141
    v_cvt_pk_bf16_f32 v141, v142, v143
    ds_write_b64 v17, v[140:141] offset:2336
    v_cvt_pk_bf16_f32 v148, v148, v149
    v_cvt_pk_bf16_f32 v149, v150, v151
    ds_write_b64 v17, v[148:149] offset:2368
    v_cvt_pk_bf16_f32 v156, v156, v157
    v_cvt_pk_bf16_f32 v157, v158, v159
    ds_write_b64 v17, v[156:157] offset:2400
    ds_read_b128 v[168:171], v18 offset:2304
    ds_read_b128 v[172:175], v18 offset:3456
    s_waitcnt lgkmcnt(7)
    buffer_store_dwordx4 v[160:163], v19, s[8:11], s50 offen sc1
    s_add_u32 s50, s50, 16384
    s_waitcnt lgkmcnt(6)
    buffer_store_dwordx4 v[164:167], v19, s[8:11], s50 offen sc1
    s_add_u32 s50, s50, 16384
    s_waitcnt lgkmcnt(1)
    buffer_store_dwordx4 v[168:171], v19, s[8:11], s50 offen sc1
    s_add_u32 s50, s50, 16384
    s_waitcnt lgkmcnt(0)
    buffer_store_dwordx4 v[172:175], v19, s[8:11], s50 offen sc1
    s_endpgm
s_start:
    v_mov_b32 v14, 0
    v_mov_b32 v15, 0
    v_mov_b32 v20, 0
    v_mov_b32 v21, 0
    v_mov_b32 v22, 0
    s_mov_b32 s41, 0
    s_mov_b32 s42, 0
    s_mov_b32 s43, 0
    s_mov_b32 s62, 0
    s_cmp_eq_u32 s16, 4
    s_cbranch_scc1 h_start
    s_cmp_eq_u32 s16, 7
    s_cbranch_scc1 z_start
l_start:
    v_lshrrev_b32 v24, 4, v1
    v_lshrrev_b32 v25, 3, v24
    v_mul_u32_u24 v12, 6144, v25
    v_and_b32 v26, 2, v25
    v_lshrrev_b32 v25, 2, v25
    v_or_b32 v26, v26, v25
    v_bfe_u32 v25, v24, 1, 2
    v_xor_b32 v26, v26, v25
    v_lshl_add_u32 v12, v26, 5, v12
    v_and_b32 v26, 1, v24
    v_lshl_add_u32 v12, v26, 4, v12
    s_lshl_b32 s3, s18, 7
    v_add_u32 v12, s3, v12
    v_add_u32 v13, 48128, v12
    s_mul_i32 s84, s18, 393216
    s_cmp_lt_u32 s18, 4
    s_cselect_b32 s85, 4, 0
    s_mul_i32 s85, s85, 393216
    s_sub_u32 s3, s16, 5
    s_lshl_b32 s41, s3, 11
    s_mul_i32 s42, s3, 98304
    s_lshl_b32 s62, s3, 15
    v_add_u32 v14, s42, v12
    v_add_u32 v15, s42, v13
    s_bitcmp1_b32 s21, 0
    s_cselect_b32 s8, s28, s24
    s_cselect_b32 s9, s29, s25
    s_cselect_b32 s12, s30, s26
    s_cselect_b32 s13, s31, s27
    s_mov_b32 s10, 6291456
    s_mov_b32 s11, 0x00020000
    s_mov_b32 s14, 2097152
    s_mov_b32 s15, 0x00020000
    s_add_u32 m0, s41, 0
    s_add_u32 s44, s84, 2048
    buffer_load_dwordx4 v14, s[8:11], s44 offen offset:0 lds
    buffer_load_dwordx4 v15, s[8:11], s44 offen offset:1024 lds
    s_add_u32 m0, s41, 4096
    s_add_u32 s44, s84, 4096
    buffer_load_dwordx4 v14, s[8:11], s44 offen offset:0 lds
    buffer_load_dwordx4 v15, s[8:11], s44 offen offset:1024 lds
    s_add_u32 m0, s41, 8192
    s_add_u32 s44, s84, 0
    buffer_load_dwordx4 v14, s[8:11], s44 offen offset:0 lds
    buffer_load_dwordx4 v15, s[8:11], s44 offen offset:1024 lds
    s_add_u32 m0, s41, 12288
    s_add_u32 s44, s84, 198656
    buffer_load_dwordx4 v14, s[8:11], s44 offen offset:0 lds
    buffer_load_dwordx4 v15, s[8:11], s44 offen offset:1024 lds
    s_add_u32 m0, s41, 16384
    s_add_u32 s44, s84, 200704
    buffer_load_dwordx4 v14, s[8:11], s44 offen offset:0 lds
    buffer_load_dwordx4 v15, s[8:11], s44 offen offset:1024 lds
    s_add_u32 m0, s41, 20480
    s_add_u32 s44, s84, 196608
    buffer_load_dwordx4 v14, s[8:11], s44 offen offset:0 lds
    buffer_load_dwordx4 v15, s[8:11], s44 offen offset:1024 lds
    s_add_u32 m0, s41, 24576
    s_add_u32 s44, s85, 2048
    buffer_load_dwordx4 v14, s[8:11], s44 offen offset:0 lds
    buffer_load_dwordx4 v15, s[8:11], s44 offen offset:1024 lds
    s_add_u32 m0, s41, 28672
    s_add_u32 s44, s85, 4096
    buffer_load_dwordx4 v14, s[8:11], s44 offen offset:0 lds
    buffer_load_dwordx4 v15, s[8:11], s44 offen offset:1024 lds
    s_cmp_lt_u32 s18, 4
    s_cselect_b32 s86, 5, 1
    s_mul_i32 s86, s86, 393216
    s_cmp_lt_u32 s18, 4
    s_cselect_b32 s87, 6, 2
    s_mul_i32 s87, s87, 393216
    s_cmp_lt_u32 s18, 4
    s_cselect_b32 s88, 7, 3
    s_mul_i32 s88, s88, 393216
    s_cmp_lt_u32 s18, 8
    s_cselect_b32 s89, 8, 4
    s_mul_i32 s89, s89, 393216
    s_cmp_lt_u32 s18, 8
    s_cselect_b32 s90, 9, 5
    s_mul_i32 s90, s90, 393216
    s_cmp_lt_u32 s18, 8
    s_cselect_b32 s91, 10, 6
    s_mul_i32 s91, s91, 393216
    s_cmp_lt_u32 s18, 8
    s_cselect_b32 s92, 11, 7
    s_mul_i32 s92, s92, 393216
    s_cmp_lt_u32 s18, 12
    s_cselect_b32 s93, 12, 8
    s_mul_i32 s93, s93, 393216
    s_cmp_lt_u32 s18, 12
    s_cselect_b32 s94, 13, 9
    s_mul_i32 s94, s94, 393216
    s_cmp_lt_u32 s18, 12
    s_cselect_b32 s95, 14, 10
    s_mul_i32 s95, s95, 393216
    s_cmp_lt_u32 s18, 12
    s_cselect_b32 s96, 15, 11
    s_mul_i32 s96, s96, 393216
    s_xor_b32 s97, s18, 1
    s_mul_i32 s97, s97, 393216
    s_xor_b32 s98, s18, 2
    s_mul_i32 s98, s98, 393216
    s_xor_b32 s99, s18, 3
    s_mul_i32 s99, s99, 393216
    v_lshrrev_b32 v24, 4, v1
    v_lshrrev_b32 v25, 3, v24
    v_mul_u32_u24 v16, 2048, v25
    v_and_b32 v26, 2, v25
    v_lshrrev_b32 v25, 2, v25
    v_or_b32 v26, v26, v25
    v_bfe_u32 v25, v24, 1, 2
    v_xor_b32 v26, v26, v25
    v_lshl_add_u32 v16, v26, 5, v16
    v_and_b32 v26, 1, v24
    v_lshl_add_u32 v16, v26, 4, v16
    s_lshl_b32 s3, s18, 7
    v_add_u32 v16, s3, v16
    v_add_u32 v17, 15360, v16
    v_add_u32 v18, 30720, v16
    v_add_u32 v19, 46080, v16
    s_and_b32 s3, s16, 3
    s_mul_i32 s3, s3, 49152
    v_add_u32 v11, s3, v12
    s_and_b32 s3, s16, 3
    s_lshl_b32 s3, s3, 10
    v_add_u32 v9, s3, v1
    v_add_u32 v10, 0x10000, v9
    s_waitcnt vmcnt(0)
    s_barrier
    s_add_u32 m0, s41, 32768
    s_add_u32 s44, s85, 0
    buffer_load_dwordx4 v14, s[8:11], s44 offen offset:0 lds
    buffer_load_dwordx4 v15, s[8:11], s44 offen offset:1024 lds
    s_add_u32 m0, s41, 36864
    s_add_u32 s44, s85, 198656
    buffer_load_dwordx4 v14, s[8:11], s44 offen offset:0 lds
    buffer_load_dwordx4 v15, s[8:11], s44 offen offset:1024 lds
    s_add_u32 m0, s41, 40960
    s_add_u32 s44, s85, 200704
    buffer_load_dwordx4 v14, s[8:11], s44 offen offset:0 lds
    buffer_load_dwordx4 v15, s[8:11], s44 offen offset:1024 lds
    s_add_u32 m0, s41, 45056
    s_add_u32 s44, s85, 196608
    buffer_load_dwordx4 v14, s[8:11], s44 offen offset:0 lds
    buffer_load_dwordx4 v15, s[8:11], s44 offen offset:1024 lds
    s_add_u32 m0, s41, 49152
    s_add_u32 s44, s86, 2048
    buffer_load_dwordx4 v14, s[8:11], s44 offen offset:0 lds
    buffer_load_dwordx4 v15, s[8:11], s44 offen offset:1024 lds
    s_add_u32 m0, s41, 53248
    s_add_u32 s44, s86, 4096
    buffer_load_dwordx4 v14, s[8:11], s44 offen offset:0 lds
    buffer_load_dwordx4 v15, s[8:11], s44 offen offset:1024 lds
    s_add_u32 m0, s41, 57344
    s_add_u32 s44, s86, 0
    buffer_load_dwordx4 v14, s[8:11], s44 offen offset:0 lds
    buffer_load_dwordx4 v15, s[8:11], s44 offen offset:1024 lds
    s_add_u32 m0, s41, 61440
    s_add_u32 s44, s86, 198656
    buffer_load_dwordx4 v14, s[8:11], s44 offen offset:0 lds
    buffer_load_dwordx4 v15, s[8:11], s44 offen offset:1024 lds
    s_waitcnt vmcnt(0)
    s_barrier
    s_add_u32 m0, s41, 65536
    s_add_u32 s44, s86, 200704
    buffer_load_dwordx4 v14, s[8:11], s44 offen offset:0 lds
    buffer_load_dwordx4 v15, s[8:11], s44 offen offset:1024 lds
    s_add_u32 m0, s41, 69632
    s_add_u32 s44, s86, 196608
    buffer_load_dwordx4 v14, s[8:11], s44 offen offset:0 lds
    buffer_load_dwordx4 v15, s[8:11], s44 offen offset:1024 lds
    s_add_u32 m0, s41, 73728
    s_add_u32 s44, s87, 2048
    buffer_load_dwordx4 v14, s[8:11], s44 offen offset:0 lds
    buffer_load_dwordx4 v15, s[8:11], s44 offen offset:1024 lds
    s_add_u32 m0, s41, 77824
    s_add_u32 s44, s87, 4096
    buffer_load_dwordx4 v14, s[8:11], s44 offen offset:0 lds
    buffer_load_dwordx4 v15, s[8:11], s44 offen offset:1024 lds
    s_add_u32 m0, s41, 81920
    s_add_u32 s44, s87, 0
    buffer_load_dwordx4 v14, s[8:11], s44 offen offset:0 lds
    buffer_load_dwordx4 v15, s[8:11], s44 offen offset:1024 lds
    s_add_u32 m0, s41, 86016
    s_add_u32 s44, s87, 198656
    buffer_load_dwordx4 v14, s[8:11], s44 offen offset:0 lds
    buffer_load_dwordx4 v15, s[8:11], s44 offen offset:1024 lds
    s_add_u32 m0, s41, 90112
    s_add_u32 s44, s87, 200704
    buffer_load_dwordx4 v14, s[8:11], s44 offen offset:0 lds
    buffer_load_dwordx4 v15, s[8:11], s44 offen offset:1024 lds
    s_add_u32 m0, s41, 94208
    s_add_u32 s44, s87, 196608
    buffer_load_dwordx4 v14, s[8:11], s44 offen offset:0 lds
    buffer_load_dwordx4 v15, s[8:11], s44 offen offset:1024 lds
    s_add_u32 m0, s41, 98304
    s_add_u32 s44, s88, 2048
    buffer_load_dwordx4 v14, s[8:11], s44 offen offset:0 lds
    buffer_load_dwordx4 v15, s[8:11], s44 offen offset:1024 lds
    s_add_u32 m0, s41, 102400
    s_add_u32 s44, s88, 4096
    buffer_load_dwordx4 v14, s[8:11], s44 offen offset:0 lds
    buffer_load_dwordx4 v15, s[8:11], s44 offen offset:1024 lds
    s_add_u32 m0, s41, 106496
    s_add_u32 s44, s88, 0
    buffer_load_dwordx4 v14, s[8:11], s44 offen offset:0 lds
    buffer_load_dwordx4 v15, s[8:11], s44 offen offset:1024 lds
    s_add_u32 m0, s41, 110592
    s_add_u32 s44, s88, 198656
    buffer_load_dwordx4 v14, s[8:11], s44 offen offset:0 lds
    buffer_load_dwordx4 v15, s[8:11], s44 offen offset:1024 lds
    s_add_u32 m0, s41, 114688
    s_add_u32 s44, s88, 200704
    buffer_load_dwordx4 v14, s[8:11], s44 offen offset:0 lds
    buffer_load_dwordx4 v15, s[8:11], s44 offen offset:1024 lds
    s_add_u32 m0, s41, 118784
    s_add_u32 s44, s88, 196608
    buffer_load_dwordx4 v14, s[8:11], s44 offen offset:0 lds
    buffer_load_dwordx4 v15, s[8:11], s44 offen offset:1024 lds
    s_add_u32 m0, s41, 122880
    s_add_u32 s44, s89, 2048
    buffer_load_dwordx4 v14, s[8:11], s44 offen offset:0 lds
    buffer_load_dwordx4 v15, s[8:11], s44 offen offset:1024 lds
    s_add_u32 m0, s41, 126976
    s_add_u32 s44, s89, 4096
    buffer_load_dwordx4 v14, s[8:11], s44 offen offset:0 lds
    buffer_load_dwordx4 v15, s[8:11], s44 offen offset:1024 lds
    s_add_u32 m0, s41, 0
    s_add_u32 s44, s89, 0
    buffer_load_dwordx4 v14, s[8:11], s44 offen offset:0 lds
    buffer_load_dwordx4 v15, s[8:11], s44 offen offset:1024 lds
    s_add_u32 m0, s41, 4096
    s_add_u32 s44, s89, 198656
    buffer_load_dwordx4 v14, s[8:11], s44 offen offset:0 lds
    buffer_load_dwordx4 v15, s[8:11], s44 offen offset:1024 lds
    s_add_u32 m0, s41, 8192
    s_add_u32 s44, s89, 200704
    buffer_load_dwordx4 v14, s[8:11], s44 offen offset:0 lds
    buffer_load_dwordx4 v15, s[8:11], s44 offen offset:1024 lds
    s_add_u32 m0, s41, 12288
    s_add_u32 s44, s89, 196608
    buffer_load_dwordx4 v14, s[8:11], s44 offen offset:0 lds
    buffer_load_dwordx4 v15, s[8:11], s44 offen offset:1024 lds
    s_waitcnt vmcnt(24)
    s_branch l_join
l_layer:
    s_waitcnt lgkmcnt(0)
    s_barrier
    s_add_u32 m0, s41, 0
    s_add_u32 s44, s89, 0
    buffer_load_dwordx4 v14, s[8:11], s44 offen offset:0 lds
    buffer_load_dwordx4 v15, s[8:11], s44 offen offset:1024 lds
    s_add_u32 m0, s41, 4096
    s_add_u32 s44, s89, 198656
    buffer_load_dwordx4 v14, s[8:11], s44 offen offset:0 lds
    buffer_load_dwordx4 v15, s[8:11], s44 offen offset:1024 lds
    s_add_u32 m0, s41, 8192
    s_add_u32 s44, s89, 200704
    buffer_load_dwordx4 v14, s[8:11], s44 offen offset:0 lds
    buffer_load_dwordx4 v15, s[8:11], s44 offen offset:1024 lds
    s_add_u32 m0, s41, 12288
    s_add_u32 s44, s89, 196608
    buffer_load_dwordx4 v14, s[8:11], s44 offen offset:0 lds
    buffer_load_dwordx4 v15, s[8:11], s44 offen offset:1024 lds
l_join:
    s_barrier
    s_add_u32 m0, s41, 16384
    s_add_u32 s44, s90, 2048
    buffer_load_dwordx4 v14, s[8:11], s44 offen offset:0 lds
    buffer_load_dwordx4 v15, s[8:11], s44 offen offset:1024 lds
    s_add_u32 m0, s41, 20480
    s_add_u32 s44, s90, 4096
    buffer_load_dwordx4 v14, s[8:11], s44 offen offset:0 lds
    buffer_load_dwordx4 v15, s[8:11], s44 offen offset:1024 lds
    s_add_u32 m0, s41, 24576
    s_add_u32 s44, s90, 0
    buffer_load_dwordx4 v14, s[8:11], s44 offen offset:0 lds
    buffer_load_dwordx4 v15, s[8:11], s44 offen offset:1024 lds
    s_add_u32 m0, s41, 28672
    s_add_u32 s44, s90, 198656
    buffer_load_dwordx4 v14, s[8:11], s44 offen offset:0 lds
    buffer_load_dwordx4 v15, s[8:11], s44 offen offset:1024 lds
    s_add_u32 m0, s41, 32768
    s_add_u32 s44, s90, 200704
    buffer_load_dwordx4 v14, s[8:11], s44 offen offset:0 lds
    buffer_load_dwordx4 v15, s[8:11], s44 offen offset:1024 lds
    s_add_u32 m0, s41, 36864
    s_add_u32 s44, s90, 196608
    buffer_load_dwordx4 v14, s[8:11], s44 offen offset:0 lds
    buffer_load_dwordx4 v15, s[8:11], s44 offen offset:1024 lds
    s_add_u32 m0, s41, 40960
    s_add_u32 s44, s91, 2048
    buffer_load_dwordx4 v14, s[8:11], s44 offen offset:0 lds
    buffer_load_dwordx4 v15, s[8:11], s44 offen offset:1024 lds
    s_add_u32 m0, s41, 45056
    s_add_u32 s44, s91, 4096
    buffer_load_dwordx4 v14, s[8:11], s44 offen offset:0 lds
    buffer_load_dwordx4 v15, s[8:11], s44 offen offset:1024 lds
    s_waitcnt vmcnt(24)
    s_barrier
    s_add_u32 m0, s41, 49152
    s_add_u32 s44, s91, 0
    buffer_load_dwordx4 v14, s[8:11], s44 offen offset:0 lds
    buffer_load_dwordx4 v15, s[8:11], s44 offen offset:1024 lds
    s_add_u32 m0, s41, 53248
    s_add_u32 s44, s91, 198656
    buffer_load_dwordx4 v14, s[8:11], s44 offen offset:0 lds
    buffer_load_dwordx4 v15, s[8:11], s44 offen offset:1024 lds
    s_add_u32 m0, s41, 57344
    s_add_u32 s44, s91, 200704
    buffer_load_dwordx4 v14, s[8:11], s44 offen offset:0 lds
    buffer_load_dwordx4 v15, s[8:11], s44 offen offset:1024 lds
    s_add_u32 m0, s41, 61440
    s_add_u32 s44, s91, 196608
    buffer_load_dwordx4 v14, s[8:11], s44 offen offset:0 lds
    buffer_load_dwordx4 v15, s[8:11], s44 offen offset:1024 lds
    s_waitcnt vmcnt(16)
    s_barrier
    s_add_u32 m0, s41, 65536
    s_add_u32 s44, s92, 2048
    buffer_load_dwordx4 v14, s[8:11], s44 offen offset:0 lds
    buffer_load_dwordx4 v15, s[8:11], s44 offen offset:1024 lds
    s_add_u32 m0, s41, 69632
    s_add_u32 s44, s92, 4096
    buffer_load_dwordx4 v14, s[8:11], s44 offen offset:0 lds
    buffer_load_dwordx4 v15, s[8:11], s44 offen offset:1024 lds
    s_add_u32 m0, s41, 73728
    s_add_u32 s44, s92, 0
    buffer_load_dwordx4 v14, s[8:11], s44 offen offset:0 lds
    buffer_load_dwordx4 v15, s[8:11], s44 offen offset:1024 lds
    s_add_u32 m0, s41, 77824
    s_add_u32 s44, s92, 198656
    buffer_load_dwordx4 v14, s[8:11], s44 offen offset:0 lds
    buffer_load_dwordx4 v15, s[8:11], s44 offen offset:1024 lds
    s_add_u32 m0, s41, 81920
    s_add_u32 s44, s92, 200704
    buffer_load_dwordx4 v14, s[8:11], s44 offen offset:0 lds
    buffer_load_dwordx4 v15, s[8:11], s44 offen offset:1024 lds
    s_add_u32 m0, s41, 86016
    s_add_u32 s44, s92, 196608
    buffer_load_dwordx4 v14, s[8:11], s44 offen offset:0 lds
    buffer_load_dwordx4 v15, s[8:11], s44 offen offset:1024 lds
    s_add_u32 m0, s41, 90112
    s_add_u32 s44, s93, 2048
    buffer_load_dwordx4 v14, s[8:11], s44 offen offset:0 lds
    buffer_load_dwordx4 v15, s[8:11], s44 offen offset:1024 lds
    s_add_u32 m0, s41, 94208
    s_add_u32 s44, s93, 4096
    buffer_load_dwordx4 v14, s[8:11], s44 offen offset:0 lds
    buffer_load_dwordx4 v15, s[8:11], s44 offen offset:1024 lds
    s_waitcnt vmcnt(16)
    s_barrier
    s_add_u32 m0, s41, 98304
    s_add_u32 s44, s93, 0
    buffer_load_dwordx4 v14, s[8:11], s44 offen offset:0 lds
    buffer_load_dwordx4 v15, s[8:11], s44 offen offset:1024 lds
    s_add_u32 m0, s41, 102400
    s_add_u32 s44, s93, 198656
    buffer_load_dwordx4 v14, s[8:11], s44 offen offset:0 lds
    buffer_load_dwordx4 v15, s[8:11], s44 offen offset:1024 lds
    s_add_u32 m0, s41, 106496
    s_add_u32 s44, s93, 200704
    buffer_load_dwordx4 v14, s[8:11], s44 offen offset:0 lds
    buffer_load_dwordx4 v15, s[8:11], s44 offen offset:1024 lds
    s_add_u32 m0, s41, 110592
    s_add_u32 s44, s93, 196608
    buffer_load_dwordx4 v14, s[8:11], s44 offen offset:0 lds
    buffer_load_dwordx4 v15, s[8:11], s44 offen offset:1024 lds
    s_add_u32 m0, s41, 114688
    s_add_u32 s44, s94, 2048
    buffer_load_dwordx4 v14, s[8:11], s44 offen offset:0 lds
    buffer_load_dwordx4 v15, s[8:11], s44 offen offset:1024 lds
    s_add_u32 m0, s41, 118784
    s_add_u32 s44, s94, 4096
    buffer_load_dwordx4 v14, s[8:11], s44 offen offset:0 lds
    buffer_load_dwordx4 v15, s[8:11], s44 offen offset:1024 lds
    s_add_u32 m0, s41, 122880
    s_add_u32 s44, s94, 198656
    buffer_load_dwordx4 v14, s[8:11], s44 offen offset:0 lds
    buffer_load_dwordx4 v15, s[8:11], s44 offen offset:1024 lds
    s_add_u32 m0, s41, 126976
    s_add_u32 s44, s94, 200704
    buffer_load_dwordx4 v14, s[8:11], s44 offen offset:0 lds
    buffer_load_dwordx4 v15, s[8:11], s44 offen offset:1024 lds
    s_waitcnt vmcnt(16)
    s_barrier
    s_add_u32 m0, s41, 0
    s_add_u32 s44, s95, 2048
    buffer_load_dwordx4 v14, s[8:11], s44 offen offset:0 lds
    buffer_load_dwordx4 v15, s[8:11], s44 offen offset:1024 lds
    s_add_u32 m0, s41, 4096
    s_add_u32 s44, s95, 4096
    buffer_load_dwordx4 v14, s[8:11], s44 offen offset:0 lds
    buffer_load_dwordx4 v15, s[8:11], s44 offen offset:1024 lds
    s_add_u32 m0, s41, 8192
    s_add_u32 s44, s95, 198656
    buffer_load_dwordx4 v14, s[8:11], s44 offen offset:0 lds
    buffer_load_dwordx4 v15, s[8:11], s44 offen offset:1024 lds
    s_add_u32 m0, s41, 12288
    s_add_u32 s44, s95, 200704
    buffer_load_dwordx4 v14, s[8:11], s44 offen offset:0 lds
    buffer_load_dwordx4 v15, s[8:11], s44 offen offset:1024 lds
    s_add_u32 m0, s41, 16384
    s_add_u32 s44, s96, 2048
    buffer_load_dwordx4 v14, s[8:11], s44 offen offset:0 lds
    buffer_load_dwordx4 v15, s[8:11], s44 offen offset:1024 lds
    s_add_u32 m0, s41, 20480
    s_add_u32 s44, s96, 198656
    buffer_load_dwordx4 v14, s[8:11], s44 offen offset:0 lds
    buffer_load_dwordx4 v15, s[8:11], s44 offen offset:1024 lds
    s_add_u32 m0, s41, 24576
    s_add_u32 s44, s97, 2048
    buffer_load_dwordx4 v14, s[8:11], s44 offen offset:0 lds
    buffer_load_dwordx4 v15, s[8:11], s44 offen offset:1024 lds
    s_add_u32 m0, s41, 28672
    s_add_u32 s44, s97, 198656
    buffer_load_dwordx4 v14, s[8:11], s44 offen offset:0 lds
    buffer_load_dwordx4 v15, s[8:11], s44 offen offset:1024 lds
    s_waitcnt vmcnt(16)
    s_barrier
    s_add_u32 m0, s41, 32768
    s_add_u32 s44, s98, 2048
    buffer_load_dwordx4 v14, s[8:11], s44 offen offset:0 lds
    buffer_load_dwordx4 v15, s[8:11], s44 offen offset:1024 lds
    s_add_u32 m0, s41, 36864
    s_add_u32 s44, s98, 198656
    buffer_load_dwordx4 v14, s[8:11], s44 offen offset:0 lds
    buffer_load_dwordx4 v15, s[8:11], s44 offen offset:1024 lds
    s_add_u32 m0, s41, 40960
    s_add_u32 s44, s99, 2048
    buffer_load_dwordx4 v14, s[8:11], s44 offen offset:0 lds
    buffer_load_dwordx4 v15, s[8:11], s44 offen offset:1024 lds
    s_add_u32 m0, s41, 45056
    s_add_u32 s44, s99, 198656
    buffer_load_dwordx4 v14, s[8:11], s44 offen offset:0 lds
    buffer_load_dwordx4 v15, s[8:11], s44 offen offset:1024 lds
    s_add_u32 m0, s41, 49152
    s_add_u32 s44, s96, 4096
    buffer_load_dwordx4 v14, s[8:11], s44 offen offset:0 lds
    buffer_load_dwordx4 v15, s[8:11], s44 offen offset:1024 lds
    s_add_u32 m0, s41, 53248
    s_add_u32 s44, s96, 200704
    buffer_load_dwordx4 v14, s[8:11], s44 offen offset:0 lds
    buffer_load_dwordx4 v15, s[8:11], s44 offen offset:1024 lds
    s_add_u32 m0, s41, 57344
    s_add_u32 s44, s97, 4096
    buffer_load_dwordx4 v14, s[8:11], s44 offen offset:0 lds
    buffer_load_dwordx4 v15, s[8:11], s44 offen offset:1024 lds
    s_add_u32 m0, s41, 61440
    s_add_u32 s44, s97, 200704
    buffer_load_dwordx4 v14, s[8:11], s44 offen offset:0 lds
    buffer_load_dwordx4 v15, s[8:11], s44 offen offset:1024 lds
    s_waitcnt vmcnt(16)
    s_barrier
    s_add_u32 m0, s41, 65536
    s_add_u32 s44, s98, 4096
    buffer_load_dwordx4 v14, s[8:11], s44 offen offset:0 lds
    buffer_load_dwordx4 v15, s[8:11], s44 offen offset:1024 lds
    s_add_u32 m0, s41, 69632
    s_add_u32 s44, s98, 200704
    buffer_load_dwordx4 v14, s[8:11], s44 offen offset:0 lds
    buffer_load_dwordx4 v15, s[8:11], s44 offen offset:1024 lds
    s_add_u32 m0, s41, 73728
    s_add_u32 s44, s99, 4096
    buffer_load_dwordx4 v14, s[8:11], s44 offen offset:0 lds
    buffer_load_dwordx4 v15, s[8:11], s44 offen offset:1024 lds
    s_add_u32 m0, s41, 77824
    s_add_u32 s44, s99, 200704
    buffer_load_dwordx4 v14, s[8:11], s44 offen offset:0 lds
    buffer_load_dwordx4 v15, s[8:11], s44 offen offset:1024 lds
    s_add_u32 m0, s41, 81920
    s_add_u32 s44, s94, 0
    buffer_load_dwordx4 v14, s[8:11], s44 offen offset:0 lds
    buffer_load_dwordx4 v15, s[8:11], s44 offen offset:1024 lds
    s_add_u32 m0, s41, 86016
    s_add_u32 s44, s94, 196608
    buffer_load_dwordx4 v14, s[8:11], s44 offen offset:0 lds
    buffer_load_dwordx4 v15, s[8:11], s44 offen offset:1024 lds
    s_add_u32 m0, s41, 90112
    s_add_u32 s44, s95, 0
    buffer_load_dwordx4 v14, s[8:11], s44 offen offset:0 lds
    buffer_load_dwordx4 v15, s[8:11], s44 offen offset:1024 lds
    s_add_u32 m0, s41, 94208
    s_add_u32 s44, s95, 196608
    buffer_load_dwordx4 v14, s[8:11], s44 offen offset:0 lds
    buffer_load_dwordx4 v15, s[8:11], s44 offen offset:1024 lds
    s_waitcnt vmcnt(16)
    s_barrier
    s_add_u32 m0, s41, 98304
    s_add_u32 s44, s96, 0
    buffer_load_dwordx4 v14, s[8:11], s44 offen offset:0 lds
    buffer_load_dwordx4 v15, s[8:11], s44 offen offset:1024 lds
    s_add_u32 m0, s41, 102400
    s_add_u32 s44, s96, 196608
    buffer_load_dwordx4 v14, s[8:11], s44 offen offset:0 lds
    buffer_load_dwordx4 v15, s[8:11], s44 offen offset:1024 lds
    s_add_u32 m0, s41, 106496
    s_add_u32 s44, s97, 0
    buffer_load_dwordx4 v14, s[8:11], s44 offen offset:0 lds
    buffer_load_dwordx4 v15, s[8:11], s44 offen offset:1024 lds
    s_add_u32 m0, s41, 110592
    s_add_u32 s44, s97, 196608
    buffer_load_dwordx4 v14, s[8:11], s44 offen offset:0 lds
    buffer_load_dwordx4 v15, s[8:11], s44 offen offset:1024 lds
    s_add_u32 m0, s41, 114688
    s_add_u32 s44, s98, 0
    buffer_load_dwordx4 v14, s[8:11], s44 offen offset:0 lds
    buffer_load_dwordx4 v15, s[8:11], s44 offen offset:1024 lds
    s_add_u32 m0, s41, 118784
    s_add_u32 s44, s98, 196608
    buffer_load_dwordx4 v14, s[8:11], s44 offen offset:0 lds
    buffer_load_dwordx4 v15, s[8:11], s44 offen offset:1024 lds
    s_add_u32 m0, s41, 122880
    s_add_u32 s44, s99, 0
    buffer_load_dwordx4 v14, s[8:11], s44 offen offset:0 lds
    buffer_load_dwordx4 v15, s[8:11], s44 offen offset:1024 lds
    s_add_u32 m0, s41, 126976
    s_add_u32 s44, s99, 196608
    buffer_load_dwordx4 v14, s[8:11], s44 offen offset:0 lds
    buffer_load_dwordx4 v15, s[8:11], s44 offen offset:1024 lds
    s_waitcnt vmcnt(16)
    s_barrier
    v_lshrrev_b32 v28, 4, v1
    v_and_b32 v29, 7, v28
    v_lshrrev_b32 v28, 3, v28
    v_mul_u32_u24 v28, 2048, v28
    v_lshl_add_u32 v28, v29, 4, v28
    s_and_b32 s3, s18, 12
    s_or_b32 s3, s3, 3
    s_lshl_b32 s3, s3, 7
    v_add_u32 v28, s3, v28
    s_lshr_b32 s3, s2, 3
    s_lshl_b32 s3, s3, 2
    s_and_b32 s60, s16, 3
    s_add_u32 s60, s60, s3
    s_lshl_b32 s61, s60, 14
    buffer_load_dwordx4 v[144:147], v28, s[12:15], s61 offen
    s_bitcmp0_b32 s21, 0
    s_cselect_b32 s56, s28, s24
    s_cselect_b32 s57, s29, s25
    s_mov_b32 s58, 6291456
    s_mov_b32 s59, 0x00020000
    v_lshrrev_b32 v28, 4, v1
    v_and_b32 v29, 7, v28
    v_lshrrev_b32 v28, 3, v28
    v_mul_u32_u24 v28, 6144, v28
    v_lshl_add_u32 v28, v29, 4, v28
    s_and_b32 s3, s18, 12
    s_or_b32 s3, s3, 3
    s_lshl_b32 s3, s3, 7
    v_add_u32 v28, s3, v28
    s_lshr_b32 s3, s2, 3
    s_lshl_b32 s3, s3, 2
    s_and_b32 s60, s16, 3
    s_add_u32 s60, s60, s3
    s_and_b32 s3, s60, 31
    s_mul_i32 s3, s3, 49152
    s_lshr_b32 s61, s60, 5
    s_min_u32 s61, s61, 2
    s_lshl_b32 s61, s61, 11
    s_add_u32 s61, s61, s3
    s_cmp_lt_u32 s18, 4
    s_cselect_b32 s3, 1572864, 0
    s_add_u32 s61, s61, s3
    buffer_load_dwordx4 v[148:151], v28, s[56:59], s61 offen
    s_waitcnt vmcnt(2)
    s_cmp_lg_u32 s21, 2
    s_cbranch_scc1 l_pe
    s_bitcmp0_b32 s21, 0
    s_cselect_b32 s56, s28, s24
    s_cselect_b32 s57, s29, s25
    s_mov_b32 s58, 6291456
    s_mov_b32 s59, 0x00020000
    s_add_u32 s61, s84, 2048
    buffer_load_dwordx4 v[160:163], v11, s[56:59], s61 offen
    s_add_u32 s61, s84, 4096
    buffer_load_dwordx4 v[164:167], v11, s[56:59], s61 offen
    s_add_u32 s61, s84, 0
    buffer_load_dwordx4 v[168:171], v11, s[56:59], s61 offen
    s_add_u32 s61, s84, 198656
    buffer_load_dwordx4 v[172:175], v11, s[56:59], s61 offen
    s_add_u32 s61, s84, 200704
    buffer_load_dwordx4 v[176:179], v11, s[56:59], s61 offen
    s_add_u32 s61, s84, 196608
    buffer_load_dwordx4 v[180:183], v11, s[56:59], s61 offen
    s_add_u32 s61, s85, 2048
    buffer_load_dwordx4 v[184:187], v11, s[56:59], s61 offen
    s_add_u32 s61, s85, 4096
    buffer_load_dwordx4 v[188:191], v11, s[56:59], s61 offen
    s_add_u32 s61, s85, 0
    buffer_load_dwordx4 v[192:195], v11, s[56:59], s61 offen
    s_add_u32 s61, s85, 198656
    buffer_load_dwordx4 v[196:199], v11, s[56:59], s61 offen
l_pe:
    s_barrier
    s_bitcmp1_b32 s21, 0
    s_cbranch_scc1 s_B
    s_add_u32 m0, s41, 0
    s_xor_b32 s44, s62, 0
    buffer_load_dwordx4 v16, s[12:15], s44 offen offset:0 lds
    buffer_load_dwordx4 v17, s[12:15], s44 offen offset:1024 lds
    s_add_u32 m0, s41, 4096
    s_xor_b32 s44, s62, 131072
    buffer_load_dwordx4 v16, s[12:15], s44 offen offset:0 lds
    buffer_load_dwordx4 v17, s[12:15], s44 offen offset:1024 lds
    s_add_u32 m0, s41, 8192
    s_xor_b32 s44, s62, 262144
    buffer_load_dwordx4 v16, s[12:15], s44 offen offset:0 lds
    buffer_load_dwordx4 v17, s[12:15], s44 offen offset:1024 lds
    s_add_u32 m0, s41, 12288
    s_xor_b32 s44, s62, 393216
    buffer_load_dwordx4 v16, s[12:15], s44 offen offset:0 lds
    buffer_load_dwordx4 v17, s[12:15], s44 offen offset:1024 lds
    s_add_u32 m0, s41, 16384
    s_xor_b32 s44, s62, 524288
    buffer_load_dwordx4 v16, s[12:15], s44 offen offset:0 lds
    buffer_load_dwordx4 v17, s[12:15], s44 offen offset:1024 lds
    s_add_u32 m0, s41, 20480
    s_xor_b32 s44, s62, 655360
    buffer_load_dwordx4 v16, s[12:15], s44 offen offset:0 lds
    buffer_load_dwordx4 v17, s[12:15], s44 offen offset:1024 lds
    s_add_u32 m0, s41, 24576
    s_xor_b32 s44, s62, 786432
    buffer_load_dwordx4 v16, s[12:15], s44 offen offset:0 lds
    buffer_load_dwordx4 v17, s[12:15], s44 offen offset:1024 lds
    s_add_u32 m0, s41, 28672
    s_xor_b32 s44, s62, 917504
    buffer_load_dwordx4 v16, s[12:15], s44 offen offset:0 lds
    buffer_load_dwordx4 v17, s[12:15], s44 offen offset:1024 lds
    s_add_u32 m0, s41, 32768
    s_xor_b32 s44, s62, 1048576
    buffer_load_dwordx4 v16, s[12:15], s44 offen offset:0 lds
    buffer_load_dwordx4 v17, s[12:15], s44 offen offset:1024 lds
    s_add_u32 m0, s41, 36864
    s_xor_b32 s44, s62, 1179648
    buffer_load_dwordx4 v16, s[12:15], s44 offen offset:0 lds
    buffer_load_dwordx4 v17, s[12:15], s44 offen offset:1024 lds
    s_add_u32 m0, s41, 40960
    s_xor_b32 s44, s62, 1310720
    buffer_load_dwordx4 v16, s[12:15], s44 offen offset:0 lds
    buffer_load_dwordx4 v17, s[12:15], s44 offen offset:1024 lds
    s_add_u32 m0, s41, 45056
    s_xor_b32 s44, s62, 1441792
    buffer_load_dwordx4 v16, s[12:15], s44 offen offset:0 lds
    buffer_load_dwordx4 v17, s[12:15], s44 offen offset:1024 lds
    s_add_u32 m0, s41, 49152
    s_xor_b32 s44, s62, 1572864
    buffer_load_dwordx4 v16, s[12:15], s44 offen offset:0 lds
    buffer_load_dwordx4 v17, s[12:15], s44 offen offset:1024 lds
    s_add_u32 m0, s41, 53248
    s_xor_b32 s44, s62, 1703936
    buffer_load_dwordx4 v16, s[12:15], s44 offen offset:0 lds
    buffer_load_dwordx4 v17, s[12:15], s44 offen offset:1024 lds
    s_add_u32 m0, s41, 57344
    s_xor_b32 s44, s62, 1835008
    buffer_load_dwordx4 v16, s[12:15], s44 offen offset:0 lds
    buffer_load_dwordx4 v17, s[12:15], s44 offen offset:1024 lds
    s_add_u32 m0, s41, 61440
    s_xor_b32 s44, s62, 1966080
    buffer_load_dwordx4 v16, s[12:15], s44 offen offset:0 lds
    buffer_load_dwordx4 v17, s[12:15], s44 offen offset:1024 lds
    s_branch s_tail
h_start:
    v_mov_b32 v20, 0
    v_mov_b32 v21, 0
    v_mov_b32 v22, 0
    v_mov_b32 v23, 0
    s_cmp_lt_u32 s2, 10
    s_cbranch_scc0 h_z0
    s_load_dword s101, s[34:35], 192
    s_lshl_b32 s44, s2, 11
    s_mov_b32 s45, 0
    s_mov_b32 s46, 0
    s_mov_b32 s47, 0
    s_mov_b32 s48, 0
    s_mov_b32 s49, 0
    s_mov_b32 s50, 0
    s_mov_b32 s51, 0
    s_mov_b32 s52, 0
    s_mov_b32 s53, 0
    s_mov_b32 s54, 0
    s_mov_b32 s55, 0
    s_mov_b32 s56, 0
    s_mov_b32 s57, 0
    s_mov_b32 s58, 0
    s_mov_b32 s59, 0
    s_mov_b32 s60, 0
    s_atomic_swap s45, s[22:23], s44 offset:0 glc
    s_atomic_swap s46, s[22:23], s44 offset:128 glc
    s_atomic_swap s47, s[22:23], s44 offset:256 glc
    s_atomic_swap s48, s[22:23], s44 offset:384 glc
    s_atomic_swap s49, s[22:23], s44 offset:512 glc
    s_atomic_swap s50, s[22:23], s44 offset:640 glc
    s_atomic_swap s51, s[22:23], s44 offset:768 glc
    s_atomic_swap s52, s[22:23], s44 offset:896 glc
    s_atomic_swap s53, s[22:23], s44 offset:1024 glc
    s_atomic_swap s54, s[22:23], s44 offset:1152 glc
    s_atomic_swap s55, s[22:23], s44 offset:1280 glc
    s_atomic_swap s56, s[22:23], s44 offset:1408 glc
    s_atomic_swap s57, s[22:23], s44 offset:1536 glc
    s_atomic_swap s58, s[22:23], s44 offset:1664 glc
    s_atomic_swap s59, s[22:23], s44 offset:1792 glc
    s_atomic_swap s60, s[22:23], s44 offset:1920 glc
    s_waitcnt lgkmcnt(0)
    s_atomic_add s40, s[34:35], 0
h_z0:
    v_lshrrev_b32 v24, 4, v1
    v_lshrrev_b32 v25, 3, v24
    v_mul_u32_u24 v12, 6144, v25
    v_and_b32 v26, 2, v25
    v_lshrrev_b32 v25, 2, v25
    v_or_b32 v26, v26, v25
    v_bfe_u32 v25, v24, 1, 2
    v_xor_b32 v26, v26, v25
    v_lshl_add_u32 v12, v26, 5, v12
    v_and_b32 v26, 1, v24
    v_lshl_add_u32 v12, v26, 4, v12
    s_lshl_b32 s3, s18, 7
    v_add_u32 v12, s3, v12
    v_add_u32 v13, 48128, v12
    s_mul_i32 s84, s18, 393216
    s_cmp_lt_u32 s18, 4
    s_cselect_b32 s85, 4, 0
    s_mul_i32 s85, s85, 393216
    s_cmp_lt_u32 s18, 4
    s_cselect_b32 s86, 5, 1
    s_mul_i32 s86, s86, 393216
    s_cmp_lt_u32 s18, 4
    s_cselect_b32 s87, 6, 2
    s_mul_i32 s87, s87, 393216
    s_cmp_lt_u32 s18, 4
    s_cselect_b32 s88, 7, 3
    s_mul_i32 s88, s88, 393216
    s_cmp_lt_u32 s18, 8
    s_cselect_b32 s89, 8, 4
    s_mul_i32 s89, s89, 393216
    s_cmp_lt_u32 s18, 8
    s_cselect_b32 s90, 9, 5
    s_mul_i32 s90, s90, 393216
    s_cmp_lt_u32 s18, 8
    s_cselect_b32 s91, 10, 6
    s_mul_i32 s91, s91, 393216
    s_cmp_lt_u32 s18, 8
    s_cselect_b32 s92, 11, 7
    s_mul_i32 s92, s92, 393216
    s_cmp_lt_u32 s18, 12
    s_cselect_b32 s93, 12, 8
    s_mul_i32 s93, s93, 393216
    s_cmp_lt_u32 s18, 12
    s_cselect_b32 s94, 13, 9
    s_mul_i32 s94, s94, 393216
    s_cmp_lt_u32 s18, 12
    s_cselect_b32 s95, 14, 10
    s_mul_i32 s95, s95, 393216
    s_cmp_lt_u32 s18, 12
    s_cselect_b32 s96, 15, 11
    s_mul_i32 s96, s96, 393216
    s_xor_b32 s97, s18, 1
    s_mul_i32 s97, s97, 393216
    s_xor_b32 s98, s18, 2
    s_mul_i32 s98, s98, 393216
    s_xor_b32 s99, s18, 3
    s_mul_i32 s99, s99, 393216
    v_lshrrev_b32 v24, 4, v1
    v_lshrrev_b32 v25, 3, v24
    v_mul_u32_u24 v16, 2048, v25
    v_and_b32 v26, 2, v25
    v_lshrrev_b32 v25, 2, v25
    v_or_b32 v26, v26, v25
    v_bfe_u32 v25, v24, 1, 2
    v_xor_b32 v26, v26, v25
    v_lshl_add_u32 v16, v26, 5, v16
    v_and_b32 v26, 1, v24
    v_lshl_add_u32 v16, v26, 4, v16
    s_lshl_b32 s3, s18, 7
    v_add_u32 v16, s3, v16
    v_add_u32 v17, 15360, v16
    v_add_u32 v18, 30720, v16
    v_add_u32 v19, 46080, v16
    s_and_b32 s3, s16, 3
    s_mul_i32 s3, s3, 49152
    v_add_u32 v11, s3, v12
    s_and_b32 s3, s16, 3
    s_lshl_b32 s3, s3, 10
    v_add_u32 v9, s3, v1
    v_add_u32 v10, 0x10000, v9
    v_lshrrev_b32 v24, 4, v1
    v_and_b32 v25, 15, v24
    v_lshrrev_b32 v24, 4, v24
    v_lshlrev_b32 v24, 2, v24
    v_sub_u32 v24, v25, v24
    v_mov_b32 v25, 0xf149f2ca
    v_add_u32 v26, 0x0, v24
    v_and_b32 v26, 0xfffffff1, v26
    v_cmp_eq_u32 vcc, 0, v26
    s_nop 1
    v_cndmask_b32 v32, v25, 0, vcc
    v_add_u32 v26, 0xffffffff, v24
    v_and_b32 v26, 0xfffffff1, v26
    v_cmp_eq_u32 vcc, 0, v26
    s_nop 1
    v_cndmask_b32 v33, v25, 0, vcc
    v_add_u32 v26, 0xfffffffe, v24
    v_and_b32 v26, 0xfffffff1, v26
    v_cmp_eq_u32 vcc, 0, v26
    s_nop 1
    v_cndmask_b32 v34, v25, 0, vcc
    v_add_u32 v26, 0xfffffffd, v24
    v_and_b32 v26, 0xfffffff1, v26
    v_cmp_eq_u32 vcc, 0, v26
    s_nop 1
    v_cndmask_b32 v35, v25, 0, vcc
    v_add_u32 v26, 0x10, v24
    v_and_b32 v26, 0xfffffff1, v26
    v_cmp_eq_u32 vcc, 0, v26
    s_nop 1
    v_cndmask_b32 v36, v25, 0, vcc
    v_add_u32 v26, 0xf, v24
    v_and_b32 v26, 0xfffffff1, v26
    v_cmp_eq_u32 vcc, 0, v26
    s_nop 1
    v_cndmask_b32 v37, v25, 0, vcc
    v_add_u32 v26, 0xe, v24
    v_and_b32 v26, 0xfffffff1, v26
    v_cmp_eq_u32 vcc, 0, v26
    s_nop 1
    v_cndmask_b32 v38, v25, 0, vcc
    v_add_u32 v26, 0xd, v24
    v_and_b32 v26, 0xfffffff1, v26
    v_cmp_eq_u32 vcc, 0, v26
    s_nop 1
    v_cndmask_b32 v39, v25, 0, vcc
    v_add_u32 v24, 153600, v1
    ds_write_b128 v24, v[32:35] offset:0
    ds_write_b128 v24, v[36:39] offset:1024
    s_waitcnt lgkmcnt(0)
    s_lshl_b32 s44, s21, 14
    s_lshl_b32 s67, s17, 9
    s_add_u32 s44, s44, s67
    s_add_u32 s44, s44, 4096
    s_barrier
    s_barrier
    s_mov_b32 s66, 0x10000
h_s0_poll:
    s_mov_b32 s68, 0
    s_mov_b32 s69, 0
    s_mov_b32 s70, 0
    s_mov_b32 s71, 0
    s_atomic_add s68, s[22:23], s44 offset:0 glc
    s_atomic_add s69, s[22:23], s44 offset:128 glc
    s_atomic_add s70, s[22:23], s44 offset:256 glc
    s_atomic_add s71, s[22:23], s44 offset:384 glc
    s_sub_u32 s66, s66, 1
    s_cselect_b32 s67, 67372036, 0
    s_waitcnt lgkmcnt(0)
    s_and_b32 s68, s68, s69
    s_and_b32 s68, s68, s70
    s_and_b32 s68, s68, s71
    s_max_u32 s68, s68, s67
    s_cmp_lt_u32 s68, 67372036
    s_cbranch_scc1 h_s0_poll
h_s0_ok:
    s_lshr_b32 s3, s2, 3
    s_cmp_eq_u32 s3, 2
    s_cbranch_scc0 h_g4
    s_barrier
    s_mul_i32 s44, s2, 24576
    s_add_u32 s44, s44, 58347520
    s_mov_b32 s45, 24
h_zloop:
    buffer_store_dwordx4 v[20:23], v1, s[4:7], s44 offen sc1
    s_add_u32 s44, s44, 1024
    s_sub_u32 s45, s45, 1
    s_cmp_lg_u32 s45, 0
    s_cbranch_scc1 h_zloop
    s_branch h_g4b
h_layer:
    s_waitcnt lgkmcnt(0)
    s_barrier
h_g4:
    s_barrier
h_g4b:
    s_lshl_b32 s44, s21, 14
    s_lshl_b32 s67, s17, 9
    s_add_u32 s44, s44, s67
    s_add_u32 s44, s44, 12288
    s_mov_b32 s66, 0x10000
h_s_poll:
    s_mov_b32 s68, 0
    s_mov_b32 s69, 0
    s_mov_b32 s70, 0
    s_mov_b32 s71, 0
    s_atomic_add s68, s[22:23], s44 offset:0 glc
    s_atomic_add s69, s[22:23], s44 offset:128 glc
    s_atomic_add s70, s[22:23], s44 offset:256 glc
    s_atomic_add s71, s[22:23], s44 offset:384 glc
    s_sub_u32 s66, s66, 1
    s_cselect_b32 s67, 16, 0
    s_waitcnt lgkmcnt(0)
    s_and_b32 s68, s68, s69
    s_and_b32 s68, s68, s70
    s_and_b32 s68, s68, s71
    s_max_u32 s68, s68, s67
    s_cmp_lt_u32 s68, 16
    s_cbranch_scc1 h_s_poll
h_s_ok:
    s_barrier
    s_lshl_b32 s44, s21, 18
    s_lshl_b32 s45, s17, 14
    s_add_u32 s44, s44, s45
    s_add_u32 s44, s44, 50331648
    buffer_load_dwordx4 v[32:35], v1, s[4:7], s44 offen offset:0 sc1
    buffer_load_dwordx4 v[36:39], v1, s[4:7], s44 offen offset:1024 sc1
    buffer_load_dwordx4 v[40:43], v1, s[4:7], s44 offen offset:2048 sc1
    buffer_load_dwordx4 v[44:47], v1, s[4:7], s44 offen offset:3072 sc1
    s_add_u32 s44, s44, 4096
    buffer_load_dwordx4 v[48:51], v1, s[4:7], s44 offen offset:0 sc1
    buffer_load_dwordx4 v[52:55], v1, s[4:7], s44 offen offset:1024 sc1
    buffer_load_dwordx4 v[56:59], v1, s[4:7], s44 offen offset:2048 sc1
    buffer_load_dwordx4 v[60:63], v1, s[4:7], s44 offen offset:3072 sc1
    s_add_u32 s44, s44, 4096
    buffer_load_dwordx4 v[64:67], v1, s[4:7], s44 offen offset:0 sc1
    buffer_load_dwordx4 v[68:71], v1, s[4:7], s44 offen offset:1024 sc1
    buffer_load_dwordx4 v[72:75], v1, s[4:7], s44 offen offset:2048 sc1
    buffer_load_dwordx4 v[76:79], v1, s[4:7], s44 offen offset:3072 sc1
    s_add_u32 s44, s44, 4096
    buffer_load_dwordx4 v[80:83], v1, s[4:7], s44 offen offset:0 sc1
    buffer_load_dwordx4 v[84:87], v1, s[4:7], s44 offen offset:1024 sc1
    buffer_load_dwordx4 v[88:91], v1, s[4:7], s44 offen offset:2048 sc1
    buffer_load_dwordx4 v[92:95], v1, s[4:7], s44 offen offset:3072 sc1
    s_barrier
    s_cmp_ge_u32 s21, 2
    s_cbranch_scc1 h_c_ok
    s_lshl_b32 s44, s21, 11
    s_lshl_b32 s67, s18, 7
    s_add_u32 s44, s44, s67
    s_add_u32 s44, s44, 0
    s_mov_b32 s66, 0x10000
h_c_poll:
    s_mov_b32 s68, 0
    s_atomic_add s68, s[22:23], s44 offset:0 glc
    s_sub_u32 s66, s66, 1
    s_cselect_b32 s67, 48, 0
    s_waitcnt lgkmcnt(0)
    s_max_u32 s68, s68, s67
    s_cmp_lt_u32 s68, 48
    s_cbranch_scc1 h_c_poll
h_c_ok:
    s_waitcnt vmcnt(0)
    s_lshl_b32 s3, s21, 8
    s_add_u32 s3, s3, s2
    s_lshr_b32 s3, s3, 3
    s_cmp_eq_u32 s3, 2
    s_cbranch_scc0 h_nf1
    s_atomic_add s40, s[34:35], 128
h_nf1:
    s_barrier
    s_cmp_ge_u32 s21, 2
    s_cbranch_scc1 h_cs1
    s_lshl_b32 s44, s21, 18
    s_lshl_b32 s45, s18, 14
    s_add_u32 s44, s44, s45
    s_add_u32 s44, s44, 52428800
    buffer_load_dwordx4 v[96:99], v1, s[4:7], s44 offen offset:0 sc1
    buffer_load_dwordx4 v[100:103], v1, s[4:7], s44 offen offset:1024 sc1
    buffer_load_dwordx4 v[104:107], v1, s[4:7], s44 offen offset:2048 sc1
    buffer_load_dwordx4 v[108:111], v1, s[4:7], s44 offen offset:3072 sc1
    s_add_u32 s44, s44, 4096
    buffer_load_dwordx4 v[112:115], v1, s[4:7], s44 offen offset:0 sc1
    buffer_load_dwordx4 v[116:119], v1, s[4:7], s44 offen offset:1024 sc1
    buffer_load_dwordx4 v[120:123], v1, s[4:7], s44 offen offset:2048 sc1
    buffer_load_dwordx4 v[124:127], v1, s[4:7], s44 offen offset:3072 sc1
    s_add_u32 s44, s44, 4096
    buffer_load_dwordx4 v[128:131], v1, s[4:7], s44 offen offset:0 sc1
    buffer_load_dwordx4 v[132:135], v1, s[4:7], s44 offen offset:1024 sc1
    buffer_load_dwordx4 v[136:139], v1, s[4:7], s44 offen offset:2048 sc1
    buffer_load_dwordx4 v[140:143], v1, s[4:7], s44 offen offset:3072 sc1
    s_add_u32 s44, s44, 4096
    buffer_load_dwordx4 v[144:147], v1, s[4:7], s44 offen offset:0 sc1
    buffer_load_dwordx4 v[148:151], v1, s[4:7], s44 offen offset:1024 sc1
    buffer_load_dwordx4 v[152:155], v1, s[4:7], s44 offen offset:2048 sc1
    buffer_load_dwordx4 v[156:159], v1, s[4:7], s44 offen offset:3072 sc1
h_cs1:
    v_add_f32 v32, v32, v36
    v_add_f32 v33, v33, v37
    v_add_f32 v34, v34, v38
    v_add_f32 v35, v35, v39
    v_add_f32 v48, v48, v52
    v_add_f32 v49, v49, v53
    v_add_f32 v50, v50, v54
    v_add_f32 v51, v51, v55
    v_add_f32 v64, v64, v68
    v_add_f32 v65, v65, v69
    v_add_f32 v66, v66, v70
    v_add_f32 v67, v67, v71
    v_add_f32 v80, v80, v84
    v_add_f32 v81, v81, v85
    v_add_f32 v82, v82, v86
    v_add_f32 v83, v83, v87
    v_add_f32 v32, v32, v40
    v_add_f32 v33, v33, v41
    v_add_f32 v34, v34, v42
    v_add_f32 v35, v35, v43
    v_add_f32 v48, v48, v56
    v_add_f32 v49, v49, v57
    v_add_f32 v50, v50, v58
    v_add_f32 v51, v51, v59
    v_add_f32 v64, v64, v72
    v_add_f32 v65, v65, v73
    v_add_f32 v66, v66, v74
    v_add_f32 v67, v67, v75
    v_add_f32 v80, v80, v88
    v_add_f32 v81, v81, v89
    v_add_f32 v82, v82, v90
    v_add_f32 v83, v83, v91
    s_barrier
    v_add_f32 v32, v32, v44
    v_add_f32 v33, v33, v45
    v_add_f32 v34, v34, v46
    v_add_f32 v35, v35, v47
    v_add_f32 v48, v48, v60
    v_add_f32 v49, v49, v61
    v_add_f32 v50, v50, v62
    v_add_f32 v51, v51, v63
    v_add_f32 v64, v64, v76
    v_add_f32 v65, v65, v77
    v_add_f32 v66, v66, v78
    v_add_f32 v67, v67, v79
    v_add_f32 v80, v80, v92
    v_add_f32 v81, v81, v93
    v_add_f32 v82, v82, v94
    v_add_f32 v83, v83, v95
    v_permlane32_swap_b32 v32, v64
    v_permlane32_swap_b32 v33, v65
    v_permlane32_swap_b32 v34, v66
    v_permlane32_swap_b32 v35, v67
    v_add_f32 v32, v32, v64
    v_add_f32 v33, v33, v65
    v_add_f32 v34, v34, v66
    v_add_f32 v35, v35, v67
    v_permlane32_swap_b32 v48, v80
    v_permlane32_swap_b32 v49, v81
    v_permlane32_swap_b32 v50, v82
    v_permlane32_swap_b32 v51, v83
    v_add_f32 v48, v48, v80
    v_add_f32 v49, v49, v81
    v_add_f32 v50, v50, v82
    v_add_f32 v51, v51, v83
    v_permlane16_swap_b32 v32, v48
    v_permlane16_swap_b32 v33, v49
    v_permlane16_swap_b32 v34, v50
    v_permlane16_swap_b32 v35, v51
    v_add_f32 v32, v32, v48
    v_add_f32 v33, v33, v49
    v_add_f32 v34, v34, v50
    v_add_f32 v35, v35, v51
    s_barrier
    v_mul_f32 v32, 0x3a800000, v32
    v_mul_f32 v33, 0x3a800000, v33
    v_mul_f32 v34, 0x3a800000, v34
    v_mul_f32 v35, 0x3a800000, v35
    v_fma_f32 v33, -v32, v32, v33
    v_fma_f32 v35, -v34, v34, v35
    v_max_f32 v33, 0, v33
    v_max_f32 v35, 0, v35
    v_add_f32 v33, 0x3727c5ac, v33
    v_add_f32 v35, 0x3727c5ac, v35
    v_rsq_f32 v33, v33
    v_rsq_f32 v35, v35
    v_lshrrev_b32 v26, 1, v1
    v_add_u32 v26, 155648, v26
    ds_write2_b32 v26, v32, v34 offset0:0 offset1:1
    ds_write2_b32 v26, v33, v35 offset0:128 offset1:129
    s_barrier
    s_cmp_ge_u32 s21, 2
    s_cbranch_scc1 h_cs_done
    s_waitcnt vmcnt(0)
    v_add_f32 v96, v96, v100
    v_add_f32 v97, v97, v101
    v_add_f32 v98, v98, v102
    v_add_f32 v99, v99, v103
    v_add_f32 v96, v96, v104
    v_add_f32 v97, v97, v105
    v_add_f32 v98, v98, v106
    v_add_f32 v99, v99, v107
    v_add_f32 v96, v96, v108
    v_add_f32 v97, v97, v109
    v_add_f32 v98, v98, v110
    v_add_f32 v99, v99, v111
    v_add_f32 v96, v96, v112
    v_add_f32 v97, v97, v113
    v_add_f32 v98, v98, v114
    v_add_f32 v99, v99, v115
    v_add_f32 v96, v96, v116
    v_add_f32 v97, v97, v117
    v_add_f32 v98, v98, v118
    v_add_f32 v99, v99, v119
    v_add_f32 v96, v96, v120
    v_add_f32 v97, v97, v121
    v_add_f32 v98, v98, v122
    v_add_f32 v99, v99, v123
    v_add_f32 v96, v96, v124
    v_add_f32 v97, v97, v125
    v_add_f32 v98, v98, v126
    v_add_f32 v99, v99, v127
    v_add_f32 v96, v96, v128
    v_add_f32 v97, v97, v129
    v_add_f32 v98, v98, v130
    v_add_f32 v99, v99, v131
    v_add_f32 v96, v96, v132
    v_add_f32 v97, v97, v133
    v_add_f32 v98, v98, v134
    v_add_f32 v99, v99, v135
    v_add_f32 v96, v96, v136
    v_add_f32 v97, v97, v137
    v_add_f32 v98, v98, v138
    v_add_f32 v99, v99, v139
    v_add_f32 v96, v96, v140
    v_add_f32 v97, v97, v141
    v_add_f32 v98, v98, v142
    v_add_f32 v99, v99, v143
    v_add_f32 v96, v96, v144
    v_add_f32 v97, v97, v145
    v_add_f32 v98, v98, v146
    v_add_f32 v99, v99, v147
    v_add_f32 v96, v96, v148
    v_add_f32 v97, v97, v149
    v_add_f32 v98, v98, v150
    v_add_f32 v99, v99, v151
    v_add_f32 v96, v96, v152
    v_add_f32 v97, v97, v153
    v_add_f32 v98, v98, v154
    v_add_f32 v99, v99, v155
    v_add_f32 v96, v96, v156
    v_add_f32 v97, v97, v157
    v_add_f32 v98, v98, v158
    v_add_f32 v99, v99, v159
    s_lshl_b32 s44, s21, 10
    s_add_u32 s44, s44, 151552
    v_add_u32 v24, s44, v1
    ds_write_b128 v24, v[96:99]
h_cs_done:
    s_waitcnt lgkmcnt(0)
    s_barrier
    s_cmp_lg_u32 s21, 0
    s_cbranch_scc1 h_f1_ok
    s_load_dword s68, s[34:35], 128
    s_mov_b32 s8, s34
    s_mov_b32 s9, s35
    s_mov_b32 s10, 256
    s_mov_b32 s11, 0x00020000
    s_mov_b32 s66, 0x10000
    v_mov_b32 v24, 0
    s_waitcnt lgkmcnt(0)
h_f1:
    s_cmp_eq_u32 s68, 8
    s_cbranch_scc1 h_f1_ok
    buffer_load_dword v25, v24, s[8:11], 0 offen offset:128 sc1
    s_waitcnt vmcnt(0)
    v_readfirstlane_b32 s68, v25
    s_sub_u32 s66, s66, 1
    s_cmp_lg_u32 s66, 0
    s_cbranch_scc1 h_f1
h_f1_ok:
    s_barrier
    s_bitcmp1_b32 s21, 0
    s_cselect_b32 s8, s28, s24
    s_cselect_b32 s9, s29, s25
    s_cselect_b32 s12, s30, s26
    s_cselect_b32 s13, s31, s27
    s_mov_b32 s10, 6291456
    s_mov_b32 s11, 0x00020000
    s_mov_b32 s14, 2097152
    s_mov_b32 s15, 0x00020000
    v_lshrrev_b32 v28, 4, v1
    v_and_b32 v29, 7, v28
    v_lshrrev_b32 v28, 3, v28
    v_mul_u32_u24 v28, 2048, v28
    v_lshl_add_u32 v28, v29, 4, v28
    s_and_b32 s3, s18, 12
    s_or_b32 s3, s3, 3
    s_lshl_b32 s3, s3, 7
    v_add_u32 v28, s3, v28
    s_lshr_b32 s3, s2, 3
    s_lshl_b32 s3, s3, 2
    s_and_b32 s60, s16, 3
    s_add_u32 s60, s60, s3
    s_lshl_b32 s61, s60, 14
    buffer_load_dwordx4 v[144:147], v28, s[12:15], s61 offen
    s_bitcmp0_b32 s21, 0
    s_cselect_b32 s56, s28, s24
    s_cselect_b32 s57, s29, s25
    s_mov_b32 s58, 6291456
    s_mov_b32 s59, 0x00020000
    v_lshrrev_b32 v28, 4, v1
    v_and_b32 v29, 7, v28
    v_lshrrev_b32 v28, 3, v28
    v_mul_u32_u24 v28, 6144, v28
    v_lshl_add_u32 v28, v29, 4, v28
    s_and_b32 s3, s18, 12
    s_or_b32 s3, s3, 3
    s_lshl_b32 s3, s3, 7
    v_add_u32 v28, s3, v28
    s_lshr_b32 s3, s2, 3
    s_lshl_b32 s3, s3, 2
    s_and_b32 s60, s16, 3
    s_add_u32 s60, s60, s3
    s_and_b32 s3, s60, 31
    s_mul_i32 s3, s3, 49152
    s_lshr_b32 s61, s60, 5
    s_min_u32 s61, s61, 2
    s_lshl_b32 s61, s61, 11
    s_add_u32 s61, s61, s3
    s_cmp_lt_u32 s18, 4
    s_cselect_b32 s3, 1572864, 0
    s_add_u32 s61, s61, s3
    buffer_load_dwordx4 v[148:151], v28, s[56:59], s61 offen
    s_cmp_lg_u32 s21, 2
    s_cbranch_scc1 h_pe
    s_bitcmp0_b32 s21, 0
    s_cselect_b32 s56, s28, s24
    s_cselect_b32 s57, s29, s25
    s_mov_b32 s58, 6291456
    s_mov_b32 s59, 0x00020000
    s_add_u32 s61, s84, 2048
    buffer_load_dwordx4 v[160:163], v11, s[56:59], s61 offen
    s_add_u32 s61, s84, 4096
    buffer_load_dwordx4 v[164:167], v11, s[56:59], s61 offen
    s_add_u32 s61, s84, 0
    buffer_load_dwordx4 v[168:171], v11, s[56:59], s61 offen
    s_add_u32 s61, s84, 198656
    buffer_load_dwordx4 v[172:175], v11, s[56:59], s61 offen
    s_add_u32 s61, s84, 200704
    buffer_load_dwordx4 v[176:179], v11, s[56:59], s61 offen
    s_add_u32 s61, s84, 196608
    buffer_load_dwordx4 v[180:183], v11, s[56:59], s61 offen
    s_add_u32 s61, s85, 2048
    buffer_load_dwordx4 v[184:187], v11, s[56:59], s61 offen
    s_add_u32 s61, s85, 4096
    buffer_load_dwordx4 v[188:191], v11, s[56:59], s61 offen
    s_add_u32 s61, s85, 0
    buffer_load_dwordx4 v[192:195], v11, s[56:59], s61 offen
    s_add_u32 s61, s85, 198656
    buffer_load_dwordx4 v[196:199], v11, s[56:59], s61 offen
h_pe:
    s_barrier
    s_branch s_tail
z_start:
    v_lshrrev_b32 v24, 4, v1
    v_lshrrev_b32 v25, 3, v24
    v_mul_u32_u24 v20, 6144, v25
    v_and_b32 v25, 7, v24
    v_lshl_add_u32 v20, v25, 4, v20
    s_add_u32 s3, s18, 2
    s_and_b32 s3, s3, 15
    s_lshl_b32 s3, s3, 7
    s_add_u32 s3, s3, 4096
    v_add_u32 v22, s3, v20
    s_add_u32 s3, s18, 1
    s_and_b32 s3, s3, 15
    s_lshl_b32 s3, s3, 7
    s_add_u32 s3, s3, 2048
    v_add_u32 v21, s3, v20
    s_add_u32 s3, s18, 0
    s_and_b32 s3, s3, 15
    s_lshl_b32 s3, s3, 7
    s_add_u32 s3, s3, 0
    v_add_u32 v20, s3, v20
    s_waitcnt lgkmcnt(0)
    s_mov_b32 s8, s24
    s_mov_b32 s9, s25
    s_mov_b32 s10, 6291456
    s_mov_b32 s11, 0x00020000
    s_mul_i32 s44, s17, 393216
    buffer_load_dwordx4 v[32:35], v20, s[8:11], s44 offen
    buffer_load_dwordx4 v[64:67], v21, s[8:11], s44 offen
    buffer_load_dwordx4 v[96:99], v22, s[8:11], s44 offen
    s_add_u32 s44, s44, 49152
    buffer_load_dwordx4 v[36:39], v20, s[8:11], s44 offen
    buffer_load_dwordx4 v[68:71], v21, s[8:11], s44 offen
    buffer_load_dwordx4 v[100:103], v22, s[8:11], s44 offen
    s_add_u32 s44, s44, 49152
    buffer_load_dwordx4 v[40:43], v20, s[8:11], s44 offen
    buffer_load_dwordx4 v[72:75], v21, s[8:11], s44 offen
    buffer_load_dwordx4 v[104:107], v22, s[8:11], s44 offen
    s_add_u32 s44, s44, 49152
    buffer_load_dwordx4 v[44:47], v20, s[8:11], s44 offen
    buffer_load_dwordx4 v[76:79], v21, s[8:11], s44 offen
    buffer_load_dwordx4 v[108:111], v22, s[8:11], s44 offen
    s_add_u32 s44, s44, 49152
    buffer_load_dwordx4 v[48:51], v20, s[8:11], s44 offen
    buffer_load_dwordx4 v[80:83], v21, s[8:11], s44 offen
    buffer_load_dwordx4 v[112:115], v22, s[8:11], s44 offen
    s_add_u32 s44, s44, 49152
    buffer_load_dwordx4 v[52:55], v20, s[8:11], s44 offen
    buffer_load_dwordx4 v[84:87], v21, s[8:11], s44 offen
    buffer_load_dwordx4 v[116:119], v22, s[8:11], s44 offen
    s_add_u32 s44, s44, 49152
    buffer_load_dwordx4 v[56:59], v20, s[8:11], s44 offen
    buffer_load_dwordx4 v[88:91], v21, s[8:11], s44 offen
    buffer_load_dwordx4 v[120:123], v22, s[8:11], s44 offen
    s_add_u32 s44, s44, 49152
    buffer_load_dwordx4 v[60:63], v20, s[8:11], s44 offen
    buffer_load_dwordx4 v[92:95], v21, s[8:11], s44 offen
    buffer_load_dwordx4 v[124:127], v22, s[8:11], s44 offen
    v_lshrrev_b32 v24, 4, v1
    v_lshrrev_b32 v25, 3, v24
    v_mul_u32_u24 v12, 6144, v25
    v_and_b32 v26, 2, v25
    v_lshrrev_b32 v25, 2, v25
    v_or_b32 v26, v26, v25
    v_bfe_u32 v25, v24, 1, 2
    v_xor_b32 v26, v26, v25
    v_lshl_add_u32 v12, v26, 5, v12
    v_and_b32 v26, 1, v24
    v_lshl_add_u32 v12, v26, 4, v12
    s_lshl_b32 s3, s18, 7
    v_add_u32 v12, s3, v12
    v_add_u32 v13, 48128, v12
    s_mul_i32 s84, s18, 393216
    s_cmp_lt_u32 s18, 4
    s_cselect_b32 s85, 4, 0
    s_mul_i32 s85, s85, 393216
    s_cmp_lt_u32 s18, 4
    s_cselect_b32 s86, 5, 1
    s_mul_i32 s86, s86, 393216
    s_cmp_lt_u32 s18, 4
    s_cselect_b32 s87, 6, 2
    s_mul_i32 s87, s87, 393216
    s_cmp_lt_u32 s18, 4
    s_cselect_b32 s88, 7, 3
    s_mul_i32 s88, s88, 393216
    s_cmp_lt_u32 s18, 8
    s_cselect_b32 s89, 8, 4
    s_mul_i32 s89, s89, 393216
    s_cmp_lt_u32 s18, 8
    s_cselect_b32 s90, 9, 5
    s_mul_i32 s90, s90, 393216
    s_cmp_lt_u32 s18, 8
    s_cselect_b32 s91, 10, 6
    s_mul_i32 s91, s91, 393216
    s_cmp_lt_u32 s18, 8
    s_cselect_b32 s92, 11, 7
    s_mul_i32 s92, s92, 393216
    s_cmp_lt_u32 s18, 12
    s_cselect_b32 s93, 12, 8
    s_mul_i32 s93, s93, 393216
    s_cmp_lt_u32 s18, 12
    s_cselect_b32 s94, 13, 9
    s_mul_i32 s94, s94, 393216
    s_cmp_lt_u32 s18, 12
    s_cselect_b32 s95, 14, 10
    s_mul_i32 s95, s95, 393216
    s_cmp_lt_u32 s18, 12
    s_cselect_b32 s96, 15, 11
    s_mul_i32 s96, s96, 393216
    s_xor_b32 s97, s18, 1
    s_mul_i32 s97, s97, 393216
    s_xor_b32 s98, s18, 2
    s_mul_i32 s98, s98, 393216
    s_xor_b32 s99, s18, 3
    s_mul_i32 s99, s99, 393216
    v_lshrrev_b32 v24, 4, v1
    v_lshrrev_b32 v25, 3, v24
    v_mul_u32_u24 v16, 2048, v25
    v_and_b32 v26, 2, v25
    v_lshrrev_b32 v25, 2, v25
    v_or_b32 v26, v26, v25
    v_bfe_u32 v25, v24, 1, 2
    v_xor_b32 v26, v26, v25
    v_lshl_add_u32 v16, v26, 5, v16
    v_and_b32 v26, 1, v24
    v_lshl_add_u32 v16, v26, 4, v16
    s_lshl_b32 s3, s18, 7
    v_add_u32 v16, s3, v16
    v_add_u32 v17, 15360, v16
    v_add_u32 v18, 30720, v16
    v_add_u32 v19, 46080, v16
    s_and_b32 s3, s16, 3
    s_mul_i32 s3, s3, 49152
    v_add_u32 v11, s3, v12
    s_and_b32 s3, s16, 3
    s_lshl_b32 s3, s3, 10
    v_add_u32 v9, s3, v1
    v_add_u32 v10, 0x10000, v9
    s_barrier
    v_lshrrev_b32 v24, 4, v1
    v_and_b32 v25, 1, v24
    v_lshlrev_b32 v25, 4, v25
    v_mov_b32 v26, 0x3f80
    v_lshlrev_b32 v25, v25, v26
    v_bfe_u32 v26, v24, 1, 2
    v_cmp_eq_u32 vcc, 0, v26
    s_nop 1
    v_cndmask_b32 v140, 0, v25, vcc
    v_cmp_eq_u32 vcc, 1, v26
    s_nop 1
    v_cndmask_b32 v141, 0, v25, vcc
    v_cmp_eq_u32 vcc, 2, v26
    s_nop 1
    v_cndmask_b32 v142, 0, v25, vcc
    v_cmp_eq_u32 vcc, 3, v26
    s_nop 1
    v_cndmask_b32 v143, 0, v25, vcc
    v_bfe_u32 v25, v24, 3, 1
    v_lshrrev_b32 v26, 5, v24
    v_lshl_add_u32 v26, v26, 1, v25
    v_lshlrev_b32 v25, 8, v26
    v_and_b32 v27, 7, v24
    v_lshl_add_u32 v25, v27, 5, v25
    v_bfe_u32 v27, v24, 4, 1
    v_lshl_add_u32 v25, v27, 4, v25
    v_add_u32 v27, s18, v26
    v_and_b32 v27, 15, v27
    v_lshl_add_u32 v25, v27, 14, v25
    s_lshl_b32 s44, s17, 10
    s_add_u32 s44, s44, 52428800
    s_waitcnt vmcnt(21)
    v_mfma_f32_16x16x32_bf16 v[128:131], v[140:143], v[32:35], 0
    v_mfma_f32_16x16x32_bf16 v[132:135], v[140:143], v[64:67], 0
    v_mfma_f32_16x16x32_bf16 v[136:139], v[140:143], v[96:99], 0
    s_waitcnt vmcnt(18)
    v_mfma_f32_16x16x32_bf16 v[128:131], v[140:143], v[36:39], v[128:131]
    v_mfma_f32_16x16x32_bf16 v[132:135], v[140:143], v[68:71], v[132:135]
    v_mfma_f32_16x16x32_bf16 v[136:139], v[140:143], v[100:103], v[136:139]
    s_waitcnt vmcnt(15)
    v_mfma_f32_16x16x32_bf16 v[128:131], v[140:143], v[40:43], v[128:131]
    v_mfma_f32_16x16x32_bf16 v[132:135], v[140:143], v[72:75], v[132:135]
    v_mfma_f32_16x16x32_bf16 v[136:139], v[140:143], v[104:107], v[136:139]
    s_waitcnt vmcnt(12)
    v_mfma_f32_16x16x32_bf16 v[128:131], v[140:143], v[44:47], v[128:131]
    v_mfma_f32_16x16x32_bf16 v[132:135], v[140:143], v[76:79], v[132:135]
    v_mfma_f32_16x16x32_bf16 v[136:139], v[140:143], v[108:111], v[136:139]
    s_waitcnt vmcnt(9)
    v_mfma_f32_16x16x32_bf16 v[128:131], v[140:143], v[48:51], v[128:131]
    v_mfma_f32_16x16x32_bf16 v[132:135], v[140:143], v[80:83], v[132:135]
    v_mfma_f32_16x16x32_bf16 v[136:139], v[140:143], v[112:115], v[136:139]
    s_waitcnt vmcnt(6)
    v_mfma_f32_16x16x32_bf16 v[128:131], v[140:143], v[52:55], v[128:131]
    v_mfma_f32_16x16x32_bf16 v[132:135], v[140:143], v[84:87], v[132:135]
    v_mfma_f32_16x16x32_bf16 v[136:139], v[140:143], v[116:119], v[136:139]
    s_waitcnt vmcnt(3)
    v_mfma_f32_16x16x32_bf16 v[128:131], v[140:143], v[56:59], v[128:131]
    v_mfma_f32_16x16x32_bf16 v[132:135], v[140:143], v[88:91], v[132:135]
    v_mfma_f32_16x16x32_bf16 v[136:139], v[140:143], v[120:123], v[136:139]
    s_waitcnt vmcnt(0)
    v_mfma_f32_16x16x32_bf16 v[128:131], v[140:143], v[60:63], v[128:131]
    v_mfma_f32_16x16x32_bf16 v[132:135], v[140:143], v[92:95], v[132:135]
    v_mfma_f32_16x16x32_bf16 v[136:139], v[140:143], v[124:127], v[136:139]
    s_barrier
    v_lshrrev_b32 v28, 4, v1
    v_and_b32 v29, 7, v28
    v_lshrrev_b32 v28, 3, v28
    v_mul_u32_u24 v28, 6144, v28
    v_lshl_add_u32 v28, v29, 4, v28
    s_and_b32 s3, s18, 12
    s_or_b32 s3, s3, 3
    s_lshl_b32 s3, s3, 7
    v_add_u32 v28, s3, v28
    s_lshr_b32 s3, s2, 3
    s_lshl_b32 s3, s3, 2
    s_and_b32 s60, s16, 3
    s_add_u32 s60, s60, s3
    s_lshr_b32 s60, s60, 2
    s_mul_i32 s60, s60, 49152
    s_cmp_lt_u32 s18, 4
    s_cselect_b32 s3, 0, 1
    s_mul_i32 s3, s3, 1572864
    s_add_u32 s3, s3, s60
    s_add_u32 s61, s3, 0
    buffer_load_dwordx4 v[160:163], v28, s[8:11], s61 offen
    s_add_u32 s61, s3, 2048
    buffer_load_dwordx4 v[164:167], v28, s[8:11], s61 offen
    s_add_u32 s61, s3, 4096
    buffer_load_dwordx4 v[168:171], v28, s[8:11], s61 offen
    s_add_u32 s3, s60, 3145728
    s_add_u32 s61, s3, 0
    buffer_load_dwordx4 v[172:175], v28, s[8:11], s61 offen
    s_add_u32 s61, s3, 2048
    buffer_load_dwordx4 v[176:179], v28, s[8:11], s61 offen
    s_add_u32 s61, s3, 4096
    buffer_load_dwordx4 v[180:183], v28, s[8:11], s61 offen
    s_add_u32 s3, s60, 4718592
    s_add_u32 s61, s3, 0
    buffer_load_dwordx4 v[184:187], v28, s[8:11], s61 offen
    s_add_u32 s61, s3, 2048
    buffer_load_dwordx4 v[188:191], v28, s[8:11], s61 offen
    s_add_u32 s61, s3, 4096
    buffer_load_dwordx4 v[192:195], v28, s[8:11], s61 offen
    v_add_f32_dpp v128, v128, v128 row_ror:8 row_mask:0xf bank_mask:0xf
    v_add_f32_dpp v129, v129, v129 row_ror:8 row_mask:0xf bank_mask:0xf
    v_add_f32_dpp v130, v130, v130 row_ror:8 row_mask:0xf bank_mask:0xf
    v_add_f32_dpp v131, v131, v131 row_ror:8 row_mask:0xf bank_mask:0xf
    v_add_f32_dpp v132, v132, v132 row_ror:8 row_mask:0xf bank_mask:0xf
    v_add_f32_dpp v133, v133, v133 row_ror:8 row_mask:0xf bank_mask:0xf
    v_add_f32_dpp v134, v134, v134 row_ror:8 row_mask:0xf bank_mask:0xf
    v_add_f32_dpp v135, v135, v135 row_ror:8 row_mask:0xf bank_mask:0xf
    v_add_f32_dpp v136, v136, v136 row_ror:8 row_mask:0xf bank_mask:0xf
    v_add_f32_dpp v137, v137, v137 row_ror:8 row_mask:0xf bank_mask:0xf
    v_add_f32_dpp v138, v138, v138 row_ror:8 row_mask:0xf bank_mask:0xf
    v_add_f32_dpp v139, v139, v139 row_ror:8 row_mask:0xf bank_mask:0xf
    v_cmp_le_u32 vcc, 1, v26
    s_nop 1
    v_cndmask_b32 v128, v128, v132, vcc
    v_cndmask_b32 v129, v129, v133, vcc
    v_cndmask_b32 v130, v130, v134, vcc
    v_cndmask_b32 v131, v131, v135, vcc
    v_cmp_le_u32 vcc, 2, v26
    s_nop 1
    v_cndmask_b32 v128, v128, v136, vcc
    v_cndmask_b32 v129, v129, v137, vcc
    v_cndmask_b32 v130, v130, v138, vcc
    v_cndmask_b32 v131, v131, v139, vcc
    buffer_store_dwordx4 v[128:131], v25, s[4:7], s44 offen sc1
    s_barrier
    s_barrier
    s_waitcnt vmcnt(0)
    s_add_u32 s44, s18, 0
    s_and_b32 s44, s44, 15
    s_lshl_b32 s44, s44, 7
    s_add_u32 s44, s44, 0
    s_atomic_add s40, s[22:23], s44
    s_add_u32 s45, s18, 1
    s_and_b32 s45, s45, 15
    s_lshl_b32 s45, s45, 7
    s_add_u32 s45, s45, 0
    s_atomic_add s40, s[22:23], s45
    s_add_u32 s46, s18, 2
    s_and_b32 s46, s46, 15
    s_lshl_b32 s46, s46, 7
    s_add_u32 s46, s46, 0
    s_atomic_add s40, s[22:23], s46
    s_barrier
    s_barrier
    s_barrier
    s_barrier
    s_barrier
    s_barrier
    s_mov_b32 s12, s26
    s_mov_b32 s13, s27
    s_mov_b32 s14, 2097152
    s_mov_b32 s15, 0x00020000
    s_lshl_b32 s44, s2, 13
    buffer_load_dwordx4 v[160:163], v1, s[12:15], s44 offen offset:0
    buffer_load_dwordx4 v[164:167], v1, s[12:15], s44 offen offset:1024
    buffer_load_dwordx4 v[168:171], v1, s[12:15], s44 offen offset:2048
    buffer_load_dwordx4 v[172:175], v1, s[12:15], s44 offen offset:3072
    s_add_u32 s44, s44, 4096
    buffer_load_dwordx4 v[176:179], v1, s[12:15], s44 offen offset:0
    buffer_load_dwordx4 v[180:183], v1, s[12:15], s44 offen offset:1024
    buffer_load_dwordx4 v[184:187], v1, s[12:15], s44 offen offset:2048
    buffer_load_dwordx4 v[188:191], v1, s[12:15], s44 offen offset:3072
    s_mov_b32 s8, s28
    s_mov_b32 s9, s29
    s_mov_b32 s10, 6291456
    s_mov_b32 s11, 0x00020000
    s_mul_i32 s44, s17, 393216
    buffer_load_dwordx4 v[32:35], v20, s[8:11], s44 offen
    buffer_load_dwordx4 v[64:67], v21, s[8:11], s44 offen
    buffer_load_dwordx4 v[96:99], v22, s[8:11], s44 offen
    s_add_u32 s44, s44, 49152
    buffer_load_dwordx4 v[36:39], v20, s[8:11], s44 offen
    buffer_load_dwordx4 v[68:71], v21, s[8:11], s44 offen
    buffer_load_dwordx4 v[100:103], v22, s[8:11], s44 offen
    s_add_u32 s44, s44, 49152
    buffer_load_dwordx4 v[40:43], v20, s[8:11], s44 offen
    buffer_load_dwordx4 v[72:75], v21, s[8:11], s44 offen
    buffer_load_dwordx4 v[104:107], v22, s[8:11], s44 offen
    s_add_u32 s44, s44, 49152
    s_barrier
    buffer_load_dwordx4 v[44:47], v20, s[8:11], s44 offen
    buffer_load_dwordx4 v[76:79], v21, s[8:11], s44 offen
    buffer_load_dwordx4 v[108:111], v22, s[8:11], s44 offen
    s_add_u32 s44, s44, 49152
    buffer_load_dwordx4 v[48:51], v20, s[8:11], s44 offen
    buffer_load_dwordx4 v[80:83], v21, s[8:11], s44 offen
    buffer_load_dwordx4 v[112:115], v22, s[8:11], s44 offen
    s_add_u32 s44, s44, 49152
    buffer_load_dwordx4 v[52:55], v20, s[8:11], s44 offen
    buffer_load_dwordx4 v[84:87], v21, s[8:11], s44 offen
    buffer_load_dwordx4 v[116:119], v22, s[8:11], s44 offen
    s_add_u32 s44, s44, 49152
    buffer_load_dwordx4 v[56:59], v20, s[8:11], s44 offen
    buffer_load_dwordx4 v[88:91], v21, s[8:11], s44 offen
    buffer_load_dwordx4 v[120:123], v22, s[8:11], s44 offen
    s_add_u32 s44, s44, 49152
    buffer_load_dwordx4 v[60:63], v20, s[8:11], s44 offen
    buffer_load_dwordx4 v[92:95], v21, s[8:11], s44 offen
    buffer_load_dwordx4 v[124:127], v22, s[8:11], s44 offen
    s_barrier
    s_bitcmp1_b32 s21, 0
    s_cselect_b32 s8, s28, s24
    s_cselect_b32 s9, s29, s25
    s_cselect_b32 s12, s30, s26
    s_cselect_b32 s13, s31, s27
    s_mov_b32 s10, 6291456
    s_mov_b32 s11, 0x00020000
    s_mov_b32 s14, 2097152
    s_mov_b32 s15, 0x00020000
    s_branch s_tail
z_layer:
    s_waitcnt lgkmcnt(0)
    v_lshrrev_b32 v28, 4, v1
    v_and_b32 v29, 7, v28
    v_lshrrev_b32 v28, 3, v28
    v_mul_u32_u24 v28, 6144, v28
    v_lshl_add_u32 v28, v29, 4, v28
    s_and_b32 s3, s18, 12
    s_or_b32 s3, s3, 3
    s_lshl_b32 s3, s3, 7
    v_add_u32 v28, s3, v28
    s_lshr_b32 s3, s2, 3
    s_lshl_b32 s3, s3, 2
    s_and_b32 s60, s16, 3
    s_add_u32 s60, s60, s3
    s_lshr_b32 s60, s60, 2
    s_mul_i32 s60, s60, 49152
    s_cmp_lt_u32 s18, 4
    s_cselect_b32 s3, 0, 1
    s_mul_i32 s3, s3, 1572864
    s_add_u32 s3, s3, s60
    s_add_u32 s61, s3, 0
    buffer_load_dwordx4 v[160:163], v28, s[8:11], s61 offen
    s_add_u32 s61, s3, 2048
    buffer_load_dwordx4 v[164:167], v28, s[8:11], s61 offen
    s_add_u32 s61, s3, 4096
    buffer_load_dwordx4 v[168:171], v28, s[8:11], s61 offen
    s_add_u32 s3, s60, 3145728
    s_add_u32 s61, s3, 0
    buffer_load_dwordx4 v[172:175], v28, s[8:11], s61 offen
    s_add_u32 s61, s3, 2048
    buffer_load_dwordx4 v[176:179], v28, s[8:11], s61 offen
    s_add_u32 s61, s3, 4096
    buffer_load_dwordx4 v[180:183], v28, s[8:11], s61 offen
    s_add_u32 s3, s60, 4718592
    s_add_u32 s61, s3, 0
    buffer_load_dwordx4 v[184:187], v28, s[8:11], s61 offen
    s_add_u32 s61, s3, 2048
    buffer_load_dwordx4 v[188:191], v28, s[8:11], s61 offen
    s_add_u32 s61, s3, 4096
    buffer_load_dwordx4 v[192:195], v28, s[8:11], s61 offen
    s_barrier
    s_barrier
    s_barrier
    s_barrier
    s_barrier
    s_barrier
    s_barrier
    s_barrier
    s_barrier
    s_barrier
    v_lshrrev_b32 v28, 4, v1
    v_and_b32 v29, 7, v28
    v_lshrrev_b32 v28, 3, v28
    v_mul_u32_u24 v28, 2048, v28
    v_lshl_add_u32 v28, v29, 4, v28
    s_and_b32 s3, s18, 12
    s_or_b32 s3, s3, 3
    s_lshl_b32 s3, s3, 7
    v_add_u32 v28, s3, v28
    s_lshr_b32 s3, s2, 3
    s_lshl_b32 s3, s3, 2
    s_and_b32 s60, s16, 3
    s_add_u32 s60, s60, s3
    s_lshl_b32 s61, s60, 14
    buffer_load_dwordx4 v[144:147], v28, s[12:15], s61 offen
    s_bitcmp0_b32 s21, 0
    s_cselect_b32 s56, s28, s24
    s_cselect_b32 s57, s29, s25
    s_mov_b32 s58, 6291456
    s_mov_b32 s59, 0x00020000
    v_lshrrev_b32 v28, 4, v1
    v_and_b32 v29, 7, v28
    v_lshrrev_b32 v28, 3, v28
    v_mul_u32_u24 v28, 6144, v28
    v_lshl_add_u32 v28, v29, 4, v28
    s_and_b32 s3, s18, 12
    s_or_b32 s3, s3, 3
    s_lshl_b32 s3, s3, 7
    v_add_u32 v28, s3, v28
    s_lshr_b32 s3, s2, 3
    s_lshl_b32 s3, s3, 2
    s_and_b32 s60, s16, 3
    s_add_u32 s60, s60, s3
    s_and_b32 s3, s60, 31
    s_mul_i32 s3, s3, 49152
    s_lshr_b32 s61, s60, 5
    s_min_u32 s61, s61, 2
    s_lshl_b32 s61, s61, 11
    s_add_u32 s61, s61, s3
    s_cmp_lt_u32 s18, 4
    s_cselect_b32 s3, 1572864, 0
    s_add_u32 s61, s61, s3
    buffer_load_dwordx4 v[148:151], v28, s[56:59], s61 offen
    s_cmp_lg_u32 s21, 2
    s_cbranch_scc1 z_pe
    s_bitcmp0_b32 s21, 0
    s_cselect_b32 s56, s28, s24
    s_cselect_b32 s57, s29, s25
    s_mov_b32 s58, 6291456
    s_mov_b32 s59, 0x00020000
    s_add_u32 s61, s84, 2048
    buffer_load_dwordx4 v[160:163], v11, s[56:59], s61 offen
    s_add_u32 s61, s84, 4096
    buffer_load_dwordx4 v[164:167], v11, s[56:59], s61 offen
    s_add_u32 s61, s84, 0
    buffer_load_dwordx4 v[168:171], v11, s[56:59], s61 offen
    s_add_u32 s61, s84, 198656
    buffer_load_dwordx4 v[172:175], v11, s[56:59], s61 offen
    s_add_u32 s61, s84, 200704
    buffer_load_dwordx4 v[176:179], v11, s[56:59], s61 offen
    s_add_u32 s61, s84, 196608
    buffer_load_dwordx4 v[180:183], v11, s[56:59], s61 offen
    s_add_u32 s61, s85, 2048
    buffer_load_dwordx4 v[184:187], v11, s[56:59], s61 offen
    s_add_u32 s61, s85, 4096
    buffer_load_dwordx4 v[188:191], v11, s[56:59], s61 offen
    s_add_u32 s61, s85, 0
    buffer_load_dwordx4 v[192:195], v11, s[56:59], s61 offen
    s_add_u32 s61, s85, 198656
    buffer_load_dwordx4 v[196:199], v11, s[56:59], s61 offen
z_pe:
    s_barrier
    s_branch s_tail
s_tail:
    s_bitcmp1_b32 s21, 0
    s_cbranch_scc1 s_B
    s_cmp_lg_u32 s16, 4
    s_cbranch_scc1 s_a1
    s_mov_b32 s45, 2146435072
    s_cmp_eq_u32 s17, 0
    s_cbranch_scc1 s_a0
    s_lshr_b32 s46, s21, 1
    s_lshl_b32 s44, s46, 15
    s_lshl_b32 s67, s17, 11
    s_add_u32 s44, s44, s67
    s_lshl_b32 s67, s18, 7
    s_add_u32 s44, s44, s67
    s_add_u32 s44, s44, 149504
    s_sub_u32 s45, s44, 151552
    s_lshl_b32 s45, s45, 5
    s_add_u32 s45, s45, 54525952
    s_mov_b32 s66, 0x10000
s_h_poll:
    s_mov_b32 s68, 0
    s_atomic_add s68, s[22:23], s44 offset:0 glc
    s_sub_u32 s66, s66, 1
    s_cselect_b32 s67, 1, 0
    s_waitcnt lgkmcnt(0)
    s_max_u32 s68, s68, s67
    s_cmp_lt_u32 s68, 1
    s_cbranch_scc1 s_h_poll
s_h_ok:
s_a0:
    s_mov_b32 m0, 131072
    s_nop 0
    buffer_load_dwordx4 v1, s[4:7], s45 offen offset:0 sc1 lds
    buffer_load_dwordx4 v1, s[4:7], s45 offen offset:1024 sc1 lds
    buffer_load_dwordx4 v1, s[4:7], s45 offen offset:2048 sc1 lds
    buffer_load_dwordx4 v1, s[4:7], s45 offen offset:3072 sc1 lds
    s_waitcnt vmcnt(0)
s_a1:
    s_barrier
    s_waitcnt vmcnt(0)
    s_barrier
    s_sub_u32 s3, s16, 5
    s_cmp_gt_u32 s3, 1
    s_cbranch_scc1 s_a2
    s_add_u32 m0, s41, 65536
    s_xor_b32 s44, s62, 65536
    buffer_load_dwordx4 v16, s[12:15], s44 offen offset:0 lds
    buffer_load_dwordx4 v17, s[12:15], s44 offen offset:1024 lds
    s_add_u32 m0, s41, 69632
    s_xor_b32 s44, s62, 196608
    buffer_load_dwordx4 v16, s[12:15], s44 offen offset:0 lds
    buffer_load_dwordx4 v17, s[12:15], s44 offen offset:1024 lds
    s_add_u32 m0, s41, 73728
    s_xor_b32 s44, s62, 327680
    buffer_load_dwordx4 v16, s[12:15], s44 offen offset:0 lds
    buffer_load_dwordx4 v17, s[12:15], s44 offen offset:1024 lds
    s_add_u32 m0, s41, 77824
    s_xor_b32 s44, s62, 458752
    buffer_load_dwordx4 v16, s[12:15], s44 offen offset:0 lds
    buffer_load_dwordx4 v17, s[12:15], s44 offen offset:1024 lds
    s_add_u32 m0, s41, 81920
    s_xor_b32 s44, s62, 589824
    buffer_load_dwordx4 v16, s[12:15], s44 offen offset:0 lds
    buffer_load_dwordx4 v17, s[12:15], s44 offen offset:1024 lds
    s_add_u32 m0, s41, 86016
    s_xor_b32 s44, s62, 720896
    buffer_load_dwordx4 v16, s[12:15], s44 offen offset:0 lds
    buffer_load_dwordx4 v17, s[12:15], s44 offen offset:1024 lds
    s_add_u32 m0, s41, 90112
    s_xor_b32 s44, s62, 851968
    buffer_load_dwordx4 v16, s[12:15], s44 offen offset:0 lds
    buffer_load_dwordx4 v17, s[12:15], s44 offen offset:1024 lds
    s_add_u32 m0, s41, 94208
    s_xor_b32 s44, s62, 983040
    buffer_load_dwordx4 v16, s[12:15], s44 offen offset:0 lds
    buffer_load_dwordx4 v17, s[12:15], s44 offen offset:1024 lds
    s_add_u32 m0, s41, 98304
    s_xor_b32 s44, s62, 1114112
    buffer_load_dwordx4 v16, s[12:15], s44 offen offset:0 lds
    buffer_load_dwordx4 v17, s[12:15], s44 offen offset:1024 lds
    s_add_u32 m0, s41, 102400
    s_xor_b32 s44, s62, 1245184
    buffer_load_dwordx4 v16, s[12:15], s44 offen offset:0 lds
    buffer_load_dwordx4 v17, s[12:15], s44 offen offset:1024 lds
    s_add_u32 m0, s41, 106496
    s_xor_b32 s44, s62, 1376256
    buffer_load_dwordx4 v16, s[12:15], s44 offen offset:0 lds
    buffer_load_dwordx4 v17, s[12:15], s44 offen offset:1024 lds
    s_add_u32 m0, s41, 110592
    s_xor_b32 s44, s62, 1507328
    buffer_load_dwordx4 v16, s[12:15], s44 offen offset:0 lds
    buffer_load_dwordx4 v17, s[12:15], s44 offen offset:1024 lds
    s_add_u32 m0, s41, 114688
    s_xor_b32 s44, s62, 1638400
    buffer_load_dwordx4 v16, s[12:15], s44 offen offset:0 lds
    buffer_load_dwordx4 v17, s[12:15], s44 offen offset:1024 lds
    s_add_u32 m0, s41, 118784
    s_xor_b32 s44, s62, 1769472
    buffer_load_dwordx4 v16, s[12:15], s44 offen offset:0 lds
    buffer_load_dwordx4 v17, s[12:15], s44 offen offset:1024 lds
    s_add_u32 m0, s41, 122880
    s_xor_b32 s44, s62, 1900544
    buffer_load_dwordx4 v16, s[12:15], s44 offen offset:0 lds
    buffer_load_dwordx4 v17, s[12:15], s44 offen offset:1024 lds
    s_add_u32 m0, s41, 126976
    s_xor_b32 s44, s62, 2031616
    buffer_load_dwordx4 v16, s[12:15], s44 offen offset:0 lds
    buffer_load_dwordx4 v17, s[12:15], s44 offen offset:1024 lds
s_a2:
    s_cmp_eq_u32 s21, 2
    s_cbranch_scc1 s_a3
    s_bitcmp0_b32 s21, 0
    s_cselect_b32 s56, s28, s24
    s_cselect_b32 s57, s29, s25
    s_mov_b32 s58, 6291456
    s_mov_b32 s59, 0x00020000
    s_add_u32 s61, s84, 2048
    buffer_load_dwordx4 v[160:163], v11, s[56:59], s61 offen
    s_add_u32 s61, s84, 4096
    buffer_load_dwordx4 v[164:167], v11, s[56:59], s61 offen
    s_add_u32 s61, s84, 0
    buffer_load_dwordx4 v[168:171], v11, s[56:59], s61 offen
    s_add_u32 s61, s84, 198656
    buffer_load_dwordx4 v[172:175], v11, s[56:59], s61 offen
    s_add_u32 s61, s84, 200704
    buffer_load_dwordx4 v[176:179], v11, s[56:59], s61 offen
    s_add_u32 s61, s84, 196608
    buffer_load_dwordx4 v[180:183], v11, s[56:59], s61 offen
    s_add_u32 s61, s85, 2048
    buffer_load_dwordx4 v[184:187], v11, s[56:59], s61 offen
    s_add_u32 s61, s85, 4096
    buffer_load_dwordx4 v[188:191], v11, s[56:59], s61 offen
    s_add_u32 s61, s85, 0
    buffer_load_dwordx4 v[192:195], v11, s[56:59], s61 offen
    s_add_u32 s61, s85, 198656
    buffer_load_dwordx4 v[196:199], v11, s[56:59], s61 offen
s_a3:
    s_bitcmp0_b32 s21, 0
    s_cselect_b32 s56, s28, s24
    s_cselect_b32 s57, s29, s25
    s_mov_b32 s58, 6291456
    s_mov_b32 s59, 0x00020000
    s_add_u32 s61, s85, 200704
    buffer_load_dwordx4 v[200:203], v11, s[56:59], s61 offen
    s_add_u32 s61, s85, 196608
    buffer_load_dwordx4 v[204:207], v11, s[56:59], s61 offen
    s_add_u32 s61, s86, 2048
    buffer_load_dwordx4 v[208:211], v11, s[56:59], s61 offen
    s_add_u32 s61, s86, 4096
    buffer_load_dwordx4 v[212:215], v11, s[56:59], s61 offen
    s_add_u32 s61, s86, 0
    buffer_load_dwordx4 v[216:219], v11, s[56:59], s61 offen
    s_add_u32 s61, s86, 198656
    buffer_load_dwordx4 v[220:223], v11, s[56:59], s61 offen
    s_add_u32 s61, s86, 200704
    buffer_load_dwordx4 v[224:227], v11, s[56:59], s61 offen
    s_add_u32 s61, s86, 196608
    buffer_load_dwordx4 v[228:231], v11, s[56:59], s61 offen
    s_add_u32 s61, s87, 2048
    buffer_load_dwordx4 v[232:235], v11, s[56:59], s61 offen
    s_add_u32 s61, s87, 4096
    buffer_load_dwordx4 v[236:239], v11, s[56:59], s61 offen
    s_add_u32 s61, s87, 0
    buffer_load_dwordx4 v[240:243], v11, s[56:59], s61 offen
    s_add_u32 s61, s87, 198656
    buffer_load_dwordx4 v[244:247], v11, s[56:59], s61 offen
    s_add_u32 s61, s87, 200704
    buffer_load_dwordx4 v[248:251], v11, s[56:59], s61 offen
    s_add_u32 s61, s87, 196608
    buffer_load_dwordx4 v[252:255], v11, s[56:59], s61 offen
    s_waitcnt vmcnt(0)
    s_lshl_b32 s3, s21, 3
    s_add_u32 s3, s3, s16
    s_cmp_lg_u32 s3, 7
    s_cbranch_scc1 s_g3
    v_lshrrev_b32 v24, 4, v1
    v_and_b32 v25, 1, v24
    v_lshlrev_b32 v25, 4, v25
    v_mov_b32 v26, 0x3f80
    v_lshlrev_b32 v25, v25, v26
    v_bfe_u32 v26, v24, 1, 2
    v_cmp_eq_u32 vcc, 0, v26
    s_nop 1
    v_cndmask_b32 v140, 0, v25, vcc
    v_cmp_eq_u32 vcc, 1, v26
    s_nop 1
    v_cndmask_b32 v141, 0, v25, vcc
    v_cmp_eq_u32 vcc, 2, v26
    s_nop 1
    v_cndmask_b32 v142, 0, v25, vcc
    v_cmp_eq_u32 vcc, 3, v26
    s_nop 1
    v_cndmask_b32 v143, 0, v25, vcc
    v_bfe_u32 v25, v24, 3, 1
    v_lshrrev_b32 v26, 5, v24
    v_lshl_add_u32 v26, v26, 1, v25
    v_lshlrev_b32 v25, 8, v26
    v_and_b32 v27, 7, v24
    v_lshl_add_u32 v25, v27, 5, v25
    v_bfe_u32 v27, v24, 4, 1
    v_lshl_add_u32 v25, v27, 4, v25
    v_add_u32 v27, s18, v26
    v_and_b32 v27, 15, v27
    v_lshl_add_u32 v25, v27, 14, v25
    s_lshl_b32 s44, s17, 10
    s_add_u32 s44, s44, 52690944
    v_mfma_f32_16x16x32_bf16 v[128:131], v[140:143], v[32:35], 0
    v_mfma_f32_16x16x32_bf16 v[132:135], v[140:143], v[64:67], 0
    v_mfma_f32_16x16x32_bf16 v[136:139], v[140:143], v[96:99], 0
    v_mfma_f32_16x16x32_bf16 v[128:131], v[140:143], v[36:39], v[128:131]
    v_mfma_f32_16x16x32_bf16 v[132:135], v[140:143], v[68:71], v[132:135]
    v_mfma_f32_16x16x32_bf16 v[136:139], v[140:143], v[100:103], v[136:139]
    v_mfma_f32_16x16x32_bf16 v[128:131], v[140:143], v[40:43], v[128:131]
    v_mfma_f32_16x16x32_bf16 v[132:135], v[140:143], v[72:75], v[132:135]
    v_mfma_f32_16x16x32_bf16 v[136:139], v[140:143], v[104:107], v[136:139]
    v_mfma_f32_16x16x32_bf16 v[128:131], v[140:143], v[44:47], v[128:131]
    v_mfma_f32_16x16x32_bf16 v[132:135], v[140:143], v[76:79], v[132:135]
    v_mfma_f32_16x16x32_bf16 v[136:139], v[140:143], v[108:111], v[136:139]
    v_mfma_f32_16x16x32_bf16 v[128:131], v[140:143], v[48:51], v[128:131]
    v_mfma_f32_16x16x32_bf16 v[132:135], v[140:143], v[80:83], v[132:135]
    v_mfma_f32_16x16x32_bf16 v[136:139], v[140:143], v[112:115], v[136:139]
    v_mfma_f32_16x16x32_bf16 v[128:131], v[140:143], v[52:55], v[128:131]
    v_mfma_f32_16x16x32_bf16 v[132:135], v[140:143], v[84:87], v[132:135]
    v_mfma_f32_16x16x32_bf16 v[136:139], v[140:143], v[116:119], v[136:139]
    v_mfma_f32_16x16x32_bf16 v[128:131], v[140:143], v[56:59], v[128:131]
    v_mfma_f32_16x16x32_bf16 v[132:135], v[140:143], v[88:91], v[132:135]
    v_mfma_f32_16x16x32_bf16 v[136:139], v[140:143], v[120:123], v[136:139]
    v_mfma_f32_16x16x32_bf16 v[128:131], v[140:143], v[60:63], v[128:131]
    v_mfma_f32_16x16x32_bf16 v[132:135], v[140:143], v[92:95], v[132:135]
    v_mfma_f32_16x16x32_bf16 v[136:139], v[140:143], v[124:127], v[136:139]
    s_nop 5
    v_add_f32_dpp v128, v128, v128 row_ror:8 row_mask:0xf bank_mask:0xf
    v_add_f32_dpp v129, v129, v129 row_ror:8 row_mask:0xf bank_mask:0xf
    v_add_f32_dpp v130, v130, v130 row_ror:8 row_mask:0xf bank_mask:0xf
    v_add_f32_dpp v131, v131, v131 row_ror:8 row_mask:0xf bank_mask:0xf
    v_add_f32_dpp v132, v132, v132 row_ror:8 row_mask:0xf bank_mask:0xf
    v_add_f32_dpp v133, v133, v133 row_ror:8 row_mask:0xf bank_mask:0xf
    v_add_f32_dpp v134, v134, v134 row_ror:8 row_mask:0xf bank_mask:0xf
    v_add_f32_dpp v135, v135, v135 row_ror:8 row_mask:0xf bank_mask:0xf
    v_add_f32_dpp v136, v136, v136 row_ror:8 row_mask:0xf bank_mask:0xf
    v_add_f32_dpp v137, v137, v137 row_ror:8 row_mask:0xf bank_mask:0xf
    v_add_f32_dpp v138, v138, v138 row_ror:8 row_mask:0xf bank_mask:0xf
    v_add_f32_dpp v139, v139, v139 row_ror:8 row_mask:0xf bank_mask:0xf
    v_cmp_le_u32 vcc, 1, v26
    s_nop 1
    v_cndmask_b32 v128, v128, v132, vcc
    v_cndmask_b32 v129, v129, v133, vcc
    v_cndmask_b32 v130, v130, v134, vcc
    v_cndmask_b32 v131, v131, v135, vcc
    v_cmp_le_u32 vcc, 2, v26
    s_nop 1
    v_cndmask_b32 v128, v128, v136, vcc
    v_cndmask_b32 v129, v129, v137, vcc
    v_cndmask_b32 v130, v130, v138, vcc
    v_cndmask_b32 v131, v131, v139, vcc
    buffer_store_dwordx4 v[128:131], v25, s[4:7], s44 offen sc1
    s_waitcnt vmcnt(0)
    s_add_u32 s44, s18, 0
    s_and_b32 s44, s44, 15
    s_lshl_b32 s44, s44, 7
    s_add_u32 s44, s44, 2048
    s_atomic_add s40, s[22:23], s44
    s_add_u32 s45, s18, 1
    s_and_b32 s45, s45, 15
    s_lshl_b32 s45, s45, 7
    s_add_u32 s45, s45, 2048
    s_atomic_add s40, s[22:23], s45
    s_add_u32 s46, s18, 2
    s_and_b32 s46, s46, 15
    s_lshl_b32 s46, s46, 7
    s_add_u32 s46, s46, 2048
    s_atomic_add s40, s[22:23], s46
    s_branch s_g3
s_B:
    s_lshr_b32 s49, s21, 1
    s_lshl_b32 s53, s49, 23
    s_lshl_b32 s50, s18, 18
    s_add_u32 s53, s53, s50
    s_add_u32 s53, s53, 33554432
    s_lshl_b32 s54, s38, 11
    s_add_u32 s55, s53, s54
    s_add_u32 s56, s55, 4194304
    s_lshl_b32 s59, s49, 13
    s_lshl_b32 s67, s18, 9
    s_add_u32 s59, s59, s67
    s_lshl_b32 s67, s16, 7
    s_add_u32 s59, s59, s67
    s_add_u32 s59, s59, 69120
    v_add_u32 v4, 131072, v1
    s_mov_b32 s68, 0
    s_mov_b32 s39, 0
    s_barrier
    buffer_load_dwordx4 v[64:67], v1, s[4:7], s55 offen offset:0 sc1
    buffer_load_dwordx4 v[68:71], v1, s[4:7], s55 offen offset:1024 sc1
    buffer_load_dwordx4 v[72:75], v1, s[4:7], s56 offen offset:0 sc1
    buffer_load_dwordx4 v[76:79], v1, s[4:7], s56 offen offset:1024 sc1
    s_atomic_add s68, s[22:23], s59 glc
    s_setprio 3
    s_branch b_att
s_att_done:
    s_waitcnt lgkmcnt(0)
    v_lshrrev_b32 v24, 4, v1
    v_lshrrev_b32 v25, 3, v24
    v_mul_u32_u24 v12, 6144, v25
    v_and_b32 v26, 2, v25
    v_lshrrev_b32 v25, 2, v25
    v_or_b32 v26, v26, v25
    v_bfe_u32 v25, v24, 1, 2
    v_xor_b32 v26, v26, v25
    v_lshl_add_u32 v12, v26, 5, v12
    v_and_b32 v26, 1, v24
    v_lshl_add_u32 v12, v26, 4, v12
    s_lshl_b32 s3, s18, 7
    v_add_u32 v12, s3, v12
    v_add_u32 v13, 48128, v12
    v_add_u32 v14, s42, v12
    v_add_u32 v15, s42, v13
    v_lshrrev_b32 v24, 4, v1
    v_lshrrev_b32 v25, 3, v24
    v_mul_u32_u24 v16, 2048, v25
    v_and_b32 v26, 2, v25
    v_lshrrev_b32 v25, 2, v25
    v_or_b32 v26, v26, v25
    v_bfe_u32 v25, v24, 1, 2
    v_xor_b32 v26, v26, v25
    v_lshl_add_u32 v16, v26, 5, v16
    v_and_b32 v26, 1, v24
    v_lshl_add_u32 v16, v26, 4, v16
    s_lshl_b32 s3, s18, 7
    v_add_u32 v16, s3, v16
    v_add_u32 v17, 15360, v16
    v_add_u32 v18, 30720, v16
    v_add_u32 v19, 46080, v16
    s_and_b32 s3, s16, 3
    s_mul_i32 s3, s3, 49152
    v_add_u32 v11, s3, v12
    s_and_b32 s3, s16, 3
    s_lshl_b32 s3, s3, 10
    v_add_u32 v9, s3, v1
    v_add_u32 v10, 0x10000, v9
    s_cmp_eq_u32 s21, 3
    s_cbranch_scc1 s_nopf
    s_lshl_b32 s3, s2, 2
    s_and_b32 s60, s16, 3
    s_add_u32 s60, s60, s3
    s_lshl_b32 s60, s60, 11
    buffer_load_dwordx4 v[96:99], v1, s[12:15], s60 offen offset:0
    buffer_load_dwordx4 v[100:103], v1, s[12:15], s60 offen offset:1024
    s_bitcmp0_b32 s21, 0
    s_cselect_b32 s56, s28, s24
    s_cselect_b32 s57, s29, s25
    s_mov_b32 s58, 6291456
    s_mov_b32 s59, 0x00020000
    s_add_u32 s61, s84, 2048
    buffer_load_dwordx4 v[160:163], v11, s[56:59], s61 offen
    s_add_u32 s61, s84, 4096
    buffer_load_dwordx4 v[164:167], v11, s[56:59], s61 offen
    s_add_u32 s61, s84, 0
    buffer_load_dwordx4 v[168:171], v11, s[56:59], s61 offen
    s_add_u32 s61, s84, 198656
    buffer_load_dwordx4 v[172:175], v11, s[56:59], s61 offen
    s_waitcnt vmcnt(4)
s_nopf:
    s_setprio 3
    s_mov_b32 s52, 0
    s_lshl_b32 s44, s16, 14
    v_add_u32 v24, s44, v1
    s_and_b32 s3, s16, 3
    s_lshl_b32 s44, s3, 10
    s_add_u32 s44, s44, 147456
    v_lshrrev_b32 v25, 2, v1
    v_add_u32 v25, s44, v25
    s_lshl_b32 s53, s21, 22
    s_lshl_b32 s44, s38, 16
    s_add_u32 s53, s53, s44
    s_lshl_b32 s44, s18, 12
    s_add_u32 s53, s53, s44
    s_add_u32 s53, s53, 16777216
    s_lshl_b32 s54, s21, 14
    s_lshl_b32 s67, s38, 8
    s_add_u32 s54, s54, s67
    s_add_u32 s54, s54, 86016
s_bhead:
    s_barrier
    ds_read_b32 v28, v25 offset:0
    ds_read_b32 v29, v25 offset:256
    ds_read_b32 v30, v25 offset:512
    ds_read_b32 v31, v25 offset:768
    ds_read_b128 v[32:35], v24 offset:0
    ds_read_b128 v[36:39], v24 offset:1024
    ds_read_b128 v[40:43], v24 offset:2048
    ds_read_b128 v[44:47], v24 offset:3072
    ds_read_b128 v[48:51], v24 offset:4096
    ds_read_b128 v[52:55], v24 offset:5120
    ds_read_b128 v[56:59], v24 offset:6144
    ds_read_b128 v[60:63], v24 offset:7168
    ds_read_b128 v[64:67], v24 offset:8192
    ds_read_b128 v[68:71], v24 offset:9216
    ds_read_b128 v[72:75], v24 offset:10240
    ds_read_b128 v[76:79], v24 offset:11264
    ds_read_b128 v[80:83], v24 offset:12288
    ds_read_b128 v[84:87], v24 offset:13312
    ds_read_b128 v[88:91], v24 offset:14336
    ds_read_b128 v[92:95], v24 offset:15360
    s_waitcnt lgkmcnt(14)
    v_add_f32 v28, v28, v29
    v_add_f32 v30, v30, v31
    v_add_f32 v28, v28, v30
    v_mov_b32 v29, 0x5d800000
    v_mov_b32 v30, 0x21800000
    v_cmp_nlt_f32 s[44:45], v28, v29
    v_cmp_ngt_f32 vcc, v28, v30
    v_rcp_f32 v28, v28
    s_or_b64 vcc, vcc, s[44:45]
    s_waitcnt lgkmcnt(8)
    v_pk_add_f32 v[32:33], v[32:33], v[48:49]
    v_pk_add_f32 v[34:35], v[34:35], v[50:51]
    v_pk_add_f32 v[36:37], v[36:37], v[52:53]
    v_pk_add_f32 v[38:39], v[38:39], v[54:55]
    v_pk_add_f32 v[40:41], v[40:41], v[56:57]
    v_pk_add_f32 v[42:43], v[42:43], v[58:59]
    v_pk_add_f32 v[44:45], v[44:45], v[60:61]
    v_pk_add_f32 v[46:47], v[46:47], v[62:63]
    s_waitcnt lgkmcnt(4)
    v_pk_add_f32 v[32:33], v[32:33], v[64:65]
    v_pk_add_f32 v[34:35], v[34:35], v[66:67]
    v_pk_add_f32 v[36:37], v[36:37], v[68:69]
    v_pk_add_f32 v[38:39], v[38:39], v[70:71]
    v_pk_add_f32 v[40:41], v[40:41], v[72:73]
    v_pk_add_f32 v[42:43], v[42:43], v[74:75]
    v_pk_add_f32 v[44:45], v[44:45], v[76:77]
    v_pk_add_f32 v[46:47], v[46:47], v[78:79]
    s_waitcnt lgkmcnt(0)
    v_pk_add_f32 v[32:33], v[32:33], v[80:81]
    v_pk_add_f32 v[34:35], v[34:35], v[82:83]
    v_pk_add_f32 v[36:37], v[36:37], v[84:85]
    v_pk_add_f32 v[38:39], v[38:39], v[86:87]
    v_pk_add_f32 v[40:41], v[40:41], v[88:89]
    v_pk_add_f32 v[42:43], v[42:43], v[90:91]
    v_pk_add_f32 v[44:45], v[44:45], v[92:93]
    v_pk_add_f32 v[46:47], v[46:47], v[94:95]
    s_cbranch_vccnz s_slow
s_fin:
    v_pk_mul_f32 v[32:33], v[28:29], v[32:33] op_sel_hi:[0,1]
    v_pk_mul_f32 v[34:35], v[28:29], v[34:35] op_sel_hi:[0,1]
    v_pk_mul_f32 v[36:37], v[28:29], v[36:37] op_sel_hi:[0,1]
    v_pk_mul_f32 v[38:39], v[28:29], v[38:39] op_sel_hi:[0,1]
    v_pk_mul_f32 v[40:41], v[28:29], v[40:41] op_sel_hi:[0,1]
    v_pk_mul_f32 v[42:43], v[28:29], v[42:43] op_sel_hi:[0,1]
    v_pk_mul_f32 v[44:45], v[28:29], v[44:45] op_sel_hi:[0,1]
    v_pk_mul_f32 v[46:47], v[28:29], v[46:47] op_sel_hi:[0,1]
    v_cvt_pk_bf16_f32 v32, v32, v33
    v_cvt_pk_bf16_f32 v33, v34, v35
    v_cvt_pk_bf16_f32 v34, v36, v37
    v_cvt_pk_bf16_f32 v35, v38, v39
    v_cvt_pk_bf16_f32 v36, v40, v41
    v_cvt_pk_bf16_f32 v37, v42, v43
    v_cvt_pk_bf16_f32 v38, v44, v45
    v_cvt_pk_bf16_f32 v39, v46, v47
    buffer_store_dwordx4 v[32:35], v1, s[4:7], s53 offen offset:0 sc1
    buffer_store_dwordx4 v[36:39], v1, s[4:7], s53 offen offset:1024 sc1
    s_cmp_lg_u32 s52, 0
    s_cbranch_scc1 s_b2
    s_waitcnt vmcnt(0)
    s_atomic_add s40, s[22:23], s54
    s_mov_b32 s52, 1
    s_add_u32 s53, s53, 2048
    s_waitcnt lgkmcnt(0)
    s_add_u32 s54, s54, 128
    s_setprio 0
    s_cmp_eq_u32 s21, 3
    s_cbranch_scc1 s_nopf2
    s_bitcmp0_b32 s21, 0
    s_cselect_b32 s56, s28, s24
    s_cselect_b32 s57, s29, s25
    s_mov_b32 s58, 6291456
    s_mov_b32 s59, 0x00020000
    s_add_u32 s61, s84, 200704
    buffer_load_dwordx4 v[176:179], v11, s[56:59], s61 offen
    s_add_u32 s61, s84, 196608
    buffer_load_dwordx4 v[180:183], v11, s[56:59], s61 offen
    s_add_u32 s61, s85, 2048
    buffer_load_dwordx4 v[184:187], v11, s[56:59], s61 offen
    s_add_u32 s61, s85, 4096
    buffer_load_dwordx4 v[188:191], v11, s[56:59], s61 offen
    s_waitcnt vmcnt(4)
s_nopf2:
    s_barrier
    s_cmp_eq_u32 s21, 3
    s_cbranch_scc1 s_nopf3
    s_bitcmp0_b32 s21, 0
    s_cselect_b32 s56, s28, s24
    s_cselect_b32 s57, s29, s25
    s_mov_b32 s58, 6291456
    s_mov_b32 s59, 0x00020000
    s_add_u32 s61, s85, 0
    buffer_load_dwordx4 v[192:195], v11, s[56:59], s61 offen
    s_add_u32 s61, s85, 198656
    buffer_load_dwordx4 v[196:199], v11, s[56:59], s61 offen
    s_add_u32 s61, s85, 200704
    buffer_load_dwordx4 v[200:203], v11, s[56:59], s61 offen
    s_add_u32 s61, s85, 196608
    buffer_load_dwordx4 v[204:207], v11, s[56:59], s61 offen
    s_waitcnt vmcnt(4)
    s_add_u32 s61, s86, 2048
    buffer_load_dwordx4 v[208:211], v11, s[56:59], s61 offen
    s_add_u32 s61, s86, 4096
    buffer_load_dwordx4 v[212:215], v11, s[56:59], s61 offen
    s_add_u32 s61, s86, 0
    buffer_load_dwordx4 v[216:219], v11, s[56:59], s61 offen
    s_add_u32 s61, s86, 198656
    buffer_load_dwordx4 v[220:223], v11, s[56:59], s61 offen
    s_waitcnt vmcnt(4)
    s_add_u32 s61, s86, 200704
    buffer_load_dwordx4 v[224:227], v11, s[56:59], s61 offen
    s_add_u32 s61, s86, 196608
    buffer_load_dwordx4 v[228:231], v11, s[56:59], s61 offen
    s_add_u32 s61, s87, 2048
    buffer_load_dwordx4 v[232:235], v11, s[56:59], s61 offen
    s_add_u32 s61, s87, 4096
    buffer_load_dwordx4 v[236:239], v11, s[56:59], s61 offen
    s_waitcnt vmcnt(4)
    s_add_u32 s61, s87, 0
    buffer_load_dwordx4 v[240:243], v11, s[56:59], s61 offen
    s_add_u32 s61, s87, 198656
    buffer_load_dwordx4 v[244:247], v11, s[56:59], s61 offen
    s_add_u32 s61, s87, 200704
    buffer_load_dwordx4 v[248:251], v11, s[56:59], s61 offen
    s_add_u32 s61, s87, 196608
    buffer_load_dwordx4 v[252:255], v11, s[56:59], s61 offen
    s_waitcnt vmcnt(4)
s_nopf3:
    s_and_b32 s3, s16, 3
    s_lshl_b32 s46, s3, 19
    s_lshl_b32 s45, s3, 14
    s_and_b32 s3, s18, 0
    s_lshl_b32 s3, s3, 17
    s_xor_b32 s46, s46, s3
    s_add_u32 m0, s45, 0
    s_xor_b32 s44, s46, 0
    buffer_load_dwordx4 v16, s[12:15], s44 offen offset:0 lds
    buffer_load_dwordx4 v17, s[12:15], s44 offen offset:1024 lds
    buffer_load_dwordx4 v18, s[12:15], s44 offen offset:2048 lds
    buffer_load_dwordx4 v19, s[12:15], s44 offen offset:3072 lds
    s_add_u32 s44, s44, 65536
    s_waitcnt vmcnt(3)
    buffer_load_dwordx4 v[96:99], v16, s[12:15], s44 offen offset:0
    buffer_load_dwordx4 v[100:103], v17, s[12:15], s44 offen offset:1024
    buffer_load_dwordx4 v[104:107], v18, s[12:15], s44 offen offset:2048
    buffer_load_dwordx4 v[108:111], v19, s[12:15], s44 offen offset:3072
    s_waitcnt vmcnt(3)
    s_add_u32 m0, s45, 4096
    s_xor_b32 s44, s46, 131072
    buffer_load_dwordx4 v16, s[12:15], s44 offen offset:0 lds
    buffer_load_dwordx4 v17, s[12:15], s44 offen offset:1024 lds
    buffer_load_dwordx4 v18, s[12:15], s44 offen offset:2048 lds
    buffer_load_dwordx4 v19, s[12:15], s44 offen offset:3072 lds
    s_add_u32 s44, s44, 65536
    s_waitcnt vmcnt(3)
    buffer_load_dwordx4 v[112:115], v16, s[12:15], s44 offen offset:0
    buffer_load_dwordx4 v[116:119], v17, s[12:15], s44 offen offset:1024
    buffer_load_dwordx4 v[120:123], v18, s[12:15], s44 offen offset:2048
    buffer_load_dwordx4 v[124:127], v19, s[12:15], s44 offen offset:3072
    s_waitcnt vmcnt(3)
    s_add_u32 m0, s45, 8192
    s_xor_b32 s44, s46, 262144
    buffer_load_dwordx4 v16, s[12:15], s44 offen offset:0 lds
    buffer_load_dwordx4 v17, s[12:15], s44 offen offset:1024 lds
    buffer_load_dwordx4 v18, s[12:15], s44 offen offset:2048 lds
    buffer_load_dwordx4 v19, s[12:15], s44 offen offset:3072 lds
    s_add_u32 s44, s44, 65536
    s_waitcnt vmcnt(3)
    buffer_load_dwordx4 v[128:131], v16, s[12:15], s44 offen offset:0
    buffer_load_dwordx4 v[132:135], v17, s[12:15], s44 offen offset:1024
    buffer_load_dwordx4 v[136:139], v18, s[12:15], s44 offen offset:2048
    buffer_load_dwordx4 v[140:143], v19, s[12:15], s44 offen offset:3072
    s_waitcnt vmcnt(3)
    s_add_u32 m0, s45, 12288
    s_xor_b32 s44, s46, 393216
    buffer_load_dwordx4 v16, s[12:15], s44 offen offset:0 lds
    buffer_load_dwordx4 v17, s[12:15], s44 offen offset:1024 lds
    buffer_load_dwordx4 v18, s[12:15], s44 offen offset:2048 lds
    buffer_load_dwordx4 v19, s[12:15], s44 offen offset:3072 lds
    s_add_u32 s44, s44, 65536
    s_waitcnt vmcnt(3)
    buffer_load_dwordx4 v[144:147], v16, s[12:15], s44 offen offset:0
    buffer_load_dwordx4 v[148:151], v17, s[12:15], s44 offen offset:1024
    buffer_load_dwordx4 v[152:155], v18, s[12:15], s44 offen offset:2048
    buffer_load_dwordx4 v[156:159], v19, s[12:15], s44 offen offset:3072
    s_waitcnt vmcnt(3)
    s_setprio 3
    s_sub_u32 s44, s54, 128
    s_mov_b32 s66, 0x10000
s_o0_poll:
    s_mov_b32 s68, 0
    s_atomic_add s68, s[22:23], s44 offset:0 glc
    s_sub_u32 s66, s66, 1
    s_cselect_b32 s67, 16, 0
    s_waitcnt lgkmcnt(0)
    s_max_u32 s68, s68, s67
    s_cmp_lt_u32 s68, 16
    s_cbranch_scc1 s_o0_poll
s_o0_ok:
    s_waitcnt vmcnt(0)
    s_branch s_bhead
s_b2:
    ds_write_b128 v24, v[96:99] offset:0
    ds_write_b128 v24, v[100:103] offset:1024
    ds_write_b128 v24, v[104:107] offset:2048
    ds_write_b128 v24, v[108:111] offset:3072
    ds_write_b128 v24, v[112:115] offset:4096
    ds_write_b128 v24, v[116:119] offset:5120
    ds_write_b128 v24, v[120:123] offset:6144
    ds_write_b128 v24, v[124:127] offset:7168
    ds_write_b128 v24, v[128:131] offset:8192
    ds_write_b128 v24, v[132:135] offset:9216
    ds_write_b128 v24, v[136:139] offset:10240
    ds_write_b128 v24, v[140:143] offset:11264
    ds_write_b128 v24, v[144:147] offset:12288
    ds_write_b128 v24, v[148:151] offset:13312
    ds_write_b128 v24, v[152:155] offset:14336
    ds_write_b128 v24, v[156:159] offset:15360
    s_mov_b32 s68, 1
    s_waitcnt vmcnt(0)
    s_atomic_add s68, s[22:23], s54 glc
    s_mov_b32 s66, 0x10000
    s_waitcnt lgkmcnt(0)
    s_cmp_eq_u32 s68, 15
    s_cbranch_scc1 s_o1_ok
s_o1_poll:
    s_mov_b32 s68, 0
    s_atomic_add s68, s[22:23], s54 offset:0 glc
    s_sub_u32 s66, s66, 1
    s_cselect_b32 s67, 16, 0
    s_waitcnt lgkmcnt(0)
    s_max_u32 s68, s68, s67
    s_cmp_lt_u32 s68, 16
    s_cbranch_scc1 s_o1_poll
s_o1_ok:
s_b3:
    s_setprio 0
    s_waitcnt lgkmcnt(0)
s_g3:
    s_barrier
    s_cmp_eq_u32 s21, 3
    s_cbranch_scc1 s_end
    s_barrier
    ds_write_b128 v9, v[160:163] offset:0
    ds_write_b128 v9, v[164:167] offset:4096
    ds_write_b128 v9, v[168:171] offset:8192
    ds_write_b128 v9, v[172:175] offset:12288
    ds_write_b128 v9, v[176:179] offset:16384
    ds_write_b128 v9, v[180:183] offset:20480
    ds_write_b128 v9, v[184:187] offset:24576
    ds_write_b128 v9, v[188:191] offset:28672
    s_add_u32 s21, s21, 1
    s_bitcmp1_b32 s21, 0
    s_cselect_b32 s8, s28, s24
    s_cselect_b32 s9, s29, s25
    s_cselect_b32 s12, s30, s26
    s_cselect_b32 s13, s31, s27
    s_mov_b32 s10, 6291456
    s_mov_b32 s11, 0x00020000
    s_mov_b32 s14, 2097152
    s_mov_b32 s15, 0x00020000
    s_sub_u32 s3, s16, 5
    s_cmp_gt_u32 s3, 1
    s_cbranch_scc1 s_n67
    s_add_u32 m0, s41, 98304
    s_add_u32 s44, s88, 2048
    buffer_load_dwordx4 v14, s[8:11], s44 offen offset:0 lds
    buffer_load_dwordx4 v15, s[8:11], s44 offen offset:1024 lds
    s_add_u32 m0, s41, 102400
    s_add_u32 s44, s88, 4096
    buffer_load_dwordx4 v14, s[8:11], s44 offen offset:0 lds
    buffer_load_dwordx4 v15, s[8:11], s44 offen offset:1024 lds
    s_add_u32 m0, s41, 106496
    s_add_u32 s44, s88, 0
    buffer_load_dwordx4 v14, s[8:11], s44 offen offset:0 lds
    buffer_load_dwordx4 v15, s[8:11], s44 offen offset:1024 lds
    s_add_u32 m0, s41, 110592
    s_add_u32 s44, s88, 198656
    buffer_load_dwordx4 v14, s[8:11], s44 offen offset:0 lds
    buffer_load_dwordx4 v15, s[8:11], s44 offen offset:1024 lds
    s_add_u32 m0, s41, 114688
    s_add_u32 s44, s88, 200704
    buffer_load_dwordx4 v14, s[8:11], s44 offen offset:0 lds
    buffer_load_dwordx4 v15, s[8:11], s44 offen offset:1024 lds
    s_add_u32 m0, s41, 118784
    s_add_u32 s44, s88, 196608
    buffer_load_dwordx4 v14, s[8:11], s44 offen offset:0 lds
    buffer_load_dwordx4 v15, s[8:11], s44 offen offset:1024 lds
    s_add_u32 m0, s41, 122880
    s_add_u32 s44, s89, 2048
    buffer_load_dwordx4 v14, s[8:11], s44 offen offset:0 lds
    buffer_load_dwordx4 v15, s[8:11], s44 offen offset:1024 lds
    s_add_u32 m0, s41, 126976
    s_add_u32 s44, s89, 4096
    buffer_load_dwordx4 v14, s[8:11], s44 offen offset:0 lds
    buffer_load_dwordx4 v15, s[8:11], s44 offen offset:1024 lds
s_n67:
    s_waitcnt lgkmcnt(0)
    s_barrier
    ds_write_b128 v9, v[192:195] offset:32768
    ds_write_b128 v9, v[196:199] offset:36864
    ds_write_b128 v9, v[200:203] offset:40960
    ds_write_b128 v9, v[204:207] offset:45056
    ds_write_b128 v9, v[208:211] offset:49152
    ds_write_b128 v9, v[212:215] offset:53248
    ds_write_b128 v9, v[216:219] offset:57344
    ds_write_b128 v9, v[220:223] offset:61440
    ds_write_b128 v10, v[224:227] offset:0
    ds_write_b128 v10, v[228:231] offset:4096
    ds_write_b128 v10, v[232:235] offset:8192
    ds_write_b128 v10, v[236:239] offset:12288
    ds_write_b128 v10, v[240:243] offset:16384
    ds_write_b128 v10, v[244:247] offset:20480
    ds_write_b128 v10, v[248:251] offset:24576
    ds_write_b128 v10, v[252:255] offset:28672
    s_cmp_eq_u32 s16, 4
    s_cbranch_scc1 h_layer
    s_cmp_eq_u32 s16, 7
    s_cbranch_scc1 z_layer
    s_branch l_layer
s_end:
    s_lshl_b32 s3, s2, 3
    s_add_u32 s3, s3, s16
    s_cmp_lg_u32 s3, 7
    s_cbranch_scc1 k_exit
    s_mov_b32 s8, s34
    s_mov_b32 s9, s35
    s_mov_b32 s10, 256
    s_mov_b32 s11, 0x00020000
    v_lshrrev_b32 v24, 2, v1
    v_mov_b32 v25, 0
    buffer_store_dword v25, v24, s[8:11], 0 offen sc1
    s_branch k_exit
s_slow:
    s_and_b32 s3, s16, 3
    s_lshl_b32 s44, s3, 11
    s_lshl_b32 s45, s52, 13
    s_add_u32 s44, s44, s45
    s_add_u32 s44, s44, 131072
    v_add_u32 v26, s44, v1
    ds_read_b128 v[48:51], v26 offset:0
    ds_read_b128 v[52:55], v26 offset:1024
    s_lshr_b32 s55, s21, 1
    s_lshl_b32 s55, s55, 23
    s_lshl_b32 s44, s18, 18
    s_add_u32 s55, s55, s44
    s_lshl_b32 s44, s52, 17
    s_add_u32 s55, s55, s44
    s_add_u32 s55, s55, 33554432
    s_waitcnt lgkmcnt(0)
    v_mov_b32 v26, 0xff800000
    s_mov_b32 s61, 0
s_slow1:
    s_add_u32 s44, s55, s61
    buffer_load_dwordx4 v[56:59], v1, s[4:7], s44 offen offset:0 sc1
    buffer_load_dwordx4 v[60:63], v1, s[4:7], s44 offen offset:1024 sc1
    s_waitcnt vmcnt(0)
    v_mfma_f32_32x32x16_bf16 v[72:87], v[56:59], v[48:51], 0
    v_mfma_f32_32x32x16_bf16 v[72:87], v[60:63], v[52:55], v[72:87]
    s_nop 11
    v_max3_f32 v26, v26, v72, v73
    v_max3_f32 v26, v26, v74, v75
    v_max3_f32 v26, v26, v76, v77
    v_max3_f32 v26, v26, v78, v79
    v_max3_f32 v26, v26, v80, v81
    v_max3_f32 v26, v26, v82, v83
    v_max3_f32 v26, v26, v84, v85
    v_max3_f32 v26, v26, v86, v87
    s_add_u32 s61, s61, 2048
    s_cmp_lt_u32 s61, 131072
    s_cbranch_scc1 s_slow1
    v_mov_b32 v27, v26
    s_nop 1
    v_permlane32_swap_b32 v26, v27
    v_max_f32 v26, v26, v27
    v_mov_b32 v32, 0
    v_mov_b32 v33, 0
    v_mov_b32 v34, 0
    v_mov_b32 v35, 0
    v_mov_b32 v36, 0
    v_mov_b32 v37, 0
    v_mov_b32 v38, 0
    v_mov_b32 v39, 0
    v_mov_b32 v40, 0
    v_mov_b32 v41, 0
    v_mov_b32 v42, 0
    v_mov_b32 v43, 0
    v_mov_b32 v44, 0
    v_mov_b32 v45, 0
    v_mov_b32 v46, 0
    v_mov_b32 v47, 0
    v_mov_b32 v28, 0
    v_mov_b32 v29, 0xdddddddd
    s_mov_b32 s3, 0xffff0000
    s_mov_b32 s61, 0
s_slow2:
    s_add_u32 s44, s55, s61
    buffer_load_dwordx4 v[56:59], v1, s[4:7], s44 offen offset:0 sc1
    buffer_load_dwordx4 v[60:63], v1, s[4:7], s44 offen offset:1024 sc1
    s_add_u32 s44, s44, 4194304
    buffer_load_dwordx4 v[64:67], v1, s[4:7], s44 offen offset:0 sc1
    buffer_load_dwordx4 v[68:71], v1, s[4:7], s44 offen offset:1024 sc1
    s_waitcnt vmcnt(0)
    v_mfma_f32_32x32x16_bf16 v[72:87], v[56:59], v[48:51], 0
    v_mfma_f32_32x32x16_bf16 v[72:87], v[60:63], v[52:55], v[72:87]
    s_nop 11
    v_sub_f32 v72, v72, v26
    v_sub_f32 v73, v73, v26
    v_sub_f32 v74, v74, v26
    v_sub_f32 v75, v75, v26
    v_sub_f32 v76, v76, v26
    v_sub_f32 v77, v77, v26
    v_sub_f32 v78, v78, v26
    v_sub_f32 v79, v79, v26
    v_sub_f32 v80, v80, v26
    v_sub_f32 v81, v81, v26
    v_sub_f32 v82, v82, v26
    v_sub_f32 v83, v83, v26
    v_sub_f32 v84, v84, v26
    v_sub_f32 v85, v85, v26
    v_sub_f32 v86, v86, v26
    v_sub_f32 v87, v87, v26
    v_exp_f32 v72, v72
    v_exp_f32 v73, v73
    v_exp_f32 v74, v74
    v_exp_f32 v75, v75
    v_exp_f32 v76, v76
    v_exp_f32 v77, v77
    v_exp_f32 v78, v78
    v_exp_f32 v79, v79
    v_exp_f32 v80, v80
    v_exp_f32 v81, v81
    v_exp_f32 v82, v82
    v_exp_f32 v83, v83
    v_exp_f32 v84, v84
    v_exp_f32 v85, v85
    v_exp_f32 v86, v86
    v_exp_f32 v87, v87
    v_and_b32 v72, s3, v72
    v_and_b32 v73, s3, v73
    v_and_b32 v74, s3, v74
    v_and_b32 v75, s3, v75
    v_and_b32 v76, s3, v76
    v_and_b32 v77, s3, v77
    v_and_b32 v78, s3, v78
    v_and_b32 v79, s3, v79
    v_and_b32 v80, s3, v80
    v_and_b32 v81, s3, v81
    v_and_b32 v82, s3, v82
    v_and_b32 v83, s3, v83
    v_and_b32 v84, s3, v84
    v_and_b32 v85, s3, v85
    v_and_b32 v86, s3, v86
    v_and_b32 v87, s3, v87
    v_add_f32 v28, v28, v72
    v_add_f32 v28, v28, v73
    v_add_f32 v28, v28, v74
    v_add_f32 v28, v28, v75
    v_add_f32 v28, v28, v76
    v_add_f32 v28, v28, v77
    v_add_f32 v28, v28, v78
    v_add_f32 v28, v28, v79
    v_add_f32 v28, v28, v80
    v_add_f32 v28, v28, v81
    v_add_f32 v28, v28, v82
    v_add_f32 v28, v28, v83
    v_add_f32 v28, v28, v84
    v_add_f32 v28, v28, v85
    v_add_f32 v28, v28, v86
    v_add_f32 v28, v28, v87
    v_smfmac_f32_32x32x32_bf16 v[32:47], v[64:67], v[72:79], v29
    v_smfmac_f32_32x32x32_bf16 v[32:47], v[68:71], v[80:87], v29
    s_add_u32 s61, s61, 2048
    s_cmp_lt_u32 s61, 131072
    s_cbranch_scc1 s_slow2
    v_mov_b32 v29, v28
    s_nop 1
    v_permlane32_swap_b32 v28, v29
    v_add_f32 v28, v28, v29
    v_rcp_f32 v28, v28
    s_nop 7
    s_branch s_fin
k_exit:
    s_endpgm
.if k_exit - interleave_layers__sliding_local_dilated__softmax_full_mha__prompt_kernel < 49152
.error "code prefetch reads past the end of the code"
.endif
.section .rodata,"a"
.p2align 6
.amdhsa_kernel interleave_layers__sliding_local_dilated__softmax_full_mha__prompt_kernel
  .amdhsa_next_free_vgpr 256
  .amdhsa_next_free_sgpr 102
  .amdhsa_accum_offset 256
  .amdhsa_group_segment_fixed_size 0
  .amdhsa_kernarg_size 72
  .amdhsa_user_sgpr_count 2
  .amdhsa_user_sgpr_kernarg_segment_ptr 1
  .amdhsa_system_sgpr_workgroup_id_x 1
.end_amdhsa_kernel
```

```asm
; @launch grid=(256,1,1) block=(512,1,1) lds=156736
.amdgcn_target "amdgcn-amd-amdhsa--gfx950"
.text
.globl interleave_layers__sliding_local_dilated__softmax_full_mha__prompt_kernel
.type interleave_layers__sliding_local_dilated__softmax_full_mha__prompt_kernel,@function
.p2align 8
interleave_layers__sliding_local_dilated__softmax_full_mha__prompt_kernel:
    s_cmp_ge_u32 s2, 256
    s_cbranch_scc1 k_exit
    s_load_dwordx2 s[36:37], s[0:1], 0
    s_load_dwordx4 s[24:27], s[0:1], 8
    s_load_dwordx8 s[28:35], s[0:1], 32
    s_load_dwordx2 s[44:45], s[0:1], 64
    v_lshrrev_b32 v2, 6, v0
    v_and_b32 v0, 63, v0
    v_readfirstlane_b32 s16, v2
    v_lshlrev_b32 v1, 4, v0
    s_mov_b32 s21, 0
    s_mov_b32 s40, 1
    s_and_b32 s3, s2, 1
    s_lshl_b32 s3, s3, 3
    s_bfe_u32 s17, s2, 0x30003
    s_add_u32 s17, s17, s3
    s_bfe_u32 s3, s2, 0x20001
    s_lshl_b32 s3, s3, 2
    s_lshr_b32 s18, s2, 6
    s_add_u32 s18, s18, s3
    s_and_b32 s3, s16, 3
    s_lshl_b32 s38, s17, 2
    s_add_u32 s38, s38, s3
    v_lshrrev_b32 v32, 3, v0
    v_and_b32 v33, 7, v0
    v_lshlrev_b32 v34, 11, v32
    v_lshl_add_u32 v34, v33, 4, v34
    s_lshl_b32 s46, s38, 16
    s_lshl_b32 s47, s18, 7
    s_add_u32 s46, s46, s47
    s_getpc_b64 s[76:77]
e_pc:
    s_sub_u32 s76, s76, e_pc - interleave_layers__sliding_local_dilated__softmax_full_mha__prompt_kernel
    s_subb_u32 s77, s77, 0
    s_and_b32 s3, s2, 0xf8
    s_add_u32 s3, s3, s16
    s_lshl_b32 s3, s3, 6
    s_add_u32 s78, s3, 49152
    s_min_u32 s78, s78, k_exit - interleave_layers__sliding_local_dilated__softmax_full_mha__prompt_kernel
    s_waitcnt lgkmcnt(0)
    s_mov_b32 s8, s36
    s_mov_b32 s9, s37
    s_mov_b32 s10, 4194304
    s_mov_b32 s11, 0x00020000
    s_cmp_gt_u32 s16, 3
    s_cbranch_scc1 e_side
    buffer_load_dwordx4 v[40:43], v34, s[8:11], s46 offen
    s_add_u32 s46, s46, 16384
    buffer_load_dwordx4 v[44:47], v34, s[8:11], s46 offen
    s_add_u32 s46, s46, 16384
    buffer_load_dwordx4 v[48:51], v34, s[8:11], s46 offen
    s_add_u32 s46, s46, 16384
    buffer_load_dwordx4 v[52:55], v34, s[8:11], s46 offen
e_side:
    s_load_dword s80, s[76:77], s3 offset:0
    s_load_dword s81, s[76:77], s3 offset:16384
    s_load_dword s82, s[76:77], s3 offset:32768
    s_load_dword s83, s[76:77], s78
    s_mov_b32 s4, s44
    s_mov_b32 s5, s45
    s_mov_b32 s6, 67108864
    s_mov_b32 s7, 0x00020000
    s_add_u32 s22, s44, 58720256
    s_addc_u32 s23, s45, 0
    s_load_dword s100, s[22:23], 217088
    s_cmp_gt_u32 s16, 3
    s_cbranch_scc1 s_start
    v_lshrrev_b32 v8, 4, v1
    s_lshl_b32 s44, s38, 16
    v_xor_b32 v88, v33, v32
    v_lshlrev_b32 v88, 4, v88
    v_lshl_add_u32 v88, v32, 11, v88
    v_xor_b32 v89, 16, v88
    v_add_u32 v89, 15360, v89
    v_add_u32 v90, 30720, v88
    v_add_u32 v91, 30720, v89
    s_mul_i32 s76, s16, 16384
    s_add_u32 s76, s76, 61440
    s_lshl_b32 s77, s38, 16
    s_mul_i32 s84, s18, 4096
    s_cmp_lt_u32 s18, 4
    s_cselect_b32 s85, 4, 0
    s_mul_i32 s85, s85, 4096
    s_cmp_lt_u32 s18, 4
    s_cselect_b32 s86, 5, 1
    s_mul_i32 s86, s86, 4096
    s_cmp_lt_u32 s18, 4
    s_cselect_b32 s87, 6, 2
    s_mul_i32 s87, s87, 4096
    s_cmp_lt_u32 s18, 4
    s_cselect_b32 s88, 7, 3
    s_mul_i32 s88, s88, 4096
    s_cmp_lt_u32 s18, 8
    s_cselect_b32 s89, 8, 4
    s_mul_i32 s89, s89, 4096
    s_cmp_lt_u32 s18, 8
    s_cselect_b32 s90, 9, 5
    s_mul_i32 s90, s90, 4096
    s_cmp_lt_u32 s18, 8
    s_cselect_b32 s91, 10, 6
    s_mul_i32 s91, s91, 4096
    s_cmp_lt_u32 s18, 8
    s_cselect_b32 s92, 11, 7
    s_mul_i32 s92, s92, 4096
    s_cmp_lt_u32 s18, 12
    s_cselect_b32 s93, 12, 8
    s_mul_i32 s93, s93, 4096
    s_cmp_lt_u32 s18, 12
    s_cselect_b32 s94, 13, 9
    s_mul_i32 s94, s94, 4096
    s_cmp_lt_u32 s18, 12
    s_cselect_b32 s95, 14, 10
    s_mul_i32 s95, s95, 4096
    s_cmp_lt_u32 s18, 12
    s_cselect_b32 s96, 15, 11
    s_mul_i32 s96, s96, 4096
    s_xor_b32 s97, s18, 1
    s_mul_i32 s97, s97, 4096
    s_xor_b32 s98, s18, 2
    s_mul_i32 s98, s98, 4096
    s_xor_b32 s99, s18, 3
    s_mul_i32 s99, s99, 4096
    s_lshr_b32 s3, s18, 2
    s_lshl_b32 s3, s3, 3
    s_lshl_b32 s63, 1, s3
    s_lshl_b32 s3, s63, 2
    s_andn2_b32 s19, 67372036, s3
    v_lshrrev_b32 v12, 4, v1
    v_and_b32 v13, 15, v12
    v_bfe_u32 v14, v12, 4, 1
    v_lshrrev_b32 v12, 5, v12
    v_lshl_add_u32 v2, v14, 5, v13
    v_lshlrev_b32 v2, 4, v2
    v_lshl_add_u32 v2, v12, 10, v2
    v_lshrrev_b32 v15, 2, v13
    v_lshl_add_u32 v15, v14, 2, v15
    v_lshlrev_b32 v3, 7, v15
    v_lshl_add_u32 v3, v12, 11, v3
    v_and_b32 v15, 3, v13
    v_lshl_add_u32 v3, v15, 3, v3
    v_lshrrev_b32 v15, 3, v13
    v_lshl_add_u32 v15, v15, 1, v14
    v_lshl_add_u32 v3, v15, 5, v3
    v_xor_b32 v4, 32, v3
    v_xor_b32 v5, 64, v3
    v_xor_b32 v6, 96, v3
    s_lshl_b32 s45, s16, 12
    s_add_u32 s45, s45, 131072
    v_lshrrev_b32 v35, 1, v33
    v_lshlrev_b32 v35, 10, v35
    v_lshl_add_u32 v35, v32, 4, v35
    v_and_b32 v36, 1, v33
    v_lshl_add_u32 v35, v36, 3, v35
    v_add_u32 v35, s45, v35
    v_add_u32 v36, s45, v1
    v_mov_b32 v37, 0x3f803f80
    v_and_b32 v38, 3, v8
    v_lshl_add_u32 v39, v38, 3, v32
    v_lshlrev_b32 v39, 3, v39
    v_mov_b32 v56, 0
    v_mov_b32 v57, 0
    v_mov_b32 v58, 0
    v_mov_b32 v59, 0
    v_mov_b32 v60, 0
    v_mov_b32 v61, 0
    v_mov_b32 v62, 0
    v_mov_b32 v63, 0
    s_waitcnt vmcnt(3)
    ds_write_b64 v35, v[40:41] offset:0
    ds_write_b64 v35, v[42:43] offset:512
    s_waitcnt vmcnt(2)
    ds_write_b64 v35, v[44:45] offset:128
    ds_write_b64 v35, v[46:47] offset:640
    s_waitcnt vmcnt(1)
    ds_write_b64 v35, v[48:49] offset:256
    ds_write_b64 v35, v[50:51] offset:768
    s_waitcnt vmcnt(0)
    ds_write_b64 v35, v[52:53] offset:384
    ds_write_b64 v35, v[54:55] offset:896
    ds_read_b128 v[64:67], v36 offset:0
    ds_read_b128 v[68:71], v36 offset:1024
    ds_read_b128 v[72:75], v36 offset:2048
    ds_read_b128 v[76:79], v36 offset:3072
    s_lshl_b32 s45, s18, 12
    s_add_u32 s46, s44, s45
    s_waitcnt lgkmcnt(3)
    buffer_store_dwordx4 v[64:67], v1, s[4:7], s46 offen offset:0 sc1
    s_waitcnt lgkmcnt(2)
    buffer_store_dwordx4 v[68:71], v1, s[4:7], s46 offen offset:1024 sc1
    s_waitcnt lgkmcnt(1)
    buffer_store_dwordx4 v[72:75], v1, s[4:7], s46 offen offset:2048 sc1
    s_waitcnt lgkmcnt(0)
    buffer_store_dwordx4 v[76:79], v1, s[4:7], s46 offen offset:3072 sc1
    s_add_u32 m0, s76, 4096
    s_lshr_b32 s78, s85, 5
    s_add_u32 s78, s78, s77
    buffer_load_dwordx4 v88, s[8:11], s78 offen offset:0 lds
    buffer_load_dwordx4 v89, s[8:11], s78 offen offset:1024 lds
    buffer_load_dwordx4 v90, s[8:11], s78 offen offset:2048 lds
    buffer_load_dwordx4 v91, s[8:11], s78 offen offset:3072 lds
    s_add_u32 m0, s76, 8192
    s_lshr_b32 s78, s86, 5
    s_add_u32 s78, s78, s77
    buffer_load_dwordx4 v88, s[8:11], s78 offen offset:0 lds
    buffer_load_dwordx4 v89, s[8:11], s78 offen offset:1024 lds
    buffer_load_dwordx4 v90, s[8:11], s78 offen offset:2048 lds
    buffer_load_dwordx4 v91, s[8:11], s78 offen offset:3072 lds
    s_add_u32 m0, s76, 12288
    s_lshr_b32 s78, s87, 5
    s_add_u32 s78, s78, s77
    buffer_load_dwordx4 v88, s[8:11], s78 offen offset:0 lds
    buffer_load_dwordx4 v89, s[8:11], s78 offen offset:1024 lds
    buffer_load_dwordx4 v90, s[8:11], s78 offen offset:2048 lds
    buffer_load_dwordx4 v91, s[8:11], s78 offen offset:3072 lds
    s_add_u32 m0, s76, 16384
    s_lshr_b32 s78, s88, 5
    s_add_u32 s78, s78, s77
    buffer_load_dwordx4 v88, s[8:11], s78 offen offset:0 lds
    buffer_load_dwordx4 v89, s[8:11], s78 offen offset:1024 lds
    buffer_load_dwordx4 v90, s[8:11], s78 offen offset:2048 lds
    buffer_load_dwordx4 v91, s[8:11], s78 offen offset:3072 lds
    v_dot2_f32_bf16 v56, v40, v37, v56
    v_dot2_f32_bf16 v57, v40, v40, v57
    v_dot2_f32_bf16 v58, v44, v37, v58
    v_dot2_f32_bf16 v59, v44, v44, v59
    v_dot2_f32_bf16 v60, v48, v37, v60
    v_dot2_f32_bf16 v61, v48, v48, v61
    v_dot2_f32_bf16 v62, v52, v37, v62
    v_dot2_f32_bf16 v63, v52, v52, v63
    v_dot2_f32_bf16 v56, v41, v37, v56
    v_dot2_f32_bf16 v57, v41, v41, v57
    v_dot2_f32_bf16 v58, v45, v37, v58
    v_dot2_f32_bf16 v59, v45, v45, v59
    v_dot2_f32_bf16 v60, v49, v37, v60
    v_dot2_f32_bf16 v61, v49, v49, v61
    v_dot2_f32_bf16 v62, v53, v37, v62
    v_dot2_f32_bf16 v63, v53, v53, v63
    v_dot2_f32_bf16 v56, v42, v37, v56
    v_dot2_f32_bf16 v57, v42, v42, v57
    v_dot2_f32_bf16 v58, v46, v37, v58
    v_dot2_f32_bf16 v59, v46, v46, v59
    v_dot2_f32_bf16 v60, v50, v37, v60
    v_dot2_f32_bf16 v61, v50, v50, v61
    v_dot2_f32_bf16 v62, v54, v37, v62
    v_dot2_f32_bf16 v63, v54, v54, v63
    v_dot2_f32_bf16 v56, v43, v37, v56
    v_dot2_f32_bf16 v57, v43, v43, v57
    v_dot2_f32_bf16 v58, v47, v37, v58
    v_dot2_f32_bf16 v59, v47, v47, v59
    v_dot2_f32_bf16 v60, v51, v37, v60
    v_dot2_f32_bf16 v61, v51, v51, v61
    v_dot2_f32_bf16 v62, v55, v37, v62
    v_dot2_f32_bf16 v63, v55, v55, v63
    s_nop 2
    v_add_f32_dpp v56, v56, v56 quad_perm:[1,0,3,2] row_mask:0xf bank_mask:0xf
    v_add_f32_dpp v57, v57, v57 quad_perm:[1,0,3,2] row_mask:0xf bank_mask:0xf
    v_add_f32_dpp v58, v58, v58 quad_perm:[1,0,3,2] row_mask:0xf bank_mask:0xf
    v_add_f32_dpp v59, v59, v59 quad_perm:[1,0,3,2] row_mask:0xf bank_mask:0xf
    v_add_f32_dpp v60, v60, v60 quad_perm:[1,0,3,2] row_mask:0xf bank_mask:0xf
    v_add_f32_dpp v61, v61, v61 quad_perm:[1,0,3,2] row_mask:0xf bank_mask:0xf
    v_add_f32_dpp v62, v62, v62 quad_perm:[1,0,3,2] row_mask:0xf bank_mask:0xf
    v_add_f32_dpp v63, v63, v63 quad_perm:[1,0,3,2] row_mask:0xf bank_mask:0xf
    v_add_f32_dpp v56, v56, v56 quad_perm:[2,3,0,1] row_mask:0xf bank_mask:0xf
    v_add_f32_dpp v57, v57, v57 quad_perm:[2,3,0,1] row_mask:0xf bank_mask:0xf
    v_add_f32_dpp v58, v58, v58 quad_perm:[2,3,0,1] row_mask:0xf bank_mask:0xf
    v_add_f32_dpp v59, v59, v59 quad_perm:[2,3,0,1] row_mask:0xf bank_mask:0xf
    v_add_f32_dpp v60, v60, v60 quad_perm:[2,3,0,1] row_mask:0xf bank_mask:0xf
    v_add_f32_dpp v61, v61, v61 quad_perm:[2,3,0,1] row_mask:0xf bank_mask:0xf
    v_add_f32_dpp v62, v62, v62 quad_perm:[2,3,0,1] row_mask:0xf bank_mask:0xf
    v_add_f32_dpp v63, v63, v63 quad_perm:[2,3,0,1] row_mask:0xf bank_mask:0xf
    v_add_f32_dpp v56, v56, v56 row_half_mirror row_mask:0xf bank_mask:0xf
    v_add_f32_dpp v57, v57, v57 row_half_mirror row_mask:0xf bank_mask:0xf
    v_add_f32_dpp v58, v58, v58 row_half_mirror row_mask:0xf bank_mask:0xf
    v_add_f32_dpp v59, v59, v59 row_half_mirror row_mask:0xf bank_mask:0xf
    v_add_f32_dpp v60, v60, v60 row_half_mirror row_mask:0xf bank_mask:0xf
    v_add_f32_dpp v61, v61, v61 row_half_mirror row_mask:0xf bank_mask:0xf
    v_add_f32_dpp v62, v62, v62 row_half_mirror row_mask:0xf bank_mask:0xf
    v_add_f32_dpp v63, v63, v63 row_half_mirror row_mask:0xf bank_mask:0xf
    v_cmp_eq_u32 vcc, 1, v38
    s_nop 1
    v_cndmask_b32 v56, v56, v58, vcc
    v_cndmask_b32 v57, v57, v59, vcc
    v_cmp_eq_u32 vcc, 2, v38
    s_nop 1
    v_cndmask_b32 v56, v56, v60, vcc
    v_cndmask_b32 v57, v57, v61, vcc
    v_cmp_eq_u32 vcc, 3, v38
    s_nop 1
    v_cndmask_b32 v56, v56, v62, vcc
    v_cndmask_b32 v57, v57, v63, vcc
    s_lshl_b32 s44, s21, 18
    s_lshl_b32 s45, s38, 12
    s_add_u32 s44, s44, s45
    s_lshl_b32 s45, s18, 8
    s_add_u32 s44, s44, s45
    s_add_u32 s44, s44, 50331648
    buffer_store_dwordx2 v[56:57], v39, s[4:7], s44 offen sc1
    s_lshl_b32 s46, s21, 14
    s_lshl_b32 s67, s38, 7
    s_add_u32 s46, s46, s67
    s_add_u32 s46, s46, 4096
    s_add_u32 s47, s46, 8192
    s_lshl_b32 s48, s21, 22
    s_lshl_b32 s49, s38, 16
    s_add_u32 s41, s48, s49
    v_lshrrev_b32 v16, 4, v1
    v_and_b32 v17, 15, v16
    v_lshrrev_b32 v16, 4, v16
    s_lshl_b32 s49, s16, 7
    s_add_u32 s50, s49, 151552
    s_and_b32 s49, s21, 1
    s_lshl_b32 s49, s49, 10
    s_add_u32 s49, s49, 151552
    v_lshlrev_b32 v11, 4, v16
    v_add_u32 v13, s50, v11
    v_add_u32 v11, s49, v11
    v_lshlrev_b32 v15, 2, v17
    v_add_u32 v9, s50, v15
    v_add_u32 v15, s49, v15
    s_lshr_b32 s49, s21, 1
    s_lshl_b32 s53, s49, 23
    s_lshl_b32 s50, s18, 18
    s_add_u32 s53, s53, s50
    s_add_u32 s53, s53, 33554432
    s_lshl_b32 s54, s38, 11
    s_add_u32 s52, s53, s54
    s_lshl_b32 s59, s49, 13
    s_lshl_b32 s67, s18, 9
    s_add_u32 s59, s59, s67
    s_lshl_b32 s67, s16, 7
    s_add_u32 s59, s59, s67
    s_add_u32 s59, s59, 69632
    s_lshl_b32 s61, s49, 15
    s_lshl_b32 s67, s17, 11
    s_add_u32 s61, s61, s67
    s_lshl_b32 s67, s18, 7
    s_add_u32 s61, s61, s67
    s_add_u32 s61, s61, 151552
    s_sub_u32 s60, s61, 151552
    s_lshl_b32 s60, s60, 5
    s_add_u32 s60, s60, 54525952
    s_lshl_b32 s62, s16, 12
    s_add_u32 s62, s62, 131072
    v_bfe_u32 v80, v8, 3, 1
    v_and_b32 v81, 7, v8
    v_lshrrev_b32 v82, 5, v8
    v_lshlrev_b32 v82, 1, v82
    v_xor_b32 v82, v82, v81
    v_xor_b32 v82, v82, v80
    v_lshlrev_b32 v82, 4, v82
    v_lshl_add_u32 v82, v81, 7, v82
    v_lshl_add_u32 v82, v80, 10, v82
    v_bfe_u32 v80, v8, 4, 1
    v_lshl_add_u32 v82, v80, 3, v82
    v_add_u32 v20, s76, v82
    v_xor_b32 v21, 16, v20
    v_xor_b32 v22, 64, v20
    v_xor_b32 v23, 80, v20
    v_add_u32 v80, s62, v2
    ds_read_b128 v[160:163], v80 offset:0
    ds_read_b128 v[164:167], v80 offset:256
    ds_read_b128 v[168:171], v80 offset:2048
    ds_read_b128 v[172:175], v80 offset:2304
    s_mov_b64 vcc, -1
    s_mov_b32 s48, 1
    s_or_b32 s20, s19, 0x80000000
    s_barrier
    ds_read_b64_tr_b16 v[32:33], v3 offset:0
    ds_read_b64_tr_b16 v[34:35], v3 offset:1024
    ds_read_b64_tr_b16 v[36:37], v4 offset:0
    ds_read_b64_tr_b16 v[38:39], v4 offset:1024
    ds_read_b64_tr_b16 v[40:41], v5 offset:0
    ds_read_b64_tr_b16 v[42:43], v5 offset:1024
    ds_read_b64_tr_b16 v[44:45], v6 offset:0
    ds_read_b64_tr_b16 v[46:47], v6 offset:1024
    ds_read_b64_tr_b16 v[48:49], v3 offset:4096
    ds_read_b64_tr_b16 v[50:51], v3 offset:5120
    ds_read_b64_tr_b16 v[52:53], v4 offset:4096
    ds_read_b64_tr_b16 v[54:55], v4 offset:5120
    ds_read_b64_tr_b16 v[56:57], v5 offset:4096
    ds_read_b64_tr_b16 v[58:59], v5 offset:5120
    s_branch c_g0
c_st1:
    s_waitcnt vmcnt(1)
    ds_read_b64 v[176:177], v20 offset:4096
    ds_read_b64 v[178:179], v21 offset:4096
    ds_read_b64 v[180:181], v20 offset:6144
    ds_read_b64 v[182:183], v21 offset:6144
    ds_read_b64 v[184:185], v22 offset:4096
    ds_read_b64 v[186:187], v23 offset:4096
    ds_read_b64 v[188:189], v22 offset:6144
    ds_read_b64 v[190:191], v23 offset:6144
    ds_read_b64 v[192:193], v20 offset:8192
    ds_read_b64 v[194:195], v21 offset:8192
    ds_read_b64 v[196:197], v20 offset:10240
    ds_read_b64 v[198:199], v21 offset:10240
    ds_read_b64 v[200:201], v22 offset:8192
    ds_read_b64 v[202:203], v23 offset:8192
    ds_read_b64 v[204:205], v22 offset:10240
    ds_read_b64 v[206:207], v23 offset:10240
    ds_read_b64 v[208:209], v20 offset:12288
    ds_read_b64 v[210:211], v21 offset:12288
    ds_read_b64 v[212:213], v20 offset:14336
    ds_read_b64 v[214:215], v21 offset:14336
    ds_read_b64 v[216:217], v22 offset:12288
    ds_read_b64 v[218:219], v23 offset:12288
    ds_read_b64 v[220:221], v22 offset:14336
    ds_read_b64 v[222:223], v23 offset:14336
    ds_read_b64 v[224:225], v20 offset:16384
    ds_read_b64 v[226:227], v21 offset:16384
    ds_read_b64 v[228:229], v20 offset:18432
    ds_read_b64 v[230:231], v21 offset:18432
    ds_read_b64 v[232:233], v22 offset:16384
    ds_read_b64 v[234:235], v23 offset:16384
    ds_read_b64 v[236:237], v22 offset:18432
    ds_read_b64 v[238:239], v23 offset:18432
    s_load_dword s68, s[34:35], 0
    s_mov_b32 s8, s34
    s_mov_b32 s9, s35
    s_mov_b32 s10, 256
    s_mov_b32 s11, 0x00020000
    s_mov_b32 s66, 0x10000
    v_mov_b32 v16, 0
    s_waitcnt lgkmcnt(0)
c_f0:
    s_cmp_eq_u32 s68, 10
    s_cbranch_scc1 c_f0_ok
    buffer_load_dword v17, v16, s[8:11], 0 offen offset:0 sc1
    s_waitcnt vmcnt(0)
    v_readfirstlane_b32 s68, v17
    s_sub_u32 s66, s66, 1
    s_cmp_lg_u32 s66, 0
    s_cbranch_scc1 c_f0
c_f0_ok:
    s_atomic_add s63, s[22:23], s46
    s_branch c_st2
c_cs1:
    s_waitcnt vmcnt(0)
    s_atomic_add s40, s[22:23], s47
    s_branch c_cs2
c_layer:
    s_mov_b64 vcc, 0
c_early2:
    s_barrier
    ds_read_b64_tr_b16 v[32:33], v3 offset:0
    ds_read_b64_tr_b16 v[34:35], v3 offset:1024
    ds_read_b64_tr_b16 v[36:37], v4 offset:0
    ds_read_b64_tr_b16 v[38:39], v4 offset:1024
    ds_read_b64_tr_b16 v[40:41], v5 offset:0
    ds_read_b64_tr_b16 v[42:43], v5 offset:1024
    ds_read_b64_tr_b16 v[44:45], v6 offset:0
    ds_read_b64_tr_b16 v[46:47], v6 offset:1024
    ds_read_b64_tr_b16 v[48:49], v3 offset:4096
    ds_read_b64_tr_b16 v[50:51], v3 offset:5120
    ds_read_b64_tr_b16 v[52:53], v4 offset:4096
    ds_read_b64_tr_b16 v[54:55], v4 offset:5120
    ds_read_b64_tr_b16 v[56:57], v5 offset:4096
    ds_read_b64_tr_b16 v[58:59], v5 offset:5120
c_g0:
    s_waitcnt lgkmcnt(10)
    v_mfma_f32_16x16x32_bf16 v[64:67], v[32:35], v[160:163], 0
    ds_read_b64_tr_b16 v[60:61], v6 offset:4096
    v_mfma_f32_16x16x32_bf16 v[68:71], v[32:35], v[164:167], 0
    ds_read_b64_tr_b16 v[62:63], v6 offset:5120
    v_mfma_f32_16x16x32_bf16 v[72:75], v[36:39], v[160:163], 0
    ds_read_b64_tr_b16 v[32:33], v3 offset:8192
    v_mfma_f32_16x16x32_bf16 v[76:79], v[36:39], v[164:167], 0
    ds_read_b64_tr_b16 v[34:35], v3 offset:9216
    s_waitcnt lgkmcnt(10)
    v_mfma_f32_16x16x32_bf16 v[80:83], v[40:43], v[160:163], 0
    ds_read_b64_tr_b16 v[36:37], v4 offset:8192
    v_mfma_f32_16x16x32_bf16 v[84:87], v[40:43], v[164:167], 0
    ds_read_b64_tr_b16 v[38:39], v4 offset:9216
    v_mfma_f32_16x16x32_bf16 v[88:91], v[44:47], v[160:163], 0
    ds_read_b64_tr_b16 v[40:41], v5 offset:8192
    v_mfma_f32_16x16x32_bf16 v[92:95], v[44:47], v[164:167], 0
    ds_read_b64_tr_b16 v[42:43], v5 offset:9216
    s_waitcnt lgkmcnt(10)
    v_mfma_f32_16x16x32_bf16 v[96:99], v[160:163], v[48:51], 0
    ds_read_b64_tr_b16 v[44:45], v6 offset:8192
    v_mfma_f32_16x16x32_bf16 v[100:103], v[164:167], v[48:51], 0
    ds_read_b64_tr_b16 v[46:47], v6 offset:9216
    v_mfma_f32_16x16x32_bf16 v[104:107], v[160:163], v[52:55], 0
    ds_read_b64_tr_b16 v[48:49], v3 offset:12288
    v_mfma_f32_16x16x32_bf16 v[108:111], v[164:167], v[52:55], 0
    ds_read_b64_tr_b16 v[50:51], v3 offset:13312
    s_waitcnt lgkmcnt(10)
    v_mfma_f32_16x16x32_bf16 v[112:115], v[160:163], v[56:59], 0
    ds_read_b64_tr_b16 v[52:53], v4 offset:12288
    v_mfma_f32_16x16x32_bf16 v[116:119], v[164:167], v[56:59], 0
    ds_read_b64_tr_b16 v[54:55], v4 offset:13312
    v_mfma_f32_16x16x32_bf16 v[120:123], v[160:163], v[60:63], 0
    ds_read_b64_tr_b16 v[56:57], v5 offset:12288
    v_mfma_f32_16x16x32_bf16 v[124:127], v[164:167], v[60:63], 0
    ds_read_b64_tr_b16 v[58:59], v5 offset:13312
    s_cmp_lg_u32 s48, 0
    s_cbranch_scc1 c_gate
    s_mov_b32 s66, 0x10000
    s_waitcnt lgkmcnt(0)
    s_and_b32 s68, s68, s19
    s_cmp_eq_u32 s68, s19
    s_cbranch_scc1 c_x_ok
c_x_poll:
    s_mov_b32 s68, 0
    s_atomic_add s68, s[22:23], s46 offset:0 glc
    s_sub_u32 s66, s66, 1
    s_cselect_b32 s67, s19, 0
    s_waitcnt lgkmcnt(0)
    s_and_b32 s68, s68, s19
    s_max_u32 s68, s68, s67
    s_cmp_lt_u32 s68, s19
    s_cbranch_scc1 c_x_poll
c_x_ok:
    s_add_u32 s42, s41, s85
    buffer_load_dwordx4 v[176:179], v2, s[4:7], s42 offen offset:0 sc1
    buffer_load_dwordx4 v[180:183], v2, s[4:7], s42 offen offset:256 sc1
    buffer_load_dwordx4 v[184:187], v2, s[4:7], s42 offen offset:2048 sc1
    buffer_load_dwordx4 v[188:191], v2, s[4:7], s42 offen offset:2304 sc1
    s_add_u32 s42, s41, s86
    buffer_load_dwordx4 v[192:195], v2, s[4:7], s42 offen offset:0 sc1
    buffer_load_dwordx4 v[196:199], v2, s[4:7], s42 offen offset:256 sc1
    buffer_load_dwordx4 v[200:203], v2, s[4:7], s42 offen offset:2048 sc1
    buffer_load_dwordx4 v[204:207], v2, s[4:7], s42 offen offset:2304 sc1
    s_add_u32 s42, s41, s87
    buffer_load_dwordx4 v[208:211], v2, s[4:7], s42 offen offset:0 sc1
    buffer_load_dwordx4 v[212:215], v2, s[4:7], s42 offen offset:256 sc1
    s_waitcnt vmcnt(10)
    s_atomic_add s40, s[22:23], s47
c_gate:
    s_waitcnt lgkmcnt(10)
    v_mfma_f32_16x16x32_bf16 v[128:131], v[32:35], v[160:163], 0
    ds_read_b64_tr_b16 v[60:61], v6 offset:12288
    v_mfma_f32_16x16x32_bf16 v[132:135], v[32:35], v[164:167], 0
    ds_read_b64_tr_b16 v[62:63], v6 offset:13312
    v_mfma_f32_16x16x32_bf16 v[136:139], v[36:39], v[160:163], 0
    ds_read_b64_tr_b16 v[32:33], v3 offset:16384
    v_mfma_f32_16x16x32_bf16 v[140:143], v[36:39], v[164:167], 0
    ds_read_b64_tr_b16 v[34:35], v3 offset:17408
    s_waitcnt lgkmcnt(10)
    v_mfma_f32_16x16x32_bf16 v[144:147], v[40:43], v[160:163], 0
    ds_read_b64_tr_b16 v[36:37], v4 offset:16384
    v_mfma_f32_16x16x32_bf16 v[148:151], v[40:43], v[164:167], 0
    ds_read_b64_tr_b16 v[38:39], v4 offset:17408
    v_mfma_f32_16x16x32_bf16 v[152:155], v[44:47], v[160:163], 0
    ds_read_b64_tr_b16 v[40:41], v5 offset:16384
    v_mfma_f32_16x16x32_bf16 v[156:159], v[44:47], v[164:167], 0
    ds_read_b64_tr_b16 v[42:43], v5 offset:17408
    s_waitcnt lgkmcnt(10)
    v_mfma_f32_16x16x32_bf16 v[64:67], v[48:51], v[168:171], v[64:67]
    ds_read_b64_tr_b16 v[44:45], v6 offset:16384
    v_mfma_f32_16x16x32_bf16 v[68:71], v[48:51], v[172:175], v[68:71]
    ds_read_b64_tr_b16 v[46:47], v6 offset:17408
    v_mfma_f32_16x16x32_bf16 v[72:75], v[52:55], v[168:171], v[72:75]
    ds_read_b64_tr_b16 v[48:49], v3 offset:20480
    v_mfma_f32_16x16x32_bf16 v[76:79], v[52:55], v[172:175], v[76:79]
    ds_read_b64_tr_b16 v[50:51], v3 offset:21504
    s_waitcnt lgkmcnt(10)
    v_mfma_f32_16x16x32_bf16 v[80:83], v[56:59], v[168:171], v[80:83]
    ds_read_b64_tr_b16 v[52:53], v4 offset:20480
    v_mfma_f32_16x16x32_bf16 v[84:87], v[56:59], v[172:175], v[84:87]
    ds_read_b64_tr_b16 v[54:55], v4 offset:21504
    v_mfma_f32_16x16x32_bf16 v[88:91], v[60:63], v[168:171], v[88:91]
    ds_read_b64_tr_b16 v[56:57], v5 offset:20480
    v_mfma_f32_16x16x32_bf16 v[92:95], v[60:63], v[172:175], v[92:95]
    ds_read_b64_tr_b16 v[58:59], v5 offset:21504
    s_waitcnt lgkmcnt(10)
    v_mfma_f32_16x16x32_bf16 v[96:99], v[168:171], v[32:35], v[96:99]
    ds_read_b64_tr_b16 v[60:61], v6 offset:20480
    v_mfma_f32_16x16x32_bf16 v[100:103], v[172:175], v[32:35], v[100:103]
    ds_read_b64_tr_b16 v[62:63], v6 offset:21504
    v_mfma_f32_16x16x32_bf16 v[104:107], v[168:171], v[36:39], v[104:107]
    ds_read_b64_tr_b16 v[32:33], v3 offset:24576
    v_mfma_f32_16x16x32_bf16 v[108:111], v[172:175], v[36:39], v[108:111]
    ds_read_b64_tr_b16 v[34:35], v3 offset:25600
    s_waitcnt lgkmcnt(10)
    v_mfma_f32_16x16x32_bf16 v[112:115], v[168:171], v[40:43], v[112:115]
    ds_read_b64_tr_b16 v[36:37], v4 offset:24576
    v_mfma_f32_16x16x32_bf16 v[116:119], v[172:175], v[40:43], v[116:119]
    ds_read_b64_tr_b16 v[38:39], v4 offset:25600
    v_mfma_f32_16x16x32_bf16 v[120:123], v[168:171], v[44:47], v[120:123]
    ds_read_b64_tr_b16 v[40:41], v5 offset:24576
    v_mfma_f32_16x16x32_bf16 v[124:127], v[172:175], v[44:47], v[124:127]
    ds_read_b64_tr_b16 v[42:43], v5 offset:25600
    s_waitcnt lgkmcnt(10)
    v_mfma_f32_16x16x32_bf16 v[128:131], v[48:51], v[168:171], v[128:131]
    ds_read_b64_tr_b16 v[44:45], v6 offset:24576
    v_mfma_f32_16x16x32_bf16 v[132:135], v[48:51], v[172:175], v[132:135]
    ds_read_b64_tr_b16 v[46:47], v6 offset:25600
    v_mfma_f32_16x16x32_bf16 v[136:139], v[52:55], v[168:171], v[136:139]
    ds_read_b64_tr_b16 v[48:49], v3 offset:28672
    v_mfma_f32_16x16x32_bf16 v[140:143], v[52:55], v[172:175], v[140:143]
    ds_read_b64_tr_b16 v[50:51], v3 offset:29696
    s_waitcnt lgkmcnt(10)
    v_mfma_f32_16x16x32_bf16 v[144:147], v[56:59], v[168:171], v[144:147]
    ds_read_b64_tr_b16 v[52:53], v4 offset:28672
    v_mfma_f32_16x16x32_bf16 v[148:151], v[56:59], v[172:175], v[148:151]
    ds_read_b64_tr_b16 v[54:55], v4 offset:29696
    v_mfma_f32_16x16x32_bf16 v[152:155], v[60:63], v[168:171], v[152:155]
    ds_read_b64_tr_b16 v[56:57], v5 offset:28672
    v_mfma_f32_16x16x32_bf16 v[156:159], v[60:63], v[172:175], v[156:159]
    ds_read_b64_tr_b16 v[58:59], v5 offset:29696
    s_cbranch_vccnz c_st1
c_st2:
    s_waitcnt vmcnt(8) lgkmcnt(10)
    v_mfma_f32_16x16x32_bf16 v[64:67], v[32:35], v[176:179], v[64:67]
    ds_read_b64_tr_b16 v[60:61], v6 offset:28672
    v_mfma_f32_16x16x32_bf16 v[68:71], v[32:35], v[180:183], v[68:71]
    ds_read_b64_tr_b16 v[62:63], v6 offset:29696
    s_barrier
    v_mfma_f32_16x16x32_bf16 v[72:75], v[36:39], v[176:179], v[72:75]
    ds_read_b64_tr_b16 v[32:33], v3 offset:32768
    v_mfma_f32_16x16x32_bf16 v[76:79], v[36:39], v[180:183], v[76:79]
    ds_read_b64_tr_b16 v[34:35], v3 offset:33792
    s_waitcnt lgkmcnt(10)
    v_mfma_f32_16x16x32_bf16 v[80:83], v[40:43], v[176:179], v[80:83]
    ds_read_b64_tr_b16 v[36:37], v4 offset:32768
    v_mfma_f32_16x16x32_bf16 v[84:87], v[40:43], v[180:183], v[84:87]
    ds_read_b64_tr_b16 v[38:39], v4 offset:33792
    v_mfma_f32_16x16x32_bf16 v[88:91], v[44:47], v[176:179], v[88:91]
    ds_read_b64_tr_b16 v[40:41], v5 offset:32768
    v_mfma_f32_16x16x32_bf16 v[92:95], v[44:47], v[180:183], v[92:95]
    ds_read_b64_tr_b16 v[42:43], v5 offset:33792
    s_waitcnt lgkmcnt(10)
    v_mfma_f32_16x16x32_bf16 v[96:99], v[176:179], v[48:51], v[96:99]
    ds_read_b64_tr_b16 v[44:45], v6 offset:32768
    v_mfma_f32_16x16x32_bf16 v[100:103], v[180:183], v[48:51], v[100:103]
    ds_read_b64_tr_b16 v[46:47], v6 offset:33792
    v_mfma_f32_16x16x32_bf16 v[104:107], v[176:179], v[52:55], v[104:107]
    ds_read_b64_tr_b16 v[48:49], v3 offset:36864
    v_mfma_f32_16x16x32_bf16 v[108:111], v[180:183], v[52:55], v[108:111]
    ds_read_b64_tr_b16 v[50:51], v3 offset:37888
    s_waitcnt lgkmcnt(10)
    v_mfma_f32_16x16x32_bf16 v[112:115], v[176:179], v[56:59], v[112:115]
    ds_read_b64_tr_b16 v[52:53], v4 offset:36864
    v_mfma_f32_16x16x32_bf16 v[116:119], v[180:183], v[56:59], v[116:119]
    ds_read_b64_tr_b16 v[54:55], v4 offset:37888
    v_mfma_f32_16x16x32_bf16 v[120:123], v[176:179], v[60:63], v[120:123]
    ds_read_b64_tr_b16 v[56:57], v5 offset:36864
    v_mfma_f32_16x16x32_bf16 v[124:127], v[180:183], v[60:63], v[124:127]
    ds_read_b64_tr_b16 v[58:59], v5 offset:37888
    s_waitcnt lgkmcnt(10)
    v_mfma_f32_16x16x32_bf16 v[128:131], v[32:35], v[176:179], v[128:131]
    ds_read_b64_tr_b16 v[60:61], v6 offset:36864
    v_mfma_f32_16x16x32_bf16 v[132:135], v[32:35], v[180:183], v[132:135]
    ds_read_b64_tr_b16 v[62:63], v6 offset:37888
    v_mfma_f32_16x16x32_bf16 v[136:139], v[36:39], v[176:179], v[136:139]
    ds_read_b64_tr_b16 v[32:33], v3 offset:40960
    v_mfma_f32_16x16x32_bf16 v[140:143], v[36:39], v[180:183], v[140:143]
    ds_read_b64_tr_b16 v[34:35], v3 offset:41984
    s_waitcnt lgkmcnt(10)
    v_mfma_f32_16x16x32_bf16 v[144:147], v[40:43], v[176:179], v[144:147]
    ds_read_b64_tr_b16 v[36:37], v4 offset:40960
    v_mfma_f32_16x16x32_bf16 v[148:151], v[40:43], v[180:183], v[148:151]
    ds_read_b64_tr_b16 v[38:39], v4 offset:41984
    v_mfma_f32_16x16x32_bf16 v[152:155], v[44:47], v[176:179], v[152:155]
    ds_read_b64_tr_b16 v[40:41], v5 offset:40960
    v_mfma_f32_16x16x32_bf16 v[156:159], v[44:47], v[180:183], v[156:159]
    ds_read_b64_tr_b16 v[42:43], v5 offset:41984
    s_waitcnt vmcnt(6) lgkmcnt(10)
    v_mfma_f32_16x16x32_bf16 v[64:67], v[48:51], v[184:187], v[64:67]
    s_add_u32 s42, s41, s87
    s_cbranch_vccnz xs1
    buffer_load_dwordx4 v[216:219], v2, s[4:7], s42 offen offset:2048 sc1
xs1:
    ds_read_b64_tr_b16 v[44:45], v6 offset:40960
    v_mfma_f32_16x16x32_bf16 v[68:71], v[48:51], v[188:191], v[68:71]
    ds_read_b64_tr_b16 v[46:47], v6 offset:41984
    v_mfma_f32_16x16x32_bf16 v[72:75], v[52:55], v[184:187], v[72:75]
    s_cbranch_vccnz xs2
    buffer_load_dwordx4 v[220:223], v2, s[4:7], s42 offen offset:2304 sc1
xs2:
    ds_read_b64_tr_b16 v[48:49], v3 offset:45056
    s_add_u32 s42, s41, s88
    v_mfma_f32_16x16x32_bf16 v[76:79], v[52:55], v[188:191], v[76:79]
    ds_read_b64_tr_b16 v[50:51], v3 offset:46080
    s_waitcnt lgkmcnt(10)
    v_mfma_f32_16x16x32_bf16 v[80:83], v[56:59], v[184:187], v[80:83]
    s_cbranch_vccnz xs3
    buffer_load_dwordx4 v[224:227], v2, s[4:7], s42 offen offset:0 sc1
xs3:
    ds_read_b64_tr_b16 v[52:53], v4 offset:45056
    v_mfma_f32_16x16x32_bf16 v[84:87], v[56:59], v[188:191], v[84:87]
    ds_read_b64_tr_b16 v[54:55], v4 offset:46080
    v_mfma_f32_16x16x32_bf16 v[88:91], v[60:63], v[184:187], v[88:91]
    s_cbranch_vccnz xs4
    buffer_load_dwordx4 v[228:231], v2, s[4:7], s42 offen offset:256 sc1
xs4:
    ds_read_b64_tr_b16 v[56:57], v5 offset:45056
    v_mfma_f32_16x16x32_bf16 v[92:95], v[60:63], v[188:191], v[92:95]
    ds_read_b64_tr_b16 v[58:59], v5 offset:46080
    s_waitcnt lgkmcnt(10)
    v_mfma_f32_16x16x32_bf16 v[96:99], v[184:187], v[32:35], v[96:99]
    ds_read_b64_tr_b16 v[60:61], v6 offset:45056
    s_cbranch_vccnz xs5
    buffer_load_dwordx4 v[232:235], v2, s[4:7], s42 offen offset:2048 sc1
xs5:
    s_cbranch_vccnz c_cs1
c_cs2:
    v_mfma_f32_16x16x32_bf16 v[100:103], v[188:191], v[32:35], v[100:103]
    ds_read_b64_tr_b16 v[62:63], v6 offset:46080
    v_mfma_f32_16x16x32_bf16 v[104:107], v[184:187], v[36:39], v[104:107]
    s_cbranch_vccnz xs6
    buffer_load_dwordx4 v[236:239], v2, s[4:7], s42 offen offset:2304 sc1
xs6:
    ds_read_b64_tr_b16 v[32:33], v3 offset:49152
    s_add_u32 s42, s41, s89
    v_mfma_f32_16x16x32_bf16 v[108:111], v[188:191], v[36:39], v[108:111]
    ds_read_b64_tr_b16 v[34:35], v3 offset:50176
    s_waitcnt lgkmcnt(10)
    v_mfma_f32_16x16x32_bf16 v[112:115], v[184:187], v[40:43], v[112:115]
    ds_read_b64_tr_b16 v[36:37], v4 offset:49152
    v_mfma_f32_16x16x32_bf16 v[116:119], v[188:191], v[40:43], v[116:119]
    ds_read_b64_tr_b16 v[38:39], v4 offset:50176
    v_mfma_f32_16x16x32_bf16 v[120:123], v[184:187], v[44:47], v[120:123]
    ds_read_b64_tr_b16 v[40:41], v5 offset:49152
    v_mfma_f32_16x16x32_bf16 v[124:127], v[188:191], v[44:47], v[124:127]
    ds_read_b64_tr_b16 v[42:43], v5 offset:50176
    s_waitcnt lgkmcnt(10)
    v_mfma_f32_16x16x32_bf16 v[128:131], v[48:51], v[184:187], v[128:131]
    ds_read_b64_tr_b16 v[44:45], v6 offset:49152
    v_mfma_f32_16x16x32_bf16 v[132:135], v[48:51], v[188:191], v[132:135]
    ds_read_b64_tr_b16 v[46:47], v6 offset:50176
    v_mfma_f32_16x16x32_bf16 v[136:139], v[52:55], v[184:187], v[136:139]
    ds_read_b64_tr_b16 v[48:49], v3 offset:53248
    v_mfma_f32_16x16x32_bf16 v[140:143], v[52:55], v[188:191], v[140:143]
    ds_read_b64_tr_b16 v[50:51], v3 offset:54272
    s_waitcnt lgkmcnt(10)
    v_mfma_f32_16x16x32_bf16 v[144:147], v[56:59], v[184:187], v[144:147]
    ds_read_b64_tr_b16 v[52:53], v4 offset:53248
    v_mfma_f32_16x16x32_bf16 v[148:151], v[56:59], v[188:191], v[148:151]
    ds_read_b64_tr_b16 v[54:55], v4 offset:54272
    v_mfma_f32_16x16x32_bf16 v[152:155], v[60:63], v[184:187], v[152:155]
    ds_read_b64_tr_b16 v[56:57], v5 offset:53248
    v_mfma_f32_16x16x32_bf16 v[156:159], v[60:63], v[188:191], v[156:159]
    ds_read_b64_tr_b16 v[58:59], v5 offset:54272
    s_waitcnt vmcnt(10) lgkmcnt(10)
    v_mfma_f32_16x16x32_bf16 v[64:67], v[32:35], v[192:195], v[64:67]
    ds_read_b64_tr_b16 v[60:61], v6 offset:53248
    v_mfma_f32_16x16x32_bf16 v[68:71], v[32:35], v[196:199], v[68:71]
    ds_read_b64_tr_b16 v[62:63], v6 offset:54272
    v_mfma_f32_16x16x32_bf16 v[72:75], v[36:39], v[192:195], v[72:75]
    ds_read_b64_tr_b16 v[32:33], v3 offset:57344
    v_mfma_f32_16x16x32_bf16 v[76:79], v[36:39], v[196:199], v[76:79]
    ds_read_b64_tr_b16 v[34:35], v3 offset:58368
    s_waitcnt lgkmcnt(10)
    v_mfma_f32_16x16x32_bf16 v[80:83], v[40:43], v[192:195], v[80:83]
    ds_read_b64_tr_b16 v[36:37], v4 offset:57344
    v_mfma_f32_16x16x32_bf16 v[84:87], v[40:43], v[196:199], v[84:87]
    ds_read_b64_tr_b16 v[38:39], v4 offset:58368
    v_mfma_f32_16x16x32_bf16 v[88:91], v[44:47], v[192:195], v[88:91]
    ds_read_b64_tr_b16 v[40:41], v5 offset:57344
    v_mfma_f32_16x16x32_bf16 v[92:95], v[44:47], v[196:199], v[92:95]
    ds_read_b64_tr_b16 v[42:43], v5 offset:58368
    s_waitcnt lgkmcnt(10)
    v_mfma_f32_16x16x32_bf16 v[96:99], v[192:195], v[48:51], v[96:99]
    ds_read_b64_tr_b16 v[44:45], v6 offset:57344
    v_mfma_f32_16x16x32_bf16 v[100:103], v[196:199], v[48:51], v[100:103]
    ds_read_b64_tr_b16 v[46:47], v6 offset:58368
    v_mfma_f32_16x16x32_bf16 v[104:107], v[192:195], v[52:55], v[104:107]
    ds_read_b64_tr_b16 v[48:49], v3 offset:61440
    v_mfma_f32_16x16x32_bf16 v[108:111], v[196:199], v[52:55], v[108:111]
    ds_read_b64_tr_b16 v[50:51], v3 offset:62464
    s_waitcnt lgkmcnt(10)
    v_mfma_f32_16x16x32_bf16 v[112:115], v[192:195], v[56:59], v[112:115]
    ds_read_b64_tr_b16 v[52:53], v4 offset:61440
    v_mfma_f32_16x16x32_bf16 v[116:119], v[196:199], v[56:59], v[116:119]
    ds_read_b64_tr_b16 v[54:55], v4 offset:62464
    v_mfma_f32_16x16x32_bf16 v[120:123], v[192:195], v[60:63], v[120:123]
    ds_read_b64_tr_b16 v[56:57], v5 offset:61440
    v_mfma_f32_16x16x32_bf16 v[124:127], v[196:199], v[60:63], v[124:127]
    ds_read_b64_tr_b16 v[58:59], v5 offset:62464
    s_waitcnt lgkmcnt(10)
    v_mfma_f32_16x16x32_bf16 v[128:131], v[32:35], v[192:195], v[128:131]
    ds_read_b64_tr_b16 v[60:61], v6 offset:61440
    v_mfma_f32_16x16x32_bf16 v[132:135], v[32:35], v[196:199], v[132:135]
    ds_read_b64_tr_b16 v[62:63], v6 offset:62464
    s_barrier
    v_xor_b32 v3, 0x10000, v3
    v_xor_b32 v4, 0x10000, v4
    v_xor_b32 v5, 0x10000, v5
    v_xor_b32 v6, 0x10000, v6
    v_mfma_f32_16x16x32_bf16 v[136:139], v[36:39], v[192:195], v[136:139]
    ds_read_b64_tr_b16 v[32:33], v3 offset:0
    v_mfma_f32_16x16x32_bf16 v[140:143], v[36:39], v[196:199], v[140:143]
    ds_read_b64_tr_b16 v[34:35], v3 offset:1024
    s_waitcnt lgkmcnt(10)
    v_mfma_f32_16x16x32_bf16 v[144:147], v[40:43], v[192:195], v[144:147]
    ds_read_b64_tr_b16 v[36:37], v4 offset:0
    v_mfma_f32_16x16x32_bf16 v[148:151], v[40:43], v[196:199], v[148:151]
    ds_read_b64_tr_b16 v[38:39], v4 offset:1024
    v_mfma_f32_16x16x32_bf16 v[152:155], v[44:47], v[192:195], v[152:155]
    ds_read_b64_tr_b16 v[40:41], v5 offset:0
    v_mfma_f32_16x16x32_bf16 v[156:159], v[44:47], v[196:199], v[156:159]
    ds_read_b64_tr_b16 v[42:43], v5 offset:1024
    s_waitcnt vmcnt(8) lgkmcnt(10)
    v_mfma_f32_16x16x32_bf16 v[64:67], v[48:51], v[200:203], v[64:67]
    ds_read_b64_tr_b16 v[44:45], v6 offset:0
    v_mfma_f32_16x16x32_bf16 v[68:71], v[48:51], v[204:207], v[68:71]
    ds_read_b64_tr_b16 v[46:47], v6 offset:1024
    v_mfma_f32_16x16x32_bf16 v[72:75], v[52:55], v[200:203], v[72:75]
    ds_read_b64_tr_b16 v[48:49], v3 offset:4096
    v_mfma_f32_16x16x32_bf16 v[76:79], v[52:55], v[204:207], v[76:79]
    ds_read_b64_tr_b16 v[50:51], v3 offset:5120
    s_waitcnt lgkmcnt(10)
    v_mfma_f32_16x16x32_bf16 v[80:83], v[56:59], v[200:203], v[80:83]
    ds_read_b64_tr_b16 v[52:53], v4 offset:4096
    v_mfma_f32_16x16x32_bf16 v[84:87], v[56:59], v[204:207], v[84:87]
    ds_read_b64_tr_b16 v[54:55], v4 offset:5120
    v_mfma_f32_16x16x32_bf16 v[88:91], v[60:63], v[200:203], v[88:91]
    ds_read_b64_tr_b16 v[56:57], v5 offset:4096
    v_mfma_f32_16x16x32_bf16 v[92:95], v[60:63], v[204:207], v[92:95]
    ds_read_b64_tr_b16 v[58:59], v5 offset:5120
    s_waitcnt lgkmcnt(10)
    v_mfma_f32_16x16x32_bf16 v[96:99], v[200:203], v[32:35], v[96:99]
    ds_read_b64_tr_b16 v[60:61], v6 offset:4096
    v_mfma_f32_16x16x32_bf16 v[100:103], v[204:207], v[32:35], v[100:103]
    ds_read_b64_tr_b16 v[62:63], v6 offset:5120
    v_mfma_f32_16x16x32_bf16 v[104:107], v[200:203], v[36:39], v[104:107]
    ds_read_b64_tr_b16 v[32:33], v3 offset:8192
    v_mfma_f32_16x16x32_bf16 v[108:111], v[204:207], v[36:39], v[108:111]
    ds_read_b64_tr_b16 v[34:35], v3 offset:9216
    s_waitcnt lgkmcnt(10)
    v_mfma_f32_16x16x32_bf16 v[112:115], v[200:203], v[40:43], v[112:115]
    ds_read_b64_tr_b16 v[36:37], v4 offset:8192
    v_mfma_f32_16x16x32_bf16 v[116:119], v[204:207], v[40:43], v[116:119]
    ds_read_b64_tr_b16 v[38:39], v4 offset:9216
    v_mfma_f32_16x16x32_bf16 v[120:123], v[200:203], v[44:47], v[120:123]
    ds_read_b64_tr_b16 v[40:41], v5 offset:8192
    v_mfma_f32_16x16x32_bf16 v[124:127], v[204:207], v[44:47], v[124:127]
    ds_read_b64_tr_b16 v[42:43], v5 offset:9216
    s_waitcnt lgkmcnt(10)
    v_mfma_f32_16x16x32_bf16 v[128:131], v[48:51], v[200:203], v[128:131]
    ds_read_b64_tr_b16 v[44:45], v6 offset:8192
    v_mfma_f32_16x16x32_bf16 v[132:135], v[48:51], v[204:207], v[132:135]
    ds_read_b64_tr_b16 v[46:47], v6 offset:9216
    v_mfma_f32_16x16x32_bf16 v[136:139], v[52:55], v[200:203], v[136:139]
    ds_read_b64_tr_b16 v[48:49], v3 offset:12288
    v_mfma_f32_16x16x32_bf16 v[140:143], v[52:55], v[204:207], v[140:143]
    ds_read_b64_tr_b16 v[50:51], v3 offset:13312
    s_waitcnt lgkmcnt(10)
    v_mfma_f32_16x16x32_bf16 v[144:147], v[56:59], v[200:203], v[144:147]
    ds_read_b64_tr_b16 v[52:53], v4 offset:12288
    v_mfma_f32_16x16x32_bf16 v[148:151], v[56:59], v[204:207], v[148:151]
    ds_read_b64_tr_b16 v[54:55], v4 offset:13312
    v_mfma_f32_16x16x32_bf16 v[152:155], v[60:63], v[200:203], v[152:155]
    ds_read_b64_tr_b16 v[56:57], v5 offset:12288
    v_mfma_f32_16x16x32_bf16 v[156:159], v[60:63], v[204:207], v[156:159]
    ds_read_b64_tr_b16 v[58:59], v5 offset:13312
    s_waitcnt vmcnt(6) lgkmcnt(10)
    v_mfma_f32_16x16x32_bf16 v[64:67], v[32:35], v[208:211], v[64:67]
    ds_read_b64_tr_b16 v[60:61], v6 offset:12288
    v_mfma_f32_16x16x32_bf16 v[68:71], v[32:35], v[212:215], v[68:71]
    ds_read_b64_tr_b16 v[62:63], v6 offset:13312
    v_mfma_f32_16x16x32_bf16 v[72:75], v[36:39], v[208:211], v[72:75]
    ds_read_b64_tr_b16 v[32:33], v3 offset:16384
    v_mfma_f32_16x16x32_bf16 v[76:79], v[36:39], v[212:215], v[76:79]
    ds_read_b64_tr_b16 v[34:35], v3 offset:17408
    s_waitcnt lgkmcnt(10)
    v_mfma_f32_16x16x32_bf16 v[80:83], v[40:43], v[208:211], v[80:83]
    ds_read_b64_tr_b16 v[36:37], v4 offset:16384
    v_mfma_f32_16x16x32_bf16 v[84:87], v[40:43], v[212:215], v[84:87]
    ds_read_b64_tr_b16 v[38:39], v4 offset:17408
    v_mfma_f32_16x16x32_bf16 v[88:91], v[44:47], v[208:211], v[88:91]
    ds_read_b64_tr_b16 v[40:41], v5 offset:16384
    v_mfma_f32_16x16x32_bf16 v[92:95], v[44:47], v[212:215], v[92:95]
    ds_read_b64_tr_b16 v[42:43], v5 offset:17408
    s_waitcnt lgkmcnt(10)
    v_mfma_f32_16x16x32_bf16 v[96:99], v[208:211], v[48:51], v[96:99]
    buffer_load_dwordx4 v[240:243], v2, s[4:7], s42 offen offset:0 sc1
    ds_read_b64_tr_b16 v[44:45], v6 offset:16384
    v_mfma_f32_16x16x32_bf16 v[100:103], v[212:215], v[48:51], v[100:103]
    ds_read_b64_tr_b16 v[46:47], v6 offset:17408
    v_mfma_f32_16x16x32_bf16 v[104:107], v[208:211], v[52:55], v[104:107]
    buffer_load_dwordx4 v[244:247], v2, s[4:7], s42 offen offset:256 sc1
    ds_read_b64_tr_b16 v[48:49], v3 offset:20480
    v_mfma_f32_16x16x32_bf16 v[108:111], v[212:215], v[52:55], v[108:111]
    ds_read_b64_tr_b16 v[50:51], v3 offset:21504
    s_waitcnt lgkmcnt(10)
    v_mfma_f32_16x16x32_bf16 v[112:115], v[208:211], v[56:59], v[112:115]
    buffer_load_dwordx4 v[248:251], v2, s[4:7], s42 offen offset:2048 sc1
    ds_read_b64_tr_b16 v[52:53], v4 offset:20480
    v_mfma_f32_16x16x32_bf16 v[116:119], v[212:215], v[56:59], v[116:119]
    ds_read_b64_tr_b16 v[54:55], v4 offset:21504
    v_mfma_f32_16x16x32_bf16 v[120:123], v[208:211], v[60:63], v[120:123]
    buffer_load_dwordx4 v[252:255], v2, s[4:7], s42 offen offset:2304 sc1
    ds_read_b64_tr_b16 v[56:57], v5 offset:20480
    s_add_u32 s42, s41, s90
    v_mfma_f32_16x16x32_bf16 v[124:127], v[212:215], v[60:63], v[124:127]
    ds_read_b64_tr_b16 v[58:59], v5 offset:21504
    s_waitcnt lgkmcnt(10)
    v_mfma_f32_16x16x32_bf16 v[128:131], v[32:35], v[208:211], v[128:131]
    ds_read_b64_tr_b16 v[60:61], v6 offset:20480
    buffer_load_dwordx4 v[160:163], v2, s[4:7], s42 offen offset:0 sc1
    v_mfma_f32_16x16x32_bf16 v[132:135], v[32:35], v[212:215], v[132:135]
    ds_read_b64_tr_b16 v[62:63], v6 offset:21504
    v_mfma_f32_16x16x32_bf16 v[136:139], v[36:39], v[208:211], v[136:139]
    buffer_load_dwordx4 v[164:167], v2, s[4:7], s42 offen offset:256 sc1
    ds_read_b64_tr_b16 v[32:33], v3 offset:24576
    v_mfma_f32_16x16x32_bf16 v[140:143], v[36:39], v[212:215], v[140:143]
    ds_read_b64_tr_b16 v[34:35], v3 offset:25600
    s_waitcnt lgkmcnt(10)
    v_mfma_f32_16x16x32_bf16 v[144:147], v[40:43], v[208:211], v[144:147]
    buffer_load_dwordx4 v[168:171], v2, s[4:7], s42 offen offset:2048 sc1
    ds_read_b64_tr_b16 v[36:37], v4 offset:24576
    v_mfma_f32_16x16x32_bf16 v[148:151], v[40:43], v[212:215], v[148:151]
    ds_read_b64_tr_b16 v[38:39], v4 offset:25600
    v_mfma_f32_16x16x32_bf16 v[152:155], v[44:47], v[208:211], v[152:155]
    buffer_load_dwordx4 v[172:175], v2, s[4:7], s42 offen offset:2304 sc1
    ds_read_b64_tr_b16 v[40:41], v5 offset:24576
    s_add_u32 s42, s41, s91
    v_mfma_f32_16x16x32_bf16 v[156:159], v[44:47], v[212:215], v[156:159]
    ds_read_b64_tr_b16 v[42:43], v5 offset:25600
    s_waitcnt vmcnt(12) lgkmcnt(10)
    v_mfma_f32_16x16x32_bf16 v[64:67], v[48:51], v[216:219], v[64:67]
    buffer_load_dwordx4 v[176:179], v2, s[4:7], s42 offen offset:0 sc1
    ds_read_b64_tr_b16 v[44:45], v6 offset:24576
    v_mfma_f32_16x16x32_bf16 v[68:71], v[48:51], v[220:223], v[68:71]
    ds_read_b64_tr_b16 v[46:47], v6 offset:25600
    v_mfma_f32_16x16x32_bf16 v[72:75], v[52:55], v[216:219], v[72:75]
    buffer_load_dwordx4 v[180:183], v2, s[4:7], s42 offen offset:256 sc1
    ds_read_b64_tr_b16 v[48:49], v3 offset:28672
    v_mfma_f32_16x16x32_bf16 v[76:79], v[52:55], v[220:223], v[76:79]
    ds_read_b64_tr_b16 v[50:51], v3 offset:29696
    s_waitcnt lgkmcnt(10)
    v_mfma_f32_16x16x32_bf16 v[80:83], v[56:59], v[216:219], v[80:83]
    buffer_load_dwordx4 v[184:187], v2, s[4:7], s42 offen offset:2048 sc1
    ds_read_b64_tr_b16 v[52:53], v4 offset:28672
    v_mfma_f32_16x16x32_bf16 v[84:87], v[56:59], v[220:223], v[84:87]
    ds_read_b64_tr_b16 v[54:55], v4 offset:29696
    v_mfma_f32_16x16x32_bf16 v[88:91], v[60:63], v[216:219], v[88:91]
    buffer_load_dwordx4 v[188:191], v2, s[4:7], s42 offen offset:2304 sc1
    ds_read_b64_tr_b16 v[56:57], v5 offset:28672
    s_add_u32 s42, s41, s92
    v_mfma_f32_16x16x32_bf16 v[92:95], v[60:63], v[220:223], v[92:95]
    ds_read_b64_tr_b16 v[58:59], v5 offset:29696
    s_waitcnt lgkmcnt(10)
    v_mfma_f32_16x16x32_bf16 v[96:99], v[216:219], v[32:35], v[96:99]
    ds_read_b64_tr_b16 v[60:61], v6 offset:28672
    v_mfma_f32_16x16x32_bf16 v[100:103], v[220:223], v[32:35], v[100:103]
    ds_read_b64_tr_b16 v[62:63], v6 offset:29696
    s_barrier
    v_mfma_f32_16x16x32_bf16 v[104:107], v[216:219], v[36:39], v[104:107]
    ds_read_b64_tr_b16 v[32:33], v3 offset:32768
    v_mfma_f32_16x16x32_bf16 v[108:111], v[220:223], v[36:39], v[108:111]
    ds_read_b64_tr_b16 v[34:35], v3 offset:33792
    s_waitcnt lgkmcnt(10)
    v_mfma_f32_16x16x32_bf16 v[112:115], v[216:219], v[40:43], v[112:115]
    ds_read_b64_tr_b16 v[36:37], v4 offset:32768
    v_mfma_f32_16x16x32_bf16 v[116:119], v[220:223], v[40:43], v[116:119]
    ds_read_b64_tr_b16 v[38:39], v4 offset:33792
    v_mfma_f32_16x16x32_bf16 v[120:123], v[216:219], v[44:47], v[120:123]
    ds_read_b64_tr_b16 v[40:41], v5 offset:32768
    v_mfma_f32_16x16x32_bf16 v[124:127], v[220:223], v[44:47], v[124:127]
    ds_read_b64_tr_b16 v[42:43], v5 offset:33792
    s_waitcnt lgkmcnt(10)
    v_mfma_f32_16x16x32_bf16 v[128:131], v[48:51], v[216:219], v[128:131]
    ds_read_b64_tr_b16 v[44:45], v6 offset:32768
    v_mfma_f32_16x16x32_bf16 v[132:135], v[48:51], v[220:223], v[132:135]
    ds_read_b64_tr_b16 v[46:47], v6 offset:33792
    v_mfma_f32_16x16x32_bf16 v[136:139], v[52:55], v[216:219], v[136:139]
    ds_read_b64_tr_b16 v[48:49], v3 offset:36864
    v_mfma_f32_16x16x32_bf16 v[140:143], v[52:55], v[220:223], v[140:143]
    ds_read_b64_tr_b16 v[50:51], v3 offset:37888
    s_waitcnt lgkmcnt(10)
    v_mfma_f32_16x16x32_bf16 v[144:147], v[56:59], v[216:219], v[144:147]
    ds_read_b64_tr_b16 v[52:53], v4 offset:36864
    v_mfma_f32_16x16x32_bf16 v[148:151], v[56:59], v[220:223], v[148:151]
    ds_read_b64_tr_b16 v[54:55], v4 offset:37888
    v_mfma_f32_16x16x32_bf16 v[152:155], v[60:63], v[216:219], v[152:155]
    ds_read_b64_tr_b16 v[56:57], v5 offset:36864
    v_mfma_f32_16x16x32_bf16 v[156:159], v[60:63], v[220:223], v[156:159]
    ds_read_b64_tr_b16 v[58:59], v5 offset:37888
    s_waitcnt vmcnt(14) lgkmcnt(10)
    v_mfma_f32_16x16x32_bf16 v[64:67], v[32:35], v[224:227], v[64:67]
    ds_read_b64_tr_b16 v[60:61], v6 offset:36864
    v_mfma_f32_16x16x32_bf16 v[68:71], v[32:35], v[228:231], v[68:71]
    ds_read_b64_tr_b16 v[62:63], v6 offset:37888
    v_mfma_f32_16x16x32_bf16 v[72:75], v[36:39], v[224:227], v[72:75]
    ds_read_b64_tr_b16 v[32:33], v3 offset:40960
    v_mfma_f32_16x16x32_bf16 v[76:79], v[36:39], v[228:231], v[76:79]
    ds_read_b64_tr_b16 v[34:35], v3 offset:41984
    s_waitcnt lgkmcnt(10)
    v_mfma_f32_16x16x32_bf16 v[80:83], v[40:43], v[224:227], v[80:83]
    ds_read_b64_tr_b16 v[36:37], v4 offset:40960
    v_mfma_f32_16x16x32_bf16 v[84:87], v[40:43], v[228:231], v[84:87]
    ds_read_b64_tr_b16 v[38:39], v4 offset:41984
    v_mfma_f32_16x16x32_bf16 v[88:91], v[44:47], v[224:227], v[88:91]
    ds_read_b64_tr_b16 v[40:41], v5 offset:40960
    v_mfma_f32_16x16x32_bf16 v[92:95], v[44:47], v[228:231], v[92:95]
    ds_read_b64_tr_b16 v[42:43], v5 offset:41984
    s_waitcnt lgkmcnt(10)
    v_mfma_f32_16x16x32_bf16 v[96:99], v[224:227], v[48:51], v[96:99]
    ds_read_b64_tr_b16 v[44:45], v6 offset:40960
    v_mfma_f32_16x16x32_bf16 v[100:103], v[228:231], v[48:51], v[100:103]
    ds_read_b64_tr_b16 v[46:47], v6 offset:41984
    v_mfma_f32_16x16x32_bf16 v[104:107], v[224:227], v[52:55], v[104:107]
    ds_read_b64_tr_b16 v[48:49], v3 offset:45056
    v_mfma_f32_16x16x32_bf16 v[108:111], v[228:231], v[52:55], v[108:111]
    ds_read_b64_tr_b16 v[50:51], v3 offset:46080
    s_waitcnt lgkmcnt(10)
    v_mfma_f32_16x16x32_bf16 v[112:115], v[224:227], v[56:59], v[112:115]
    ds_read_b64_tr_b16 v[52:53], v4 offset:45056
    v_mfma_f32_16x16x32_bf16 v[116:119], v[228:231], v[56:59], v[116:119]
    ds_read_b64_tr_b16 v[54:55], v4 offset:46080
    v_mfma_f32_16x16x32_bf16 v[120:123], v[224:227], v[60:63], v[120:123]
    ds_read_b64_tr_b16 v[56:57], v5 offset:45056
    v_mfma_f32_16x16x32_bf16 v[124:127], v[228:231], v[60:63], v[124:127]
    ds_read_b64_tr_b16 v[58:59], v5 offset:46080
    s_waitcnt lgkmcnt(10)
    v_mfma_f32_16x16x32_bf16 v[128:131], v[32:35], v[224:227], v[128:131]
    ds_read_b64_tr_b16 v[60:61], v6 offset:45056
    v_mfma_f32_16x16x32_bf16 v[132:135], v[32:35], v[228:231], v[132:135]
    ds_read_b64_tr_b16 v[62:63], v6 offset:46080
    v_mfma_f32_16x16x32_bf16 v[136:139], v[36:39], v[224:227], v[136:139]
    ds_read_b64_tr_b16 v[32:33], v3 offset:49152
    v_mfma_f32_16x16x32_bf16 v[140:143], v[36:39], v[228:231], v[140:143]
    ds_read_b64_tr_b16 v[34:35], v3 offset:50176
    s_waitcnt lgkmcnt(10)
    v_mfma_f32_16x16x32_bf16 v[144:147], v[40:43], v[224:227], v[144:147]
    ds_read_b64_tr_b16 v[36:37], v4 offset:49152
    v_mfma_f32_16x16x32_bf16 v[148:151], v[40:43], v[228:231], v[148:151]
    ds_read_b64_tr_b16 v[38:39], v4 offset:50176
    v_mfma_f32_16x16x32_bf16 v[152:155], v[44:47], v[224:227], v[152:155]
    ds_read_b64_tr_b16 v[40:41], v5 offset:49152
    v_mfma_f32_16x16x32_bf16 v[156:159], v[44:47], v[228:231], v[156:159]
    ds_read_b64_tr_b16 v[42:43], v5 offset:50176
    s_waitcnt vmcnt(12) lgkmcnt(10)
    v_mfma_f32_16x16x32_bf16 v[64:67], v[48:51], v[232:235], v[64:67]
    buffer_load_dwordx4 v[192:195], v2, s[4:7], s42 offen offset:0 sc1
    ds_read_b64_tr_b16 v[44:45], v6 offset:49152
    v_mfma_f32_16x16x32_bf16 v[68:71], v[48:51], v[236:239], v[68:71]
    ds_read_b64_tr_b16 v[46:47], v6 offset:50176
    v_mfma_f32_16x16x32_bf16 v[72:75], v[52:55], v[232:235], v[72:75]
    buffer_load_dwordx4 v[196:199], v2, s[4:7], s42 offen offset:256 sc1
    ds_read_b64_tr_b16 v[48:49], v3 offset:53248
    v_mfma_f32_16x16x32_bf16 v[76:79], v[52:55], v[236:239], v[76:79]
    ds_read_b64_tr_b16 v[50:51], v3 offset:54272
    s_waitcnt lgkmcnt(10)
    v_mfma_f32_16x16x32_bf16 v[80:83], v[56:59], v[232:235], v[80:83]
    buffer_load_dwordx4 v[200:203], v2, s[4:7], s42 offen offset:2048 sc1
    ds_read_b64_tr_b16 v[52:53], v4 offset:53248
    v_mfma_f32_16x16x32_bf16 v[84:87], v[56:59], v[236:239], v[84:87]
    ds_read_b64_tr_b16 v[54:55], v4 offset:54272
    v_mfma_f32_16x16x32_bf16 v[88:91], v[60:63], v[232:235], v[88:91]
    buffer_load_dwordx4 v[204:207], v2, s[4:7], s42 offen offset:2304 sc1
    ds_read_b64_tr_b16 v[56:57], v5 offset:53248
    s_add_u32 s42, s41, s93
    v_mfma_f32_16x16x32_bf16 v[92:95], v[60:63], v[236:239], v[92:95]
    ds_read_b64_tr_b16 v[58:59], v5 offset:54272
    s_waitcnt lgkmcnt(10)
    v_mfma_f32_16x16x32_bf16 v[96:99], v[232:235], v[32:35], v[96:99]
    ds_read_b64_tr_b16 v[60:61], v6 offset:53248
    buffer_load_dwordx4 v[208:211], v2, s[4:7], s42 offen offset:0 sc1
    v_mfma_f32_16x16x32_bf16 v[100:103], v[236:239], v[32:35], v[100:103]
    ds_read_b64_tr_b16 v[62:63], v6 offset:54272
    v_mfma_f32_16x16x32_bf16 v[104:107], v[232:235], v[36:39], v[104:107]
    ds_read_b64_tr_b16 v[32:33], v3 offset:57344
    v_mfma_f32_16x16x32_bf16 v[108:111], v[236:239], v[36:39], v[108:111]
    ds_read_b64_tr_b16 v[34:35], v3 offset:58368
    s_waitcnt lgkmcnt(10)
    v_mfma_f32_16x16x32_bf16 v[112:115], v[232:235], v[40:43], v[112:115]
    ds_read_b64_tr_b16 v[36:37], v4 offset:57344
    v_mfma_f32_16x16x32_bf16 v[116:119], v[236:239], v[40:43], v[116:119]
    ds_read_b64_tr_b16 v[38:39], v4 offset:58368
    v_mfma_f32_16x16x32_bf16 v[120:123], v[232:235], v[44:47], v[120:123]
    buffer_load_dwordx4 v[212:215], v2, s[4:7], s42 offen offset:256 sc1
    ds_read_b64_tr_b16 v[40:41], v5 offset:57344
    v_mfma_f32_16x16x32_bf16 v[124:127], v[236:239], v[44:47], v[124:127]
    ds_read_b64_tr_b16 v[42:43], v5 offset:58368
    s_waitcnt lgkmcnt(10)
    v_mfma_f32_16x16x32_bf16 v[128:131], v[48:51], v[232:235], v[128:131]
    ds_read_b64_tr_b16 v[44:45], v6 offset:57344
    v_mfma_f32_16x16x32_bf16 v[132:135], v[48:51], v[236:239], v[132:135]
    ds_read_b64_tr_b16 v[46:47], v6 offset:58368
    v_mfma_f32_16x16x32_bf16 v[136:139], v[52:55], v[232:235], v[136:139]
    ds_read_b64_tr_b16 v[48:49], v3 offset:61440
    v_mfma_f32_16x16x32_bf16 v[140:143], v[52:55], v[236:239], v[140:143]
    ds_read_b64_tr_b16 v[50:51], v3 offset:62464
    s_waitcnt lgkmcnt(10)
    v_mfma_f32_16x16x32_bf16 v[144:147], v[56:59], v[232:235], v[144:147]
    ds_read_b64_tr_b16 v[52:53], v4 offset:61440
    v_mfma_f32_16x16x32_bf16 v[148:151], v[56:59], v[236:239], v[148:151]
    ds_read_b64_tr_b16 v[54:55], v4 offset:62464
    v_mfma_f32_16x16x32_bf16 v[152:155], v[60:63], v[232:235], v[152:155]
    ds_read_b64_tr_b16 v[56:57], v5 offset:61440
    v_mfma_f32_16x16x32_bf16 v[156:159], v[60:63], v[236:239], v[156:159]
    ds_read_b64_tr_b16 v[58:59], v5 offset:62464
    s_waitcnt vmcnt(16) lgkmcnt(10)
    v_mfma_f32_16x16x32_bf16 v[64:67], v[32:35], v[240:243], v[64:67]
    ds_read_b64_tr_b16 v[60:61], v6 offset:61440
    v_mfma_f32_16x16x32_bf16 v[68:71], v[32:35], v[244:247], v[68:71]
    ds_read_b64_tr_b16 v[62:63], v6 offset:62464
    s_barrier
    v_xor_b32 v3, 0x10000, v3
    v_xor_b32 v4, 0x10000, v4
    v_xor_b32 v5, 0x10000, v5
    v_xor_b32 v6, 0x10000, v6
    v_mfma_f32_16x16x32_bf16 v[72:75], v[36:39], v[240:243], v[72:75]
    ds_read_b64_tr_b16 v[32:33], v3 offset:0
    v_mfma_f32_16x16x32_bf16 v[76:79], v[36:39], v[244:247], v[76:79]
    ds_read_b64_tr_b16 v[34:35], v3 offset:1024
    s_waitcnt lgkmcnt(10)
    v_mfma_f32_16x16x32_bf16 v[80:83], v[40:43], v[240:243], v[80:83]
    ds_read_b64_tr_b16 v[36:37], v4 offset:0
    v_mfma_f32_16x16x32_bf16 v[84:87], v[40:43], v[244:247], v[84:87]
    ds_read_b64_tr_b16 v[38:39], v4 offset:1024
    v_mfma_f32_16x16x32_bf16 v[88:91], v[44:47], v[240:243], v[88:91]
    ds_read_b64_tr_b16 v[40:41], v5 offset:0
    v_mfma_f32_16x16x32_bf16 v[92:95], v[44:47], v[244:247], v[92:95]
    ds_read_b64_tr_b16 v[42:43], v5 offset:1024
    s_waitcnt lgkmcnt(10)
    v_mfma_f32_16x16x32_bf16 v[96:99], v[240:243], v[48:51], v[96:99]
    ds_read_b64_tr_b16 v[44:45], v6 offset:0
    v_mfma_f32_16x16x32_bf16 v[100:103], v[244:247], v[48:51], v[100:103]
    ds_read_b64_tr_b16 v[46:47], v6 offset:1024
    v_mfma_f32_16x16x32_bf16 v[104:107], v[240:243], v[52:55], v[104:107]
    ds_read_b64_tr_b16 v[48:49], v3 offset:4096
    v_mfma_f32_16x16x32_bf16 v[108:111], v[244:247], v[52:55], v[108:111]
    ds_read_b64_tr_b16 v[50:51], v3 offset:5120
    s_waitcnt lgkmcnt(10)
    v_mfma_f32_16x16x32_bf16 v[112:115], v[240:243], v[56:59], v[112:115]
    ds_read_b64_tr_b16 v[52:53], v4 offset:4096
    v_mfma_f32_16x16x32_bf16 v[116:119], v[244:247], v[56:59], v[116:119]
    ds_read_b64_tr_b16 v[54:55], v4 offset:5120
    v_mfma_f32_16x16x32_bf16 v[120:123], v[240:243], v[60:63], v[120:123]
    ds_read_b64_tr_b16 v[56:57], v5 offset:4096
    v_mfma_f32_16x16x32_bf16 v[124:127], v[244:247], v[60:63], v[124:127]
    ds_read_b64_tr_b16 v[58:59], v5 offset:5120
    s_waitcnt lgkmcnt(10)
    v_mfma_f32_16x16x32_bf16 v[128:131], v[32:35], v[240:243], v[128:131]
    ds_read_b64_tr_b16 v[60:61], v6 offset:4096
    v_mfma_f32_16x16x32_bf16 v[132:135], v[32:35], v[244:247], v[132:135]
    ds_read_b64_tr_b16 v[62:63], v6 offset:5120
    v_mfma_f32_16x16x32_bf16 v[136:139], v[36:39], v[240:243], v[136:139]
    ds_read_b64_tr_b16 v[32:33], v3 offset:8192
    v_mfma_f32_16x16x32_bf16 v[140:143], v[36:39], v[244:247], v[140:143]
    ds_read_b64_tr_b16 v[34:35], v3 offset:9216
    s_waitcnt lgkmcnt(10)
    v_mfma_f32_16x16x32_bf16 v[144:147], v[40:43], v[240:243], v[144:147]
    ds_read_b64_tr_b16 v[36:37], v4 offset:8192
    v_mfma_f32_16x16x32_bf16 v[148:151], v[40:43], v[244:247], v[148:151]
    ds_read_b64_tr_b16 v[38:39], v4 offset:9216
    v_mfma_f32_16x16x32_bf16 v[152:155], v[44:47], v[240:243], v[152:155]
    ds_read_b64_tr_b16 v[40:41], v5 offset:8192
    v_mfma_f32_16x16x32_bf16 v[156:159], v[44:47], v[244:247], v[156:159]
    ds_read_b64_tr_b16 v[42:43], v5 offset:9216
    s_waitcnt vmcnt(14) lgkmcnt(10)
    v_mfma_f32_16x16x32_bf16 v[64:67], v[48:51], v[248:251], v[64:67]
    ds_read_b64_tr_b16 v[44:45], v6 offset:8192
    v_mfma_f32_16x16x32_bf16 v[68:71], v[48:51], v[252:255], v[68:71]
    ds_read_b64_tr_b16 v[46:47], v6 offset:9216
    v_mfma_f32_16x16x32_bf16 v[72:75], v[52:55], v[248:251], v[72:75]
    ds_read_b64_tr_b16 v[48:49], v3 offset:12288
    v_mfma_f32_16x16x32_bf16 v[76:79], v[52:55], v[252:255], v[76:79]
    ds_read_b64_tr_b16 v[50:51], v3 offset:13312
    s_waitcnt lgkmcnt(10)
    v_mfma_f32_16x16x32_bf16 v[80:83], v[56:59], v[248:251], v[80:83]
    ds_read_b64_tr_b16 v[52:53], v4 offset:12288
    v_mfma_f32_16x16x32_bf16 v[84:87], v[56:59], v[252:255], v[84:87]
    ds_read_b64_tr_b16 v[54:55], v4 offset:13312
    v_mfma_f32_16x16x32_bf16 v[88:91], v[60:63], v[248:251], v[88:91]
    ds_read_b64_tr_b16 v[56:57], v5 offset:12288
    v_mfma_f32_16x16x32_bf16 v[92:95], v[60:63], v[252:255], v[92:95]
    ds_read_b64_tr_b16 v[58:59], v5 offset:13312
    s_waitcnt lgkmcnt(10)
    v_mfma_f32_16x16x32_bf16 v[96:99], v[248:251], v[32:35], v[96:99]
    ds_read_b64_tr_b16 v[60:61], v6 offset:12288
    v_mfma_f32_16x16x32_bf16 v[100:103], v[252:255], v[32:35], v[100:103]
    ds_read_b64_tr_b16 v[62:63], v6 offset:13312
    v_mfma_f32_16x16x32_bf16 v[104:107], v[248:251], v[36:39], v[104:107]
    ds_read_b64_tr_b16 v[32:33], v3 offset:16384
    v_mfma_f32_16x16x32_bf16 v[108:111], v[252:255], v[36:39], v[108:111]
    ds_read_b64_tr_b16 v[34:35], v3 offset:17408
    s_waitcnt lgkmcnt(10)
    v_mfma_f32_16x16x32_bf16 v[112:115], v[248:251], v[40:43], v[112:115]
    ds_read_b64_tr_b16 v[36:37], v4 offset:16384
    v_mfma_f32_16x16x32_bf16 v[116:119], v[252:255], v[40:43], v[116:119]
    ds_read_b64_tr_b16 v[38:39], v4 offset:17408
    v_mfma_f32_16x16x32_bf16 v[120:123], v[248:251], v[44:47], v[120:123]
    ds_read_b64_tr_b16 v[40:41], v5 offset:16384
    v_mfma_f32_16x16x32_bf16 v[124:127], v[252:255], v[44:47], v[124:127]
    ds_read_b64_tr_b16 v[42:43], v5 offset:17408
    s_waitcnt lgkmcnt(10)
    v_mfma_f32_16x16x32_bf16 v[128:131], v[48:51], v[248:251], v[128:131]
    buffer_load_dwordx4 v[216:219], v2, s[4:7], s42 offen offset:2048 sc1
    ds_read_b64_tr_b16 v[44:45], v6 offset:16384
    v_mfma_f32_16x16x32_bf16 v[132:135], v[48:51], v[252:255], v[132:135]
    ds_read_b64_tr_b16 v[46:47], v6 offset:17408
    v_mfma_f32_16x16x32_bf16 v[136:139], v[52:55], v[248:251], v[136:139]
    buffer_load_dwordx4 v[220:223], v2, s[4:7], s42 offen offset:2304 sc1
    ds_read_b64_tr_b16 v[48:49], v3 offset:20480
    s_add_u32 s42, s41, s94
    v_mfma_f32_16x16x32_bf16 v[140:143], v[52:55], v[252:255], v[140:143]
    ds_read_b64_tr_b16 v[50:51], v3 offset:21504
    s_waitcnt lgkmcnt(10)
    v_mfma_f32_16x16x32_bf16 v[144:147], v[56:59], v[248:251], v[144:147]
    buffer_load_dwordx4 v[224:227], v2, s[4:7], s42 offen offset:0 sc1
    ds_read_b64_tr_b16 v[52:53], v4 offset:20480
    v_mfma_f32_16x16x32_bf16 v[148:151], v[56:59], v[252:255], v[148:151]
    ds_read_b64_tr_b16 v[54:55], v4 offset:21504
    v_mfma_f32_16x16x32_bf16 v[152:155], v[60:63], v[248:251], v[152:155]
    buffer_load_dwordx4 v[228:231], v2, s[4:7], s42 offen offset:256 sc1
    ds_read_b64_tr_b16 v[56:57], v5 offset:20480
    v_mfma_f32_16x16x32_bf16 v[156:159], v[60:63], v[252:255], v[156:159]
    ds_read_b64_tr_b16 v[58:59], v5 offset:21504
    s_waitcnt vmcnt(16) lgkmcnt(10)
    v_mfma_f32_16x16x32_bf16 v[64:67], v[32:35], v[160:163], v[64:67]
    ds_read_b64_tr_b16 v[60:61], v6 offset:20480
    buffer_load_dwordx4 v[232:235], v2, s[4:7], s42 offen offset:2048 sc1
    v_mfma_f32_16x16x32_bf16 v[68:71], v[32:35], v[164:167], v[68:71]
    ds_read_b64_tr_b16 v[62:63], v6 offset:21504
    v_mfma_f32_16x16x32_bf16 v[72:75], v[36:39], v[160:163], v[72:75]
    buffer_load_dwordx4 v[236:239], v2, s[4:7], s42 offen offset:2304 sc1
    ds_read_b64_tr_b16 v[32:33], v3 offset:24576
    s_add_u32 s42, s41, s95
    v_mfma_f32_16x16x32_bf16 v[76:79], v[36:39], v[164:167], v[76:79]
    ds_read_b64_tr_b16 v[34:35], v3 offset:25600
    s_waitcnt lgkmcnt(10)
    v_mfma_f32_16x16x32_bf16 v[80:83], v[40:43], v[160:163], v[80:83]
    ds_read_b64_tr_b16 v[36:37], v4 offset:24576
    v_mfma_f32_16x16x32_bf16 v[84:87], v[40:43], v[164:167], v[84:87]
    ds_read_b64_tr_b16 v[38:39], v4 offset:25600
    v_mfma_f32_16x16x32_bf16 v[88:91], v[44:47], v[160:163], v[88:91]
    ds_read_b64_tr_b16 v[40:41], v5 offset:24576
    v_mfma_f32_16x16x32_bf16 v[92:95], v[44:47], v[164:167], v[92:95]
    ds_read_b64_tr_b16 v[42:43], v5 offset:25600
    s_waitcnt lgkmcnt(10)
    v_mfma_f32_16x16x32_bf16 v[96:99], v[160:163], v[48:51], v[96:99]
    buffer_load_dwordx4 v[240:243], v2, s[4:7], s42 offen offset:0 sc1
    ds_read_b64_tr_b16 v[44:45], v6 offset:24576
    v_mfma_f32_16x16x32_bf16 v[100:103], v[164:167], v[48:51], v[100:103]
    ds_read_b64_tr_b16 v[46:47], v6 offset:25600
    v_mfma_f32_16x16x32_bf16 v[104:107], v[160:163], v[52:55], v[104:107]
    ds_read_b64_tr_b16 v[48:49], v3 offset:28672
    v_mfma_f32_16x16x32_bf16 v[108:111], v[164:167], v[52:55], v[108:111]
    ds_read_b64_tr_b16 v[50:51], v3 offset:29696
    s_waitcnt lgkmcnt(10)
    v_mfma_f32_16x16x32_bf16 v[112:115], v[160:163], v[56:59], v[112:115]
    ds_read_b64_tr_b16 v[52:53], v4 offset:28672
    v_mfma_f32_16x16x32_bf16 v[116:119], v[164:167], v[56:59], v[116:119]
    ds_read_b64_tr_b16 v[54:55], v4 offset:29696
    v_mfma_f32_16x16x32_bf16 v[120:123], v[160:163], v[60:63], v[120:123]
    ds_read_b64_tr_b16 v[56:57], v5 offset:28672
    v_mfma_f32_16x16x32_bf16 v[124:127], v[164:167], v[60:63], v[124:127]
    ds_read_b64_tr_b16 v[58:59], v5 offset:29696
    s_waitcnt lgkmcnt(10)
    v_mfma_f32_16x16x32_bf16 v[128:131], v[32:35], v[160:163], v[128:131]
    ds_read_b64_tr_b16 v[60:61], v6 offset:28672
    v_mfma_f32_16x16x32_bf16 v[132:135], v[32:35], v[164:167], v[132:135]
    ds_read_b64_tr_b16 v[62:63], v6 offset:29696
    s_barrier
    v_mfma_f32_16x16x32_bf16 v[136:139], v[36:39], v[160:163], v[136:139]
    ds_read_b64_tr_b16 v[32:33], v3 offset:32768
    v_mfma_f32_16x16x32_bf16 v[140:143], v[36:39], v[164:167], v[140:143]
    ds_read_b64_tr_b16 v[34:35], v3 offset:33792
    s_waitcnt lgkmcnt(10)
    v_mfma_f32_16x16x32_bf16 v[144:147], v[40:43], v[160:163], v[144:147]
    ds_read_b64_tr_b16 v[36:37], v4 offset:32768
    v_mfma_f32_16x16x32_bf16 v[148:151], v[40:43], v[164:167], v[148:151]
    ds_read_b64_tr_b16 v[38:39], v4 offset:33792
    v_mfma_f32_16x16x32_bf16 v[152:155], v[44:47], v[160:163], v[152:155]
    ds_read_b64_tr_b16 v[40:41], v5 offset:32768
    v_mfma_f32_16x16x32_bf16 v[156:159], v[44:47], v[164:167], v[156:159]
    ds_read_b64_tr_b16 v[42:43], v5 offset:33792
    s_waitcnt vmcnt(17) lgkmcnt(10)
    v_mfma_f32_16x16x32_bf16 v[64:67], v[48:51], v[168:171], v[64:67]
    ds_read_b64_tr_b16 v[44:45], v6 offset:32768
    v_mfma_f32_16x16x32_bf16 v[68:71], v[48:51], v[172:175], v[68:71]
    ds_read_b64_tr_b16 v[46:47], v6 offset:33792
    v_mfma_f32_16x16x32_bf16 v[72:75], v[52:55], v[168:171], v[72:75]
    ds_read_b64_tr_b16 v[48:49], v3 offset:36864
    v_mfma_f32_16x16x32_bf16 v[76:79], v[52:55], v[172:175], v[76:79]
    ds_read_b64_tr_b16 v[50:51], v3 offset:37888
    s_waitcnt lgkmcnt(10)
    v_mfma_f32_16x16x32_bf16 v[80:83], v[56:59], v[168:171], v[80:83]
    ds_read_b64_tr_b16 v[52:53], v4 offset:36864
    v_mfma_f32_16x16x32_bf16 v[84:87], v[56:59], v[172:175], v[84:87]
    ds_read_b64_tr_b16 v[54:55], v4 offset:37888
    v_mfma_f32_16x16x32_bf16 v[88:91], v[60:63], v[168:171], v[88:91]
    ds_read_b64_tr_b16 v[56:57], v5 offset:36864
    v_mfma_f32_16x16x32_bf16 v[92:95], v[60:63], v[172:175], v[92:95]
    ds_read_b64_tr_b16 v[58:59], v5 offset:37888
    s_waitcnt lgkmcnt(10)
    v_mfma_f32_16x16x32_bf16 v[96:99], v[168:171], v[32:35], v[96:99]
    ds_read_b64_tr_b16 v[60:61], v6 offset:36864
    v_mfma_f32_16x16x32_bf16 v[100:103], v[172:175], v[32:35], v[100:103]
    ds_read_b64_tr_b16 v[62:63], v6 offset:37888
    v_mfma_f32_16x16x32_bf16 v[104:107], v[168:171], v[36:39], v[104:107]
    ds_read_b64_tr_b16 v[32:33], v3 offset:40960
    v_mfma_f32_16x16x32_bf16 v[108:111], v[172:175], v[36:39], v[108:111]
    ds_read_b64_tr_b16 v[34:35], v3 offset:41984
    s_waitcnt lgkmcnt(10)
    v_mfma_f32_16x16x32_bf16 v[112:115], v[168:171], v[40:43], v[112:115]
    ds_read_b64_tr_b16 v[36:37], v4 offset:40960
    v_mfma_f32_16x16x32_bf16 v[116:119], v[172:175], v[40:43], v[116:119]
    ds_read_b64_tr_b16 v[38:39], v4 offset:41984
    v_mfma_f32_16x16x32_bf16 v[120:123], v[168:171], v[44:47], v[120:123]
    ds_read_b64_tr_b16 v[40:41], v5 offset:40960
    v_mfma_f32_16x16x32_bf16 v[124:127], v[172:175], v[44:47], v[124:127]
    ds_read_b64_tr_b16 v[42:43], v5 offset:41984
    s_waitcnt lgkmcnt(10)
    v_mfma_f32_16x16x32_bf16 v[128:131], v[48:51], v[168:171], v[128:131]
    ds_read_b64_tr_b16 v[44:45], v6 offset:40960
    v_mfma_f32_16x16x32_bf16 v[132:135], v[48:51], v[172:175], v[132:135]
    ds_read_b64_tr_b16 v[46:47], v6 offset:41984
    v_mfma_f32_16x16x32_bf16 v[136:139], v[52:55], v[168:171], v[136:139]
    ds_read_b64_tr_b16 v[48:49], v3 offset:45056
    v_mfma_f32_16x16x32_bf16 v[140:143], v[52:55], v[172:175], v[140:143]
    ds_read_b64_tr_b16 v[50:51], v3 offset:46080
    s_waitcnt lgkmcnt(10)
    v_mfma_f32_16x16x32_bf16 v[144:147], v[56:59], v[168:171], v[144:147]
    ds_read_b64_tr_b16 v[52:53], v4 offset:45056
    v_mfma_f32_16x16x32_bf16 v[148:151], v[56:59], v[172:175], v[148:151]
    ds_read_b64_tr_b16 v[54:55], v4 offset:46080
    v_mfma_f32_16x16x32_bf16 v[152:155], v[60:63], v[168:171], v[152:155]
    ds_read_b64_tr_b16 v[56:57], v5 offset:45056
    v_mfma_f32_16x16x32_bf16 v[156:159], v[60:63], v[172:175], v[156:159]
    ds_read_b64_tr_b16 v[58:59], v5 offset:46080
    s_waitcnt vmcnt(15) lgkmcnt(10)
    v_mfma_f32_16x16x32_bf16 v[64:67], v[32:35], v[176:179], v[64:67]
    ds_read_b64_tr_b16 v[60:61], v6 offset:45056
    v_mfma_f32_16x16x32_bf16 v[68:71], v[32:35], v[180:183], v[68:71]
    ds_read_b64_tr_b16 v[62:63], v6 offset:46080
    v_mfma_f32_16x16x32_bf16 v[72:75], v[36:39], v[176:179], v[72:75]
    ds_read_b64_tr_b16 v[32:33], v3 offset:49152
    v_mfma_f32_16x16x32_bf16 v[76:79], v[36:39], v[180:183], v[76:79]
    ds_read_b64_tr_b16 v[34:35], v3 offset:50176
    s_waitcnt lgkmcnt(10)
    v_mfma_f32_16x16x32_bf16 v[80:83], v[40:43], v[176:179], v[80:83]
    ds_read_b64_tr_b16 v[36:37], v4 offset:49152
    v_mfma_f32_16x16x32_bf16 v[84:87], v[40:43], v[180:183], v[84:87]
    ds_read_b64_tr_b16 v[38:39], v4 offset:50176
    v_mfma_f32_16x16x32_bf16 v[88:91], v[44:47], v[176:179], v[88:91]
    ds_read_b64_tr_b16 v[40:41], v5 offset:49152
    v_mfma_f32_16x16x32_bf16 v[92:95], v[44:47], v[180:183], v[92:95]
    ds_read_b64_tr_b16 v[42:43], v5 offset:50176
    s_waitcnt lgkmcnt(10)
    v_mfma_f32_16x16x32_bf16 v[96:99], v[176:179], v[48:51], v[96:99]
    buffer_load_dwordx4 v[244:247], v2, s[4:7], s42 offen offset:256 sc1
    ds_read_b64_tr_b16 v[44:45], v6 offset:49152
    v_mfma_f32_16x16x32_bf16 v[100:103], v[180:183], v[48:51], v[100:103]
    ds_read_b64_tr_b16 v[46:47], v6 offset:50176
    v_mfma_f32_16x16x32_bf16 v[104:107], v[176:179], v[52:55], v[104:107]
    buffer_load_dwordx4 v[248:251], v2, s[4:7], s42 offen offset:2048 sc1
    ds_read_b64_tr_b16 v[48:49], v3 offset:53248
    v_mfma_f32_16x16x32_bf16 v[108:111], v[180:183], v[52:55], v[108:111]
    ds_read_b64_tr_b16 v[50:51], v3 offset:54272
    s_waitcnt lgkmcnt(10)
    v_mfma_f32_16x16x32_bf16 v[112:115], v[176:179], v[56:59], v[112:115]
    buffer_load_dwordx4 v[252:255], v2, s[4:7], s42 offen offset:2304 sc1
    ds_read_b64_tr_b16 v[52:53], v4 offset:53248
    s_add_u32 s42, s41, s96
    v_mfma_f32_16x16x32_bf16 v[116:119], v[180:183], v[56:59], v[116:119]
    ds_read_b64_tr_b16 v[54:55], v4 offset:54272
    v_mfma_f32_16x16x32_bf16 v[120:123], v[176:179], v[60:63], v[120:123]
    buffer_load_dwordx4 v[160:163], v2, s[4:7], s42 offen offset:0 sc1
    ds_read_b64_tr_b16 v[56:57], v5 offset:53248
    v_mfma_f32_16x16x32_bf16 v[124:127], v[180:183], v[60:63], v[124:127]
    ds_read_b64_tr_b16 v[58:59], v5 offset:54272
    s_waitcnt lgkmcnt(10)
    v_mfma_f32_16x16x32_bf16 v[128:131], v[32:35], v[176:179], v[128:131]
    ds_read_b64_tr_b16 v[60:61], v6 offset:53248
    buffer_load_dwordx4 v[164:167], v2, s[4:7], s42 offen offset:256 sc1
    v_mfma_f32_16x16x32_bf16 v[132:135], v[32:35], v[180:183], v[132:135]
    ds_read_b64_tr_b16 v[62:63], v6 offset:54272
    v_mfma_f32_16x16x32_bf16 v[136:139], v[36:39], v[176:179], v[136:139]
    buffer_load_dwordx4 v[168:171], v2, s[4:7], s42 offen offset:2048 sc1
    ds_read_b64_tr_b16 v[32:33], v3 offset:57344
    v_mfma_f32_16x16x32_bf16 v[140:143], v[36:39], v[180:183], v[140:143]
    ds_read_b64_tr_b16 v[34:35], v3 offset:58368
    s_waitcnt lgkmcnt(10)
    v_mfma_f32_16x16x32_bf16 v[144:147], v[40:43], v[176:179], v[144:147]
    ds_read_b64_tr_b16 v[36:37], v4 offset:57344
    v_mfma_f32_16x16x32_bf16 v[148:151], v[40:43], v[180:183], v[148:151]
    ds_read_b64_tr_b16 v[38:39], v4 offset:58368
    v_mfma_f32_16x16x32_bf16 v[152:155], v[44:47], v[176:179], v[152:155]
    ds_read_b64_tr_b16 v[40:41], v5 offset:57344
    v_mfma_f32_16x16x32_bf16 v[156:159], v[44:47], v[180:183], v[156:159]
    ds_read_b64_tr_b16 v[42:43], v5 offset:58368
    s_waitcnt vmcnt(19) lgkmcnt(10)
    v_mfma_f32_16x16x32_bf16 v[64:67], v[48:51], v[184:187], v[64:67]
    ds_read_b64_tr_b16 v[44:45], v6 offset:57344
    v_mfma_f32_16x16x32_bf16 v[68:71], v[48:51], v[188:191], v[68:71]
    ds_read_b64_tr_b16 v[46:47], v6 offset:58368
    v_mfma_f32_16x16x32_bf16 v[72:75], v[52:55], v[184:187], v[72:75]
    ds_read_b64_tr_b16 v[48:49], v3 offset:61440
    v_mfma_f32_16x16x32_bf16 v[76:79], v[52:55], v[188:191], v[76:79]
    ds_read_b64_tr_b16 v[50:51], v3 offset:62464
    s_waitcnt lgkmcnt(10)
    v_mfma_f32_16x16x32_bf16 v[80:83], v[56:59], v[184:187], v[80:83]
    buffer_load_dwordx4 v[172:175], v2, s[4:7], s42 offen offset:2304 sc1
    ds_read_b64_tr_b16 v[52:53], v4 offset:61440
    s_add_u32 s42, s41, s97
    v_mfma_f32_16x16x32_bf16 v[84:87], v[56:59], v[188:191], v[84:87]
    ds_read_b64_tr_b16 v[54:55], v4 offset:62464
    v_mfma_f32_16x16x32_bf16 v[88:91], v[60:63], v[184:187], v[88:91]
    ds_read_b64_tr_b16 v[56:57], v5 offset:61440
    v_mfma_f32_16x16x32_bf16 v[92:95], v[60:63], v[188:191], v[92:95]
    ds_read_b64_tr_b16 v[58:59], v5 offset:62464
    s_waitcnt lgkmcnt(10)
    v_mfma_f32_16x16x32_bf16 v[96:99], v[184:187], v[32:35], v[96:99]
    ds_read_b64_tr_b16 v[60:61], v6 offset:61440
    v_mfma_f32_16x16x32_bf16 v[100:103], v[188:191], v[32:35], v[100:103]
    ds_read_b64_tr_b16 v[62:63], v6 offset:62464
    s_barrier
    v_xor_b32 v3, 0x10000, v3
    v_xor_b32 v4, 0x10000, v4
    v_xor_b32 v5, 0x10000, v5
    v_xor_b32 v6, 0x10000, v6
    v_mfma_f32_16x16x32_bf16 v[104:107], v[184:187], v[36:39], v[104:107]
    ds_read_b64_tr_b16 v[32:33], v3 offset:0
    v_mfma_f32_16x16x32_bf16 v[108:111], v[188:191], v[36:39], v[108:111]
    ds_read_b64_tr_b16 v[34:35], v3 offset:1024
    s_waitcnt lgkmcnt(10)
    v_mfma_f32_16x16x32_bf16 v[112:115], v[184:187], v[40:43], v[112:115]
    ds_read_b64_tr_b16 v[36:37], v4 offset:0
    v_mfma_f32_16x16x32_bf16 v[116:119], v[188:191], v[40:43], v[116:119]
    ds_read_b64_tr_b16 v[38:39], v4 offset:1024
    v_mfma_f32_16x16x32_bf16 v[120:123], v[184:187], v[44:47], v[120:123]
    ds_read_b64_tr_b16 v[40:41], v5 offset:0
    v_mfma_f32_16x16x32_bf16 v[124:127], v[188:191], v[44:47], v[124:127]
    ds_read_b64_tr_b16 v[42:43], v5 offset:1024
    s_waitcnt lgkmcnt(10)
    v_mfma_f32_16x16x32_bf16 v[128:131], v[48:51], v[184:187], v[128:131]
    ds_read_b64_tr_b16 v[44:45], v6 offset:0
    v_mfma_f32_16x16x32_bf16 v[132:135], v[48:51], v[188:191], v[132:135]
    ds_read_b64_tr_b16 v[46:47], v6 offset:1024
    v_mfma_f32_16x16x32_bf16 v[136:139], v[52:55], v[184:187], v[136:139]
    ds_read_b64_tr_b16 v[48:49], v3 offset:4096
    v_mfma_f32_16x16x32_bf16 v[140:143], v[52:55], v[188:191], v[140:143]
    ds_read_b64_tr_b16 v[50:51], v3 offset:5120
    s_waitcnt lgkmcnt(10)
    v_mfma_f32_16x16x32_bf16 v[144:147], v[56:59], v[184:187], v[144:147]
    ds_read_b64_tr_b16 v[52:53], v4 offset:4096
    v_mfma_f32_16x16x32_bf16 v[148:151], v[56:59], v[188:191], v[148:151]
    ds_read_b64_tr_b16 v[54:55], v4 offset:5120
    v_mfma_f32_16x16x32_bf16 v[152:155], v[60:63], v[184:187], v[152:155]
    ds_read_b64_tr_b16 v[56:57], v5 offset:4096
    v_mfma_f32_16x16x32_bf16 v[156:159], v[60:63], v[188:191], v[156:159]
    ds_read_b64_tr_b16 v[58:59], v5 offset:5120
    s_waitcnt vmcnt(18) lgkmcnt(10)
    v_mfma_f32_16x16x32_bf16 v[64:67], v[32:35], v[192:195], v[64:67]
    ds_read_b64_tr_b16 v[60:61], v6 offset:4096
    v_mfma_f32_16x16x32_bf16 v[68:71], v[32:35], v[196:199], v[68:71]
    ds_read_b64_tr_b16 v[62:63], v6 offset:5120
    v_mfma_f32_16x16x32_bf16 v[72:75], v[36:39], v[192:195], v[72:75]
    ds_read_b64_tr_b16 v[32:33], v3 offset:8192
    v_mfma_f32_16x16x32_bf16 v[76:79], v[36:39], v[196:199], v[76:79]
    ds_read_b64_tr_b16 v[34:35], v3 offset:9216
    s_waitcnt lgkmcnt(10)
    v_mfma_f32_16x16x32_bf16 v[80:83], v[40:43], v[192:195], v[80:83]
    ds_read_b64_tr_b16 v[36:37], v4 offset:8192
    v_mfma_f32_16x16x32_bf16 v[84:87], v[40:43], v[196:199], v[84:87]
    ds_read_b64_tr_b16 v[38:39], v4 offset:9216
    v_mfma_f32_16x16x32_bf16 v[88:91], v[44:47], v[192:195], v[88:91]
    ds_read_b64_tr_b16 v[40:41], v5 offset:8192
    v_mfma_f32_16x16x32_bf16 v[92:95], v[44:47], v[196:199], v[92:95]
    ds_read_b64_tr_b16 v[42:43], v5 offset:9216
    s_waitcnt lgkmcnt(10)
    v_mfma_f32_16x16x32_bf16 v[96:99], v[192:195], v[48:51], v[96:99]
    ds_read_b64_tr_b16 v[44:45], v6 offset:8192
    v_mfma_f32_16x16x32_bf16 v[100:103], v[196:199], v[48:51], v[100:103]
    ds_read_b64_tr_b16 v[46:47], v6 offset:9216
    v_mfma_f32_16x16x32_bf16 v[104:107], v[192:195], v[52:55], v[104:107]
    ds_read_b64_tr_b16 v[48:49], v3 offset:12288
    v_mfma_f32_16x16x32_bf16 v[108:111], v[196:199], v[52:55], v[108:111]
    ds_read_b64_tr_b16 v[50:51], v3 offset:13312
    s_waitcnt lgkmcnt(10)
    v_mfma_f32_16x16x32_bf16 v[112:115], v[192:195], v[56:59], v[112:115]
    ds_read_b64_tr_b16 v[52:53], v4 offset:12288
    v_mfma_f32_16x16x32_bf16 v[116:119], v[196:199], v[56:59], v[116:119]
    ds_read_b64_tr_b16 v[54:55], v4 offset:13312
    v_mfma_f32_16x16x32_bf16 v[120:123], v[192:195], v[60:63], v[120:123]
    ds_read_b64_tr_b16 v[56:57], v5 offset:12288
    v_mfma_f32_16x16x32_bf16 v[124:127], v[196:199], v[60:63], v[124:127]
    ds_read_b64_tr_b16 v[58:59], v5 offset:13312
    s_waitcnt lgkmcnt(10)
    v_mfma_f32_16x16x32_bf16 v[128:131], v[32:35], v[192:195], v[128:131]
    ds_read_b64_tr_b16 v[60:61], v6 offset:12288
    v_mfma_f32_16x16x32_bf16 v[132:135], v[32:35], v[196:199], v[132:135]
    ds_read_b64_tr_b16 v[62:63], v6 offset:13312
    v_mfma_f32_16x16x32_bf16 v[136:139], v[36:39], v[192:195], v[136:139]
    ds_read_b64_tr_b16 v[32:33], v3 offset:16384
    v_mfma_f32_16x16x32_bf16 v[140:143], v[36:39], v[196:199], v[140:143]
    ds_read_b64_tr_b16 v[34:35], v3 offset:17408
    s_waitcnt lgkmcnt(10)
    v_mfma_f32_16x16x32_bf16 v[144:147], v[40:43], v[192:195], v[144:147]
    ds_read_b64_tr_b16 v[36:37], v4 offset:16384
    v_mfma_f32_16x16x32_bf16 v[148:151], v[40:43], v[196:199], v[148:151]
    ds_read_b64_tr_b16 v[38:39], v4 offset:17408
    v_mfma_f32_16x16x32_bf16 v[152:155], v[44:47], v[192:195], v[152:155]
    ds_read_b64_tr_b16 v[40:41], v5 offset:16384
    v_mfma_f32_16x16x32_bf16 v[156:159], v[44:47], v[196:199], v[156:159]
    ds_read_b64_tr_b16 v[42:43], v5 offset:17408
    s_waitcnt vmcnt(16) lgkmcnt(10)
    v_mfma_f32_16x16x32_bf16 v[64:67], v[48:51], v[200:203], v[64:67]
    buffer_load_dwordx4 v[176:179], v2, s[4:7], s42 offen offset:0 sc1
    ds_read_b64_tr_b16 v[44:45], v6 offset:16384
    v_mfma_f32_16x16x32_bf16 v[68:71], v[48:51], v[204:207], v[68:71]
    ds_read_b64_tr_b16 v[46:47], v6 offset:17408
    v_mfma_f32_16x16x32_bf16 v[72:75], v[52:55], v[200:203], v[72:75]
    buffer_load_dwordx4 v[180:183], v2, s[4:7], s42 offen offset:256 sc1
    ds_read_b64_tr_b16 v[48:49], v3 offset:20480
    v_mfma_f32_16x16x32_bf16 v[76:79], v[52:55], v[204:207], v[76:79]
    ds_read_b64_tr_b16 v[50:51], v3 offset:21504
    s_waitcnt lgkmcnt(10)
    v_mfma_f32_16x16x32_bf16 v[80:83], v[56:59], v[200:203], v[80:83]
    buffer_load_dwordx4 v[184:187], v2, s[4:7], s42 offen offset:2048 sc1
    ds_read_b64_tr_b16 v[52:53], v4 offset:20480
    v_mfma_f32_16x16x32_bf16 v[84:87], v[56:59], v[204:207], v[84:87]
    ds_read_b64_tr_b16 v[54:55], v4 offset:21504
    v_mfma_f32_16x16x32_bf16 v[88:91], v[60:63], v[200:203], v[88:91]
    buffer_load_dwordx4 v[188:191], v2, s[4:7], s42 offen offset:2304 sc1
    ds_read_b64_tr_b16 v[56:57], v5 offset:20480
    s_add_u32 s42, s41, s98
    v_mfma_f32_16x16x32_bf16 v[92:95], v[60:63], v[204:207], v[92:95]
    ds_read_b64_tr_b16 v[58:59], v5 offset:21504
    s_waitcnt lgkmcnt(10)
    v_mfma_f32_16x16x32_bf16 v[96:99], v[200:203], v[32:35], v[96:99]
    ds_read_b64_tr_b16 v[60:61], v6 offset:20480
    buffer_load_dwordx4 v[192:195], v2, s[4:7], s42 offen offset:0 sc1
    v_mfma_f32_16x16x32_bf16 v[100:103], v[204:207], v[32:35], v[100:103]
    ds_read_b64_tr_b16 v[62:63], v6 offset:21504
    v_mfma_f32_16x16x32_bf16 v[104:107], v[200:203], v[36:39], v[104:107]
    ds_read_b64_tr_b16 v[32:33], v3 offset:24576
    v_mfma_f32_16x16x32_bf16 v[108:111], v[204:207], v[36:39], v[108:111]
    ds_read_b64_tr_b16 v[34:35], v3 offset:25600
    s_waitcnt lgkmcnt(10)
    v_mfma_f32_16x16x32_bf16 v[112:115], v[200:203], v[40:43], v[112:115]
    ds_read_b64_tr_b16 v[36:37], v4 offset:24576
    v_mfma_f32_16x16x32_bf16 v[116:119], v[204:207], v[40:43], v[116:119]
    ds_read_b64_tr_b16 v[38:39], v4 offset:25600
    v_mfma_f32_16x16x32_bf16 v[120:123], v[200:203], v[44:47], v[120:123]
    buffer_load_dwordx4 v[196:199], v2, s[4:7], s42 offen offset:256 sc1
    ds_read_b64_tr_b16 v[40:41], v5 offset:24576
    v_mfma_f32_16x16x32_bf16 v[124:127], v[204:207], v[44:47], v[124:127]
    ds_read_b64_tr_b16 v[42:43], v5 offset:25600
    s_waitcnt lgkmcnt(10)
    v_mfma_f32_16x16x32_bf16 v[128:131], v[48:51], v[200:203], v[128:131]
    ds_read_b64_tr_b16 v[44:45], v6 offset:24576
    v_mfma_f32_16x16x32_bf16 v[132:135], v[48:51], v[204:207], v[132:135]
    ds_read_b64_tr_b16 v[46:47], v6 offset:25600
    v_mfma_f32_16x16x32_bf16 v[136:139], v[52:55], v[200:203], v[136:139]
    ds_read_b64_tr_b16 v[48:49], v3 offset:28672
    v_mfma_f32_16x16x32_bf16 v[140:143], v[52:55], v[204:207], v[140:143]
    ds_read_b64_tr_b16 v[50:51], v3 offset:29696
    s_waitcnt lgkmcnt(10)
    v_mfma_f32_16x16x32_bf16 v[144:147], v[56:59], v[200:203], v[144:147]
    ds_read_b64_tr_b16 v[52:53], v4 offset:28672
    v_mfma_f32_16x16x32_bf16 v[148:151], v[56:59], v[204:207], v[148:151]
    ds_read_b64_tr_b16 v[54:55], v4 offset:29696
    v_mfma_f32_16x16x32_bf16 v[152:155], v[60:63], v[200:203], v[152:155]
    ds_read_b64_tr_b16 v[56:57], v5 offset:28672
    v_mfma_f32_16x16x32_bf16 v[156:159], v[60:63], v[204:207], v[156:159]
    ds_read_b64_tr_b16 v[58:59], v5 offset:29696
    s_waitcnt vmcnt(20) lgkmcnt(10)
    v_mfma_f32_16x16x32_bf16 v[64:67], v[32:35], v[208:211], v[64:67]
    ds_read_b64_tr_b16 v[60:61], v6 offset:28672
    v_mfma_f32_16x16x32_bf16 v[68:71], v[32:35], v[212:215], v[68:71]
    ds_read_b64_tr_b16 v[62:63], v6 offset:29696
    s_barrier
    v_mfma_f32_16x16x32_bf16 v[72:75], v[36:39], v[208:211], v[72:75]
    ds_read_b64_tr_b16 v[32:33], v3 offset:32768
    v_mfma_f32_16x16x32_bf16 v[76:79], v[36:39], v[212:215], v[76:79]
    ds_read_b64_tr_b16 v[34:35], v3 offset:33792
    s_waitcnt lgkmcnt(10)
    v_mfma_f32_16x16x32_bf16 v[80:83], v[40:43], v[208:211], v[80:83]
    ds_read_b64_tr_b16 v[36:37], v4 offset:32768
    v_mfma_f32_16x16x32_bf16 v[84:87], v[40:43], v[212:215], v[84:87]
    ds_read_b64_tr_b16 v[38:39], v4 offset:33792
    v_mfma_f32_16x16x32_bf16 v[88:91], v[44:47], v[208:211], v[88:91]
    ds_read_b64_tr_b16 v[40:41], v5 offset:32768
    v_mfma_f32_16x16x32_bf16 v[92:95], v[44:47], v[212:215], v[92:95]
    ds_read_b64_tr_b16 v[42:43], v5 offset:33792
    s_waitcnt lgkmcnt(10)
    v_mfma_f32_16x16x32_bf16 v[96:99], v[208:211], v[48:51], v[96:99]
    ds_read_b64_tr_b16 v[44:45], v6 offset:32768
    v_mfma_f32_16x16x32_bf16 v[100:103], v[212:215], v[48:51], v[100:103]
    ds_read_b64_tr_b16 v[46:47], v6 offset:33792
    v_mfma_f32_16x16x32_bf16 v[104:107], v[208:211], v[52:55], v[104:107]
    ds_read_b64_tr_b16 v[48:49], v3 offset:36864
    v_mfma_f32_16x16x32_bf16 v[108:111], v[212:215], v[52:55], v[108:111]
    ds_read_b64_tr_b16 v[50:51], v3 offset:37888
    s_waitcnt lgkmcnt(10)
    v_mfma_f32_16x16x32_bf16 v[112:115], v[208:211], v[56:59], v[112:115]
    ds_read_b64_tr_b16 v[52:53], v4 offset:36864
    v_mfma_f32_16x16x32_bf16 v[116:119], v[212:215], v[56:59], v[116:119]
    ds_read_b64_tr_b16 v[54:55], v4 offset:37888
    v_mfma_f32_16x16x32_bf16 v[120:123], v[208:211], v[60:63], v[120:123]
    ds_read_b64_tr_b16 v[56:57], v5 offset:36864
    v_mfma_f32_16x16x32_bf16 v[124:127], v[212:215], v[60:63], v[124:127]
    ds_read_b64_tr_b16 v[58:59], v5 offset:37888
    s_waitcnt lgkmcnt(10)
    v_mfma_f32_16x16x32_bf16 v[128:131], v[32:35], v[208:211], v[128:131]
    ds_read_b64_tr_b16 v[60:61], v6 offset:36864
    v_mfma_f32_16x16x32_bf16 v[132:135], v[32:35], v[212:215], v[132:135]
    ds_read_b64_tr_b16 v[62:63], v6 offset:37888
    v_mfma_f32_16x16x32_bf16 v[136:139], v[36:39], v[208:211], v[136:139]
    ds_read_b64_tr_b16 v[32:33], v3 offset:40960
    v_mfma_f32_16x16x32_bf16 v[140:143], v[36:39], v[212:215], v[140:143]
    ds_read_b64_tr_b16 v[34:35], v3 offset:41984
    s_waitcnt lgkmcnt(10)
    v_mfma_f32_16x16x32_bf16 v[144:147], v[40:43], v[208:211], v[144:147]
    ds_read_b64_tr_b16 v[36:37], v4 offset:40960
    v_mfma_f32_16x16x32_bf16 v[148:151], v[40:43], v[212:215], v[148:151]
    ds_read_b64_tr_b16 v[38:39], v4 offset:41984
    v_mfma_f32_16x16x32_bf16 v[152:155], v[44:47], v[208:211], v[152:155]
    ds_read_b64_tr_b16 v[40:41], v5 offset:40960
    v_mfma_f32_16x16x32_bf16 v[156:159], v[44:47], v[212:215], v[156:159]
    ds_read_b64_tr_b16 v[42:43], v5 offset:41984
    s_waitcnt vmcnt(18) lgkmcnt(10)
    v_mfma_f32_16x16x32_bf16 v[64:67], v[48:51], v[216:219], v[64:67]
    ds_read_b64_tr_b16 v[44:45], v6 offset:40960
    v_mfma_f32_16x16x32_bf16 v[68:71], v[48:51], v[220:223], v[68:71]
    ds_read_b64_tr_b16 v[46:47], v6 offset:41984
    v_mfma_f32_16x16x32_bf16 v[72:75], v[52:55], v[216:219], v[72:75]
    ds_read_b64_tr_b16 v[48:49], v3 offset:45056
    v_mfma_f32_16x16x32_bf16 v[76:79], v[52:55], v[220:223], v[76:79]
    ds_read_b64_tr_b16 v[50:51], v3 offset:46080
    s_waitcnt lgkmcnt(10)
    v_mfma_f32_16x16x32_bf16 v[80:83], v[56:59], v[216:219], v[80:83]
    ds_read_b64_tr_b16 v[52:53], v4 offset:45056
    v_mfma_f32_16x16x32_bf16 v[84:87], v[56:59], v[220:223], v[84:87]
    ds_read_b64_tr_b16 v[54:55], v4 offset:46080
    v_mfma_f32_16x16x32_bf16 v[88:91], v[60:63], v[216:219], v[88:91]
    ds_read_b64_tr_b16 v[56:57], v5 offset:45056
    v_mfma_f32_16x16x32_bf16 v[92:95], v[60:63], v[220:223], v[92:95]
    ds_read_b64_tr_b16 v[58:59], v5 offset:46080
    s_waitcnt lgkmcnt(10)
    v_mfma_f32_16x16x32_bf16 v[96:99], v[216:219], v[32:35], v[96:99]
    ds_read_b64_tr_b16 v[60:61], v6 offset:45056
    v_mfma_f32_16x16x32_bf16 v[100:103], v[220:223], v[32:35], v[100:103]
    ds_read_b64_tr_b16 v[62:63], v6 offset:46080
    v_mfma_f32_16x16x32_bf16 v[104:107], v[216:219], v[36:39], v[104:107]
    ds_read_b64_tr_b16 v[32:33], v3 offset:49152
    v_mfma_f32_16x16x32_bf16 v[108:111], v[220:223], v[36:39], v[108:111]
    ds_read_b64_tr_b16 v[34:35], v3 offset:50176
    s_waitcnt lgkmcnt(10)
    v_mfma_f32_16x16x32_bf16 v[112:115], v[216:219], v[40:43], v[112:115]
    ds_read_b64_tr_b16 v[36:37], v4 offset:49152
    v_mfma_f32_16x16x32_bf16 v[116:119], v[220:223], v[40:43], v[116:119]
    ds_read_b64_tr_b16 v[38:39], v4 offset:50176
    v_mfma_f32_16x16x32_bf16 v[120:123], v[216:219], v[44:47], v[120:123]
    ds_read_b64_tr_b16 v[40:41], v5 offset:49152
    v_mfma_f32_16x16x32_bf16 v[124:127], v[220:223], v[44:47], v[124:127]
    ds_read_b64_tr_b16 v[42:43], v5 offset:50176
    s_waitcnt lgkmcnt(10)
    v_mfma_f32_16x16x32_bf16 v[128:131], v[48:51], v[216:219], v[128:131]
    buffer_load_dwordx4 v[200:203], v2, s[4:7], s42 offen offset:2048 sc1
    ds_read_b64_tr_b16 v[44:45], v6 offset:49152
    v_mfma_f32_16x16x32_bf16 v[132:135], v[48:51], v[220:223], v[132:135]
    ds_read_b64_tr_b16 v[46:47], v6 offset:50176
    v_mfma_f32_16x16x32_bf16 v[136:139], v[52:55], v[216:219], v[136:139]
    buffer_load_dwordx4 v[204:207], v2, s[4:7], s42 offen offset:2304 sc1
    ds_read_b64_tr_b16 v[48:49], v3 offset:53248
    s_add_u32 s42, s41, s99
    v_mfma_f32_16x16x32_bf16 v[140:143], v[52:55], v[220:223], v[140:143]
    ds_read_b64_tr_b16 v[50:51], v3 offset:54272
    s_waitcnt lgkmcnt(10)
    v_mfma_f32_16x16x32_bf16 v[144:147], v[56:59], v[216:219], v[144:147]
    buffer_load_dwordx4 v[208:211], v2, s[4:7], s42 offen offset:0 sc1
    ds_read_b64_tr_b16 v[52:53], v4 offset:53248
    v_mfma_f32_16x16x32_bf16 v[148:151], v[56:59], v[220:223], v[148:151]
    ds_read_b64_tr_b16 v[54:55], v4 offset:54272
    v_mfma_f32_16x16x32_bf16 v[152:155], v[60:63], v[216:219], v[152:155]
    buffer_load_dwordx4 v[212:215], v2, s[4:7], s42 offen offset:256 sc1
    ds_read_b64_tr_b16 v[56:57], v5 offset:53248
    v_mfma_f32_16x16x32_bf16 v[156:159], v[60:63], v[220:223], v[156:159]
    ds_read_b64_tr_b16 v[58:59], v5 offset:54272
    s_waitcnt vmcnt(20) lgkmcnt(10)
    v_mfma_f32_16x16x32_bf16 v[64:67], v[32:35], v[224:227], v[64:67]
    ds_read_b64_tr_b16 v[60:61], v6 offset:53248
    buffer_load_dwordx4 v[216:219], v2, s[4:7], s42 offen offset:2048 sc1
    v_mfma_f32_16x16x32_bf16 v[68:71], v[32:35], v[228:231], v[68:71]
    ds_read_b64_tr_b16 v[62:63], v6 offset:54272
    v_mfma_f32_16x16x32_bf16 v[72:75], v[36:39], v[224:227], v[72:75]
    buffer_load_dwordx4 v[220:223], v2, s[4:7], s42 offen offset:2304 sc1
    ds_read_b64_tr_b16 v[32:33], v3 offset:57344
    v_mfma_f32_16x16x32_bf16 v[76:79], v[36:39], v[228:231], v[76:79]
    ds_read_b64_tr_b16 v[34:35], v3 offset:58368
    s_waitcnt lgkmcnt(10)
    v_mfma_f32_16x16x32_bf16 v[80:83], v[40:43], v[224:227], v[80:83]
    ds_read_b64_tr_b16 v[36:37], v4 offset:57344
    v_mfma_f32_16x16x32_bf16 v[84:87], v[40:43], v[228:231], v[84:87]
    ds_read_b64_tr_b16 v[38:39], v4 offset:58368
    v_mfma_f32_16x16x32_bf16 v[88:91], v[44:47], v[224:227], v[88:91]
    ds_read_b64_tr_b16 v[40:41], v5 offset:57344
    v_mfma_f32_16x16x32_bf16 v[92:95], v[44:47], v[228:231], v[92:95]
    ds_read_b64_tr_b16 v[42:43], v5 offset:58368
    s_waitcnt lgkmcnt(10)
    v_mfma_f32_16x16x32_bf16 v[96:99], v[224:227], v[48:51], v[96:99]
    ds_read_b64_tr_b16 v[44:45], v6 offset:57344
    v_mfma_f32_16x16x32_bf16 v[100:103], v[228:231], v[48:51], v[100:103]
    ds_read_b64_tr_b16 v[46:47], v6 offset:58368
    v_mfma_f32_16x16x32_bf16 v[104:107], v[224:227], v[52:55], v[104:107]
    ds_read_b64_tr_b16 v[48:49], v3 offset:61440
    v_mfma_f32_16x16x32_bf16 v[108:111], v[228:231], v[52:55], v[108:111]
    ds_read_b64_tr_b16 v[50:51], v3 offset:62464
    s_waitcnt lgkmcnt(10)
    v_mfma_f32_16x16x32_bf16 v[112:115], v[224:227], v[56:59], v[112:115]
    ds_read_b64_tr_b16 v[52:53], v4 offset:61440
    v_mfma_f32_16x16x32_bf16 v[116:119], v[228:231], v[56:59], v[116:119]
    ds_read_b64_tr_b16 v[54:55], v4 offset:62464
    v_mfma_f32_16x16x32_bf16 v[120:123], v[224:227], v[60:63], v[120:123]
    ds_read_b64_tr_b16 v[56:57], v5 offset:61440
    v_mfma_f32_16x16x32_bf16 v[124:127], v[228:231], v[60:63], v[124:127]
    ds_read_b64_tr_b16 v[58:59], v5 offset:62464
    s_waitcnt vmcnt(20) lgkmcnt(10)
    v_mfma_f32_16x16x32_bf16 v[64:67], v[32:35], v[232:235], v[64:67]
    ds_read_b64_tr_b16 v[60:61], v6 offset:61440
    v_mfma_f32_16x16x32_bf16 v[68:71], v[32:35], v[236:239], v[68:71]
    ds_read_b64_tr_b16 v[62:63], v6 offset:62464
    s_barrier
    v_xor_b32 v3, 0x10000, v3
    v_xor_b32 v4, 0x10000, v4
    v_xor_b32 v5, 0x10000, v5
    v_xor_b32 v6, 0x10000, v6
    v_mfma_f32_16x16x32_bf16 v[72:75], v[36:39], v[232:235], v[72:75]
    ds_read_b64_tr_b16 v[32:33], v3 offset:0
    v_mfma_f32_16x16x32_bf16 v[76:79], v[36:39], v[236:239], v[76:79]
    ds_read_b64_tr_b16 v[34:35], v3 offset:1024
    s_waitcnt lgkmcnt(10)
    v_mfma_f32_16x16x32_bf16 v[80:83], v[40:43], v[232:235], v[80:83]
    ds_read_b64_tr_b16 v[36:37], v4 offset:0
    v_mfma_f32_16x16x32_bf16 v[84:87], v[40:43], v[236:239], v[84:87]
    ds_read_b64_tr_b16 v[38:39], v4 offset:1024
    v_mfma_f32_16x16x32_bf16 v[88:91], v[44:47], v[232:235], v[88:91]
    ds_read_b64_tr_b16 v[40:41], v5 offset:0
    v_mfma_f32_16x16x32_bf16 v[92:95], v[44:47], v[236:239], v[92:95]
    ds_read_b64_tr_b16 v[42:43], v5 offset:1024
    s_waitcnt lgkmcnt(10)
    v_mfma_f32_16x16x32_bf16 v[96:99], v[232:235], v[48:51], v[96:99]
    ds_read_b64_tr_b16 v[44:45], v6 offset:0
    v_mfma_f32_16x16x32_bf16 v[100:103], v[236:239], v[48:51], v[100:103]
    ds_read_b64_tr_b16 v[46:47], v6 offset:1024
    v_mfma_f32_16x16x32_bf16 v[104:107], v[232:235], v[52:55], v[104:107]
    ds_read_b64_tr_b16 v[48:49], v3 offset:4096
    v_mfma_f32_16x16x32_bf16 v[108:111], v[236:239], v[52:55], v[108:111]
    ds_read_b64_tr_b16 v[50:51], v3 offset:5120
    s_waitcnt lgkmcnt(10)
    v_mfma_f32_16x16x32_bf16 v[112:115], v[232:235], v[56:59], v[112:115]
    ds_read_b64_tr_b16 v[52:53], v4 offset:4096
    v_mfma_f32_16x16x32_bf16 v[116:119], v[236:239], v[56:59], v[116:119]
    ds_read_b64_tr_b16 v[54:55], v4 offset:5120
    v_mfma_f32_16x16x32_bf16 v[120:123], v[232:235], v[60:63], v[120:123]
    ds_read_b64_tr_b16 v[56:57], v5 offset:4096
    v_mfma_f32_16x16x32_bf16 v[124:127], v[236:239], v[60:63], v[124:127]
    ds_read_b64_tr_b16 v[58:59], v5 offset:5120
    s_waitcnt vmcnt(18) lgkmcnt(10)
    v_mfma_f32_16x16x32_bf16 v[64:67], v[32:35], v[240:243], v[64:67]
    ds_read_b64_tr_b16 v[60:61], v6 offset:4096
    v_mfma_f32_16x16x32_bf16 v[68:71], v[32:35], v[244:247], v[68:71]
    ds_read_b64_tr_b16 v[62:63], v6 offset:5120
    v_mfma_f32_16x16x32_bf16 v[72:75], v[36:39], v[240:243], v[72:75]
    ds_read_b64_tr_b16 v[32:33], v3 offset:8192
    v_mfma_f32_16x16x32_bf16 v[76:79], v[36:39], v[244:247], v[76:79]
    ds_read_b64_tr_b16 v[34:35], v3 offset:9216
    s_waitcnt lgkmcnt(10)
    v_mfma_f32_16x16x32_bf16 v[80:83], v[40:43], v[240:243], v[80:83]
    ds_read_b64_tr_b16 v[36:37], v4 offset:8192
    v_mfma_f32_16x16x32_bf16 v[84:87], v[40:43], v[244:247], v[84:87]
    ds_read_b64_tr_b16 v[38:39], v4 offset:9216
    v_mfma_f32_16x16x32_bf16 v[88:91], v[44:47], v[240:243], v[88:91]
    ds_read_b64_tr_b16 v[40:41], v5 offset:8192
    v_mfma_f32_16x16x32_bf16 v[92:95], v[44:47], v[244:247], v[92:95]
    ds_read_b64_tr_b16 v[42:43], v5 offset:9216
    s_waitcnt lgkmcnt(10)
    v_mfma_f32_16x16x32_bf16 v[96:99], v[240:243], v[48:51], v[96:99]
    ds_read_b64_tr_b16 v[44:45], v6 offset:8192
    v_mfma_f32_16x16x32_bf16 v[100:103], v[244:247], v[48:51], v[100:103]
    ds_read_b64_tr_b16 v[46:47], v6 offset:9216
    v_mfma_f32_16x16x32_bf16 v[104:107], v[240:243], v[52:55], v[104:107]
    ds_read_b64_tr_b16 v[48:49], v3 offset:12288
    v_mfma_f32_16x16x32_bf16 v[108:111], v[244:247], v[52:55], v[108:111]
    ds_read_b64_tr_b16 v[50:51], v3 offset:13312
    s_waitcnt lgkmcnt(10)
    v_mfma_f32_16x16x32_bf16 v[112:115], v[240:243], v[56:59], v[112:115]
    ds_read_b64_tr_b16 v[52:53], v4 offset:12288
    v_mfma_f32_16x16x32_bf16 v[116:119], v[244:247], v[56:59], v[116:119]
    ds_read_b64_tr_b16 v[54:55], v4 offset:13312
    v_mfma_f32_16x16x32_bf16 v[120:123], v[240:243], v[60:63], v[120:123]
    ds_read_b64_tr_b16 v[56:57], v5 offset:12288
    v_mfma_f32_16x16x32_bf16 v[124:127], v[244:247], v[60:63], v[124:127]
    ds_read_b64_tr_b16 v[58:59], v5 offset:13312
    s_waitcnt vmcnt(16) lgkmcnt(10)
    v_mfma_f32_16x16x32_bf16 v[64:67], v[32:35], v[248:251], v[64:67]
    ds_read_b64_tr_b16 v[60:61], v6 offset:12288
    v_mfma_f32_16x16x32_bf16 v[68:71], v[32:35], v[252:255], v[68:71]
    ds_read_b64_tr_b16 v[62:63], v6 offset:13312
    v_mfma_f32_16x16x32_bf16 v[72:75], v[36:39], v[248:251], v[72:75]
    ds_read_b64_tr_b16 v[32:33], v3 offset:16384
    v_mfma_f32_16x16x32_bf16 v[76:79], v[36:39], v[252:255], v[76:79]
    ds_read_b64_tr_b16 v[34:35], v3 offset:17408
    s_waitcnt lgkmcnt(10)
    v_mfma_f32_16x16x32_bf16 v[80:83], v[40:43], v[248:251], v[80:83]
    ds_read_b64_tr_b16 v[36:37], v4 offset:16384
    v_mfma_f32_16x16x32_bf16 v[84:87], v[40:43], v[252:255], v[84:87]
    ds_read_b64_tr_b16 v[38:39], v4 offset:17408
    v_mfma_f32_16x16x32_bf16 v[88:91], v[44:47], v[248:251], v[88:91]
    ds_read_b64_tr_b16 v[40:41], v5 offset:16384
    v_mfma_f32_16x16x32_bf16 v[92:95], v[44:47], v[252:255], v[92:95]
    ds_read_b64_tr_b16 v[42:43], v5 offset:17408
    s_waitcnt lgkmcnt(10)
    v_mfma_f32_16x16x32_bf16 v[96:99], v[248:251], v[48:51], v[96:99]
    ds_read_b64_tr_b16 v[44:45], v6 offset:16384
    v_mfma_f32_16x16x32_bf16 v[100:103], v[252:255], v[48:51], v[100:103]
    ds_read_b64_tr_b16 v[46:47], v6 offset:17408
    v_mfma_f32_16x16x32_bf16 v[104:107], v[248:251], v[52:55], v[104:107]
    ds_read_b64_tr_b16 v[48:49], v3 offset:20480
    v_mfma_f32_16x16x32_bf16 v[108:111], v[252:255], v[52:55], v[108:111]
    ds_read_b64_tr_b16 v[50:51], v3 offset:21504
    s_waitcnt lgkmcnt(10)
    v_mfma_f32_16x16x32_bf16 v[112:115], v[248:251], v[56:59], v[112:115]
    ds_read_b64_tr_b16 v[52:53], v4 offset:20480
    v_mfma_f32_16x16x32_bf16 v[116:119], v[252:255], v[56:59], v[116:119]
    ds_read_b64_tr_b16 v[54:55], v4 offset:21504
    v_mfma_f32_16x16x32_bf16 v[120:123], v[248:251], v[60:63], v[120:123]
    ds_read_b64_tr_b16 v[56:57], v5 offset:20480
    v_mfma_f32_16x16x32_bf16 v[124:127], v[252:255], v[60:63], v[124:127]
    ds_read_b64_tr_b16 v[58:59], v5 offset:21504
    s_waitcnt vmcnt(14) lgkmcnt(10)
    v_mfma_f32_16x16x32_bf16 v[64:67], v[32:35], v[160:163], v[64:67]
    ds_read_b64_tr_b16 v[60:61], v6 offset:20480
    v_mfma_f32_16x16x32_bf16 v[68:71], v[32:35], v[164:167], v[68:71]
    ds_read_b64_tr_b16 v[62:63], v6 offset:21504
    v_mfma_f32_16x16x32_bf16 v[72:75], v[36:39], v[160:163], v[72:75]
    ds_read_b64_tr_b16 v[32:33], v3 offset:24576
    v_mfma_f32_16x16x32_bf16 v[76:79], v[36:39], v[164:167], v[76:79]
    ds_read_b64_tr_b16 v[34:35], v3 offset:25600
    s_waitcnt lgkmcnt(10)
    v_mfma_f32_16x16x32_bf16 v[80:83], v[40:43], v[160:163], v[80:83]
    ds_read_b64_tr_b16 v[36:37], v4 offset:24576
    v_mfma_f32_16x16x32_bf16 v[84:87], v[40:43], v[164:167], v[84:87]
    ds_read_b64_tr_b16 v[38:39], v4 offset:25600
    v_mfma_f32_16x16x32_bf16 v[88:91], v[44:47], v[160:163], v[88:91]
    ds_read_b64_tr_b16 v[40:41], v5 offset:24576
    v_mfma_f32_16x16x32_bf16 v[92:95], v[44:47], v[164:167], v[92:95]
    ds_read_b64_tr_b16 v[42:43], v5 offset:25600
    s_waitcnt vmcnt(12) lgkmcnt(10)
    v_mfma_f32_16x16x32_bf16 v[64:67], v[48:51], v[168:171], v[64:67]
    ds_read_b64_tr_b16 v[44:45], v6 offset:24576
    v_mfma_f32_16x16x32_bf16 v[68:71], v[48:51], v[172:175], v[68:71]
    ds_read_b64_tr_b16 v[46:47], v6 offset:25600
    v_mfma_f32_16x16x32_bf16 v[72:75], v[52:55], v[168:171], v[72:75]
    ds_read_b64_tr_b16 v[48:49], v3 offset:28672
    v_mfma_f32_16x16x32_bf16 v[76:79], v[52:55], v[172:175], v[76:79]
    ds_read_b64_tr_b16 v[50:51], v3 offset:29696
    s_waitcnt lgkmcnt(10)
    v_mfma_f32_16x16x32_bf16 v[80:83], v[56:59], v[168:171], v[80:83]
    ds_read_b64_tr_b16 v[52:53], v4 offset:28672
    v_mfma_f32_16x16x32_bf16 v[84:87], v[56:59], v[172:175], v[84:87]
    ds_read_b64_tr_b16 v[54:55], v4 offset:29696
    v_mfma_f32_16x16x32_bf16 v[88:91], v[60:63], v[168:171], v[88:91]
    ds_read_b64_tr_b16 v[56:57], v5 offset:28672
    v_mfma_f32_16x16x32_bf16 v[92:95], v[60:63], v[172:175], v[92:95]
    ds_read_b64_tr_b16 v[58:59], v5 offset:29696
    s_waitcnt vmcnt(10) lgkmcnt(10)
    v_mfma_f32_16x16x32_bf16 v[64:67], v[32:35], v[176:179], v[64:67]
    ds_read_b64_tr_b16 v[60:61], v6 offset:28672
    v_mfma_f32_16x16x32_bf16 v[68:71], v[32:35], v[180:183], v[68:71]
    ds_read_b64_tr_b16 v[62:63], v6 offset:29696
    s_barrier
    v_mfma_f32_16x16x32_bf16 v[72:75], v[36:39], v[176:179], v[72:75]
    ds_read_b64_tr_b16 v[32:33], v3 offset:32768
    v_mfma_f32_16x16x32_bf16 v[76:79], v[36:39], v[180:183], v[76:79]
    ds_read_b64_tr_b16 v[34:35], v3 offset:33792
    s_waitcnt lgkmcnt(10)
    v_mfma_f32_16x16x32_bf16 v[80:83], v[40:43], v[176:179], v[80:83]
    ds_read_b64_tr_b16 v[36:37], v4 offset:32768
    v_mfma_f32_16x16x32_bf16 v[84:87], v[40:43], v[180:183], v[84:87]
    ds_read_b64_tr_b16 v[38:39], v4 offset:33792
    v_mfma_f32_16x16x32_bf16 v[88:91], v[44:47], v[176:179], v[88:91]
    ds_read_b64_tr_b16 v[40:41], v5 offset:32768
    v_mfma_f32_16x16x32_bf16 v[92:95], v[44:47], v[180:183], v[92:95]
    ds_read_b64_tr_b16 v[42:43], v5 offset:33792
    s_waitcnt vmcnt(8) lgkmcnt(10)
    v_mfma_f32_16x16x32_bf16 v[64:67], v[48:51], v[184:187], v[64:67]
    ds_read_b64_tr_b16 v[44:45], v6 offset:32768
    v_mfma_f32_16x16x32_bf16 v[68:71], v[48:51], v[188:191], v[68:71]
    ds_read_b64_tr_b16 v[46:47], v6 offset:33792
    v_mfma_f32_16x16x32_bf16 v[72:75], v[52:55], v[184:187], v[72:75]
    ds_read_b64_tr_b16 v[48:49], v3 offset:36864
    v_mfma_f32_16x16x32_bf16 v[76:79], v[52:55], v[188:191], v[76:79]
    ds_read_b64_tr_b16 v[50:51], v3 offset:37888
    s_waitcnt lgkmcnt(10)
    v_mfma_f32_16x16x32_bf16 v[80:83], v[56:59], v[184:187], v[80:83]
    ds_read_b64_tr_b16 v[52:53], v4 offset:36864
    v_mfma_f32_16x16x32_bf16 v[84:87], v[56:59], v[188:191], v[84:87]
    ds_read_b64_tr_b16 v[54:55], v4 offset:37888
    v_mfma_f32_16x16x32_bf16 v[88:91], v[60:63], v[184:187], v[88:91]
    ds_read_b64_tr_b16 v[56:57], v5 offset:36864
    v_mfma_f32_16x16x32_bf16 v[92:95], v[60:63], v[188:191], v[92:95]
    ds_read_b64_tr_b16 v[58:59], v5 offset:37888
    s_waitcnt vmcnt(6) lgkmcnt(10)
    v_mfma_f32_16x16x32_bf16 v[64:67], v[32:35], v[192:195], v[64:67]
    ds_read_b64_tr_b16 v[60:61], v6 offset:36864
    v_mfma_f32_16x16x32_bf16 v[68:71], v[32:35], v[196:199], v[68:71]
    ds_read_b64_tr_b16 v[62:63], v6 offset:37888
    v_mfma_f32_16x16x32_bf16 v[72:75], v[36:39], v[192:195], v[72:75]
    ds_read_b64_tr_b16 v[32:33], v3 offset:40960
    v_mfma_f32_16x16x32_bf16 v[76:79], v[36:39], v[196:199], v[76:79]
    ds_read_b64_tr_b16 v[34:35], v3 offset:41984
    s_waitcnt lgkmcnt(10)
    v_mfma_f32_16x16x32_bf16 v[80:83], v[40:43], v[192:195], v[80:83]
    ds_read_b64_tr_b16 v[36:37], v4 offset:40960
    v_mfma_f32_16x16x32_bf16 v[84:87], v[40:43], v[196:199], v[84:87]
    ds_read_b64_tr_b16 v[38:39], v4 offset:41984
    v_mfma_f32_16x16x32_bf16 v[88:91], v[44:47], v[192:195], v[88:91]
    ds_read_b64_tr_b16 v[40:41], v5 offset:40960
    v_mfma_f32_16x16x32_bf16 v[92:95], v[44:47], v[196:199], v[92:95]
    ds_read_b64_tr_b16 v[42:43], v5 offset:41984
    s_waitcnt vmcnt(4) lgkmcnt(10)
    v_mfma_f32_16x16x32_bf16 v[64:67], v[48:51], v[200:203], v[64:67]
    ds_read_b64_tr_b16 v[44:45], v6 offset:40960
    v_mfma_f32_16x16x32_bf16 v[68:71], v[48:51], v[204:207], v[68:71]
    ds_read_b64_tr_b16 v[46:47], v6 offset:41984
    v_mfma_f32_16x16x32_bf16 v[72:75], v[52:55], v[200:203], v[72:75]
    ds_read_b64_tr_b16 v[48:49], v3 offset:45056
    v_mfma_f32_16x16x32_bf16 v[76:79], v[52:55], v[204:207], v[76:79]
    ds_read_b64_tr_b16 v[50:51], v3 offset:46080
    s_waitcnt lgkmcnt(10)
    v_mfma_f32_16x16x32_bf16 v[80:83], v[56:59], v[200:203], v[80:83]
    ds_read_b64_tr_b16 v[52:53], v4 offset:45056
    v_mfma_f32_16x16x32_bf16 v[84:87], v[56:59], v[204:207], v[84:87]
    ds_read_b64_tr_b16 v[54:55], v4 offset:46080
    v_mfma_f32_16x16x32_bf16 v[88:91], v[60:63], v[200:203], v[88:91]
    ds_read_b64_tr_b16 v[56:57], v5 offset:45056
    v_mfma_f32_16x16x32_bf16 v[92:95], v[60:63], v[204:207], v[92:95]
    ds_read_b64_tr_b16 v[58:59], v5 offset:46080
    s_waitcnt vmcnt(2) lgkmcnt(10)
    v_mfma_f32_16x16x32_bf16 v[64:67], v[32:35], v[208:211], v[64:67]
    ds_read_b64_tr_b16 v[60:61], v6 offset:45056
    v_mfma_f32_16x16x32_bf16 v[68:71], v[32:35], v[212:215], v[68:71]
    ds_read_b64_tr_b16 v[62:63], v6 offset:46080
    v_mfma_f32_16x16x32_bf16 v[72:75], v[36:39], v[208:211], v[72:75]
    ds_read_b64_tr_b16 v[32:33], v3 offset:49152
    ds_read_b32 v8, v9 offset:4096
    v_mfma_f32_16x16x32_bf16 v[76:79], v[36:39], v[212:215], v[76:79]
    ds_read_b64_tr_b16 v[34:35], v3 offset:50176
    ds_read_b32 v10, v9 offset:4608
    s_waitcnt lgkmcnt(12)
    v_mfma_f32_16x16x32_bf16 v[80:83], v[40:43], v[208:211], v[80:83]
    ds_read_b64_tr_b16 v[36:37], v4 offset:49152
    ds_read_b32 v12, v9 offset:4160
    v_mfma_f32_16x16x32_bf16 v[84:87], v[40:43], v[212:215], v[84:87]
    ds_read_b64_tr_b16 v[38:39], v4 offset:50176
    ds_read_b32 v14, v9 offset:4672
    v_mfma_f32_16x16x32_bf16 v[88:91], v[44:47], v[208:211], v[88:91]
    ds_read_b64_tr_b16 v[40:41], v5 offset:49152
    ds_read_b128 v[16:19], v11 offset:256
    v_mfma_f32_16x16x32_bf16 v[92:95], v[44:47], v[212:215], v[92:95]
    ds_read_b64_tr_b16 v[42:43], v5 offset:50176
    ds_read_b128 v[20:23], v11 offset:320
    s_waitcnt vmcnt(0) lgkmcnt(14)
    v_mfma_f32_16x16x32_bf16 v[64:67], v[48:51], v[216:219], v[64:67]
    ds_read_b64_tr_b16 v[44:45], v6 offset:49152
    ds_read_b128 v[24:27], v11 offset:384
    v_mfma_f32_16x16x32_bf16 v[68:71], v[48:51], v[220:223], v[68:71]
    ds_read_b64_tr_b16 v[46:47], v6 offset:50176
    ds_read_b128 v[28:31], v11 offset:448
    v_mfma_f32_16x16x32_bf16 v[72:75], v[52:55], v[216:219], v[72:75]
    ds_read_b64_tr_b16 v[48:49], v3 offset:53248
    v_mfma_f32_16x16x32_bf16 v[76:79], v[52:55], v[220:223], v[76:79]
    ds_read_b64_tr_b16 v[50:51], v3 offset:54272
    s_waitcnt lgkmcnt(14)
    v_mfma_f32_16x16x32_bf16 v[80:83], v[56:59], v[216:219], v[80:83]
    ds_read_b64_tr_b16 v[52:53], v4 offset:53248
    v_mfma_f32_16x16x32_bf16 v[84:87], v[56:59], v[220:223], v[84:87]
    ds_read_b64_tr_b16 v[54:55], v4 offset:54272
    v_mfma_f32_16x16x32_bf16 v[88:91], v[60:63], v[216:219], v[88:91]
    ds_read_b64_tr_b16 v[56:57], v5 offset:53248
    v_mfma_f32_16x16x32_bf16 v[92:95], v[60:63], v[220:223], v[92:95]
    ds_read_b64_tr_b16 v[58:59], v5 offset:54272
    s_bitcmp1_b32 s21, 0
    s_cbranch_scc1 c_B
    v_add_u32 v7, s62, v1
    s_waitcnt lgkmcnt(6)
    v_pk_fma_f32 v[68:69], v[12:13], v[16:17], v[68:69] op_sel_hi:[0,1,1] neg_lo:[1,0,0] neg_hi:[1,0,0]
    v_pk_fma_f32 v[70:71], v[12:13], v[18:19], v[70:71] op_sel_hi:[0,1,1] neg_lo:[1,0,0] neg_hi:[1,0,0]
    v_pk_fma_f32 v[76:77], v[12:13], v[20:21], v[76:77] op_sel_hi:[0,1,1] neg_lo:[1,0,0] neg_hi:[1,0,0]
    v_pk_fma_f32 v[78:79], v[12:13], v[22:23], v[78:79] op_sel_hi:[0,1,1] neg_lo:[1,0,0] neg_hi:[1,0,0]
    v_pk_mul_f32 v[68:69], v[14:15], v[68:69] op_sel_hi:[0,1]
    v_pk_mul_f32 v[70:71], v[14:15], v[70:71] op_sel_hi:[0,1]
    v_pk_mul_f32 v[76:77], v[14:15], v[76:77] op_sel_hi:[0,1]
    v_pk_mul_f32 v[78:79], v[14:15], v[78:79] op_sel_hi:[0,1]
    v_cvt_pk_bf16_f32 v68, v68, v69
    v_cvt_pk_bf16_f32 v69, v70, v71
    v_cvt_pk_bf16_f32 v70, v76, v77
    v_cvt_pk_bf16_f32 v71, v78, v79
    ds_write_b128 v7, v[68:71] offset:4096
    v_pk_fma_f32 v[64:65], v[8:9], v[16:17], v[64:65] op_sel_hi:[0,1,1] neg_lo:[1,0,0] neg_hi:[1,0,0]
    v_pk_fma_f32 v[66:67], v[8:9], v[18:19], v[66:67] op_sel_hi:[0,1,1] neg_lo:[1,0,0] neg_hi:[1,0,0]
    v_pk_fma_f32 v[72:73], v[8:9], v[20:21], v[72:73] op_sel_hi:[0,1,1] neg_lo:[1,0,0] neg_hi:[1,0,0]
    v_pk_fma_f32 v[74:75], v[8:9], v[22:23], v[74:75] op_sel_hi:[0,1,1] neg_lo:[1,0,0] neg_hi:[1,0,0]
    v_pk_mul_f32 v[64:65], v[10:11], v[64:65] op_sel_hi:[0,1]
    v_pk_mul_f32 v[66:67], v[10:11], v[66:67] op_sel_hi:[0,1]
    v_pk_mul_f32 v[72:73], v[10:11], v[72:73] op_sel_hi:[0,1]
    v_pk_mul_f32 v[74:75], v[10:11], v[74:75] op_sel_hi:[0,1]
    v_cvt_pk_bf16_f32 v64, v64, v65
    v_cvt_pk_bf16_f32 v65, v66, v67
    v_cvt_pk_bf16_f32 v66, v72, v73
    v_cvt_pk_bf16_f32 v67, v74, v75
    v_pk_fma_f32 v[84:85], v[12:13], v[24:25], v[84:85] op_sel_hi:[0,1,1] neg_lo:[1,0,0] neg_hi:[1,0,0]
    v_pk_fma_f32 v[86:87], v[12:13], v[26:27], v[86:87] op_sel_hi:[0,1,1] neg_lo:[1,0,0] neg_hi:[1,0,0]
    v_pk_fma_f32 v[92:93], v[12:13], v[28:29], v[92:93] op_sel_hi:[0,1,1] neg_lo:[1,0,0] neg_hi:[1,0,0]
    v_pk_fma_f32 v[94:95], v[12:13], v[30:31], v[94:95] op_sel_hi:[0,1,1] neg_lo:[1,0,0] neg_hi:[1,0,0]
    v_pk_mul_f32 v[84:85], v[14:15], v[84:85] op_sel_hi:[0,1]
    v_pk_mul_f32 v[86:87], v[14:15], v[86:87] op_sel_hi:[0,1]
    v_pk_mul_f32 v[92:93], v[14:15], v[92:93] op_sel_hi:[0,1]
    v_pk_mul_f32 v[94:95], v[14:15], v[94:95] op_sel_hi:[0,1]
    v_cvt_pk_bf16_f32 v84, v84, v85
    v_cvt_pk_bf16_f32 v85, v86, v87
    v_cvt_pk_bf16_f32 v86, v92, v93
    v_cvt_pk_bf16_f32 v87, v94, v95
    ds_write_b128 v7, v[84:87] offset:5120
    v_pk_fma_f32 v[80:81], v[8:9], v[24:25], v[80:81] op_sel_hi:[0,1,1] neg_lo:[1,0,0] neg_hi:[1,0,0]
    v_pk_fma_f32 v[82:83], v[8:9], v[26:27], v[82:83] op_sel_hi:[0,1,1] neg_lo:[1,0,0] neg_hi:[1,0,0]
    v_pk_fma_f32 v[88:89], v[8:9], v[28:29], v[88:89] op_sel_hi:[0,1,1] neg_lo:[1,0,0] neg_hi:[1,0,0]
    v_pk_fma_f32 v[90:91], v[8:9], v[30:31], v[90:91] op_sel_hi:[0,1,1] neg_lo:[1,0,0] neg_hi:[1,0,0]
    v_pk_mul_f32 v[80:81], v[10:11], v[80:81] op_sel_hi:[0,1]
    v_pk_mul_f32 v[82:83], v[10:11], v[82:83] op_sel_hi:[0,1]
    v_pk_mul_f32 v[88:89], v[10:11], v[88:89] op_sel_hi:[0,1]
    v_pk_mul_f32 v[90:91], v[10:11], v[90:91] op_sel_hi:[0,1]
    v_cvt_pk_bf16_f32 v80, v80, v81
    v_cvt_pk_bf16_f32 v81, v82, v83
    v_cvt_pk_bf16_f32 v82, v88, v89
    v_cvt_pk_bf16_f32 v83, v90, v91
    v_mfma_f32_16x16x32_bf16 v[96:99], v[160:163], v[32:35], v[96:99]
    ds_read_b64_tr_b16 v[60:61], v6 offset:53248
    v_mfma_f32_16x16x32_bf16 v[100:103], v[164:167], v[32:35], v[100:103]
    ds_read_b64_tr_b16 v[62:63], v6 offset:54272
    v_mfma_f32_16x16x32_bf16 v[104:107], v[160:163], v[36:39], v[104:107]
    ds_read_b64_tr_b16 v[32:33], v3 offset:57344
    v_mfma_f32_16x16x32_bf16 v[108:111], v[164:167], v[36:39], v[108:111]
    ds_read_b64_tr_b16 v[34:35], v3 offset:58368
    v_mfma_f32_16x16x32_bf16 v[112:115], v[160:163], v[40:43], v[112:115]
    ds_read_b64_tr_b16 v[36:37], v4 offset:57344
    v_mfma_f32_16x16x32_bf16 v[116:119], v[164:167], v[40:43], v[116:119]
    ds_read_b64_tr_b16 v[38:39], v4 offset:58368
    v_mfma_f32_16x16x32_bf16 v[120:123], v[160:163], v[44:47], v[120:123]
    ds_read_b64_tr_b16 v[40:41], v5 offset:57344
    v_mfma_f32_16x16x32_bf16 v[124:127], v[164:167], v[44:47], v[124:127]
    ds_read_b64_tr_b16 v[42:43], v5 offset:58368
    s_waitcnt lgkmcnt(12)
    v_mfma_f32_16x16x32_bf16 v[96:99], v[168:171], v[48:51], v[96:99]
    ds_read_b64_tr_b16 v[44:45], v6 offset:57344
    v_mfma_f32_16x16x32_bf16 v[100:103], v[172:175], v[48:51], v[100:103]
    ds_read_b64_tr_b16 v[46:47], v6 offset:58368
    v_mfma_f32_16x16x32_bf16 v[104:107], v[168:171], v[52:55], v[104:107]
    ds_read_b64_tr_b16 v[48:49], v3 offset:61440
    v_mfma_f32_16x16x32_bf16 v[108:111], v[172:175], v[52:55], v[108:111]
    ds_read_b64_tr_b16 v[50:51], v3 offset:62464
    s_waitcnt lgkmcnt(10)
    v_mfma_f32_16x16x32_bf16 v[112:115], v[168:171], v[56:59], v[112:115]
    ds_read_b64_tr_b16 v[52:53], v4 offset:61440
    v_mfma_f32_16x16x32_bf16 v[116:119], v[172:175], v[56:59], v[116:119]
    ds_read_b64_tr_b16 v[54:55], v4 offset:62464
    v_mfma_f32_16x16x32_bf16 v[120:123], v[168:171], v[60:63], v[120:123]
    ds_read_b64_tr_b16 v[56:57], v5 offset:61440
    v_mfma_f32_16x16x32_bf16 v[124:127], v[172:175], v[60:63], v[124:127]
    ds_read_b64_tr_b16 v[58:59], v5 offset:62464
    s_waitcnt lgkmcnt(10)
    v_mfma_f32_16x16x32_bf16 v[96:99], v[176:179], v[32:35], v[96:99]
    ds_read_b64_tr_b16 v[60:61], v6 offset:61440
    v_mfma_f32_16x16x32_bf16 v[100:103], v[180:183], v[32:35], v[100:103]
    ds_read_b64_tr_b16 v[62:63], v6 offset:62464
    s_barrier
    v_xor_b32 v3, 0x10000, v3
    v_xor_b32 v4, 0x10000, v4
    v_xor_b32 v5, 0x10000, v5
    v_xor_b32 v6, 0x10000, v6
    v_mfma_f32_16x16x32_bf16 v[104:107], v[176:179], v[36:39], v[104:107]
    ds_read_b64_tr_b16 v[32:33], v3 offset:0
    v_mfma_f32_16x16x32_bf16 v[108:111], v[180:183], v[36:39], v[108:111]
    ds_read_b64_tr_b16 v[34:35], v3 offset:1024
    s_waitcnt lgkmcnt(10)
    v_mfma_f32_16x16x32_bf16 v[112:115], v[176:179], v[40:43], v[112:115]
    ds_read_b64_tr_b16 v[36:37], v4 offset:0
    v_mfma_f32_16x16x32_bf16 v[116:119], v[180:183], v[40:43], v[116:119]
    ds_read_b64_tr_b16 v[38:39], v4 offset:1024
    v_mfma_f32_16x16x32_bf16 v[120:123], v[176:179], v[44:47], v[120:123]
    ds_read_b64_tr_b16 v[40:41], v5 offset:0
    v_mfma_f32_16x16x32_bf16 v[124:127], v[180:183], v[44:47], v[124:127]
    ds_read_b64_tr_b16 v[42:43], v5 offset:1024
    s_waitcnt lgkmcnt(10)
    v_mfma_f32_16x16x32_bf16 v[96:99], v[184:187], v[48:51], v[96:99]
    ds_read_b64_tr_b16 v[44:45], v6 offset:0
    v_mfma_f32_16x16x32_bf16 v[100:103], v[188:191], v[48:51], v[100:103]
    ds_read_b64_tr_b16 v[46:47], v6 offset:1024
    v_mfma_f32_16x16x32_bf16 v[104:107], v[184:187], v[52:55], v[104:107]
    ds_read_b64_tr_b16 v[48:49], v3 offset:4096
    v_mfma_f32_16x16x32_bf16 v[108:111], v[188:191], v[52:55], v[108:111]
    ds_read_b64_tr_b16 v[50:51], v3 offset:5120
    s_waitcnt lgkmcnt(10)
    v_mfma_f32_16x16x32_bf16 v[112:115], v[184:187], v[56:59], v[112:115]
    ds_read_b64_tr_b16 v[52:53], v4 offset:4096
    v_mfma_f32_16x16x32_bf16 v[116:119], v[188:191], v[56:59], v[116:119]
    ds_read_b64_tr_b16 v[54:55], v4 offset:5120
    v_mfma_f32_16x16x32_bf16 v[120:123], v[184:187], v[60:63], v[120:123]
    ds_read_b64_tr_b16 v[56:57], v5 offset:4096
    v_mfma_f32_16x16x32_bf16 v[124:127], v[188:191], v[60:63], v[124:127]
    ds_read_b64_tr_b16 v[58:59], v5 offset:5120
    s_waitcnt lgkmcnt(10)
    v_mfma_f32_16x16x32_bf16 v[96:99], v[192:195], v[32:35], v[96:99]
    ds_read_b64_tr_b16 v[60:61], v6 offset:4096
    v_mfma_f32_16x16x32_bf16 v[100:103], v[196:199], v[32:35], v[100:103]
    ds_read_b64_tr_b16 v[62:63], v6 offset:5120
    v_mfma_f32_16x16x32_bf16 v[104:107], v[192:195], v[36:39], v[104:107]
    ds_read_b64_tr_b16 v[32:33], v3 offset:8192
    v_mfma_f32_16x16x32_bf16 v[108:111], v[196:199], v[36:39], v[108:111]
    ds_read_b64_tr_b16 v[34:35], v3 offset:9216
    s_waitcnt lgkmcnt(10)
    v_mfma_f32_16x16x32_bf16 v[112:115], v[192:195], v[40:43], v[112:115]
    ds_read_b64_tr_b16 v[36:37], v4 offset:8192
    v_mfma_f32_16x16x32_bf16 v[116:119], v[196:199], v[40:43], v[116:119]
    ds_read_b64_tr_b16 v[38:39], v4 offset:9216
    v_mfma_f32_16x16x32_bf16 v[120:123], v[192:195], v[44:47], v[120:123]
    ds_read_b64_tr_b16 v[40:41], v5 offset:8192
    v_mfma_f32_16x16x32_bf16 v[124:127], v[196:199], v[44:47], v[124:127]
    ds_read_b64_tr_b16 v[42:43], v5 offset:9216
    s_waitcnt lgkmcnt(10)
    v_mfma_f32_16x16x32_bf16 v[96:99], v[200:203], v[48:51], v[96:99]
    ds_read_b64_tr_b16 v[44:45], v6 offset:8192
    v_mfma_f32_16x16x32_bf16 v[100:103], v[204:207], v[48:51], v[100:103]
    ds_read_b64_tr_b16 v[46:47], v6 offset:9216
    v_mfma_f32_16x16x32_bf16 v[104:107], v[200:203], v[52:55], v[104:107]
    ds_read_b64_tr_b16 v[48:49], v3 offset:12288
    v_mfma_f32_16x16x32_bf16 v[108:111], v[204:207], v[52:55], v[108:111]
    ds_read_b64_tr_b16 v[50:51], v3 offset:13312
    s_waitcnt lgkmcnt(10)
    v_mfma_f32_16x16x32_bf16 v[112:115], v[200:203], v[56:59], v[112:115]
    ds_read_b64_tr_b16 v[52:53], v4 offset:12288
    v_mfma_f32_16x16x32_bf16 v[116:119], v[204:207], v[56:59], v[116:119]
    ds_read_b64_tr_b16 v[54:55], v4 offset:13312
    v_mfma_f32_16x16x32_bf16 v[120:123], v[200:203], v[60:63], v[120:123]
    ds_read_b64_tr_b16 v[56:57], v5 offset:12288
    v_mfma_f32_16x16x32_bf16 v[124:127], v[204:207], v[60:63], v[124:127]
    ds_read_b64_tr_b16 v[58:59], v5 offset:13312
    s_waitcnt lgkmcnt(10)
    v_mfma_f32_16x16x32_bf16 v[96:99], v[208:211], v[32:35], v[96:99]
    ds_read_b64_tr_b16 v[60:61], v6 offset:12288
    v_mfma_f32_16x16x32_bf16 v[100:103], v[212:215], v[32:35], v[100:103]
    ds_read_b64_tr_b16 v[62:63], v6 offset:13312
    v_mfma_f32_16x16x32_bf16 v[104:107], v[208:211], v[36:39], v[104:107]
    ds_read_b64_tr_b16 v[32:33], v3 offset:16384
    ds_read_b128 v[16:19], v13 offset:4096
    v_mfma_f32_16x16x32_bf16 v[108:111], v[212:215], v[36:39], v[108:111]
    ds_read_b64_tr_b16 v[34:35], v3 offset:17408
    ds_read_b128 v[20:23], v13 offset:4608
    s_waitcnt lgkmcnt(12)
    v_mfma_f32_16x16x32_bf16 v[112:115], v[208:211], v[40:43], v[112:115]
    ds_read_b64_tr_b16 v[36:37], v4 offset:16384
    ds_read_b128 v[24:27], v13 offset:4160
    v_mfma_f32_16x16x32_bf16 v[116:119], v[212:215], v[40:43], v[116:119]
    ds_read_b64_tr_b16 v[38:39], v4 offset:17408
    ds_read_b128 v[28:31], v13 offset:4672
    v_mfma_f32_16x16x32_bf16 v[120:123], v[208:211], v[44:47], v[120:123]
    ds_read_b64_tr_b16 v[40:41], v5 offset:16384
    ds_read_b32 v8, v15 offset:512
    v_mfma_f32_16x16x32_bf16 v[124:127], v[212:215], v[44:47], v[124:127]
    ds_read_b64_tr_b16 v[42:43], v5 offset:17408
    ds_read_b32 v10, v15 offset:576
    s_waitcnt lgkmcnt(14)
    v_mfma_f32_16x16x32_bf16 v[96:99], v[216:219], v[48:51], v[96:99]
    ds_read_b64_tr_b16 v[44:45], v6 offset:16384
    ds_read_b32 v12, v15 offset:640
    v_mfma_f32_16x16x32_bf16 v[100:103], v[220:223], v[48:51], v[100:103]
    ds_read_b64_tr_b16 v[46:47], v6 offset:17408
    ds_read_b32 v14, v15 offset:704
    v_mfma_f32_16x16x32_bf16 v[104:107], v[216:219], v[52:55], v[104:107]
    ds_read_b64_tr_b16 v[48:49], v3 offset:20480
    v_mfma_f32_16x16x32_bf16 v[108:111], v[220:223], v[52:55], v[108:111]
    ds_read_b64_tr_b16 v[50:51], v3 offset:21504
    s_waitcnt lgkmcnt(14)
    v_mfma_f32_16x16x32_bf16 v[112:115], v[216:219], v[56:59], v[112:115]
    ds_read_b64_tr_b16 v[52:53], v4 offset:20480
    v_mfma_f32_16x16x32_bf16 v[116:119], v[220:223], v[56:59], v[116:119]
    ds_read_b64_tr_b16 v[54:55], v4 offset:21504
    v_mfma_f32_16x16x32_bf16 v[120:123], v[216:219], v[60:63], v[120:123]
    ds_read_b64_tr_b16 v[56:57], v5 offset:20480
    v_mfma_f32_16x16x32_bf16 v[124:127], v[220:223], v[60:63], v[124:127]
    ds_read_b64_tr_b16 v[58:59], v5 offset:21504
    s_waitcnt lgkmcnt(6)
    v_pk_fma_f32 v[100:101], v[8:9], v[24:25], v[100:101] op_sel_hi:[0,1,1] neg_lo:[1,0,0] neg_hi:[1,0,0]
    v_pk_fma_f32 v[102:103], v[8:9], v[26:27], v[102:103] op_sel_hi:[0,1,1] neg_lo:[1,0,0] neg_hi:[1,0,0]
    v_pk_fma_f32 v[108:109], v[10:11], v[24:25], v[108:109] op_sel_hi:[0,1,1] neg_lo:[1,0,0] neg_hi:[1,0,0]
    v_pk_fma_f32 v[110:111], v[10:11], v[26:27], v[110:111] op_sel_hi:[0,1,1] neg_lo:[1,0,0] neg_hi:[1,0,0]
    v_pk_mul_f32 v[100:101], v[28:29], v[100:101]
    v_pk_mul_f32 v[102:103], v[30:31], v[102:103]
    v_pk_mul_f32 v[108:109], v[28:29], v[108:109]
    v_pk_mul_f32 v[110:111], v[30:31], v[110:111]
    v_cvt_pk_bf16_f32 v74, v100, v101
    v_cvt_pk_bf16_f32 v75, v102, v103
    v_cvt_pk_bf16_f32 v78, v108, v109
    v_cvt_pk_bf16_f32 v79, v110, v111
    v_cvt_pk_bf16_f32 v100, v100, v101
    v_cvt_pk_bf16_f32 v101, v102, v103
    v_cvt_pk_bf16_f32 v102, v108, v109
    v_cvt_pk_bf16_f32 v103, v110, v111
    ds_write_b128 v7, v[100:103] offset:6144
    v_pk_fma_f32 v[116:117], v[12:13], v[24:25], v[116:117] op_sel_hi:[0,1,1] neg_lo:[1,0,0] neg_hi:[1,0,0]
    v_pk_fma_f32 v[118:119], v[12:13], v[26:27], v[118:119] op_sel_hi:[0,1,1] neg_lo:[1,0,0] neg_hi:[1,0,0]
    v_pk_fma_f32 v[124:125], v[14:15], v[24:25], v[124:125] op_sel_hi:[0,1,1] neg_lo:[1,0,0] neg_hi:[1,0,0]
    v_pk_fma_f32 v[126:127], v[14:15], v[26:27], v[126:127] op_sel_hi:[0,1,1] neg_lo:[1,0,0] neg_hi:[1,0,0]
    v_pk_mul_f32 v[116:117], v[28:29], v[116:117]
    v_pk_mul_f32 v[118:119], v[30:31], v[118:119]
    v_pk_mul_f32 v[124:125], v[28:29], v[124:125]
    v_pk_mul_f32 v[126:127], v[30:31], v[126:127]
    v_cvt_pk_bf16_f32 v90, v116, v117
    v_cvt_pk_bf16_f32 v91, v118, v119
    v_cvt_pk_bf16_f32 v94, v124, v125
    v_cvt_pk_bf16_f32 v95, v126, v127
    v_cvt_pk_bf16_f32 v116, v116, v117
    v_cvt_pk_bf16_f32 v117, v118, v119
    v_cvt_pk_bf16_f32 v118, v124, v125
    v_cvt_pk_bf16_f32 v119, v126, v127
    ds_write_b128 v7, v[116:119] offset:7168
    s_cmp_lg_u32 s16, 3
    s_cbranch_scc1 a_nh
    buffer_store_dwordx4 v[68:71], v1, s[4:7], s60 offen offset:0 sc1
    buffer_store_dwordx4 v[84:87], v1, s[4:7], s60 offen offset:1024 sc1
    buffer_store_dwordx4 v[100:103], v1, s[4:7], s60 offen offset:2048 sc1
    buffer_store_dwordx4 v[116:119], v1, s[4:7], s60 offen offset:3072 sc1
a_nh:
    v_pk_fma_f32 v[96:97], v[8:9], v[16:17], v[96:97] op_sel_hi:[0,1,1] neg_lo:[1,0,0] neg_hi:[1,0,0]
    v_pk_fma_f32 v[98:99], v[8:9], v[18:19], v[98:99] op_sel_hi:[0,1,1] neg_lo:[1,0,0] neg_hi:[1,0,0]
    v_pk_fma_f32 v[104:105], v[10:11], v[16:17], v[104:105] op_sel_hi:[0,1,1] neg_lo:[1,0,0] neg_hi:[1,0,0]
    v_pk_fma_f32 v[106:107], v[10:11], v[18:19], v[106:107] op_sel_hi:[0,1,1] neg_lo:[1,0,0] neg_hi:[1,0,0]
    v_pk_mul_f32 v[96:97], v[20:21], v[96:97]
    v_pk_mul_f32 v[98:99], v[22:23], v[98:99]
    v_pk_mul_f32 v[104:105], v[20:21], v[104:105]
    v_pk_mul_f32 v[106:107], v[22:23], v[106:107]
    v_cvt_pk_bf16_f32 v72, v96, v97
    v_cvt_pk_bf16_f32 v73, v98, v99
    v_cvt_pk_bf16_f32 v76, v104, v105
    v_cvt_pk_bf16_f32 v77, v106, v107
    v_pk_fma_f32 v[112:113], v[12:13], v[16:17], v[112:113] op_sel_hi:[0,1,1] neg_lo:[1,0,0] neg_hi:[1,0,0]
    v_pk_fma_f32 v[114:115], v[12:13], v[18:19], v[114:115] op_sel_hi:[0,1,1] neg_lo:[1,0,0] neg_hi:[1,0,0]
    v_pk_fma_f32 v[120:121], v[14:15], v[16:17], v[120:121] op_sel_hi:[0,1,1] neg_lo:[1,0,0] neg_hi:[1,0,0]
    v_pk_fma_f32 v[122:123], v[14:15], v[18:19], v[122:123] op_sel_hi:[0,1,1] neg_lo:[1,0,0] neg_hi:[1,0,0]
    v_pk_mul_f32 v[112:113], v[20:21], v[112:113]
    v_pk_mul_f32 v[114:115], v[22:23], v[114:115]
    v_pk_mul_f32 v[120:121], v[20:21], v[120:121]
    v_pk_mul_f32 v[122:123], v[22:23], v[122:123]
    v_cvt_pk_bf16_f32 v88, v112, v113
    v_cvt_pk_bf16_f32 v89, v114, v115
    v_cvt_pk_bf16_f32 v92, v120, v121
    v_cvt_pk_bf16_f32 v93, v122, v123
    v_mfma_f32_16x16x32_bf16 v[128:131], v[32:35], v[224:227], v[128:131]
    ds_read_b64_tr_b16 v[60:61], v6 offset:20480
    v_mfma_f32_16x16x32_bf16 v[132:135], v[32:35], v[228:231], v[132:135]
    ds_read_b64_tr_b16 v[62:63], v6 offset:21504
    v_mfma_f32_16x16x32_bf16 v[136:139], v[36:39], v[224:227], v[136:139]
    ds_read_b64_tr_b16 v[32:33], v3 offset:24576
    v_mfma_f32_16x16x32_bf16 v[140:143], v[36:39], v[228:231], v[140:143]
    ds_read_b64_tr_b16 v[34:35], v3 offset:25600
    v_mfma_f32_16x16x32_bf16 v[144:147], v[40:43], v[224:227], v[144:147]
    ds_read_b64_tr_b16 v[36:37], v4 offset:24576
    v_mfma_f32_16x16x32_bf16 v[148:151], v[40:43], v[228:231], v[148:151]
    ds_read_b64_tr_b16 v[38:39], v4 offset:25600
    v_mfma_f32_16x16x32_bf16 v[152:155], v[44:47], v[224:227], v[152:155]
    ds_read_b64_tr_b16 v[40:41], v5 offset:24576
    v_mfma_f32_16x16x32_bf16 v[156:159], v[44:47], v[228:231], v[156:159]
    ds_read_b64_tr_b16 v[42:43], v5 offset:25600
    s_waitcnt lgkmcnt(12)
    v_mfma_f32_16x16x32_bf16 v[128:131], v[48:51], v[232:235], v[128:131]
    ds_read_b64_tr_b16 v[44:45], v6 offset:24576
    v_mfma_f32_16x16x32_bf16 v[132:135], v[48:51], v[236:239], v[132:135]
    ds_read_b64_tr_b16 v[46:47], v6 offset:25600
    v_mfma_f32_16x16x32_bf16 v[136:139], v[52:55], v[232:235], v[136:139]
    ds_read_b64_tr_b16 v[48:49], v3 offset:28672
    v_mfma_f32_16x16x32_bf16 v[140:143], v[52:55], v[236:239], v[140:143]
    ds_read_b64_tr_b16 v[50:51], v3 offset:29696
    s_waitcnt lgkmcnt(10)
    v_mfma_f32_16x16x32_bf16 v[144:147], v[56:59], v[232:235], v[144:147]
    ds_read_b64_tr_b16 v[52:53], v4 offset:28672
    v_mfma_f32_16x16x32_bf16 v[148:151], v[56:59], v[236:239], v[148:151]
    ds_read_b64_tr_b16 v[54:55], v4 offset:29696
    v_mfma_f32_16x16x32_bf16 v[152:155], v[60:63], v[232:235], v[152:155]
    ds_read_b64_tr_b16 v[56:57], v5 offset:28672
    v_mfma_f32_16x16x32_bf16 v[156:159], v[60:63], v[236:239], v[156:159]
    ds_read_b64_tr_b16 v[58:59], v5 offset:29696
    s_waitcnt lgkmcnt(10)
    v_mfma_f32_16x16x32_bf16 v[128:131], v[32:35], v[240:243], v[128:131]
    ds_read_b64_tr_b16 v[60:61], v6 offset:28672
    v_mfma_f32_16x16x32_bf16 v[132:135], v[32:35], v[244:247], v[132:135]
    ds_read_b64_tr_b16 v[62:63], v6 offset:29696
    s_barrier
    v_mfma_f32_16x16x32_bf16 v[136:139], v[36:39], v[240:243], v[136:139]
    ds_read_b64_tr_b16 v[32:33], v3 offset:32768
    v_mfma_f32_16x16x32_bf16 v[140:143], v[36:39], v[244:247], v[140:143]
    ds_read_b64_tr_b16 v[34:35], v3 offset:33792
    s_waitcnt lgkmcnt(10)
    v_mfma_f32_16x16x32_bf16 v[144:147], v[40:43], v[240:243], v[144:147]
    ds_read_b64_tr_b16 v[36:37], v4 offset:32768
    v_mfma_f32_16x16x32_bf16 v[148:151], v[40:43], v[244:247], v[148:151]
    ds_read_b64_tr_b16 v[38:39], v4 offset:33792
    v_mfma_f32_16x16x32_bf16 v[152:155], v[44:47], v[240:243], v[152:155]
    ds_read_b64_tr_b16 v[40:41], v5 offset:32768
    v_mfma_f32_16x16x32_bf16 v[156:159], v[44:47], v[244:247], v[156:159]
    ds_read_b64_tr_b16 v[42:43], v5 offset:33792
    s_waitcnt lgkmcnt(10)
    v_mfma_f32_16x16x32_bf16 v[128:131], v[48:51], v[248:251], v[128:131]
    ds_read_b64_tr_b16 v[44:45], v6 offset:32768
    v_mfma_f32_16x16x32_bf16 v[132:135], v[48:51], v[252:255], v[132:135]
    ds_read_b64_tr_b16 v[46:47], v6 offset:33792
    v_mfma_f32_16x16x32_bf16 v[136:139], v[52:55], v[248:251], v[136:139]
    ds_read_b64_tr_b16 v[48:49], v3 offset:36864
    v_mfma_f32_16x16x32_bf16 v[140:143], v[52:55], v[252:255], v[140:143]
    ds_read_b64_tr_b16 v[50:51], v3 offset:37888
    s_waitcnt lgkmcnt(10)
    v_mfma_f32_16x16x32_bf16 v[144:147], v[56:59], v[248:251], v[144:147]
    ds_read_b64_tr_b16 v[52:53], v4 offset:36864
    v_mfma_f32_16x16x32_bf16 v[148:151], v[56:59], v[252:255], v[148:151]
    ds_read_b64_tr_b16 v[54:55], v4 offset:37888
    v_mfma_f32_16x16x32_bf16 v[152:155], v[60:63], v[248:251], v[152:155]
    ds_read_b64_tr_b16 v[56:57], v5 offset:36864
    v_mfma_f32_16x16x32_bf16 v[156:159], v[60:63], v[252:255], v[156:159]
    ds_read_b64_tr_b16 v[58:59], v5 offset:37888
    s_waitcnt lgkmcnt(10)
    v_mfma_f32_16x16x32_bf16 v[128:131], v[32:35], v[160:163], v[128:131]
    ds_read_b64_tr_b16 v[60:61], v6 offset:36864
    v_mfma_f32_16x16x32_bf16 v[132:135], v[32:35], v[164:167], v[132:135]
    ds_read_b64_tr_b16 v[62:63], v6 offset:37888
    v_mfma_f32_16x16x32_bf16 v[136:139], v[36:39], v[160:163], v[136:139]
    ds_read_b64_tr_b16 v[32:33], v3 offset:40960
    v_mfma_f32_16x16x32_bf16 v[140:143], v[36:39], v[164:167], v[140:143]
    ds_read_b64_tr_b16 v[34:35], v3 offset:41984
    s_waitcnt lgkmcnt(10)
    v_mfma_f32_16x16x32_bf16 v[144:147], v[40:43], v[160:163], v[144:147]
    ds_read_b64_tr_b16 v[36:37], v4 offset:40960
    v_mfma_f32_16x16x32_bf16 v[148:151], v[40:43], v[164:167], v[148:151]
    ds_read_b64_tr_b16 v[38:39], v4 offset:41984
    v_mfma_f32_16x16x32_bf16 v[152:155], v[44:47], v[160:163], v[152:155]
    ds_read_b64_tr_b16 v[40:41], v5 offset:40960
    v_mfma_f32_16x16x32_bf16 v[156:159], v[44:47], v[164:167], v[156:159]
    ds_read_b64_tr_b16 v[42:43], v5 offset:41984
    s_waitcnt lgkmcnt(10)
    v_mfma_f32_16x16x32_bf16 v[128:131], v[48:51], v[168:171], v[128:131]
    ds_read_b64_tr_b16 v[44:45], v6 offset:40960
    s_cmp_lg_u32 s16, 3
    s_cbranch_scc1 a_nopub
    s_waitcnt vmcnt(0)
    s_atomic_add s40, s[22:23], s61
a_nopub:
    v_mfma_f32_16x16x32_bf16 v[132:135], v[48:51], v[172:175], v[132:135]
    ds_read_b64_tr_b16 v[46:47], v6 offset:41984
    v_mfma_f32_16x16x32_bf16 v[136:139], v[52:55], v[168:171], v[136:139]
    ds_read_b64_tr_b16 v[48:49], v3 offset:45056
    v_mfma_f32_16x16x32_bf16 v[140:143], v[52:55], v[172:175], v[140:143]
    ds_read_b64_tr_b16 v[50:51], v3 offset:46080
    s_waitcnt lgkmcnt(10)
    v_mfma_f32_16x16x32_bf16 v[144:147], v[56:59], v[168:171], v[144:147]
    ds_read_b64_tr_b16 v[52:53], v4 offset:45056
    v_mfma_f32_16x16x32_bf16 v[148:151], v[56:59], v[172:175], v[148:151]
    ds_read_b64_tr_b16 v[54:55], v4 offset:46080
    v_mfma_f32_16x16x32_bf16 v[152:155], v[60:63], v[168:171], v[152:155]
    ds_read_b64_tr_b16 v[56:57], v5 offset:45056
    v_mfma_f32_16x16x32_bf16 v[156:159], v[60:63], v[172:175], v[156:159]
    ds_read_b64_tr_b16 v[58:59], v5 offset:46080
    s_waitcnt lgkmcnt(10)
    v_mfma_f32_16x16x32_bf16 v[128:131], v[32:35], v[176:179], v[128:131]
    ds_read_b64_tr_b16 v[60:61], v6 offset:45056
    v_mfma_f32_16x16x32_bf16 v[132:135], v[32:35], v[180:183], v[132:135]
    ds_read_b64_tr_b16 v[62:63], v6 offset:46080
    v_mfma_f32_16x16x32_bf16 v[136:139], v[36:39], v[176:179], v[136:139]
    ds_read_b64_tr_b16 v[32:33], v3 offset:49152
    v_mfma_f32_16x16x32_bf16 v[140:143], v[36:39], v[180:183], v[140:143]
    ds_read_b64_tr_b16 v[34:35], v3 offset:50176
    s_waitcnt lgkmcnt(10)
    v_mfma_f32_16x16x32_bf16 v[144:147], v[40:43], v[176:179], v[144:147]
    ds_read_b64_tr_b16 v[36:37], v4 offset:49152
    v_mfma_f32_16x16x32_bf16 v[148:151], v[40:43], v[180:183], v[148:151]
    ds_read_b64_tr_b16 v[38:39], v4 offset:50176
    v_mfma_f32_16x16x32_bf16 v[152:155], v[44:47], v[176:179], v[152:155]
    ds_read_b64_tr_b16 v[40:41], v5 offset:49152
    v_mfma_f32_16x16x32_bf16 v[156:159], v[44:47], v[180:183], v[156:159]
    ds_read_b64_tr_b16 v[42:43], v5 offset:50176
    s_waitcnt lgkmcnt(10)
    v_mfma_f32_16x16x32_bf16 v[128:131], v[48:51], v[184:187], v[128:131]
    ds_read_b64_tr_b16 v[44:45], v6 offset:49152
    ds_read_b32 v8, v9 offset:4096
    v_mfma_f32_16x16x32_bf16 v[132:135], v[48:51], v[188:191], v[132:135]
    ds_read_b64_tr_b16 v[46:47], v6 offset:50176
    ds_read_b32 v10, v9 offset:4608
    v_mfma_f32_16x16x32_bf16 v[136:139], v[52:55], v[184:187], v[136:139]
    ds_read_b64_tr_b16 v[48:49], v3 offset:53248
    ds_read_b32 v12, v9 offset:4160
    v_mfma_f32_16x16x32_bf16 v[140:143], v[52:55], v[188:191], v[140:143]
    ds_read_b64_tr_b16 v[50:51], v3 offset:54272
    ds_read_b32 v14, v9 offset:4672
    s_waitcnt lgkmcnt(14)
    v_mfma_f32_16x16x32_bf16 v[144:147], v[56:59], v[184:187], v[144:147]
    ds_read_b64_tr_b16 v[52:53], v4 offset:53248
    ds_read_b128 v[16:19], v11 offset:0
    v_mfma_f32_16x16x32_bf16 v[148:151], v[56:59], v[188:191], v[148:151]
    ds_read_b64_tr_b16 v[54:55], v4 offset:54272
    ds_read_b128 v[20:23], v11 offset:64
    v_mfma_f32_16x16x32_bf16 v[152:155], v[60:63], v[184:187], v[152:155]
    ds_read_b64_tr_b16 v[56:57], v5 offset:53248
    ds_read_b128 v[24:27], v11 offset:128
    v_mfma_f32_16x16x32_bf16 v[156:159], v[60:63], v[188:191], v[156:159]
    ds_read_b64_tr_b16 v[58:59], v5 offset:54272
    ds_read_b128 v[28:31], v11 offset:192
    s_waitcnt lgkmcnt(14)
    v_mfma_f32_16x16x32_bf16 v[128:131], v[32:35], v[192:195], v[128:131]
    ds_read_b64_tr_b16 v[60:61], v6 offset:53248
    v_add_u32 v13, 153600, v1
    v_mfma_f32_16x16x32_bf16 v[132:135], v[32:35], v[196:199], v[132:135]
    ds_read_b64_tr_b16 v[62:63], v6 offset:54272
    v_mfma_f32_16x16x32_bf16 v[136:139], v[36:39], v[192:195], v[136:139]
    ds_read_b64_tr_b16 v[32:33], v3 offset:57344
    v_mfma_f32_16x16x32_bf16 v[140:143], v[36:39], v[196:199], v[140:143]
    ds_read_b64_tr_b16 v[34:35], v3 offset:58368
    s_waitcnt lgkmcnt(14)
    v_mfma_f32_16x16x32_bf16 v[144:147], v[40:43], v[192:195], v[144:147]
    ds_read_b64_tr_b16 v[36:37], v4 offset:57344
    v_mfma_f32_16x16x32_bf16 v[148:151], v[40:43], v[196:199], v[148:151]
    ds_read_b64_tr_b16 v[38:39], v4 offset:58368
    v_mfma_f32_16x16x32_bf16 v[152:155], v[44:47], v[192:195], v[152:155]
    ds_read_b64_tr_b16 v[40:41], v5 offset:57344
    v_mfma_f32_16x16x32_bf16 v[156:159], v[44:47], v[196:199], v[156:159]
    ds_read_b64_tr_b16 v[42:43], v5 offset:58368
    s_waitcnt lgkmcnt(13)
    v_mfma_f32_16x16x32_bf16 v[128:131], v[48:51], v[200:203], v[128:131]
    ds_read_b64_tr_b16 v[44:45], v6 offset:57344
    s_waitcnt lgkmcnt(9)
    v_mfma_f32_16x16x32_bf16 v[132:135], v[48:51], v[204:207], v[132:135]
    ds_read_b64_tr_b16 v[46:47], v6 offset:58368
    v_mul_f32 v10, 0x3e8293ee, v10
    v_mfma_f32_16x16x32_bf16 v[136:139], v[52:55], v[200:203], v[136:139]
    ds_read_b64_tr_b16 v[48:49], v3 offset:61440
    v_mul_f32 v14, 0x3e8293ee, v14
    v_mfma_f32_16x16x32_bf16 v[140:143], v[52:55], v[204:207], v[140:143]
    ds_read_b64_tr_b16 v[50:51], v3 offset:62464
    ds_read_b128 v[120:123], v13 offset:0
    s_waitcnt lgkmcnt(11)
    v_mfma_f32_16x16x32_bf16 v[144:147], v[56:59], v[200:203], v[144:147]
    ds_read_b64_tr_b16 v[52:53], v4 offset:61440
    ds_read_b128 v[124:127], v13 offset:1024
    v_mfma_f32_16x16x32_bf16 v[148:151], v[56:59], v[204:207], v[148:151]
    ds_read_b64_tr_b16 v[54:55], v4 offset:62464
    v_mfma_f32_16x16x32_bf16 v[152:155], v[60:63], v[200:203], v[152:155]
    ds_read_b64_tr_b16 v[56:57], v5 offset:61440
    v_mfma_f32_16x16x32_bf16 v[156:159], v[60:63], v[204:207], v[156:159]
    ds_read_b64_tr_b16 v[58:59], v5 offset:62464
    s_waitcnt lgkmcnt(12)
    v_mfma_f32_16x16x32_bf16 v[128:131], v[32:35], v[208:211], v[128:131]
    ds_read_b64_tr_b16 v[60:61], v6 offset:61440
    v_mfma_f32_16x16x32_bf16 v[132:135], v[32:35], v[212:215], v[132:135]
    ds_read_b64_tr_b16 v[62:63], v6 offset:62464
    v_xor_b32 v3, 0x10000, v3
    v_xor_b32 v4, 0x10000, v4
    v_xor_b32 v5, 0x10000, v5
    v_xor_b32 v6, 0x10000, v6
    v_mfma_f32_16x16x32_bf16 v[136:139], v[36:39], v[208:211], v[136:139]
    v_mfma_f32_16x16x32_bf16 v[140:143], v[36:39], v[212:215], v[140:143]
    s_waitcnt lgkmcnt(10)
    v_mfma_f32_16x16x32_bf16 v[144:147], v[40:43], v[208:211], v[144:147]
    v_mfma_f32_16x16x32_bf16 v[148:151], v[40:43], v[212:215], v[148:151]
    v_mfma_f32_16x16x32_bf16 v[152:155], v[44:47], v[208:211], v[152:155]
    v_mfma_f32_16x16x32_bf16 v[156:159], v[44:47], v[212:215], v[156:159]
    s_waitcnt lgkmcnt(4)
    v_mfma_f32_16x16x32_bf16 v[128:131], v[48:51], v[216:219], v[128:131]
    v_mfma_f32_16x16x32_bf16 v[132:135], v[48:51], v[220:223], v[132:135]
    v_mfma_f32_16x16x32_bf16 v[136:139], v[52:55], v[216:219], v[136:139]
    v_mfma_f32_16x16x32_bf16 v[140:143], v[52:55], v[220:223], v[140:143]
    s_waitcnt lgkmcnt(0)
    v_mfma_f32_16x16x32_bf16 v[144:147], v[56:59], v[216:219], v[144:147]
    v_mfma_f32_16x16x32_bf16 v[148:151], v[56:59], v[220:223], v[148:151]
    v_mfma_f32_16x16x32_bf16 v[152:155], v[60:63], v[216:219], v[152:155]
    v_mfma_f32_16x16x32_bf16 v[156:159], v[60:63], v[220:223], v[156:159]
    s_lshl_b32 s44, s21, 22
    s_lshl_b32 s45, s38, 16
    s_add_u32 s44, s44, s45
    s_lshl_b32 s45, s18, 12
    s_add_u32 s44, s44, s45
    s_add_u32 s52, s44, 16777216
    v_pk_fma_f32 v[132:133], v[12:13], v[16:17], v[132:133] op_sel_hi:[0,1,1] neg_lo:[1,0,0] neg_hi:[1,0,0]
    v_pk_fma_f32 v[134:135], v[12:13], v[18:19], v[134:135] op_sel_hi:[0,1,1] neg_lo:[1,0,0] neg_hi:[1,0,0]
    v_pk_fma_f32 v[140:141], v[12:13], v[20:21], v[140:141] op_sel_hi:[0,1,1] neg_lo:[1,0,0] neg_hi:[1,0,0]
    v_pk_fma_f32 v[142:143], v[12:13], v[22:23], v[142:143] op_sel_hi:[0,1,1] neg_lo:[1,0,0] neg_hi:[1,0,0]
    v_pk_fma_f32 v[148:149], v[12:13], v[24:25], v[148:149] op_sel_hi:[0,1,1] neg_lo:[1,0,0] neg_hi:[1,0,0]
    v_pk_fma_f32 v[150:151], v[12:13], v[26:27], v[150:151] op_sel_hi:[0,1,1] neg_lo:[1,0,0] neg_hi:[1,0,0]
    v_pk_fma_f32 v[156:157], v[12:13], v[28:29], v[156:157] op_sel_hi:[0,1,1] neg_lo:[1,0,0] neg_hi:[1,0,0]
    v_pk_fma_f32 v[158:159], v[12:13], v[30:31], v[158:159] op_sel_hi:[0,1,1] neg_lo:[1,0,0] neg_hi:[1,0,0]
    v_pk_mul_f32 v[132:133], v[14:15], v[132:133] op_sel_hi:[0,1]
    v_pk_mul_f32 v[134:135], v[14:15], v[134:135] op_sel_hi:[0,1]
    v_pk_mul_f32 v[140:141], v[14:15], v[140:141] op_sel_hi:[0,1]
    v_pk_mul_f32 v[142:143], v[14:15], v[142:143] op_sel_hi:[0,1]
    v_pk_mul_f32 v[148:149], v[14:15], v[148:149] op_sel_hi:[0,1]
    v_pk_mul_f32 v[150:151], v[14:15], v[150:151] op_sel_hi:[0,1]
    v_pk_mul_f32 v[156:157], v[14:15], v[156:157] op_sel_hi:[0,1]
    v_pk_mul_f32 v[158:159], v[14:15], v[158:159] op_sel_hi:[0,1]
    v_cvt_pk_bf16_f32 v132, v132, v133
    v_cvt_pk_bf16_f32 v133, v134, v135
    v_cvt_pk_bf16_f32 v134, v140, v141
    v_cvt_pk_bf16_f32 v135, v142, v143
    v_cvt_pk_bf16_f32 v148, v148, v149
    v_cvt_pk_bf16_f32 v149, v150, v151
    v_cvt_pk_bf16_f32 v150, v156, v157
    v_cvt_pk_bf16_f32 v151, v158, v159
    v_mfma_f32_16x16x32_bf16 v[172:175], v[68:71], v[132:135], v[120:123]
    v_mfma_f32_16x16x32_bf16 v[168:171], v[64:67], v[132:135], v[124:127]
    v_mfma_f32_16x16x32_bf16 v[188:191], v[84:87], v[148:151], v[120:123]
    v_mfma_f32_16x16x32_bf16 v[184:187], v[80:83], v[148:151], v[124:127]
    v_pk_fma_f32 v[128:129], v[8:9], v[16:17], v[128:129] op_sel_hi:[0,1,1] neg_lo:[1,0,0] neg_hi:[1,0,0]
    v_pk_fma_f32 v[130:131], v[8:9], v[18:19], v[130:131] op_sel_hi:[0,1,1] neg_lo:[1,0,0] neg_hi:[1,0,0]
    v_pk_fma_f32 v[136:137], v[8:9], v[20:21], v[136:137] op_sel_hi:[0,1,1] neg_lo:[1,0,0] neg_hi:[1,0,0]
    v_pk_fma_f32 v[138:139], v[8:9], v[22:23], v[138:139] op_sel_hi:[0,1,1] neg_lo:[1,0,0] neg_hi:[1,0,0]
    v_pk_fma_f32 v[144:145], v[8:9], v[24:25], v[144:145] op_sel_hi:[0,1,1] neg_lo:[1,0,0] neg_hi:[1,0,0]
    v_pk_fma_f32 v[146:147], v[8:9], v[26:27], v[146:147] op_sel_hi:[0,1,1] neg_lo:[1,0,0] neg_hi:[1,0,0]
    v_pk_fma_f32 v[152:153], v[8:9], v[28:29], v[152:153] op_sel_hi:[0,1,1] neg_lo:[1,0,0] neg_hi:[1,0,0]
    v_pk_fma_f32 v[154:155], v[8:9], v[30:31], v[154:155] op_sel_hi:[0,1,1] neg_lo:[1,0,0] neg_hi:[1,0,0]
    v_pk_mul_f32 v[128:129], v[10:11], v[128:129] op_sel_hi:[0,1]
    v_pk_mul_f32 v[130:131], v[10:11], v[130:131] op_sel_hi:[0,1]
    v_pk_mul_f32 v[136:137], v[10:11], v[136:137] op_sel_hi:[0,1]
    v_pk_mul_f32 v[138:139], v[10:11], v[138:139] op_sel_hi:[0,1]
    v_pk_mul_f32 v[144:145], v[10:11], v[144:145] op_sel_hi:[0,1]
    v_pk_mul_f32 v[146:147], v[10:11], v[146:147] op_sel_hi:[0,1]
    v_pk_mul_f32 v[152:153], v[10:11], v[152:153] op_sel_hi:[0,1]
    v_pk_mul_f32 v[154:155], v[10:11], v[154:155] op_sel_hi:[0,1]
    v_cvt_pk_bf16_f32 v128, v128, v129
    v_cvt_pk_bf16_f32 v129, v130, v131
    v_cvt_pk_bf16_f32 v130, v136, v137
    v_cvt_pk_bf16_f32 v131, v138, v139
    v_cvt_pk_bf16_f32 v144, v144, v145
    v_cvt_pk_bf16_f32 v145, v146, v147
    v_cvt_pk_bf16_f32 v146, v152, v153
    v_cvt_pk_bf16_f32 v147, v154, v155
    v_mfma_f32_16x16x32_bf16 v[164:167], v[64:67], v[128:131], v[120:123]
    s_nop 0
    v_mfma_f32_16x16x32_bf16 v[180:183], v[80:83], v[144:147], v[120:123]
    v_mov_b32 v232, 0x3f803f80
    v_mov_b32 v233, 0x3f803f80
    v_mov_b32 v234, 0x3f803f80
    v_mov_b32 v235, 0x3f803f80
    v_exp_f32 v172, v172
    v_exp_f32 v173, v173
    v_exp_f32 v174, v174
    v_exp_f32 v175, v175
    v_exp_f32 v188, v188
    v_exp_f32 v189, v189
    v_exp_f32 v190, v190
    v_exp_f32 v191, v191
    s_mov_b32 s46, 1006632960
a_exp1:
    v_exp_f32 v168, v168
    v_exp_f32 v169, v169
    v_exp_f32 v170, v170
    v_exp_f32 v171, v171
    v_exp_f32 v184, v184
    v_exp_f32 v185, v185
    v_exp_f32 v186, v186
    v_exp_f32 v187, v187
    v_cvt_pk_bf16_f32 v200, v168, v169
    v_cvt_pk_bf16_f32 v201, v170, v171
    v_cvt_pk_bf16_f32 v202, v172, v173
    v_cvt_pk_bf16_f32 v203, v174, v175
    v_cvt_pk_bf16_f32 v204, v184, v185
    v_cvt_pk_bf16_f32 v205, v186, v187
    v_cvt_pk_bf16_f32 v206, v188, v189
    v_cvt_pk_bf16_f32 v207, v190, v191
    v_mfma_f32_16x16x32_bf16 v[16:19], v[232:235], v[200:203], 0
    s_nop 0
    v_mfma_f32_16x16x32_bf16 v[20:23], v[232:235], v[204:207], 0
    v_mfma_f32_16x16x32_bf16 v[40:43], v[72:75], v[200:203], 0
    v_mfma_f32_16x16x32_bf16 v[44:47], v[76:79], v[200:203], 0
    v_mfma_f32_16x16x32_bf16 v[56:59], v[88:91], v[204:207], 0
    v_mfma_f32_16x16x32_bf16 v[60:63], v[92:95], v[204:207], 0
    v_mov_b32 v218, v72
    v_mov_b32 v219, v73
    v_mov_b32 v222, v76
    v_mov_b32 v223, v77
    v_mov_b32 v226, v88
    v_mov_b32 v227, v89
    v_mov_b32 v230, v92
    v_mov_b32 v231, v93
    v_subrev_u32 v18, 0x21800000, v16
    v_subrev_u32 v22, 0x21800000, v20
    v_max_u32 v18, v18, v22
    v_cmp_le_u32 vcc, s46, v18
    v_rcp_f32 v16, v16
    v_rcp_f32 v20, v20
    s_cbranch_vccnz a_slow1
a_fin1:
    v_pk_mul_f32 v[40:41], v[16:17], v[40:41] op_sel_hi:[0,1]
    v_pk_mul_f32 v[42:43], v[16:17], v[42:43] op_sel_hi:[0,1]
    v_pk_mul_f32 v[44:45], v[16:17], v[44:45] op_sel_hi:[0,1]
    v_pk_mul_f32 v[46:47], v[16:17], v[46:47] op_sel_hi:[0,1]
    v_pk_mul_f32 v[56:57], v[20:21], v[56:57] op_sel_hi:[0,1]
    v_pk_mul_f32 v[58:59], v[20:21], v[58:59] op_sel_hi:[0,1]
    v_pk_mul_f32 v[60:61], v[20:21], v[60:61] op_sel_hi:[0,1]
    v_pk_mul_f32 v[62:63], v[20:21], v[62:63] op_sel_hi:[0,1]
    v_cvt_pk_bf16_f32 v40, v40, v41
    v_cvt_pk_bf16_f32 v41, v42, v43
    v_cvt_pk_bf16_f32 v42, v44, v45
    v_cvt_pk_bf16_f32 v43, v46, v47
    v_cvt_pk_bf16_f32 v56, v56, v57
    v_cvt_pk_bf16_f32 v57, v58, v59
    v_cvt_pk_bf16_f32 v58, v60, v61
    v_cvt_pk_bf16_f32 v59, v62, v63
    v_permlane32_swap_b32 v40, v42
    v_permlane32_swap_b32 v41, v43
    buffer_store_dwordx4 v[40:43], v2, s[4:7], s52 offen offset:256 sc1
    v_permlane32_swap_b32 v56, v58
    v_permlane32_swap_b32 v57, v59
    buffer_store_dwordx4 v[56:59], v2, s[4:7], s52 offen offset:2304 sc1
    s_cmp_lg_u32 s38, 0
    s_cbranch_scc1 a_hasprev
    v_mov_b32 v124, 0xf149f2ca
    v_mov_b32 v125, 0xf149f2ca
    v_mov_b32 v126, 0xf149f2ca
    v_mov_b32 v127, 0xf149f2ca
a_hasprev:
    s_waitcnt lgkmcnt(0)
    s_barrier
    ds_read_b128 v[192:195], v7 offset:0
    ds_read_b128 v[196:199], v7 offset:1024
    ds_read_b64 v[216:217], v7 offset:2048
    ds_read_b64 v[220:221], v7 offset:2056
    ds_read_b64 v[224:225], v7 offset:3072
    ds_read_b64 v[228:229], v7 offset:3080
    s_waitcnt lgkmcnt(4)
    v_mfma_f32_16x16x32_bf16 v[160:163], v[192:195], v[128:131], v[124:127]
    v_mfma_f32_16x16x32_bf16 v[176:179], v[196:199], v[144:147], v[124:127]
    v_exp_f32 v164, v164
    v_exp_f32 v165, v165
    v_exp_f32 v166, v166
    v_exp_f32 v167, v167
    v_exp_f32 v180, v180
    v_exp_f32 v181, v181
    v_exp_f32 v182, v182
    v_exp_f32 v183, v183
    s_waitcnt lgkmcnt(0)
    s_mov_b32 s46, 1006632960
a_exp0:
    v_exp_f32 v160, v160
    v_exp_f32 v161, v161
    v_exp_f32 v162, v162
    v_exp_f32 v163, v163
    v_exp_f32 v176, v176
    v_exp_f32 v177, v177
    v_exp_f32 v178, v178
    v_exp_f32 v179, v179
    v_cvt_pk_bf16_f32 v200, v160, v161
    v_cvt_pk_bf16_f32 v201, v162, v163
    v_cvt_pk_bf16_f32 v202, v164, v165
    v_cvt_pk_bf16_f32 v203, v166, v167
    v_cvt_pk_bf16_f32 v204, v176, v177
    v_cvt_pk_bf16_f32 v205, v178, v179
    v_cvt_pk_bf16_f32 v206, v180, v181
    v_cvt_pk_bf16_f32 v207, v182, v183
    v_mfma_f32_16x16x32_bf16 v[16:19], v[232:235], v[200:203], 0
    s_nop 0
    v_mfma_f32_16x16x32_bf16 v[20:23], v[232:235], v[204:207], 0
    v_mfma_f32_16x16x32_bf16 v[32:35], v[216:219], v[200:203], 0
    v_mfma_f32_16x16x32_bf16 v[36:39], v[220:223], v[200:203], 0
    v_mfma_f32_16x16x32_bf16 v[48:51], v[224:227], v[204:207], 0
    v_mfma_f32_16x16x32_bf16 v[52:55], v[228:231], v[204:207], 0
    s_nop 1
    v_subrev_u32 v18, 0x21800000, v16
    s_nop 0
    v_subrev_u32 v22, 0x21800000, v20
    v_max_u32 v18, v18, v22
    v_cmp_le_u32 vcc, s46, v18
    v_rcp_f32 v16, v16
    v_rcp_f32 v20, v20
    s_cbranch_vccnz a_slow0
a_fin0:
    v_pk_mul_f32 v[32:33], v[16:17], v[32:33] op_sel_hi:[0,1]
    v_pk_mul_f32 v[34:35], v[16:17], v[34:35] op_sel_hi:[0,1]
    v_pk_mul_f32 v[36:37], v[16:17], v[36:37] op_sel_hi:[0,1]
    v_pk_mul_f32 v[38:39], v[16:17], v[38:39] op_sel_hi:[0,1]
    v_pk_mul_f32 v[48:49], v[20:21], v[48:49] op_sel_hi:[0,1]
    v_pk_mul_f32 v[50:51], v[20:21], v[50:51] op_sel_hi:[0,1]
    v_pk_mul_f32 v[52:53], v[20:21], v[52:53] op_sel_hi:[0,1]
    v_pk_mul_f32 v[54:55], v[20:21], v[54:55] op_sel_hi:[0,1]
    v_cvt_pk_bf16_f32 v32, v32, v33
    v_cvt_pk_bf16_f32 v33, v34, v35
    v_cvt_pk_bf16_f32 v34, v36, v37
    v_cvt_pk_bf16_f32 v35, v38, v39
    v_cvt_pk_bf16_f32 v48, v48, v49
    v_cvt_pk_bf16_f32 v49, v50, v51
    v_cvt_pk_bf16_f32 v50, v52, v53
    v_cvt_pk_bf16_f32 v51, v54, v55
    v_permlane32_swap_b32 v32, v34
    v_permlane32_swap_b32 v33, v35
    buffer_store_dwordx4 v[32:35], v2, s[4:7], s52 offen offset:0 sc1
    v_permlane32_swap_b32 v48, v50
    v_permlane32_swap_b32 v49, v51
    buffer_store_dwordx4 v[48:51], v2, s[4:7], s52 offen offset:2048 sc1
    s_lshl_b32 s44, s21, 22
    s_lshl_b32 s45, s38, 16
    s_add_u32 s41, s44, s45
    s_lshl_b32 s45, s18, 12
    s_add_u32 s43, s41, s45
    s_and_b32 s45, s45, 0
    s_add_u32 s41, s41, s45
    s_add_u32 s41, s41, 16777216
    buffer_load_dwordx4 v[224:227], v2, s[4:7], s43 offen offset:0 sc1
    buffer_load_dwordx4 v[228:231], v2, s[4:7], s43 offen offset:256 sc1
    buffer_load_dwordx4 v[232:235], v2, s[4:7], s43 offen offset:2048 sc1
    buffer_load_dwordx4 v[236:239], v2, s[4:7], s43 offen offset:2304 sc1
    s_barrier
    s_lshl_b32 s47, s21, 14
    s_lshl_b32 s67, s38, 8
    s_add_u32 s47, s47, s67
    s_add_u32 s47, s47, 86144
    s_mov_b32 s68, 1
    s_waitcnt vmcnt(4)
    s_atomic_add s68, s[22:23], s47 glc
    s_mov_b32 s66, 0x10000
    s_waitcnt lgkmcnt(0)
    s_cmp_eq_u32 s68, 15
    s_cbranch_scc1 c_o_ok
c_o_poll:
    s_mov_b32 s68, 0
    s_atomic_add s68, s[22:23], s47 offset:0 glc
    s_sub_u32 s66, s66, 1
    s_cselect_b32 s67, 16, 0
    s_waitcnt lgkmcnt(0)
    s_max_u32 s68, s68, s67
    s_cmp_lt_u32 s68, 16
    s_cbranch_scc1 c_o_poll
c_o_ok:
    s_branch c_wo
a_slow1:
    s_cmp_eq_u32 s46, 0
    s_cbranch_scc1 a_fin1
    s_mov_b32 s46, 0
    v_mfma_f32_16x16x32_bf16 v[172:175], v[68:71], v[132:135], v[120:123]
    v_mfma_f32_16x16x32_bf16 v[168:171], v[64:67], v[132:135], v[124:127]
    v_mfma_f32_16x16x32_bf16 v[188:191], v[84:87], v[148:151], v[120:123]
    v_mfma_f32_16x16x32_bf16 v[184:187], v[80:83], v[148:151], v[124:127]
    s_nop 5
    v_max3_f32 v24, v168, v169, v170
    v_max3_f32 v24, v24, v171, v172
    v_max3_f32 v24, v24, v173, v174
    v_max_f32 v24, v24, v175
    v_max3_f32 v26, v184, v185, v186
    v_max3_f32 v26, v26, v187, v188
    v_max3_f32 v26, v26, v189, v190
    v_max_f32 v26, v26, v191
    v_mov_b32 v25, v24
    v_mov_b32 v27, v26
    s_nop 0
    v_permlane32_swap_b32 v24, v25
    v_permlane32_swap_b32 v26, v27
    v_max_f32 v24, v24, v25
    v_max_f32 v26, v26, v27
    v_mov_b32 v25, v24
    v_mov_b32 v27, v26
    s_nop 0
    v_permlane16_swap_b32 v24, v25
    v_permlane16_swap_b32 v26, v27
    v_max_f32 v24, v24, v25
    v_max_f32 v26, v26, v27
    v_sub_f32 v168, v168, v24
    v_sub_f32 v169, v169, v24
    v_sub_f32 v170, v170, v24
    v_sub_f32 v171, v171, v24
    v_sub_f32 v172, v172, v24
    v_sub_f32 v173, v173, v24
    v_sub_f32 v174, v174, v24
    v_sub_f32 v175, v175, v24
    v_sub_f32 v184, v184, v26
    v_sub_f32 v185, v185, v26
    v_sub_f32 v186, v186, v26
    v_sub_f32 v187, v187, v26
    v_sub_f32 v188, v188, v26
    v_sub_f32 v189, v189, v26
    v_sub_f32 v190, v190, v26
    v_sub_f32 v191, v191, v26
    v_exp_f32 v172, v172
    v_exp_f32 v173, v173
    v_exp_f32 v174, v174
    v_exp_f32 v175, v175
    v_exp_f32 v188, v188
    v_exp_f32 v189, v189
    v_exp_f32 v190, v190
    v_exp_f32 v191, v191
    s_branch a_exp1
a_slow0:
    s_cmp_eq_u32 s46, 0
    s_cbranch_scc1 a_fin0
    s_mov_b32 s46, 0
    v_mfma_f32_16x16x32_bf16 v[164:167], v[64:67], v[128:131], v[120:123]
    v_mfma_f32_16x16x32_bf16 v[160:163], v[192:195], v[128:131], v[124:127]
    v_mfma_f32_16x16x32_bf16 v[180:183], v[80:83], v[144:147], v[120:123]
    v_mfma_f32_16x16x32_bf16 v[176:179], v[196:199], v[144:147], v[124:127]
    s_nop 5
    v_max3_f32 v24, v160, v161, v162
    v_max3_f32 v24, v24, v163, v164
    v_max3_f32 v24, v24, v165, v166
    v_max_f32 v24, v24, v167
    v_max3_f32 v26, v176, v177, v178
    v_max3_f32 v26, v26, v179, v180
    v_max3_f32 v26, v26, v181, v182
    v_max_f32 v26, v26, v183
    v_mov_b32 v25, v24
    v_mov_b32 v27, v26
    s_nop 0
    v_permlane32_swap_b32 v24, v25
    v_permlane32_swap_b32 v26, v27
    v_max_f32 v24, v24, v25
    v_max_f32 v26, v26, v27
    v_mov_b32 v25, v24
    v_mov_b32 v27, v26
    s_nop 0
    v_permlane16_swap_b32 v24, v25
    v_permlane16_swap_b32 v26, v27
    v_max_f32 v24, v24, v25
    v_max_f32 v26, v26, v27
    v_sub_f32 v160, v160, v24
    v_sub_f32 v161, v161, v24
    v_sub_f32 v162, v162, v24
    v_sub_f32 v163, v163, v24
    v_sub_f32 v164, v164, v24
    v_sub_f32 v165, v165, v24
    v_sub_f32 v166, v166, v24
    v_sub_f32 v167, v167, v24
    v_sub_f32 v176, v176, v26
    v_sub_f32 v177, v177, v26
    v_sub_f32 v178, v178, v26
    v_sub_f32 v179, v179, v26
    v_sub_f32 v180, v180, v26
    v_sub_f32 v181, v181, v26
    v_sub_f32 v182, v182, v26
    v_sub_f32 v183, v183, v26
    v_exp_f32 v164, v164
    v_exp_f32 v165, v165
    v_exp_f32 v166, v166
    v_exp_f32 v167, v167
    v_exp_f32 v180, v180
    v_exp_f32 v181, v181
    v_exp_f32 v182, v182
    v_exp_f32 v183, v183
    s_branch a_exp0
c_B:
    s_waitcnt lgkmcnt(6)
    v_pk_fma_f32 v[64:65], v[8:9], v[16:17], v[64:65] op_sel_hi:[0,1,1] neg_lo:[1,0,0] neg_hi:[1,0,0]
    v_pk_fma_f32 v[66:67], v[8:9], v[18:19], v[66:67] op_sel_hi:[0,1,1] neg_lo:[1,0,0] neg_hi:[1,0,0]
    v_pk_fma_f32 v[72:73], v[8:9], v[20:21], v[72:73] op_sel_hi:[0,1,1] neg_lo:[1,0,0] neg_hi:[1,0,0]
    v_pk_fma_f32 v[74:75], v[8:9], v[22:23], v[74:75] op_sel_hi:[0,1,1] neg_lo:[1,0,0] neg_hi:[1,0,0]
    v_pk_mul_f32 v[64:65], v[10:11], v[64:65] op_sel_hi:[0,1]
    v_pk_mul_f32 v[66:67], v[10:11], v[66:67] op_sel_hi:[0,1]
    v_pk_mul_f32 v[72:73], v[10:11], v[72:73] op_sel_hi:[0,1]
    v_pk_mul_f32 v[74:75], v[10:11], v[74:75] op_sel_hi:[0,1]
    v_cvt_pk_bf16_f32 v64, v64, v65
    v_cvt_pk_bf16_f32 v65, v66, v67
    v_cvt_pk_bf16_f32 v66, v72, v73
    v_cvt_pk_bf16_f32 v67, v74, v75
    s_add_u32 s55, s52, 0
    buffer_store_dwordx4 v[64:67], v2, s[4:7], s55 offen offset:0 sc1
    v_pk_fma_f32 v[68:69], v[12:13], v[16:17], v[68:69] op_sel_hi:[0,1,1] neg_lo:[1,0,0] neg_hi:[1,0,0]
    v_pk_fma_f32 v[70:71], v[12:13], v[18:19], v[70:71] op_sel_hi:[0,1,1] neg_lo:[1,0,0] neg_hi:[1,0,0]
    v_pk_fma_f32 v[76:77], v[12:13], v[20:21], v[76:77] op_sel_hi:[0,1,1] neg_lo:[1,0,0] neg_hi:[1,0,0]
    v_pk_fma_f32 v[78:79], v[12:13], v[22:23], v[78:79] op_sel_hi:[0,1,1] neg_lo:[1,0,0] neg_hi:[1,0,0]
    v_pk_mul_f32 v[68:69], v[14:15], v[68:69] op_sel_hi:[0,1]
    v_pk_mul_f32 v[70:71], v[14:15], v[70:71] op_sel_hi:[0,1]
    v_pk_mul_f32 v[76:77], v[14:15], v[76:77] op_sel_hi:[0,1]
    v_pk_mul_f32 v[78:79], v[14:15], v[78:79] op_sel_hi:[0,1]
    v_cvt_pk_bf16_f32 v68, v68, v69
    v_cvt_pk_bf16_f32 v69, v70, v71
    v_cvt_pk_bf16_f32 v70, v76, v77
    v_cvt_pk_bf16_f32 v71, v78, v79
    buffer_store_dwordx4 v[68:71], v2, s[4:7], s55 offen offset:256 sc1
    v_pk_fma_f32 v[80:81], v[8:9], v[24:25], v[80:81] op_sel_hi:[0,1,1] neg_lo:[1,0,0] neg_hi:[1,0,0]
    v_pk_fma_f32 v[82:83], v[8:9], v[26:27], v[82:83] op_sel_hi:[0,1,1] neg_lo:[1,0,0] neg_hi:[1,0,0]
    v_pk_fma_f32 v[88:89], v[8:9], v[28:29], v[88:89] op_sel_hi:[0,1,1] neg_lo:[1,0,0] neg_hi:[1,0,0]
    v_pk_fma_f32 v[90:91], v[8:9], v[30:31], v[90:91] op_sel_hi:[0,1,1] neg_lo:[1,0,0] neg_hi:[1,0,0]
    v_pk_mul_f32 v[80:81], v[10:11], v[80:81] op_sel_hi:[0,1]
    v_pk_mul_f32 v[82:83], v[10:11], v[82:83] op_sel_hi:[0,1]
    v_pk_mul_f32 v[88:89], v[10:11], v[88:89] op_sel_hi:[0,1]
    v_pk_mul_f32 v[90:91], v[10:11], v[90:91] op_sel_hi:[0,1]
    v_cvt_pk_bf16_f32 v80, v80, v81
    v_cvt_pk_bf16_f32 v81, v82, v83
    v_cvt_pk_bf16_f32 v82, v88, v89
    v_cvt_pk_bf16_f32 v83, v90, v91
    s_add_u32 s55, s52, 131072
    buffer_store_dwordx4 v[80:83], v2, s[4:7], s55 offen offset:0 sc1
    v_pk_fma_f32 v[84:85], v[12:13], v[24:25], v[84:85] op_sel_hi:[0,1,1] neg_lo:[1,0,0] neg_hi:[1,0,0]
    v_pk_fma_f32 v[86:87], v[12:13], v[26:27], v[86:87] op_sel_hi:[0,1,1] neg_lo:[1,0,0] neg_hi:[1,0,0]
    v_pk_fma_f32 v[92:93], v[12:13], v[28:29], v[92:93] op_sel_hi:[0,1,1] neg_lo:[1,0,0] neg_hi:[1,0,0]
    v_pk_fma_f32 v[94:95], v[12:13], v[30:31], v[94:95] op_sel_hi:[0,1,1] neg_lo:[1,0,0] neg_hi:[1,0,0]
    v_pk_mul_f32 v[84:85], v[14:15], v[84:85] op_sel_hi:[0,1]
    v_pk_mul_f32 v[86:87], v[14:15], v[86:87] op_sel_hi:[0,1]
    v_pk_mul_f32 v[92:93], v[14:15], v[92:93] op_sel_hi:[0,1]
    v_pk_mul_f32 v[94:95], v[14:15], v[94:95] op_sel_hi:[0,1]
    v_cvt_pk_bf16_f32 v84, v84, v85
    v_cvt_pk_bf16_f32 v85, v86, v87
    v_cvt_pk_bf16_f32 v86, v92, v93
    v_cvt_pk_bf16_f32 v87, v94, v95
    buffer_store_dwordx4 v[84:87], v2, s[4:7], s55 offen offset:256 sc1
    v_mfma_f32_16x16x32_bf16 v[96:99], v[160:163], v[32:35], v[96:99]
    ds_read_b64_tr_b16 v[60:61], v6 offset:53248
    v_mfma_f32_16x16x32_bf16 v[100:103], v[164:167], v[32:35], v[100:103]
    ds_read_b64_tr_b16 v[62:63], v6 offset:54272
    v_mfma_f32_16x16x32_bf16 v[104:107], v[160:163], v[36:39], v[104:107]
    ds_read_b64_tr_b16 v[32:33], v3 offset:57344
    v_mfma_f32_16x16x32_bf16 v[108:111], v[164:167], v[36:39], v[108:111]
    ds_read_b64_tr_b16 v[34:35], v3 offset:58368
    v_mfma_f32_16x16x32_bf16 v[112:115], v[160:163], v[40:43], v[112:115]
    ds_read_b64_tr_b16 v[36:37], v4 offset:57344
    v_mfma_f32_16x16x32_bf16 v[116:119], v[164:167], v[40:43], v[116:119]
    ds_read_b64_tr_b16 v[38:39], v4 offset:58368
    v_mfma_f32_16x16x32_bf16 v[120:123], v[160:163], v[44:47], v[120:123]
    ds_read_b64_tr_b16 v[40:41], v5 offset:57344
    v_mfma_f32_16x16x32_bf16 v[124:127], v[164:167], v[44:47], v[124:127]
    ds_read_b64_tr_b16 v[42:43], v5 offset:58368
    s_waitcnt lgkmcnt(10)
    v_mfma_f32_16x16x32_bf16 v[96:99], v[168:171], v[48:51], v[96:99]
    ds_read_b64_tr_b16 v[44:45], v6 offset:57344
    v_mfma_f32_16x16x32_bf16 v[100:103], v[172:175], v[48:51], v[100:103]
    ds_read_b64_tr_b16 v[46:47], v6 offset:58368
    v_mfma_f32_16x16x32_bf16 v[104:107], v[168:171], v[52:55], v[104:107]
    ds_read_b64_tr_b16 v[48:49], v3 offset:61440
    v_mfma_f32_16x16x32_bf16 v[108:111], v[172:175], v[52:55], v[108:111]
    ds_read_b64_tr_b16 v[50:51], v3 offset:62464
    s_waitcnt lgkmcnt(10)
    v_mfma_f32_16x16x32_bf16 v[112:115], v[168:171], v[56:59], v[112:115]
    ds_read_b64_tr_b16 v[52:53], v4 offset:61440
    v_mfma_f32_16x16x32_bf16 v[116:119], v[172:175], v[56:59], v[116:119]
    ds_read_b64_tr_b16 v[54:55], v4 offset:62464
    v_mfma_f32_16x16x32_bf16 v[120:123], v[168:171], v[60:63], v[120:123]
    ds_read_b64_tr_b16 v[56:57], v5 offset:61440
    v_mfma_f32_16x16x32_bf16 v[124:127], v[172:175], v[60:63], v[124:127]
    ds_read_b64_tr_b16 v[58:59], v5 offset:62464
    s_waitcnt lgkmcnt(10)
    v_mfma_f32_16x16x32_bf16 v[96:99], v[176:179], v[32:35], v[96:99]
    ds_read_b64_tr_b16 v[60:61], v6 offset:61440
    v_mfma_f32_16x16x32_bf16 v[100:103], v[180:183], v[32:35], v[100:103]
    ds_read_b64_tr_b16 v[62:63], v6 offset:62464
    s_barrier
    v_xor_b32 v3, 0x10000, v3
    v_xor_b32 v4, 0x10000, v4
    v_xor_b32 v5, 0x10000, v5
    v_xor_b32 v6, 0x10000, v6
    v_mfma_f32_16x16x32_bf16 v[104:107], v[176:179], v[36:39], v[104:107]
    ds_read_b64_tr_b16 v[32:33], v3 offset:0
    v_mfma_f32_16x16x32_bf16 v[108:111], v[180:183], v[36:39], v[108:111]
    ds_read_b64_tr_b16 v[34:35], v3 offset:1024
    s_waitcnt lgkmcnt(10)
    v_mfma_f32_16x16x32_bf16 v[112:115], v[176:179], v[40:43], v[112:115]
    ds_read_b64_tr_b16 v[36:37], v4 offset:0
    v_mfma_f32_16x16x32_bf16 v[116:119], v[180:183], v[40:43], v[116:119]
    ds_read_b64_tr_b16 v[38:39], v4 offset:1024
    v_mfma_f32_16x16x32_bf16 v[120:123], v[176:179], v[44:47], v[120:123]
    ds_read_b64_tr_b16 v[40:41], v5 offset:0
    v_mfma_f32_16x16x32_bf16 v[124:127], v[180:183], v[44:47], v[124:127]
    ds_read_b64_tr_b16 v[42:43], v5 offset:1024
    s_waitcnt lgkmcnt(10)
    v_mfma_f32_16x16x32_bf16 v[96:99], v[184:187], v[48:51], v[96:99]
    ds_read_b64_tr_b16 v[44:45], v6 offset:0
    v_mfma_f32_16x16x32_bf16 v[100:103], v[188:191], v[48:51], v[100:103]
    ds_read_b64_tr_b16 v[46:47], v6 offset:1024
    v_mfma_f32_16x16x32_bf16 v[104:107], v[184:187], v[52:55], v[104:107]
    ds_read_b64_tr_b16 v[48:49], v3 offset:4096
    v_mfma_f32_16x16x32_bf16 v[108:111], v[188:191], v[52:55], v[108:111]
    ds_read_b64_tr_b16 v[50:51], v3 offset:5120
    s_waitcnt lgkmcnt(10)
    v_mfma_f32_16x16x32_bf16 v[112:115], v[184:187], v[56:59], v[112:115]
    ds_read_b64_tr_b16 v[52:53], v4 offset:4096
    v_mfma_f32_16x16x32_bf16 v[116:119], v[188:191], v[56:59], v[116:119]
    ds_read_b64_tr_b16 v[54:55], v4 offset:5120
    v_mfma_f32_16x16x32_bf16 v[120:123], v[184:187], v[60:63], v[120:123]
    ds_read_b64_tr_b16 v[56:57], v5 offset:4096
    v_mfma_f32_16x16x32_bf16 v[124:127], v[188:191], v[60:63], v[124:127]
    ds_read_b64_tr_b16 v[58:59], v5 offset:5120
    s_waitcnt lgkmcnt(10)
    v_mfma_f32_16x16x32_bf16 v[96:99], v[192:195], v[32:35], v[96:99]
    ds_read_b64_tr_b16 v[60:61], v6 offset:4096
    v_mfma_f32_16x16x32_bf16 v[100:103], v[196:199], v[32:35], v[100:103]
    ds_read_b64_tr_b16 v[62:63], v6 offset:5120
    v_mfma_f32_16x16x32_bf16 v[104:107], v[192:195], v[36:39], v[104:107]
    ds_read_b64_tr_b16 v[32:33], v3 offset:8192
    v_mfma_f32_16x16x32_bf16 v[108:111], v[196:199], v[36:39], v[108:111]
    ds_read_b64_tr_b16 v[34:35], v3 offset:9216
    s_waitcnt lgkmcnt(10)
    v_mfma_f32_16x16x32_bf16 v[112:115], v[192:195], v[40:43], v[112:115]
    ds_read_b64_tr_b16 v[36:37], v4 offset:8192
    v_mfma_f32_16x16x32_bf16 v[116:119], v[196:199], v[40:43], v[116:119]
    ds_read_b64_tr_b16 v[38:39], v4 offset:9216
    v_mfma_f32_16x16x32_bf16 v[120:123], v[192:195], v[44:47], v[120:123]
    ds_read_b64_tr_b16 v[40:41], v5 offset:8192
    v_mfma_f32_16x16x32_bf16 v[124:127], v[196:199], v[44:47], v[124:127]
    ds_read_b64_tr_b16 v[42:43], v5 offset:9216
    s_waitcnt lgkmcnt(10)
    v_mfma_f32_16x16x32_bf16 v[96:99], v[200:203], v[48:51], v[96:99]
    ds_read_b64_tr_b16 v[44:45], v6 offset:8192
    v_mfma_f32_16x16x32_bf16 v[100:103], v[204:207], v[48:51], v[100:103]
    ds_read_b64_tr_b16 v[46:47], v6 offset:9216
    v_mfma_f32_16x16x32_bf16 v[104:107], v[200:203], v[52:55], v[104:107]
    ds_read_b64_tr_b16 v[48:49], v3 offset:12288
    v_mfma_f32_16x16x32_bf16 v[108:111], v[204:207], v[52:55], v[108:111]
    ds_read_b64_tr_b16 v[50:51], v3 offset:13312
    s_waitcnt lgkmcnt(10)
    v_mfma_f32_16x16x32_bf16 v[112:115], v[200:203], v[56:59], v[112:115]
    ds_read_b64_tr_b16 v[52:53], v4 offset:12288
    v_mfma_f32_16x16x32_bf16 v[116:119], v[204:207], v[56:59], v[116:119]
    ds_read_b64_tr_b16 v[54:55], v4 offset:13312
    v_mfma_f32_16x16x32_bf16 v[120:123], v[200:203], v[60:63], v[120:123]
    ds_read_b64_tr_b16 v[56:57], v5 offset:12288
    v_mfma_f32_16x16x32_bf16 v[124:127], v[204:207], v[60:63], v[124:127]
    ds_read_b64_tr_b16 v[58:59], v5 offset:13312
    s_waitcnt lgkmcnt(10)
    v_mfma_f32_16x16x32_bf16 v[96:99], v[208:211], v[32:35], v[96:99]
    ds_read_b64_tr_b16 v[60:61], v6 offset:12288
    v_mfma_f32_16x16x32_bf16 v[100:103], v[212:215], v[32:35], v[100:103]
    ds_read_b64_tr_b16 v[62:63], v6 offset:13312
    v_mfma_f32_16x16x32_bf16 v[104:107], v[208:211], v[36:39], v[104:107]
    ds_read_b64_tr_b16 v[32:33], v3 offset:16384
    ds_read_b128 v[16:19], v13 offset:4096
    v_mfma_f32_16x16x32_bf16 v[108:111], v[212:215], v[36:39], v[108:111]
    ds_read_b64_tr_b16 v[34:35], v3 offset:17408
    ds_read_b128 v[20:23], v13 offset:4608
    s_waitcnt lgkmcnt(12)
    v_mfma_f32_16x16x32_bf16 v[112:115], v[208:211], v[40:43], v[112:115]
    ds_read_b64_tr_b16 v[36:37], v4 offset:16384
    ds_read_b128 v[24:27], v13 offset:4160
    v_mfma_f32_16x16x32_bf16 v[116:119], v[212:215], v[40:43], v[116:119]
    ds_read_b64_tr_b16 v[38:39], v4 offset:17408
    ds_read_b128 v[28:31], v13 offset:4672
    v_mfma_f32_16x16x32_bf16 v[120:123], v[208:211], v[44:47], v[120:123]
    ds_read_b64_tr_b16 v[40:41], v5 offset:16384
    ds_read_b32 v8, v15 offset:512
    v_mfma_f32_16x16x32_bf16 v[124:127], v[212:215], v[44:47], v[124:127]
    ds_read_b64_tr_b16 v[42:43], v5 offset:17408
    ds_read_b32 v10, v15 offset:576
    s_waitcnt lgkmcnt(14)
    v_mfma_f32_16x16x32_bf16 v[96:99], v[216:219], v[48:51], v[96:99]
    ds_read_b64_tr_b16 v[44:45], v6 offset:16384
    ds_read_b32 v12, v15 offset:640
    v_mfma_f32_16x16x32_bf16 v[100:103], v[220:223], v[48:51], v[100:103]
    ds_read_b64_tr_b16 v[46:47], v6 offset:17408
    ds_read_b32 v14, v15 offset:704
    v_mfma_f32_16x16x32_bf16 v[104:107], v[216:219], v[52:55], v[104:107]
    ds_read_b64_tr_b16 v[48:49], v3 offset:20480
    v_mfma_f32_16x16x32_bf16 v[108:111], v[220:223], v[52:55], v[108:111]
    ds_read_b64_tr_b16 v[50:51], v3 offset:21504
    s_waitcnt lgkmcnt(14)
    v_mfma_f32_16x16x32_bf16 v[112:115], v[216:219], v[56:59], v[112:115]
    ds_read_b64_tr_b16 v[52:53], v4 offset:20480
    v_mfma_f32_16x16x32_bf16 v[116:119], v[220:223], v[56:59], v[116:119]
    ds_read_b64_tr_b16 v[54:55], v4 offset:21504
    v_mfma_f32_16x16x32_bf16 v[120:123], v[216:219], v[60:63], v[120:123]
    ds_read_b64_tr_b16 v[56:57], v5 offset:20480
    v_mfma_f32_16x16x32_bf16 v[124:127], v[220:223], v[60:63], v[124:127]
    ds_read_b64_tr_b16 v[58:59], v5 offset:21504
    s_waitcnt lgkmcnt(6)
    v_pk_fma_f32 v[96:97], v[8:9], v[16:17], v[96:97] op_sel_hi:[0,1,1] neg_lo:[1,0,0] neg_hi:[1,0,0]
    v_pk_fma_f32 v[98:99], v[8:9], v[18:19], v[98:99] op_sel_hi:[0,1,1] neg_lo:[1,0,0] neg_hi:[1,0,0]
    v_pk_fma_f32 v[104:105], v[10:11], v[16:17], v[104:105] op_sel_hi:[0,1,1] neg_lo:[1,0,0] neg_hi:[1,0,0]
    v_pk_fma_f32 v[106:107], v[10:11], v[18:19], v[106:107] op_sel_hi:[0,1,1] neg_lo:[1,0,0] neg_hi:[1,0,0]
    v_pk_mul_f32 v[96:97], v[20:21], v[96:97]
    v_pk_mul_f32 v[98:99], v[22:23], v[98:99]
    v_pk_mul_f32 v[104:105], v[20:21], v[104:105]
    v_pk_mul_f32 v[106:107], v[22:23], v[106:107]
    v_cvt_pk_bf16_f32 v72, v96, v97
    v_cvt_pk_bf16_f32 v73, v98, v99
    v_cvt_pk_bf16_f32 v74, v104, v105
    v_cvt_pk_bf16_f32 v75, v106, v107
    s_add_u32 s56, s52, 4194304
    v_permlane16_swap_b32 v72, v74
    v_permlane16_swap_b32 v73, v75
    buffer_store_dwordx4 v[72:75], v1, s[4:7], s56 offen offset:0 sc1
    v_pk_fma_f32 v[112:113], v[12:13], v[16:17], v[112:113] op_sel_hi:[0,1,1] neg_lo:[1,0,0] neg_hi:[1,0,0]
    v_pk_fma_f32 v[114:115], v[12:13], v[18:19], v[114:115] op_sel_hi:[0,1,1] neg_lo:[1,0,0] neg_hi:[1,0,0]
    v_pk_fma_f32 v[120:121], v[14:15], v[16:17], v[120:121] op_sel_hi:[0,1,1] neg_lo:[1,0,0] neg_hi:[1,0,0]
    v_pk_fma_f32 v[122:123], v[14:15], v[18:19], v[122:123] op_sel_hi:[0,1,1] neg_lo:[1,0,0] neg_hi:[1,0,0]
    v_pk_mul_f32 v[112:113], v[20:21], v[112:113]
    v_pk_mul_f32 v[114:115], v[22:23], v[114:115]
    v_pk_mul_f32 v[120:121], v[20:21], v[120:121]
    v_pk_mul_f32 v[122:123], v[22:23], v[122:123]
    v_cvt_pk_bf16_f32 v88, v112, v113
    v_cvt_pk_bf16_f32 v89, v114, v115
    v_cvt_pk_bf16_f32 v90, v120, v121
    v_cvt_pk_bf16_f32 v91, v122, v123
    s_add_u32 s56, s52, 4325376
    v_permlane16_swap_b32 v88, v90
    v_permlane16_swap_b32 v89, v91
    buffer_store_dwordx4 v[88:91], v1, s[4:7], s56 offen offset:0 sc1
    v_pk_fma_f32 v[100:101], v[8:9], v[24:25], v[100:101] op_sel_hi:[0,1,1] neg_lo:[1,0,0] neg_hi:[1,0,0]
    v_pk_fma_f32 v[102:103], v[8:9], v[26:27], v[102:103] op_sel_hi:[0,1,1] neg_lo:[1,0,0] neg_hi:[1,0,0]
    v_pk_fma_f32 v[108:109], v[10:11], v[24:25], v[108:109] op_sel_hi:[0,1,1] neg_lo:[1,0,0] neg_hi:[1,0,0]
    v_pk_fma_f32 v[110:111], v[10:11], v[26:27], v[110:111] op_sel_hi:[0,1,1] neg_lo:[1,0,0] neg_hi:[1,0,0]
    v_pk_mul_f32 v[100:101], v[28:29], v[100:101]
    v_pk_mul_f32 v[102:103], v[30:31], v[102:103]
    v_pk_mul_f32 v[108:109], v[28:29], v[108:109]
    v_pk_mul_f32 v[110:111], v[30:31], v[110:111]
    v_cvt_pk_bf16_f32 v76, v100, v101
    v_cvt_pk_bf16_f32 v77, v102, v103
    v_cvt_pk_bf16_f32 v78, v108, v109
    v_cvt_pk_bf16_f32 v79, v110, v111
    s_add_u32 s56, s52, 4194304
    v_permlane16_swap_b32 v76, v78
    v_permlane16_swap_b32 v77, v79
    buffer_store_dwordx4 v[76:79], v1, s[4:7], s56 offen offset:1024 sc1
    v_pk_fma_f32 v[116:117], v[12:13], v[24:25], v[116:117] op_sel_hi:[0,1,1] neg_lo:[1,0,0] neg_hi:[1,0,0]
    v_pk_fma_f32 v[118:119], v[12:13], v[26:27], v[118:119] op_sel_hi:[0,1,1] neg_lo:[1,0,0] neg_hi:[1,0,0]
    v_pk_fma_f32 v[124:125], v[14:15], v[24:25], v[124:125] op_sel_hi:[0,1,1] neg_lo:[1,0,0] neg_hi:[1,0,0]
    v_pk_fma_f32 v[126:127], v[14:15], v[26:27], v[126:127] op_sel_hi:[0,1,1] neg_lo:[1,0,0] neg_hi:[1,0,0]
    v_pk_mul_f32 v[116:117], v[28:29], v[116:117]
    v_pk_mul_f32 v[118:119], v[30:31], v[118:119]
    v_pk_mul_f32 v[124:125], v[28:29], v[124:125]
    v_pk_mul_f32 v[126:127], v[30:31], v[126:127]
    v_cvt_pk_bf16_f32 v92, v116, v117
    v_cvt_pk_bf16_f32 v93, v118, v119
    v_cvt_pk_bf16_f32 v94, v124, v125
    v_cvt_pk_bf16_f32 v95, v126, v127
    s_add_u32 s56, s52, 4325376
    v_permlane16_swap_b32 v92, v94
    v_permlane16_swap_b32 v93, v95
    buffer_store_dwordx4 v[92:95], v1, s[4:7], s56 offen offset:1024 sc1
    v_mfma_f32_16x16x32_bf16 v[128:131], v[32:35], v[224:227], v[128:131]
    ds_read_b64_tr_b16 v[60:61], v6 offset:20480
    v_mfma_f32_16x16x32_bf16 v[132:135], v[32:35], v[228:231], v[132:135]
    ds_read_b64_tr_b16 v[62:63], v6 offset:21504
    v_mfma_f32_16x16x32_bf16 v[136:139], v[36:39], v[224:227], v[136:139]
    ds_read_b64_tr_b16 v[32:33], v3 offset:24576
    v_mfma_f32_16x16x32_bf16 v[140:143], v[36:39], v[228:231], v[140:143]
    ds_read_b64_tr_b16 v[34:35], v3 offset:25600
    v_mfma_f32_16x16x32_bf16 v[144:147], v[40:43], v[224:227], v[144:147]
    ds_read_b64_tr_b16 v[36:37], v4 offset:24576
    v_mfma_f32_16x16x32_bf16 v[148:151], v[40:43], v[228:231], v[148:151]
    ds_read_b64_tr_b16 v[38:39], v4 offset:25600
    v_mfma_f32_16x16x32_bf16 v[152:155], v[44:47], v[224:227], v[152:155]
    ds_read_b64_tr_b16 v[40:41], v5 offset:24576
    v_mfma_f32_16x16x32_bf16 v[156:159], v[44:47], v[228:231], v[156:159]
    ds_read_b64_tr_b16 v[42:43], v5 offset:25600
    s_waitcnt lgkmcnt(10)
    v_mfma_f32_16x16x32_bf16 v[128:131], v[48:51], v[232:235], v[128:131]
    ds_read_b64_tr_b16 v[44:45], v6 offset:24576
    v_mfma_f32_16x16x32_bf16 v[132:135], v[48:51], v[236:239], v[132:135]
    ds_read_b64_tr_b16 v[46:47], v6 offset:25600
    v_mfma_f32_16x16x32_bf16 v[136:139], v[52:55], v[232:235], v[136:139]
    ds_read_b64_tr_b16 v[48:49], v3 offset:28672
    v_mfma_f32_16x16x32_bf16 v[140:143], v[52:55], v[236:239], v[140:143]
    ds_read_b64_tr_b16 v[50:51], v3 offset:29696
    s_waitcnt lgkmcnt(10)
    v_mfma_f32_16x16x32_bf16 v[144:147], v[56:59], v[232:235], v[144:147]
    ds_read_b64_tr_b16 v[52:53], v4 offset:28672
    v_mfma_f32_16x16x32_bf16 v[148:151], v[56:59], v[236:239], v[148:151]
    ds_read_b64_tr_b16 v[54:55], v4 offset:29696
    v_mfma_f32_16x16x32_bf16 v[152:155], v[60:63], v[232:235], v[152:155]
    ds_read_b64_tr_b16 v[56:57], v5 offset:28672
    v_mfma_f32_16x16x32_bf16 v[156:159], v[60:63], v[236:239], v[156:159]
    ds_read_b64_tr_b16 v[58:59], v5 offset:29696
    s_waitcnt lgkmcnt(10)
    v_mfma_f32_16x16x32_bf16 v[128:131], v[32:35], v[240:243], v[128:131]
    ds_read_b64_tr_b16 v[60:61], v6 offset:28672
    v_mfma_f32_16x16x32_bf16 v[132:135], v[32:35], v[244:247], v[132:135]
    ds_read_b64_tr_b16 v[62:63], v6 offset:29696
    s_barrier
    v_mfma_f32_16x16x32_bf16 v[136:139], v[36:39], v[240:243], v[136:139]
    ds_read_b64_tr_b16 v[32:33], v3 offset:32768
    v_mfma_f32_16x16x32_bf16 v[140:143], v[36:39], v[244:247], v[140:143]
    ds_read_b64_tr_b16 v[34:35], v3 offset:33792
    s_waitcnt lgkmcnt(10)
    v_mfma_f32_16x16x32_bf16 v[144:147], v[40:43], v[240:243], v[144:147]
    ds_read_b64_tr_b16 v[36:37], v4 offset:32768
    v_mfma_f32_16x16x32_bf16 v[148:151], v[40:43], v[244:247], v[148:151]
    ds_read_b64_tr_b16 v[38:39], v4 offset:33792
    v_mfma_f32_16x16x32_bf16 v[152:155], v[44:47], v[240:243], v[152:155]
    ds_read_b64_tr_b16 v[40:41], v5 offset:32768
    v_mfma_f32_16x16x32_bf16 v[156:159], v[44:47], v[244:247], v[156:159]
    ds_read_b64_tr_b16 v[42:43], v5 offset:33792
    s_waitcnt lgkmcnt(10)
    v_mfma_f32_16x16x32_bf16 v[128:131], v[48:51], v[248:251], v[128:131]
    ds_read_b64_tr_b16 v[44:45], v6 offset:32768
    v_mfma_f32_16x16x32_bf16 v[132:135], v[48:51], v[252:255], v[132:135]
    ds_read_b64_tr_b16 v[46:47], v6 offset:33792
    v_mfma_f32_16x16x32_bf16 v[136:139], v[52:55], v[248:251], v[136:139]
    ds_read_b64_tr_b16 v[48:49], v3 offset:36864
    v_mfma_f32_16x16x32_bf16 v[140:143], v[52:55], v[252:255], v[140:143]
    ds_read_b64_tr_b16 v[50:51], v3 offset:37888
    s_waitcnt lgkmcnt(10)
    v_mfma_f32_16x16x32_bf16 v[144:147], v[56:59], v[248:251], v[144:147]
    ds_read_b64_tr_b16 v[52:53], v4 offset:36864
    v_mfma_f32_16x16x32_bf16 v[148:151], v[56:59], v[252:255], v[148:151]
    ds_read_b64_tr_b16 v[54:55], v4 offset:37888
    v_mfma_f32_16x16x32_bf16 v[152:155], v[60:63], v[248:251], v[152:155]
    ds_read_b64_tr_b16 v[56:57], v5 offset:36864
    v_mfma_f32_16x16x32_bf16 v[156:159], v[60:63], v[252:255], v[156:159]
    ds_read_b64_tr_b16 v[58:59], v5 offset:37888
    s_waitcnt lgkmcnt(10)
    v_mfma_f32_16x16x32_bf16 v[128:131], v[32:35], v[160:163], v[128:131]
    ds_read_b64_tr_b16 v[60:61], v6 offset:36864
    v_mfma_f32_16x16x32_bf16 v[132:135], v[32:35], v[164:167], v[132:135]
    ds_read_b64_tr_b16 v[62:63], v6 offset:37888
    v_mfma_f32_16x16x32_bf16 v[136:139], v[36:39], v[160:163], v[136:139]
    ds_read_b64_tr_b16 v[32:33], v3 offset:40960
    v_mfma_f32_16x16x32_bf16 v[140:143], v[36:39], v[164:167], v[140:143]
    ds_read_b64_tr_b16 v[34:35], v3 offset:41984
    s_waitcnt lgkmcnt(10)
    v_mfma_f32_16x16x32_bf16 v[144:147], v[40:43], v[160:163], v[144:147]
    ds_read_b64_tr_b16 v[36:37], v4 offset:40960
    v_mfma_f32_16x16x32_bf16 v[148:151], v[40:43], v[164:167], v[148:151]
    ds_read_b64_tr_b16 v[38:39], v4 offset:41984
    v_mfma_f32_16x16x32_bf16 v[152:155], v[44:47], v[160:163], v[152:155]
    ds_read_b64_tr_b16 v[40:41], v5 offset:40960
    v_mfma_f32_16x16x32_bf16 v[156:159], v[44:47], v[164:167], v[156:159]
    ds_read_b64_tr_b16 v[42:43], v5 offset:41984
    s_waitcnt lgkmcnt(10)
    v_mfma_f32_16x16x32_bf16 v[128:131], v[48:51], v[168:171], v[128:131]
    ds_read_b64_tr_b16 v[44:45], v6 offset:40960
    v_mfma_f32_16x16x32_bf16 v[132:135], v[48:51], v[172:175], v[132:135]
    ds_read_b64_tr_b16 v[46:47], v6 offset:41984
    v_mfma_f32_16x16x32_bf16 v[136:139], v[52:55], v[168:171], v[136:139]
    ds_read_b64_tr_b16 v[48:49], v3 offset:45056
    v_mfma_f32_16x16x32_bf16 v[140:143], v[52:55], v[172:175], v[140:143]
    ds_read_b64_tr_b16 v[50:51], v3 offset:46080
    s_waitcnt lgkmcnt(10)
    v_mfma_f32_16x16x32_bf16 v[144:147], v[56:59], v[168:171], v[144:147]
    ds_read_b64_tr_b16 v[52:53], v4 offset:45056
    v_mfma_f32_16x16x32_bf16 v[148:151], v[56:59], v[172:175], v[148:151]
    ds_read_b64_tr_b16 v[54:55], v4 offset:46080
    v_mfma_f32_16x16x32_bf16 v[152:155], v[60:63], v[168:171], v[152:155]
    ds_read_b64_tr_b16 v[56:57], v5 offset:45056
    v_mfma_f32_16x16x32_bf16 v[156:159], v[60:63], v[172:175], v[156:159]
    ds_read_b64_tr_b16 v[58:59], v5 offset:46080
    s_waitcnt lgkmcnt(10)
    v_mfma_f32_16x16x32_bf16 v[128:131], v[32:35], v[176:179], v[128:131]
    ds_read_b64_tr_b16 v[60:61], v6 offset:45056
    v_mfma_f32_16x16x32_bf16 v[132:135], v[32:35], v[180:183], v[132:135]
    ds_read_b64_tr_b16 v[62:63], v6 offset:46080
    v_mfma_f32_16x16x32_bf16 v[136:139], v[36:39], v[176:179], v[136:139]
    ds_read_b64_tr_b16 v[32:33], v3 offset:49152
    v_mfma_f32_16x16x32_bf16 v[140:143], v[36:39], v[180:183], v[140:143]
    ds_read_b64_tr_b16 v[34:35], v3 offset:50176
    s_waitcnt lgkmcnt(10)
    v_mfma_f32_16x16x32_bf16 v[144:147], v[40:43], v[176:179], v[144:147]
    ds_read_b64_tr_b16 v[36:37], v4 offset:49152
    v_mfma_f32_16x16x32_bf16 v[148:151], v[40:43], v[180:183], v[148:151]
    ds_read_b64_tr_b16 v[38:39], v4 offset:50176
    v_mfma_f32_16x16x32_bf16 v[152:155], v[44:47], v[176:179], v[152:155]
    ds_read_b64_tr_b16 v[40:41], v5 offset:49152
    v_mfma_f32_16x16x32_bf16 v[156:159], v[44:47], v[180:183], v[156:159]
    ds_read_b64_tr_b16 v[42:43], v5 offset:50176
    s_waitcnt lgkmcnt(10)
    v_mfma_f32_16x16x32_bf16 v[128:131], v[48:51], v[184:187], v[128:131]
    ds_read_b64_tr_b16 v[44:45], v6 offset:49152
    s_mov_b32 s68, 1
    s_waitcnt vmcnt(0)
    s_atomic_add s68, s[22:23], s59 glc
    s_add_u32 s55, s52, 131072
    s_add_u32 s56, s52, 4325376
    s_add_u32 s53, s53, 131072
    ds_read_b32 v8, v9 offset:4096
    v_mfma_f32_16x16x32_bf16 v[132:135], v[48:51], v[188:191], v[132:135]
    ds_read_b64_tr_b16 v[46:47], v6 offset:50176
    buffer_load_dwordx4 v[64:67], v1, s[4:7], s55 offen offset:0 sc1
    ds_read_b32 v10, v9 offset:4608
    v_mfma_f32_16x16x32_bf16 v[136:139], v[52:55], v[184:187], v[136:139]
    ds_read_b64_tr_b16 v[48:49], v3 offset:53248
    buffer_load_dwordx4 v[68:71], v1, s[4:7], s55 offen offset:1024 sc1
    ds_read_b32 v12, v9 offset:4160
    v_mfma_f32_16x16x32_bf16 v[140:143], v[52:55], v[188:191], v[140:143]
    ds_read_b64_tr_b16 v[50:51], v3 offset:54272
    buffer_load_dwordx4 v[72:75], v1, s[4:7], s56 offen offset:0 sc1
    ds_read_b32 v14, v9 offset:4672
    s_waitcnt lgkmcnt(14)
    v_mfma_f32_16x16x32_bf16 v[144:147], v[56:59], v[184:187], v[144:147]
    ds_read_b64_tr_b16 v[52:53], v4 offset:53248
    buffer_load_dwordx4 v[76:79], v1, s[4:7], s56 offen offset:1024 sc1
    ds_read_b128 v[16:19], v11 offset:0
    v_mfma_f32_16x16x32_bf16 v[148:151], v[56:59], v[188:191], v[148:151]
    ds_read_b64_tr_b16 v[54:55], v4 offset:54272
    ds_read_b128 v[20:23], v11 offset:64
    v_mfma_f32_16x16x32_bf16 v[152:155], v[60:63], v[184:187], v[152:155]
    ds_read_b64_tr_b16 v[56:57], v5 offset:53248
    ds_read_b128 v[24:27], v11 offset:128
    v_mfma_f32_16x16x32_bf16 v[156:159], v[60:63], v[188:191], v[156:159]
    ds_read_b64_tr_b16 v[58:59], v5 offset:54272
    ds_read_b128 v[28:31], v11 offset:192
    s_waitcnt lgkmcnt(14)
    v_mfma_f32_16x16x32_bf16 v[128:131], v[32:35], v[192:195], v[128:131]
    ds_read_b64_tr_b16 v[60:61], v6 offset:53248
    v_mfma_f32_16x16x32_bf16 v[132:135], v[32:35], v[196:199], v[132:135]
    ds_read_b64_tr_b16 v[62:63], v6 offset:54272
    v_mfma_f32_16x16x32_bf16 v[136:139], v[36:39], v[192:195], v[136:139]
    ds_read_b64_tr_b16 v[32:33], v3 offset:57344
    v_mfma_f32_16x16x32_bf16 v[140:143], v[36:39], v[196:199], v[140:143]
    ds_read_b64_tr_b16 v[34:35], v3 offset:58368
    s_waitcnt lgkmcnt(14)
    v_mfma_f32_16x16x32_bf16 v[144:147], v[40:43], v[192:195], v[144:147]
    ds_read_b64_tr_b16 v[36:37], v4 offset:57344
    v_mfma_f32_16x16x32_bf16 v[148:151], v[40:43], v[196:199], v[148:151]
    ds_read_b64_tr_b16 v[38:39], v4 offset:58368
    v_mfma_f32_16x16x32_bf16 v[152:155], v[44:47], v[192:195], v[152:155]
    ds_read_b64_tr_b16 v[40:41], v5 offset:57344
    v_mfma_f32_16x16x32_bf16 v[156:159], v[44:47], v[196:199], v[156:159]
    ds_read_b64_tr_b16 v[42:43], v5 offset:58368
    s_waitcnt lgkmcnt(13)
    v_mfma_f32_16x16x32_bf16 v[128:131], v[48:51], v[200:203], v[128:131]
    ds_read_b64_tr_b16 v[44:45], v6 offset:57344
    s_waitcnt lgkmcnt(9)
    v_mfma_f32_16x16x32_bf16 v[132:135], v[48:51], v[204:207], v[132:135]
    ds_read_b64_tr_b16 v[46:47], v6 offset:58368
    v_mul_f32 v10, 0x3e8293ee, v10
    v_mfma_f32_16x16x32_bf16 v[136:139], v[52:55], v[200:203], v[136:139]
    ds_read_b64_tr_b16 v[48:49], v3 offset:61440
    v_mul_f32 v14, 0x3e8293ee, v14
    v_mfma_f32_16x16x32_bf16 v[140:143], v[52:55], v[204:207], v[140:143]
    ds_read_b64_tr_b16 v[50:51], v3 offset:62464
    s_lshl_b32 s44, s16, 11
    s_waitcnt lgkmcnt(10)
    v_mfma_f32_16x16x32_bf16 v[144:147], v[56:59], v[200:203], v[144:147]
    ds_read_b64_tr_b16 v[52:53], v4 offset:61440
    s_add_u32 s44, s44, 131072
    v_mfma_f32_16x16x32_bf16 v[148:151], v[56:59], v[204:207], v[148:151]
    ds_read_b64_tr_b16 v[54:55], v4 offset:62464
    v_add_u32 v13, s44, v2
    v_mfma_f32_16x16x32_bf16 v[152:155], v[60:63], v[200:203], v[152:155]
    ds_read_b64_tr_b16 v[56:57], v5 offset:61440
    v_mfma_f32_16x16x32_bf16 v[156:159], v[60:63], v[204:207], v[156:159]
    ds_read_b64_tr_b16 v[58:59], v5 offset:62464
    s_waitcnt lgkmcnt(10)
    v_mfma_f32_16x16x32_bf16 v[128:131], v[32:35], v[208:211], v[128:131]
    ds_read_b64_tr_b16 v[60:61], v6 offset:61440
    v_mfma_f32_16x16x32_bf16 v[132:135], v[32:35], v[212:215], v[132:135]
    ds_read_b64_tr_b16 v[62:63], v6 offset:62464
    v_xor_b32 v3, 0x10000, v3
    v_xor_b32 v4, 0x10000, v4
    v_xor_b32 v5, 0x10000, v5
    v_xor_b32 v6, 0x10000, v6
    v_mfma_f32_16x16x32_bf16 v[136:139], v[36:39], v[208:211], v[136:139]
    v_mfma_f32_16x16x32_bf16 v[140:143], v[36:39], v[212:215], v[140:143]
    s_waitcnt lgkmcnt(8)
    v_mfma_f32_16x16x32_bf16 v[144:147], v[40:43], v[208:211], v[144:147]
    v_mfma_f32_16x16x32_bf16 v[148:151], v[40:43], v[212:215], v[148:151]
    v_mfma_f32_16x16x32_bf16 v[152:155], v[44:47], v[208:211], v[152:155]
    v_mfma_f32_16x16x32_bf16 v[156:159], v[44:47], v[212:215], v[156:159]
    s_waitcnt lgkmcnt(4)
    v_mfma_f32_16x16x32_bf16 v[128:131], v[48:51], v[216:219], v[128:131]
    v_mfma_f32_16x16x32_bf16 v[132:135], v[48:51], v[220:223], v[132:135]
    v_mfma_f32_16x16x32_bf16 v[136:139], v[52:55], v[216:219], v[136:139]
    v_mfma_f32_16x16x32_bf16 v[140:143], v[52:55], v[220:223], v[140:143]
    s_waitcnt lgkmcnt(0)
    v_mfma_f32_16x16x32_bf16 v[144:147], v[56:59], v[216:219], v[144:147]
    v_mfma_f32_16x16x32_bf16 v[148:151], v[56:59], v[220:223], v[148:151]
    v_mfma_f32_16x16x32_bf16 v[152:155], v[60:63], v[216:219], v[152:155]
    v_mfma_f32_16x16x32_bf16 v[156:159], v[60:63], v[220:223], v[156:159]
    v_pk_fma_f32 v[128:129], v[8:9], v[16:17], v[128:129] op_sel_hi:[0,1,1] neg_lo:[1,0,0] neg_hi:[1,0,0]
    v_pk_fma_f32 v[130:131], v[8:9], v[18:19], v[130:131] op_sel_hi:[0,1,1] neg_lo:[1,0,0] neg_hi:[1,0,0]
    v_pk_fma_f32 v[136:137], v[8:9], v[20:21], v[136:137] op_sel_hi:[0,1,1] neg_lo:[1,0,0] neg_hi:[1,0,0]
    v_pk_fma_f32 v[138:139], v[8:9], v[22:23], v[138:139] op_sel_hi:[0,1,1] neg_lo:[1,0,0] neg_hi:[1,0,0]
    v_pk_mul_f32 v[128:129], v[10:11], v[128:129] op_sel_hi:[0,1]
    v_pk_mul_f32 v[130:131], v[10:11], v[130:131] op_sel_hi:[0,1]
    v_pk_mul_f32 v[136:137], v[10:11], v[136:137] op_sel_hi:[0,1]
    v_pk_mul_f32 v[138:139], v[10:11], v[138:139] op_sel_hi:[0,1]
    v_cvt_pk_bf16_f32 v128, v128, v129
    v_cvt_pk_bf16_f32 v129, v130, v131
    v_cvt_pk_bf16_f32 v130, v136, v137
    v_cvt_pk_bf16_f32 v131, v138, v139
    ds_write_b128 v13, v[128:131] offset:0
    v_pk_fma_f32 v[132:133], v[12:13], v[16:17], v[132:133] op_sel_hi:[0,1,1] neg_lo:[1,0,0] neg_hi:[1,0,0]
    v_pk_fma_f32 v[134:135], v[12:13], v[18:19], v[134:135] op_sel_hi:[0,1,1] neg_lo:[1,0,0] neg_hi:[1,0,0]
    v_pk_fma_f32 v[140:141], v[12:13], v[20:21], v[140:141] op_sel_hi:[0,1,1] neg_lo:[1,0,0] neg_hi:[1,0,0]
    v_pk_fma_f32 v[142:143], v[12:13], v[22:23], v[142:143] op_sel_hi:[0,1,1] neg_lo:[1,0,0] neg_hi:[1,0,0]
    v_pk_mul_f32 v[132:133], v[14:15], v[132:133] op_sel_hi:[0,1]
    v_pk_mul_f32 v[134:135], v[14:15], v[134:135] op_sel_hi:[0,1]
    v_pk_mul_f32 v[140:141], v[14:15], v[140:141] op_sel_hi:[0,1]
    v_pk_mul_f32 v[142:143], v[14:15], v[142:143] op_sel_hi:[0,1]
    v_cvt_pk_bf16_f32 v132, v132, v133
    v_cvt_pk_bf16_f32 v133, v134, v135
    v_cvt_pk_bf16_f32 v134, v140, v141
    v_cvt_pk_bf16_f32 v135, v142, v143
    ds_write_b128 v13, v[132:135] offset:256
    v_pk_fma_f32 v[144:145], v[8:9], v[24:25], v[144:145] op_sel_hi:[0,1,1] neg_lo:[1,0,0] neg_hi:[1,0,0]
    v_pk_fma_f32 v[146:147], v[8:9], v[26:27], v[146:147] op_sel_hi:[0,1,1] neg_lo:[1,0,0] neg_hi:[1,0,0]
    v_pk_fma_f32 v[152:153], v[8:9], v[28:29], v[152:153] op_sel_hi:[0,1,1] neg_lo:[1,0,0] neg_hi:[1,0,0]
    v_pk_fma_f32 v[154:155], v[8:9], v[30:31], v[154:155] op_sel_hi:[0,1,1] neg_lo:[1,0,0] neg_hi:[1,0,0]
    v_pk_mul_f32 v[144:145], v[10:11], v[144:145] op_sel_hi:[0,1]
    v_pk_mul_f32 v[146:147], v[10:11], v[146:147] op_sel_hi:[0,1]
    v_pk_mul_f32 v[152:153], v[10:11], v[152:153] op_sel_hi:[0,1]
    v_pk_mul_f32 v[154:155], v[10:11], v[154:155] op_sel_hi:[0,1]
    v_cvt_pk_bf16_f32 v144, v144, v145
    v_cvt_pk_bf16_f32 v145, v146, v147
    v_cvt_pk_bf16_f32 v146, v152, v153
    v_cvt_pk_bf16_f32 v147, v154, v155
    ds_write_b128 v13, v[144:147] offset:8192
    v_pk_fma_f32 v[148:149], v[12:13], v[24:25], v[148:149] op_sel_hi:[0,1,1] neg_lo:[1,0,0] neg_hi:[1,0,0]
    v_pk_fma_f32 v[150:151], v[12:13], v[26:27], v[150:151] op_sel_hi:[0,1,1] neg_lo:[1,0,0] neg_hi:[1,0,0]
    v_pk_fma_f32 v[156:157], v[12:13], v[28:29], v[156:157] op_sel_hi:[0,1,1] neg_lo:[1,0,0] neg_hi:[1,0,0]
    v_pk_fma_f32 v[158:159], v[12:13], v[30:31], v[158:159] op_sel_hi:[0,1,1] neg_lo:[1,0,0] neg_hi:[1,0,0]
    v_pk_mul_f32 v[148:149], v[14:15], v[148:149] op_sel_hi:[0,1]
    v_pk_mul_f32 v[150:151], v[14:15], v[150:151] op_sel_hi:[0,1]
    v_pk_mul_f32 v[156:157], v[14:15], v[156:157] op_sel_hi:[0,1]
    v_pk_mul_f32 v[158:159], v[14:15], v[158:159] op_sel_hi:[0,1]
    v_cvt_pk_bf16_f32 v148, v148, v149
    v_cvt_pk_bf16_f32 v149, v150, v151
    v_cvt_pk_bf16_f32 v150, v156, v157
    v_cvt_pk_bf16_f32 v151, v158, v159
    ds_write_b128 v13, v[148:151] offset:8448
    v_add_u32 v4, 139264, v1
    s_lshl_b32 s44, s21, 22
    s_lshl_b32 s45, s38, 16
    s_add_u32 s41, s44, s45
    s_lshl_b32 s45, s18, 12
    s_add_u32 s43, s41, s45
    s_and_b32 s45, s45, 0
    s_add_u32 s41, s41, s45
    s_add_u32 s41, s41, 16777216
    s_mov_b32 s39, 1
    s_waitcnt lgkmcnt(0)
    s_cmp_eq_u32 s68, 15
    s_cselect_b32 s68, 16, 0
    s_cbranch_scc1 b_k2
    s_atomic_add s68, s[22:23], s59 glc
b_k2:
    s_barrier
b_att:
    ds_read_b128 v[32:35], v4 offset:0
    ds_read_b128 v[36:39], v4 offset:1024
    ds_read_b128 v[40:43], v4 offset:2048
    ds_read_b128 v[44:47], v4 offset:3072
    ds_read_b128 v[48:51], v4 offset:4096
    ds_read_b128 v[52:55], v4 offset:5120
    ds_read_b128 v[56:59], v4 offset:6144
    ds_read_b128 v[60:63], v4 offset:7168
    v_mov_b32 v9, 0xdddddddd
    v_bfe_u32 v10, v1, 4, 3
    v_mov_b32 v11, 0x3f803f80
    v_cmp_eq_u32 vcc, 0, v10
    v_cmp_eq_u32 s[44:45], 4, v10
    s_mov_b32 s58, 3
    v_cndmask_b32 v28, 0, v11, vcc
    v_cndmask_b32 v29, 0, v11, vcc
    v_cndmask_b32 v30, 0, v11, s[44:45]
    v_cndmask_b32 v31, 0, v11, s[44:45]
    v_mov_b32 v10, 0
    v_mov_b32 v11, 0
    s_waitcnt vmcnt(0) lgkmcnt(6)
    v_mfma_f32_32x32x16_bf16 v[192:207], v[64:67], v[32:35], 0
    v_mfma_f32_32x32x16_bf16 v[192:207], v[68:71], v[36:39], v[192:207]
    s_and_b32 s3, s16, 3
    s_lshl_b32 s44, s3, 12
    s_add_u32 s44, s44, 65536
    v_add_u32 v5, s44, v1
    s_lshl_b32 s44, s3, 8
    s_add_u32 s44, s44, 147456
    v_lshrrev_b32 v6, 2, v1
    v_add_u32 v6, s44, v6
    s_waitcnt lgkmcnt(4)
    v_mfma_f32_32x32x16_bf16 v[208:223], v[64:67], v[40:43], 0
    s_nop 1
    v_exp_f32 v192, v192
    v_exp_f32 v193, v193
    v_exp_f32 v194, v194
    v_mfma_f32_32x32x8_bf16 v[128:143], v[10:11], v[10:11], 0
    v_mov_b32 v12, 0
    v_exp_f32 v195, v195
    v_exp_f32 v196, v196
    v_exp_f32 v197, v197
    v_mfma_f32_32x32x16_bf16 v[208:223], v[68:71], v[44:47], v[208:223]
    v_exp_f32 v198, v198
    v_exp_f32 v199, v199
    v_exp_f32 v200, v200
    v_mfma_f32_32x32x8_bf16 v[144:159], v[10:11], v[10:11], 0
    v_mov_b32 v16, 0
    v_exp_f32 v201, v201
    v_exp_f32 v202, v202
    v_mfma_f32_32x32x8_bf16 v[160:175], v[10:11], v[10:11], 0
    v_mov_b32 v20, 0
    v_exp_f32 v203, v203
    v_exp_f32 v204, v204
    v_exp_f32 v205, v205
    v_mfma_f32_32x32x8_bf16 v[176:191], v[10:11], v[10:11], 0
    v_mov_b32 v24, 0
    v_exp_f32 v206, v206
    v_exp_f32 v207, v207
    s_waitcnt lgkmcnt(2)
    v_mfma_f32_32x32x16_bf16 v[224:239], v[64:67], v[48:51], 0
    v_exp_f32 v208, v208
    v_exp_f32 v209, v209
    v_exp_f32 v210, v210
    v_smfmac_f32_32x32x32_bf16 v[128:143], v[72:75], v[192:199], v9
    v_exp_f32 v211, v211
    v_exp_f32 v212, v212
    v_exp_f32 v213, v213
    v_mfma_f32_32x32x16_bf16 v[224:239], v[68:71], v[52:55], v[224:239]
    v_exp_f32 v214, v214
    v_exp_f32 v215, v215
    v_exp_f32 v216, v216
    v_smfmac_f32_16x16x64_bf16 v[12:15], v[28:31], v[192:199], v9
    v_exp_f32 v217, v217
    v_smfmac_f32_32x32x32_bf16 v[128:143], v[76:79], v[200:207], v9
    v_exp_f32 v218, v218
    v_exp_f32 v219, v219
    v_exp_f32 v220, v220
    v_smfmac_f32_16x16x64_bf16 v[12:15], v[28:31], v[200:207], v9
    v_exp_f32 v221, v221
    v_exp_f32 v222, v222
    v_exp_f32 v223, v223
    s_mov_b32 s66, 0x10000
    s_waitcnt lgkmcnt(0)
    s_cmp_eq_u32 s68, 16
    s_cbranch_scc1 c_k_ok
c_k_poll:
    s_mov_b32 s68, 0
    s_atomic_add s68, s[22:23], s59 offset:0 glc
    s_sub_u32 s66, s66, 1
    s_cselect_b32 s67, 16, 0
    s_waitcnt lgkmcnt(0)
    s_max_u32 s68, s68, s67
    s_cmp_lt_u32 s68, 16
    s_cbranch_scc1 c_k_poll
c_k_ok:
    s_add_u32 s54, s54, 8192
    s_and_b32 s54, s54, 0x1ffff
    s_add_u32 s55, s53, s54
    s_add_u32 s56, s55, 4194304
    buffer_load_dwordx4 v[80:83], v1, s[4:7], s55 offen offset:0 sc1
    buffer_load_dwordx4 v[84:87], v1, s[4:7], s55 offen offset:1024 sc1
    buffer_load_dwordx4 v[88:91], v1, s[4:7], s56 offen offset:0 sc1
    buffer_load_dwordx4 v[92:95], v1, s[4:7], s56 offen offset:1024 sc1
    s_add_u32 s54, s54, 8192
    s_and_b32 s54, s54, 0x1ffff
    s_add_u32 s55, s53, s54
    s_add_u32 s56, s55, 4194304
    buffer_load_dwordx4 v[96:99], v1, s[4:7], s55 offen offset:0 sc1
    buffer_load_dwordx4 v[100:103], v1, s[4:7], s55 offen offset:1024 sc1
    buffer_load_dwordx4 v[104:107], v1, s[4:7], s56 offen offset:0 sc1
    buffer_load_dwordx4 v[108:111], v1, s[4:7], s56 offen offset:1024 sc1
    s_add_u32 s54, s54, 8192
    s_and_b32 s54, s54, 0x1ffff
    s_add_u32 s55, s53, s54
    s_add_u32 s56, s55, 4194304
    buffer_load_dwordx4 v[112:115], v1, s[4:7], s55 offen offset:0 sc1
    buffer_load_dwordx4 v[116:119], v1, s[4:7], s55 offen offset:1024 sc1
    buffer_load_dwordx4 v[120:123], v1, s[4:7], s56 offen offset:0 sc1
    v_mfma_f32_32x32x16_bf16 v[240:255], v[64:67], v[56:59], 0
    v_exp_f32 v224, v224
    v_exp_f32 v225, v225
    v_exp_f32 v226, v226
    v_smfmac_f32_32x32x32_bf16 v[144:159], v[72:75], v[208:215], v9
    v_exp_f32 v227, v227
    v_exp_f32 v228, v228
    v_exp_f32 v229, v229
    v_mfma_f32_32x32x16_bf16 v[240:255], v[68:71], v[60:63], v[240:255]
    v_exp_f32 v230, v230
    v_exp_f32 v231, v231
    v_exp_f32 v232, v232
    v_smfmac_f32_16x16x64_bf16 v[16:19], v[28:31], v[208:215], v9
    v_exp_f32 v233, v233
    v_smfmac_f32_32x32x32_bf16 v[144:159], v[76:79], v[216:223], v9
    v_exp_f32 v234, v234
    v_exp_f32 v235, v235
    v_exp_f32 v236, v236
    v_smfmac_f32_16x16x64_bf16 v[16:19], v[28:31], v[216:223], v9
    v_exp_f32 v237, v237
    v_exp_f32 v238, v238
    v_exp_f32 v239, v239
b_loop:
    s_waitcnt vmcnt(7)
    v_mfma_f32_32x32x16_bf16 v[192:207], v[80:83], v[32:35], 0
    v_exp_f32 v240, v240
    v_exp_f32 v241, v241
    v_exp_f32 v242, v242
    v_smfmac_f32_32x32x32_bf16 v[160:175], v[72:75], v[224:231], v9
    v_exp_f32 v243, v243
    v_exp_f32 v244, v244
    v_exp_f32 v245, v245
    v_mfma_f32_32x32x16_bf16 v[192:207], v[84:87], v[36:39], v[192:207]
    v_exp_f32 v246, v246
    v_exp_f32 v247, v247
    v_exp_f32 v248, v248
    v_smfmac_f32_16x16x64_bf16 v[20:23], v[28:31], v[224:231], v9
    buffer_load_dwordx4 v[124:127], v1, s[4:7], s56 offen offset:1024 sc1
    v_exp_f32 v249, v249
    v_smfmac_f32_32x32x32_bf16 v[160:175], v[76:79], v[232:239], v9
    v_exp_f32 v250, v250
    v_exp_f32 v251, v251
    v_exp_f32 v252, v252
    v_smfmac_f32_16x16x64_bf16 v[20:23], v[28:31], v[232:239], v9
    v_exp_f32 v253, v253
    v_exp_f32 v254, v254
    v_exp_f32 v255, v255
    v_mfma_f32_32x32x16_bf16 v[208:223], v[80:83], v[40:43], 0
    s_add_u32 s54, s54, 8192
    s_and_b32 s54, s54, 0x1ffff
    s_add_u32 s55, s53, s54
    s_add_u32 s56, s55, 4194304
    v_exp_f32 v192, v192
    v_exp_f32 v193, v193
    v_exp_f32 v194, v194
    v_smfmac_f32_32x32x32_bf16 v[176:191], v[72:75], v[240:247], v9
    v_exp_f32 v195, v195
    v_exp_f32 v196, v196
    v_exp_f32 v197, v197
    v_mfma_f32_32x32x16_bf16 v[208:223], v[84:87], v[44:47], v[208:223]
    v_exp_f32 v198, v198
    v_exp_f32 v199, v199
    v_exp_f32 v200, v200
    v_smfmac_f32_16x16x64_bf16 v[24:27], v[28:31], v[240:247], v9
    buffer_load_dwordx4 v[64:67], v1, s[4:7], s55 offen offset:0 sc1
    v_exp_f32 v201, v201
    v_smfmac_f32_32x32x32_bf16 v[176:191], v[76:79], v[248:255], v9
    v_exp_f32 v202, v202
    v_exp_f32 v203, v203
    v_exp_f32 v204, v204
    v_smfmac_f32_16x16x64_bf16 v[24:27], v[28:31], v[248:255], v9
    v_exp_f32 v205, v205
    v_exp_f32 v206, v206
    v_exp_f32 v207, v207
    v_mfma_f32_32x32x16_bf16 v[224:239], v[80:83], v[48:51], 0
    v_exp_f32 v208, v208
    v_exp_f32 v209, v209
    v_exp_f32 v210, v210
    v_smfmac_f32_32x32x32_bf16 v[128:143], v[88:91], v[192:199], v9
    v_exp_f32 v211, v211
    v_exp_f32 v212, v212
    v_exp_f32 v213, v213
    v_mfma_f32_32x32x16_bf16 v[224:239], v[84:87], v[52:55], v[224:239]
    v_exp_f32 v214, v214
    v_exp_f32 v215, v215
    v_exp_f32 v216, v216
    v_smfmac_f32_16x16x64_bf16 v[12:15], v[28:31], v[192:199], v9
    buffer_load_dwordx4 v[68:71], v1, s[4:7], s55 offen offset:1024 sc1
    v_exp_f32 v217, v217
    v_smfmac_f32_32x32x32_bf16 v[128:143], v[92:95], v[200:207], v9
    v_exp_f32 v218, v218
    v_exp_f32 v219, v219
    v_exp_f32 v220, v220
    v_smfmac_f32_16x16x64_bf16 v[12:15], v[28:31], v[200:207], v9
    v_exp_f32 v221, v221
    v_exp_f32 v222, v222
    v_exp_f32 v223, v223
    v_mfma_f32_32x32x16_bf16 v[240:255], v[80:83], v[56:59], 0
    v_exp_f32 v224, v224
    v_exp_f32 v225, v225
    v_exp_f32 v226, v226
    v_smfmac_f32_32x32x32_bf16 v[144:159], v[88:91], v[208:215], v9
    v_exp_f32 v227, v227
    v_exp_f32 v228, v228
    v_exp_f32 v229, v229
    v_mfma_f32_32x32x16_bf16 v[240:255], v[84:87], v[60:63], v[240:255]
    v_exp_f32 v230, v230
    v_exp_f32 v231, v231
    v_exp_f32 v232, v232
    v_smfmac_f32_16x16x64_bf16 v[16:19], v[28:31], v[208:215], v9
    buffer_load_dwordx4 v[72:75], v1, s[4:7], s56 offen offset:0 sc1
    v_exp_f32 v233, v233
    v_smfmac_f32_32x32x32_bf16 v[144:159], v[92:95], v[216:223], v9
    v_exp_f32 v234, v234
    v_exp_f32 v235, v235
    v_exp_f32 v236, v236
    v_smfmac_f32_16x16x64_bf16 v[16:19], v[28:31], v[216:223], v9
    v_exp_f32 v237, v237
    v_exp_f32 v238, v238
    v_exp_f32 v239, v239
    s_waitcnt vmcnt(7)
    v_mfma_f32_32x32x16_bf16 v[192:207], v[96:99], v[32:35], 0
    v_exp_f32 v240, v240
    v_exp_f32 v241, v241
    v_exp_f32 v242, v242
    v_smfmac_f32_32x32x32_bf16 v[160:175], v[88:91], v[224:231], v9
    v_exp_f32 v243, v243
    v_exp_f32 v244, v244
    v_exp_f32 v245, v245
    v_mfma_f32_32x32x16_bf16 v[192:207], v[100:103], v[36:39], v[192:207]
    v_exp_f32 v246, v246
    v_exp_f32 v247, v247
    v_exp_f32 v248, v248
    v_smfmac_f32_16x16x64_bf16 v[20:23], v[28:31], v[224:231], v9
    buffer_load_dwordx4 v[76:79], v1, s[4:7], s56 offen offset:1024 sc1
    v_exp_f32 v249, v249
    v_smfmac_f32_32x32x32_bf16 v[160:175], v[92:95], v[232:239], v9
    v_exp_f32 v250, v250
    v_exp_f32 v251, v251
    v_exp_f32 v252, v252
    v_smfmac_f32_16x16x64_bf16 v[20:23], v[28:31], v[232:239], v9
    v_exp_f32 v253, v253
    v_exp_f32 v254, v254
    v_exp_f32 v255, v255
    v_mfma_f32_32x32x16_bf16 v[208:223], v[96:99], v[40:43], 0
    s_add_u32 s54, s54, 8192
    s_and_b32 s54, s54, 0x1ffff
    s_add_u32 s55, s53, s54
    s_add_u32 s56, s55, 4194304
    v_exp_f32 v192, v192
    v_exp_f32 v193, v193
    v_exp_f32 v194, v194
    v_smfmac_f32_32x32x32_bf16 v[176:191], v[88:91], v[240:247], v9
    v_exp_f32 v195, v195
    v_exp_f32 v196, v196
    v_exp_f32 v197, v197
    v_mfma_f32_32x32x16_bf16 v[208:223], v[100:103], v[44:47], v[208:223]
    v_exp_f32 v198, v198
    v_exp_f32 v199, v199
    v_exp_f32 v200, v200
    v_smfmac_f32_16x16x64_bf16 v[24:27], v[28:31], v[240:247], v9
    buffer_load_dwordx4 v[80:83], v1, s[4:7], s55 offen offset:0 sc1
    v_exp_f32 v201, v201
    v_smfmac_f32_32x32x32_bf16 v[176:191], v[92:95], v[248:255], v9
    v_exp_f32 v202, v202
    v_exp_f32 v203, v203
    v_exp_f32 v204, v204
    v_smfmac_f32_16x16x64_bf16 v[24:27], v[28:31], v[248:255], v9
    v_exp_f32 v205, v205
    v_exp_f32 v206, v206
    v_exp_f32 v207, v207
    v_mfma_f32_32x32x16_bf16 v[224:239], v[96:99], v[48:51], 0
    v_exp_f32 v208, v208
    v_exp_f32 v209, v209
    v_exp_f32 v210, v210
    v_smfmac_f32_32x32x32_bf16 v[128:143], v[104:107], v[192:199], v9
    v_exp_f32 v211, v211
    v_exp_f32 v212, v212
    v_exp_f32 v213, v213
    v_mfma_f32_32x32x16_bf16 v[224:239], v[100:103], v[52:55], v[224:239]
    v_exp_f32 v214, v214
    v_exp_f32 v215, v215
    v_exp_f32 v216, v216
    v_smfmac_f32_16x16x64_bf16 v[12:15], v[28:31], v[192:199], v9
    buffer_load_dwordx4 v[84:87], v1, s[4:7], s55 offen offset:1024 sc1
    v_exp_f32 v217, v217
    v_smfmac_f32_32x32x32_bf16 v[128:143], v[108:111], v[200:207], v9
    v_exp_f32 v218, v218
    v_exp_f32 v219, v219
    v_exp_f32 v220, v220
    v_smfmac_f32_16x16x64_bf16 v[12:15], v[28:31], v[200:207], v9
    v_exp_f32 v221, v221
    v_exp_f32 v222, v222
    v_exp_f32 v223, v223
    v_mfma_f32_32x32x16_bf16 v[240:255], v[96:99], v[56:59], 0
    v_exp_f32 v224, v224
    v_exp_f32 v225, v225
    v_exp_f32 v226, v226
    v_smfmac_f32_32x32x32_bf16 v[144:159], v[104:107], v[208:215], v9
    v_exp_f32 v227, v227
    v_exp_f32 v228, v228
    v_exp_f32 v229, v229
    v_mfma_f32_32x32x16_bf16 v[240:255], v[100:103], v[60:63], v[240:255]
    v_exp_f32 v230, v230
    v_exp_f32 v231, v231
    v_exp_f32 v232, v232
    v_smfmac_f32_16x16x64_bf16 v[16:19], v[28:31], v[208:215], v9
    buffer_load_dwordx4 v[88:91], v1, s[4:7], s56 offen offset:0 sc1
    v_exp_f32 v233, v233
    v_smfmac_f32_32x32x32_bf16 v[144:159], v[108:111], v[216:223], v9
    v_exp_f32 v234, v234
    v_exp_f32 v235, v235
    v_exp_f32 v236, v236
    v_smfmac_f32_16x16x64_bf16 v[16:19], v[28:31], v[216:223], v9
    v_exp_f32 v237, v237
    v_exp_f32 v238, v238
    v_exp_f32 v239, v239
    s_waitcnt vmcnt(7)
    v_mfma_f32_32x32x16_bf16 v[192:207], v[112:115], v[32:35], 0
    v_exp_f32 v240, v240
    v_exp_f32 v241, v241
    v_exp_f32 v242, v242
    v_smfmac_f32_32x32x32_bf16 v[160:175], v[104:107], v[224:231], v9
    v_exp_f32 v243, v243
    v_exp_f32 v244, v244
    v_exp_f32 v245, v245
    v_mfma_f32_32x32x16_bf16 v[192:207], v[116:119], v[36:39], v[192:207]
    v_exp_f32 v246, v246
    v_exp_f32 v247, v247
    v_exp_f32 v248, v248
    v_smfmac_f32_16x16x64_bf16 v[20:23], v[28:31], v[224:231], v9
    buffer_load_dwordx4 v[92:95], v1, s[4:7], s56 offen offset:1024 sc1
    v_exp_f32 v249, v249
    v_smfmac_f32_32x32x32_bf16 v[160:175], v[108:111], v[232:239], v9
    v_exp_f32 v250, v250
    v_exp_f32 v251, v251
    v_exp_f32 v252, v252
    v_smfmac_f32_16x16x64_bf16 v[20:23], v[28:31], v[232:239], v9
    v_exp_f32 v253, v253
    v_exp_f32 v254, v254
    v_exp_f32 v255, v255
    v_mfma_f32_32x32x16_bf16 v[208:223], v[112:115], v[40:43], 0
    s_add_u32 s54, s54, 8192
    s_and_b32 s54, s54, 0x1ffff
    s_add_u32 s55, s53, s54
    s_add_u32 s56, s55, 4194304
    v_exp_f32 v192, v192
    v_exp_f32 v193, v193
    v_exp_f32 v194, v194
    v_smfmac_f32_32x32x32_bf16 v[176:191], v[104:107], v[240:247], v9
    v_exp_f32 v195, v195
    v_exp_f32 v196, v196
    v_exp_f32 v197, v197
    v_mfma_f32_32x32x16_bf16 v[208:223], v[116:119], v[44:47], v[208:223]
    v_exp_f32 v198, v198
    v_exp_f32 v199, v199
    v_exp_f32 v200, v200
    v_smfmac_f32_16x16x64_bf16 v[24:27], v[28:31], v[240:247], v9
    buffer_load_dwordx4 v[96:99], v1, s[4:7], s55 offen offset:0 sc1
    v_exp_f32 v201, v201
    v_smfmac_f32_32x32x32_bf16 v[176:191], v[108:111], v[248:255], v9
    v_exp_f32 v202, v202
    v_exp_f32 v203, v203
    v_exp_f32 v204, v204
    v_smfmac_f32_16x16x64_bf16 v[24:27], v[28:31], v[248:255], v9
    v_exp_f32 v205, v205
    v_exp_f32 v206, v206
    v_exp_f32 v207, v207
    v_mfma_f32_32x32x16_bf16 v[224:239], v[112:115], v[48:51], 0
    v_exp_f32 v208, v208
    v_exp_f32 v209, v209
    v_exp_f32 v210, v210
    v_smfmac_f32_32x32x32_bf16 v[128:143], v[120:123], v[192:199], v9
    v_exp_f32 v211, v211
    v_exp_f32 v212, v212
    v_exp_f32 v213, v213
    v_mfma_f32_32x32x16_bf16 v[224:239], v[116:119], v[52:55], v[224:239]
    v_exp_f32 v214, v214
    v_exp_f32 v215, v215
    v_exp_f32 v216, v216
    v_smfmac_f32_16x16x64_bf16 v[12:15], v[28:31], v[192:199], v9
    buffer_load_dwordx4 v[100:103], v1, s[4:7], s55 offen offset:1024 sc1
    v_exp_f32 v217, v217
    v_smfmac_f32_32x32x32_bf16 v[128:143], v[124:127], v[200:207], v9
    v_exp_f32 v218, v218
    v_exp_f32 v219, v219
    v_exp_f32 v220, v220
    v_smfmac_f32_16x16x64_bf16 v[12:15], v[28:31], v[200:207], v9
    v_exp_f32 v221, v221
    v_exp_f32 v222, v222
    v_exp_f32 v223, v223
    v_mfma_f32_32x32x16_bf16 v[240:255], v[112:115], v[56:59], 0
    v_exp_f32 v224, v224
    v_exp_f32 v225, v225
    v_exp_f32 v226, v226
    v_smfmac_f32_32x32x32_bf16 v[144:159], v[120:123], v[208:215], v9
    v_exp_f32 v227, v227
    v_exp_f32 v228, v228
    v_exp_f32 v229, v229
    v_mfma_f32_32x32x16_bf16 v[240:255], v[116:119], v[60:63], v[240:255]
    v_exp_f32 v230, v230
    v_exp_f32 v231, v231
    v_exp_f32 v232, v232
    v_smfmac_f32_16x16x64_bf16 v[16:19], v[28:31], v[208:215], v9
    buffer_load_dwordx4 v[104:107], v1, s[4:7], s56 offen offset:0 sc1
    v_exp_f32 v233, v233
    v_smfmac_f32_32x32x32_bf16 v[144:159], v[124:127], v[216:223], v9
    v_exp_f32 v234, v234
    v_exp_f32 v235, v235
    v_exp_f32 v236, v236
    v_smfmac_f32_16x16x64_bf16 v[16:19], v[28:31], v[216:223], v9
    v_exp_f32 v237, v237
    v_exp_f32 v238, v238
    v_exp_f32 v239, v239
    s_waitcnt vmcnt(7)
    v_mfma_f32_32x32x16_bf16 v[192:207], v[64:67], v[32:35], 0
    v_exp_f32 v240, v240
    v_exp_f32 v241, v241
    v_exp_f32 v242, v242
    v_smfmac_f32_32x32x32_bf16 v[160:175], v[120:123], v[224:231], v9
    v_exp_f32 v243, v243
    v_exp_f32 v244, v244
    v_exp_f32 v245, v245
    v_mfma_f32_32x32x16_bf16 v[192:207], v[68:71], v[36:39], v[192:207]
    v_exp_f32 v246, v246
    v_exp_f32 v247, v247
    v_exp_f32 v248, v248
    v_smfmac_f32_16x16x64_bf16 v[20:23], v[28:31], v[224:231], v9
    buffer_load_dwordx4 v[108:111], v1, s[4:7], s56 offen offset:1024 sc1
    v_exp_f32 v249, v249
    v_smfmac_f32_32x32x32_bf16 v[160:175], v[124:127], v[232:239], v9
    v_exp_f32 v250, v250
    v_exp_f32 v251, v251
    v_exp_f32 v252, v252
    v_smfmac_f32_16x16x64_bf16 v[20:23], v[28:31], v[232:239], v9
    v_exp_f32 v253, v253
    v_exp_f32 v254, v254
    v_exp_f32 v255, v255
    v_mfma_f32_32x32x16_bf16 v[208:223], v[64:67], v[40:43], 0
    s_add_u32 s54, s54, 8192
    s_and_b32 s54, s54, 0x1ffff
    s_add_u32 s55, s53, s54
    s_add_u32 s56, s55, 4194304
    v_exp_f32 v192, v192
    v_exp_f32 v193, v193
    v_exp_f32 v194, v194
    v_smfmac_f32_32x32x32_bf16 v[176:191], v[120:123], v[240:247], v9
    v_exp_f32 v195, v195
    v_exp_f32 v196, v196
    v_exp_f32 v197, v197
    v_mfma_f32_32x32x16_bf16 v[208:223], v[68:71], v[44:47], v[208:223]
    v_exp_f32 v198, v198
    v_exp_f32 v199, v199
    v_exp_f32 v200, v200
    v_smfmac_f32_16x16x64_bf16 v[24:27], v[28:31], v[240:247], v9
    buffer_load_dwordx4 v[112:115], v1, s[4:7], s55 offen offset:0 sc1
    v_exp_f32 v201, v201
    v_smfmac_f32_32x32x32_bf16 v[176:191], v[124:127], v[248:255], v9
    v_exp_f32 v202, v202
    v_exp_f32 v203, v203
    v_exp_f32 v204, v204
    v_smfmac_f32_16x16x64_bf16 v[24:27], v[28:31], v[248:255], v9
    v_exp_f32 v205, v205
    v_exp_f32 v206, v206
    v_exp_f32 v207, v207
    v_mfma_f32_32x32x16_bf16 v[224:239], v[64:67], v[48:51], 0
    v_exp_f32 v208, v208
    v_exp_f32 v209, v209
    v_exp_f32 v210, v210
    v_smfmac_f32_32x32x32_bf16 v[128:143], v[72:75], v[192:199], v9
    v_exp_f32 v211, v211
    v_exp_f32 v212, v212
    v_exp_f32 v213, v213
    v_mfma_f32_32x32x16_bf16 v[224:239], v[68:71], v[52:55], v[224:239]
    v_exp_f32 v214, v214
    v_exp_f32 v215, v215
    v_exp_f32 v216, v216
    v_smfmac_f32_16x16x64_bf16 v[12:15], v[28:31], v[192:199], v9
    buffer_load_dwordx4 v[116:119], v1, s[4:7], s55 offen offset:1024 sc1
    v_exp_f32 v217, v217
    v_smfmac_f32_32x32x32_bf16 v[128:143], v[76:79], v[200:207], v9
    v_exp_f32 v218, v218
    v_exp_f32 v219, v219
    v_exp_f32 v220, v220
    v_smfmac_f32_16x16x64_bf16 v[12:15], v[28:31], v[200:207], v9
    v_exp_f32 v221, v221
    v_exp_f32 v222, v222
    v_exp_f32 v223, v223
    v_mfma_f32_32x32x16_bf16 v[240:255], v[64:67], v[56:59], 0
    v_exp_f32 v224, v224
    v_exp_f32 v225, v225
    v_exp_f32 v226, v226
    v_smfmac_f32_32x32x32_bf16 v[144:159], v[72:75], v[208:215], v9
    v_exp_f32 v227, v227
    v_exp_f32 v228, v228
    v_exp_f32 v229, v229
    v_mfma_f32_32x32x16_bf16 v[240:255], v[68:71], v[60:63], v[240:255]
    v_exp_f32 v230, v230
    v_exp_f32 v231, v231
    v_exp_f32 v232, v232
    v_smfmac_f32_16x16x64_bf16 v[16:19], v[28:31], v[208:215], v9
    buffer_load_dwordx4 v[120:123], v1, s[4:7], s56 offen offset:0 sc1
    v_exp_f32 v233, v233
    v_smfmac_f32_32x32x32_bf16 v[144:159], v[76:79], v[216:223], v9
    v_exp_f32 v234, v234
    v_exp_f32 v235, v235
    v_exp_f32 v236, v236
    v_smfmac_f32_16x16x64_bf16 v[16:19], v[28:31], v[216:223], v9
    v_exp_f32 v237, v237
    v_exp_f32 v238, v238
    v_exp_f32 v239, v239
    s_sub_u32 s58, s58, 1
    s_cmp_eq_u32 s58, 0
    s_cbranch_scc1 b_last
    s_cmp_eq_u32 s39, 0
    s_cbranch_scc1 b_loop
    s_barrier
    s_branch b_loop
b_last:
    s_waitcnt vmcnt(7)
    v_mfma_f32_32x32x16_bf16 v[192:207], v[80:83], v[32:35], 0
    v_exp_f32 v240, v240
    v_exp_f32 v241, v241
    v_exp_f32 v242, v242
    v_smfmac_f32_32x32x32_bf16 v[160:175], v[72:75], v[224:231], v9
    v_exp_f32 v243, v243
    v_exp_f32 v244, v244
    v_exp_f32 v245, v245
    v_mfma_f32_32x32x16_bf16 v[192:207], v[84:87], v[36:39], v[192:207]
    v_exp_f32 v246, v246
    v_exp_f32 v247, v247
    v_exp_f32 v248, v248
    v_smfmac_f32_16x16x64_bf16 v[20:23], v[28:31], v[224:231], v9
    buffer_load_dwordx4 v[124:127], v1, s[4:7], s56 offen offset:1024 sc1
    v_exp_f32 v249, v249
    v_smfmac_f32_32x32x32_bf16 v[160:175], v[76:79], v[232:239], v9
    v_exp_f32 v250, v250
    v_exp_f32 v251, v251
    v_exp_f32 v252, v252
    v_smfmac_f32_16x16x64_bf16 v[20:23], v[28:31], v[232:239], v9
    v_exp_f32 v253, v253
    v_exp_f32 v254, v254
    v_exp_f32 v255, v255
    v_mfma_f32_32x32x16_bf16 v[208:223], v[80:83], v[40:43], 0
    v_exp_f32 v192, v192
    v_exp_f32 v193, v193
    v_exp_f32 v194, v194
    v_smfmac_f32_32x32x32_bf16 v[176:191], v[72:75], v[240:247], v9
    v_exp_f32 v195, v195
    v_exp_f32 v196, v196
    v_exp_f32 v197, v197
    v_mfma_f32_32x32x16_bf16 v[208:223], v[84:87], v[44:47], v[208:223]
    v_exp_f32 v198, v198
    v_exp_f32 v199, v199
    v_exp_f32 v200, v200
    v_smfmac_f32_16x16x64_bf16 v[24:27], v[28:31], v[240:247], v9
    v_exp_f32 v201, v201
    v_smfmac_f32_32x32x32_bf16 v[176:191], v[76:79], v[248:255], v9
    v_exp_f32 v202, v202
    v_exp_f32 v203, v203
    v_exp_f32 v204, v204
    v_smfmac_f32_16x16x64_bf16 v[24:27], v[28:31], v[248:255], v9
    v_exp_f32 v205, v205
    v_exp_f32 v206, v206
    v_exp_f32 v207, v207
    v_mfma_f32_32x32x16_bf16 v[224:239], v[80:83], v[48:51], 0
    v_exp_f32 v208, v208
    v_exp_f32 v209, v209
    v_exp_f32 v210, v210
    v_smfmac_f32_32x32x32_bf16 v[128:143], v[88:91], v[192:199], v9
    v_exp_f32 v211, v211
    v_exp_f32 v212, v212
    v_exp_f32 v213, v213
    v_mfma_f32_32x32x16_bf16 v[224:239], v[84:87], v[52:55], v[224:239]
    v_exp_f32 v214, v214
    v_exp_f32 v215, v215
    v_exp_f32 v216, v216
    v_smfmac_f32_16x16x64_bf16 v[12:15], v[28:31], v[192:199], v9
    v_exp_f32 v217, v217
    v_smfmac_f32_32x32x32_bf16 v[128:143], v[92:95], v[200:207], v9
    v_exp_f32 v218, v218
    v_exp_f32 v219, v219
    v_exp_f32 v220, v220
    v_smfmac_f32_16x16x64_bf16 v[12:15], v[28:31], v[200:207], v9
    v_exp_f32 v221, v221
    v_exp_f32 v222, v222
    v_exp_f32 v223, v223
    v_mfma_f32_32x32x16_bf16 v[240:255], v[80:83], v[56:59], 0
    v_exp_f32 v224, v224
    v_exp_f32 v225, v225
    v_exp_f32 v226, v226
    v_smfmac_f32_32x32x32_bf16 v[144:159], v[88:91], v[208:215], v9
    v_exp_f32 v227, v227
    v_exp_f32 v228, v228
    v_exp_f32 v229, v229
    v_mfma_f32_32x32x16_bf16 v[240:255], v[84:87], v[60:63], v[240:255]
    v_exp_f32 v230, v230
    v_exp_f32 v231, v231
    v_exp_f32 v232, v232
    v_smfmac_f32_16x16x64_bf16 v[16:19], v[28:31], v[208:215], v9
    v_exp_f32 v233, v233
    v_smfmac_f32_32x32x32_bf16 v[144:159], v[92:95], v[216:223], v9
    v_exp_f32 v234, v234
    v_exp_f32 v235, v235
    v_exp_f32 v236, v236
    v_smfmac_f32_16x16x64_bf16 v[16:19], v[28:31], v[216:223], v9
    v_exp_f32 v237, v237
    v_exp_f32 v238, v238
    v_exp_f32 v239, v239
    s_waitcnt vmcnt(4)
    v_mfma_f32_32x32x16_bf16 v[192:207], v[96:99], v[32:35], 0
    v_exp_f32 v240, v240
    v_exp_f32 v241, v241
    v_exp_f32 v242, v242
    v_smfmac_f32_32x32x32_bf16 v[160:175], v[88:91], v[224:231], v9
    v_exp_f32 v243, v243
    v_exp_f32 v244, v244
    v_exp_f32 v245, v245
    v_mfma_f32_32x32x16_bf16 v[192:207], v[100:103], v[36:39], v[192:207]
    v_exp_f32 v246, v246
    v_exp_f32 v247, v247
    v_exp_f32 v248, v248
    v_smfmac_f32_16x16x64_bf16 v[20:23], v[28:31], v[224:231], v9
    v_exp_f32 v249, v249
    v_smfmac_f32_32x32x32_bf16 v[160:175], v[92:95], v[232:239], v9
    v_exp_f32 v250, v250
    v_exp_f32 v251, v251
    v_exp_f32 v252, v252
    v_smfmac_f32_16x16x64_bf16 v[20:23], v[28:31], v[232:239], v9
    v_exp_f32 v253, v253
    v_exp_f32 v254, v254
    v_exp_f32 v255, v255
    v_mfma_f32_32x32x16_bf16 v[208:223], v[96:99], v[40:43], 0
    v_exp_f32 v192, v192
    v_exp_f32 v193, v193
    v_exp_f32 v194, v194
    v_smfmac_f32_32x32x32_bf16 v[176:191], v[88:91], v[240:247], v9
    v_exp_f32 v195, v195
    v_exp_f32 v196, v196
    v_exp_f32 v197, v197
    v_mfma_f32_32x32x16_bf16 v[208:223], v[100:103], v[44:47], v[208:223]
    v_exp_f32 v198, v198
    v_exp_f32 v199, v199
    v_exp_f32 v200, v200
    v_smfmac_f32_16x16x64_bf16 v[24:27], v[28:31], v[240:247], v9
    v_exp_f32 v201, v201
    v_smfmac_f32_32x32x32_bf16 v[176:191], v[92:95], v[248:255], v9
    v_exp_f32 v202, v202
    v_exp_f32 v203, v203
    v_exp_f32 v204, v204
    v_smfmac_f32_16x16x64_bf16 v[24:27], v[28:31], v[248:255], v9
    v_exp_f32 v205, v205
    v_exp_f32 v206, v206
    v_exp_f32 v207, v207
    v_mfma_f32_32x32x16_bf16 v[224:239], v[96:99], v[48:51], 0
    v_exp_f32 v208, v208
    v_exp_f32 v209, v209
    v_exp_f32 v210, v210
    v_smfmac_f32_32x32x32_bf16 v[128:143], v[104:107], v[192:199], v9
    v_exp_f32 v211, v211
    v_exp_f32 v212, v212
    v_exp_f32 v213, v213
    v_mfma_f32_32x32x16_bf16 v[224:239], v[100:103], v[52:55], v[224:239]
    v_exp_f32 v214, v214
    v_exp_f32 v215, v215
    v_exp_f32 v216, v216
    v_smfmac_f32_16x16x64_bf16 v[12:15], v[28:31], v[192:199], v9
    v_exp_f32 v217, v217
    v_smfmac_f32_32x32x32_bf16 v[128:143], v[108:111], v[200:207], v9
    v_exp_f32 v218, v218
    v_exp_f32 v219, v219
    v_exp_f32 v220, v220
    v_smfmac_f32_16x16x64_bf16 v[12:15], v[28:31], v[200:207], v9
    v_exp_f32 v221, v221
    v_exp_f32 v222, v222
    v_exp_f32 v223, v223
    v_mfma_f32_32x32x16_bf16 v[240:255], v[96:99], v[56:59], 0
    v_exp_f32 v224, v224
    v_exp_f32 v225, v225
    v_exp_f32 v226, v226
    v_smfmac_f32_32x32x32_bf16 v[144:159], v[104:107], v[208:215], v9
    v_exp_f32 v227, v227
    v_exp_f32 v228, v228
    v_exp_f32 v229, v229
    v_mfma_f32_32x32x16_bf16 v[240:255], v[100:103], v[60:63], v[240:255]
    v_exp_f32 v230, v230
    v_exp_f32 v231, v231
    v_exp_f32 v232, v232
    v_smfmac_f32_16x16x64_bf16 v[16:19], v[28:31], v[208:215], v9
    v_exp_f32 v233, v233
    v_smfmac_f32_32x32x32_bf16 v[144:159], v[108:111], v[216:223], v9
    v_exp_f32 v234, v234
    v_exp_f32 v235, v235
    v_exp_f32 v236, v236
    v_smfmac_f32_16x16x64_bf16 v[16:19], v[28:31], v[216:223], v9
    v_exp_f32 v237, v237
    v_exp_f32 v238, v238
    v_exp_f32 v239, v239
    s_waitcnt vmcnt(0)
    v_mfma_f32_32x32x16_bf16 v[192:207], v[112:115], v[32:35], 0
    v_exp_f32 v240, v240
    v_exp_f32 v241, v241
    v_exp_f32 v242, v242
    v_smfmac_f32_32x32x32_bf16 v[160:175], v[104:107], v[224:231], v9
    v_exp_f32 v243, v243
    v_exp_f32 v244, v244
    v_exp_f32 v245, v245
    v_mfma_f32_32x32x16_bf16 v[192:207], v[116:119], v[36:39], v[192:207]
    v_exp_f32 v246, v246
    v_exp_f32 v247, v247
    v_exp_f32 v248, v248
    v_smfmac_f32_16x16x64_bf16 v[20:23], v[28:31], v[224:231], v9
    v_exp_f32 v249, v249
    v_smfmac_f32_32x32x32_bf16 v[160:175], v[108:111], v[232:239], v9
    v_exp_f32 v250, v250
    v_exp_f32 v251, v251
    v_exp_f32 v252, v252
    v_smfmac_f32_16x16x64_bf16 v[20:23], v[28:31], v[232:239], v9
    v_exp_f32 v253, v253
    v_exp_f32 v254, v254
    v_exp_f32 v255, v255
    v_mfma_f32_32x32x16_bf16 v[208:223], v[112:115], v[40:43], 0
    v_exp_f32 v192, v192
    v_exp_f32 v193, v193
    v_exp_f32 v194, v194
    v_smfmac_f32_32x32x32_bf16 v[176:191], v[104:107], v[240:247], v9
    v_exp_f32 v195, v195
    v_exp_f32 v196, v196
    v_exp_f32 v197, v197
    v_mfma_f32_32x32x16_bf16 v[208:223], v[116:119], v[44:47], v[208:223]
    v_exp_f32 v198, v198
    v_exp_f32 v199, v199
    v_exp_f32 v200, v200
    v_smfmac_f32_16x16x64_bf16 v[24:27], v[28:31], v[240:247], v9
    v_exp_f32 v201, v201
    v_smfmac_f32_32x32x32_bf16 v[176:191], v[108:111], v[248:255], v9
    v_exp_f32 v202, v202
    v_exp_f32 v203, v203
    v_exp_f32 v204, v204
    v_smfmac_f32_16x16x64_bf16 v[24:27], v[28:31], v[248:255], v9
    v_exp_f32 v205, v205
    v_exp_f32 v206, v206
    v_exp_f32 v207, v207
    v_mfma_f32_32x32x16_bf16 v[224:239], v[112:115], v[48:51], 0
    v_exp_f32 v208, v208
    v_exp_f32 v209, v209
    v_exp_f32 v210, v210
    v_smfmac_f32_32x32x32_bf16 v[128:143], v[120:123], v[192:199], v9
    v_exp_f32 v211, v211
    v_exp_f32 v212, v212
    v_exp_f32 v213, v213
    v_mfma_f32_32x32x16_bf16 v[224:239], v[116:119], v[52:55], v[224:239]
    v_exp_f32 v214, v214
    v_exp_f32 v215, v215
    v_exp_f32 v216, v216
    v_smfmac_f32_16x16x64_bf16 v[12:15], v[28:31], v[192:199], v9
    v_exp_f32 v217, v217
    v_smfmac_f32_32x32x32_bf16 v[128:143], v[124:127], v[200:207], v9
    v_exp_f32 v218, v218
    v_exp_f32 v219, v219
    v_exp_f32 v220, v220
    v_smfmac_f32_16x16x64_bf16 v[12:15], v[28:31], v[200:207], v9
    v_exp_f32 v221, v221
    v_exp_f32 v222, v222
    v_exp_f32 v223, v223
    v_mfma_f32_32x32x16_bf16 v[240:255], v[112:115], v[56:59], 0
    v_exp_f32 v224, v224
    v_exp_f32 v225, v225
    v_exp_f32 v226, v226
    v_smfmac_f32_32x32x32_bf16 v[144:159], v[120:123], v[208:215], v9
    ds_write_b128 v5, v[128:131] offset:0
    v_exp_f32 v227, v227
    v_exp_f32 v228, v228
    v_exp_f32 v229, v229
    v_mfma_f32_32x32x16_bf16 v[240:255], v[116:119], v[60:63], v[240:255]
    ds_write_b128 v5, v[132:135] offset:1024
    v_exp_f32 v230, v230
    v_exp_f32 v231, v231
    v_exp_f32 v232, v232
    v_smfmac_f32_16x16x64_bf16 v[16:19], v[28:31], v[208:215], v9
    ds_write_b32 v6, v12 offset:0
    v_exp_f32 v233, v233
    v_smfmac_f32_32x32x32_bf16 v[144:159], v[124:127], v[216:223], v9
    ds_write_b128 v5, v[136:139] offset:2048
    v_exp_f32 v234, v234
    v_exp_f32 v235, v235
    v_exp_f32 v236, v236
    v_smfmac_f32_16x16x64_bf16 v[16:19], v[28:31], v[216:223], v9
    ds_write_b128 v5, v[140:143] offset:3072
    v_exp_f32 v237, v237
    v_exp_f32 v238, v238
    v_exp_f32 v239, v239
    v_exp_f32 v240, v240
    v_exp_f32 v241, v241
    v_exp_f32 v242, v242
    v_smfmac_f32_32x32x32_bf16 v[160:175], v[120:123], v[224:231], v9
    ds_write_b128 v5, v[144:147] offset:16384
    v_exp_f32 v243, v243
    v_exp_f32 v244, v244
    v_exp_f32 v245, v245
    ds_write_b128 v5, v[148:151] offset:17408
    v_exp_f32 v246, v246
    v_exp_f32 v247, v247
    v_exp_f32 v248, v248
    v_smfmac_f32_16x16x64_bf16 v[20:23], v[28:31], v[224:231], v9
    ds_write_b32 v6, v16 offset:1024
    v_exp_f32 v249, v249
    v_smfmac_f32_32x32x32_bf16 v[160:175], v[124:127], v[232:239], v9
    ds_write_b128 v5, v[152:155] offset:18432
    v_exp_f32 v250, v250
    v_exp_f32 v251, v251
    v_exp_f32 v252, v252
    v_smfmac_f32_16x16x64_bf16 v[20:23], v[28:31], v[232:239], v9
    ds_write_b128 v5, v[156:159] offset:19456
    v_exp_f32 v253, v253
    v_exp_f32 v254, v254
    v_exp_f32 v255, v255
    v_smfmac_f32_32x32x32_bf16 v[176:191], v[120:123], v[240:247], v9
    s_nop 0
    v_smfmac_f32_32x32x32_bf16 v[176:191], v[124:127], v[248:255], v9
    ds_write_b128 v5, v[160:163] offset:32768
    ds_write_b128 v5, v[164:167] offset:33792
    v_smfmac_f32_16x16x64_bf16 v[24:27], v[28:31], v[240:247], v9
    ds_write_b128 v5, v[168:171] offset:34816
    v_smfmac_f32_16x16x64_bf16 v[24:27], v[28:31], v[248:255], v9
    ds_write_b128 v5, v[172:175] offset:35840
    ds_write_b32 v6, v20 offset:2048
    s_nop 4
    ds_write_b128 v5, v[176:179] offset:49152
    ds_write_b128 v5, v[180:183] offset:50176
    ds_write_b128 v5, v[184:187] offset:51200
    ds_write_b128 v5, v[188:191] offset:52224
    s_nop 0
    ds_write_b32 v6, v24 offset:3072
    s_cmp_eq_u32 s39, 0
    s_cbranch_scc1 s_att_done
    buffer_load_dwordx4 v[224:227], v2, s[4:7], s43 offen offset:0 sc1
    buffer_load_dwordx4 v[228:231], v2, s[4:7], s43 offen offset:256 sc1
    buffer_load_dwordx4 v[232:235], v2, s[4:7], s43 offen offset:2048 sc1
    buffer_load_dwordx4 v[236:239], v2, s[4:7], s43 offen offset:2304 sc1
    s_waitcnt lgkmcnt(0)
    s_barrier
    v_xor_b32 v4, 32, v3
    v_xor_b32 v5, 64, v3
    v_xor_b32 v6, 96, v3
c_wo:
    s_xor_b32 s42, s41, 0
    buffer_load_dwordx4 v[64:67], v2, s[4:7], s42 offen offset:0 sc1
    buffer_load_dwordx4 v[68:71], v2, s[4:7], s42 offen offset:256 sc1
    s_xor_b32 s42, s41, 4096
    buffer_load_dwordx4 v[72:75], v2, s[4:7], s42 offen offset:0 sc1
    buffer_load_dwordx4 v[76:79], v2, s[4:7], s42 offen offset:256 sc1
    s_xor_b32 s42, s41, 8192
    buffer_load_dwordx4 v[80:83], v2, s[4:7], s42 offen offset:0 sc1
    buffer_load_dwordx4 v[84:87], v2, s[4:7], s42 offen offset:256 sc1
    s_xor_b32 s42, s41, 12288
    buffer_load_dwordx4 v[88:91], v2, s[4:7], s42 offen offset:0 sc1
    buffer_load_dwordx4 v[92:95], v2, s[4:7], s42 offen offset:256 sc1
    s_xor_b32 s42, s41, 16384
    buffer_load_dwordx4 v[96:99], v2, s[4:7], s42 offen offset:0 sc1
    buffer_load_dwordx4 v[100:103], v2, s[4:7], s42 offen offset:256 sc1
    ds_read_b64_tr_b16 v[32:33], v3 offset:0
    ds_read_b64_tr_b16 v[34:35], v3 offset:1024
    ds_read_b64_tr_b16 v[36:37], v4 offset:0
    ds_read_b64_tr_b16 v[38:39], v4 offset:1024
    ds_read_b64_tr_b16 v[40:41], v5 offset:0
    ds_read_b64_tr_b16 v[42:43], v5 offset:1024
    ds_read_b64_tr_b16 v[44:45], v6 offset:0
    ds_read_b64_tr_b16 v[46:47], v6 offset:1024
    ds_read_b64_tr_b16 v[48:49], v3 offset:4096
    ds_read_b64_tr_b16 v[50:51], v3 offset:5120
    ds_read_b64_tr_b16 v[52:53], v4 offset:4096
    ds_read_b64_tr_b16 v[54:55], v4 offset:5120
    ds_read_b64_tr_b16 v[56:57], v5 offset:4096
    ds_read_b64_tr_b16 v[58:59], v5 offset:5120
    v_lshrrev_b32 v12, 4, v1
    v_and_b32 v13, 1, v12
    v_lshlrev_b32 v13, 4, v13
    v_mov_b32 v14, 0x3f80
    v_lshlrev_b32 v13, v13, v14
    v_lshrrev_b32 v14, 2, v12
    v_lshrrev_b32 v15, 4, v12
    v_xor_b32 v14, v14, v15
    v_and_b32 v14, 1, v14
    v_bfe_u32 v15, v12, 3, 1
    v_bfe_u32 v16, v12, 1, 1
    v_lshl_add_u32 v15, v15, 1, v16
    v_lshrrev_b32 v16, 5, v12
    v_lshl_add_u32 v15, v16, 2, v15
    v_lshl_add_u32 v15, v14, 3, v15
    v_cmp_eq_u32 vcc, 0, v15
    s_nop 1
    v_cndmask_b32 v240, 0, v13, vcc
    v_cmp_eq_u32 vcc, 1, v15
    s_nop 1
    v_cndmask_b32 v241, 0, v13, vcc
    v_cmp_eq_u32 vcc, 2, v15
    s_nop 1
    v_cndmask_b32 v242, 0, v13, vcc
    v_cmp_eq_u32 vcc, 3, v15
    s_nop 1
    v_cndmask_b32 v243, 0, v13, vcc
    v_cmp_eq_u32 vcc, 4, v15
    s_nop 1
    v_cndmask_b32 v244, 0, v13, vcc
    v_cmp_eq_u32 vcc, 5, v15
    s_nop 1
    v_cndmask_b32 v245, 0, v13, vcc
    v_cmp_eq_u32 vcc, 6, v15
    s_nop 1
    v_cndmask_b32 v246, 0, v13, vcc
    v_cmp_eq_u32 vcc, 7, v15
    s_nop 1
    v_cndmask_b32 v247, 0, v13, vcc
    s_mov_b32 s8, s32
    s_mov_b32 s9, s33
    s_mov_b32 s10, 4194304
    s_mov_b32 s11, 0x00020000
    s_mul_i32 s49, s16, 4608
    s_add_u32 s49, s49, 131072
    v_and_b32 v13, 15, v12
    v_mul_u32_u24 v13, 144, v13
    v_lshrrev_b32 v14, 4, v12
    v_lshl_add_u32 v13, v14, 3, v13
    v_add_u32 v17, s49, v13
    v_lshrrev_b32 v14, 3, v12
    v_and_b32 v15, 7, v12
    v_mul_u32_u24 v16, 144, v14
    v_lshl_add_u32 v16, v15, 4, v16
    v_add_u32 v18, s49, v16
    v_lshlrev_b32 v19, 11, v14
    v_lshl_add_u32 v19, v15, 4, v19
    s_lshl_b32 s50, s38, 16
    s_lshl_b32 s49, s18, 7
    s_add_u32 s50, s50, s49
    s_waitcnt vmcnt(10)
    v_mfma_f32_16x16x32_bf16 v[128:131], v[240:243], v[224:227], 0
    v_mfma_f32_16x16x32_bf16 v[132:135], v[240:243], v[228:231], 0
    v_mfma_f32_16x16x32_bf16 v[136:139], v[244:247], v[224:227], 0
    v_mfma_f32_16x16x32_bf16 v[140:143], v[244:247], v[228:231], 0
    v_mfma_f32_16x16x32_bf16 v[144:147], v[240:243], v[232:235], 0
    v_mfma_f32_16x16x32_bf16 v[148:151], v[240:243], v[236:239], 0
    v_mfma_f32_16x16x32_bf16 v[152:155], v[244:247], v[232:235], 0
    v_mfma_f32_16x16x32_bf16 v[156:159], v[244:247], v[236:239], 0
    s_waitcnt vmcnt(8) lgkmcnt(10)
    v_mfma_f32_16x16x32_bf16 v[128:131], v[32:35], v[64:67], v[128:131]
    ds_read_b64_tr_b16 v[60:61], v6 offset:4096
    s_xor_b32 s42, s41, 20480
    buffer_load_dwordx4 v[104:107], v2, s[4:7], s42 offen offset:0 sc1
    v_mfma_f32_16x16x32_bf16 v[132:135], v[32:35], v[68:71], v[132:135]
    ds_read_b64_tr_b16 v[62:63], v6 offset:5120
    v_mfma_f32_16x16x32_bf16 v[136:139], v[36:39], v[64:67], v[136:139]
    ds_read_b64_tr_b16 v[32:33], v3 offset:8192
    v_mfma_f32_16x16x32_bf16 v[140:143], v[36:39], v[68:71], v[140:143]
    ds_read_b64_tr_b16 v[34:35], v3 offset:9216
    s_waitcnt lgkmcnt(10)
    v_mfma_f32_16x16x32_bf16 v[144:147], v[40:43], v[64:67], v[144:147]
    buffer_load_dwordx4 v[108:111], v2, s[4:7], s42 offen offset:256 sc1
    ds_read_b64_tr_b16 v[36:37], v4 offset:8192
    s_xor_b32 s42, s41, 24576
    v_mfma_f32_16x16x32_bf16 v[148:151], v[40:43], v[68:71], v[148:151]
    ds_read_b64_tr_b16 v[38:39], v4 offset:9216
    v_mfma_f32_16x16x32_bf16 v[152:155], v[44:47], v[64:67], v[152:155]
    ds_read_b64_tr_b16 v[40:41], v5 offset:8192
    v_mfma_f32_16x16x32_bf16 v[156:159], v[44:47], v[68:71], v[156:159]
    ds_read_b64_tr_b16 v[42:43], v5 offset:9216
    s_waitcnt vmcnt(8) lgkmcnt(10)
    v_mfma_f32_16x16x32_bf16 v[128:131], v[48:51], v[72:75], v[128:131]
    buffer_load_dwordx4 v[112:115], v2, s[4:7], s42 offen offset:0 sc1
    ds_read_b64_tr_b16 v[44:45], v6 offset:8192
    v_mfma_f32_16x16x32_bf16 v[132:135], v[48:51], v[76:79], v[132:135]
    ds_read_b64_tr_b16 v[46:47], v6 offset:9216
    v_mfma_f32_16x16x32_bf16 v[136:139], v[52:55], v[72:75], v[136:139]
    ds_read_b64_tr_b16 v[48:49], v3 offset:12288
    v_mfma_f32_16x16x32_bf16 v[140:143], v[52:55], v[76:79], v[140:143]
    ds_read_b64_tr_b16 v[50:51], v3 offset:13312
    s_waitcnt lgkmcnt(10)
    v_mfma_f32_16x16x32_bf16 v[144:147], v[56:59], v[72:75], v[144:147]
    buffer_load_dwordx4 v[116:119], v2, s[4:7], s42 offen offset:256 sc1
    ds_read_b64_tr_b16 v[52:53], v4 offset:12288
    s_xor_b32 s42, s41, 28672
    v_mfma_f32_16x16x32_bf16 v[148:151], v[56:59], v[76:79], v[148:151]
    ds_read_b64_tr_b16 v[54:55], v4 offset:13312
    v_mfma_f32_16x16x32_bf16 v[152:155], v[60:63], v[72:75], v[152:155]
    ds_read_b64_tr_b16 v[56:57], v5 offset:12288
    v_mfma_f32_16x16x32_bf16 v[156:159], v[60:63], v[76:79], v[156:159]
    ds_read_b64_tr_b16 v[58:59], v5 offset:13312
    s_waitcnt vmcnt(8) lgkmcnt(10)
    v_mfma_f32_16x16x32_bf16 v[128:131], v[32:35], v[80:83], v[128:131]
    ds_read_b64_tr_b16 v[60:61], v6 offset:12288
    buffer_load_dwordx4 v[120:123], v2, s[4:7], s42 offen offset:0 sc1
    v_mfma_f32_16x16x32_bf16 v[132:135], v[32:35], v[84:87], v[132:135]
    ds_read_b64_tr_b16 v[62:63], v6 offset:13312
    v_mfma_f32_16x16x32_bf16 v[136:139], v[36:39], v[80:83], v[136:139]
    ds_read_b64_tr_b16 v[32:33], v3 offset:16384
    v_mfma_f32_16x16x32_bf16 v[140:143], v[36:39], v[84:87], v[140:143]
    ds_read_b64_tr_b16 v[34:35], v3 offset:17408
    s_waitcnt lgkmcnt(10)
    v_mfma_f32_16x16x32_bf16 v[144:147], v[40:43], v[80:83], v[144:147]
    buffer_load_dwordx4 v[124:127], v2, s[4:7], s42 offen offset:256 sc1
    ds_read_b64_tr_b16 v[36:37], v4 offset:16384
    s_xor_b32 s42, s41, 32768
    v_mfma_f32_16x16x32_bf16 v[148:151], v[40:43], v[84:87], v[148:151]
    ds_read_b64_tr_b16 v[38:39], v4 offset:17408
    v_mfma_f32_16x16x32_bf16 v[152:155], v[44:47], v[80:83], v[152:155]
    ds_read_b64_tr_b16 v[40:41], v5 offset:16384
    v_mfma_f32_16x16x32_bf16 v[156:159], v[44:47], v[84:87], v[156:159]
    ds_read_b64_tr_b16 v[42:43], v5 offset:17408
    s_waitcnt vmcnt(8) lgkmcnt(10)
    v_mfma_f32_16x16x32_bf16 v[128:131], v[48:51], v[88:91], v[128:131]
    buffer_load_dwordx4 v[160:163], v2, s[4:7], s42 offen offset:0 sc1
    ds_read_b64_tr_b16 v[44:45], v6 offset:16384
    v_mfma_f32_16x16x32_bf16 v[132:135], v[48:51], v[92:95], v[132:135]
    ds_read_b64_tr_b16 v[46:47], v6 offset:17408
    v_mfma_f32_16x16x32_bf16 v[136:139], v[52:55], v[88:91], v[136:139]
    ds_read_b64_tr_b16 v[48:49], v3 offset:20480
    v_mfma_f32_16x16x32_bf16 v[140:143], v[52:55], v[92:95], v[140:143]
    ds_read_b64_tr_b16 v[50:51], v3 offset:21504
    s_waitcnt lgkmcnt(10)
    v_mfma_f32_16x16x32_bf16 v[144:147], v[56:59], v[88:91], v[144:147]
    buffer_load_dwordx4 v[164:167], v2, s[4:7], s42 offen offset:256 sc1
    ds_read_b64_tr_b16 v[52:53], v4 offset:20480
    s_xor_b32 s42, s41, 36864
    v_mfma_f32_16x16x32_bf16 v[148:151], v[56:59], v[92:95], v[148:151]
    ds_read_b64_tr_b16 v[54:55], v4 offset:21504
    v_mfma_f32_16x16x32_bf16 v[152:155], v[60:63], v[88:91], v[152:155]
    ds_read_b64_tr_b16 v[56:57], v5 offset:20480
    v_mfma_f32_16x16x32_bf16 v[156:159], v[60:63], v[92:95], v[156:159]
    ds_read_b64_tr_b16 v[58:59], v5 offset:21504
    s_waitcnt vmcnt(8) lgkmcnt(10)
    v_mfma_f32_16x16x32_bf16 v[128:131], v[32:35], v[96:99], v[128:131]
    ds_read_b64_tr_b16 v[60:61], v6 offset:20480
    buffer_load_dwordx4 v[168:171], v2, s[4:7], s42 offen offset:0 sc1
    v_mfma_f32_16x16x32_bf16 v[132:135], v[32:35], v[100:103], v[132:135]
    ds_read_b64_tr_b16 v[62:63], v6 offset:21504
    v_mfma_f32_16x16x32_bf16 v[136:139], v[36:39], v[96:99], v[136:139]
    ds_read_b64_tr_b16 v[32:33], v3 offset:24576
    v_mfma_f32_16x16x32_bf16 v[140:143], v[36:39], v[100:103], v[140:143]
    ds_read_b64_tr_b16 v[34:35], v3 offset:25600
    s_waitcnt lgkmcnt(10)
    v_mfma_f32_16x16x32_bf16 v[144:147], v[40:43], v[96:99], v[144:147]
    buffer_load_dwordx4 v[172:175], v2, s[4:7], s42 offen offset:256 sc1
    ds_read_b64_tr_b16 v[36:37], v4 offset:24576
    s_xor_b32 s42, s41, 40960
    v_mfma_f32_16x16x32_bf16 v[148:151], v[40:43], v[100:103], v[148:151]
    ds_read_b64_tr_b16 v[38:39], v4 offset:25600
    v_mfma_f32_16x16x32_bf16 v[152:155], v[44:47], v[96:99], v[152:155]
    ds_read_b64_tr_b16 v[40:41], v5 offset:24576
    v_mfma_f32_16x16x32_bf16 v[156:159], v[44:47], v[100:103], v[156:159]
    ds_read_b64_tr_b16 v[42:43], v5 offset:25600
    s_waitcnt vmcnt(8) lgkmcnt(10)
    v_mfma_f32_16x16x32_bf16 v[128:131], v[48:51], v[104:107], v[128:131]
    buffer_load_dwordx4 v[176:179], v2, s[4:7], s42 offen offset:0 sc1
    ds_read_b64_tr_b16 v[44:45], v6 offset:24576
    v_mfma_f32_16x16x32_bf16 v[132:135], v[48:51], v[108:111], v[132:135]
    ds_read_b64_tr_b16 v[46:47], v6 offset:25600
    v_mfma_f32_16x16x32_bf16 v[136:139], v[52:55], v[104:107], v[136:139]
    ds_read_b64_tr_b16 v[48:49], v3 offset:28672
    v_mfma_f32_16x16x32_bf16 v[140:143], v[52:55], v[108:111], v[140:143]
    ds_read_b64_tr_b16 v[50:51], v3 offset:29696
    s_waitcnt lgkmcnt(10)
    v_mfma_f32_16x16x32_bf16 v[144:147], v[56:59], v[104:107], v[144:147]
    buffer_load_dwordx4 v[180:183], v2, s[4:7], s42 offen offset:256 sc1
    ds_read_b64_tr_b16 v[52:53], v4 offset:28672
    s_xor_b32 s42, s41, 45056
    v_mfma_f32_16x16x32_bf16 v[148:151], v[56:59], v[108:111], v[148:151]
    ds_read_b64_tr_b16 v[54:55], v4 offset:29696
    v_mfma_f32_16x16x32_bf16 v[152:155], v[60:63], v[104:107], v[152:155]
    ds_read_b64_tr_b16 v[56:57], v5 offset:28672
    v_mfma_f32_16x16x32_bf16 v[156:159], v[60:63], v[108:111], v[156:159]
    ds_read_b64_tr_b16 v[58:59], v5 offset:29696
    s_waitcnt vmcnt(8) lgkmcnt(10)
    v_mfma_f32_16x16x32_bf16 v[128:131], v[32:35], v[112:115], v[128:131]
    ds_read_b64_tr_b16 v[60:61], v6 offset:28672
    buffer_load_dwordx4 v[184:187], v2, s[4:7], s42 offen offset:0 sc1
    v_mfma_f32_16x16x32_bf16 v[132:135], v[32:35], v[116:119], v[132:135]
    ds_read_b64_tr_b16 v[62:63], v6 offset:29696
    v_mfma_f32_16x16x32_bf16 v[136:139], v[36:39], v[112:115], v[136:139]
    ds_read_b64_tr_b16 v[32:33], v3 offset:32768
    v_mfma_f32_16x16x32_bf16 v[140:143], v[36:39], v[116:119], v[140:143]
    ds_read_b64_tr_b16 v[34:35], v3 offset:33792
    s_waitcnt lgkmcnt(10)
    v_mfma_f32_16x16x32_bf16 v[144:147], v[40:43], v[112:115], v[144:147]
    buffer_load_dwordx4 v[188:191], v2, s[4:7], s42 offen offset:256 sc1
    ds_read_b64_tr_b16 v[36:37], v4 offset:32768
    s_xor_b32 s42, s41, 49152
    v_mfma_f32_16x16x32_bf16 v[148:151], v[40:43], v[116:119], v[148:151]
    ds_read_b64_tr_b16 v[38:39], v4 offset:33792
    v_mfma_f32_16x16x32_bf16 v[152:155], v[44:47], v[112:115], v[152:155]
    ds_read_b64_tr_b16 v[40:41], v5 offset:32768
    v_mfma_f32_16x16x32_bf16 v[156:159], v[44:47], v[116:119], v[156:159]
    ds_read_b64_tr_b16 v[42:43], v5 offset:33792
    s_waitcnt vmcnt(8) lgkmcnt(10)
    v_mfma_f32_16x16x32_bf16 v[128:131], v[48:51], v[120:123], v[128:131]
    buffer_load_dwordx4 v[64:67], v2, s[4:7], s42 offen offset:0 sc1
    ds_read_b64_tr_b16 v[44:45], v6 offset:32768
    v_mfma_f32_16x16x32_bf16 v[132:135], v[48:51], v[124:127], v[132:135]
    ds_read_b64_tr_b16 v[46:47], v6 offset:33792
    v_mfma_f32_16x16x32_bf16 v[136:139], v[52:55], v[120:123], v[136:139]
    ds_read_b64_tr_b16 v[48:49], v3 offset:36864
    v_mfma_f32_16x16x32_bf16 v[140:143], v[52:55], v[124:127], v[140:143]
    ds_read_b64_tr_b16 v[50:51], v3 offset:37888
    s_waitcnt lgkmcnt(10)
    v_mfma_f32_16x16x32_bf16 v[144:147], v[56:59], v[120:123], v[144:147]
    buffer_load_dwordx4 v[68:71], v2, s[4:7], s42 offen offset:256 sc1
    ds_read_b64_tr_b16 v[52:53], v4 offset:36864
    s_xor_b32 s42, s41, 53248
    v_mfma_f32_16x16x32_bf16 v[148:151], v[56:59], v[124:127], v[148:151]
    ds_read_b64_tr_b16 v[54:55], v4 offset:37888
    v_mfma_f32_16x16x32_bf16 v[152:155], v[60:63], v[120:123], v[152:155]
    ds_read_b64_tr_b16 v[56:57], v5 offset:36864
    v_mfma_f32_16x16x32_bf16 v[156:159], v[60:63], v[124:127], v[156:159]
    ds_read_b64_tr_b16 v[58:59], v5 offset:37888
    s_waitcnt vmcnt(8) lgkmcnt(10)
    v_mfma_f32_16x16x32_bf16 v[128:131], v[32:35], v[160:163], v[128:131]
    ds_read_b64_tr_b16 v[60:61], v6 offset:36864
    buffer_load_dwordx4 v[72:75], v2, s[4:7], s42 offen offset:0 sc1
    v_mfma_f32_16x16x32_bf16 v[132:135], v[32:35], v[164:167], v[132:135]
    ds_read_b64_tr_b16 v[62:63], v6 offset:37888
    v_mfma_f32_16x16x32_bf16 v[136:139], v[36:39], v[160:163], v[136:139]
    ds_read_b64_tr_b16 v[32:33], v3 offset:40960
    v_mfma_f32_16x16x32_bf16 v[140:143], v[36:39], v[164:167], v[140:143]
    ds_read_b64_tr_b16 v[34:35], v3 offset:41984
    s_waitcnt lgkmcnt(10)
    v_mfma_f32_16x16x32_bf16 v[144:147], v[40:43], v[160:163], v[144:147]
    buffer_load_dwordx4 v[76:79], v2, s[4:7], s42 offen offset:256 sc1
    ds_read_b64_tr_b16 v[36:37], v4 offset:40960
    s_xor_b32 s42, s41, 57344
    v_mfma_f32_16x16x32_bf16 v[148:151], v[40:43], v[164:167], v[148:151]
    ds_read_b64_tr_b16 v[38:39], v4 offset:41984
    v_mfma_f32_16x16x32_bf16 v[152:155], v[44:47], v[160:163], v[152:155]
    ds_read_b64_tr_b16 v[40:41], v5 offset:40960
    v_mfma_f32_16x16x32_bf16 v[156:159], v[44:47], v[164:167], v[156:159]
    ds_read_b64_tr_b16 v[42:43], v5 offset:41984
    s_waitcnt vmcnt(8) lgkmcnt(10)
    v_mfma_f32_16x16x32_bf16 v[128:131], v[48:51], v[168:171], v[128:131]
    buffer_load_dwordx4 v[80:83], v2, s[4:7], s42 offen offset:0 sc1
    ds_read_b64_tr_b16 v[44:45], v6 offset:40960
    v_mfma_f32_16x16x32_bf16 v[132:135], v[48:51], v[172:175], v[132:135]
    ds_read_b64_tr_b16 v[46:47], v6 offset:41984
    v_mfma_f32_16x16x32_bf16 v[136:139], v[52:55], v[168:171], v[136:139]
    ds_read_b64_tr_b16 v[48:49], v3 offset:45056
    v_mfma_f32_16x16x32_bf16 v[140:143], v[52:55], v[172:175], v[140:143]
    ds_read_b64_tr_b16 v[50:51], v3 offset:46080
    s_waitcnt lgkmcnt(10)
    v_mfma_f32_16x16x32_bf16 v[144:147], v[56:59], v[168:171], v[144:147]
    buffer_load_dwordx4 v[84:87], v2, s[4:7], s42 offen offset:256 sc1
    ds_read_b64_tr_b16 v[52:53], v4 offset:45056
    s_xor_b32 s42, s41, 61440
    v_mfma_f32_16x16x32_bf16 v[148:151], v[56:59], v[172:175], v[148:151]
    ds_read_b64_tr_b16 v[54:55], v4 offset:46080
    v_mfma_f32_16x16x32_bf16 v[152:155], v[60:63], v[168:171], v[152:155]
    ds_read_b64_tr_b16 v[56:57], v5 offset:45056
    v_mfma_f32_16x16x32_bf16 v[156:159], v[60:63], v[172:175], v[156:159]
    ds_read_b64_tr_b16 v[58:59], v5 offset:46080
    s_waitcnt vmcnt(8) lgkmcnt(10)
    v_mfma_f32_16x16x32_bf16 v[128:131], v[32:35], v[176:179], v[128:131]
    ds_read_b64_tr_b16 v[60:61], v6 offset:45056
    buffer_load_dwordx4 v[88:91], v2, s[4:7], s42 offen offset:0 sc1
    v_mfma_f32_16x16x32_bf16 v[132:135], v[32:35], v[180:183], v[132:135]
    ds_read_b64_tr_b16 v[62:63], v6 offset:46080
    s_barrier
    v_mfma_f32_16x16x32_bf16 v[136:139], v[36:39], v[176:179], v[136:139]
    ds_read_b64_tr_b16 v[32:33], v3 offset:49152
    v_mfma_f32_16x16x32_bf16 v[140:143], v[36:39], v[180:183], v[140:143]
    ds_read_b64_tr_b16 v[34:35], v3 offset:50176
    s_waitcnt lgkmcnt(10)
    v_mfma_f32_16x16x32_bf16 v[144:147], v[40:43], v[176:179], v[144:147]
    buffer_load_dwordx4 v[92:95], v2, s[4:7], s42 offen offset:256 sc1
    ds_read_b64_tr_b16 v[36:37], v4 offset:49152
    s_xor_b32 s42, s41, 0
    v_mfma_f32_16x16x32_bf16 v[148:151], v[40:43], v[180:183], v[148:151]
    ds_read_b64_tr_b16 v[38:39], v4 offset:50176
    v_mfma_f32_16x16x32_bf16 v[152:155], v[44:47], v[176:179], v[152:155]
    ds_read_b64_tr_b16 v[40:41], v5 offset:49152
    v_mfma_f32_16x16x32_bf16 v[156:159], v[44:47], v[180:183], v[156:159]
    ds_read_b64_tr_b16 v[42:43], v5 offset:50176
    s_waitcnt vmcnt(8) lgkmcnt(10)
    v_mfma_f32_16x16x32_bf16 v[128:131], v[48:51], v[184:187], v[128:131]
    buffer_load_dwordx4 v[96:99], v2, s[4:7], s42 offen offset:2048 sc1
    ds_read_b64_tr_b16 v[44:45], v6 offset:49152
    v_mfma_f32_16x16x32_bf16 v[132:135], v[48:51], v[188:191], v[132:135]
    ds_read_b64_tr_b16 v[46:47], v6 offset:50176
    v_mfma_f32_16x16x32_bf16 v[136:139], v[52:55], v[184:187], v[136:139]
    ds_read_b64_tr_b16 v[48:49], v3 offset:53248
    v_mfma_f32_16x16x32_bf16 v[140:143], v[52:55], v[188:191], v[140:143]
    ds_read_b64_tr_b16 v[50:51], v3 offset:54272
    s_waitcnt lgkmcnt(10)
    v_mfma_f32_16x16x32_bf16 v[144:147], v[56:59], v[184:187], v[144:147]
    buffer_load_dwordx4 v[100:103], v2, s[4:7], s42 offen offset:2304 sc1
    ds_read_b64_tr_b16 v[52:53], v4 offset:53248
    s_xor_b32 s42, s41, 4096
    v_mfma_f32_16x16x32_bf16 v[148:151], v[56:59], v[188:191], v[148:151]
    ds_read_b64_tr_b16 v[54:55], v4 offset:54272
    v_mfma_f32_16x16x32_bf16 v[152:155], v[60:63], v[184:187], v[152:155]
    ds_read_b64_tr_b16 v[56:57], v5 offset:53248
    v_mfma_f32_16x16x32_bf16 v[156:159], v[60:63], v[188:191], v[156:159]
    ds_read_b64_tr_b16 v[58:59], v5 offset:54272
    s_waitcnt vmcnt(8) lgkmcnt(10)
    v_mfma_f32_16x16x32_bf16 v[128:131], v[32:35], v[64:67], v[128:131]
    ds_read_b64_tr_b16 v[60:61], v6 offset:53248
    buffer_load_dwordx4 v[104:107], v2, s[4:7], s42 offen offset:2048 sc1
    v_mfma_f32_16x16x32_bf16 v[132:135], v[32:35], v[68:71], v[132:135]
    ds_read_b64_tr_b16 v[62:63], v6 offset:54272
    v_mfma_f32_16x16x32_bf16 v[136:139], v[36:39], v[64:67], v[136:139]
    ds_read_b64_tr_b16 v[32:33], v3 offset:57344
    v_mfma_f32_16x16x32_bf16 v[140:143], v[36:39], v[68:71], v[140:143]
    ds_read_b64_tr_b16 v[34:35], v3 offset:58368
    s_waitcnt lgkmcnt(10)
    v_mfma_f32_16x16x32_bf16 v[144:147], v[40:43], v[64:67], v[144:147]
    buffer_load_dwordx4 v[108:111], v2, s[4:7], s42 offen offset:2304 sc1
    ds_read_b64_tr_b16 v[36:37], v4 offset:57344
    s_xor_b32 s42, s41, 8192
    v_mfma_f32_16x16x32_bf16 v[148:151], v[40:43], v[68:71], v[148:151]
    ds_read_b64_tr_b16 v[38:39], v4 offset:58368
    v_mfma_f32_16x16x32_bf16 v[152:155], v[44:47], v[64:67], v[152:155]
    ds_read_b64_tr_b16 v[40:41], v5 offset:57344
    v_mfma_f32_16x16x32_bf16 v[156:159], v[44:47], v[68:71], v[156:159]
    ds_read_b64_tr_b16 v[42:43], v5 offset:58368
    s_waitcnt vmcnt(8) lgkmcnt(10)
    v_mfma_f32_16x16x32_bf16 v[128:131], v[48:51], v[72:75], v[128:131]
    buffer_load_dwordx4 v[112:115], v2, s[4:7], s42 offen offset:2048 sc1
    ds_read_b64_tr_b16 v[44:45], v6 offset:57344
    v_mfma_f32_16x16x32_bf16 v[132:135], v[48:51], v[76:79], v[132:135]
    ds_read_b64_tr_b16 v[46:47], v6 offset:58368
    v_mfma_f32_16x16x32_bf16 v[136:139], v[52:55], v[72:75], v[136:139]
    ds_read_b64_tr_b16 v[48:49], v3 offset:61440
    v_mfma_f32_16x16x32_bf16 v[140:143], v[52:55], v[76:79], v[140:143]
    ds_read_b64_tr_b16 v[50:51], v3 offset:62464
    s_waitcnt lgkmcnt(10)
    v_mfma_f32_16x16x32_bf16 v[144:147], v[56:59], v[72:75], v[144:147]
    buffer_load_dwordx4 v[116:119], v2, s[4:7], s42 offen offset:2304 sc1
    ds_read_b64_tr_b16 v[52:53], v4 offset:61440
    s_xor_b32 s42, s41, 12288
    v_mfma_f32_16x16x32_bf16 v[148:151], v[56:59], v[76:79], v[148:151]
    ds_read_b64_tr_b16 v[54:55], v4 offset:62464
    v_mfma_f32_16x16x32_bf16 v[152:155], v[60:63], v[72:75], v[152:155]
    ds_read_b64_tr_b16 v[56:57], v5 offset:61440
    v_mfma_f32_16x16x32_bf16 v[156:159], v[60:63], v[76:79], v[156:159]
    ds_read_b64_tr_b16 v[58:59], v5 offset:62464
    s_waitcnt vmcnt(8) lgkmcnt(10)
    v_mfma_f32_16x16x32_bf16 v[128:131], v[32:35], v[80:83], v[128:131]
    ds_read_b64_tr_b16 v[60:61], v6 offset:61440
    buffer_load_dwordx4 v[120:123], v2, s[4:7], s42 offen offset:2048 sc1
    v_mfma_f32_16x16x32_bf16 v[132:135], v[32:35], v[84:87], v[132:135]
    ds_read_b64_tr_b16 v[62:63], v6 offset:62464
    v_xor_b32 v3, 0x10000, v3
    v_xor_b32 v4, 0x10000, v4
    v_xor_b32 v5, 0x10000, v5
    v_xor_b32 v6, 0x10000, v6
    v_mfma_f32_16x16x32_bf16 v[136:139], v[36:39], v[80:83], v[136:139]
    ds_read_b64_tr_b16 v[32:33], v3 offset:0
    v_mfma_f32_16x16x32_bf16 v[140:143], v[36:39], v[84:87], v[140:143]
    ds_read_b64_tr_b16 v[34:35], v3 offset:1024
    s_waitcnt lgkmcnt(10)
    v_mfma_f32_16x16x32_bf16 v[144:147], v[40:43], v[80:83], v[144:147]
    buffer_load_dwordx4 v[124:127], v2, s[4:7], s42 offen offset:2304 sc1
    ds_read_b64_tr_b16 v[36:37], v4 offset:0
    s_xor_b32 s42, s41, 16384
    v_mfma_f32_16x16x32_bf16 v[148:151], v[40:43], v[84:87], v[148:151]
    ds_read_b64_tr_b16 v[38:39], v4 offset:1024
    v_mfma_f32_16x16x32_bf16 v[152:155], v[44:47], v[80:83], v[152:155]
    ds_read_b64_tr_b16 v[40:41], v5 offset:0
    v_mfma_f32_16x16x32_bf16 v[156:159], v[44:47], v[84:87], v[156:159]
    ds_read_b64_tr_b16 v[42:43], v5 offset:1024
    s_waitcnt vmcnt(8) lgkmcnt(10)
    v_mfma_f32_16x16x32_bf16 v[128:131], v[48:51], v[88:91], v[128:131]
    buffer_load_dwordx4 v[160:163], v2, s[4:7], s42 offen offset:2048 sc1
    ds_read_b64_tr_b16 v[44:45], v6 offset:0
    v_mfma_f32_16x16x32_bf16 v[132:135], v[48:51], v[92:95], v[132:135]
    ds_read_b64_tr_b16 v[46:47], v6 offset:1024
    v_mfma_f32_16x16x32_bf16 v[136:139], v[52:55], v[88:91], v[136:139]
    ds_read_b64_tr_b16 v[48:49], v3 offset:4096
    v_mfma_f32_16x16x32_bf16 v[140:143], v[52:55], v[92:95], v[140:143]
    ds_read_b64_tr_b16 v[50:51], v3 offset:5120
    s_waitcnt lgkmcnt(10)
    v_mfma_f32_16x16x32_bf16 v[144:147], v[56:59], v[88:91], v[144:147]
    buffer_load_dwordx4 v[164:167], v2, s[4:7], s42 offen offset:2304 sc1
    ds_read_b64_tr_b16 v[52:53], v4 offset:4096
    s_xor_b32 s42, s41, 20480
    v_mfma_f32_16x16x32_bf16 v[148:151], v[56:59], v[92:95], v[148:151]
    ds_read_b64_tr_b16 v[54:55], v4 offset:5120
    v_mfma_f32_16x16x32_bf16 v[152:155], v[60:63], v[88:91], v[152:155]
    ds_read_b64_tr_b16 v[56:57], v5 offset:4096
    v_mfma_f32_16x16x32_bf16 v[156:159], v[60:63], v[92:95], v[156:159]
    ds_read_b64_tr_b16 v[58:59], v5 offset:5120
    s_waitcnt vmcnt(8) lgkmcnt(10)
    v_mfma_f32_16x16x32_bf16 v[128:131], v[32:35], v[96:99], v[128:131]
    ds_read_b64_tr_b16 v[60:61], v6 offset:4096
    buffer_load_dwordx4 v[168:171], v2, s[4:7], s42 offen offset:2048 sc1
    v_mfma_f32_16x16x32_bf16 v[132:135], v[32:35], v[100:103], v[132:135]
    ds_read_b64_tr_b16 v[62:63], v6 offset:5120
    v_mfma_f32_16x16x32_bf16 v[136:139], v[36:39], v[96:99], v[136:139]
    ds_read_b64_tr_b16 v[32:33], v3 offset:8192
    v_mfma_f32_16x16x32_bf16 v[140:143], v[36:39], v[100:103], v[140:143]
    ds_read_b64_tr_b16 v[34:35], v3 offset:9216
    s_waitcnt lgkmcnt(10)
    v_mfma_f32_16x16x32_bf16 v[144:147], v[40:43], v[96:99], v[144:147]
    buffer_load_dwordx4 v[172:175], v2, s[4:7], s42 offen offset:2304 sc1
    ds_read_b64_tr_b16 v[36:37], v4 offset:8192
    s_xor_b32 s42, s41, 24576
    v_mfma_f32_16x16x32_bf16 v[148:151], v[40:43], v[100:103], v[148:151]
    ds_read_b64_tr_b16 v[38:39], v4 offset:9216
    v_mfma_f32_16x16x32_bf16 v[152:155], v[44:47], v[96:99], v[152:155]
    ds_read_b64_tr_b16 v[40:41], v5 offset:8192
    v_mfma_f32_16x16x32_bf16 v[156:159], v[44:47], v[100:103], v[156:159]
    ds_read_b64_tr_b16 v[42:43], v5 offset:9216
    s_waitcnt vmcnt(8) lgkmcnt(10)
    v_mfma_f32_16x16x32_bf16 v[128:131], v[48:51], v[104:107], v[128:131]
    buffer_load_dwordx4 v[176:179], v2, s[4:7], s42 offen offset:2048 sc1
    ds_read_b64_tr_b16 v[44:45], v6 offset:8192
    v_mfma_f32_16x16x32_bf16 v[132:135], v[48:51], v[108:111], v[132:135]
    ds_read_b64_tr_b16 v[46:47], v6 offset:9216
    v_mfma_f32_16x16x32_bf16 v[136:139], v[52:55], v[104:107], v[136:139]
    ds_read_b64_tr_b16 v[48:49], v3 offset:12288
    v_mfma_f32_16x16x32_bf16 v[140:143], v[52:55], v[108:111], v[140:143]
    ds_read_b64_tr_b16 v[50:51], v3 offset:13312
    s_waitcnt lgkmcnt(10)
    v_mfma_f32_16x16x32_bf16 v[144:147], v[56:59], v[104:107], v[144:147]
    buffer_load_dwordx4 v[180:183], v2, s[4:7], s42 offen offset:2304 sc1
    ds_read_b64_tr_b16 v[52:53], v4 offset:12288
    s_xor_b32 s42, s41, 28672
    v_mfma_f32_16x16x32_bf16 v[148:151], v[56:59], v[108:111], v[148:151]
    ds_read_b64_tr_b16 v[54:55], v4 offset:13312
    v_mfma_f32_16x16x32_bf16 v[152:155], v[60:63], v[104:107], v[152:155]
    ds_read_b64_tr_b16 v[56:57], v5 offset:12288
    v_mfma_f32_16x16x32_bf16 v[156:159], v[60:63], v[108:111], v[156:159]
    ds_read_b64_tr_b16 v[58:59], v5 offset:13312
    s_waitcnt vmcnt(8) lgkmcnt(10)
    v_mfma_f32_16x16x32_bf16 v[128:131], v[32:35], v[112:115], v[128:131]
    ds_read_b64_tr_b16 v[60:61], v6 offset:12288
    buffer_load_dwordx4 v[184:187], v2, s[4:7], s42 offen offset:2048 sc1
    v_mfma_f32_16x16x32_bf16 v[132:135], v[32:35], v[116:119], v[132:135]
    ds_read_b64_tr_b16 v[62:63], v6 offset:13312
    v_mfma_f32_16x16x32_bf16 v[136:139], v[36:39], v[112:115], v[136:139]
    ds_read_b64_tr_b16 v[32:33], v3 offset:16384
    v_mfma_f32_16x16x32_bf16 v[140:143], v[36:39], v[116:119], v[140:143]
    ds_read_b64_tr_b16 v[34:35], v3 offset:17408
    s_waitcnt lgkmcnt(10)
    v_mfma_f32_16x16x32_bf16 v[144:147], v[40:43], v[112:115], v[144:147]
    buffer_load_dwordx4 v[188:191], v2, s[4:7], s42 offen offset:2304 sc1
    ds_read_b64_tr_b16 v[36:37], v4 offset:16384
    s_xor_b32 s42, s41, 32768
    v_mfma_f32_16x16x32_bf16 v[148:151], v[40:43], v[116:119], v[148:151]
    ds_read_b64_tr_b16 v[38:39], v4 offset:17408
    v_mfma_f32_16x16x32_bf16 v[152:155], v[44:47], v[112:115], v[152:155]
    ds_read_b64_tr_b16 v[40:41], v5 offset:16384
    v_mfma_f32_16x16x32_bf16 v[156:159], v[44:47], v[116:119], v[156:159]
    ds_read_b64_tr_b16 v[42:43], v5 offset:17408
    s_waitcnt vmcnt(8) lgkmcnt(10)
    v_mfma_f32_16x16x32_bf16 v[128:131], v[48:51], v[120:123], v[128:131]
    buffer_load_dwordx4 v[64:67], v2, s[4:7], s42 offen offset:2048 sc1
    ds_read_b64_tr_b16 v[44:45], v6 offset:16384
    v_mfma_f32_16x16x32_bf16 v[132:135], v[48:51], v[124:127], v[132:135]
    ds_read_b64_tr_b16 v[46:47], v6 offset:17408
    v_mfma_f32_16x16x32_bf16 v[136:139], v[52:55], v[120:123], v[136:139]
    ds_read_b64_tr_b16 v[48:49], v3 offset:20480
    v_mfma_f32_16x16x32_bf16 v[140:143], v[52:55], v[124:127], v[140:143]
    ds_read_b64_tr_b16 v[50:51], v3 offset:21504
    s_waitcnt lgkmcnt(10)
    v_mfma_f32_16x16x32_bf16 v[144:147], v[56:59], v[120:123], v[144:147]
    buffer_load_dwordx4 v[68:71], v2, s[4:7], s42 offen offset:2304 sc1
    ds_read_b64_tr_b16 v[52:53], v4 offset:20480
    s_xor_b32 s42, s41, 36864
    v_mfma_f32_16x16x32_bf16 v[148:151], v[56:59], v[124:127], v[148:151]
    ds_read_b64_tr_b16 v[54:55], v4 offset:21504
    v_mfma_f32_16x16x32_bf16 v[152:155], v[60:63], v[120:123], v[152:155]
    ds_read_b64_tr_b16 v[56:57], v5 offset:20480
    v_mfma_f32_16x16x32_bf16 v[156:159], v[60:63], v[124:127], v[156:159]
    ds_read_b64_tr_b16 v[58:59], v5 offset:21504
    s_waitcnt vmcnt(8) lgkmcnt(10)
    v_mfma_f32_16x16x32_bf16 v[128:131], v[32:35], v[160:163], v[128:131]
    ds_read_b64_tr_b16 v[60:61], v6 offset:20480
    buffer_load_dwordx4 v[72:75], v2, s[4:7], s42 offen offset:2048 sc1
    v_mfma_f32_16x16x32_bf16 v[132:135], v[32:35], v[164:167], v[132:135]
    ds_read_b64_tr_b16 v[62:63], v6 offset:21504
    v_mfma_f32_16x16x32_bf16 v[136:139], v[36:39], v[160:163], v[136:139]
    ds_read_b64_tr_b16 v[32:33], v3 offset:24576
    v_mfma_f32_16x16x32_bf16 v[140:143], v[36:39], v[164:167], v[140:143]
    ds_read_b64_tr_b16 v[34:35], v3 offset:25600
    s_waitcnt lgkmcnt(10)
    v_mfma_f32_16x16x32_bf16 v[144:147], v[40:43], v[160:163], v[144:147]
    buffer_load_dwordx4 v[76:79], v2, s[4:7], s42 offen offset:2304 sc1
    ds_read_b64_tr_b16 v[36:37], v4 offset:24576
    s_xor_b32 s42, s41, 40960
    v_mfma_f32_16x16x32_bf16 v[148:151], v[40:43], v[164:167], v[148:151]
    ds_read_b64_tr_b16 v[38:39], v4 offset:25600
    v_mfma_f32_16x16x32_bf16 v[152:155], v[44:47], v[160:163], v[152:155]
    ds_read_b64_tr_b16 v[40:41], v5 offset:24576
    v_mfma_f32_16x16x32_bf16 v[156:159], v[44:47], v[164:167], v[156:159]
    ds_read_b64_tr_b16 v[42:43], v5 offset:25600
    s_waitcnt vmcnt(8) lgkmcnt(10)
    v_mfma_f32_16x16x32_bf16 v[128:131], v[48:51], v[168:171], v[128:131]
    buffer_load_dwordx4 v[80:83], v2, s[4:7], s42 offen offset:2048 sc1
    ds_read_b64_tr_b16 v[44:45], v6 offset:24576
    v_mfma_f32_16x16x32_bf16 v[132:135], v[48:51], v[172:175], v[132:135]
    ds_read_b64_tr_b16 v[46:47], v6 offset:25600
    v_mfma_f32_16x16x32_bf16 v[136:139], v[52:55], v[168:171], v[136:139]
    ds_read_b64_tr_b16 v[48:49], v3 offset:28672
    v_mfma_f32_16x16x32_bf16 v[140:143], v[52:55], v[172:175], v[140:143]
    ds_read_b64_tr_b16 v[50:51], v3 offset:29696
    s_waitcnt lgkmcnt(10)
    v_mfma_f32_16x16x32_bf16 v[144:147], v[56:59], v[168:171], v[144:147]
    buffer_load_dwordx4 v[84:87], v2, s[4:7], s42 offen offset:2304 sc1
    ds_read_b64_tr_b16 v[52:53], v4 offset:28672
    s_xor_b32 s42, s41, 45056
    v_mfma_f32_16x16x32_bf16 v[148:151], v[56:59], v[172:175], v[148:151]
    ds_read_b64_tr_b16 v[54:55], v4 offset:29696
    v_mfma_f32_16x16x32_bf16 v[152:155], v[60:63], v[168:171], v[152:155]
    ds_read_b64_tr_b16 v[56:57], v5 offset:28672
    v_mfma_f32_16x16x32_bf16 v[156:159], v[60:63], v[172:175], v[156:159]
    ds_read_b64_tr_b16 v[58:59], v5 offset:29696
    s_waitcnt vmcnt(8) lgkmcnt(10)
    v_mfma_f32_16x16x32_bf16 v[128:131], v[32:35], v[176:179], v[128:131]
    ds_read_b64_tr_b16 v[60:61], v6 offset:28672
    buffer_load_dwordx4 v[88:91], v2, s[4:7], s42 offen offset:2048 sc1
    v_mfma_f32_16x16x32_bf16 v[132:135], v[32:35], v[180:183], v[132:135]
    ds_read_b64_tr_b16 v[62:63], v6 offset:29696
    v_mfma_f32_16x16x32_bf16 v[136:139], v[36:39], v[176:179], v[136:139]
    ds_read_b64_tr_b16 v[32:33], v3 offset:32768
    v_mfma_f32_16x16x32_bf16 v[140:143], v[36:39], v[180:183], v[140:143]
    ds_read_b64_tr_b16 v[34:35], v3 offset:33792
    s_waitcnt lgkmcnt(10)
    v_mfma_f32_16x16x32_bf16 v[144:147], v[40:43], v[176:179], v[144:147]
    buffer_load_dwordx4 v[92:95], v2, s[4:7], s42 offen offset:2304 sc1
    ds_read_b64_tr_b16 v[36:37], v4 offset:32768
    s_xor_b32 s42, s41, 49152
    v_mfma_f32_16x16x32_bf16 v[148:151], v[40:43], v[180:183], v[148:151]
    ds_read_b64_tr_b16 v[38:39], v4 offset:33792
    v_mfma_f32_16x16x32_bf16 v[152:155], v[44:47], v[176:179], v[152:155]
    ds_read_b64_tr_b16 v[40:41], v5 offset:32768
    v_mfma_f32_16x16x32_bf16 v[156:159], v[44:47], v[180:183], v[156:159]
    ds_read_b64_tr_b16 v[42:43], v5 offset:33792
    s_waitcnt vmcnt(8) lgkmcnt(10)
    v_mfma_f32_16x16x32_bf16 v[128:131], v[48:51], v[184:187], v[128:131]
    buffer_load_dwordx4 v[96:99], v2, s[4:7], s42 offen offset:2048 sc1
    ds_read_b64_tr_b16 v[44:45], v6 offset:32768
    v_mfma_f32_16x16x32_bf16 v[132:135], v[48:51], v[188:191], v[132:135]
    ds_read_b64_tr_b16 v[46:47], v6 offset:33792
    v_mfma_f32_16x16x32_bf16 v[136:139], v[52:55], v[184:187], v[136:139]
    ds_read_b64_tr_b16 v[48:49], v3 offset:36864
    v_mfma_f32_16x16x32_bf16 v[140:143], v[52:55], v[188:191], v[140:143]
    ds_read_b64_tr_b16 v[50:51], v3 offset:37888
    s_waitcnt lgkmcnt(10)
    v_mfma_f32_16x16x32_bf16 v[144:147], v[56:59], v[184:187], v[144:147]
    buffer_load_dwordx4 v[100:103], v2, s[4:7], s42 offen offset:2304 sc1
    ds_read_b64_tr_b16 v[52:53], v4 offset:36864
    s_xor_b32 s42, s41, 53248
    v_mfma_f32_16x16x32_bf16 v[148:151], v[56:59], v[188:191], v[148:151]
    ds_read_b64_tr_b16 v[54:55], v4 offset:37888
    v_mfma_f32_16x16x32_bf16 v[152:155], v[60:63], v[184:187], v[152:155]
    ds_read_b64_tr_b16 v[56:57], v5 offset:36864
    v_mfma_f32_16x16x32_bf16 v[156:159], v[60:63], v[188:191], v[156:159]
    ds_read_b64_tr_b16 v[58:59], v5 offset:37888
    s_waitcnt vmcnt(8) lgkmcnt(10)
    v_mfma_f32_16x16x32_bf16 v[128:131], v[32:35], v[64:67], v[128:131]
    ds_read_b64_tr_b16 v[60:61], v6 offset:36864
    buffer_load_dwordx4 v[104:107], v2, s[4:7], s42 offen offset:2048 sc1
    v_mfma_f32_16x16x32_bf16 v[132:135], v[32:35], v[68:71], v[132:135]
    ds_read_b64_tr_b16 v[62:63], v6 offset:37888
    v_mfma_f32_16x16x32_bf16 v[136:139], v[36:39], v[64:67], v[136:139]
    ds_read_b64_tr_b16 v[32:33], v3 offset:40960
    v_mfma_f32_16x16x32_bf16 v[140:143], v[36:39], v[68:71], v[140:143]
    ds_read_b64_tr_b16 v[34:35], v3 offset:41984
    s_waitcnt lgkmcnt(10)
    v_mfma_f32_16x16x32_bf16 v[144:147], v[40:43], v[64:67], v[144:147]
    buffer_load_dwordx4 v[108:111], v2, s[4:7], s42 offen offset:2304 sc1
    ds_read_b64_tr_b16 v[36:37], v4 offset:40960
    s_xor_b32 s42, s41, 57344
    v_mfma_f32_16x16x32_bf16 v[148:151], v[40:43], v[68:71], v[148:151]
    ds_read_b64_tr_b16 v[38:39], v4 offset:41984
    v_mfma_f32_16x16x32_bf16 v[152:155], v[44:47], v[64:67], v[152:155]
    ds_read_b64_tr_b16 v[40:41], v5 offset:40960
    v_mfma_f32_16x16x32_bf16 v[156:159], v[44:47], v[68:71], v[156:159]
    ds_read_b64_tr_b16 v[42:43], v5 offset:41984
    s_waitcnt vmcnt(8) lgkmcnt(10)
    v_mfma_f32_16x16x32_bf16 v[128:131], v[48:51], v[72:75], v[128:131]
    buffer_load_dwordx4 v[112:115], v2, s[4:7], s42 offen offset:2048 sc1
    ds_read_b64_tr_b16 v[44:45], v6 offset:40960
    v_mfma_f32_16x16x32_bf16 v[132:135], v[48:51], v[76:79], v[132:135]
    ds_read_b64_tr_b16 v[46:47], v6 offset:41984
    v_mfma_f32_16x16x32_bf16 v[136:139], v[52:55], v[72:75], v[136:139]
    ds_read_b64_tr_b16 v[48:49], v3 offset:45056
    v_mfma_f32_16x16x32_bf16 v[140:143], v[52:55], v[76:79], v[140:143]
    ds_read_b64_tr_b16 v[50:51], v3 offset:46080
    s_waitcnt lgkmcnt(10)
    v_mfma_f32_16x16x32_bf16 v[144:147], v[56:59], v[72:75], v[144:147]
    buffer_load_dwordx4 v[116:119], v2, s[4:7], s42 offen offset:2304 sc1
    ds_read_b64_tr_b16 v[52:53], v4 offset:45056
    s_xor_b32 s42, s41, 61440
    v_mfma_f32_16x16x32_bf16 v[148:151], v[56:59], v[76:79], v[148:151]
    ds_read_b64_tr_b16 v[54:55], v4 offset:46080
    v_mfma_f32_16x16x32_bf16 v[152:155], v[60:63], v[72:75], v[152:155]
    ds_read_b64_tr_b16 v[56:57], v5 offset:45056
    v_mfma_f32_16x16x32_bf16 v[156:159], v[60:63], v[76:79], v[156:159]
    ds_read_b64_tr_b16 v[58:59], v5 offset:46080
    s_waitcnt vmcnt(8) lgkmcnt(10)
    v_mfma_f32_16x16x32_bf16 v[128:131], v[32:35], v[80:83], v[128:131]
    ds_read_b64_tr_b16 v[60:61], v6 offset:45056
    buffer_load_dwordx4 v[120:123], v2, s[4:7], s42 offen offset:2048 sc1
    v_mfma_f32_16x16x32_bf16 v[132:135], v[32:35], v[84:87], v[132:135]
    ds_read_b64_tr_b16 v[62:63], v6 offset:46080
    v_mfma_f32_16x16x32_bf16 v[136:139], v[36:39], v[80:83], v[136:139]
    ds_read_b64_tr_b16 v[32:33], v3 offset:49152
    v_mfma_f32_16x16x32_bf16 v[140:143], v[36:39], v[84:87], v[140:143]
    ds_read_b64_tr_b16 v[34:35], v3 offset:50176
    s_waitcnt lgkmcnt(10)
    v_mfma_f32_16x16x32_bf16 v[144:147], v[40:43], v[80:83], v[144:147]
    buffer_load_dwordx4 v[124:127], v2, s[4:7], s42 offen offset:2304 sc1
    ds_read_b64_tr_b16 v[36:37], v4 offset:49152
    v_mfma_f32_16x16x32_bf16 v[148:151], v[40:43], v[84:87], v[148:151]
    ds_read_b64_tr_b16 v[38:39], v4 offset:50176
    v_mfma_f32_16x16x32_bf16 v[152:155], v[44:47], v[80:83], v[152:155]
    ds_read_b64_tr_b16 v[40:41], v5 offset:49152
    v_mfma_f32_16x16x32_bf16 v[156:159], v[44:47], v[84:87], v[156:159]
    ds_read_b64_tr_b16 v[42:43], v5 offset:50176
    s_waitcnt vmcnt(8) lgkmcnt(10)
    v_mfma_f32_16x16x32_bf16 v[128:131], v[48:51], v[88:91], v[128:131]
    ds_read_b64_tr_b16 v[44:45], v6 offset:49152
    v_mfma_f32_16x16x32_bf16 v[132:135], v[48:51], v[92:95], v[132:135]
    ds_read_b64_tr_b16 v[46:47], v6 offset:50176
    v_mfma_f32_16x16x32_bf16 v[136:139], v[52:55], v[88:91], v[136:139]
    ds_read_b64_tr_b16 v[48:49], v3 offset:53248
    v_mfma_f32_16x16x32_bf16 v[140:143], v[52:55], v[92:95], v[140:143]
    ds_read_b64_tr_b16 v[50:51], v3 offset:54272
    s_waitcnt lgkmcnt(10)
    v_mfma_f32_16x16x32_bf16 v[144:147], v[56:59], v[88:91], v[144:147]
    ds_read_b64_tr_b16 v[52:53], v4 offset:53248
    v_mfma_f32_16x16x32_bf16 v[148:151], v[56:59], v[92:95], v[148:151]
    ds_read_b64_tr_b16 v[54:55], v4 offset:54272
    v_mfma_f32_16x16x32_bf16 v[152:155], v[60:63], v[88:91], v[152:155]
    ds_read_b64_tr_b16 v[56:57], v5 offset:53248
    v_mfma_f32_16x16x32_bf16 v[156:159], v[60:63], v[92:95], v[156:159]
    ds_read_b64_tr_b16 v[58:59], v5 offset:54272
    s_waitcnt vmcnt(6) lgkmcnt(10)
    v_mfma_f32_16x16x32_bf16 v[128:131], v[32:35], v[96:99], v[128:131]
    ds_read_b64_tr_b16 v[60:61], v6 offset:53248
    v_mfma_f32_16x16x32_bf16 v[132:135], v[32:35], v[100:103], v[132:135]
    ds_read_b64_tr_b16 v[62:63], v6 offset:54272
    v_mfma_f32_16x16x32_bf16 v[136:139], v[36:39], v[96:99], v[136:139]
    ds_read_b64_tr_b16 v[32:33], v3 offset:57344
    v_mfma_f32_16x16x32_bf16 v[140:143], v[36:39], v[100:103], v[140:143]
    ds_read_b64_tr_b16 v[34:35], v3 offset:58368
    s_waitcnt lgkmcnt(10)
    v_mfma_f32_16x16x32_bf16 v[144:147], v[40:43], v[96:99], v[144:147]
    ds_read_b64_tr_b16 v[36:37], v4 offset:57344
    v_mfma_f32_16x16x32_bf16 v[148:151], v[40:43], v[100:103], v[148:151]
    ds_read_b64_tr_b16 v[38:39], v4 offset:58368
    v_mfma_f32_16x16x32_bf16 v[152:155], v[44:47], v[96:99], v[152:155]
    ds_read_b64_tr_b16 v[40:41], v5 offset:57344
    v_mfma_f32_16x16x32_bf16 v[156:159], v[44:47], v[100:103], v[156:159]
    ds_read_b64_tr_b16 v[42:43], v5 offset:58368
    s_waitcnt vmcnt(4) lgkmcnt(10)
    v_mfma_f32_16x16x32_bf16 v[128:131], v[48:51], v[104:107], v[128:131]
    ds_read_b64_tr_b16 v[44:45], v6 offset:57344
    v_mfma_f32_16x16x32_bf16 v[132:135], v[48:51], v[108:111], v[132:135]
    ds_read_b64_tr_b16 v[46:47], v6 offset:58368
    v_mfma_f32_16x16x32_bf16 v[136:139], v[52:55], v[104:107], v[136:139]
    ds_read_b64_tr_b16 v[48:49], v3 offset:61440
    v_mfma_f32_16x16x32_bf16 v[140:143], v[52:55], v[108:111], v[140:143]
    ds_read_b64_tr_b16 v[50:51], v3 offset:62464
    s_waitcnt lgkmcnt(10)
    v_mfma_f32_16x16x32_bf16 v[144:147], v[56:59], v[104:107], v[144:147]
    ds_read_b64_tr_b16 v[52:53], v4 offset:61440
    v_mfma_f32_16x16x32_bf16 v[148:151], v[56:59], v[108:111], v[148:151]
    ds_read_b64_tr_b16 v[54:55], v4 offset:62464
    v_mfma_f32_16x16x32_bf16 v[152:155], v[60:63], v[104:107], v[152:155]
    ds_read_b64_tr_b16 v[56:57], v5 offset:61440
    v_mfma_f32_16x16x32_bf16 v[156:159], v[60:63], v[108:111], v[156:159]
    ds_read_b64_tr_b16 v[58:59], v5 offset:62464
    s_waitcnt vmcnt(2) lgkmcnt(10)
    v_mfma_f32_16x16x32_bf16 v[128:131], v[32:35], v[112:115], v[128:131]
    ds_read_b64_tr_b16 v[60:61], v6 offset:61440
    ds_read_b64_tr_b16 v[62:63], v6 offset:62464
    v_mfma_f32_16x16x32_bf16 v[136:139], v[36:39], v[112:115], v[136:139]
    v_xor_b32 v3, 0x10000, v3
    s_waitcnt lgkmcnt(8)
    v_mfma_f32_16x16x32_bf16 v[144:147], v[40:43], v[112:115], v[144:147]
    v_xor_b32 v4, 0x10000, v4
    v_mfma_f32_16x16x32_bf16 v[152:155], v[44:47], v[112:115], v[152:155]
    v_xor_b32 v5, 0x10000, v5
    s_waitcnt vmcnt(0) lgkmcnt(4)
    v_mfma_f32_16x16x32_bf16 v[128:131], v[48:51], v[120:123], v[128:131]
    v_xor_b32 v6, 0x10000, v6
    v_mfma_f32_16x16x32_bf16 v[136:139], v[52:55], v[120:123], v[136:139]
    s_waitcnt lgkmcnt(0)
    v_mfma_f32_16x16x32_bf16 v[144:147], v[56:59], v[120:123], v[144:147]
    v_mfma_f32_16x16x32_bf16 v[152:155], v[60:63], v[120:123], v[152:155]
    s_cmp_eq_u32 s21, 3
    s_cbranch_scc1 c_final
    s_barrier
    s_add_u32 s43, s43, 4194304
    v_mfma_f32_16x16x32_bf16 v[132:135], v[32:35], v[116:119], v[132:135]
    v_mfma_f32_16x16x32_bf16 v[140:143], v[36:39], v[116:119], v[140:143]
    v_mfma_f32_16x16x32_bf16 v[148:151], v[40:43], v[116:119], v[148:151]
    v_cvt_pk_bf16_f32 v160, v128, v129
    v_cvt_pk_bf16_f32 v161, v130, v131
    v_cvt_pk_bf16_f32 v162, v136, v137
    v_mfma_f32_16x16x32_bf16 v[156:159], v[44:47], v[116:119], v[156:159]
    v_cvt_pk_bf16_f32 v163, v138, v139
    v_cvt_pk_bf16_f32 v168, v144, v145
    v_cvt_pk_bf16_f32 v169, v146, v147
    v_mfma_f32_16x16x32_bf16 v[132:135], v[48:51], v[124:127], v[132:135]
    v_cvt_pk_bf16_f32 v170, v152, v153
    v_cvt_pk_bf16_f32 v171, v154, v155
    v_permlane32_swap_b32 v160, v162
    v_mfma_f32_16x16x32_bf16 v[140:143], v[52:55], v[124:127], v[140:143]
    v_permlane32_swap_b32 v161, v163
    buffer_store_dwordx4 v[160:163], v2, s[4:7], s43 offen offset:0 sc1
    v_permlane32_swap_b32 v168, v170
    v_mfma_f32_16x16x32_bf16 v[148:151], v[56:59], v[124:127], v[148:151]
    v_permlane32_swap_b32 v169, v171
    buffer_store_dwordx4 v[168:171], v2, s[4:7], s43 offen offset:2048 sc1
    v_mfma_f32_16x16x32_bf16 v[156:159], v[60:63], v[124:127], v[156:159]
    v_cvt_pk_bf16_f32 v164, v132, v133
    v_cvt_pk_bf16_f32 v165, v134, v135
    v_cvt_pk_bf16_f32 v166, v140, v141
    v_cvt_pk_bf16_f32 v167, v142, v143
    s_nop 0
    v_cvt_pk_bf16_f32 v172, v148, v149
    v_cvt_pk_bf16_f32 v173, v150, v151
    s_nop 0
    v_cvt_pk_bf16_f32 v174, v156, v157
    v_cvt_pk_bf16_f32 v175, v158, v159
    v_permlane32_swap_b32 v164, v166
    v_permlane32_swap_b32 v165, v167
    buffer_store_dwordx4 v[164:167], v2, s[4:7], s43 offen offset:256 sc1
    v_permlane32_swap_b32 v172, v174
    v_permlane32_swap_b32 v173, v175
    buffer_store_dwordx4 v[172:175], v2, s[4:7], s43 offen offset:2304 sc1
    s_add_u32 s21, s21, 1
    v_mov_b32 v22, 0x3f803f80
    v_dot2_f32_bf16 v24, v160, v22, 0
    v_dot2_f32_bf16 v25, v160, v160, 0
    v_dot2_f32_bf16 v26, v164, v22, 0
    v_dot2_f32_bf16 v27, v164, v164, 0
    v_dot2_f32_bf16 v24, v161, v22, v24
    v_dot2_f32_bf16 v25, v161, v161, v25
    v_dot2_f32_bf16 v26, v165, v22, v26
    v_dot2_f32_bf16 v27, v165, v165, v27
    v_dot2_f32_bf16 v24, v162, v22, v24
    v_dot2_f32_bf16 v25, v162, v162, v25
    v_dot2_f32_bf16 v26, v166, v22, v26
    v_dot2_f32_bf16 v27, v166, v166, v27
    v_dot2_f32_bf16 v24, v163, v22, v24
    v_dot2_f32_bf16 v25, v163, v163, v25
    v_dot2_f32_bf16 v26, v167, v22, v26
    v_dot2_f32_bf16 v27, v167, v167, v27
    v_dot2_f32_bf16 v24, v168, v22, v24
    v_dot2_f32_bf16 v25, v168, v168, v25
    v_dot2_f32_bf16 v26, v172, v22, v26
    v_dot2_f32_bf16 v27, v172, v172, v27
    v_dot2_f32_bf16 v24, v169, v22, v24
    v_dot2_f32_bf16 v25, v169, v169, v25
    v_dot2_f32_bf16 v26, v173, v22, v26
    v_dot2_f32_bf16 v27, v173, v173, v27
    v_dot2_f32_bf16 v24, v170, v22, v24
    v_dot2_f32_bf16 v25, v170, v170, v25
    v_dot2_f32_bf16 v26, v174, v22, v26
    v_dot2_f32_bf16 v27, v174, v174, v27
    v_dot2_f32_bf16 v24, v171, v22, v24
    v_dot2_f32_bf16 v25, v171, v171, v25
    v_dot2_f32_bf16 v26, v175, v22, v26
    v_dot2_f32_bf16 v27, v175, v175, v27
    v_lshrrev_b32 v23, 1, v1
    v_and_b32 v23, 0xf8, v23
    s_nop 0
    v_permlane16_swap_b32 v24, v26
    v_permlane16_swap_b32 v25, v27
    v_pk_add_f32 v[24:25], v[24:25], v[26:27]
    v_mov_b32 v26, v24
    v_mov_b32 v27, v25
    s_nop 0
    v_permlane32_swap_b32 v24, v26
    v_permlane32_swap_b32 v25, v27
    v_pk_add_f32 v[24:25], v[24:25], v[26:27]
    s_lshl_b32 s44, s21, 18
    s_lshl_b32 s45, s38, 12
    s_add_u32 s44, s44, s45
    s_lshl_b32 s45, s18, 8
    s_add_u32 s44, s44, s45
    s_add_u32 s44, s44, 50331648
    buffer_store_dwordx2 v[24:25], v23, s[4:7], s44 offen sc1
    s_lshl_b32 s46, s21, 14
    s_lshl_b32 s67, s38, 7
    s_add_u32 s46, s46, s67
    s_add_u32 s46, s46, 4096
    s_add_u32 s47, s46, 8192
    s_lshl_b32 s48, s21, 22
    s_lshl_b32 s49, s38, 16
    s_add_u32 s41, s48, s49
    v_lshrrev_b32 v16, 4, v1
    v_and_b32 v17, 15, v16
    v_lshrrev_b32 v16, 4, v16
    s_lshl_b32 s49, s16, 7
    s_add_u32 s50, s49, 151552
    s_and_b32 s49, s21, 1
    s_lshl_b32 s49, s49, 10
    s_add_u32 s49, s49, 151552
    v_lshlrev_b32 v11, 4, v16
    v_add_u32 v13, s50, v11
    v_add_u32 v11, s49, v11
    v_lshlrev_b32 v15, 2, v17
    v_add_u32 v9, s50, v15
    v_add_u32 v15, s49, v15
    s_lshr_b32 s49, s21, 1
    s_lshl_b32 s53, s49, 23
    s_lshl_b32 s50, s18, 18
    s_add_u32 s53, s53, s50
    s_add_u32 s53, s53, 33554432
    s_lshl_b32 s54, s38, 11
    s_add_u32 s52, s53, s54
    s_lshl_b32 s59, s49, 13
    s_lshl_b32 s67, s18, 9
    s_add_u32 s59, s59, s67
    s_lshl_b32 s67, s16, 7
    s_add_u32 s59, s59, s67
    s_add_u32 s59, s59, 69632
    s_lshl_b32 s61, s49, 15
    s_lshl_b32 s67, s17, 11
    s_add_u32 s61, s61, s67
    s_lshl_b32 s67, s18, 7
    s_add_u32 s61, s61, s67
    s_add_u32 s61, s61, 151552
    s_sub_u32 s60, s61, 151552
    s_lshl_b32 s60, s60, 5
    s_add_u32 s60, s60, 54525952
    s_lshl_b32 s62, s16, 12
    s_add_u32 s62, s62, 131072
    s_mov_b32 s68, s63
    s_waitcnt vmcnt(1)
    s_atomic_add s68, s[22:23], s46 glc
    s_mov_b32 s48, 0
    s_branch c_layer
c_final:
    v_mfma_f32_16x16x32_bf16 v[132:135], v[32:35], v[116:119], v[132:135]
    v_mfma_f32_16x16x32_bf16 v[140:143], v[36:39], v[116:119], v[140:143]
    v_mfma_f32_16x16x32_bf16 v[148:151], v[40:43], v[116:119], v[148:151]
    v_cvt_pk_bf16_f32 v128, v128, v129
    v_cvt_pk_bf16_f32 v129, v130, v131
    ds_write_b64 v17, v[128:129] offset:0
    v_mfma_f32_16x16x32_bf16 v[156:159], v[44:47], v[116:119], v[156:159]
    v_cvt_pk_bf16_f32 v136, v136, v137
    v_cvt_pk_bf16_f32 v137, v138, v139
    ds_write_b64 v17, v[136:137] offset:32
    v_mfma_f32_16x16x32_bf16 v[132:135], v[48:51], v[124:127], v[132:135]
    v_cvt_pk_bf16_f32 v144, v144, v145
    v_cvt_pk_bf16_f32 v145, v146, v147
    ds_write_b64 v17, v[144:145] offset:64
    v_mfma_f32_16x16x32_bf16 v[140:143], v[52:55], v[124:127], v[140:143]
    v_cvt_pk_bf16_f32 v152, v152, v153
    v_cvt_pk_bf16_f32 v153, v154, v155
    ds_write_b64 v17, v[152:153] offset:96
    v_mfma_f32_16x16x32_bf16 v[148:151], v[56:59], v[124:127], v[148:151]
    ds_read_b128 v[160:163], v18 offset:0
    ds_read_b128 v[164:167], v18 offset:1152
    v_mfma_f32_16x16x32_bf16 v[156:159], v[60:63], v[124:127], v[156:159]
    v_cvt_pk_bf16_f32 v132, v132, v133
    v_cvt_pk_bf16_f32 v133, v134, v135
    ds_write_b64 v17, v[132:133] offset:2304
    v_cvt_pk_bf16_f32 v140, v140, v141
    v_cvt_pk_bf16_f32 v141, v142, v143
    ds_write_b64 v17, v[140:141] offset:2336
    v_cvt_pk_bf16_f32 v148, v148, v149
    v_cvt_pk_bf16_f32 v149, v150, v151
    ds_write_b64 v17, v[148:149] offset:2368
    v_cvt_pk_bf16_f32 v156, v156, v157
    v_cvt_pk_bf16_f32 v157, v158, v159
    ds_write_b64 v17, v[156:157] offset:2400
    ds_read_b128 v[168:171], v18 offset:2304
    ds_read_b128 v[172:175], v18 offset:3456
    s_waitcnt lgkmcnt(7)
    buffer_store_dwordx4 v[160:163], v19, s[8:11], s50 offen sc1
    s_add_u32 s50, s50, 16384
    s_waitcnt lgkmcnt(6)
    buffer_store_dwordx4 v[164:167], v19, s[8:11], s50 offen sc1
    s_add_u32 s50, s50, 16384
    s_waitcnt lgkmcnt(1)
    buffer_store_dwordx4 v[168:171], v19, s[8:11], s50 offen sc1
    s_add_u32 s50, s50, 16384
    s_waitcnt lgkmcnt(0)
    buffer_store_dwordx4 v[172:175], v19, s[8:11], s50 offen sc1
    s_endpgm
s_start:
    v_mov_b32 v14, 0
    v_mov_b32 v15, 0
    v_mov_b32 v20, 0
    v_mov_b32 v21, 0
    v_mov_b32 v22, 0
    s_mov_b32 s41, 0
    s_mov_b32 s42, 0
    s_mov_b32 s43, 0
    s_mov_b32 s62, 0
    s_cmp_eq_u32 s16, 4
    s_cbranch_scc1 h_start
    s_cmp_eq_u32 s16, 7
    s_cbranch_scc1 z_start
l_start:
    v_lshrrev_b32 v24, 4, v1
    v_lshrrev_b32 v25, 3, v24
    v_mul_u32_u24 v12, 6144, v25
    v_and_b32 v26, 2, v25
    v_lshrrev_b32 v25, 2, v25
    v_or_b32 v26, v26, v25
    v_bfe_u32 v25, v24, 1, 2
    v_xor_b32 v26, v26, v25
    v_lshl_add_u32 v12, v26, 5, v12
    v_and_b32 v26, 1, v24
    v_lshl_add_u32 v12, v26, 4, v12
    s_lshl_b32 s3, s18, 7
    v_add_u32 v12, s3, v12
    v_add_u32 v13, 48128, v12
    s_mul_i32 s84, s18, 393216
    s_cmp_lt_u32 s18, 4
    s_cselect_b32 s85, 4, 0
    s_mul_i32 s85, s85, 393216
    s_sub_u32 s3, s16, 5
    s_lshl_b32 s41, s3, 11
    s_mul_i32 s42, s3, 98304
    s_lshl_b32 s62, s3, 15
    v_add_u32 v14, s42, v12
    v_add_u32 v15, s42, v13
    s_bitcmp1_b32 s21, 0
    s_cselect_b32 s8, s28, s24
    s_cselect_b32 s9, s29, s25
    s_cselect_b32 s12, s30, s26
    s_cselect_b32 s13, s31, s27
    s_mov_b32 s10, 6291456
    s_mov_b32 s11, 0x00020000
    s_mov_b32 s14, 2097152
    s_mov_b32 s15, 0x00020000
    s_add_u32 m0, s41, 0
    s_add_u32 s44, s84, 2048
    buffer_load_dwordx4 v14, s[8:11], s44 offen offset:0 lds
    buffer_load_dwordx4 v15, s[8:11], s44 offen offset:1024 lds
    s_add_u32 m0, s41, 4096
    s_add_u32 s44, s84, 4096
    buffer_load_dwordx4 v14, s[8:11], s44 offen offset:0 lds
    buffer_load_dwordx4 v15, s[8:11], s44 offen offset:1024 lds
    s_add_u32 m0, s41, 8192
    s_add_u32 s44, s84, 0
    buffer_load_dwordx4 v14, s[8:11], s44 offen offset:0 lds
    buffer_load_dwordx4 v15, s[8:11], s44 offen offset:1024 lds
    s_add_u32 m0, s41, 12288
    s_add_u32 s44, s84, 198656
    buffer_load_dwordx4 v14, s[8:11], s44 offen offset:0 lds
    buffer_load_dwordx4 v15, s[8:11], s44 offen offset:1024 lds
    s_add_u32 m0, s41, 16384
    s_add_u32 s44, s84, 200704
    buffer_load_dwordx4 v14, s[8:11], s44 offen offset:0 lds
    buffer_load_dwordx4 v15, s[8:11], s44 offen offset:1024 lds
    s_add_u32 m0, s41, 20480
    s_add_u32 s44, s84, 196608
    buffer_load_dwordx4 v14, s[8:11], s44 offen offset:0 lds
    buffer_load_dwordx4 v15, s[8:11], s44 offen offset:1024 lds
    s_add_u32 m0, s41, 24576
    s_add_u32 s44, s85, 2048
    buffer_load_dwordx4 v14, s[8:11], s44 offen offset:0 lds
    buffer_load_dwordx4 v15, s[8:11], s44 offen offset:1024 lds
    s_add_u32 m0, s41, 28672
    s_add_u32 s44, s85, 4096
    buffer_load_dwordx4 v14, s[8:11], s44 offen offset:0 lds
    buffer_load_dwordx4 v15, s[8:11], s44 offen offset:1024 lds
    s_cmp_lt_u32 s18, 4
    s_cselect_b32 s86, 5, 1
    s_mul_i32 s86, s86, 393216
    s_cmp_lt_u32 s18, 4
    s_cselect_b32 s87, 6, 2
    s_mul_i32 s87, s87, 393216
    s_cmp_lt_u32 s18, 4
    s_cselect_b32 s88, 7, 3
    s_mul_i32 s88, s88, 393216
    s_cmp_lt_u32 s18, 8
    s_cselect_b32 s89, 8, 4
    s_mul_i32 s89, s89, 393216
    s_cmp_lt_u32 s18, 8
    s_cselect_b32 s90, 9, 5
    s_mul_i32 s90, s90, 393216
    s_cmp_lt_u32 s18, 8
    s_cselect_b32 s91, 10, 6
    s_mul_i32 s91, s91, 393216
    s_cmp_lt_u32 s18, 8
    s_cselect_b32 s92, 11, 7
    s_mul_i32 s92, s92, 393216
    s_cmp_lt_u32 s18, 12
    s_cselect_b32 s93, 12, 8
    s_mul_i32 s93, s93, 393216
    s_cmp_lt_u32 s18, 12
    s_cselect_b32 s94, 13, 9
    s_mul_i32 s94, s94, 393216
    s_cmp_lt_u32 s18, 12
    s_cselect_b32 s95, 14, 10
    s_mul_i32 s95, s95, 393216
    s_cmp_lt_u32 s18, 12
    s_cselect_b32 s96, 15, 11
    s_mul_i32 s96, s96, 393216
    s_xor_b32 s97, s18, 1
    s_mul_i32 s97, s97, 393216
    s_xor_b32 s98, s18, 2
    s_mul_i32 s98, s98, 393216
    s_xor_b32 s99, s18, 3
    s_mul_i32 s99, s99, 393216
    v_lshrrev_b32 v24, 4, v1
    v_lshrrev_b32 v25, 3, v24
    v_mul_u32_u24 v16, 2048, v25
    v_and_b32 v26, 2, v25
    v_lshrrev_b32 v25, 2, v25
    v_or_b32 v26, v26, v25
    v_bfe_u32 v25, v24, 1, 2
    v_xor_b32 v26, v26, v25
    v_lshl_add_u32 v16, v26, 5, v16
    v_and_b32 v26, 1, v24
    v_lshl_add_u32 v16, v26, 4, v16
    s_lshl_b32 s3, s18, 7
    v_add_u32 v16, s3, v16
    v_add_u32 v17, 15360, v16
    v_add_u32 v18, 30720, v16
    v_add_u32 v19, 46080, v16
    s_and_b32 s3, s16, 3
    s_mul_i32 s3, s3, 49152
    v_add_u32 v11, s3, v12
    s_and_b32 s3, s16, 3
    s_lshl_b32 s3, s3, 10
    v_add_u32 v9, s3, v1
    v_add_u32 v10, 0x10000, v9
    s_waitcnt vmcnt(0)
    s_barrier
    s_add_u32 m0, s41, 32768
    s_add_u32 s44, s85, 0
    buffer_load_dwordx4 v14, s[8:11], s44 offen offset:0 lds
    buffer_load_dwordx4 v15, s[8:11], s44 offen offset:1024 lds
    s_add_u32 m0, s41, 36864
    s_add_u32 s44, s85, 198656
    buffer_load_dwordx4 v14, s[8:11], s44 offen offset:0 lds
    buffer_load_dwordx4 v15, s[8:11], s44 offen offset:1024 lds
    s_add_u32 m0, s41, 40960
    s_add_u32 s44, s85, 200704
    buffer_load_dwordx4 v14, s[8:11], s44 offen offset:0 lds
    buffer_load_dwordx4 v15, s[8:11], s44 offen offset:1024 lds
    s_add_u32 m0, s41, 45056
    s_add_u32 s44, s85, 196608
    buffer_load_dwordx4 v14, s[8:11], s44 offen offset:0 lds
    buffer_load_dwordx4 v15, s[8:11], s44 offen offset:1024 lds
    s_add_u32 m0, s41, 49152
    s_add_u32 s44, s86, 2048
    buffer_load_dwordx4 v14, s[8:11], s44 offen offset:0 lds
    buffer_load_dwordx4 v15, s[8:11], s44 offen offset:1024 lds
    s_add_u32 m0, s41, 53248
    s_add_u32 s44, s86, 4096
    buffer_load_dwordx4 v14, s[8:11], s44 offen offset:0 lds
    buffer_load_dwordx4 v15, s[8:11], s44 offen offset:1024 lds
    s_add_u32 m0, s41, 57344
    s_add_u32 s44, s86, 0
    buffer_load_dwordx4 v14, s[8:11], s44 offen offset:0 lds
    buffer_load_dwordx4 v15, s[8:11], s44 offen offset:1024 lds
    s_add_u32 m0, s41, 61440
    s_add_u32 s44, s86, 198656
    buffer_load_dwordx4 v14, s[8:11], s44 offen offset:0 lds
    buffer_load_dwordx4 v15, s[8:11], s44 offen offset:1024 lds
    s_waitcnt vmcnt(0)
    s_barrier
    s_add_u32 m0, s41, 65536
    s_add_u32 s44, s86, 200704
    buffer_load_dwordx4 v14, s[8:11], s44 offen offset:0 lds
    buffer_load_dwordx4 v15, s[8:11], s44 offen offset:1024 lds
    s_add_u32 m0, s41, 69632
    s_add_u32 s44, s86, 196608
    buffer_load_dwordx4 v14, s[8:11], s44 offen offset:0 lds
    buffer_load_dwordx4 v15, s[8:11], s44 offen offset:1024 lds
    s_add_u32 m0, s41, 73728
    s_add_u32 s44, s87, 2048
    buffer_load_dwordx4 v14, s[8:11], s44 offen offset:0 lds
    buffer_load_dwordx4 v15, s[8:11], s44 offen offset:1024 lds
    s_add_u32 m0, s41, 77824
    s_add_u32 s44, s87, 4096
    buffer_load_dwordx4 v14, s[8:11], s44 offen offset:0 lds
    buffer_load_dwordx4 v15, s[8:11], s44 offen offset:1024 lds
    s_add_u32 m0, s41, 81920
    s_add_u32 s44, s87, 0
    buffer_load_dwordx4 v14, s[8:11], s44 offen offset:0 lds
    buffer_load_dwordx4 v15, s[8:11], s44 offen offset:1024 lds
    s_add_u32 m0, s41, 86016
    s_add_u32 s44, s87, 198656
    buffer_load_dwordx4 v14, s[8:11], s44 offen offset:0 lds
    buffer_load_dwordx4 v15, s[8:11], s44 offen offset:1024 lds
    s_add_u32 m0, s41, 90112
    s_add_u32 s44, s87, 200704
    buffer_load_dwordx4 v14, s[8:11], s44 offen offset:0 lds
    buffer_load_dwordx4 v15, s[8:11], s44 offen offset:1024 lds
    s_add_u32 m0, s41, 94208
    s_add_u32 s44, s87, 196608
    buffer_load_dwordx4 v14, s[8:11], s44 offen offset:0 lds
    buffer_load_dwordx4 v15, s[8:11], s44 offen offset:1024 lds
    s_add_u32 m0, s41, 98304
    s_add_u32 s44, s88, 2048
    buffer_load_dwordx4 v14, s[8:11], s44 offen offset:0 lds
    buffer_load_dwordx4 v15, s[8:11], s44 offen offset:1024 lds
    s_add_u32 m0, s41, 102400
    s_add_u32 s44, s88, 4096
    buffer_load_dwordx4 v14, s[8:11], s44 offen offset:0 lds
    buffer_load_dwordx4 v15, s[8:11], s44 offen offset:1024 lds
    s_add_u32 m0, s41, 106496
    s_add_u32 s44, s88, 0
    buffer_load_dwordx4 v14, s[8:11], s44 offen offset:0 lds
    buffer_load_dwordx4 v15, s[8:11], s44 offen offset:1024 lds
    s_add_u32 m0, s41, 110592
    s_add_u32 s44, s88, 198656
    buffer_load_dwordx4 v14, s[8:11], s44 offen offset:0 lds
    buffer_load_dwordx4 v15, s[8:11], s44 offen offset:1024 lds
    s_add_u32 m0, s41, 114688
    s_add_u32 s44, s88, 200704
    buffer_load_dwordx4 v14, s[8:11], s44 offen offset:0 lds
    buffer_load_dwordx4 v15, s[8:11], s44 offen offset:1024 lds
    s_add_u32 m0, s41, 118784
    s_add_u32 s44, s88, 196608
    buffer_load_dwordx4 v14, s[8:11], s44 offen offset:0 lds
    buffer_load_dwordx4 v15, s[8:11], s44 offen offset:1024 lds
    s_add_u32 m0, s41, 122880
    s_add_u32 s44, s89, 2048
    buffer_load_dwordx4 v14, s[8:11], s44 offen offset:0 lds
    buffer_load_dwordx4 v15, s[8:11], s44 offen offset:1024 lds
    s_add_u32 m0, s41, 126976
    s_add_u32 s44, s89, 4096
    buffer_load_dwordx4 v14, s[8:11], s44 offen offset:0 lds
    buffer_load_dwordx4 v15, s[8:11], s44 offen offset:1024 lds
    s_add_u32 m0, s41, 0
    s_add_u32 s44, s89, 0
    buffer_load_dwordx4 v14, s[8:11], s44 offen offset:0 lds
    buffer_load_dwordx4 v15, s[8:11], s44 offen offset:1024 lds
    s_add_u32 m0, s41, 4096
    s_add_u32 s44, s89, 198656
    buffer_load_dwordx4 v14, s[8:11], s44 offen offset:0 lds
    buffer_load_dwordx4 v15, s[8:11], s44 offen offset:1024 lds
    s_add_u32 m0, s41, 8192
    s_add_u32 s44, s89, 200704
    buffer_load_dwordx4 v14, s[8:11], s44 offen offset:0 lds
    buffer_load_dwordx4 v15, s[8:11], s44 offen offset:1024 lds
    s_add_u32 m0, s41, 12288
    s_add_u32 s44, s89, 196608
    buffer_load_dwordx4 v14, s[8:11], s44 offen offset:0 lds
    buffer_load_dwordx4 v15, s[8:11], s44 offen offset:1024 lds
    s_waitcnt vmcnt(24)
    s_branch l_join
l_layer:
    s_waitcnt lgkmcnt(0)
    s_barrier
    s_add_u32 m0, s41, 0
    s_add_u32 s44, s89, 0
    buffer_load_dwordx4 v14, s[8:11], s44 offen offset:0 lds
    buffer_load_dwordx4 v15, s[8:11], s44 offen offset:1024 lds
    s_add_u32 m0, s41, 4096
    s_add_u32 s44, s89, 198656
    buffer_load_dwordx4 v14, s[8:11], s44 offen offset:0 lds
    buffer_load_dwordx4 v15, s[8:11], s44 offen offset:1024 lds
    s_add_u32 m0, s41, 8192
    s_add_u32 s44, s89, 200704
    buffer_load_dwordx4 v14, s[8:11], s44 offen offset:0 lds
    buffer_load_dwordx4 v15, s[8:11], s44 offen offset:1024 lds
    s_add_u32 m0, s41, 12288
    s_add_u32 s44, s89, 196608
    buffer_load_dwordx4 v14, s[8:11], s44 offen offset:0 lds
    buffer_load_dwordx4 v15, s[8:11], s44 offen offset:1024 lds
    s_waitcnt vmcnt(24)
l_join:
    s_barrier
    s_add_u32 m0, s41, 16384
    s_add_u32 s44, s90, 2048
    buffer_load_dwordx4 v14, s[8:11], s44 offen offset:0 lds
    buffer_load_dwordx4 v15, s[8:11], s44 offen offset:1024 lds
    s_add_u32 m0, s41, 20480
    s_add_u32 s44, s90, 4096
    buffer_load_dwordx4 v14, s[8:11], s44 offen offset:0 lds
    buffer_load_dwordx4 v15, s[8:11], s44 offen offset:1024 lds
    s_add_u32 m0, s41, 24576
    s_add_u32 s44, s90, 0
    buffer_load_dwordx4 v14, s[8:11], s44 offen offset:0 lds
    buffer_load_dwordx4 v15, s[8:11], s44 offen offset:1024 lds
    s_add_u32 m0, s41, 28672
    s_add_u32 s44, s90, 198656
    buffer_load_dwordx4 v14, s[8:11], s44 offen offset:0 lds
    buffer_load_dwordx4 v15, s[8:11], s44 offen offset:1024 lds
    s_add_u32 m0, s41, 32768
    s_add_u32 s44, s90, 200704
    buffer_load_dwordx4 v14, s[8:11], s44 offen offset:0 lds
    buffer_load_dwordx4 v15, s[8:11], s44 offen offset:1024 lds
    s_add_u32 m0, s41, 36864
    s_add_u32 s44, s90, 196608
    buffer_load_dwordx4 v14, s[8:11], s44 offen offset:0 lds
    buffer_load_dwordx4 v15, s[8:11], s44 offen offset:1024 lds
    s_add_u32 m0, s41, 40960
    s_add_u32 s44, s91, 2048
    buffer_load_dwordx4 v14, s[8:11], s44 offen offset:0 lds
    buffer_load_dwordx4 v15, s[8:11], s44 offen offset:1024 lds
    s_add_u32 m0, s41, 45056
    s_add_u32 s44, s91, 4096
    buffer_load_dwordx4 v14, s[8:11], s44 offen offset:0 lds
    buffer_load_dwordx4 v15, s[8:11], s44 offen offset:1024 lds
    s_waitcnt vmcnt(24)
    s_barrier
    s_add_u32 m0, s41, 49152
    s_add_u32 s44, s91, 0
    buffer_load_dwordx4 v14, s[8:11], s44 offen offset:0 lds
    buffer_load_dwordx4 v15, s[8:11], s44 offen offset:1024 lds
    s_add_u32 m0, s41, 53248
    s_add_u32 s44, s91, 198656
    buffer_load_dwordx4 v14, s[8:11], s44 offen offset:0 lds
    buffer_load_dwordx4 v15, s[8:11], s44 offen offset:1024 lds
    s_add_u32 m0, s41, 57344
    s_add_u32 s44, s91, 200704
    buffer_load_dwordx4 v14, s[8:11], s44 offen offset:0 lds
    buffer_load_dwordx4 v15, s[8:11], s44 offen offset:1024 lds
    s_add_u32 m0, s41, 61440
    s_add_u32 s44, s91, 196608
    buffer_load_dwordx4 v14, s[8:11], s44 offen offset:0 lds
    buffer_load_dwordx4 v15, s[8:11], s44 offen offset:1024 lds
    s_waitcnt vmcnt(16)
    s_barrier
    s_add_u32 m0, s41, 65536
    s_add_u32 s44, s92, 2048
    buffer_load_dwordx4 v14, s[8:11], s44 offen offset:0 lds
    buffer_load_dwordx4 v15, s[8:11], s44 offen offset:1024 lds
    s_add_u32 m0, s41, 69632
    s_add_u32 s44, s92, 4096
    buffer_load_dwordx4 v14, s[8:11], s44 offen offset:0 lds
    buffer_load_dwordx4 v15, s[8:11], s44 offen offset:1024 lds
    s_add_u32 m0, s41, 73728
    s_add_u32 s44, s92, 0
    buffer_load_dwordx4 v14, s[8:11], s44 offen offset:0 lds
    buffer_load_dwordx4 v15, s[8:11], s44 offen offset:1024 lds
    s_add_u32 m0, s41, 77824
    s_add_u32 s44, s92, 198656
    buffer_load_dwordx4 v14, s[8:11], s44 offen offset:0 lds
    buffer_load_dwordx4 v15, s[8:11], s44 offen offset:1024 lds
    s_add_u32 m0, s41, 81920
    s_add_u32 s44, s92, 200704
    buffer_load_dwordx4 v14, s[8:11], s44 offen offset:0 lds
    buffer_load_dwordx4 v15, s[8:11], s44 offen offset:1024 lds
    s_add_u32 m0, s41, 86016
    s_add_u32 s44, s92, 196608
    buffer_load_dwordx4 v14, s[8:11], s44 offen offset:0 lds
    buffer_load_dwordx4 v15, s[8:11], s44 offen offset:1024 lds
    s_add_u32 m0, s41, 90112
    s_add_u32 s44, s93, 2048
    buffer_load_dwordx4 v14, s[8:11], s44 offen offset:0 lds
    buffer_load_dwordx4 v15, s[8:11], s44 offen offset:1024 lds
    s_add_u32 m0, s41, 94208
    s_add_u32 s44, s93, 4096
    buffer_load_dwordx4 v14, s[8:11], s44 offen offset:0 lds
    buffer_load_dwordx4 v15, s[8:11], s44 offen offset:1024 lds
    s_waitcnt vmcnt(16)
    s_barrier
    s_add_u32 m0, s41, 98304
    s_add_u32 s44, s93, 0
    buffer_load_dwordx4 v14, s[8:11], s44 offen offset:0 lds
    buffer_load_dwordx4 v15, s[8:11], s44 offen offset:1024 lds
    s_add_u32 m0, s41, 102400
    s_add_u32 s44, s93, 198656
    buffer_load_dwordx4 v14, s[8:11], s44 offen offset:0 lds
    buffer_load_dwordx4 v15, s[8:11], s44 offen offset:1024 lds
    s_add_u32 m0, s41, 106496
    s_add_u32 s44, s93, 200704
    buffer_load_dwordx4 v14, s[8:11], s44 offen offset:0 lds
    buffer_load_dwordx4 v15, s[8:11], s44 offen offset:1024 lds
    s_add_u32 m0, s41, 110592
    s_add_u32 s44, s93, 196608
    buffer_load_dwordx4 v14, s[8:11], s44 offen offset:0 lds
    buffer_load_dwordx4 v15, s[8:11], s44 offen offset:1024 lds
    s_add_u32 m0, s41, 114688
    s_add_u32 s44, s94, 2048
    buffer_load_dwordx4 v14, s[8:11], s44 offen offset:0 lds
    buffer_load_dwordx4 v15, s[8:11], s44 offen offset:1024 lds
    s_add_u32 m0, s41, 118784
    s_add_u32 s44, s94, 4096
    buffer_load_dwordx4 v14, s[8:11], s44 offen offset:0 lds
    buffer_load_dwordx4 v15, s[8:11], s44 offen offset:1024 lds
    s_add_u32 m0, s41, 122880
    s_add_u32 s44, s94, 198656
    buffer_load_dwordx4 v14, s[8:11], s44 offen offset:0 lds
    buffer_load_dwordx4 v15, s[8:11], s44 offen offset:1024 lds
    s_add_u32 m0, s41, 126976
    s_add_u32 s44, s94, 200704
    buffer_load_dwordx4 v14, s[8:11], s44 offen offset:0 lds
    buffer_load_dwordx4 v15, s[8:11], s44 offen offset:1024 lds
    s_waitcnt vmcnt(16)
    s_barrier
    s_add_u32 m0, s41, 0
    s_add_u32 s44, s95, 2048
    buffer_load_dwordx4 v14, s[8:11], s44 offen offset:0 lds
    buffer_load_dwordx4 v15, s[8:11], s44 offen offset:1024 lds
    s_add_u32 m0, s41, 4096
    s_add_u32 s44, s95, 4096
    buffer_load_dwordx4 v14, s[8:11], s44 offen offset:0 lds
    buffer_load_dwordx4 v15, s[8:11], s44 offen offset:1024 lds
    s_add_u32 m0, s41, 8192
    s_add_u32 s44, s95, 198656
    buffer_load_dwordx4 v14, s[8:11], s44 offen offset:0 lds
    buffer_load_dwordx4 v15, s[8:11], s44 offen offset:1024 lds
    s_add_u32 m0, s41, 12288
    s_add_u32 s44, s95, 200704
    buffer_load_dwordx4 v14, s[8:11], s44 offen offset:0 lds
    buffer_load_dwordx4 v15, s[8:11], s44 offen offset:1024 lds
    s_add_u32 m0, s41, 16384
    s_add_u32 s44, s96, 2048
    buffer_load_dwordx4 v14, s[8:11], s44 offen offset:0 lds
    buffer_load_dwordx4 v15, s[8:11], s44 offen offset:1024 lds
    s_add_u32 m0, s41, 20480
    s_add_u32 s44, s96, 198656
    buffer_load_dwordx4 v14, s[8:11], s44 offen offset:0 lds
    buffer_load_dwordx4 v15, s[8:11], s44 offen offset:1024 lds
    s_add_u32 m0, s41, 24576
    s_add_u32 s44, s97, 2048
    buffer_load_dwordx4 v14, s[8:11], s44 offen offset:0 lds
    buffer_load_dwordx4 v15, s[8:11], s44 offen offset:1024 lds
    s_add_u32 m0, s41, 28672
    s_add_u32 s44, s97, 198656
    buffer_load_dwordx4 v14, s[8:11], s44 offen offset:0 lds
    buffer_load_dwordx4 v15, s[8:11], s44 offen offset:1024 lds
    s_waitcnt vmcnt(16)
    s_barrier
    s_add_u32 m0, s41, 32768
    s_add_u32 s44, s98, 2048
    buffer_load_dwordx4 v14, s[8:11], s44 offen offset:0 lds
    buffer_load_dwordx4 v15, s[8:11], s44 offen offset:1024 lds
    s_add_u32 m0, s41, 36864
    s_add_u32 s44, s98, 198656
    buffer_load_dwordx4 v14, s[8:11], s44 offen offset:0 lds
    buffer_load_dwordx4 v15, s[8:11], s44 offen offset:1024 lds
    s_add_u32 m0, s41, 40960
    s_add_u32 s44, s99, 2048
    buffer_load_dwordx4 v14, s[8:11], s44 offen offset:0 lds
    buffer_load_dwordx4 v15, s[8:11], s44 offen offset:1024 lds
    s_add_u32 m0, s41, 45056
    s_add_u32 s44, s99, 198656
    buffer_load_dwordx4 v14, s[8:11], s44 offen offset:0 lds
    buffer_load_dwordx4 v15, s[8:11], s44 offen offset:1024 lds
    s_add_u32 m0, s41, 49152
    s_add_u32 s44, s96, 4096
    buffer_load_dwordx4 v14, s[8:11], s44 offen offset:0 lds
    buffer_load_dwordx4 v15, s[8:11], s44 offen offset:1024 lds
    s_add_u32 m0, s41, 53248
    s_add_u32 s44, s96, 200704
    buffer_load_dwordx4 v14, s[8:11], s44 offen offset:0 lds
    buffer_load_dwordx4 v15, s[8:11], s44 offen offset:1024 lds
    s_add_u32 m0, s41, 57344
    s_add_u32 s44, s97, 4096
    buffer_load_dwordx4 v14, s[8:11], s44 offen offset:0 lds
    buffer_load_dwordx4 v15, s[8:11], s44 offen offset:1024 lds
    s_add_u32 m0, s41, 61440
    s_add_u32 s44, s97, 200704
    buffer_load_dwordx4 v14, s[8:11], s44 offen offset:0 lds
    buffer_load_dwordx4 v15, s[8:11], s44 offen offset:1024 lds
    s_waitcnt vmcnt(16)
    s_barrier
    s_add_u32 m0, s41, 65536
    s_add_u32 s44, s98, 4096
    buffer_load_dwordx4 v14, s[8:11], s44 offen offset:0 lds
    buffer_load_dwordx4 v15, s[8:11], s44 offen offset:1024 lds
    s_add_u32 m0, s41, 69632
    s_add_u32 s44, s98, 200704
    buffer_load_dwordx4 v14, s[8:11], s44 offen offset:0 lds
    buffer_load_dwordx4 v15, s[8:11], s44 offen offset:1024 lds
    s_add_u32 m0, s41, 73728
    s_add_u32 s44, s99, 4096
    buffer_load_dwordx4 v14, s[8:11], s44 offen offset:0 lds
    buffer_load_dwordx4 v15, s[8:11], s44 offen offset:1024 lds
    s_add_u32 m0, s41, 77824
    s_add_u32 s44, s99, 200704
    buffer_load_dwordx4 v14, s[8:11], s44 offen offset:0 lds
    buffer_load_dwordx4 v15, s[8:11], s44 offen offset:1024 lds
    s_add_u32 m0, s41, 81920
    s_add_u32 s44, s94, 0
    buffer_load_dwordx4 v14, s[8:11], s44 offen offset:0 lds
    buffer_load_dwordx4 v15, s[8:11], s44 offen offset:1024 lds
    s_add_u32 m0, s41, 86016
    s_add_u32 s44, s94, 196608
    buffer_load_dwordx4 v14, s[8:11], s44 offen offset:0 lds
    buffer_load_dwordx4 v15, s[8:11], s44 offen offset:1024 lds
    s_add_u32 m0, s41, 90112
    s_add_u32 s44, s95, 0
    buffer_load_dwordx4 v14, s[8:11], s44 offen offset:0 lds
    buffer_load_dwordx4 v15, s[8:11], s44 offen offset:1024 lds
    s_add_u32 m0, s41, 94208
    s_add_u32 s44, s95, 196608
    buffer_load_dwordx4 v14, s[8:11], s44 offen offset:0 lds
    buffer_load_dwordx4 v15, s[8:11], s44 offen offset:1024 lds
    s_waitcnt vmcnt(16)
    s_barrier
    s_add_u32 m0, s41, 98304
    s_add_u32 s44, s96, 0
    buffer_load_dwordx4 v14, s[8:11], s44 offen offset:0 lds
    buffer_load_dwordx4 v15, s[8:11], s44 offen offset:1024 lds
    s_add_u32 m0, s41, 102400
    s_add_u32 s44, s96, 196608
    buffer_load_dwordx4 v14, s[8:11], s44 offen offset:0 lds
    buffer_load_dwordx4 v15, s[8:11], s44 offen offset:1024 lds
    s_add_u32 m0, s41, 106496
    s_add_u32 s44, s97, 0
    buffer_load_dwordx4 v14, s[8:11], s44 offen offset:0 lds
    buffer_load_dwordx4 v15, s[8:11], s44 offen offset:1024 lds
    s_add_u32 m0, s41, 110592
    s_add_u32 s44, s97, 196608
    buffer_load_dwordx4 v14, s[8:11], s44 offen offset:0 lds
    buffer_load_dwordx4 v15, s[8:11], s44 offen offset:1024 lds
    s_add_u32 m0, s41, 114688
    s_add_u32 s44, s98, 0
    buffer_load_dwordx4 v14, s[8:11], s44 offen offset:0 lds
    buffer_load_dwordx4 v15, s[8:11], s44 offen offset:1024 lds
    s_add_u32 m0, s41, 118784
    s_add_u32 s44, s98, 196608
    buffer_load_dwordx4 v14, s[8:11], s44 offen offset:0 lds
    buffer_load_dwordx4 v15, s[8:11], s44 offen offset:1024 lds
    s_add_u32 m0, s41, 122880
    s_add_u32 s44, s99, 0
    buffer_load_dwordx4 v14, s[8:11], s44 offen offset:0 lds
    buffer_load_dwordx4 v15, s[8:11], s44 offen offset:1024 lds
    s_add_u32 m0, s41, 126976
    s_add_u32 s44, s99, 196608
    buffer_load_dwordx4 v14, s[8:11], s44 offen offset:0 lds
    buffer_load_dwordx4 v15, s[8:11], s44 offen offset:1024 lds
    s_waitcnt vmcnt(16)
    s_barrier
    v_lshrrev_b32 v28, 4, v1
    v_and_b32 v29, 7, v28
    v_lshrrev_b32 v28, 3, v28
    v_mul_u32_u24 v28, 2048, v28
    v_lshl_add_u32 v28, v29, 4, v28
    s_and_b32 s3, s18, 12
    s_or_b32 s3, s3, 3
    s_lshl_b32 s3, s3, 7
    v_add_u32 v28, s3, v28
    s_lshr_b32 s3, s2, 3
    s_lshl_b32 s3, s3, 2
    s_and_b32 s60, s16, 3
    s_add_u32 s60, s60, s3
    s_lshl_b32 s61, s60, 14
    buffer_load_dwordx4 v[144:147], v28, s[12:15], s61 offen
    s_bitcmp0_b32 s21, 0
    s_cselect_b32 s56, s28, s24
    s_cselect_b32 s57, s29, s25
    s_mov_b32 s58, 6291456
    s_mov_b32 s59, 0x00020000
    v_lshrrev_b32 v28, 4, v1
    v_and_b32 v29, 7, v28
    v_lshrrev_b32 v28, 3, v28
    v_mul_u32_u24 v28, 6144, v28
    v_lshl_add_u32 v28, v29, 4, v28
    s_and_b32 s3, s18, 12
    s_or_b32 s3, s3, 3
    s_lshl_b32 s3, s3, 7
    v_add_u32 v28, s3, v28
    s_lshr_b32 s3, s2, 3
    s_lshl_b32 s3, s3, 2
    s_and_b32 s60, s16, 3
    s_add_u32 s60, s60, s3
    s_and_b32 s3, s60, 31
    s_mul_i32 s3, s3, 49152
    s_lshr_b32 s61, s60, 5
    s_min_u32 s61, s61, 2
    s_lshl_b32 s61, s61, 11
    s_add_u32 s61, s61, s3
    s_cmp_lt_u32 s18, 4
    s_cselect_b32 s3, 1572864, 0
    s_add_u32 s61, s61, s3
    buffer_load_dwordx4 v[148:151], v28, s[56:59], s61 offen
    s_waitcnt vmcnt(2)
    s_bitcmp1_b32 s21, 0
    s_cbranch_scc1 l_pe
    s_bitcmp0_b32 s21, 0
    s_cselect_b32 s56, s28, s24
    s_cselect_b32 s57, s29, s25
    s_mov_b32 s58, 6291456
    s_mov_b32 s59, 0x00020000
    s_add_u32 s61, s84, 2048
    buffer_load_dwordx4 v[160:163], v11, s[56:59], s61 offen
    s_add_u32 s61, s84, 4096
    buffer_load_dwordx4 v[164:167], v11, s[56:59], s61 offen
    s_add_u32 s61, s84, 0
    buffer_load_dwordx4 v[168:171], v11, s[56:59], s61 offen
    s_add_u32 s61, s84, 198656
    buffer_load_dwordx4 v[172:175], v11, s[56:59], s61 offen
    s_add_u32 s61, s84, 200704
    buffer_load_dwordx4 v[176:179], v11, s[56:59], s61 offen
    s_add_u32 s61, s84, 196608
    buffer_load_dwordx4 v[180:183], v11, s[56:59], s61 offen
l_pe:
    s_barrier
    s_bitcmp1_b32 s21, 0
    s_cbranch_scc1 s_B
    s_add_u32 m0, s41, 0
    s_xor_b32 s44, s62, 0
    buffer_load_dwordx4 v16, s[12:15], s44 offen offset:0 lds
    buffer_load_dwordx4 v17, s[12:15], s44 offen offset:1024 lds
    s_add_u32 m0, s41, 4096
    s_xor_b32 s44, s62, 131072
    buffer_load_dwordx4 v16, s[12:15], s44 offen offset:0 lds
    buffer_load_dwordx4 v17, s[12:15], s44 offen offset:1024 lds
    s_add_u32 m0, s41, 8192
    s_xor_b32 s44, s62, 262144
    buffer_load_dwordx4 v16, s[12:15], s44 offen offset:0 lds
    buffer_load_dwordx4 v17, s[12:15], s44 offen offset:1024 lds
    s_add_u32 m0, s41, 12288
    s_xor_b32 s44, s62, 393216
    buffer_load_dwordx4 v16, s[12:15], s44 offen offset:0 lds
    buffer_load_dwordx4 v17, s[12:15], s44 offen offset:1024 lds
    s_add_u32 m0, s41, 16384
    s_xor_b32 s44, s62, 524288
    buffer_load_dwordx4 v16, s[12:15], s44 offen offset:0 lds
    buffer_load_dwordx4 v17, s[12:15], s44 offen offset:1024 lds
    s_add_u32 m0, s41, 20480
    s_xor_b32 s44, s62, 655360
    buffer_load_dwordx4 v16, s[12:15], s44 offen offset:0 lds
    buffer_load_dwordx4 v17, s[12:15], s44 offen offset:1024 lds
    s_add_u32 m0, s41, 24576
    s_xor_b32 s44, s62, 786432
    buffer_load_dwordx4 v16, s[12:15], s44 offen offset:0 lds
    buffer_load_dwordx4 v17, s[12:15], s44 offen offset:1024 lds
    s_add_u32 m0, s41, 28672
    s_xor_b32 s44, s62, 917504
    buffer_load_dwordx4 v16, s[12:15], s44 offen offset:0 lds
    buffer_load_dwordx4 v17, s[12:15], s44 offen offset:1024 lds
    s_add_u32 m0, s41, 32768
    s_xor_b32 s44, s62, 1048576
    buffer_load_dwordx4 v16, s[12:15], s44 offen offset:0 lds
    buffer_load_dwordx4 v17, s[12:15], s44 offen offset:1024 lds
    s_add_u32 m0, s41, 36864
    s_xor_b32 s44, s62, 1179648
    buffer_load_dwordx4 v16, s[12:15], s44 offen offset:0 lds
    buffer_load_dwordx4 v17, s[12:15], s44 offen offset:1024 lds
    s_add_u32 m0, s41, 40960
    s_xor_b32 s44, s62, 1310720
    buffer_load_dwordx4 v16, s[12:15], s44 offen offset:0 lds
    buffer_load_dwordx4 v17, s[12:15], s44 offen offset:1024 lds
    s_add_u32 m0, s41, 45056
    s_xor_b32 s44, s62, 1441792
    buffer_load_dwordx4 v16, s[12:15], s44 offen offset:0 lds
    buffer_load_dwordx4 v17, s[12:15], s44 offen offset:1024 lds
    s_add_u32 m0, s41, 49152
    s_xor_b32 s44, s62, 1572864
    buffer_load_dwordx4 v16, s[12:15], s44 offen offset:0 lds
    buffer_load_dwordx4 v17, s[12:15], s44 offen offset:1024 lds
    s_add_u32 m0, s41, 53248
    s_xor_b32 s44, s62, 1703936
    buffer_load_dwordx4 v16, s[12:15], s44 offen offset:0 lds
    buffer_load_dwordx4 v17, s[12:15], s44 offen offset:1024 lds
    s_add_u32 m0, s41, 57344
    s_xor_b32 s44, s62, 1835008
    buffer_load_dwordx4 v16, s[12:15], s44 offen offset:0 lds
    buffer_load_dwordx4 v17, s[12:15], s44 offen offset:1024 lds
    s_add_u32 m0, s41, 61440
    s_xor_b32 s44, s62, 1966080
    buffer_load_dwordx4 v16, s[12:15], s44 offen offset:0 lds
    buffer_load_dwordx4 v17, s[12:15], s44 offen offset:1024 lds
    s_branch s_tail
h_start:
    v_mov_b32 v20, 0
    v_mov_b32 v21, 0
    v_mov_b32 v22, 0
    v_mov_b32 v23, 0
    s_cmp_lt_u32 s2, 10
    s_cbranch_scc0 h_z0
    s_load_dword s101, s[34:35], 192
    s_lshl_b32 s44, s2, 11
    s_mov_b32 s45, 0
    s_mov_b32 s46, 0
    s_mov_b32 s47, 0
    s_mov_b32 s48, 0
    s_mov_b32 s49, 0
    s_mov_b32 s50, 0
    s_mov_b32 s51, 0
    s_mov_b32 s52, 0
    s_mov_b32 s53, 0
    s_mov_b32 s54, 0
    s_mov_b32 s55, 0
    s_mov_b32 s56, 0
    s_mov_b32 s57, 0
    s_mov_b32 s58, 0
    s_mov_b32 s59, 0
    s_mov_b32 s60, 0
    s_atomic_swap s45, s[22:23], s44 offset:0 glc
    s_atomic_swap s46, s[22:23], s44 offset:128 glc
    s_atomic_swap s47, s[22:23], s44 offset:256 glc
    s_atomic_swap s48, s[22:23], s44 offset:384 glc
    s_atomic_swap s49, s[22:23], s44 offset:512 glc
    s_atomic_swap s50, s[22:23], s44 offset:640 glc
    s_atomic_swap s51, s[22:23], s44 offset:768 glc
    s_atomic_swap s52, s[22:23], s44 offset:896 glc
    s_atomic_swap s53, s[22:23], s44 offset:1024 glc
    s_atomic_swap s54, s[22:23], s44 offset:1152 glc
    s_atomic_swap s55, s[22:23], s44 offset:1280 glc
    s_atomic_swap s56, s[22:23], s44 offset:1408 glc
    s_atomic_swap s57, s[22:23], s44 offset:1536 glc
    s_atomic_swap s58, s[22:23], s44 offset:1664 glc
    s_atomic_swap s59, s[22:23], s44 offset:1792 glc
    s_atomic_swap s60, s[22:23], s44 offset:1920 glc
    s_waitcnt lgkmcnt(0)
    s_atomic_add s40, s[34:35], 0
h_z0:
    v_lshrrev_b32 v24, 4, v1
    v_lshrrev_b32 v25, 3, v24
    v_mul_u32_u24 v12, 6144, v25
    v_and_b32 v26, 2, v25
    v_lshrrev_b32 v25, 2, v25
    v_or_b32 v26, v26, v25
    v_bfe_u32 v25, v24, 1, 2
    v_xor_b32 v26, v26, v25
    v_lshl_add_u32 v12, v26, 5, v12
    v_and_b32 v26, 1, v24
    v_lshl_add_u32 v12, v26, 4, v12
    s_lshl_b32 s3, s18, 7
    v_add_u32 v12, s3, v12
    v_add_u32 v13, 48128, v12
    s_mul_i32 s84, s18, 393216
    s_cmp_lt_u32 s18, 4
    s_cselect_b32 s85, 4, 0
    s_mul_i32 s85, s85, 393216
    s_cmp_lt_u32 s18, 4
    s_cselect_b32 s86, 5, 1
    s_mul_i32 s86, s86, 393216
    s_cmp_lt_u32 s18, 4
    s_cselect_b32 s87, 6, 2
    s_mul_i32 s87, s87, 393216
    s_cmp_lt_u32 s18, 4
    s_cselect_b32 s88, 7, 3
    s_mul_i32 s88, s88, 393216
    s_cmp_lt_u32 s18, 8
    s_cselect_b32 s89, 8, 4
    s_mul_i32 s89, s89, 393216
    s_cmp_lt_u32 s18, 8
    s_cselect_b32 s90, 9, 5
    s_mul_i32 s90, s90, 393216
    s_cmp_lt_u32 s18, 8
    s_cselect_b32 s91, 10, 6
    s_mul_i32 s91, s91, 393216
    s_cmp_lt_u32 s18, 8
    s_cselect_b32 s92, 11, 7
    s_mul_i32 s92, s92, 393216
    s_cmp_lt_u32 s18, 12
    s_cselect_b32 s93, 12, 8
    s_mul_i32 s93, s93, 393216
    s_cmp_lt_u32 s18, 12
    s_cselect_b32 s94, 13, 9
    s_mul_i32 s94, s94, 393216
    s_cmp_lt_u32 s18, 12
    s_cselect_b32 s95, 14, 10
    s_mul_i32 s95, s95, 393216
    s_cmp_lt_u32 s18, 12
    s_cselect_b32 s96, 15, 11
    s_mul_i32 s96, s96, 393216
    s_xor_b32 s97, s18, 1
    s_mul_i32 s97, s97, 393216
    s_xor_b32 s98, s18, 2
    s_mul_i32 s98, s98, 393216
    s_xor_b32 s99, s18, 3
    s_mul_i32 s99, s99, 393216
    v_lshrrev_b32 v24, 4, v1
    v_lshrrev_b32 v25, 3, v24
    v_mul_u32_u24 v16, 2048, v25
    v_and_b32 v26, 2, v25
    v_lshrrev_b32 v25, 2, v25
    v_or_b32 v26, v26, v25
    v_bfe_u32 v25, v24, 1, 2
    v_xor_b32 v26, v26, v25
    v_lshl_add_u32 v16, v26, 5, v16
    v_and_b32 v26, 1, v24
    v_lshl_add_u32 v16, v26, 4, v16
    s_lshl_b32 s3, s18, 7
    v_add_u32 v16, s3, v16
    v_add_u32 v17, 15360, v16
    v_add_u32 v18, 30720, v16
    v_add_u32 v19, 46080, v16
    s_and_b32 s3, s16, 3
    s_mul_i32 s3, s3, 49152
    v_add_u32 v11, s3, v12
    s_and_b32 s3, s16, 3
    s_lshl_b32 s3, s3, 10
    v_add_u32 v9, s3, v1
    v_add_u32 v10, 0x10000, v9
    v_lshrrev_b32 v24, 4, v1
    v_and_b32 v25, 15, v24
    v_lshrrev_b32 v24, 4, v24
    v_lshlrev_b32 v24, 2, v24
    v_sub_u32 v24, v25, v24
    v_mov_b32 v25, 0xf149f2ca
    v_add_u32 v26, 0x0, v24
    v_and_b32 v26, 0xfffffff1, v26
    v_cmp_eq_u32 vcc, 0, v26
    s_nop 1
    v_cndmask_b32 v32, v25, 0, vcc
    v_add_u32 v26, 0xffffffff, v24
    v_and_b32 v26, 0xfffffff1, v26
    v_cmp_eq_u32 vcc, 0, v26
    s_nop 1
    v_cndmask_b32 v33, v25, 0, vcc
    v_add_u32 v26, 0xfffffffe, v24
    v_and_b32 v26, 0xfffffff1, v26
    v_cmp_eq_u32 vcc, 0, v26
    s_nop 1
    v_cndmask_b32 v34, v25, 0, vcc
    v_add_u32 v26, 0xfffffffd, v24
    v_and_b32 v26, 0xfffffff1, v26
    v_cmp_eq_u32 vcc, 0, v26
    s_nop 1
    v_cndmask_b32 v35, v25, 0, vcc
    v_add_u32 v26, 0x10, v24
    v_and_b32 v26, 0xfffffff1, v26
    v_cmp_eq_u32 vcc, 0, v26
    s_nop 1
    v_cndmask_b32 v36, v25, 0, vcc
    v_add_u32 v26, 0xf, v24
    v_and_b32 v26, 0xfffffff1, v26
    v_cmp_eq_u32 vcc, 0, v26
    s_nop 1
    v_cndmask_b32 v37, v25, 0, vcc
    v_add_u32 v26, 0xe, v24
    v_and_b32 v26, 0xfffffff1, v26
    v_cmp_eq_u32 vcc, 0, v26
    s_nop 1
    v_cndmask_b32 v38, v25, 0, vcc
    v_add_u32 v26, 0xd, v24
    v_and_b32 v26, 0xfffffff1, v26
    v_cmp_eq_u32 vcc, 0, v26
    s_nop 1
    v_cndmask_b32 v39, v25, 0, vcc
    v_add_u32 v24, 153600, v1
    ds_write_b128 v24, v[32:35] offset:0
    ds_write_b128 v24, v[36:39] offset:1024
    s_waitcnt lgkmcnt(0)
    s_lshl_b32 s44, s21, 14
    s_lshl_b32 s67, s17, 9
    s_add_u32 s44, s44, s67
    s_add_u32 s44, s44, 4096
    s_barrier
    s_barrier
    s_mov_b32 s66, 0x10000
h_s0_poll:
    s_mov_b32 s68, 0
    s_mov_b32 s69, 0
    s_mov_b32 s70, 0
    s_mov_b32 s71, 0
    s_atomic_add s68, s[22:23], s44 offset:0 glc
    s_atomic_add s69, s[22:23], s44 offset:128 glc
    s_atomic_add s70, s[22:23], s44 offset:256 glc
    s_atomic_add s71, s[22:23], s44 offset:384 glc
    s_sub_u32 s66, s66, 1
    s_cselect_b32 s67, 67372036, 0
    s_waitcnt lgkmcnt(0)
    s_and_b32 s68, s68, s69
    s_and_b32 s68, s68, s70
    s_and_b32 s68, s68, s71
    s_max_u32 s68, s68, s67
    s_cmp_lt_u32 s68, 67372036
    s_cbranch_scc1 h_s0_poll
h_s0_ok:
    s_lshr_b32 s3, s2, 3
    s_cmp_eq_u32 s3, 2
    s_cbranch_scc0 h_g4
    s_barrier
    s_mul_i32 s44, s2, 24576
    s_add_u32 s44, s44, 58347520
    s_mov_b32 s45, 24
h_zloop:
    buffer_store_dwordx4 v[20:23], v1, s[4:7], s44 offen sc1
    s_add_u32 s44, s44, 1024
    s_sub_u32 s45, s45, 1
    s_cmp_lg_u32 s45, 0
    s_cbranch_scc1 h_zloop
    s_branch h_g4b
h_layer:
    s_waitcnt lgkmcnt(0)
    s_barrier
h_g4:
    s_barrier
h_g4b:
    s_lshl_b32 s44, s21, 14
    s_lshl_b32 s67, s17, 9
    s_add_u32 s44, s44, s67
    s_add_u32 s44, s44, 12288
    s_mov_b32 s66, 0x10000
h_s_poll:
    s_mov_b32 s68, 0
    s_mov_b32 s69, 0
    s_mov_b32 s70, 0
    s_mov_b32 s71, 0
    s_atomic_add s68, s[22:23], s44 offset:0 glc
    s_atomic_add s69, s[22:23], s44 offset:128 glc
    s_atomic_add s70, s[22:23], s44 offset:256 glc
    s_atomic_add s71, s[22:23], s44 offset:384 glc
    s_sub_u32 s66, s66, 1
    s_cselect_b32 s67, 16, 0
    s_waitcnt lgkmcnt(0)
    s_and_b32 s68, s68, s69
    s_and_b32 s68, s68, s70
    s_and_b32 s68, s68, s71
    s_max_u32 s68, s68, s67
    s_cmp_lt_u32 s68, 16
    s_cbranch_scc1 h_s_poll
h_s_ok:
    s_barrier
    s_lshl_b32 s44, s21, 18
    s_lshl_b32 s45, s17, 14
    s_add_u32 s44, s44, s45
    s_add_u32 s44, s44, 50331648
    buffer_load_dwordx4 v[32:35], v1, s[4:7], s44 offen offset:0 sc1
    buffer_load_dwordx4 v[36:39], v1, s[4:7], s44 offen offset:1024 sc1
    buffer_load_dwordx4 v[40:43], v1, s[4:7], s44 offen offset:2048 sc1
    buffer_load_dwordx4 v[44:47], v1, s[4:7], s44 offen offset:3072 sc1
    s_add_u32 s44, s44, 4096
    buffer_load_dwordx4 v[48:51], v1, s[4:7], s44 offen offset:0 sc1
    buffer_load_dwordx4 v[52:55], v1, s[4:7], s44 offen offset:1024 sc1
    buffer_load_dwordx4 v[56:59], v1, s[4:7], s44 offen offset:2048 sc1
    buffer_load_dwordx4 v[60:63], v1, s[4:7], s44 offen offset:3072 sc1
    s_add_u32 s44, s44, 4096
    buffer_load_dwordx4 v[64:67], v1, s[4:7], s44 offen offset:0 sc1
    buffer_load_dwordx4 v[68:71], v1, s[4:7], s44 offen offset:1024 sc1
    buffer_load_dwordx4 v[72:75], v1, s[4:7], s44 offen offset:2048 sc1
    buffer_load_dwordx4 v[76:79], v1, s[4:7], s44 offen offset:3072 sc1
    s_add_u32 s44, s44, 4096
    buffer_load_dwordx4 v[80:83], v1, s[4:7], s44 offen offset:0 sc1
    buffer_load_dwordx4 v[84:87], v1, s[4:7], s44 offen offset:1024 sc1
    buffer_load_dwordx4 v[88:91], v1, s[4:7], s44 offen offset:2048 sc1
    buffer_load_dwordx4 v[92:95], v1, s[4:7], s44 offen offset:3072 sc1
    s_barrier
    s_cmp_ge_u32 s21, 2
    s_cbranch_scc1 h_c_ok
    s_lshl_b32 s44, s21, 11
    s_lshl_b32 s67, s18, 7
    s_add_u32 s44, s44, s67
    s_add_u32 s44, s44, 0
    s_mov_b32 s66, 0x10000
h_c_poll:
    s_mov_b32 s68, 0
    s_atomic_add s68, s[22:23], s44 offset:0 glc
    s_sub_u32 s66, s66, 1
    s_cselect_b32 s67, 48, 0
    s_waitcnt lgkmcnt(0)
    s_max_u32 s68, s68, s67
    s_cmp_lt_u32 s68, 48
    s_cbranch_scc1 h_c_poll
h_c_ok:
    s_waitcnt vmcnt(0)
    s_lshl_b32 s3, s21, 8
    s_add_u32 s3, s3, s2
    s_lshr_b32 s3, s3, 3
    s_cmp_eq_u32 s3, 2
    s_cbranch_scc0 h_nf1
    s_atomic_add s40, s[34:35], 128
h_nf1:
    s_barrier
    s_cmp_ge_u32 s21, 2
    s_cbranch_scc1 h_cs1
    s_lshl_b32 s44, s21, 18
    s_lshl_b32 s45, s18, 14
    s_add_u32 s44, s44, s45
    s_add_u32 s44, s44, 52428800
    buffer_load_dwordx4 v[96:99], v1, s[4:7], s44 offen offset:0 sc1
    buffer_load_dwordx4 v[100:103], v1, s[4:7], s44 offen offset:1024 sc1
    buffer_load_dwordx4 v[104:107], v1, s[4:7], s44 offen offset:2048 sc1
    buffer_load_dwordx4 v[108:111], v1, s[4:7], s44 offen offset:3072 sc1
    s_add_u32 s44, s44, 4096
    buffer_load_dwordx4 v[112:115], v1, s[4:7], s44 offen offset:0 sc1
    buffer_load_dwordx4 v[116:119], v1, s[4:7], s44 offen offset:1024 sc1
    buffer_load_dwordx4 v[120:123], v1, s[4:7], s44 offen offset:2048 sc1
    buffer_load_dwordx4 v[124:127], v1, s[4:7], s44 offen offset:3072 sc1
    s_add_u32 s44, s44, 4096
    buffer_load_dwordx4 v[128:131], v1, s[4:7], s44 offen offset:0 sc1
    buffer_load_dwordx4 v[132:135], v1, s[4:7], s44 offen offset:1024 sc1
    buffer_load_dwordx4 v[136:139], v1, s[4:7], s44 offen offset:2048 sc1
    buffer_load_dwordx4 v[140:143], v1, s[4:7], s44 offen offset:3072 sc1
    s_add_u32 s44, s44, 4096
    buffer_load_dwordx4 v[144:147], v1, s[4:7], s44 offen offset:0 sc1
    buffer_load_dwordx4 v[148:151], v1, s[4:7], s44 offen offset:1024 sc1
    buffer_load_dwordx4 v[152:155], v1, s[4:7], s44 offen offset:2048 sc1
    buffer_load_dwordx4 v[156:159], v1, s[4:7], s44 offen offset:3072 sc1
h_cs1:
    v_add_f32 v32, v32, v36
    v_add_f32 v33, v33, v37
    v_add_f32 v34, v34, v38
    v_add_f32 v35, v35, v39
    v_add_f32 v48, v48, v52
    v_add_f32 v49, v49, v53
    v_add_f32 v50, v50, v54
    v_add_f32 v51, v51, v55
    v_add_f32 v64, v64, v68
    v_add_f32 v65, v65, v69
    v_add_f32 v66, v66, v70
    v_add_f32 v67, v67, v71
    v_add_f32 v80, v80, v84
    v_add_f32 v81, v81, v85
    v_add_f32 v82, v82, v86
    v_add_f32 v83, v83, v87
    v_add_f32 v32, v32, v40
    v_add_f32 v33, v33, v41
    v_add_f32 v34, v34, v42
    v_add_f32 v35, v35, v43
    v_add_f32 v48, v48, v56
    v_add_f32 v49, v49, v57
    v_add_f32 v50, v50, v58
    v_add_f32 v51, v51, v59
    v_add_f32 v64, v64, v72
    v_add_f32 v65, v65, v73
    v_add_f32 v66, v66, v74
    v_add_f32 v67, v67, v75
    v_add_f32 v80, v80, v88
    v_add_f32 v81, v81, v89
    v_add_f32 v82, v82, v90
    v_add_f32 v83, v83, v91
    s_barrier
    v_add_f32 v32, v32, v44
    v_add_f32 v33, v33, v45
    v_add_f32 v34, v34, v46
    v_add_f32 v35, v35, v47
    v_add_f32 v48, v48, v60
    v_add_f32 v49, v49, v61
    v_add_f32 v50, v50, v62
    v_add_f32 v51, v51, v63
    v_add_f32 v64, v64, v76
    v_add_f32 v65, v65, v77
    v_add_f32 v66, v66, v78
    v_add_f32 v67, v67, v79
    v_add_f32 v80, v80, v92
    v_add_f32 v81, v81, v93
    v_add_f32 v82, v82, v94
    v_add_f32 v83, v83, v95
    v_permlane32_swap_b32 v32, v64
    v_permlane32_swap_b32 v33, v65
    v_permlane32_swap_b32 v34, v66
    v_permlane32_swap_b32 v35, v67
    v_add_f32 v32, v32, v64
    v_add_f32 v33, v33, v65
    v_add_f32 v34, v34, v66
    v_add_f32 v35, v35, v67
    v_permlane32_swap_b32 v48, v80
    v_permlane32_swap_b32 v49, v81
    v_permlane32_swap_b32 v50, v82
    v_permlane32_swap_b32 v51, v83
    v_add_f32 v48, v48, v80
    v_add_f32 v49, v49, v81
    v_add_f32 v50, v50, v82
    v_add_f32 v51, v51, v83
    v_permlane16_swap_b32 v32, v48
    v_permlane16_swap_b32 v33, v49
    v_permlane16_swap_b32 v34, v50
    v_permlane16_swap_b32 v35, v51
    v_add_f32 v32, v32, v48
    v_add_f32 v33, v33, v49
    v_add_f32 v34, v34, v50
    v_add_f32 v35, v35, v51
    s_barrier
    v_mul_f32 v32, 0x3a800000, v32
    v_mul_f32 v33, 0x3a800000, v33
    v_mul_f32 v34, 0x3a800000, v34
    v_mul_f32 v35, 0x3a800000, v35
    v_fma_f32 v33, -v32, v32, v33
    v_fma_f32 v35, -v34, v34, v35
    v_max_f32 v33, 0, v33
    v_max_f32 v35, 0, v35
    v_add_f32 v33, 0x3727c5ac, v33
    v_add_f32 v35, 0x3727c5ac, v35
    v_rsq_f32 v33, v33
    v_rsq_f32 v35, v35
    v_lshrrev_b32 v26, 1, v1
    v_add_u32 v26, 155648, v26
    ds_write2_b32 v26, v32, v34 offset0:0 offset1:1
    ds_write2_b32 v26, v33, v35 offset0:128 offset1:129
    s_barrier
    s_cmp_ge_u32 s21, 2
    s_cbranch_scc1 h_cs_done
    s_waitcnt vmcnt(0)
    v_add_f32 v96, v96, v100
    v_add_f32 v97, v97, v101
    v_add_f32 v98, v98, v102
    v_add_f32 v99, v99, v103
    v_add_f32 v96, v96, v104
    v_add_f32 v97, v97, v105
    v_add_f32 v98, v98, v106
    v_add_f32 v99, v99, v107
    v_add_f32 v96, v96, v108
    v_add_f32 v97, v97, v109
    v_add_f32 v98, v98, v110
    v_add_f32 v99, v99, v111
    v_add_f32 v96, v96, v112
    v_add_f32 v97, v97, v113
    v_add_f32 v98, v98, v114
    v_add_f32 v99, v99, v115
    v_add_f32 v96, v96, v116
    v_add_f32 v97, v97, v117
    v_add_f32 v98, v98, v118
    v_add_f32 v99, v99, v119
    v_add_f32 v96, v96, v120
    v_add_f32 v97, v97, v121
    v_add_f32 v98, v98, v122
    v_add_f32 v99, v99, v123
    v_add_f32 v96, v96, v124
    v_add_f32 v97, v97, v125
    v_add_f32 v98, v98, v126
    v_add_f32 v99, v99, v127
    v_add_f32 v96, v96, v128
    v_add_f32 v97, v97, v129
    v_add_f32 v98, v98, v130
    v_add_f32 v99, v99, v131
    v_add_f32 v96, v96, v132
    v_add_f32 v97, v97, v133
    v_add_f32 v98, v98, v134
    v_add_f32 v99, v99, v135
    v_add_f32 v96, v96, v136
    v_add_f32 v97, v97, v137
    v_add_f32 v98, v98, v138
    v_add_f32 v99, v99, v139
    v_add_f32 v96, v96, v140
    v_add_f32 v97, v97, v141
    v_add_f32 v98, v98, v142
    v_add_f32 v99, v99, v143
    v_add_f32 v96, v96, v144
    v_add_f32 v97, v97, v145
    v_add_f32 v98, v98, v146
    v_add_f32 v99, v99, v147
    v_add_f32 v96, v96, v148
    v_add_f32 v97, v97, v149
    v_add_f32 v98, v98, v150
    v_add_f32 v99, v99, v151
    v_add_f32 v96, v96, v152
    v_add_f32 v97, v97, v153
    v_add_f32 v98, v98, v154
    v_add_f32 v99, v99, v155
    v_add_f32 v96, v96, v156
    v_add_f32 v97, v97, v157
    v_add_f32 v98, v98, v158
    v_add_f32 v99, v99, v159
    s_lshl_b32 s44, s21, 10
    s_add_u32 s44, s44, 151552
    v_add_u32 v24, s44, v1
    ds_write_b128 v24, v[96:99]
h_cs_done:
    s_waitcnt lgkmcnt(0)
    s_barrier
    s_cmp_lg_u32 s21, 0
    s_cbranch_scc1 h_f1_ok
    s_load_dword s68, s[34:35], 128
    s_mov_b32 s8, s34
    s_mov_b32 s9, s35
    s_mov_b32 s10, 256
    s_mov_b32 s11, 0x00020000
    s_mov_b32 s66, 0x10000
    v_mov_b32 v24, 0
    s_waitcnt lgkmcnt(0)
h_f1:
    s_cmp_eq_u32 s68, 8
    s_cbranch_scc1 h_f1_ok
    buffer_load_dword v25, v24, s[8:11], 0 offen offset:128 sc1
    s_waitcnt vmcnt(0)
    v_readfirstlane_b32 s68, v25
    s_sub_u32 s66, s66, 1
    s_cmp_lg_u32 s66, 0
    s_cbranch_scc1 h_f1
h_f1_ok:
    s_barrier
    s_bitcmp1_b32 s21, 0
    s_cselect_b32 s8, s28, s24
    s_cselect_b32 s9, s29, s25
    s_cselect_b32 s12, s30, s26
    s_cselect_b32 s13, s31, s27
    s_mov_b32 s10, 6291456
    s_mov_b32 s11, 0x00020000
    s_mov_b32 s14, 2097152
    s_mov_b32 s15, 0x00020000
    v_lshrrev_b32 v28, 4, v1
    v_and_b32 v29, 7, v28
    v_lshrrev_b32 v28, 3, v28
    v_mul_u32_u24 v28, 2048, v28
    v_lshl_add_u32 v28, v29, 4, v28
    s_and_b32 s3, s18, 12
    s_or_b32 s3, s3, 3
    s_lshl_b32 s3, s3, 7
    v_add_u32 v28, s3, v28
    s_lshr_b32 s3, s2, 3
    s_lshl_b32 s3, s3, 2
    s_and_b32 s60, s16, 3
    s_add_u32 s60, s60, s3
    s_lshl_b32 s61, s60, 14
    buffer_load_dwordx4 v[144:147], v28, s[12:15], s61 offen
    s_bitcmp0_b32 s21, 0
    s_cselect_b32 s56, s28, s24
    s_cselect_b32 s57, s29, s25
    s_mov_b32 s58, 6291456
    s_mov_b32 s59, 0x00020000
    v_lshrrev_b32 v28, 4, v1
    v_and_b32 v29, 7, v28
    v_lshrrev_b32 v28, 3, v28
    v_mul_u32_u24 v28, 6144, v28
    v_lshl_add_u32 v28, v29, 4, v28
    s_and_b32 s3, s18, 12
    s_or_b32 s3, s3, 3
    s_lshl_b32 s3, s3, 7
    v_add_u32 v28, s3, v28
    s_lshr_b32 s3, s2, 3
    s_lshl_b32 s3, s3, 2
    s_and_b32 s60, s16, 3
    s_add_u32 s60, s60, s3
    s_and_b32 s3, s60, 31
    s_mul_i32 s3, s3, 49152
    s_lshr_b32 s61, s60, 5
    s_min_u32 s61, s61, 2
    s_lshl_b32 s61, s61, 11
    s_add_u32 s61, s61, s3
    s_cmp_lt_u32 s18, 4
    s_cselect_b32 s3, 1572864, 0
    s_add_u32 s61, s61, s3
    buffer_load_dwordx4 v[148:151], v28, s[56:59], s61 offen
    s_bitcmp1_b32 s21, 0
    s_cbranch_scc1 h_pe
    s_bitcmp0_b32 s21, 0
    s_cselect_b32 s56, s28, s24
    s_cselect_b32 s57, s29, s25
    s_mov_b32 s58, 6291456
    s_mov_b32 s59, 0x00020000
    s_add_u32 s61, s84, 2048
    buffer_load_dwordx4 v[160:163], v11, s[56:59], s61 offen
    s_add_u32 s61, s84, 4096
    buffer_load_dwordx4 v[164:167], v11, s[56:59], s61 offen
    s_add_u32 s61, s84, 0
    buffer_load_dwordx4 v[168:171], v11, s[56:59], s61 offen
    s_add_u32 s61, s84, 198656
    buffer_load_dwordx4 v[172:175], v11, s[56:59], s61 offen
    s_add_u32 s61, s84, 200704
    buffer_load_dwordx4 v[176:179], v11, s[56:59], s61 offen
    s_add_u32 s61, s84, 196608
    buffer_load_dwordx4 v[180:183], v11, s[56:59], s61 offen
h_pe:
    s_barrier
    s_branch s_tail
z_start:
    v_lshrrev_b32 v24, 4, v1
    v_lshrrev_b32 v25, 3, v24
    v_mul_u32_u24 v20, 6144, v25
    v_and_b32 v25, 7, v24
    v_lshl_add_u32 v20, v25, 4, v20
    s_add_u32 s3, s18, 2
    s_and_b32 s3, s3, 15
    s_lshl_b32 s3, s3, 7
    s_add_u32 s3, s3, 4096
    v_add_u32 v22, s3, v20
    s_add_u32 s3, s18, 1
    s_and_b32 s3, s3, 15
    s_lshl_b32 s3, s3, 7
    s_add_u32 s3, s3, 2048
    v_add_u32 v21, s3, v20
    s_add_u32 s3, s18, 0
    s_and_b32 s3, s3, 15
    s_lshl_b32 s3, s3, 7
    s_add_u32 s3, s3, 0
    v_add_u32 v20, s3, v20
    s_waitcnt lgkmcnt(0)
    s_mov_b32 s8, s24
    s_mov_b32 s9, s25
    s_mov_b32 s10, 6291456
    s_mov_b32 s11, 0x00020000
    s_mul_i32 s44, s17, 393216
    buffer_load_dwordx4 v[32:35], v20, s[8:11], s44 offen
    buffer_load_dwordx4 v[64:67], v21, s[8:11], s44 offen
    buffer_load_dwordx4 v[96:99], v22, s[8:11], s44 offen
    s_add_u32 s44, s44, 49152
    buffer_load_dwordx4 v[36:39], v20, s[8:11], s44 offen
    buffer_load_dwordx4 v[68:71], v21, s[8:11], s44 offen
    buffer_load_dwordx4 v[100:103], v22, s[8:11], s44 offen
    s_add_u32 s44, s44, 49152
    buffer_load_dwordx4 v[40:43], v20, s[8:11], s44 offen
    buffer_load_dwordx4 v[72:75], v21, s[8:11], s44 offen
    buffer_load_dwordx4 v[104:107], v22, s[8:11], s44 offen
    s_add_u32 s44, s44, 49152
    buffer_load_dwordx4 v[44:47], v20, s[8:11], s44 offen
    buffer_load_dwordx4 v[76:79], v21, s[8:11], s44 offen
    buffer_load_dwordx4 v[108:111], v22, s[8:11], s44 offen
    s_add_u32 s44, s44, 49152
    buffer_load_dwordx4 v[48:51], v20, s[8:11], s44 offen
    buffer_load_dwordx4 v[80:83], v21, s[8:11], s44 offen
    buffer_load_dwordx4 v[112:115], v22, s[8:11], s44 offen
    s_add_u32 s44, s44, 49152
    buffer_load_dwordx4 v[52:55], v20, s[8:11], s44 offen
    buffer_load_dwordx4 v[84:87], v21, s[8:11], s44 offen
    buffer_load_dwordx4 v[116:119], v22, s[8:11], s44 offen
    s_add_u32 s44, s44, 49152
    buffer_load_dwordx4 v[56:59], v20, s[8:11], s44 offen
    buffer_load_dwordx4 v[88:91], v21, s[8:11], s44 offen
    buffer_load_dwordx4 v[120:123], v22, s[8:11], s44 offen
    s_add_u32 s44, s44, 49152
    buffer_load_dwordx4 v[60:63], v20, s[8:11], s44 offen
    buffer_load_dwordx4 v[92:95], v21, s[8:11], s44 offen
    buffer_load_dwordx4 v[124:127], v22, s[8:11], s44 offen
    v_lshrrev_b32 v24, 4, v1
    v_lshrrev_b32 v25, 3, v24
    v_mul_u32_u24 v12, 6144, v25
    v_and_b32 v26, 2, v25
    v_lshrrev_b32 v25, 2, v25
    v_or_b32 v26, v26, v25
    v_bfe_u32 v25, v24, 1, 2
    v_xor_b32 v26, v26, v25
    v_lshl_add_u32 v12, v26, 5, v12
    v_and_b32 v26, 1, v24
    v_lshl_add_u32 v12, v26, 4, v12
    s_lshl_b32 s3, s18, 7
    v_add_u32 v12, s3, v12
    v_add_u32 v13, 48128, v12
    s_mul_i32 s84, s18, 393216
    s_cmp_lt_u32 s18, 4
    s_cselect_b32 s85, 4, 0
    s_mul_i32 s85, s85, 393216
    s_cmp_lt_u32 s18, 4
    s_cselect_b32 s86, 5, 1
    s_mul_i32 s86, s86, 393216
    s_cmp_lt_u32 s18, 4
    s_cselect_b32 s87, 6, 2
    s_mul_i32 s87, s87, 393216
    s_cmp_lt_u32 s18, 4
    s_cselect_b32 s88, 7, 3
    s_mul_i32 s88, s88, 393216
    s_cmp_lt_u32 s18, 8
    s_cselect_b32 s89, 8, 4
    s_mul_i32 s89, s89, 393216
    s_cmp_lt_u32 s18, 8
    s_cselect_b32 s90, 9, 5
    s_mul_i32 s90, s90, 393216
    s_cmp_lt_u32 s18, 8
    s_cselect_b32 s91, 10, 6
    s_mul_i32 s91, s91, 393216
    s_cmp_lt_u32 s18, 8
    s_cselect_b32 s92, 11, 7
    s_mul_i32 s92, s92, 393216
    s_cmp_lt_u32 s18, 12
    s_cselect_b32 s93, 12, 8
    s_mul_i32 s93, s93, 393216
    s_cmp_lt_u32 s18, 12
    s_cselect_b32 s94, 13, 9
    s_mul_i32 s94, s94, 393216
    s_cmp_lt_u32 s18, 12
    s_cselect_b32 s95, 14, 10
    s_mul_i32 s95, s95, 393216
    s_cmp_lt_u32 s18, 12
    s_cselect_b32 s96, 15, 11
    s_mul_i32 s96, s96, 393216
    s_xor_b32 s97, s18, 1
    s_mul_i32 s97, s97, 393216
    s_xor_b32 s98, s18, 2
    s_mul_i32 s98, s98, 393216
    s_xor_b32 s99, s18, 3
    s_mul_i32 s99, s99, 393216
    v_lshrrev_b32 v24, 4, v1
    v_lshrrev_b32 v25, 3, v24
    v_mul_u32_u24 v16, 2048, v25
    v_and_b32 v26, 2, v25
    v_lshrrev_b32 v25, 2, v25
    v_or_b32 v26, v26, v25
    v_bfe_u32 v25, v24, 1, 2
    v_xor_b32 v26, v26, v25
    v_lshl_add_u32 v16, v26, 5, v16
    v_and_b32 v26, 1, v24
    v_lshl_add_u32 v16, v26, 4, v16
    s_lshl_b32 s3, s18, 7
    v_add_u32 v16, s3, v16
    v_add_u32 v17, 15360, v16
    v_add_u32 v18, 30720, v16
    v_add_u32 v19, 46080, v16
    s_and_b32 s3, s16, 3
    s_mul_i32 s3, s3, 49152
    v_add_u32 v11, s3, v12
    s_and_b32 s3, s16, 3
    s_lshl_b32 s3, s3, 10
    v_add_u32 v9, s3, v1
    v_add_u32 v10, 0x10000, v9
    s_barrier
    v_lshrrev_b32 v24, 4, v1
    v_and_b32 v25, 1, v24
    v_lshlrev_b32 v25, 4, v25
    v_mov_b32 v26, 0x3f80
    v_lshlrev_b32 v25, v25, v26
    v_bfe_u32 v26, v24, 1, 2
    v_cmp_eq_u32 vcc, 0, v26
    s_nop 1
    v_cndmask_b32 v140, 0, v25, vcc
    v_cmp_eq_u32 vcc, 1, v26
    s_nop 1
    v_cndmask_b32 v141, 0, v25, vcc
    v_cmp_eq_u32 vcc, 2, v26
    s_nop 1
    v_cndmask_b32 v142, 0, v25, vcc
    v_cmp_eq_u32 vcc, 3, v26
    s_nop 1
    v_cndmask_b32 v143, 0, v25, vcc
    v_bfe_u32 v25, v24, 3, 1
    v_lshrrev_b32 v26, 5, v24
    v_lshl_add_u32 v26, v26, 1, v25
    v_lshlrev_b32 v25, 8, v26
    v_and_b32 v27, 7, v24
    v_lshl_add_u32 v25, v27, 5, v25
    v_bfe_u32 v27, v24, 4, 1
    v_lshl_add_u32 v25, v27, 4, v25
    v_add_u32 v27, s18, v26
    v_and_b32 v27, 15, v27
    v_lshl_add_u32 v25, v27, 14, v25
    s_lshl_b32 s44, s17, 10
    s_add_u32 s44, s44, 52428800
    s_waitcnt vmcnt(21)
    v_mfma_f32_16x16x32_bf16 v[128:131], v[140:143], v[32:35], 0
    v_mfma_f32_16x16x32_bf16 v[132:135], v[140:143], v[64:67], 0
    v_mfma_f32_16x16x32_bf16 v[136:139], v[140:143], v[96:99], 0
    s_waitcnt vmcnt(18)
    v_mfma_f32_16x16x32_bf16 v[128:131], v[140:143], v[36:39], v[128:131]
    v_mfma_f32_16x16x32_bf16 v[132:135], v[140:143], v[68:71], v[132:135]
    v_mfma_f32_16x16x32_bf16 v[136:139], v[140:143], v[100:103], v[136:139]
    s_waitcnt vmcnt(15)
    v_mfma_f32_16x16x32_bf16 v[128:131], v[140:143], v[40:43], v[128:131]
    v_mfma_f32_16x16x32_bf16 v[132:135], v[140:143], v[72:75], v[132:135]
    v_mfma_f32_16x16x32_bf16 v[136:139], v[140:143], v[104:107], v[136:139]
    s_waitcnt vmcnt(12)
    v_mfma_f32_16x16x32_bf16 v[128:131], v[140:143], v[44:47], v[128:131]
    v_mfma_f32_16x16x32_bf16 v[132:135], v[140:143], v[76:79], v[132:135]
    v_mfma_f32_16x16x32_bf16 v[136:139], v[140:143], v[108:111], v[136:139]
    s_waitcnt vmcnt(9)
    v_mfma_f32_16x16x32_bf16 v[128:131], v[140:143], v[48:51], v[128:131]
    v_mfma_f32_16x16x32_bf16 v[132:135], v[140:143], v[80:83], v[132:135]
    v_mfma_f32_16x16x32_bf16 v[136:139], v[140:143], v[112:115], v[136:139]
    s_waitcnt vmcnt(6)
    v_mfma_f32_16x16x32_bf16 v[128:131], v[140:143], v[52:55], v[128:131]
    v_mfma_f32_16x16x32_bf16 v[132:135], v[140:143], v[84:87], v[132:135]
    v_mfma_f32_16x16x32_bf16 v[136:139], v[140:143], v[116:119], v[136:139]
    s_waitcnt vmcnt(3)
    v_mfma_f32_16x16x32_bf16 v[128:131], v[140:143], v[56:59], v[128:131]
    v_mfma_f32_16x16x32_bf16 v[132:135], v[140:143], v[88:91], v[132:135]
    v_mfma_f32_16x16x32_bf16 v[136:139], v[140:143], v[120:123], v[136:139]
    s_waitcnt vmcnt(0)
    v_mfma_f32_16x16x32_bf16 v[128:131], v[140:143], v[60:63], v[128:131]
    v_mfma_f32_16x16x32_bf16 v[132:135], v[140:143], v[92:95], v[132:135]
    v_mfma_f32_16x16x32_bf16 v[136:139], v[140:143], v[124:127], v[136:139]
    s_barrier
    v_lshrrev_b32 v28, 4, v1
    v_and_b32 v29, 7, v28
    v_lshrrev_b32 v28, 3, v28
    v_mul_u32_u24 v28, 6144, v28
    v_lshl_add_u32 v28, v29, 4, v28
    s_and_b32 s3, s18, 12
    s_or_b32 s3, s3, 3
    s_lshl_b32 s3, s3, 7
    v_add_u32 v28, s3, v28
    s_lshr_b32 s3, s2, 3
    s_lshl_b32 s3, s3, 2
    s_and_b32 s60, s16, 3
    s_add_u32 s60, s60, s3
    s_lshr_b32 s60, s60, 2
    s_mul_i32 s60, s60, 49152
    s_cmp_lt_u32 s18, 4
    s_cselect_b32 s3, 0, 1
    s_mul_i32 s3, s3, 1572864
    s_add_u32 s3, s3, s60
    s_add_u32 s61, s3, 0
    buffer_load_dwordx4 v[160:163], v28, s[8:11], s61 offen
    s_add_u32 s61, s3, 2048
    buffer_load_dwordx4 v[164:167], v28, s[8:11], s61 offen
    s_add_u32 s61, s3, 4096
    buffer_load_dwordx4 v[168:171], v28, s[8:11], s61 offen
    s_add_u32 s3, s60, 3145728
    s_add_u32 s61, s3, 0
    buffer_load_dwordx4 v[172:175], v28, s[8:11], s61 offen
    s_add_u32 s61, s3, 2048
    buffer_load_dwordx4 v[176:179], v28, s[8:11], s61 offen
    s_add_u32 s61, s3, 4096
    buffer_load_dwordx4 v[180:183], v28, s[8:11], s61 offen
    s_add_u32 s3, s60, 4718592
    s_add_u32 s61, s3, 0
    buffer_load_dwordx4 v[184:187], v28, s[8:11], s61 offen
    s_add_u32 s61, s3, 2048
    buffer_load_dwordx4 v[188:191], v28, s[8:11], s61 offen
    s_add_u32 s61, s3, 4096
    buffer_load_dwordx4 v[192:195], v28, s[8:11], s61 offen
    v_add_f32_dpp v128, v128, v128 row_ror:8 row_mask:0xf bank_mask:0xf
    v_add_f32_dpp v129, v129, v129 row_ror:8 row_mask:0xf bank_mask:0xf
    v_add_f32_dpp v130, v130, v130 row_ror:8 row_mask:0xf bank_mask:0xf
    v_add_f32_dpp v131, v131, v131 row_ror:8 row_mask:0xf bank_mask:0xf
    v_add_f32_dpp v132, v132, v132 row_ror:8 row_mask:0xf bank_mask:0xf
    v_add_f32_dpp v133, v133, v133 row_ror:8 row_mask:0xf bank_mask:0xf
    v_add_f32_dpp v134, v134, v134 row_ror:8 row_mask:0xf bank_mask:0xf
    v_add_f32_dpp v135, v135, v135 row_ror:8 row_mask:0xf bank_mask:0xf
    v_add_f32_dpp v136, v136, v136 row_ror:8 row_mask:0xf bank_mask:0xf
    v_add_f32_dpp v137, v137, v137 row_ror:8 row_mask:0xf bank_mask:0xf
    v_add_f32_dpp v138, v138, v138 row_ror:8 row_mask:0xf bank_mask:0xf
    v_add_f32_dpp v139, v139, v139 row_ror:8 row_mask:0xf bank_mask:0xf
    v_cmp_le_u32 vcc, 1, v26
    s_nop 1
    v_cndmask_b32 v128, v128, v132, vcc
    v_cndmask_b32 v129, v129, v133, vcc
    v_cndmask_b32 v130, v130, v134, vcc
    v_cndmask_b32 v131, v131, v135, vcc
    v_cmp_le_u32 vcc, 2, v26
    s_nop 1
    v_cndmask_b32 v128, v128, v136, vcc
    v_cndmask_b32 v129, v129, v137, vcc
    v_cndmask_b32 v130, v130, v138, vcc
    v_cndmask_b32 v131, v131, v139, vcc
    buffer_store_dwordx4 v[128:131], v25, s[4:7], s44 offen sc1
    s_barrier
    s_barrier
    s_waitcnt vmcnt(0)
    s_add_u32 s44, s18, 0
    s_and_b32 s44, s44, 15
    s_lshl_b32 s44, s44, 7
    s_add_u32 s44, s44, 0
    s_atomic_add s40, s[22:23], s44
    s_add_u32 s45, s18, 1
    s_and_b32 s45, s45, 15
    s_lshl_b32 s45, s45, 7
    s_add_u32 s45, s45, 0
    s_atomic_add s40, s[22:23], s45
    s_add_u32 s46, s18, 2
    s_and_b32 s46, s46, 15
    s_lshl_b32 s46, s46, 7
    s_add_u32 s46, s46, 0
    s_atomic_add s40, s[22:23], s46
    s_barrier
    s_barrier
    s_barrier
    s_barrier
    s_barrier
    s_barrier
    s_mov_b32 s12, s26
    s_mov_b32 s13, s27
    s_mov_b32 s14, 2097152
    s_mov_b32 s15, 0x00020000
    s_lshl_b32 s44, s2, 13
    buffer_load_dwordx4 v[160:163], v1, s[12:15], s44 offen offset:0
    buffer_load_dwordx4 v[164:167], v1, s[12:15], s44 offen offset:1024
    buffer_load_dwordx4 v[168:171], v1, s[12:15], s44 offen offset:2048
    buffer_load_dwordx4 v[172:175], v1, s[12:15], s44 offen offset:3072
    s_add_u32 s44, s44, 4096
    buffer_load_dwordx4 v[176:179], v1, s[12:15], s44 offen offset:0
    buffer_load_dwordx4 v[180:183], v1, s[12:15], s44 offen offset:1024
    buffer_load_dwordx4 v[184:187], v1, s[12:15], s44 offen offset:2048
    buffer_load_dwordx4 v[188:191], v1, s[12:15], s44 offen offset:3072
    s_mov_b32 s8, s28
    s_mov_b32 s9, s29
    s_mov_b32 s10, 6291456
    s_mov_b32 s11, 0x00020000
    s_mul_i32 s44, s17, 393216
    buffer_load_dwordx4 v[32:35], v20, s[8:11], s44 offen
    buffer_load_dwordx4 v[64:67], v21, s[8:11], s44 offen
    buffer_load_dwordx4 v[96:99], v22, s[8:11], s44 offen
    s_add_u32 s44, s44, 49152
    buffer_load_dwordx4 v[36:39], v20, s[8:11], s44 offen
    buffer_load_dwordx4 v[68:71], v21, s[8:11], s44 offen
    buffer_load_dwordx4 v[100:103], v22, s[8:11], s44 offen
    s_add_u32 s44, s44, 49152
    buffer_load_dwordx4 v[40:43], v20, s[8:11], s44 offen
    buffer_load_dwordx4 v[72:75], v21, s[8:11], s44 offen
    buffer_load_dwordx4 v[104:107], v22, s[8:11], s44 offen
    s_add_u32 s44, s44, 49152
    s_barrier
    buffer_load_dwordx4 v[44:47], v20, s[8:11], s44 offen
    buffer_load_dwordx4 v[76:79], v21, s[8:11], s44 offen
    buffer_load_dwordx4 v[108:111], v22, s[8:11], s44 offen
    s_add_u32 s44, s44, 49152
    buffer_load_dwordx4 v[48:51], v20, s[8:11], s44 offen
    buffer_load_dwordx4 v[80:83], v21, s[8:11], s44 offen
    buffer_load_dwordx4 v[112:115], v22, s[8:11], s44 offen
    s_add_u32 s44, s44, 49152
    buffer_load_dwordx4 v[52:55], v20, s[8:11], s44 offen
    buffer_load_dwordx4 v[84:87], v21, s[8:11], s44 offen
    buffer_load_dwordx4 v[116:119], v22, s[8:11], s44 offen
    s_add_u32 s44, s44, 49152
    buffer_load_dwordx4 v[56:59], v20, s[8:11], s44 offen
    buffer_load_dwordx4 v[88:91], v21, s[8:11], s44 offen
    buffer_load_dwordx4 v[120:123], v22, s[8:11], s44 offen
    s_add_u32 s44, s44, 49152
    buffer_load_dwordx4 v[60:63], v20, s[8:11], s44 offen
    buffer_load_dwordx4 v[92:95], v21, s[8:11], s44 offen
    buffer_load_dwordx4 v[124:127], v22, s[8:11], s44 offen
    s_bitcmp1_b32 s21, 0
    s_cselect_b32 s8, s28, s24
    s_cselect_b32 s9, s29, s25
    s_cselect_b32 s12, s30, s26
    s_cselect_b32 s13, s31, s27
    s_mov_b32 s10, 6291456
    s_mov_b32 s11, 0x00020000
    s_mov_b32 s14, 2097152
    s_mov_b32 s15, 0x00020000
    v_lshrrev_b32 v28, 4, v1
    v_and_b32 v29, 7, v28
    v_lshrrev_b32 v28, 3, v28
    v_mul_u32_u24 v28, 2048, v28
    v_lshl_add_u32 v28, v29, 4, v28
    s_and_b32 s3, s18, 12
    s_or_b32 s3, s3, 3
    s_lshl_b32 s3, s3, 7
    v_add_u32 v28, s3, v28
    s_lshr_b32 s3, s2, 3
    s_lshl_b32 s3, s3, 2
    s_and_b32 s60, s16, 3
    s_add_u32 s60, s60, s3
    s_lshl_b32 s61, s60, 14
    buffer_load_dwordx4 v[144:147], v28, s[12:15], s61 offen
    s_bitcmp0_b32 s21, 0
    s_cselect_b32 s56, s28, s24
    s_cselect_b32 s57, s29, s25
    s_mov_b32 s58, 6291456
    s_mov_b32 s59, 0x00020000
    v_lshrrev_b32 v28, 4, v1
    v_and_b32 v29, 7, v28
    v_lshrrev_b32 v28, 3, v28
    v_mul_u32_u24 v28, 6144, v28
    v_lshl_add_u32 v28, v29, 4, v28
    s_and_b32 s3, s18, 12
    s_or_b32 s3, s3, 3
    s_lshl_b32 s3, s3, 7
    v_add_u32 v28, s3, v28
    s_lshr_b32 s3, s2, 3
    s_lshl_b32 s3, s3, 2
    s_and_b32 s60, s16, 3
    s_add_u32 s60, s60, s3
    s_and_b32 s3, s60, 31
    s_mul_i32 s3, s3, 49152
    s_lshr_b32 s61, s60, 5
    s_min_u32 s61, s61, 2
    s_lshl_b32 s61, s61, 11
    s_add_u32 s61, s61, s3
    s_cmp_lt_u32 s18, 4
    s_cselect_b32 s3, 1572864, 0
    s_add_u32 s61, s61, s3
    buffer_load_dwordx4 v[148:151], v28, s[56:59], s61 offen
    s_bitcmp1_b32 s21, 0
    s_cbranch_scc1 z0_pe
    s_bitcmp0_b32 s21, 0
    s_cselect_b32 s56, s28, s24
    s_cselect_b32 s57, s29, s25
    s_mov_b32 s58, 6291456
    s_mov_b32 s59, 0x00020000
    s_add_u32 s61, s84, 2048
    buffer_load_dwordx4 v[160:163], v11, s[56:59], s61 offen
    s_add_u32 s61, s84, 4096
    buffer_load_dwordx4 v[164:167], v11, s[56:59], s61 offen
    s_add_u32 s61, s84, 0
    buffer_load_dwordx4 v[168:171], v11, s[56:59], s61 offen
    s_add_u32 s61, s84, 198656
    buffer_load_dwordx4 v[172:175], v11, s[56:59], s61 offen
    s_add_u32 s61, s84, 200704
    buffer_load_dwordx4 v[176:179], v11, s[56:59], s61 offen
    s_add_u32 s61, s84, 196608
    buffer_load_dwordx4 v[180:183], v11, s[56:59], s61 offen
z0_pe:
    s_barrier
    s_bitcmp1_b32 s21, 0
    s_cselect_b32 s8, s28, s24
    s_cselect_b32 s9, s29, s25
    s_cselect_b32 s12, s30, s26
    s_cselect_b32 s13, s31, s27
    s_mov_b32 s10, 6291456
    s_mov_b32 s11, 0x00020000
    s_mov_b32 s14, 2097152
    s_mov_b32 s15, 0x00020000
    s_branch s_tail
z_layer:
    s_waitcnt lgkmcnt(0)
    v_lshrrev_b32 v28, 4, v1
    v_and_b32 v29, 7, v28
    v_lshrrev_b32 v28, 3, v28
    v_mul_u32_u24 v28, 6144, v28
    v_lshl_add_u32 v28, v29, 4, v28
    s_and_b32 s3, s18, 12
    s_or_b32 s3, s3, 3
    s_lshl_b32 s3, s3, 7
    v_add_u32 v28, s3, v28
    s_lshr_b32 s3, s2, 3
    s_lshl_b32 s3, s3, 2
    s_and_b32 s60, s16, 3
    s_add_u32 s60, s60, s3
    s_lshr_b32 s60, s60, 2
    s_mul_i32 s60, s60, 49152
    s_cmp_lt_u32 s18, 4
    s_cselect_b32 s3, 0, 1
    s_mul_i32 s3, s3, 1572864
    s_add_u32 s3, s3, s60
    s_add_u32 s61, s3, 0
    buffer_load_dwordx4 v[160:163], v28, s[8:11], s61 offen
    s_add_u32 s61, s3, 2048
    buffer_load_dwordx4 v[164:167], v28, s[8:11], s61 offen
    s_add_u32 s61, s3, 4096
    buffer_load_dwordx4 v[168:171], v28, s[8:11], s61 offen
    s_add_u32 s3, s60, 3145728
    s_add_u32 s61, s3, 0
    buffer_load_dwordx4 v[172:175], v28, s[8:11], s61 offen
    s_add_u32 s61, s3, 2048
    buffer_load_dwordx4 v[176:179], v28, s[8:11], s61 offen
    s_add_u32 s61, s3, 4096
    buffer_load_dwordx4 v[180:183], v28, s[8:11], s61 offen
    s_add_u32 s3, s60, 4718592
    s_add_u32 s61, s3, 0
    buffer_load_dwordx4 v[184:187], v28, s[8:11], s61 offen
    s_add_u32 s61, s3, 2048
    buffer_load_dwordx4 v[188:191], v28, s[8:11], s61 offen
    s_add_u32 s61, s3, 4096
    buffer_load_dwordx4 v[192:195], v28, s[8:11], s61 offen
    s_barrier
    s_barrier
    s_barrier
    s_barrier
    s_barrier
    s_barrier
    s_barrier
    s_barrier
    s_barrier
    s_barrier
    v_lshrrev_b32 v28, 4, v1
    v_and_b32 v29, 7, v28
    v_lshrrev_b32 v28, 3, v28
    v_mul_u32_u24 v28, 2048, v28
    v_lshl_add_u32 v28, v29, 4, v28
    s_and_b32 s3, s18, 12
    s_or_b32 s3, s3, 3
    s_lshl_b32 s3, s3, 7
    v_add_u32 v28, s3, v28
    s_lshr_b32 s3, s2, 3
    s_lshl_b32 s3, s3, 2
    s_and_b32 s60, s16, 3
    s_add_u32 s60, s60, s3
    s_lshl_b32 s61, s60, 14
    buffer_load_dwordx4 v[144:147], v28, s[12:15], s61 offen
    s_bitcmp0_b32 s21, 0
    s_cselect_b32 s56, s28, s24
    s_cselect_b32 s57, s29, s25
    s_mov_b32 s58, 6291456
    s_mov_b32 s59, 0x00020000
    v_lshrrev_b32 v28, 4, v1
    v_and_b32 v29, 7, v28
    v_lshrrev_b32 v28, 3, v28
    v_mul_u32_u24 v28, 6144, v28
    v_lshl_add_u32 v28, v29, 4, v28
    s_and_b32 s3, s18, 12
    s_or_b32 s3, s3, 3
    s_lshl_b32 s3, s3, 7
    v_add_u32 v28, s3, v28
    s_lshr_b32 s3, s2, 3
    s_lshl_b32 s3, s3, 2
    s_and_b32 s60, s16, 3
    s_add_u32 s60, s60, s3
    s_and_b32 s3, s60, 31
    s_mul_i32 s3, s3, 49152
    s_lshr_b32 s61, s60, 5
    s_min_u32 s61, s61, 2
    s_lshl_b32 s61, s61, 11
    s_add_u32 s61, s61, s3
    s_cmp_lt_u32 s18, 4
    s_cselect_b32 s3, 1572864, 0
    s_add_u32 s61, s61, s3
    buffer_load_dwordx4 v[148:151], v28, s[56:59], s61 offen
    s_bitcmp1_b32 s21, 0
    s_cbranch_scc1 z_pe
    s_bitcmp0_b32 s21, 0
    s_cselect_b32 s56, s28, s24
    s_cselect_b32 s57, s29, s25
    s_mov_b32 s58, 6291456
    s_mov_b32 s59, 0x00020000
    s_add_u32 s61, s84, 2048
    buffer_load_dwordx4 v[160:163], v11, s[56:59], s61 offen
    s_add_u32 s61, s84, 4096
    buffer_load_dwordx4 v[164:167], v11, s[56:59], s61 offen
    s_add_u32 s61, s84, 0
    buffer_load_dwordx4 v[168:171], v11, s[56:59], s61 offen
    s_add_u32 s61, s84, 198656
    buffer_load_dwordx4 v[172:175], v11, s[56:59], s61 offen
    s_add_u32 s61, s84, 200704
    buffer_load_dwordx4 v[176:179], v11, s[56:59], s61 offen
    s_add_u32 s61, s84, 196608
    buffer_load_dwordx4 v[180:183], v11, s[56:59], s61 offen
z_pe:
    s_barrier
    s_branch s_tail
s_tail:
    s_bitcmp1_b32 s21, 0
    s_cbranch_scc1 s_B
    s_cmp_lg_u32 s16, 4
    s_cbranch_scc1 s_a1
    s_mov_b32 s45, 2146435072
    s_cmp_eq_u32 s17, 0
    s_cbranch_scc1 s_a0
    s_lshr_b32 s46, s21, 1
    s_lshl_b32 s44, s46, 15
    s_lshl_b32 s67, s17, 11
    s_add_u32 s44, s44, s67
    s_lshl_b32 s67, s18, 7
    s_add_u32 s44, s44, s67
    s_add_u32 s44, s44, 149504
    s_sub_u32 s45, s44, 151552
    s_lshl_b32 s45, s45, 5
    s_add_u32 s45, s45, 54525952
    s_mov_b32 s66, 0x10000
s_h_poll:
    s_mov_b32 s68, 0
    s_atomic_add s68, s[22:23], s44 offset:0 glc
    s_sub_u32 s66, s66, 1
    s_cselect_b32 s67, 1, 0
    s_waitcnt lgkmcnt(0)
    s_max_u32 s68, s68, s67
    s_cmp_lt_u32 s68, 1
    s_cbranch_scc1 s_h_poll
s_h_ok:
s_a0:
    s_mov_b32 m0, 131072
    s_nop 0
    buffer_load_dwordx4 v1, s[4:7], s45 offen offset:0 sc1 lds
    buffer_load_dwordx4 v1, s[4:7], s45 offen offset:1024 sc1 lds
    buffer_load_dwordx4 v1, s[4:7], s45 offen offset:2048 sc1 lds
    buffer_load_dwordx4 v1, s[4:7], s45 offen offset:3072 sc1 lds
    s_waitcnt vmcnt(0)
s_a1:
    s_barrier
    s_waitcnt vmcnt(0)
    s_barrier
    s_sub_u32 s3, s16, 5
    s_cmp_gt_u32 s3, 1
    s_cbranch_scc1 s_a2
    s_add_u32 m0, s41, 65536
    s_xor_b32 s44, s62, 65536
    buffer_load_dwordx4 v16, s[12:15], s44 offen offset:0 lds
    buffer_load_dwordx4 v17, s[12:15], s44 offen offset:1024 lds
    s_add_u32 m0, s41, 69632
    s_xor_b32 s44, s62, 196608
    buffer_load_dwordx4 v16, s[12:15], s44 offen offset:0 lds
    buffer_load_dwordx4 v17, s[12:15], s44 offen offset:1024 lds
    s_add_u32 m0, s41, 73728
    s_xor_b32 s44, s62, 327680
    buffer_load_dwordx4 v16, s[12:15], s44 offen offset:0 lds
    buffer_load_dwordx4 v17, s[12:15], s44 offen offset:1024 lds
    s_add_u32 m0, s41, 77824
    s_xor_b32 s44, s62, 458752
    buffer_load_dwordx4 v16, s[12:15], s44 offen offset:0 lds
    buffer_load_dwordx4 v17, s[12:15], s44 offen offset:1024 lds
    s_add_u32 m0, s41, 81920
    s_xor_b32 s44, s62, 589824
    buffer_load_dwordx4 v16, s[12:15], s44 offen offset:0 lds
    buffer_load_dwordx4 v17, s[12:15], s44 offen offset:1024 lds
    s_add_u32 m0, s41, 86016
    s_xor_b32 s44, s62, 720896
    buffer_load_dwordx4 v16, s[12:15], s44 offen offset:0 lds
    buffer_load_dwordx4 v17, s[12:15], s44 offen offset:1024 lds
    s_add_u32 m0, s41, 90112
    s_xor_b32 s44, s62, 851968
    buffer_load_dwordx4 v16, s[12:15], s44 offen offset:0 lds
    buffer_load_dwordx4 v17, s[12:15], s44 offen offset:1024 lds
    s_add_u32 m0, s41, 94208
    s_xor_b32 s44, s62, 983040
    buffer_load_dwordx4 v16, s[12:15], s44 offen offset:0 lds
    buffer_load_dwordx4 v17, s[12:15], s44 offen offset:1024 lds
    s_add_u32 m0, s41, 98304
    s_xor_b32 s44, s62, 1114112
    buffer_load_dwordx4 v16, s[12:15], s44 offen offset:0 lds
    buffer_load_dwordx4 v17, s[12:15], s44 offen offset:1024 lds
    s_add_u32 m0, s41, 102400
    s_xor_b32 s44, s62, 1245184
    buffer_load_dwordx4 v16, s[12:15], s44 offen offset:0 lds
    buffer_load_dwordx4 v17, s[12:15], s44 offen offset:1024 lds
    s_add_u32 m0, s41, 106496
    s_xor_b32 s44, s62, 1376256
    buffer_load_dwordx4 v16, s[12:15], s44 offen offset:0 lds
    buffer_load_dwordx4 v17, s[12:15], s44 offen offset:1024 lds
    s_add_u32 m0, s41, 110592
    s_xor_b32 s44, s62, 1507328
    buffer_load_dwordx4 v16, s[12:15], s44 offen offset:0 lds
    buffer_load_dwordx4 v17, s[12:15], s44 offen offset:1024 lds
    s_add_u32 m0, s41, 114688
    s_xor_b32 s44, s62, 1638400
    buffer_load_dwordx4 v16, s[12:15], s44 offen offset:0 lds
    buffer_load_dwordx4 v17, s[12:15], s44 offen offset:1024 lds
    s_add_u32 m0, s41, 118784
    s_xor_b32 s44, s62, 1769472
    buffer_load_dwordx4 v16, s[12:15], s44 offen offset:0 lds
    buffer_load_dwordx4 v17, s[12:15], s44 offen offset:1024 lds
    s_add_u32 m0, s41, 122880
    s_xor_b32 s44, s62, 1900544
    buffer_load_dwordx4 v16, s[12:15], s44 offen offset:0 lds
    buffer_load_dwordx4 v17, s[12:15], s44 offen offset:1024 lds
    s_add_u32 m0, s41, 126976
    s_xor_b32 s44, s62, 2031616
    buffer_load_dwordx4 v16, s[12:15], s44 offen offset:0 lds
    buffer_load_dwordx4 v17, s[12:15], s44 offen offset:1024 lds
s_a2:
    s_bitcmp0_b32 s21, 0
    s_cselect_b32 s56, s28, s24
    s_cselect_b32 s57, s29, s25
    s_mov_b32 s58, 6291456
    s_mov_b32 s59, 0x00020000
    s_add_u32 s61, s85, 2048
    buffer_load_dwordx4 v[184:187], v11, s[56:59], s61 offen
    s_add_u32 s61, s85, 4096
    buffer_load_dwordx4 v[188:191], v11, s[56:59], s61 offen
    s_add_u32 s61, s85, 0
    buffer_load_dwordx4 v[192:195], v11, s[56:59], s61 offen
    s_add_u32 s61, s85, 198656
    buffer_load_dwordx4 v[196:199], v11, s[56:59], s61 offen
    s_add_u32 s61, s85, 200704
    buffer_load_dwordx4 v[200:203], v11, s[56:59], s61 offen
    s_add_u32 s61, s85, 196608
    buffer_load_dwordx4 v[204:207], v11, s[56:59], s61 offen
    s_add_u32 s61, s86, 2048
    buffer_load_dwordx4 v[208:211], v11, s[56:59], s61 offen
    s_add_u32 s61, s86, 4096
    buffer_load_dwordx4 v[212:215], v11, s[56:59], s61 offen
    s_add_u32 s61, s86, 0
    buffer_load_dwordx4 v[216:219], v11, s[56:59], s61 offen
    s_add_u32 s61, s86, 198656
    buffer_load_dwordx4 v[220:223], v11, s[56:59], s61 offen
    s_waitcnt vmcnt(0)
    s_lshl_b32 s3, s21, 3
    s_add_u32 s3, s3, s16
    s_cmp_lg_u32 s3, 7
    s_cbranch_scc1 s_g3
    v_lshrrev_b32 v24, 4, v1
    v_and_b32 v25, 1, v24
    v_lshlrev_b32 v25, 4, v25
    v_mov_b32 v26, 0x3f80
    v_lshlrev_b32 v25, v25, v26
    v_bfe_u32 v26, v24, 1, 2
    v_cmp_eq_u32 vcc, 0, v26
    s_nop 1
    v_cndmask_b32 v140, 0, v25, vcc
    v_cmp_eq_u32 vcc, 1, v26
    s_nop 1
    v_cndmask_b32 v141, 0, v25, vcc
    v_cmp_eq_u32 vcc, 2, v26
    s_nop 1
    v_cndmask_b32 v142, 0, v25, vcc
    v_cmp_eq_u32 vcc, 3, v26
    s_nop 1
    v_cndmask_b32 v143, 0, v25, vcc
    v_bfe_u32 v25, v24, 3, 1
    v_lshrrev_b32 v26, 5, v24
    v_lshl_add_u32 v26, v26, 1, v25
    v_lshlrev_b32 v25, 8, v26
    v_and_b32 v27, 7, v24
    v_lshl_add_u32 v25, v27, 5, v25
    v_bfe_u32 v27, v24, 4, 1
    v_lshl_add_u32 v25, v27, 4, v25
    v_add_u32 v27, s18, v26
    v_and_b32 v27, 15, v27
    v_lshl_add_u32 v25, v27, 14, v25
    s_lshl_b32 s44, s17, 10
    s_add_u32 s44, s44, 52690944
    v_mfma_f32_16x16x32_bf16 v[128:131], v[140:143], v[32:35], 0
    v_mfma_f32_16x16x32_bf16 v[132:135], v[140:143], v[64:67], 0
    v_mfma_f32_16x16x32_bf16 v[136:139], v[140:143], v[96:99], 0
    v_mfma_f32_16x16x32_bf16 v[128:131], v[140:143], v[36:39], v[128:131]
    v_mfma_f32_16x16x32_bf16 v[132:135], v[140:143], v[68:71], v[132:135]
    v_mfma_f32_16x16x32_bf16 v[136:139], v[140:143], v[100:103], v[136:139]
    v_mfma_f32_16x16x32_bf16 v[128:131], v[140:143], v[40:43], v[128:131]
    v_mfma_f32_16x16x32_bf16 v[132:135], v[140:143], v[72:75], v[132:135]
    v_mfma_f32_16x16x32_bf16 v[136:139], v[140:143], v[104:107], v[136:139]
    v_mfma_f32_16x16x32_bf16 v[128:131], v[140:143], v[44:47], v[128:131]
    v_mfma_f32_16x16x32_bf16 v[132:135], v[140:143], v[76:79], v[132:135]
    v_mfma_f32_16x16x32_bf16 v[136:139], v[140:143], v[108:111], v[136:139]
    v_mfma_f32_16x16x32_bf16 v[128:131], v[140:143], v[48:51], v[128:131]
    v_mfma_f32_16x16x32_bf16 v[132:135], v[140:143], v[80:83], v[132:135]
    v_mfma_f32_16x16x32_bf16 v[136:139], v[140:143], v[112:115], v[136:139]
    v_mfma_f32_16x16x32_bf16 v[128:131], v[140:143], v[52:55], v[128:131]
    v_mfma_f32_16x16x32_bf16 v[132:135], v[140:143], v[84:87], v[132:135]
    v_mfma_f32_16x16x32_bf16 v[136:139], v[140:143], v[116:119], v[136:139]
    v_mfma_f32_16x16x32_bf16 v[128:131], v[140:143], v[56:59], v[128:131]
    v_mfma_f32_16x16x32_bf16 v[132:135], v[140:143], v[88:91], v[132:135]
    v_mfma_f32_16x16x32_bf16 v[136:139], v[140:143], v[120:123], v[136:139]
    v_mfma_f32_16x16x32_bf16 v[128:131], v[140:143], v[60:63], v[128:131]
    v_mfma_f32_16x16x32_bf16 v[132:135], v[140:143], v[92:95], v[132:135]
    v_mfma_f32_16x16x32_bf16 v[136:139], v[140:143], v[124:127], v[136:139]
    s_nop 5
    v_add_f32_dpp v128, v128, v128 row_ror:8 row_mask:0xf bank_mask:0xf
    v_add_f32_dpp v129, v129, v129 row_ror:8 row_mask:0xf bank_mask:0xf
    v_add_f32_dpp v130, v130, v130 row_ror:8 row_mask:0xf bank_mask:0xf
    v_add_f32_dpp v131, v131, v131 row_ror:8 row_mask:0xf bank_mask:0xf
    v_add_f32_dpp v132, v132, v132 row_ror:8 row_mask:0xf bank_mask:0xf
    v_add_f32_dpp v133, v133, v133 row_ror:8 row_mask:0xf bank_mask:0xf
    v_add_f32_dpp v134, v134, v134 row_ror:8 row_mask:0xf bank_mask:0xf
    v_add_f32_dpp v135, v135, v135 row_ror:8 row_mask:0xf bank_mask:0xf
    v_add_f32_dpp v136, v136, v136 row_ror:8 row_mask:0xf bank_mask:0xf
    v_add_f32_dpp v137, v137, v137 row_ror:8 row_mask:0xf bank_mask:0xf
    v_add_f32_dpp v138, v138, v138 row_ror:8 row_mask:0xf bank_mask:0xf
    v_add_f32_dpp v139, v139, v139 row_ror:8 row_mask:0xf bank_mask:0xf
    v_cmp_le_u32 vcc, 1, v26
    s_nop 1
    v_cndmask_b32 v128, v128, v132, vcc
    v_cndmask_b32 v129, v129, v133, vcc
    v_cndmask_b32 v130, v130, v134, vcc
    v_cndmask_b32 v131, v131, v135, vcc
    v_cmp_le_u32 vcc, 2, v26
    s_nop 1
    v_cndmask_b32 v128, v128, v136, vcc
    v_cndmask_b32 v129, v129, v137, vcc
    v_cndmask_b32 v130, v130, v138, vcc
    v_cndmask_b32 v131, v131, v139, vcc
    buffer_store_dwordx4 v[128:131], v25, s[4:7], s44 offen sc1
    s_waitcnt vmcnt(0)
    s_add_u32 s44, s18, 0
    s_and_b32 s44, s44, 15
    s_lshl_b32 s44, s44, 7
    s_add_u32 s44, s44, 2048
    s_atomic_add s40, s[22:23], s44
    s_add_u32 s45, s18, 1
    s_and_b32 s45, s45, 15
    s_lshl_b32 s45, s45, 7
    s_add_u32 s45, s45, 2048
    s_atomic_add s40, s[22:23], s45
    s_add_u32 s46, s18, 2
    s_and_b32 s46, s46, 15
    s_lshl_b32 s46, s46, 7
    s_add_u32 s46, s46, 2048
    s_atomic_add s40, s[22:23], s46
    s_branch s_g3
s_B:
    s_lshr_b32 s49, s21, 1
    s_lshl_b32 s53, s49, 23
    s_lshl_b32 s50, s18, 18
    s_add_u32 s53, s53, s50
    s_add_u32 s53, s53, 33554432
    s_lshl_b32 s54, s38, 11
    s_add_u32 s55, s53, s54
    s_add_u32 s56, s55, 4194304
    s_lshl_b32 s59, s49, 13
    s_lshl_b32 s67, s18, 9
    s_add_u32 s59, s59, s67
    s_lshl_b32 s67, s16, 7
    s_add_u32 s59, s59, s67
    s_add_u32 s59, s59, 69120
    v_add_u32 v4, 131072, v1
    s_mov_b32 s68, 0
    s_mov_b32 s39, 0
    s_barrier
    buffer_load_dwordx4 v[64:67], v1, s[4:7], s55 offen offset:0 sc1
    buffer_load_dwordx4 v[68:71], v1, s[4:7], s55 offen offset:1024 sc1
    buffer_load_dwordx4 v[72:75], v1, s[4:7], s56 offen offset:0 sc1
    buffer_load_dwordx4 v[76:79], v1, s[4:7], s56 offen offset:1024 sc1
    s_atomic_add s68, s[22:23], s59 glc
    s_setprio 3
    s_branch b_att
s_att_done:
    s_waitcnt lgkmcnt(0)
    v_lshrrev_b32 v24, 4, v1
    v_lshrrev_b32 v25, 3, v24
    v_mul_u32_u24 v12, 6144, v25
    v_and_b32 v26, 2, v25
    v_lshrrev_b32 v25, 2, v25
    v_or_b32 v26, v26, v25
    v_bfe_u32 v25, v24, 1, 2
    v_xor_b32 v26, v26, v25
    v_lshl_add_u32 v12, v26, 5, v12
    v_and_b32 v26, 1, v24
    v_lshl_add_u32 v12, v26, 4, v12
    s_lshl_b32 s3, s18, 7
    v_add_u32 v12, s3, v12
    v_add_u32 v13, 48128, v12
    v_add_u32 v14, s42, v12
    v_add_u32 v15, s42, v13
    v_lshrrev_b32 v24, 4, v1
    v_lshrrev_b32 v25, 3, v24
    v_mul_u32_u24 v16, 2048, v25
    v_and_b32 v26, 2, v25
    v_lshrrev_b32 v25, 2, v25
    v_or_b32 v26, v26, v25
    v_bfe_u32 v25, v24, 1, 2
    v_xor_b32 v26, v26, v25
    v_lshl_add_u32 v16, v26, 5, v16
    v_and_b32 v26, 1, v24
    v_lshl_add_u32 v16, v26, 4, v16
    s_lshl_b32 s3, s18, 7
    v_add_u32 v16, s3, v16
    v_add_u32 v17, 15360, v16
    v_add_u32 v18, 30720, v16
    v_add_u32 v19, 46080, v16
    s_and_b32 s3, s16, 3
    s_mul_i32 s3, s3, 49152
    v_add_u32 v11, s3, v12
    s_and_b32 s3, s16, 3
    s_lshl_b32 s3, s3, 10
    v_add_u32 v9, s3, v1
    v_add_u32 v10, 0x10000, v9
    s_cmp_eq_u32 s21, 3
    s_cbranch_scc1 s_nopf
    s_lshl_b32 s3, s2, 2
    s_and_b32 s60, s16, 3
    s_add_u32 s60, s60, s3
    s_lshl_b32 s60, s60, 11
    buffer_load_dwordx4 v[96:99], v1, s[12:15], s60 offen offset:0
    buffer_load_dwordx4 v[100:103], v1, s[12:15], s60 offen offset:1024
    s_bitcmp0_b32 s21, 0
    s_cselect_b32 s56, s28, s24
    s_cselect_b32 s57, s29, s25
    s_mov_b32 s58, 6291456
    s_mov_b32 s59, 0x00020000
    s_add_u32 s61, s84, 2048
    buffer_load_dwordx4 v[160:163], v11, s[56:59], s61 offen
    s_add_u32 s61, s84, 4096
    buffer_load_dwordx4 v[164:167], v11, s[56:59], s61 offen
    s_add_u32 s61, s84, 0
    buffer_load_dwordx4 v[168:171], v11, s[56:59], s61 offen
    s_add_u32 s61, s84, 198656
    buffer_load_dwordx4 v[172:175], v11, s[56:59], s61 offen
    s_waitcnt vmcnt(4)
s_nopf:
    s_setprio 3
    s_mov_b32 s52, 0
    s_lshl_b32 s44, s16, 14
    v_add_u32 v24, s44, v1
    s_and_b32 s3, s16, 3
    s_lshl_b32 s44, s3, 10
    s_add_u32 s44, s44, 147456
    v_lshrrev_b32 v25, 2, v1
    v_add_u32 v25, s44, v25
    s_lshl_b32 s53, s21, 22
    s_lshl_b32 s44, s38, 16
    s_add_u32 s53, s53, s44
    s_lshl_b32 s44, s18, 12
    s_add_u32 s53, s53, s44
    s_add_u32 s53, s53, 16777216
    s_lshl_b32 s54, s21, 14
    s_lshl_b32 s67, s38, 8
    s_add_u32 s54, s54, s67
    s_add_u32 s54, s54, 86016
s_bhead:
    s_barrier
    ds_read_b32 v28, v25 offset:0
    ds_read_b32 v29, v25 offset:256
    ds_read_b32 v30, v25 offset:512
    ds_read_b32 v31, v25 offset:768
    ds_read_b128 v[32:35], v24 offset:0
    ds_read_b128 v[36:39], v24 offset:1024
    ds_read_b128 v[40:43], v24 offset:2048
    ds_read_b128 v[44:47], v24 offset:3072
    ds_read_b128 v[48:51], v24 offset:4096
    ds_read_b128 v[52:55], v24 offset:5120
    ds_read_b128 v[56:59], v24 offset:6144
    ds_read_b128 v[60:63], v24 offset:7168
    ds_read_b128 v[64:67], v24 offset:8192
    ds_read_b128 v[68:71], v24 offset:9216
    ds_read_b128 v[72:75], v24 offset:10240
    ds_read_b128 v[76:79], v24 offset:11264
    ds_read_b128 v[80:83], v24 offset:12288
    ds_read_b128 v[84:87], v24 offset:13312
    ds_read_b128 v[88:91], v24 offset:14336
    ds_read_b128 v[92:95], v24 offset:15360
    s_waitcnt lgkmcnt(14)
    v_add_f32 v28, v28, v29
    v_add_f32 v30, v30, v31
    v_add_f32 v28, v28, v30
    v_mov_b32 v29, 0x5d800000
    v_mov_b32 v30, 0x21800000
    v_cmp_nlt_f32 s[44:45], v28, v29
    v_cmp_ngt_f32 vcc, v28, v30
    v_rcp_f32 v28, v28
    s_or_b64 vcc, vcc, s[44:45]
    s_waitcnt lgkmcnt(8)
    v_pk_add_f32 v[32:33], v[32:33], v[48:49]
    v_pk_add_f32 v[34:35], v[34:35], v[50:51]
    v_pk_add_f32 v[36:37], v[36:37], v[52:53]
    v_pk_add_f32 v[38:39], v[38:39], v[54:55]
    v_pk_add_f32 v[40:41], v[40:41], v[56:57]
    v_pk_add_f32 v[42:43], v[42:43], v[58:59]
    v_pk_add_f32 v[44:45], v[44:45], v[60:61]
    v_pk_add_f32 v[46:47], v[46:47], v[62:63]
    s_waitcnt lgkmcnt(4)
    v_pk_add_f32 v[32:33], v[32:33], v[64:65]
    v_pk_add_f32 v[34:35], v[34:35], v[66:67]
    v_pk_add_f32 v[36:37], v[36:37], v[68:69]
    v_pk_add_f32 v[38:39], v[38:39], v[70:71]
    v_pk_add_f32 v[40:41], v[40:41], v[72:73]
    v_pk_add_f32 v[42:43], v[42:43], v[74:75]
    v_pk_add_f32 v[44:45], v[44:45], v[76:77]
    v_pk_add_f32 v[46:47], v[46:47], v[78:79]
    s_waitcnt lgkmcnt(0)
    v_pk_add_f32 v[32:33], v[32:33], v[80:81]
    v_pk_add_f32 v[34:35], v[34:35], v[82:83]
    v_pk_add_f32 v[36:37], v[36:37], v[84:85]
    v_pk_add_f32 v[38:39], v[38:39], v[86:87]
    v_pk_add_f32 v[40:41], v[40:41], v[88:89]
    v_pk_add_f32 v[42:43], v[42:43], v[90:91]
    v_pk_add_f32 v[44:45], v[44:45], v[92:93]
    v_pk_add_f32 v[46:47], v[46:47], v[94:95]
    s_cbranch_vccnz s_slow
s_fin:
    v_pk_mul_f32 v[32:33], v[28:29], v[32:33] op_sel_hi:[0,1]
    v_pk_mul_f32 v[34:35], v[28:29], v[34:35] op_sel_hi:[0,1]
    v_pk_mul_f32 v[36:37], v[28:29], v[36:37] op_sel_hi:[0,1]
    v_pk_mul_f32 v[38:39], v[28:29], v[38:39] op_sel_hi:[0,1]
    v_pk_mul_f32 v[40:41], v[28:29], v[40:41] op_sel_hi:[0,1]
    v_pk_mul_f32 v[42:43], v[28:29], v[42:43] op_sel_hi:[0,1]
    v_pk_mul_f32 v[44:45], v[28:29], v[44:45] op_sel_hi:[0,1]
    v_pk_mul_f32 v[46:47], v[28:29], v[46:47] op_sel_hi:[0,1]
    v_cvt_pk_bf16_f32 v32, v32, v33
    v_cvt_pk_bf16_f32 v33, v34, v35
    v_cvt_pk_bf16_f32 v34, v36, v37
    v_cvt_pk_bf16_f32 v35, v38, v39
    v_cvt_pk_bf16_f32 v36, v40, v41
    v_cvt_pk_bf16_f32 v37, v42, v43
    v_cvt_pk_bf16_f32 v38, v44, v45
    v_cvt_pk_bf16_f32 v39, v46, v47
    buffer_store_dwordx4 v[32:35], v1, s[4:7], s53 offen offset:0 sc1
    buffer_store_dwordx4 v[36:39], v1, s[4:7], s53 offen offset:1024 sc1
    s_cmp_lg_u32 s52, 0
    s_cbranch_scc1 s_b2
    s_waitcnt vmcnt(0)
    s_atomic_add s40, s[22:23], s54
    s_mov_b32 s52, 1
    s_add_u32 s53, s53, 2048
    s_waitcnt lgkmcnt(0)
    s_add_u32 s54, s54, 128
    s_setprio 0
    s_cmp_eq_u32 s21, 3
    s_cbranch_scc1 s_nopf2
    s_bitcmp0_b32 s21, 0
    s_cselect_b32 s56, s28, s24
    s_cselect_b32 s57, s29, s25
    s_mov_b32 s58, 6291456
    s_mov_b32 s59, 0x00020000
    s_add_u32 s61, s84, 200704
    buffer_load_dwordx4 v[176:179], v11, s[56:59], s61 offen
    s_add_u32 s61, s84, 196608
    buffer_load_dwordx4 v[180:183], v11, s[56:59], s61 offen
    s_add_u32 s61, s85, 2048
    buffer_load_dwordx4 v[184:187], v11, s[56:59], s61 offen
    s_add_u32 s61, s85, 4096
    buffer_load_dwordx4 v[188:191], v11, s[56:59], s61 offen
    s_waitcnt vmcnt(4)
s_nopf2:
    s_barrier
    s_cmp_eq_u32 s21, 3
    s_cbranch_scc1 s_nopf3
    s_bitcmp0_b32 s21, 0
    s_cselect_b32 s56, s28, s24
    s_cselect_b32 s57, s29, s25
    s_mov_b32 s58, 6291456
    s_mov_b32 s59, 0x00020000
    s_add_u32 s61, s85, 0
    buffer_load_dwordx4 v[192:195], v11, s[56:59], s61 offen
    s_add_u32 s61, s85, 198656
    buffer_load_dwordx4 v[196:199], v11, s[56:59], s61 offen
    s_add_u32 s61, s85, 200704
    buffer_load_dwordx4 v[200:203], v11, s[56:59], s61 offen
    s_add_u32 s61, s85, 196608
    buffer_load_dwordx4 v[204:207], v11, s[56:59], s61 offen
    s_waitcnt vmcnt(4)
    s_add_u32 s61, s86, 2048
    buffer_load_dwordx4 v[208:211], v11, s[56:59], s61 offen
    s_add_u32 s61, s86, 4096
    buffer_load_dwordx4 v[212:215], v11, s[56:59], s61 offen
    s_add_u32 s61, s86, 0
    buffer_load_dwordx4 v[216:219], v11, s[56:59], s61 offen
    s_add_u32 s61, s86, 198656
    buffer_load_dwordx4 v[220:223], v11, s[56:59], s61 offen
    s_waitcnt vmcnt(4)
s_nopf3:
    s_and_b32 s3, s16, 3
    s_lshl_b32 s46, s3, 19
    s_lshl_b32 s45, s3, 14
    s_and_b32 s3, s18, 0
    s_lshl_b32 s3, s3, 17
    s_xor_b32 s46, s46, s3
    s_add_u32 m0, s45, 0
    s_xor_b32 s44, s46, 0
    buffer_load_dwordx4 v16, s[12:15], s44 offen offset:0 lds
    buffer_load_dwordx4 v17, s[12:15], s44 offen offset:1024 lds
    buffer_load_dwordx4 v18, s[12:15], s44 offen offset:2048 lds
    buffer_load_dwordx4 v19, s[12:15], s44 offen offset:3072 lds
    s_add_u32 s44, s44, 65536
    s_waitcnt vmcnt(3)
    buffer_load_dwordx4 v[96:99], v16, s[12:15], s44 offen offset:0
    buffer_load_dwordx4 v[100:103], v17, s[12:15], s44 offen offset:1024
    buffer_load_dwordx4 v[104:107], v18, s[12:15], s44 offen offset:2048
    buffer_load_dwordx4 v[108:111], v19, s[12:15], s44 offen offset:3072
    s_waitcnt vmcnt(3)
    s_add_u32 m0, s45, 4096
    s_xor_b32 s44, s46, 131072
    buffer_load_dwordx4 v16, s[12:15], s44 offen offset:0 lds
    buffer_load_dwordx4 v17, s[12:15], s44 offen offset:1024 lds
    buffer_load_dwordx4 v18, s[12:15], s44 offen offset:2048 lds
    buffer_load_dwordx4 v19, s[12:15], s44 offen offset:3072 lds
    s_add_u32 s44, s44, 65536
    s_waitcnt vmcnt(3)
    buffer_load_dwordx4 v[112:115], v16, s[12:15], s44 offen offset:0
    buffer_load_dwordx4 v[116:119], v17, s[12:15], s44 offen offset:1024
    buffer_load_dwordx4 v[120:123], v18, s[12:15], s44 offen offset:2048
    buffer_load_dwordx4 v[124:127], v19, s[12:15], s44 offen offset:3072
    s_waitcnt vmcnt(3)
    s_add_u32 m0, s45, 8192
    s_xor_b32 s44, s46, 262144
    buffer_load_dwordx4 v16, s[12:15], s44 offen offset:0 lds
    buffer_load_dwordx4 v17, s[12:15], s44 offen offset:1024 lds
    buffer_load_dwordx4 v18, s[12:15], s44 offen offset:2048 lds
    buffer_load_dwordx4 v19, s[12:15], s44 offen offset:3072 lds
    s_add_u32 s44, s44, 65536
    s_waitcnt vmcnt(3)
    buffer_load_dwordx4 v[128:131], v16, s[12:15], s44 offen offset:0
    buffer_load_dwordx4 v[132:135], v17, s[12:15], s44 offen offset:1024
    buffer_load_dwordx4 v[136:139], v18, s[12:15], s44 offen offset:2048
    buffer_load_dwordx4 v[140:143], v19, s[12:15], s44 offen offset:3072
    s_waitcnt vmcnt(3)
    s_add_u32 m0, s45, 12288
    s_xor_b32 s44, s46, 393216
    buffer_load_dwordx4 v16, s[12:15], s44 offen offset:0 lds
    buffer_load_dwordx4 v17, s[12:15], s44 offen offset:1024 lds
    buffer_load_dwordx4 v18, s[12:15], s44 offen offset:2048 lds
    buffer_load_dwordx4 v19, s[12:15], s44 offen offset:3072 lds
    s_add_u32 s44, s44, 65536
    s_waitcnt vmcnt(3)
    buffer_load_dwordx4 v[144:147], v16, s[12:15], s44 offen offset:0
    buffer_load_dwordx4 v[148:151], v17, s[12:15], s44 offen offset:1024
    buffer_load_dwordx4 v[152:155], v18, s[12:15], s44 offen offset:2048
    buffer_load_dwordx4 v[156:159], v19, s[12:15], s44 offen offset:3072
    s_waitcnt vmcnt(3)
    s_setprio 3
    s_sub_u32 s44, s54, 128
    s_mov_b32 s66, 0x10000
s_o0_poll:
    s_mov_b32 s68, 0
    s_atomic_add s68, s[22:23], s44 offset:0 glc
    s_sub_u32 s66, s66, 1
    s_cselect_b32 s67, 16, 0
    s_waitcnt lgkmcnt(0)
    s_max_u32 s68, s68, s67
    s_cmp_lt_u32 s68, 16
    s_cbranch_scc1 s_o0_poll
s_o0_ok:
    s_waitcnt vmcnt(0)
    s_branch s_bhead
s_b2:
    ds_write_b128 v24, v[96:99] offset:0
    ds_write_b128 v24, v[100:103] offset:1024
    ds_write_b128 v24, v[104:107] offset:2048
    ds_write_b128 v24, v[108:111] offset:3072
    ds_write_b128 v24, v[112:115] offset:4096
    ds_write_b128 v24, v[116:119] offset:5120
    ds_write_b128 v24, v[120:123] offset:6144
    ds_write_b128 v24, v[124:127] offset:7168
    ds_write_b128 v24, v[128:131] offset:8192
    ds_write_b128 v24, v[132:135] offset:9216
    ds_write_b128 v24, v[136:139] offset:10240
    ds_write_b128 v24, v[140:143] offset:11264
    ds_write_b128 v24, v[144:147] offset:12288
    ds_write_b128 v24, v[148:151] offset:13312
    ds_write_b128 v24, v[152:155] offset:14336
    ds_write_b128 v24, v[156:159] offset:15360
    s_mov_b32 s68, 1
    s_waitcnt vmcnt(0)
    s_atomic_add s68, s[22:23], s54 glc
    s_mov_b32 s66, 0x10000
    s_waitcnt lgkmcnt(0)
    s_cmp_eq_u32 s68, 15
    s_cbranch_scc1 s_o1_ok
s_o1_poll:
    s_mov_b32 s68, 0
    s_atomic_add s68, s[22:23], s54 offset:0 glc
    s_sub_u32 s66, s66, 1
    s_cselect_b32 s67, 16, 0
    s_waitcnt lgkmcnt(0)
    s_max_u32 s68, s68, s67
    s_cmp_lt_u32 s68, 16
    s_cbranch_scc1 s_o1_poll
s_o1_ok:
s_b3:
    s_setprio 0
    s_waitcnt lgkmcnt(0)
s_g3:
    s_barrier
    s_cmp_eq_u32 s21, 3
    s_cbranch_scc1 s_end
    s_barrier
    ds_write_b128 v9, v[160:163] offset:0
    ds_write_b128 v9, v[164:167] offset:4096
    ds_write_b128 v9, v[168:171] offset:8192
    ds_write_b128 v9, v[172:175] offset:12288
    ds_write_b128 v9, v[176:179] offset:16384
    ds_write_b128 v9, v[180:183] offset:20480
    ds_write_b128 v9, v[184:187] offset:24576
    ds_write_b128 v9, v[188:191] offset:28672
    s_add_u32 s21, s21, 1
    s_bitcmp1_b32 s21, 0
    s_cselect_b32 s8, s28, s24
    s_cselect_b32 s9, s29, s25
    s_cselect_b32 s12, s30, s26
    s_cselect_b32 s13, s31, s27
    s_mov_b32 s10, 6291456
    s_mov_b32 s11, 0x00020000
    s_mov_b32 s14, 2097152
    s_mov_b32 s15, 0x00020000
    s_sub_u32 s3, s16, 5
    s_cmp_gt_u32 s3, 1
    s_cbranch_scc1 s_n67
    s_add_u32 m0, s41, 65536
    s_add_u32 s44, s86, 200704
    buffer_load_dwordx4 v14, s[8:11], s44 offen offset:0 lds
    buffer_load_dwordx4 v15, s[8:11], s44 offen offset:1024 lds
    s_add_u32 m0, s41, 69632
    s_add_u32 s44, s86, 196608
    buffer_load_dwordx4 v14, s[8:11], s44 offen offset:0 lds
    buffer_load_dwordx4 v15, s[8:11], s44 offen offset:1024 lds
    s_add_u32 m0, s41, 73728
    s_add_u32 s44, s87, 2048
    buffer_load_dwordx4 v14, s[8:11], s44 offen offset:0 lds
    buffer_load_dwordx4 v15, s[8:11], s44 offen offset:1024 lds
    s_add_u32 m0, s41, 77824
    s_add_u32 s44, s87, 4096
    buffer_load_dwordx4 v14, s[8:11], s44 offen offset:0 lds
    buffer_load_dwordx4 v15, s[8:11], s44 offen offset:1024 lds
    s_add_u32 m0, s41, 81920
    s_add_u32 s44, s87, 0
    buffer_load_dwordx4 v14, s[8:11], s44 offen offset:0 lds
    buffer_load_dwordx4 v15, s[8:11], s44 offen offset:1024 lds
    s_add_u32 m0, s41, 86016
    s_add_u32 s44, s87, 198656
    buffer_load_dwordx4 v14, s[8:11], s44 offen offset:0 lds
    buffer_load_dwordx4 v15, s[8:11], s44 offen offset:1024 lds
    s_add_u32 m0, s41, 90112
    s_add_u32 s44, s87, 200704
    buffer_load_dwordx4 v14, s[8:11], s44 offen offset:0 lds
    buffer_load_dwordx4 v15, s[8:11], s44 offen offset:1024 lds
    s_add_u32 m0, s41, 94208
    s_add_u32 s44, s87, 196608
    buffer_load_dwordx4 v14, s[8:11], s44 offen offset:0 lds
    buffer_load_dwordx4 v15, s[8:11], s44 offen offset:1024 lds
    s_add_u32 m0, s41, 98304
    s_add_u32 s44, s88, 2048
    buffer_load_dwordx4 v14, s[8:11], s44 offen offset:0 lds
    buffer_load_dwordx4 v15, s[8:11], s44 offen offset:1024 lds
    s_add_u32 m0, s41, 102400
    s_add_u32 s44, s88, 4096
    buffer_load_dwordx4 v14, s[8:11], s44 offen offset:0 lds
    buffer_load_dwordx4 v15, s[8:11], s44 offen offset:1024 lds
    s_add_u32 m0, s41, 106496
    s_add_u32 s44, s88, 0
    buffer_load_dwordx4 v14, s[8:11], s44 offen offset:0 lds
    buffer_load_dwordx4 v15, s[8:11], s44 offen offset:1024 lds
    s_add_u32 m0, s41, 110592
    s_add_u32 s44, s88, 198656
    buffer_load_dwordx4 v14, s[8:11], s44 offen offset:0 lds
    buffer_load_dwordx4 v15, s[8:11], s44 offen offset:1024 lds
    s_add_u32 m0, s41, 114688
    s_add_u32 s44, s88, 200704
    buffer_load_dwordx4 v14, s[8:11], s44 offen offset:0 lds
    buffer_load_dwordx4 v15, s[8:11], s44 offen offset:1024 lds
    s_add_u32 m0, s41, 118784
    s_add_u32 s44, s88, 196608
    buffer_load_dwordx4 v14, s[8:11], s44 offen offset:0 lds
    buffer_load_dwordx4 v15, s[8:11], s44 offen offset:1024 lds
    s_add_u32 m0, s41, 122880
    s_add_u32 s44, s89, 2048
    buffer_load_dwordx4 v14, s[8:11], s44 offen offset:0 lds
    buffer_load_dwordx4 v15, s[8:11], s44 offen offset:1024 lds
    s_add_u32 m0, s41, 126976
    s_add_u32 s44, s89, 4096
    buffer_load_dwordx4 v14, s[8:11], s44 offen offset:0 lds
    buffer_load_dwordx4 v15, s[8:11], s44 offen offset:1024 lds
s_n67:
    s_waitcnt lgkmcnt(0)
    s_barrier
    ds_write_b128 v9, v[192:195] offset:32768
    ds_write_b128 v9, v[196:199] offset:36864
    ds_write_b128 v9, v[200:203] offset:40960
    ds_write_b128 v9, v[204:207] offset:45056
    ds_write_b128 v9, v[208:211] offset:49152
    ds_write_b128 v9, v[212:215] offset:53248
    ds_write_b128 v9, v[216:219] offset:57344
    ds_write_b128 v9, v[220:223] offset:61440
    s_cmp_eq_u32 s16, 4
    s_cbranch_scc1 h_layer
    s_cmp_eq_u32 s16, 7
    s_cbranch_scc1 z_layer
    s_branch l_layer
s_end:
    s_lshl_b32 s3, s2, 3
    s_add_u32 s3, s3, s16
    s_cmp_lg_u32 s3, 7
    s_cbranch_scc1 k_exit
    s_mov_b32 s8, s34
    s_mov_b32 s9, s35
    s_mov_b32 s10, 256
    s_mov_b32 s11, 0x00020000
    v_lshrrev_b32 v24, 2, v1
    v_mov_b32 v25, 0
    buffer_store_dword v25, v24, s[8:11], 0 offen sc1
    s_branch k_exit
s_slow:
    s_and_b32 s3, s16, 3
    s_lshl_b32 s44, s3, 11
    s_lshl_b32 s45, s52, 13
    s_add_u32 s44, s44, s45
    s_add_u32 s44, s44, 131072
    v_add_u32 v26, s44, v1
    ds_read_b128 v[48:51], v26 offset:0
    ds_read_b128 v[52:55], v26 offset:1024
    s_lshr_b32 s55, s21, 1
    s_lshl_b32 s55, s55, 23
    s_lshl_b32 s44, s18, 18
    s_add_u32 s55, s55, s44
    s_lshl_b32 s44, s52, 17
    s_add_u32 s55, s55, s44
    s_add_u32 s55, s55, 33554432
    s_waitcnt lgkmcnt(0)
    v_mov_b32 v26, 0xff800000
    s_mov_b32 s61, 0
s_slow1:
    s_add_u32 s44, s55, s61
    buffer_load_dwordx4 v[56:59], v1, s[4:7], s44 offen offset:0 sc1
    buffer_load_dwordx4 v[60:63], v1, s[4:7], s44 offen offset:1024 sc1
    s_waitcnt vmcnt(0)
    v_mfma_f32_32x32x16_bf16 v[72:87], v[56:59], v[48:51], 0
    v_mfma_f32_32x32x16_bf16 v[72:87], v[60:63], v[52:55], v[72:87]
    s_nop 11
    v_max3_f32 v26, v26, v72, v73
    v_max3_f32 v26, v26, v74, v75
    v_max3_f32 v26, v26, v76, v77
    v_max3_f32 v26, v26, v78, v79
    v_max3_f32 v26, v26, v80, v81
    v_max3_f32 v26, v26, v82, v83
    v_max3_f32 v26, v26, v84, v85
    v_max3_f32 v26, v26, v86, v87
    s_add_u32 s61, s61, 2048
    s_cmp_lt_u32 s61, 131072
    s_cbranch_scc1 s_slow1
    v_mov_b32 v27, v26
    s_nop 1
    v_permlane32_swap_b32 v26, v27
    v_max_f32 v26, v26, v27
    v_mov_b32 v32, 0
    v_mov_b32 v33, 0
    v_mov_b32 v34, 0
    v_mov_b32 v35, 0
    v_mov_b32 v36, 0
    v_mov_b32 v37, 0
    v_mov_b32 v38, 0
    v_mov_b32 v39, 0
    v_mov_b32 v40, 0
    v_mov_b32 v41, 0
    v_mov_b32 v42, 0
    v_mov_b32 v43, 0
    v_mov_b32 v44, 0
    v_mov_b32 v45, 0
    v_mov_b32 v46, 0
    v_mov_b32 v47, 0
    v_mov_b32 v28, 0
    v_mov_b32 v29, 0xdddddddd
    s_mov_b32 s3, 0xffff0000
    s_mov_b32 s61, 0
s_slow2:
    s_add_u32 s44, s55, s61
    buffer_load_dwordx4 v[56:59], v1, s[4:7], s44 offen offset:0 sc1
    buffer_load_dwordx4 v[60:63], v1, s[4:7], s44 offen offset:1024 sc1
    s_add_u32 s44, s44, 4194304
    buffer_load_dwordx4 v[64:67], v1, s[4:7], s44 offen offset:0 sc1
    buffer_load_dwordx4 v[68:71], v1, s[4:7], s44 offen offset:1024 sc1
    s_waitcnt vmcnt(0)
    v_mfma_f32_32x32x16_bf16 v[72:87], v[56:59], v[48:51], 0
    v_mfma_f32_32x32x16_bf16 v[72:87], v[60:63], v[52:55], v[72:87]
    s_nop 11
    v_sub_f32 v72, v72, v26
    v_sub_f32 v73, v73, v26
    v_sub_f32 v74, v74, v26
    v_sub_f32 v75, v75, v26
    v_sub_f32 v76, v76, v26
    v_sub_f32 v77, v77, v26
    v_sub_f32 v78, v78, v26
    v_sub_f32 v79, v79, v26
    v_sub_f32 v80, v80, v26
    v_sub_f32 v81, v81, v26
    v_sub_f32 v82, v82, v26
    v_sub_f32 v83, v83, v26
    v_sub_f32 v84, v84, v26
    v_sub_f32 v85, v85, v26
    v_sub_f32 v86, v86, v26
    v_sub_f32 v87, v87, v26
    v_exp_f32 v72, v72
    v_exp_f32 v73, v73
    v_exp_f32 v74, v74
    v_exp_f32 v75, v75
    v_exp_f32 v76, v76
    v_exp_f32 v77, v77
    v_exp_f32 v78, v78
    v_exp_f32 v79, v79
    v_exp_f32 v80, v80
    v_exp_f32 v81, v81
    v_exp_f32 v82, v82
    v_exp_f32 v83, v83
    v_exp_f32 v84, v84
    v_exp_f32 v85, v85
    v_exp_f32 v86, v86
    v_exp_f32 v87, v87
    v_and_b32 v72, s3, v72
    v_and_b32 v73, s3, v73
    v_and_b32 v74, s3, v74
    v_and_b32 v75, s3, v75
    v_and_b32 v76, s3, v76
    v_and_b32 v77, s3, v77
    v_and_b32 v78, s3, v78
    v_and_b32 v79, s3, v79
    v_and_b32 v80, s3, v80
    v_and_b32 v81, s3, v81
    v_and_b32 v82, s3, v82
    v_and_b32 v83, s3, v83
    v_and_b32 v84, s3, v84
    v_and_b32 v85, s3, v85
    v_and_b32 v86, s3, v86
    v_and_b32 v87, s3, v87
    v_add_f32 v28, v28, v72
    v_add_f32 v28, v28, v73
    v_add_f32 v28, v28, v74
    v_add_f32 v28, v28, v75
    v_add_f32 v28, v28, v76
    v_add_f32 v28, v28, v77
    v_add_f32 v28, v28, v78
    v_add_f32 v28, v28, v79
    v_add_f32 v28, v28, v80
    v_add_f32 v28, v28, v81
    v_add_f32 v28, v28, v82
    v_add_f32 v28, v28, v83
    v_add_f32 v28, v28, v84
    v_add_f32 v28, v28, v85
    v_add_f32 v28, v28, v86
    v_add_f32 v28, v28, v87
    v_smfmac_f32_32x32x32_bf16 v[32:47], v[64:67], v[72:79], v29
    v_smfmac_f32_32x32x32_bf16 v[32:47], v[68:71], v[80:87], v29
    s_add_u32 s61, s61, 2048
    s_cmp_lt_u32 s61, 131072
    s_cbranch_scc1 s_slow2
    v_mov_b32 v29, v28
    s_nop 1
    v_permlane32_swap_b32 v28, v29
    v_add_f32 v28, v28, v29
    v_rcp_f32 v28, v28
    s_nop 7
    s_branch s_fin
k_exit:
    s_endpgm
.if k_exit - interleave_layers__sliding_local_dilated__softmax_full_mha__prompt_kernel < 49152
.error "code prefetch reads past the end of the code"
.endif
.section .rodata,"a"
.p2align 6
.amdhsa_kernel interleave_layers__sliding_local_dilated__softmax_full_mha__prompt_kernel
  .amdhsa_next_free_vgpr 256
  .amdhsa_next_free_sgpr 102
  .amdhsa_accum_offset 256
  .amdhsa_group_segment_fixed_size 0
  .amdhsa_kernarg_size 72
  .amdhsa_user_sgpr_count 2
  .amdhsa_user_sgpr_kernarg_segment_ptr 1
  .amdhsa_system_sgpr_workgroup_id_x 1
.end_amdhsa_kernel
```

```asm
; @launch grid=(256,1,1) block=(512,1,1) lds=156736
.amdgcn_target "amdgcn-amd-amdhsa--gfx950"
.text
.globl interleave_layers__sliding_local_dilated__softmax_full_mha__prompt_kernel
.type interleave_layers__sliding_local_dilated__softmax_full_mha__prompt_kernel,@function
.p2align 8
interleave_layers__sliding_local_dilated__softmax_full_mha__prompt_kernel:
    s_cmp_ge_u32 s2, 256
    s_cbranch_scc1 k_exit
    s_load_dwordx2 s[36:37], s[0:1], 0
    s_load_dwordx4 s[24:27], s[0:1], 8
    s_load_dwordx8 s[28:35], s[0:1], 32
    s_load_dwordx2 s[44:45], s[0:1], 64
    v_lshrrev_b32 v2, 6, v0
    v_and_b32 v0, 63, v0
    v_readfirstlane_b32 s16, v2
    v_lshlrev_b32 v1, 4, v0
    s_mov_b32 s21, 0
    s_mov_b32 s40, 1
    s_and_b32 s3, s2, 1
    s_lshl_b32 s3, s3, 3
    s_bfe_u32 s17, s2, 0x30003
    s_add_u32 s17, s17, s3
    s_bfe_u32 s3, s2, 0x20001
    s_lshl_b32 s3, s3, 2
    s_lshr_b32 s18, s2, 6
    s_add_u32 s18, s18, s3
    s_and_b32 s3, s16, 3
    s_lshl_b32 s38, s17, 2
    s_add_u32 s38, s38, s3
    v_lshrrev_b32 v32, 3, v0
    v_and_b32 v33, 7, v0
    v_lshlrev_b32 v34, 11, v32
    v_lshl_add_u32 v34, v33, 4, v34
    s_lshl_b32 s46, s38, 16
    s_lshl_b32 s47, s18, 7
    s_add_u32 s46, s46, s47
    s_getpc_b64 s[76:77]
e_pc:
    s_sub_u32 s76, s76, e_pc - interleave_layers__sliding_local_dilated__softmax_full_mha__prompt_kernel
    s_subb_u32 s77, s77, 0
    s_and_b32 s3, s2, 0xf8
    s_add_u32 s3, s3, s16
    s_lshl_b32 s3, s3, 6
    s_add_u32 s78, s3, 49152
    s_min_u32 s78, s78, k_exit - interleave_layers__sliding_local_dilated__softmax_full_mha__prompt_kernel
    s_waitcnt lgkmcnt(0)
    s_mov_b32 s8, s36
    s_mov_b32 s9, s37
    s_mov_b32 s10, 4194304
    s_mov_b32 s11, 0x00020000
    s_cmp_gt_u32 s16, 3
    s_cbranch_scc1 e_side
    buffer_load_dwordx4 v[40:43], v34, s[8:11], s46 offen
    s_add_u32 s46, s46, 16384
    buffer_load_dwordx4 v[44:47], v34, s[8:11], s46 offen
    s_add_u32 s46, s46, 16384
    buffer_load_dwordx4 v[48:51], v34, s[8:11], s46 offen
    s_add_u32 s46, s46, 16384
    buffer_load_dwordx4 v[52:55], v34, s[8:11], s46 offen
e_side:
    s_load_dword s80, s[76:77], s3 offset:0
    s_load_dword s81, s[76:77], s3 offset:16384
    s_load_dword s82, s[76:77], s3 offset:32768
    s_load_dword s83, s[76:77], s78
    s_mov_b32 s4, s44
    s_mov_b32 s5, s45
    s_mov_b32 s6, 67108864
    s_mov_b32 s7, 0x00020000
    s_add_u32 s22, s44, 58720256
    s_addc_u32 s23, s45, 0
    s_load_dword s100, s[22:23], 217088
    s_cmp_gt_u32 s16, 3
    s_cbranch_scc1 s_start
    v_lshrrev_b32 v8, 4, v1
    s_lshl_b32 s44, s38, 16
    v_xor_b32 v88, v33, v32
    v_lshlrev_b32 v88, 4, v88
    v_lshl_add_u32 v88, v32, 11, v88
    v_xor_b32 v89, 16, v88
    v_add_u32 v89, 15360, v89
    v_add_u32 v90, 30720, v88
    v_add_u32 v91, 30720, v89
    s_mul_i32 s76, s16, 16384
    s_add_u32 s76, s76, 61440
    s_lshl_b32 s77, s38, 16
    s_mul_i32 s84, s18, 4096
    s_cmp_lt_u32 s18, 4
    s_cselect_b32 s85, 4, 0
    s_mul_i32 s85, s85, 4096
    s_cmp_lt_u32 s18, 4
    s_cselect_b32 s86, 5, 1
    s_mul_i32 s86, s86, 4096
    s_cmp_lt_u32 s18, 4
    s_cselect_b32 s87, 6, 2
    s_mul_i32 s87, s87, 4096
    s_cmp_lt_u32 s18, 4
    s_cselect_b32 s88, 7, 3
    s_mul_i32 s88, s88, 4096
    s_cmp_lt_u32 s18, 8
    s_cselect_b32 s89, 8, 4
    s_mul_i32 s89, s89, 4096
    s_cmp_lt_u32 s18, 8
    s_cselect_b32 s90, 9, 5
    s_mul_i32 s90, s90, 4096
    s_cmp_lt_u32 s18, 8
    s_cselect_b32 s91, 10, 6
    s_mul_i32 s91, s91, 4096
    s_cmp_lt_u32 s18, 8
    s_cselect_b32 s92, 11, 7
    s_mul_i32 s92, s92, 4096
    s_cmp_lt_u32 s18, 12
    s_cselect_b32 s93, 12, 8
    s_mul_i32 s93, s93, 4096
    s_cmp_lt_u32 s18, 12
    s_cselect_b32 s94, 13, 9
    s_mul_i32 s94, s94, 4096
    s_cmp_lt_u32 s18, 12
    s_cselect_b32 s95, 14, 10
    s_mul_i32 s95, s95, 4096
    s_cmp_lt_u32 s18, 12
    s_cselect_b32 s96, 15, 11
    s_mul_i32 s96, s96, 4096
    s_xor_b32 s97, s18, 1
    s_mul_i32 s97, s97, 4096
    s_xor_b32 s98, s18, 2
    s_mul_i32 s98, s98, 4096
    s_xor_b32 s99, s18, 3
    s_mul_i32 s99, s99, 4096
    s_lshr_b32 s3, s18, 2
    s_lshl_b32 s3, s3, 3
    s_lshl_b32 s63, 1, s3
    s_lshl_b32 s3, s63, 2
    s_andn2_b32 s19, 67372036, s3
    v_lshrrev_b32 v12, 4, v1
    v_and_b32 v13, 15, v12
    v_bfe_u32 v14, v12, 4, 1
    v_lshrrev_b32 v12, 5, v12
    v_lshl_add_u32 v2, v14, 5, v13
    v_lshlrev_b32 v2, 4, v2
    v_lshl_add_u32 v2, v12, 10, v2
    v_lshrrev_b32 v15, 2, v13
    v_lshl_add_u32 v15, v14, 2, v15
    v_lshlrev_b32 v3, 7, v15
    v_lshl_add_u32 v3, v12, 11, v3
    v_and_b32 v15, 3, v13
    v_lshl_add_u32 v3, v15, 3, v3
    v_lshrrev_b32 v15, 3, v13
    v_lshl_add_u32 v15, v15, 1, v14
    v_lshl_add_u32 v3, v15, 5, v3
    v_xor_b32 v4, 32, v3
    v_xor_b32 v5, 64, v3
    v_xor_b32 v6, 96, v3
    s_lshl_b32 s45, s16, 12
    s_add_u32 s45, s45, 131072
    v_lshrrev_b32 v35, 1, v33
    v_lshlrev_b32 v35, 10, v35
    v_lshl_add_u32 v35, v32, 4, v35
    v_and_b32 v36, 1, v33
    v_lshl_add_u32 v35, v36, 3, v35
    v_add_u32 v35, s45, v35
    v_add_u32 v36, s45, v1
    v_mov_b32 v37, 0x3f803f80
    v_and_b32 v38, 3, v8
    v_lshl_add_u32 v39, v38, 3, v32
    v_lshlrev_b32 v39, 3, v39
    v_mov_b32 v56, 0
    v_mov_b32 v57, 0
    v_mov_b32 v58, 0
    v_mov_b32 v59, 0
    v_mov_b32 v60, 0
    v_mov_b32 v61, 0
    v_mov_b32 v62, 0
    v_mov_b32 v63, 0
    s_waitcnt vmcnt(3)
    ds_write_b64 v35, v[40:41] offset:0
    ds_write_b64 v35, v[42:43] offset:512
    s_waitcnt vmcnt(2)
    ds_write_b64 v35, v[44:45] offset:128
    ds_write_b64 v35, v[46:47] offset:640
    s_waitcnt vmcnt(1)
    ds_write_b64 v35, v[48:49] offset:256
    ds_write_b64 v35, v[50:51] offset:768
    s_waitcnt vmcnt(0)
    ds_write_b64 v35, v[52:53] offset:384
    ds_write_b64 v35, v[54:55] offset:896
    ds_read_b128 v[64:67], v36 offset:0
    ds_read_b128 v[68:71], v36 offset:1024
    ds_read_b128 v[72:75], v36 offset:2048
    ds_read_b128 v[76:79], v36 offset:3072
    s_lshl_b32 s45, s18, 12
    s_add_u32 s46, s44, s45
    s_waitcnt lgkmcnt(3)
    buffer_store_dwordx4 v[64:67], v1, s[4:7], s46 offen offset:0 sc1
    s_waitcnt lgkmcnt(2)
    buffer_store_dwordx4 v[68:71], v1, s[4:7], s46 offen offset:1024 sc1
    s_waitcnt lgkmcnt(1)
    buffer_store_dwordx4 v[72:75], v1, s[4:7], s46 offen offset:2048 sc1
    s_waitcnt lgkmcnt(0)
    buffer_store_dwordx4 v[76:79], v1, s[4:7], s46 offen offset:3072 sc1
    s_add_u32 m0, s76, 4096
    s_lshr_b32 s78, s85, 5
    s_add_u32 s78, s78, s77
    buffer_load_dwordx4 v88, s[8:11], s78 offen offset:0 lds
    buffer_load_dwordx4 v89, s[8:11], s78 offen offset:1024 lds
    buffer_load_dwordx4 v90, s[8:11], s78 offen offset:2048 lds
    buffer_load_dwordx4 v91, s[8:11], s78 offen offset:3072 lds
    s_add_u32 m0, s76, 8192
    s_lshr_b32 s78, s86, 5
    s_add_u32 s78, s78, s77
    buffer_load_dwordx4 v88, s[8:11], s78 offen offset:0 lds
    buffer_load_dwordx4 v89, s[8:11], s78 offen offset:1024 lds
    buffer_load_dwordx4 v90, s[8:11], s78 offen offset:2048 lds
    buffer_load_dwordx4 v91, s[8:11], s78 offen offset:3072 lds
    s_add_u32 m0, s76, 12288
    s_lshr_b32 s78, s87, 5
    s_add_u32 s78, s78, s77
    buffer_load_dwordx4 v88, s[8:11], s78 offen offset:0 lds
    buffer_load_dwordx4 v89, s[8:11], s78 offen offset:1024 lds
    buffer_load_dwordx4 v90, s[8:11], s78 offen offset:2048 lds
    buffer_load_dwordx4 v91, s[8:11], s78 offen offset:3072 lds
    s_add_u32 m0, s76, 16384
    s_lshr_b32 s78, s88, 5
    s_add_u32 s78, s78, s77
    buffer_load_dwordx4 v88, s[8:11], s78 offen offset:0 lds
    buffer_load_dwordx4 v89, s[8:11], s78 offen offset:1024 lds
    buffer_load_dwordx4 v90, s[8:11], s78 offen offset:2048 lds
    buffer_load_dwordx4 v91, s[8:11], s78 offen offset:3072 lds
    v_dot2_f32_bf16 v56, v40, v37, v56
    v_dot2_f32_bf16 v57, v40, v40, v57
    v_dot2_f32_bf16 v58, v44, v37, v58
    v_dot2_f32_bf16 v59, v44, v44, v59
    v_dot2_f32_bf16 v60, v48, v37, v60
    v_dot2_f32_bf16 v61, v48, v48, v61
    v_dot2_f32_bf16 v62, v52, v37, v62
    v_dot2_f32_bf16 v63, v52, v52, v63
    v_dot2_f32_bf16 v56, v41, v37, v56
    v_dot2_f32_bf16 v57, v41, v41, v57
    v_dot2_f32_bf16 v58, v45, v37, v58
    v_dot2_f32_bf16 v59, v45, v45, v59
    v_dot2_f32_bf16 v60, v49, v37, v60
    v_dot2_f32_bf16 v61, v49, v49, v61
    v_dot2_f32_bf16 v62, v53, v37, v62
    v_dot2_f32_bf16 v63, v53, v53, v63
    v_dot2_f32_bf16 v56, v42, v37, v56
    v_dot2_f32_bf16 v57, v42, v42, v57
    v_dot2_f32_bf16 v58, v46, v37, v58
    v_dot2_f32_bf16 v59, v46, v46, v59
    v_dot2_f32_bf16 v60, v50, v37, v60
    v_dot2_f32_bf16 v61, v50, v50, v61
    v_dot2_f32_bf16 v62, v54, v37, v62
    v_dot2_f32_bf16 v63, v54, v54, v63
    v_dot2_f32_bf16 v56, v43, v37, v56
    v_dot2_f32_bf16 v57, v43, v43, v57
    v_dot2_f32_bf16 v58, v47, v37, v58
    v_dot2_f32_bf16 v59, v47, v47, v59
    v_dot2_f32_bf16 v60, v51, v37, v60
    v_dot2_f32_bf16 v61, v51, v51, v61
    v_dot2_f32_bf16 v62, v55, v37, v62
    v_dot2_f32_bf16 v63, v55, v55, v63
    s_nop 2
    v_add_f32_dpp v56, v56, v56 quad_perm:[1,0,3,2] row_mask:0xf bank_mask:0xf
    v_add_f32_dpp v57, v57, v57 quad_perm:[1,0,3,2] row_mask:0xf bank_mask:0xf
    v_add_f32_dpp v58, v58, v58 quad_perm:[1,0,3,2] row_mask:0xf bank_mask:0xf
    v_add_f32_dpp v59, v59, v59 quad_perm:[1,0,3,2] row_mask:0xf bank_mask:0xf
    v_add_f32_dpp v60, v60, v60 quad_perm:[1,0,3,2] row_mask:0xf bank_mask:0xf
    v_add_f32_dpp v61, v61, v61 quad_perm:[1,0,3,2] row_mask:0xf bank_mask:0xf
    v_add_f32_dpp v62, v62, v62 quad_perm:[1,0,3,2] row_mask:0xf bank_mask:0xf
    v_add_f32_dpp v63, v63, v63 quad_perm:[1,0,3,2] row_mask:0xf bank_mask:0xf
    v_add_f32_dpp v56, v56, v56 quad_perm:[2,3,0,1] row_mask:0xf bank_mask:0xf
    v_add_f32_dpp v57, v57, v57 quad_perm:[2,3,0,1] row_mask:0xf bank_mask:0xf
    v_add_f32_dpp v58, v58, v58 quad_perm:[2,3,0,1] row_mask:0xf bank_mask:0xf
    v_add_f32_dpp v59, v59, v59 quad_perm:[2,3,0,1] row_mask:0xf bank_mask:0xf
    v_add_f32_dpp v60, v60, v60 quad_perm:[2,3,0,1] row_mask:0xf bank_mask:0xf
    v_add_f32_dpp v61, v61, v61 quad_perm:[2,3,0,1] row_mask:0xf bank_mask:0xf
    v_add_f32_dpp v62, v62, v62 quad_perm:[2,3,0,1] row_mask:0xf bank_mask:0xf
    v_add_f32_dpp v63, v63, v63 quad_perm:[2,3,0,1] row_mask:0xf bank_mask:0xf
    v_add_f32_dpp v56, v56, v56 row_half_mirror row_mask:0xf bank_mask:0xf
    v_add_f32_dpp v57, v57, v57 row_half_mirror row_mask:0xf bank_mask:0xf
    v_add_f32_dpp v58, v58, v58 row_half_mirror row_mask:0xf bank_mask:0xf
    v_add_f32_dpp v59, v59, v59 row_half_mirror row_mask:0xf bank_mask:0xf
    v_add_f32_dpp v60, v60, v60 row_half_mirror row_mask:0xf bank_mask:0xf
    v_add_f32_dpp v61, v61, v61 row_half_mirror row_mask:0xf bank_mask:0xf
    v_add_f32_dpp v62, v62, v62 row_half_mirror row_mask:0xf bank_mask:0xf
    v_add_f32_dpp v63, v63, v63 row_half_mirror row_mask:0xf bank_mask:0xf
    v_cmp_eq_u32 vcc, 1, v38
    s_nop 1
    v_cndmask_b32 v56, v56, v58, vcc
    v_cndmask_b32 v57, v57, v59, vcc
    v_cmp_eq_u32 vcc, 2, v38
    s_nop 1
    v_cndmask_b32 v56, v56, v60, vcc
    v_cndmask_b32 v57, v57, v61, vcc
    v_cmp_eq_u32 vcc, 3, v38
    s_nop 1
    v_cndmask_b32 v56, v56, v62, vcc
    v_cndmask_b32 v57, v57, v63, vcc
    s_lshl_b32 s44, s21, 18
    s_lshl_b32 s45, s38, 12
    s_add_u32 s44, s44, s45
    s_lshl_b32 s45, s18, 8
    s_add_u32 s44, s44, s45
    s_add_u32 s44, s44, 50331648
    buffer_store_dwordx2 v[56:57], v39, s[4:7], s44 offen sc1
    s_lshl_b32 s46, s21, 14
    s_lshl_b32 s67, s38, 7
    s_add_u32 s46, s46, s67
    s_add_u32 s46, s46, 4096
    s_add_u32 s47, s46, 8192
    s_lshl_b32 s48, s21, 22
    s_lshl_b32 s49, s38, 16
    s_add_u32 s41, s48, s49
    v_lshrrev_b32 v16, 4, v1
    v_and_b32 v17, 15, v16
    v_lshrrev_b32 v16, 4, v16
    s_lshl_b32 s49, s16, 7
    s_add_u32 s50, s49, 151552
    s_and_b32 s49, s21, 1
    s_lshl_b32 s49, s49, 10
    s_add_u32 s49, s49, 151552
    v_lshlrev_b32 v11, 4, v16
    v_add_u32 v13, s50, v11
    v_add_u32 v11, s49, v11
    v_lshlrev_b32 v15, 2, v17
    v_add_u32 v9, s50, v15
    v_add_u32 v15, s49, v15
    s_lshr_b32 s49, s21, 1
    s_lshl_b32 s53, s49, 23
    s_lshl_b32 s50, s18, 18
    s_add_u32 s53, s53, s50
    s_add_u32 s53, s53, 33554432
    s_lshl_b32 s54, s38, 11
    s_add_u32 s52, s53, s54
    s_lshl_b32 s59, s49, 13
    s_lshl_b32 s67, s18, 9
    s_add_u32 s59, s59, s67
    s_lshl_b32 s67, s16, 7
    s_add_u32 s59, s59, s67
    s_add_u32 s59, s59, 69632
    s_lshl_b32 s61, s49, 15
    s_lshl_b32 s67, s17, 11
    s_add_u32 s61, s61, s67
    s_lshl_b32 s67, s18, 7
    s_add_u32 s61, s61, s67
    s_add_u32 s61, s61, 151552
    s_sub_u32 s60, s61, 151552
    s_lshl_b32 s60, s60, 5
    s_add_u32 s60, s60, 54525952
    s_lshl_b32 s62, s16, 12
    s_add_u32 s62, s62, 131072
    v_bfe_u32 v80, v8, 3, 1
    v_and_b32 v81, 7, v8
    v_lshrrev_b32 v82, 5, v8
    v_lshlrev_b32 v82, 1, v82
    v_xor_b32 v82, v82, v81
    v_xor_b32 v82, v82, v80
    v_lshlrev_b32 v82, 4, v82
    v_lshl_add_u32 v82, v81, 7, v82
    v_lshl_add_u32 v82, v80, 10, v82
    v_bfe_u32 v80, v8, 4, 1
    v_lshl_add_u32 v82, v80, 3, v82
    v_add_u32 v20, s76, v82
    v_xor_b32 v21, 16, v20
    v_xor_b32 v22, 64, v20
    v_xor_b32 v23, 80, v20
    v_add_u32 v80, s62, v2
    ds_read_b128 v[160:163], v80 offset:0
    ds_read_b128 v[164:167], v80 offset:256
    ds_read_b128 v[168:171], v80 offset:2048
    ds_read_b128 v[172:175], v80 offset:2304
    s_mov_b64 vcc, -1
    s_mov_b32 s48, 1
    s_or_b32 s20, s19, 0x80000000
    s_barrier
    ds_read_b64_tr_b16 v[32:33], v3 offset:0
    ds_read_b64_tr_b16 v[34:35], v3 offset:1024
    ds_read_b64_tr_b16 v[36:37], v4 offset:0
    ds_read_b64_tr_b16 v[38:39], v4 offset:1024
    ds_read_b64_tr_b16 v[40:41], v5 offset:0
    ds_read_b64_tr_b16 v[42:43], v5 offset:1024
    ds_read_b64_tr_b16 v[44:45], v6 offset:0
    ds_read_b64_tr_b16 v[46:47], v6 offset:1024
    ds_read_b64_tr_b16 v[48:49], v3 offset:4096
    ds_read_b64_tr_b16 v[50:51], v3 offset:5120
    ds_read_b64_tr_b16 v[52:53], v4 offset:4096
    ds_read_b64_tr_b16 v[54:55], v4 offset:5120
    ds_read_b64_tr_b16 v[56:57], v5 offset:4096
    ds_read_b64_tr_b16 v[58:59], v5 offset:5120
    s_branch c_g0
c_st1:
    s_waitcnt vmcnt(1)
    ds_read_b64 v[176:177], v20 offset:4096
    ds_read_b64 v[178:179], v21 offset:4096
    ds_read_b64 v[180:181], v20 offset:6144
    ds_read_b64 v[182:183], v21 offset:6144
    ds_read_b64 v[184:185], v22 offset:4096
    ds_read_b64 v[186:187], v23 offset:4096
    ds_read_b64 v[188:189], v22 offset:6144
    ds_read_b64 v[190:191], v23 offset:6144
    ds_read_b64 v[192:193], v20 offset:8192
    ds_read_b64 v[194:195], v21 offset:8192
    ds_read_b64 v[196:197], v20 offset:10240
    ds_read_b64 v[198:199], v21 offset:10240
    ds_read_b64 v[200:201], v22 offset:8192
    ds_read_b64 v[202:203], v23 offset:8192
    ds_read_b64 v[204:205], v22 offset:10240
    ds_read_b64 v[206:207], v23 offset:10240
    ds_read_b64 v[208:209], v20 offset:12288
    ds_read_b64 v[210:211], v21 offset:12288
    ds_read_b64 v[212:213], v20 offset:14336
    ds_read_b64 v[214:215], v21 offset:14336
    ds_read_b64 v[216:217], v22 offset:12288
    ds_read_b64 v[218:219], v23 offset:12288
    ds_read_b64 v[220:221], v22 offset:14336
    ds_read_b64 v[222:223], v23 offset:14336
    ds_read_b64 v[224:225], v20 offset:16384
    ds_read_b64 v[226:227], v21 offset:16384
    ds_read_b64 v[228:229], v20 offset:18432
    ds_read_b64 v[230:231], v21 offset:18432
    ds_read_b64 v[232:233], v22 offset:16384
    ds_read_b64 v[234:235], v23 offset:16384
    ds_read_b64 v[236:237], v22 offset:18432
    ds_read_b64 v[238:239], v23 offset:18432
    s_load_dword s68, s[34:35], 0
    s_mov_b32 s8, s34
    s_mov_b32 s9, s35
    s_mov_b32 s10, 256
    s_mov_b32 s11, 0x00020000
    s_mov_b32 s66, 0x10000
    v_mov_b32 v16, 0
    s_waitcnt lgkmcnt(0)
c_f0:
    s_cmp_eq_u32 s68, 10
    s_cbranch_scc1 c_f0_ok
    buffer_load_dword v17, v16, s[8:11], 0 offen offset:0 sc1
    s_waitcnt vmcnt(0)
    v_readfirstlane_b32 s68, v17
    s_sub_u32 s66, s66, 1
    s_cmp_lg_u32 s66, 0
    s_cbranch_scc1 c_f0
c_f0_ok:
    s_atomic_add s63, s[22:23], s46
    s_branch c_st2
c_cs1:
    s_waitcnt vmcnt(0)
    s_atomic_add s40, s[22:23], s47
    s_branch c_cs2
c_layer:
    s_mov_b64 vcc, 0
c_early2:
    s_barrier
    ds_read_b64_tr_b16 v[32:33], v3 offset:0
    ds_read_b64_tr_b16 v[34:35], v3 offset:1024
    ds_read_b64_tr_b16 v[36:37], v4 offset:0
    ds_read_b64_tr_b16 v[38:39], v4 offset:1024
    ds_read_b64_tr_b16 v[40:41], v5 offset:0
    ds_read_b64_tr_b16 v[42:43], v5 offset:1024
    ds_read_b64_tr_b16 v[44:45], v6 offset:0
    ds_read_b64_tr_b16 v[46:47], v6 offset:1024
    ds_read_b64_tr_b16 v[48:49], v3 offset:4096
    ds_read_b64_tr_b16 v[50:51], v3 offset:5120
    ds_read_b64_tr_b16 v[52:53], v4 offset:4096
    ds_read_b64_tr_b16 v[54:55], v4 offset:5120
    ds_read_b64_tr_b16 v[56:57], v5 offset:4096
    ds_read_b64_tr_b16 v[58:59], v5 offset:5120
c_g0:
    s_waitcnt lgkmcnt(10)
    v_mfma_f32_16x16x32_bf16 v[64:67], v[32:35], v[160:163], 0
    ds_read_b64_tr_b16 v[60:61], v6 offset:4096
    v_mfma_f32_16x16x32_bf16 v[68:71], v[32:35], v[164:167], 0
    ds_read_b64_tr_b16 v[62:63], v6 offset:5120
    v_mfma_f32_16x16x32_bf16 v[72:75], v[36:39], v[160:163], 0
    ds_read_b64_tr_b16 v[32:33], v3 offset:8192
    v_mfma_f32_16x16x32_bf16 v[76:79], v[36:39], v[164:167], 0
    ds_read_b64_tr_b16 v[34:35], v3 offset:9216
    s_waitcnt lgkmcnt(10)
    v_mfma_f32_16x16x32_bf16 v[80:83], v[40:43], v[160:163], 0
    ds_read_b64_tr_b16 v[36:37], v4 offset:8192
    v_mfma_f32_16x16x32_bf16 v[84:87], v[40:43], v[164:167], 0
    ds_read_b64_tr_b16 v[38:39], v4 offset:9216
    v_mfma_f32_16x16x32_bf16 v[88:91], v[44:47], v[160:163], 0
    ds_read_b64_tr_b16 v[40:41], v5 offset:8192
    v_mfma_f32_16x16x32_bf16 v[92:95], v[44:47], v[164:167], 0
    ds_read_b64_tr_b16 v[42:43], v5 offset:9216
    s_waitcnt lgkmcnt(10)
    v_mfma_f32_16x16x32_bf16 v[96:99], v[160:163], v[48:51], 0
    ds_read_b64_tr_b16 v[44:45], v6 offset:8192
    v_mfma_f32_16x16x32_bf16 v[100:103], v[164:167], v[48:51], 0
    ds_read_b64_tr_b16 v[46:47], v6 offset:9216
    v_mfma_f32_16x16x32_bf16 v[104:107], v[160:163], v[52:55], 0
    ds_read_b64_tr_b16 v[48:49], v3 offset:12288
    v_mfma_f32_16x16x32_bf16 v[108:111], v[164:167], v[52:55], 0
    ds_read_b64_tr_b16 v[50:51], v3 offset:13312
    s_waitcnt lgkmcnt(10)
    v_mfma_f32_16x16x32_bf16 v[112:115], v[160:163], v[56:59], 0
    ds_read_b64_tr_b16 v[52:53], v4 offset:12288
    v_mfma_f32_16x16x32_bf16 v[116:119], v[164:167], v[56:59], 0
    ds_read_b64_tr_b16 v[54:55], v4 offset:13312
    v_mfma_f32_16x16x32_bf16 v[120:123], v[160:163], v[60:63], 0
    ds_read_b64_tr_b16 v[56:57], v5 offset:12288
    v_mfma_f32_16x16x32_bf16 v[124:127], v[164:167], v[60:63], 0
    ds_read_b64_tr_b16 v[58:59], v5 offset:13312
    s_cmp_lg_u32 s48, 0
    s_cbranch_scc1 c_gate
    s_mov_b32 s66, 0x10000
    s_waitcnt lgkmcnt(0)
    s_and_b32 s68, s68, s19
    s_cmp_eq_u32 s68, s19
    s_cbranch_scc1 c_x_ok
c_x_poll:
    s_mov_b32 s68, 0
    s_atomic_add s68, s[22:23], s46 offset:0 glc
    s_sub_u32 s66, s66, 1
    s_cselect_b32 s67, s19, 0
    s_waitcnt lgkmcnt(0)
    s_and_b32 s68, s68, s19
    s_max_u32 s68, s68, s67
    s_cmp_lt_u32 s68, s19
    s_cbranch_scc1 c_x_poll
c_x_ok:
    s_add_u32 s42, s41, s85
    buffer_load_dwordx4 v[176:179], v2, s[4:7], s42 offen offset:0 sc1
    buffer_load_dwordx4 v[180:183], v2, s[4:7], s42 offen offset:256 sc1
    buffer_load_dwordx4 v[184:187], v2, s[4:7], s42 offen offset:2048 sc1
    buffer_load_dwordx4 v[188:191], v2, s[4:7], s42 offen offset:2304 sc1
    s_add_u32 s42, s41, s86
    buffer_load_dwordx4 v[192:195], v2, s[4:7], s42 offen offset:0 sc1
    buffer_load_dwordx4 v[196:199], v2, s[4:7], s42 offen offset:256 sc1
    buffer_load_dwordx4 v[200:203], v2, s[4:7], s42 offen offset:2048 sc1
    buffer_load_dwordx4 v[204:207], v2, s[4:7], s42 offen offset:2304 sc1
    s_add_u32 s42, s41, s87
    buffer_load_dwordx4 v[208:211], v2, s[4:7], s42 offen offset:0 sc1
    buffer_load_dwordx4 v[212:215], v2, s[4:7], s42 offen offset:256 sc1
    s_waitcnt vmcnt(10)
    s_atomic_add s40, s[22:23], s47
c_gate:
    s_waitcnt lgkmcnt(10)
    v_mfma_f32_16x16x32_bf16 v[128:131], v[32:35], v[160:163], 0
    ds_read_b64_tr_b16 v[60:61], v6 offset:12288
    v_mfma_f32_16x16x32_bf16 v[132:135], v[32:35], v[164:167], 0
    ds_read_b64_tr_b16 v[62:63], v6 offset:13312
    v_mfma_f32_16x16x32_bf16 v[136:139], v[36:39], v[160:163], 0
    ds_read_b64_tr_b16 v[32:33], v3 offset:16384
    v_mfma_f32_16x16x32_bf16 v[140:143], v[36:39], v[164:167], 0
    ds_read_b64_tr_b16 v[34:35], v3 offset:17408
    s_waitcnt lgkmcnt(10)
    v_mfma_f32_16x16x32_bf16 v[144:147], v[40:43], v[160:163], 0
    ds_read_b64_tr_b16 v[36:37], v4 offset:16384
    v_mfma_f32_16x16x32_bf16 v[148:151], v[40:43], v[164:167], 0
    ds_read_b64_tr_b16 v[38:39], v4 offset:17408
    v_mfma_f32_16x16x32_bf16 v[152:155], v[44:47], v[160:163], 0
    ds_read_b64_tr_b16 v[40:41], v5 offset:16384
    v_mfma_f32_16x16x32_bf16 v[156:159], v[44:47], v[164:167], 0
    ds_read_b64_tr_b16 v[42:43], v5 offset:17408
    s_waitcnt lgkmcnt(10)
    v_mfma_f32_16x16x32_bf16 v[64:67], v[48:51], v[168:171], v[64:67]
    ds_read_b64_tr_b16 v[44:45], v6 offset:16384
    v_mfma_f32_16x16x32_bf16 v[68:71], v[48:51], v[172:175], v[68:71]
    ds_read_b64_tr_b16 v[46:47], v6 offset:17408
    v_mfma_f32_16x16x32_bf16 v[72:75], v[52:55], v[168:171], v[72:75]
    ds_read_b64_tr_b16 v[48:49], v3 offset:20480
    v_mfma_f32_16x16x32_bf16 v[76:79], v[52:55], v[172:175], v[76:79]
    ds_read_b64_tr_b16 v[50:51], v3 offset:21504
    s_waitcnt lgkmcnt(10)
    v_mfma_f32_16x16x32_bf16 v[80:83], v[56:59], v[168:171], v[80:83]
    ds_read_b64_tr_b16 v[52:53], v4 offset:20480
    v_mfma_f32_16x16x32_bf16 v[84:87], v[56:59], v[172:175], v[84:87]
    ds_read_b64_tr_b16 v[54:55], v4 offset:21504
    v_mfma_f32_16x16x32_bf16 v[88:91], v[60:63], v[168:171], v[88:91]
    ds_read_b64_tr_b16 v[56:57], v5 offset:20480
    v_mfma_f32_16x16x32_bf16 v[92:95], v[60:63], v[172:175], v[92:95]
    ds_read_b64_tr_b16 v[58:59], v5 offset:21504
    s_waitcnt lgkmcnt(10)
    v_mfma_f32_16x16x32_bf16 v[96:99], v[168:171], v[32:35], v[96:99]
    ds_read_b64_tr_b16 v[60:61], v6 offset:20480
    v_mfma_f32_16x16x32_bf16 v[100:103], v[172:175], v[32:35], v[100:103]
    ds_read_b64_tr_b16 v[62:63], v6 offset:21504
    v_mfma_f32_16x16x32_bf16 v[104:107], v[168:171], v[36:39], v[104:107]
    ds_read_b64_tr_b16 v[32:33], v3 offset:24576
    v_mfma_f32_16x16x32_bf16 v[108:111], v[172:175], v[36:39], v[108:111]
    ds_read_b64_tr_b16 v[34:35], v3 offset:25600
    s_waitcnt lgkmcnt(10)
    v_mfma_f32_16x16x32_bf16 v[112:115], v[168:171], v[40:43], v[112:115]
    ds_read_b64_tr_b16 v[36:37], v4 offset:24576
    v_mfma_f32_16x16x32_bf16 v[116:119], v[172:175], v[40:43], v[116:119]
    ds_read_b64_tr_b16 v[38:39], v4 offset:25600
    v_mfma_f32_16x16x32_bf16 v[120:123], v[168:171], v[44:47], v[120:123]
    ds_read_b64_tr_b16 v[40:41], v5 offset:24576
    v_mfma_f32_16x16x32_bf16 v[124:127], v[172:175], v[44:47], v[124:127]
    ds_read_b64_tr_b16 v[42:43], v5 offset:25600
    s_waitcnt lgkmcnt(10)
    v_mfma_f32_16x16x32_bf16 v[128:131], v[48:51], v[168:171], v[128:131]
    ds_read_b64_tr_b16 v[44:45], v6 offset:24576
    v_mfma_f32_16x16x32_bf16 v[132:135], v[48:51], v[172:175], v[132:135]
    ds_read_b64_tr_b16 v[46:47], v6 offset:25600
    v_mfma_f32_16x16x32_bf16 v[136:139], v[52:55], v[168:171], v[136:139]
    ds_read_b64_tr_b16 v[48:49], v3 offset:28672
    v_mfma_f32_16x16x32_bf16 v[140:143], v[52:55], v[172:175], v[140:143]
    ds_read_b64_tr_b16 v[50:51], v3 offset:29696
    s_waitcnt lgkmcnt(10)
    v_mfma_f32_16x16x32_bf16 v[144:147], v[56:59], v[168:171], v[144:147]
    ds_read_b64_tr_b16 v[52:53], v4 offset:28672
    v_mfma_f32_16x16x32_bf16 v[148:151], v[56:59], v[172:175], v[148:151]
    ds_read_b64_tr_b16 v[54:55], v4 offset:29696
    v_mfma_f32_16x16x32_bf16 v[152:155], v[60:63], v[168:171], v[152:155]
    ds_read_b64_tr_b16 v[56:57], v5 offset:28672
    v_mfma_f32_16x16x32_bf16 v[156:159], v[60:63], v[172:175], v[156:159]
    ds_read_b64_tr_b16 v[58:59], v5 offset:29696
    s_cbranch_vccnz c_st1
c_st2:
    s_waitcnt vmcnt(8) lgkmcnt(10)
    v_mfma_f32_16x16x32_bf16 v[64:67], v[32:35], v[176:179], v[64:67]
    ds_read_b64_tr_b16 v[60:61], v6 offset:28672
    v_mfma_f32_16x16x32_bf16 v[68:71], v[32:35], v[180:183], v[68:71]
    ds_read_b64_tr_b16 v[62:63], v6 offset:29696
    s_barrier
    v_mfma_f32_16x16x32_bf16 v[72:75], v[36:39], v[176:179], v[72:75]
    ds_read_b64_tr_b16 v[32:33], v3 offset:32768
    v_mfma_f32_16x16x32_bf16 v[76:79], v[36:39], v[180:183], v[76:79]
    ds_read_b64_tr_b16 v[34:35], v3 offset:33792
    s_waitcnt lgkmcnt(10)
    v_mfma_f32_16x16x32_bf16 v[80:83], v[40:43], v[176:179], v[80:83]
    ds_read_b64_tr_b16 v[36:37], v4 offset:32768
    v_mfma_f32_16x16x32_bf16 v[84:87], v[40:43], v[180:183], v[84:87]
    ds_read_b64_tr_b16 v[38:39], v4 offset:33792
    v_mfma_f32_16x16x32_bf16 v[88:91], v[44:47], v[176:179], v[88:91]
    ds_read_b64_tr_b16 v[40:41], v5 offset:32768
    v_mfma_f32_16x16x32_bf16 v[92:95], v[44:47], v[180:183], v[92:95]
    ds_read_b64_tr_b16 v[42:43], v5 offset:33792
    s_waitcnt lgkmcnt(10)
    v_mfma_f32_16x16x32_bf16 v[96:99], v[176:179], v[48:51], v[96:99]
    ds_read_b64_tr_b16 v[44:45], v6 offset:32768
    v_mfma_f32_16x16x32_bf16 v[100:103], v[180:183], v[48:51], v[100:103]
    ds_read_b64_tr_b16 v[46:47], v6 offset:33792
    v_mfma_f32_16x16x32_bf16 v[104:107], v[176:179], v[52:55], v[104:107]
    ds_read_b64_tr_b16 v[48:49], v3 offset:36864
    v_mfma_f32_16x16x32_bf16 v[108:111], v[180:183], v[52:55], v[108:111]
    ds_read_b64_tr_b16 v[50:51], v3 offset:37888
    s_waitcnt lgkmcnt(10)
    v_mfma_f32_16x16x32_bf16 v[112:115], v[176:179], v[56:59], v[112:115]
    ds_read_b64_tr_b16 v[52:53], v4 offset:36864
    v_mfma_f32_16x16x32_bf16 v[116:119], v[180:183], v[56:59], v[116:119]
    ds_read_b64_tr_b16 v[54:55], v4 offset:37888
    v_mfma_f32_16x16x32_bf16 v[120:123], v[176:179], v[60:63], v[120:123]
    ds_read_b64_tr_b16 v[56:57], v5 offset:36864
    v_mfma_f32_16x16x32_bf16 v[124:127], v[180:183], v[60:63], v[124:127]
    ds_read_b64_tr_b16 v[58:59], v5 offset:37888
    s_waitcnt lgkmcnt(10)
    v_mfma_f32_16x16x32_bf16 v[128:131], v[32:35], v[176:179], v[128:131]
    ds_read_b64_tr_b16 v[60:61], v6 offset:36864
    v_mfma_f32_16x16x32_bf16 v[132:135], v[32:35], v[180:183], v[132:135]
    ds_read_b64_tr_b16 v[62:63], v6 offset:37888
    v_mfma_f32_16x16x32_bf16 v[136:139], v[36:39], v[176:179], v[136:139]
    ds_read_b64_tr_b16 v[32:33], v3 offset:40960
    v_mfma_f32_16x16x32_bf16 v[140:143], v[36:39], v[180:183], v[140:143]
    ds_read_b64_tr_b16 v[34:35], v3 offset:41984
    s_waitcnt lgkmcnt(10)
    v_mfma_f32_16x16x32_bf16 v[144:147], v[40:43], v[176:179], v[144:147]
    ds_read_b64_tr_b16 v[36:37], v4 offset:40960
    v_mfma_f32_16x16x32_bf16 v[148:151], v[40:43], v[180:183], v[148:151]
    ds_read_b64_tr_b16 v[38:39], v4 offset:41984
    v_mfma_f32_16x16x32_bf16 v[152:155], v[44:47], v[176:179], v[152:155]
    ds_read_b64_tr_b16 v[40:41], v5 offset:40960
    v_mfma_f32_16x16x32_bf16 v[156:159], v[44:47], v[180:183], v[156:159]
    ds_read_b64_tr_b16 v[42:43], v5 offset:41984
    s_waitcnt vmcnt(6) lgkmcnt(10)
    v_mfma_f32_16x16x32_bf16 v[64:67], v[48:51], v[184:187], v[64:67]
    s_add_u32 s42, s41, s87
    s_cbranch_vccnz xs1
    buffer_load_dwordx4 v[216:219], v2, s[4:7], s42 offen offset:2048 sc1
xs1:
    ds_read_b64_tr_b16 v[44:45], v6 offset:40960
    v_mfma_f32_16x16x32_bf16 v[68:71], v[48:51], v[188:191], v[68:71]
    ds_read_b64_tr_b16 v[46:47], v6 offset:41984
    v_mfma_f32_16x16x32_bf16 v[72:75], v[52:55], v[184:187], v[72:75]
    s_cbranch_vccnz xs2
    buffer_load_dwordx4 v[220:223], v2, s[4:7], s42 offen offset:2304 sc1
xs2:
    ds_read_b64_tr_b16 v[48:49], v3 offset:45056
    s_add_u32 s42, s41, s88
    v_mfma_f32_16x16x32_bf16 v[76:79], v[52:55], v[188:191], v[76:79]
    ds_read_b64_tr_b16 v[50:51], v3 offset:46080
    s_waitcnt lgkmcnt(10)
    v_mfma_f32_16x16x32_bf16 v[80:83], v[56:59], v[184:187], v[80:83]
    s_cbranch_vccnz xs3
    buffer_load_dwordx4 v[224:227], v2, s[4:7], s42 offen offset:0 sc1
xs3:
    ds_read_b64_tr_b16 v[52:53], v4 offset:45056
    v_mfma_f32_16x16x32_bf16 v[84:87], v[56:59], v[188:191], v[84:87]
    ds_read_b64_tr_b16 v[54:55], v4 offset:46080
    v_mfma_f32_16x16x32_bf16 v[88:91], v[60:63], v[184:187], v[88:91]
    s_cbranch_vccnz xs4
    buffer_load_dwordx4 v[228:231], v2, s[4:7], s42 offen offset:256 sc1
xs4:
    ds_read_b64_tr_b16 v[56:57], v5 offset:45056
    v_mfma_f32_16x16x32_bf16 v[92:95], v[60:63], v[188:191], v[92:95]
    ds_read_b64_tr_b16 v[58:59], v5 offset:46080
    s_waitcnt lgkmcnt(10)
    v_mfma_f32_16x16x32_bf16 v[96:99], v[184:187], v[32:35], v[96:99]
    ds_read_b64_tr_b16 v[60:61], v6 offset:45056
    s_cbranch_vccnz xs5
    buffer_load_dwordx4 v[232:235], v2, s[4:7], s42 offen offset:2048 sc1
xs5:
    s_cbranch_vccnz c_cs1
c_cs2:
    v_mfma_f32_16x16x32_bf16 v[100:103], v[188:191], v[32:35], v[100:103]
    ds_read_b64_tr_b16 v[62:63], v6 offset:46080
    v_mfma_f32_16x16x32_bf16 v[104:107], v[184:187], v[36:39], v[104:107]
    s_cbranch_vccnz xs6
    buffer_load_dwordx4 v[236:239], v2, s[4:7], s42 offen offset:2304 sc1
xs6:
    ds_read_b64_tr_b16 v[32:33], v3 offset:49152
    s_add_u32 s42, s41, s89
    v_mfma_f32_16x16x32_bf16 v[108:111], v[188:191], v[36:39], v[108:111]
    ds_read_b64_tr_b16 v[34:35], v3 offset:50176
    s_waitcnt lgkmcnt(10)
    v_mfma_f32_16x16x32_bf16 v[112:115], v[184:187], v[40:43], v[112:115]
    ds_read_b64_tr_b16 v[36:37], v4 offset:49152
    v_mfma_f32_16x16x32_bf16 v[116:119], v[188:191], v[40:43], v[116:119]
    ds_read_b64_tr_b16 v[38:39], v4 offset:50176
    v_mfma_f32_16x16x32_bf16 v[120:123], v[184:187], v[44:47], v[120:123]
    ds_read_b64_tr_b16 v[40:41], v5 offset:49152
    v_mfma_f32_16x16x32_bf16 v[124:127], v[188:191], v[44:47], v[124:127]
    ds_read_b64_tr_b16 v[42:43], v5 offset:50176
    s_waitcnt lgkmcnt(10)
    v_mfma_f32_16x16x32_bf16 v[128:131], v[48:51], v[184:187], v[128:131]
    ds_read_b64_tr_b16 v[44:45], v6 offset:49152
    v_mfma_f32_16x16x32_bf16 v[132:135], v[48:51], v[188:191], v[132:135]
    ds_read_b64_tr_b16 v[46:47], v6 offset:50176
    v_mfma_f32_16x16x32_bf16 v[136:139], v[52:55], v[184:187], v[136:139]
    ds_read_b64_tr_b16 v[48:49], v3 offset:53248
    v_mfma_f32_16x16x32_bf16 v[140:143], v[52:55], v[188:191], v[140:143]
    ds_read_b64_tr_b16 v[50:51], v3 offset:54272
    s_waitcnt lgkmcnt(10)
    v_mfma_f32_16x16x32_bf16 v[144:147], v[56:59], v[184:187], v[144:147]
    ds_read_b64_tr_b16 v[52:53], v4 offset:53248
    v_mfma_f32_16x16x32_bf16 v[148:151], v[56:59], v[188:191], v[148:151]
    ds_read_b64_tr_b16 v[54:55], v4 offset:54272
    v_mfma_f32_16x16x32_bf16 v[152:155], v[60:63], v[184:187], v[152:155]
    ds_read_b64_tr_b16 v[56:57], v5 offset:53248
    v_mfma_f32_16x16x32_bf16 v[156:159], v[60:63], v[188:191], v[156:159]
    ds_read_b64_tr_b16 v[58:59], v5 offset:54272
    s_waitcnt vmcnt(10) lgkmcnt(10)
    v_mfma_f32_16x16x32_bf16 v[64:67], v[32:35], v[192:195], v[64:67]
    ds_read_b64_tr_b16 v[60:61], v6 offset:53248
    v_mfma_f32_16x16x32_bf16 v[68:71], v[32:35], v[196:199], v[68:71]
    ds_read_b64_tr_b16 v[62:63], v6 offset:54272
    v_mfma_f32_16x16x32_bf16 v[72:75], v[36:39], v[192:195], v[72:75]
    ds_read_b64_tr_b16 v[32:33], v3 offset:57344
    v_mfma_f32_16x16x32_bf16 v[76:79], v[36:39], v[196:199], v[76:79]
    ds_read_b64_tr_b16 v[34:35], v3 offset:58368
    s_waitcnt lgkmcnt(10)
    v_mfma_f32_16x16x32_bf16 v[80:83], v[40:43], v[192:195], v[80:83]
    ds_read_b64_tr_b16 v[36:37], v4 offset:57344
    v_mfma_f32_16x16x32_bf16 v[84:87], v[40:43], v[196:199], v[84:87]
    ds_read_b64_tr_b16 v[38:39], v4 offset:58368
    v_mfma_f32_16x16x32_bf16 v[88:91], v[44:47], v[192:195], v[88:91]
    ds_read_b64_tr_b16 v[40:41], v5 offset:57344
    v_mfma_f32_16x16x32_bf16 v[92:95], v[44:47], v[196:199], v[92:95]
    ds_read_b64_tr_b16 v[42:43], v5 offset:58368
    s_waitcnt lgkmcnt(10)
    v_mfma_f32_16x16x32_bf16 v[96:99], v[192:195], v[48:51], v[96:99]
    ds_read_b64_tr_b16 v[44:45], v6 offset:57344
    v_mfma_f32_16x16x32_bf16 v[100:103], v[196:199], v[48:51], v[100:103]
    ds_read_b64_tr_b16 v[46:47], v6 offset:58368
    v_mfma_f32_16x16x32_bf16 v[104:107], v[192:195], v[52:55], v[104:107]
    ds_read_b64_tr_b16 v[48:49], v3 offset:61440
    v_mfma_f32_16x16x32_bf16 v[108:111], v[196:199], v[52:55], v[108:111]
    ds_read_b64_tr_b16 v[50:51], v3 offset:62464
    s_waitcnt lgkmcnt(10)
    v_mfma_f32_16x16x32_bf16 v[112:115], v[192:195], v[56:59], v[112:115]
    ds_read_b64_tr_b16 v[52:53], v4 offset:61440
    v_mfma_f32_16x16x32_bf16 v[116:119], v[196:199], v[56:59], v[116:119]
    ds_read_b64_tr_b16 v[54:55], v4 offset:62464
    v_mfma_f32_16x16x32_bf16 v[120:123], v[192:195], v[60:63], v[120:123]
    ds_read_b64_tr_b16 v[56:57], v5 offset:61440
    v_mfma_f32_16x16x32_bf16 v[124:127], v[196:199], v[60:63], v[124:127]
    ds_read_b64_tr_b16 v[58:59], v5 offset:62464
    s_waitcnt lgkmcnt(10)
    v_mfma_f32_16x16x32_bf16 v[128:131], v[32:35], v[192:195], v[128:131]
    ds_read_b64_tr_b16 v[60:61], v6 offset:61440
    v_mfma_f32_16x16x32_bf16 v[132:135], v[32:35], v[196:199], v[132:135]
    ds_read_b64_tr_b16 v[62:63], v6 offset:62464
    s_barrier
    v_xor_b32 v3, 0x10000, v3
    v_xor_b32 v4, 0x10000, v4
    v_xor_b32 v5, 0x10000, v5
    v_xor_b32 v6, 0x10000, v6
    v_mfma_f32_16x16x32_bf16 v[136:139], v[36:39], v[192:195], v[136:139]
    ds_read_b64_tr_b16 v[32:33], v3 offset:0
    v_mfma_f32_16x16x32_bf16 v[140:143], v[36:39], v[196:199], v[140:143]
    ds_read_b64_tr_b16 v[34:35], v3 offset:1024
    s_waitcnt lgkmcnt(10)
    v_mfma_f32_16x16x32_bf16 v[144:147], v[40:43], v[192:195], v[144:147]
    ds_read_b64_tr_b16 v[36:37], v4 offset:0
    v_mfma_f32_16x16x32_bf16 v[148:151], v[40:43], v[196:199], v[148:151]
    ds_read_b64_tr_b16 v[38:39], v4 offset:1024
    v_mfma_f32_16x16x32_bf16 v[152:155], v[44:47], v[192:195], v[152:155]
    ds_read_b64_tr_b16 v[40:41], v5 offset:0
    v_mfma_f32_16x16x32_bf16 v[156:159], v[44:47], v[196:199], v[156:159]
    ds_read_b64_tr_b16 v[42:43], v5 offset:1024
    s_waitcnt vmcnt(8) lgkmcnt(10)
    v_mfma_f32_16x16x32_bf16 v[64:67], v[48:51], v[200:203], v[64:67]
    ds_read_b64_tr_b16 v[44:45], v6 offset:0
    v_mfma_f32_16x16x32_bf16 v[68:71], v[48:51], v[204:207], v[68:71]
    ds_read_b64_tr_b16 v[46:47], v6 offset:1024
    v_mfma_f32_16x16x32_bf16 v[72:75], v[52:55], v[200:203], v[72:75]
    ds_read_b64_tr_b16 v[48:49], v3 offset:4096
    v_mfma_f32_16x16x32_bf16 v[76:79], v[52:55], v[204:207], v[76:79]
    ds_read_b64_tr_b16 v[50:51], v3 offset:5120
    s_waitcnt lgkmcnt(10)
    v_mfma_f32_16x16x32_bf16 v[80:83], v[56:59], v[200:203], v[80:83]
    ds_read_b64_tr_b16 v[52:53], v4 offset:4096
    v_mfma_f32_16x16x32_bf16 v[84:87], v[56:59], v[204:207], v[84:87]
    ds_read_b64_tr_b16 v[54:55], v4 offset:5120
    v_mfma_f32_16x16x32_bf16 v[88:91], v[60:63], v[200:203], v[88:91]
    ds_read_b64_tr_b16 v[56:57], v5 offset:4096
    v_mfma_f32_16x16x32_bf16 v[92:95], v[60:63], v[204:207], v[92:95]
    ds_read_b64_tr_b16 v[58:59], v5 offset:5120
    s_waitcnt lgkmcnt(10)
    v_mfma_f32_16x16x32_bf16 v[96:99], v[200:203], v[32:35], v[96:99]
    ds_read_b64_tr_b16 v[60:61], v6 offset:4096
    v_mfma_f32_16x16x32_bf16 v[100:103], v[204:207], v[32:35], v[100:103]
    ds_read_b64_tr_b16 v[62:63], v6 offset:5120
    v_mfma_f32_16x16x32_bf16 v[104:107], v[200:203], v[36:39], v[104:107]
    ds_read_b64_tr_b16 v[32:33], v3 offset:8192
    v_mfma_f32_16x16x32_bf16 v[108:111], v[204:207], v[36:39], v[108:111]
    ds_read_b64_tr_b16 v[34:35], v3 offset:9216
    s_waitcnt lgkmcnt(10)
    v_mfma_f32_16x16x32_bf16 v[112:115], v[200:203], v[40:43], v[112:115]
    ds_read_b64_tr_b16 v[36:37], v4 offset:8192
    v_mfma_f32_16x16x32_bf16 v[116:119], v[204:207], v[40:43], v[116:119]
    ds_read_b64_tr_b16 v[38:39], v4 offset:9216
    v_mfma_f32_16x16x32_bf16 v[120:123], v[200:203], v[44:47], v[120:123]
    ds_read_b64_tr_b16 v[40:41], v5 offset:8192
    v_mfma_f32_16x16x32_bf16 v[124:127], v[204:207], v[44:47], v[124:127]
    ds_read_b64_tr_b16 v[42:43], v5 offset:9216
    s_waitcnt lgkmcnt(10)
    v_mfma_f32_16x16x32_bf16 v[128:131], v[48:51], v[200:203], v[128:131]
    ds_read_b64_tr_b16 v[44:45], v6 offset:8192
    v_mfma_f32_16x16x32_bf16 v[132:135], v[48:51], v[204:207], v[132:135]
    ds_read_b64_tr_b16 v[46:47], v6 offset:9216
    v_mfma_f32_16x16x32_bf16 v[136:139], v[52:55], v[200:203], v[136:139]
    ds_read_b64_tr_b16 v[48:49], v3 offset:12288
    v_mfma_f32_16x16x32_bf16 v[140:143], v[52:55], v[204:207], v[140:143]
    ds_read_b64_tr_b16 v[50:51], v3 offset:13312
    s_waitcnt lgkmcnt(10)
    v_mfma_f32_16x16x32_bf16 v[144:147], v[56:59], v[200:203], v[144:147]
    ds_read_b64_tr_b16 v[52:53], v4 offset:12288
    v_mfma_f32_16x16x32_bf16 v[148:151], v[56:59], v[204:207], v[148:151]
    ds_read_b64_tr_b16 v[54:55], v4 offset:13312
    v_mfma_f32_16x16x32_bf16 v[152:155], v[60:63], v[200:203], v[152:155]
    ds_read_b64_tr_b16 v[56:57], v5 offset:12288
    v_mfma_f32_16x16x32_bf16 v[156:159], v[60:63], v[204:207], v[156:159]
    ds_read_b64_tr_b16 v[58:59], v5 offset:13312
    s_waitcnt vmcnt(6) lgkmcnt(10)
    v_mfma_f32_16x16x32_bf16 v[64:67], v[32:35], v[208:211], v[64:67]
    ds_read_b64_tr_b16 v[60:61], v6 offset:12288
    v_mfma_f32_16x16x32_bf16 v[68:71], v[32:35], v[212:215], v[68:71]
    ds_read_b64_tr_b16 v[62:63], v6 offset:13312
    v_mfma_f32_16x16x32_bf16 v[72:75], v[36:39], v[208:211], v[72:75]
    ds_read_b64_tr_b16 v[32:33], v3 offset:16384
    v_mfma_f32_16x16x32_bf16 v[76:79], v[36:39], v[212:215], v[76:79]
    ds_read_b64_tr_b16 v[34:35], v3 offset:17408
    s_waitcnt lgkmcnt(10)
    v_mfma_f32_16x16x32_bf16 v[80:83], v[40:43], v[208:211], v[80:83]
    ds_read_b64_tr_b16 v[36:37], v4 offset:16384
    v_mfma_f32_16x16x32_bf16 v[84:87], v[40:43], v[212:215], v[84:87]
    ds_read_b64_tr_b16 v[38:39], v4 offset:17408
    v_mfma_f32_16x16x32_bf16 v[88:91], v[44:47], v[208:211], v[88:91]
    ds_read_b64_tr_b16 v[40:41], v5 offset:16384
    v_mfma_f32_16x16x32_bf16 v[92:95], v[44:47], v[212:215], v[92:95]
    ds_read_b64_tr_b16 v[42:43], v5 offset:17408
    s_waitcnt lgkmcnt(10)
    v_mfma_f32_16x16x32_bf16 v[96:99], v[208:211], v[48:51], v[96:99]
    buffer_load_dwordx4 v[240:243], v2, s[4:7], s42 offen offset:0 sc1
    ds_read_b64_tr_b16 v[44:45], v6 offset:16384
    v_mfma_f32_16x16x32_bf16 v[100:103], v[212:215], v[48:51], v[100:103]
    ds_read_b64_tr_b16 v[46:47], v6 offset:17408
    v_mfma_f32_16x16x32_bf16 v[104:107], v[208:211], v[52:55], v[104:107]
    buffer_load_dwordx4 v[244:247], v2, s[4:7], s42 offen offset:256 sc1
    ds_read_b64_tr_b16 v[48:49], v3 offset:20480
    v_mfma_f32_16x16x32_bf16 v[108:111], v[212:215], v[52:55], v[108:111]
    ds_read_b64_tr_b16 v[50:51], v3 offset:21504
    s_waitcnt lgkmcnt(10)
    v_mfma_f32_16x16x32_bf16 v[112:115], v[208:211], v[56:59], v[112:115]
    buffer_load_dwordx4 v[248:251], v2, s[4:7], s42 offen offset:2048 sc1
    ds_read_b64_tr_b16 v[52:53], v4 offset:20480
    v_mfma_f32_16x16x32_bf16 v[116:119], v[212:215], v[56:59], v[116:119]
    ds_read_b64_tr_b16 v[54:55], v4 offset:21504
    v_mfma_f32_16x16x32_bf16 v[120:123], v[208:211], v[60:63], v[120:123]
    buffer_load_dwordx4 v[252:255], v2, s[4:7], s42 offen offset:2304 sc1
    ds_read_b64_tr_b16 v[56:57], v5 offset:20480
    s_add_u32 s42, s41, s90
    v_mfma_f32_16x16x32_bf16 v[124:127], v[212:215], v[60:63], v[124:127]
    ds_read_b64_tr_b16 v[58:59], v5 offset:21504
    s_waitcnt lgkmcnt(10)
    v_mfma_f32_16x16x32_bf16 v[128:131], v[32:35], v[208:211], v[128:131]
    ds_read_b64_tr_b16 v[60:61], v6 offset:20480
    buffer_load_dwordx4 v[160:163], v2, s[4:7], s42 offen offset:0 sc1
    v_mfma_f32_16x16x32_bf16 v[132:135], v[32:35], v[212:215], v[132:135]
    ds_read_b64_tr_b16 v[62:63], v6 offset:21504
    v_mfma_f32_16x16x32_bf16 v[136:139], v[36:39], v[208:211], v[136:139]
    buffer_load_dwordx4 v[164:167], v2, s[4:7], s42 offen offset:256 sc1
    ds_read_b64_tr_b16 v[32:33], v3 offset:24576
    v_mfma_f32_16x16x32_bf16 v[140:143], v[36:39], v[212:215], v[140:143]
    ds_read_b64_tr_b16 v[34:35], v3 offset:25600
    s_waitcnt lgkmcnt(10)
    v_mfma_f32_16x16x32_bf16 v[144:147], v[40:43], v[208:211], v[144:147]
    buffer_load_dwordx4 v[168:171], v2, s[4:7], s42 offen offset:2048 sc1
    ds_read_b64_tr_b16 v[36:37], v4 offset:24576
    v_mfma_f32_16x16x32_bf16 v[148:151], v[40:43], v[212:215], v[148:151]
    ds_read_b64_tr_b16 v[38:39], v4 offset:25600
    v_mfma_f32_16x16x32_bf16 v[152:155], v[44:47], v[208:211], v[152:155]
    buffer_load_dwordx4 v[172:175], v2, s[4:7], s42 offen offset:2304 sc1
    ds_read_b64_tr_b16 v[40:41], v5 offset:24576
    s_add_u32 s42, s41, s91
    v_mfma_f32_16x16x32_bf16 v[156:159], v[44:47], v[212:215], v[156:159]
    ds_read_b64_tr_b16 v[42:43], v5 offset:25600
    s_waitcnt vmcnt(12) lgkmcnt(10)
    v_mfma_f32_16x16x32_bf16 v[64:67], v[48:51], v[216:219], v[64:67]
    buffer_load_dwordx4 v[176:179], v2, s[4:7], s42 offen offset:0 sc1
    ds_read_b64_tr_b16 v[44:45], v6 offset:24576
    v_mfma_f32_16x16x32_bf16 v[68:71], v[48:51], v[220:223], v[68:71]
    ds_read_b64_tr_b16 v[46:47], v6 offset:25600
    v_mfma_f32_16x16x32_bf16 v[72:75], v[52:55], v[216:219], v[72:75]
    buffer_load_dwordx4 v[180:183], v2, s[4:7], s42 offen offset:256 sc1
    ds_read_b64_tr_b16 v[48:49], v3 offset:28672
    v_mfma_f32_16x16x32_bf16 v[76:79], v[52:55], v[220:223], v[76:79]
    ds_read_b64_tr_b16 v[50:51], v3 offset:29696
    s_waitcnt lgkmcnt(10)
    v_mfma_f32_16x16x32_bf16 v[80:83], v[56:59], v[216:219], v[80:83]
    buffer_load_dwordx4 v[184:187], v2, s[4:7], s42 offen offset:2048 sc1
    ds_read_b64_tr_b16 v[52:53], v4 offset:28672
    v_mfma_f32_16x16x32_bf16 v[84:87], v[56:59], v[220:223], v[84:87]
    ds_read_b64_tr_b16 v[54:55], v4 offset:29696
    v_mfma_f32_16x16x32_bf16 v[88:91], v[60:63], v[216:219], v[88:91]
    buffer_load_dwordx4 v[188:191], v2, s[4:7], s42 offen offset:2304 sc1
    ds_read_b64_tr_b16 v[56:57], v5 offset:28672
    s_add_u32 s42, s41, s92
    v_mfma_f32_16x16x32_bf16 v[92:95], v[60:63], v[220:223], v[92:95]
    ds_read_b64_tr_b16 v[58:59], v5 offset:29696
    s_waitcnt lgkmcnt(10)
    v_mfma_f32_16x16x32_bf16 v[96:99], v[216:219], v[32:35], v[96:99]
    ds_read_b64_tr_b16 v[60:61], v6 offset:28672
    v_mfma_f32_16x16x32_bf16 v[100:103], v[220:223], v[32:35], v[100:103]
    ds_read_b64_tr_b16 v[62:63], v6 offset:29696
    s_barrier
    v_mfma_f32_16x16x32_bf16 v[104:107], v[216:219], v[36:39], v[104:107]
    ds_read_b64_tr_b16 v[32:33], v3 offset:32768
    v_mfma_f32_16x16x32_bf16 v[108:111], v[220:223], v[36:39], v[108:111]
    ds_read_b64_tr_b16 v[34:35], v3 offset:33792
    s_waitcnt lgkmcnt(10)
    v_mfma_f32_16x16x32_bf16 v[112:115], v[216:219], v[40:43], v[112:115]
    ds_read_b64_tr_b16 v[36:37], v4 offset:32768
    v_mfma_f32_16x16x32_bf16 v[116:119], v[220:223], v[40:43], v[116:119]
    ds_read_b64_tr_b16 v[38:39], v4 offset:33792
    v_mfma_f32_16x16x32_bf16 v[120:123], v[216:219], v[44:47], v[120:123]
    ds_read_b64_tr_b16 v[40:41], v5 offset:32768
    v_mfma_f32_16x16x32_bf16 v[124:127], v[220:223], v[44:47], v[124:127]
    ds_read_b64_tr_b16 v[42:43], v5 offset:33792
    s_waitcnt lgkmcnt(10)
    v_mfma_f32_16x16x32_bf16 v[128:131], v[48:51], v[216:219], v[128:131]
    ds_read_b64_tr_b16 v[44:45], v6 offset:32768
    v_mfma_f32_16x16x32_bf16 v[132:135], v[48:51], v[220:223], v[132:135]
    ds_read_b64_tr_b16 v[46:47], v6 offset:33792
    v_mfma_f32_16x16x32_bf16 v[136:139], v[52:55], v[216:219], v[136:139]
    ds_read_b64_tr_b16 v[48:49], v3 offset:36864
    v_mfma_f32_16x16x32_bf16 v[140:143], v[52:55], v[220:223], v[140:143]
    ds_read_b64_tr_b16 v[50:51], v3 offset:37888
    s_waitcnt lgkmcnt(10)
    v_mfma_f32_16x16x32_bf16 v[144:147], v[56:59], v[216:219], v[144:147]
    ds_read_b64_tr_b16 v[52:53], v4 offset:36864
    v_mfma_f32_16x16x32_bf16 v[148:151], v[56:59], v[220:223], v[148:151]
    ds_read_b64_tr_b16 v[54:55], v4 offset:37888
    v_mfma_f32_16x16x32_bf16 v[152:155], v[60:63], v[216:219], v[152:155]
    ds_read_b64_tr_b16 v[56:57], v5 offset:36864
    v_mfma_f32_16x16x32_bf16 v[156:159], v[60:63], v[220:223], v[156:159]
    ds_read_b64_tr_b16 v[58:59], v5 offset:37888
    s_waitcnt vmcnt(14) lgkmcnt(10)
    v_mfma_f32_16x16x32_bf16 v[64:67], v[32:35], v[224:227], v[64:67]
    ds_read_b64_tr_b16 v[60:61], v6 offset:36864
    v_mfma_f32_16x16x32_bf16 v[68:71], v[32:35], v[228:231], v[68:71]
    ds_read_b64_tr_b16 v[62:63], v6 offset:37888
    v_mfma_f32_16x16x32_bf16 v[72:75], v[36:39], v[224:227], v[72:75]
    ds_read_b64_tr_b16 v[32:33], v3 offset:40960
    v_mfma_f32_16x16x32_bf16 v[76:79], v[36:39], v[228:231], v[76:79]
    ds_read_b64_tr_b16 v[34:35], v3 offset:41984
    s_waitcnt lgkmcnt(10)
    v_mfma_f32_16x16x32_bf16 v[80:83], v[40:43], v[224:227], v[80:83]
    ds_read_b64_tr_b16 v[36:37], v4 offset:40960
    v_mfma_f32_16x16x32_bf16 v[84:87], v[40:43], v[228:231], v[84:87]
    ds_read_b64_tr_b16 v[38:39], v4 offset:41984
    v_mfma_f32_16x16x32_bf16 v[88:91], v[44:47], v[224:227], v[88:91]
    ds_read_b64_tr_b16 v[40:41], v5 offset:40960
    v_mfma_f32_16x16x32_bf16 v[92:95], v[44:47], v[228:231], v[92:95]
    ds_read_b64_tr_b16 v[42:43], v5 offset:41984
    s_waitcnt lgkmcnt(10)
    v_mfma_f32_16x16x32_bf16 v[96:99], v[224:227], v[48:51], v[96:99]
    ds_read_b64_tr_b16 v[44:45], v6 offset:40960
    v_mfma_f32_16x16x32_bf16 v[100:103], v[228:231], v[48:51], v[100:103]
    ds_read_b64_tr_b16 v[46:47], v6 offset:41984
    v_mfma_f32_16x16x32_bf16 v[104:107], v[224:227], v[52:55], v[104:107]
    ds_read_b64_tr_b16 v[48:49], v3 offset:45056
    v_mfma_f32_16x16x32_bf16 v[108:111], v[228:231], v[52:55], v[108:111]
    ds_read_b64_tr_b16 v[50:51], v3 offset:46080
    s_waitcnt lgkmcnt(10)
    v_mfma_f32_16x16x32_bf16 v[112:115], v[224:227], v[56:59], v[112:115]
    ds_read_b64_tr_b16 v[52:53], v4 offset:45056
    v_mfma_f32_16x16x32_bf16 v[116:119], v[228:231], v[56:59], v[116:119]
    ds_read_b64_tr_b16 v[54:55], v4 offset:46080
    v_mfma_f32_16x16x32_bf16 v[120:123], v[224:227], v[60:63], v[120:123]
    ds_read_b64_tr_b16 v[56:57], v5 offset:45056
    v_mfma_f32_16x16x32_bf16 v[124:127], v[228:231], v[60:63], v[124:127]
    ds_read_b64_tr_b16 v[58:59], v5 offset:46080
    s_waitcnt lgkmcnt(10)
    v_mfma_f32_16x16x32_bf16 v[128:131], v[32:35], v[224:227], v[128:131]
    ds_read_b64_tr_b16 v[60:61], v6 offset:45056
    v_mfma_f32_16x16x32_bf16 v[132:135], v[32:35], v[228:231], v[132:135]
    ds_read_b64_tr_b16 v[62:63], v6 offset:46080
    v_mfma_f32_16x16x32_bf16 v[136:139], v[36:39], v[224:227], v[136:139]
    ds_read_b64_tr_b16 v[32:33], v3 offset:49152
    v_mfma_f32_16x16x32_bf16 v[140:143], v[36:39], v[228:231], v[140:143]
    ds_read_b64_tr_b16 v[34:35], v3 offset:50176
    s_waitcnt lgkmcnt(10)
    v_mfma_f32_16x16x32_bf16 v[144:147], v[40:43], v[224:227], v[144:147]
    ds_read_b64_tr_b16 v[36:37], v4 offset:49152
    v_mfma_f32_16x16x32_bf16 v[148:151], v[40:43], v[228:231], v[148:151]
    ds_read_b64_tr_b16 v[38:39], v4 offset:50176
    v_mfma_f32_16x16x32_bf16 v[152:155], v[44:47], v[224:227], v[152:155]
    ds_read_b64_tr_b16 v[40:41], v5 offset:49152
    v_mfma_f32_16x16x32_bf16 v[156:159], v[44:47], v[228:231], v[156:159]
    ds_read_b64_tr_b16 v[42:43], v5 offset:50176
    s_waitcnt vmcnt(12) lgkmcnt(10)
    v_mfma_f32_16x16x32_bf16 v[64:67], v[48:51], v[232:235], v[64:67]
    buffer_load_dwordx4 v[192:195], v2, s[4:7], s42 offen offset:0 sc1
    ds_read_b64_tr_b16 v[44:45], v6 offset:49152
    v_mfma_f32_16x16x32_bf16 v[68:71], v[48:51], v[236:239], v[68:71]
    ds_read_b64_tr_b16 v[46:47], v6 offset:50176
    v_mfma_f32_16x16x32_bf16 v[72:75], v[52:55], v[232:235], v[72:75]
    buffer_load_dwordx4 v[196:199], v2, s[4:7], s42 offen offset:256 sc1
    ds_read_b64_tr_b16 v[48:49], v3 offset:53248
    v_mfma_f32_16x16x32_bf16 v[76:79], v[52:55], v[236:239], v[76:79]
    ds_read_b64_tr_b16 v[50:51], v3 offset:54272
    s_waitcnt lgkmcnt(10)
    v_mfma_f32_16x16x32_bf16 v[80:83], v[56:59], v[232:235], v[80:83]
    buffer_load_dwordx4 v[200:203], v2, s[4:7], s42 offen offset:2048 sc1
    ds_read_b64_tr_b16 v[52:53], v4 offset:53248
    v_mfma_f32_16x16x32_bf16 v[84:87], v[56:59], v[236:239], v[84:87]
    ds_read_b64_tr_b16 v[54:55], v4 offset:54272
    v_mfma_f32_16x16x32_bf16 v[88:91], v[60:63], v[232:235], v[88:91]
    buffer_load_dwordx4 v[204:207], v2, s[4:7], s42 offen offset:2304 sc1
    ds_read_b64_tr_b16 v[56:57], v5 offset:53248
    s_add_u32 s42, s41, s93
    v_mfma_f32_16x16x32_bf16 v[92:95], v[60:63], v[236:239], v[92:95]
    ds_read_b64_tr_b16 v[58:59], v5 offset:54272
    s_waitcnt lgkmcnt(10)
    v_mfma_f32_16x16x32_bf16 v[96:99], v[232:235], v[32:35], v[96:99]
    ds_read_b64_tr_b16 v[60:61], v6 offset:53248
    buffer_load_dwordx4 v[208:211], v2, s[4:7], s42 offen offset:0 sc1
    v_mfma_f32_16x16x32_bf16 v[100:103], v[236:239], v[32:35], v[100:103]
    ds_read_b64_tr_b16 v[62:63], v6 offset:54272
    v_mfma_f32_16x16x32_bf16 v[104:107], v[232:235], v[36:39], v[104:107]
    ds_read_b64_tr_b16 v[32:33], v3 offset:57344
    v_mfma_f32_16x16x32_bf16 v[108:111], v[236:239], v[36:39], v[108:111]
    ds_read_b64_tr_b16 v[34:35], v3 offset:58368
    s_waitcnt lgkmcnt(10)
    v_mfma_f32_16x16x32_bf16 v[112:115], v[232:235], v[40:43], v[112:115]
    ds_read_b64_tr_b16 v[36:37], v4 offset:57344
    v_mfma_f32_16x16x32_bf16 v[116:119], v[236:239], v[40:43], v[116:119]
    ds_read_b64_tr_b16 v[38:39], v4 offset:58368
    v_mfma_f32_16x16x32_bf16 v[120:123], v[232:235], v[44:47], v[120:123]
    buffer_load_dwordx4 v[212:215], v2, s[4:7], s42 offen offset:256 sc1
    ds_read_b64_tr_b16 v[40:41], v5 offset:57344
    v_mfma_f32_16x16x32_bf16 v[124:127], v[236:239], v[44:47], v[124:127]
    ds_read_b64_tr_b16 v[42:43], v5 offset:58368
    s_waitcnt lgkmcnt(10)
    v_mfma_f32_16x16x32_bf16 v[128:131], v[48:51], v[232:235], v[128:131]
    ds_read_b64_tr_b16 v[44:45], v6 offset:57344
    v_mfma_f32_16x16x32_bf16 v[132:135], v[48:51], v[236:239], v[132:135]
    ds_read_b64_tr_b16 v[46:47], v6 offset:58368
    v_mfma_f32_16x16x32_bf16 v[136:139], v[52:55], v[232:235], v[136:139]
    ds_read_b64_tr_b16 v[48:49], v3 offset:61440
    v_mfma_f32_16x16x32_bf16 v[140:143], v[52:55], v[236:239], v[140:143]
    ds_read_b64_tr_b16 v[50:51], v3 offset:62464
    s_waitcnt lgkmcnt(10)
    v_mfma_f32_16x16x32_bf16 v[144:147], v[56:59], v[232:235], v[144:147]
    ds_read_b64_tr_b16 v[52:53], v4 offset:61440
    v_mfma_f32_16x16x32_bf16 v[148:151], v[56:59], v[236:239], v[148:151]
    ds_read_b64_tr_b16 v[54:55], v4 offset:62464
    v_mfma_f32_16x16x32_bf16 v[152:155], v[60:63], v[232:235], v[152:155]
    ds_read_b64_tr_b16 v[56:57], v5 offset:61440
    v_mfma_f32_16x16x32_bf16 v[156:159], v[60:63], v[236:239], v[156:159]
    ds_read_b64_tr_b16 v[58:59], v5 offset:62464
    s_waitcnt vmcnt(16) lgkmcnt(10)
    v_mfma_f32_16x16x32_bf16 v[64:67], v[32:35], v[240:243], v[64:67]
    ds_read_b64_tr_b16 v[60:61], v6 offset:61440
    v_mfma_f32_16x16x32_bf16 v[68:71], v[32:35], v[244:247], v[68:71]
    ds_read_b64_tr_b16 v[62:63], v6 offset:62464
    s_barrier
    v_xor_b32 v3, 0x10000, v3
    v_xor_b32 v4, 0x10000, v4
    v_xor_b32 v5, 0x10000, v5
    v_xor_b32 v6, 0x10000, v6
    v_mfma_f32_16x16x32_bf16 v[72:75], v[36:39], v[240:243], v[72:75]
    ds_read_b64_tr_b16 v[32:33], v3 offset:0
    v_mfma_f32_16x16x32_bf16 v[76:79], v[36:39], v[244:247], v[76:79]
    ds_read_b64_tr_b16 v[34:35], v3 offset:1024
    s_waitcnt lgkmcnt(10)
    v_mfma_f32_16x16x32_bf16 v[80:83], v[40:43], v[240:243], v[80:83]
    ds_read_b64_tr_b16 v[36:37], v4 offset:0
    v_mfma_f32_16x16x32_bf16 v[84:87], v[40:43], v[244:247], v[84:87]
    ds_read_b64_tr_b16 v[38:39], v4 offset:1024
    v_mfma_f32_16x16x32_bf16 v[88:91], v[44:47], v[240:243], v[88:91]
    ds_read_b64_tr_b16 v[40:41], v5 offset:0
    v_mfma_f32_16x16x32_bf16 v[92:95], v[44:47], v[244:247], v[92:95]
    ds_read_b64_tr_b16 v[42:43], v5 offset:1024
    s_waitcnt lgkmcnt(10)
    v_mfma_f32_16x16x32_bf16 v[96:99], v[240:243], v[48:51], v[96:99]
    ds_read_b64_tr_b16 v[44:45], v6 offset:0
    v_mfma_f32_16x16x32_bf16 v[100:103], v[244:247], v[48:51], v[100:103]
    ds_read_b64_tr_b16 v[46:47], v6 offset:1024
    v_mfma_f32_16x16x32_bf16 v[104:107], v[240:243], v[52:55], v[104:107]
    ds_read_b64_tr_b16 v[48:49], v3 offset:4096
    v_mfma_f32_16x16x32_bf16 v[108:111], v[244:247], v[52:55], v[108:111]
    ds_read_b64_tr_b16 v[50:51], v3 offset:5120
    s_waitcnt lgkmcnt(10)
    v_mfma_f32_16x16x32_bf16 v[112:115], v[240:243], v[56:59], v[112:115]
    ds_read_b64_tr_b16 v[52:53], v4 offset:4096
    v_mfma_f32_16x16x32_bf16 v[116:119], v[244:247], v[56:59], v[116:119]
    ds_read_b64_tr_b16 v[54:55], v4 offset:5120
    v_mfma_f32_16x16x32_bf16 v[120:123], v[240:243], v[60:63], v[120:123]
    ds_read_b64_tr_b16 v[56:57], v5 offset:4096
    v_mfma_f32_16x16x32_bf16 v[124:127], v[244:247], v[60:63], v[124:127]
    ds_read_b64_tr_b16 v[58:59], v5 offset:5120
    s_waitcnt lgkmcnt(10)
    v_mfma_f32_16x16x32_bf16 v[128:131], v[32:35], v[240:243], v[128:131]
    ds_read_b64_tr_b16 v[60:61], v6 offset:4096
    v_mfma_f32_16x16x32_bf16 v[132:135], v[32:35], v[244:247], v[132:135]
    ds_read_b64_tr_b16 v[62:63], v6 offset:5120
    v_mfma_f32_16x16x32_bf16 v[136:139], v[36:39], v[240:243], v[136:139]
    ds_read_b64_tr_b16 v[32:33], v3 offset:8192
    v_mfma_f32_16x16x32_bf16 v[140:143], v[36:39], v[244:247], v[140:143]
    ds_read_b64_tr_b16 v[34:35], v3 offset:9216
    s_waitcnt lgkmcnt(10)
    v_mfma_f32_16x16x32_bf16 v[144:147], v[40:43], v[240:243], v[144:147]
    ds_read_b64_tr_b16 v[36:37], v4 offset:8192
    v_mfma_f32_16x16x32_bf16 v[148:151], v[40:43], v[244:247], v[148:151]
    ds_read_b64_tr_b16 v[38:39], v4 offset:9216
    v_mfma_f32_16x16x32_bf16 v[152:155], v[44:47], v[240:243], v[152:155]
    ds_read_b64_tr_b16 v[40:41], v5 offset:8192
    v_mfma_f32_16x16x32_bf16 v[156:159], v[44:47], v[244:247], v[156:159]
    ds_read_b64_tr_b16 v[42:43], v5 offset:9216
    s_waitcnt vmcnt(14) lgkmcnt(10)
    v_mfma_f32_16x16x32_bf16 v[64:67], v[48:51], v[248:251], v[64:67]
    ds_read_b64_tr_b16 v[44:45], v6 offset:8192
    v_mfma_f32_16x16x32_bf16 v[68:71], v[48:51], v[252:255], v[68:71]
    ds_read_b64_tr_b16 v[46:47], v6 offset:9216
    v_mfma_f32_16x16x32_bf16 v[72:75], v[52:55], v[248:251], v[72:75]
    ds_read_b64_tr_b16 v[48:49], v3 offset:12288
    v_mfma_f32_16x16x32_bf16 v[76:79], v[52:55], v[252:255], v[76:79]
    ds_read_b64_tr_b16 v[50:51], v3 offset:13312
    s_waitcnt lgkmcnt(10)
    v_mfma_f32_16x16x32_bf16 v[80:83], v[56:59], v[248:251], v[80:83]
    ds_read_b64_tr_b16 v[52:53], v4 offset:12288
    v_mfma_f32_16x16x32_bf16 v[84:87], v[56:59], v[252:255], v[84:87]
    ds_read_b64_tr_b16 v[54:55], v4 offset:13312
    v_mfma_f32_16x16x32_bf16 v[88:91], v[60:63], v[248:251], v[88:91]
    ds_read_b64_tr_b16 v[56:57], v5 offset:12288
    v_mfma_f32_16x16x32_bf16 v[92:95], v[60:63], v[252:255], v[92:95]
    ds_read_b64_tr_b16 v[58:59], v5 offset:13312
    s_waitcnt lgkmcnt(10)
    v_mfma_f32_16x16x32_bf16 v[96:99], v[248:251], v[32:35], v[96:99]
    ds_read_b64_tr_b16 v[60:61], v6 offset:12288
    v_mfma_f32_16x16x32_bf16 v[100:103], v[252:255], v[32:35], v[100:103]
    ds_read_b64_tr_b16 v[62:63], v6 offset:13312
    v_mfma_f32_16x16x32_bf16 v[104:107], v[248:251], v[36:39], v[104:107]
    ds_read_b64_tr_b16 v[32:33], v3 offset:16384
    v_mfma_f32_16x16x32_bf16 v[108:111], v[252:255], v[36:39], v[108:111]
    ds_read_b64_tr_b16 v[34:35], v3 offset:17408
    s_waitcnt lgkmcnt(10)
    v_mfma_f32_16x16x32_bf16 v[112:115], v[248:251], v[40:43], v[112:115]
    ds_read_b64_tr_b16 v[36:37], v4 offset:16384
    v_mfma_f32_16x16x32_bf16 v[116:119], v[252:255], v[40:43], v[116:119]
    ds_read_b64_tr_b16 v[38:39], v4 offset:17408
    v_mfma_f32_16x16x32_bf16 v[120:123], v[248:251], v[44:47], v[120:123]
    ds_read_b64_tr_b16 v[40:41], v5 offset:16384
    v_mfma_f32_16x16x32_bf16 v[124:127], v[252:255], v[44:47], v[124:127]
    ds_read_b64_tr_b16 v[42:43], v5 offset:17408
    s_waitcnt lgkmcnt(10)
    v_mfma_f32_16x16x32_bf16 v[128:131], v[48:51], v[248:251], v[128:131]
    buffer_load_dwordx4 v[216:219], v2, s[4:7], s42 offen offset:2048 sc1
    ds_read_b64_tr_b16 v[44:45], v6 offset:16384
    v_mfma_f32_16x16x32_bf16 v[132:135], v[48:51], v[252:255], v[132:135]
    ds_read_b64_tr_b16 v[46:47], v6 offset:17408
    v_mfma_f32_16x16x32_bf16 v[136:139], v[52:55], v[248:251], v[136:139]
    buffer_load_dwordx4 v[220:223], v2, s[4:7], s42 offen offset:2304 sc1
    ds_read_b64_tr_b16 v[48:49], v3 offset:20480
    s_add_u32 s42, s41, s94
    v_mfma_f32_16x16x32_bf16 v[140:143], v[52:55], v[252:255], v[140:143]
    ds_read_b64_tr_b16 v[50:51], v3 offset:21504
    s_waitcnt lgkmcnt(10)
    v_mfma_f32_16x16x32_bf16 v[144:147], v[56:59], v[248:251], v[144:147]
    buffer_load_dwordx4 v[224:227], v2, s[4:7], s42 offen offset:0 sc1
    ds_read_b64_tr_b16 v[52:53], v4 offset:20480
    v_mfma_f32_16x16x32_bf16 v[148:151], v[56:59], v[252:255], v[148:151]
    ds_read_b64_tr_b16 v[54:55], v4 offset:21504
    v_mfma_f32_16x16x32_bf16 v[152:155], v[60:63], v[248:251], v[152:155]
    buffer_load_dwordx4 v[228:231], v2, s[4:7], s42 offen offset:256 sc1
    ds_read_b64_tr_b16 v[56:57], v5 offset:20480
    v_mfma_f32_16x16x32_bf16 v[156:159], v[60:63], v[252:255], v[156:159]
    ds_read_b64_tr_b16 v[58:59], v5 offset:21504
    s_waitcnt vmcnt(16) lgkmcnt(10)
    v_mfma_f32_16x16x32_bf16 v[64:67], v[32:35], v[160:163], v[64:67]
    ds_read_b64_tr_b16 v[60:61], v6 offset:20480
    buffer_load_dwordx4 v[232:235], v2, s[4:7], s42 offen offset:2048 sc1
    v_mfma_f32_16x16x32_bf16 v[68:71], v[32:35], v[164:167], v[68:71]
    ds_read_b64_tr_b16 v[62:63], v6 offset:21504
    v_mfma_f32_16x16x32_bf16 v[72:75], v[36:39], v[160:163], v[72:75]
    buffer_load_dwordx4 v[236:239], v2, s[4:7], s42 offen offset:2304 sc1
    ds_read_b64_tr_b16 v[32:33], v3 offset:24576
    s_add_u32 s42, s41, s95
    v_mfma_f32_16x16x32_bf16 v[76:79], v[36:39], v[164:167], v[76:79]
    ds_read_b64_tr_b16 v[34:35], v3 offset:25600
    s_waitcnt lgkmcnt(10)
    v_mfma_f32_16x16x32_bf16 v[80:83], v[40:43], v[160:163], v[80:83]
    ds_read_b64_tr_b16 v[36:37], v4 offset:24576
    v_mfma_f32_16x16x32_bf16 v[84:87], v[40:43], v[164:167], v[84:87]
    ds_read_b64_tr_b16 v[38:39], v4 offset:25600
    v_mfma_f32_16x16x32_bf16 v[88:91], v[44:47], v[160:163], v[88:91]
    ds_read_b64_tr_b16 v[40:41], v5 offset:24576
    v_mfma_f32_16x16x32_bf16 v[92:95], v[44:47], v[164:167], v[92:95]
    ds_read_b64_tr_b16 v[42:43], v5 offset:25600
    s_waitcnt lgkmcnt(10)
    v_mfma_f32_16x16x32_bf16 v[96:99], v[160:163], v[48:51], v[96:99]
    buffer_load_dwordx4 v[240:243], v2, s[4:7], s42 offen offset:0 sc1
    ds_read_b64_tr_b16 v[44:45], v6 offset:24576
    v_mfma_f32_16x16x32_bf16 v[100:103], v[164:167], v[48:51], v[100:103]
    ds_read_b64_tr_b16 v[46:47], v6 offset:25600
    v_mfma_f32_16x16x32_bf16 v[104:107], v[160:163], v[52:55], v[104:107]
    ds_read_b64_tr_b16 v[48:49], v3 offset:28672
    v_mfma_f32_16x16x32_bf16 v[108:111], v[164:167], v[52:55], v[108:111]
    ds_read_b64_tr_b16 v[50:51], v3 offset:29696
    s_waitcnt lgkmcnt(10)
    v_mfma_f32_16x16x32_bf16 v[112:115], v[160:163], v[56:59], v[112:115]
    ds_read_b64_tr_b16 v[52:53], v4 offset:28672
    v_mfma_f32_16x16x32_bf16 v[116:119], v[164:167], v[56:59], v[116:119]
    ds_read_b64_tr_b16 v[54:55], v4 offset:29696
    v_mfma_f32_16x16x32_bf16 v[120:123], v[160:163], v[60:63], v[120:123]
    ds_read_b64_tr_b16 v[56:57], v5 offset:28672
    v_mfma_f32_16x16x32_bf16 v[124:127], v[164:167], v[60:63], v[124:127]
    ds_read_b64_tr_b16 v[58:59], v5 offset:29696
    s_waitcnt lgkmcnt(10)
    v_mfma_f32_16x16x32_bf16 v[128:131], v[32:35], v[160:163], v[128:131]
    ds_read_b64_tr_b16 v[60:61], v6 offset:28672
    v_mfma_f32_16x16x32_bf16 v[132:135], v[32:35], v[164:167], v[132:135]
    ds_read_b64_tr_b16 v[62:63], v6 offset:29696
    s_barrier
    v_mfma_f32_16x16x32_bf16 v[136:139], v[36:39], v[160:163], v[136:139]
    ds_read_b64_tr_b16 v[32:33], v3 offset:32768
    v_mfma_f32_16x16x32_bf16 v[140:143], v[36:39], v[164:167], v[140:143]
    ds_read_b64_tr_b16 v[34:35], v3 offset:33792
    s_waitcnt lgkmcnt(10)
    v_mfma_f32_16x16x32_bf16 v[144:147], v[40:43], v[160:163], v[144:147]
    ds_read_b64_tr_b16 v[36:37], v4 offset:32768
    v_mfma_f32_16x16x32_bf16 v[148:151], v[40:43], v[164:167], v[148:151]
    ds_read_b64_tr_b16 v[38:39], v4 offset:33792
    v_mfma_f32_16x16x32_bf16 v[152:155], v[44:47], v[160:163], v[152:155]
    ds_read_b64_tr_b16 v[40:41], v5 offset:32768
    v_mfma_f32_16x16x32_bf16 v[156:159], v[44:47], v[164:167], v[156:159]
    ds_read_b64_tr_b16 v[42:43], v5 offset:33792
    s_waitcnt vmcnt(17) lgkmcnt(10)
    v_mfma_f32_16x16x32_bf16 v[64:67], v[48:51], v[168:171], v[64:67]
    ds_read_b64_tr_b16 v[44:45], v6 offset:32768
    v_mfma_f32_16x16x32_bf16 v[68:71], v[48:51], v[172:175], v[68:71]
    ds_read_b64_tr_b16 v[46:47], v6 offset:33792
    v_mfma_f32_16x16x32_bf16 v[72:75], v[52:55], v[168:171], v[72:75]
    ds_read_b64_tr_b16 v[48:49], v3 offset:36864
    v_mfma_f32_16x16x32_bf16 v[76:79], v[52:55], v[172:175], v[76:79]
    ds_read_b64_tr_b16 v[50:51], v3 offset:37888
    s_waitcnt lgkmcnt(10)
    v_mfma_f32_16x16x32_bf16 v[80:83], v[56:59], v[168:171], v[80:83]
    ds_read_b64_tr_b16 v[52:53], v4 offset:36864
    v_mfma_f32_16x16x32_bf16 v[84:87], v[56:59], v[172:175], v[84:87]
    ds_read_b64_tr_b16 v[54:55], v4 offset:37888
    v_mfma_f32_16x16x32_bf16 v[88:91], v[60:63], v[168:171], v[88:91]
    ds_read_b64_tr_b16 v[56:57], v5 offset:36864
    v_mfma_f32_16x16x32_bf16 v[92:95], v[60:63], v[172:175], v[92:95]
    ds_read_b64_tr_b16 v[58:59], v5 offset:37888
    s_waitcnt lgkmcnt(10)
    v_mfma_f32_16x16x32_bf16 v[96:99], v[168:171], v[32:35], v[96:99]
    ds_read_b64_tr_b16 v[60:61], v6 offset:36864
    v_mfma_f32_16x16x32_bf16 v[100:103], v[172:175], v[32:35], v[100:103]
    ds_read_b64_tr_b16 v[62:63], v6 offset:37888
    v_mfma_f32_16x16x32_bf16 v[104:107], v[168:171], v[36:39], v[104:107]
    ds_read_b64_tr_b16 v[32:33], v3 offset:40960
    v_mfma_f32_16x16x32_bf16 v[108:111], v[172:175], v[36:39], v[108:111]
    ds_read_b64_tr_b16 v[34:35], v3 offset:41984
    s_waitcnt lgkmcnt(10)
    v_mfma_f32_16x16x32_bf16 v[112:115], v[168:171], v[40:43], v[112:115]
    ds_read_b64_tr_b16 v[36:37], v4 offset:40960
    v_mfma_f32_16x16x32_bf16 v[116:119], v[172:175], v[40:43], v[116:119]
    ds_read_b64_tr_b16 v[38:39], v4 offset:41984
    v_mfma_f32_16x16x32_bf16 v[120:123], v[168:171], v[44:47], v[120:123]
    ds_read_b64_tr_b16 v[40:41], v5 offset:40960
    v_mfma_f32_16x16x32_bf16 v[124:127], v[172:175], v[44:47], v[124:127]
    ds_read_b64_tr_b16 v[42:43], v5 offset:41984
    s_waitcnt lgkmcnt(10)
    v_mfma_f32_16x16x32_bf16 v[128:131], v[48:51], v[168:171], v[128:131]
    ds_read_b64_tr_b16 v[44:45], v6 offset:40960
    v_mfma_f32_16x16x32_bf16 v[132:135], v[48:51], v[172:175], v[132:135]
    ds_read_b64_tr_b16 v[46:47], v6 offset:41984
    v_mfma_f32_16x16x32_bf16 v[136:139], v[52:55], v[168:171], v[136:139]
    ds_read_b64_tr_b16 v[48:49], v3 offset:45056
    v_mfma_f32_16x16x32_bf16 v[140:143], v[52:55], v[172:175], v[140:143]
    ds_read_b64_tr_b16 v[50:51], v3 offset:46080
    s_waitcnt lgkmcnt(10)
    v_mfma_f32_16x16x32_bf16 v[144:147], v[56:59], v[168:171], v[144:147]
    ds_read_b64_tr_b16 v[52:53], v4 offset:45056
    v_mfma_f32_16x16x32_bf16 v[148:151], v[56:59], v[172:175], v[148:151]
    ds_read_b64_tr_b16 v[54:55], v4 offset:46080
    v_mfma_f32_16x16x32_bf16 v[152:155], v[60:63], v[168:171], v[152:155]
    ds_read_b64_tr_b16 v[56:57], v5 offset:45056
    v_mfma_f32_16x16x32_bf16 v[156:159], v[60:63], v[172:175], v[156:159]
    ds_read_b64_tr_b16 v[58:59], v5 offset:46080
    s_waitcnt vmcnt(15) lgkmcnt(10)
    v_mfma_f32_16x16x32_bf16 v[64:67], v[32:35], v[176:179], v[64:67]
    ds_read_b64_tr_b16 v[60:61], v6 offset:45056
    v_mfma_f32_16x16x32_bf16 v[68:71], v[32:35], v[180:183], v[68:71]
    ds_read_b64_tr_b16 v[62:63], v6 offset:46080
    v_mfma_f32_16x16x32_bf16 v[72:75], v[36:39], v[176:179], v[72:75]
    ds_read_b64_tr_b16 v[32:33], v3 offset:49152
    v_mfma_f32_16x16x32_bf16 v[76:79], v[36:39], v[180:183], v[76:79]
    ds_read_b64_tr_b16 v[34:35], v3 offset:50176
    s_waitcnt lgkmcnt(10)
    v_mfma_f32_16x16x32_bf16 v[80:83], v[40:43], v[176:179], v[80:83]
    ds_read_b64_tr_b16 v[36:37], v4 offset:49152
    v_mfma_f32_16x16x32_bf16 v[84:87], v[40:43], v[180:183], v[84:87]
    ds_read_b64_tr_b16 v[38:39], v4 offset:50176
    v_mfma_f32_16x16x32_bf16 v[88:91], v[44:47], v[176:179], v[88:91]
    ds_read_b64_tr_b16 v[40:41], v5 offset:49152
    v_mfma_f32_16x16x32_bf16 v[92:95], v[44:47], v[180:183], v[92:95]
    ds_read_b64_tr_b16 v[42:43], v5 offset:50176
    s_waitcnt lgkmcnt(10)
    v_mfma_f32_16x16x32_bf16 v[96:99], v[176:179], v[48:51], v[96:99]
    buffer_load_dwordx4 v[244:247], v2, s[4:7], s42 offen offset:256 sc1
    ds_read_b64_tr_b16 v[44:45], v6 offset:49152
    v_mfma_f32_16x16x32_bf16 v[100:103], v[180:183], v[48:51], v[100:103]
    ds_read_b64_tr_b16 v[46:47], v6 offset:50176
    v_mfma_f32_16x16x32_bf16 v[104:107], v[176:179], v[52:55], v[104:107]
    buffer_load_dwordx4 v[248:251], v2, s[4:7], s42 offen offset:2048 sc1
    ds_read_b64_tr_b16 v[48:49], v3 offset:53248
    v_mfma_f32_16x16x32_bf16 v[108:111], v[180:183], v[52:55], v[108:111]
    ds_read_b64_tr_b16 v[50:51], v3 offset:54272
    s_waitcnt lgkmcnt(10)
    v_mfma_f32_16x16x32_bf16 v[112:115], v[176:179], v[56:59], v[112:115]
    buffer_load_dwordx4 v[252:255], v2, s[4:7], s42 offen offset:2304 sc1
    ds_read_b64_tr_b16 v[52:53], v4 offset:53248
    s_add_u32 s42, s41, s96
    v_mfma_f32_16x16x32_bf16 v[116:119], v[180:183], v[56:59], v[116:119]
    ds_read_b64_tr_b16 v[54:55], v4 offset:54272
    v_mfma_f32_16x16x32_bf16 v[120:123], v[176:179], v[60:63], v[120:123]
    buffer_load_dwordx4 v[160:163], v2, s[4:7], s42 offen offset:0 sc1
    ds_read_b64_tr_b16 v[56:57], v5 offset:53248
    v_mfma_f32_16x16x32_bf16 v[124:127], v[180:183], v[60:63], v[124:127]
    ds_read_b64_tr_b16 v[58:59], v5 offset:54272
    s_waitcnt lgkmcnt(10)
    v_mfma_f32_16x16x32_bf16 v[128:131], v[32:35], v[176:179], v[128:131]
    ds_read_b64_tr_b16 v[60:61], v6 offset:53248
    buffer_load_dwordx4 v[164:167], v2, s[4:7], s42 offen offset:256 sc1
    v_mfma_f32_16x16x32_bf16 v[132:135], v[32:35], v[180:183], v[132:135]
    ds_read_b64_tr_b16 v[62:63], v6 offset:54272
    v_mfma_f32_16x16x32_bf16 v[136:139], v[36:39], v[176:179], v[136:139]
    buffer_load_dwordx4 v[168:171], v2, s[4:7], s42 offen offset:2048 sc1
    ds_read_b64_tr_b16 v[32:33], v3 offset:57344
    v_mfma_f32_16x16x32_bf16 v[140:143], v[36:39], v[180:183], v[140:143]
    ds_read_b64_tr_b16 v[34:35], v3 offset:58368
    s_waitcnt lgkmcnt(10)
    v_mfma_f32_16x16x32_bf16 v[144:147], v[40:43], v[176:179], v[144:147]
    ds_read_b64_tr_b16 v[36:37], v4 offset:57344
    v_mfma_f32_16x16x32_bf16 v[148:151], v[40:43], v[180:183], v[148:151]
    ds_read_b64_tr_b16 v[38:39], v4 offset:58368
    v_mfma_f32_16x16x32_bf16 v[152:155], v[44:47], v[176:179], v[152:155]
    ds_read_b64_tr_b16 v[40:41], v5 offset:57344
    v_mfma_f32_16x16x32_bf16 v[156:159], v[44:47], v[180:183], v[156:159]
    ds_read_b64_tr_b16 v[42:43], v5 offset:58368
    s_waitcnt vmcnt(19) lgkmcnt(10)
    v_mfma_f32_16x16x32_bf16 v[64:67], v[48:51], v[184:187], v[64:67]
    ds_read_b64_tr_b16 v[44:45], v6 offset:57344
    v_mfma_f32_16x16x32_bf16 v[68:71], v[48:51], v[188:191], v[68:71]
    ds_read_b64_tr_b16 v[46:47], v6 offset:58368
    v_mfma_f32_16x16x32_bf16 v[72:75], v[52:55], v[184:187], v[72:75]
    ds_read_b64_tr_b16 v[48:49], v3 offset:61440
    v_mfma_f32_16x16x32_bf16 v[76:79], v[52:55], v[188:191], v[76:79]
    ds_read_b64_tr_b16 v[50:51], v3 offset:62464
    s_waitcnt lgkmcnt(10)
    v_mfma_f32_16x16x32_bf16 v[80:83], v[56:59], v[184:187], v[80:83]
    buffer_load_dwordx4 v[172:175], v2, s[4:7], s42 offen offset:2304 sc1
    ds_read_b64_tr_b16 v[52:53], v4 offset:61440
    s_add_u32 s42, s41, s97
    v_mfma_f32_16x16x32_bf16 v[84:87], v[56:59], v[188:191], v[84:87]
    ds_read_b64_tr_b16 v[54:55], v4 offset:62464
    v_mfma_f32_16x16x32_bf16 v[88:91], v[60:63], v[184:187], v[88:91]
    ds_read_b64_tr_b16 v[56:57], v5 offset:61440
    v_mfma_f32_16x16x32_bf16 v[92:95], v[60:63], v[188:191], v[92:95]
    ds_read_b64_tr_b16 v[58:59], v5 offset:62464
    s_waitcnt lgkmcnt(10)
    v_mfma_f32_16x16x32_bf16 v[96:99], v[184:187], v[32:35], v[96:99]
    ds_read_b64_tr_b16 v[60:61], v6 offset:61440
    v_mfma_f32_16x16x32_bf16 v[100:103], v[188:191], v[32:35], v[100:103]
    ds_read_b64_tr_b16 v[62:63], v6 offset:62464
    s_barrier
    v_xor_b32 v3, 0x10000, v3
    v_xor_b32 v4, 0x10000, v4
    v_xor_b32 v5, 0x10000, v5
    v_xor_b32 v6, 0x10000, v6
    v_mfma_f32_16x16x32_bf16 v[104:107], v[184:187], v[36:39], v[104:107]
    ds_read_b64_tr_b16 v[32:33], v3 offset:0
    v_mfma_f32_16x16x32_bf16 v[108:111], v[188:191], v[36:39], v[108:111]
    ds_read_b64_tr_b16 v[34:35], v3 offset:1024
    s_waitcnt lgkmcnt(10)
    v_mfma_f32_16x16x32_bf16 v[112:115], v[184:187], v[40:43], v[112:115]
    ds_read_b64_tr_b16 v[36:37], v4 offset:0
    v_mfma_f32_16x16x32_bf16 v[116:119], v[188:191], v[40:43], v[116:119]
    ds_read_b64_tr_b16 v[38:39], v4 offset:1024
    v_mfma_f32_16x16x32_bf16 v[120:123], v[184:187], v[44:47], v[120:123]
    ds_read_b64_tr_b16 v[40:41], v5 offset:0
    v_mfma_f32_16x16x32_bf16 v[124:127], v[188:191], v[44:47], v[124:127]
    ds_read_b64_tr_b16 v[42:43], v5 offset:1024
    s_waitcnt lgkmcnt(10)
    v_mfma_f32_16x16x32_bf16 v[128:131], v[48:51], v[184:187], v[128:131]
    ds_read_b64_tr_b16 v[44:45], v6 offset:0
    v_mfma_f32_16x16x32_bf16 v[132:135], v[48:51], v[188:191], v[132:135]
    ds_read_b64_tr_b16 v[46:47], v6 offset:1024
    v_mfma_f32_16x16x32_bf16 v[136:139], v[52:55], v[184:187], v[136:139]
    ds_read_b64_tr_b16 v[48:49], v3 offset:4096
    v_mfma_f32_16x16x32_bf16 v[140:143], v[52:55], v[188:191], v[140:143]
    ds_read_b64_tr_b16 v[50:51], v3 offset:5120
    s_waitcnt lgkmcnt(10)
    v_mfma_f32_16x16x32_bf16 v[144:147], v[56:59], v[184:187], v[144:147]
    ds_read_b64_tr_b16 v[52:53], v4 offset:4096
    v_mfma_f32_16x16x32_bf16 v[148:151], v[56:59], v[188:191], v[148:151]
    ds_read_b64_tr_b16 v[54:55], v4 offset:5120
    v_mfma_f32_16x16x32_bf16 v[152:155], v[60:63], v[184:187], v[152:155]
    ds_read_b64_tr_b16 v[56:57], v5 offset:4096
    v_mfma_f32_16x16x32_bf16 v[156:159], v[60:63], v[188:191], v[156:159]
    ds_read_b64_tr_b16 v[58:59], v5 offset:5120
    s_waitcnt vmcnt(18) lgkmcnt(10)
    v_mfma_f32_16x16x32_bf16 v[64:67], v[32:35], v[192:195], v[64:67]
    ds_read_b64_tr_b16 v[60:61], v6 offset:4096
    v_mfma_f32_16x16x32_bf16 v[68:71], v[32:35], v[196:199], v[68:71]
    ds_read_b64_tr_b16 v[62:63], v6 offset:5120
    v_mfma_f32_16x16x32_bf16 v[72:75], v[36:39], v[192:195], v[72:75]
    ds_read_b64_tr_b16 v[32:33], v3 offset:8192
    v_mfma_f32_16x16x32_bf16 v[76:79], v[36:39], v[196:199], v[76:79]
    ds_read_b64_tr_b16 v[34:35], v3 offset:9216
    s_waitcnt lgkmcnt(10)
    v_mfma_f32_16x16x32_bf16 v[80:83], v[40:43], v[192:195], v[80:83]
    ds_read_b64_tr_b16 v[36:37], v4 offset:8192
    v_mfma_f32_16x16x32_bf16 v[84:87], v[40:43], v[196:199], v[84:87]
    ds_read_b64_tr_b16 v[38:39], v4 offset:9216
    v_mfma_f32_16x16x32_bf16 v[88:91], v[44:47], v[192:195], v[88:91]
    ds_read_b64_tr_b16 v[40:41], v5 offset:8192
    v_mfma_f32_16x16x32_bf16 v[92:95], v[44:47], v[196:199], v[92:95]
    ds_read_b64_tr_b16 v[42:43], v5 offset:9216
    s_waitcnt lgkmcnt(10)
    v_mfma_f32_16x16x32_bf16 v[96:99], v[192:195], v[48:51], v[96:99]
    ds_read_b64_tr_b16 v[44:45], v6 offset:8192
    v_mfma_f32_16x16x32_bf16 v[100:103], v[196:199], v[48:51], v[100:103]
    ds_read_b64_tr_b16 v[46:47], v6 offset:9216
    v_mfma_f32_16x16x32_bf16 v[104:107], v[192:195], v[52:55], v[104:107]
    ds_read_b64_tr_b16 v[48:49], v3 offset:12288
    v_mfma_f32_16x16x32_bf16 v[108:111], v[196:199], v[52:55], v[108:111]
    ds_read_b64_tr_b16 v[50:51], v3 offset:13312
    s_waitcnt lgkmcnt(10)
    v_mfma_f32_16x16x32_bf16 v[112:115], v[192:195], v[56:59], v[112:115]
    ds_read_b64_tr_b16 v[52:53], v4 offset:12288
    v_mfma_f32_16x16x32_bf16 v[116:119], v[196:199], v[56:59], v[116:119]
    ds_read_b64_tr_b16 v[54:55], v4 offset:13312
    v_mfma_f32_16x16x32_bf16 v[120:123], v[192:195], v[60:63], v[120:123]
    ds_read_b64_tr_b16 v[56:57], v5 offset:12288
    v_mfma_f32_16x16x32_bf16 v[124:127], v[196:199], v[60:63], v[124:127]
    ds_read_b64_tr_b16 v[58:59], v5 offset:13312
    s_waitcnt lgkmcnt(10)
    v_mfma_f32_16x16x32_bf16 v[128:131], v[32:35], v[192:195], v[128:131]
    ds_read_b64_tr_b16 v[60:61], v6 offset:12288
    v_mfma_f32_16x16x32_bf16 v[132:135], v[32:35], v[196:199], v[132:135]
    ds_read_b64_tr_b16 v[62:63], v6 offset:13312
    v_mfma_f32_16x16x32_bf16 v[136:139], v[36:39], v[192:195], v[136:139]
    ds_read_b64_tr_b16 v[32:33], v3 offset:16384
    v_mfma_f32_16x16x32_bf16 v[140:143], v[36:39], v[196:199], v[140:143]
    ds_read_b64_tr_b16 v[34:35], v3 offset:17408
    s_waitcnt lgkmcnt(10)
    v_mfma_f32_16x16x32_bf16 v[144:147], v[40:43], v[192:195], v[144:147]
    ds_read_b64_tr_b16 v[36:37], v4 offset:16384
    v_mfma_f32_16x16x32_bf16 v[148:151], v[40:43], v[196:199], v[148:151]
    ds_read_b64_tr_b16 v[38:39], v4 offset:17408
    v_mfma_f32_16x16x32_bf16 v[152:155], v[44:47], v[192:195], v[152:155]
    ds_read_b64_tr_b16 v[40:41], v5 offset:16384
    v_mfma_f32_16x16x32_bf16 v[156:159], v[44:47], v[196:199], v[156:159]
    ds_read_b64_tr_b16 v[42:43], v5 offset:17408
    s_waitcnt vmcnt(16) lgkmcnt(10)
    v_mfma_f32_16x16x32_bf16 v[64:67], v[48:51], v[200:203], v[64:67]
    buffer_load_dwordx4 v[176:179], v2, s[4:7], s42 offen offset:0 sc1
    ds_read_b64_tr_b16 v[44:45], v6 offset:16384
    v_mfma_f32_16x16x32_bf16 v[68:71], v[48:51], v[204:207], v[68:71]
    ds_read_b64_tr_b16 v[46:47], v6 offset:17408
    v_mfma_f32_16x16x32_bf16 v[72:75], v[52:55], v[200:203], v[72:75]
    buffer_load_dwordx4 v[180:183], v2, s[4:7], s42 offen offset:256 sc1
    ds_read_b64_tr_b16 v[48:49], v3 offset:20480
    v_mfma_f32_16x16x32_bf16 v[76:79], v[52:55], v[204:207], v[76:79]
    ds_read_b64_tr_b16 v[50:51], v3 offset:21504
    s_waitcnt lgkmcnt(10)
    v_mfma_f32_16x16x32_bf16 v[80:83], v[56:59], v[200:203], v[80:83]
    buffer_load_dwordx4 v[184:187], v2, s[4:7], s42 offen offset:2048 sc1
    ds_read_b64_tr_b16 v[52:53], v4 offset:20480
    v_mfma_f32_16x16x32_bf16 v[84:87], v[56:59], v[204:207], v[84:87]
    ds_read_b64_tr_b16 v[54:55], v4 offset:21504
    v_mfma_f32_16x16x32_bf16 v[88:91], v[60:63], v[200:203], v[88:91]
    buffer_load_dwordx4 v[188:191], v2, s[4:7], s42 offen offset:2304 sc1
    ds_read_b64_tr_b16 v[56:57], v5 offset:20480
    s_add_u32 s42, s41, s98
    v_mfma_f32_16x16x32_bf16 v[92:95], v[60:63], v[204:207], v[92:95]
    ds_read_b64_tr_b16 v[58:59], v5 offset:21504
    s_waitcnt lgkmcnt(10)
    v_mfma_f32_16x16x32_bf16 v[96:99], v[200:203], v[32:35], v[96:99]
    ds_read_b64_tr_b16 v[60:61], v6 offset:20480
    buffer_load_dwordx4 v[192:195], v2, s[4:7], s42 offen offset:0 sc1
    v_mfma_f32_16x16x32_bf16 v[100:103], v[204:207], v[32:35], v[100:103]
    ds_read_b64_tr_b16 v[62:63], v6 offset:21504
    v_mfma_f32_16x16x32_bf16 v[104:107], v[200:203], v[36:39], v[104:107]
    ds_read_b64_tr_b16 v[32:33], v3 offset:24576
    v_mfma_f32_16x16x32_bf16 v[108:111], v[204:207], v[36:39], v[108:111]
    ds_read_b64_tr_b16 v[34:35], v3 offset:25600
    s_waitcnt lgkmcnt(10)
    v_mfma_f32_16x16x32_bf16 v[112:115], v[200:203], v[40:43], v[112:115]
    ds_read_b64_tr_b16 v[36:37], v4 offset:24576
    v_mfma_f32_16x16x32_bf16 v[116:119], v[204:207], v[40:43], v[116:119]
    ds_read_b64_tr_b16 v[38:39], v4 offset:25600
    v_mfma_f32_16x16x32_bf16 v[120:123], v[200:203], v[44:47], v[120:123]
    buffer_load_dwordx4 v[196:199], v2, s[4:7], s42 offen offset:256 sc1
    ds_read_b64_tr_b16 v[40:41], v5 offset:24576
    v_mfma_f32_16x16x32_bf16 v[124:127], v[204:207], v[44:47], v[124:127]
    ds_read_b64_tr_b16 v[42:43], v5 offset:25600
    s_waitcnt lgkmcnt(10)
    v_mfma_f32_16x16x32_bf16 v[128:131], v[48:51], v[200:203], v[128:131]
    ds_read_b64_tr_b16 v[44:45], v6 offset:24576
    v_mfma_f32_16x16x32_bf16 v[132:135], v[48:51], v[204:207], v[132:135]
    ds_read_b64_tr_b16 v[46:47], v6 offset:25600
    v_mfma_f32_16x16x32_bf16 v[136:139], v[52:55], v[200:203], v[136:139]
    ds_read_b64_tr_b16 v[48:49], v3 offset:28672
    v_mfma_f32_16x16x32_bf16 v[140:143], v[52:55], v[204:207], v[140:143]
    ds_read_b64_tr_b16 v[50:51], v3 offset:29696
    s_waitcnt lgkmcnt(10)
    v_mfma_f32_16x16x32_bf16 v[144:147], v[56:59], v[200:203], v[144:147]
    ds_read_b64_tr_b16 v[52:53], v4 offset:28672
    v_mfma_f32_16x16x32_bf16 v[148:151], v[56:59], v[204:207], v[148:151]
    ds_read_b64_tr_b16 v[54:55], v4 offset:29696
    v_mfma_f32_16x16x32_bf16 v[152:155], v[60:63], v[200:203], v[152:155]
    ds_read_b64_tr_b16 v[56:57], v5 offset:28672
    v_mfma_f32_16x16x32_bf16 v[156:159], v[60:63], v[204:207], v[156:159]
    ds_read_b64_tr_b16 v[58:59], v5 offset:29696
    s_waitcnt vmcnt(20) lgkmcnt(10)
    v_mfma_f32_16x16x32_bf16 v[64:67], v[32:35], v[208:211], v[64:67]
    ds_read_b64_tr_b16 v[60:61], v6 offset:28672
    v_mfma_f32_16x16x32_bf16 v[68:71], v[32:35], v[212:215], v[68:71]
    ds_read_b64_tr_b16 v[62:63], v6 offset:29696
    s_barrier
    v_mfma_f32_16x16x32_bf16 v[72:75], v[36:39], v[208:211], v[72:75]
    ds_read_b64_tr_b16 v[32:33], v3 offset:32768
    v_mfma_f32_16x16x32_bf16 v[76:79], v[36:39], v[212:215], v[76:79]
    ds_read_b64_tr_b16 v[34:35], v3 offset:33792
    s_waitcnt lgkmcnt(10)
    v_mfma_f32_16x16x32_bf16 v[80:83], v[40:43], v[208:211], v[80:83]
    ds_read_b64_tr_b16 v[36:37], v4 offset:32768
    v_mfma_f32_16x16x32_bf16 v[84:87], v[40:43], v[212:215], v[84:87]
    ds_read_b64_tr_b16 v[38:39], v4 offset:33792
    v_mfma_f32_16x16x32_bf16 v[88:91], v[44:47], v[208:211], v[88:91]
    ds_read_b64_tr_b16 v[40:41], v5 offset:32768
    v_mfma_f32_16x16x32_bf16 v[92:95], v[44:47], v[212:215], v[92:95]
    ds_read_b64_tr_b16 v[42:43], v5 offset:33792
    s_waitcnt lgkmcnt(10)
    v_mfma_f32_16x16x32_bf16 v[96:99], v[208:211], v[48:51], v[96:99]
    ds_read_b64_tr_b16 v[44:45], v6 offset:32768
    v_mfma_f32_16x16x32_bf16 v[100:103], v[212:215], v[48:51], v[100:103]
    ds_read_b64_tr_b16 v[46:47], v6 offset:33792
    v_mfma_f32_16x16x32_bf16 v[104:107], v[208:211], v[52:55], v[104:107]
    ds_read_b64_tr_b16 v[48:49], v3 offset:36864
    v_mfma_f32_16x16x32_bf16 v[108:111], v[212:215], v[52:55], v[108:111]
    ds_read_b64_tr_b16 v[50:51], v3 offset:37888
    s_waitcnt lgkmcnt(10)
    v_mfma_f32_16x16x32_bf16 v[112:115], v[208:211], v[56:59], v[112:115]
    ds_read_b64_tr_b16 v[52:53], v4 offset:36864
    v_mfma_f32_16x16x32_bf16 v[116:119], v[212:215], v[56:59], v[116:119]
    ds_read_b64_tr_b16 v[54:55], v4 offset:37888
    v_mfma_f32_16x16x32_bf16 v[120:123], v[208:211], v[60:63], v[120:123]
    ds_read_b64_tr_b16 v[56:57], v5 offset:36864
    v_mfma_f32_16x16x32_bf16 v[124:127], v[212:215], v[60:63], v[124:127]
    ds_read_b64_tr_b16 v[58:59], v5 offset:37888
    s_waitcnt lgkmcnt(10)
    v_mfma_f32_16x16x32_bf16 v[128:131], v[32:35], v[208:211], v[128:131]
    ds_read_b64_tr_b16 v[60:61], v6 offset:36864
    v_mfma_f32_16x16x32_bf16 v[132:135], v[32:35], v[212:215], v[132:135]
    ds_read_b64_tr_b16 v[62:63], v6 offset:37888
    v_mfma_f32_16x16x32_bf16 v[136:139], v[36:39], v[208:211], v[136:139]
    ds_read_b64_tr_b16 v[32:33], v3 offset:40960
    v_mfma_f32_16x16x32_bf16 v[140:143], v[36:39], v[212:215], v[140:143]
    ds_read_b64_tr_b16 v[34:35], v3 offset:41984
    s_waitcnt lgkmcnt(10)
    v_mfma_f32_16x16x32_bf16 v[144:147], v[40:43], v[208:211], v[144:147]
    ds_read_b64_tr_b16 v[36:37], v4 offset:40960
    v_mfma_f32_16x16x32_bf16 v[148:151], v[40:43], v[212:215], v[148:151]
    ds_read_b64_tr_b16 v[38:39], v4 offset:41984
    v_mfma_f32_16x16x32_bf16 v[152:155], v[44:47], v[208:211], v[152:155]
    ds_read_b64_tr_b16 v[40:41], v5 offset:40960
    v_mfma_f32_16x16x32_bf16 v[156:159], v[44:47], v[212:215], v[156:159]
    ds_read_b64_tr_b16 v[42:43], v5 offset:41984
    s_waitcnt vmcnt(18) lgkmcnt(10)
    v_mfma_f32_16x16x32_bf16 v[64:67], v[48:51], v[216:219], v[64:67]
    ds_read_b64_tr_b16 v[44:45], v6 offset:40960
    v_mfma_f32_16x16x32_bf16 v[68:71], v[48:51], v[220:223], v[68:71]
    ds_read_b64_tr_b16 v[46:47], v6 offset:41984
    v_mfma_f32_16x16x32_bf16 v[72:75], v[52:55], v[216:219], v[72:75]
    ds_read_b64_tr_b16 v[48:49], v3 offset:45056
    v_mfma_f32_16x16x32_bf16 v[76:79], v[52:55], v[220:223], v[76:79]
    ds_read_b64_tr_b16 v[50:51], v3 offset:46080
    s_waitcnt lgkmcnt(10)
    v_mfma_f32_16x16x32_bf16 v[80:83], v[56:59], v[216:219], v[80:83]
    ds_read_b64_tr_b16 v[52:53], v4 offset:45056
    v_mfma_f32_16x16x32_bf16 v[84:87], v[56:59], v[220:223], v[84:87]
    ds_read_b64_tr_b16 v[54:55], v4 offset:46080
    v_mfma_f32_16x16x32_bf16 v[88:91], v[60:63], v[216:219], v[88:91]
    ds_read_b64_tr_b16 v[56:57], v5 offset:45056
    v_mfma_f32_16x16x32_bf16 v[92:95], v[60:63], v[220:223], v[92:95]
    ds_read_b64_tr_b16 v[58:59], v5 offset:46080
    s_waitcnt lgkmcnt(10)
    v_mfma_f32_16x16x32_bf16 v[96:99], v[216:219], v[32:35], v[96:99]
    ds_read_b64_tr_b16 v[60:61], v6 offset:45056
    v_mfma_f32_16x16x32_bf16 v[100:103], v[220:223], v[32:35], v[100:103]
    ds_read_b64_tr_b16 v[62:63], v6 offset:46080
    v_mfma_f32_16x16x32_bf16 v[104:107], v[216:219], v[36:39], v[104:107]
    ds_read_b64_tr_b16 v[32:33], v3 offset:49152
    v_mfma_f32_16x16x32_bf16 v[108:111], v[220:223], v[36:39], v[108:111]
    ds_read_b64_tr_b16 v[34:35], v3 offset:50176
    s_waitcnt lgkmcnt(10)
    v_mfma_f32_16x16x32_bf16 v[112:115], v[216:219], v[40:43], v[112:115]
    ds_read_b64_tr_b16 v[36:37], v4 offset:49152
    v_mfma_f32_16x16x32_bf16 v[116:119], v[220:223], v[40:43], v[116:119]
    ds_read_b64_tr_b16 v[38:39], v4 offset:50176
    v_mfma_f32_16x16x32_bf16 v[120:123], v[216:219], v[44:47], v[120:123]
    ds_read_b64_tr_b16 v[40:41], v5 offset:49152
    v_mfma_f32_16x16x32_bf16 v[124:127], v[220:223], v[44:47], v[124:127]
    ds_read_b64_tr_b16 v[42:43], v5 offset:50176
    s_waitcnt lgkmcnt(10)
    v_mfma_f32_16x16x32_bf16 v[128:131], v[48:51], v[216:219], v[128:131]
    buffer_load_dwordx4 v[200:203], v2, s[4:7], s42 offen offset:2048 sc1
    ds_read_b64_tr_b16 v[44:45], v6 offset:49152
    v_mfma_f32_16x16x32_bf16 v[132:135], v[48:51], v[220:223], v[132:135]
    ds_read_b64_tr_b16 v[46:47], v6 offset:50176
    v_mfma_f32_16x16x32_bf16 v[136:139], v[52:55], v[216:219], v[136:139]
    buffer_load_dwordx4 v[204:207], v2, s[4:7], s42 offen offset:2304 sc1
    ds_read_b64_tr_b16 v[48:49], v3 offset:53248
    s_add_u32 s42, s41, s99
    v_mfma_f32_16x16x32_bf16 v[140:143], v[52:55], v[220:223], v[140:143]
    ds_read_b64_tr_b16 v[50:51], v3 offset:54272
    s_waitcnt lgkmcnt(10)
    v_mfma_f32_16x16x32_bf16 v[144:147], v[56:59], v[216:219], v[144:147]
    buffer_load_dwordx4 v[208:211], v2, s[4:7], s42 offen offset:0 sc1
    ds_read_b64_tr_b16 v[52:53], v4 offset:53248
    v_mfma_f32_16x16x32_bf16 v[148:151], v[56:59], v[220:223], v[148:151]
    ds_read_b64_tr_b16 v[54:55], v4 offset:54272
    v_mfma_f32_16x16x32_bf16 v[152:155], v[60:63], v[216:219], v[152:155]
    buffer_load_dwordx4 v[212:215], v2, s[4:7], s42 offen offset:256 sc1
    ds_read_b64_tr_b16 v[56:57], v5 offset:53248
    v_mfma_f32_16x16x32_bf16 v[156:159], v[60:63], v[220:223], v[156:159]
    ds_read_b64_tr_b16 v[58:59], v5 offset:54272
    s_waitcnt vmcnt(20) lgkmcnt(10)
    v_mfma_f32_16x16x32_bf16 v[64:67], v[32:35], v[224:227], v[64:67]
    ds_read_b64_tr_b16 v[60:61], v6 offset:53248
    buffer_load_dwordx4 v[216:219], v2, s[4:7], s42 offen offset:2048 sc1
    v_mfma_f32_16x16x32_bf16 v[68:71], v[32:35], v[228:231], v[68:71]
    ds_read_b64_tr_b16 v[62:63], v6 offset:54272
    v_mfma_f32_16x16x32_bf16 v[72:75], v[36:39], v[224:227], v[72:75]
    buffer_load_dwordx4 v[220:223], v2, s[4:7], s42 offen offset:2304 sc1
    ds_read_b64_tr_b16 v[32:33], v3 offset:57344
    v_mfma_f32_16x16x32_bf16 v[76:79], v[36:39], v[228:231], v[76:79]
    ds_read_b64_tr_b16 v[34:35], v3 offset:58368
    s_waitcnt lgkmcnt(10)
    v_mfma_f32_16x16x32_bf16 v[80:83], v[40:43], v[224:227], v[80:83]
    ds_read_b64_tr_b16 v[36:37], v4 offset:57344
    v_mfma_f32_16x16x32_bf16 v[84:87], v[40:43], v[228:231], v[84:87]
    ds_read_b64_tr_b16 v[38:39], v4 offset:58368
    v_mfma_f32_16x16x32_bf16 v[88:91], v[44:47], v[224:227], v[88:91]
    ds_read_b64_tr_b16 v[40:41], v5 offset:57344
    v_mfma_f32_16x16x32_bf16 v[92:95], v[44:47], v[228:231], v[92:95]
    ds_read_b64_tr_b16 v[42:43], v5 offset:58368
    s_waitcnt lgkmcnt(10)
    v_mfma_f32_16x16x32_bf16 v[96:99], v[224:227], v[48:51], v[96:99]
    ds_read_b64_tr_b16 v[44:45], v6 offset:57344
    v_mfma_f32_16x16x32_bf16 v[100:103], v[228:231], v[48:51], v[100:103]
    ds_read_b64_tr_b16 v[46:47], v6 offset:58368
    v_mfma_f32_16x16x32_bf16 v[104:107], v[224:227], v[52:55], v[104:107]
    ds_read_b64_tr_b16 v[48:49], v3 offset:61440
    v_mfma_f32_16x16x32_bf16 v[108:111], v[228:231], v[52:55], v[108:111]
    ds_read_b64_tr_b16 v[50:51], v3 offset:62464
    s_waitcnt lgkmcnt(10)
    v_mfma_f32_16x16x32_bf16 v[112:115], v[224:227], v[56:59], v[112:115]
    ds_read_b64_tr_b16 v[52:53], v4 offset:61440
    v_mfma_f32_16x16x32_bf16 v[116:119], v[228:231], v[56:59], v[116:119]
    ds_read_b64_tr_b16 v[54:55], v4 offset:62464
    v_mfma_f32_16x16x32_bf16 v[120:123], v[224:227], v[60:63], v[120:123]
    ds_read_b64_tr_b16 v[56:57], v5 offset:61440
    v_mfma_f32_16x16x32_bf16 v[124:127], v[228:231], v[60:63], v[124:127]
    ds_read_b64_tr_b16 v[58:59], v5 offset:62464
    s_waitcnt vmcnt(20) lgkmcnt(10)
    v_mfma_f32_16x16x32_bf16 v[64:67], v[32:35], v[232:235], v[64:67]
    ds_read_b64_tr_b16 v[60:61], v6 offset:61440
    v_mfma_f32_16x16x32_bf16 v[68:71], v[32:35], v[236:239], v[68:71]
    ds_read_b64_tr_b16 v[62:63], v6 offset:62464
    s_barrier
    v_xor_b32 v3, 0x10000, v3
    v_xor_b32 v4, 0x10000, v4
    v_xor_b32 v5, 0x10000, v5
    v_xor_b32 v6, 0x10000, v6
    v_mfma_f32_16x16x32_bf16 v[72:75], v[36:39], v[232:235], v[72:75]
    ds_read_b64_tr_b16 v[32:33], v3 offset:0
    v_mfma_f32_16x16x32_bf16 v[76:79], v[36:39], v[236:239], v[76:79]
    ds_read_b64_tr_b16 v[34:35], v3 offset:1024
    s_waitcnt lgkmcnt(10)
    v_mfma_f32_16x16x32_bf16 v[80:83], v[40:43], v[232:235], v[80:83]
    ds_read_b64_tr_b16 v[36:37], v4 offset:0
    v_mfma_f32_16x16x32_bf16 v[84:87], v[40:43], v[236:239], v[84:87]
    ds_read_b64_tr_b16 v[38:39], v4 offset:1024
    v_mfma_f32_16x16x32_bf16 v[88:91], v[44:47], v[232:235], v[88:91]
    ds_read_b64_tr_b16 v[40:41], v5 offset:0
    v_mfma_f32_16x16x32_bf16 v[92:95], v[44:47], v[236:239], v[92:95]
    ds_read_b64_tr_b16 v[42:43], v5 offset:1024
    s_waitcnt lgkmcnt(10)
    v_mfma_f32_16x16x32_bf16 v[96:99], v[232:235], v[48:51], v[96:99]
    ds_read_b64_tr_b16 v[44:45], v6 offset:0
    v_mfma_f32_16x16x32_bf16 v[100:103], v[236:239], v[48:51], v[100:103]
    ds_read_b64_tr_b16 v[46:47], v6 offset:1024
    v_mfma_f32_16x16x32_bf16 v[104:107], v[232:235], v[52:55], v[104:107]
    ds_read_b64_tr_b16 v[48:49], v3 offset:4096
    v_mfma_f32_16x16x32_bf16 v[108:111], v[236:239], v[52:55], v[108:111]
    ds_read_b64_tr_b16 v[50:51], v3 offset:5120
    s_waitcnt lgkmcnt(10)
    v_mfma_f32_16x16x32_bf16 v[112:115], v[232:235], v[56:59], v[112:115]
    ds_read_b64_tr_b16 v[52:53], v4 offset:4096
    v_mfma_f32_16x16x32_bf16 v[116:119], v[236:239], v[56:59], v[116:119]
    ds_read_b64_tr_b16 v[54:55], v4 offset:5120
    v_mfma_f32_16x16x32_bf16 v[120:123], v[232:235], v[60:63], v[120:123]
    ds_read_b64_tr_b16 v[56:57], v5 offset:4096
    v_mfma_f32_16x16x32_bf16 v[124:127], v[236:239], v[60:63], v[124:127]
    ds_read_b64_tr_b16 v[58:59], v5 offset:5120
    s_waitcnt vmcnt(18) lgkmcnt(10)
    v_mfma_f32_16x16x32_bf16 v[64:67], v[32:35], v[240:243], v[64:67]
    ds_read_b64_tr_b16 v[60:61], v6 offset:4096
    v_mfma_f32_16x16x32_bf16 v[68:71], v[32:35], v[244:247], v[68:71]
    ds_read_b64_tr_b16 v[62:63], v6 offset:5120
    v_mfma_f32_16x16x32_bf16 v[72:75], v[36:39], v[240:243], v[72:75]
    ds_read_b64_tr_b16 v[32:33], v3 offset:8192
    v_mfma_f32_16x16x32_bf16 v[76:79], v[36:39], v[244:247], v[76:79]
    ds_read_b64_tr_b16 v[34:35], v3 offset:9216
    s_waitcnt lgkmcnt(10)
    v_mfma_f32_16x16x32_bf16 v[80:83], v[40:43], v[240:243], v[80:83]
    ds_read_b64_tr_b16 v[36:37], v4 offset:8192
    v_mfma_f32_16x16x32_bf16 v[84:87], v[40:43], v[244:247], v[84:87]
    ds_read_b64_tr_b16 v[38:39], v4 offset:9216
    v_mfma_f32_16x16x32_bf16 v[88:91], v[44:47], v[240:243], v[88:91]
    ds_read_b64_tr_b16 v[40:41], v5 offset:8192
    v_mfma_f32_16x16x32_bf16 v[92:95], v[44:47], v[244:247], v[92:95]
    ds_read_b64_tr_b16 v[42:43], v5 offset:9216
    s_waitcnt lgkmcnt(10)
    v_mfma_f32_16x16x32_bf16 v[96:99], v[240:243], v[48:51], v[96:99]
    ds_read_b64_tr_b16 v[44:45], v6 offset:8192
    v_mfma_f32_16x16x32_bf16 v[100:103], v[244:247], v[48:51], v[100:103]
    ds_read_b64_tr_b16 v[46:47], v6 offset:9216
    v_mfma_f32_16x16x32_bf16 v[104:107], v[240:243], v[52:55], v[104:107]
    ds_read_b64_tr_b16 v[48:49], v3 offset:12288
    v_mfma_f32_16x16x32_bf16 v[108:111], v[244:247], v[52:55], v[108:111]
    ds_read_b64_tr_b16 v[50:51], v3 offset:13312
    s_waitcnt lgkmcnt(10)
    v_mfma_f32_16x16x32_bf16 v[112:115], v[240:243], v[56:59], v[112:115]
    ds_read_b64_tr_b16 v[52:53], v4 offset:12288
    v_mfma_f32_16x16x32_bf16 v[116:119], v[244:247], v[56:59], v[116:119]
    ds_read_b64_tr_b16 v[54:55], v4 offset:13312
    v_mfma_f32_16x16x32_bf16 v[120:123], v[240:243], v[60:63], v[120:123]
    ds_read_b64_tr_b16 v[56:57], v5 offset:12288
    v_mfma_f32_16x16x32_bf16 v[124:127], v[244:247], v[60:63], v[124:127]
    ds_read_b64_tr_b16 v[58:59], v5 offset:13312
    s_waitcnt vmcnt(16) lgkmcnt(10)
    v_mfma_f32_16x16x32_bf16 v[64:67], v[32:35], v[248:251], v[64:67]
    ds_read_b64_tr_b16 v[60:61], v6 offset:12288
    v_mfma_f32_16x16x32_bf16 v[68:71], v[32:35], v[252:255], v[68:71]
    ds_read_b64_tr_b16 v[62:63], v6 offset:13312
    v_mfma_f32_16x16x32_bf16 v[72:75], v[36:39], v[248:251], v[72:75]
    ds_read_b64_tr_b16 v[32:33], v3 offset:16384
    v_mfma_f32_16x16x32_bf16 v[76:79], v[36:39], v[252:255], v[76:79]
    ds_read_b64_tr_b16 v[34:35], v3 offset:17408
    s_waitcnt lgkmcnt(10)
    v_mfma_f32_16x16x32_bf16 v[80:83], v[40:43], v[248:251], v[80:83]
    ds_read_b64_tr_b16 v[36:37], v4 offset:16384
    v_mfma_f32_16x16x32_bf16 v[84:87], v[40:43], v[252:255], v[84:87]
    ds_read_b64_tr_b16 v[38:39], v4 offset:17408
    v_mfma_f32_16x16x32_bf16 v[88:91], v[44:47], v[248:251], v[88:91]
    ds_read_b64_tr_b16 v[40:41], v5 offset:16384
    v_mfma_f32_16x16x32_bf16 v[92:95], v[44:47], v[252:255], v[92:95]
    ds_read_b64_tr_b16 v[42:43], v5 offset:17408
    s_waitcnt lgkmcnt(10)
    v_mfma_f32_16x16x32_bf16 v[96:99], v[248:251], v[48:51], v[96:99]
    ds_read_b64_tr_b16 v[44:45], v6 offset:16384
    v_mfma_f32_16x16x32_bf16 v[100:103], v[252:255], v[48:51], v[100:103]
    ds_read_b64_tr_b16 v[46:47], v6 offset:17408
    v_mfma_f32_16x16x32_bf16 v[104:107], v[248:251], v[52:55], v[104:107]
    ds_read_b64_tr_b16 v[48:49], v3 offset:20480
    v_mfma_f32_16x16x32_bf16 v[108:111], v[252:255], v[52:55], v[108:111]
    ds_read_b64_tr_b16 v[50:51], v3 offset:21504
    s_waitcnt lgkmcnt(10)
    v_mfma_f32_16x16x32_bf16 v[112:115], v[248:251], v[56:59], v[112:115]
    ds_read_b64_tr_b16 v[52:53], v4 offset:20480
    v_mfma_f32_16x16x32_bf16 v[116:119], v[252:255], v[56:59], v[116:119]
    ds_read_b64_tr_b16 v[54:55], v4 offset:21504
    v_mfma_f32_16x16x32_bf16 v[120:123], v[248:251], v[60:63], v[120:123]
    ds_read_b64_tr_b16 v[56:57], v5 offset:20480
    v_mfma_f32_16x16x32_bf16 v[124:127], v[252:255], v[60:63], v[124:127]
    ds_read_b64_tr_b16 v[58:59], v5 offset:21504
    s_waitcnt vmcnt(14) lgkmcnt(10)
    v_mfma_f32_16x16x32_bf16 v[64:67], v[32:35], v[160:163], v[64:67]
    ds_read_b64_tr_b16 v[60:61], v6 offset:20480
    v_mfma_f32_16x16x32_bf16 v[68:71], v[32:35], v[164:167], v[68:71]
    ds_read_b64_tr_b16 v[62:63], v6 offset:21504
    v_mfma_f32_16x16x32_bf16 v[72:75], v[36:39], v[160:163], v[72:75]
    ds_read_b64_tr_b16 v[32:33], v3 offset:24576
    v_mfma_f32_16x16x32_bf16 v[76:79], v[36:39], v[164:167], v[76:79]
    ds_read_b64_tr_b16 v[34:35], v3 offset:25600
    s_waitcnt lgkmcnt(10)
    v_mfma_f32_16x16x32_bf16 v[80:83], v[40:43], v[160:163], v[80:83]
    ds_read_b64_tr_b16 v[36:37], v4 offset:24576
    v_mfma_f32_16x16x32_bf16 v[84:87], v[40:43], v[164:167], v[84:87]
    ds_read_b64_tr_b16 v[38:39], v4 offset:25600
    v_mfma_f32_16x16x32_bf16 v[88:91], v[44:47], v[160:163], v[88:91]
    ds_read_b64_tr_b16 v[40:41], v5 offset:24576
    v_mfma_f32_16x16x32_bf16 v[92:95], v[44:47], v[164:167], v[92:95]
    ds_read_b64_tr_b16 v[42:43], v5 offset:25600
    s_waitcnt vmcnt(12) lgkmcnt(10)
    v_mfma_f32_16x16x32_bf16 v[64:67], v[48:51], v[168:171], v[64:67]
    ds_read_b64_tr_b16 v[44:45], v6 offset:24576
    v_mfma_f32_16x16x32_bf16 v[68:71], v[48:51], v[172:175], v[68:71]
    ds_read_b64_tr_b16 v[46:47], v6 offset:25600
    v_mfma_f32_16x16x32_bf16 v[72:75], v[52:55], v[168:171], v[72:75]
    ds_read_b64_tr_b16 v[48:49], v3 offset:28672
    v_mfma_f32_16x16x32_bf16 v[76:79], v[52:55], v[172:175], v[76:79]
    ds_read_b64_tr_b16 v[50:51], v3 offset:29696
    s_waitcnt lgkmcnt(10)
    v_mfma_f32_16x16x32_bf16 v[80:83], v[56:59], v[168:171], v[80:83]
    ds_read_b64_tr_b16 v[52:53], v4 offset:28672
    v_mfma_f32_16x16x32_bf16 v[84:87], v[56:59], v[172:175], v[84:87]
    ds_read_b64_tr_b16 v[54:55], v4 offset:29696
    v_mfma_f32_16x16x32_bf16 v[88:91], v[60:63], v[168:171], v[88:91]
    ds_read_b64_tr_b16 v[56:57], v5 offset:28672
    v_mfma_f32_16x16x32_bf16 v[92:95], v[60:63], v[172:175], v[92:95]
    ds_read_b64_tr_b16 v[58:59], v5 offset:29696
    s_waitcnt vmcnt(10) lgkmcnt(10)
    v_mfma_f32_16x16x32_bf16 v[64:67], v[32:35], v[176:179], v[64:67]
    ds_read_b64_tr_b16 v[60:61], v6 offset:28672
    v_mfma_f32_16x16x32_bf16 v[68:71], v[32:35], v[180:183], v[68:71]
    ds_read_b64_tr_b16 v[62:63], v6 offset:29696
    s_barrier
    v_mfma_f32_16x16x32_bf16 v[72:75], v[36:39], v[176:179], v[72:75]
    ds_read_b64_tr_b16 v[32:33], v3 offset:32768
    v_mfma_f32_16x16x32_bf16 v[76:79], v[36:39], v[180:183], v[76:79]
    ds_read_b64_tr_b16 v[34:35], v3 offset:33792
    s_waitcnt lgkmcnt(10)
    v_mfma_f32_16x16x32_bf16 v[80:83], v[40:43], v[176:179], v[80:83]
    ds_read_b64_tr_b16 v[36:37], v4 offset:32768
    v_mfma_f32_16x16x32_bf16 v[84:87], v[40:43], v[180:183], v[84:87]
    ds_read_b64_tr_b16 v[38:39], v4 offset:33792
    v_mfma_f32_16x16x32_bf16 v[88:91], v[44:47], v[176:179], v[88:91]
    ds_read_b64_tr_b16 v[40:41], v5 offset:32768
    v_mfma_f32_16x16x32_bf16 v[92:95], v[44:47], v[180:183], v[92:95]
    ds_read_b64_tr_b16 v[42:43], v5 offset:33792
    s_waitcnt vmcnt(8) lgkmcnt(10)
    v_mfma_f32_16x16x32_bf16 v[64:67], v[48:51], v[184:187], v[64:67]
    ds_read_b64_tr_b16 v[44:45], v6 offset:32768
    v_mfma_f32_16x16x32_bf16 v[68:71], v[48:51], v[188:191], v[68:71]
    ds_read_b64_tr_b16 v[46:47], v6 offset:33792
    v_mfma_f32_16x16x32_bf16 v[72:75], v[52:55], v[184:187], v[72:75]
    ds_read_b64_tr_b16 v[48:49], v3 offset:36864
    v_mfma_f32_16x16x32_bf16 v[76:79], v[52:55], v[188:191], v[76:79]
    ds_read_b64_tr_b16 v[50:51], v3 offset:37888
    s_waitcnt lgkmcnt(10)
    v_mfma_f32_16x16x32_bf16 v[80:83], v[56:59], v[184:187], v[80:83]
    ds_read_b64_tr_b16 v[52:53], v4 offset:36864
    v_mfma_f32_16x16x32_bf16 v[84:87], v[56:59], v[188:191], v[84:87]
    ds_read_b64_tr_b16 v[54:55], v4 offset:37888
    v_mfma_f32_16x16x32_bf16 v[88:91], v[60:63], v[184:187], v[88:91]
    ds_read_b64_tr_b16 v[56:57], v5 offset:36864
    v_mfma_f32_16x16x32_bf16 v[92:95], v[60:63], v[188:191], v[92:95]
    ds_read_b64_tr_b16 v[58:59], v5 offset:37888
    s_waitcnt vmcnt(6) lgkmcnt(10)
    v_mfma_f32_16x16x32_bf16 v[64:67], v[32:35], v[192:195], v[64:67]
    ds_read_b64_tr_b16 v[60:61], v6 offset:36864
    v_mfma_f32_16x16x32_bf16 v[68:71], v[32:35], v[196:199], v[68:71]
    ds_read_b64_tr_b16 v[62:63], v6 offset:37888
    v_mfma_f32_16x16x32_bf16 v[72:75], v[36:39], v[192:195], v[72:75]
    ds_read_b64_tr_b16 v[32:33], v3 offset:40960
    v_mfma_f32_16x16x32_bf16 v[76:79], v[36:39], v[196:199], v[76:79]
    ds_read_b64_tr_b16 v[34:35], v3 offset:41984
    s_waitcnt lgkmcnt(10)
    v_mfma_f32_16x16x32_bf16 v[80:83], v[40:43], v[192:195], v[80:83]
    ds_read_b64_tr_b16 v[36:37], v4 offset:40960
    v_mfma_f32_16x16x32_bf16 v[84:87], v[40:43], v[196:199], v[84:87]
    ds_read_b64_tr_b16 v[38:39], v4 offset:41984
    v_mfma_f32_16x16x32_bf16 v[88:91], v[44:47], v[192:195], v[88:91]
    ds_read_b64_tr_b16 v[40:41], v5 offset:40960
    v_mfma_f32_16x16x32_bf16 v[92:95], v[44:47], v[196:199], v[92:95]
    ds_read_b64_tr_b16 v[42:43], v5 offset:41984
    s_waitcnt vmcnt(4) lgkmcnt(10)
    v_mfma_f32_16x16x32_bf16 v[64:67], v[48:51], v[200:203], v[64:67]
    ds_read_b64_tr_b16 v[44:45], v6 offset:40960
    v_mfma_f32_16x16x32_bf16 v[68:71], v[48:51], v[204:207], v[68:71]
    ds_read_b64_tr_b16 v[46:47], v6 offset:41984
    v_mfma_f32_16x16x32_bf16 v[72:75], v[52:55], v[200:203], v[72:75]
    ds_read_b64_tr_b16 v[48:49], v3 offset:45056
    v_mfma_f32_16x16x32_bf16 v[76:79], v[52:55], v[204:207], v[76:79]
    ds_read_b64_tr_b16 v[50:51], v3 offset:46080
    s_waitcnt lgkmcnt(10)
    v_mfma_f32_16x16x32_bf16 v[80:83], v[56:59], v[200:203], v[80:83]
    ds_read_b64_tr_b16 v[52:53], v4 offset:45056
    v_mfma_f32_16x16x32_bf16 v[84:87], v[56:59], v[204:207], v[84:87]
    ds_read_b64_tr_b16 v[54:55], v4 offset:46080
    v_mfma_f32_16x16x32_bf16 v[88:91], v[60:63], v[200:203], v[88:91]
    ds_read_b64_tr_b16 v[56:57], v5 offset:45056
    v_mfma_f32_16x16x32_bf16 v[92:95], v[60:63], v[204:207], v[92:95]
    ds_read_b64_tr_b16 v[58:59], v5 offset:46080
    s_waitcnt vmcnt(2) lgkmcnt(10)
    v_mfma_f32_16x16x32_bf16 v[64:67], v[32:35], v[208:211], v[64:67]
    ds_read_b64_tr_b16 v[60:61], v6 offset:45056
    v_mfma_f32_16x16x32_bf16 v[68:71], v[32:35], v[212:215], v[68:71]
    ds_read_b64_tr_b16 v[62:63], v6 offset:46080
    v_mfma_f32_16x16x32_bf16 v[72:75], v[36:39], v[208:211], v[72:75]
    ds_read_b64_tr_b16 v[32:33], v3 offset:49152
    ds_read_b32 v8, v9 offset:4096
    v_mfma_f32_16x16x32_bf16 v[76:79], v[36:39], v[212:215], v[76:79]
    ds_read_b64_tr_b16 v[34:35], v3 offset:50176
    ds_read_b32 v10, v9 offset:4608
    s_waitcnt lgkmcnt(12)
    v_mfma_f32_16x16x32_bf16 v[80:83], v[40:43], v[208:211], v[80:83]
    ds_read_b64_tr_b16 v[36:37], v4 offset:49152
    ds_read_b32 v12, v9 offset:4160
    v_mfma_f32_16x16x32_bf16 v[84:87], v[40:43], v[212:215], v[84:87]
    ds_read_b64_tr_b16 v[38:39], v4 offset:50176
    ds_read_b32 v14, v9 offset:4672
    v_mfma_f32_16x16x32_bf16 v[88:91], v[44:47], v[208:211], v[88:91]
    ds_read_b64_tr_b16 v[40:41], v5 offset:49152
    ds_read_b128 v[16:19], v11 offset:256
    v_mfma_f32_16x16x32_bf16 v[92:95], v[44:47], v[212:215], v[92:95]
    ds_read_b64_tr_b16 v[42:43], v5 offset:50176
    ds_read_b128 v[20:23], v11 offset:320
    s_waitcnt vmcnt(0) lgkmcnt(14)
    v_mfma_f32_16x16x32_bf16 v[64:67], v[48:51], v[216:219], v[64:67]
    ds_read_b64_tr_b16 v[44:45], v6 offset:49152
    ds_read_b128 v[24:27], v11 offset:384
    v_mfma_f32_16x16x32_bf16 v[68:71], v[48:51], v[220:223], v[68:71]
    ds_read_b64_tr_b16 v[46:47], v6 offset:50176
    ds_read_b128 v[28:31], v11 offset:448
    v_mfma_f32_16x16x32_bf16 v[72:75], v[52:55], v[216:219], v[72:75]
    ds_read_b64_tr_b16 v[48:49], v3 offset:53248
    v_mfma_f32_16x16x32_bf16 v[76:79], v[52:55], v[220:223], v[76:79]
    ds_read_b64_tr_b16 v[50:51], v3 offset:54272
    s_waitcnt lgkmcnt(14)
    v_mfma_f32_16x16x32_bf16 v[80:83], v[56:59], v[216:219], v[80:83]
    ds_read_b64_tr_b16 v[52:53], v4 offset:53248
    v_mfma_f32_16x16x32_bf16 v[84:87], v[56:59], v[220:223], v[84:87]
    ds_read_b64_tr_b16 v[54:55], v4 offset:54272
    v_mfma_f32_16x16x32_bf16 v[88:91], v[60:63], v[216:219], v[88:91]
    ds_read_b64_tr_b16 v[56:57], v5 offset:53248
    v_mfma_f32_16x16x32_bf16 v[92:95], v[60:63], v[220:223], v[92:95]
    ds_read_b64_tr_b16 v[58:59], v5 offset:54272
    s_bitcmp1_b32 s21, 0
    s_cbranch_scc1 c_B
    v_add_u32 v7, s62, v1
    s_waitcnt lgkmcnt(6)
    v_pk_fma_f32 v[68:69], v[12:13], v[16:17], v[68:69] op_sel_hi:[0,1,1] neg_lo:[1,0,0] neg_hi:[1,0,0]
    v_pk_fma_f32 v[70:71], v[12:13], v[18:19], v[70:71] op_sel_hi:[0,1,1] neg_lo:[1,0,0] neg_hi:[1,0,0]
    v_pk_fma_f32 v[76:77], v[12:13], v[20:21], v[76:77] op_sel_hi:[0,1,1] neg_lo:[1,0,0] neg_hi:[1,0,0]
    v_pk_fma_f32 v[78:79], v[12:13], v[22:23], v[78:79] op_sel_hi:[0,1,1] neg_lo:[1,0,0] neg_hi:[1,0,0]
    v_pk_mul_f32 v[68:69], v[14:15], v[68:69] op_sel_hi:[0,1]
    v_pk_mul_f32 v[70:71], v[14:15], v[70:71] op_sel_hi:[0,1]
    v_pk_mul_f32 v[76:77], v[14:15], v[76:77] op_sel_hi:[0,1]
    v_pk_mul_f32 v[78:79], v[14:15], v[78:79] op_sel_hi:[0,1]
    v_cvt_pk_bf16_f32 v68, v68, v69
    v_cvt_pk_bf16_f32 v69, v70, v71
    v_cvt_pk_bf16_f32 v70, v76, v77
    v_cvt_pk_bf16_f32 v71, v78, v79
    ds_write_b128 v7, v[68:71] offset:4096
    v_pk_fma_f32 v[64:65], v[8:9], v[16:17], v[64:65] op_sel_hi:[0,1,1] neg_lo:[1,0,0] neg_hi:[1,0,0]
    v_pk_fma_f32 v[66:67], v[8:9], v[18:19], v[66:67] op_sel_hi:[0,1,1] neg_lo:[1,0,0] neg_hi:[1,0,0]
    v_pk_fma_f32 v[72:73], v[8:9], v[20:21], v[72:73] op_sel_hi:[0,1,1] neg_lo:[1,0,0] neg_hi:[1,0,0]
    v_pk_fma_f32 v[74:75], v[8:9], v[22:23], v[74:75] op_sel_hi:[0,1,1] neg_lo:[1,0,0] neg_hi:[1,0,0]
    v_pk_mul_f32 v[64:65], v[10:11], v[64:65] op_sel_hi:[0,1]
    v_pk_mul_f32 v[66:67], v[10:11], v[66:67] op_sel_hi:[0,1]
    v_pk_mul_f32 v[72:73], v[10:11], v[72:73] op_sel_hi:[0,1]
    v_pk_mul_f32 v[74:75], v[10:11], v[74:75] op_sel_hi:[0,1]
    v_cvt_pk_bf16_f32 v64, v64, v65
    v_cvt_pk_bf16_f32 v65, v66, v67
    v_cvt_pk_bf16_f32 v66, v72, v73
    v_cvt_pk_bf16_f32 v67, v74, v75
    v_pk_fma_f32 v[84:85], v[12:13], v[24:25], v[84:85] op_sel_hi:[0,1,1] neg_lo:[1,0,0] neg_hi:[1,0,0]
    v_pk_fma_f32 v[86:87], v[12:13], v[26:27], v[86:87] op_sel_hi:[0,1,1] neg_lo:[1,0,0] neg_hi:[1,0,0]
    v_pk_fma_f32 v[92:93], v[12:13], v[28:29], v[92:93] op_sel_hi:[0,1,1] neg_lo:[1,0,0] neg_hi:[1,0,0]
    v_pk_fma_f32 v[94:95], v[12:13], v[30:31], v[94:95] op_sel_hi:[0,1,1] neg_lo:[1,0,0] neg_hi:[1,0,0]
    v_pk_mul_f32 v[84:85], v[14:15], v[84:85] op_sel_hi:[0,1]
    v_pk_mul_f32 v[86:87], v[14:15], v[86:87] op_sel_hi:[0,1]
    v_pk_mul_f32 v[92:93], v[14:15], v[92:93] op_sel_hi:[0,1]
    v_pk_mul_f32 v[94:95], v[14:15], v[94:95] op_sel_hi:[0,1]
    v_cvt_pk_bf16_f32 v84, v84, v85
    v_cvt_pk_bf16_f32 v85, v86, v87
    v_cvt_pk_bf16_f32 v86, v92, v93
    v_cvt_pk_bf16_f32 v87, v94, v95
    ds_write_b128 v7, v[84:87] offset:5120
    v_pk_fma_f32 v[80:81], v[8:9], v[24:25], v[80:81] op_sel_hi:[0,1,1] neg_lo:[1,0,0] neg_hi:[1,0,0]
    v_pk_fma_f32 v[82:83], v[8:9], v[26:27], v[82:83] op_sel_hi:[0,1,1] neg_lo:[1,0,0] neg_hi:[1,0,0]
    v_pk_fma_f32 v[88:89], v[8:9], v[28:29], v[88:89] op_sel_hi:[0,1,1] neg_lo:[1,0,0] neg_hi:[1,0,0]
    v_pk_fma_f32 v[90:91], v[8:9], v[30:31], v[90:91] op_sel_hi:[0,1,1] neg_lo:[1,0,0] neg_hi:[1,0,0]
    v_pk_mul_f32 v[80:81], v[10:11], v[80:81] op_sel_hi:[0,1]
    v_pk_mul_f32 v[82:83], v[10:11], v[82:83] op_sel_hi:[0,1]
    v_pk_mul_f32 v[88:89], v[10:11], v[88:89] op_sel_hi:[0,1]
    v_pk_mul_f32 v[90:91], v[10:11], v[90:91] op_sel_hi:[0,1]
    v_cvt_pk_bf16_f32 v80, v80, v81
    v_cvt_pk_bf16_f32 v81, v82, v83
    v_cvt_pk_bf16_f32 v82, v88, v89
    v_cvt_pk_bf16_f32 v83, v90, v91
    v_mfma_f32_16x16x32_bf16 v[96:99], v[160:163], v[32:35], v[96:99]
    ds_read_b64_tr_b16 v[60:61], v6 offset:53248
    v_mfma_f32_16x16x32_bf16 v[100:103], v[164:167], v[32:35], v[100:103]
    ds_read_b64_tr_b16 v[62:63], v6 offset:54272
    v_mfma_f32_16x16x32_bf16 v[104:107], v[160:163], v[36:39], v[104:107]
    ds_read_b64_tr_b16 v[32:33], v3 offset:57344
    v_mfma_f32_16x16x32_bf16 v[108:111], v[164:167], v[36:39], v[108:111]
    ds_read_b64_tr_b16 v[34:35], v3 offset:58368
    v_mfma_f32_16x16x32_bf16 v[112:115], v[160:163], v[40:43], v[112:115]
    ds_read_b64_tr_b16 v[36:37], v4 offset:57344
    v_mfma_f32_16x16x32_bf16 v[116:119], v[164:167], v[40:43], v[116:119]
    ds_read_b64_tr_b16 v[38:39], v4 offset:58368
    v_mfma_f32_16x16x32_bf16 v[120:123], v[160:163], v[44:47], v[120:123]
    ds_read_b64_tr_b16 v[40:41], v5 offset:57344
    v_mfma_f32_16x16x32_bf16 v[124:127], v[164:167], v[44:47], v[124:127]
    ds_read_b64_tr_b16 v[42:43], v5 offset:58368
    s_waitcnt lgkmcnt(12)
    v_mfma_f32_16x16x32_bf16 v[96:99], v[168:171], v[48:51], v[96:99]
    ds_read_b64_tr_b16 v[44:45], v6 offset:57344
    v_mfma_f32_16x16x32_bf16 v[100:103], v[172:175], v[48:51], v[100:103]
    ds_read_b64_tr_b16 v[46:47], v6 offset:58368
    v_mfma_f32_16x16x32_bf16 v[104:107], v[168:171], v[52:55], v[104:107]
    ds_read_b64_tr_b16 v[48:49], v3 offset:61440
    v_mfma_f32_16x16x32_bf16 v[108:111], v[172:175], v[52:55], v[108:111]
    ds_read_b64_tr_b16 v[50:51], v3 offset:62464
    s_waitcnt lgkmcnt(10)
    v_mfma_f32_16x16x32_bf16 v[112:115], v[168:171], v[56:59], v[112:115]
    ds_read_b64_tr_b16 v[52:53], v4 offset:61440
    v_mfma_f32_16x16x32_bf16 v[116:119], v[172:175], v[56:59], v[116:119]
    ds_read_b64_tr_b16 v[54:55], v4 offset:62464
    v_mfma_f32_16x16x32_bf16 v[120:123], v[168:171], v[60:63], v[120:123]
    ds_read_b64_tr_b16 v[56:57], v5 offset:61440
    v_mfma_f32_16x16x32_bf16 v[124:127], v[172:175], v[60:63], v[124:127]
    ds_read_b64_tr_b16 v[58:59], v5 offset:62464
    s_waitcnt lgkmcnt(10)
    v_mfma_f32_16x16x32_bf16 v[96:99], v[176:179], v[32:35], v[96:99]
    ds_read_b64_tr_b16 v[60:61], v6 offset:61440
    v_mfma_f32_16x16x32_bf16 v[100:103], v[180:183], v[32:35], v[100:103]
    ds_read_b64_tr_b16 v[62:63], v6 offset:62464
    s_barrier
    v_xor_b32 v3, 0x10000, v3
    v_xor_b32 v4, 0x10000, v4
    v_xor_b32 v5, 0x10000, v5
    v_xor_b32 v6, 0x10000, v6
    v_mfma_f32_16x16x32_bf16 v[104:107], v[176:179], v[36:39], v[104:107]
    ds_read_b64_tr_b16 v[32:33], v3 offset:0
    v_mfma_f32_16x16x32_bf16 v[108:111], v[180:183], v[36:39], v[108:111]
    ds_read_b64_tr_b16 v[34:35], v3 offset:1024
    s_waitcnt lgkmcnt(10)
    v_mfma_f32_16x16x32_bf16 v[112:115], v[176:179], v[40:43], v[112:115]
    ds_read_b64_tr_b16 v[36:37], v4 offset:0
    v_mfma_f32_16x16x32_bf16 v[116:119], v[180:183], v[40:43], v[116:119]
    ds_read_b64_tr_b16 v[38:39], v4 offset:1024
    v_mfma_f32_16x16x32_bf16 v[120:123], v[176:179], v[44:47], v[120:123]
    ds_read_b64_tr_b16 v[40:41], v5 offset:0
    v_mfma_f32_16x16x32_bf16 v[124:127], v[180:183], v[44:47], v[124:127]
    ds_read_b64_tr_b16 v[42:43], v5 offset:1024
    s_waitcnt lgkmcnt(10)
    v_mfma_f32_16x16x32_bf16 v[96:99], v[184:187], v[48:51], v[96:99]
    ds_read_b64_tr_b16 v[44:45], v6 offset:0
    v_mfma_f32_16x16x32_bf16 v[100:103], v[188:191], v[48:51], v[100:103]
    ds_read_b64_tr_b16 v[46:47], v6 offset:1024
    v_mfma_f32_16x16x32_bf16 v[104:107], v[184:187], v[52:55], v[104:107]
    ds_read_b64_tr_b16 v[48:49], v3 offset:4096
    v_mfma_f32_16x16x32_bf16 v[108:111], v[188:191], v[52:55], v[108:111]
    ds_read_b64_tr_b16 v[50:51], v3 offset:5120
    s_waitcnt lgkmcnt(10)
    v_mfma_f32_16x16x32_bf16 v[112:115], v[184:187], v[56:59], v[112:115]
    ds_read_b64_tr_b16 v[52:53], v4 offset:4096
    v_mfma_f32_16x16x32_bf16 v[116:119], v[188:191], v[56:59], v[116:119]
    ds_read_b64_tr_b16 v[54:55], v4 offset:5120
    v_mfma_f32_16x16x32_bf16 v[120:123], v[184:187], v[60:63], v[120:123]
    ds_read_b64_tr_b16 v[56:57], v5 offset:4096
    v_mfma_f32_16x16x32_bf16 v[124:127], v[188:191], v[60:63], v[124:127]
    ds_read_b64_tr_b16 v[58:59], v5 offset:5120
    s_waitcnt lgkmcnt(10)
    v_mfma_f32_16x16x32_bf16 v[96:99], v[192:195], v[32:35], v[96:99]
    ds_read_b64_tr_b16 v[60:61], v6 offset:4096
    v_mfma_f32_16x16x32_bf16 v[100:103], v[196:199], v[32:35], v[100:103]
    ds_read_b64_tr_b16 v[62:63], v6 offset:5120
    v_mfma_f32_16x16x32_bf16 v[104:107], v[192:195], v[36:39], v[104:107]
    ds_read_b64_tr_b16 v[32:33], v3 offset:8192
    v_mfma_f32_16x16x32_bf16 v[108:111], v[196:199], v[36:39], v[108:111]
    ds_read_b64_tr_b16 v[34:35], v3 offset:9216
    s_waitcnt lgkmcnt(10)
    v_mfma_f32_16x16x32_bf16 v[112:115], v[192:195], v[40:43], v[112:115]
    ds_read_b64_tr_b16 v[36:37], v4 offset:8192
    v_mfma_f32_16x16x32_bf16 v[116:119], v[196:199], v[40:43], v[116:119]
    ds_read_b64_tr_b16 v[38:39], v4 offset:9216
    v_mfma_f32_16x16x32_bf16 v[120:123], v[192:195], v[44:47], v[120:123]
    ds_read_b64_tr_b16 v[40:41], v5 offset:8192
    v_mfma_f32_16x16x32_bf16 v[124:127], v[196:199], v[44:47], v[124:127]
    ds_read_b64_tr_b16 v[42:43], v5 offset:9216
    s_waitcnt lgkmcnt(10)
    v_mfma_f32_16x16x32_bf16 v[96:99], v[200:203], v[48:51], v[96:99]
    ds_read_b64_tr_b16 v[44:45], v6 offset:8192
    v_mfma_f32_16x16x32_bf16 v[100:103], v[204:207], v[48:51], v[100:103]
    ds_read_b64_tr_b16 v[46:47], v6 offset:9216
    v_mfma_f32_16x16x32_bf16 v[104:107], v[200:203], v[52:55], v[104:107]
    ds_read_b64_tr_b16 v[48:49], v3 offset:12288
    v_mfma_f32_16x16x32_bf16 v[108:111], v[204:207], v[52:55], v[108:111]
    ds_read_b64_tr_b16 v[50:51], v3 offset:13312
    s_waitcnt lgkmcnt(10)
    v_mfma_f32_16x16x32_bf16 v[112:115], v[200:203], v[56:59], v[112:115]
    ds_read_b64_tr_b16 v[52:53], v4 offset:12288
    v_mfma_f32_16x16x32_bf16 v[116:119], v[204:207], v[56:59], v[116:119]
    ds_read_b64_tr_b16 v[54:55], v4 offset:13312
    v_mfma_f32_16x16x32_bf16 v[120:123], v[200:203], v[60:63], v[120:123]
    ds_read_b64_tr_b16 v[56:57], v5 offset:12288
    v_mfma_f32_16x16x32_bf16 v[124:127], v[204:207], v[60:63], v[124:127]
    ds_read_b64_tr_b16 v[58:59], v5 offset:13312
    s_waitcnt lgkmcnt(10)
    v_mfma_f32_16x16x32_bf16 v[96:99], v[208:211], v[32:35], v[96:99]
    ds_read_b64_tr_b16 v[60:61], v6 offset:12288
    v_mfma_f32_16x16x32_bf16 v[100:103], v[212:215], v[32:35], v[100:103]
    ds_read_b64_tr_b16 v[62:63], v6 offset:13312
    v_mfma_f32_16x16x32_bf16 v[104:107], v[208:211], v[36:39], v[104:107]
    ds_read_b64_tr_b16 v[32:33], v3 offset:16384
    ds_read_b128 v[16:19], v13 offset:4096
    v_mfma_f32_16x16x32_bf16 v[108:111], v[212:215], v[36:39], v[108:111]
    ds_read_b64_tr_b16 v[34:35], v3 offset:17408
    ds_read_b128 v[20:23], v13 offset:4608
    s_waitcnt lgkmcnt(12)
    v_mfma_f32_16x16x32_bf16 v[112:115], v[208:211], v[40:43], v[112:115]
    ds_read_b64_tr_b16 v[36:37], v4 offset:16384
    ds_read_b128 v[24:27], v13 offset:4160
    v_mfma_f32_16x16x32_bf16 v[116:119], v[212:215], v[40:43], v[116:119]
    ds_read_b64_tr_b16 v[38:39], v4 offset:17408
    ds_read_b128 v[28:31], v13 offset:4672
    v_mfma_f32_16x16x32_bf16 v[120:123], v[208:211], v[44:47], v[120:123]
    ds_read_b64_tr_b16 v[40:41], v5 offset:16384
    ds_read_b32 v8, v15 offset:512
    v_mfma_f32_16x16x32_bf16 v[124:127], v[212:215], v[44:47], v[124:127]
    ds_read_b64_tr_b16 v[42:43], v5 offset:17408
    ds_read_b32 v10, v15 offset:576
    s_waitcnt lgkmcnt(14)
    v_mfma_f32_16x16x32_bf16 v[96:99], v[216:219], v[48:51], v[96:99]
    ds_read_b64_tr_b16 v[44:45], v6 offset:16384
    ds_read_b32 v12, v15 offset:640
    v_mfma_f32_16x16x32_bf16 v[100:103], v[220:223], v[48:51], v[100:103]
    ds_read_b64_tr_b16 v[46:47], v6 offset:17408
    ds_read_b32 v14, v15 offset:704
    v_mfma_f32_16x16x32_bf16 v[104:107], v[216:219], v[52:55], v[104:107]
    ds_read_b64_tr_b16 v[48:49], v3 offset:20480
    v_mfma_f32_16x16x32_bf16 v[108:111], v[220:223], v[52:55], v[108:111]
    ds_read_b64_tr_b16 v[50:51], v3 offset:21504
    s_waitcnt lgkmcnt(14)
    v_mfma_f32_16x16x32_bf16 v[112:115], v[216:219], v[56:59], v[112:115]
    ds_read_b64_tr_b16 v[52:53], v4 offset:20480
    v_mfma_f32_16x16x32_bf16 v[116:119], v[220:223], v[56:59], v[116:119]
    ds_read_b64_tr_b16 v[54:55], v4 offset:21504
    v_mfma_f32_16x16x32_bf16 v[120:123], v[216:219], v[60:63], v[120:123]
    ds_read_b64_tr_b16 v[56:57], v5 offset:20480
    v_mfma_f32_16x16x32_bf16 v[124:127], v[220:223], v[60:63], v[124:127]
    ds_read_b64_tr_b16 v[58:59], v5 offset:21504
    s_waitcnt lgkmcnt(6)
    v_pk_fma_f32 v[100:101], v[8:9], v[24:25], v[100:101] op_sel_hi:[0,1,1] neg_lo:[1,0,0] neg_hi:[1,0,0]
    v_pk_fma_f32 v[102:103], v[8:9], v[26:27], v[102:103] op_sel_hi:[0,1,1] neg_lo:[1,0,0] neg_hi:[1,0,0]
    v_pk_fma_f32 v[108:109], v[10:11], v[24:25], v[108:109] op_sel_hi:[0,1,1] neg_lo:[1,0,0] neg_hi:[1,0,0]
    v_pk_fma_f32 v[110:111], v[10:11], v[26:27], v[110:111] op_sel_hi:[0,1,1] neg_lo:[1,0,0] neg_hi:[1,0,0]
    v_pk_mul_f32 v[100:101], v[28:29], v[100:101]
    v_pk_mul_f32 v[102:103], v[30:31], v[102:103]
    v_pk_mul_f32 v[108:109], v[28:29], v[108:109]
    v_pk_mul_f32 v[110:111], v[30:31], v[110:111]
    v_cvt_pk_bf16_f32 v74, v100, v101
    v_cvt_pk_bf16_f32 v75, v102, v103
    v_cvt_pk_bf16_f32 v78, v108, v109
    v_cvt_pk_bf16_f32 v79, v110, v111
    v_cvt_pk_bf16_f32 v100, v100, v101
    v_cvt_pk_bf16_f32 v101, v102, v103
    v_cvt_pk_bf16_f32 v102, v108, v109
    v_cvt_pk_bf16_f32 v103, v110, v111
    ds_write_b128 v7, v[100:103] offset:6144
    v_pk_fma_f32 v[116:117], v[12:13], v[24:25], v[116:117] op_sel_hi:[0,1,1] neg_lo:[1,0,0] neg_hi:[1,0,0]
    v_pk_fma_f32 v[118:119], v[12:13], v[26:27], v[118:119] op_sel_hi:[0,1,1] neg_lo:[1,0,0] neg_hi:[1,0,0]
    v_pk_fma_f32 v[124:125], v[14:15], v[24:25], v[124:125] op_sel_hi:[0,1,1] neg_lo:[1,0,0] neg_hi:[1,0,0]
    v_pk_fma_f32 v[126:127], v[14:15], v[26:27], v[126:127] op_sel_hi:[0,1,1] neg_lo:[1,0,0] neg_hi:[1,0,0]
    v_pk_mul_f32 v[116:117], v[28:29], v[116:117]
    v_pk_mul_f32 v[118:119], v[30:31], v[118:119]
    v_pk_mul_f32 v[124:125], v[28:29], v[124:125]
    v_pk_mul_f32 v[126:127], v[30:31], v[126:127]
    v_cvt_pk_bf16_f32 v90, v116, v117
    v_cvt_pk_bf16_f32 v91, v118, v119
    v_cvt_pk_bf16_f32 v94, v124, v125
    v_cvt_pk_bf16_f32 v95, v126, v127
    v_cvt_pk_bf16_f32 v116, v116, v117
    v_cvt_pk_bf16_f32 v117, v118, v119
    v_cvt_pk_bf16_f32 v118, v124, v125
    v_cvt_pk_bf16_f32 v119, v126, v127
    ds_write_b128 v7, v[116:119] offset:7168
    s_cmp_lg_u32 s16, 3
    s_cbranch_scc1 a_nh
    buffer_store_dwordx4 v[68:71], v1, s[4:7], s60 offen offset:0 sc1
    buffer_store_dwordx4 v[84:87], v1, s[4:7], s60 offen offset:1024 sc1
    buffer_store_dwordx4 v[100:103], v1, s[4:7], s60 offen offset:2048 sc1
    buffer_store_dwordx4 v[116:119], v1, s[4:7], s60 offen offset:3072 sc1
a_nh:
    v_pk_fma_f32 v[96:97], v[8:9], v[16:17], v[96:97] op_sel_hi:[0,1,1] neg_lo:[1,0,0] neg_hi:[1,0,0]
    v_pk_fma_f32 v[98:99], v[8:9], v[18:19], v[98:99] op_sel_hi:[0,1,1] neg_lo:[1,0,0] neg_hi:[1,0,0]
    v_pk_fma_f32 v[104:105], v[10:11], v[16:17], v[104:105] op_sel_hi:[0,1,1] neg_lo:[1,0,0] neg_hi:[1,0,0]
    v_pk_fma_f32 v[106:107], v[10:11], v[18:19], v[106:107] op_sel_hi:[0,1,1] neg_lo:[1,0,0] neg_hi:[1,0,0]
    v_pk_mul_f32 v[96:97], v[20:21], v[96:97]
    v_pk_mul_f32 v[98:99], v[22:23], v[98:99]
    v_pk_mul_f32 v[104:105], v[20:21], v[104:105]
    v_pk_mul_f32 v[106:107], v[22:23], v[106:107]
    v_cvt_pk_bf16_f32 v72, v96, v97
    v_cvt_pk_bf16_f32 v73, v98, v99
    v_cvt_pk_bf16_f32 v76, v104, v105
    v_cvt_pk_bf16_f32 v77, v106, v107
    v_pk_fma_f32 v[112:113], v[12:13], v[16:17], v[112:113] op_sel_hi:[0,1,1] neg_lo:[1,0,0] neg_hi:[1,0,0]
    v_pk_fma_f32 v[114:115], v[12:13], v[18:19], v[114:115] op_sel_hi:[0,1,1] neg_lo:[1,0,0] neg_hi:[1,0,0]
    v_pk_fma_f32 v[120:121], v[14:15], v[16:17], v[120:121] op_sel_hi:[0,1,1] neg_lo:[1,0,0] neg_hi:[1,0,0]
    v_pk_fma_f32 v[122:123], v[14:15], v[18:19], v[122:123] op_sel_hi:[0,1,1] neg_lo:[1,0,0] neg_hi:[1,0,0]
    v_pk_mul_f32 v[112:113], v[20:21], v[112:113]
    v_pk_mul_f32 v[114:115], v[22:23], v[114:115]
    v_pk_mul_f32 v[120:121], v[20:21], v[120:121]
    v_pk_mul_f32 v[122:123], v[22:23], v[122:123]
    v_cvt_pk_bf16_f32 v88, v112, v113
    v_cvt_pk_bf16_f32 v89, v114, v115
    v_cvt_pk_bf16_f32 v92, v120, v121
    v_cvt_pk_bf16_f32 v93, v122, v123
    v_mfma_f32_16x16x32_bf16 v[128:131], v[32:35], v[224:227], v[128:131]
    ds_read_b64_tr_b16 v[60:61], v6 offset:20480
    v_mfma_f32_16x16x32_bf16 v[132:135], v[32:35], v[228:231], v[132:135]
    ds_read_b64_tr_b16 v[62:63], v6 offset:21504
    v_mfma_f32_16x16x32_bf16 v[136:139], v[36:39], v[224:227], v[136:139]
    ds_read_b64_tr_b16 v[32:33], v3 offset:24576
    v_mfma_f32_16x16x32_bf16 v[140:143], v[36:39], v[228:231], v[140:143]
    ds_read_b64_tr_b16 v[34:35], v3 offset:25600
    v_mfma_f32_16x16x32_bf16 v[144:147], v[40:43], v[224:227], v[144:147]
    ds_read_b64_tr_b16 v[36:37], v4 offset:24576
    v_mfma_f32_16x16x32_bf16 v[148:151], v[40:43], v[228:231], v[148:151]
    ds_read_b64_tr_b16 v[38:39], v4 offset:25600
    v_mfma_f32_16x16x32_bf16 v[152:155], v[44:47], v[224:227], v[152:155]
    ds_read_b64_tr_b16 v[40:41], v5 offset:24576
    v_mfma_f32_16x16x32_bf16 v[156:159], v[44:47], v[228:231], v[156:159]
    ds_read_b64_tr_b16 v[42:43], v5 offset:25600
    s_waitcnt lgkmcnt(12)
    v_mfma_f32_16x16x32_bf16 v[128:131], v[48:51], v[232:235], v[128:131]
    ds_read_b64_tr_b16 v[44:45], v6 offset:24576
    v_mfma_f32_16x16x32_bf16 v[132:135], v[48:51], v[236:239], v[132:135]
    ds_read_b64_tr_b16 v[46:47], v6 offset:25600
    v_mfma_f32_16x16x32_bf16 v[136:139], v[52:55], v[232:235], v[136:139]
    ds_read_b64_tr_b16 v[48:49], v3 offset:28672
    v_mfma_f32_16x16x32_bf16 v[140:143], v[52:55], v[236:239], v[140:143]
    ds_read_b64_tr_b16 v[50:51], v3 offset:29696
    s_waitcnt lgkmcnt(10)
    v_mfma_f32_16x16x32_bf16 v[144:147], v[56:59], v[232:235], v[144:147]
    ds_read_b64_tr_b16 v[52:53], v4 offset:28672
    v_mfma_f32_16x16x32_bf16 v[148:151], v[56:59], v[236:239], v[148:151]
    ds_read_b64_tr_b16 v[54:55], v4 offset:29696
    v_mfma_f32_16x16x32_bf16 v[152:155], v[60:63], v[232:235], v[152:155]
    ds_read_b64_tr_b16 v[56:57], v5 offset:28672
    v_mfma_f32_16x16x32_bf16 v[156:159], v[60:63], v[236:239], v[156:159]
    ds_read_b64_tr_b16 v[58:59], v5 offset:29696
    s_waitcnt lgkmcnt(10)
    v_mfma_f32_16x16x32_bf16 v[128:131], v[32:35], v[240:243], v[128:131]
    ds_read_b64_tr_b16 v[60:61], v6 offset:28672
    v_mfma_f32_16x16x32_bf16 v[132:135], v[32:35], v[244:247], v[132:135]
    ds_read_b64_tr_b16 v[62:63], v6 offset:29696
    s_barrier
    v_mfma_f32_16x16x32_bf16 v[136:139], v[36:39], v[240:243], v[136:139]
    ds_read_b64_tr_b16 v[32:33], v3 offset:32768
    v_mfma_f32_16x16x32_bf16 v[140:143], v[36:39], v[244:247], v[140:143]
    ds_read_b64_tr_b16 v[34:35], v3 offset:33792
    s_waitcnt lgkmcnt(10)
    v_mfma_f32_16x16x32_bf16 v[144:147], v[40:43], v[240:243], v[144:147]
    ds_read_b64_tr_b16 v[36:37], v4 offset:32768
    v_mfma_f32_16x16x32_bf16 v[148:151], v[40:43], v[244:247], v[148:151]
    ds_read_b64_tr_b16 v[38:39], v4 offset:33792
    v_mfma_f32_16x16x32_bf16 v[152:155], v[44:47], v[240:243], v[152:155]
    ds_read_b64_tr_b16 v[40:41], v5 offset:32768
    v_mfma_f32_16x16x32_bf16 v[156:159], v[44:47], v[244:247], v[156:159]
    ds_read_b64_tr_b16 v[42:43], v5 offset:33792
    s_waitcnt lgkmcnt(10)
    v_mfma_f32_16x16x32_bf16 v[128:131], v[48:51], v[248:251], v[128:131]
    ds_read_b64_tr_b16 v[44:45], v6 offset:32768
    v_mfma_f32_16x16x32_bf16 v[132:135], v[48:51], v[252:255], v[132:135]
    ds_read_b64_tr_b16 v[46:47], v6 offset:33792
    v_mfma_f32_16x16x32_bf16 v[136:139], v[52:55], v[248:251], v[136:139]
    ds_read_b64_tr_b16 v[48:49], v3 offset:36864
    v_mfma_f32_16x16x32_bf16 v[140:143], v[52:55], v[252:255], v[140:143]
    ds_read_b64_tr_b16 v[50:51], v3 offset:37888
    s_waitcnt lgkmcnt(10)
    v_mfma_f32_16x16x32_bf16 v[144:147], v[56:59], v[248:251], v[144:147]
    ds_read_b64_tr_b16 v[52:53], v4 offset:36864
    v_mfma_f32_16x16x32_bf16 v[148:151], v[56:59], v[252:255], v[148:151]
    ds_read_b64_tr_b16 v[54:55], v4 offset:37888
    v_mfma_f32_16x16x32_bf16 v[152:155], v[60:63], v[248:251], v[152:155]
    ds_read_b64_tr_b16 v[56:57], v5 offset:36864
    v_mfma_f32_16x16x32_bf16 v[156:159], v[60:63], v[252:255], v[156:159]
    ds_read_b64_tr_b16 v[58:59], v5 offset:37888
    s_waitcnt lgkmcnt(10)
    v_mfma_f32_16x16x32_bf16 v[128:131], v[32:35], v[160:163], v[128:131]
    ds_read_b64_tr_b16 v[60:61], v6 offset:36864
    v_mfma_f32_16x16x32_bf16 v[132:135], v[32:35], v[164:167], v[132:135]
    ds_read_b64_tr_b16 v[62:63], v6 offset:37888
    v_mfma_f32_16x16x32_bf16 v[136:139], v[36:39], v[160:163], v[136:139]
    ds_read_b64_tr_b16 v[32:33], v3 offset:40960
    v_mfma_f32_16x16x32_bf16 v[140:143], v[36:39], v[164:167], v[140:143]
    ds_read_b64_tr_b16 v[34:35], v3 offset:41984
    s_waitcnt lgkmcnt(10)
    v_mfma_f32_16x16x32_bf16 v[144:147], v[40:43], v[160:163], v[144:147]
    ds_read_b64_tr_b16 v[36:37], v4 offset:40960
    v_mfma_f32_16x16x32_bf16 v[148:151], v[40:43], v[164:167], v[148:151]
    ds_read_b64_tr_b16 v[38:39], v4 offset:41984
    v_mfma_f32_16x16x32_bf16 v[152:155], v[44:47], v[160:163], v[152:155]
    ds_read_b64_tr_b16 v[40:41], v5 offset:40960
    v_mfma_f32_16x16x32_bf16 v[156:159], v[44:47], v[164:167], v[156:159]
    ds_read_b64_tr_b16 v[42:43], v5 offset:41984
    s_waitcnt lgkmcnt(10)
    v_mfma_f32_16x16x32_bf16 v[128:131], v[48:51], v[168:171], v[128:131]
    ds_read_b64_tr_b16 v[44:45], v6 offset:40960
    s_cmp_lg_u32 s16, 3
    s_cbranch_scc1 a_nopub
    s_waitcnt vmcnt(0)
    s_atomic_add s40, s[22:23], s61
a_nopub:
    v_mfma_f32_16x16x32_bf16 v[132:135], v[48:51], v[172:175], v[132:135]
    ds_read_b64_tr_b16 v[46:47], v6 offset:41984
    v_mfma_f32_16x16x32_bf16 v[136:139], v[52:55], v[168:171], v[136:139]
    ds_read_b64_tr_b16 v[48:49], v3 offset:45056
    v_mfma_f32_16x16x32_bf16 v[140:143], v[52:55], v[172:175], v[140:143]
    ds_read_b64_tr_b16 v[50:51], v3 offset:46080
    s_waitcnt lgkmcnt(10)
    v_mfma_f32_16x16x32_bf16 v[144:147], v[56:59], v[168:171], v[144:147]
    ds_read_b64_tr_b16 v[52:53], v4 offset:45056
    v_mfma_f32_16x16x32_bf16 v[148:151], v[56:59], v[172:175], v[148:151]
    ds_read_b64_tr_b16 v[54:55], v4 offset:46080
    v_mfma_f32_16x16x32_bf16 v[152:155], v[60:63], v[168:171], v[152:155]
    ds_read_b64_tr_b16 v[56:57], v5 offset:45056
    v_mfma_f32_16x16x32_bf16 v[156:159], v[60:63], v[172:175], v[156:159]
    ds_read_b64_tr_b16 v[58:59], v5 offset:46080
    s_waitcnt lgkmcnt(10)
    v_mfma_f32_16x16x32_bf16 v[128:131], v[32:35], v[176:179], v[128:131]
    ds_read_b64_tr_b16 v[60:61], v6 offset:45056
    v_mfma_f32_16x16x32_bf16 v[132:135], v[32:35], v[180:183], v[132:135]
    ds_read_b64_tr_b16 v[62:63], v6 offset:46080
    v_mfma_f32_16x16x32_bf16 v[136:139], v[36:39], v[176:179], v[136:139]
    ds_read_b64_tr_b16 v[32:33], v3 offset:49152
    v_mfma_f32_16x16x32_bf16 v[140:143], v[36:39], v[180:183], v[140:143]
    ds_read_b64_tr_b16 v[34:35], v3 offset:50176
    s_waitcnt lgkmcnt(10)
    v_mfma_f32_16x16x32_bf16 v[144:147], v[40:43], v[176:179], v[144:147]
    ds_read_b64_tr_b16 v[36:37], v4 offset:49152
    v_mfma_f32_16x16x32_bf16 v[148:151], v[40:43], v[180:183], v[148:151]
    ds_read_b64_tr_b16 v[38:39], v4 offset:50176
    v_mfma_f32_16x16x32_bf16 v[152:155], v[44:47], v[176:179], v[152:155]
    ds_read_b64_tr_b16 v[40:41], v5 offset:49152
    v_mfma_f32_16x16x32_bf16 v[156:159], v[44:47], v[180:183], v[156:159]
    ds_read_b64_tr_b16 v[42:43], v5 offset:50176
    s_waitcnt lgkmcnt(10)
    v_mfma_f32_16x16x32_bf16 v[128:131], v[48:51], v[184:187], v[128:131]
    ds_read_b64_tr_b16 v[44:45], v6 offset:49152
    ds_read_b32 v8, v9 offset:4096
    v_mfma_f32_16x16x32_bf16 v[132:135], v[48:51], v[188:191], v[132:135]
    ds_read_b64_tr_b16 v[46:47], v6 offset:50176
    ds_read_b32 v10, v9 offset:4608
    v_mfma_f32_16x16x32_bf16 v[136:139], v[52:55], v[184:187], v[136:139]
    ds_read_b64_tr_b16 v[48:49], v3 offset:53248
    ds_read_b32 v12, v9 offset:4160
    v_mfma_f32_16x16x32_bf16 v[140:143], v[52:55], v[188:191], v[140:143]
    ds_read_b64_tr_b16 v[50:51], v3 offset:54272
    ds_read_b32 v14, v9 offset:4672
    s_waitcnt lgkmcnt(14)
    v_mfma_f32_16x16x32_bf16 v[144:147], v[56:59], v[184:187], v[144:147]
    ds_read_b64_tr_b16 v[52:53], v4 offset:53248
    ds_read_b128 v[16:19], v11 offset:0
    v_mfma_f32_16x16x32_bf16 v[148:151], v[56:59], v[188:191], v[148:151]
    ds_read_b64_tr_b16 v[54:55], v4 offset:54272
    ds_read_b128 v[20:23], v11 offset:64
    v_mfma_f32_16x16x32_bf16 v[152:155], v[60:63], v[184:187], v[152:155]
    ds_read_b64_tr_b16 v[56:57], v5 offset:53248
    ds_read_b128 v[24:27], v11 offset:128
    v_mfma_f32_16x16x32_bf16 v[156:159], v[60:63], v[188:191], v[156:159]
    ds_read_b64_tr_b16 v[58:59], v5 offset:54272
    ds_read_b128 v[28:31], v11 offset:192
    s_waitcnt lgkmcnt(14)
    v_mfma_f32_16x16x32_bf16 v[128:131], v[32:35], v[192:195], v[128:131]
    ds_read_b64_tr_b16 v[60:61], v6 offset:53248
    v_add_u32 v13, 153600, v1
    v_mfma_f32_16x16x32_bf16 v[132:135], v[32:35], v[196:199], v[132:135]
    ds_read_b64_tr_b16 v[62:63], v6 offset:54272
    v_mfma_f32_16x16x32_bf16 v[136:139], v[36:39], v[192:195], v[136:139]
    ds_read_b64_tr_b16 v[32:33], v3 offset:57344
    v_mfma_f32_16x16x32_bf16 v[140:143], v[36:39], v[196:199], v[140:143]
    ds_read_b64_tr_b16 v[34:35], v3 offset:58368
    s_waitcnt lgkmcnt(14)
    v_mfma_f32_16x16x32_bf16 v[144:147], v[40:43], v[192:195], v[144:147]
    ds_read_b64_tr_b16 v[36:37], v4 offset:57344
    v_mfma_f32_16x16x32_bf16 v[148:151], v[40:43], v[196:199], v[148:151]
    ds_read_b64_tr_b16 v[38:39], v4 offset:58368
    v_mfma_f32_16x16x32_bf16 v[152:155], v[44:47], v[192:195], v[152:155]
    ds_read_b64_tr_b16 v[40:41], v5 offset:57344
    v_mfma_f32_16x16x32_bf16 v[156:159], v[44:47], v[196:199], v[156:159]
    ds_read_b64_tr_b16 v[42:43], v5 offset:58368
    s_waitcnt lgkmcnt(13)
    v_mfma_f32_16x16x32_bf16 v[128:131], v[48:51], v[200:203], v[128:131]
    ds_read_b64_tr_b16 v[44:45], v6 offset:57344
    s_waitcnt lgkmcnt(9)
    v_mfma_f32_16x16x32_bf16 v[132:135], v[48:51], v[204:207], v[132:135]
    ds_read_b64_tr_b16 v[46:47], v6 offset:58368
    v_mul_f32 v10, 0x3e8293ee, v10
    v_mfma_f32_16x16x32_bf16 v[136:139], v[52:55], v[200:203], v[136:139]
    ds_read_b64_tr_b16 v[48:49], v3 offset:61440
    v_mul_f32 v14, 0x3e8293ee, v14
    v_mfma_f32_16x16x32_bf16 v[140:143], v[52:55], v[204:207], v[140:143]
    ds_read_b64_tr_b16 v[50:51], v3 offset:62464
    ds_read_b128 v[120:123], v13 offset:0
    s_waitcnt lgkmcnt(11)
    v_mfma_f32_16x16x32_bf16 v[144:147], v[56:59], v[200:203], v[144:147]
    ds_read_b64_tr_b16 v[52:53], v4 offset:61440
    ds_read_b128 v[124:127], v13 offset:1024
    v_mfma_f32_16x16x32_bf16 v[148:151], v[56:59], v[204:207], v[148:151]
    ds_read_b64_tr_b16 v[54:55], v4 offset:62464
    v_mfma_f32_16x16x32_bf16 v[152:155], v[60:63], v[200:203], v[152:155]
    ds_read_b64_tr_b16 v[56:57], v5 offset:61440
    v_mfma_f32_16x16x32_bf16 v[156:159], v[60:63], v[204:207], v[156:159]
    ds_read_b64_tr_b16 v[58:59], v5 offset:62464
    s_waitcnt lgkmcnt(12)
    v_mfma_f32_16x16x32_bf16 v[128:131], v[32:35], v[208:211], v[128:131]
    ds_read_b64_tr_b16 v[60:61], v6 offset:61440
    v_mfma_f32_16x16x32_bf16 v[132:135], v[32:35], v[212:215], v[132:135]
    ds_read_b64_tr_b16 v[62:63], v6 offset:62464
    v_xor_b32 v3, 0x10000, v3
    v_xor_b32 v4, 0x10000, v4
    v_xor_b32 v5, 0x10000, v5
    v_xor_b32 v6, 0x10000, v6
    v_mfma_f32_16x16x32_bf16 v[136:139], v[36:39], v[208:211], v[136:139]
    v_mfma_f32_16x16x32_bf16 v[140:143], v[36:39], v[212:215], v[140:143]
    s_waitcnt lgkmcnt(10)
    v_mfma_f32_16x16x32_bf16 v[144:147], v[40:43], v[208:211], v[144:147]
    v_mfma_f32_16x16x32_bf16 v[148:151], v[40:43], v[212:215], v[148:151]
    v_mfma_f32_16x16x32_bf16 v[152:155], v[44:47], v[208:211], v[152:155]
    v_mfma_f32_16x16x32_bf16 v[156:159], v[44:47], v[212:215], v[156:159]
    s_waitcnt lgkmcnt(4)
    v_mfma_f32_16x16x32_bf16 v[128:131], v[48:51], v[216:219], v[128:131]
    v_mfma_f32_16x16x32_bf16 v[132:135], v[48:51], v[220:223], v[132:135]
    v_mfma_f32_16x16x32_bf16 v[136:139], v[52:55], v[216:219], v[136:139]
    v_mfma_f32_16x16x32_bf16 v[140:143], v[52:55], v[220:223], v[140:143]
    s_waitcnt lgkmcnt(0)
    v_mfma_f32_16x16x32_bf16 v[144:147], v[56:59], v[216:219], v[144:147]
    v_mfma_f32_16x16x32_bf16 v[148:151], v[56:59], v[220:223], v[148:151]
    v_mfma_f32_16x16x32_bf16 v[152:155], v[60:63], v[216:219], v[152:155]
    v_mfma_f32_16x16x32_bf16 v[156:159], v[60:63], v[220:223], v[156:159]
    s_lshl_b32 s44, s21, 22
    s_lshl_b32 s45, s38, 16
    s_add_u32 s44, s44, s45
    s_lshl_b32 s45, s18, 12
    s_add_u32 s44, s44, s45
    s_add_u32 s52, s44, 16777216
    v_pk_fma_f32 v[132:133], v[12:13], v[16:17], v[132:133] op_sel_hi:[0,1,1] neg_lo:[1,0,0] neg_hi:[1,0,0]
    v_pk_fma_f32 v[134:135], v[12:13], v[18:19], v[134:135] op_sel_hi:[0,1,1] neg_lo:[1,0,0] neg_hi:[1,0,0]
    v_pk_fma_f32 v[140:141], v[12:13], v[20:21], v[140:141] op_sel_hi:[0,1,1] neg_lo:[1,0,0] neg_hi:[1,0,0]
    v_pk_fma_f32 v[142:143], v[12:13], v[22:23], v[142:143] op_sel_hi:[0,1,1] neg_lo:[1,0,0] neg_hi:[1,0,0]
    v_pk_fma_f32 v[148:149], v[12:13], v[24:25], v[148:149] op_sel_hi:[0,1,1] neg_lo:[1,0,0] neg_hi:[1,0,0]
    v_pk_fma_f32 v[150:151], v[12:13], v[26:27], v[150:151] op_sel_hi:[0,1,1] neg_lo:[1,0,0] neg_hi:[1,0,0]
    v_pk_fma_f32 v[156:157], v[12:13], v[28:29], v[156:157] op_sel_hi:[0,1,1] neg_lo:[1,0,0] neg_hi:[1,0,0]
    v_pk_fma_f32 v[158:159], v[12:13], v[30:31], v[158:159] op_sel_hi:[0,1,1] neg_lo:[1,0,0] neg_hi:[1,0,0]
    v_pk_mul_f32 v[132:133], v[14:15], v[132:133] op_sel_hi:[0,1]
    v_pk_mul_f32 v[134:135], v[14:15], v[134:135] op_sel_hi:[0,1]
    v_pk_mul_f32 v[140:141], v[14:15], v[140:141] op_sel_hi:[0,1]
    v_pk_mul_f32 v[142:143], v[14:15], v[142:143] op_sel_hi:[0,1]
    v_pk_mul_f32 v[148:149], v[14:15], v[148:149] op_sel_hi:[0,1]
    v_pk_mul_f32 v[150:151], v[14:15], v[150:151] op_sel_hi:[0,1]
    v_pk_mul_f32 v[156:157], v[14:15], v[156:157] op_sel_hi:[0,1]
    v_pk_mul_f32 v[158:159], v[14:15], v[158:159] op_sel_hi:[0,1]
    v_cvt_pk_bf16_f32 v132, v132, v133
    v_cvt_pk_bf16_f32 v133, v134, v135
    v_cvt_pk_bf16_f32 v134, v140, v141
    v_cvt_pk_bf16_f32 v135, v142, v143
    v_cvt_pk_bf16_f32 v148, v148, v149
    v_cvt_pk_bf16_f32 v149, v150, v151
    v_cvt_pk_bf16_f32 v150, v156, v157
    v_cvt_pk_bf16_f32 v151, v158, v159
    v_mfma_f32_16x16x32_bf16 v[172:175], v[68:71], v[132:135], v[120:123]
    v_mfma_f32_16x16x32_bf16 v[168:171], v[64:67], v[132:135], v[124:127]
    v_mfma_f32_16x16x32_bf16 v[188:191], v[84:87], v[148:151], v[120:123]
    v_mfma_f32_16x16x32_bf16 v[184:187], v[80:83], v[148:151], v[124:127]
    v_pk_fma_f32 v[128:129], v[8:9], v[16:17], v[128:129] op_sel_hi:[0,1,1] neg_lo:[1,0,0] neg_hi:[1,0,0]
    v_pk_fma_f32 v[130:131], v[8:9], v[18:19], v[130:131] op_sel_hi:[0,1,1] neg_lo:[1,0,0] neg_hi:[1,0,0]
    v_pk_fma_f32 v[136:137], v[8:9], v[20:21], v[136:137] op_sel_hi:[0,1,1] neg_lo:[1,0,0] neg_hi:[1,0,0]
    v_pk_fma_f32 v[138:139], v[8:9], v[22:23], v[138:139] op_sel_hi:[0,1,1] neg_lo:[1,0,0] neg_hi:[1,0,0]
    v_pk_fma_f32 v[144:145], v[8:9], v[24:25], v[144:145] op_sel_hi:[0,1,1] neg_lo:[1,0,0] neg_hi:[1,0,0]
    v_pk_fma_f32 v[146:147], v[8:9], v[26:27], v[146:147] op_sel_hi:[0,1,1] neg_lo:[1,0,0] neg_hi:[1,0,0]
    v_pk_fma_f32 v[152:153], v[8:9], v[28:29], v[152:153] op_sel_hi:[0,1,1] neg_lo:[1,0,0] neg_hi:[1,0,0]
    v_pk_fma_f32 v[154:155], v[8:9], v[30:31], v[154:155] op_sel_hi:[0,1,1] neg_lo:[1,0,0] neg_hi:[1,0,0]
    v_pk_mul_f32 v[128:129], v[10:11], v[128:129] op_sel_hi:[0,1]
    v_pk_mul_f32 v[130:131], v[10:11], v[130:131] op_sel_hi:[0,1]
    v_pk_mul_f32 v[136:137], v[10:11], v[136:137] op_sel_hi:[0,1]
    v_pk_mul_f32 v[138:139], v[10:11], v[138:139] op_sel_hi:[0,1]
    v_pk_mul_f32 v[144:145], v[10:11], v[144:145] op_sel_hi:[0,1]
    v_pk_mul_f32 v[146:147], v[10:11], v[146:147] op_sel_hi:[0,1]
    v_pk_mul_f32 v[152:153], v[10:11], v[152:153] op_sel_hi:[0,1]
    v_pk_mul_f32 v[154:155], v[10:11], v[154:155] op_sel_hi:[0,1]
    v_cvt_pk_bf16_f32 v128, v128, v129
    v_cvt_pk_bf16_f32 v129, v130, v131
    v_cvt_pk_bf16_f32 v130, v136, v137
    v_cvt_pk_bf16_f32 v131, v138, v139
    v_cvt_pk_bf16_f32 v144, v144, v145
    v_cvt_pk_bf16_f32 v145, v146, v147
    v_cvt_pk_bf16_f32 v146, v152, v153
    v_cvt_pk_bf16_f32 v147, v154, v155
    v_mfma_f32_16x16x32_bf16 v[164:167], v[64:67], v[128:131], v[120:123]
    s_nop 0
    v_mfma_f32_16x16x32_bf16 v[180:183], v[80:83], v[144:147], v[120:123]
    v_mov_b32 v232, 0x3f803f80
    v_mov_b32 v233, 0x3f803f80
    v_mov_b32 v234, 0x3f803f80
    v_mov_b32 v235, 0x3f803f80
    v_exp_f32 v172, v172
    v_exp_f32 v173, v173
    v_exp_f32 v174, v174
    v_exp_f32 v175, v175
    v_exp_f32 v188, v188
    v_exp_f32 v189, v189
    v_exp_f32 v190, v190
    v_exp_f32 v191, v191
    s_mov_b32 s46, 1006632960
a_exp1:
    v_exp_f32 v168, v168
    v_exp_f32 v169, v169
    v_exp_f32 v170, v170
    v_exp_f32 v171, v171
    v_exp_f32 v184, v184
    v_exp_f32 v185, v185
    v_exp_f32 v186, v186
    v_exp_f32 v187, v187
    v_cvt_pk_bf16_f32 v200, v168, v169
    v_cvt_pk_bf16_f32 v201, v170, v171
    v_cvt_pk_bf16_f32 v202, v172, v173
    v_cvt_pk_bf16_f32 v203, v174, v175
    v_cvt_pk_bf16_f32 v204, v184, v185
    v_cvt_pk_bf16_f32 v205, v186, v187
    v_cvt_pk_bf16_f32 v206, v188, v189
    v_cvt_pk_bf16_f32 v207, v190, v191
    v_mfma_f32_16x16x32_bf16 v[16:19], v[232:235], v[200:203], 0
    s_nop 0
    v_mfma_f32_16x16x32_bf16 v[20:23], v[232:235], v[204:207], 0
    v_mfma_f32_16x16x32_bf16 v[40:43], v[72:75], v[200:203], 0
    v_mfma_f32_16x16x32_bf16 v[44:47], v[76:79], v[200:203], 0
    v_mfma_f32_16x16x32_bf16 v[56:59], v[88:91], v[204:207], 0
    v_mfma_f32_16x16x32_bf16 v[60:63], v[92:95], v[204:207], 0
    v_mov_b32 v218, v72
    v_mov_b32 v219, v73
    v_mov_b32 v222, v76
    v_mov_b32 v223, v77
    v_mov_b32 v226, v88
    v_mov_b32 v227, v89
    v_mov_b32 v230, v92
    v_mov_b32 v231, v93
    v_subrev_u32 v18, 0x21800000, v16
    v_subrev_u32 v22, 0x21800000, v20
    v_max_u32 v18, v18, v22
    v_cmp_le_u32 vcc, s46, v18
    v_rcp_f32 v16, v16
    v_rcp_f32 v20, v20
    s_cbranch_vccnz a_slow1
a_fin1:
    v_pk_mul_f32 v[40:41], v[16:17], v[40:41] op_sel_hi:[0,1]
    v_pk_mul_f32 v[42:43], v[16:17], v[42:43] op_sel_hi:[0,1]
    v_pk_mul_f32 v[44:45], v[16:17], v[44:45] op_sel_hi:[0,1]
    v_pk_mul_f32 v[46:47], v[16:17], v[46:47] op_sel_hi:[0,1]
    v_pk_mul_f32 v[56:57], v[20:21], v[56:57] op_sel_hi:[0,1]
    v_pk_mul_f32 v[58:59], v[20:21], v[58:59] op_sel_hi:[0,1]
    v_pk_mul_f32 v[60:61], v[20:21], v[60:61] op_sel_hi:[0,1]
    v_pk_mul_f32 v[62:63], v[20:21], v[62:63] op_sel_hi:[0,1]
    v_cvt_pk_bf16_f32 v40, v40, v41
    v_cvt_pk_bf16_f32 v41, v42, v43
    v_cvt_pk_bf16_f32 v42, v44, v45
    v_cvt_pk_bf16_f32 v43, v46, v47
    v_cvt_pk_bf16_f32 v56, v56, v57
    v_cvt_pk_bf16_f32 v57, v58, v59
    v_cvt_pk_bf16_f32 v58, v60, v61
    v_cvt_pk_bf16_f32 v59, v62, v63
    v_permlane32_swap_b32 v40, v42
    v_permlane32_swap_b32 v41, v43
    buffer_store_dwordx4 v[40:43], v2, s[4:7], s52 offen offset:256 sc1
    v_permlane32_swap_b32 v56, v58
    v_permlane32_swap_b32 v57, v59
    buffer_store_dwordx4 v[56:59], v2, s[4:7], s52 offen offset:2304 sc1
    s_cmp_lg_u32 s38, 0
    s_cbranch_scc1 a_hasprev
    v_mov_b32 v124, 0xf149f2ca
    v_mov_b32 v125, 0xf149f2ca
    v_mov_b32 v126, 0xf149f2ca
    v_mov_b32 v127, 0xf149f2ca
a_hasprev:
    s_waitcnt lgkmcnt(0)
    s_barrier
    ds_read_b128 v[192:195], v7 offset:0
    ds_read_b128 v[196:199], v7 offset:1024
    ds_read_b64 v[216:217], v7 offset:2048
    ds_read_b64 v[220:221], v7 offset:2056
    ds_read_b64 v[224:225], v7 offset:3072
    ds_read_b64 v[228:229], v7 offset:3080
    s_waitcnt lgkmcnt(4)
    v_mfma_f32_16x16x32_bf16 v[160:163], v[192:195], v[128:131], v[124:127]
    v_mfma_f32_16x16x32_bf16 v[176:179], v[196:199], v[144:147], v[124:127]
    v_exp_f32 v164, v164
    v_exp_f32 v165, v165
    v_exp_f32 v166, v166
    v_exp_f32 v167, v167
    v_exp_f32 v180, v180
    v_exp_f32 v181, v181
    v_exp_f32 v182, v182
    v_exp_f32 v183, v183
    s_waitcnt lgkmcnt(0)
    s_mov_b32 s46, 1006632960
a_exp0:
    v_exp_f32 v160, v160
    v_exp_f32 v161, v161
    v_exp_f32 v162, v162
    v_exp_f32 v163, v163
    v_exp_f32 v176, v176
    v_exp_f32 v177, v177
    v_exp_f32 v178, v178
    v_exp_f32 v179, v179
    v_cvt_pk_bf16_f32 v200, v160, v161
    v_cvt_pk_bf16_f32 v201, v162, v163
    v_cvt_pk_bf16_f32 v202, v164, v165
    v_cvt_pk_bf16_f32 v203, v166, v167
    v_cvt_pk_bf16_f32 v204, v176, v177
    v_cvt_pk_bf16_f32 v205, v178, v179
    v_cvt_pk_bf16_f32 v206, v180, v181
    v_cvt_pk_bf16_f32 v207, v182, v183
    v_mfma_f32_16x16x32_bf16 v[16:19], v[232:235], v[200:203], 0
    s_nop 0
    v_mfma_f32_16x16x32_bf16 v[20:23], v[232:235], v[204:207], 0
    v_mfma_f32_16x16x32_bf16 v[32:35], v[216:219], v[200:203], 0
    v_mfma_f32_16x16x32_bf16 v[36:39], v[220:223], v[200:203], 0
    v_mfma_f32_16x16x32_bf16 v[48:51], v[224:227], v[204:207], 0
    v_mfma_f32_16x16x32_bf16 v[52:55], v[228:231], v[204:207], 0
    s_nop 1
    v_subrev_u32 v18, 0x21800000, v16
    s_nop 0
    v_subrev_u32 v22, 0x21800000, v20
    v_max_u32 v18, v18, v22
    v_cmp_le_u32 vcc, s46, v18
    v_rcp_f32 v16, v16
    v_rcp_f32 v20, v20
    s_cbranch_vccnz a_slow0
a_fin0:
    v_pk_mul_f32 v[32:33], v[16:17], v[32:33] op_sel_hi:[0,1]
    v_pk_mul_f32 v[34:35], v[16:17], v[34:35] op_sel_hi:[0,1]
    v_pk_mul_f32 v[36:37], v[16:17], v[36:37] op_sel_hi:[0,1]
    v_pk_mul_f32 v[38:39], v[16:17], v[38:39] op_sel_hi:[0,1]
    v_pk_mul_f32 v[48:49], v[20:21], v[48:49] op_sel_hi:[0,1]
    v_pk_mul_f32 v[50:51], v[20:21], v[50:51] op_sel_hi:[0,1]
    v_pk_mul_f32 v[52:53], v[20:21], v[52:53] op_sel_hi:[0,1]
    v_pk_mul_f32 v[54:55], v[20:21], v[54:55] op_sel_hi:[0,1]
    v_cvt_pk_bf16_f32 v32, v32, v33
    v_cvt_pk_bf16_f32 v33, v34, v35
    v_cvt_pk_bf16_f32 v34, v36, v37
    v_cvt_pk_bf16_f32 v35, v38, v39
    v_cvt_pk_bf16_f32 v48, v48, v49
    v_cvt_pk_bf16_f32 v49, v50, v51
    v_cvt_pk_bf16_f32 v50, v52, v53
    v_cvt_pk_bf16_f32 v51, v54, v55
    v_permlane32_swap_b32 v32, v34
    v_permlane32_swap_b32 v33, v35
    buffer_store_dwordx4 v[32:35], v2, s[4:7], s52 offen offset:0 sc1
    v_permlane32_swap_b32 v48, v50
    v_permlane32_swap_b32 v49, v51
    buffer_store_dwordx4 v[48:51], v2, s[4:7], s52 offen offset:2048 sc1
    s_lshl_b32 s44, s21, 22
    s_lshl_b32 s45, s38, 16
    s_add_u32 s41, s44, s45
    s_lshl_b32 s45, s18, 12
    s_add_u32 s43, s41, s45
    s_and_b32 s45, s45, 0
    s_add_u32 s41, s41, s45
    s_add_u32 s41, s41, 16777216
    buffer_load_dwordx4 v[224:227], v2, s[4:7], s43 offen offset:0 sc1
    buffer_load_dwordx4 v[228:231], v2, s[4:7], s43 offen offset:256 sc1
    buffer_load_dwordx4 v[232:235], v2, s[4:7], s43 offen offset:2048 sc1
    buffer_load_dwordx4 v[236:239], v2, s[4:7], s43 offen offset:2304 sc1
    s_barrier
    s_lshl_b32 s47, s21, 14
    s_lshl_b32 s67, s38, 8
    s_add_u32 s47, s47, s67
    s_add_u32 s47, s47, 86144
    s_mov_b32 s68, 1
    s_waitcnt vmcnt(4)
    s_atomic_add s68, s[22:23], s47 glc
    v_lshrrev_b32 v12, 4, v1
    v_and_b32 v13, 1, v12
    v_lshlrev_b32 v13, 4, v13
    v_mov_b32 v14, 0x3f80
    v_lshlrev_b32 v13, v13, v14
    v_lshrrev_b32 v14, 2, v12
    v_lshrrev_b32 v15, 4, v12
    v_xor_b32 v14, v14, v15
    v_and_b32 v14, 1, v14
    v_bfe_u32 v15, v12, 3, 1
    v_bfe_u32 v16, v12, 1, 1
    v_lshl_add_u32 v15, v15, 1, v16
    v_lshrrev_b32 v16, 5, v12
    v_lshl_add_u32 v15, v16, 2, v15
    v_lshl_add_u32 v15, v14, 3, v15
    v_cmp_eq_u32 vcc, 0, v15
    s_nop 1
    v_cndmask_b32 v240, 0, v13, vcc
    v_cmp_eq_u32 vcc, 1, v15
    s_nop 1
    v_cndmask_b32 v241, 0, v13, vcc
    v_cmp_eq_u32 vcc, 2, v15
    s_nop 1
    v_cndmask_b32 v242, 0, v13, vcc
    v_cmp_eq_u32 vcc, 3, v15
    s_nop 1
    v_cndmask_b32 v243, 0, v13, vcc
    v_cmp_eq_u32 vcc, 4, v15
    s_nop 1
    v_cndmask_b32 v244, 0, v13, vcc
    v_cmp_eq_u32 vcc, 5, v15
    s_nop 1
    v_cndmask_b32 v245, 0, v13, vcc
    v_cmp_eq_u32 vcc, 6, v15
    s_nop 1
    v_cndmask_b32 v246, 0, v13, vcc
    v_cmp_eq_u32 vcc, 7, v15
    s_nop 1
    v_cndmask_b32 v247, 0, v13, vcc
    s_mov_b32 s8, s32
    s_mov_b32 s9, s33
    s_mov_b32 s10, 4194304
    s_mov_b32 s11, 0x00020000
    s_mul_i32 s49, s16, 4608
    s_add_u32 s49, s49, 131072
    v_and_b32 v13, 15, v12
    v_mul_u32_u24 v13, 144, v13
    v_lshrrev_b32 v14, 4, v12
    v_lshl_add_u32 v13, v14, 3, v13
    v_add_u32 v17, s49, v13
    v_lshrrev_b32 v14, 3, v12
    v_and_b32 v15, 7, v12
    v_mul_u32_u24 v16, 144, v14
    v_lshl_add_u32 v16, v15, 4, v16
    v_add_u32 v18, s49, v16
    v_lshlrev_b32 v19, 11, v14
    v_lshl_add_u32 v19, v15, 4, v19
    s_lshl_b32 s50, s38, 16
    s_lshl_b32 s49, s18, 7
    s_add_u32 s50, s50, s49
    s_waitcnt vmcnt(0)
    v_mfma_f32_16x16x32_bf16 v[128:131], v[240:243], v[224:227], 0
    v_mfma_f32_16x16x32_bf16 v[132:135], v[240:243], v[228:231], 0
    v_mfma_f32_16x16x32_bf16 v[136:139], v[244:247], v[224:227], 0
    v_mfma_f32_16x16x32_bf16 v[140:143], v[244:247], v[228:231], 0
    v_mfma_f32_16x16x32_bf16 v[144:147], v[240:243], v[232:235], 0
    v_mfma_f32_16x16x32_bf16 v[148:151], v[240:243], v[236:239], 0
    v_mfma_f32_16x16x32_bf16 v[152:155], v[244:247], v[232:235], 0
    v_mfma_f32_16x16x32_bf16 v[156:159], v[244:247], v[236:239], 0
    ds_read_b64_tr_b16 v[32:33], v3 offset:0
    ds_read_b64_tr_b16 v[34:35], v3 offset:1024
    ds_read_b64_tr_b16 v[36:37], v4 offset:0
    ds_read_b64_tr_b16 v[38:39], v4 offset:1024
    ds_read_b64_tr_b16 v[40:41], v5 offset:0
    ds_read_b64_tr_b16 v[42:43], v5 offset:1024
    ds_read_b64_tr_b16 v[44:45], v6 offset:0
    ds_read_b64_tr_b16 v[46:47], v6 offset:1024
    ds_read_b64_tr_b16 v[48:49], v3 offset:4096
    ds_read_b64_tr_b16 v[50:51], v3 offset:5120
    ds_read_b64_tr_b16 v[52:53], v4 offset:4096
    ds_read_b64_tr_b16 v[54:55], v4 offset:5120
    ds_read_b64_tr_b16 v[56:57], v5 offset:4096
    ds_read_b64_tr_b16 v[58:59], v5 offset:5120
    s_mov_b32 s66, 0x10000
    s_waitcnt lgkmcnt(0)
    s_cmp_eq_u32 s68, 15
    s_cbranch_scc1 c_o_ok
c_o_poll:
    s_mov_b32 s68, 0
    s_atomic_add s68, s[22:23], s47 offset:0 glc
    s_sub_u32 s66, s66, 1
    s_cselect_b32 s67, 16, 0
    s_waitcnt lgkmcnt(0)
    s_max_u32 s68, s68, s67
    s_cmp_lt_u32 s68, 16
    s_cbranch_scc1 c_o_poll
c_o_ok:
    s_xor_b32 s42, s41, 0
    buffer_load_dwordx4 v[64:67], v2, s[4:7], s42 offen offset:0 sc1
    buffer_load_dwordx4 v[68:71], v2, s[4:7], s42 offen offset:256 sc1
    s_xor_b32 s42, s41, 4096
    buffer_load_dwordx4 v[72:75], v2, s[4:7], s42 offen offset:0 sc1
    buffer_load_dwordx4 v[76:79], v2, s[4:7], s42 offen offset:256 sc1
    s_xor_b32 s42, s41, 8192
    buffer_load_dwordx4 v[80:83], v2, s[4:7], s42 offen offset:0 sc1
    buffer_load_dwordx4 v[84:87], v2, s[4:7], s42 offen offset:256 sc1
    s_xor_b32 s42, s41, 12288
    buffer_load_dwordx4 v[88:91], v2, s[4:7], s42 offen offset:0 sc1
    buffer_load_dwordx4 v[92:95], v2, s[4:7], s42 offen offset:256 sc1
    s_xor_b32 s42, s41, 16384
    buffer_load_dwordx4 v[96:99], v2, s[4:7], s42 offen offset:0 sc1
    buffer_load_dwordx4 v[100:103], v2, s[4:7], s42 offen offset:256 sc1
    s_branch c_wo
a_slow1:
    s_cmp_eq_u32 s46, 0
    s_cbranch_scc1 a_fin1
    s_mov_b32 s46, 0
    v_mfma_f32_16x16x32_bf16 v[172:175], v[68:71], v[132:135], v[120:123]
    v_mfma_f32_16x16x32_bf16 v[168:171], v[64:67], v[132:135], v[124:127]
    v_mfma_f32_16x16x32_bf16 v[188:191], v[84:87], v[148:151], v[120:123]
    v_mfma_f32_16x16x32_bf16 v[184:187], v[80:83], v[148:151], v[124:127]
    s_nop 5
    v_max3_f32 v24, v168, v169, v170
    v_max3_f32 v24, v24, v171, v172
    v_max3_f32 v24, v24, v173, v174
    v_max_f32 v24, v24, v175
    v_max3_f32 v26, v184, v185, v186
    v_max3_f32 v26, v26, v187, v188
    v_max3_f32 v26, v26, v189, v190
    v_max_f32 v26, v26, v191
    v_mov_b32 v25, v24
    v_mov_b32 v27, v26
    s_nop 0
    v_permlane32_swap_b32 v24, v25
    v_permlane32_swap_b32 v26, v27
    v_max_f32 v24, v24, v25
    v_max_f32 v26, v26, v27
    v_mov_b32 v25, v24
    v_mov_b32 v27, v26
    s_nop 0
    v_permlane16_swap_b32 v24, v25
    v_permlane16_swap_b32 v26, v27
    v_max_f32 v24, v24, v25
    v_max_f32 v26, v26, v27
    v_sub_f32 v168, v168, v24
    v_sub_f32 v169, v169, v24
    v_sub_f32 v170, v170, v24
    v_sub_f32 v171, v171, v24
    v_sub_f32 v172, v172, v24
    v_sub_f32 v173, v173, v24
    v_sub_f32 v174, v174, v24
    v_sub_f32 v175, v175, v24
    v_sub_f32 v184, v184, v26
    v_sub_f32 v185, v185, v26
    v_sub_f32 v186, v186, v26
    v_sub_f32 v187, v187, v26
    v_sub_f32 v188, v188, v26
    v_sub_f32 v189, v189, v26
    v_sub_f32 v190, v190, v26
    v_sub_f32 v191, v191, v26
    v_exp_f32 v172, v172
    v_exp_f32 v173, v173
    v_exp_f32 v174, v174
    v_exp_f32 v175, v175
    v_exp_f32 v188, v188
    v_exp_f32 v189, v189
    v_exp_f32 v190, v190
    v_exp_f32 v191, v191
    s_branch a_exp1
a_slow0:
    s_cmp_eq_u32 s46, 0
    s_cbranch_scc1 a_fin0
    s_mov_b32 s46, 0
    v_mfma_f32_16x16x32_bf16 v[164:167], v[64:67], v[128:131], v[120:123]
    v_mfma_f32_16x16x32_bf16 v[160:163], v[192:195], v[128:131], v[124:127]
    v_mfma_f32_16x16x32_bf16 v[180:183], v[80:83], v[144:147], v[120:123]
    v_mfma_f32_16x16x32_bf16 v[176:179], v[196:199], v[144:147], v[124:127]
    s_nop 5
    v_max3_f32 v24, v160, v161, v162
    v_max3_f32 v24, v24, v163, v164
    v_max3_f32 v24, v24, v165, v166
    v_max_f32 v24, v24, v167
    v_max3_f32 v26, v176, v177, v178
    v_max3_f32 v26, v26, v179, v180
    v_max3_f32 v26, v26, v181, v182
    v_max_f32 v26, v26, v183
    v_mov_b32 v25, v24
    v_mov_b32 v27, v26
    s_nop 0
    v_permlane32_swap_b32 v24, v25
    v_permlane32_swap_b32 v26, v27
    v_max_f32 v24, v24, v25
    v_max_f32 v26, v26, v27
    v_mov_b32 v25, v24
    v_mov_b32 v27, v26
    s_nop 0
    v_permlane16_swap_b32 v24, v25
    v_permlane16_swap_b32 v26, v27
    v_max_f32 v24, v24, v25
    v_max_f32 v26, v26, v27
    v_sub_f32 v160, v160, v24
    v_sub_f32 v161, v161, v24
    v_sub_f32 v162, v162, v24
    v_sub_f32 v163, v163, v24
    v_sub_f32 v164, v164, v24
    v_sub_f32 v165, v165, v24
    v_sub_f32 v166, v166, v24
    v_sub_f32 v167, v167, v24
    v_sub_f32 v176, v176, v26
    v_sub_f32 v177, v177, v26
    v_sub_f32 v178, v178, v26
    v_sub_f32 v179, v179, v26
    v_sub_f32 v180, v180, v26
    v_sub_f32 v181, v181, v26
    v_sub_f32 v182, v182, v26
    v_sub_f32 v183, v183, v26
    v_exp_f32 v164, v164
    v_exp_f32 v165, v165
    v_exp_f32 v166, v166
    v_exp_f32 v167, v167
    v_exp_f32 v180, v180
    v_exp_f32 v181, v181
    v_exp_f32 v182, v182
    v_exp_f32 v183, v183
    s_branch a_exp0
c_B:
    s_waitcnt lgkmcnt(6)
    v_pk_fma_f32 v[64:65], v[8:9], v[16:17], v[64:65] op_sel_hi:[0,1,1] neg_lo:[1,0,0] neg_hi:[1,0,0]
    v_pk_fma_f32 v[66:67], v[8:9], v[18:19], v[66:67] op_sel_hi:[0,1,1] neg_lo:[1,0,0] neg_hi:[1,0,0]
    v_pk_fma_f32 v[72:73], v[8:9], v[20:21], v[72:73] op_sel_hi:[0,1,1] neg_lo:[1,0,0] neg_hi:[1,0,0]
    v_pk_fma_f32 v[74:75], v[8:9], v[22:23], v[74:75] op_sel_hi:[0,1,1] neg_lo:[1,0,0] neg_hi:[1,0,0]
    v_pk_mul_f32 v[64:65], v[10:11], v[64:65] op_sel_hi:[0,1]
    v_pk_mul_f32 v[66:67], v[10:11], v[66:67] op_sel_hi:[0,1]
    v_pk_mul_f32 v[72:73], v[10:11], v[72:73] op_sel_hi:[0,1]
    v_pk_mul_f32 v[74:75], v[10:11], v[74:75] op_sel_hi:[0,1]
    v_cvt_pk_bf16_f32 v64, v64, v65
    v_cvt_pk_bf16_f32 v65, v66, v67
    v_cvt_pk_bf16_f32 v66, v72, v73
    v_cvt_pk_bf16_f32 v67, v74, v75
    s_add_u32 s55, s52, 0
    buffer_store_dwordx4 v[64:67], v2, s[4:7], s55 offen offset:0 sc1
    v_pk_fma_f32 v[68:69], v[12:13], v[16:17], v[68:69] op_sel_hi:[0,1,1] neg_lo:[1,0,0] neg_hi:[1,0,0]
    v_pk_fma_f32 v[70:71], v[12:13], v[18:19], v[70:71] op_sel_hi:[0,1,1] neg_lo:[1,0,0] neg_hi:[1,0,0]
    v_pk_fma_f32 v[76:77], v[12:13], v[20:21], v[76:77] op_sel_hi:[0,1,1] neg_lo:[1,0,0] neg_hi:[1,0,0]
    v_pk_fma_f32 v[78:79], v[12:13], v[22:23], v[78:79] op_sel_hi:[0,1,1] neg_lo:[1,0,0] neg_hi:[1,0,0]
    v_pk_mul_f32 v[68:69], v[14:15], v[68:69] op_sel_hi:[0,1]
    v_pk_mul_f32 v[70:71], v[14:15], v[70:71] op_sel_hi:[0,1]
    v_pk_mul_f32 v[76:77], v[14:15], v[76:77] op_sel_hi:[0,1]
    v_pk_mul_f32 v[78:79], v[14:15], v[78:79] op_sel_hi:[0,1]
    v_cvt_pk_bf16_f32 v68, v68, v69
    v_cvt_pk_bf16_f32 v69, v70, v71
    v_cvt_pk_bf16_f32 v70, v76, v77
    v_cvt_pk_bf16_f32 v71, v78, v79
    buffer_store_dwordx4 v[68:71], v2, s[4:7], s55 offen offset:256 sc1
    v_pk_fma_f32 v[80:81], v[8:9], v[24:25], v[80:81] op_sel_hi:[0,1,1] neg_lo:[1,0,0] neg_hi:[1,0,0]
    v_pk_fma_f32 v[82:83], v[8:9], v[26:27], v[82:83] op_sel_hi:[0,1,1] neg_lo:[1,0,0] neg_hi:[1,0,0]
    v_pk_fma_f32 v[88:89], v[8:9], v[28:29], v[88:89] op_sel_hi:[0,1,1] neg_lo:[1,0,0] neg_hi:[1,0,0]
    v_pk_fma_f32 v[90:91], v[8:9], v[30:31], v[90:91] op_sel_hi:[0,1,1] neg_lo:[1,0,0] neg_hi:[1,0,0]
    v_pk_mul_f32 v[80:81], v[10:11], v[80:81] op_sel_hi:[0,1]
    v_pk_mul_f32 v[82:83], v[10:11], v[82:83] op_sel_hi:[0,1]
    v_pk_mul_f32 v[88:89], v[10:11], v[88:89] op_sel_hi:[0,1]
    v_pk_mul_f32 v[90:91], v[10:11], v[90:91] op_sel_hi:[0,1]
    v_cvt_pk_bf16_f32 v80, v80, v81
    v_cvt_pk_bf16_f32 v81, v82, v83
    v_cvt_pk_bf16_f32 v82, v88, v89
    v_cvt_pk_bf16_f32 v83, v90, v91
    s_add_u32 s55, s52, 131072
    buffer_store_dwordx4 v[80:83], v2, s[4:7], s55 offen offset:0 sc1
    v_pk_fma_f32 v[84:85], v[12:13], v[24:25], v[84:85] op_sel_hi:[0,1,1] neg_lo:[1,0,0] neg_hi:[1,0,0]
    v_pk_fma_f32 v[86:87], v[12:13], v[26:27], v[86:87] op_sel_hi:[0,1,1] neg_lo:[1,0,0] neg_hi:[1,0,0]
    v_pk_fma_f32 v[92:93], v[12:13], v[28:29], v[92:93] op_sel_hi:[0,1,1] neg_lo:[1,0,0] neg_hi:[1,0,0]
    v_pk_fma_f32 v[94:95], v[12:13], v[30:31], v[94:95] op_sel_hi:[0,1,1] neg_lo:[1,0,0] neg_hi:[1,0,0]
    v_pk_mul_f32 v[84:85], v[14:15], v[84:85] op_sel_hi:[0,1]
    v_pk_mul_f32 v[86:87], v[14:15], v[86:87] op_sel_hi:[0,1]
    v_pk_mul_f32 v[92:93], v[14:15], v[92:93] op_sel_hi:[0,1]
    v_pk_mul_f32 v[94:95], v[14:15], v[94:95] op_sel_hi:[0,1]
    v_cvt_pk_bf16_f32 v84, v84, v85
    v_cvt_pk_bf16_f32 v85, v86, v87
    v_cvt_pk_bf16_f32 v86, v92, v93
    v_cvt_pk_bf16_f32 v87, v94, v95
    buffer_store_dwordx4 v[84:87], v2, s[4:7], s55 offen offset:256 sc1
    v_mfma_f32_16x16x32_bf16 v[96:99], v[160:163], v[32:35], v[96:99]
    ds_read_b64_tr_b16 v[60:61], v6 offset:53248
    v_mfma_f32_16x16x32_bf16 v[100:103], v[164:167], v[32:35], v[100:103]
    ds_read_b64_tr_b16 v[62:63], v6 offset:54272
    v_mfma_f32_16x16x32_bf16 v[104:107], v[160:163], v[36:39], v[104:107]
    ds_read_b64_tr_b16 v[32:33], v3 offset:57344
    v_mfma_f32_16x16x32_bf16 v[108:111], v[164:167], v[36:39], v[108:111]
    ds_read_b64_tr_b16 v[34:35], v3 offset:58368
    v_mfma_f32_16x16x32_bf16 v[112:115], v[160:163], v[40:43], v[112:115]
    ds_read_b64_tr_b16 v[36:37], v4 offset:57344
    v_mfma_f32_16x16x32_bf16 v[116:119], v[164:167], v[40:43], v[116:119]
    ds_read_b64_tr_b16 v[38:39], v4 offset:58368
    v_mfma_f32_16x16x32_bf16 v[120:123], v[160:163], v[44:47], v[120:123]
    ds_read_b64_tr_b16 v[40:41], v5 offset:57344
    v_mfma_f32_16x16x32_bf16 v[124:127], v[164:167], v[44:47], v[124:127]
    ds_read_b64_tr_b16 v[42:43], v5 offset:58368
    s_waitcnt lgkmcnt(10)
    v_mfma_f32_16x16x32_bf16 v[96:99], v[168:171], v[48:51], v[96:99]
    ds_read_b64_tr_b16 v[44:45], v6 offset:57344
    v_mfma_f32_16x16x32_bf16 v[100:103], v[172:175], v[48:51], v[100:103]
    ds_read_b64_tr_b16 v[46:47], v6 offset:58368
    v_mfma_f32_16x16x32_bf16 v[104:107], v[168:171], v[52:55], v[104:107]
    ds_read_b64_tr_b16 v[48:49], v3 offset:61440
    v_mfma_f32_16x16x32_bf16 v[108:111], v[172:175], v[52:55], v[108:111]
    ds_read_b64_tr_b16 v[50:51], v3 offset:62464
    s_waitcnt lgkmcnt(10)
    v_mfma_f32_16x16x32_bf16 v[112:115], v[168:171], v[56:59], v[112:115]
    ds_read_b64_tr_b16 v[52:53], v4 offset:61440
    v_mfma_f32_16x16x32_bf16 v[116:119], v[172:175], v[56:59], v[116:119]
    ds_read_b64_tr_b16 v[54:55], v4 offset:62464
    v_mfma_f32_16x16x32_bf16 v[120:123], v[168:171], v[60:63], v[120:123]
    ds_read_b64_tr_b16 v[56:57], v5 offset:61440
    v_mfma_f32_16x16x32_bf16 v[124:127], v[172:175], v[60:63], v[124:127]
    ds_read_b64_tr_b16 v[58:59], v5 offset:62464
    s_waitcnt lgkmcnt(10)
    v_mfma_f32_16x16x32_bf16 v[96:99], v[176:179], v[32:35], v[96:99]
    ds_read_b64_tr_b16 v[60:61], v6 offset:61440
    v_mfma_f32_16x16x32_bf16 v[100:103], v[180:183], v[32:35], v[100:103]
    ds_read_b64_tr_b16 v[62:63], v6 offset:62464
    s_barrier
    v_xor_b32 v3, 0x10000, v3
    v_xor_b32 v4, 0x10000, v4
    v_xor_b32 v5, 0x10000, v5
    v_xor_b32 v6, 0x10000, v6
    v_mfma_f32_16x16x32_bf16 v[104:107], v[176:179], v[36:39], v[104:107]
    ds_read_b64_tr_b16 v[32:33], v3 offset:0
    v_mfma_f32_16x16x32_bf16 v[108:111], v[180:183], v[36:39], v[108:111]
    ds_read_b64_tr_b16 v[34:35], v3 offset:1024
    s_waitcnt lgkmcnt(10)
    v_mfma_f32_16x16x32_bf16 v[112:115], v[176:179], v[40:43], v[112:115]
    ds_read_b64_tr_b16 v[36:37], v4 offset:0
    v_mfma_f32_16x16x32_bf16 v[116:119], v[180:183], v[40:43], v[116:119]
    ds_read_b64_tr_b16 v[38:39], v4 offset:1024
    v_mfma_f32_16x16x32_bf16 v[120:123], v[176:179], v[44:47], v[120:123]
    ds_read_b64_tr_b16 v[40:41], v5 offset:0
    v_mfma_f32_16x16x32_bf16 v[124:127], v[180:183], v[44:47], v[124:127]
    ds_read_b64_tr_b16 v[42:43], v5 offset:1024
    s_waitcnt lgkmcnt(10)
    v_mfma_f32_16x16x32_bf16 v[96:99], v[184:187], v[48:51], v[96:99]
    ds_read_b64_tr_b16 v[44:45], v6 offset:0
    v_mfma_f32_16x16x32_bf16 v[100:103], v[188:191], v[48:51], v[100:103]
    ds_read_b64_tr_b16 v[46:47], v6 offset:1024
    v_mfma_f32_16x16x32_bf16 v[104:107], v[184:187], v[52:55], v[104:107]
    ds_read_b64_tr_b16 v[48:49], v3 offset:4096
    v_mfma_f32_16x16x32_bf16 v[108:111], v[188:191], v[52:55], v[108:111]
    ds_read_b64_tr_b16 v[50:51], v3 offset:5120
    s_waitcnt lgkmcnt(10)
    v_mfma_f32_16x16x32_bf16 v[112:115], v[184:187], v[56:59], v[112:115]
    ds_read_b64_tr_b16 v[52:53], v4 offset:4096
    v_mfma_f32_16x16x32_bf16 v[116:119], v[188:191], v[56:59], v[116:119]
    ds_read_b64_tr_b16 v[54:55], v4 offset:5120
    v_mfma_f32_16x16x32_bf16 v[120:123], v[184:187], v[60:63], v[120:123]
    ds_read_b64_tr_b16 v[56:57], v5 offset:4096
    v_mfma_f32_16x16x32_bf16 v[124:127], v[188:191], v[60:63], v[124:127]
    ds_read_b64_tr_b16 v[58:59], v5 offset:5120
    s_waitcnt lgkmcnt(10)
    v_mfma_f32_16x16x32_bf16 v[96:99], v[192:195], v[32:35], v[96:99]
    ds_read_b64_tr_b16 v[60:61], v6 offset:4096
    v_mfma_f32_16x16x32_bf16 v[100:103], v[196:199], v[32:35], v[100:103]
    ds_read_b64_tr_b16 v[62:63], v6 offset:5120
    v_mfma_f32_16x16x32_bf16 v[104:107], v[192:195], v[36:39], v[104:107]
    ds_read_b64_tr_b16 v[32:33], v3 offset:8192
    v_mfma_f32_16x16x32_bf16 v[108:111], v[196:199], v[36:39], v[108:111]
    ds_read_b64_tr_b16 v[34:35], v3 offset:9216
    s_waitcnt lgkmcnt(10)
    v_mfma_f32_16x16x32_bf16 v[112:115], v[192:195], v[40:43], v[112:115]
    ds_read_b64_tr_b16 v[36:37], v4 offset:8192
    v_mfma_f32_16x16x32_bf16 v[116:119], v[196:199], v[40:43], v[116:119]
    ds_read_b64_tr_b16 v[38:39], v4 offset:9216
    v_mfma_f32_16x16x32_bf16 v[120:123], v[192:195], v[44:47], v[120:123]
    ds_read_b64_tr_b16 v[40:41], v5 offset:8192
    v_mfma_f32_16x16x32_bf16 v[124:127], v[196:199], v[44:47], v[124:127]
    ds_read_b64_tr_b16 v[42:43], v5 offset:9216
    s_waitcnt lgkmcnt(10)
    v_mfma_f32_16x16x32_bf16 v[96:99], v[200:203], v[48:51], v[96:99]
    ds_read_b64_tr_b16 v[44:45], v6 offset:8192
    v_mfma_f32_16x16x32_bf16 v[100:103], v[204:207], v[48:51], v[100:103]
    ds_read_b64_tr_b16 v[46:47], v6 offset:9216
    v_mfma_f32_16x16x32_bf16 v[104:107], v[200:203], v[52:55], v[104:107]
    ds_read_b64_tr_b16 v[48:49], v3 offset:12288
    v_mfma_f32_16x16x32_bf16 v[108:111], v[204:207], v[52:55], v[108:111]
    ds_read_b64_tr_b16 v[50:51], v3 offset:13312
    s_waitcnt lgkmcnt(10)
    v_mfma_f32_16x16x32_bf16 v[112:115], v[200:203], v[56:59], v[112:115]
    ds_read_b64_tr_b16 v[52:53], v4 offset:12288
    v_mfma_f32_16x16x32_bf16 v[116:119], v[204:207], v[56:59], v[116:119]
    ds_read_b64_tr_b16 v[54:55], v4 offset:13312
    v_mfma_f32_16x16x32_bf16 v[120:123], v[200:203], v[60:63], v[120:123]
    ds_read_b64_tr_b16 v[56:57], v5 offset:12288
    v_mfma_f32_16x16x32_bf16 v[124:127], v[204:207], v[60:63], v[124:127]
    ds_read_b64_tr_b16 v[58:59], v5 offset:13312
    s_waitcnt lgkmcnt(10)
    v_mfma_f32_16x16x32_bf16 v[96:99], v[208:211], v[32:35], v[96:99]
    ds_read_b64_tr_b16 v[60:61], v6 offset:12288
    v_mfma_f32_16x16x32_bf16 v[100:103], v[212:215], v[32:35], v[100:103]
    ds_read_b64_tr_b16 v[62:63], v6 offset:13312
    v_mfma_f32_16x16x32_bf16 v[104:107], v[208:211], v[36:39], v[104:107]
    ds_read_b64_tr_b16 v[32:33], v3 offset:16384
    ds_read_b128 v[16:19], v13 offset:4096
    v_mfma_f32_16x16x32_bf16 v[108:111], v[212:215], v[36:39], v[108:111]
    ds_read_b64_tr_b16 v[34:35], v3 offset:17408
    ds_read_b128 v[20:23], v13 offset:4608
    s_waitcnt lgkmcnt(12)
    v_mfma_f32_16x16x32_bf16 v[112:115], v[208:211], v[40:43], v[112:115]
    ds_read_b64_tr_b16 v[36:37], v4 offset:16384
    ds_read_b128 v[24:27], v13 offset:4160
    v_mfma_f32_16x16x32_bf16 v[116:119], v[212:215], v[40:43], v[116:119]
    ds_read_b64_tr_b16 v[38:39], v4 offset:17408
    ds_read_b128 v[28:31], v13 offset:4672
    v_mfma_f32_16x16x32_bf16 v[120:123], v[208:211], v[44:47], v[120:123]
    ds_read_b64_tr_b16 v[40:41], v5 offset:16384
    ds_read_b32 v8, v15 offset:512
    v_mfma_f32_16x16x32_bf16 v[124:127], v[212:215], v[44:47], v[124:127]
    ds_read_b64_tr_b16 v[42:43], v5 offset:17408
    ds_read_b32 v10, v15 offset:576
    s_waitcnt lgkmcnt(14)
    v_mfma_f32_16x16x32_bf16 v[96:99], v[216:219], v[48:51], v[96:99]
    ds_read_b64_tr_b16 v[44:45], v6 offset:16384
    ds_read_b32 v12, v15 offset:640
    v_mfma_f32_16x16x32_bf16 v[100:103], v[220:223], v[48:51], v[100:103]
    ds_read_b64_tr_b16 v[46:47], v6 offset:17408
    ds_read_b32 v14, v15 offset:704
    v_mfma_f32_16x16x32_bf16 v[104:107], v[216:219], v[52:55], v[104:107]
    ds_read_b64_tr_b16 v[48:49], v3 offset:20480
    v_mfma_f32_16x16x32_bf16 v[108:111], v[220:223], v[52:55], v[108:111]
    ds_read_b64_tr_b16 v[50:51], v3 offset:21504
    s_waitcnt lgkmcnt(14)
    v_mfma_f32_16x16x32_bf16 v[112:115], v[216:219], v[56:59], v[112:115]
    ds_read_b64_tr_b16 v[52:53], v4 offset:20480
    v_mfma_f32_16x16x32_bf16 v[116:119], v[220:223], v[56:59], v[116:119]
    ds_read_b64_tr_b16 v[54:55], v4 offset:21504
    v_mfma_f32_16x16x32_bf16 v[120:123], v[216:219], v[60:63], v[120:123]
    ds_read_b64_tr_b16 v[56:57], v5 offset:20480
    v_mfma_f32_16x16x32_bf16 v[124:127], v[220:223], v[60:63], v[124:127]
    ds_read_b64_tr_b16 v[58:59], v5 offset:21504
    s_waitcnt lgkmcnt(6)
    v_pk_fma_f32 v[96:97], v[8:9], v[16:17], v[96:97] op_sel_hi:[0,1,1] neg_lo:[1,0,0] neg_hi:[1,0,0]
    v_pk_fma_f32 v[98:99], v[8:9], v[18:19], v[98:99] op_sel_hi:[0,1,1] neg_lo:[1,0,0] neg_hi:[1,0,0]
    v_pk_fma_f32 v[104:105], v[10:11], v[16:17], v[104:105] op_sel_hi:[0,1,1] neg_lo:[1,0,0] neg_hi:[1,0,0]
    v_pk_fma_f32 v[106:107], v[10:11], v[18:19], v[106:107] op_sel_hi:[0,1,1] neg_lo:[1,0,0] neg_hi:[1,0,0]
    v_pk_mul_f32 v[96:97], v[20:21], v[96:97]
    v_pk_mul_f32 v[98:99], v[22:23], v[98:99]
    v_pk_mul_f32 v[104:105], v[20:21], v[104:105]
    v_pk_mul_f32 v[106:107], v[22:23], v[106:107]
    v_cvt_pk_bf16_f32 v72, v96, v97
    v_cvt_pk_bf16_f32 v73, v98, v99
    v_cvt_pk_bf16_f32 v74, v104, v105
    v_cvt_pk_bf16_f32 v75, v106, v107
    s_add_u32 s56, s52, 4194304
    v_permlane16_swap_b32 v72, v74
    v_permlane16_swap_b32 v73, v75
    buffer_store_dwordx4 v[72:75], v1, s[4:7], s56 offen offset:0 sc1
    v_pk_fma_f32 v[112:113], v[12:13], v[16:17], v[112:113] op_sel_hi:[0,1,1] neg_lo:[1,0,0] neg_hi:[1,0,0]
    v_pk_fma_f32 v[114:115], v[12:13], v[18:19], v[114:115] op_sel_hi:[0,1,1] neg_lo:[1,0,0] neg_hi:[1,0,0]
    v_pk_fma_f32 v[120:121], v[14:15], v[16:17], v[120:121] op_sel_hi:[0,1,1] neg_lo:[1,0,0] neg_hi:[1,0,0]
    v_pk_fma_f32 v[122:123], v[14:15], v[18:19], v[122:123] op_sel_hi:[0,1,1] neg_lo:[1,0,0] neg_hi:[1,0,0]
    v_pk_mul_f32 v[112:113], v[20:21], v[112:113]
    v_pk_mul_f32 v[114:115], v[22:23], v[114:115]
    v_pk_mul_f32 v[120:121], v[20:21], v[120:121]
    v_pk_mul_f32 v[122:123], v[22:23], v[122:123]
    v_cvt_pk_bf16_f32 v88, v112, v113
    v_cvt_pk_bf16_f32 v89, v114, v115
    v_cvt_pk_bf16_f32 v90, v120, v121
    v_cvt_pk_bf16_f32 v91, v122, v123
    s_add_u32 s56, s52, 4325376
    v_permlane16_swap_b32 v88, v90
    v_permlane16_swap_b32 v89, v91
    buffer_store_dwordx4 v[88:91], v1, s[4:7], s56 offen offset:0 sc1
    v_pk_fma_f32 v[100:101], v[8:9], v[24:25], v[100:101] op_sel_hi:[0,1,1] neg_lo:[1,0,0] neg_hi:[1,0,0]
    v_pk_fma_f32 v[102:103], v[8:9], v[26:27], v[102:103] op_sel_hi:[0,1,1] neg_lo:[1,0,0] neg_hi:[1,0,0]
    v_pk_fma_f32 v[108:109], v[10:11], v[24:25], v[108:109] op_sel_hi:[0,1,1] neg_lo:[1,0,0] neg_hi:[1,0,0]
    v_pk_fma_f32 v[110:111], v[10:11], v[26:27], v[110:111] op_sel_hi:[0,1,1] neg_lo:[1,0,0] neg_hi:[1,0,0]
    v_pk_mul_f32 v[100:101], v[28:29], v[100:101]
    v_pk_mul_f32 v[102:103], v[30:31], v[102:103]
    v_pk_mul_f32 v[108:109], v[28:29], v[108:109]
    v_pk_mul_f32 v[110:111], v[30:31], v[110:111]
    v_cvt_pk_bf16_f32 v76, v100, v101
    v_cvt_pk_bf16_f32 v77, v102, v103
    v_cvt_pk_bf16_f32 v78, v108, v109
    v_cvt_pk_bf16_f32 v79, v110, v111
    s_add_u32 s56, s52, 4194304
    v_permlane16_swap_b32 v76, v78
    v_permlane16_swap_b32 v77, v79
    buffer_store_dwordx4 v[76:79], v1, s[4:7], s56 offen offset:1024 sc1
    v_pk_fma_f32 v[116:117], v[12:13], v[24:25], v[116:117] op_sel_hi:[0,1,1] neg_lo:[1,0,0] neg_hi:[1,0,0]
    v_pk_fma_f32 v[118:119], v[12:13], v[26:27], v[118:119] op_sel_hi:[0,1,1] neg_lo:[1,0,0] neg_hi:[1,0,0]
    v_pk_fma_f32 v[124:125], v[14:15], v[24:25], v[124:125] op_sel_hi:[0,1,1] neg_lo:[1,0,0] neg_hi:[1,0,0]
    v_pk_fma_f32 v[126:127], v[14:15], v[26:27], v[126:127] op_sel_hi:[0,1,1] neg_lo:[1,0,0] neg_hi:[1,0,0]
    v_pk_mul_f32 v[116:117], v[28:29], v[116:117]
    v_pk_mul_f32 v[118:119], v[30:31], v[118:119]
    v_pk_mul_f32 v[124:125], v[28:29], v[124:125]
    v_pk_mul_f32 v[126:127], v[30:31], v[126:127]
    v_cvt_pk_bf16_f32 v92, v116, v117
    v_cvt_pk_bf16_f32 v93, v118, v119
    v_cvt_pk_bf16_f32 v94, v124, v125
    v_cvt_pk_bf16_f32 v95, v126, v127
    s_add_u32 s56, s52, 4325376
    v_permlane16_swap_b32 v92, v94
    v_permlane16_swap_b32 v93, v95
    buffer_store_dwordx4 v[92:95], v1, s[4:7], s56 offen offset:1024 sc1
    v_mfma_f32_16x16x32_bf16 v[128:131], v[32:35], v[224:227], v[128:131]
    ds_read_b64_tr_b16 v[60:61], v6 offset:20480
    v_mfma_f32_16x16x32_bf16 v[132:135], v[32:35], v[228:231], v[132:135]
    ds_read_b64_tr_b16 v[62:63], v6 offset:21504
    v_mfma_f32_16x16x32_bf16 v[136:139], v[36:39], v[224:227], v[136:139]
    ds_read_b64_tr_b16 v[32:33], v3 offset:24576
    v_mfma_f32_16x16x32_bf16 v[140:143], v[36:39], v[228:231], v[140:143]
    ds_read_b64_tr_b16 v[34:35], v3 offset:25600
    v_mfma_f32_16x16x32_bf16 v[144:147], v[40:43], v[224:227], v[144:147]
    ds_read_b64_tr_b16 v[36:37], v4 offset:24576
    v_mfma_f32_16x16x32_bf16 v[148:151], v[40:43], v[228:231], v[148:151]
    ds_read_b64_tr_b16 v[38:39], v4 offset:25600
    v_mfma_f32_16x16x32_bf16 v[152:155], v[44:47], v[224:227], v[152:155]
    ds_read_b64_tr_b16 v[40:41], v5 offset:24576
    v_mfma_f32_16x16x32_bf16 v[156:159], v[44:47], v[228:231], v[156:159]
    ds_read_b64_tr_b16 v[42:43], v5 offset:25600
    s_waitcnt lgkmcnt(10)
    v_mfma_f32_16x16x32_bf16 v[128:131], v[48:51], v[232:235], v[128:131]
    ds_read_b64_tr_b16 v[44:45], v6 offset:24576
    v_mfma_f32_16x16x32_bf16 v[132:135], v[48:51], v[236:239], v[132:135]
    ds_read_b64_tr_b16 v[46:47], v6 offset:25600
    v_mfma_f32_16x16x32_bf16 v[136:139], v[52:55], v[232:235], v[136:139]
    ds_read_b64_tr_b16 v[48:49], v3 offset:28672
    v_mfma_f32_16x16x32_bf16 v[140:143], v[52:55], v[236:239], v[140:143]
    ds_read_b64_tr_b16 v[50:51], v3 offset:29696
    s_waitcnt lgkmcnt(10)
    v_mfma_f32_16x16x32_bf16 v[144:147], v[56:59], v[232:235], v[144:147]
    ds_read_b64_tr_b16 v[52:53], v4 offset:28672
    v_mfma_f32_16x16x32_bf16 v[148:151], v[56:59], v[236:239], v[148:151]
    ds_read_b64_tr_b16 v[54:55], v4 offset:29696
    v_mfma_f32_16x16x32_bf16 v[152:155], v[60:63], v[232:235], v[152:155]
    ds_read_b64_tr_b16 v[56:57], v5 offset:28672
    v_mfma_f32_16x16x32_bf16 v[156:159], v[60:63], v[236:239], v[156:159]
    ds_read_b64_tr_b16 v[58:59], v5 offset:29696
    s_waitcnt lgkmcnt(10)
    v_mfma_f32_16x16x32_bf16 v[128:131], v[32:35], v[240:243], v[128:131]
    ds_read_b64_tr_b16 v[60:61], v6 offset:28672
    v_mfma_f32_16x16x32_bf16 v[132:135], v[32:35], v[244:247], v[132:135]
    ds_read_b64_tr_b16 v[62:63], v6 offset:29696
    s_barrier
    v_mfma_f32_16x16x32_bf16 v[136:139], v[36:39], v[240:243], v[136:139]
    ds_read_b64_tr_b16 v[32:33], v3 offset:32768
    v_mfma_f32_16x16x32_bf16 v[140:143], v[36:39], v[244:247], v[140:143]
    ds_read_b64_tr_b16 v[34:35], v3 offset:33792
    s_waitcnt lgkmcnt(10)
    v_mfma_f32_16x16x32_bf16 v[144:147], v[40:43], v[240:243], v[144:147]
    ds_read_b64_tr_b16 v[36:37], v4 offset:32768
    v_mfma_f32_16x16x32_bf16 v[148:151], v[40:43], v[244:247], v[148:151]
    ds_read_b64_tr_b16 v[38:39], v4 offset:33792
    v_mfma_f32_16x16x32_bf16 v[152:155], v[44:47], v[240:243], v[152:155]
    ds_read_b64_tr_b16 v[40:41], v5 offset:32768
    v_mfma_f32_16x16x32_bf16 v[156:159], v[44:47], v[244:247], v[156:159]
    ds_read_b64_tr_b16 v[42:43], v5 offset:33792
    s_waitcnt lgkmcnt(10)
    v_mfma_f32_16x16x32_bf16 v[128:131], v[48:51], v[248:251], v[128:131]
    ds_read_b64_tr_b16 v[44:45], v6 offset:32768
    v_mfma_f32_16x16x32_bf16 v[132:135], v[48:51], v[252:255], v[132:135]
    ds_read_b64_tr_b16 v[46:47], v6 offset:33792
    v_mfma_f32_16x16x32_bf16 v[136:139], v[52:55], v[248:251], v[136:139]
    ds_read_b64_tr_b16 v[48:49], v3 offset:36864
    v_mfma_f32_16x16x32_bf16 v[140:143], v[52:55], v[252:255], v[140:143]
    ds_read_b64_tr_b16 v[50:51], v3 offset:37888
    s_waitcnt lgkmcnt(10)
    v_mfma_f32_16x16x32_bf16 v[144:147], v[56:59], v[248:251], v[144:147]
    ds_read_b64_tr_b16 v[52:53], v4 offset:36864
    v_mfma_f32_16x16x32_bf16 v[148:151], v[56:59], v[252:255], v[148:151]
    ds_read_b64_tr_b16 v[54:55], v4 offset:37888
    v_mfma_f32_16x16x32_bf16 v[152:155], v[60:63], v[248:251], v[152:155]
    ds_read_b64_tr_b16 v[56:57], v5 offset:36864
    v_mfma_f32_16x16x32_bf16 v[156:159], v[60:63], v[252:255], v[156:159]
    ds_read_b64_tr_b16 v[58:59], v5 offset:37888
    s_waitcnt lgkmcnt(10)
    v_mfma_f32_16x16x32_bf16 v[128:131], v[32:35], v[160:163], v[128:131]
    ds_read_b64_tr_b16 v[60:61], v6 offset:36864
    v_mfma_f32_16x16x32_bf16 v[132:135], v[32:35], v[164:167], v[132:135]
    ds_read_b64_tr_b16 v[62:63], v6 offset:37888
    v_mfma_f32_16x16x32_bf16 v[136:139], v[36:39], v[160:163], v[136:139]
    ds_read_b64_tr_b16 v[32:33], v3 offset:40960
    v_mfma_f32_16x16x32_bf16 v[140:143], v[36:39], v[164:167], v[140:143]
    ds_read_b64_tr_b16 v[34:35], v3 offset:41984
    s_waitcnt lgkmcnt(10)
    v_mfma_f32_16x16x32_bf16 v[144:147], v[40:43], v[160:163], v[144:147]
    ds_read_b64_tr_b16 v[36:37], v4 offset:40960
    v_mfma_f32_16x16x32_bf16 v[148:151], v[40:43], v[164:167], v[148:151]
    ds_read_b64_tr_b16 v[38:39], v4 offset:41984
    v_mfma_f32_16x16x32_bf16 v[152:155], v[44:47], v[160:163], v[152:155]
    ds_read_b64_tr_b16 v[40:41], v5 offset:40960
    v_mfma_f32_16x16x32_bf16 v[156:159], v[44:47], v[164:167], v[156:159]
    ds_read_b64_tr_b16 v[42:43], v5 offset:41984
    s_waitcnt lgkmcnt(10)
    v_mfma_f32_16x16x32_bf16 v[128:131], v[48:51], v[168:171], v[128:131]
    ds_read_b64_tr_b16 v[44:45], v6 offset:40960
    v_mfma_f32_16x16x32_bf16 v[132:135], v[48:51], v[172:175], v[132:135]
    ds_read_b64_tr_b16 v[46:47], v6 offset:41984
    v_mfma_f32_16x16x32_bf16 v[136:139], v[52:55], v[168:171], v[136:139]
    ds_read_b64_tr_b16 v[48:49], v3 offset:45056
    v_mfma_f32_16x16x32_bf16 v[140:143], v[52:55], v[172:175], v[140:143]
    ds_read_b64_tr_b16 v[50:51], v3 offset:46080
    s_waitcnt lgkmcnt(10)
    v_mfma_f32_16x16x32_bf16 v[144:147], v[56:59], v[168:171], v[144:147]
    ds_read_b64_tr_b16 v[52:53], v4 offset:45056
    v_mfma_f32_16x16x32_bf16 v[148:151], v[56:59], v[172:175], v[148:151]
    ds_read_b64_tr_b16 v[54:55], v4 offset:46080
    v_mfma_f32_16x16x32_bf16 v[152:155], v[60:63], v[168:171], v[152:155]
    ds_read_b64_tr_b16 v[56:57], v5 offset:45056
    v_mfma_f32_16x16x32_bf16 v[156:159], v[60:63], v[172:175], v[156:159]
    ds_read_b64_tr_b16 v[58:59], v5 offset:46080
    s_waitcnt lgkmcnt(10)
    v_mfma_f32_16x16x32_bf16 v[128:131], v[32:35], v[176:179], v[128:131]
    ds_read_b64_tr_b16 v[60:61], v6 offset:45056
    v_mfma_f32_16x16x32_bf16 v[132:135], v[32:35], v[180:183], v[132:135]
    ds_read_b64_tr_b16 v[62:63], v6 offset:46080
    v_mfma_f32_16x16x32_bf16 v[136:139], v[36:39], v[176:179], v[136:139]
    ds_read_b64_tr_b16 v[32:33], v3 offset:49152
    v_mfma_f32_16x16x32_bf16 v[140:143], v[36:39], v[180:183], v[140:143]
    ds_read_b64_tr_b16 v[34:35], v3 offset:50176
    s_waitcnt lgkmcnt(10)
    v_mfma_f32_16x16x32_bf16 v[144:147], v[40:43], v[176:179], v[144:147]
    ds_read_b64_tr_b16 v[36:37], v4 offset:49152
    v_mfma_f32_16x16x32_bf16 v[148:151], v[40:43], v[180:183], v[148:151]
    ds_read_b64_tr_b16 v[38:39], v4 offset:50176
    v_mfma_f32_16x16x32_bf16 v[152:155], v[44:47], v[176:179], v[152:155]
    ds_read_b64_tr_b16 v[40:41], v5 offset:49152
    v_mfma_f32_16x16x32_bf16 v[156:159], v[44:47], v[180:183], v[156:159]
    ds_read_b64_tr_b16 v[42:43], v5 offset:50176
    s_waitcnt lgkmcnt(10)
    v_mfma_f32_16x16x32_bf16 v[128:131], v[48:51], v[184:187], v[128:131]
    ds_read_b64_tr_b16 v[44:45], v6 offset:49152
    s_mov_b32 s68, 1
    s_waitcnt vmcnt(0)
    s_atomic_add s68, s[22:23], s59 glc
    s_add_u32 s55, s52, 131072
    s_add_u32 s56, s52, 4325376
    s_add_u32 s53, s53, 131072
    ds_read_b32 v8, v9 offset:4096
    v_mfma_f32_16x16x32_bf16 v[132:135], v[48:51], v[188:191], v[132:135]
    ds_read_b64_tr_b16 v[46:47], v6 offset:50176
    buffer_load_dwordx4 v[64:67], v1, s[4:7], s55 offen offset:0 sc1
    ds_read_b32 v10, v9 offset:4608
    v_mfma_f32_16x16x32_bf16 v[136:139], v[52:55], v[184:187], v[136:139]
    ds_read_b64_tr_b16 v[48:49], v3 offset:53248
    buffer_load_dwordx4 v[68:71], v1, s[4:7], s55 offen offset:1024 sc1
    ds_read_b32 v12, v9 offset:4160
    v_mfma_f32_16x16x32_bf16 v[140:143], v[52:55], v[188:191], v[140:143]
    ds_read_b64_tr_b16 v[50:51], v3 offset:54272
    buffer_load_dwordx4 v[72:75], v1, s[4:7], s56 offen offset:0 sc1
    ds_read_b32 v14, v9 offset:4672
    s_waitcnt lgkmcnt(14)
    v_mfma_f32_16x16x32_bf16 v[144:147], v[56:59], v[184:187], v[144:147]
    ds_read_b64_tr_b16 v[52:53], v4 offset:53248
    buffer_load_dwordx4 v[76:79], v1, s[4:7], s56 offen offset:1024 sc1
    ds_read_b128 v[16:19], v11 offset:0
    v_mfma_f32_16x16x32_bf16 v[148:151], v[56:59], v[188:191], v[148:151]
    ds_read_b64_tr_b16 v[54:55], v4 offset:54272
    ds_read_b128 v[20:23], v11 offset:64
    v_mfma_f32_16x16x32_bf16 v[152:155], v[60:63], v[184:187], v[152:155]
    ds_read_b64_tr_b16 v[56:57], v5 offset:53248
    ds_read_b128 v[24:27], v11 offset:128
    v_mfma_f32_16x16x32_bf16 v[156:159], v[60:63], v[188:191], v[156:159]
    ds_read_b64_tr_b16 v[58:59], v5 offset:54272
    ds_read_b128 v[28:31], v11 offset:192
    s_waitcnt lgkmcnt(14)
    v_mfma_f32_16x16x32_bf16 v[128:131], v[32:35], v[192:195], v[128:131]
    ds_read_b64_tr_b16 v[60:61], v6 offset:53248
    v_mfma_f32_16x16x32_bf16 v[132:135], v[32:35], v[196:199], v[132:135]
    ds_read_b64_tr_b16 v[62:63], v6 offset:54272
    v_mfma_f32_16x16x32_bf16 v[136:139], v[36:39], v[192:195], v[136:139]
    ds_read_b64_tr_b16 v[32:33], v3 offset:57344
    v_mfma_f32_16x16x32_bf16 v[140:143], v[36:39], v[196:199], v[140:143]
    ds_read_b64_tr_b16 v[34:35], v3 offset:58368
    s_waitcnt lgkmcnt(14)
    v_mfma_f32_16x16x32_bf16 v[144:147], v[40:43], v[192:195], v[144:147]
    ds_read_b64_tr_b16 v[36:37], v4 offset:57344
    v_mfma_f32_16x16x32_bf16 v[148:151], v[40:43], v[196:199], v[148:151]
    ds_read_b64_tr_b16 v[38:39], v4 offset:58368
    v_mfma_f32_16x16x32_bf16 v[152:155], v[44:47], v[192:195], v[152:155]
    ds_read_b64_tr_b16 v[40:41], v5 offset:57344
    v_mfma_f32_16x16x32_bf16 v[156:159], v[44:47], v[196:199], v[156:159]
    ds_read_b64_tr_b16 v[42:43], v5 offset:58368
    s_waitcnt lgkmcnt(13)
    v_mfma_f32_16x16x32_bf16 v[128:131], v[48:51], v[200:203], v[128:131]
    ds_read_b64_tr_b16 v[44:45], v6 offset:57344
    s_waitcnt lgkmcnt(9)
    v_mfma_f32_16x16x32_bf16 v[132:135], v[48:51], v[204:207], v[132:135]
    ds_read_b64_tr_b16 v[46:47], v6 offset:58368
    v_mul_f32 v10, 0x3e8293ee, v10
    v_mfma_f32_16x16x32_bf16 v[136:139], v[52:55], v[200:203], v[136:139]
    ds_read_b64_tr_b16 v[48:49], v3 offset:61440
    v_mul_f32 v14, 0x3e8293ee, v14
    v_mfma_f32_16x16x32_bf16 v[140:143], v[52:55], v[204:207], v[140:143]
    ds_read_b64_tr_b16 v[50:51], v3 offset:62464
    s_lshl_b32 s44, s16, 11
    s_waitcnt lgkmcnt(10)
    v_mfma_f32_16x16x32_bf16 v[144:147], v[56:59], v[200:203], v[144:147]
    ds_read_b64_tr_b16 v[52:53], v4 offset:61440
    s_add_u32 s44, s44, 131072
    v_mfma_f32_16x16x32_bf16 v[148:151], v[56:59], v[204:207], v[148:151]
    ds_read_b64_tr_b16 v[54:55], v4 offset:62464
    v_add_u32 v13, s44, v2
    v_mfma_f32_16x16x32_bf16 v[152:155], v[60:63], v[200:203], v[152:155]
    ds_read_b64_tr_b16 v[56:57], v5 offset:61440
    v_mfma_f32_16x16x32_bf16 v[156:159], v[60:63], v[204:207], v[156:159]
    ds_read_b64_tr_b16 v[58:59], v5 offset:62464
    s_waitcnt lgkmcnt(10)
    v_mfma_f32_16x16x32_bf16 v[128:131], v[32:35], v[208:211], v[128:131]
    ds_read_b64_tr_b16 v[60:61], v6 offset:61440
    v_mfma_f32_16x16x32_bf16 v[132:135], v[32:35], v[212:215], v[132:135]
    ds_read_b64_tr_b16 v[62:63], v6 offset:62464
    v_xor_b32 v3, 0x10000, v3
    v_xor_b32 v4, 0x10000, v4
    v_xor_b32 v5, 0x10000, v5
    v_xor_b32 v6, 0x10000, v6
    v_mfma_f32_16x16x32_bf16 v[136:139], v[36:39], v[208:211], v[136:139]
    v_mfma_f32_16x16x32_bf16 v[140:143], v[36:39], v[212:215], v[140:143]
    s_waitcnt lgkmcnt(8)
    v_mfma_f32_16x16x32_bf16 v[144:147], v[40:43], v[208:211], v[144:147]
    v_mfma_f32_16x16x32_bf16 v[148:151], v[40:43], v[212:215], v[148:151]
    v_mfma_f32_16x16x32_bf16 v[152:155], v[44:47], v[208:211], v[152:155]
    v_mfma_f32_16x16x32_bf16 v[156:159], v[44:47], v[212:215], v[156:159]
    s_waitcnt lgkmcnt(4)
    v_mfma_f32_16x16x32_bf16 v[128:131], v[48:51], v[216:219], v[128:131]
    v_mfma_f32_16x16x32_bf16 v[132:135], v[48:51], v[220:223], v[132:135]
    v_mfma_f32_16x16x32_bf16 v[136:139], v[52:55], v[216:219], v[136:139]
    v_mfma_f32_16x16x32_bf16 v[140:143], v[52:55], v[220:223], v[140:143]
    s_waitcnt lgkmcnt(0)
    v_mfma_f32_16x16x32_bf16 v[144:147], v[56:59], v[216:219], v[144:147]
    v_mfma_f32_16x16x32_bf16 v[148:151], v[56:59], v[220:223], v[148:151]
    v_mfma_f32_16x16x32_bf16 v[152:155], v[60:63], v[216:219], v[152:155]
    v_mfma_f32_16x16x32_bf16 v[156:159], v[60:63], v[220:223], v[156:159]
    v_pk_fma_f32 v[128:129], v[8:9], v[16:17], v[128:129] op_sel_hi:[0,1,1] neg_lo:[1,0,0] neg_hi:[1,0,0]
    v_pk_fma_f32 v[130:131], v[8:9], v[18:19], v[130:131] op_sel_hi:[0,1,1] neg_lo:[1,0,0] neg_hi:[1,0,0]
    v_pk_fma_f32 v[136:137], v[8:9], v[20:21], v[136:137] op_sel_hi:[0,1,1] neg_lo:[1,0,0] neg_hi:[1,0,0]
    v_pk_fma_f32 v[138:139], v[8:9], v[22:23], v[138:139] op_sel_hi:[0,1,1] neg_lo:[1,0,0] neg_hi:[1,0,0]
    v_pk_mul_f32 v[128:129], v[10:11], v[128:129] op_sel_hi:[0,1]
    v_pk_mul_f32 v[130:131], v[10:11], v[130:131] op_sel_hi:[0,1]
    v_pk_mul_f32 v[136:137], v[10:11], v[136:137] op_sel_hi:[0,1]
    v_pk_mul_f32 v[138:139], v[10:11], v[138:139] op_sel_hi:[0,1]
    v_cvt_pk_bf16_f32 v128, v128, v129
    v_cvt_pk_bf16_f32 v129, v130, v131
    v_cvt_pk_bf16_f32 v130, v136, v137
    v_cvt_pk_bf16_f32 v131, v138, v139
    ds_write_b128 v13, v[128:131] offset:0
    v_pk_fma_f32 v[132:133], v[12:13], v[16:17], v[132:133] op_sel_hi:[0,1,1] neg_lo:[1,0,0] neg_hi:[1,0,0]
    v_pk_fma_f32 v[134:135], v[12:13], v[18:19], v[134:135] op_sel_hi:[0,1,1] neg_lo:[1,0,0] neg_hi:[1,0,0]
    v_pk_fma_f32 v[140:141], v[12:13], v[20:21], v[140:141] op_sel_hi:[0,1,1] neg_lo:[1,0,0] neg_hi:[1,0,0]
    v_pk_fma_f32 v[142:143], v[12:13], v[22:23], v[142:143] op_sel_hi:[0,1,1] neg_lo:[1,0,0] neg_hi:[1,0,0]
    v_pk_mul_f32 v[132:133], v[14:15], v[132:133] op_sel_hi:[0,1]
    v_pk_mul_f32 v[134:135], v[14:15], v[134:135] op_sel_hi:[0,1]
    v_pk_mul_f32 v[140:141], v[14:15], v[140:141] op_sel_hi:[0,1]
    v_pk_mul_f32 v[142:143], v[14:15], v[142:143] op_sel_hi:[0,1]
    v_cvt_pk_bf16_f32 v132, v132, v133
    v_cvt_pk_bf16_f32 v133, v134, v135
    v_cvt_pk_bf16_f32 v134, v140, v141
    v_cvt_pk_bf16_f32 v135, v142, v143
    ds_write_b128 v13, v[132:135] offset:256
    v_pk_fma_f32 v[144:145], v[8:9], v[24:25], v[144:145] op_sel_hi:[0,1,1] neg_lo:[1,0,0] neg_hi:[1,0,0]
    v_pk_fma_f32 v[146:147], v[8:9], v[26:27], v[146:147] op_sel_hi:[0,1,1] neg_lo:[1,0,0] neg_hi:[1,0,0]
    v_pk_fma_f32 v[152:153], v[8:9], v[28:29], v[152:153] op_sel_hi:[0,1,1] neg_lo:[1,0,0] neg_hi:[1,0,0]
    v_pk_fma_f32 v[154:155], v[8:9], v[30:31], v[154:155] op_sel_hi:[0,1,1] neg_lo:[1,0,0] neg_hi:[1,0,0]
    v_pk_mul_f32 v[144:145], v[10:11], v[144:145] op_sel_hi:[0,1]
    v_pk_mul_f32 v[146:147], v[10:11], v[146:147] op_sel_hi:[0,1]
    v_pk_mul_f32 v[152:153], v[10:11], v[152:153] op_sel_hi:[0,1]
    v_pk_mul_f32 v[154:155], v[10:11], v[154:155] op_sel_hi:[0,1]
    v_cvt_pk_bf16_f32 v144, v144, v145
    v_cvt_pk_bf16_f32 v145, v146, v147
    v_cvt_pk_bf16_f32 v146, v152, v153
    v_cvt_pk_bf16_f32 v147, v154, v155
    ds_write_b128 v13, v[144:147] offset:8192
    v_pk_fma_f32 v[148:149], v[12:13], v[24:25], v[148:149] op_sel_hi:[0,1,1] neg_lo:[1,0,0] neg_hi:[1,0,0]
    v_pk_fma_f32 v[150:151], v[12:13], v[26:27], v[150:151] op_sel_hi:[0,1,1] neg_lo:[1,0,0] neg_hi:[1,0,0]
    v_pk_fma_f32 v[156:157], v[12:13], v[28:29], v[156:157] op_sel_hi:[0,1,1] neg_lo:[1,0,0] neg_hi:[1,0,0]
    v_pk_fma_f32 v[158:159], v[12:13], v[30:31], v[158:159] op_sel_hi:[0,1,1] neg_lo:[1,0,0] neg_hi:[1,0,0]
    v_pk_mul_f32 v[148:149], v[14:15], v[148:149] op_sel_hi:[0,1]
    v_pk_mul_f32 v[150:151], v[14:15], v[150:151] op_sel_hi:[0,1]
    v_pk_mul_f32 v[156:157], v[14:15], v[156:157] op_sel_hi:[0,1]
    v_pk_mul_f32 v[158:159], v[14:15], v[158:159] op_sel_hi:[0,1]
    v_cvt_pk_bf16_f32 v148, v148, v149
    v_cvt_pk_bf16_f32 v149, v150, v151
    v_cvt_pk_bf16_f32 v150, v156, v157
    v_cvt_pk_bf16_f32 v151, v158, v159
    ds_write_b128 v13, v[148:151] offset:8448
    v_add_u32 v4, 139264, v1
    s_lshl_b32 s44, s21, 22
    s_lshl_b32 s45, s38, 16
    s_add_u32 s41, s44, s45
    s_lshl_b32 s45, s18, 12
    s_add_u32 s43, s41, s45
    s_and_b32 s45, s45, 0
    s_add_u32 s41, s41, s45
    s_add_u32 s41, s41, 16777216
    s_lshl_b32 s47, s21, 14
    s_lshl_b32 s67, s38, 8
    s_add_u32 s47, s47, s67
    s_add_u32 s47, s47, 86016
    s_mov_b32 s39, 1
    s_waitcnt lgkmcnt(0)
    s_cmp_eq_u32 s68, 15
    s_cselect_b32 s68, 16, 0
    s_cbranch_scc1 b_k2
    s_atomic_add s68, s[22:23], s59 glc
b_k2:
    s_barrier
b_att:
    ds_read_b128 v[32:35], v4 offset:0
    ds_read_b128 v[36:39], v4 offset:1024
    ds_read_b128 v[40:43], v4 offset:2048
    ds_read_b128 v[44:47], v4 offset:3072
    ds_read_b128 v[48:51], v4 offset:4096
    ds_read_b128 v[52:55], v4 offset:5120
    ds_read_b128 v[56:59], v4 offset:6144
    ds_read_b128 v[60:63], v4 offset:7168
    v_mov_b32 v9, 0xdddddddd
    v_bfe_u32 v10, v1, 4, 3
    v_mov_b32 v11, 0x3f803f80
    v_cmp_eq_u32 vcc, 0, v10
    v_cmp_eq_u32 s[44:45], 4, v10
    s_mov_b32 s58, 3
    v_cndmask_b32 v28, 0, v11, vcc
    v_cndmask_b32 v29, 0, v11, vcc
    v_cndmask_b32 v30, 0, v11, s[44:45]
    v_cndmask_b32 v31, 0, v11, s[44:45]
    v_mov_b32 v10, 0
    v_mov_b32 v11, 0
    s_waitcnt vmcnt(0) lgkmcnt(6)
    v_mfma_f32_32x32x16_bf16 v[192:207], v[64:67], v[32:35], 0
    v_mfma_f32_32x32x16_bf16 v[192:207], v[68:71], v[36:39], v[192:207]
    s_and_b32 s3, s16, 3
    s_lshl_b32 s44, s3, 12
    s_add_u32 s44, s44, 65536
    v_add_u32 v5, s44, v1
    s_lshl_b32 s44, s3, 8
    s_add_u32 s44, s44, 147456
    v_lshrrev_b32 v6, 2, v1
    v_add_u32 v6, s44, v6
    s_waitcnt lgkmcnt(4)
    v_mfma_f32_32x32x16_bf16 v[208:223], v[64:67], v[40:43], 0
    s_nop 1
    v_exp_f32 v192, v192
    v_exp_f32 v193, v193
    v_exp_f32 v194, v194
    v_mfma_f32_32x32x8_bf16 v[128:143], v[10:11], v[10:11], 0
    v_mov_b32 v12, 0
    v_exp_f32 v195, v195
    v_exp_f32 v196, v196
    v_exp_f32 v197, v197
    v_mfma_f32_32x32x16_bf16 v[208:223], v[68:71], v[44:47], v[208:223]
    v_exp_f32 v198, v198
    v_exp_f32 v199, v199
    v_exp_f32 v200, v200
    v_mfma_f32_32x32x8_bf16 v[144:159], v[10:11], v[10:11], 0
    v_mov_b32 v16, 0
    v_exp_f32 v201, v201
    v_exp_f32 v202, v202
    v_mfma_f32_32x32x8_bf16 v[160:175], v[10:11], v[10:11], 0
    v_mov_b32 v20, 0
    v_exp_f32 v203, v203
    v_exp_f32 v204, v204
    v_exp_f32 v205, v205
    v_mfma_f32_32x32x8_bf16 v[176:191], v[10:11], v[10:11], 0
    v_mov_b32 v24, 0
    v_exp_f32 v206, v206
    v_exp_f32 v207, v207
    s_waitcnt lgkmcnt(2)
    v_mfma_f32_32x32x16_bf16 v[224:239], v[64:67], v[48:51], 0
    v_exp_f32 v208, v208
    v_exp_f32 v209, v209
    v_exp_f32 v210, v210
    v_smfmac_f32_32x32x32_bf16 v[128:143], v[72:75], v[192:199], v9
    v_exp_f32 v211, v211
    v_exp_f32 v212, v212
    v_exp_f32 v213, v213
    v_mfma_f32_32x32x16_bf16 v[224:239], v[68:71], v[52:55], v[224:239]
    v_exp_f32 v214, v214
    v_exp_f32 v215, v215
    v_exp_f32 v216, v216
    v_smfmac_f32_16x16x64_bf16 v[12:15], v[28:31], v[192:199], v9
    v_exp_f32 v217, v217
    v_smfmac_f32_32x32x32_bf16 v[128:143], v[76:79], v[200:207], v9
    v_exp_f32 v218, v218
    v_exp_f32 v219, v219
    v_exp_f32 v220, v220
    v_smfmac_f32_16x16x64_bf16 v[12:15], v[28:31], v[200:207], v9
    v_exp_f32 v221, v221
    v_exp_f32 v222, v222
    v_exp_f32 v223, v223
    s_mov_b32 s66, 0x10000
    s_waitcnt lgkmcnt(0)
    s_cmp_eq_u32 s68, 16
    s_cbranch_scc1 c_k_ok
c_k_poll:
    s_mov_b32 s68, 0
    s_atomic_add s68, s[22:23], s59 offset:0 glc
    s_sub_u32 s66, s66, 1
    s_cselect_b32 s67, 16, 0
    s_waitcnt lgkmcnt(0)
    s_max_u32 s68, s68, s67
    s_cmp_lt_u32 s68, 16
    s_cbranch_scc1 c_k_poll
c_k_ok:
    s_add_u32 s54, s54, 8192
    s_and_b32 s54, s54, 0x1ffff
    s_add_u32 s55, s53, s54
    s_add_u32 s56, s55, 4194304
    buffer_load_dwordx4 v[80:83], v1, s[4:7], s55 offen offset:0 sc1
    buffer_load_dwordx4 v[84:87], v1, s[4:7], s55 offen offset:1024 sc1
    buffer_load_dwordx4 v[88:91], v1, s[4:7], s56 offen offset:0 sc1
    buffer_load_dwordx4 v[92:95], v1, s[4:7], s56 offen offset:1024 sc1
    s_add_u32 s54, s54, 8192
    s_and_b32 s54, s54, 0x1ffff
    s_add_u32 s55, s53, s54
    s_add_u32 s56, s55, 4194304
    buffer_load_dwordx4 v[96:99], v1, s[4:7], s55 offen offset:0 sc1
    buffer_load_dwordx4 v[100:103], v1, s[4:7], s55 offen offset:1024 sc1
    buffer_load_dwordx4 v[104:107], v1, s[4:7], s56 offen offset:0 sc1
    buffer_load_dwordx4 v[108:111], v1, s[4:7], s56 offen offset:1024 sc1
    s_add_u32 s54, s54, 8192
    s_and_b32 s54, s54, 0x1ffff
    s_add_u32 s55, s53, s54
    s_add_u32 s56, s55, 4194304
    buffer_load_dwordx4 v[112:115], v1, s[4:7], s55 offen offset:0 sc1
    buffer_load_dwordx4 v[116:119], v1, s[4:7], s55 offen offset:1024 sc1
    buffer_load_dwordx4 v[120:123], v1, s[4:7], s56 offen offset:0 sc1
    v_mfma_f32_32x32x16_bf16 v[240:255], v[64:67], v[56:59], 0
    v_exp_f32 v224, v224
    v_exp_f32 v225, v225
    v_exp_f32 v226, v226
    v_smfmac_f32_32x32x32_bf16 v[144:159], v[72:75], v[208:215], v9
    v_exp_f32 v227, v227
    v_exp_f32 v228, v228
    v_exp_f32 v229, v229
    v_mfma_f32_32x32x16_bf16 v[240:255], v[68:71], v[60:63], v[240:255]
    v_exp_f32 v230, v230
    v_exp_f32 v231, v231
    v_exp_f32 v232, v232
    v_smfmac_f32_16x16x64_bf16 v[16:19], v[28:31], v[208:215], v9
    v_exp_f32 v233, v233
    v_smfmac_f32_32x32x32_bf16 v[144:159], v[76:79], v[216:223], v9
    v_exp_f32 v234, v234
    v_exp_f32 v235, v235
    v_exp_f32 v236, v236
    v_smfmac_f32_16x16x64_bf16 v[16:19], v[28:31], v[216:223], v9
    v_exp_f32 v237, v237
    v_exp_f32 v238, v238
    v_exp_f32 v239, v239
b_loop:
    s_waitcnt vmcnt(7)
    v_mfma_f32_32x32x16_bf16 v[192:207], v[80:83], v[32:35], 0
    v_exp_f32 v240, v240
    v_exp_f32 v241, v241
    v_exp_f32 v242, v242
    v_smfmac_f32_32x32x32_bf16 v[160:175], v[72:75], v[224:231], v9
    v_exp_f32 v243, v243
    v_exp_f32 v244, v244
    v_exp_f32 v245, v245
    v_mfma_f32_32x32x16_bf16 v[192:207], v[84:87], v[36:39], v[192:207]
    v_exp_f32 v246, v246
    v_exp_f32 v247, v247
    v_exp_f32 v248, v248
    v_smfmac_f32_16x16x64_bf16 v[20:23], v[28:31], v[224:231], v9
    buffer_load_dwordx4 v[124:127], v1, s[4:7], s56 offen offset:1024 sc1
    v_exp_f32 v249, v249
    v_smfmac_f32_32x32x32_bf16 v[160:175], v[76:79], v[232:239], v9
    v_exp_f32 v250, v250
    v_exp_f32 v251, v251
    v_exp_f32 v252, v252
    v_smfmac_f32_16x16x64_bf16 v[20:23], v[28:31], v[232:239], v9
    v_exp_f32 v253, v253
    v_exp_f32 v254, v254
    v_exp_f32 v255, v255
    v_mfma_f32_32x32x16_bf16 v[208:223], v[80:83], v[40:43], 0
    s_add_u32 s54, s54, 8192
    s_and_b32 s54, s54, 0x1ffff
    s_add_u32 s55, s53, s54
    s_add_u32 s56, s55, 4194304
    v_exp_f32 v192, v192
    v_exp_f32 v193, v193
    v_exp_f32 v194, v194
    v_smfmac_f32_32x32x32_bf16 v[176:191], v[72:75], v[240:247], v9
    v_exp_f32 v195, v195
    v_exp_f32 v196, v196
    v_exp_f32 v197, v197
    v_mfma_f32_32x32x16_bf16 v[208:223], v[84:87], v[44:47], v[208:223]
    v_exp_f32 v198, v198
    v_exp_f32 v199, v199
    v_exp_f32 v200, v200
    v_smfmac_f32_16x16x64_bf16 v[24:27], v[28:31], v[240:247], v9
    buffer_load_dwordx4 v[64:67], v1, s[4:7], s55 offen offset:0 sc1
    v_exp_f32 v201, v201
    v_smfmac_f32_32x32x32_bf16 v[176:191], v[76:79], v[248:255], v9
    v_exp_f32 v202, v202
    v_exp_f32 v203, v203
    v_exp_f32 v204, v204
    v_smfmac_f32_16x16x64_bf16 v[24:27], v[28:31], v[248:255], v9
    v_exp_f32 v205, v205
    v_exp_f32 v206, v206
    v_exp_f32 v207, v207
    v_mfma_f32_32x32x16_bf16 v[224:239], v[80:83], v[48:51], 0
    v_exp_f32 v208, v208
    v_exp_f32 v209, v209
    v_exp_f32 v210, v210
    v_smfmac_f32_32x32x32_bf16 v[128:143], v[88:91], v[192:199], v9
    v_exp_f32 v211, v211
    v_exp_f32 v212, v212
    v_exp_f32 v213, v213
    v_mfma_f32_32x32x16_bf16 v[224:239], v[84:87], v[52:55], v[224:239]
    v_exp_f32 v214, v214
    v_exp_f32 v215, v215
    v_exp_f32 v216, v216
    v_smfmac_f32_16x16x64_bf16 v[12:15], v[28:31], v[192:199], v9
    buffer_load_dwordx4 v[68:71], v1, s[4:7], s55 offen offset:1024 sc1
    v_exp_f32 v217, v217
    v_smfmac_f32_32x32x32_bf16 v[128:143], v[92:95], v[200:207], v9
    v_exp_f32 v218, v218
    v_exp_f32 v219, v219
    v_exp_f32 v220, v220
    v_smfmac_f32_16x16x64_bf16 v[12:15], v[28:31], v[200:207], v9
    v_exp_f32 v221, v221
    v_exp_f32 v222, v222
    v_exp_f32 v223, v223
    v_mfma_f32_32x32x16_bf16 v[240:255], v[80:83], v[56:59], 0
    v_exp_f32 v224, v224
    v_exp_f32 v225, v225
    v_exp_f32 v226, v226
    v_smfmac_f32_32x32x32_bf16 v[144:159], v[88:91], v[208:215], v9
    v_exp_f32 v227, v227
    v_exp_f32 v228, v228
    v_exp_f32 v229, v229
    v_mfma_f32_32x32x16_bf16 v[240:255], v[84:87], v[60:63], v[240:255]
    v_exp_f32 v230, v230
    v_exp_f32 v231, v231
    v_exp_f32 v232, v232
    v_smfmac_f32_16x16x64_bf16 v[16:19], v[28:31], v[208:215], v9
    buffer_load_dwordx4 v[72:75], v1, s[4:7], s56 offen offset:0 sc1
    v_exp_f32 v233, v233
    v_smfmac_f32_32x32x32_bf16 v[144:159], v[92:95], v[216:223], v9
    v_exp_f32 v234, v234
    v_exp_f32 v235, v235
    v_exp_f32 v236, v236
    v_smfmac_f32_16x16x64_bf16 v[16:19], v[28:31], v[216:223], v9
    v_exp_f32 v237, v237
    v_exp_f32 v238, v238
    v_exp_f32 v239, v239
    s_waitcnt vmcnt(7)
    v_mfma_f32_32x32x16_bf16 v[192:207], v[96:99], v[32:35], 0
    v_exp_f32 v240, v240
    v_exp_f32 v241, v241
    v_exp_f32 v242, v242
    v_smfmac_f32_32x32x32_bf16 v[160:175], v[88:91], v[224:231], v9
    v_exp_f32 v243, v243
    v_exp_f32 v244, v244
    v_exp_f32 v245, v245
    v_mfma_f32_32x32x16_bf16 v[192:207], v[100:103], v[36:39], v[192:207]
    v_exp_f32 v246, v246
    v_exp_f32 v247, v247
    v_exp_f32 v248, v248
    v_smfmac_f32_16x16x64_bf16 v[20:23], v[28:31], v[224:231], v9
    buffer_load_dwordx4 v[76:79], v1, s[4:7], s56 offen offset:1024 sc1
    v_exp_f32 v249, v249
    v_smfmac_f32_32x32x32_bf16 v[160:175], v[92:95], v[232:239], v9
    v_exp_f32 v250, v250
    v_exp_f32 v251, v251
    v_exp_f32 v252, v252
    v_smfmac_f32_16x16x64_bf16 v[20:23], v[28:31], v[232:239], v9
    v_exp_f32 v253, v253
    v_exp_f32 v254, v254
    v_exp_f32 v255, v255
    v_mfma_f32_32x32x16_bf16 v[208:223], v[96:99], v[40:43], 0
    s_add_u32 s54, s54, 8192
    s_and_b32 s54, s54, 0x1ffff
    s_add_u32 s55, s53, s54
    s_add_u32 s56, s55, 4194304
    v_exp_f32 v192, v192
    v_exp_f32 v193, v193
    v_exp_f32 v194, v194
    v_smfmac_f32_32x32x32_bf16 v[176:191], v[88:91], v[240:247], v9
    v_exp_f32 v195, v195
    v_exp_f32 v196, v196
    v_exp_f32 v197, v197
    v_mfma_f32_32x32x16_bf16 v[208:223], v[100:103], v[44:47], v[208:223]
    v_exp_f32 v198, v198
    v_exp_f32 v199, v199
    v_exp_f32 v200, v200
    v_smfmac_f32_16x16x64_bf16 v[24:27], v[28:31], v[240:247], v9
    buffer_load_dwordx4 v[80:83], v1, s[4:7], s55 offen offset:0 sc1
    v_exp_f32 v201, v201
    v_smfmac_f32_32x32x32_bf16 v[176:191], v[92:95], v[248:255], v9
    v_exp_f32 v202, v202
    v_exp_f32 v203, v203
    v_exp_f32 v204, v204
    v_smfmac_f32_16x16x64_bf16 v[24:27], v[28:31], v[248:255], v9
    v_exp_f32 v205, v205
    v_exp_f32 v206, v206
    v_exp_f32 v207, v207
    v_mfma_f32_32x32x16_bf16 v[224:239], v[96:99], v[48:51], 0
    v_exp_f32 v208, v208
    v_exp_f32 v209, v209
    v_exp_f32 v210, v210
    v_smfmac_f32_32x32x32_bf16 v[128:143], v[104:107], v[192:199], v9
    v_exp_f32 v211, v211
    v_exp_f32 v212, v212
    v_exp_f32 v213, v213
    v_mfma_f32_32x32x16_bf16 v[224:239], v[100:103], v[52:55], v[224:239]
    v_exp_f32 v214, v214
    v_exp_f32 v215, v215
    v_exp_f32 v216, v216
    v_smfmac_f32_16x16x64_bf16 v[12:15], v[28:31], v[192:199], v9
    buffer_load_dwordx4 v[84:87], v1, s[4:7], s55 offen offset:1024 sc1
    v_exp_f32 v217, v217
    v_smfmac_f32_32x32x32_bf16 v[128:143], v[108:111], v[200:207], v9
    v_exp_f32 v218, v218
    v_exp_f32 v219, v219
    v_exp_f32 v220, v220
    v_smfmac_f32_16x16x64_bf16 v[12:15], v[28:31], v[200:207], v9
    v_exp_f32 v221, v221
    v_exp_f32 v222, v222
    v_exp_f32 v223, v223
    v_mfma_f32_32x32x16_bf16 v[240:255], v[96:99], v[56:59], 0
    v_exp_f32 v224, v224
    v_exp_f32 v225, v225
    v_exp_f32 v226, v226
    v_smfmac_f32_32x32x32_bf16 v[144:159], v[104:107], v[208:215], v9
    v_exp_f32 v227, v227
    v_exp_f32 v228, v228
    v_exp_f32 v229, v229
    v_mfma_f32_32x32x16_bf16 v[240:255], v[100:103], v[60:63], v[240:255]
    v_exp_f32 v230, v230
    v_exp_f32 v231, v231
    v_exp_f32 v232, v232
    v_smfmac_f32_16x16x64_bf16 v[16:19], v[28:31], v[208:215], v9
    buffer_load_dwordx4 v[88:91], v1, s[4:7], s56 offen offset:0 sc1
    v_exp_f32 v233, v233
    v_smfmac_f32_32x32x32_bf16 v[144:159], v[108:111], v[216:223], v9
    v_exp_f32 v234, v234
    v_exp_f32 v235, v235
    v_exp_f32 v236, v236
    v_smfmac_f32_16x16x64_bf16 v[16:19], v[28:31], v[216:223], v9
    v_exp_f32 v237, v237
    v_exp_f32 v238, v238
    v_exp_f32 v239, v239
    s_waitcnt vmcnt(7)
    v_mfma_f32_32x32x16_bf16 v[192:207], v[112:115], v[32:35], 0
    v_exp_f32 v240, v240
    v_exp_f32 v241, v241
    v_exp_f32 v242, v242
    v_smfmac_f32_32x32x32_bf16 v[160:175], v[104:107], v[224:231], v9
    v_exp_f32 v243, v243
    v_exp_f32 v244, v244
    v_exp_f32 v245, v245
    v_mfma_f32_32x32x16_bf16 v[192:207], v[116:119], v[36:39], v[192:207]
    v_exp_f32 v246, v246
    v_exp_f32 v247, v247
    v_exp_f32 v248, v248
    v_smfmac_f32_16x16x64_bf16 v[20:23], v[28:31], v[224:231], v9
    buffer_load_dwordx4 v[92:95], v1, s[4:7], s56 offen offset:1024 sc1
    v_exp_f32 v249, v249
    v_smfmac_f32_32x32x32_bf16 v[160:175], v[108:111], v[232:239], v9
    v_exp_f32 v250, v250
    v_exp_f32 v251, v251
    v_exp_f32 v252, v252
    v_smfmac_f32_16x16x64_bf16 v[20:23], v[28:31], v[232:239], v9
    v_exp_f32 v253, v253
    v_exp_f32 v254, v254
    v_exp_f32 v255, v255
    v_mfma_f32_32x32x16_bf16 v[208:223], v[112:115], v[40:43], 0
    s_add_u32 s54, s54, 8192
    s_and_b32 s54, s54, 0x1ffff
    s_add_u32 s55, s53, s54
    s_add_u32 s56, s55, 4194304
    v_exp_f32 v192, v192
    v_exp_f32 v193, v193
    v_exp_f32 v194, v194
    v_smfmac_f32_32x32x32_bf16 v[176:191], v[104:107], v[240:247], v9
    v_exp_f32 v195, v195
    v_exp_f32 v196, v196
    v_exp_f32 v197, v197
    v_mfma_f32_32x32x16_bf16 v[208:223], v[116:119], v[44:47], v[208:223]
    v_exp_f32 v198, v198
    v_exp_f32 v199, v199
    v_exp_f32 v200, v200
    v_smfmac_f32_16x16x64_bf16 v[24:27], v[28:31], v[240:247], v9
    buffer_load_dwordx4 v[96:99], v1, s[4:7], s55 offen offset:0 sc1
    v_exp_f32 v201, v201
    v_smfmac_f32_32x32x32_bf16 v[176:191], v[108:111], v[248:255], v9
    v_exp_f32 v202, v202
    v_exp_f32 v203, v203
    v_exp_f32 v204, v204
    v_smfmac_f32_16x16x64_bf16 v[24:27], v[28:31], v[248:255], v9
    v_exp_f32 v205, v205
    v_exp_f32 v206, v206
    v_exp_f32 v207, v207
    v_mfma_f32_32x32x16_bf16 v[224:239], v[112:115], v[48:51], 0
    v_exp_f32 v208, v208
    v_exp_f32 v209, v209
    v_exp_f32 v210, v210
    v_smfmac_f32_32x32x32_bf16 v[128:143], v[120:123], v[192:199], v9
    v_exp_f32 v211, v211
    v_exp_f32 v212, v212
    v_exp_f32 v213, v213
    v_mfma_f32_32x32x16_bf16 v[224:239], v[116:119], v[52:55], v[224:239]
    v_exp_f32 v214, v214
    v_exp_f32 v215, v215
    v_exp_f32 v216, v216
    v_smfmac_f32_16x16x64_bf16 v[12:15], v[28:31], v[192:199], v9
    buffer_load_dwordx4 v[100:103], v1, s[4:7], s55 offen offset:1024 sc1
    v_exp_f32 v217, v217
    v_smfmac_f32_32x32x32_bf16 v[128:143], v[124:127], v[200:207], v9
    v_exp_f32 v218, v218
    v_exp_f32 v219, v219
    v_exp_f32 v220, v220
    v_smfmac_f32_16x16x64_bf16 v[12:15], v[28:31], v[200:207], v9
    v_exp_f32 v221, v221
    v_exp_f32 v222, v222
    v_exp_f32 v223, v223
    v_mfma_f32_32x32x16_bf16 v[240:255], v[112:115], v[56:59], 0
    v_exp_f32 v224, v224
    v_exp_f32 v225, v225
    v_exp_f32 v226, v226
    v_smfmac_f32_32x32x32_bf16 v[144:159], v[120:123], v[208:215], v9
    v_exp_f32 v227, v227
    v_exp_f32 v228, v228
    v_exp_f32 v229, v229
    v_mfma_f32_32x32x16_bf16 v[240:255], v[116:119], v[60:63], v[240:255]
    v_exp_f32 v230, v230
    v_exp_f32 v231, v231
    v_exp_f32 v232, v232
    v_smfmac_f32_16x16x64_bf16 v[16:19], v[28:31], v[208:215], v9
    buffer_load_dwordx4 v[104:107], v1, s[4:7], s56 offen offset:0 sc1
    v_exp_f32 v233, v233
    v_smfmac_f32_32x32x32_bf16 v[144:159], v[124:127], v[216:223], v9
    v_exp_f32 v234, v234
    v_exp_f32 v235, v235
    v_exp_f32 v236, v236
    v_smfmac_f32_16x16x64_bf16 v[16:19], v[28:31], v[216:223], v9
    v_exp_f32 v237, v237
    v_exp_f32 v238, v238
    v_exp_f32 v239, v239
    s_waitcnt vmcnt(7)
    v_mfma_f32_32x32x16_bf16 v[192:207], v[64:67], v[32:35], 0
    v_exp_f32 v240, v240
    v_exp_f32 v241, v241
    v_exp_f32 v242, v242
    v_smfmac_f32_32x32x32_bf16 v[160:175], v[120:123], v[224:231], v9
    v_exp_f32 v243, v243
    v_exp_f32 v244, v244
    v_exp_f32 v245, v245
    v_mfma_f32_32x32x16_bf16 v[192:207], v[68:71], v[36:39], v[192:207]
    v_exp_f32 v246, v246
    v_exp_f32 v247, v247
    v_exp_f32 v248, v248
    v_smfmac_f32_16x16x64_bf16 v[20:23], v[28:31], v[224:231], v9
    buffer_load_dwordx4 v[108:111], v1, s[4:7], s56 offen offset:1024 sc1
    v_exp_f32 v249, v249
    v_smfmac_f32_32x32x32_bf16 v[160:175], v[124:127], v[232:239], v9
    v_exp_f32 v250, v250
    v_exp_f32 v251, v251
    v_exp_f32 v252, v252
    v_smfmac_f32_16x16x64_bf16 v[20:23], v[28:31], v[232:239], v9
    v_exp_f32 v253, v253
    v_exp_f32 v254, v254
    v_exp_f32 v255, v255
    v_mfma_f32_32x32x16_bf16 v[208:223], v[64:67], v[40:43], 0
    s_add_u32 s54, s54, 8192
    s_and_b32 s54, s54, 0x1ffff
    s_add_u32 s55, s53, s54
    s_add_u32 s56, s55, 4194304
    v_exp_f32 v192, v192
    v_exp_f32 v193, v193
    v_exp_f32 v194, v194
    v_smfmac_f32_32x32x32_bf16 v[176:191], v[120:123], v[240:247], v9
    v_exp_f32 v195, v195
    v_exp_f32 v196, v196
    v_exp_f32 v197, v197
    v_mfma_f32_32x32x16_bf16 v[208:223], v[68:71], v[44:47], v[208:223]
    v_exp_f32 v198, v198
    v_exp_f32 v199, v199
    v_exp_f32 v200, v200
    v_smfmac_f32_16x16x64_bf16 v[24:27], v[28:31], v[240:247], v9
    buffer_load_dwordx4 v[112:115], v1, s[4:7], s55 offen offset:0 sc1
    v_exp_f32 v201, v201
    v_smfmac_f32_32x32x32_bf16 v[176:191], v[124:127], v[248:255], v9
    v_exp_f32 v202, v202
    v_exp_f32 v203, v203
    v_exp_f32 v204, v204
    v_smfmac_f32_16x16x64_bf16 v[24:27], v[28:31], v[248:255], v9
    v_exp_f32 v205, v205
    v_exp_f32 v206, v206
    v_exp_f32 v207, v207
    v_mfma_f32_32x32x16_bf16 v[224:239], v[64:67], v[48:51], 0
    v_exp_f32 v208, v208
    v_exp_f32 v209, v209
    v_exp_f32 v210, v210
    v_smfmac_f32_32x32x32_bf16 v[128:143], v[72:75], v[192:199], v9
    v_exp_f32 v211, v211
    v_exp_f32 v212, v212
    v_exp_f32 v213, v213
    v_mfma_f32_32x32x16_bf16 v[224:239], v[68:71], v[52:55], v[224:239]
    v_exp_f32 v214, v214
    v_exp_f32 v215, v215
    v_exp_f32 v216, v216
    v_smfmac_f32_16x16x64_bf16 v[12:15], v[28:31], v[192:199], v9
    buffer_load_dwordx4 v[116:119], v1, s[4:7], s55 offen offset:1024 sc1
    v_exp_f32 v217, v217
    v_smfmac_f32_32x32x32_bf16 v[128:143], v[76:79], v[200:207], v9
    v_exp_f32 v218, v218
    v_exp_f32 v219, v219
    v_exp_f32 v220, v220
    v_smfmac_f32_16x16x64_bf16 v[12:15], v[28:31], v[200:207], v9
    v_exp_f32 v221, v221
    v_exp_f32 v222, v222
    v_exp_f32 v223, v223
    v_mfma_f32_32x32x16_bf16 v[240:255], v[64:67], v[56:59], 0
    v_exp_f32 v224, v224
    v_exp_f32 v225, v225
    v_exp_f32 v226, v226
    v_smfmac_f32_32x32x32_bf16 v[144:159], v[72:75], v[208:215], v9
    v_exp_f32 v227, v227
    v_exp_f32 v228, v228
    v_exp_f32 v229, v229
    v_mfma_f32_32x32x16_bf16 v[240:255], v[68:71], v[60:63], v[240:255]
    v_exp_f32 v230, v230
    v_exp_f32 v231, v231
    v_exp_f32 v232, v232
    v_smfmac_f32_16x16x64_bf16 v[16:19], v[28:31], v[208:215], v9
    buffer_load_dwordx4 v[120:123], v1, s[4:7], s56 offen offset:0 sc1
    v_exp_f32 v233, v233
    v_smfmac_f32_32x32x32_bf16 v[144:159], v[76:79], v[216:223], v9
    v_exp_f32 v234, v234
    v_exp_f32 v235, v235
    v_exp_f32 v236, v236
    v_smfmac_f32_16x16x64_bf16 v[16:19], v[28:31], v[216:223], v9
    v_exp_f32 v237, v237
    v_exp_f32 v238, v238
    v_exp_f32 v239, v239
    s_sub_u32 s58, s58, 1
    s_cmp_eq_u32 s58, 0
    s_cbranch_scc1 b_last
    s_cmp_eq_u32 s39, 0
    s_cbranch_scc1 b_loop
    s_barrier
    s_branch b_loop
b_last:
    s_waitcnt vmcnt(7)
    v_mfma_f32_32x32x16_bf16 v[192:207], v[80:83], v[32:35], 0
    v_exp_f32 v240, v240
    v_exp_f32 v241, v241
    v_exp_f32 v242, v242
    v_smfmac_f32_32x32x32_bf16 v[160:175], v[72:75], v[224:231], v9
    v_exp_f32 v243, v243
    v_exp_f32 v244, v244
    v_exp_f32 v245, v245
    v_mfma_f32_32x32x16_bf16 v[192:207], v[84:87], v[36:39], v[192:207]
    v_exp_f32 v246, v246
    v_exp_f32 v247, v247
    v_exp_f32 v248, v248
    v_smfmac_f32_16x16x64_bf16 v[20:23], v[28:31], v[224:231], v9
    buffer_load_dwordx4 v[124:127], v1, s[4:7], s56 offen offset:1024 sc1
    v_exp_f32 v249, v249
    v_smfmac_f32_32x32x32_bf16 v[160:175], v[76:79], v[232:239], v9
    v_exp_f32 v250, v250
    v_exp_f32 v251, v251
    v_exp_f32 v252, v252
    v_smfmac_f32_16x16x64_bf16 v[20:23], v[28:31], v[232:239], v9
    v_exp_f32 v253, v253
    v_exp_f32 v254, v254
    v_exp_f32 v255, v255
    v_mfma_f32_32x32x16_bf16 v[208:223], v[80:83], v[40:43], 0
    v_exp_f32 v192, v192
    v_exp_f32 v193, v193
    v_exp_f32 v194, v194
    v_smfmac_f32_32x32x32_bf16 v[176:191], v[72:75], v[240:247], v9
    v_exp_f32 v195, v195
    v_exp_f32 v196, v196
    v_exp_f32 v197, v197
    v_mfma_f32_32x32x16_bf16 v[208:223], v[84:87], v[44:47], v[208:223]
    v_exp_f32 v198, v198
    v_exp_f32 v199, v199
    v_exp_f32 v200, v200
    v_smfmac_f32_16x16x64_bf16 v[24:27], v[28:31], v[240:247], v9
    v_exp_f32 v201, v201
    v_smfmac_f32_32x32x32_bf16 v[176:191], v[76:79], v[248:255], v9
    v_exp_f32 v202, v202
    v_exp_f32 v203, v203
    v_exp_f32 v204, v204
    v_smfmac_f32_16x16x64_bf16 v[24:27], v[28:31], v[248:255], v9
    v_exp_f32 v205, v205
    v_exp_f32 v206, v206
    v_exp_f32 v207, v207
    v_mfma_f32_32x32x16_bf16 v[224:239], v[80:83], v[48:51], 0
    v_exp_f32 v208, v208
    v_exp_f32 v209, v209
    v_exp_f32 v210, v210
    v_smfmac_f32_32x32x32_bf16 v[128:143], v[88:91], v[192:199], v9
    v_exp_f32 v211, v211
    v_exp_f32 v212, v212
    v_exp_f32 v213, v213
    v_mfma_f32_32x32x16_bf16 v[224:239], v[84:87], v[52:55], v[224:239]
    v_exp_f32 v214, v214
    v_exp_f32 v215, v215
    v_exp_f32 v216, v216
    v_smfmac_f32_16x16x64_bf16 v[12:15], v[28:31], v[192:199], v9
    v_exp_f32 v217, v217
    v_smfmac_f32_32x32x32_bf16 v[128:143], v[92:95], v[200:207], v9
    v_exp_f32 v218, v218
    v_exp_f32 v219, v219
    v_exp_f32 v220, v220
    v_smfmac_f32_16x16x64_bf16 v[12:15], v[28:31], v[200:207], v9
    v_exp_f32 v221, v221
    v_exp_f32 v222, v222
    v_exp_f32 v223, v223
    v_mfma_f32_32x32x16_bf16 v[240:255], v[80:83], v[56:59], 0
    v_exp_f32 v224, v224
    v_exp_f32 v225, v225
    v_exp_f32 v226, v226
    v_smfmac_f32_32x32x32_bf16 v[144:159], v[88:91], v[208:215], v9
    v_exp_f32 v227, v227
    v_exp_f32 v228, v228
    v_exp_f32 v229, v229
    v_mfma_f32_32x32x16_bf16 v[240:255], v[84:87], v[60:63], v[240:255]
    v_exp_f32 v230, v230
    v_exp_f32 v231, v231
    v_exp_f32 v232, v232
    v_smfmac_f32_16x16x64_bf16 v[16:19], v[28:31], v[208:215], v9
    v_exp_f32 v233, v233
    v_smfmac_f32_32x32x32_bf16 v[144:159], v[92:95], v[216:223], v9
    v_exp_f32 v234, v234
    v_exp_f32 v235, v235
    v_exp_f32 v236, v236
    v_smfmac_f32_16x16x64_bf16 v[16:19], v[28:31], v[216:223], v9
    v_exp_f32 v237, v237
    v_exp_f32 v238, v238
    v_exp_f32 v239, v239
    s_waitcnt vmcnt(4)
    v_mfma_f32_32x32x16_bf16 v[192:207], v[96:99], v[32:35], 0
    v_exp_f32 v240, v240
    v_exp_f32 v241, v241
    v_exp_f32 v242, v242
    v_smfmac_f32_32x32x32_bf16 v[160:175], v[88:91], v[224:231], v9
    v_exp_f32 v243, v243
    v_exp_f32 v244, v244
    v_exp_f32 v245, v245
    v_mfma_f32_32x32x16_bf16 v[192:207], v[100:103], v[36:39], v[192:207]
    v_exp_f32 v246, v246
    v_exp_f32 v247, v247
    v_exp_f32 v248, v248
    v_smfmac_f32_16x16x64_bf16 v[20:23], v[28:31], v[224:231], v9
    v_exp_f32 v249, v249
    v_smfmac_f32_32x32x32_bf16 v[160:175], v[92:95], v[232:239], v9
    v_exp_f32 v250, v250
    v_exp_f32 v251, v251
    v_exp_f32 v252, v252
    v_smfmac_f32_16x16x64_bf16 v[20:23], v[28:31], v[232:239], v9
    v_exp_f32 v253, v253
    v_exp_f32 v254, v254
    v_exp_f32 v255, v255
    v_mfma_f32_32x32x16_bf16 v[208:223], v[96:99], v[40:43], 0
    v_exp_f32 v192, v192
    v_exp_f32 v193, v193
    v_exp_f32 v194, v194
    v_smfmac_f32_32x32x32_bf16 v[176:191], v[88:91], v[240:247], v9
    v_exp_f32 v195, v195
    v_exp_f32 v196, v196
    v_exp_f32 v197, v197
    v_mfma_f32_32x32x16_bf16 v[208:223], v[100:103], v[44:47], v[208:223]
    v_exp_f32 v198, v198
    v_exp_f32 v199, v199
    v_exp_f32 v200, v200
    v_smfmac_f32_16x16x64_bf16 v[24:27], v[28:31], v[240:247], v9
    v_exp_f32 v201, v201
    v_smfmac_f32_32x32x32_bf16 v[176:191], v[92:95], v[248:255], v9
    v_exp_f32 v202, v202
    v_exp_f32 v203, v203
    v_exp_f32 v204, v204
    v_smfmac_f32_16x16x64_bf16 v[24:27], v[28:31], v[248:255], v9
    v_exp_f32 v205, v205
    v_exp_f32 v206, v206
    v_exp_f32 v207, v207
    v_mfma_f32_32x32x16_bf16 v[224:239], v[96:99], v[48:51], 0
    v_exp_f32 v208, v208
    v_exp_f32 v209, v209
    v_exp_f32 v210, v210
    v_smfmac_f32_32x32x32_bf16 v[128:143], v[104:107], v[192:199], v9
    v_exp_f32 v211, v211
    v_exp_f32 v212, v212
    v_exp_f32 v213, v213
    v_mfma_f32_32x32x16_bf16 v[224:239], v[100:103], v[52:55], v[224:239]
    v_exp_f32 v214, v214
    v_exp_f32 v215, v215
    v_exp_f32 v216, v216
    v_smfmac_f32_16x16x64_bf16 v[12:15], v[28:31], v[192:199], v9
    v_exp_f32 v217, v217
    v_smfmac_f32_32x32x32_bf16 v[128:143], v[108:111], v[200:207], v9
    v_exp_f32 v218, v218
    v_exp_f32 v219, v219
    v_exp_f32 v220, v220
    v_smfmac_f32_16x16x64_bf16 v[12:15], v[28:31], v[200:207], v9
    v_exp_f32 v221, v221
    v_exp_f32 v222, v222
    v_exp_f32 v223, v223
    v_mfma_f32_32x32x16_bf16 v[240:255], v[96:99], v[56:59], 0
    v_exp_f32 v224, v224
    v_exp_f32 v225, v225
    v_exp_f32 v226, v226
    v_smfmac_f32_32x32x32_bf16 v[144:159], v[104:107], v[208:215], v9
    v_exp_f32 v227, v227
    v_exp_f32 v228, v228
    v_exp_f32 v229, v229
    v_mfma_f32_32x32x16_bf16 v[240:255], v[100:103], v[60:63], v[240:255]
    v_exp_f32 v230, v230
    v_exp_f32 v231, v231
    v_exp_f32 v232, v232
    v_smfmac_f32_16x16x64_bf16 v[16:19], v[28:31], v[208:215], v9
    v_exp_f32 v233, v233
    v_smfmac_f32_32x32x32_bf16 v[144:159], v[108:111], v[216:223], v9
    v_exp_f32 v234, v234
    v_exp_f32 v235, v235
    v_exp_f32 v236, v236
    v_smfmac_f32_16x16x64_bf16 v[16:19], v[28:31], v[216:223], v9
    v_exp_f32 v237, v237
    v_exp_f32 v238, v238
    v_exp_f32 v239, v239
    s_waitcnt vmcnt(0)
    v_mfma_f32_32x32x16_bf16 v[192:207], v[112:115], v[32:35], 0
    v_exp_f32 v240, v240
    v_exp_f32 v241, v241
    v_exp_f32 v242, v242
    v_smfmac_f32_32x32x32_bf16 v[160:175], v[104:107], v[224:231], v9
    v_exp_f32 v243, v243
    v_exp_f32 v244, v244
    v_exp_f32 v245, v245
    v_mfma_f32_32x32x16_bf16 v[192:207], v[116:119], v[36:39], v[192:207]
    v_exp_f32 v246, v246
    v_exp_f32 v247, v247
    v_exp_f32 v248, v248
    v_smfmac_f32_16x16x64_bf16 v[20:23], v[28:31], v[224:231], v9
    v_exp_f32 v249, v249
    v_smfmac_f32_32x32x32_bf16 v[160:175], v[108:111], v[232:239], v9
    v_exp_f32 v250, v250
    v_exp_f32 v251, v251
    v_exp_f32 v252, v252
    v_smfmac_f32_16x16x64_bf16 v[20:23], v[28:31], v[232:239], v9
    v_exp_f32 v253, v253
    v_exp_f32 v254, v254
    v_exp_f32 v255, v255
    v_mfma_f32_32x32x16_bf16 v[208:223], v[112:115], v[40:43], 0
    v_exp_f32 v192, v192
    v_exp_f32 v193, v193
    v_exp_f32 v194, v194
    v_smfmac_f32_32x32x32_bf16 v[176:191], v[104:107], v[240:247], v9
    v_exp_f32 v195, v195
    v_exp_f32 v196, v196
    v_exp_f32 v197, v197
    v_mfma_f32_32x32x16_bf16 v[208:223], v[116:119], v[44:47], v[208:223]
    v_exp_f32 v198, v198
    v_exp_f32 v199, v199
    v_exp_f32 v200, v200
    v_smfmac_f32_16x16x64_bf16 v[24:27], v[28:31], v[240:247], v9
    v_exp_f32 v201, v201
    v_smfmac_f32_32x32x32_bf16 v[176:191], v[108:111], v[248:255], v9
    v_exp_f32 v202, v202
    v_exp_f32 v203, v203
    v_exp_f32 v204, v204
    v_smfmac_f32_16x16x64_bf16 v[24:27], v[28:31], v[248:255], v9
    v_exp_f32 v205, v205
    v_exp_f32 v206, v206
    v_exp_f32 v207, v207
    v_mfma_f32_32x32x16_bf16 v[224:239], v[112:115], v[48:51], 0
    v_exp_f32 v208, v208
    v_exp_f32 v209, v209
    v_exp_f32 v210, v210
    v_smfmac_f32_32x32x32_bf16 v[128:143], v[120:123], v[192:199], v9
    v_exp_f32 v211, v211
    v_exp_f32 v212, v212
    v_exp_f32 v213, v213
    v_mfma_f32_32x32x16_bf16 v[224:239], v[116:119], v[52:55], v[224:239]
    v_exp_f32 v214, v214
    v_exp_f32 v215, v215
    v_exp_f32 v216, v216
    v_smfmac_f32_16x16x64_bf16 v[12:15], v[28:31], v[192:199], v9
    v_exp_f32 v217, v217
    v_smfmac_f32_32x32x32_bf16 v[128:143], v[124:127], v[200:207], v9
    v_exp_f32 v218, v218
    v_exp_f32 v219, v219
    v_exp_f32 v220, v220
    v_smfmac_f32_16x16x64_bf16 v[12:15], v[28:31], v[200:207], v9
    v_exp_f32 v221, v221
    v_exp_f32 v222, v222
    v_exp_f32 v223, v223
    v_mfma_f32_32x32x16_bf16 v[240:255], v[112:115], v[56:59], 0
    v_exp_f32 v224, v224
    v_exp_f32 v225, v225
    v_exp_f32 v226, v226
    v_smfmac_f32_32x32x32_bf16 v[144:159], v[120:123], v[208:215], v9
    ds_write_b128 v5, v[128:131] offset:0
    v_exp_f32 v227, v227
    v_exp_f32 v228, v228
    v_exp_f32 v229, v229
    v_mfma_f32_32x32x16_bf16 v[240:255], v[116:119], v[60:63], v[240:255]
    ds_write_b128 v5, v[132:135] offset:1024
    v_exp_f32 v230, v230
    v_exp_f32 v231, v231
    v_exp_f32 v232, v232
    v_smfmac_f32_16x16x64_bf16 v[16:19], v[28:31], v[208:215], v9
    ds_write_b32 v6, v12 offset:0
    v_exp_f32 v233, v233
    v_smfmac_f32_32x32x32_bf16 v[144:159], v[124:127], v[216:223], v9
    ds_write_b128 v5, v[136:139] offset:2048
    v_exp_f32 v234, v234
    v_exp_f32 v235, v235
    v_exp_f32 v236, v236
    v_smfmac_f32_16x16x64_bf16 v[16:19], v[28:31], v[216:223], v9
    ds_write_b128 v5, v[140:143] offset:3072
    v_exp_f32 v237, v237
    v_exp_f32 v238, v238
    v_exp_f32 v239, v239
    v_exp_f32 v240, v240
    v_exp_f32 v241, v241
    v_exp_f32 v242, v242
    v_smfmac_f32_32x32x32_bf16 v[160:175], v[120:123], v[224:231], v9
    ds_write_b128 v5, v[144:147] offset:16384
    v_exp_f32 v243, v243
    v_exp_f32 v244, v244
    v_exp_f32 v245, v245
    ds_write_b128 v5, v[148:151] offset:17408
    v_exp_f32 v246, v246
    v_exp_f32 v247, v247
    v_exp_f32 v248, v248
    v_smfmac_f32_16x16x64_bf16 v[20:23], v[28:31], v[224:231], v9
    ds_write_b32 v6, v16 offset:1024
    v_exp_f32 v249, v249
    v_smfmac_f32_32x32x32_bf16 v[160:175], v[124:127], v[232:239], v9
    ds_write_b128 v5, v[152:155] offset:18432
    v_exp_f32 v250, v250
    v_exp_f32 v251, v251
    v_exp_f32 v252, v252
    v_smfmac_f32_16x16x64_bf16 v[20:23], v[28:31], v[232:239], v9
    ds_write_b128 v5, v[156:159] offset:19456
    v_exp_f32 v253, v253
    v_exp_f32 v254, v254
    v_exp_f32 v255, v255
    v_smfmac_f32_32x32x32_bf16 v[176:191], v[120:123], v[240:247], v9
    s_nop 0
    v_smfmac_f32_32x32x32_bf16 v[176:191], v[124:127], v[248:255], v9
    ds_write_b128 v5, v[160:163] offset:32768
    ds_write_b128 v5, v[164:167] offset:33792
    v_smfmac_f32_16x16x64_bf16 v[24:27], v[28:31], v[240:247], v9
    ds_write_b128 v5, v[168:171] offset:34816
    v_smfmac_f32_16x16x64_bf16 v[24:27], v[28:31], v[248:255], v9
    ds_write_b128 v5, v[172:175] offset:35840
    ds_write_b32 v6, v20 offset:2048
    s_nop 4
    ds_write_b128 v5, v[176:179] offset:49152
    ds_write_b128 v5, v[180:183] offset:50176
    ds_write_b128 v5, v[184:187] offset:51200
    ds_write_b128 v5, v[188:191] offset:52224
    s_nop 0
    ds_write_b32 v6, v24 offset:3072
    s_cmp_eq_u32 s39, 0
    s_cbranch_scc1 s_att_done
    buffer_load_dwordx4 v[224:227], v2, s[4:7], s43 offen offset:0 sc1
    buffer_load_dwordx4 v[228:231], v2, s[4:7], s43 offen offset:256 sc1
    buffer_load_dwordx4 v[232:235], v2, s[4:7], s43 offen offset:2048 sc1
    buffer_load_dwordx4 v[236:239], v2, s[4:7], s43 offen offset:2304 sc1
    s_waitcnt lgkmcnt(0)
    s_barrier
    s_xor_b32 s42, s41, 0
    buffer_load_dwordx4 v[64:67], v2, s[4:7], s42 offen offset:0 sc1
    buffer_load_dwordx4 v[68:71], v2, s[4:7], s42 offen offset:256 sc1
    s_xor_b32 s42, s41, 4096
    buffer_load_dwordx4 v[72:75], v2, s[4:7], s42 offen offset:0 sc1
    buffer_load_dwordx4 v[76:79], v2, s[4:7], s42 offen offset:256 sc1
    s_xor_b32 s42, s41, 8192
    buffer_load_dwordx4 v[80:83], v2, s[4:7], s42 offen offset:0 sc1
    buffer_load_dwordx4 v[84:87], v2, s[4:7], s42 offen offset:256 sc1
    s_xor_b32 s42, s41, 12288
    buffer_load_dwordx4 v[88:91], v2, s[4:7], s42 offen offset:0 sc1
    buffer_load_dwordx4 v[92:95], v2, s[4:7], s42 offen offset:256 sc1
    s_xor_b32 s42, s41, 16384
    buffer_load_dwordx4 v[96:99], v2, s[4:7], s42 offen offset:0 sc1
    buffer_load_dwordx4 v[100:103], v2, s[4:7], s42 offen offset:256 sc1
    v_xor_b32 v4, 32, v3
    v_xor_b32 v5, 64, v3
    v_xor_b32 v6, 96, v3
    ds_read_b64_tr_b16 v[32:33], v3 offset:0
    ds_read_b64_tr_b16 v[34:35], v3 offset:1024
    ds_read_b64_tr_b16 v[36:37], v4 offset:0
    ds_read_b64_tr_b16 v[38:39], v4 offset:1024
    ds_read_b64_tr_b16 v[40:41], v5 offset:0
    ds_read_b64_tr_b16 v[42:43], v5 offset:1024
    ds_read_b64_tr_b16 v[44:45], v6 offset:0
    ds_read_b64_tr_b16 v[46:47], v6 offset:1024
    ds_read_b64_tr_b16 v[48:49], v3 offset:4096
    ds_read_b64_tr_b16 v[50:51], v3 offset:5120
    ds_read_b64_tr_b16 v[52:53], v4 offset:4096
    ds_read_b64_tr_b16 v[54:55], v4 offset:5120
    ds_read_b64_tr_b16 v[56:57], v5 offset:4096
    ds_read_b64_tr_b16 v[58:59], v5 offset:5120
    v_lshrrev_b32 v12, 4, v1
    v_and_b32 v13, 1, v12
    v_lshlrev_b32 v13, 4, v13
    v_mov_b32 v14, 0x3f80
    v_lshlrev_b32 v13, v13, v14
    v_lshrrev_b32 v14, 2, v12
    v_lshrrev_b32 v15, 4, v12
    v_xor_b32 v14, v14, v15
    v_and_b32 v14, 1, v14
    v_bfe_u32 v15, v12, 3, 1
    v_bfe_u32 v16, v12, 1, 1
    v_lshl_add_u32 v15, v15, 1, v16
    v_lshrrev_b32 v16, 5, v12
    v_lshl_add_u32 v15, v16, 2, v15
    v_lshl_add_u32 v15, v14, 3, v15
    v_cmp_eq_u32 vcc, 0, v15
    s_nop 1
    v_cndmask_b32 v240, 0, v13, vcc
    v_cmp_eq_u32 vcc, 1, v15
    s_nop 1
    v_cndmask_b32 v241, 0, v13, vcc
    v_cmp_eq_u32 vcc, 2, v15
    s_nop 1
    v_cndmask_b32 v242, 0, v13, vcc
    v_cmp_eq_u32 vcc, 3, v15
    s_nop 1
    v_cndmask_b32 v243, 0, v13, vcc
    v_cmp_eq_u32 vcc, 4, v15
    s_nop 1
    v_cndmask_b32 v244, 0, v13, vcc
    v_cmp_eq_u32 vcc, 5, v15
    s_nop 1
    v_cndmask_b32 v245, 0, v13, vcc
    v_cmp_eq_u32 vcc, 6, v15
    s_nop 1
    v_cndmask_b32 v246, 0, v13, vcc
    v_cmp_eq_u32 vcc, 7, v15
    s_nop 1
    v_cndmask_b32 v247, 0, v13, vcc
    s_mov_b32 s8, s32
    s_mov_b32 s9, s33
    s_mov_b32 s10, 4194304
    s_mov_b32 s11, 0x00020000
    s_mul_i32 s49, s16, 4608
    s_add_u32 s49, s49, 131072
    v_and_b32 v13, 15, v12
    v_mul_u32_u24 v13, 144, v13
    v_lshrrev_b32 v14, 4, v12
    v_lshl_add_u32 v13, v14, 3, v13
    v_add_u32 v17, s49, v13
    v_lshrrev_b32 v14, 3, v12
    v_and_b32 v15, 7, v12
    v_mul_u32_u24 v16, 144, v14
    v_lshl_add_u32 v16, v15, 4, v16
    v_add_u32 v18, s49, v16
    v_lshlrev_b32 v19, 11, v14
    v_lshl_add_u32 v19, v15, 4, v19
    s_lshl_b32 s50, s38, 16
    s_lshl_b32 s49, s18, 7
    s_add_u32 s50, s50, s49
    s_waitcnt vmcnt(10)
    v_mfma_f32_16x16x32_bf16 v[128:131], v[240:243], v[224:227], 0
    v_mfma_f32_16x16x32_bf16 v[132:135], v[240:243], v[228:231], 0
    v_mfma_f32_16x16x32_bf16 v[136:139], v[244:247], v[224:227], 0
    v_mfma_f32_16x16x32_bf16 v[140:143], v[244:247], v[228:231], 0
    v_mfma_f32_16x16x32_bf16 v[144:147], v[240:243], v[232:235], 0
    v_mfma_f32_16x16x32_bf16 v[148:151], v[240:243], v[236:239], 0
    v_mfma_f32_16x16x32_bf16 v[152:155], v[244:247], v[232:235], 0
    v_mfma_f32_16x16x32_bf16 v[156:159], v[244:247], v[236:239], 0
c_wo:
    s_waitcnt vmcnt(8) lgkmcnt(10)
    v_mfma_f32_16x16x32_bf16 v[128:131], v[32:35], v[64:67], v[128:131]
    ds_read_b64_tr_b16 v[60:61], v6 offset:4096
    s_xor_b32 s42, s41, 20480
    buffer_load_dwordx4 v[104:107], v2, s[4:7], s42 offen offset:0 sc1
    v_mfma_f32_16x16x32_bf16 v[132:135], v[32:35], v[68:71], v[132:135]
    ds_read_b64_tr_b16 v[62:63], v6 offset:5120
    v_mfma_f32_16x16x32_bf16 v[136:139], v[36:39], v[64:67], v[136:139]
    ds_read_b64_tr_b16 v[32:33], v3 offset:8192
    v_mfma_f32_16x16x32_bf16 v[140:143], v[36:39], v[68:71], v[140:143]
    ds_read_b64_tr_b16 v[34:35], v3 offset:9216
    s_waitcnt lgkmcnt(10)
    v_mfma_f32_16x16x32_bf16 v[144:147], v[40:43], v[64:67], v[144:147]
    buffer_load_dwordx4 v[108:111], v2, s[4:7], s42 offen offset:256 sc1
    ds_read_b64_tr_b16 v[36:37], v4 offset:8192
    s_xor_b32 s42, s41, 24576
    v_mfma_f32_16x16x32_bf16 v[148:151], v[40:43], v[68:71], v[148:151]
    ds_read_b64_tr_b16 v[38:39], v4 offset:9216
    v_mfma_f32_16x16x32_bf16 v[152:155], v[44:47], v[64:67], v[152:155]
    ds_read_b64_tr_b16 v[40:41], v5 offset:8192
    v_mfma_f32_16x16x32_bf16 v[156:159], v[44:47], v[68:71], v[156:159]
    ds_read_b64_tr_b16 v[42:43], v5 offset:9216
    s_waitcnt vmcnt(8) lgkmcnt(10)
    v_mfma_f32_16x16x32_bf16 v[128:131], v[48:51], v[72:75], v[128:131]
    buffer_load_dwordx4 v[112:115], v2, s[4:7], s42 offen offset:0 sc1
    ds_read_b64_tr_b16 v[44:45], v6 offset:8192
    v_mfma_f32_16x16x32_bf16 v[132:135], v[48:51], v[76:79], v[132:135]
    ds_read_b64_tr_b16 v[46:47], v6 offset:9216
    v_mfma_f32_16x16x32_bf16 v[136:139], v[52:55], v[72:75], v[136:139]
    ds_read_b64_tr_b16 v[48:49], v3 offset:12288
    v_mfma_f32_16x16x32_bf16 v[140:143], v[52:55], v[76:79], v[140:143]
    ds_read_b64_tr_b16 v[50:51], v3 offset:13312
    s_waitcnt lgkmcnt(10)
    v_mfma_f32_16x16x32_bf16 v[144:147], v[56:59], v[72:75], v[144:147]
    buffer_load_dwordx4 v[116:119], v2, s[4:7], s42 offen offset:256 sc1
    ds_read_b64_tr_b16 v[52:53], v4 offset:12288
    s_xor_b32 s42, s41, 28672
    v_mfma_f32_16x16x32_bf16 v[148:151], v[56:59], v[76:79], v[148:151]
    ds_read_b64_tr_b16 v[54:55], v4 offset:13312
    v_mfma_f32_16x16x32_bf16 v[152:155], v[60:63], v[72:75], v[152:155]
    ds_read_b64_tr_b16 v[56:57], v5 offset:12288
    v_mfma_f32_16x16x32_bf16 v[156:159], v[60:63], v[76:79], v[156:159]
    ds_read_b64_tr_b16 v[58:59], v5 offset:13312
    s_waitcnt vmcnt(8) lgkmcnt(10)
    v_mfma_f32_16x16x32_bf16 v[128:131], v[32:35], v[80:83], v[128:131]
    ds_read_b64_tr_b16 v[60:61], v6 offset:12288
    buffer_load_dwordx4 v[120:123], v2, s[4:7], s42 offen offset:0 sc1
    v_mfma_f32_16x16x32_bf16 v[132:135], v[32:35], v[84:87], v[132:135]
    ds_read_b64_tr_b16 v[62:63], v6 offset:13312
    v_mfma_f32_16x16x32_bf16 v[136:139], v[36:39], v[80:83], v[136:139]
    ds_read_b64_tr_b16 v[32:33], v3 offset:16384
    v_mfma_f32_16x16x32_bf16 v[140:143], v[36:39], v[84:87], v[140:143]
    ds_read_b64_tr_b16 v[34:35], v3 offset:17408
    s_waitcnt lgkmcnt(10)
    v_mfma_f32_16x16x32_bf16 v[144:147], v[40:43], v[80:83], v[144:147]
    buffer_load_dwordx4 v[124:127], v2, s[4:7], s42 offen offset:256 sc1
    ds_read_b64_tr_b16 v[36:37], v4 offset:16384
    s_xor_b32 s42, s41, 32768
    v_mfma_f32_16x16x32_bf16 v[148:151], v[40:43], v[84:87], v[148:151]
    ds_read_b64_tr_b16 v[38:39], v4 offset:17408
    v_mfma_f32_16x16x32_bf16 v[152:155], v[44:47], v[80:83], v[152:155]
    ds_read_b64_tr_b16 v[40:41], v5 offset:16384
    v_mfma_f32_16x16x32_bf16 v[156:159], v[44:47], v[84:87], v[156:159]
    ds_read_b64_tr_b16 v[42:43], v5 offset:17408
    s_waitcnt vmcnt(8) lgkmcnt(10)
    v_mfma_f32_16x16x32_bf16 v[128:131], v[48:51], v[88:91], v[128:131]
    buffer_load_dwordx4 v[160:163], v2, s[4:7], s42 offen offset:0 sc1
    ds_read_b64_tr_b16 v[44:45], v6 offset:16384
    v_mfma_f32_16x16x32_bf16 v[132:135], v[48:51], v[92:95], v[132:135]
    ds_read_b64_tr_b16 v[46:47], v6 offset:17408
    v_mfma_f32_16x16x32_bf16 v[136:139], v[52:55], v[88:91], v[136:139]
    ds_read_b64_tr_b16 v[48:49], v3 offset:20480
    v_mfma_f32_16x16x32_bf16 v[140:143], v[52:55], v[92:95], v[140:143]
    ds_read_b64_tr_b16 v[50:51], v3 offset:21504
    s_waitcnt lgkmcnt(10)
    v_mfma_f32_16x16x32_bf16 v[144:147], v[56:59], v[88:91], v[144:147]
    buffer_load_dwordx4 v[164:167], v2, s[4:7], s42 offen offset:256 sc1
    ds_read_b64_tr_b16 v[52:53], v4 offset:20480
    s_xor_b32 s42, s41, 36864
    v_mfma_f32_16x16x32_bf16 v[148:151], v[56:59], v[92:95], v[148:151]
    ds_read_b64_tr_b16 v[54:55], v4 offset:21504
    v_mfma_f32_16x16x32_bf16 v[152:155], v[60:63], v[88:91], v[152:155]
    ds_read_b64_tr_b16 v[56:57], v5 offset:20480
    v_mfma_f32_16x16x32_bf16 v[156:159], v[60:63], v[92:95], v[156:159]
    ds_read_b64_tr_b16 v[58:59], v5 offset:21504
    s_waitcnt vmcnt(8) lgkmcnt(10)
    v_mfma_f32_16x16x32_bf16 v[128:131], v[32:35], v[96:99], v[128:131]
    ds_read_b64_tr_b16 v[60:61], v6 offset:20480
    buffer_load_dwordx4 v[168:171], v2, s[4:7], s42 offen offset:0 sc1
    v_mfma_f32_16x16x32_bf16 v[132:135], v[32:35], v[100:103], v[132:135]
    ds_read_b64_tr_b16 v[62:63], v6 offset:21504
    v_mfma_f32_16x16x32_bf16 v[136:139], v[36:39], v[96:99], v[136:139]
    ds_read_b64_tr_b16 v[32:33], v3 offset:24576
    v_mfma_f32_16x16x32_bf16 v[140:143], v[36:39], v[100:103], v[140:143]
    ds_read_b64_tr_b16 v[34:35], v3 offset:25600
    s_waitcnt lgkmcnt(10)
    v_mfma_f32_16x16x32_bf16 v[144:147], v[40:43], v[96:99], v[144:147]
    buffer_load_dwordx4 v[172:175], v2, s[4:7], s42 offen offset:256 sc1
    ds_read_b64_tr_b16 v[36:37], v4 offset:24576
    s_xor_b32 s42, s41, 40960
    v_mfma_f32_16x16x32_bf16 v[148:151], v[40:43], v[100:103], v[148:151]
    ds_read_b64_tr_b16 v[38:39], v4 offset:25600
    v_mfma_f32_16x16x32_bf16 v[152:155], v[44:47], v[96:99], v[152:155]
    ds_read_b64_tr_b16 v[40:41], v5 offset:24576
    v_mfma_f32_16x16x32_bf16 v[156:159], v[44:47], v[100:103], v[156:159]
    ds_read_b64_tr_b16 v[42:43], v5 offset:25600
    s_waitcnt vmcnt(8) lgkmcnt(10)
    v_mfma_f32_16x16x32_bf16 v[128:131], v[48:51], v[104:107], v[128:131]
    buffer_load_dwordx4 v[176:179], v2, s[4:7], s42 offen offset:0 sc1
    ds_read_b64_tr_b16 v[44:45], v6 offset:24576
    v_mfma_f32_16x16x32_bf16 v[132:135], v[48:51], v[108:111], v[132:135]
    ds_read_b64_tr_b16 v[46:47], v6 offset:25600
    v_mfma_f32_16x16x32_bf16 v[136:139], v[52:55], v[104:107], v[136:139]
    ds_read_b64_tr_b16 v[48:49], v3 offset:28672
    v_mfma_f32_16x16x32_bf16 v[140:143], v[52:55], v[108:111], v[140:143]
    ds_read_b64_tr_b16 v[50:51], v3 offset:29696
    s_waitcnt lgkmcnt(10)
    v_mfma_f32_16x16x32_bf16 v[144:147], v[56:59], v[104:107], v[144:147]
    buffer_load_dwordx4 v[180:183], v2, s[4:7], s42 offen offset:256 sc1
    ds_read_b64_tr_b16 v[52:53], v4 offset:28672
    s_xor_b32 s42, s41, 45056
    v_mfma_f32_16x16x32_bf16 v[148:151], v[56:59], v[108:111], v[148:151]
    ds_read_b64_tr_b16 v[54:55], v4 offset:29696
    v_mfma_f32_16x16x32_bf16 v[152:155], v[60:63], v[104:107], v[152:155]
    ds_read_b64_tr_b16 v[56:57], v5 offset:28672
    v_mfma_f32_16x16x32_bf16 v[156:159], v[60:63], v[108:111], v[156:159]
    ds_read_b64_tr_b16 v[58:59], v5 offset:29696
    s_waitcnt vmcnt(8) lgkmcnt(10)
    v_mfma_f32_16x16x32_bf16 v[128:131], v[32:35], v[112:115], v[128:131]
    ds_read_b64_tr_b16 v[60:61], v6 offset:28672
    buffer_load_dwordx4 v[184:187], v2, s[4:7], s42 offen offset:0 sc1
    v_mfma_f32_16x16x32_bf16 v[132:135], v[32:35], v[116:119], v[132:135]
    ds_read_b64_tr_b16 v[62:63], v6 offset:29696
    v_mfma_f32_16x16x32_bf16 v[136:139], v[36:39], v[112:115], v[136:139]
    ds_read_b64_tr_b16 v[32:33], v3 offset:32768
    v_mfma_f32_16x16x32_bf16 v[140:143], v[36:39], v[116:119], v[140:143]
    ds_read_b64_tr_b16 v[34:35], v3 offset:33792
    s_waitcnt lgkmcnt(10)
    v_mfma_f32_16x16x32_bf16 v[144:147], v[40:43], v[112:115], v[144:147]
    buffer_load_dwordx4 v[188:191], v2, s[4:7], s42 offen offset:256 sc1
    ds_read_b64_tr_b16 v[36:37], v4 offset:32768
    s_xor_b32 s42, s41, 49152
    v_mfma_f32_16x16x32_bf16 v[148:151], v[40:43], v[116:119], v[148:151]
    ds_read_b64_tr_b16 v[38:39], v4 offset:33792
    v_mfma_f32_16x16x32_bf16 v[152:155], v[44:47], v[112:115], v[152:155]
    ds_read_b64_tr_b16 v[40:41], v5 offset:32768
    v_mfma_f32_16x16x32_bf16 v[156:159], v[44:47], v[116:119], v[156:159]
    ds_read_b64_tr_b16 v[42:43], v5 offset:33792
    s_waitcnt vmcnt(8) lgkmcnt(10)
    v_mfma_f32_16x16x32_bf16 v[128:131], v[48:51], v[120:123], v[128:131]
    buffer_load_dwordx4 v[64:67], v2, s[4:7], s42 offen offset:0 sc1
    ds_read_b64_tr_b16 v[44:45], v6 offset:32768
    v_mfma_f32_16x16x32_bf16 v[132:135], v[48:51], v[124:127], v[132:135]
    ds_read_b64_tr_b16 v[46:47], v6 offset:33792
    v_mfma_f32_16x16x32_bf16 v[136:139], v[52:55], v[120:123], v[136:139]
    ds_read_b64_tr_b16 v[48:49], v3 offset:36864
    v_mfma_f32_16x16x32_bf16 v[140:143], v[52:55], v[124:127], v[140:143]
    ds_read_b64_tr_b16 v[50:51], v3 offset:37888
    s_waitcnt lgkmcnt(10)
    v_mfma_f32_16x16x32_bf16 v[144:147], v[56:59], v[120:123], v[144:147]
    buffer_load_dwordx4 v[68:71], v2, s[4:7], s42 offen offset:256 sc1
    ds_read_b64_tr_b16 v[52:53], v4 offset:36864
    s_xor_b32 s42, s41, 53248
    v_mfma_f32_16x16x32_bf16 v[148:151], v[56:59], v[124:127], v[148:151]
    ds_read_b64_tr_b16 v[54:55], v4 offset:37888
    v_mfma_f32_16x16x32_bf16 v[152:155], v[60:63], v[120:123], v[152:155]
    ds_read_b64_tr_b16 v[56:57], v5 offset:36864
    v_mfma_f32_16x16x32_bf16 v[156:159], v[60:63], v[124:127], v[156:159]
    ds_read_b64_tr_b16 v[58:59], v5 offset:37888
    s_waitcnt vmcnt(8) lgkmcnt(10)
    v_mfma_f32_16x16x32_bf16 v[128:131], v[32:35], v[160:163], v[128:131]
    ds_read_b64_tr_b16 v[60:61], v6 offset:36864
    buffer_load_dwordx4 v[72:75], v2, s[4:7], s42 offen offset:0 sc1
    v_mfma_f32_16x16x32_bf16 v[132:135], v[32:35], v[164:167], v[132:135]
    ds_read_b64_tr_b16 v[62:63], v6 offset:37888
    v_mfma_f32_16x16x32_bf16 v[136:139], v[36:39], v[160:163], v[136:139]
    ds_read_b64_tr_b16 v[32:33], v3 offset:40960
    v_mfma_f32_16x16x32_bf16 v[140:143], v[36:39], v[164:167], v[140:143]
    ds_read_b64_tr_b16 v[34:35], v3 offset:41984
    s_waitcnt lgkmcnt(10)
    v_mfma_f32_16x16x32_bf16 v[144:147], v[40:43], v[160:163], v[144:147]
    buffer_load_dwordx4 v[76:79], v2, s[4:7], s42 offen offset:256 sc1
    ds_read_b64_tr_b16 v[36:37], v4 offset:40960
    s_xor_b32 s42, s41, 57344
    v_mfma_f32_16x16x32_bf16 v[148:151], v[40:43], v[164:167], v[148:151]
    ds_read_b64_tr_b16 v[38:39], v4 offset:41984
    v_mfma_f32_16x16x32_bf16 v[152:155], v[44:47], v[160:163], v[152:155]
    ds_read_b64_tr_b16 v[40:41], v5 offset:40960
    v_mfma_f32_16x16x32_bf16 v[156:159], v[44:47], v[164:167], v[156:159]
    ds_read_b64_tr_b16 v[42:43], v5 offset:41984
    s_waitcnt vmcnt(8) lgkmcnt(10)
    v_mfma_f32_16x16x32_bf16 v[128:131], v[48:51], v[168:171], v[128:131]
    buffer_load_dwordx4 v[80:83], v2, s[4:7], s42 offen offset:0 sc1
    ds_read_b64_tr_b16 v[44:45], v6 offset:40960
    v_mfma_f32_16x16x32_bf16 v[132:135], v[48:51], v[172:175], v[132:135]
    ds_read_b64_tr_b16 v[46:47], v6 offset:41984
    v_mfma_f32_16x16x32_bf16 v[136:139], v[52:55], v[168:171], v[136:139]
    ds_read_b64_tr_b16 v[48:49], v3 offset:45056
    v_mfma_f32_16x16x32_bf16 v[140:143], v[52:55], v[172:175], v[140:143]
    ds_read_b64_tr_b16 v[50:51], v3 offset:46080
    s_waitcnt lgkmcnt(10)
    v_mfma_f32_16x16x32_bf16 v[144:147], v[56:59], v[168:171], v[144:147]
    buffer_load_dwordx4 v[84:87], v2, s[4:7], s42 offen offset:256 sc1
    ds_read_b64_tr_b16 v[52:53], v4 offset:45056
    s_xor_b32 s42, s41, 61440
    v_mfma_f32_16x16x32_bf16 v[148:151], v[56:59], v[172:175], v[148:151]
    ds_read_b64_tr_b16 v[54:55], v4 offset:46080
    v_mfma_f32_16x16x32_bf16 v[152:155], v[60:63], v[168:171], v[152:155]
    ds_read_b64_tr_b16 v[56:57], v5 offset:45056
    v_mfma_f32_16x16x32_bf16 v[156:159], v[60:63], v[172:175], v[156:159]
    ds_read_b64_tr_b16 v[58:59], v5 offset:46080
    s_waitcnt vmcnt(8) lgkmcnt(10)
    v_mfma_f32_16x16x32_bf16 v[128:131], v[32:35], v[176:179], v[128:131]
    ds_read_b64_tr_b16 v[60:61], v6 offset:45056
    buffer_load_dwordx4 v[88:91], v2, s[4:7], s42 offen offset:0 sc1
    v_mfma_f32_16x16x32_bf16 v[132:135], v[32:35], v[180:183], v[132:135]
    ds_read_b64_tr_b16 v[62:63], v6 offset:46080
    s_barrier
    v_mfma_f32_16x16x32_bf16 v[136:139], v[36:39], v[176:179], v[136:139]
    ds_read_b64_tr_b16 v[32:33], v3 offset:49152
    v_mfma_f32_16x16x32_bf16 v[140:143], v[36:39], v[180:183], v[140:143]
    ds_read_b64_tr_b16 v[34:35], v3 offset:50176
    s_waitcnt lgkmcnt(10)
    v_mfma_f32_16x16x32_bf16 v[144:147], v[40:43], v[176:179], v[144:147]
    buffer_load_dwordx4 v[92:95], v2, s[4:7], s42 offen offset:256 sc1
    ds_read_b64_tr_b16 v[36:37], v4 offset:49152
    s_xor_b32 s42, s41, 0
    v_mfma_f32_16x16x32_bf16 v[148:151], v[40:43], v[180:183], v[148:151]
    ds_read_b64_tr_b16 v[38:39], v4 offset:50176
    v_mfma_f32_16x16x32_bf16 v[152:155], v[44:47], v[176:179], v[152:155]
    ds_read_b64_tr_b16 v[40:41], v5 offset:49152
    v_mfma_f32_16x16x32_bf16 v[156:159], v[44:47], v[180:183], v[156:159]
    ds_read_b64_tr_b16 v[42:43], v5 offset:50176
    s_waitcnt vmcnt(8) lgkmcnt(10)
    v_mfma_f32_16x16x32_bf16 v[128:131], v[48:51], v[184:187], v[128:131]
    buffer_load_dwordx4 v[96:99], v2, s[4:7], s42 offen offset:2048 sc1
    ds_read_b64_tr_b16 v[44:45], v6 offset:49152
    v_mfma_f32_16x16x32_bf16 v[132:135], v[48:51], v[188:191], v[132:135]
    ds_read_b64_tr_b16 v[46:47], v6 offset:50176
    v_mfma_f32_16x16x32_bf16 v[136:139], v[52:55], v[184:187], v[136:139]
    ds_read_b64_tr_b16 v[48:49], v3 offset:53248
    v_mfma_f32_16x16x32_bf16 v[140:143], v[52:55], v[188:191], v[140:143]
    ds_read_b64_tr_b16 v[50:51], v3 offset:54272
    s_waitcnt lgkmcnt(10)
    v_mfma_f32_16x16x32_bf16 v[144:147], v[56:59], v[184:187], v[144:147]
    buffer_load_dwordx4 v[100:103], v2, s[4:7], s42 offen offset:2304 sc1
    ds_read_b64_tr_b16 v[52:53], v4 offset:53248
    s_xor_b32 s42, s41, 4096
    v_mfma_f32_16x16x32_bf16 v[148:151], v[56:59], v[188:191], v[148:151]
    ds_read_b64_tr_b16 v[54:55], v4 offset:54272
    v_mfma_f32_16x16x32_bf16 v[152:155], v[60:63], v[184:187], v[152:155]
    ds_read_b64_tr_b16 v[56:57], v5 offset:53248
    v_mfma_f32_16x16x32_bf16 v[156:159], v[60:63], v[188:191], v[156:159]
    ds_read_b64_tr_b16 v[58:59], v5 offset:54272
    s_waitcnt vmcnt(8) lgkmcnt(10)
    v_mfma_f32_16x16x32_bf16 v[128:131], v[32:35], v[64:67], v[128:131]
    ds_read_b64_tr_b16 v[60:61], v6 offset:53248
    buffer_load_dwordx4 v[104:107], v2, s[4:7], s42 offen offset:2048 sc1
    v_mfma_f32_16x16x32_bf16 v[132:135], v[32:35], v[68:71], v[132:135]
    ds_read_b64_tr_b16 v[62:63], v6 offset:54272
    v_mfma_f32_16x16x32_bf16 v[136:139], v[36:39], v[64:67], v[136:139]
    ds_read_b64_tr_b16 v[32:33], v3 offset:57344
    v_mfma_f32_16x16x32_bf16 v[140:143], v[36:39], v[68:71], v[140:143]
    ds_read_b64_tr_b16 v[34:35], v3 offset:58368
    s_waitcnt lgkmcnt(10)
    v_mfma_f32_16x16x32_bf16 v[144:147], v[40:43], v[64:67], v[144:147]
    buffer_load_dwordx4 v[108:111], v2, s[4:7], s42 offen offset:2304 sc1
    ds_read_b64_tr_b16 v[36:37], v4 offset:57344
    s_xor_b32 s42, s41, 8192
    v_mfma_f32_16x16x32_bf16 v[148:151], v[40:43], v[68:71], v[148:151]
    ds_read_b64_tr_b16 v[38:39], v4 offset:58368
    v_mfma_f32_16x16x32_bf16 v[152:155], v[44:47], v[64:67], v[152:155]
    ds_read_b64_tr_b16 v[40:41], v5 offset:57344
    v_mfma_f32_16x16x32_bf16 v[156:159], v[44:47], v[68:71], v[156:159]
    ds_read_b64_tr_b16 v[42:43], v5 offset:58368
    s_waitcnt vmcnt(8) lgkmcnt(10)
    v_mfma_f32_16x16x32_bf16 v[128:131], v[48:51], v[72:75], v[128:131]
    buffer_load_dwordx4 v[112:115], v2, s[4:7], s42 offen offset:2048 sc1
    ds_read_b64_tr_b16 v[44:45], v6 offset:57344
    v_mfma_f32_16x16x32_bf16 v[132:135], v[48:51], v[76:79], v[132:135]
    ds_read_b64_tr_b16 v[46:47], v6 offset:58368
    v_mfma_f32_16x16x32_bf16 v[136:139], v[52:55], v[72:75], v[136:139]
    ds_read_b64_tr_b16 v[48:49], v3 offset:61440
    v_mfma_f32_16x16x32_bf16 v[140:143], v[52:55], v[76:79], v[140:143]
    ds_read_b64_tr_b16 v[50:51], v3 offset:62464
    s_waitcnt lgkmcnt(10)
    v_mfma_f32_16x16x32_bf16 v[144:147], v[56:59], v[72:75], v[144:147]
    buffer_load_dwordx4 v[116:119], v2, s[4:7], s42 offen offset:2304 sc1
    ds_read_b64_tr_b16 v[52:53], v4 offset:61440
    s_xor_b32 s42, s41, 12288
    v_mfma_f32_16x16x32_bf16 v[148:151], v[56:59], v[76:79], v[148:151]
    ds_read_b64_tr_b16 v[54:55], v4 offset:62464
    v_mfma_f32_16x16x32_bf16 v[152:155], v[60:63], v[72:75], v[152:155]
    ds_read_b64_tr_b16 v[56:57], v5 offset:61440
    v_mfma_f32_16x16x32_bf16 v[156:159], v[60:63], v[76:79], v[156:159]
    ds_read_b64_tr_b16 v[58:59], v5 offset:62464
    s_waitcnt vmcnt(8) lgkmcnt(10)
    v_mfma_f32_16x16x32_bf16 v[128:131], v[32:35], v[80:83], v[128:131]
    ds_read_b64_tr_b16 v[60:61], v6 offset:61440
    buffer_load_dwordx4 v[120:123], v2, s[4:7], s42 offen offset:2048 sc1
    v_mfma_f32_16x16x32_bf16 v[132:135], v[32:35], v[84:87], v[132:135]
    ds_read_b64_tr_b16 v[62:63], v6 offset:62464
    v_xor_b32 v3, 0x10000, v3
    v_xor_b32 v4, 0x10000, v4
    v_xor_b32 v5, 0x10000, v5
    v_xor_b32 v6, 0x10000, v6
    v_mfma_f32_16x16x32_bf16 v[136:139], v[36:39], v[80:83], v[136:139]
    ds_read_b64_tr_b16 v[32:33], v3 offset:0
    v_mfma_f32_16x16x32_bf16 v[140:143], v[36:39], v[84:87], v[140:143]
    ds_read_b64_tr_b16 v[34:35], v3 offset:1024
    s_waitcnt lgkmcnt(10)
    v_mfma_f32_16x16x32_bf16 v[144:147], v[40:43], v[80:83], v[144:147]
    buffer_load_dwordx4 v[124:127], v2, s[4:7], s42 offen offset:2304 sc1
    ds_read_b64_tr_b16 v[36:37], v4 offset:0
    s_xor_b32 s42, s41, 16384
    v_mfma_f32_16x16x32_bf16 v[148:151], v[40:43], v[84:87], v[148:151]
    ds_read_b64_tr_b16 v[38:39], v4 offset:1024
    v_mfma_f32_16x16x32_bf16 v[152:155], v[44:47], v[80:83], v[152:155]
    ds_read_b64_tr_b16 v[40:41], v5 offset:0
    v_mfma_f32_16x16x32_bf16 v[156:159], v[44:47], v[84:87], v[156:159]
    ds_read_b64_tr_b16 v[42:43], v5 offset:1024
    s_waitcnt vmcnt(8) lgkmcnt(10)
    v_mfma_f32_16x16x32_bf16 v[128:131], v[48:51], v[88:91], v[128:131]
    buffer_load_dwordx4 v[160:163], v2, s[4:7], s42 offen offset:2048 sc1
    ds_read_b64_tr_b16 v[44:45], v6 offset:0
    v_mfma_f32_16x16x32_bf16 v[132:135], v[48:51], v[92:95], v[132:135]
    ds_read_b64_tr_b16 v[46:47], v6 offset:1024
    v_mfma_f32_16x16x32_bf16 v[136:139], v[52:55], v[88:91], v[136:139]
    ds_read_b64_tr_b16 v[48:49], v3 offset:4096
    v_mfma_f32_16x16x32_bf16 v[140:143], v[52:55], v[92:95], v[140:143]
    ds_read_b64_tr_b16 v[50:51], v3 offset:5120
    s_waitcnt lgkmcnt(10)
    v_mfma_f32_16x16x32_bf16 v[144:147], v[56:59], v[88:91], v[144:147]
    buffer_load_dwordx4 v[164:167], v2, s[4:7], s42 offen offset:2304 sc1
    ds_read_b64_tr_b16 v[52:53], v4 offset:4096
    s_xor_b32 s42, s41, 20480
    v_mfma_f32_16x16x32_bf16 v[148:151], v[56:59], v[92:95], v[148:151]
    ds_read_b64_tr_b16 v[54:55], v4 offset:5120
    v_mfma_f32_16x16x32_bf16 v[152:155], v[60:63], v[88:91], v[152:155]
    ds_read_b64_tr_b16 v[56:57], v5 offset:4096
    v_mfma_f32_16x16x32_bf16 v[156:159], v[60:63], v[92:95], v[156:159]
    ds_read_b64_tr_b16 v[58:59], v5 offset:5120
    s_waitcnt vmcnt(8) lgkmcnt(10)
    v_mfma_f32_16x16x32_bf16 v[128:131], v[32:35], v[96:99], v[128:131]
    ds_read_b64_tr_b16 v[60:61], v6 offset:4096
    buffer_load_dwordx4 v[168:171], v2, s[4:7], s42 offen offset:2048 sc1
    v_mfma_f32_16x16x32_bf16 v[132:135], v[32:35], v[100:103], v[132:135]
    ds_read_b64_tr_b16 v[62:63], v6 offset:5120
    v_mfma_f32_16x16x32_bf16 v[136:139], v[36:39], v[96:99], v[136:139]
    ds_read_b64_tr_b16 v[32:33], v3 offset:8192
    v_mfma_f32_16x16x32_bf16 v[140:143], v[36:39], v[100:103], v[140:143]
    ds_read_b64_tr_b16 v[34:35], v3 offset:9216
    s_waitcnt lgkmcnt(10)
    v_mfma_f32_16x16x32_bf16 v[144:147], v[40:43], v[96:99], v[144:147]
    buffer_load_dwordx4 v[172:175], v2, s[4:7], s42 offen offset:2304 sc1
    ds_read_b64_tr_b16 v[36:37], v4 offset:8192
    s_xor_b32 s42, s41, 24576
    v_mfma_f32_16x16x32_bf16 v[148:151], v[40:43], v[100:103], v[148:151]
    ds_read_b64_tr_b16 v[38:39], v4 offset:9216
    v_mfma_f32_16x16x32_bf16 v[152:155], v[44:47], v[96:99], v[152:155]
    ds_read_b64_tr_b16 v[40:41], v5 offset:8192
    v_mfma_f32_16x16x32_bf16 v[156:159], v[44:47], v[100:103], v[156:159]
    ds_read_b64_tr_b16 v[42:43], v5 offset:9216
    s_waitcnt vmcnt(8) lgkmcnt(10)
    v_mfma_f32_16x16x32_bf16 v[128:131], v[48:51], v[104:107], v[128:131]
    buffer_load_dwordx4 v[176:179], v2, s[4:7], s42 offen offset:2048 sc1
    ds_read_b64_tr_b16 v[44:45], v6 offset:8192
    v_mfma_f32_16x16x32_bf16 v[132:135], v[48:51], v[108:111], v[132:135]
    ds_read_b64_tr_b16 v[46:47], v6 offset:9216
    v_mfma_f32_16x16x32_bf16 v[136:139], v[52:55], v[104:107], v[136:139]
    ds_read_b64_tr_b16 v[48:49], v3 offset:12288
    v_mfma_f32_16x16x32_bf16 v[140:143], v[52:55], v[108:111], v[140:143]
    ds_read_b64_tr_b16 v[50:51], v3 offset:13312
    s_waitcnt lgkmcnt(10)
    v_mfma_f32_16x16x32_bf16 v[144:147], v[56:59], v[104:107], v[144:147]
    buffer_load_dwordx4 v[180:183], v2, s[4:7], s42 offen offset:2304 sc1
    ds_read_b64_tr_b16 v[52:53], v4 offset:12288
    s_xor_b32 s42, s41, 28672
    v_mfma_f32_16x16x32_bf16 v[148:151], v[56:59], v[108:111], v[148:151]
    ds_read_b64_tr_b16 v[54:55], v4 offset:13312
    v_mfma_f32_16x16x32_bf16 v[152:155], v[60:63], v[104:107], v[152:155]
    ds_read_b64_tr_b16 v[56:57], v5 offset:12288
    v_mfma_f32_16x16x32_bf16 v[156:159], v[60:63], v[108:111], v[156:159]
    ds_read_b64_tr_b16 v[58:59], v5 offset:13312
    s_waitcnt vmcnt(8) lgkmcnt(10)
    v_mfma_f32_16x16x32_bf16 v[128:131], v[32:35], v[112:115], v[128:131]
    ds_read_b64_tr_b16 v[60:61], v6 offset:12288
    buffer_load_dwordx4 v[184:187], v2, s[4:7], s42 offen offset:2048 sc1
    v_mfma_f32_16x16x32_bf16 v[132:135], v[32:35], v[116:119], v[132:135]
    ds_read_b64_tr_b16 v[62:63], v6 offset:13312
    v_mfma_f32_16x16x32_bf16 v[136:139], v[36:39], v[112:115], v[136:139]
    ds_read_b64_tr_b16 v[32:33], v3 offset:16384
    v_mfma_f32_16x16x32_bf16 v[140:143], v[36:39], v[116:119], v[140:143]
    ds_read_b64_tr_b16 v[34:35], v3 offset:17408
    s_waitcnt lgkmcnt(10)
    v_mfma_f32_16x16x32_bf16 v[144:147], v[40:43], v[112:115], v[144:147]
    buffer_load_dwordx4 v[188:191], v2, s[4:7], s42 offen offset:2304 sc1
    ds_read_b64_tr_b16 v[36:37], v4 offset:16384
    s_xor_b32 s42, s41, 32768
    v_mfma_f32_16x16x32_bf16 v[148:151], v[40:43], v[116:119], v[148:151]
    ds_read_b64_tr_b16 v[38:39], v4 offset:17408
    v_mfma_f32_16x16x32_bf16 v[152:155], v[44:47], v[112:115], v[152:155]
    ds_read_b64_tr_b16 v[40:41], v5 offset:16384
    v_mfma_f32_16x16x32_bf16 v[156:159], v[44:47], v[116:119], v[156:159]
    ds_read_b64_tr_b16 v[42:43], v5 offset:17408
    s_waitcnt vmcnt(8) lgkmcnt(10)
    v_mfma_f32_16x16x32_bf16 v[128:131], v[48:51], v[120:123], v[128:131]
    buffer_load_dwordx4 v[64:67], v2, s[4:7], s42 offen offset:2048 sc1
    ds_read_b64_tr_b16 v[44:45], v6 offset:16384
    v_mfma_f32_16x16x32_bf16 v[132:135], v[48:51], v[124:127], v[132:135]
    ds_read_b64_tr_b16 v[46:47], v6 offset:17408
    v_mfma_f32_16x16x32_bf16 v[136:139], v[52:55], v[120:123], v[136:139]
    ds_read_b64_tr_b16 v[48:49], v3 offset:20480
    v_mfma_f32_16x16x32_bf16 v[140:143], v[52:55], v[124:127], v[140:143]
    ds_read_b64_tr_b16 v[50:51], v3 offset:21504
    s_waitcnt lgkmcnt(10)
    v_mfma_f32_16x16x32_bf16 v[144:147], v[56:59], v[120:123], v[144:147]
    buffer_load_dwordx4 v[68:71], v2, s[4:7], s42 offen offset:2304 sc1
    ds_read_b64_tr_b16 v[52:53], v4 offset:20480
    s_xor_b32 s42, s41, 36864
    v_mfma_f32_16x16x32_bf16 v[148:151], v[56:59], v[124:127], v[148:151]
    ds_read_b64_tr_b16 v[54:55], v4 offset:21504
    v_mfma_f32_16x16x32_bf16 v[152:155], v[60:63], v[120:123], v[152:155]
    ds_read_b64_tr_b16 v[56:57], v5 offset:20480
    v_mfma_f32_16x16x32_bf16 v[156:159], v[60:63], v[124:127], v[156:159]
    ds_read_b64_tr_b16 v[58:59], v5 offset:21504
    s_waitcnt vmcnt(8) lgkmcnt(10)
    v_mfma_f32_16x16x32_bf16 v[128:131], v[32:35], v[160:163], v[128:131]
    ds_read_b64_tr_b16 v[60:61], v6 offset:20480
    buffer_load_dwordx4 v[72:75], v2, s[4:7], s42 offen offset:2048 sc1
    v_mfma_f32_16x16x32_bf16 v[132:135], v[32:35], v[164:167], v[132:135]
    ds_read_b64_tr_b16 v[62:63], v6 offset:21504
    v_mfma_f32_16x16x32_bf16 v[136:139], v[36:39], v[160:163], v[136:139]
    ds_read_b64_tr_b16 v[32:33], v3 offset:24576
    v_mfma_f32_16x16x32_bf16 v[140:143], v[36:39], v[164:167], v[140:143]
    ds_read_b64_tr_b16 v[34:35], v3 offset:25600
    s_waitcnt lgkmcnt(10)
    v_mfma_f32_16x16x32_bf16 v[144:147], v[40:43], v[160:163], v[144:147]
    buffer_load_dwordx4 v[76:79], v2, s[4:7], s42 offen offset:2304 sc1
    ds_read_b64_tr_b16 v[36:37], v4 offset:24576
    s_xor_b32 s42, s41, 40960
    v_mfma_f32_16x16x32_bf16 v[148:151], v[40:43], v[164:167], v[148:151]
    ds_read_b64_tr_b16 v[38:39], v4 offset:25600
    v_mfma_f32_16x16x32_bf16 v[152:155], v[44:47], v[160:163], v[152:155]
    ds_read_b64_tr_b16 v[40:41], v5 offset:24576
    v_mfma_f32_16x16x32_bf16 v[156:159], v[44:47], v[164:167], v[156:159]
    ds_read_b64_tr_b16 v[42:43], v5 offset:25600
    s_waitcnt vmcnt(8) lgkmcnt(10)
    v_mfma_f32_16x16x32_bf16 v[128:131], v[48:51], v[168:171], v[128:131]
    buffer_load_dwordx4 v[80:83], v2, s[4:7], s42 offen offset:2048 sc1
    ds_read_b64_tr_b16 v[44:45], v6 offset:24576
    v_mfma_f32_16x16x32_bf16 v[132:135], v[48:51], v[172:175], v[132:135]
    ds_read_b64_tr_b16 v[46:47], v6 offset:25600
    v_mfma_f32_16x16x32_bf16 v[136:139], v[52:55], v[168:171], v[136:139]
    ds_read_b64_tr_b16 v[48:49], v3 offset:28672
    v_mfma_f32_16x16x32_bf16 v[140:143], v[52:55], v[172:175], v[140:143]
    ds_read_b64_tr_b16 v[50:51], v3 offset:29696
    s_waitcnt lgkmcnt(10)
    v_mfma_f32_16x16x32_bf16 v[144:147], v[56:59], v[168:171], v[144:147]
    buffer_load_dwordx4 v[84:87], v2, s[4:7], s42 offen offset:2304 sc1
    ds_read_b64_tr_b16 v[52:53], v4 offset:28672
    s_xor_b32 s42, s41, 45056
    v_mfma_f32_16x16x32_bf16 v[148:151], v[56:59], v[172:175], v[148:151]
    ds_read_b64_tr_b16 v[54:55], v4 offset:29696
    v_mfma_f32_16x16x32_bf16 v[152:155], v[60:63], v[168:171], v[152:155]
    ds_read_b64_tr_b16 v[56:57], v5 offset:28672
    v_mfma_f32_16x16x32_bf16 v[156:159], v[60:63], v[172:175], v[156:159]
    ds_read_b64_tr_b16 v[58:59], v5 offset:29696
    s_waitcnt vmcnt(8) lgkmcnt(10)
    v_mfma_f32_16x16x32_bf16 v[128:131], v[32:35], v[176:179], v[128:131]
    ds_read_b64_tr_b16 v[60:61], v6 offset:28672
    buffer_load_dwordx4 v[88:91], v2, s[4:7], s42 offen offset:2048 sc1
    v_mfma_f32_16x16x32_bf16 v[132:135], v[32:35], v[180:183], v[132:135]
    ds_read_b64_tr_b16 v[62:63], v6 offset:29696
    v_mfma_f32_16x16x32_bf16 v[136:139], v[36:39], v[176:179], v[136:139]
    ds_read_b64_tr_b16 v[32:33], v3 offset:32768
    v_mfma_f32_16x16x32_bf16 v[140:143], v[36:39], v[180:183], v[140:143]
    ds_read_b64_tr_b16 v[34:35], v3 offset:33792
    s_waitcnt lgkmcnt(10)
    v_mfma_f32_16x16x32_bf16 v[144:147], v[40:43], v[176:179], v[144:147]
    buffer_load_dwordx4 v[92:95], v2, s[4:7], s42 offen offset:2304 sc1
    ds_read_b64_tr_b16 v[36:37], v4 offset:32768
    s_xor_b32 s42, s41, 49152
    v_mfma_f32_16x16x32_bf16 v[148:151], v[40:43], v[180:183], v[148:151]
    ds_read_b64_tr_b16 v[38:39], v4 offset:33792
    v_mfma_f32_16x16x32_bf16 v[152:155], v[44:47], v[176:179], v[152:155]
    ds_read_b64_tr_b16 v[40:41], v5 offset:32768
    v_mfma_f32_16x16x32_bf16 v[156:159], v[44:47], v[180:183], v[156:159]
    ds_read_b64_tr_b16 v[42:43], v5 offset:33792
    s_waitcnt vmcnt(8) lgkmcnt(10)
    v_mfma_f32_16x16x32_bf16 v[128:131], v[48:51], v[184:187], v[128:131]
    buffer_load_dwordx4 v[96:99], v2, s[4:7], s42 offen offset:2048 sc1
    ds_read_b64_tr_b16 v[44:45], v6 offset:32768
    v_mfma_f32_16x16x32_bf16 v[132:135], v[48:51], v[188:191], v[132:135]
    ds_read_b64_tr_b16 v[46:47], v6 offset:33792
    v_mfma_f32_16x16x32_bf16 v[136:139], v[52:55], v[184:187], v[136:139]
    ds_read_b64_tr_b16 v[48:49], v3 offset:36864
    v_mfma_f32_16x16x32_bf16 v[140:143], v[52:55], v[188:191], v[140:143]
    ds_read_b64_tr_b16 v[50:51], v3 offset:37888
    s_waitcnt lgkmcnt(10)
    v_mfma_f32_16x16x32_bf16 v[144:147], v[56:59], v[184:187], v[144:147]
    buffer_load_dwordx4 v[100:103], v2, s[4:7], s42 offen offset:2304 sc1
    ds_read_b64_tr_b16 v[52:53], v4 offset:36864
    s_xor_b32 s42, s41, 53248
    v_mfma_f32_16x16x32_bf16 v[148:151], v[56:59], v[188:191], v[148:151]
    ds_read_b64_tr_b16 v[54:55], v4 offset:37888
    v_mfma_f32_16x16x32_bf16 v[152:155], v[60:63], v[184:187], v[152:155]
    ds_read_b64_tr_b16 v[56:57], v5 offset:36864
    v_mfma_f32_16x16x32_bf16 v[156:159], v[60:63], v[188:191], v[156:159]
    ds_read_b64_tr_b16 v[58:59], v5 offset:37888
    s_waitcnt vmcnt(8) lgkmcnt(10)
    v_mfma_f32_16x16x32_bf16 v[128:131], v[32:35], v[64:67], v[128:131]
    ds_read_b64_tr_b16 v[60:61], v6 offset:36864
    buffer_load_dwordx4 v[104:107], v2, s[4:7], s42 offen offset:2048 sc1
    v_mfma_f32_16x16x32_bf16 v[132:135], v[32:35], v[68:71], v[132:135]
    ds_read_b64_tr_b16 v[62:63], v6 offset:37888
    v_mfma_f32_16x16x32_bf16 v[136:139], v[36:39], v[64:67], v[136:139]
    ds_read_b64_tr_b16 v[32:33], v3 offset:40960
    v_mfma_f32_16x16x32_bf16 v[140:143], v[36:39], v[68:71], v[140:143]
    ds_read_b64_tr_b16 v[34:35], v3 offset:41984
    s_waitcnt lgkmcnt(10)
    v_mfma_f32_16x16x32_bf16 v[144:147], v[40:43], v[64:67], v[144:147]
    buffer_load_dwordx4 v[108:111], v2, s[4:7], s42 offen offset:2304 sc1
    ds_read_b64_tr_b16 v[36:37], v4 offset:40960
    s_xor_b32 s42, s41, 57344
    v_mfma_f32_16x16x32_bf16 v[148:151], v[40:43], v[68:71], v[148:151]
    ds_read_b64_tr_b16 v[38:39], v4 offset:41984
    v_mfma_f32_16x16x32_bf16 v[152:155], v[44:47], v[64:67], v[152:155]
    ds_read_b64_tr_b16 v[40:41], v5 offset:40960
    v_mfma_f32_16x16x32_bf16 v[156:159], v[44:47], v[68:71], v[156:159]
    ds_read_b64_tr_b16 v[42:43], v5 offset:41984
    s_waitcnt vmcnt(8) lgkmcnt(10)
    v_mfma_f32_16x16x32_bf16 v[128:131], v[48:51], v[72:75], v[128:131]
    buffer_load_dwordx4 v[112:115], v2, s[4:7], s42 offen offset:2048 sc1
    ds_read_b64_tr_b16 v[44:45], v6 offset:40960
    v_mfma_f32_16x16x32_bf16 v[132:135], v[48:51], v[76:79], v[132:135]
    ds_read_b64_tr_b16 v[46:47], v6 offset:41984
    v_mfma_f32_16x16x32_bf16 v[136:139], v[52:55], v[72:75], v[136:139]
    ds_read_b64_tr_b16 v[48:49], v3 offset:45056
    v_mfma_f32_16x16x32_bf16 v[140:143], v[52:55], v[76:79], v[140:143]
    ds_read_b64_tr_b16 v[50:51], v3 offset:46080
    s_waitcnt lgkmcnt(10)
    v_mfma_f32_16x16x32_bf16 v[144:147], v[56:59], v[72:75], v[144:147]
    buffer_load_dwordx4 v[116:119], v2, s[4:7], s42 offen offset:2304 sc1
    ds_read_b64_tr_b16 v[52:53], v4 offset:45056
    s_xor_b32 s42, s41, 61440
    v_mfma_f32_16x16x32_bf16 v[148:151], v[56:59], v[76:79], v[148:151]
    ds_read_b64_tr_b16 v[54:55], v4 offset:46080
    v_mfma_f32_16x16x32_bf16 v[152:155], v[60:63], v[72:75], v[152:155]
    ds_read_b64_tr_b16 v[56:57], v5 offset:45056
    v_mfma_f32_16x16x32_bf16 v[156:159], v[60:63], v[76:79], v[156:159]
    ds_read_b64_tr_b16 v[58:59], v5 offset:46080
    s_waitcnt vmcnt(8) lgkmcnt(10)
    v_mfma_f32_16x16x32_bf16 v[128:131], v[32:35], v[80:83], v[128:131]
    ds_read_b64_tr_b16 v[60:61], v6 offset:45056
    buffer_load_dwordx4 v[120:123], v2, s[4:7], s42 offen offset:2048 sc1
    v_mfma_f32_16x16x32_bf16 v[132:135], v[32:35], v[84:87], v[132:135]
    ds_read_b64_tr_b16 v[62:63], v6 offset:46080
    v_mfma_f32_16x16x32_bf16 v[136:139], v[36:39], v[80:83], v[136:139]
    ds_read_b64_tr_b16 v[32:33], v3 offset:49152
    v_mfma_f32_16x16x32_bf16 v[140:143], v[36:39], v[84:87], v[140:143]
    ds_read_b64_tr_b16 v[34:35], v3 offset:50176
    s_waitcnt lgkmcnt(10)
    v_mfma_f32_16x16x32_bf16 v[144:147], v[40:43], v[80:83], v[144:147]
    buffer_load_dwordx4 v[124:127], v2, s[4:7], s42 offen offset:2304 sc1
    ds_read_b64_tr_b16 v[36:37], v4 offset:49152
    v_mfma_f32_16x16x32_bf16 v[148:151], v[40:43], v[84:87], v[148:151]
    ds_read_b64_tr_b16 v[38:39], v4 offset:50176
    v_mfma_f32_16x16x32_bf16 v[152:155], v[44:47], v[80:83], v[152:155]
    ds_read_b64_tr_b16 v[40:41], v5 offset:49152
    v_mfma_f32_16x16x32_bf16 v[156:159], v[44:47], v[84:87], v[156:159]
    ds_read_b64_tr_b16 v[42:43], v5 offset:50176
    s_waitcnt vmcnt(8) lgkmcnt(10)
    v_mfma_f32_16x16x32_bf16 v[128:131], v[48:51], v[88:91], v[128:131]
    ds_read_b64_tr_b16 v[44:45], v6 offset:49152
    v_mfma_f32_16x16x32_bf16 v[132:135], v[48:51], v[92:95], v[132:135]
    ds_read_b64_tr_b16 v[46:47], v6 offset:50176
    v_mfma_f32_16x16x32_bf16 v[136:139], v[52:55], v[88:91], v[136:139]
    ds_read_b64_tr_b16 v[48:49], v3 offset:53248
    v_mfma_f32_16x16x32_bf16 v[140:143], v[52:55], v[92:95], v[140:143]
    ds_read_b64_tr_b16 v[50:51], v3 offset:54272
    s_waitcnt lgkmcnt(10)
    v_mfma_f32_16x16x32_bf16 v[144:147], v[56:59], v[88:91], v[144:147]
    ds_read_b64_tr_b16 v[52:53], v4 offset:53248
    v_mfma_f32_16x16x32_bf16 v[148:151], v[56:59], v[92:95], v[148:151]
    ds_read_b64_tr_b16 v[54:55], v4 offset:54272
    v_mfma_f32_16x16x32_bf16 v[152:155], v[60:63], v[88:91], v[152:155]
    ds_read_b64_tr_b16 v[56:57], v5 offset:53248
    v_mfma_f32_16x16x32_bf16 v[156:159], v[60:63], v[92:95], v[156:159]
    ds_read_b64_tr_b16 v[58:59], v5 offset:54272
    s_waitcnt vmcnt(6) lgkmcnt(10)
    v_mfma_f32_16x16x32_bf16 v[128:131], v[32:35], v[96:99], v[128:131]
    ds_read_b64_tr_b16 v[60:61], v6 offset:53248
    v_mfma_f32_16x16x32_bf16 v[132:135], v[32:35], v[100:103], v[132:135]
    ds_read_b64_tr_b16 v[62:63], v6 offset:54272
    v_mfma_f32_16x16x32_bf16 v[136:139], v[36:39], v[96:99], v[136:139]
    ds_read_b64_tr_b16 v[32:33], v3 offset:57344
    v_mfma_f32_16x16x32_bf16 v[140:143], v[36:39], v[100:103], v[140:143]
    ds_read_b64_tr_b16 v[34:35], v3 offset:58368
    s_waitcnt lgkmcnt(10)
    v_mfma_f32_16x16x32_bf16 v[144:147], v[40:43], v[96:99], v[144:147]
    ds_read_b64_tr_b16 v[36:37], v4 offset:57344
    v_mfma_f32_16x16x32_bf16 v[148:151], v[40:43], v[100:103], v[148:151]
    ds_read_b64_tr_b16 v[38:39], v4 offset:58368
    v_mfma_f32_16x16x32_bf16 v[152:155], v[44:47], v[96:99], v[152:155]
    ds_read_b64_tr_b16 v[40:41], v5 offset:57344
    v_mfma_f32_16x16x32_bf16 v[156:159], v[44:47], v[100:103], v[156:159]
    ds_read_b64_tr_b16 v[42:43], v5 offset:58368
    s_waitcnt vmcnt(4) lgkmcnt(10)
    v_mfma_f32_16x16x32_bf16 v[128:131], v[48:51], v[104:107], v[128:131]
    ds_read_b64_tr_b16 v[44:45], v6 offset:57344
    v_mfma_f32_16x16x32_bf16 v[132:135], v[48:51], v[108:111], v[132:135]
    ds_read_b64_tr_b16 v[46:47], v6 offset:58368
    v_mfma_f32_16x16x32_bf16 v[136:139], v[52:55], v[104:107], v[136:139]
    ds_read_b64_tr_b16 v[48:49], v3 offset:61440
    v_mfma_f32_16x16x32_bf16 v[140:143], v[52:55], v[108:111], v[140:143]
    ds_read_b64_tr_b16 v[50:51], v3 offset:62464
    s_waitcnt lgkmcnt(10)
    v_mfma_f32_16x16x32_bf16 v[144:147], v[56:59], v[104:107], v[144:147]
    ds_read_b64_tr_b16 v[52:53], v4 offset:61440
    v_mfma_f32_16x16x32_bf16 v[148:151], v[56:59], v[108:111], v[148:151]
    ds_read_b64_tr_b16 v[54:55], v4 offset:62464
    v_mfma_f32_16x16x32_bf16 v[152:155], v[60:63], v[104:107], v[152:155]
    ds_read_b64_tr_b16 v[56:57], v5 offset:61440
    v_mfma_f32_16x16x32_bf16 v[156:159], v[60:63], v[108:111], v[156:159]
    ds_read_b64_tr_b16 v[58:59], v5 offset:62464
    s_waitcnt vmcnt(2) lgkmcnt(10)
    v_mfma_f32_16x16x32_bf16 v[128:131], v[32:35], v[112:115], v[128:131]
    ds_read_b64_tr_b16 v[60:61], v6 offset:61440
    ds_read_b64_tr_b16 v[62:63], v6 offset:62464
    v_mfma_f32_16x16x32_bf16 v[136:139], v[36:39], v[112:115], v[136:139]
    v_xor_b32 v3, 0x10000, v3
    s_waitcnt lgkmcnt(8)
    v_mfma_f32_16x16x32_bf16 v[144:147], v[40:43], v[112:115], v[144:147]
    v_xor_b32 v4, 0x10000, v4
    v_mfma_f32_16x16x32_bf16 v[152:155], v[44:47], v[112:115], v[152:155]
    v_xor_b32 v5, 0x10000, v5
    s_waitcnt vmcnt(0) lgkmcnt(4)
    v_mfma_f32_16x16x32_bf16 v[128:131], v[48:51], v[120:123], v[128:131]
    v_xor_b32 v6, 0x10000, v6
    v_mfma_f32_16x16x32_bf16 v[136:139], v[52:55], v[120:123], v[136:139]
    s_waitcnt lgkmcnt(0)
    v_mfma_f32_16x16x32_bf16 v[144:147], v[56:59], v[120:123], v[144:147]
    v_mfma_f32_16x16x32_bf16 v[152:155], v[60:63], v[120:123], v[152:155]
    s_cmp_eq_u32 s21, 3
    s_cbranch_scc1 c_final
    s_barrier
    s_add_u32 s43, s43, 4194304
    v_mfma_f32_16x16x32_bf16 v[132:135], v[32:35], v[116:119], v[132:135]
    v_mfma_f32_16x16x32_bf16 v[140:143], v[36:39], v[116:119], v[140:143]
    v_mfma_f32_16x16x32_bf16 v[148:151], v[40:43], v[116:119], v[148:151]
    v_cvt_pk_bf16_f32 v160, v128, v129
    v_cvt_pk_bf16_f32 v161, v130, v131
    v_cvt_pk_bf16_f32 v162, v136, v137
    v_mfma_f32_16x16x32_bf16 v[156:159], v[44:47], v[116:119], v[156:159]
    v_cvt_pk_bf16_f32 v163, v138, v139
    v_cvt_pk_bf16_f32 v168, v144, v145
    v_cvt_pk_bf16_f32 v169, v146, v147
    v_mfma_f32_16x16x32_bf16 v[132:135], v[48:51], v[124:127], v[132:135]
    v_cvt_pk_bf16_f32 v170, v152, v153
    v_cvt_pk_bf16_f32 v171, v154, v155
    v_permlane32_swap_b32 v160, v162
    v_mfma_f32_16x16x32_bf16 v[140:143], v[52:55], v[124:127], v[140:143]
    v_permlane32_swap_b32 v161, v163
    buffer_store_dwordx4 v[160:163], v2, s[4:7], s43 offen offset:0 sc1
    v_permlane32_swap_b32 v168, v170
    v_mfma_f32_16x16x32_bf16 v[148:151], v[56:59], v[124:127], v[148:151]
    v_permlane32_swap_b32 v169, v171
    buffer_store_dwordx4 v[168:171], v2, s[4:7], s43 offen offset:2048 sc1
    v_mfma_f32_16x16x32_bf16 v[156:159], v[60:63], v[124:127], v[156:159]
    v_cvt_pk_bf16_f32 v164, v132, v133
    v_cvt_pk_bf16_f32 v165, v134, v135
    v_cvt_pk_bf16_f32 v166, v140, v141
    v_cvt_pk_bf16_f32 v167, v142, v143
    s_nop 0
    v_cvt_pk_bf16_f32 v172, v148, v149
    v_cvt_pk_bf16_f32 v173, v150, v151
    s_nop 0
    v_cvt_pk_bf16_f32 v174, v156, v157
    v_cvt_pk_bf16_f32 v175, v158, v159
    v_permlane32_swap_b32 v164, v166
    v_permlane32_swap_b32 v165, v167
    buffer_store_dwordx4 v[164:167], v2, s[4:7], s43 offen offset:256 sc1
    v_permlane32_swap_b32 v172, v174
    v_permlane32_swap_b32 v173, v175
    buffer_store_dwordx4 v[172:175], v2, s[4:7], s43 offen offset:2304 sc1
    s_add_u32 s21, s21, 1
    v_mov_b32 v22, 0x3f803f80
    v_dot2_f32_bf16 v24, v160, v22, 0
    v_dot2_f32_bf16 v25, v160, v160, 0
    v_dot2_f32_bf16 v26, v164, v22, 0
    v_dot2_f32_bf16 v27, v164, v164, 0
    v_dot2_f32_bf16 v24, v161, v22, v24
    v_dot2_f32_bf16 v25, v161, v161, v25
    v_dot2_f32_bf16 v26, v165, v22, v26
    v_dot2_f32_bf16 v27, v165, v165, v27
    v_dot2_f32_bf16 v24, v162, v22, v24
    v_dot2_f32_bf16 v25, v162, v162, v25
    v_dot2_f32_bf16 v26, v166, v22, v26
    v_dot2_f32_bf16 v27, v166, v166, v27
    v_dot2_f32_bf16 v24, v163, v22, v24
    v_dot2_f32_bf16 v25, v163, v163, v25
    v_dot2_f32_bf16 v26, v167, v22, v26
    v_dot2_f32_bf16 v27, v167, v167, v27
    v_dot2_f32_bf16 v24, v168, v22, v24
    v_dot2_f32_bf16 v25, v168, v168, v25
    v_dot2_f32_bf16 v26, v172, v22, v26
    v_dot2_f32_bf16 v27, v172, v172, v27
    v_dot2_f32_bf16 v24, v169, v22, v24
    v_dot2_f32_bf16 v25, v169, v169, v25
    v_dot2_f32_bf16 v26, v173, v22, v26
    v_dot2_f32_bf16 v27, v173, v173, v27
    v_dot2_f32_bf16 v24, v170, v22, v24
    v_dot2_f32_bf16 v25, v170, v170, v25
    v_dot2_f32_bf16 v26, v174, v22, v26
    v_dot2_f32_bf16 v27, v174, v174, v27
    v_dot2_f32_bf16 v24, v171, v22, v24
    v_dot2_f32_bf16 v25, v171, v171, v25
    v_dot2_f32_bf16 v26, v175, v22, v26
    v_dot2_f32_bf16 v27, v175, v175, v27
    v_lshrrev_b32 v23, 1, v1
    v_and_b32 v23, 0xf8, v23
    s_nop 0
    v_permlane16_swap_b32 v24, v26
    v_permlane16_swap_b32 v25, v27
    v_pk_add_f32 v[24:25], v[24:25], v[26:27]
    v_mov_b32 v26, v24
    v_mov_b32 v27, v25
    s_nop 0
    v_permlane32_swap_b32 v24, v26
    v_permlane32_swap_b32 v25, v27
    v_pk_add_f32 v[24:25], v[24:25], v[26:27]
    s_lshl_b32 s44, s21, 18
    s_lshl_b32 s45, s38, 12
    s_add_u32 s44, s44, s45
    s_lshl_b32 s45, s18, 8
    s_add_u32 s44, s44, s45
    s_add_u32 s44, s44, 50331648
    buffer_store_dwordx2 v[24:25], v23, s[4:7], s44 offen sc1
    s_lshl_b32 s46, s21, 14
    s_lshl_b32 s67, s38, 7
    s_add_u32 s46, s46, s67
    s_add_u32 s46, s46, 4096
    s_add_u32 s47, s46, 8192
    s_lshl_b32 s48, s21, 22
    s_lshl_b32 s49, s38, 16
    s_add_u32 s41, s48, s49
    v_lshrrev_b32 v16, 4, v1
    v_and_b32 v17, 15, v16
    v_lshrrev_b32 v16, 4, v16
    s_lshl_b32 s49, s16, 7
    s_add_u32 s50, s49, 151552
    s_and_b32 s49, s21, 1
    s_lshl_b32 s49, s49, 10
    s_add_u32 s49, s49, 151552
    v_lshlrev_b32 v11, 4, v16
    v_add_u32 v13, s50, v11
    v_add_u32 v11, s49, v11
    v_lshlrev_b32 v15, 2, v17
    v_add_u32 v9, s50, v15
    v_add_u32 v15, s49, v15
    s_lshr_b32 s49, s21, 1
    s_lshl_b32 s53, s49, 23
    s_lshl_b32 s50, s18, 18
    s_add_u32 s53, s53, s50
    s_add_u32 s53, s53, 33554432
    s_lshl_b32 s54, s38, 11
    s_add_u32 s52, s53, s54
    s_lshl_b32 s59, s49, 13
    s_lshl_b32 s67, s18, 9
    s_add_u32 s59, s59, s67
    s_lshl_b32 s67, s16, 7
    s_add_u32 s59, s59, s67
    s_add_u32 s59, s59, 69632
    s_lshl_b32 s61, s49, 15
    s_lshl_b32 s67, s17, 11
    s_add_u32 s61, s61, s67
    s_lshl_b32 s67, s18, 7
    s_add_u32 s61, s61, s67
    s_add_u32 s61, s61, 151552
    s_sub_u32 s60, s61, 151552
    s_lshl_b32 s60, s60, 5
    s_add_u32 s60, s60, 54525952
    s_lshl_b32 s62, s16, 12
    s_add_u32 s62, s62, 131072
    s_mov_b32 s68, s63
    s_waitcnt vmcnt(1)
    s_atomic_add s68, s[22:23], s46 glc
    s_mov_b32 s48, 0
    s_branch c_layer
c_final:
    v_mfma_f32_16x16x32_bf16 v[132:135], v[32:35], v[116:119], v[132:135]
    v_mfma_f32_16x16x32_bf16 v[140:143], v[36:39], v[116:119], v[140:143]
    v_mfma_f32_16x16x32_bf16 v[148:151], v[40:43], v[116:119], v[148:151]
    v_cvt_pk_bf16_f32 v128, v128, v129
    v_cvt_pk_bf16_f32 v129, v130, v131
    ds_write_b64 v17, v[128:129] offset:0
    v_mfma_f32_16x16x32_bf16 v[156:159], v[44:47], v[116:119], v[156:159]
    v_cvt_pk_bf16_f32 v136, v136, v137
    v_cvt_pk_bf16_f32 v137, v138, v139
    ds_write_b64 v17, v[136:137] offset:32
    v_mfma_f32_16x16x32_bf16 v[132:135], v[48:51], v[124:127], v[132:135]
    v_cvt_pk_bf16_f32 v144, v144, v145
    v_cvt_pk_bf16_f32 v145, v146, v147
    ds_write_b64 v17, v[144:145] offset:64
    v_mfma_f32_16x16x32_bf16 v[140:143], v[52:55], v[124:127], v[140:143]
    v_cvt_pk_bf16_f32 v152, v152, v153
    v_cvt_pk_bf16_f32 v153, v154, v155
    ds_write_b64 v17, v[152:153] offset:96
    v_mfma_f32_16x16x32_bf16 v[148:151], v[56:59], v[124:127], v[148:151]
    ds_read_b128 v[160:163], v18 offset:0
    ds_read_b128 v[164:167], v18 offset:1152
    v_mfma_f32_16x16x32_bf16 v[156:159], v[60:63], v[124:127], v[156:159]
    v_cvt_pk_bf16_f32 v132, v132, v133
    v_cvt_pk_bf16_f32 v133, v134, v135
    ds_write_b64 v17, v[132:133] offset:2304
    v_cvt_pk_bf16_f32 v140, v140, v141
    v_cvt_pk_bf16_f32 v141, v142, v143
    ds_write_b64 v17, v[140:141] offset:2336
    v_cvt_pk_bf16_f32 v148, v148, v149
    v_cvt_pk_bf16_f32 v149, v150, v151
    ds_write_b64 v17, v[148:149] offset:2368
    v_cvt_pk_bf16_f32 v156, v156, v157
    v_cvt_pk_bf16_f32 v157, v158, v159
    ds_write_b64 v17, v[156:157] offset:2400
    ds_read_b128 v[168:171], v18 offset:2304
    ds_read_b128 v[172:175], v18 offset:3456
    s_waitcnt lgkmcnt(7)
    buffer_store_dwordx4 v[160:163], v19, s[8:11], s50 offen sc1
    s_add_u32 s50, s50, 16384
    s_waitcnt lgkmcnt(6)
    buffer_store_dwordx4 v[164:167], v19, s[8:11], s50 offen sc1
    s_add_u32 s50, s50, 16384
    s_waitcnt lgkmcnt(1)
    buffer_store_dwordx4 v[168:171], v19, s[8:11], s50 offen sc1
    s_add_u32 s50, s50, 16384
    s_waitcnt lgkmcnt(0)
    buffer_store_dwordx4 v[172:175], v19, s[8:11], s50 offen sc1
    s_endpgm
s_start:
    v_mov_b32 v14, 0
    v_mov_b32 v15, 0
    v_mov_b32 v20, 0
    v_mov_b32 v21, 0
    v_mov_b32 v22, 0
    s_mov_b32 s41, 0
    s_mov_b32 s42, 0
    s_mov_b32 s43, 0
    s_mov_b32 s62, 0
    s_cmp_eq_u32 s16, 4
    s_cbranch_scc1 h_start
    s_cmp_eq_u32 s16, 7
    s_cbranch_scc1 z_start
l_start:
    v_lshrrev_b32 v24, 4, v1
    v_lshrrev_b32 v25, 3, v24
    v_mul_u32_u24 v12, 6144, v25
    v_and_b32 v26, 2, v25
    v_lshrrev_b32 v25, 2, v25
    v_or_b32 v26, v26, v25
    v_bfe_u32 v25, v24, 1, 2
    v_xor_b32 v26, v26, v25
    v_lshl_add_u32 v12, v26, 5, v12
    v_and_b32 v26, 1, v24
    v_lshl_add_u32 v12, v26, 4, v12
    s_lshl_b32 s3, s18, 7
    v_add_u32 v12, s3, v12
    v_add_u32 v13, 48128, v12
    s_mul_i32 s84, s18, 393216
    s_cmp_lt_u32 s18, 4
    s_cselect_b32 s85, 4, 0
    s_mul_i32 s85, s85, 393216
    s_sub_u32 s3, s16, 5
    s_lshl_b32 s41, s3, 11
    s_mul_i32 s42, s3, 98304
    s_lshl_b32 s62, s3, 15
    v_add_u32 v14, s42, v12
    v_add_u32 v15, s42, v13
    s_bitcmp1_b32 s21, 0
    s_cselect_b32 s8, s28, s24
    s_cselect_b32 s9, s29, s25
    s_cselect_b32 s12, s30, s26
    s_cselect_b32 s13, s31, s27
    s_mov_b32 s10, 6291456
    s_mov_b32 s11, 0x00020000
    s_mov_b32 s14, 2097152
    s_mov_b32 s15, 0x00020000
    s_add_u32 m0, s41, 0
    s_add_u32 s44, s84, 2048
    buffer_load_dwordx4 v14, s[8:11], s44 offen offset:0 lds
    buffer_load_dwordx4 v15, s[8:11], s44 offen offset:1024 lds
    s_add_u32 m0, s41, 4096
    s_add_u32 s44, s84, 4096
    buffer_load_dwordx4 v14, s[8:11], s44 offen offset:0 lds
    buffer_load_dwordx4 v15, s[8:11], s44 offen offset:1024 lds
    s_add_u32 m0, s41, 8192
    s_add_u32 s44, s84, 0
    buffer_load_dwordx4 v14, s[8:11], s44 offen offset:0 lds
    buffer_load_dwordx4 v15, s[8:11], s44 offen offset:1024 lds
    s_add_u32 m0, s41, 12288
    s_add_u32 s44, s84, 198656
    buffer_load_dwordx4 v14, s[8:11], s44 offen offset:0 lds
    buffer_load_dwordx4 v15, s[8:11], s44 offen offset:1024 lds
    s_add_u32 m0, s41, 16384
    s_add_u32 s44, s84, 200704
    buffer_load_dwordx4 v14, s[8:11], s44 offen offset:0 lds
    buffer_load_dwordx4 v15, s[8:11], s44 offen offset:1024 lds
    s_add_u32 m0, s41, 20480
    s_add_u32 s44, s84, 196608
    buffer_load_dwordx4 v14, s[8:11], s44 offen offset:0 lds
    buffer_load_dwordx4 v15, s[8:11], s44 offen offset:1024 lds
    s_add_u32 m0, s41, 24576
    s_add_u32 s44, s85, 2048
    buffer_load_dwordx4 v14, s[8:11], s44 offen offset:0 lds
    buffer_load_dwordx4 v15, s[8:11], s44 offen offset:1024 lds
    s_add_u32 m0, s41, 28672
    s_add_u32 s44, s85, 4096
    buffer_load_dwordx4 v14, s[8:11], s44 offen offset:0 lds
    buffer_load_dwordx4 v15, s[8:11], s44 offen offset:1024 lds
    s_cmp_lt_u32 s18, 4
    s_cselect_b32 s86, 5, 1
    s_mul_i32 s86, s86, 393216
    s_cmp_lt_u32 s18, 4
    s_cselect_b32 s87, 6, 2
    s_mul_i32 s87, s87, 393216
    s_cmp_lt_u32 s18, 4
    s_cselect_b32 s88, 7, 3
    s_mul_i32 s88, s88, 393216
    s_cmp_lt_u32 s18, 8
    s_cselect_b32 s89, 8, 4
    s_mul_i32 s89, s89, 393216
    s_cmp_lt_u32 s18, 8
    s_cselect_b32 s90, 9, 5
    s_mul_i32 s90, s90, 393216
    s_cmp_lt_u32 s18, 8
    s_cselect_b32 s91, 10, 6
    s_mul_i32 s91, s91, 393216
    s_cmp_lt_u32 s18, 8
    s_cselect_b32 s92, 11, 7
    s_mul_i32 s92, s92, 393216
    s_cmp_lt_u32 s18, 12
    s_cselect_b32 s93, 12, 8
    s_mul_i32 s93, s93, 393216
    s_cmp_lt_u32 s18, 12
    s_cselect_b32 s94, 13, 9
    s_mul_i32 s94, s94, 393216
    s_cmp_lt_u32 s18, 12
    s_cselect_b32 s95, 14, 10
    s_mul_i32 s95, s95, 393216
    s_cmp_lt_u32 s18, 12
    s_cselect_b32 s96, 15, 11
    s_mul_i32 s96, s96, 393216
    s_xor_b32 s97, s18, 1
    s_mul_i32 s97, s97, 393216
    s_xor_b32 s98, s18, 2
    s_mul_i32 s98, s98, 393216
    s_xor_b32 s99, s18, 3
    s_mul_i32 s99, s99, 393216
    v_lshrrev_b32 v24, 4, v1
    v_lshrrev_b32 v25, 3, v24
    v_mul_u32_u24 v16, 2048, v25
    v_and_b32 v26, 2, v25
    v_lshrrev_b32 v25, 2, v25
    v_or_b32 v26, v26, v25
    v_bfe_u32 v25, v24, 1, 2
    v_xor_b32 v26, v26, v25
    v_lshl_add_u32 v16, v26, 5, v16
    v_and_b32 v26, 1, v24
    v_lshl_add_u32 v16, v26, 4, v16
    s_lshl_b32 s3, s18, 7
    v_add_u32 v16, s3, v16
    v_add_u32 v17, 15360, v16
    v_add_u32 v18, 30720, v16
    v_add_u32 v19, 46080, v16
    s_and_b32 s3, s16, 3
    s_mul_i32 s3, s3, 49152
    v_add_u32 v11, s3, v12
    s_and_b32 s3, s16, 3
    s_lshl_b32 s3, s3, 10
    v_add_u32 v9, s3, v1
    v_add_u32 v10, 0x10000, v9
    s_waitcnt vmcnt(0)
    s_barrier
    s_add_u32 m0, s41, 32768
    s_add_u32 s44, s85, 0
    buffer_load_dwordx4 v14, s[8:11], s44 offen offset:0 lds
    buffer_load_dwordx4 v15, s[8:11], s44 offen offset:1024 lds
    s_add_u32 m0, s41, 36864
    s_add_u32 s44, s85, 198656
    buffer_load_dwordx4 v14, s[8:11], s44 offen offset:0 lds
    buffer_load_dwordx4 v15, s[8:11], s44 offen offset:1024 lds
    s_add_u32 m0, s41, 40960
    s_add_u32 s44, s85, 200704
    buffer_load_dwordx4 v14, s[8:11], s44 offen offset:0 lds
    buffer_load_dwordx4 v15, s[8:11], s44 offen offset:1024 lds
    s_add_u32 m0, s41, 45056
    s_add_u32 s44, s85, 196608
    buffer_load_dwordx4 v14, s[8:11], s44 offen offset:0 lds
    buffer_load_dwordx4 v15, s[8:11], s44 offen offset:1024 lds
    s_add_u32 m0, s41, 49152
    s_add_u32 s44, s86, 2048
    buffer_load_dwordx4 v14, s[8:11], s44 offen offset:0 lds
    buffer_load_dwordx4 v15, s[8:11], s44 offen offset:1024 lds
    s_add_u32 m0, s41, 53248
    s_add_u32 s44, s86, 4096
    buffer_load_dwordx4 v14, s[8:11], s44 offen offset:0 lds
    buffer_load_dwordx4 v15, s[8:11], s44 offen offset:1024 lds
    s_add_u32 m0, s41, 57344
    s_add_u32 s44, s86, 0
    buffer_load_dwordx4 v14, s[8:11], s44 offen offset:0 lds
    buffer_load_dwordx4 v15, s[8:11], s44 offen offset:1024 lds
    s_add_u32 m0, s41, 61440
    s_add_u32 s44, s86, 198656
    buffer_load_dwordx4 v14, s[8:11], s44 offen offset:0 lds
    buffer_load_dwordx4 v15, s[8:11], s44 offen offset:1024 lds
    s_waitcnt vmcnt(0)
    s_barrier
    s_add_u32 m0, s41, 65536
    s_add_u32 s44, s86, 200704
    buffer_load_dwordx4 v14, s[8:11], s44 offen offset:0 lds
    buffer_load_dwordx4 v15, s[8:11], s44 offen offset:1024 lds
    s_add_u32 m0, s41, 69632
    s_add_u32 s44, s86, 196608
    buffer_load_dwordx4 v14, s[8:11], s44 offen offset:0 lds
    buffer_load_dwordx4 v15, s[8:11], s44 offen offset:1024 lds
    s_add_u32 m0, s41, 73728
    s_add_u32 s44, s87, 2048
    buffer_load_dwordx4 v14, s[8:11], s44 offen offset:0 lds
    buffer_load_dwordx4 v15, s[8:11], s44 offen offset:1024 lds
    s_add_u32 m0, s41, 77824
    s_add_u32 s44, s87, 4096
    buffer_load_dwordx4 v14, s[8:11], s44 offen offset:0 lds
    buffer_load_dwordx4 v15, s[8:11], s44 offen offset:1024 lds
    s_add_u32 m0, s41, 81920
    s_add_u32 s44, s87, 0
    buffer_load_dwordx4 v14, s[8:11], s44 offen offset:0 lds
    buffer_load_dwordx4 v15, s[8:11], s44 offen offset:1024 lds
    s_add_u32 m0, s41, 86016
    s_add_u32 s44, s87, 198656
    buffer_load_dwordx4 v14, s[8:11], s44 offen offset:0 lds
    buffer_load_dwordx4 v15, s[8:11], s44 offen offset:1024 lds
    s_add_u32 m0, s41, 90112
    s_add_u32 s44, s87, 200704
    buffer_load_dwordx4 v14, s[8:11], s44 offen offset:0 lds
    buffer_load_dwordx4 v15, s[8:11], s44 offen offset:1024 lds
    s_add_u32 m0, s41, 94208
    s_add_u32 s44, s87, 196608
    buffer_load_dwordx4 v14, s[8:11], s44 offen offset:0 lds
    buffer_load_dwordx4 v15, s[8:11], s44 offen offset:1024 lds
    s_add_u32 m0, s41, 98304
    s_add_u32 s44, s88, 2048
    buffer_load_dwordx4 v14, s[8:11], s44 offen offset:0 lds
    buffer_load_dwordx4 v15, s[8:11], s44 offen offset:1024 lds
    s_add_u32 m0, s41, 102400
    s_add_u32 s44, s88, 4096
    buffer_load_dwordx4 v14, s[8:11], s44 offen offset:0 lds
    buffer_load_dwordx4 v15, s[8:11], s44 offen offset:1024 lds
    s_add_u32 m0, s41, 106496
    s_add_u32 s44, s88, 0
    buffer_load_dwordx4 v14, s[8:11], s44 offen offset:0 lds
    buffer_load_dwordx4 v15, s[8:11], s44 offen offset:1024 lds
    s_add_u32 m0, s41, 110592
    s_add_u32 s44, s88, 198656
    buffer_load_dwordx4 v14, s[8:11], s44 offen offset:0 lds
    buffer_load_dwordx4 v15, s[8:11], s44 offen offset:1024 lds
    s_add_u32 m0, s41, 114688
    s_add_u32 s44, s88, 200704
    buffer_load_dwordx4 v14, s[8:11], s44 offen offset:0 lds
    buffer_load_dwordx4 v15, s[8:11], s44 offen offset:1024 lds
    s_add_u32 m0, s41, 118784
    s_add_u32 s44, s88, 196608
    buffer_load_dwordx4 v14, s[8:11], s44 offen offset:0 lds
    buffer_load_dwordx4 v15, s[8:11], s44 offen offset:1024 lds
    s_add_u32 m0, s41, 122880
    s_add_u32 s44, s89, 2048
    buffer_load_dwordx4 v14, s[8:11], s44 offen offset:0 lds
    buffer_load_dwordx4 v15, s[8:11], s44 offen offset:1024 lds
    s_add_u32 m0, s41, 126976
    s_add_u32 s44, s89, 4096
    buffer_load_dwordx4 v14, s[8:11], s44 offen offset:0 lds
    buffer_load_dwordx4 v15, s[8:11], s44 offen offset:1024 lds
    s_add_u32 m0, s41, 0
    s_add_u32 s44, s89, 0
    buffer_load_dwordx4 v14, s[8:11], s44 offen offset:0 lds
    buffer_load_dwordx4 v15, s[8:11], s44 offen offset:1024 lds
    s_add_u32 m0, s41, 4096
    s_add_u32 s44, s89, 198656
    buffer_load_dwordx4 v14, s[8:11], s44 offen offset:0 lds
    buffer_load_dwordx4 v15, s[8:11], s44 offen offset:1024 lds
    s_add_u32 m0, s41, 8192
    s_add_u32 s44, s89, 200704
    buffer_load_dwordx4 v14, s[8:11], s44 offen offset:0 lds
    buffer_load_dwordx4 v15, s[8:11], s44 offen offset:1024 lds
    s_add_u32 m0, s41, 12288
    s_add_u32 s44, s89, 196608
    buffer_load_dwordx4 v14, s[8:11], s44 offen offset:0 lds
    buffer_load_dwordx4 v15, s[8:11], s44 offen offset:1024 lds
    s_waitcnt vmcnt(24)
    s_branch l_join
l_layer:
    s_waitcnt lgkmcnt(0)
    s_barrier
    s_add_u32 m0, s41, 0
    s_add_u32 s44, s89, 0
    buffer_load_dwordx4 v14, s[8:11], s44 offen offset:0 lds
    buffer_load_dwordx4 v15, s[8:11], s44 offen offset:1024 lds
    s_add_u32 m0, s41, 4096
    s_add_u32 s44, s89, 198656
    buffer_load_dwordx4 v14, s[8:11], s44 offen offset:0 lds
    buffer_load_dwordx4 v15, s[8:11], s44 offen offset:1024 lds
    s_add_u32 m0, s41, 8192
    s_add_u32 s44, s89, 200704
    buffer_load_dwordx4 v14, s[8:11], s44 offen offset:0 lds
    buffer_load_dwordx4 v15, s[8:11], s44 offen offset:1024 lds
    s_add_u32 m0, s41, 12288
    s_add_u32 s44, s89, 196608
    buffer_load_dwordx4 v14, s[8:11], s44 offen offset:0 lds
    buffer_load_dwordx4 v15, s[8:11], s44 offen offset:1024 lds
    s_waitcnt vmcnt(24)
l_join:
    s_barrier
    s_add_u32 m0, s41, 16384
    s_add_u32 s44, s90, 2048
    buffer_load_dwordx4 v14, s[8:11], s44 offen offset:0 lds
    buffer_load_dwordx4 v15, s[8:11], s44 offen offset:1024 lds
    s_add_u32 m0, s41, 20480
    s_add_u32 s44, s90, 4096
    buffer_load_dwordx4 v14, s[8:11], s44 offen offset:0 lds
    buffer_load_dwordx4 v15, s[8:11], s44 offen offset:1024 lds
    s_add_u32 m0, s41, 24576
    s_add_u32 s44, s90, 0
    buffer_load_dwordx4 v14, s[8:11], s44 offen offset:0 lds
    buffer_load_dwordx4 v15, s[8:11], s44 offen offset:1024 lds
    s_add_u32 m0, s41, 28672
    s_add_u32 s44, s90, 198656
    buffer_load_dwordx4 v14, s[8:11], s44 offen offset:0 lds
    buffer_load_dwordx4 v15, s[8:11], s44 offen offset:1024 lds
    s_add_u32 m0, s41, 32768
    s_add_u32 s44, s90, 200704
    buffer_load_dwordx4 v14, s[8:11], s44 offen offset:0 lds
    buffer_load_dwordx4 v15, s[8:11], s44 offen offset:1024 lds
    s_add_u32 m0, s41, 36864
    s_add_u32 s44, s90, 196608
    buffer_load_dwordx4 v14, s[8:11], s44 offen offset:0 lds
    buffer_load_dwordx4 v15, s[8:11], s44 offen offset:1024 lds
    s_add_u32 m0, s41, 40960
    s_add_u32 s44, s91, 2048
    buffer_load_dwordx4 v14, s[8:11], s44 offen offset:0 lds
    buffer_load_dwordx4 v15, s[8:11], s44 offen offset:1024 lds
    s_add_u32 m0, s41, 45056
    s_add_u32 s44, s91, 4096
    buffer_load_dwordx4 v14, s[8:11], s44 offen offset:0 lds
    buffer_load_dwordx4 v15, s[8:11], s44 offen offset:1024 lds
    s_waitcnt vmcnt(24)
    s_barrier
    s_add_u32 m0, s41, 49152
    s_add_u32 s44, s91, 0
    buffer_load_dwordx4 v14, s[8:11], s44 offen offset:0 lds
    buffer_load_dwordx4 v15, s[8:11], s44 offen offset:1024 lds
    s_add_u32 m0, s41, 53248
    s_add_u32 s44, s91, 198656
    buffer_load_dwordx4 v14, s[8:11], s44 offen offset:0 lds
    buffer_load_dwordx4 v15, s[8:11], s44 offen offset:1024 lds
    s_add_u32 m0, s41, 57344
    s_add_u32 s44, s91, 200704
    buffer_load_dwordx4 v14, s[8:11], s44 offen offset:0 lds
    buffer_load_dwordx4 v15, s[8:11], s44 offen offset:1024 lds
    s_add_u32 m0, s41, 61440
    s_add_u32 s44, s91, 196608
    buffer_load_dwordx4 v14, s[8:11], s44 offen offset:0 lds
    buffer_load_dwordx4 v15, s[8:11], s44 offen offset:1024 lds
    s_waitcnt vmcnt(16)
    s_barrier
    s_add_u32 m0, s41, 65536
    s_add_u32 s44, s92, 2048
    buffer_load_dwordx4 v14, s[8:11], s44 offen offset:0 lds
    buffer_load_dwordx4 v15, s[8:11], s44 offen offset:1024 lds
    s_add_u32 m0, s41, 69632
    s_add_u32 s44, s92, 4096
    buffer_load_dwordx4 v14, s[8:11], s44 offen offset:0 lds
    buffer_load_dwordx4 v15, s[8:11], s44 offen offset:1024 lds
    s_add_u32 m0, s41, 73728
    s_add_u32 s44, s92, 0
    buffer_load_dwordx4 v14, s[8:11], s44 offen offset:0 lds
    buffer_load_dwordx4 v15, s[8:11], s44 offen offset:1024 lds
    s_add_u32 m0, s41, 77824
    s_add_u32 s44, s92, 198656
    buffer_load_dwordx4 v14, s[8:11], s44 offen offset:0 lds
    buffer_load_dwordx4 v15, s[8:11], s44 offen offset:1024 lds
    s_add_u32 m0, s41, 81920
    s_add_u32 s44, s92, 200704
    buffer_load_dwordx4 v14, s[8:11], s44 offen offset:0 lds
    buffer_load_dwordx4 v15, s[8:11], s44 offen offset:1024 lds
    s_add_u32 m0, s41, 86016
    s_add_u32 s44, s92, 196608
    buffer_load_dwordx4 v14, s[8:11], s44 offen offset:0 lds
    buffer_load_dwordx4 v15, s[8:11], s44 offen offset:1024 lds
    s_add_u32 m0, s41, 90112
    s_add_u32 s44, s93, 2048
    buffer_load_dwordx4 v14, s[8:11], s44 offen offset:0 lds
    buffer_load_dwordx4 v15, s[8:11], s44 offen offset:1024 lds
    s_add_u32 m0, s41, 94208
    s_add_u32 s44, s93, 4096
    buffer_load_dwordx4 v14, s[8:11], s44 offen offset:0 lds
    buffer_load_dwordx4 v15, s[8:11], s44 offen offset:1024 lds
    s_waitcnt vmcnt(16)
    s_barrier
    s_add_u32 m0, s41, 98304
    s_add_u32 s44, s93, 0
    buffer_load_dwordx4 v14, s[8:11], s44 offen offset:0 lds
    buffer_load_dwordx4 v15, s[8:11], s44 offen offset:1024 lds
    s_add_u32 m0, s41, 102400
    s_add_u32 s44, s93, 198656
    buffer_load_dwordx4 v14, s[8:11], s44 offen offset:0 lds
    buffer_load_dwordx4 v15, s[8:11], s44 offen offset:1024 lds
    s_add_u32 m0, s41, 106496
    s_add_u32 s44, s93, 200704
    buffer_load_dwordx4 v14, s[8:11], s44 offen offset:0 lds
    buffer_load_dwordx4 v15, s[8:11], s44 offen offset:1024 lds
    s_add_u32 m0, s41, 110592
    s_add_u32 s44, s93, 196608
    buffer_load_dwordx4 v14, s[8:11], s44 offen offset:0 lds
    buffer_load_dwordx4 v15, s[8:11], s44 offen offset:1024 lds
    s_add_u32 m0, s41, 114688
    s_add_u32 s44, s94, 2048
    buffer_load_dwordx4 v14, s[8:11], s44 offen offset:0 lds
    buffer_load_dwordx4 v15, s[8:11], s44 offen offset:1024 lds
    s_add_u32 m0, s41, 118784
    s_add_u32 s44, s94, 4096
    buffer_load_dwordx4 v14, s[8:11], s44 offen offset:0 lds
    buffer_load_dwordx4 v15, s[8:11], s44 offen offset:1024 lds
    s_add_u32 m0, s41, 122880
    s_add_u32 s44, s94, 198656
    buffer_load_dwordx4 v14, s[8:11], s44 offen offset:0 lds
    buffer_load_dwordx4 v15, s[8:11], s44 offen offset:1024 lds
    s_add_u32 m0, s41, 126976
    s_add_u32 s44, s94, 200704
    buffer_load_dwordx4 v14, s[8:11], s44 offen offset:0 lds
    buffer_load_dwordx4 v15, s[8:11], s44 offen offset:1024 lds
    s_waitcnt vmcnt(16)
    s_barrier
    s_add_u32 m0, s41, 0
    s_add_u32 s44, s95, 2048
    buffer_load_dwordx4 v14, s[8:11], s44 offen offset:0 lds
    buffer_load_dwordx4 v15, s[8:11], s44 offen offset:1024 lds
    s_add_u32 m0, s41, 4096
    s_add_u32 s44, s95, 4096
    buffer_load_dwordx4 v14, s[8:11], s44 offen offset:0 lds
    buffer_load_dwordx4 v15, s[8:11], s44 offen offset:1024 lds
    s_add_u32 m0, s41, 8192
    s_add_u32 s44, s95, 198656
    buffer_load_dwordx4 v14, s[8:11], s44 offen offset:0 lds
    buffer_load_dwordx4 v15, s[8:11], s44 offen offset:1024 lds
    s_add_u32 m0, s41, 12288
    s_add_u32 s44, s95, 200704
    buffer_load_dwordx4 v14, s[8:11], s44 offen offset:0 lds
    buffer_load_dwordx4 v15, s[8:11], s44 offen offset:1024 lds
    s_add_u32 m0, s41, 16384
    s_add_u32 s44, s96, 2048
    buffer_load_dwordx4 v14, s[8:11], s44 offen offset:0 lds
    buffer_load_dwordx4 v15, s[8:11], s44 offen offset:1024 lds
    s_add_u32 m0, s41, 20480
    s_add_u32 s44, s96, 198656
    buffer_load_dwordx4 v14, s[8:11], s44 offen offset:0 lds
    buffer_load_dwordx4 v15, s[8:11], s44 offen offset:1024 lds
    s_add_u32 m0, s41, 24576
    s_add_u32 s44, s97, 2048
    buffer_load_dwordx4 v14, s[8:11], s44 offen offset:0 lds
    buffer_load_dwordx4 v15, s[8:11], s44 offen offset:1024 lds
    s_add_u32 m0, s41, 28672
    s_add_u32 s44, s97, 198656
    buffer_load_dwordx4 v14, s[8:11], s44 offen offset:0 lds
    buffer_load_dwordx4 v15, s[8:11], s44 offen offset:1024 lds
    s_waitcnt vmcnt(16)
    s_barrier
    s_add_u32 m0, s41, 32768
    s_add_u32 s44, s98, 2048
    buffer_load_dwordx4 v14, s[8:11], s44 offen offset:0 lds
    buffer_load_dwordx4 v15, s[8:11], s44 offen offset:1024 lds
    s_add_u32 m0, s41, 36864
    s_add_u32 s44, s98, 198656
    buffer_load_dwordx4 v14, s[8:11], s44 offen offset:0 lds
    buffer_load_dwordx4 v15, s[8:11], s44 offen offset:1024 lds
    s_add_u32 m0, s41, 40960
    s_add_u32 s44, s99, 2048
    buffer_load_dwordx4 v14, s[8:11], s44 offen offset:0 lds
    buffer_load_dwordx4 v15, s[8:11], s44 offen offset:1024 lds
    s_add_u32 m0, s41, 45056
    s_add_u32 s44, s99, 198656
    buffer_load_dwordx4 v14, s[8:11], s44 offen offset:0 lds
    buffer_load_dwordx4 v15, s[8:11], s44 offen offset:1024 lds
    s_add_u32 m0, s41, 49152
    s_add_u32 s44, s96, 4096
    buffer_load_dwordx4 v14, s[8:11], s44 offen offset:0 lds
    buffer_load_dwordx4 v15, s[8:11], s44 offen offset:1024 lds
    s_add_u32 m0, s41, 53248
    s_add_u32 s44, s96, 200704
    buffer_load_dwordx4 v14, s[8:11], s44 offen offset:0 lds
    buffer_load_dwordx4 v15, s[8:11], s44 offen offset:1024 lds
    s_add_u32 m0, s41, 57344
    s_add_u32 s44, s97, 4096
    buffer_load_dwordx4 v14, s[8:11], s44 offen offset:0 lds
    buffer_load_dwordx4 v15, s[8:11], s44 offen offset:1024 lds
    s_add_u32 m0, s41, 61440
    s_add_u32 s44, s97, 200704
    buffer_load_dwordx4 v14, s[8:11], s44 offen offset:0 lds
    buffer_load_dwordx4 v15, s[8:11], s44 offen offset:1024 lds
    s_waitcnt vmcnt(16)
    s_barrier
    s_add_u32 m0, s41, 65536
    s_add_u32 s44, s98, 4096
    buffer_load_dwordx4 v14, s[8:11], s44 offen offset:0 lds
    buffer_load_dwordx4 v15, s[8:11], s44 offen offset:1024 lds
    s_add_u32 m0, s41, 69632
    s_add_u32 s44, s98, 200704
    buffer_load_dwordx4 v14, s[8:11], s44 offen offset:0 lds
    buffer_load_dwordx4 v15, s[8:11], s44 offen offset:1024 lds
    s_add_u32 m0, s41, 73728
    s_add_u32 s44, s99, 4096
    buffer_load_dwordx4 v14, s[8:11], s44 offen offset:0 lds
    buffer_load_dwordx4 v15, s[8:11], s44 offen offset:1024 lds
    s_add_u32 m0, s41, 77824
    s_add_u32 s44, s99, 200704
    buffer_load_dwordx4 v14, s[8:11], s44 offen offset:0 lds
    buffer_load_dwordx4 v15, s[8:11], s44 offen offset:1024 lds
    s_add_u32 m0, s41, 81920
    s_add_u32 s44, s94, 0
    buffer_load_dwordx4 v14, s[8:11], s44 offen offset:0 lds
    buffer_load_dwordx4 v15, s[8:11], s44 offen offset:1024 lds
    s_add_u32 m0, s41, 86016
    s_add_u32 s44, s94, 196608
    buffer_load_dwordx4 v14, s[8:11], s44 offen offset:0 lds
    buffer_load_dwordx4 v15, s[8:11], s44 offen offset:1024 lds
    s_add_u32 m0, s41, 90112
    s_add_u32 s44, s95, 0
    buffer_load_dwordx4 v14, s[8:11], s44 offen offset:0 lds
    buffer_load_dwordx4 v15, s[8:11], s44 offen offset:1024 lds
    s_add_u32 m0, s41, 94208
    s_add_u32 s44, s95, 196608
    buffer_load_dwordx4 v14, s[8:11], s44 offen offset:0 lds
    buffer_load_dwordx4 v15, s[8:11], s44 offen offset:1024 lds
    s_waitcnt vmcnt(16)
    s_barrier
    s_add_u32 m0, s41, 98304
    s_add_u32 s44, s96, 0
    buffer_load_dwordx4 v14, s[8:11], s44 offen offset:0 lds
    buffer_load_dwordx4 v15, s[8:11], s44 offen offset:1024 lds
    s_add_u32 m0, s41, 102400
    s_add_u32 s44, s96, 196608
    buffer_load_dwordx4 v14, s[8:11], s44 offen offset:0 lds
    buffer_load_dwordx4 v15, s[8:11], s44 offen offset:1024 lds
    s_add_u32 m0, s41, 106496
    s_add_u32 s44, s97, 0
    buffer_load_dwordx4 v14, s[8:11], s44 offen offset:0 lds
    buffer_load_dwordx4 v15, s[8:11], s44 offen offset:1024 lds
    s_add_u32 m0, s41, 110592
    s_add_u32 s44, s97, 196608
    buffer_load_dwordx4 v14, s[8:11], s44 offen offset:0 lds
    buffer_load_dwordx4 v15, s[8:11], s44 offen offset:1024 lds
    s_add_u32 m0, s41, 114688
    s_add_u32 s44, s98, 0
    buffer_load_dwordx4 v14, s[8:11], s44 offen offset:0 lds
    buffer_load_dwordx4 v15, s[8:11], s44 offen offset:1024 lds
    s_add_u32 m0, s41, 118784
    s_add_u32 s44, s98, 196608
    buffer_load_dwordx4 v14, s[8:11], s44 offen offset:0 lds
    buffer_load_dwordx4 v15, s[8:11], s44 offen offset:1024 lds
    s_add_u32 m0, s41, 122880
    s_add_u32 s44, s99, 0
    buffer_load_dwordx4 v14, s[8:11], s44 offen offset:0 lds
    buffer_load_dwordx4 v15, s[8:11], s44 offen offset:1024 lds
    s_add_u32 m0, s41, 126976
    s_add_u32 s44, s99, 196608
    buffer_load_dwordx4 v14, s[8:11], s44 offen offset:0 lds
    buffer_load_dwordx4 v15, s[8:11], s44 offen offset:1024 lds
    s_waitcnt vmcnt(16)
    s_barrier
    v_lshrrev_b32 v28, 4, v1
    v_and_b32 v29, 7, v28
    v_lshrrev_b32 v28, 3, v28
    v_mul_u32_u24 v28, 2048, v28
    v_lshl_add_u32 v28, v29, 4, v28
    s_and_b32 s3, s18, 12
    s_or_b32 s3, s3, 3
    s_lshl_b32 s3, s3, 7
    v_add_u32 v28, s3, v28
    s_lshr_b32 s3, s2, 3
    s_lshl_b32 s3, s3, 2
    s_and_b32 s60, s16, 3
    s_add_u32 s60, s60, s3
    s_lshl_b32 s61, s60, 14
    buffer_load_dwordx4 v[144:147], v28, s[12:15], s61 offen
    s_bitcmp0_b32 s21, 0
    s_cselect_b32 s56, s28, s24
    s_cselect_b32 s57, s29, s25
    s_mov_b32 s58, 6291456
    s_mov_b32 s59, 0x00020000
    v_lshrrev_b32 v28, 4, v1
    v_and_b32 v29, 7, v28
    v_lshrrev_b32 v28, 3, v28
    v_mul_u32_u24 v28, 6144, v28
    v_lshl_add_u32 v28, v29, 4, v28
    s_and_b32 s3, s18, 12
    s_or_b32 s3, s3, 3
    s_lshl_b32 s3, s3, 7
    v_add_u32 v28, s3, v28
    s_lshr_b32 s3, s2, 3
    s_lshl_b32 s3, s3, 2
    s_and_b32 s60, s16, 3
    s_add_u32 s60, s60, s3
    s_and_b32 s3, s60, 31
    s_mul_i32 s3, s3, 49152
    s_lshr_b32 s61, s60, 5
    s_min_u32 s61, s61, 2
    s_lshl_b32 s61, s61, 11
    s_add_u32 s61, s61, s3
    s_cmp_lt_u32 s18, 4
    s_cselect_b32 s3, 1572864, 0
    s_add_u32 s61, s61, s3
    buffer_load_dwordx4 v[148:151], v28, s[56:59], s61 offen
    s_waitcnt vmcnt(2)
    s_bitcmp1_b32 s21, 0
    s_cbranch_scc1 l_pe
    s_bitcmp0_b32 s21, 0
    s_cselect_b32 s56, s28, s24
    s_cselect_b32 s57, s29, s25
    s_mov_b32 s58, 6291456
    s_mov_b32 s59, 0x00020000
    s_add_u32 s61, s84, 2048
    buffer_load_dwordx4 v[160:163], v11, s[56:59], s61 offen
    s_add_u32 s61, s84, 4096
    buffer_load_dwordx4 v[164:167], v11, s[56:59], s61 offen
    s_add_u32 s61, s84, 0
    buffer_load_dwordx4 v[168:171], v11, s[56:59], s61 offen
    s_add_u32 s61, s84, 198656
    buffer_load_dwordx4 v[172:175], v11, s[56:59], s61 offen
    s_add_u32 s61, s84, 200704
    buffer_load_dwordx4 v[176:179], v11, s[56:59], s61 offen
    s_add_u32 s61, s84, 196608
    buffer_load_dwordx4 v[180:183], v11, s[56:59], s61 offen
l_pe:
    s_barrier
    s_bitcmp1_b32 s21, 0
    s_cbranch_scc1 s_B
    s_add_u32 m0, s41, 0
    s_xor_b32 s44, s62, 0
    buffer_load_dwordx4 v16, s[12:15], s44 offen offset:0 lds
    buffer_load_dwordx4 v17, s[12:15], s44 offen offset:1024 lds
    s_add_u32 m0, s41, 4096
    s_xor_b32 s44, s62, 131072
    buffer_load_dwordx4 v16, s[12:15], s44 offen offset:0 lds
    buffer_load_dwordx4 v17, s[12:15], s44 offen offset:1024 lds
    s_add_u32 m0, s41, 8192
    s_xor_b32 s44, s62, 262144
    buffer_load_dwordx4 v16, s[12:15], s44 offen offset:0 lds
    buffer_load_dwordx4 v17, s[12:15], s44 offen offset:1024 lds
    s_add_u32 m0, s41, 12288
    s_xor_b32 s44, s62, 393216
    buffer_load_dwordx4 v16, s[12:15], s44 offen offset:0 lds
    buffer_load_dwordx4 v17, s[12:15], s44 offen offset:1024 lds
    s_add_u32 m0, s41, 16384
    s_xor_b32 s44, s62, 524288
    buffer_load_dwordx4 v16, s[12:15], s44 offen offset:0 lds
    buffer_load_dwordx4 v17, s[12:15], s44 offen offset:1024 lds
    s_add_u32 m0, s41, 20480
    s_xor_b32 s44, s62, 655360
    buffer_load_dwordx4 v16, s[12:15], s44 offen offset:0 lds
    buffer_load_dwordx4 v17, s[12:15], s44 offen offset:1024 lds
    s_add_u32 m0, s41, 24576
    s_xor_b32 s44, s62, 786432
    buffer_load_dwordx4 v16, s[12:15], s44 offen offset:0 lds
    buffer_load_dwordx4 v17, s[12:15], s44 offen offset:1024 lds
    s_add_u32 m0, s41, 28672
    s_xor_b32 s44, s62, 917504
    buffer_load_dwordx4 v16, s[12:15], s44 offen offset:0 lds
    buffer_load_dwordx4 v17, s[12:15], s44 offen offset:1024 lds
    s_add_u32 m0, s41, 32768
    s_xor_b32 s44, s62, 1048576
    buffer_load_dwordx4 v16, s[12:15], s44 offen offset:0 lds
    buffer_load_dwordx4 v17, s[12:15], s44 offen offset:1024 lds
    s_add_u32 m0, s41, 36864
    s_xor_b32 s44, s62, 1179648
    buffer_load_dwordx4 v16, s[12:15], s44 offen offset:0 lds
    buffer_load_dwordx4 v17, s[12:15], s44 offen offset:1024 lds
    s_add_u32 m0, s41, 40960
    s_xor_b32 s44, s62, 1310720
    buffer_load_dwordx4 v16, s[12:15], s44 offen offset:0 lds
    buffer_load_dwordx4 v17, s[12:15], s44 offen offset:1024 lds
    s_add_u32 m0, s41, 45056
    s_xor_b32 s44, s62, 1441792
    buffer_load_dwordx4 v16, s[12:15], s44 offen offset:0 lds
    buffer_load_dwordx4 v17, s[12:15], s44 offen offset:1024 lds
    s_add_u32 m0, s41, 49152
    s_xor_b32 s44, s62, 1572864
    buffer_load_dwordx4 v16, s[12:15], s44 offen offset:0 lds
    buffer_load_dwordx4 v17, s[12:15], s44 offen offset:1024 lds
    s_add_u32 m0, s41, 53248
    s_xor_b32 s44, s62, 1703936
    buffer_load_dwordx4 v16, s[12:15], s44 offen offset:0 lds
    buffer_load_dwordx4 v17, s[12:15], s44 offen offset:1024 lds
    s_add_u32 m0, s41, 57344
    s_xor_b32 s44, s62, 1835008
    buffer_load_dwordx4 v16, s[12:15], s44 offen offset:0 lds
    buffer_load_dwordx4 v17, s[12:15], s44 offen offset:1024 lds
    s_add_u32 m0, s41, 61440
    s_xor_b32 s44, s62, 1966080
    buffer_load_dwordx4 v16, s[12:15], s44 offen offset:0 lds
    buffer_load_dwordx4 v17, s[12:15], s44 offen offset:1024 lds
    s_branch s_tail
h_start:
    v_mov_b32 v20, 0
    v_mov_b32 v21, 0
    v_mov_b32 v22, 0
    v_mov_b32 v23, 0
    s_cmp_lt_u32 s2, 10
    s_cbranch_scc0 h_z0
    s_load_dword s101, s[34:35], 192
    s_lshl_b32 s44, s2, 11
    s_mov_b32 s45, 0
    s_mov_b32 s46, 0
    s_mov_b32 s47, 0
    s_mov_b32 s48, 0
    s_mov_b32 s49, 0
    s_mov_b32 s50, 0
    s_mov_b32 s51, 0
    s_mov_b32 s52, 0
    s_mov_b32 s53, 0
    s_mov_b32 s54, 0
    s_mov_b32 s55, 0
    s_mov_b32 s56, 0
    s_mov_b32 s57, 0
    s_mov_b32 s58, 0
    s_mov_b32 s59, 0
    s_mov_b32 s60, 0
    s_atomic_swap s45, s[22:23], s44 offset:0 glc
    s_atomic_swap s46, s[22:23], s44 offset:128 glc
    s_atomic_swap s47, s[22:23], s44 offset:256 glc
    s_atomic_swap s48, s[22:23], s44 offset:384 glc
    s_atomic_swap s49, s[22:23], s44 offset:512 glc
    s_atomic_swap s50, s[22:23], s44 offset:640 glc
    s_atomic_swap s51, s[22:23], s44 offset:768 glc
    s_atomic_swap s52, s[22:23], s44 offset:896 glc
    s_atomic_swap s53, s[22:23], s44 offset:1024 glc
    s_atomic_swap s54, s[22:23], s44 offset:1152 glc
    s_atomic_swap s55, s[22:23], s44 offset:1280 glc
    s_atomic_swap s56, s[22:23], s44 offset:1408 glc
    s_atomic_swap s57, s[22:23], s44 offset:1536 glc
    s_atomic_swap s58, s[22:23], s44 offset:1664 glc
    s_atomic_swap s59, s[22:23], s44 offset:1792 glc
    s_atomic_swap s60, s[22:23], s44 offset:1920 glc
    s_waitcnt lgkmcnt(0)
    s_atomic_add s40, s[34:35], 0
h_z0:
    v_lshrrev_b32 v24, 4, v1
    v_lshrrev_b32 v25, 3, v24
    v_mul_u32_u24 v12, 6144, v25
    v_and_b32 v26, 2, v25
    v_lshrrev_b32 v25, 2, v25
    v_or_b32 v26, v26, v25
    v_bfe_u32 v25, v24, 1, 2
    v_xor_b32 v26, v26, v25
    v_lshl_add_u32 v12, v26, 5, v12
    v_and_b32 v26, 1, v24
    v_lshl_add_u32 v12, v26, 4, v12
    s_lshl_b32 s3, s18, 7
    v_add_u32 v12, s3, v12
    v_add_u32 v13, 48128, v12
    s_mul_i32 s84, s18, 393216
    s_cmp_lt_u32 s18, 4
    s_cselect_b32 s85, 4, 0
    s_mul_i32 s85, s85, 393216
    s_cmp_lt_u32 s18, 4
    s_cselect_b32 s86, 5, 1
    s_mul_i32 s86, s86, 393216
    s_cmp_lt_u32 s18, 4
    s_cselect_b32 s87, 6, 2
    s_mul_i32 s87, s87, 393216
    s_cmp_lt_u32 s18, 4
    s_cselect_b32 s88, 7, 3
    s_mul_i32 s88, s88, 393216
    s_cmp_lt_u32 s18, 8
    s_cselect_b32 s89, 8, 4
    s_mul_i32 s89, s89, 393216
    s_cmp_lt_u32 s18, 8
    s_cselect_b32 s90, 9, 5
    s_mul_i32 s90, s90, 393216
    s_cmp_lt_u32 s18, 8
    s_cselect_b32 s91, 10, 6
    s_mul_i32 s91, s91, 393216
    s_cmp_lt_u32 s18, 8
    s_cselect_b32 s92, 11, 7
    s_mul_i32 s92, s92, 393216
    s_cmp_lt_u32 s18, 12
    s_cselect_b32 s93, 12, 8
    s_mul_i32 s93, s93, 393216
    s_cmp_lt_u32 s18, 12
    s_cselect_b32 s94, 13, 9
    s_mul_i32 s94, s94, 393216
    s_cmp_lt_u32 s18, 12
    s_cselect_b32 s95, 14, 10
    s_mul_i32 s95, s95, 393216
    s_cmp_lt_u32 s18, 12
    s_cselect_b32 s96, 15, 11
    s_mul_i32 s96, s96, 393216
    s_xor_b32 s97, s18, 1
    s_mul_i32 s97, s97, 393216
    s_xor_b32 s98, s18, 2
    s_mul_i32 s98, s98, 393216
    s_xor_b32 s99, s18, 3
    s_mul_i32 s99, s99, 393216
    v_lshrrev_b32 v24, 4, v1
    v_lshrrev_b32 v25, 3, v24
    v_mul_u32_u24 v16, 2048, v25
    v_and_b32 v26, 2, v25
    v_lshrrev_b32 v25, 2, v25
    v_or_b32 v26, v26, v25
    v_bfe_u32 v25, v24, 1, 2
    v_xor_b32 v26, v26, v25
    v_lshl_add_u32 v16, v26, 5, v16
    v_and_b32 v26, 1, v24
    v_lshl_add_u32 v16, v26, 4, v16
    s_lshl_b32 s3, s18, 7
    v_add_u32 v16, s3, v16
    v_add_u32 v17, 15360, v16
    v_add_u32 v18, 30720, v16
    v_add_u32 v19, 46080, v16
    s_and_b32 s3, s16, 3
    s_mul_i32 s3, s3, 49152
    v_add_u32 v11, s3, v12
    s_and_b32 s3, s16, 3
    s_lshl_b32 s3, s3, 10
    v_add_u32 v9, s3, v1
    v_add_u32 v10, 0x10000, v9
    v_lshrrev_b32 v24, 4, v1
    v_and_b32 v25, 15, v24
    v_lshrrev_b32 v24, 4, v24
    v_lshlrev_b32 v24, 2, v24
    v_sub_u32 v24, v25, v24
    v_mov_b32 v25, 0xf149f2ca
    v_add_u32 v26, 0x0, v24
    v_and_b32 v26, 0xfffffff1, v26
    v_cmp_eq_u32 vcc, 0, v26
    s_nop 1
    v_cndmask_b32 v32, v25, 0, vcc
    v_add_u32 v26, 0xffffffff, v24
    v_and_b32 v26, 0xfffffff1, v26
    v_cmp_eq_u32 vcc, 0, v26
    s_nop 1
    v_cndmask_b32 v33, v25, 0, vcc
    v_add_u32 v26, 0xfffffffe, v24
    v_and_b32 v26, 0xfffffff1, v26
    v_cmp_eq_u32 vcc, 0, v26
    s_nop 1
    v_cndmask_b32 v34, v25, 0, vcc
    v_add_u32 v26, 0xfffffffd, v24
    v_and_b32 v26, 0xfffffff1, v26
    v_cmp_eq_u32 vcc, 0, v26
    s_nop 1
    v_cndmask_b32 v35, v25, 0, vcc
    v_add_u32 v26, 0x10, v24
    v_and_b32 v26, 0xfffffff1, v26
    v_cmp_eq_u32 vcc, 0, v26
    s_nop 1
    v_cndmask_b32 v36, v25, 0, vcc
    v_add_u32 v26, 0xf, v24
    v_and_b32 v26, 0xfffffff1, v26
    v_cmp_eq_u32 vcc, 0, v26
    s_nop 1
    v_cndmask_b32 v37, v25, 0, vcc
    v_add_u32 v26, 0xe, v24
    v_and_b32 v26, 0xfffffff1, v26
    v_cmp_eq_u32 vcc, 0, v26
    s_nop 1
    v_cndmask_b32 v38, v25, 0, vcc
    v_add_u32 v26, 0xd, v24
    v_and_b32 v26, 0xfffffff1, v26
    v_cmp_eq_u32 vcc, 0, v26
    s_nop 1
    v_cndmask_b32 v39, v25, 0, vcc
    v_add_u32 v24, 153600, v1
    ds_write_b128 v24, v[32:35] offset:0
    ds_write_b128 v24, v[36:39] offset:1024
    s_waitcnt lgkmcnt(0)
    s_lshl_b32 s44, s21, 14
    s_lshl_b32 s67, s17, 9
    s_add_u32 s44, s44, s67
    s_add_u32 s44, s44, 4096
    s_barrier
    s_barrier
    s_mov_b32 s66, 0x10000
h_s0_poll:
    s_mov_b32 s68, 0
    s_mov_b32 s69, 0
    s_mov_b32 s70, 0
    s_mov_b32 s71, 0
    s_atomic_add s68, s[22:23], s44 offset:0 glc
    s_atomic_add s69, s[22:23], s44 offset:128 glc
    s_atomic_add s70, s[22:23], s44 offset:256 glc
    s_atomic_add s71, s[22:23], s44 offset:384 glc
    s_sub_u32 s66, s66, 1
    s_cselect_b32 s67, 67372036, 0
    s_waitcnt lgkmcnt(0)
    s_and_b32 s68, s68, s69
    s_and_b32 s68, s68, s70
    s_and_b32 s68, s68, s71
    s_max_u32 s68, s68, s67
    s_cmp_lt_u32 s68, 67372036
    s_cbranch_scc1 h_s0_poll
h_s0_ok:
    s_lshr_b32 s3, s2, 3
    s_cmp_eq_u32 s3, 2
    s_cbranch_scc0 h_g4
    s_barrier
    s_mul_i32 s44, s2, 24576
    s_add_u32 s44, s44, 58347520
    s_mov_b32 s45, 24
h_zloop:
    buffer_store_dwordx4 v[20:23], v1, s[4:7], s44 offen sc1
    s_add_u32 s44, s44, 1024
    s_sub_u32 s45, s45, 1
    s_cmp_lg_u32 s45, 0
    s_cbranch_scc1 h_zloop
    s_branch h_g4b
h_layer:
    s_waitcnt lgkmcnt(0)
    s_barrier
h_g4:
    s_barrier
h_g4b:
    s_lshl_b32 s44, s21, 14
    s_lshl_b32 s67, s17, 9
    s_add_u32 s44, s44, s67
    s_add_u32 s44, s44, 12288
    s_mov_b32 s66, 0x10000
h_s_poll:
    s_mov_b32 s68, 0
    s_mov_b32 s69, 0
    s_mov_b32 s70, 0
    s_mov_b32 s71, 0
    s_atomic_add s68, s[22:23], s44 offset:0 glc
    s_atomic_add s69, s[22:23], s44 offset:128 glc
    s_atomic_add s70, s[22:23], s44 offset:256 glc
    s_atomic_add s71, s[22:23], s44 offset:384 glc
    s_sub_u32 s66, s66, 1
    s_cselect_b32 s67, 16, 0
    s_waitcnt lgkmcnt(0)
    s_and_b32 s68, s68, s69
    s_and_b32 s68, s68, s70
    s_and_b32 s68, s68, s71
    s_max_u32 s68, s68, s67
    s_cmp_lt_u32 s68, 16
    s_cbranch_scc1 h_s_poll
h_s_ok:
    s_barrier
    s_lshl_b32 s44, s21, 18
    s_lshl_b32 s45, s17, 14
    s_add_u32 s44, s44, s45
    s_add_u32 s44, s44, 50331648
    buffer_load_dwordx4 v[32:35], v1, s[4:7], s44 offen offset:0 sc1
    buffer_load_dwordx4 v[36:39], v1, s[4:7], s44 offen offset:1024 sc1
    buffer_load_dwordx4 v[40:43], v1, s[4:7], s44 offen offset:2048 sc1
    buffer_load_dwordx4 v[44:47], v1, s[4:7], s44 offen offset:3072 sc1
    s_add_u32 s44, s44, 4096
    buffer_load_dwordx4 v[48:51], v1, s[4:7], s44 offen offset:0 sc1
    buffer_load_dwordx4 v[52:55], v1, s[4:7], s44 offen offset:1024 sc1
    buffer_load_dwordx4 v[56:59], v1, s[4:7], s44 offen offset:2048 sc1
    buffer_load_dwordx4 v[60:63], v1, s[4:7], s44 offen offset:3072 sc1
    s_add_u32 s44, s44, 4096
    buffer_load_dwordx4 v[64:67], v1, s[4:7], s44 offen offset:0 sc1
    buffer_load_dwordx4 v[68:71], v1, s[4:7], s44 offen offset:1024 sc1
    buffer_load_dwordx4 v[72:75], v1, s[4:7], s44 offen offset:2048 sc1
    buffer_load_dwordx4 v[76:79], v1, s[4:7], s44 offen offset:3072 sc1
    s_add_u32 s44, s44, 4096
    buffer_load_dwordx4 v[80:83], v1, s[4:7], s44 offen offset:0 sc1
    buffer_load_dwordx4 v[84:87], v1, s[4:7], s44 offen offset:1024 sc1
    buffer_load_dwordx4 v[88:91], v1, s[4:7], s44 offen offset:2048 sc1
    buffer_load_dwordx4 v[92:95], v1, s[4:7], s44 offen offset:3072 sc1
    s_barrier
    s_cmp_ge_u32 s21, 2
    s_cbranch_scc1 h_c_ok
    s_lshl_b32 s44, s21, 11
    s_lshl_b32 s67, s18, 7
    s_add_u32 s44, s44, s67
    s_add_u32 s44, s44, 0
    s_mov_b32 s66, 0x10000
h_c_poll:
    s_mov_b32 s68, 0
    s_atomic_add s68, s[22:23], s44 offset:0 glc
    s_sub_u32 s66, s66, 1
    s_cselect_b32 s67, 48, 0
    s_waitcnt lgkmcnt(0)
    s_max_u32 s68, s68, s67
    s_cmp_lt_u32 s68, 48
    s_cbranch_scc1 h_c_poll
h_c_ok:
    s_waitcnt vmcnt(0)
    s_lshl_b32 s3, s21, 8
    s_add_u32 s3, s3, s2
    s_lshr_b32 s3, s3, 3
    s_cmp_eq_u32 s3, 2
    s_cbranch_scc0 h_nf1
    s_atomic_add s40, s[34:35], 128
h_nf1:
    s_barrier
    s_cmp_ge_u32 s21, 2
    s_cbranch_scc1 h_cs1
    s_lshl_b32 s44, s21, 18
    s_lshl_b32 s45, s18, 14
    s_add_u32 s44, s44, s45
    s_add_u32 s44, s44, 52428800
    buffer_load_dwordx4 v[96:99], v1, s[4:7], s44 offen offset:0 sc1
    buffer_load_dwordx4 v[100:103], v1, s[4:7], s44 offen offset:1024 sc1
    buffer_load_dwordx4 v[104:107], v1, s[4:7], s44 offen offset:2048 sc1
    buffer_load_dwordx4 v[108:111], v1, s[4:7], s44 offen offset:3072 sc1
    s_add_u32 s44, s44, 4096
    buffer_load_dwordx4 v[112:115], v1, s[4:7], s44 offen offset:0 sc1
    buffer_load_dwordx4 v[116:119], v1, s[4:7], s44 offen offset:1024 sc1
    buffer_load_dwordx4 v[120:123], v1, s[4:7], s44 offen offset:2048 sc1
    buffer_load_dwordx4 v[124:127], v1, s[4:7], s44 offen offset:3072 sc1
    s_add_u32 s44, s44, 4096
    buffer_load_dwordx4 v[128:131], v1, s[4:7], s44 offen offset:0 sc1
    buffer_load_dwordx4 v[132:135], v1, s[4:7], s44 offen offset:1024 sc1
    buffer_load_dwordx4 v[136:139], v1, s[4:7], s44 offen offset:2048 sc1
    buffer_load_dwordx4 v[140:143], v1, s[4:7], s44 offen offset:3072 sc1
    s_add_u32 s44, s44, 4096
    buffer_load_dwordx4 v[144:147], v1, s[4:7], s44 offen offset:0 sc1
    buffer_load_dwordx4 v[148:151], v1, s[4:7], s44 offen offset:1024 sc1
    buffer_load_dwordx4 v[152:155], v1, s[4:7], s44 offen offset:2048 sc1
    buffer_load_dwordx4 v[156:159], v1, s[4:7], s44 offen offset:3072 sc1
h_cs1:
    v_add_f32 v32, v32, v36
    v_add_f32 v33, v33, v37
    v_add_f32 v34, v34, v38
    v_add_f32 v35, v35, v39
    v_add_f32 v48, v48, v52
    v_add_f32 v49, v49, v53
    v_add_f32 v50, v50, v54
    v_add_f32 v51, v51, v55
    v_add_f32 v64, v64, v68
    v_add_f32 v65, v65, v69
    v_add_f32 v66, v66, v70
    v_add_f32 v67, v67, v71
    v_add_f32 v80, v80, v84
    v_add_f32 v81, v81, v85
    v_add_f32 v82, v82, v86
    v_add_f32 v83, v83, v87
    v_add_f32 v32, v32, v40
    v_add_f32 v33, v33, v41
    v_add_f32 v34, v34, v42
    v_add_f32 v35, v35, v43
    v_add_f32 v48, v48, v56
    v_add_f32 v49, v49, v57
    v_add_f32 v50, v50, v58
    v_add_f32 v51, v51, v59
    v_add_f32 v64, v64, v72
    v_add_f32 v65, v65, v73
    v_add_f32 v66, v66, v74
    v_add_f32 v67, v67, v75
    v_add_f32 v80, v80, v88
    v_add_f32 v81, v81, v89
    v_add_f32 v82, v82, v90
    v_add_f32 v83, v83, v91
    s_barrier
    v_add_f32 v32, v32, v44
    v_add_f32 v33, v33, v45
    v_add_f32 v34, v34, v46
    v_add_f32 v35, v35, v47
    v_add_f32 v48, v48, v60
    v_add_f32 v49, v49, v61
    v_add_f32 v50, v50, v62
    v_add_f32 v51, v51, v63
    v_add_f32 v64, v64, v76
    v_add_f32 v65, v65, v77
    v_add_f32 v66, v66, v78
    v_add_f32 v67, v67, v79
    v_add_f32 v80, v80, v92
    v_add_f32 v81, v81, v93
    v_add_f32 v82, v82, v94
    v_add_f32 v83, v83, v95
    v_permlane32_swap_b32 v32, v64
    v_permlane32_swap_b32 v33, v65
    v_permlane32_swap_b32 v34, v66
    v_permlane32_swap_b32 v35, v67
    v_add_f32 v32, v32, v64
    v_add_f32 v33, v33, v65
    v_add_f32 v34, v34, v66
    v_add_f32 v35, v35, v67
    v_permlane32_swap_b32 v48, v80
    v_permlane32_swap_b32 v49, v81
    v_permlane32_swap_b32 v50, v82
    v_permlane32_swap_b32 v51, v83
    v_add_f32 v48, v48, v80
    v_add_f32 v49, v49, v81
    v_add_f32 v50, v50, v82
    v_add_f32 v51, v51, v83
    v_permlane16_swap_b32 v32, v48
    v_permlane16_swap_b32 v33, v49
    v_permlane16_swap_b32 v34, v50
    v_permlane16_swap_b32 v35, v51
    v_add_f32 v32, v32, v48
    v_add_f32 v33, v33, v49
    v_add_f32 v34, v34, v50
    v_add_f32 v35, v35, v51
    s_barrier
    v_mul_f32 v32, 0x3a800000, v32
    v_mul_f32 v33, 0x3a800000, v33
    v_mul_f32 v34, 0x3a800000, v34
    v_mul_f32 v35, 0x3a800000, v35
    v_fma_f32 v33, -v32, v32, v33
    v_fma_f32 v35, -v34, v34, v35
    v_max_f32 v33, 0, v33
    v_max_f32 v35, 0, v35
    v_add_f32 v33, 0x3727c5ac, v33
    v_add_f32 v35, 0x3727c5ac, v35
    v_rsq_f32 v33, v33
    v_rsq_f32 v35, v35
    v_lshrrev_b32 v26, 1, v1
    v_add_u32 v26, 155648, v26
    ds_write2_b32 v26, v32, v34 offset0:0 offset1:1
    ds_write2_b32 v26, v33, v35 offset0:128 offset1:129
    s_barrier
    s_cmp_ge_u32 s21, 2
    s_cbranch_scc1 h_cs_done
    s_waitcnt vmcnt(0)
    v_add_f32 v96, v96, v100
    v_add_f32 v97, v97, v101
    v_add_f32 v98, v98, v102
    v_add_f32 v99, v99, v103
    v_add_f32 v96, v96, v104
    v_add_f32 v97, v97, v105
    v_add_f32 v98, v98, v106
    v_add_f32 v99, v99, v107
    v_add_f32 v96, v96, v108
    v_add_f32 v97, v97, v109
    v_add_f32 v98, v98, v110
    v_add_f32 v99, v99, v111
    v_add_f32 v96, v96, v112
    v_add_f32 v97, v97, v113
    v_add_f32 v98, v98, v114
    v_add_f32 v99, v99, v115
    v_add_f32 v96, v96, v116
    v_add_f32 v97, v97, v117
    v_add_f32 v98, v98, v118
    v_add_f32 v99, v99, v119
    v_add_f32 v96, v96, v120
    v_add_f32 v97, v97, v121
    v_add_f32 v98, v98, v122
    v_add_f32 v99, v99, v123
    v_add_f32 v96, v96, v124
    v_add_f32 v97, v97, v125
    v_add_f32 v98, v98, v126
    v_add_f32 v99, v99, v127
    v_add_f32 v96, v96, v128
    v_add_f32 v97, v97, v129
    v_add_f32 v98, v98, v130
    v_add_f32 v99, v99, v131
    v_add_f32 v96, v96, v132
    v_add_f32 v97, v97, v133
    v_add_f32 v98, v98, v134
    v_add_f32 v99, v99, v135
    v_add_f32 v96, v96, v136
    v_add_f32 v97, v97, v137
    v_add_f32 v98, v98, v138
    v_add_f32 v99, v99, v139
    v_add_f32 v96, v96, v140
    v_add_f32 v97, v97, v141
    v_add_f32 v98, v98, v142
    v_add_f32 v99, v99, v143
    v_add_f32 v96, v96, v144
    v_add_f32 v97, v97, v145
    v_add_f32 v98, v98, v146
    v_add_f32 v99, v99, v147
    v_add_f32 v96, v96, v148
    v_add_f32 v97, v97, v149
    v_add_f32 v98, v98, v150
    v_add_f32 v99, v99, v151
    v_add_f32 v96, v96, v152
    v_add_f32 v97, v97, v153
    v_add_f32 v98, v98, v154
    v_add_f32 v99, v99, v155
    v_add_f32 v96, v96, v156
    v_add_f32 v97, v97, v157
    v_add_f32 v98, v98, v158
    v_add_f32 v99, v99, v159
    s_lshl_b32 s44, s21, 10
    s_add_u32 s44, s44, 151552
    v_add_u32 v24, s44, v1
    ds_write_b128 v24, v[96:99]
h_cs_done:
    s_waitcnt lgkmcnt(0)
    s_barrier
    s_cmp_lg_u32 s21, 0
    s_cbranch_scc1 h_f1_ok
    s_load_dword s68, s[34:35], 128
    s_mov_b32 s8, s34
    s_mov_b32 s9, s35
    s_mov_b32 s10, 256
    s_mov_b32 s11, 0x00020000
    s_mov_b32 s66, 0x10000
    v_mov_b32 v24, 0
    s_waitcnt lgkmcnt(0)
h_f1:
    s_cmp_eq_u32 s68, 8
    s_cbranch_scc1 h_f1_ok
    buffer_load_dword v25, v24, s[8:11], 0 offen offset:128 sc1
    s_waitcnt vmcnt(0)
    v_readfirstlane_b32 s68, v25
    s_sub_u32 s66, s66, 1
    s_cmp_lg_u32 s66, 0
    s_cbranch_scc1 h_f1
h_f1_ok:
    s_barrier
    s_bitcmp1_b32 s21, 0
    s_cselect_b32 s8, s28, s24
    s_cselect_b32 s9, s29, s25
    s_cselect_b32 s12, s30, s26
    s_cselect_b32 s13, s31, s27
    s_mov_b32 s10, 6291456
    s_mov_b32 s11, 0x00020000
    s_mov_b32 s14, 2097152
    s_mov_b32 s15, 0x00020000
    v_lshrrev_b32 v28, 4, v1
    v_and_b32 v29, 7, v28
    v_lshrrev_b32 v28, 3, v28
    v_mul_u32_u24 v28, 2048, v28
    v_lshl_add_u32 v28, v29, 4, v28
    s_and_b32 s3, s18, 12
    s_or_b32 s3, s3, 3
    s_lshl_b32 s3, s3, 7
    v_add_u32 v28, s3, v28
    s_lshr_b32 s3, s2, 3
    s_lshl_b32 s3, s3, 2
    s_and_b32 s60, s16, 3
    s_add_u32 s60, s60, s3
    s_lshl_b32 s61, s60, 14
    buffer_load_dwordx4 v[144:147], v28, s[12:15], s61 offen
    s_bitcmp0_b32 s21, 0
    s_cselect_b32 s56, s28, s24
    s_cselect_b32 s57, s29, s25
    s_mov_b32 s58, 6291456
    s_mov_b32 s59, 0x00020000
    v_lshrrev_b32 v28, 4, v1
    v_and_b32 v29, 7, v28
    v_lshrrev_b32 v28, 3, v28
    v_mul_u32_u24 v28, 6144, v28
    v_lshl_add_u32 v28, v29, 4, v28
    s_and_b32 s3, s18, 12
    s_or_b32 s3, s3, 3
    s_lshl_b32 s3, s3, 7
    v_add_u32 v28, s3, v28
    s_lshr_b32 s3, s2, 3
    s_lshl_b32 s3, s3, 2
    s_and_b32 s60, s16, 3
    s_add_u32 s60, s60, s3
    s_and_b32 s3, s60, 31
    s_mul_i32 s3, s3, 49152
    s_lshr_b32 s61, s60, 5
    s_min_u32 s61, s61, 2
    s_lshl_b32 s61, s61, 11
    s_add_u32 s61, s61, s3
    s_cmp_lt_u32 s18, 4
    s_cselect_b32 s3, 1572864, 0
    s_add_u32 s61, s61, s3
    buffer_load_dwordx4 v[148:151], v28, s[56:59], s61 offen
    s_bitcmp1_b32 s21, 0
    s_cbranch_scc1 h_pe
    s_bitcmp0_b32 s21, 0
    s_cselect_b32 s56, s28, s24
    s_cselect_b32 s57, s29, s25
    s_mov_b32 s58, 6291456
    s_mov_b32 s59, 0x00020000
    s_add_u32 s61, s84, 2048
    buffer_load_dwordx4 v[160:163], v11, s[56:59], s61 offen
    s_add_u32 s61, s84, 4096
    buffer_load_dwordx4 v[164:167], v11, s[56:59], s61 offen
    s_add_u32 s61, s84, 0
    buffer_load_dwordx4 v[168:171], v11, s[56:59], s61 offen
    s_add_u32 s61, s84, 198656
    buffer_load_dwordx4 v[172:175], v11, s[56:59], s61 offen
    s_add_u32 s61, s84, 200704
    buffer_load_dwordx4 v[176:179], v11, s[56:59], s61 offen
    s_add_u32 s61, s84, 196608
    buffer_load_dwordx4 v[180:183], v11, s[56:59], s61 offen
h_pe:
    s_barrier
    s_branch s_tail
z_start:
    v_lshrrev_b32 v24, 4, v1
    v_lshrrev_b32 v25, 3, v24
    v_mul_u32_u24 v20, 6144, v25
    v_and_b32 v25, 7, v24
    v_lshl_add_u32 v20, v25, 4, v20
    s_add_u32 s3, s18, 2
    s_and_b32 s3, s3, 15
    s_lshl_b32 s3, s3, 7
    s_add_u32 s3, s3, 4096
    v_add_u32 v22, s3, v20
    s_add_u32 s3, s18, 1
    s_and_b32 s3, s3, 15
    s_lshl_b32 s3, s3, 7
    s_add_u32 s3, s3, 2048
    v_add_u32 v21, s3, v20
    s_add_u32 s3, s18, 0
    s_and_b32 s3, s3, 15
    s_lshl_b32 s3, s3, 7
    s_add_u32 s3, s3, 0
    v_add_u32 v20, s3, v20
    s_waitcnt lgkmcnt(0)
    s_mov_b32 s8, s24
    s_mov_b32 s9, s25
    s_mov_b32 s10, 6291456
    s_mov_b32 s11, 0x00020000
    s_mul_i32 s44, s17, 393216
    buffer_load_dwordx4 v[32:35], v20, s[8:11], s44 offen
    buffer_load_dwordx4 v[64:67], v21, s[8:11], s44 offen
    buffer_load_dwordx4 v[96:99], v22, s[8:11], s44 offen
    s_add_u32 s44, s44, 49152
    buffer_load_dwordx4 v[36:39], v20, s[8:11], s44 offen
    buffer_load_dwordx4 v[68:71], v21, s[8:11], s44 offen
    buffer_load_dwordx4 v[100:103], v22, s[8:11], s44 offen
    s_add_u32 s44, s44, 49152
    buffer_load_dwordx4 v[40:43], v20, s[8:11], s44 offen
    buffer_load_dwordx4 v[72:75], v21, s[8:11], s44 offen
    buffer_load_dwordx4 v[104:107], v22, s[8:11], s44 offen
    s_add_u32 s44, s44, 49152
    buffer_load_dwordx4 v[44:47], v20, s[8:11], s44 offen
    buffer_load_dwordx4 v[76:79], v21, s[8:11], s44 offen
    buffer_load_dwordx4 v[108:111], v22, s[8:11], s44 offen
    s_add_u32 s44, s44, 49152
    buffer_load_dwordx4 v[48:51], v20, s[8:11], s44 offen
    buffer_load_dwordx4 v[80:83], v21, s[8:11], s44 offen
    buffer_load_dwordx4 v[112:115], v22, s[8:11], s44 offen
    s_add_u32 s44, s44, 49152
    buffer_load_dwordx4 v[52:55], v20, s[8:11], s44 offen
    buffer_load_dwordx4 v[84:87], v21, s[8:11], s44 offen
    buffer_load_dwordx4 v[116:119], v22, s[8:11], s44 offen
    s_add_u32 s44, s44, 49152
    buffer_load_dwordx4 v[56:59], v20, s[8:11], s44 offen
    buffer_load_dwordx4 v[88:91], v21, s[8:11], s44 offen
    buffer_load_dwordx4 v[120:123], v22, s[8:11], s44 offen
    s_add_u32 s44, s44, 49152
    buffer_load_dwordx4 v[60:63], v20, s[8:11], s44 offen
    buffer_load_dwordx4 v[92:95], v21, s[8:11], s44 offen
    buffer_load_dwordx4 v[124:127], v22, s[8:11], s44 offen
    v_lshrrev_b32 v24, 4, v1
    v_lshrrev_b32 v25, 3, v24
    v_mul_u32_u24 v12, 6144, v25
    v_and_b32 v26, 2, v25
    v_lshrrev_b32 v25, 2, v25
    v_or_b32 v26, v26, v25
    v_bfe_u32 v25, v24, 1, 2
    v_xor_b32 v26, v26, v25
    v_lshl_add_u32 v12, v26, 5, v12
    v_and_b32 v26, 1, v24
    v_lshl_add_u32 v12, v26, 4, v12
    s_lshl_b32 s3, s18, 7
    v_add_u32 v12, s3, v12
    v_add_u32 v13, 48128, v12
    s_mul_i32 s84, s18, 393216
    s_cmp_lt_u32 s18, 4
    s_cselect_b32 s85, 4, 0
    s_mul_i32 s85, s85, 393216
    s_cmp_lt_u32 s18, 4
    s_cselect_b32 s86, 5, 1
    s_mul_i32 s86, s86, 393216
    s_cmp_lt_u32 s18, 4
    s_cselect_b32 s87, 6, 2
    s_mul_i32 s87, s87, 393216
    s_cmp_lt_u32 s18, 4
    s_cselect_b32 s88, 7, 3
    s_mul_i32 s88, s88, 393216
    s_cmp_lt_u32 s18, 8
    s_cselect_b32 s89, 8, 4
    s_mul_i32 s89, s89, 393216
    s_cmp_lt_u32 s18, 8
    s_cselect_b32 s90, 9, 5
    s_mul_i32 s90, s90, 393216
    s_cmp_lt_u32 s18, 8
    s_cselect_b32 s91, 10, 6
    s_mul_i32 s91, s91, 393216
    s_cmp_lt_u32 s18, 8
    s_cselect_b32 s92, 11, 7
    s_mul_i32 s92, s92, 393216
    s_cmp_lt_u32 s18, 12
    s_cselect_b32 s93, 12, 8
    s_mul_i32 s93, s93, 393216
    s_cmp_lt_u32 s18, 12
    s_cselect_b32 s94, 13, 9
    s_mul_i32 s94, s94, 393216
    s_cmp_lt_u32 s18, 12
    s_cselect_b32 s95, 14, 10
    s_mul_i32 s95, s95, 393216
    s_cmp_lt_u32 s18, 12
    s_cselect_b32 s96, 15, 11
    s_mul_i32 s96, s96, 393216
    s_xor_b32 s97, s18, 1
    s_mul_i32 s97, s97, 393216
    s_xor_b32 s98, s18, 2
    s_mul_i32 s98, s98, 393216
    s_xor_b32 s99, s18, 3
    s_mul_i32 s99, s99, 393216
    v_lshrrev_b32 v24, 4, v1
    v_lshrrev_b32 v25, 3, v24
    v_mul_u32_u24 v16, 2048, v25
    v_and_b32 v26, 2, v25
    v_lshrrev_b32 v25, 2, v25
    v_or_b32 v26, v26, v25
    v_bfe_u32 v25, v24, 1, 2
    v_xor_b32 v26, v26, v25
    v_lshl_add_u32 v16, v26, 5, v16
    v_and_b32 v26, 1, v24
    v_lshl_add_u32 v16, v26, 4, v16
    s_lshl_b32 s3, s18, 7
    v_add_u32 v16, s3, v16
    v_add_u32 v17, 15360, v16
    v_add_u32 v18, 30720, v16
    v_add_u32 v19, 46080, v16
    s_and_b32 s3, s16, 3
    s_mul_i32 s3, s3, 49152
    v_add_u32 v11, s3, v12
    s_and_b32 s3, s16, 3
    s_lshl_b32 s3, s3, 10
    v_add_u32 v9, s3, v1
    v_add_u32 v10, 0x10000, v9
    s_barrier
    v_lshrrev_b32 v24, 4, v1
    v_and_b32 v25, 1, v24
    v_lshlrev_b32 v25, 4, v25
    v_mov_b32 v26, 0x3f80
    v_lshlrev_b32 v25, v25, v26
    v_bfe_u32 v26, v24, 1, 2
    v_cmp_eq_u32 vcc, 0, v26
    s_nop 1
    v_cndmask_b32 v140, 0, v25, vcc
    v_cmp_eq_u32 vcc, 1, v26
    s_nop 1
    v_cndmask_b32 v141, 0, v25, vcc
    v_cmp_eq_u32 vcc, 2, v26
    s_nop 1
    v_cndmask_b32 v142, 0, v25, vcc
    v_cmp_eq_u32 vcc, 3, v26
    s_nop 1
    v_cndmask_b32 v143, 0, v25, vcc
    v_bfe_u32 v25, v24, 3, 1
    v_lshrrev_b32 v26, 5, v24
    v_lshl_add_u32 v26, v26, 1, v25
    v_lshlrev_b32 v25, 8, v26
    v_and_b32 v27, 7, v24
    v_lshl_add_u32 v25, v27, 5, v25
    v_bfe_u32 v27, v24, 4, 1
    v_lshl_add_u32 v25, v27, 4, v25
    v_add_u32 v27, s18, v26
    v_and_b32 v27, 15, v27
    v_lshl_add_u32 v25, v27, 14, v25
    s_lshl_b32 s44, s17, 10
    s_add_u32 s44, s44, 52428800
    s_waitcnt vmcnt(21)
    v_mfma_f32_16x16x32_bf16 v[128:131], v[140:143], v[32:35], 0
    v_mfma_f32_16x16x32_bf16 v[132:135], v[140:143], v[64:67], 0
    v_mfma_f32_16x16x32_bf16 v[136:139], v[140:143], v[96:99], 0
    s_waitcnt vmcnt(18)
    v_mfma_f32_16x16x32_bf16 v[128:131], v[140:143], v[36:39], v[128:131]
    v_mfma_f32_16x16x32_bf16 v[132:135], v[140:143], v[68:71], v[132:135]
    v_mfma_f32_16x16x32_bf16 v[136:139], v[140:143], v[100:103], v[136:139]
    s_waitcnt vmcnt(15)
    v_mfma_f32_16x16x32_bf16 v[128:131], v[140:143], v[40:43], v[128:131]
    v_mfma_f32_16x16x32_bf16 v[132:135], v[140:143], v[72:75], v[132:135]
    v_mfma_f32_16x16x32_bf16 v[136:139], v[140:143], v[104:107], v[136:139]
    s_waitcnt vmcnt(12)
    v_mfma_f32_16x16x32_bf16 v[128:131], v[140:143], v[44:47], v[128:131]
    v_mfma_f32_16x16x32_bf16 v[132:135], v[140:143], v[76:79], v[132:135]
    v_mfma_f32_16x16x32_bf16 v[136:139], v[140:143], v[108:111], v[136:139]
    s_waitcnt vmcnt(9)
    v_mfma_f32_16x16x32_bf16 v[128:131], v[140:143], v[48:51], v[128:131]
    v_mfma_f32_16x16x32_bf16 v[132:135], v[140:143], v[80:83], v[132:135]
    v_mfma_f32_16x16x32_bf16 v[136:139], v[140:143], v[112:115], v[136:139]
    s_waitcnt vmcnt(6)
    v_mfma_f32_16x16x32_bf16 v[128:131], v[140:143], v[52:55], v[128:131]
    v_mfma_f32_16x16x32_bf16 v[132:135], v[140:143], v[84:87], v[132:135]
    v_mfma_f32_16x16x32_bf16 v[136:139], v[140:143], v[116:119], v[136:139]
    s_waitcnt vmcnt(3)
    v_mfma_f32_16x16x32_bf16 v[128:131], v[140:143], v[56:59], v[128:131]
    v_mfma_f32_16x16x32_bf16 v[132:135], v[140:143], v[88:91], v[132:135]
    v_mfma_f32_16x16x32_bf16 v[136:139], v[140:143], v[120:123], v[136:139]
    s_waitcnt vmcnt(0)
    v_mfma_f32_16x16x32_bf16 v[128:131], v[140:143], v[60:63], v[128:131]
    v_mfma_f32_16x16x32_bf16 v[132:135], v[140:143], v[92:95], v[132:135]
    v_mfma_f32_16x16x32_bf16 v[136:139], v[140:143], v[124:127], v[136:139]
    s_barrier
    v_lshrrev_b32 v28, 4, v1
    v_and_b32 v29, 7, v28
    v_lshrrev_b32 v28, 3, v28
    v_mul_u32_u24 v28, 6144, v28
    v_lshl_add_u32 v28, v29, 4, v28
    s_and_b32 s3, s18, 12
    s_or_b32 s3, s3, 3
    s_lshl_b32 s3, s3, 7
    v_add_u32 v28, s3, v28
    s_lshr_b32 s3, s2, 3
    s_lshl_b32 s3, s3, 2
    s_and_b32 s60, s16, 3
    s_add_u32 s60, s60, s3
    s_lshr_b32 s60, s60, 2
    s_mul_i32 s60, s60, 49152
    s_cmp_lt_u32 s18, 4
    s_cselect_b32 s3, 0, 1
    s_mul_i32 s3, s3, 1572864
    s_add_u32 s3, s3, s60
    s_add_u32 s61, s3, 0
    buffer_load_dwordx4 v[160:163], v28, s[8:11], s61 offen
    s_add_u32 s61, s3, 2048
    buffer_load_dwordx4 v[164:167], v28, s[8:11], s61 offen
    s_add_u32 s61, s3, 4096
    buffer_load_dwordx4 v[168:171], v28, s[8:11], s61 offen
    s_add_u32 s3, s60, 3145728
    s_add_u32 s61, s3, 0
    buffer_load_dwordx4 v[172:175], v28, s[8:11], s61 offen
    s_add_u32 s61, s3, 2048
    buffer_load_dwordx4 v[176:179], v28, s[8:11], s61 offen
    s_add_u32 s61, s3, 4096
    buffer_load_dwordx4 v[180:183], v28, s[8:11], s61 offen
    s_add_u32 s3, s60, 4718592
    s_add_u32 s61, s3, 0
    buffer_load_dwordx4 v[184:187], v28, s[8:11], s61 offen
    s_add_u32 s61, s3, 2048
    buffer_load_dwordx4 v[188:191], v28, s[8:11], s61 offen
    s_add_u32 s61, s3, 4096
    buffer_load_dwordx4 v[192:195], v28, s[8:11], s61 offen
    v_add_f32_dpp v128, v128, v128 row_ror:8 row_mask:0xf bank_mask:0xf
    v_add_f32_dpp v129, v129, v129 row_ror:8 row_mask:0xf bank_mask:0xf
    v_add_f32_dpp v130, v130, v130 row_ror:8 row_mask:0xf bank_mask:0xf
    v_add_f32_dpp v131, v131, v131 row_ror:8 row_mask:0xf bank_mask:0xf
    v_add_f32_dpp v132, v132, v132 row_ror:8 row_mask:0xf bank_mask:0xf
    v_add_f32_dpp v133, v133, v133 row_ror:8 row_mask:0xf bank_mask:0xf
    v_add_f32_dpp v134, v134, v134 row_ror:8 row_mask:0xf bank_mask:0xf
    v_add_f32_dpp v135, v135, v135 row_ror:8 row_mask:0xf bank_mask:0xf
    v_add_f32_dpp v136, v136, v136 row_ror:8 row_mask:0xf bank_mask:0xf
    v_add_f32_dpp v137, v137, v137 row_ror:8 row_mask:0xf bank_mask:0xf
    v_add_f32_dpp v138, v138, v138 row_ror:8 row_mask:0xf bank_mask:0xf
    v_add_f32_dpp v139, v139, v139 row_ror:8 row_mask:0xf bank_mask:0xf
    v_cmp_le_u32 vcc, 1, v26
    s_nop 1
    v_cndmask_b32 v128, v128, v132, vcc
    v_cndmask_b32 v129, v129, v133, vcc
    v_cndmask_b32 v130, v130, v134, vcc
    v_cndmask_b32 v131, v131, v135, vcc
    v_cmp_le_u32 vcc, 2, v26
    s_nop 1
    v_cndmask_b32 v128, v128, v136, vcc
    v_cndmask_b32 v129, v129, v137, vcc
    v_cndmask_b32 v130, v130, v138, vcc
    v_cndmask_b32 v131, v131, v139, vcc
    buffer_store_dwordx4 v[128:131], v25, s[4:7], s44 offen sc1
    s_barrier
    s_barrier
    s_waitcnt vmcnt(0)
    s_add_u32 s44, s18, 0
    s_and_b32 s44, s44, 15
    s_lshl_b32 s44, s44, 7
    s_add_u32 s44, s44, 0
    s_atomic_add s40, s[22:23], s44
    s_add_u32 s45, s18, 1
    s_and_b32 s45, s45, 15
    s_lshl_b32 s45, s45, 7
    s_add_u32 s45, s45, 0
    s_atomic_add s40, s[22:23], s45
    s_add_u32 s46, s18, 2
    s_and_b32 s46, s46, 15
    s_lshl_b32 s46, s46, 7
    s_add_u32 s46, s46, 0
    s_atomic_add s40, s[22:23], s46
    s_barrier
    s_barrier
    s_barrier
    s_barrier
    s_barrier
    s_barrier
    s_mov_b32 s12, s26
    s_mov_b32 s13, s27
    s_mov_b32 s14, 2097152
    s_mov_b32 s15, 0x00020000
    s_lshl_b32 s44, s2, 13
    buffer_load_dwordx4 v[160:163], v1, s[12:15], s44 offen offset:0
    buffer_load_dwordx4 v[164:167], v1, s[12:15], s44 offen offset:1024
    buffer_load_dwordx4 v[168:171], v1, s[12:15], s44 offen offset:2048
    buffer_load_dwordx4 v[172:175], v1, s[12:15], s44 offen offset:3072
    s_add_u32 s44, s44, 4096
    buffer_load_dwordx4 v[176:179], v1, s[12:15], s44 offen offset:0
    buffer_load_dwordx4 v[180:183], v1, s[12:15], s44 offen offset:1024
    buffer_load_dwordx4 v[184:187], v1, s[12:15], s44 offen offset:2048
    buffer_load_dwordx4 v[188:191], v1, s[12:15], s44 offen offset:3072
    s_mov_b32 s8, s28
    s_mov_b32 s9, s29
    s_mov_b32 s10, 6291456
    s_mov_b32 s11, 0x00020000
    s_mul_i32 s44, s17, 393216
    buffer_load_dwordx4 v[32:35], v20, s[8:11], s44 offen
    buffer_load_dwordx4 v[64:67], v21, s[8:11], s44 offen
    buffer_load_dwordx4 v[96:99], v22, s[8:11], s44 offen
    s_add_u32 s44, s44, 49152
    buffer_load_dwordx4 v[36:39], v20, s[8:11], s44 offen
    buffer_load_dwordx4 v[68:71], v21, s[8:11], s44 offen
    buffer_load_dwordx4 v[100:103], v22, s[8:11], s44 offen
    s_add_u32 s44, s44, 49152
    buffer_load_dwordx4 v[40:43], v20, s[8:11], s44 offen
    buffer_load_dwordx4 v[72:75], v21, s[8:11], s44 offen
    buffer_load_dwordx4 v[104:107], v22, s[8:11], s44 offen
    s_barrier
    s_add_u32 s44, s44, 49152
    buffer_load_dwordx4 v[44:47], v20, s[8:11], s44 offen
    buffer_load_dwordx4 v[76:79], v21, s[8:11], s44 offen
    buffer_load_dwordx4 v[108:111], v22, s[8:11], s44 offen
    s_add_u32 s44, s44, 49152
    buffer_load_dwordx4 v[48:51], v20, s[8:11], s44 offen
    buffer_load_dwordx4 v[80:83], v21, s[8:11], s44 offen
    buffer_load_dwordx4 v[112:115], v22, s[8:11], s44 offen
    s_add_u32 s44, s44, 49152
    buffer_load_dwordx4 v[52:55], v20, s[8:11], s44 offen
    buffer_load_dwordx4 v[84:87], v21, s[8:11], s44 offen
    buffer_load_dwordx4 v[116:119], v22, s[8:11], s44 offen
    s_add_u32 s44, s44, 49152
    buffer_load_dwordx4 v[56:59], v20, s[8:11], s44 offen
    buffer_load_dwordx4 v[88:91], v21, s[8:11], s44 offen
    buffer_load_dwordx4 v[120:123], v22, s[8:11], s44 offen
    s_add_u32 s44, s44, 49152
    buffer_load_dwordx4 v[60:63], v20, s[8:11], s44 offen
    buffer_load_dwordx4 v[92:95], v21, s[8:11], s44 offen
    buffer_load_dwordx4 v[124:127], v22, s[8:11], s44 offen
    s_bitcmp1_b32 s21, 0
    s_cselect_b32 s8, s28, s24
    s_cselect_b32 s9, s29, s25
    s_cselect_b32 s12, s30, s26
    s_cselect_b32 s13, s31, s27
    s_mov_b32 s10, 6291456
    s_mov_b32 s11, 0x00020000
    s_mov_b32 s14, 2097152
    s_mov_b32 s15, 0x00020000
    v_lshrrev_b32 v28, 4, v1
    v_and_b32 v29, 7, v28
    v_lshrrev_b32 v28, 3, v28
    v_mul_u32_u24 v28, 2048, v28
    v_lshl_add_u32 v28, v29, 4, v28
    s_and_b32 s3, s18, 12
    s_or_b32 s3, s3, 3
    s_lshl_b32 s3, s3, 7
    v_add_u32 v28, s3, v28
    s_lshr_b32 s3, s2, 3
    s_lshl_b32 s3, s3, 2
    s_and_b32 s60, s16, 3
    s_add_u32 s60, s60, s3
    s_lshl_b32 s61, s60, 14
    buffer_load_dwordx4 v[144:147], v28, s[12:15], s61 offen
    s_bitcmp0_b32 s21, 0
    s_cselect_b32 s56, s28, s24
    s_cselect_b32 s57, s29, s25
    s_mov_b32 s58, 6291456
    s_mov_b32 s59, 0x00020000
    v_lshrrev_b32 v28, 4, v1
    v_and_b32 v29, 7, v28
    v_lshrrev_b32 v28, 3, v28
    v_mul_u32_u24 v28, 6144, v28
    v_lshl_add_u32 v28, v29, 4, v28
    s_and_b32 s3, s18, 12
    s_or_b32 s3, s3, 3
    s_lshl_b32 s3, s3, 7
    v_add_u32 v28, s3, v28
    s_lshr_b32 s3, s2, 3
    s_lshl_b32 s3, s3, 2
    s_and_b32 s60, s16, 3
    s_add_u32 s60, s60, s3
    s_and_b32 s3, s60, 31
    s_mul_i32 s3, s3, 49152
    s_lshr_b32 s61, s60, 5
    s_min_u32 s61, s61, 2
    s_lshl_b32 s61, s61, 11
    s_add_u32 s61, s61, s3
    s_cmp_lt_u32 s18, 4
    s_cselect_b32 s3, 1572864, 0
    s_add_u32 s61, s61, s3
    buffer_load_dwordx4 v[148:151], v28, s[56:59], s61 offen
    s_bitcmp1_b32 s21, 0
    s_cbranch_scc1 z0_pe
    s_bitcmp0_b32 s21, 0
    s_cselect_b32 s56, s28, s24
    s_cselect_b32 s57, s29, s25
    s_mov_b32 s58, 6291456
    s_mov_b32 s59, 0x00020000
    s_add_u32 s61, s84, 2048
    buffer_load_dwordx4 v[160:163], v11, s[56:59], s61 offen
    s_add_u32 s61, s84, 4096
    buffer_load_dwordx4 v[164:167], v11, s[56:59], s61 offen
    s_add_u32 s61, s84, 0
    buffer_load_dwordx4 v[168:171], v11, s[56:59], s61 offen
    s_add_u32 s61, s84, 198656
    buffer_load_dwordx4 v[172:175], v11, s[56:59], s61 offen
    s_add_u32 s61, s84, 200704
    buffer_load_dwordx4 v[176:179], v11, s[56:59], s61 offen
    s_add_u32 s61, s84, 196608
    buffer_load_dwordx4 v[180:183], v11, s[56:59], s61 offen
z0_pe:
    s_barrier
    s_bitcmp1_b32 s21, 0
    s_cselect_b32 s8, s28, s24
    s_cselect_b32 s9, s29, s25
    s_cselect_b32 s12, s30, s26
    s_cselect_b32 s13, s31, s27
    s_mov_b32 s10, 6291456
    s_mov_b32 s11, 0x00020000
    s_mov_b32 s14, 2097152
    s_mov_b32 s15, 0x00020000
    s_branch s_tail
z_layer:
    s_waitcnt lgkmcnt(0)
    v_lshrrev_b32 v28, 4, v1
    v_and_b32 v29, 7, v28
    v_lshrrev_b32 v28, 3, v28
    v_mul_u32_u24 v28, 6144, v28
    v_lshl_add_u32 v28, v29, 4, v28
    s_and_b32 s3, s18, 12
    s_or_b32 s3, s3, 3
    s_lshl_b32 s3, s3, 7
    v_add_u32 v28, s3, v28
    s_lshr_b32 s3, s2, 3
    s_lshl_b32 s3, s3, 2
    s_and_b32 s60, s16, 3
    s_add_u32 s60, s60, s3
    s_lshr_b32 s60, s60, 2
    s_mul_i32 s60, s60, 49152
    s_cmp_lt_u32 s18, 4
    s_cselect_b32 s3, 0, 1
    s_mul_i32 s3, s3, 1572864
    s_add_u32 s3, s3, s60
    s_add_u32 s61, s3, 0
    buffer_load_dwordx4 v[160:163], v28, s[8:11], s61 offen
    s_add_u32 s61, s3, 2048
    buffer_load_dwordx4 v[164:167], v28, s[8:11], s61 offen
    s_add_u32 s61, s3, 4096
    buffer_load_dwordx4 v[168:171], v28, s[8:11], s61 offen
    s_add_u32 s3, s60, 3145728
    s_add_u32 s61, s3, 0
    buffer_load_dwordx4 v[172:175], v28, s[8:11], s61 offen
    s_add_u32 s61, s3, 2048
    buffer_load_dwordx4 v[176:179], v28, s[8:11], s61 offen
    s_add_u32 s61, s3, 4096
    buffer_load_dwordx4 v[180:183], v28, s[8:11], s61 offen
    s_add_u32 s3, s60, 4718592
    s_add_u32 s61, s3, 0
    buffer_load_dwordx4 v[184:187], v28, s[8:11], s61 offen
    s_add_u32 s61, s3, 2048
    buffer_load_dwordx4 v[188:191], v28, s[8:11], s61 offen
    s_add_u32 s61, s3, 4096
    buffer_load_dwordx4 v[192:195], v28, s[8:11], s61 offen
    s_barrier
    s_barrier
    s_barrier
    s_barrier
    s_barrier
    s_barrier
    s_barrier
    s_barrier
    s_barrier
    s_barrier
    v_lshrrev_b32 v28, 4, v1
    v_and_b32 v29, 7, v28
    v_lshrrev_b32 v28, 3, v28
    v_mul_u32_u24 v28, 2048, v28
    v_lshl_add_u32 v28, v29, 4, v28
    s_and_b32 s3, s18, 12
    s_or_b32 s3, s3, 3
    s_lshl_b32 s3, s3, 7
    v_add_u32 v28, s3, v28
    s_lshr_b32 s3, s2, 3
    s_lshl_b32 s3, s3, 2
    s_and_b32 s60, s16, 3
    s_add_u32 s60, s60, s3
    s_lshl_b32 s61, s60, 14
    buffer_load_dwordx4 v[144:147], v28, s[12:15], s61 offen
    s_bitcmp0_b32 s21, 0
    s_cselect_b32 s56, s28, s24
    s_cselect_b32 s57, s29, s25
    s_mov_b32 s58, 6291456
    s_mov_b32 s59, 0x00020000
    v_lshrrev_b32 v28, 4, v1
    v_and_b32 v29, 7, v28
    v_lshrrev_b32 v28, 3, v28
    v_mul_u32_u24 v28, 6144, v28
    v_lshl_add_u32 v28, v29, 4, v28
    s_and_b32 s3, s18, 12
    s_or_b32 s3, s3, 3
    s_lshl_b32 s3, s3, 7
    v_add_u32 v28, s3, v28
    s_lshr_b32 s3, s2, 3
    s_lshl_b32 s3, s3, 2
    s_and_b32 s60, s16, 3
    s_add_u32 s60, s60, s3
    s_and_b32 s3, s60, 31
    s_mul_i32 s3, s3, 49152
    s_lshr_b32 s61, s60, 5
    s_min_u32 s61, s61, 2
    s_lshl_b32 s61, s61, 11
    s_add_u32 s61, s61, s3
    s_cmp_lt_u32 s18, 4
    s_cselect_b32 s3, 1572864, 0
    s_add_u32 s61, s61, s3
    buffer_load_dwordx4 v[148:151], v28, s[56:59], s61 offen
    s_bitcmp1_b32 s21, 0
    s_cbranch_scc1 z_pe
    s_bitcmp0_b32 s21, 0
    s_cselect_b32 s56, s28, s24
    s_cselect_b32 s57, s29, s25
    s_mov_b32 s58, 6291456
    s_mov_b32 s59, 0x00020000
    s_add_u32 s61, s84, 2048
    buffer_load_dwordx4 v[160:163], v11, s[56:59], s61 offen
    s_add_u32 s61, s84, 4096
    buffer_load_dwordx4 v[164:167], v11, s[56:59], s61 offen
    s_add_u32 s61, s84, 0
    buffer_load_dwordx4 v[168:171], v11, s[56:59], s61 offen
    s_add_u32 s61, s84, 198656
    buffer_load_dwordx4 v[172:175], v11, s[56:59], s61 offen
    s_add_u32 s61, s84, 200704
    buffer_load_dwordx4 v[176:179], v11, s[56:59], s61 offen
    s_add_u32 s61, s84, 196608
    buffer_load_dwordx4 v[180:183], v11, s[56:59], s61 offen
z_pe:
    s_barrier
    s_branch s_tail
s_tail:
    s_bitcmp1_b32 s21, 0
    s_cbranch_scc1 s_B
    s_cmp_lg_u32 s16, 4
    s_cbranch_scc1 s_a1
    s_mov_b32 s45, 2146435072
    s_cmp_eq_u32 s17, 0
    s_cbranch_scc1 s_a0
    s_lshr_b32 s46, s21, 1
    s_lshl_b32 s44, s46, 15
    s_lshl_b32 s67, s17, 11
    s_add_u32 s44, s44, s67
    s_lshl_b32 s67, s18, 7
    s_add_u32 s44, s44, s67
    s_add_u32 s44, s44, 149504
    s_sub_u32 s45, s44, 151552
    s_lshl_b32 s45, s45, 5
    s_add_u32 s45, s45, 54525952
    s_mov_b32 s66, 0x10000
s_h_poll:
    s_mov_b32 s68, 0
    s_atomic_add s68, s[22:23], s44 offset:0 glc
    s_sub_u32 s66, s66, 1
    s_cselect_b32 s67, 1, 0
    s_waitcnt lgkmcnt(0)
    s_max_u32 s68, s68, s67
    s_cmp_lt_u32 s68, 1
    s_cbranch_scc1 s_h_poll
s_h_ok:
s_a0:
    s_mov_b32 m0, 131072
    s_nop 0
    buffer_load_dwordx4 v1, s[4:7], s45 offen offset:0 sc1 lds
    buffer_load_dwordx4 v1, s[4:7], s45 offen offset:1024 sc1 lds
    buffer_load_dwordx4 v1, s[4:7], s45 offen offset:2048 sc1 lds
    buffer_load_dwordx4 v1, s[4:7], s45 offen offset:3072 sc1 lds
    s_waitcnt vmcnt(0)
s_a1:
    s_barrier
    s_waitcnt vmcnt(0)
    s_barrier
    s_sub_u32 s3, s16, 5
    s_cmp_gt_u32 s3, 1
    s_cbranch_scc1 s_a2
    s_add_u32 m0, s41, 65536
    s_xor_b32 s44, s62, 65536
    buffer_load_dwordx4 v16, s[12:15], s44 offen offset:0 lds
    buffer_load_dwordx4 v17, s[12:15], s44 offen offset:1024 lds
    s_add_u32 m0, s41, 69632
    s_xor_b32 s44, s62, 196608
    buffer_load_dwordx4 v16, s[12:15], s44 offen offset:0 lds
    buffer_load_dwordx4 v17, s[12:15], s44 offen offset:1024 lds
    s_add_u32 m0, s41, 73728
    s_xor_b32 s44, s62, 327680
    buffer_load_dwordx4 v16, s[12:15], s44 offen offset:0 lds
    buffer_load_dwordx4 v17, s[12:15], s44 offen offset:1024 lds
    s_add_u32 m0, s41, 77824
    s_xor_b32 s44, s62, 458752
    buffer_load_dwordx4 v16, s[12:15], s44 offen offset:0 lds
    buffer_load_dwordx4 v17, s[12:15], s44 offen offset:1024 lds
    s_add_u32 m0, s41, 81920
    s_xor_b32 s44, s62, 589824
    buffer_load_dwordx4 v16, s[12:15], s44 offen offset:0 lds
    buffer_load_dwordx4 v17, s[12:15], s44 offen offset:1024 lds
    s_add_u32 m0, s41, 86016
    s_xor_b32 s44, s62, 720896
    buffer_load_dwordx4 v16, s[12:15], s44 offen offset:0 lds
    buffer_load_dwordx4 v17, s[12:15], s44 offen offset:1024 lds
    s_add_u32 m0, s41, 90112
    s_xor_b32 s44, s62, 851968
    buffer_load_dwordx4 v16, s[12:15], s44 offen offset:0 lds
    buffer_load_dwordx4 v17, s[12:15], s44 offen offset:1024 lds
    s_add_u32 m0, s41, 94208
    s_xor_b32 s44, s62, 983040
    buffer_load_dwordx4 v16, s[12:15], s44 offen offset:0 lds
    buffer_load_dwordx4 v17, s[12:15], s44 offen offset:1024 lds
    s_add_u32 m0, s41, 98304
    s_xor_b32 s44, s62, 1114112
    buffer_load_dwordx4 v16, s[12:15], s44 offen offset:0 lds
    buffer_load_dwordx4 v17, s[12:15], s44 offen offset:1024 lds
    s_add_u32 m0, s41, 102400
    s_xor_b32 s44, s62, 1245184
    buffer_load_dwordx4 v16, s[12:15], s44 offen offset:0 lds
    buffer_load_dwordx4 v17, s[12:15], s44 offen offset:1024 lds
    s_add_u32 m0, s41, 106496
    s_xor_b32 s44, s62, 1376256
    buffer_load_dwordx4 v16, s[12:15], s44 offen offset:0 lds
    buffer_load_dwordx4 v17, s[12:15], s44 offen offset:1024 lds
    s_add_u32 m0, s41, 110592
    s_xor_b32 s44, s62, 1507328
    buffer_load_dwordx4 v16, s[12:15], s44 offen offset:0 lds
    buffer_load_dwordx4 v17, s[12:15], s44 offen offset:1024 lds
    s_add_u32 m0, s41, 114688
    s_xor_b32 s44, s62, 1638400
    buffer_load_dwordx4 v16, s[12:15], s44 offen offset:0 lds
    buffer_load_dwordx4 v17, s[12:15], s44 offen offset:1024 lds
    s_add_u32 m0, s41, 118784
    s_xor_b32 s44, s62, 1769472
    buffer_load_dwordx4 v16, s[12:15], s44 offen offset:0 lds
    buffer_load_dwordx4 v17, s[12:15], s44 offen offset:1024 lds
    s_add_u32 m0, s41, 122880
    s_xor_b32 s44, s62, 1900544
    buffer_load_dwordx4 v16, s[12:15], s44 offen offset:0 lds
    buffer_load_dwordx4 v17, s[12:15], s44 offen offset:1024 lds
    s_add_u32 m0, s41, 126976
    s_xor_b32 s44, s62, 2031616
    buffer_load_dwordx4 v16, s[12:15], s44 offen offset:0 lds
    buffer_load_dwordx4 v17, s[12:15], s44 offen offset:1024 lds
s_a2:
    s_bitcmp0_b32 s21, 0
    s_cselect_b32 s56, s28, s24
    s_cselect_b32 s57, s29, s25
    s_mov_b32 s58, 6291456
    s_mov_b32 s59, 0x00020000
    s_add_u32 s61, s85, 2048
    buffer_load_dwordx4 v[184:187], v11, s[56:59], s61 offen
    s_add_u32 s61, s85, 4096
    buffer_load_dwordx4 v[188:191], v11, s[56:59], s61 offen
    s_add_u32 s61, s85, 0
    buffer_load_dwordx4 v[192:195], v11, s[56:59], s61 offen
    s_add_u32 s61, s85, 198656
    buffer_load_dwordx4 v[196:199], v11, s[56:59], s61 offen
    s_add_u32 s61, s85, 200704
    buffer_load_dwordx4 v[200:203], v11, s[56:59], s61 offen
    s_add_u32 s61, s85, 196608
    buffer_load_dwordx4 v[204:207], v11, s[56:59], s61 offen
    s_add_u32 s61, s86, 2048
    buffer_load_dwordx4 v[208:211], v11, s[56:59], s61 offen
    s_add_u32 s61, s86, 4096
    buffer_load_dwordx4 v[212:215], v11, s[56:59], s61 offen
    s_add_u32 s61, s86, 0
    buffer_load_dwordx4 v[216:219], v11, s[56:59], s61 offen
    s_add_u32 s61, s86, 198656
    buffer_load_dwordx4 v[220:223], v11, s[56:59], s61 offen
    s_waitcnt vmcnt(0)
    s_lshl_b32 s3, s21, 3
    s_add_u32 s3, s3, s16
    s_cmp_lg_u32 s3, 7
    s_cbranch_scc1 s_g3
    v_lshrrev_b32 v24, 4, v1
    v_and_b32 v25, 1, v24
    v_lshlrev_b32 v25, 4, v25
    v_mov_b32 v26, 0x3f80
    v_lshlrev_b32 v25, v25, v26
    v_bfe_u32 v26, v24, 1, 2
    v_cmp_eq_u32 vcc, 0, v26
    s_nop 1
    v_cndmask_b32 v140, 0, v25, vcc
    v_cmp_eq_u32 vcc, 1, v26
    s_nop 1
    v_cndmask_b32 v141, 0, v25, vcc
    v_cmp_eq_u32 vcc, 2, v26
    s_nop 1
    v_cndmask_b32 v142, 0, v25, vcc
    v_cmp_eq_u32 vcc, 3, v26
    s_nop 1
    v_cndmask_b32 v143, 0, v25, vcc
    v_bfe_u32 v25, v24, 3, 1
    v_lshrrev_b32 v26, 5, v24
    v_lshl_add_u32 v26, v26, 1, v25
    v_lshlrev_b32 v25, 8, v26
    v_and_b32 v27, 7, v24
    v_lshl_add_u32 v25, v27, 5, v25
    v_bfe_u32 v27, v24, 4, 1
    v_lshl_add_u32 v25, v27, 4, v25
    v_add_u32 v27, s18, v26
    v_and_b32 v27, 15, v27
    v_lshl_add_u32 v25, v27, 14, v25
    s_lshl_b32 s44, s17, 10
    s_add_u32 s44, s44, 52690944
    v_mfma_f32_16x16x32_bf16 v[128:131], v[140:143], v[32:35], 0
    v_mfma_f32_16x16x32_bf16 v[132:135], v[140:143], v[64:67], 0
    v_mfma_f32_16x16x32_bf16 v[136:139], v[140:143], v[96:99], 0
    v_mfma_f32_16x16x32_bf16 v[128:131], v[140:143], v[36:39], v[128:131]
    v_mfma_f32_16x16x32_bf16 v[132:135], v[140:143], v[68:71], v[132:135]
    v_mfma_f32_16x16x32_bf16 v[136:139], v[140:143], v[100:103], v[136:139]
    v_mfma_f32_16x16x32_bf16 v[128:131], v[140:143], v[40:43], v[128:131]
    v_mfma_f32_16x16x32_bf16 v[132:135], v[140:143], v[72:75], v[132:135]
    v_mfma_f32_16x16x32_bf16 v[136:139], v[140:143], v[104:107], v[136:139]
    v_mfma_f32_16x16x32_bf16 v[128:131], v[140:143], v[44:47], v[128:131]
    v_mfma_f32_16x16x32_bf16 v[132:135], v[140:143], v[76:79], v[132:135]
    v_mfma_f32_16x16x32_bf16 v[136:139], v[140:143], v[108:111], v[136:139]
    v_mfma_f32_16x16x32_bf16 v[128:131], v[140:143], v[48:51], v[128:131]
    v_mfma_f32_16x16x32_bf16 v[132:135], v[140:143], v[80:83], v[132:135]
    v_mfma_f32_16x16x32_bf16 v[136:139], v[140:143], v[112:115], v[136:139]
    v_mfma_f32_16x16x32_bf16 v[128:131], v[140:143], v[52:55], v[128:131]
    v_mfma_f32_16x16x32_bf16 v[132:135], v[140:143], v[84:87], v[132:135]
    v_mfma_f32_16x16x32_bf16 v[136:139], v[140:143], v[116:119], v[136:139]
    v_mfma_f32_16x16x32_bf16 v[128:131], v[140:143], v[56:59], v[128:131]
    v_mfma_f32_16x16x32_bf16 v[132:135], v[140:143], v[88:91], v[132:135]
    v_mfma_f32_16x16x32_bf16 v[136:139], v[140:143], v[120:123], v[136:139]
    v_mfma_f32_16x16x32_bf16 v[128:131], v[140:143], v[60:63], v[128:131]
    v_mfma_f32_16x16x32_bf16 v[132:135], v[140:143], v[92:95], v[132:135]
    v_mfma_f32_16x16x32_bf16 v[136:139], v[140:143], v[124:127], v[136:139]
    s_nop 5
    v_add_f32_dpp v128, v128, v128 row_ror:8 row_mask:0xf bank_mask:0xf
    v_add_f32_dpp v129, v129, v129 row_ror:8 row_mask:0xf bank_mask:0xf
    v_add_f32_dpp v130, v130, v130 row_ror:8 row_mask:0xf bank_mask:0xf
    v_add_f32_dpp v131, v131, v131 row_ror:8 row_mask:0xf bank_mask:0xf
    v_add_f32_dpp v132, v132, v132 row_ror:8 row_mask:0xf bank_mask:0xf
    v_add_f32_dpp v133, v133, v133 row_ror:8 row_mask:0xf bank_mask:0xf
    v_add_f32_dpp v134, v134, v134 row_ror:8 row_mask:0xf bank_mask:0xf
    v_add_f32_dpp v135, v135, v135 row_ror:8 row_mask:0xf bank_mask:0xf
    v_add_f32_dpp v136, v136, v136 row_ror:8 row_mask:0xf bank_mask:0xf
    v_add_f32_dpp v137, v137, v137 row_ror:8 row_mask:0xf bank_mask:0xf
    v_add_f32_dpp v138, v138, v138 row_ror:8 row_mask:0xf bank_mask:0xf
    v_add_f32_dpp v139, v139, v139 row_ror:8 row_mask:0xf bank_mask:0xf
    v_cmp_le_u32 vcc, 1, v26
    s_nop 1
    v_cndmask_b32 v128, v128, v132, vcc
    v_cndmask_b32 v129, v129, v133, vcc
    v_cndmask_b32 v130, v130, v134, vcc
    v_cndmask_b32 v131, v131, v135, vcc
    v_cmp_le_u32 vcc, 2, v26
    s_nop 1
    v_cndmask_b32 v128, v128, v136, vcc
    v_cndmask_b32 v129, v129, v137, vcc
    v_cndmask_b32 v130, v130, v138, vcc
    v_cndmask_b32 v131, v131, v139, vcc
    buffer_store_dwordx4 v[128:131], v25, s[4:7], s44 offen sc1
    s_waitcnt vmcnt(0)
    s_add_u32 s44, s18, 0
    s_and_b32 s44, s44, 15
    s_lshl_b32 s44, s44, 7
    s_add_u32 s44, s44, 2048
    s_atomic_add s40, s[22:23], s44
    s_add_u32 s45, s18, 1
    s_and_b32 s45, s45, 15
    s_lshl_b32 s45, s45, 7
    s_add_u32 s45, s45, 2048
    s_atomic_add s40, s[22:23], s45
    s_add_u32 s46, s18, 2
    s_and_b32 s46, s46, 15
    s_lshl_b32 s46, s46, 7
    s_add_u32 s46, s46, 2048
    s_atomic_add s40, s[22:23], s46
    s_branch s_g3
s_B:
    s_lshr_b32 s49, s21, 1
    s_lshl_b32 s53, s49, 23
    s_lshl_b32 s50, s18, 18
    s_add_u32 s53, s53, s50
    s_add_u32 s53, s53, 33554432
    s_lshl_b32 s54, s38, 11
    s_add_u32 s55, s53, s54
    s_add_u32 s56, s55, 4194304
    s_lshl_b32 s59, s49, 13
    s_lshl_b32 s67, s18, 9
    s_add_u32 s59, s59, s67
    s_lshl_b32 s67, s16, 7
    s_add_u32 s59, s59, s67
    s_add_u32 s59, s59, 69120
    v_add_u32 v4, 131072, v1
    s_mov_b32 s68, 0
    s_mov_b32 s39, 0
    s_barrier
    buffer_load_dwordx4 v[64:67], v1, s[4:7], s55 offen offset:0 sc1
    buffer_load_dwordx4 v[68:71], v1, s[4:7], s55 offen offset:1024 sc1
    buffer_load_dwordx4 v[72:75], v1, s[4:7], s56 offen offset:0 sc1
    buffer_load_dwordx4 v[76:79], v1, s[4:7], s56 offen offset:1024 sc1
    s_atomic_add s68, s[22:23], s59 glc
    s_setprio 3
    s_branch b_att
s_att_done:
    s_waitcnt lgkmcnt(0)
    v_lshrrev_b32 v24, 4, v1
    v_lshrrev_b32 v25, 3, v24
    v_mul_u32_u24 v12, 6144, v25
    v_and_b32 v26, 2, v25
    v_lshrrev_b32 v25, 2, v25
    v_or_b32 v26, v26, v25
    v_bfe_u32 v25, v24, 1, 2
    v_xor_b32 v26, v26, v25
    v_lshl_add_u32 v12, v26, 5, v12
    v_and_b32 v26, 1, v24
    v_lshl_add_u32 v12, v26, 4, v12
    s_lshl_b32 s3, s18, 7
    v_add_u32 v12, s3, v12
    v_add_u32 v13, 48128, v12
    v_add_u32 v14, s42, v12
    v_add_u32 v15, s42, v13
    v_lshrrev_b32 v24, 4, v1
    v_lshrrev_b32 v25, 3, v24
    v_mul_u32_u24 v16, 2048, v25
    v_and_b32 v26, 2, v25
    v_lshrrev_b32 v25, 2, v25
    v_or_b32 v26, v26, v25
    v_bfe_u32 v25, v24, 1, 2
    v_xor_b32 v26, v26, v25
    v_lshl_add_u32 v16, v26, 5, v16
    v_and_b32 v26, 1, v24
    v_lshl_add_u32 v16, v26, 4, v16
    s_lshl_b32 s3, s18, 7
    v_add_u32 v16, s3, v16
    v_add_u32 v17, 15360, v16
    v_add_u32 v18, 30720, v16
    v_add_u32 v19, 46080, v16
    s_and_b32 s3, s16, 3
    s_mul_i32 s3, s3, 49152
    v_add_u32 v11, s3, v12
    s_and_b32 s3, s16, 3
    s_lshl_b32 s3, s3, 10
    v_add_u32 v9, s3, v1
    v_add_u32 v10, 0x10000, v9
    s_cmp_eq_u32 s21, 3
    s_cbranch_scc1 s_nopf
    s_lshl_b32 s3, s2, 2
    s_and_b32 s60, s16, 3
    s_add_u32 s60, s60, s3
    s_lshl_b32 s60, s60, 11
    buffer_load_dwordx4 v[96:99], v1, s[12:15], s60 offen offset:0
    buffer_load_dwordx4 v[100:103], v1, s[12:15], s60 offen offset:1024
    s_bitcmp0_b32 s21, 0
    s_cselect_b32 s56, s28, s24
    s_cselect_b32 s57, s29, s25
    s_mov_b32 s58, 6291456
    s_mov_b32 s59, 0x00020000
    s_add_u32 s61, s84, 2048
    buffer_load_dwordx4 v[160:163], v11, s[56:59], s61 offen
    s_add_u32 s61, s84, 4096
    buffer_load_dwordx4 v[164:167], v11, s[56:59], s61 offen
    s_add_u32 s61, s84, 0
    buffer_load_dwordx4 v[168:171], v11, s[56:59], s61 offen
    s_add_u32 s61, s84, 198656
    buffer_load_dwordx4 v[172:175], v11, s[56:59], s61 offen
    s_waitcnt vmcnt(4)
s_nopf:
    s_setprio 3
    s_mov_b32 s52, 0
    s_lshl_b32 s44, s16, 14
    v_add_u32 v24, s44, v1
    s_and_b32 s3, s16, 3
    s_lshl_b32 s44, s3, 10
    s_add_u32 s44, s44, 147456
    v_lshrrev_b32 v25, 2, v1
    v_add_u32 v25, s44, v25
    s_lshl_b32 s53, s21, 22
    s_lshl_b32 s44, s38, 16
    s_add_u32 s53, s53, s44
    s_lshl_b32 s44, s18, 12
    s_add_u32 s53, s53, s44
    s_add_u32 s53, s53, 16777216
    s_lshl_b32 s54, s21, 14
    s_lshl_b32 s67, s38, 8
    s_add_u32 s54, s54, s67
    s_add_u32 s54, s54, 86016
s_bhead:
    s_barrier
    ds_read_b32 v28, v25 offset:0
    ds_read_b32 v29, v25 offset:256
    ds_read_b32 v30, v25 offset:512
    ds_read_b32 v31, v25 offset:768
    ds_read_b128 v[32:35], v24 offset:0
    ds_read_b128 v[36:39], v24 offset:1024
    ds_read_b128 v[40:43], v24 offset:2048
    ds_read_b128 v[44:47], v24 offset:3072
    ds_read_b128 v[48:51], v24 offset:4096
    ds_read_b128 v[52:55], v24 offset:5120
    ds_read_b128 v[56:59], v24 offset:6144
    ds_read_b128 v[60:63], v24 offset:7168
    ds_read_b128 v[64:67], v24 offset:8192
    ds_read_b128 v[68:71], v24 offset:9216
    ds_read_b128 v[72:75], v24 offset:10240
    ds_read_b128 v[76:79], v24 offset:11264
    ds_read_b128 v[80:83], v24 offset:12288
    ds_read_b128 v[84:87], v24 offset:13312
    ds_read_b128 v[88:91], v24 offset:14336
    ds_read_b128 v[92:95], v24 offset:15360
    s_waitcnt lgkmcnt(14)
    v_add_f32 v28, v28, v29
    v_add_f32 v30, v30, v31
    v_add_f32 v28, v28, v30
    v_mov_b32 v29, 0x5d800000
    v_mov_b32 v30, 0x21800000
    v_cmp_nlt_f32 s[44:45], v28, v29
    v_cmp_ngt_f32 vcc, v28, v30
    v_rcp_f32 v28, v28
    s_or_b64 vcc, vcc, s[44:45]
    s_waitcnt lgkmcnt(8)
    v_pk_add_f32 v[32:33], v[32:33], v[48:49]
    v_pk_add_f32 v[34:35], v[34:35], v[50:51]
    v_pk_add_f32 v[36:37], v[36:37], v[52:53]
    v_pk_add_f32 v[38:39], v[38:39], v[54:55]
    v_pk_add_f32 v[40:41], v[40:41], v[56:57]
    v_pk_add_f32 v[42:43], v[42:43], v[58:59]
    v_pk_add_f32 v[44:45], v[44:45], v[60:61]
    v_pk_add_f32 v[46:47], v[46:47], v[62:63]
    s_waitcnt lgkmcnt(4)
    v_pk_add_f32 v[32:33], v[32:33], v[64:65]
    v_pk_add_f32 v[34:35], v[34:35], v[66:67]
    v_pk_add_f32 v[36:37], v[36:37], v[68:69]
    v_pk_add_f32 v[38:39], v[38:39], v[70:71]
    v_pk_add_f32 v[40:41], v[40:41], v[72:73]
    v_pk_add_f32 v[42:43], v[42:43], v[74:75]
    v_pk_add_f32 v[44:45], v[44:45], v[76:77]
    v_pk_add_f32 v[46:47], v[46:47], v[78:79]
    s_waitcnt lgkmcnt(0)
    v_pk_add_f32 v[32:33], v[32:33], v[80:81]
    v_pk_add_f32 v[34:35], v[34:35], v[82:83]
    v_pk_add_f32 v[36:37], v[36:37], v[84:85]
    v_pk_add_f32 v[38:39], v[38:39], v[86:87]
    v_pk_add_f32 v[40:41], v[40:41], v[88:89]
    v_pk_add_f32 v[42:43], v[42:43], v[90:91]
    v_pk_add_f32 v[44:45], v[44:45], v[92:93]
    v_pk_add_f32 v[46:47], v[46:47], v[94:95]
    s_cbranch_vccnz s_slow
s_fin:
    v_pk_mul_f32 v[32:33], v[28:29], v[32:33] op_sel_hi:[0,1]
    v_pk_mul_f32 v[34:35], v[28:29], v[34:35] op_sel_hi:[0,1]
    v_pk_mul_f32 v[36:37], v[28:29], v[36:37] op_sel_hi:[0,1]
    v_pk_mul_f32 v[38:39], v[28:29], v[38:39] op_sel_hi:[0,1]
    v_pk_mul_f32 v[40:41], v[28:29], v[40:41] op_sel_hi:[0,1]
    v_pk_mul_f32 v[42:43], v[28:29], v[42:43] op_sel_hi:[0,1]
    v_pk_mul_f32 v[44:45], v[28:29], v[44:45] op_sel_hi:[0,1]
    v_pk_mul_f32 v[46:47], v[28:29], v[46:47] op_sel_hi:[0,1]
    v_cvt_pk_bf16_f32 v32, v32, v33
    v_cvt_pk_bf16_f32 v33, v34, v35
    v_cvt_pk_bf16_f32 v34, v36, v37
    v_cvt_pk_bf16_f32 v35, v38, v39
    v_cvt_pk_bf16_f32 v36, v40, v41
    v_cvt_pk_bf16_f32 v37, v42, v43
    v_cvt_pk_bf16_f32 v38, v44, v45
    v_cvt_pk_bf16_f32 v39, v46, v47
    buffer_store_dwordx4 v[32:35], v1, s[4:7], s53 offen offset:0 sc1
    buffer_store_dwordx4 v[36:39], v1, s[4:7], s53 offen offset:1024 sc1
    s_cmp_lg_u32 s52, 0
    s_cbranch_scc1 s_b2
    s_waitcnt vmcnt(0)
    s_atomic_add s40, s[22:23], s54
    s_mov_b32 s52, 1
    s_add_u32 s53, s53, 2048
    s_waitcnt lgkmcnt(0)
    s_add_u32 s54, s54, 128
    s_setprio 0
    s_cmp_eq_u32 s21, 3
    s_cbranch_scc1 s_nopf2
    s_bitcmp0_b32 s21, 0
    s_cselect_b32 s56, s28, s24
    s_cselect_b32 s57, s29, s25
    s_mov_b32 s58, 6291456
    s_mov_b32 s59, 0x00020000
    s_add_u32 s61, s84, 200704
    buffer_load_dwordx4 v[176:179], v11, s[56:59], s61 offen
    s_add_u32 s61, s84, 196608
    buffer_load_dwordx4 v[180:183], v11, s[56:59], s61 offen
    s_add_u32 s61, s85, 2048
    buffer_load_dwordx4 v[184:187], v11, s[56:59], s61 offen
    s_add_u32 s61, s85, 4096
    buffer_load_dwordx4 v[188:191], v11, s[56:59], s61 offen
    s_waitcnt vmcnt(4)
s_nopf2:
    s_barrier
    s_cmp_eq_u32 s21, 3
    s_cbranch_scc1 s_nopf3
    s_bitcmp0_b32 s21, 0
    s_cselect_b32 s56, s28, s24
    s_cselect_b32 s57, s29, s25
    s_mov_b32 s58, 6291456
    s_mov_b32 s59, 0x00020000
    s_add_u32 s61, s85, 0
    buffer_load_dwordx4 v[192:195], v11, s[56:59], s61 offen
    s_add_u32 s61, s85, 198656
    buffer_load_dwordx4 v[196:199], v11, s[56:59], s61 offen
    s_add_u32 s61, s85, 200704
    buffer_load_dwordx4 v[200:203], v11, s[56:59], s61 offen
    s_add_u32 s61, s85, 196608
    buffer_load_dwordx4 v[204:207], v11, s[56:59], s61 offen
    s_waitcnt vmcnt(4)
    s_add_u32 s61, s86, 2048
    buffer_load_dwordx4 v[208:211], v11, s[56:59], s61 offen
    s_add_u32 s61, s86, 4096
    buffer_load_dwordx4 v[212:215], v11, s[56:59], s61 offen
    s_add_u32 s61, s86, 0
    buffer_load_dwordx4 v[216:219], v11, s[56:59], s61 offen
    s_add_u32 s61, s86, 198656
    buffer_load_dwordx4 v[220:223], v11, s[56:59], s61 offen
    s_waitcnt vmcnt(4)
s_nopf3:
    s_and_b32 s3, s16, 3
    s_lshl_b32 s46, s3, 19
    s_lshl_b32 s45, s3, 14
    s_and_b32 s3, s18, 0
    s_lshl_b32 s3, s3, 17
    s_xor_b32 s46, s46, s3
    s_add_u32 m0, s45, 0
    s_xor_b32 s44, s46, 0
    buffer_load_dwordx4 v16, s[12:15], s44 offen offset:0 lds
    buffer_load_dwordx4 v17, s[12:15], s44 offen offset:1024 lds
    buffer_load_dwordx4 v18, s[12:15], s44 offen offset:2048 lds
    buffer_load_dwordx4 v19, s[12:15], s44 offen offset:3072 lds
    s_add_u32 s44, s44, 65536
    s_waitcnt vmcnt(3)
    buffer_load_dwordx4 v[96:99], v16, s[12:15], s44 offen offset:0
    buffer_load_dwordx4 v[100:103], v17, s[12:15], s44 offen offset:1024
    buffer_load_dwordx4 v[104:107], v18, s[12:15], s44 offen offset:2048
    buffer_load_dwordx4 v[108:111], v19, s[12:15], s44 offen offset:3072
    s_waitcnt vmcnt(3)
    s_add_u32 m0, s45, 4096
    s_xor_b32 s44, s46, 131072
    buffer_load_dwordx4 v16, s[12:15], s44 offen offset:0 lds
    buffer_load_dwordx4 v17, s[12:15], s44 offen offset:1024 lds
    buffer_load_dwordx4 v18, s[12:15], s44 offen offset:2048 lds
    buffer_load_dwordx4 v19, s[12:15], s44 offen offset:3072 lds
    s_add_u32 s44, s44, 65536
    s_waitcnt vmcnt(3)
    buffer_load_dwordx4 v[112:115], v16, s[12:15], s44 offen offset:0
    buffer_load_dwordx4 v[116:119], v17, s[12:15], s44 offen offset:1024
    buffer_load_dwordx4 v[120:123], v18, s[12:15], s44 offen offset:2048
    buffer_load_dwordx4 v[124:127], v19, s[12:15], s44 offen offset:3072
    s_waitcnt vmcnt(3)
    s_add_u32 m0, s45, 8192
    s_xor_b32 s44, s46, 262144
    buffer_load_dwordx4 v16, s[12:15], s44 offen offset:0 lds
    buffer_load_dwordx4 v17, s[12:15], s44 offen offset:1024 lds
    buffer_load_dwordx4 v18, s[12:15], s44 offen offset:2048 lds
    buffer_load_dwordx4 v19, s[12:15], s44 offen offset:3072 lds
    s_add_u32 s44, s44, 65536
    s_waitcnt vmcnt(3)
    buffer_load_dwordx4 v[128:131], v16, s[12:15], s44 offen offset:0
    buffer_load_dwordx4 v[132:135], v17, s[12:15], s44 offen offset:1024
    buffer_load_dwordx4 v[136:139], v18, s[12:15], s44 offen offset:2048
    buffer_load_dwordx4 v[140:143], v19, s[12:15], s44 offen offset:3072
    s_waitcnt vmcnt(3)
    s_add_u32 m0, s45, 12288
    s_xor_b32 s44, s46, 393216
    buffer_load_dwordx4 v16, s[12:15], s44 offen offset:0 lds
    buffer_load_dwordx4 v17, s[12:15], s44 offen offset:1024 lds
    buffer_load_dwordx4 v18, s[12:15], s44 offen offset:2048 lds
    buffer_load_dwordx4 v19, s[12:15], s44 offen offset:3072 lds
    s_add_u32 s44, s44, 65536
    s_waitcnt vmcnt(3)
    buffer_load_dwordx4 v[144:147], v16, s[12:15], s44 offen offset:0
    buffer_load_dwordx4 v[148:151], v17, s[12:15], s44 offen offset:1024
    buffer_load_dwordx4 v[152:155], v18, s[12:15], s44 offen offset:2048
    buffer_load_dwordx4 v[156:159], v19, s[12:15], s44 offen offset:3072
    s_waitcnt vmcnt(3)
    s_setprio 3
    s_sub_u32 s44, s54, 128
    s_mov_b32 s66, 0x10000
s_o0_poll:
    s_mov_b32 s68, 0
    s_atomic_add s68, s[22:23], s44 offset:0 glc
    s_sub_u32 s66, s66, 1
    s_cselect_b32 s67, 16, 0
    s_waitcnt lgkmcnt(0)
    s_max_u32 s68, s68, s67
    s_cmp_lt_u32 s68, 16
    s_cbranch_scc1 s_o0_poll
s_o0_ok:
    s_waitcnt vmcnt(0)
    s_branch s_bhead
s_b2:
    ds_write_b128 v24, v[96:99] offset:0
    ds_write_b128 v24, v[100:103] offset:1024
    ds_write_b128 v24, v[104:107] offset:2048
    ds_write_b128 v24, v[108:111] offset:3072
    ds_write_b128 v24, v[112:115] offset:4096
    ds_write_b128 v24, v[116:119] offset:5120
    ds_write_b128 v24, v[120:123] offset:6144
    ds_write_b128 v24, v[124:127] offset:7168
    ds_write_b128 v24, v[128:131] offset:8192
    ds_write_b128 v24, v[132:135] offset:9216
    ds_write_b128 v24, v[136:139] offset:10240
    ds_write_b128 v24, v[140:143] offset:11264
    ds_write_b128 v24, v[144:147] offset:12288
    ds_write_b128 v24, v[148:151] offset:13312
    ds_write_b128 v24, v[152:155] offset:14336
    ds_write_b128 v24, v[156:159] offset:15360
    s_mov_b32 s68, 1
    s_waitcnt vmcnt(0)
    s_atomic_add s68, s[22:23], s54 glc
    s_mov_b32 s66, 0x10000
    s_waitcnt lgkmcnt(0)
    s_cmp_eq_u32 s68, 15
    s_cbranch_scc1 s_o1_ok
s_o1_poll:
    s_mov_b32 s68, 0
    s_atomic_add s68, s[22:23], s54 offset:0 glc
    s_sub_u32 s66, s66, 1
    s_cselect_b32 s67, 16, 0
    s_waitcnt lgkmcnt(0)
    s_max_u32 s68, s68, s67
    s_cmp_lt_u32 s68, 16
    s_cbranch_scc1 s_o1_poll
s_o1_ok:
s_b3:
    s_setprio 0
    s_waitcnt lgkmcnt(0)
s_g3:
    s_barrier
    s_cmp_eq_u32 s21, 3
    s_cbranch_scc1 s_end
    s_barrier
    ds_write_b128 v9, v[160:163] offset:0
    ds_write_b128 v9, v[164:167] offset:4096
    ds_write_b128 v9, v[168:171] offset:8192
    ds_write_b128 v9, v[172:175] offset:12288
    ds_write_b128 v9, v[176:179] offset:16384
    ds_write_b128 v9, v[180:183] offset:20480
    ds_write_b128 v9, v[184:187] offset:24576
    ds_write_b128 v9, v[188:191] offset:28672
    s_add_u32 s21, s21, 1
    s_bitcmp1_b32 s21, 0
    s_cselect_b32 s8, s28, s24
    s_cselect_b32 s9, s29, s25
    s_cselect_b32 s12, s30, s26
    s_cselect_b32 s13, s31, s27
    s_mov_b32 s10, 6291456
    s_mov_b32 s11, 0x00020000
    s_mov_b32 s14, 2097152
    s_mov_b32 s15, 0x00020000
    s_sub_u32 s3, s16, 5
    s_cmp_gt_u32 s3, 1
    s_cbranch_scc1 s_n67
    s_add_u32 m0, s41, 65536
    s_add_u32 s44, s86, 200704
    buffer_load_dwordx4 v14, s[8:11], s44 offen offset:0 lds
    buffer_load_dwordx4 v15, s[8:11], s44 offen offset:1024 lds
    s_add_u32 m0, s41, 69632
    s_add_u32 s44, s86, 196608
    buffer_load_dwordx4 v14, s[8:11], s44 offen offset:0 lds
    buffer_load_dwordx4 v15, s[8:11], s44 offen offset:1024 lds
    s_add_u32 m0, s41, 73728
    s_add_u32 s44, s87, 2048
    buffer_load_dwordx4 v14, s[8:11], s44 offen offset:0 lds
    buffer_load_dwordx4 v15, s[8:11], s44 offen offset:1024 lds
    s_add_u32 m0, s41, 77824
    s_add_u32 s44, s87, 4096
    buffer_load_dwordx4 v14, s[8:11], s44 offen offset:0 lds
    buffer_load_dwordx4 v15, s[8:11], s44 offen offset:1024 lds
    s_add_u32 m0, s41, 81920
    s_add_u32 s44, s87, 0
    buffer_load_dwordx4 v14, s[8:11], s44 offen offset:0 lds
    buffer_load_dwordx4 v15, s[8:11], s44 offen offset:1024 lds
    s_add_u32 m0, s41, 86016
    s_add_u32 s44, s87, 198656
    buffer_load_dwordx4 v14, s[8:11], s44 offen offset:0 lds
    buffer_load_dwordx4 v15, s[8:11], s44 offen offset:1024 lds
    s_add_u32 m0, s41, 90112
    s_add_u32 s44, s87, 200704
    buffer_load_dwordx4 v14, s[8:11], s44 offen offset:0 lds
    buffer_load_dwordx4 v15, s[8:11], s44 offen offset:1024 lds
    s_add_u32 m0, s41, 94208
    s_add_u32 s44, s87, 196608
    buffer_load_dwordx4 v14, s[8:11], s44 offen offset:0 lds
    buffer_load_dwordx4 v15, s[8:11], s44 offen offset:1024 lds
    s_add_u32 m0, s41, 98304
    s_add_u32 s44, s88, 2048
    buffer_load_dwordx4 v14, s[8:11], s44 offen offset:0 lds
    buffer_load_dwordx4 v15, s[8:11], s44 offen offset:1024 lds
    s_add_u32 m0, s41, 102400
    s_add_u32 s44, s88, 4096
    buffer_load_dwordx4 v14, s[8:11], s44 offen offset:0 lds
    buffer_load_dwordx4 v15, s[8:11], s44 offen offset:1024 lds
    s_add_u32 m0, s41, 106496
    s_add_u32 s44, s88, 0
    buffer_load_dwordx4 v14, s[8:11], s44 offen offset:0 lds
    buffer_load_dwordx4 v15, s[8:11], s44 offen offset:1024 lds
    s_add_u32 m0, s41, 110592
    s_add_u32 s44, s88, 198656
    buffer_load_dwordx4 v14, s[8:11], s44 offen offset:0 lds
    buffer_load_dwordx4 v15, s[8:11], s44 offen offset:1024 lds
    s_add_u32 m0, s41, 114688
    s_add_u32 s44, s88, 200704
    buffer_load_dwordx4 v14, s[8:11], s44 offen offset:0 lds
    buffer_load_dwordx4 v15, s[8:11], s44 offen offset:1024 lds
    s_add_u32 m0, s41, 118784
    s_add_u32 s44, s88, 196608
    buffer_load_dwordx4 v14, s[8:11], s44 offen offset:0 lds
    buffer_load_dwordx4 v15, s[8:11], s44 offen offset:1024 lds
    s_add_u32 m0, s41, 122880
    s_add_u32 s44, s89, 2048
    buffer_load_dwordx4 v14, s[8:11], s44 offen offset:0 lds
    buffer_load_dwordx4 v15, s[8:11], s44 offen offset:1024 lds
    s_add_u32 m0, s41, 126976
    s_add_u32 s44, s89, 4096
    buffer_load_dwordx4 v14, s[8:11], s44 offen offset:0 lds
    buffer_load_dwordx4 v15, s[8:11], s44 offen offset:1024 lds
s_n67:
    s_waitcnt lgkmcnt(0)
    s_barrier
    ds_write_b128 v9, v[192:195] offset:32768
    ds_write_b128 v9, v[196:199] offset:36864
    ds_write_b128 v9, v[200:203] offset:40960
    ds_write_b128 v9, v[204:207] offset:45056
    ds_write_b128 v9, v[208:211] offset:49152
    ds_write_b128 v9, v[212:215] offset:53248
    ds_write_b128 v9, v[216:219] offset:57344
    ds_write_b128 v9, v[220:223] offset:61440
    s_cmp_eq_u32 s16, 4
    s_cbranch_scc1 h_layer
    s_cmp_eq_u32 s16, 7
    s_cbranch_scc1 z_layer
    s_branch l_layer
s_end:
    s_lshl_b32 s3, s2, 3
    s_add_u32 s3, s3, s16
    s_cmp_lg_u32 s3, 7
    s_cbranch_scc1 k_exit
    s_mov_b32 s8, s34
    s_mov_b32 s9, s35
    s_mov_b32 s10, 256
    s_mov_b32 s11, 0x00020000
    v_lshrrev_b32 v24, 2, v1
    v_mov_b32 v25, 0
    buffer_store_dword v25, v24, s[8:11], 0 offen sc1
    s_branch k_exit
s_slow:
    s_and_b32 s3, s16, 3
    s_lshl_b32 s44, s3, 11
    s_lshl_b32 s45, s52, 13
    s_add_u32 s44, s44, s45
    s_add_u32 s44, s44, 131072
    v_add_u32 v26, s44, v1
    ds_read_b128 v[48:51], v26 offset:0
    ds_read_b128 v[52:55], v26 offset:1024
    s_lshr_b32 s55, s21, 1
    s_lshl_b32 s55, s55, 23
    s_lshl_b32 s44, s18, 18
    s_add_u32 s55, s55, s44
    s_lshl_b32 s44, s52, 17
    s_add_u32 s55, s55, s44
    s_add_u32 s55, s55, 33554432
    s_waitcnt lgkmcnt(0)
    v_mov_b32 v26, 0xff800000
    s_mov_b32 s61, 0
s_slow1:
    s_add_u32 s44, s55, s61
    buffer_load_dwordx4 v[56:59], v1, s[4:7], s44 offen offset:0 sc1
    buffer_load_dwordx4 v[60:63], v1, s[4:7], s44 offen offset:1024 sc1
    s_waitcnt vmcnt(0)
    v_mfma_f32_32x32x16_bf16 v[72:87], v[56:59], v[48:51], 0
    v_mfma_f32_32x32x16_bf16 v[72:87], v[60:63], v[52:55], v[72:87]
    s_nop 11
    v_max3_f32 v26, v26, v72, v73
    v_max3_f32 v26, v26, v74, v75
    v_max3_f32 v26, v26, v76, v77
    v_max3_f32 v26, v26, v78, v79
    v_max3_f32 v26, v26, v80, v81
    v_max3_f32 v26, v26, v82, v83
    v_max3_f32 v26, v26, v84, v85
    v_max3_f32 v26, v26, v86, v87
    s_add_u32 s61, s61, 2048
    s_cmp_lt_u32 s61, 131072
    s_cbranch_scc1 s_slow1
    v_mov_b32 v27, v26
    s_nop 1
    v_permlane32_swap_b32 v26, v27
    v_max_f32 v26, v26, v27
    v_mov_b32 v32, 0
    v_mov_b32 v33, 0
    v_mov_b32 v34, 0
    v_mov_b32 v35, 0
    v_mov_b32 v36, 0
    v_mov_b32 v37, 0
    v_mov_b32 v38, 0
    v_mov_b32 v39, 0
    v_mov_b32 v40, 0
    v_mov_b32 v41, 0
    v_mov_b32 v42, 0
    v_mov_b32 v43, 0
    v_mov_b32 v44, 0
    v_mov_b32 v45, 0
    v_mov_b32 v46, 0
    v_mov_b32 v47, 0
    v_mov_b32 v28, 0
    v_mov_b32 v29, 0xdddddddd
    s_mov_b32 s3, 0xffff0000
    s_mov_b32 s61, 0
s_slow2:
    s_add_u32 s44, s55, s61
    buffer_load_dwordx4 v[56:59], v1, s[4:7], s44 offen offset:0 sc1
    buffer_load_dwordx4 v[60:63], v1, s[4:7], s44 offen offset:1024 sc1
    s_add_u32 s44, s44, 4194304
    buffer_load_dwordx4 v[64:67], v1, s[4:7], s44 offen offset:0 sc1
    buffer_load_dwordx4 v[68:71], v1, s[4:7], s44 offen offset:1024 sc1
    s_waitcnt vmcnt(0)
    v_mfma_f32_32x32x16_bf16 v[72:87], v[56:59], v[48:51], 0
    v_mfma_f32_32x32x16_bf16 v[72:87], v[60:63], v[52:55], v[72:87]
    s_nop 11
    v_sub_f32 v72, v72, v26
    v_sub_f32 v73, v73, v26
    v_sub_f32 v74, v74, v26
    v_sub_f32 v75, v75, v26
    v_sub_f32 v76, v76, v26
    v_sub_f32 v77, v77, v26
    v_sub_f32 v78, v78, v26
    v_sub_f32 v79, v79, v26
    v_sub_f32 v80, v80, v26
    v_sub_f32 v81, v81, v26
    v_sub_f32 v82, v82, v26
    v_sub_f32 v83, v83, v26
    v_sub_f32 v84, v84, v26
    v_sub_f32 v85, v85, v26
    v_sub_f32 v86, v86, v26
    v_sub_f32 v87, v87, v26
    v_exp_f32 v72, v72
    v_exp_f32 v73, v73
    v_exp_f32 v74, v74
    v_exp_f32 v75, v75
    v_exp_f32 v76, v76
    v_exp_f32 v77, v77
    v_exp_f32 v78, v78
    v_exp_f32 v79, v79
    v_exp_f32 v80, v80
    v_exp_f32 v81, v81
    v_exp_f32 v82, v82
    v_exp_f32 v83, v83
    v_exp_f32 v84, v84
    v_exp_f32 v85, v85
    v_exp_f32 v86, v86
    v_exp_f32 v87, v87
    v_and_b32 v72, s3, v72
    v_and_b32 v73, s3, v73
    v_and_b32 v74, s3, v74
    v_and_b32 v75, s3, v75
    v_and_b32 v76, s3, v76
    v_and_b32 v77, s3, v77
    v_and_b32 v78, s3, v78
    v_and_b32 v79, s3, v79
    v_and_b32 v80, s3, v80
    v_and_b32 v81, s3, v81
    v_and_b32 v82, s3, v82
    v_and_b32 v83, s3, v83
    v_and_b32 v84, s3, v84
    v_and_b32 v85, s3, v85
    v_and_b32 v86, s3, v86
    v_and_b32 v87, s3, v87
    v_add_f32 v28, v28, v72
    v_add_f32 v28, v28, v73
    v_add_f32 v28, v28, v74
    v_add_f32 v28, v28, v75
    v_add_f32 v28, v28, v76
    v_add_f32 v28, v28, v77
    v_add_f32 v28, v28, v78
    v_add_f32 v28, v28, v79
    v_add_f32 v28, v28, v80
    v_add_f32 v28, v28, v81
    v_add_f32 v28, v28, v82
    v_add_f32 v28, v28, v83
    v_add_f32 v28, v28, v84
    v_add_f32 v28, v28, v85
    v_add_f32 v28, v28, v86
    v_add_f32 v28, v28, v87
    v_smfmac_f32_32x32x32_bf16 v[32:47], v[64:67], v[72:79], v29
    v_smfmac_f32_32x32x32_bf16 v[32:47], v[68:71], v[80:87], v29
    s_add_u32 s61, s61, 2048
    s_cmp_lt_u32 s61, 131072
    s_cbranch_scc1 s_slow2
    v_mov_b32 v29, v28
    s_nop 1
    v_permlane32_swap_b32 v28, v29
    v_add_f32 v28, v28, v29
    v_rcp_f32 v28, v28
    s_nop 7
    s_branch s_fin
k_exit:
    s_endpgm
.if k_exit - interleave_layers__sliding_local_dilated__softmax_full_mha__prompt_kernel < 49152
.error "code prefetch reads past the end of the code"
.endif
.section .rodata,"a"
.p2align 6
.amdhsa_kernel interleave_layers__sliding_local_dilated__softmax_full_mha__prompt_kernel
  .amdhsa_next_free_vgpr 256
  .amdhsa_next_free_sgpr 102
  .amdhsa_accum_offset 256
  .amdhsa_group_segment_fixed_size 0
  .amdhsa_kernarg_size 72
  .amdhsa_user_sgpr_count 2
  .amdhsa_user_sgpr_kernarg_segment_ptr 1
  .amdhsa_system_sgpr_workgroup_id_x 1
.end_amdhsa_kernel
```
